```python
import torch

def _softmax(x, axis=-1):
    return torch.softmax(x, dim=axis)

def _gelu(x):
    return torch.nn.functional.gelu(x, approximate='tanh')

def _silu(x):
    return torch.nn.functional.silu(x)

def _sigmoid(x):
    return torch.sigmoid(x)

def _layernorm(x, axis=-1, eps=1e-05):
    m = x.mean(dim=axis, keepdim=True)
    v = x.var(dim=axis, keepdim=True, unbiased=False)
    return (x - m) / torch.sqrt(v + eps)

def _scatter_add(tgt, idx, src, axis=0):
    return tgt.clone().index_add_(axis, idx, src)

def _segment_sum(src, seg, n):
    out = torch.zeros((n,) + src.shape[1:], dtype=src.dtype)
    return out.index_add_(0, seg, src)

def _pad(x, pw):
    flat = tuple((v for pair in reversed(pw) for v in pair))
    return torch.nn.functional.pad(x, flat)
kernel_name = 'adaLN_cond__memory_aug_recurrent_mem_tr__dense_activation_gelu__prompt'

def setup_inputs():

    _w = lambda a: (lambda t: t.to(torch.bfloat16) if t.is_floating_point() else t)(torch.as_tensor(a))

    def _A_setup():
        B, S, Dm = (1, 2048, 1024)
        H, Dh = (32, 128)
        M, seg = (8, 32)
        seg = min(seg, S)
        S = S // seg * seg
        return {'x': _w((lambda *s: torch.randn(*s, dtype=torch.bfloat16) * 0.05)(B, S, Dm)), 'mem0': _w((lambda *s: torch.randn(*s, dtype=torch.bfloat16) * 0.8)(B, M, Dm)), 'Wq': _w((lambda *s: torch.randn(*s, dtype=torch.bfloat16) * 1.6)(Dm, H, Dh) * Dm ** (-0.5)), 'Wk': _w((lambda *s: torch.randn(*s, dtype=torch.bfloat16) * 1.6)(Dm, H, Dh) * Dm ** (-0.5)), 'Wv': _w((lambda *s: torch.randn(*s, dtype=torch.bfloat16) * 0.8)(Dm, H, Dh) * Dm ** (-0.5)), 'Wo': _w((lambda *s: torch.randn(*s, dtype=torch.bfloat16) * 0.8)(H, Dh, Dm) * (H * Dh) ** (-0.5)), 'seg_len': seg}
    _A_in = _A_setup()

    def _B_setup():
        B, S, D, F = (1, 2048, 1024, 3584)
        return {'x': _w((lambda *s: torch.randn(*s, dtype=torch.bfloat16) * 0.05)(B, S, D)), 'w1': _w((lambda *s: torch.randn(*s, dtype=torch.bfloat16) * 1.6)(D, F) * D ** (-0.5)), 'b1': _w((lambda *s: torch.randn(*s, dtype=torch.bfloat16) * 1.6)(F) * 0.01), 'w2': _w((lambda *s: torch.randn(*s, dtype=torch.bfloat16) * 0.2)(F, D) * F ** (-0.5)), 'b2': _w((lambda *s: torch.randn(*s, dtype=torch.bfloat16) * 0.2)(D) * 0.01)}
    _B_in = _B_setup()
    return {'A_x': _A_in['x'], 'A_mem0': _A_in['mem0'], 'A_Wq': _A_in['Wq'], 'A_Wk': _A_in['Wk'], 'A_Wv': _A_in['Wv'], 'A_Wo': _A_in['Wo'], 'A_seg_len': _A_in['seg_len'], 'B_x': _B_in['x'], 'B_w1': _B_in['w1'], 'B_b1': _B_in['b1'], 'B_w2': _B_in['w2'], 'B_b2': _B_in['b2'], 'c': _w((lambda *s: torch.randn(*s, dtype=torch.bfloat16) * 0.05)(1, 1024) * 8.0), 'w_mod': _w((lambda *s: torch.randn(*s, dtype=torch.bfloat16) * 0.05)(1024, 6 * 1024) * 1024 ** (-0.5) * 8.0)}

def reference(A_x, A_mem0, A_Wq, A_Wk, A_Wv, A_Wo, A_seg_len, B_x, B_w1, B_b1, B_w2, B_b2, c, w_mod):

    def _A_ref(x, mem0, Wq, Wk, Wv, Wo, seg_len):
        B, S, Dm = x.shape
        H, Dh = (Wq.shape[1], Wq.shape[2])
        M = mem0.shape[1]
        scale = Dh ** (-0.5)
        n_seg = S // seg_len
        L = M + seg_len
        idx = torch.arange(L)
        mask = (idx[:, None] < M) | (idx[:, None] >= idx[None, :])
        mem = mem0
        outs = []
        for s in range(n_seg):
            xs = x[:, s * seg_len:(s + 1) * seg_len, :].clone()
            h = torch.concatenate([mem, xs], axis=1)
            q = torch.einsum('btd,dhe->bhte', h, Wq)
            k = torch.einsum('btd,dhe->bhte', h, Wk)
            v = torch.einsum('btd,dhe->bhte', h, Wv)
            scores = torch.einsum('bhqe,bhke->bhqk', q, k) * scale
            scores = torch.where(mask[None, None], scores, -1000000000.0)
            p = _softmax(scores, axis=-1)
            o = torch.einsum('bhqk,bhke->bhqe', p, v)
            o = torch.einsum('bhte,hed->btd', o, Wo)
            mem = o[:, :M, :].clone()
            outs.append(o[:, M:, :])
        return torch.concatenate(outs, axis=1)

    def _B_ref(x, w1, b1, w2, b2):
        h = torch.einsum('bsd,df->bsf', x, w1) + b1
        h = _gelu(h)
        return torch.einsum('bsf,fd->bsd', h, w2) + b2
    x = A_x
    mod = (_silu(c) @ w_mod).reshape(c.shape[0], 6, 1, -1)
    sa, ca, ga, sb, cb, gb = (mod[:, 0].clone(), mod[:, 1].clone(), mod[:, 2].clone(), mod[:, 3].clone(), mod[:, 4].clone(), mod[:, 5].clone())
    h = _layernorm(x, axis=-1) * (1 + ca) + sa
    x = x + ga * _A_ref(h, A_mem0, A_Wq, A_Wk, A_Wv, A_Wo, A_seg_len)
    h = _layernorm(x, axis=-1) * (1 + cb) + sb
    x = x + gb * _B_ref(h, B_w1, B_b1, B_w2, B_b2)
    return x
```

```asm
; @launch kernel=k0_mod_kernel grid=(192,1,1) block=(256,1,1) lds=8192
; @launch kernel=k1_ln_kernel grid=(512,1,1) block=(256,1,1) lds=0
; @launch kernel=k2_qkv_kernel grid=(1536,1,1) block=(256,1,1) lds=65536
; @launch kernel=k3_chain_kernel grid=(256,1,1) block=(512,1,1) lds=147712
.amdgcn_target "amdgcn-amd-amdhsa--gfx950"
.text
.globl k0_mod_kernel
.p2align 8
.type k0_mod_kernel,@function
k0_mod_kernel:
    s_cmp_ge_u32 s2, 192
    s_cbranch_scc1 L_mod_done_1
    s_load_dwordx2 s[4:5], s[0:1], 96
    s_load_dwordx2 s[6:7], s[0:1], 104
    s_load_dwordx2 s[20:21], s[0:1], 128
    s_load_dwordx2 s[22:23], s[0:1], 8
    v_and_b32 v1, 3, v0
    v_lshrrev_b32 v2, 2, v0
    s_waitcnt lgkmcnt(0)
    s_mov_b32 s8, s4
    s_and_b32 s9, s5, 0xffff
    s_mov_b32 s10, 0x800
    s_mov_b32 s11, 0x00020000
    s_mov_b32 s12, s6
    s_and_b32 s13, s7, 0xffff
    s_mov_b32 s14, 0xc00000
    s_mov_b32 s15, 0x00020000
    s_mov_b32 s16, s20
    s_and_b32 s17, s21, 0xffff
    s_mov_b32 s18, 0x10000000
    s_mov_b32 s19, 0x00020000
    s_mov_b32 s32, s22
    s_and_b32 s33, s23, 0xffff
    s_mov_b32 s34, 0x4000
    s_mov_b32 s35, 0x00020000
    v_lshlrev_b32 v3, 5, v2
    buffer_load_dwordx4 v[8:11], v3, s[8:11], 0 offen
    buffer_load_dwordx4 v[12:15], v3, s[8:11], 0 offen offset:16
    s_mov_b32 s36, 196608
    v_mul_lo_u32 v4, v2, s36
    v_lshlrev_b32 v5, 4, v1
    v_add_u32 v4, v4, v5
    s_lshl_b32 s37, s2, 6
    buffer_load_dwordx4 v[32:35], v4, s[12:15], s37 offen
    v_add_u32 v4, 12288, v4
    buffer_load_dwordx4 v[36:39], v4, s[12:15], s37 offen
    v_add_u32 v4, 12288, v4
    buffer_load_dwordx4 v[40:43], v4, s[12:15], s37 offen
    v_add_u32 v4, 12288, v4
    buffer_load_dwordx4 v[44:47], v4, s[12:15], s37 offen
    v_add_u32 v4, 12288, v4
    buffer_load_dwordx4 v[48:51], v4, s[12:15], s37 offen
    v_add_u32 v4, 12288, v4
    buffer_load_dwordx4 v[52:55], v4, s[12:15], s37 offen
    v_add_u32 v4, 12288, v4
    buffer_load_dwordx4 v[56:59], v4, s[12:15], s37 offen
    v_add_u32 v4, 12288, v4
    buffer_load_dwordx4 v[60:63], v4, s[12:15], s37 offen
    v_add_u32 v4, 12288, v4
    buffer_load_dwordx4 v[64:67], v4, s[12:15], s37 offen
    v_add_u32 v4, 12288, v4
    buffer_load_dwordx4 v[68:71], v4, s[12:15], s37 offen
    v_add_u32 v4, 12288, v4
    buffer_load_dwordx4 v[72:75], v4, s[12:15], s37 offen
    v_add_u32 v4, 12288, v4
    buffer_load_dwordx4 v[76:79], v4, s[12:15], s37 offen
    v_add_u32 v4, 12288, v4
    buffer_load_dwordx4 v[80:83], v4, s[12:15], s37 offen
    v_add_u32 v4, 12288, v4
    buffer_load_dwordx4 v[84:87], v4, s[12:15], s37 offen
    v_add_u32 v4, 12288, v4
    buffer_load_dwordx4 v[88:91], v4, s[12:15], s37 offen
    v_add_u32 v4, 12288, v4
    buffer_load_dwordx4 v[92:95], v4, s[12:15], s37 offen
    s_load_dwordx4 s[40:43], s[0:1], 16
    s_load_dwordx2 s[44:45], s[0:1], 32
    s_lshl_b32 s38, s2, 12
    v_lshlrev_b32 v7, 4, v0
    v_add_u32 v7, s38, v7
    s_waitcnt lgkmcnt(0)
    s_mov_b32 s48, s40
    s_and_b32 s49, s41, 0xffff
    s_mov_b32 s50, 0x800000
    s_mov_b32 s51, 0x00020000
    s_mov_b32 s38, 0
    buffer_load_dwordx4 v[120:123], v7, s[48:51], s38 offen
    s_mov_b32 s38, 786432
    buffer_load_dwordx4 v[124:127], v7, s[48:51], s38 offen
    s_mov_b32 s38, 1572864
    buffer_load_dwordx4 v[120:123], v7, s[48:51], s38 offen
    s_mov_b32 s38, 2359296
    buffer_load_dwordx4 v[124:127], v7, s[48:51], s38 offen
    s_mov_b32 s38, 3145728
    buffer_load_dwordx4 v[120:123], v7, s[48:51], s38 offen
    s_mov_b32 s38, 3932160
    buffer_load_dwordx4 v[124:127], v7, s[48:51], s38 offen
    s_mov_b32 s38, 4718592
    buffer_load_dwordx4 v[120:123], v7, s[48:51], s38 offen
    s_mov_b32 s38, 5505024
    buffer_load_dwordx4 v[124:127], v7, s[48:51], s38 offen
    s_mov_b32 s38, 6291456
    buffer_load_dwordx4 v[120:123], v7, s[48:51], s38 offen
    s_mov_b32 s38, 7077888
    buffer_load_dwordx4 v[124:127], v7, s[48:51], s38 offen
    s_mov_b32 s38, 7864320
    buffer_load_dwordx4 v[120:123], v7, s[48:51], s38 offen
    s_mov_b32 s48, s42
    s_and_b32 s49, s43, 0xffff
    s_mov_b32 s50, 0x800000
    s_mov_b32 s51, 0x00020000
    s_mov_b32 s38, 0
    buffer_load_dwordx4 v[120:123], v7, s[48:51], s38 offen
    s_mov_b32 s38, 786432
    buffer_load_dwordx4 v[124:127], v7, s[48:51], s38 offen
    s_mov_b32 s38, 1572864
    buffer_load_dwordx4 v[120:123], v7, s[48:51], s38 offen
    s_mov_b32 s38, 2359296
    buffer_load_dwordx4 v[124:127], v7, s[48:51], s38 offen
    s_mov_b32 s38, 3145728
    buffer_load_dwordx4 v[120:123], v7, s[48:51], s38 offen
    s_mov_b32 s38, 3932160
    buffer_load_dwordx4 v[124:127], v7, s[48:51], s38 offen
    s_mov_b32 s38, 4718592
    buffer_load_dwordx4 v[120:123], v7, s[48:51], s38 offen
    s_mov_b32 s38, 5505024
    buffer_load_dwordx4 v[124:127], v7, s[48:51], s38 offen
    s_mov_b32 s38, 6291456
    buffer_load_dwordx4 v[120:123], v7, s[48:51], s38 offen
    s_mov_b32 s38, 7077888
    buffer_load_dwordx4 v[124:127], v7, s[48:51], s38 offen
    s_mov_b32 s38, 7864320
    buffer_load_dwordx4 v[120:123], v7, s[48:51], s38 offen
    s_cmp_ge_u32 s2, 12
    s_cbranch_scc1 L_mod_skipm_2
    s_lshl_b32 s38, s2, 12
    v_lshlrev_b32 v7, 4, v0
    v_add_u32 v7, s38, v7
    v_mov_b32 v104, 0
    v_mov_b32 v105, 0
    v_mov_b32 v106, 0
    v_mov_b32 v107, 0
    s_mov_b32 s39, 0x100000
    buffer_store_dwordx4 v[104:107], v7, s[16:19], s39 offen
L_mod_skipm_2:
    s_waitcnt vmcnt(0)
    v_lshlrev_b32 v16, 16, v8
    v_and_b32 v17, 0xffff0000, v8
    v_lshlrev_b32 v18, 16, v9
    v_and_b32 v19, 0xffff0000, v9
    v_lshlrev_b32 v20, 16, v10
    v_and_b32 v21, 0xffff0000, v10
    v_lshlrev_b32 v22, 16, v11
    v_and_b32 v23, 0xffff0000, v11
    v_lshlrev_b32 v24, 16, v12
    v_and_b32 v25, 0xffff0000, v12
    v_lshlrev_b32 v26, 16, v13
    v_and_b32 v27, 0xffff0000, v13
    v_lshlrev_b32 v28, 16, v14
    v_and_b32 v29, 0xffff0000, v14
    v_lshlrev_b32 v30, 16, v15
    v_and_b32 v31, 0xffff0000, v15
    v_mul_f32 v110, 0xbfb8aa3b, v16
    v_exp_f32 v110, v110
    s_nop 0
    v_add_f32 v110, 1.0, v110
    v_rcp_f32 v110, v110
    s_nop 0
    v_mul_f32 v16, v16, v110
    v_cvt_pk_bf16_f32 v16, v16, v16
    v_lshlrev_b32 v16, 16, v16
    v_mul_f32 v110, 0xbfb8aa3b, v17
    v_exp_f32 v110, v110
    s_nop 0
    v_add_f32 v110, 1.0, v110
    v_rcp_f32 v110, v110
    s_nop 0
    v_mul_f32 v17, v17, v110
    v_cvt_pk_bf16_f32 v17, v17, v17
    v_lshlrev_b32 v17, 16, v17
    v_mul_f32 v110, 0xbfb8aa3b, v18
    v_exp_f32 v110, v110
    s_nop 0
    v_add_f32 v110, 1.0, v110
    v_rcp_f32 v110, v110
    s_nop 0
    v_mul_f32 v18, v18, v110
    v_cvt_pk_bf16_f32 v18, v18, v18
    v_lshlrev_b32 v18, 16, v18
    v_mul_f32 v110, 0xbfb8aa3b, v19
    v_exp_f32 v110, v110
    s_nop 0
    v_add_f32 v110, 1.0, v110
    v_rcp_f32 v110, v110
    s_nop 0
    v_mul_f32 v19, v19, v110
    v_cvt_pk_bf16_f32 v19, v19, v19
    v_lshlrev_b32 v19, 16, v19
    v_mul_f32 v110, 0xbfb8aa3b, v20
    v_exp_f32 v110, v110
    s_nop 0
    v_add_f32 v110, 1.0, v110
    v_rcp_f32 v110, v110
    s_nop 0
    v_mul_f32 v20, v20, v110
    v_cvt_pk_bf16_f32 v20, v20, v20
    v_lshlrev_b32 v20, 16, v20
    v_mul_f32 v110, 0xbfb8aa3b, v21
    v_exp_f32 v110, v110
    s_nop 0
    v_add_f32 v110, 1.0, v110
    v_rcp_f32 v110, v110
    s_nop 0
    v_mul_f32 v21, v21, v110
    v_cvt_pk_bf16_f32 v21, v21, v21
    v_lshlrev_b32 v21, 16, v21
    v_mul_f32 v110, 0xbfb8aa3b, v22
    v_exp_f32 v110, v110
    s_nop 0
    v_add_f32 v110, 1.0, v110
    v_rcp_f32 v110, v110
    s_nop 0
    v_mul_f32 v22, v22, v110
    v_cvt_pk_bf16_f32 v22, v22, v22
    v_lshlrev_b32 v22, 16, v22
    v_mul_f32 v110, 0xbfb8aa3b, v23
    v_exp_f32 v110, v110
    s_nop 0
    v_add_f32 v110, 1.0, v110
    v_rcp_f32 v110, v110
    s_nop 0
    v_mul_f32 v23, v23, v110
    v_cvt_pk_bf16_f32 v23, v23, v23
    v_lshlrev_b32 v23, 16, v23
    v_mul_f32 v110, 0xbfb8aa3b, v24
    v_exp_f32 v110, v110
    s_nop 0
    v_add_f32 v110, 1.0, v110
    v_rcp_f32 v110, v110
    s_nop 0
    v_mul_f32 v24, v24, v110
    v_cvt_pk_bf16_f32 v24, v24, v24
    v_lshlrev_b32 v24, 16, v24
    v_mul_f32 v110, 0xbfb8aa3b, v25
    v_exp_f32 v110, v110
    s_nop 0
    v_add_f32 v110, 1.0, v110
    v_rcp_f32 v110, v110
    s_nop 0
    v_mul_f32 v25, v25, v110
    v_cvt_pk_bf16_f32 v25, v25, v25
    v_lshlrev_b32 v25, 16, v25
    v_mul_f32 v110, 0xbfb8aa3b, v26
    v_exp_f32 v110, v110
    s_nop 0
    v_add_f32 v110, 1.0, v110
    v_rcp_f32 v110, v110
    s_nop 0
    v_mul_f32 v26, v26, v110
    v_cvt_pk_bf16_f32 v26, v26, v26
    v_lshlrev_b32 v26, 16, v26
    v_mul_f32 v110, 0xbfb8aa3b, v27
    v_exp_f32 v110, v110
    s_nop 0
    v_add_f32 v110, 1.0, v110
    v_rcp_f32 v110, v110
    s_nop 0
    v_mul_f32 v27, v27, v110
    v_cvt_pk_bf16_f32 v27, v27, v27
    v_lshlrev_b32 v27, 16, v27
    v_mul_f32 v110, 0xbfb8aa3b, v28
    v_exp_f32 v110, v110
    s_nop 0
    v_add_f32 v110, 1.0, v110
    v_rcp_f32 v110, v110
    s_nop 0
    v_mul_f32 v28, v28, v110
    v_cvt_pk_bf16_f32 v28, v28, v28
    v_lshlrev_b32 v28, 16, v28
    v_mul_f32 v110, 0xbfb8aa3b, v29
    v_exp_f32 v110, v110
    s_nop 0
    v_add_f32 v110, 1.0, v110
    v_rcp_f32 v110, v110
    s_nop 0
    v_mul_f32 v29, v29, v110
    v_cvt_pk_bf16_f32 v29, v29, v29
    v_lshlrev_b32 v29, 16, v29
    v_mul_f32 v110, 0xbfb8aa3b, v30
    v_exp_f32 v110, v110
    s_nop 0
    v_add_f32 v110, 1.0, v110
    v_rcp_f32 v110, v110
    s_nop 0
    v_mul_f32 v30, v30, v110
    v_cvt_pk_bf16_f32 v30, v30, v30
    v_lshlrev_b32 v30, 16, v30
    v_mul_f32 v110, 0xbfb8aa3b, v31
    v_exp_f32 v110, v110
    s_nop 0
    v_add_f32 v110, 1.0, v110
    v_rcp_f32 v110, v110
    s_nop 0
    v_mul_f32 v31, v31, v110
    v_cvt_pk_bf16_f32 v31, v31, v31
    v_lshlrev_b32 v31, 16, v31
    v_mov_b32 v112, 0
    v_mov_b32 v113, 0
    v_mov_b32 v114, 0
    v_mov_b32 v115, 0
    v_mov_b32 v116, 0
    v_mov_b32 v117, 0
    v_mov_b32 v118, 0
    v_mov_b32 v119, 0
    v_lshlrev_b32 v110, 16, v32
    v_and_b32 v111, 0xffff0000, v32
    v_fmac_f32 v112, v110, v16
    v_fmac_f32 v113, v111, v16
    v_lshlrev_b32 v110, 16, v33
    v_and_b32 v111, 0xffff0000, v33
    v_fmac_f32 v114, v110, v16
    v_fmac_f32 v115, v111, v16
    v_lshlrev_b32 v110, 16, v34
    v_and_b32 v111, 0xffff0000, v34
    v_fmac_f32 v116, v110, v16
    v_fmac_f32 v117, v111, v16
    v_lshlrev_b32 v110, 16, v35
    v_and_b32 v111, 0xffff0000, v35
    v_fmac_f32 v118, v110, v16
    v_fmac_f32 v119, v111, v16
    v_lshlrev_b32 v110, 16, v36
    v_and_b32 v111, 0xffff0000, v36
    v_fmac_f32 v112, v110, v17
    v_fmac_f32 v113, v111, v17
    v_lshlrev_b32 v110, 16, v37
    v_and_b32 v111, 0xffff0000, v37
    v_fmac_f32 v114, v110, v17
    v_fmac_f32 v115, v111, v17
    v_lshlrev_b32 v110, 16, v38
    v_and_b32 v111, 0xffff0000, v38
    v_fmac_f32 v116, v110, v17
    v_fmac_f32 v117, v111, v17
    v_lshlrev_b32 v110, 16, v39
    v_and_b32 v111, 0xffff0000, v39
    v_fmac_f32 v118, v110, v17
    v_fmac_f32 v119, v111, v17
    v_lshlrev_b32 v110, 16, v40
    v_and_b32 v111, 0xffff0000, v40
    v_fmac_f32 v112, v110, v18
    v_fmac_f32 v113, v111, v18
    v_lshlrev_b32 v110, 16, v41
    v_and_b32 v111, 0xffff0000, v41
    v_fmac_f32 v114, v110, v18
    v_fmac_f32 v115, v111, v18
    v_lshlrev_b32 v110, 16, v42
    v_and_b32 v111, 0xffff0000, v42
    v_fmac_f32 v116, v110, v18
    v_fmac_f32 v117, v111, v18
    v_lshlrev_b32 v110, 16, v43
    v_and_b32 v111, 0xffff0000, v43
    v_fmac_f32 v118, v110, v18
    v_fmac_f32 v119, v111, v18
    v_lshlrev_b32 v110, 16, v44
    v_and_b32 v111, 0xffff0000, v44
    v_fmac_f32 v112, v110, v19
    v_fmac_f32 v113, v111, v19
    v_lshlrev_b32 v110, 16, v45
    v_and_b32 v111, 0xffff0000, v45
    v_fmac_f32 v114, v110, v19
    v_fmac_f32 v115, v111, v19
    v_lshlrev_b32 v110, 16, v46
    v_and_b32 v111, 0xffff0000, v46
    v_fmac_f32 v116, v110, v19
    v_fmac_f32 v117, v111, v19
    v_lshlrev_b32 v110, 16, v47
    v_and_b32 v111, 0xffff0000, v47
    v_fmac_f32 v118, v110, v19
    v_fmac_f32 v119, v111, v19
    v_lshlrev_b32 v110, 16, v48
    v_and_b32 v111, 0xffff0000, v48
    v_fmac_f32 v112, v110, v20
    v_fmac_f32 v113, v111, v20
    v_lshlrev_b32 v110, 16, v49
    v_and_b32 v111, 0xffff0000, v49
    v_fmac_f32 v114, v110, v20
    v_fmac_f32 v115, v111, v20
    v_lshlrev_b32 v110, 16, v50
    v_and_b32 v111, 0xffff0000, v50
    v_fmac_f32 v116, v110, v20
    v_fmac_f32 v117, v111, v20
    v_lshlrev_b32 v110, 16, v51
    v_and_b32 v111, 0xffff0000, v51
    v_fmac_f32 v118, v110, v20
    v_fmac_f32 v119, v111, v20
    v_lshlrev_b32 v110, 16, v52
    v_and_b32 v111, 0xffff0000, v52
    v_fmac_f32 v112, v110, v21
    v_fmac_f32 v113, v111, v21
    v_lshlrev_b32 v110, 16, v53
    v_and_b32 v111, 0xffff0000, v53
    v_fmac_f32 v114, v110, v21
    v_fmac_f32 v115, v111, v21
    v_lshlrev_b32 v110, 16, v54
    v_and_b32 v111, 0xffff0000, v54
    v_fmac_f32 v116, v110, v21
    v_fmac_f32 v117, v111, v21
    v_lshlrev_b32 v110, 16, v55
    v_and_b32 v111, 0xffff0000, v55
    v_fmac_f32 v118, v110, v21
    v_fmac_f32 v119, v111, v21
    v_lshlrev_b32 v110, 16, v56
    v_and_b32 v111, 0xffff0000, v56
    v_fmac_f32 v112, v110, v22
    v_fmac_f32 v113, v111, v22
    v_lshlrev_b32 v110, 16, v57
    v_and_b32 v111, 0xffff0000, v57
    v_fmac_f32 v114, v110, v22
    v_fmac_f32 v115, v111, v22
    v_lshlrev_b32 v110, 16, v58
    v_and_b32 v111, 0xffff0000, v58
    v_fmac_f32 v116, v110, v22
    v_fmac_f32 v117, v111, v22
    v_lshlrev_b32 v110, 16, v59
    v_and_b32 v111, 0xffff0000, v59
    v_fmac_f32 v118, v110, v22
    v_fmac_f32 v119, v111, v22
    v_lshlrev_b32 v110, 16, v60
    v_and_b32 v111, 0xffff0000, v60
    v_fmac_f32 v112, v110, v23
    v_fmac_f32 v113, v111, v23
    v_lshlrev_b32 v110, 16, v61
    v_and_b32 v111, 0xffff0000, v61
    v_fmac_f32 v114, v110, v23
    v_fmac_f32 v115, v111, v23
    v_lshlrev_b32 v110, 16, v62
    v_and_b32 v111, 0xffff0000, v62
    v_fmac_f32 v116, v110, v23
    v_fmac_f32 v117, v111, v23
    v_lshlrev_b32 v110, 16, v63
    v_and_b32 v111, 0xffff0000, v63
    v_fmac_f32 v118, v110, v23
    v_fmac_f32 v119, v111, v23
    v_lshlrev_b32 v110, 16, v64
    v_and_b32 v111, 0xffff0000, v64
    v_fmac_f32 v112, v110, v24
    v_fmac_f32 v113, v111, v24
    v_lshlrev_b32 v110, 16, v65
    v_and_b32 v111, 0xffff0000, v65
    v_fmac_f32 v114, v110, v24
    v_fmac_f32 v115, v111, v24
    v_lshlrev_b32 v110, 16, v66
    v_and_b32 v111, 0xffff0000, v66
    v_fmac_f32 v116, v110, v24
    v_fmac_f32 v117, v111, v24
    v_lshlrev_b32 v110, 16, v67
    v_and_b32 v111, 0xffff0000, v67
    v_fmac_f32 v118, v110, v24
    v_fmac_f32 v119, v111, v24
    v_lshlrev_b32 v110, 16, v68
    v_and_b32 v111, 0xffff0000, v68
    v_fmac_f32 v112, v110, v25
    v_fmac_f32 v113, v111, v25
    v_lshlrev_b32 v110, 16, v69
    v_and_b32 v111, 0xffff0000, v69
    v_fmac_f32 v114, v110, v25
    v_fmac_f32 v115, v111, v25
    v_lshlrev_b32 v110, 16, v70
    v_and_b32 v111, 0xffff0000, v70
    v_fmac_f32 v116, v110, v25
    v_fmac_f32 v117, v111, v25
    v_lshlrev_b32 v110, 16, v71
    v_and_b32 v111, 0xffff0000, v71
    v_fmac_f32 v118, v110, v25
    v_fmac_f32 v119, v111, v25
    v_lshlrev_b32 v110, 16, v72
    v_and_b32 v111, 0xffff0000, v72
    v_fmac_f32 v112, v110, v26
    v_fmac_f32 v113, v111, v26
    v_lshlrev_b32 v110, 16, v73
    v_and_b32 v111, 0xffff0000, v73
    v_fmac_f32 v114, v110, v26
    v_fmac_f32 v115, v111, v26
    v_lshlrev_b32 v110, 16, v74
    v_and_b32 v111, 0xffff0000, v74
    v_fmac_f32 v116, v110, v26
    v_fmac_f32 v117, v111, v26
    v_lshlrev_b32 v110, 16, v75
    v_and_b32 v111, 0xffff0000, v75
    v_fmac_f32 v118, v110, v26
    v_fmac_f32 v119, v111, v26
    v_lshlrev_b32 v110, 16, v76
    v_and_b32 v111, 0xffff0000, v76
    v_fmac_f32 v112, v110, v27
    v_fmac_f32 v113, v111, v27
    v_lshlrev_b32 v110, 16, v77
    v_and_b32 v111, 0xffff0000, v77
    v_fmac_f32 v114, v110, v27
    v_fmac_f32 v115, v111, v27
    v_lshlrev_b32 v110, 16, v78
    v_and_b32 v111, 0xffff0000, v78
    v_fmac_f32 v116, v110, v27
    v_fmac_f32 v117, v111, v27
    v_lshlrev_b32 v110, 16, v79
    v_and_b32 v111, 0xffff0000, v79
    v_fmac_f32 v118, v110, v27
    v_fmac_f32 v119, v111, v27
    v_lshlrev_b32 v110, 16, v80
    v_and_b32 v111, 0xffff0000, v80
    v_fmac_f32 v112, v110, v28
    v_fmac_f32 v113, v111, v28
    v_lshlrev_b32 v110, 16, v81
    v_and_b32 v111, 0xffff0000, v81
    v_fmac_f32 v114, v110, v28
    v_fmac_f32 v115, v111, v28
    v_lshlrev_b32 v110, 16, v82
    v_and_b32 v111, 0xffff0000, v82
    v_fmac_f32 v116, v110, v28
    v_fmac_f32 v117, v111, v28
    v_lshlrev_b32 v110, 16, v83
    v_and_b32 v111, 0xffff0000, v83
    v_fmac_f32 v118, v110, v28
    v_fmac_f32 v119, v111, v28
    v_lshlrev_b32 v110, 16, v84
    v_and_b32 v111, 0xffff0000, v84
    v_fmac_f32 v112, v110, v29
    v_fmac_f32 v113, v111, v29
    v_lshlrev_b32 v110, 16, v85
    v_and_b32 v111, 0xffff0000, v85
    v_fmac_f32 v114, v110, v29
    v_fmac_f32 v115, v111, v29
    v_lshlrev_b32 v110, 16, v86
    v_and_b32 v111, 0xffff0000, v86
    v_fmac_f32 v116, v110, v29
    v_fmac_f32 v117, v111, v29
    v_lshlrev_b32 v110, 16, v87
    v_and_b32 v111, 0xffff0000, v87
    v_fmac_f32 v118, v110, v29
    v_fmac_f32 v119, v111, v29
    v_lshlrev_b32 v110, 16, v88
    v_and_b32 v111, 0xffff0000, v88
    v_fmac_f32 v112, v110, v30
    v_fmac_f32 v113, v111, v30
    v_lshlrev_b32 v110, 16, v89
    v_and_b32 v111, 0xffff0000, v89
    v_fmac_f32 v114, v110, v30
    v_fmac_f32 v115, v111, v30
    v_lshlrev_b32 v110, 16, v90
    v_and_b32 v111, 0xffff0000, v90
    v_fmac_f32 v116, v110, v30
    v_fmac_f32 v117, v111, v30
    v_lshlrev_b32 v110, 16, v91
    v_and_b32 v111, 0xffff0000, v91
    v_fmac_f32 v118, v110, v30
    v_fmac_f32 v119, v111, v30
    v_lshlrev_b32 v110, 16, v92
    v_and_b32 v111, 0xffff0000, v92
    v_fmac_f32 v112, v110, v31
    v_fmac_f32 v113, v111, v31
    v_lshlrev_b32 v110, 16, v93
    v_and_b32 v111, 0xffff0000, v93
    v_fmac_f32 v114, v110, v31
    v_fmac_f32 v115, v111, v31
    v_lshlrev_b32 v110, 16, v94
    v_and_b32 v111, 0xffff0000, v94
    v_fmac_f32 v116, v110, v31
    v_fmac_f32 v117, v111, v31
    v_lshlrev_b32 v110, 16, v95
    v_and_b32 v111, 0xffff0000, v95
    v_fmac_f32 v118, v110, v31
    v_fmac_f32 v119, v111, v31
    v_lshlrev_b32 v3, 5, v0
    ds_write_b128 v3, v[112:115]
    ds_write_b128 v3, v[116:119] offset:16
    s_waitcnt lgkmcnt(0)
    s_barrier
    v_cmp_gt_u32 vcc, 32, v0
    s_and_saveexec_b64 s[40:41], vcc
    s_cbranch_execz L_mod_fin_3
    v_lshlrev_b32 v3, 2, v0
    v_mov_b32 v5, 0
    ds_read_b32 v32, v3 offset:0
    ds_read_b32 v33, v3 offset:128
    ds_read_b32 v34, v3 offset:256
    ds_read_b32 v35, v3 offset:384
    ds_read_b32 v36, v3 offset:512
    ds_read_b32 v37, v3 offset:640
    ds_read_b32 v38, v3 offset:768
    ds_read_b32 v39, v3 offset:896
    ds_read_b32 v40, v3 offset:1024
    ds_read_b32 v41, v3 offset:1152
    ds_read_b32 v42, v3 offset:1280
    ds_read_b32 v43, v3 offset:1408
    ds_read_b32 v44, v3 offset:1536
    ds_read_b32 v45, v3 offset:1664
    ds_read_b32 v46, v3 offset:1792
    ds_read_b32 v47, v3 offset:1920
    s_waitcnt lgkmcnt(0)
    v_add_f32 v5, v5, v32
    v_add_f32 v5, v5, v33
    v_add_f32 v5, v5, v34
    v_add_f32 v5, v5, v35
    v_add_f32 v5, v5, v36
    v_add_f32 v5, v5, v37
    v_add_f32 v5, v5, v38
    v_add_f32 v5, v5, v39
    v_add_f32 v5, v5, v40
    v_add_f32 v5, v5, v41
    v_add_f32 v5, v5, v42
    v_add_f32 v5, v5, v43
    v_add_f32 v5, v5, v44
    v_add_f32 v5, v5, v45
    v_add_f32 v5, v5, v46
    v_add_f32 v5, v5, v47
    ds_read_b32 v32, v3 offset:2048
    ds_read_b32 v33, v3 offset:2176
    ds_read_b32 v34, v3 offset:2304
    ds_read_b32 v35, v3 offset:2432
    ds_read_b32 v36, v3 offset:2560
    ds_read_b32 v37, v3 offset:2688
    ds_read_b32 v38, v3 offset:2816
    ds_read_b32 v39, v3 offset:2944
    ds_read_b32 v40, v3 offset:3072
    ds_read_b32 v41, v3 offset:3200
    ds_read_b32 v42, v3 offset:3328
    ds_read_b32 v43, v3 offset:3456
    ds_read_b32 v44, v3 offset:3584
    ds_read_b32 v45, v3 offset:3712
    ds_read_b32 v46, v3 offset:3840
    ds_read_b32 v47, v3 offset:3968
    s_waitcnt lgkmcnt(0)
    v_add_f32 v5, v5, v32
    v_add_f32 v5, v5, v33
    v_add_f32 v5, v5, v34
    v_add_f32 v5, v5, v35
    v_add_f32 v5, v5, v36
    v_add_f32 v5, v5, v37
    v_add_f32 v5, v5, v38
    v_add_f32 v5, v5, v39
    v_add_f32 v5, v5, v40
    v_add_f32 v5, v5, v41
    v_add_f32 v5, v5, v42
    v_add_f32 v5, v5, v43
    v_add_f32 v5, v5, v44
    v_add_f32 v5, v5, v45
    v_add_f32 v5, v5, v46
    v_add_f32 v5, v5, v47
    ds_read_b32 v32, v3 offset:4096
    ds_read_b32 v33, v3 offset:4224
    ds_read_b32 v34, v3 offset:4352
    ds_read_b32 v35, v3 offset:4480
    ds_read_b32 v36, v3 offset:4608
    ds_read_b32 v37, v3 offset:4736
    ds_read_b32 v38, v3 offset:4864
    ds_read_b32 v39, v3 offset:4992
    ds_read_b32 v40, v3 offset:5120
    ds_read_b32 v41, v3 offset:5248
    ds_read_b32 v42, v3 offset:5376
    ds_read_b32 v43, v3 offset:5504
    ds_read_b32 v44, v3 offset:5632
    ds_read_b32 v45, v3 offset:5760
    ds_read_b32 v46, v3 offset:5888
    ds_read_b32 v47, v3 offset:6016
    s_waitcnt lgkmcnt(0)
    v_add_f32 v5, v5, v32
    v_add_f32 v5, v5, v33
    v_add_f32 v5, v5, v34
    v_add_f32 v5, v5, v35
    v_add_f32 v5, v5, v36
    v_add_f32 v5, v5, v37
    v_add_f32 v5, v5, v38
    v_add_f32 v5, v5, v39
    v_add_f32 v5, v5, v40
    v_add_f32 v5, v5, v41
    v_add_f32 v5, v5, v42
    v_add_f32 v5, v5, v43
    v_add_f32 v5, v5, v44
    v_add_f32 v5, v5, v45
    v_add_f32 v5, v5, v46
    v_add_f32 v5, v5, v47
    ds_read_b32 v32, v3 offset:6144
    ds_read_b32 v33, v3 offset:6272
    ds_read_b32 v34, v3 offset:6400
    ds_read_b32 v35, v3 offset:6528
    ds_read_b32 v36, v3 offset:6656
    ds_read_b32 v37, v3 offset:6784
    ds_read_b32 v38, v3 offset:6912
    ds_read_b32 v39, v3 offset:7040
    ds_read_b32 v40, v3 offset:7168
    ds_read_b32 v41, v3 offset:7296
    ds_read_b32 v42, v3 offset:7424
    ds_read_b32 v43, v3 offset:7552
    ds_read_b32 v44, v3 offset:7680
    ds_read_b32 v45, v3 offset:7808
    ds_read_b32 v46, v3 offset:7936
    ds_read_b32 v47, v3 offset:8064
    s_waitcnt lgkmcnt(0)
    v_add_f32 v5, v5, v32
    v_add_f32 v5, v5, v33
    v_add_f32 v5, v5, v34
    v_add_f32 v5, v5, v35
    v_add_f32 v5, v5, v36
    v_add_f32 v5, v5, v37
    v_add_f32 v5, v5, v38
    v_add_f32 v5, v5, v39
    v_add_f32 v5, v5, v40
    v_add_f32 v5, v5, v41
    v_add_f32 v5, v5, v42
    v_add_f32 v5, v5, v43
    v_add_f32 v5, v5, v44
    v_add_f32 v5, v5, v45
    v_add_f32 v5, v5, v46
    v_add_f32 v5, v5, v47
    v_cvt_pk_bf16_f32 v5, v5, v5
    v_lshlrev_b32 v5, 16, v5
    s_lshl_b32 s38, s2, 7
    buffer_store_dword v5, v3, s[16:19], s38 offen
L_mod_fin_3:
    s_mov_b64 exec, s[40:41]
L_mod_done_1:
    s_endpgm
.globl k1_ln_kernel
.p2align 8
.type k1_ln_kernel,@function
k1_ln_kernel:
    s_cmp_ge_u32 s2, 512
    s_cbranch_scc1 L_ln_done_4
    s_load_dwordx2 s[4:5], s[0:1], 0
    s_load_dwordx2 s[20:21], s[0:1], 128
    v_lshrrev_b32 v1, 6, v0
    v_and_b32 v2, 63, v0
    s_waitcnt lgkmcnt(0)
    s_mov_b32 s8, s4
    s_and_b32 s9, s5, 0xffff
    s_mov_b32 s10, 0x400000
    s_mov_b32 s11, 0x00020000
    s_add_u32 s12, s20, 0x400000
    s_addc_u32 s13, s21, 0
    s_and_b32 s13, s13, 0xffff
    s_mov_b32 s14, 0x400000
    s_mov_b32 s15, 0x00020000
    s_mov_b32 s16, s20
    s_and_b32 s17, s21, 0xffff
    s_mov_b32 s18, 0x6000
    s_mov_b32 s19, 0x00020000
    s_lshl_b32 s25, s2, 12
    v_lshlrev_b32 v68, 4, v0
    v_add_u32 v68, s25, v68
    s_load_dwordx4 s[40:43], s[0:1], 16
    s_load_dwordx2 s[44:45], s[0:1], 32
    s_waitcnt lgkmcnt(0)
    s_mov_b32 s48, s44
    s_and_b32 s49, s45, 0xffff
    s_mov_b32 s50, 0x800000
    s_mov_b32 s51, 0x00020000
    s_mov_b32 s25, 0
    buffer_load_dwordx4 v[72:75], v68, s[48:51], s25 offen
    s_mov_b32 s25, 2097152
    buffer_load_dwordx4 v[76:79], v68, s[48:51], s25 offen
    s_mov_b32 s25, 4194304
    buffer_load_dwordx4 v[80:83], v68, s[48:51], s25 offen
    s_mov_b32 s25, 6291456
    buffer_load_dwordx4 v[84:87], v68, s[48:51], s25 offen
    s_lshl_b32 s22, s2, 13
    v_lshlrev_b32 v3, 11, v1
    v_lshlrev_b32 v4, 4, v2
    v_add_u32 v3, v3, v4
    buffer_load_dwordx4 v[8:11], v3, s[8:11], s22 offen
    buffer_load_dwordx4 v[12:15], v3, s[8:11], s22 offen offset:1024
    v_lshlrev_b32 v5, 5, v2
    s_mov_b32 s23, 0
    s_mov_b32 s24, 4096
    buffer_load_dwordx4 v[32:35], v5, s[16:19], s23 offen offset:0
    buffer_load_dwordx4 v[48:51], v5, s[16:19], s24 offen offset:0
    buffer_load_dwordx4 v[36:39], v5, s[16:19], s23 offen offset:16
    buffer_load_dwordx4 v[52:55], v5, s[16:19], s24 offen offset:16
    buffer_load_dwordx4 v[40:43], v5, s[16:19], s23 offen offset:2048
    buffer_load_dwordx4 v[56:59], v5, s[16:19], s24 offen offset:2048
    buffer_load_dwordx4 v[44:47], v5, s[16:19], s23 offen offset:2064
    buffer_load_dwordx4 v[60:63], v5, s[16:19], s24 offen offset:2064
    s_waitcnt vmcnt(8)
    v_lshlrev_b32 v16, 16, v8
    v_and_b32 v17, 0xffff0000, v8
    v_lshlrev_b32 v18, 16, v9
    v_and_b32 v19, 0xffff0000, v9
    v_lshlrev_b32 v20, 16, v10
    v_and_b32 v21, 0xffff0000, v10
    v_lshlrev_b32 v22, 16, v11
    v_and_b32 v23, 0xffff0000, v11
    v_lshlrev_b32 v24, 16, v12
    v_and_b32 v25, 0xffff0000, v12
    v_lshlrev_b32 v26, 16, v13
    v_and_b32 v27, 0xffff0000, v13
    v_lshlrev_b32 v28, 16, v14
    v_and_b32 v29, 0xffff0000, v14
    v_lshlrev_b32 v30, 16, v15
    v_and_b32 v31, 0xffff0000, v15
    v_add_f32 v6, v16, v17
    v_add_f32 v6, v6, v18
    v_add_f32 v6, v6, v19
    v_add_f32 v6, v6, v20
    v_add_f32 v6, v6, v21
    v_add_f32 v6, v6, v22
    v_add_f32 v6, v6, v23
    v_add_f32 v6, v6, v24
    v_add_f32 v6, v6, v25
    v_add_f32 v6, v6, v26
    v_add_f32 v6, v6, v27
    v_add_f32 v6, v6, v28
    v_add_f32 v6, v6, v29
    v_add_f32 v6, v6, v30
    v_add_f32 v6, v6, v31
    s_nop 1
    v_add_f32_dpp v6, v6, v6 row_shr:1 row_mask:0xf bank_mask:0xf bound_ctrl:0
    s_nop 1
    v_add_f32_dpp v6, v6, v6 row_shr:2 row_mask:0xf bank_mask:0xf bound_ctrl:0
    s_nop 1
    v_add_f32_dpp v6, v6, v6 row_shr:4 row_mask:0xf bank_mask:0xf bound_ctrl:0
    s_nop 1
    v_add_f32_dpp v6, v6, v6 row_shr:8 row_mask:0xf bank_mask:0xf bound_ctrl:0
    s_nop 1
    v_add_f32_dpp v6, v6, v6 row_bcast:15 row_mask:0xa bank_mask:0xf
    s_nop 1
    v_add_f32_dpp v6, v6, v6 row_bcast:31 row_mask:0xc bank_mask:0xf
    s_nop 1
    v_readlane_b32 s26, v6, 63
    v_mov_b32 v7, s26
    v_mul_f32 v7, 0x3a800000, v7
    v_mov_b32 v6, 0
    v_sub_f32 v64, v16, v7
    v_fmac_f32 v6, v64, v64
    v_sub_f32 v64, v17, v7
    v_fmac_f32 v6, v64, v64
    v_sub_f32 v64, v18, v7
    v_fmac_f32 v6, v64, v64
    v_sub_f32 v64, v19, v7
    v_fmac_f32 v6, v64, v64
    v_sub_f32 v64, v20, v7
    v_fmac_f32 v6, v64, v64
    v_sub_f32 v64, v21, v7
    v_fmac_f32 v6, v64, v64
    v_sub_f32 v64, v22, v7
    v_fmac_f32 v6, v64, v64
    v_sub_f32 v64, v23, v7
    v_fmac_f32 v6, v64, v64
    v_sub_f32 v64, v24, v7
    v_fmac_f32 v6, v64, v64
    v_sub_f32 v64, v25, v7
    v_fmac_f32 v6, v64, v64
    v_sub_f32 v64, v26, v7
    v_fmac_f32 v6, v64, v64
    v_sub_f32 v64, v27, v7
    v_fmac_f32 v6, v64, v64
    v_sub_f32 v64, v28, v7
    v_fmac_f32 v6, v64, v64
    v_sub_f32 v64, v29, v7
    v_fmac_f32 v6, v64, v64
    v_sub_f32 v64, v30, v7
    v_fmac_f32 v6, v64, v64
    v_sub_f32 v64, v31, v7
    v_fmac_f32 v6, v64, v64
    s_nop 1
    v_add_f32_dpp v6, v6, v6 row_shr:1 row_mask:0xf bank_mask:0xf bound_ctrl:0
    s_nop 1
    v_add_f32_dpp v6, v6, v6 row_shr:2 row_mask:0xf bank_mask:0xf bound_ctrl:0
    s_nop 1
    v_add_f32_dpp v6, v6, v6 row_shr:4 row_mask:0xf bank_mask:0xf bound_ctrl:0
    s_nop 1
    v_add_f32_dpp v6, v6, v6 row_shr:8 row_mask:0xf bank_mask:0xf bound_ctrl:0
    s_nop 1
    v_add_f32_dpp v6, v6, v6 row_bcast:15 row_mask:0xa bank_mask:0xf
    s_nop 1
    v_add_f32_dpp v6, v6, v6 row_bcast:31 row_mask:0xc bank_mask:0xf
    s_nop 1
    v_readlane_b32 s27, v6, 63
    v_mov_b32 v6, s27
    v_mul_f32 v6, 0x3a800000, v6
    v_cvt_pk_bf16_f32 v6, v6, v6
    v_lshlrev_b32 v6, 16, v6
    v_cvt_pk_bf16_f32 v7, v7, v7
    v_lshlrev_b32 v7, 16, v7
    v_add_f32 v6, 0x3727c5ac, v6
    v_cvt_pk_bf16_f32 v6, v6, v6
    v_lshlrev_b32 v6, 16, v6
    v_sqrt_f32 v6, v6
    s_nop 0
    v_cvt_pk_bf16_f32 v6, v6, v6
    v_lshlrev_b32 v6, 16, v6
    v_rcp_f32 v6, v6
    s_waitcnt vmcnt(0)
    v_sub_f32 v16, v16, v7
    v_cvt_pk_bf16_f32 v16, v16, v16
    v_lshlrev_b32 v16, 16, v16
    v_mul_f32 v16, v16, v6
    v_cvt_pk_bf16_f32 v16, v16, v16
    v_lshlrev_b32 v16, 16, v16
    v_add_f32 v64, 1.0, v48
    v_cvt_pk_bf16_f32 v64, v64, v64
    v_lshlrev_b32 v64, 16, v64
    v_mul_f32 v16, v16, v64
    v_cvt_pk_bf16_f32 v16, v16, v16
    v_lshlrev_b32 v16, 16, v16
    v_add_f32 v16, v16, v32
    v_sub_f32 v17, v17, v7
    v_cvt_pk_bf16_f32 v17, v17, v17
    v_lshlrev_b32 v17, 16, v17
    v_mul_f32 v17, v17, v6
    v_cvt_pk_bf16_f32 v17, v17, v17
    v_lshlrev_b32 v17, 16, v17
    v_add_f32 v64, 1.0, v49
    v_cvt_pk_bf16_f32 v64, v64, v64
    v_lshlrev_b32 v64, 16, v64
    v_mul_f32 v17, v17, v64
    v_cvt_pk_bf16_f32 v17, v17, v17
    v_lshlrev_b32 v17, 16, v17
    v_add_f32 v17, v17, v33
    v_sub_f32 v18, v18, v7
    v_cvt_pk_bf16_f32 v18, v18, v18
    v_lshlrev_b32 v18, 16, v18
    v_mul_f32 v18, v18, v6
    v_cvt_pk_bf16_f32 v18, v18, v18
    v_lshlrev_b32 v18, 16, v18
    v_add_f32 v64, 1.0, v50
    v_cvt_pk_bf16_f32 v64, v64, v64
    v_lshlrev_b32 v64, 16, v64
    v_mul_f32 v18, v18, v64
    v_cvt_pk_bf16_f32 v18, v18, v18
    v_lshlrev_b32 v18, 16, v18
    v_add_f32 v18, v18, v34
    v_sub_f32 v19, v19, v7
    v_cvt_pk_bf16_f32 v19, v19, v19
    v_lshlrev_b32 v19, 16, v19
    v_mul_f32 v19, v19, v6
    v_cvt_pk_bf16_f32 v19, v19, v19
    v_lshlrev_b32 v19, 16, v19
    v_add_f32 v64, 1.0, v51
    v_cvt_pk_bf16_f32 v64, v64, v64
    v_lshlrev_b32 v64, 16, v64
    v_mul_f32 v19, v19, v64
    v_cvt_pk_bf16_f32 v19, v19, v19
    v_lshlrev_b32 v19, 16, v19
    v_add_f32 v19, v19, v35
    v_sub_f32 v20, v20, v7
    v_cvt_pk_bf16_f32 v20, v20, v20
    v_lshlrev_b32 v20, 16, v20
    v_mul_f32 v20, v20, v6
    v_cvt_pk_bf16_f32 v20, v20, v20
    v_lshlrev_b32 v20, 16, v20
    v_add_f32 v64, 1.0, v52
    v_cvt_pk_bf16_f32 v64, v64, v64
    v_lshlrev_b32 v64, 16, v64
    v_mul_f32 v20, v20, v64
    v_cvt_pk_bf16_f32 v20, v20, v20
    v_lshlrev_b32 v20, 16, v20
    v_add_f32 v20, v20, v36
    v_sub_f32 v21, v21, v7
    v_cvt_pk_bf16_f32 v21, v21, v21
    v_lshlrev_b32 v21, 16, v21
    v_mul_f32 v21, v21, v6
    v_cvt_pk_bf16_f32 v21, v21, v21
    v_lshlrev_b32 v21, 16, v21
    v_add_f32 v64, 1.0, v53
    v_cvt_pk_bf16_f32 v64, v64, v64
    v_lshlrev_b32 v64, 16, v64
    v_mul_f32 v21, v21, v64
    v_cvt_pk_bf16_f32 v21, v21, v21
    v_lshlrev_b32 v21, 16, v21
    v_add_f32 v21, v21, v37
    v_sub_f32 v22, v22, v7
    v_cvt_pk_bf16_f32 v22, v22, v22
    v_lshlrev_b32 v22, 16, v22
    v_mul_f32 v22, v22, v6
    v_cvt_pk_bf16_f32 v22, v22, v22
    v_lshlrev_b32 v22, 16, v22
    v_add_f32 v64, 1.0, v54
    v_cvt_pk_bf16_f32 v64, v64, v64
    v_lshlrev_b32 v64, 16, v64
    v_mul_f32 v22, v22, v64
    v_cvt_pk_bf16_f32 v22, v22, v22
    v_lshlrev_b32 v22, 16, v22
    v_add_f32 v22, v22, v38
    v_sub_f32 v23, v23, v7
    v_cvt_pk_bf16_f32 v23, v23, v23
    v_lshlrev_b32 v23, 16, v23
    v_mul_f32 v23, v23, v6
    v_cvt_pk_bf16_f32 v23, v23, v23
    v_lshlrev_b32 v23, 16, v23
    v_add_f32 v64, 1.0, v55
    v_cvt_pk_bf16_f32 v64, v64, v64
    v_lshlrev_b32 v64, 16, v64
    v_mul_f32 v23, v23, v64
    v_cvt_pk_bf16_f32 v23, v23, v23
    v_lshlrev_b32 v23, 16, v23
    v_add_f32 v23, v23, v39
    v_sub_f32 v24, v24, v7
    v_cvt_pk_bf16_f32 v24, v24, v24
    v_lshlrev_b32 v24, 16, v24
    v_mul_f32 v24, v24, v6
    v_cvt_pk_bf16_f32 v24, v24, v24
    v_lshlrev_b32 v24, 16, v24
    v_add_f32 v64, 1.0, v56
    v_cvt_pk_bf16_f32 v64, v64, v64
    v_lshlrev_b32 v64, 16, v64
    v_mul_f32 v24, v24, v64
    v_cvt_pk_bf16_f32 v24, v24, v24
    v_lshlrev_b32 v24, 16, v24
    v_add_f32 v24, v24, v40
    v_sub_f32 v25, v25, v7
    v_cvt_pk_bf16_f32 v25, v25, v25
    v_lshlrev_b32 v25, 16, v25
    v_mul_f32 v25, v25, v6
    v_cvt_pk_bf16_f32 v25, v25, v25
    v_lshlrev_b32 v25, 16, v25
    v_add_f32 v64, 1.0, v57
    v_cvt_pk_bf16_f32 v64, v64, v64
    v_lshlrev_b32 v64, 16, v64
    v_mul_f32 v25, v25, v64
    v_cvt_pk_bf16_f32 v25, v25, v25
    v_lshlrev_b32 v25, 16, v25
    v_add_f32 v25, v25, v41
    v_sub_f32 v26, v26, v7
    v_cvt_pk_bf16_f32 v26, v26, v26
    v_lshlrev_b32 v26, 16, v26
    v_mul_f32 v26, v26, v6
    v_cvt_pk_bf16_f32 v26, v26, v26
    v_lshlrev_b32 v26, 16, v26
    v_add_f32 v64, 1.0, v58
    v_cvt_pk_bf16_f32 v64, v64, v64
    v_lshlrev_b32 v64, 16, v64
    v_mul_f32 v26, v26, v64
    v_cvt_pk_bf16_f32 v26, v26, v26
    v_lshlrev_b32 v26, 16, v26
    v_add_f32 v26, v26, v42
    v_sub_f32 v27, v27, v7
    v_cvt_pk_bf16_f32 v27, v27, v27
    v_lshlrev_b32 v27, 16, v27
    v_mul_f32 v27, v27, v6
    v_cvt_pk_bf16_f32 v27, v27, v27
    v_lshlrev_b32 v27, 16, v27
    v_add_f32 v64, 1.0, v59
    v_cvt_pk_bf16_f32 v64, v64, v64
    v_lshlrev_b32 v64, 16, v64
    v_mul_f32 v27, v27, v64
    v_cvt_pk_bf16_f32 v27, v27, v27
    v_lshlrev_b32 v27, 16, v27
    v_add_f32 v27, v27, v43
    v_sub_f32 v28, v28, v7
    v_cvt_pk_bf16_f32 v28, v28, v28
    v_lshlrev_b32 v28, 16, v28
    v_mul_f32 v28, v28, v6
    v_cvt_pk_bf16_f32 v28, v28, v28
    v_lshlrev_b32 v28, 16, v28
    v_add_f32 v64, 1.0, v60
    v_cvt_pk_bf16_f32 v64, v64, v64
    v_lshlrev_b32 v64, 16, v64
    v_mul_f32 v28, v28, v64
    v_cvt_pk_bf16_f32 v28, v28, v28
    v_lshlrev_b32 v28, 16, v28
    v_add_f32 v28, v28, v44
    v_sub_f32 v29, v29, v7
    v_cvt_pk_bf16_f32 v29, v29, v29
    v_lshlrev_b32 v29, 16, v29
    v_mul_f32 v29, v29, v6
    v_cvt_pk_bf16_f32 v29, v29, v29
    v_lshlrev_b32 v29, 16, v29
    v_add_f32 v64, 1.0, v61
    v_cvt_pk_bf16_f32 v64, v64, v64
    v_lshlrev_b32 v64, 16, v64
    v_mul_f32 v29, v29, v64
    v_cvt_pk_bf16_f32 v29, v29, v29
    v_lshlrev_b32 v29, 16, v29
    v_add_f32 v29, v29, v45
    v_sub_f32 v30, v30, v7
    v_cvt_pk_bf16_f32 v30, v30, v30
    v_lshlrev_b32 v30, 16, v30
    v_mul_f32 v30, v30, v6
    v_cvt_pk_bf16_f32 v30, v30, v30
    v_lshlrev_b32 v30, 16, v30
    v_add_f32 v64, 1.0, v62
    v_cvt_pk_bf16_f32 v64, v64, v64
    v_lshlrev_b32 v64, 16, v64
    v_mul_f32 v30, v30, v64
    v_cvt_pk_bf16_f32 v30, v30, v30
    v_lshlrev_b32 v30, 16, v30
    v_add_f32 v30, v30, v46
    v_sub_f32 v31, v31, v7
    v_cvt_pk_bf16_f32 v31, v31, v31
    v_lshlrev_b32 v31, 16, v31
    v_mul_f32 v31, v31, v6
    v_cvt_pk_bf16_f32 v31, v31, v31
    v_lshlrev_b32 v31, 16, v31
    v_add_f32 v64, 1.0, v63
    v_cvt_pk_bf16_f32 v64, v64, v64
    v_lshlrev_b32 v64, 16, v64
    v_mul_f32 v31, v31, v64
    v_cvt_pk_bf16_f32 v31, v31, v31
    v_lshlrev_b32 v31, 16, v31
    v_add_f32 v31, v31, v47
    v_cvt_pk_bf16_f32 v8, v16, v17
    v_cvt_pk_bf16_f32 v9, v18, v19
    v_cvt_pk_bf16_f32 v10, v20, v21
    v_cvt_pk_bf16_f32 v11, v22, v23
    v_cvt_pk_bf16_f32 v12, v24, v25
    v_cvt_pk_bf16_f32 v13, v26, v27
    v_cvt_pk_bf16_f32 v14, v28, v29
    v_cvt_pk_bf16_f32 v15, v30, v31
    buffer_store_dwordx4 v[8:11], v3, s[12:15], s22 offen
    buffer_store_dwordx4 v[12:15], v3, s[12:15], s22 offen offset:1024
L_ln_done_4:
    s_endpgm
.globl k2_qkv_kernel
.p2align 8
.type k2_qkv_kernel,@function
k2_qkv_kernel:
    s_cmp_ge_u32 s2, 1536
    s_cbranch_scc1 L_g_done_5
    s_load_dwordx2 s[20:21], s[0:1], 128
    s_and_b32 s42, s2, 7
    s_lshr_b32 s43, s2, 3
    s_and_b32 s40, s43, 15
    s_lshr_b32 s41, s43, 4
    s_lshl_b32 s41, s41, 3
    s_add_u32 s41, s41, s42
    s_lshr_b32 s42, s41, 5
    s_lshl_b32 s42, s42, 3
    s_add_u32 s42, s42, 16
    s_load_dwordx2 s[6:7], s[0:1], s42
    s_and_b32 s43, s41, 31
    v_and_b32 v1, 63, v0
    v_lshrrev_b32 v2, 6, v0
    s_nop 0
    v_readfirstlane_b32 s44, v2
    s_waitcnt lgkmcnt(0)
    s_add_u32 s8, s20, 0x400000
    s_addc_u32 s9, s21, 0
    s_and_b32 s9, s9, 0xffff
    s_mov_b32 s10, 0x400000
    s_mov_b32 s11, 0x00020000
    s_mov_b32 s12, s6
    s_and_b32 s13, s7, 0xffff
    s_mov_b32 s14, 0x800000
    s_mov_b32 s15, 0x00020000
    s_add_u32 s16, s20, 0x2000000
    s_addc_u32 s17, s21, 0
    s_and_b32 s17, s17, 0xffff
    s_mov_b32 s18, 0x3000000
    s_mov_b32 s19, 0x00020000
    v_lshrrev_b32 v3, 2, v1
    s_lshl_b32 s45, s44, 5
    v_add_u32 v3, s45, v3
    v_and_b32 v4, 3, v1
    s_lshl_b32 s46, s40, 7
    s_mov_b32 s47, 2048
    v_add_u32 v5, 0, v3
    v_lshrrev_b32 v6, 2, v5
    v_and_b32 v6, 3, v6
    v_xor_b32 v6, v6, v4
    v_lshlrev_b32 v6, 4, v6
    v_add_u32 v5, s46, v5
    v_mul_lo_u32 v5, v5, s47
    v_add_u32 v10, v5, v6
    v_add_u32 v5, 16, v3
    v_lshrrev_b32 v6, 2, v5
    v_and_b32 v6, 3, v6
    v_xor_b32 v6, v6, v4
    v_lshlrev_b32 v6, 4, v6
    v_add_u32 v5, s46, v5
    v_mul_lo_u32 v5, v5, s47
    v_add_u32 v11, v5, v6
    v_lshrrev_b32 v3, 4, v1
    s_mul_i32 s45, s44, 8
    v_add_u32 v3, s45, v3
    v_and_b32 v4, 15, v1
    s_lshl_b32 s46, s43, 8
    s_mov_b32 s47, 8192
    v_add_u32 v5, 0, v3
    v_and_b32 v6, 3, v5
    v_lshlrev_b32 v6, 2, v6
    v_xor_b32 v6, v6, v4
    v_lshlrev_b32 v6, 4, v6
    v_mul_lo_u32 v5, v5, s47
    v_add_u32 v5, s46, v5
    v_add_u32 v14, v5, v6
    v_add_u32 v5, 4, v3
    v_and_b32 v6, 3, v5
    v_lshlrev_b32 v6, 2, v6
    v_xor_b32 v6, v6, v4
    v_lshlrev_b32 v6, 4, v6
    v_mul_lo_u32 v5, v5, s47
    v_add_u32 v5, s46, v5
    v_add_u32 v15, v5, v6
    s_lshr_b32 s48, s44, 1
    s_and_b32 s49, s44, 1
    v_and_b32 v3, 31, v1
    s_lshl_b32 s45, s48, 6
    v_add_u32 v3, s45, v3
    v_lshrrev_b32 v4, 2, v3
    v_and_b32 v4, 3, v4
    v_lshrrev_b32 v5, 5, v1
    v_lshlrev_b32 v3, 6, v3
    v_add_u32 v6, 0, v5
    v_xor_b32 v6, v6, v4
    v_lshlrev_b32 v6, 4, v6
    v_add_u32 v18, v3, v6
    v_add_u32 v6, 2, v5
    v_xor_b32 v6, v6, v4
    v_lshlrev_b32 v6, 4, v6
    v_add_u32 v19, v3, v6
    v_lshrrev_b32 v3, 5, v1
    v_lshlrev_b32 v3, 3, v3
    v_bfe_u32 v4, v1, 2, 2
    v_add_u32 v3, v3, v4
    v_bfe_u32 v5, v1, 4, 1
    v_lshlrev_b32 v5, 4, v5
    v_and_b32 v6, 3, v1
    v_lshlrev_b32 v6, 2, v6
    v_add_u32 v5, v5, v6
    s_mul_i32 s45, s49, 64
    v_add_u32 v5, s45, v5
    v_lshlrev_b32 v7, 2, v4
    v_mul_u32_u24 v3, 256, v3
    v_add_u32 v6, 0, v5
    v_lshrrev_b32 v8, 3, v6
    v_xor_b32 v8, v8, v7
    v_lshlrev_b32 v8, 4, v8
    v_and_b32 v6, 4, v6
    v_lshlrev_b32 v6, 1, v6
    v_add_u32 v8, v8, v6
    v_add_u32 v22, v3, v8
    v_add_u32 v6, 32, v5
    v_lshrrev_b32 v8, 3, v6
    v_xor_b32 v8, v8, v7
    v_lshlrev_b32 v8, 4, v8
    v_and_b32 v6, 4, v6
    v_lshlrev_b32 v6, 1, v6
    v_add_u32 v8, v8, v6
    v_add_u32 v23, v3, v8
    v_mov_b32 v64, 0
    v_mov_b32 v65, 0
    v_mov_b32 v66, 0
    v_mov_b32 v67, 0
    v_mov_b32 v68, 0
    v_mov_b32 v69, 0
    v_mov_b32 v70, 0
    v_mov_b32 v71, 0
    v_mov_b32 v72, 0
    v_mov_b32 v73, 0
    v_mov_b32 v74, 0
    v_mov_b32 v75, 0
    v_mov_b32 v76, 0
    v_mov_b32 v77, 0
    v_mov_b32 v78, 0
    v_mov_b32 v79, 0
    v_mov_b32 v80, 0
    v_mov_b32 v81, 0
    v_mov_b32 v82, 0
    v_mov_b32 v83, 0
    v_mov_b32 v84, 0
    v_mov_b32 v85, 0
    v_mov_b32 v86, 0
    v_mov_b32 v87, 0
    v_mov_b32 v88, 0
    v_mov_b32 v89, 0
    v_mov_b32 v90, 0
    v_mov_b32 v91, 0
    v_mov_b32 v92, 0
    v_mov_b32 v93, 0
    v_mov_b32 v94, 0
    v_mov_b32 v95, 0
    v_mov_b32 v96, 0
    v_mov_b32 v97, 0
    v_mov_b32 v98, 0
    v_mov_b32 v99, 0
    v_mov_b32 v100, 0
    v_mov_b32 v101, 0
    v_mov_b32 v102, 0
    v_mov_b32 v103, 0
    v_mov_b32 v104, 0
    v_mov_b32 v105, 0
    v_mov_b32 v106, 0
    v_mov_b32 v107, 0
    v_mov_b32 v108, 0
    v_mov_b32 v109, 0
    v_mov_b32 v110, 0
    v_mov_b32 v111, 0
    v_mov_b32 v112, 0
    v_mov_b32 v113, 0
    v_mov_b32 v114, 0
    v_mov_b32 v115, 0
    v_mov_b32 v116, 0
    v_mov_b32 v117, 0
    v_mov_b32 v118, 0
    v_mov_b32 v119, 0
    v_mov_b32 v120, 0
    v_mov_b32 v121, 0
    v_mov_b32 v122, 0
    v_mov_b32 v123, 0
    v_mov_b32 v124, 0
    v_mov_b32 v125, 0
    v_mov_b32 v126, 0
    v_mov_b32 v127, 0
    s_mov_b32 s50, 0
    s_mov_b32 s51, 0
    s_lshl_b32 s52, s44, 11
    s_mul_i32 s53, s44, 2048
    s_add_u32 s53, s53, 8192
    s_add_u32 m0, s52, 0
    s_nop 0
    buffer_load_dwordx4 v10, s[8:11], s50 offen lds
    s_add_u32 m0, s52, 1024
    s_nop 0
    buffer_load_dwordx4 v11, s[8:11], s50 offen lds
    s_add_u32 m0, s53, 0
    s_nop 0
    buffer_load_dwordx4 v14, s[12:15], s51 offen lds
    s_add_u32 m0, s53, 1024
    s_nop 0
    buffer_load_dwordx4 v15, s[12:15], s51 offen lds
    s_add_u32 s50, s50, 64
    s_add_u32 s51, s51, 262144
    s_add_u32 m0, s52, 16384
    s_nop 0
    buffer_load_dwordx4 v10, s[8:11], s50 offen lds
    s_add_u32 m0, s52, 17408
    s_nop 0
    buffer_load_dwordx4 v11, s[8:11], s50 offen lds
    s_add_u32 m0, s53, 16384
    s_nop 0
    buffer_load_dwordx4 v14, s[12:15], s51 offen lds
    s_add_u32 m0, s53, 17408
    s_nop 0
    buffer_load_dwordx4 v15, s[12:15], s51 offen lds
    s_add_u32 s50, s50, 64
    s_add_u32 s51, s51, 262144
    s_add_u32 m0, s52, 32768
    s_nop 0
    buffer_load_dwordx4 v10, s[8:11], s50 offen lds
    s_add_u32 m0, s52, 33792
    s_nop 0
    buffer_load_dwordx4 v11, s[8:11], s50 offen lds
    s_add_u32 m0, s53, 32768
    s_nop 0
    buffer_load_dwordx4 v14, s[12:15], s51 offen lds
    s_add_u32 m0, s53, 33792
    s_nop 0
    buffer_load_dwordx4 v15, s[12:15], s51 offen lds
    s_add_u32 s50, s50, 64
    s_add_u32 s51, s51, 262144
    s_mov_b32 s54, 0
L_g_loop_6:
    s_waitcnt vmcnt(8)
    s_barrier
    ds_read_b128 v[26:29], v18 offset:0
    ds_read_b128 v[30:33], v18 offset:2048
    ds_read_b64_tr_b16 v[34:35], v22 offset:8192
    ds_read_b64_tr_b16 v[36:37], v22 offset:9216
    ds_read_b64_tr_b16 v[38:39], v23 offset:8192
    ds_read_b64_tr_b16 v[40:41], v23 offset:9216
    ds_read_b128 v[42:45], v19 offset:0
    ds_read_b128 v[46:49], v19 offset:2048
    ds_read_b64_tr_b16 v[50:51], v22 offset:12288
    ds_read_b64_tr_b16 v[52:53], v22 offset:13312
    ds_read_b64_tr_b16 v[54:55], v23 offset:12288
    ds_read_b64_tr_b16 v[56:57], v23 offset:13312
    s_add_u32 m0, s52, 49152
    s_nop 0
    buffer_load_dwordx4 v10, s[8:11], s50 offen lds
    s_add_u32 m0, s52, 50176
    s_nop 0
    buffer_load_dwordx4 v11, s[8:11], s50 offen lds
    s_add_u32 m0, s53, 49152
    s_nop 0
    buffer_load_dwordx4 v14, s[12:15], s51 offen lds
    s_add_u32 m0, s53, 50176
    s_nop 0
    buffer_load_dwordx4 v15, s[12:15], s51 offen lds
    s_add_u32 s50, s50, 64
    s_add_u32 s51, s51, 262144
    s_waitcnt lgkmcnt(6)
    v_mfma_f32_32x32x16_bf16 v[64:79], v[34:37], v[26:29], v[64:79]
    v_mfma_f32_32x32x16_bf16 v[80:95], v[38:41], v[26:29], v[80:95]
    v_mfma_f32_32x32x16_bf16 v[96:111], v[34:37], v[30:33], v[96:111]
    v_mfma_f32_32x32x16_bf16 v[112:127], v[38:41], v[30:33], v[112:127]
    s_waitcnt lgkmcnt(0)
    v_mfma_f32_32x32x16_bf16 v[64:79], v[50:53], v[42:45], v[64:79]
    v_mfma_f32_32x32x16_bf16 v[80:95], v[54:57], v[42:45], v[80:95]
    v_mfma_f32_32x32x16_bf16 v[96:111], v[50:53], v[46:49], v[96:111]
    v_mfma_f32_32x32x16_bf16 v[112:127], v[54:57], v[46:49], v[112:127]
    s_waitcnt vmcnt(8)
    s_barrier
    ds_read_b128 v[26:29], v18 offset:16384
    ds_read_b128 v[30:33], v18 offset:18432
    ds_read_b64_tr_b16 v[34:35], v22 offset:24576
    ds_read_b64_tr_b16 v[36:37], v22 offset:25600
    ds_read_b64_tr_b16 v[38:39], v23 offset:24576
    ds_read_b64_tr_b16 v[40:41], v23 offset:25600
    ds_read_b128 v[42:45], v19 offset:16384
    ds_read_b128 v[46:49], v19 offset:18432
    ds_read_b64_tr_b16 v[50:51], v22 offset:28672
    ds_read_b64_tr_b16 v[52:53], v22 offset:29696
    ds_read_b64_tr_b16 v[54:55], v23 offset:28672
    ds_read_b64_tr_b16 v[56:57], v23 offset:29696
    s_add_u32 m0, s52, 0
    s_nop 0
    buffer_load_dwordx4 v10, s[8:11], s50 offen lds
    s_add_u32 m0, s52, 1024
    s_nop 0
    buffer_load_dwordx4 v11, s[8:11], s50 offen lds
    s_add_u32 m0, s53, 0
    s_nop 0
    buffer_load_dwordx4 v14, s[12:15], s51 offen lds
    s_add_u32 m0, s53, 1024
    s_nop 0
    buffer_load_dwordx4 v15, s[12:15], s51 offen lds
    s_add_u32 s50, s50, 64
    s_add_u32 s51, s51, 262144
    s_waitcnt lgkmcnt(6)
    v_mfma_f32_32x32x16_bf16 v[64:79], v[34:37], v[26:29], v[64:79]
    v_mfma_f32_32x32x16_bf16 v[80:95], v[38:41], v[26:29], v[80:95]
    v_mfma_f32_32x32x16_bf16 v[96:111], v[34:37], v[30:33], v[96:111]
    v_mfma_f32_32x32x16_bf16 v[112:127], v[38:41], v[30:33], v[112:127]
    s_waitcnt lgkmcnt(0)
    v_mfma_f32_32x32x16_bf16 v[64:79], v[50:53], v[42:45], v[64:79]
    v_mfma_f32_32x32x16_bf16 v[80:95], v[54:57], v[42:45], v[80:95]
    v_mfma_f32_32x32x16_bf16 v[96:111], v[50:53], v[46:49], v[96:111]
    v_mfma_f32_32x32x16_bf16 v[112:127], v[54:57], v[46:49], v[112:127]
    s_waitcnt vmcnt(8)
    s_barrier
    ds_read_b128 v[26:29], v18 offset:32768
    ds_read_b128 v[30:33], v18 offset:34816
    ds_read_b64_tr_b16 v[34:35], v22 offset:40960
    ds_read_b64_tr_b16 v[36:37], v22 offset:41984
    ds_read_b64_tr_b16 v[38:39], v23 offset:40960
    ds_read_b64_tr_b16 v[40:41], v23 offset:41984
    ds_read_b128 v[42:45], v19 offset:32768
    ds_read_b128 v[46:49], v19 offset:34816
    ds_read_b64_tr_b16 v[50:51], v22 offset:45056
    ds_read_b64_tr_b16 v[52:53], v22 offset:46080
    ds_read_b64_tr_b16 v[54:55], v23 offset:45056
    ds_read_b64_tr_b16 v[56:57], v23 offset:46080
    s_add_u32 m0, s52, 16384
    s_nop 0
    buffer_load_dwordx4 v10, s[8:11], s50 offen lds
    s_add_u32 m0, s52, 17408
    s_nop 0
    buffer_load_dwordx4 v11, s[8:11], s50 offen lds
    s_add_u32 m0, s53, 16384
    s_nop 0
    buffer_load_dwordx4 v14, s[12:15], s51 offen lds
    s_add_u32 m0, s53, 17408
    s_nop 0
    buffer_load_dwordx4 v15, s[12:15], s51 offen lds
    s_add_u32 s50, s50, 64
    s_add_u32 s51, s51, 262144
    s_waitcnt lgkmcnt(6)
    v_mfma_f32_32x32x16_bf16 v[64:79], v[34:37], v[26:29], v[64:79]
    v_mfma_f32_32x32x16_bf16 v[80:95], v[38:41], v[26:29], v[80:95]
    v_mfma_f32_32x32x16_bf16 v[96:111], v[34:37], v[30:33], v[96:111]
    v_mfma_f32_32x32x16_bf16 v[112:127], v[38:41], v[30:33], v[112:127]
    s_waitcnt lgkmcnt(0)
    v_mfma_f32_32x32x16_bf16 v[64:79], v[50:53], v[42:45], v[64:79]
    v_mfma_f32_32x32x16_bf16 v[80:95], v[54:57], v[42:45], v[80:95]
    v_mfma_f32_32x32x16_bf16 v[96:111], v[50:53], v[46:49], v[96:111]
    v_mfma_f32_32x32x16_bf16 v[112:127], v[54:57], v[46:49], v[112:127]
    s_waitcnt vmcnt(8)
    s_barrier
    ds_read_b128 v[26:29], v18 offset:49152
    ds_read_b128 v[30:33], v18 offset:51200
    ds_read_b64_tr_b16 v[34:35], v22 offset:57344
    ds_read_b64_tr_b16 v[36:37], v22 offset:58368
    ds_read_b64_tr_b16 v[38:39], v23 offset:57344
    ds_read_b64_tr_b16 v[40:41], v23 offset:58368
    ds_read_b128 v[42:45], v19 offset:49152
    ds_read_b128 v[46:49], v19 offset:51200
    ds_read_b64_tr_b16 v[50:51], v22 offset:61440
    ds_read_b64_tr_b16 v[52:53], v22 offset:62464
    ds_read_b64_tr_b16 v[54:55], v23 offset:61440
    ds_read_b64_tr_b16 v[56:57], v23 offset:62464
    s_add_u32 m0, s52, 32768
    s_nop 0
    buffer_load_dwordx4 v10, s[8:11], s50 offen lds
    s_add_u32 m0, s52, 33792
    s_nop 0
    buffer_load_dwordx4 v11, s[8:11], s50 offen lds
    s_add_u32 m0, s53, 32768
    s_nop 0
    buffer_load_dwordx4 v14, s[12:15], s51 offen lds
    s_add_u32 m0, s53, 33792
    s_nop 0
    buffer_load_dwordx4 v15, s[12:15], s51 offen lds
    s_add_u32 s50, s50, 64
    s_add_u32 s51, s51, 262144
    s_waitcnt lgkmcnt(6)
    v_mfma_f32_32x32x16_bf16 v[64:79], v[34:37], v[26:29], v[64:79]
    v_mfma_f32_32x32x16_bf16 v[80:95], v[38:41], v[26:29], v[80:95]
    v_mfma_f32_32x32x16_bf16 v[96:111], v[34:37], v[30:33], v[96:111]
    v_mfma_f32_32x32x16_bf16 v[112:127], v[38:41], v[30:33], v[112:127]
    s_waitcnt lgkmcnt(0)
    v_mfma_f32_32x32x16_bf16 v[64:79], v[50:53], v[42:45], v[64:79]
    v_mfma_f32_32x32x16_bf16 v[80:95], v[54:57], v[42:45], v[80:95]
    v_mfma_f32_32x32x16_bf16 v[96:111], v[50:53], v[46:49], v[96:111]
    v_mfma_f32_32x32x16_bf16 v[112:127], v[54:57], v[46:49], v[112:127]
    s_add_u32 s54, s54, 4
    s_cmp_lt_u32 s54, 32
    s_cbranch_scc1 L_g_loop_6
    s_nop 15
    s_waitcnt vmcnt(0)
    v_and_b32 v3, 31, v1
    s_lshl_b32 s45, s40, 7
    s_lshl_b32 s46, s48, 6
    s_add_u32 s45, s45, s46
    v_add_u32 v3, s45, v3
    v_lshrrev_b32 v4, 5, v1
    v_lshlrev_b32 v4, 2, v4
    s_mul_i32 s45, s41, 128
    s_mul_i32 s46, s49, 64
    s_add_u32 s45, s45, s46
    v_add_u32 v4, s45, v4
    s_mov_b32 s47, 24576
    v_mul_lo_u32 v5, v3, s47
    v_lshlrev_b32 v6, 1, v4
    v_add_u32 v5, v5, v6
    v_lshrrev_b32 v61, 5, v1
    v_lshlrev_b32 v61, 3, v61
    v_add_u32 v61, v61, v5
    s_lshl_b32 s45, s40, 2
    s_lshl_b32 s46, s48, 1
    s_add_u32 s45, s45, s46
    s_mul_i32 s45, s45, 786432
    s_mul_i32 s46, s43, 24576
    s_add_u32 s45, s45, s46
    s_lshr_b32 s46, s41, 5
    s_lshl_b32 s46, s46, 13
    s_add_u32 s45, s45, s46
    s_lshl_b32 s46, s49, 11
    s_add_u32 s45, s45, s46
    v_and_b32 v62, 15, v1
    v_lshlrev_b32 v62, 4, v62
    v_bfe_u32 v63, v1, 4, 1
    v_lshl_add_u32 v62, v63, 12, v62
    v_lshrrev_b32 v63, 5, v1
    v_lshl_add_u32 v62, v63, 8, v62
    v_add_u32 v62, s45, v62
    s_waitcnt vmcnt(0)
    v_cvt_pk_bf16_f32 v64, v64, v65
    v_cvt_pk_bf16_f32 v65, v66, v67
    v_cvt_pk_bf16_f32 v66, v68, v69
    v_cvt_pk_bf16_f32 v67, v70, v71
    v_cvt_pk_bf16_f32 v72, v72, v73
    v_cvt_pk_bf16_f32 v73, v74, v75
    v_cvt_pk_bf16_f32 v74, v76, v77
    v_cvt_pk_bf16_f32 v75, v78, v79
    v_add_u32 v9, 0, v62
    s_nop 0
    v_permlane32_swap_b32 v64, v66
    v_permlane32_swap_b32 v65, v67
    v_permlane32_swap_b32 v72, v74
    v_permlane32_swap_b32 v73, v75
    buffer_store_dwordx4 v[64:67], v9, s[16:19], 0 offen offset:0
    buffer_store_dwordx4 v[72:75], v9, s[16:19], 0 offen offset:512
    s_waitcnt vmcnt(0)
    v_cvt_pk_bf16_f32 v96, v96, v97
    v_cvt_pk_bf16_f32 v97, v98, v99
    v_cvt_pk_bf16_f32 v98, v100, v101
    v_cvt_pk_bf16_f32 v99, v102, v103
    v_cvt_pk_bf16_f32 v104, v104, v105
    v_cvt_pk_bf16_f32 v105, v106, v107
    v_cvt_pk_bf16_f32 v106, v108, v109
    v_cvt_pk_bf16_f32 v107, v110, v111
    v_add_u32 v9, 786432, v62
    s_nop 0
    v_permlane32_swap_b32 v96, v98
    v_permlane32_swap_b32 v97, v99
    v_permlane32_swap_b32 v104, v106
    v_permlane32_swap_b32 v105, v107
    buffer_store_dwordx4 v[96:99], v9, s[16:19], 0 offen offset:0
    buffer_store_dwordx4 v[104:107], v9, s[16:19], 0 offen offset:512
    s_waitcnt vmcnt(0)
    v_cvt_pk_bf16_f32 v80, v80, v81
    v_cvt_pk_bf16_f32 v81, v82, v83
    v_cvt_pk_bf16_f32 v82, v84, v85
    v_cvt_pk_bf16_f32 v83, v86, v87
    v_cvt_pk_bf16_f32 v88, v88, v89
    v_cvt_pk_bf16_f32 v89, v90, v91
    v_cvt_pk_bf16_f32 v90, v92, v93
    v_cvt_pk_bf16_f32 v91, v94, v95
    v_add_u32 v9, 0, v62
    s_nop 0
    v_permlane32_swap_b32 v80, v82
    v_permlane32_swap_b32 v81, v83
    v_permlane32_swap_b32 v88, v90
    v_permlane32_swap_b32 v89, v91
    buffer_store_dwordx4 v[80:83], v9, s[16:19], 0 offen offset:1024
    buffer_store_dwordx4 v[88:91], v9, s[16:19], 0 offen offset:1536
    s_waitcnt vmcnt(0)
    v_cvt_pk_bf16_f32 v112, v112, v113
    v_cvt_pk_bf16_f32 v113, v114, v115
    v_cvt_pk_bf16_f32 v114, v116, v117
    v_cvt_pk_bf16_f32 v115, v118, v119
    v_cvt_pk_bf16_f32 v120, v120, v121
    v_cvt_pk_bf16_f32 v121, v122, v123
    v_cvt_pk_bf16_f32 v122, v124, v125
    v_cvt_pk_bf16_f32 v123, v126, v127
    v_add_u32 v9, 786432, v62
    s_nop 0
    v_permlane32_swap_b32 v112, v114
    v_permlane32_swap_b32 v113, v115
    v_permlane32_swap_b32 v120, v122
    v_permlane32_swap_b32 v121, v123
    buffer_store_dwordx4 v[112:115], v9, s[16:19], 0 offen offset:1024
    buffer_store_dwordx4 v[120:123], v9, s[16:19], 0 offen offset:1536
L_g_done_5:
    s_endpgm
.globl k3_chain_kernel
.p2align 8
.type k3_chain_kernel,@function
k3_chain_kernel:
    s_cmp_ge_u32 s2, 256
    s_cbranch_scc1 L_c_done_7
    s_load_dwordx2 s[20:21], s[0:1], 128
    v_and_b32 v1, 63, v0
    v_lshrrev_b32 v2, 6, v0
    s_nop 0
    v_readfirstlane_b32 s44, v2
    s_waitcnt lgkmcnt(0)
    s_mov_b32 s12, s20
    s_and_b32 s13, s21, 0xffff
    s_mov_b32 s14, 0x10000000
    s_mov_b32 s15, 0x00020000
    s_getreg_b32 s47, hwreg(HW_REG_XCC_ID)
    s_and_b32 s47, s47, 7
    s_mov_b32 s39, s47
    s_cmp_lg_u32 s44, 0
    s_cbranch_scc1 L_tk_8
    v_mov_b32 v3, 1
    s_lshl_b32 s45, s47, 8
    s_add_u32 s45, s45, 0x100000
    v_mov_b32 v4, 0
    s_mov_b64 exec, 1
    buffer_atomic_add v3, v4, s[12:15], s45 offen sc0
    s_waitcnt vmcnt(0)
    v_readfirstlane_b32 s41, v3
    s_mov_b32 s40, s47
    s_nop 3
    s_cmp_lt_u32 s41, 32
    s_cbranch_scc1 L_got_9
    v_mov_b32 v3, 1
    s_mov_b32 s45, 0x100800
    buffer_atomic_add v3, v4, s[12:15], s45 offen sc0
    s_waitcnt vmcnt(0)
    v_readfirstlane_b32 s46, v3
    s_mov_b64 exec, -1
    v_and_b32 v4, 7, v1
    v_lshlrev_b32 v4, 8, v4
    s_mov_b32 s45, 0x100000
    s_mov_b32 s70, 0
L_sp_10:
    s_sleep 8
    buffer_load_dword v3, v4, s[12:15], s45 offen sc1
    s_waitcnt vmcnt(0)
    s_mov_b32 s48, 0
    v_readlane_b32 s50, v3, 0
    v_readlane_b32 s51, v3, 1
    v_readlane_b32 s52, v3, 2
    v_readlane_b32 s53, v3, 3
    v_readlane_b32 s54, v3, 4
    v_readlane_b32 s55, v3, 5
    v_readlane_b32 s56, v3, 6
    v_readlane_b32 s57, v3, 7
    s_nop 3
    s_add_u32 s48, s48, s50
    s_add_u32 s48, s48, s51
    s_add_u32 s48, s48, s52
    s_add_u32 s48, s48, s53
    s_add_u32 s48, s48, s54
    s_add_u32 s48, s48, s55
    s_add_u32 s48, s48, s56
    s_add_u32 s48, s48, s57
    s_add_u32 s70, s70, 1
    s_cmp_ge_u32 s70, 524288
    s_cbranch_scc1 L_c_done_7
    s_cmp_lt_u32 s48, 256
    s_cbranch_scc1 L_sp_10
    s_min_u32 s48, s50, 32
    s_mov_b32 s40, 0
    s_add_u32 s41, s48, s46
    s_cmp_lt_u32 s41, 32
    s_cbranch_scc1 L_got_9
    s_sub_u32 s46, s41, 32
    s_min_u32 s48, s51, 32
    s_mov_b32 s40, 1
    s_add_u32 s41, s48, s46
    s_cmp_lt_u32 s41, 32
    s_cbranch_scc1 L_got_9
    s_sub_u32 s46, s41, 32
    s_min_u32 s48, s52, 32
    s_mov_b32 s40, 2
    s_add_u32 s41, s48, s46
    s_cmp_lt_u32 s41, 32
    s_cbranch_scc1 L_got_9
    s_sub_u32 s46, s41, 32
    s_min_u32 s48, s53, 32
    s_mov_b32 s40, 3
    s_add_u32 s41, s48, s46
    s_cmp_lt_u32 s41, 32
    s_cbranch_scc1 L_got_9
    s_sub_u32 s46, s41, 32
    s_min_u32 s48, s54, 32
    s_mov_b32 s40, 4
    s_add_u32 s41, s48, s46
    s_cmp_lt_u32 s41, 32
    s_cbranch_scc1 L_got_9
    s_sub_u32 s46, s41, 32
    s_min_u32 s48, s55, 32
    s_mov_b32 s40, 5
    s_add_u32 s41, s48, s46
    s_cmp_lt_u32 s41, 32
    s_cbranch_scc1 L_got_9
    s_sub_u32 s46, s41, 32
    s_min_u32 s48, s56, 32
    s_mov_b32 s40, 6
    s_add_u32 s41, s48, s46
    s_cmp_lt_u32 s41, 32
    s_cbranch_scc1 L_got_9
    s_sub_u32 s46, s41, 32
    s_min_u32 s48, s57, 32
    s_mov_b32 s40, 7
    s_add_u32 s41, s48, s46
    s_cmp_lt_u32 s41, 32
    s_cbranch_scc1 L_got_9
    s_sub_u32 s46, s41, 32
    s_branch L_c_done_7
L_got_9:
    s_mov_b64 exec, -1
    s_lshl_b32 s45, s40, 8
    s_or_b32 s45, s45, s41
    v_mov_b32 v3, s45
    v_mov_b32 v4, 26624
    ds_write_b32 v4, v3
    s_waitcnt lgkmcnt(0)
L_tk_8:
    s_barrier
    v_mov_b32 v4, 26624
    ds_read_b32 v3, v4
    s_waitcnt lgkmcnt(0)
    v_readfirstlane_b32 s45, v3
    s_nop 3
    s_lshr_b32 s40, s45, 8
    s_and_b32 s41, s45, 0xff
    s_barrier
    s_cmp_lt_u32 s41, 16
    s_cbranch_scc1 L_c_chain_19
    s_sub_u32 s45, s41, 16
    s_lshr_b32 s42, s40, 1
    s_and_b32 s43, s40, 1
    s_lshl_b32 s43, s43, 2
    s_and_b32 s46, s45, 3
    s_add_u32 s43, s43, s46
    s_cmp_lt_u32 s45, 4
    s_cbranch_scc1 L_w_wo_20
    s_cmp_lt_u32 s45, 8
    s_cbranch_scc1 L_w_f2_21
    s_cmp_lt_u32 s45, 12
    s_cbranch_scc1 L_w_f1_22
    s_cmp_lt_u32 s45, 14
    s_cbranch_scc1 L_w_att_23
    s_and_b32 s42, s40, 3
    s_lshr_b32 s43, s40, 2
    s_cmp_eq_u32 s45, 14
    s_cbranch_scc1 L_w_c_24
    s_load_dwordx2 s[4:5], s[0:1], 112
    s_load_dwordx2 s[6:7], s[0:1], 88
    v_lshlrev_b32 v2, 4, v1
    v_lshlrev_b32 v3, 5, v1
    s_waitcnt lgkmcnt(0)
    s_mov_b32 s24, s4
    s_and_b32 s25, s5, 0xffff
    s_mov_b32 s26, 0x400000
    s_mov_b32 s27, 0x00020000
    s_mov_b32 s28, s6
    s_and_b32 s29, s7, 0xffff
    s_mov_b32 s30, 0x800
    s_mov_b32 s31, 0x00020000
    s_mov_b32 s46, 20480
    buffer_load_dwordx4 v[16:19], v3, s[12:15], s46 offen offset:0
    buffer_load_dwordx4 v[20:23], v3, s[12:15], s46 offen offset:16
    buffer_load_dwordx4 v[24:27], v3, s[12:15], s46 offen offset:2048
    buffer_load_dwordx4 v[28:31], v3, s[12:15], s46 offen offset:2064
    buffer_load_dwordx4 v[48:51], v2, s[28:31], 0 offen
    buffer_load_dwordx4 v[52:55], v2, s[28:31], 0 offen offset:1024
    s_waitcnt vmcnt(0)
    v_lshlrev_b32 v32, 16, v48
    v_and_b32 v33, 0xffff0000, v48
    v_lshlrev_b32 v34, 16, v49
    v_and_b32 v35, 0xffff0000, v49
    v_lshlrev_b32 v36, 16, v50
    v_and_b32 v37, 0xffff0000, v50
    v_lshlrev_b32 v38, 16, v51
    v_and_b32 v39, 0xffff0000, v51
    v_lshlrev_b32 v40, 16, v52
    v_and_b32 v41, 0xffff0000, v52
    v_lshlrev_b32 v42, 16, v53
    v_and_b32 v43, 0xffff0000, v53
    v_lshlrev_b32 v44, 16, v54
    v_and_b32 v45, 0xffff0000, v54
    v_lshlrev_b32 v46, 16, v55
    v_and_b32 v47, 0xffff0000, v55
    s_lshl_b32 s46, s42, 15
    s_lshl_b32 s47, s44, 12
    s_add_u32 s46, s46, s47
    s_add_u32 s46, s46, 0xb000000
    v_add_u32 v4, s46, v2
    v_and_b32 v5, 31, v1
    v_lshlrev_b32 v5, 7, v5
    v_add_u32 v5, 0x10a400, v5
    v_and_b32 v6, 31, v1
    v_lshlrev_b32 v6, 2, v6
    v_lshrrev_b32 v7, 5, v1
    v_lshl_add_u32 v6, v7, 14, v6
    s_lshl_b32 s46, s44, 9
    v_add_u32 v6, s46, v6
    s_lshl_b32 s46, s44, 12
    v_add_u32 v7, s46, v3
    s_lshl_b32 s46, s42, 3
    s_add_u32 s46, s46, s44
    s_lshl_b32 s46, s46, 11
    v_add_u32 v8, s46, v2
    v_add_u32 v9, 0x800000, v8
    s_mov_b32 s60, s43
L_r_loop_26:
    s_lshl_b32 s61, s60, 19
    s_lshl_b32 s63, s60, 16
    s_cmp_lg_u32 s44, 0
    s_cbranch_scc1 L_r_nsp_27
    s_mov_b32 s70, 0
L_spin_28:
    buffer_load_dword v14, v5, s[12:15], 0 offen sc1
    s_waitcnt vmcnt(0)
    v_cmp_ge_u32 vcc, s60, v14
    s_add_u32 s70, s70, 1
    s_cbranch_vccz L_spok_29
    s_sleep 8
    s_cmp_lt_u32 s70, 524288
    s_cbranch_scc1 L_spin_28
    s_branch L_c_done_7
L_spok_29:
L_r_nsp_27:
    s_barrier
    buffer_load_dwordx4 v[64:67], v4, s[12:15], s61 offen offset:0 sc1
    buffer_load_dwordx4 v[68:71], v4, s[12:15], s61 offen offset:1024 sc1
    buffer_load_dwordx4 v[72:75], v4, s[12:15], s61 offen offset:2048 sc1
    buffer_load_dwordx4 v[76:79], v4, s[12:15], s61 offen offset:3072 sc1
    s_add_u32 s61, s61, 131072
    buffer_load_dwordx4 v[80:83], v4, s[12:15], s61 offen offset:0 sc1
    buffer_load_dwordx4 v[84:87], v4, s[12:15], s61 offen offset:1024 sc1
    buffer_load_dwordx4 v[88:91], v4, s[12:15], s61 offen offset:2048 sc1
    buffer_load_dwordx4 v[92:95], v4, s[12:15], s61 offen offset:3072 sc1
    s_add_u32 s61, s61, 131072
    buffer_load_dwordx4 v[96:99], v4, s[12:15], s61 offen offset:0 sc1
    buffer_load_dwordx4 v[100:103], v4, s[12:15], s61 offen offset:1024 sc1
    buffer_load_dwordx4 v[104:107], v4, s[12:15], s61 offen offset:2048 sc1
    buffer_load_dwordx4 v[108:111], v4, s[12:15], s61 offen offset:3072 sc1
    s_add_u32 s61, s61, 131072
    buffer_load_dwordx4 v[112:115], v4, s[12:15], s61 offen offset:0 sc1
    buffer_load_dwordx4 v[116:119], v4, s[12:15], s61 offen offset:1024 sc1
    buffer_load_dwordx4 v[120:123], v4, s[12:15], s61 offen offset:2048 sc1
    buffer_load_dwordx4 v[124:127], v4, s[12:15], s61 offen offset:3072 sc1
    buffer_load_dwordx4 a[0:3], v9, s[12:15], s63 offen sc1
    buffer_load_dwordx4 a[4:7], v9, s[12:15], s63 offen offset:1024 sc1
    s_waitcnt vmcnt(10)
    v_pk_add_f32 v[64:65], v[64:65], v[80:81]
    v_pk_add_f32 v[66:67], v[66:67], v[82:83]
    v_pk_add_f32 v[68:69], v[68:69], v[84:85]
    v_pk_add_f32 v[70:71], v[70:71], v[86:87]
    v_pk_add_f32 v[72:73], v[72:73], v[88:89]
    v_pk_add_f32 v[74:75], v[74:75], v[90:91]
    v_pk_add_f32 v[76:77], v[76:77], v[92:93]
    v_pk_add_f32 v[78:79], v[78:79], v[94:95]
    s_waitcnt vmcnt(2)
    v_pk_add_f32 v[96:97], v[96:97], v[112:113]
    v_pk_add_f32 v[98:99], v[98:99], v[114:115]
    v_pk_add_f32 v[100:101], v[100:101], v[116:117]
    v_pk_add_f32 v[102:103], v[102:103], v[118:119]
    v_pk_add_f32 v[104:105], v[104:105], v[120:121]
    v_pk_add_f32 v[106:107], v[106:107], v[122:123]
    v_pk_add_f32 v[108:109], v[108:109], v[124:125]
    v_pk_add_f32 v[110:111], v[110:111], v[126:127]
    v_pk_add_f32 v[64:65], v[64:65], v[96:97]
    v_pk_add_f32 v[66:67], v[66:67], v[98:99]
    v_pk_add_f32 v[68:69], v[68:69], v[100:101]
    v_pk_add_f32 v[70:71], v[70:71], v[102:103]
    v_pk_add_f32 v[72:73], v[72:73], v[104:105]
    v_pk_add_f32 v[74:75], v[74:75], v[106:107]
    v_pk_add_f32 v[76:77], v[76:77], v[108:109]
    v_pk_add_f32 v[78:79], v[78:79], v[110:111]
    ds_write_b32 v6, v64 offset:0
    ds_write_b32 v6, v65 offset:4096
    ds_write_b32 v6, v66 offset:8192
    ds_write_b32 v6, v67 offset:12288
    ds_write_b32 v6, v68 offset:128
    ds_write_b32 v6, v69 offset:4224
    ds_write_b32 v6, v70 offset:8320
    ds_write_b32 v6, v71 offset:12416
    ds_write_b32 v6, v72 offset:256
    ds_write_b32 v6, v73 offset:4352
    ds_write_b32 v6, v74 offset:8448
    ds_write_b32 v6, v75 offset:12544
    ds_write_b32 v6, v76 offset:384
    ds_write_b32 v6, v77 offset:4480
    ds_write_b32 v6, v78 offset:8576
    ds_write_b32 v6, v79 offset:12672
    s_waitcnt lgkmcnt(0)
    s_barrier
    ds_read_b128 v[64:67], v7
    ds_read_b128 v[68:71], v7 offset:16
    ds_read_b128 v[72:75], v7 offset:2048
    ds_read_b128 v[76:79], v7 offset:2064
    s_waitcnt vmcnt(0)
    v_accvgpr_read_b32 v96, a0
    v_accvgpr_read_b32 v97, a1
    v_accvgpr_read_b32 v98, a2
    v_accvgpr_read_b32 v99, a3
    v_accvgpr_read_b32 v100, a4
    v_accvgpr_read_b32 v101, a5
    v_accvgpr_read_b32 v102, a6
    v_accvgpr_read_b32 v103, a7
    v_lshlrev_b32 v80, 16, v96
    v_and_b32 v81, 0xffff0000, v96
    v_lshlrev_b32 v82, 16, v97
    v_and_b32 v83, 0xffff0000, v97
    v_lshlrev_b32 v84, 16, v98
    v_and_b32 v85, 0xffff0000, v98
    v_lshlrev_b32 v86, 16, v99
    v_and_b32 v87, 0xffff0000, v99
    v_lshlrev_b32 v88, 16, v100
    v_and_b32 v89, 0xffff0000, v100
    v_lshlrev_b32 v90, 16, v101
    v_and_b32 v91, 0xffff0000, v101
    v_lshlrev_b32 v92, 16, v102
    v_and_b32 v93, 0xffff0000, v102
    v_lshlrev_b32 v94, 16, v103
    v_and_b32 v95, 0xffff0000, v103
    s_waitcnt lgkmcnt(0)
    v_cvt_pk_bf16_f32 v64, v64, v64
    v_cvt_pk_bf16_f32 v65, v65, v65
    v_cvt_pk_bf16_f32 v66, v66, v66
    v_cvt_pk_bf16_f32 v67, v67, v67
    v_cvt_pk_bf16_f32 v68, v68, v68
    v_cvt_pk_bf16_f32 v69, v69, v69
    v_cvt_pk_bf16_f32 v70, v70, v70
    v_cvt_pk_bf16_f32 v71, v71, v71
    v_cvt_pk_bf16_f32 v72, v72, v72
    v_cvt_pk_bf16_f32 v73, v73, v73
    v_cvt_pk_bf16_f32 v74, v74, v74
    v_cvt_pk_bf16_f32 v75, v75, v75
    v_cvt_pk_bf16_f32 v76, v76, v76
    v_cvt_pk_bf16_f32 v77, v77, v77
    v_cvt_pk_bf16_f32 v78, v78, v78
    v_cvt_pk_bf16_f32 v79, v79, v79
    v_lshlrev_b32 v64, 16, v64
    v_lshlrev_b32 v65, 16, v65
    v_lshlrev_b32 v66, 16, v66
    v_lshlrev_b32 v67, 16, v67
    v_lshlrev_b32 v68, 16, v68
    v_lshlrev_b32 v69, 16, v69
    v_lshlrev_b32 v70, 16, v70
    v_lshlrev_b32 v71, 16, v71
    v_lshlrev_b32 v72, 16, v72
    v_lshlrev_b32 v73, 16, v73
    v_lshlrev_b32 v74, 16, v74
    v_lshlrev_b32 v75, 16, v75
    v_lshlrev_b32 v76, 16, v76
    v_lshlrev_b32 v77, 16, v77
    v_lshlrev_b32 v78, 16, v78
    v_lshlrev_b32 v79, 16, v79
    v_add_f32 v64, v64, v32
    v_add_f32 v65, v65, v33
    v_add_f32 v66, v66, v34
    v_add_f32 v67, v67, v35
    v_add_f32 v68, v68, v36
    v_add_f32 v69, v69, v37
    v_add_f32 v70, v70, v38
    v_add_f32 v71, v71, v39
    v_add_f32 v72, v72, v40
    v_add_f32 v73, v73, v41
    v_add_f32 v74, v74, v42
    v_add_f32 v75, v75, v43
    v_add_f32 v76, v76, v44
    v_add_f32 v77, v77, v45
    v_add_f32 v78, v78, v46
    v_add_f32 v79, v79, v47
    v_cvt_pk_bf16_f32 v64, v64, v64
    v_cvt_pk_bf16_f32 v65, v65, v65
    v_cvt_pk_bf16_f32 v66, v66, v66
    v_cvt_pk_bf16_f32 v67, v67, v67
    v_cvt_pk_bf16_f32 v68, v68, v68
    v_cvt_pk_bf16_f32 v69, v69, v69
    v_cvt_pk_bf16_f32 v70, v70, v70
    v_cvt_pk_bf16_f32 v71, v71, v71
    v_cvt_pk_bf16_f32 v72, v72, v72
    v_cvt_pk_bf16_f32 v73, v73, v73
    v_cvt_pk_bf16_f32 v74, v74, v74
    v_cvt_pk_bf16_f32 v75, v75, v75
    v_cvt_pk_bf16_f32 v76, v76, v76
    v_cvt_pk_bf16_f32 v77, v77, v77
    v_cvt_pk_bf16_f32 v78, v78, v78
    v_cvt_pk_bf16_f32 v79, v79, v79
    v_lshlrev_b32 v64, 16, v64
    v_lshlrev_b32 v65, 16, v65
    v_lshlrev_b32 v66, 16, v66
    v_lshlrev_b32 v67, 16, v67
    v_lshlrev_b32 v68, 16, v68
    v_lshlrev_b32 v69, 16, v69
    v_lshlrev_b32 v70, 16, v70
    v_lshlrev_b32 v71, 16, v71
    v_lshlrev_b32 v72, 16, v72
    v_lshlrev_b32 v73, 16, v73
    v_lshlrev_b32 v74, 16, v74
    v_lshlrev_b32 v75, 16, v75
    v_lshlrev_b32 v76, 16, v76
    v_lshlrev_b32 v77, 16, v77
    v_lshlrev_b32 v78, 16, v78
    v_lshlrev_b32 v79, 16, v79
    v_mul_f32 v64, v64, v16
    v_mul_f32 v65, v65, v17
    v_mul_f32 v66, v66, v18
    v_mul_f32 v67, v67, v19
    v_mul_f32 v68, v68, v20
    v_mul_f32 v69, v69, v21
    v_mul_f32 v70, v70, v22
    v_mul_f32 v71, v71, v23
    v_mul_f32 v72, v72, v24
    v_mul_f32 v73, v73, v25
    v_mul_f32 v74, v74, v26
    v_mul_f32 v75, v75, v27
    v_mul_f32 v76, v76, v28
    v_mul_f32 v77, v77, v29
    v_mul_f32 v78, v78, v30
    v_mul_f32 v79, v79, v31
    v_cvt_pk_bf16_f32 v64, v64, v64
    v_cvt_pk_bf16_f32 v65, v65, v65
    v_cvt_pk_bf16_f32 v66, v66, v66
    v_cvt_pk_bf16_f32 v67, v67, v67
    v_cvt_pk_bf16_f32 v68, v68, v68
    v_cvt_pk_bf16_f32 v69, v69, v69
    v_cvt_pk_bf16_f32 v70, v70, v70
    v_cvt_pk_bf16_f32 v71, v71, v71
    v_cvt_pk_bf16_f32 v72, v72, v72
    v_cvt_pk_bf16_f32 v73, v73, v73
    v_cvt_pk_bf16_f32 v74, v74, v74
    v_cvt_pk_bf16_f32 v75, v75, v75
    v_cvt_pk_bf16_f32 v76, v76, v76
    v_cvt_pk_bf16_f32 v77, v77, v77
    v_cvt_pk_bf16_f32 v78, v78, v78
    v_cvt_pk_bf16_f32 v79, v79, v79
    v_lshlrev_b32 v64, 16, v64
    v_lshlrev_b32 v65, 16, v65
    v_lshlrev_b32 v66, 16, v66
    v_lshlrev_b32 v67, 16, v67
    v_lshlrev_b32 v68, 16, v68
    v_lshlrev_b32 v69, 16, v69
    v_lshlrev_b32 v70, 16, v70
    v_lshlrev_b32 v71, 16, v71
    v_lshlrev_b32 v72, 16, v72
    v_lshlrev_b32 v73, 16, v73
    v_lshlrev_b32 v74, 16, v74
    v_lshlrev_b32 v75, 16, v75
    v_lshlrev_b32 v76, 16, v76
    v_lshlrev_b32 v77, 16, v77
    v_lshlrev_b32 v78, 16, v78
    v_lshlrev_b32 v79, 16, v79
    v_add_f32 v64, v64, v80
    v_add_f32 v65, v65, v81
    v_add_f32 v66, v66, v82
    v_add_f32 v67, v67, v83
    v_add_f32 v68, v68, v84
    v_add_f32 v69, v69, v85
    v_add_f32 v70, v70, v86
    v_add_f32 v71, v71, v87
    v_add_f32 v72, v72, v88
    v_add_f32 v73, v73, v89
    v_add_f32 v74, v74, v90
    v_add_f32 v75, v75, v91
    v_add_f32 v76, v76, v92
    v_add_f32 v77, v77, v93
    v_add_f32 v78, v78, v94
    v_add_f32 v79, v79, v95
    v_cvt_pk_bf16_f32 v96, v64, v65
    v_cvt_pk_bf16_f32 v97, v66, v67
    v_cvt_pk_bf16_f32 v98, v68, v69
    v_cvt_pk_bf16_f32 v99, v70, v71
    v_cvt_pk_bf16_f32 v100, v72, v73
    v_cvt_pk_bf16_f32 v101, v74, v75
    v_cvt_pk_bf16_f32 v102, v76, v77
    v_cvt_pk_bf16_f32 v103, v78, v79
    buffer_store_dwordx4 v[96:99], v8, s[24:27], s63 offen
    buffer_store_dwordx4 v[100:103], v8, s[24:27], s63 offen offset:1024
    s_add_u32 s60, s60, 2
    s_cmp_lt_u32 s60, 64
    s_cbranch_scc1 L_r_loop_26
    s_branch L_c_done_7
L_w_c_24:
    s_load_dwordx2 s[4:5], s[0:1], 0
    s_load_dwordx2 s[6:7], s[0:1], 88
    v_lshlrev_b32 v2, 4, v1
    v_lshlrev_b32 v3, 5, v1
    s_waitcnt lgkmcnt(0)
    s_mov_b32 s24, s4
    s_and_b32 s25, s5, 0xffff
    s_mov_b32 s26, 0x400000
    s_mov_b32 s27, 0x00020000
    s_mov_b32 s28, s6
    s_and_b32 s29, s7, 0xffff
    s_mov_b32 s30, 0x800
    s_mov_b32 s31, 0x00020000
    s_mov_b32 s46, 8192
    buffer_load_dwordx4 v[16:19], v3, s[12:15], s46 offen offset:0
    buffer_load_dwordx4 v[20:23], v3, s[12:15], s46 offen offset:16
    buffer_load_dwordx4 v[24:27], v3, s[12:15], s46 offen offset:2048
    buffer_load_dwordx4 v[28:31], v3, s[12:15], s46 offen offset:2064
    s_mov_b32 s46, 16384
    buffer_load_dwordx4 v[32:35], v3, s[12:15], s46 offen offset:0
    buffer_load_dwordx4 v[36:39], v3, s[12:15], s46 offen offset:16
    buffer_load_dwordx4 v[40:43], v3, s[12:15], s46 offen offset:2048
    buffer_load_dwordx4 v[44:47], v3, s[12:15], s46 offen offset:2064
    s_mov_b32 s46, 12288
    buffer_load_dwordx4 v[48:51], v3, s[12:15], s46 offen offset:0
    buffer_load_dwordx4 v[52:55], v3, s[12:15], s46 offen offset:16
    buffer_load_dwordx4 v[56:59], v3, s[12:15], s46 offen offset:2048
    buffer_load_dwordx4 v[60:63], v3, s[12:15], s46 offen offset:2064
    s_waitcnt vmcnt(0)
    v_add_f32 v32, 1.0, v32
    v_cvt_pk_bf16_f32 v32, v32, v32
    v_lshlrev_b32 v32, 16, v32
    v_add_f32 v33, 1.0, v33
    v_cvt_pk_bf16_f32 v33, v33, v33
    v_lshlrev_b32 v33, 16, v33
    v_add_f32 v34, 1.0, v34
    v_cvt_pk_bf16_f32 v34, v34, v34
    v_lshlrev_b32 v34, 16, v34
    v_add_f32 v35, 1.0, v35
    v_cvt_pk_bf16_f32 v35, v35, v35
    v_lshlrev_b32 v35, 16, v35
    v_add_f32 v36, 1.0, v36
    v_cvt_pk_bf16_f32 v36, v36, v36
    v_lshlrev_b32 v36, 16, v36
    v_add_f32 v37, 1.0, v37
    v_cvt_pk_bf16_f32 v37, v37, v37
    v_lshlrev_b32 v37, 16, v37
    v_add_f32 v38, 1.0, v38
    v_cvt_pk_bf16_f32 v38, v38, v38
    v_lshlrev_b32 v38, 16, v38
    v_add_f32 v39, 1.0, v39
    v_cvt_pk_bf16_f32 v39, v39, v39
    v_lshlrev_b32 v39, 16, v39
    v_add_f32 v40, 1.0, v40
    v_cvt_pk_bf16_f32 v40, v40, v40
    v_lshlrev_b32 v40, 16, v40
    v_add_f32 v41, 1.0, v41
    v_cvt_pk_bf16_f32 v41, v41, v41
    v_lshlrev_b32 v41, 16, v41
    v_add_f32 v42, 1.0, v42
    v_cvt_pk_bf16_f32 v42, v42, v42
    v_lshlrev_b32 v42, 16, v42
    v_add_f32 v43, 1.0, v43
    v_cvt_pk_bf16_f32 v43, v43, v43
    v_lshlrev_b32 v43, 16, v43
    v_add_f32 v44, 1.0, v44
    v_cvt_pk_bf16_f32 v44, v44, v44
    v_lshlrev_b32 v44, 16, v44
    v_add_f32 v45, 1.0, v45
    v_cvt_pk_bf16_f32 v45, v45, v45
    v_lshlrev_b32 v45, 16, v45
    v_add_f32 v46, 1.0, v46
    v_cvt_pk_bf16_f32 v46, v46, v46
    v_lshlrev_b32 v46, 16, v46
    v_add_f32 v47, 1.0, v47
    v_cvt_pk_bf16_f32 v47, v47, v47
    v_lshlrev_b32 v47, 16, v47
    s_lshl_b32 s46, s42, 15
    s_lshl_b32 s47, s44, 12
    s_add_u32 s46, s46, s47
    s_add_u32 s46, s46, 0x9000000
    v_add_u32 v4, s46, v2
    v_and_b32 v5, 31, v1
    v_lshlrev_b32 v5, 7, v5
    v_add_u32 v5, 0x109400, v5
    v_and_b32 v6, 31, v1
    v_lshlrev_b32 v6, 2, v6
    v_lshrrev_b32 v7, 5, v1
    v_lshl_add_u32 v6, v7, 14, v6
    s_lshl_b32 s46, s44, 9
    v_add_u32 v6, s46, v6
    s_lshl_b32 s46, s44, 12
    v_add_u32 v7, s46, v3
    s_lshl_b32 s46, s42, 3
    s_add_u32 s46, s46, s44
    s_lshl_b32 s46, s46, 11
    v_add_u32 v8, s46, v2
    v_add_u32 v9, 0x800000, v8
    s_mul_i32 s46, s44, 2064
    s_add_u32 s46, s46, 32768
    v_add_u32 v10, s46, v2
    v_and_b32 v11, 7, v1
    v_lshrrev_b32 v12, 3, v1
    v_mul_u32_u24 v13, 2064, v11
    v_lshl_add_u32 v13, v12, 4, v13
    s_lshl_b32 s46, s44, 8
    s_add_u32 s46, s46, 32768
    v_add_u32 v13, s46, v13
    v_lshlrev_b32 v11, 4, v11
    v_lshl_add_u32 v11, v12, 9, v11
    s_lshl_b32 s46, s44, 13
    s_lshl_b32 s47, s42, 7
    s_add_u32 s46, s46, s47
    s_add_u32 s46, s46, 0xc00000
    v_add_u32 v11, s46, v11
    v_add_u32 v12, 4096, v11
    s_mov_b32 s60, s43
L_r_loop_30:
    s_lshl_b32 s61, s60, 19
    s_lshl_b32 s63, s60, 16
    buffer_load_dwordx4 a[0:3], v8, s[24:27], s63 offen
    buffer_load_dwordx4 a[4:7], v8, s[24:27], s63 offen offset:1024
    s_cmp_lg_u32 s44, 0
    s_cbranch_scc1 L_r_nsp_31
    s_mov_b32 s70, 0
L_spin_32:
    buffer_load_dword v14, v5, s[12:15], 0 offen sc1
    s_waitcnt vmcnt(0)
    v_cmp_ge_u32 vcc, s60, v14
    s_add_u32 s70, s70, 1
    s_cbranch_vccz L_spok_33
    s_sleep 8
    s_cmp_lt_u32 s70, 524288
    s_cbranch_scc1 L_spin_32
    s_branch L_c_done_7
L_spok_33:
L_r_nsp_31:
    s_barrier
    buffer_load_dwordx4 v[64:67], v4, s[12:15], s61 offen offset:0 sc1
    buffer_load_dwordx4 v[68:71], v4, s[12:15], s61 offen offset:1024 sc1
    buffer_load_dwordx4 v[72:75], v4, s[12:15], s61 offen offset:2048 sc1
    buffer_load_dwordx4 v[76:79], v4, s[12:15], s61 offen offset:3072 sc1
    s_add_u32 s61, s61, 131072
    buffer_load_dwordx4 v[80:83], v4, s[12:15], s61 offen offset:0 sc1
    buffer_load_dwordx4 v[84:87], v4, s[12:15], s61 offen offset:1024 sc1
    buffer_load_dwordx4 v[88:91], v4, s[12:15], s61 offen offset:2048 sc1
    buffer_load_dwordx4 v[92:95], v4, s[12:15], s61 offen offset:3072 sc1
    s_add_u32 s61, s61, 131072
    buffer_load_dwordx4 v[96:99], v4, s[12:15], s61 offen offset:0 sc1
    buffer_load_dwordx4 v[100:103], v4, s[12:15], s61 offen offset:1024 sc1
    buffer_load_dwordx4 v[104:107], v4, s[12:15], s61 offen offset:2048 sc1
    buffer_load_dwordx4 v[108:111], v4, s[12:15], s61 offen offset:3072 sc1
    s_add_u32 s61, s61, 131072
    buffer_load_dwordx4 v[112:115], v4, s[12:15], s61 offen offset:0 sc1
    buffer_load_dwordx4 v[116:119], v4, s[12:15], s61 offen offset:1024 sc1
    buffer_load_dwordx4 v[120:123], v4, s[12:15], s61 offen offset:2048 sc1
    buffer_load_dwordx4 v[124:127], v4, s[12:15], s61 offen offset:3072 sc1
    s_waitcnt vmcnt(8)
    v_pk_add_f32 v[64:65], v[64:65], v[80:81]
    v_pk_add_f32 v[66:67], v[66:67], v[82:83]
    v_pk_add_f32 v[68:69], v[68:69], v[84:85]
    v_pk_add_f32 v[70:71], v[70:71], v[86:87]
    v_pk_add_f32 v[72:73], v[72:73], v[88:89]
    v_pk_add_f32 v[74:75], v[74:75], v[90:91]
    v_pk_add_f32 v[76:77], v[76:77], v[92:93]
    v_pk_add_f32 v[78:79], v[78:79], v[94:95]
    s_waitcnt vmcnt(0)
    v_pk_add_f32 v[96:97], v[96:97], v[112:113]
    v_pk_add_f32 v[98:99], v[98:99], v[114:115]
    v_pk_add_f32 v[100:101], v[100:101], v[116:117]
    v_pk_add_f32 v[102:103], v[102:103], v[118:119]
    v_pk_add_f32 v[104:105], v[104:105], v[120:121]
    v_pk_add_f32 v[106:107], v[106:107], v[122:123]
    v_pk_add_f32 v[108:109], v[108:109], v[124:125]
    v_pk_add_f32 v[110:111], v[110:111], v[126:127]
    v_pk_add_f32 v[64:65], v[64:65], v[96:97]
    v_pk_add_f32 v[66:67], v[66:67], v[98:99]
    v_pk_add_f32 v[68:69], v[68:69], v[100:101]
    v_pk_add_f32 v[70:71], v[70:71], v[102:103]
    v_pk_add_f32 v[72:73], v[72:73], v[104:105]
    v_pk_add_f32 v[74:75], v[74:75], v[106:107]
    v_pk_add_f32 v[76:77], v[76:77], v[108:109]
    v_pk_add_f32 v[78:79], v[78:79], v[110:111]
    ds_write_b32 v6, v64 offset:0
    ds_write_b32 v6, v65 offset:4096
    ds_write_b32 v6, v66 offset:8192
    ds_write_b32 v6, v67 offset:12288
    ds_write_b32 v6, v68 offset:128
    ds_write_b32 v6, v69 offset:4224
    ds_write_b32 v6, v70 offset:8320
    ds_write_b32 v6, v71 offset:12416
    ds_write_b32 v6, v72 offset:256
    ds_write_b32 v6, v73 offset:4352
    ds_write_b32 v6, v74 offset:8448
    ds_write_b32 v6, v75 offset:12544
    ds_write_b32 v6, v76 offset:384
    ds_write_b32 v6, v77 offset:4480
    ds_write_b32 v6, v78 offset:8576
    ds_write_b32 v6, v79 offset:12672
    s_waitcnt lgkmcnt(0)
    s_barrier
    ds_read_b128 v[64:67], v7
    ds_read_b128 v[68:71], v7 offset:16
    ds_read_b128 v[72:75], v7 offset:2048
    ds_read_b128 v[76:79], v7 offset:2064
    s_waitcnt vmcnt(0)
    v_accvgpr_read_b32 v96, a0
    v_accvgpr_read_b32 v97, a1
    v_accvgpr_read_b32 v98, a2
    v_accvgpr_read_b32 v99, a3
    v_accvgpr_read_b32 v100, a4
    v_accvgpr_read_b32 v101, a5
    v_accvgpr_read_b32 v102, a6
    v_accvgpr_read_b32 v103, a7
    v_lshlrev_b32 v80, 16, v96
    v_and_b32 v81, 0xffff0000, v96
    v_lshlrev_b32 v82, 16, v97
    v_and_b32 v83, 0xffff0000, v97
    v_lshlrev_b32 v84, 16, v98
    v_and_b32 v85, 0xffff0000, v98
    v_lshlrev_b32 v86, 16, v99
    v_and_b32 v87, 0xffff0000, v99
    v_lshlrev_b32 v88, 16, v100
    v_and_b32 v89, 0xffff0000, v100
    v_lshlrev_b32 v90, 16, v101
    v_and_b32 v91, 0xffff0000, v101
    v_lshlrev_b32 v92, 16, v102
    v_and_b32 v93, 0xffff0000, v102
    v_lshlrev_b32 v94, 16, v103
    v_and_b32 v95, 0xffff0000, v103
    s_waitcnt lgkmcnt(0)
    v_cvt_pk_bf16_f32 v64, v64, v64
    v_cvt_pk_bf16_f32 v65, v65, v65
    v_cvt_pk_bf16_f32 v66, v66, v66
    v_cvt_pk_bf16_f32 v67, v67, v67
    v_cvt_pk_bf16_f32 v68, v68, v68
    v_cvt_pk_bf16_f32 v69, v69, v69
    v_cvt_pk_bf16_f32 v70, v70, v70
    v_cvt_pk_bf16_f32 v71, v71, v71
    v_cvt_pk_bf16_f32 v72, v72, v72
    v_cvt_pk_bf16_f32 v73, v73, v73
    v_cvt_pk_bf16_f32 v74, v74, v74
    v_cvt_pk_bf16_f32 v75, v75, v75
    v_cvt_pk_bf16_f32 v76, v76, v76
    v_cvt_pk_bf16_f32 v77, v77, v77
    v_cvt_pk_bf16_f32 v78, v78, v78
    v_cvt_pk_bf16_f32 v79, v79, v79
    v_lshlrev_b32 v64, 16, v64
    v_lshlrev_b32 v65, 16, v65
    v_lshlrev_b32 v66, 16, v66
    v_lshlrev_b32 v67, 16, v67
    v_lshlrev_b32 v68, 16, v68
    v_lshlrev_b32 v69, 16, v69
    v_lshlrev_b32 v70, 16, v70
    v_lshlrev_b32 v71, 16, v71
    v_lshlrev_b32 v72, 16, v72
    v_lshlrev_b32 v73, 16, v73
    v_lshlrev_b32 v74, 16, v74
    v_lshlrev_b32 v75, 16, v75
    v_lshlrev_b32 v76, 16, v76
    v_lshlrev_b32 v77, 16, v77
    v_lshlrev_b32 v78, 16, v78
    v_lshlrev_b32 v79, 16, v79
    v_mul_f32 v64, v64, v16
    v_mul_f32 v65, v65, v17
    v_mul_f32 v66, v66, v18
    v_mul_f32 v67, v67, v19
    v_mul_f32 v68, v68, v20
    v_mul_f32 v69, v69, v21
    v_mul_f32 v70, v70, v22
    v_mul_f32 v71, v71, v23
    v_mul_f32 v72, v72, v24
    v_mul_f32 v73, v73, v25
    v_mul_f32 v74, v74, v26
    v_mul_f32 v75, v75, v27
    v_mul_f32 v76, v76, v28
    v_mul_f32 v77, v77, v29
    v_mul_f32 v78, v78, v30
    v_mul_f32 v79, v79, v31
    v_cvt_pk_bf16_f32 v64, v64, v64
    v_cvt_pk_bf16_f32 v65, v65, v65
    v_cvt_pk_bf16_f32 v66, v66, v66
    v_cvt_pk_bf16_f32 v67, v67, v67
    v_cvt_pk_bf16_f32 v68, v68, v68
    v_cvt_pk_bf16_f32 v69, v69, v69
    v_cvt_pk_bf16_f32 v70, v70, v70
    v_cvt_pk_bf16_f32 v71, v71, v71
    v_cvt_pk_bf16_f32 v72, v72, v72
    v_cvt_pk_bf16_f32 v73, v73, v73
    v_cvt_pk_bf16_f32 v74, v74, v74
    v_cvt_pk_bf16_f32 v75, v75, v75
    v_cvt_pk_bf16_f32 v76, v76, v76
    v_cvt_pk_bf16_f32 v77, v77, v77
    v_cvt_pk_bf16_f32 v78, v78, v78
    v_cvt_pk_bf16_f32 v79, v79, v79
    v_lshlrev_b32 v64, 16, v64
    v_lshlrev_b32 v65, 16, v65
    v_lshlrev_b32 v66, 16, v66
    v_lshlrev_b32 v67, 16, v67
    v_lshlrev_b32 v68, 16, v68
    v_lshlrev_b32 v69, 16, v69
    v_lshlrev_b32 v70, 16, v70
    v_lshlrev_b32 v71, 16, v71
    v_lshlrev_b32 v72, 16, v72
    v_lshlrev_b32 v73, 16, v73
    v_lshlrev_b32 v74, 16, v74
    v_lshlrev_b32 v75, 16, v75
    v_lshlrev_b32 v76, 16, v76
    v_lshlrev_b32 v77, 16, v77
    v_lshlrev_b32 v78, 16, v78
    v_lshlrev_b32 v79, 16, v79
    v_add_f32 v64, v64, v80
    v_add_f32 v65, v65, v81
    v_add_f32 v66, v66, v82
    v_add_f32 v67, v67, v83
    v_add_f32 v68, v68, v84
    v_add_f32 v69, v69, v85
    v_add_f32 v70, v70, v86
    v_add_f32 v71, v71, v87
    v_add_f32 v72, v72, v88
    v_add_f32 v73, v73, v89
    v_add_f32 v74, v74, v90
    v_add_f32 v75, v75, v91
    v_add_f32 v76, v76, v92
    v_add_f32 v77, v77, v93
    v_add_f32 v78, v78, v94
    v_add_f32 v79, v79, v95
    v_cvt_pk_bf16_f32 v96, v64, v65
    v_cvt_pk_bf16_f32 v97, v66, v67
    v_cvt_pk_bf16_f32 v98, v68, v69
    v_cvt_pk_bf16_f32 v99, v70, v71
    v_cvt_pk_bf16_f32 v100, v72, v73
    v_cvt_pk_bf16_f32 v101, v74, v75
    v_cvt_pk_bf16_f32 v102, v76, v77
    v_cvt_pk_bf16_f32 v103, v78, v79
    buffer_store_dwordx4 v[96:99], v9, s[12:15], s63 offen sc1
    buffer_store_dwordx4 v[100:103], v9, s[12:15], s63 offen offset:1024 sc1
    v_lshlrev_b32 v64, 16, v96
    v_and_b32 v65, 0xffff0000, v96
    v_lshlrev_b32 v66, 16, v97
    v_and_b32 v67, 0xffff0000, v97
    v_lshlrev_b32 v68, 16, v98
    v_and_b32 v69, 0xffff0000, v98
    v_lshlrev_b32 v70, 16, v99
    v_and_b32 v71, 0xffff0000, v99
    v_lshlrev_b32 v72, 16, v100
    v_and_b32 v73, 0xffff0000, v100
    v_lshlrev_b32 v74, 16, v101
    v_and_b32 v75, 0xffff0000, v101
    v_lshlrev_b32 v76, 16, v102
    v_and_b32 v77, 0xffff0000, v102
    v_lshlrev_b32 v78, 16, v103
    v_and_b32 v79, 0xffff0000, v103
    v_add_f32 v14, v64, v65
    v_add_f32 v14, v14, v66
    v_add_f32 v14, v14, v67
    v_add_f32 v14, v14, v68
    v_add_f32 v14, v14, v69
    v_add_f32 v14, v14, v70
    v_add_f32 v14, v14, v71
    v_add_f32 v14, v14, v72
    v_add_f32 v14, v14, v73
    v_add_f32 v14, v14, v74
    v_add_f32 v14, v14, v75
    v_add_f32 v14, v14, v76
    v_add_f32 v14, v14, v77
    v_add_f32 v14, v14, v78
    v_add_f32 v14, v14, v79
    s_nop 1
    v_add_f32_dpp v14, v14, v14 row_shr:1 row_mask:0xf bank_mask:0xf bound_ctrl:0
    s_nop 1
    v_add_f32_dpp v14, v14, v14 row_shr:2 row_mask:0xf bank_mask:0xf bound_ctrl:0
    s_nop 1
    v_add_f32_dpp v14, v14, v14 row_shr:4 row_mask:0xf bank_mask:0xf bound_ctrl:0
    s_nop 1
    v_add_f32_dpp v14, v14, v14 row_shr:8 row_mask:0xf bank_mask:0xf bound_ctrl:0
    s_nop 1
    v_add_f32_dpp v14, v14, v14 row_bcast:15 row_mask:0xa bank_mask:0xf
    s_nop 1
    v_add_f32_dpp v14, v14, v14 row_bcast:31 row_mask:0xc bank_mask:0xf
    s_nop 1
    v_readlane_b32 s46, v14, 63
    s_nop 1
    v_mov_b32 v15, s46
    v_mul_f32 v15, 0x3a800000, v15
    v_mov_b32 v14, 0
    v_sub_f32 v80, v64, v15
    v_sub_f32 v81, v65, v15
    v_sub_f32 v82, v66, v15
    v_sub_f32 v83, v67, v15
    v_sub_f32 v84, v68, v15
    v_sub_f32 v85, v69, v15
    v_sub_f32 v86, v70, v15
    v_sub_f32 v87, v71, v15
    v_sub_f32 v88, v72, v15
    v_sub_f32 v89, v73, v15
    v_sub_f32 v90, v74, v15
    v_sub_f32 v91, v75, v15
    v_sub_f32 v92, v76, v15
    v_sub_f32 v93, v77, v15
    v_sub_f32 v94, v78, v15
    v_sub_f32 v95, v79, v15
    v_fmac_f32 v14, v80, v80
    v_fmac_f32 v14, v81, v81
    v_fmac_f32 v14, v82, v82
    v_fmac_f32 v14, v83, v83
    v_fmac_f32 v14, v84, v84
    v_fmac_f32 v14, v85, v85
    v_fmac_f32 v14, v86, v86
    v_fmac_f32 v14, v87, v87
    v_fmac_f32 v14, v88, v88
    v_fmac_f32 v14, v89, v89
    v_fmac_f32 v14, v90, v90
    v_fmac_f32 v14, v91, v91
    v_fmac_f32 v14, v92, v92
    v_fmac_f32 v14, v93, v93
    v_fmac_f32 v14, v94, v94
    v_fmac_f32 v14, v95, v95
    s_nop 1
    v_add_f32_dpp v14, v14, v14 row_shr:1 row_mask:0xf bank_mask:0xf bound_ctrl:0
    s_nop 1
    v_add_f32_dpp v14, v14, v14 row_shr:2 row_mask:0xf bank_mask:0xf bound_ctrl:0
    s_nop 1
    v_add_f32_dpp v14, v14, v14 row_shr:4 row_mask:0xf bank_mask:0xf bound_ctrl:0
    s_nop 1
    v_add_f32_dpp v14, v14, v14 row_shr:8 row_mask:0xf bank_mask:0xf bound_ctrl:0
    s_nop 1
    v_add_f32_dpp v14, v14, v14 row_bcast:15 row_mask:0xa bank_mask:0xf
    s_nop 1
    v_add_f32_dpp v14, v14, v14 row_bcast:31 row_mask:0xc bank_mask:0xf
    s_nop 1
    v_readlane_b32 s47, v14, 63
    s_nop 1
    v_mov_b32 v14, s47
    v_mul_f32 v14, 0x3a800000, v14
    v_cvt_pk_bf16_f32 v14, v14, v14
    v_lshlrev_b32 v14, 16, v14
    v_cvt_pk_bf16_f32 v15, v15, v15
    v_lshlrev_b32 v15, 16, v15
    v_add_f32 v14, 0x3727c5ac, v14
    v_cvt_pk_bf16_f32 v14, v14, v14
    v_lshlrev_b32 v14, 16, v14
    v_sqrt_f32 v14, v14
    s_nop 0
    v_cvt_pk_bf16_f32 v14, v14, v14
    v_lshlrev_b32 v14, 16, v14
    v_rcp_f32 v14, v14
    v_sub_f32 v64, v64, v15
    v_sub_f32 v65, v65, v15
    v_sub_f32 v66, v66, v15
    v_sub_f32 v67, v67, v15
    v_sub_f32 v68, v68, v15
    v_sub_f32 v69, v69, v15
    v_sub_f32 v70, v70, v15
    v_sub_f32 v71, v71, v15
    v_sub_f32 v72, v72, v15
    v_sub_f32 v73, v73, v15
    v_sub_f32 v74, v74, v15
    v_sub_f32 v75, v75, v15
    v_sub_f32 v76, v76, v15
    v_sub_f32 v77, v77, v15
    v_sub_f32 v78, v78, v15
    v_sub_f32 v79, v79, v15
    v_cvt_pk_bf16_f32 v64, v64, v64
    v_cvt_pk_bf16_f32 v65, v65, v65
    v_cvt_pk_bf16_f32 v66, v66, v66
    v_cvt_pk_bf16_f32 v67, v67, v67
    v_cvt_pk_bf16_f32 v68, v68, v68
    v_cvt_pk_bf16_f32 v69, v69, v69
    v_cvt_pk_bf16_f32 v70, v70, v70
    v_cvt_pk_bf16_f32 v71, v71, v71
    v_cvt_pk_bf16_f32 v72, v72, v72
    v_cvt_pk_bf16_f32 v73, v73, v73
    v_cvt_pk_bf16_f32 v74, v74, v74
    v_cvt_pk_bf16_f32 v75, v75, v75
    v_cvt_pk_bf16_f32 v76, v76, v76
    v_cvt_pk_bf16_f32 v77, v77, v77
    v_cvt_pk_bf16_f32 v78, v78, v78
    v_cvt_pk_bf16_f32 v79, v79, v79
    v_lshlrev_b32 v64, 16, v64
    v_lshlrev_b32 v65, 16, v65
    v_lshlrev_b32 v66, 16, v66
    v_lshlrev_b32 v67, 16, v67
    v_lshlrev_b32 v68, 16, v68
    v_lshlrev_b32 v69, 16, v69
    v_lshlrev_b32 v70, 16, v70
    v_lshlrev_b32 v71, 16, v71
    v_lshlrev_b32 v72, 16, v72
    v_lshlrev_b32 v73, 16, v73
    v_lshlrev_b32 v74, 16, v74
    v_lshlrev_b32 v75, 16, v75
    v_lshlrev_b32 v76, 16, v76
    v_lshlrev_b32 v77, 16, v77
    v_lshlrev_b32 v78, 16, v78
    v_lshlrev_b32 v79, 16, v79
    v_mul_f32 v64, v64, v14
    v_mul_f32 v65, v65, v14
    v_mul_f32 v66, v66, v14
    v_mul_f32 v67, v67, v14
    v_mul_f32 v68, v68, v14
    v_mul_f32 v69, v69, v14
    v_mul_f32 v70, v70, v14
    v_mul_f32 v71, v71, v14
    v_mul_f32 v72, v72, v14
    v_mul_f32 v73, v73, v14
    v_mul_f32 v74, v74, v14
    v_mul_f32 v75, v75, v14
    v_mul_f32 v76, v76, v14
    v_mul_f32 v77, v77, v14
    v_mul_f32 v78, v78, v14
    v_mul_f32 v79, v79, v14
    v_cvt_pk_bf16_f32 v64, v64, v64
    v_cvt_pk_bf16_f32 v65, v65, v65
    v_cvt_pk_bf16_f32 v66, v66, v66
    v_cvt_pk_bf16_f32 v67, v67, v67
    v_cvt_pk_bf16_f32 v68, v68, v68
    v_cvt_pk_bf16_f32 v69, v69, v69
    v_cvt_pk_bf16_f32 v70, v70, v70
    v_cvt_pk_bf16_f32 v71, v71, v71
    v_cvt_pk_bf16_f32 v72, v72, v72
    v_cvt_pk_bf16_f32 v73, v73, v73
    v_cvt_pk_bf16_f32 v74, v74, v74
    v_cvt_pk_bf16_f32 v75, v75, v75
    v_cvt_pk_bf16_f32 v76, v76, v76
    v_cvt_pk_bf16_f32 v77, v77, v77
    v_cvt_pk_bf16_f32 v78, v78, v78
    v_cvt_pk_bf16_f32 v79, v79, v79
    v_lshlrev_b32 v64, 16, v64
    v_lshlrev_b32 v65, 16, v65
    v_lshlrev_b32 v66, 16, v66
    v_lshlrev_b32 v67, 16, v67
    v_lshlrev_b32 v68, 16, v68
    v_lshlrev_b32 v69, 16, v69
    v_lshlrev_b32 v70, 16, v70
    v_lshlrev_b32 v71, 16, v71
    v_lshlrev_b32 v72, 16, v72
    v_lshlrev_b32 v73, 16, v73
    v_lshlrev_b32 v74, 16, v74
    v_lshlrev_b32 v75, 16, v75
    v_lshlrev_b32 v76, 16, v76
    v_lshlrev_b32 v77, 16, v77
    v_lshlrev_b32 v78, 16, v78
    v_lshlrev_b32 v79, 16, v79
    v_mul_f32 v64, v64, v32
    v_mul_f32 v65, v65, v33
    v_mul_f32 v66, v66, v34
    v_mul_f32 v67, v67, v35
    v_mul_f32 v68, v68, v36
    v_mul_f32 v69, v69, v37
    v_mul_f32 v70, v70, v38
    v_mul_f32 v71, v71, v39
    v_mul_f32 v72, v72, v40
    v_mul_f32 v73, v73, v41
    v_mul_f32 v74, v74, v42
    v_mul_f32 v75, v75, v43
    v_mul_f32 v76, v76, v44
    v_mul_f32 v77, v77, v45
    v_mul_f32 v78, v78, v46
    v_mul_f32 v79, v79, v47
    v_cvt_pk_bf16_f32 v64, v64, v64
    v_cvt_pk_bf16_f32 v65, v65, v65
    v_cvt_pk_bf16_f32 v66, v66, v66
    v_cvt_pk_bf16_f32 v67, v67, v67
    v_cvt_pk_bf16_f32 v68, v68, v68
    v_cvt_pk_bf16_f32 v69, v69, v69
    v_cvt_pk_bf16_f32 v70, v70, v70
    v_cvt_pk_bf16_f32 v71, v71, v71
    v_cvt_pk_bf16_f32 v72, v72, v72
    v_cvt_pk_bf16_f32 v73, v73, v73
    v_cvt_pk_bf16_f32 v74, v74, v74
    v_cvt_pk_bf16_f32 v75, v75, v75
    v_cvt_pk_bf16_f32 v76, v76, v76
    v_cvt_pk_bf16_f32 v77, v77, v77
    v_cvt_pk_bf16_f32 v78, v78, v78
    v_cvt_pk_bf16_f32 v79, v79, v79
    v_lshlrev_b32 v64, 16, v64
    v_lshlrev_b32 v65, 16, v65
    v_lshlrev_b32 v66, 16, v66
    v_lshlrev_b32 v67, 16, v67
    v_lshlrev_b32 v68, 16, v68
    v_lshlrev_b32 v69, 16, v69
    v_lshlrev_b32 v70, 16, v70
    v_lshlrev_b32 v71, 16, v71
    v_lshlrev_b32 v72, 16, v72
    v_lshlrev_b32 v73, 16, v73
    v_lshlrev_b32 v74, 16, v74
    v_lshlrev_b32 v75, 16, v75
    v_lshlrev_b32 v76, 16, v76
    v_lshlrev_b32 v77, 16, v77
    v_lshlrev_b32 v78, 16, v78
    v_lshlrev_b32 v79, 16, v79
    v_add_f32 v64, v64, v48
    v_add_f32 v65, v65, v49
    v_add_f32 v66, v66, v50
    v_add_f32 v67, v67, v51
    v_add_f32 v68, v68, v52
    v_add_f32 v69, v69, v53
    v_add_f32 v70, v70, v54
    v_add_f32 v71, v71, v55
    v_add_f32 v72, v72, v56
    v_add_f32 v73, v73, v57
    v_add_f32 v74, v74, v58
    v_add_f32 v75, v75, v59
    v_add_f32 v76, v76, v60
    v_add_f32 v77, v77, v61
    v_add_f32 v78, v78, v62
    v_add_f32 v79, v79, v63
    v_cvt_pk_bf16_f32 v104, v64, v65
    v_cvt_pk_bf16_f32 v105, v66, v67
    v_cvt_pk_bf16_f32 v106, v68, v69
    v_cvt_pk_bf16_f32 v107, v70, v71
    v_cvt_pk_bf16_f32 v108, v72, v73
    v_cvt_pk_bf16_f32 v109, v74, v75
    v_cvt_pk_bf16_f32 v110, v76, v77
    v_cvt_pk_bf16_f32 v111, v78, v79
    ds_write_b128 v10, v[104:107]
    ds_write_b128 v10, v[108:111] offset:1024
    s_waitcnt lgkmcnt(0)
    s_barrier
    ds_read_b128 v[104:107], v13
    ds_read_b128 v[108:111], v13 offset:128
    s_waitcnt lgkmcnt(1)
    buffer_store_dwordx4 v[104:107], v11, s[12:15], s63 offen sc1
    s_waitcnt lgkmcnt(0)
    buffer_store_dwordx4 v[108:111], v12, s[12:15], s63 offen sc1
    s_lshl_b32 s46, s42, 8
    s_lshl_b32 s47, s43, 7
    s_add_u32 s46, s46, s47
    s_add_u32 s46, s46, 0x108000
    s_waitcnt vmcnt(0)
    s_barrier
    s_cmp_lg_u32 s44, 0
    s_cbranch_scc1 L_sf_34
    v_mov_b32 v14, s60
    v_add_u32 v14, 1, v14
    v_mov_b32 v15, 0
    s_mov_b64 exec, 1
    buffer_store_dword v14, v15, s[12:15], s46 offen sc1
    s_mov_b64 exec, -1
L_sf_34:
    s_add_u32 s60, s60, 2
    s_cmp_lt_u32 s60, 64
    s_cbranch_scc1 L_r_loop_30
    s_branch L_c_done_7
L_w_att_23:
    s_lshl_b32 s42, s40, 2
    s_and_b32 s46, s44, 3
    s_add_u32 s42, s42, s46
    s_and_b32 s43, s45, 1
    s_lshl_b32 s43, s43, 1
    s_lshr_b32 s46, s44, 2
    s_add_u32 s43, s43, s46
    s_mul_i32 s46, s42, 24576
    s_add_u32 s46, s46, 0x2000000
    v_lshlrev_b32 v2, 4, v1
    v_add_u32 v3, s46, v2
    v_add_u32 v5, 4096, v3
    v_lshrrev_b32 v4, 4, v1
    v_and_b32 v9, 15, v1
    s_lshl_b32 s46, s42, 12
    s_add_u32 s46, s46, 0x1000000
    v_and_b32 v6, 7, v1
    v_lshlrev_b32 v6, 4, v6
    v_lshl_add_u32 v6, v4, 7, v6
    v_add_u32 v6, s46, v6
    v_and_b32 v7, 31, v1
    v_lshlrev_b32 v7, 4, v7
    v_lshrrev_b32 v10, 5, v1
    v_lshl_add_u32 v7, v10, 10, v7
    v_add_u32 v7, s46, v7
    s_mul_i32 s50, s44, 13056
    v_mul_u32_u24 v8, 272, v9
    v_lshl_add_u32 v8, v4, 4, v8
    v_add_u32 v8, s50, v8
    v_bfe_u32 v11, v1, 2, 3
    v_mul_u32_u24 v11, 272, v11
    v_lshl_add_u32 v11, v10, 6, v11
    v_and_b32 v12, 3, v1
    v_lshl_add_u32 v11, v12, 4, v11
    v_add_u32 v11, s50, v11
    v_mul_u32_u24 v14, 272, v4
    v_lshl_add_u32 v14, v9, 4, v14
    v_add_u32 v14, s50, v14
    v_mov_b32 v16, 0
    v_mov_b32 v17, 0
    v_mov_b32 v18, 0
    v_mov_b32 v19, 0
    ds_write_b128 v14, v[16:19] offset:10880
    ds_write_b128 v14, v[16:19] offset:11968
    v_lshlrev_b32 v12, 2, v4
    v_bfe_u32 v13, v1, 2, 2
    v_add_u32 v12, v12, v13
    v_mul_u32_u24 v12, 272, v12
    v_and_b32 v13, 3, v1
    v_lshl_add_u32 v12, v13, 3, v12
    v_add_u32 v12, s50, v12
    v_lshlrev_b32 v13, 10, v13
    s_lshl_b32 s46, s42, 12
    s_add_u32 s46, s46, 0x1000000
    v_add_u32 v13, s46, v13
    v_add_u32 v41, s46, v2
    v_lshlrev_b32 v10, 9, v4
    v_lshl_add_u32 v10, v9, 4, v10
    s_lshl_b32 s46, s42, 13
    s_add_u32 s46, s46, 0x5000000
    v_add_u32 v10, s46, v10
    s_lshl_b32 s52, s42, 9
    s_lshl_b32 s47, s43, 7
    s_add_u32 s52, s52, s47
    s_add_u32 s52, s52, 0x104000
    v_cmp_le_u32 s[56:57], 32, v1
    v_lshlrev_b32 v14, 2, v4
    s_mov_b32 s54, 0x3e0293ee
    s_mov_b32 s60, s43
    v_add_u32 v15, 0, v14
    v_cmp_gt_u32 s[84:85], v15, v9
    v_add_u32 v15, 1, v14
    v_cmp_gt_u32 s[86:87], v15, v9
    v_add_u32 v15, 2, v14
    v_cmp_gt_u32 s[88:89], v15, v9
    v_add_u32 v15, 3, v14
    v_cmp_gt_u32 s[90:91], v15, v9
    v_mov_b32 v16, -1
    v_mov_b32 v17, -1
    v_mov_b32 v18, -1
    v_mov_b32 v19, -1
    s_lshl_b32 s46, s43, 17
    buffer_store_dwordx4 v[16:19], v41, s[12:15], s46 offen offset:0 sc1
    buffer_store_dwordx4 v[16:19], v41, s[12:15], s46 offen offset:1024 sc1
    buffer_store_dwordx4 v[16:19], v41, s[12:15], s46 offen offset:2048 sc1
    buffer_store_dwordx4 v[16:19], v41, s[12:15], s46 offen offset:3072 sc1
    s_add_u32 s46, s46, 524288
    buffer_store_dwordx4 v[16:19], v41, s[12:15], s46 offen offset:0 sc1
    buffer_store_dwordx4 v[16:19], v41, s[12:15], s46 offen offset:1024 sc1
    buffer_store_dwordx4 v[16:19], v41, s[12:15], s46 offen offset:2048 sc1
    buffer_store_dwordx4 v[16:19], v41, s[12:15], s46 offen offset:3072 sc1
    s_add_u32 s46, s46, 524288
    buffer_store_dwordx4 v[16:19], v41, s[12:15], s46 offen offset:0 sc1
    buffer_store_dwordx4 v[16:19], v41, s[12:15], s46 offen offset:1024 sc1
    buffer_store_dwordx4 v[16:19], v41, s[12:15], s46 offen offset:2048 sc1
    buffer_store_dwordx4 v[16:19], v41, s[12:15], s46 offen offset:3072 sc1
    s_add_u32 s46, s46, 524288
    buffer_store_dwordx4 v[16:19], v41, s[12:15], s46 offen offset:0 sc1
    buffer_store_dwordx4 v[16:19], v41, s[12:15], s46 offen offset:1024 sc1
    buffer_store_dwordx4 v[16:19], v41, s[12:15], s46 offen offset:2048 sc1
    buffer_store_dwordx4 v[16:19], v41, s[12:15], s46 offen offset:3072 sc1
    s_add_u32 s46, s46, 524288
    buffer_store_dwordx4 v[16:19], v41, s[12:15], s46 offen offset:0 sc1
    buffer_store_dwordx4 v[16:19], v41, s[12:15], s46 offen offset:1024 sc1
    buffer_store_dwordx4 v[16:19], v41, s[12:15], s46 offen offset:2048 sc1
    buffer_store_dwordx4 v[16:19], v41, s[12:15], s46 offen offset:3072 sc1
    s_add_u32 s46, s46, 524288
    buffer_store_dwordx4 v[16:19], v41, s[12:15], s46 offen offset:0 sc1
    buffer_store_dwordx4 v[16:19], v41, s[12:15], s46 offen offset:1024 sc1
    buffer_store_dwordx4 v[16:19], v41, s[12:15], s46 offen offset:2048 sc1
    buffer_store_dwordx4 v[16:19], v41, s[12:15], s46 offen offset:3072 sc1
    s_add_u32 s46, s46, 524288
    buffer_store_dwordx4 v[16:19], v41, s[12:15], s46 offen offset:0 sc1
    buffer_store_dwordx4 v[16:19], v41, s[12:15], s46 offen offset:1024 sc1
    buffer_store_dwordx4 v[16:19], v41, s[12:15], s46 offen offset:2048 sc1
    buffer_store_dwordx4 v[16:19], v41, s[12:15], s46 offen offset:3072 sc1
    s_add_u32 s46, s46, 524288
    buffer_store_dwordx4 v[16:19], v41, s[12:15], s46 offen offset:0 sc1
    buffer_store_dwordx4 v[16:19], v41, s[12:15], s46 offen offset:1024 sc1
    buffer_store_dwordx4 v[16:19], v41, s[12:15], s46 offen offset:2048 sc1
    buffer_store_dwordx4 v[16:19], v41, s[12:15], s46 offen offset:3072 sc1
    s_add_u32 s46, s46, 524288
    buffer_store_dwordx4 v[16:19], v41, s[12:15], s46 offen offset:0 sc1
    buffer_store_dwordx4 v[16:19], v41, s[12:15], s46 offen offset:1024 sc1
    buffer_store_dwordx4 v[16:19], v41, s[12:15], s46 offen offset:2048 sc1
    buffer_store_dwordx4 v[16:19], v41, s[12:15], s46 offen offset:3072 sc1
    s_add_u32 s46, s46, 524288
    buffer_store_dwordx4 v[16:19], v41, s[12:15], s46 offen offset:0 sc1
    buffer_store_dwordx4 v[16:19], v41, s[12:15], s46 offen offset:1024 sc1
    buffer_store_dwordx4 v[16:19], v41, s[12:15], s46 offen offset:2048 sc1
    buffer_store_dwordx4 v[16:19], v41, s[12:15], s46 offen offset:3072 sc1
    s_add_u32 s46, s46, 524288
    buffer_store_dwordx4 v[16:19], v41, s[12:15], s46 offen offset:0 sc1
    buffer_store_dwordx4 v[16:19], v41, s[12:15], s46 offen offset:1024 sc1
    buffer_store_dwordx4 v[16:19], v41, s[12:15], s46 offen offset:2048 sc1
    buffer_store_dwordx4 v[16:19], v41, s[12:15], s46 offen offset:3072 sc1
    s_add_u32 s46, s46, 524288
    buffer_store_dwordx4 v[16:19], v41, s[12:15], s46 offen offset:0 sc1
    buffer_store_dwordx4 v[16:19], v41, s[12:15], s46 offen offset:1024 sc1
    buffer_store_dwordx4 v[16:19], v41, s[12:15], s46 offen offset:2048 sc1
    buffer_store_dwordx4 v[16:19], v41, s[12:15], s46 offen offset:3072 sc1
    s_add_u32 s46, s46, 524288
    buffer_store_dwordx4 v[16:19], v41, s[12:15], s46 offen offset:0 sc1
    buffer_store_dwordx4 v[16:19], v41, s[12:15], s46 offen offset:1024 sc1
    buffer_store_dwordx4 v[16:19], v41, s[12:15], s46 offen offset:2048 sc1
    buffer_store_dwordx4 v[16:19], v41, s[12:15], s46 offen offset:3072 sc1
    s_add_u32 s46, s46, 524288
    buffer_store_dwordx4 v[16:19], v41, s[12:15], s46 offen offset:0 sc1
    buffer_store_dwordx4 v[16:19], v41, s[12:15], s46 offen offset:1024 sc1
    buffer_store_dwordx4 v[16:19], v41, s[12:15], s46 offen offset:2048 sc1
    buffer_store_dwordx4 v[16:19], v41, s[12:15], s46 offen offset:3072 sc1
    s_add_u32 s46, s46, 524288
    buffer_store_dwordx4 v[16:19], v41, s[12:15], s46 offen offset:0 sc1
    buffer_store_dwordx4 v[16:19], v41, s[12:15], s46 offen offset:1024 sc1
    buffer_store_dwordx4 v[16:19], v41, s[12:15], s46 offen offset:2048 sc1
    buffer_store_dwordx4 v[16:19], v41, s[12:15], s46 offen offset:3072 sc1
    s_add_u32 s46, s46, 524288
    buffer_store_dwordx4 v[16:19], v41, s[12:15], s46 offen offset:0 sc1
    buffer_store_dwordx4 v[16:19], v41, s[12:15], s46 offen offset:1024 sc1
    buffer_store_dwordx4 v[16:19], v41, s[12:15], s46 offen offset:2048 sc1
    buffer_store_dwordx4 v[16:19], v41, s[12:15], s46 offen offset:3072 sc1
    s_add_u32 s46, s46, 524288
    s_waitcnt vmcnt(0)
    s_barrier
    s_cmp_lg_u32 s44, 0
    s_cbranch_scc1 L_a_nr_35
    s_or_b32 s47, s39, 0x100
    v_mov_b32 v16, s47
    v_mov_b32 v17, 0
    s_lshl_b32 s46, s40, 3
    s_and_b32 s47, s41, 1
    s_lshl_b32 s47, s47, 2
    s_add_u32 s46, s46, s47
    s_add_u32 s46, s46, 0x101200
    s_mov_b64 exec, 1
    buffer_store_dword v16, v17, s[12:15], s46 offen sc1
    s_mov_b64 exec, -1
L_a_nr_35:
L_a_loop_36:
    s_mul_i32 s45, s60, 786432
    s_add_u32 s48, s45, 8192
    s_add_u32 s49, s45, 16384
    s_lshl_b32 s61, s60, 17
    s_lshl_b32 s63, s60, 18
    buffer_load_dwordx4 a[0:3], v3, s[12:15], s45 offen offset:0
    buffer_load_dwordx4 a[4:7], v3, s[12:15], s45 offen offset:1024
    buffer_load_dwordx4 a[8:11], v3, s[12:15], s45 offen offset:2048
    buffer_load_dwordx4 a[12:15], v3, s[12:15], s45 offen offset:3072
    buffer_load_dwordx4 a[16:19], v5, s[12:15], s45 offen offset:0
    buffer_load_dwordx4 a[20:23], v5, s[12:15], s45 offen offset:1024
    buffer_load_dwordx4 a[24:27], v5, s[12:15], s45 offen offset:2048
    buffer_load_dwordx4 a[28:31], v5, s[12:15], s45 offen offset:3072
    buffer_load_dwordx4 a[32:35], v3, s[12:15], s48 offen offset:0
    buffer_load_dwordx4 a[36:39], v3, s[12:15], s48 offen offset:1024
    buffer_load_dwordx4 a[40:43], v3, s[12:15], s48 offen offset:2048
    buffer_load_dwordx4 a[44:47], v3, s[12:15], s48 offen offset:3072
    buffer_load_dwordx4 a[48:51], v5, s[12:15], s48 offen offset:0
    buffer_load_dwordx4 a[52:55], v5, s[12:15], s48 offen offset:1024
    buffer_load_dwordx4 a[56:59], v5, s[12:15], s48 offen offset:2048
    buffer_load_dwordx4 a[60:63], v5, s[12:15], s48 offen offset:3072
    buffer_load_dwordx4 v[16:19], v3, s[12:15], s49 offen offset:0
    buffer_load_dwordx4 v[20:23], v3, s[12:15], s49 offen offset:1024
    buffer_load_dwordx4 v[24:27], v3, s[12:15], s49 offen offset:2048
    buffer_load_dwordx4 v[28:31], v3, s[12:15], s49 offen offset:3072
    buffer_load_dwordx4 v[32:35], v5, s[12:15], s49 offen offset:0
    buffer_load_dwordx4 v[36:39], v5, s[12:15], s49 offen offset:1024
    buffer_load_dwordx4 v[40:43], v5, s[12:15], s49 offen offset:2048
    buffer_load_dwordx4 v[44:47], v5, s[12:15], s49 offen offset:3072
    s_waitcnt vmcnt(0)
    ds_write_b128 v8, v[16:19] offset:0
    ds_write_b128 v8, v[20:23] offset:64
    ds_write_b128 v8, v[24:27] offset:128
    ds_write_b128 v8, v[28:31] offset:192
    ds_write_b128 v8, v[32:35] offset:4352
    ds_write_b128 v8, v[36:39] offset:4416
    ds_write_b128 v8, v[40:43] offset:4480
    ds_write_b128 v8, v[44:47] offset:4544
    v_mfma_f32_16x16x32_bf16 v[56:59], a[32:35], a[0:3], 0
    v_mfma_f32_16x16x32_bf16 v[60:63], a[32:35], a[16:19], 0
    v_mfma_f32_16x16x32_bf16 v[68:71], a[48:51], a[16:19], 0
    v_mfma_f32_16x16x32_bf16 v[56:59], a[36:39], a[4:7], v[56:59]
    v_mfma_f32_16x16x32_bf16 v[60:63], a[36:39], a[20:23], v[60:63]
    v_mfma_f32_16x16x32_bf16 v[68:71], a[52:55], a[20:23], v[68:71]
    v_mfma_f32_16x16x32_bf16 v[56:59], a[40:43], a[8:11], v[56:59]
    v_mfma_f32_16x16x32_bf16 v[60:63], a[40:43], a[24:27], v[60:63]
    v_mfma_f32_16x16x32_bf16 v[68:71], a[56:59], a[24:27], v[68:71]
    v_mfma_f32_16x16x32_bf16 v[56:59], a[44:47], a[12:15], v[56:59]
    v_mfma_f32_16x16x32_bf16 v[60:63], a[44:47], a[28:31], v[60:63]
    v_mfma_f32_16x16x32_bf16 v[68:71], a[60:63], a[28:31], v[68:71]
    s_waitcnt lgkmcnt(0)
    ds_read_b64_tr_b16 a[80:81], v12 offset:0
    ds_read_b64_tr_b16 a[82:83], v12 offset:4352
    ds_read_b64_tr_b16 a[86:87], v12 offset:32
    ds_read_b64_tr_b16 a[88:89], v12 offset:4384
    ds_read_b64_tr_b16 a[92:93], v12 offset:64
    ds_read_b64_tr_b16 a[94:95], v12 offset:4416
    ds_read_b64_tr_b16 a[98:99], v12 offset:96
    ds_read_b64_tr_b16 a[100:101], v12 offset:4448
    s_waitcnt lgkmcnt(0)
    ds_read_b64_tr_b16 a[104:105], v12 offset:128
    ds_read_b64_tr_b16 a[106:107], v12 offset:4480
    ds_read_b64_tr_b16 a[110:111], v12 offset:160
    ds_read_b64_tr_b16 a[112:113], v12 offset:4512
    ds_read_b64_tr_b16 a[116:117], v12 offset:192
    ds_read_b64_tr_b16 a[118:119], v12 offset:4544
    ds_read_b64_tr_b16 a[122:123], v12 offset:224
    ds_read_b64_tr_b16 a[124:125], v12 offset:4576
    v_mov_b32 v15, 0xff800000
    v_cndmask_b32 v56, v56, v15, s[84:85]
    v_cndmask_b32 v68, v68, v15, s[84:85]
    v_cndmask_b32 v57, v57, v15, s[86:87]
    v_cndmask_b32 v69, v69, v15, s[86:87]
    v_cndmask_b32 v58, v58, v15, s[88:89]
    v_cndmask_b32 v70, v70, v15, s[88:89]
    v_cndmask_b32 v59, v59, v15, s[90:91]
    v_cndmask_b32 v71, v71, v15, s[90:91]
    s_mov_b32 s70, 0
L_a_cp_37:
    buffer_load_dword v40, v13, s[12:15], s61 offen sc1
    s_waitcnt vmcnt(0)
    v_cmp_eq_u32 vcc, -1, v40
    s_add_u32 s70, s70, 1
    s_cbranch_vccz L_a_fl_38
L_a_cp_37_s:
    s_sleep 16
    s_cmp_lt_u32 s70, 524288
    s_cbranch_scc1 L_a_cp_37
    s_branch L_c_done_7
L_a_fl_38:
    buffer_load_dwordx4 v[24:27], v6, s[12:15], s61 offen offset:0 sc1
    buffer_load_dwordx4 v[28:31], v6, s[12:15], s61 offen offset:1024 sc1
    buffer_load_dwordx4 v[32:35], v6, s[12:15], s61 offen offset:2048 sc1
    buffer_load_dwordx4 v[36:39], v6, s[12:15], s61 offen offset:3072 sc1
    buffer_load_dwordx4 v[16:19], v7, s[12:15], s61 offen offset:512 sc1
    buffer_load_dwordx4 v[20:23], v7, s[12:15], s61 offen offset:2560 sc1
    s_waitcnt vmcnt(0)
    v_max_u32 v40, v16, v17
    v_max3_u32 v40, v40, v18, v19
    v_max3_u32 v40, v40, v20, v21
    v_max3_u32 v40, v40, v22, v23
    v_max3_u32 v40, v40, v24, v25
    v_max3_u32 v40, v40, v26, v27
    v_max3_u32 v40, v40, v28, v29
    v_max3_u32 v40, v40, v30, v31
    v_max3_u32 v40, v40, v32, v33
    v_max3_u32 v40, v40, v34, v35
    v_max3_u32 v40, v40, v36, v37
    v_max3_u32 v40, v40, v38, v39
    v_cmp_eq_u32 vcc, -1, v40
    s_nop 0
    s_cbranch_vccnz L_a_cp_37_s
    v_mfma_f32_16x16x32_bf16 v[72:75], v[24:27], a[0:3], 0
    v_mfma_f32_16x16x32_bf16 v[76:79], v[24:27], a[16:19], 0
    v_mfma_f32_16x16x32_bf16 v[72:75], v[28:31], a[4:7], v[72:75]
    v_mfma_f32_16x16x32_bf16 v[76:79], v[28:31], a[20:23], v[76:79]
    v_mfma_f32_16x16x32_bf16 v[72:75], v[32:35], a[8:11], v[72:75]
    v_mfma_f32_16x16x32_bf16 v[76:79], v[32:35], a[24:27], v[76:79]
    v_mfma_f32_16x16x32_bf16 v[72:75], v[36:39], a[12:15], v[72:75]
    v_mfma_f32_16x16x32_bf16 v[76:79], v[36:39], a[28:31], v[76:79]
    ds_write_b128 v11, v[16:19] offset:8704
    ds_write_b128 v11, v[20:23] offset:8832
    s_waitcnt lgkmcnt(0)
    ds_read_b64_tr_b16 a[84:85], v12 offset:8704
    ds_read_b64_tr_b16 a[90:91], v12 offset:8736
    ds_read_b64_tr_b16 a[96:97], v12 offset:8768
    ds_read_b64_tr_b16 a[102:103], v12 offset:8800
    ds_read_b64_tr_b16 a[108:109], v12 offset:8832
    ds_read_b64_tr_b16 a[114:115], v12 offset:8864
    ds_read_b64_tr_b16 a[120:121], v12 offset:8896
    ds_read_b64_tr_b16 a[126:127], v12 offset:8928
    v_cndmask_b32 v72, v72, v15, s[56:57]
    v_cndmask_b32 v73, v73, v15, s[56:57]
    v_cndmask_b32 v74, v74, v15, s[56:57]
    v_cndmask_b32 v75, v75, v15, s[56:57]
    v_cndmask_b32 v76, v76, v15, s[56:57]
    v_cndmask_b32 v77, v77, v15, s[56:57]
    v_cndmask_b32 v78, v78, v15, s[56:57]
    v_cndmask_b32 v79, v79, v15, s[56:57]
    v_max_f32 v40, v56, v57
    v_max3_f32 v40, v40, v58, v59
    v_max3_f32 v40, v40, v72, v73
    v_max3_f32 v40, v40, v74, v75
    v_mov_b32 v41, v40
    s_nop 1
    v_permlane16_swap_b32 v40, v41
    v_max_f32 v40, v40, v41
    v_mov_b32 v41, v40
    s_nop 1
    v_permlane32_swap_b32 v40, v41
    v_max_f32 v40, v40, v41
    v_mul_f32 v40, s54, v40
    v_fma_f32 v56, v56, s54, -v40
    v_fma_f32 v57, v57, s54, -v40
    v_fma_f32 v58, v58, s54, -v40
    v_fma_f32 v59, v59, s54, -v40
    v_fma_f32 v72, v72, s54, -v40
    v_fma_f32 v73, v73, s54, -v40
    v_fma_f32 v74, v74, s54, -v40
    v_fma_f32 v75, v75, s54, -v40
    v_exp_f32 v56, v56
    v_exp_f32 v57, v57
    v_exp_f32 v58, v58
    v_exp_f32 v59, v59
    v_exp_f32 v72, v72
    v_exp_f32 v73, v73
    v_exp_f32 v74, v74
    v_exp_f32 v75, v75
    v_add_f32 v40, v56, v57
    v_add_f32 v40, v40, v58
    v_add_f32 v40, v40, v59
    v_add_f32 v40, v40, v72
    v_add_f32 v40, v40, v73
    v_add_f32 v40, v40, v74
    v_add_f32 v40, v40, v75
    v_mov_b32 v41, v40
    s_nop 1
    v_permlane16_swap_b32 v40, v41
    v_add_f32 v40, v40, v41
    v_mov_b32 v41, v40
    s_nop 1
    v_permlane32_swap_b32 v40, v41
    v_add_f32 v40, v40, v41
    v_rcp_f32 v40, v40
    s_nop 0
    v_mul_f32 v56, v56, v40
    v_mul_f32 v57, v57, v40
    v_mul_f32 v58, v58, v40
    v_mul_f32 v59, v59, v40
    v_mul_f32 v72, v72, v40
    v_mul_f32 v73, v73, v40
    v_mul_f32 v74, v74, v40
    v_mul_f32 v75, v75, v40
    v_cvt_pk_bf16_f32 v24, v56, v57
    v_cvt_pk_bf16_f32 v25, v58, v59
    v_cvt_pk_bf16_f32 v28, v72, v73
    v_cvt_pk_bf16_f32 v29, v74, v75
    v_max_f32 v40, v60, v61
    v_max3_f32 v40, v40, v62, v63
    v_max3_f32 v40, v40, v68, v69
    v_max3_f32 v40, v40, v70, v71
    v_max3_f32 v40, v40, v76, v77
    v_max3_f32 v40, v40, v78, v79
    v_mov_b32 v41, v40
    s_nop 1
    v_permlane16_swap_b32 v40, v41
    v_max_f32 v40, v40, v41
    v_mov_b32 v41, v40
    s_nop 1
    v_permlane32_swap_b32 v40, v41
    v_max_f32 v40, v40, v41
    v_mul_f32 v40, s54, v40
    v_fma_f32 v60, v60, s54, -v40
    v_fma_f32 v61, v61, s54, -v40
    v_fma_f32 v62, v62, s54, -v40
    v_fma_f32 v63, v63, s54, -v40
    v_fma_f32 v68, v68, s54, -v40
    v_fma_f32 v69, v69, s54, -v40
    v_fma_f32 v70, v70, s54, -v40
    v_fma_f32 v71, v71, s54, -v40
    v_fma_f32 v76, v76, s54, -v40
    v_fma_f32 v77, v77, s54, -v40
    v_fma_f32 v78, v78, s54, -v40
    v_fma_f32 v79, v79, s54, -v40
    v_exp_f32 v60, v60
    v_exp_f32 v61, v61
    v_exp_f32 v62, v62
    v_exp_f32 v63, v63
    v_exp_f32 v68, v68
    v_exp_f32 v69, v69
    v_exp_f32 v70, v70
    v_exp_f32 v71, v71
    v_exp_f32 v76, v76
    v_exp_f32 v77, v77
    v_exp_f32 v78, v78
    v_exp_f32 v79, v79
    v_add_f32 v40, v60, v61
    v_add_f32 v40, v40, v62
    v_add_f32 v40, v40, v63
    v_add_f32 v40, v40, v68
    v_add_f32 v40, v40, v69
    v_add_f32 v40, v40, v70
    v_add_f32 v40, v40, v71
    v_add_f32 v40, v40, v76
    v_add_f32 v40, v40, v77
    v_add_f32 v40, v40, v78
    v_add_f32 v40, v40, v79
    v_mov_b32 v41, v40
    s_nop 1
    v_permlane16_swap_b32 v40, v41
    v_add_f32 v40, v40, v41
    v_mov_b32 v41, v40
    s_nop 1
    v_permlane32_swap_b32 v40, v41
    v_add_f32 v40, v40, v41
    v_rcp_f32 v40, v40
    s_nop 0
    v_mul_f32 v60, v60, v40
    v_mul_f32 v61, v61, v40
    v_mul_f32 v62, v62, v40
    v_mul_f32 v63, v63, v40
    v_mul_f32 v68, v68, v40
    v_mul_f32 v69, v69, v40
    v_mul_f32 v70, v70, v40
    v_mul_f32 v71, v71, v40
    v_mul_f32 v76, v76, v40
    v_mul_f32 v77, v77, v40
    v_mul_f32 v78, v78, v40
    v_mul_f32 v79, v79, v40
    v_cvt_pk_bf16_f32 v30, v60, v61
    v_cvt_pk_bf16_f32 v31, v62, v63
    v_cvt_pk_bf16_f32 v32, v68, v69
    v_cvt_pk_bf16_f32 v33, v70, v71
    v_cvt_pk_bf16_f32 v34, v76, v77
    v_cvt_pk_bf16_f32 v35, v78, v79
    s_waitcnt lgkmcnt(0)
    s_nop 0
    v_mfma_f32_16x16x16_bf16 v[64:67], a[80:81], v[24:25], 0
    v_mfma_f32_16x16x16_bf16 v[68:71], a[86:87], v[24:25], 0
    v_mfma_f32_16x16x16_bf16 v[72:75], a[92:93], v[24:25], 0
    v_mfma_f32_16x16x16_bf16 v[76:79], a[98:99], v[24:25], 0
    v_mfma_f32_16x16x16_bf16 v[80:83], a[104:105], v[24:25], 0
    v_mfma_f32_16x16x16_bf16 v[84:87], a[110:111], v[24:25], 0
    v_mfma_f32_16x16x16_bf16 v[88:91], a[116:117], v[24:25], 0
    v_mfma_f32_16x16x16_bf16 v[92:95], a[122:123], v[24:25], 0
    v_mfma_f32_16x16x16_bf16 v[64:67], a[84:85], v[28:29], v[64:67]
    v_mfma_f32_16x16x16_bf16 v[68:71], a[90:91], v[28:29], v[68:71]
    v_mfma_f32_16x16x16_bf16 v[72:75], a[96:97], v[28:29], v[72:75]
    v_mfma_f32_16x16x16_bf16 v[76:79], a[102:103], v[28:29], v[76:79]
    v_mfma_f32_16x16x16_bf16 v[80:83], a[108:109], v[28:29], v[80:83]
    v_mfma_f32_16x16x16_bf16 v[84:87], a[114:115], v[28:29], v[84:87]
    v_mfma_f32_16x16x16_bf16 v[88:91], a[120:121], v[28:29], v[88:91]
    v_mfma_f32_16x16x16_bf16 v[92:95], a[126:127], v[28:29], v[92:95]
    v_mfma_f32_16x16x16_bf16 v[96:99], a[80:81], v[30:31], 0
    v_mfma_f32_16x16x16_bf16 v[100:103], a[86:87], v[30:31], 0
    v_mfma_f32_16x16x16_bf16 v[104:107], a[92:93], v[30:31], 0
    v_mfma_f32_16x16x16_bf16 v[108:111], a[98:99], v[30:31], 0
    v_mfma_f32_16x16x16_bf16 v[112:115], a[104:105], v[30:31], 0
    v_mfma_f32_16x16x16_bf16 v[116:119], a[110:111], v[30:31], 0
    v_mfma_f32_16x16x16_bf16 v[120:123], a[116:117], v[30:31], 0
    v_mfma_f32_16x16x16_bf16 v[124:127], a[122:123], v[30:31], 0
    v_mfma_f32_16x16x16_bf16 v[96:99], a[82:83], v[32:33], v[96:99]
    v_mfma_f32_16x16x16_bf16 v[100:103], a[88:89], v[32:33], v[100:103]
    v_mfma_f32_16x16x16_bf16 v[104:107], a[94:95], v[32:33], v[104:107]
    v_mfma_f32_16x16x16_bf16 v[108:111], a[100:101], v[32:33], v[108:111]
    v_mfma_f32_16x16x16_bf16 v[112:115], a[106:107], v[32:33], v[112:115]
    v_mfma_f32_16x16x16_bf16 v[116:119], a[112:113], v[32:33], v[116:119]
    v_mfma_f32_16x16x16_bf16 v[120:123], a[118:119], v[32:33], v[120:123]
    v_mfma_f32_16x16x16_bf16 v[124:127], a[124:125], v[32:33], v[124:127]
    v_mfma_f32_16x16x16_bf16 v[96:99], a[84:85], v[34:35], v[96:99]
    v_mfma_f32_16x16x16_bf16 v[100:103], a[90:91], v[34:35], v[100:103]
    v_mfma_f32_16x16x16_bf16 v[104:107], a[96:97], v[34:35], v[104:107]
    v_mfma_f32_16x16x16_bf16 v[108:111], a[102:103], v[34:35], v[108:111]
    v_mfma_f32_16x16x16_bf16 v[112:115], a[108:109], v[34:35], v[112:115]
    v_mfma_f32_16x16x16_bf16 v[116:119], a[114:115], v[34:35], v[116:119]
    v_mfma_f32_16x16x16_bf16 v[120:123], a[120:121], v[34:35], v[120:123]
    v_mfma_f32_16x16x16_bf16 v[124:127], a[126:127], v[34:35], v[124:127]
    s_add_u32 s46, s63, 4096
    v_cvt_pk_bf16_f32 v64, v64, v65
    v_cvt_pk_bf16_f32 v65, v66, v67
    v_cvt_pk_bf16_f32 v66, v68, v69
    v_cvt_pk_bf16_f32 v67, v70, v71
    buffer_store_dwordx4 v[64:67], v10, s[12:15], s63 offen offset:0 sc1
    v_cvt_pk_bf16_f32 v72, v72, v73
    v_cvt_pk_bf16_f32 v73, v74, v75
    v_cvt_pk_bf16_f32 v74, v76, v77
    v_cvt_pk_bf16_f32 v75, v78, v79
    buffer_store_dwordx4 v[72:75], v10, s[12:15], s63 offen offset:2048 sc1
    v_cvt_pk_bf16_f32 v80, v80, v81
    v_cvt_pk_bf16_f32 v81, v82, v83
    v_cvt_pk_bf16_f32 v82, v84, v85
    v_cvt_pk_bf16_f32 v83, v86, v87
    buffer_store_dwordx4 v[80:83], v10, s[12:15], s46 offen offset:0 sc1
    v_cvt_pk_bf16_f32 v88, v88, v89
    v_cvt_pk_bf16_f32 v89, v90, v91
    v_cvt_pk_bf16_f32 v90, v92, v93
    v_cvt_pk_bf16_f32 v91, v94, v95
    buffer_store_dwordx4 v[88:91], v10, s[12:15], s46 offen offset:2048 sc1
    v_cvt_pk_bf16_f32 v96, v96, v97
    v_cvt_pk_bf16_f32 v97, v98, v99
    v_cvt_pk_bf16_f32 v98, v100, v101
    v_cvt_pk_bf16_f32 v99, v102, v103
    buffer_store_dwordx4 v[96:99], v10, s[12:15], s63 offen offset:256 sc1
    v_cvt_pk_bf16_f32 v104, v104, v105
    v_cvt_pk_bf16_f32 v105, v106, v107
    v_cvt_pk_bf16_f32 v106, v108, v109
    v_cvt_pk_bf16_f32 v107, v110, v111
    buffer_store_dwordx4 v[104:107], v10, s[12:15], s63 offen offset:2304 sc1
    v_cvt_pk_bf16_f32 v112, v112, v113
    v_cvt_pk_bf16_f32 v113, v114, v115
    v_cvt_pk_bf16_f32 v114, v116, v117
    v_cvt_pk_bf16_f32 v115, v118, v119
    buffer_store_dwordx4 v[112:115], v10, s[12:15], s46 offen offset:256 sc1
    v_cvt_pk_bf16_f32 v120, v120, v121
    v_cvt_pk_bf16_f32 v121, v122, v123
    v_cvt_pk_bf16_f32 v122, v124, v125
    v_cvt_pk_bf16_f32 v123, v126, v127
    buffer_store_dwordx4 v[120:123], v10, s[12:15], s46 offen offset:2304 sc1
    s_waitcnt vmcnt(0)
    v_mov_b32 v16, s60
    v_add_u32 v16, 1, v16
    v_mov_b32 v17, 0
    s_mov_b64 exec, 1
    buffer_store_dword v16, v17, s[12:15], s52 offen sc1
    s_mov_b64 exec, -1
L_sf_40:
    s_add_u32 s60, s60, 4
    s_cmp_lt_u32 s60, 64
    s_cbranch_scc1 L_a_loop_36
    s_branch L_c_done_7
L_w_f1_22:
    s_cmp_eq_u32 s43, 7
    s_cbranch_scc1 L_c_done_7
    s_load_dwordx2 s[4:5], s[0:1], 64
    s_load_dwordx2 s[6:7], s[0:1], 72
    s_and_b32 s50, s44, 3
    s_lshr_b32 s51, s44, 2
    s_waitcnt lgkmcnt(0)
    s_mov_b32 s24, s4
    s_and_b32 s25, s5, 0xffff
    s_mov_b32 s26, 0x700000
    s_mov_b32 s27, 0x00020000
    s_mul_i32 s49, s42, 7
    s_add_u32 s49, s49, s43
    v_lshrrev_b32 v3, 4, v1
    v_and_b32 v4, 15, v1
    v_lshlrev_b32 v5, 2, v3
    v_xor_b32 v4, v4, v5
    v_mul_u32_u24 v3, 7168, v3
    v_lshl_add_u32 v3, v4, 4, v3
    s_mul_i32 s46, s51, 512
    s_mul_i32 s47, s50, 64
    s_add_u32 s46, s46, s47
    s_mul_i32 s46, s46, 7168
    s_lshl_b32 s47, s49, 8
    s_add_u32 s46, s46, s47
    s_lshl_b32 s45, s51, 16
    s_mul_i32 s47, s50, 16384
    s_add_u32 s45, s45, s47
    v_bfe_u32 v4, v1, 2, 2
    v_bfe_u32 v5, v1, 4, 1
    v_lshlrev_b32 v5, 1, v5
    v_bfe_u32 v6, v1, 1, 1
    v_add_u32 v5, v5, v6
    s_lshl_b32 s47, s50, 2
    v_add_u32 v5, s47, v5
    v_lshlrev_b32 v6, 2, v4
    v_xor_b32 v5, v5, v6
    v_lshlrev_b32 v5, 4, v5
    v_lshl_add_u32 v5, v4, 8, v5
    v_and_b32 v6, 1, v1
    v_lshl_add_u32 v5, v6, 3, v5
    v_lshrrev_b32 v6, 5, v1
    v_mul_u32_u24 v6, 2048, v6
    v_add_u32 v5, v5, v6
    s_lshl_b32 s47, s51, 16
    v_add_u32 v5, s47, v5
    s_add_u32 m0, s45, 0
    s_add_u32 s47, s46, 0x0
    buffer_load_dwordx4 v3, s[24:27], s47 offen lds
    s_add_u32 m0, s45, 1024
    s_add_u32 s47, s46, 0x7000
    buffer_load_dwordx4 v3, s[24:27], s47 offen lds
    s_add_u32 m0, s45, 2048
    s_add_u32 s47, s46, 0xe000
    buffer_load_dwordx4 v3, s[24:27], s47 offen lds
    s_add_u32 m0, s45, 3072
    s_add_u32 s47, s46, 0x15000
    buffer_load_dwordx4 v3, s[24:27], s47 offen lds
    s_add_u32 m0, s45, 4096
    s_add_u32 s47, s46, 0x1c000
    buffer_load_dwordx4 v3, s[24:27], s47 offen lds
    s_add_u32 m0, s45, 5120
    s_add_u32 s47, s46, 0x23000
    buffer_load_dwordx4 v3, s[24:27], s47 offen lds
    s_add_u32 m0, s45, 6144
    s_add_u32 s47, s46, 0x2a000
    buffer_load_dwordx4 v3, s[24:27], s47 offen lds
    s_add_u32 m0, s45, 7168
    s_add_u32 s47, s46, 0x31000
    buffer_load_dwordx4 v3, s[24:27], s47 offen lds
    s_add_u32 m0, s45, 8192
    s_add_u32 s47, s46, 0x38000
    buffer_load_dwordx4 v3, s[24:27], s47 offen lds
    s_add_u32 m0, s45, 9216
    s_add_u32 s47, s46, 0x3f000
    buffer_load_dwordx4 v3, s[24:27], s47 offen lds
    s_add_u32 m0, s45, 10240
    s_add_u32 s47, s46, 0x46000
    buffer_load_dwordx4 v3, s[24:27], s47 offen lds
    s_add_u32 m0, s45, 11264
    s_add_u32 s47, s46, 0x4d000
    buffer_load_dwordx4 v3, s[24:27], s47 offen lds
    s_add_u32 m0, s45, 12288
    s_add_u32 s47, s46, 0x54000
    buffer_load_dwordx4 v3, s[24:27], s47 offen lds
    s_add_u32 m0, s45, 13312
    s_add_u32 s47, s46, 0x5b000
    buffer_load_dwordx4 v3, s[24:27], s47 offen lds
    s_add_u32 m0, s45, 14336
    s_add_u32 s47, s46, 0x62000
    buffer_load_dwordx4 v3, s[24:27], s47 offen lds
    s_add_u32 m0, s45, 15360
    s_add_u32 s47, s46, 0x69000
    buffer_load_dwordx4 v3, s[24:27], s47 offen lds
    s_waitcnt vmcnt(0)
    s_barrier
    ds_read_b64_tr_b16 a[0:1], v5 offset:0
    ds_read_b64_tr_b16 a[2:3], v5 offset:1024
    ds_read_b64_tr_b16 a[4:5], v5 offset:4096
    ds_read_b64_tr_b16 a[6:7], v5 offset:5120
    ds_read_b64_tr_b16 a[8:9], v5 offset:8192
    ds_read_b64_tr_b16 a[10:11], v5 offset:9216
    ds_read_b64_tr_b16 a[12:13], v5 offset:12288
    ds_read_b64_tr_b16 a[14:15], v5 offset:13312
    s_waitcnt lgkmcnt(0)
    ds_read_b64_tr_b16 a[16:17], v5 offset:16384
    ds_read_b64_tr_b16 a[18:19], v5 offset:17408
    ds_read_b64_tr_b16 a[20:21], v5 offset:20480
    ds_read_b64_tr_b16 a[22:23], v5 offset:21504
    ds_read_b64_tr_b16 a[24:25], v5 offset:24576
    ds_read_b64_tr_b16 a[26:27], v5 offset:25600
    ds_read_b64_tr_b16 a[28:29], v5 offset:28672
    ds_read_b64_tr_b16 a[30:31], v5 offset:29696
    s_waitcnt lgkmcnt(0)
    ds_read_b64_tr_b16 a[32:33], v5 offset:32768
    ds_read_b64_tr_b16 a[34:35], v5 offset:33792
    ds_read_b64_tr_b16 a[36:37], v5 offset:36864
    ds_read_b64_tr_b16 a[38:39], v5 offset:37888
    ds_read_b64_tr_b16 a[40:41], v5 offset:40960
    ds_read_b64_tr_b16 a[42:43], v5 offset:41984
    ds_read_b64_tr_b16 a[44:45], v5 offset:45056
    ds_read_b64_tr_b16 a[46:47], v5 offset:46080
    s_waitcnt lgkmcnt(0)
    ds_read_b64_tr_b16 a[48:49], v5 offset:49152
    ds_read_b64_tr_b16 a[50:51], v5 offset:50176
    ds_read_b64_tr_b16 a[52:53], v5 offset:53248
    ds_read_b64_tr_b16 a[54:55], v5 offset:54272
    ds_read_b64_tr_b16 a[56:57], v5 offset:57344
    ds_read_b64_tr_b16 a[58:59], v5 offset:58368
    ds_read_b64_tr_b16 a[60:61], v5 offset:61440
    ds_read_b64_tr_b16 a[62:63], v5 offset:62464
    s_waitcnt lgkmcnt(0)
    s_waitcnt lgkmcnt(0)
    s_barrier
    s_add_u32 m0, s45, 0
    s_add_u32 s47, s46, 0x1c0000
    buffer_load_dwordx4 v3, s[24:27], s47 offen lds
    s_add_u32 m0, s45, 1024
    s_add_u32 s47, s46, 0x1c7000
    buffer_load_dwordx4 v3, s[24:27], s47 offen lds
    s_add_u32 m0, s45, 2048
    s_add_u32 s47, s46, 0x1ce000
    buffer_load_dwordx4 v3, s[24:27], s47 offen lds
    s_add_u32 m0, s45, 3072
    s_add_u32 s47, s46, 0x1d5000
    buffer_load_dwordx4 v3, s[24:27], s47 offen lds
    s_add_u32 m0, s45, 4096
    s_add_u32 s47, s46, 0x1dc000
    buffer_load_dwordx4 v3, s[24:27], s47 offen lds
    s_add_u32 m0, s45, 5120
    s_add_u32 s47, s46, 0x1e3000
    buffer_load_dwordx4 v3, s[24:27], s47 offen lds
    s_add_u32 m0, s45, 6144
    s_add_u32 s47, s46, 0x1ea000
    buffer_load_dwordx4 v3, s[24:27], s47 offen lds
    s_add_u32 m0, s45, 7168
    s_add_u32 s47, s46, 0x1f1000
    buffer_load_dwordx4 v3, s[24:27], s47 offen lds
    s_add_u32 m0, s45, 8192
    s_add_u32 s47, s46, 0x1f8000
    buffer_load_dwordx4 v3, s[24:27], s47 offen lds
    s_add_u32 m0, s45, 9216
    s_add_u32 s47, s46, 0x1ff000
    buffer_load_dwordx4 v3, s[24:27], s47 offen lds
    s_add_u32 m0, s45, 10240
    s_add_u32 s47, s46, 0x206000
    buffer_load_dwordx4 v3, s[24:27], s47 offen lds
    s_add_u32 m0, s45, 11264
    s_add_u32 s47, s46, 0x20d000
    buffer_load_dwordx4 v3, s[24:27], s47 offen lds
    s_add_u32 m0, s45, 12288
    s_add_u32 s47, s46, 0x214000
    buffer_load_dwordx4 v3, s[24:27], s47 offen lds
    s_add_u32 m0, s45, 13312
    s_add_u32 s47, s46, 0x21b000
    buffer_load_dwordx4 v3, s[24:27], s47 offen lds
    s_add_u32 m0, s45, 14336
    s_add_u32 s47, s46, 0x222000
    buffer_load_dwordx4 v3, s[24:27], s47 offen lds
    s_add_u32 m0, s45, 15360
    s_add_u32 s47, s46, 0x229000
    buffer_load_dwordx4 v3, s[24:27], s47 offen lds
    s_waitcnt vmcnt(0)
    s_barrier
    ds_read_b64_tr_b16 a[64:65], v5 offset:0
    ds_read_b64_tr_b16 a[66:67], v5 offset:1024
    ds_read_b64_tr_b16 a[68:69], v5 offset:4096
    ds_read_b64_tr_b16 a[70:71], v5 offset:5120
    ds_read_b64_tr_b16 a[72:73], v5 offset:8192
    ds_read_b64_tr_b16 a[74:75], v5 offset:9216
    ds_read_b64_tr_b16 a[76:77], v5 offset:12288
    ds_read_b64_tr_b16 a[78:79], v5 offset:13312
    s_waitcnt lgkmcnt(0)
    ds_read_b64_tr_b16 a[80:81], v5 offset:16384
    ds_read_b64_tr_b16 a[82:83], v5 offset:17408
    ds_read_b64_tr_b16 a[84:85], v5 offset:20480
    ds_read_b64_tr_b16 a[86:87], v5 offset:21504
    ds_read_b64_tr_b16 a[88:89], v5 offset:24576
    ds_read_b64_tr_b16 a[90:91], v5 offset:25600
    ds_read_b64_tr_b16 a[92:93], v5 offset:28672
    ds_read_b64_tr_b16 a[94:95], v5 offset:29696
    s_waitcnt lgkmcnt(0)
    ds_read_b64_tr_b16 a[96:97], v5 offset:32768
    ds_read_b64_tr_b16 a[98:99], v5 offset:33792
    ds_read_b64_tr_b16 a[100:101], v5 offset:36864
    ds_read_b64_tr_b16 a[102:103], v5 offset:37888
    ds_read_b64_tr_b16 a[104:105], v5 offset:40960
    ds_read_b64_tr_b16 a[106:107], v5 offset:41984
    ds_read_b64_tr_b16 a[108:109], v5 offset:45056
    ds_read_b64_tr_b16 a[110:111], v5 offset:46080
    s_waitcnt lgkmcnt(0)
    ds_read_b64_tr_b16 a[112:113], v5 offset:49152
    ds_read_b64_tr_b16 a[114:115], v5 offset:50176
    ds_read_b64_tr_b16 a[116:117], v5 offset:53248
    ds_read_b64_tr_b16 a[118:119], v5 offset:54272
    ds_read_b64_tr_b16 a[120:121], v5 offset:57344
    ds_read_b64_tr_b16 a[122:123], v5 offset:58368
    ds_read_b64_tr_b16 a[124:125], v5 offset:61440
    ds_read_b64_tr_b16 a[126:127], v5 offset:62464
    s_waitcnt lgkmcnt(0)
    s_waitcnt lgkmcnt(0)
    s_barrier
    v_lshlrev_b32 v2, 4, v1
    s_lshl_b32 s46, s44, 13
    s_add_u32 s46, s46, 0xc00000
    v_add_u32 v3, s46, v2
    s_mul_i32 s46, s51, 32768
    v_add_u32 v4, s46, v2
    s_lshl_b32 s46, s44, 11
    s_add_u32 s46, s46, 131072
    v_add_u32 v5, s46, v2
    v_xor_b32 v6, 8192, v5
    v_and_b32 v7, 3, v1
    v_lshlrev_b32 v7, 8, v7
    v_add_u32 v7, 0x108000, v7
    s_lshl_b32 s46, s49, 13
    s_lshl_b32 s47, s50, 11
    s_add_u32 s46, s46, s47
    s_lshl_b32 s47, s51, 10
    s_add_u32 s46, s46, s47
    s_add_u32 s46, s46, 0x6000000
    v_add_u32 v8, s46, v2
    s_lshl_b32 s52, s49, 7
    s_add_u32 s52, s52, 0x108400
    s_mov_b32 s28, s6
    s_and_b32 s29, s7, 0xffff
    s_mov_b32 s30, 0x1c00
    s_mov_b32 s31, 0x00020000
    s_lshl_b32 s46, s49, 8
    s_lshl_b32 s47, s50, 6
    s_add_u32 s46, s46, s47
    s_lshl_b32 s47, s51, 5
    s_add_u32 s46, s46, s47
    v_lshrrev_b32 v9, 5, v1
    v_lshlrev_b32 v9, 3, v9
    buffer_load_dwordx2 v[10:11], v9, s[28:31], s46 offen
    buffer_load_dwordx2 v[12:13], v9, s[28:31], s46 offen offset:16
    s_waitcnt vmcnt(0)
    v_lshlrev_b32 v64, 16, v10
    v_and_b32 v65, 0xffff0000, v10
    v_lshlrev_b32 v66, 16, v11
    v_and_b32 v67, 0xffff0000, v11
    v_lshlrev_b32 v68, 16, v12
    v_and_b32 v69, 0xffff0000, v12
    v_lshlrev_b32 v70, 16, v13
    v_and_b32 v71, 0xffff0000, v13
    s_mov_b32 s60, 0
    s_mov_b32 s61, 0
    s_mov_b32 s62, 0
    s_mov_b32 s63, 0
    s_lshl_b32 s64, s44, 13
    s_mov_b32 s66, 0
    v_mov_b32 v15, 147456
L_g_fetch_41:
    s_cmp_lg_u32 s44, 0
    s_cbranch_scc1 L_g_nsp_43
    s_and_b32 s46, s62, 1
    s_lshl_b32 s46, s46, 7
    s_mov_b32 s70, 0
L_spin_46:
    buffer_load_dword v14, v7, s[12:15], s46 offen sc1
    s_waitcnt vmcnt(0)
    v_cmp_ge_u32 vcc, s62, v14
    s_add_u32 s70, s70, 1
    s_cbranch_vccz L_spok_47
    s_sleep 8
    s_cmp_lt_u32 s70, 524288
    s_cbranch_scc1 L_spin_46
    s_branch L_c_done_7
L_spok_47:
L_g_nsp_43:
    s_barrier
L_g_fetch2_42:
    s_add_u32 s47, s61, 4096
    s_add_u32 m0, s64, 0
    s_nop 0
    buffer_load_dwordx4 v3, s[12:15], s61 offen offset:0 sc1 lds
    buffer_load_dwordx4 v3, s[12:15], s61 offen offset:1024 sc1 lds
    buffer_load_dwordx4 v3, s[12:15], s61 offen offset:2048 sc1 lds
    buffer_load_dwordx4 v3, s[12:15], s61 offen offset:3072 sc1 lds
    s_add_u32 m0, s64, 4096
    s_nop 0
    buffer_load_dwordx4 v3, s[12:15], s47 offen offset:0 sc1 lds
    buffer_load_dwordx4 v3, s[12:15], s47 offen offset:1024 sc1 lds
    buffer_load_dwordx4 v3, s[12:15], s47 offen offset:2048 sc1 lds
    buffer_load_dwordx4 v3, s[12:15], s47 offen offset:3072 sc1 lds
L_nod_48:
    s_add_u32 s61, s61, 65536
    s_add_u32 s62, s62, 1
    s_xor_b32 s64, s64, 0x10000
    s_waitcnt vmcnt(0)
    s_barrier
L_g_top_44:
    s_mov_b32 s65, 0
    s_bitcmp1_b32 s66, 1
    s_cbranch_scc0 L_g_nopend_45
    s_mov_b32 s65, 1
    s_add_u32 s47, s61, 4096
    s_add_u32 m0, s64, 0
    s_nop 0
    buffer_load_dwordx4 v3, s[12:15], s61 offen offset:0 sc1 lds
    buffer_load_dwordx4 v3, s[12:15], s61 offen offset:1024 sc1 lds
    buffer_load_dwordx4 v3, s[12:15], s61 offen offset:2048 sc1 lds
    buffer_load_dwordx4 v3, s[12:15], s61 offen offset:3072 sc1 lds
    s_add_u32 m0, s64, 4096
    s_nop 0
    buffer_load_dwordx4 v3, s[12:15], s47 offen offset:0 sc1 lds
    buffer_load_dwordx4 v3, s[12:15], s47 offen offset:1024 sc1 lds
    buffer_load_dwordx4 v3, s[12:15], s47 offen offset:2048 sc1 lds
    buffer_load_dwordx4 v3, s[12:15], s47 offen offset:3072 sc1 lds
L_nod_49:
    s_add_u32 s61, s61, 65536
    s_add_u32 s62, s62, 1
    s_xor_b32 s64, s64, 0x10000
L_g_nopend_45:
    ds_read_b128 v[32:35], v4 offset:0
    ds_read_b128 v[36:39], v4 offset:1024
    ds_read_b128 v[40:43], v4 offset:2048
    ds_read_b128 v[44:47], v4 offset:3072
    ds_read_b128 v[48:51], v4 offset:4096
    ds_read_b128 v[52:55], v4 offset:5120
    ds_read_b128 v[56:59], v4 offset:6144
    ds_read_b128 v[60:63], v4 offset:7168
    s_waitcnt lgkmcnt(7)
    v_mfma_f32_32x32x16_bf16 v[16:31], a[0:3], v[32:35], 0
    ds_read_b128 v[32:35], v4 offset:8192
    s_waitcnt lgkmcnt(7)
    v_mfma_f32_32x32x16_bf16 v[16:31], a[4:7], v[36:39], v[16:31]
    ds_read_b128 v[36:39], v4 offset:9216
    s_waitcnt lgkmcnt(7)
    v_mfma_f32_32x32x16_bf16 v[16:31], a[8:11], v[40:43], v[16:31]
    ds_read_b128 v[40:43], v4 offset:10240
    s_waitcnt lgkmcnt(7)
    v_mfma_f32_32x32x16_bf16 v[16:31], a[12:15], v[44:47], v[16:31]
    ds_read_b128 v[44:47], v4 offset:11264
    s_waitcnt lgkmcnt(7)
    v_mfma_f32_32x32x16_bf16 v[16:31], a[16:19], v[48:51], v[16:31]
    ds_read_b128 v[48:51], v4 offset:12288
    s_waitcnt lgkmcnt(7)
    v_mfma_f32_32x32x16_bf16 v[16:31], a[20:23], v[52:55], v[16:31]
    ds_read_b128 v[52:55], v4 offset:13312
    s_waitcnt lgkmcnt(7)
    v_mfma_f32_32x32x16_bf16 v[16:31], a[24:27], v[56:59], v[16:31]
    ds_read_b128 v[56:59], v4 offset:14336
    s_waitcnt lgkmcnt(7)
    v_mfma_f32_32x32x16_bf16 v[16:31], a[28:31], v[60:63], v[16:31]
    ds_read_b128 v[60:63], v4 offset:15360
    s_waitcnt lgkmcnt(7)
    v_mfma_f32_32x32x16_bf16 v[16:31], a[32:35], v[32:35], v[16:31]
    ds_read_b128 v[32:35], v4 offset:16384
    s_waitcnt lgkmcnt(7)
    v_mfma_f32_32x32x16_bf16 v[16:31], a[36:39], v[36:39], v[16:31]
    ds_read_b128 v[36:39], v4 offset:17408
    s_waitcnt lgkmcnt(7)
    v_mfma_f32_32x32x16_bf16 v[16:31], a[40:43], v[40:43], v[16:31]
    ds_read_b128 v[40:43], v4 offset:18432
    s_waitcnt lgkmcnt(7)
    v_mfma_f32_32x32x16_bf16 v[16:31], a[44:47], v[44:47], v[16:31]
    ds_read_b128 v[44:47], v4 offset:19456
    s_waitcnt lgkmcnt(7)
    v_mfma_f32_32x32x16_bf16 v[16:31], a[48:51], v[48:51], v[16:31]
    ds_read_b128 v[48:51], v4 offset:20480
    s_waitcnt lgkmcnt(7)
    v_mfma_f32_32x32x16_bf16 v[16:31], a[52:55], v[52:55], v[16:31]
    ds_read_b128 v[52:55], v4 offset:21504
    s_waitcnt lgkmcnt(7)
    v_mfma_f32_32x32x16_bf16 v[16:31], a[56:59], v[56:59], v[16:31]
    ds_read_b128 v[56:59], v4 offset:22528
    s_waitcnt lgkmcnt(7)
    v_mfma_f32_32x32x16_bf16 v[16:31], a[60:63], v[60:63], v[16:31]
    ds_read_b128 v[60:63], v4 offset:23552
    s_waitcnt lgkmcnt(7)
    v_mfma_f32_32x32x16_bf16 v[16:31], a[64:67], v[32:35], v[16:31]
    ds_read_b128 v[32:35], v4 offset:24576
    s_waitcnt lgkmcnt(7)
    v_mfma_f32_32x32x16_bf16 v[16:31], a[68:71], v[36:39], v[16:31]
    ds_read_b128 v[36:39], v4 offset:25600
    s_waitcnt lgkmcnt(7)
    v_mfma_f32_32x32x16_bf16 v[16:31], a[72:75], v[40:43], v[16:31]
    ds_read_b128 v[40:43], v4 offset:26624
    s_waitcnt lgkmcnt(7)
    v_mfma_f32_32x32x16_bf16 v[16:31], a[76:79], v[44:47], v[16:31]
    ds_read_b128 v[44:47], v4 offset:27648
    s_waitcnt lgkmcnt(7)
    v_mfma_f32_32x32x16_bf16 v[16:31], a[80:83], v[48:51], v[16:31]
    ds_read_b128 v[48:51], v4 offset:28672
    s_waitcnt lgkmcnt(7)
    v_mfma_f32_32x32x16_bf16 v[16:31], a[84:87], v[52:55], v[16:31]
    ds_read_b128 v[52:55], v4 offset:29696
    s_waitcnt lgkmcnt(7)
    v_mfma_f32_32x32x16_bf16 v[16:31], a[88:91], v[56:59], v[16:31]
    ds_read_b128 v[56:59], v4 offset:30720
    s_waitcnt lgkmcnt(7)
    v_mfma_f32_32x32x16_bf16 v[16:31], a[92:95], v[60:63], v[16:31]
    ds_read_b128 v[60:63], v4 offset:31744
    s_waitcnt lgkmcnt(7)
    v_mfma_f32_32x32x16_bf16 v[16:31], a[96:99], v[32:35], v[16:31]
    s_waitcnt lgkmcnt(6)
    v_mfma_f32_32x32x16_bf16 v[16:31], a[100:103], v[36:39], v[16:31]
    s_waitcnt lgkmcnt(5)
    v_mfma_f32_32x32x16_bf16 v[16:31], a[104:107], v[40:43], v[16:31]
    s_waitcnt lgkmcnt(4)
    v_mfma_f32_32x32x16_bf16 v[16:31], a[108:111], v[44:47], v[16:31]
    s_waitcnt lgkmcnt(3)
    v_mfma_f32_32x32x16_bf16 v[16:31], a[112:115], v[48:51], v[16:31]
    s_waitcnt lgkmcnt(2)
    v_mfma_f32_32x32x16_bf16 v[16:31], a[116:119], v[52:55], v[16:31]
    s_waitcnt lgkmcnt(1)
    v_mfma_f32_32x32x16_bf16 v[16:31], a[120:123], v[56:59], v[16:31]
    s_waitcnt lgkmcnt(0)
    v_mfma_f32_32x32x16_bf16 v[16:31], a[124:127], v[60:63], v[16:31]
    v_xor_b32 v4, 0x10000, v4
    s_cmp_eq_u32 s51, 1
    s_nop 9
    s_cbranch_scc1 L_g_k1_50
    ds_write_b128 v5, v[24:27]
    ds_write_b128 v5, v[28:31] offset:1024
    s_waitcnt lgkmcnt(0)
    s_barrier
    ds_read_b128 v[32:35], v6
    ds_read_b128 v[36:39], v6 offset:1024
    s_waitcnt lgkmcnt(0)
    v_pk_add_f32 v[32:33], v[32:33], v[16:17]
    v_pk_add_f32 v[34:35], v[34:35], v[18:19]
    v_pk_add_f32 v[36:37], v[36:37], v[20:21]
    v_pk_add_f32 v[38:39], v[38:39], v[22:23]
    s_branch L_g_k2_51
L_g_k1_50:
    ds_write_b128 v5, v[16:19]
    ds_write_b128 v5, v[20:23] offset:1024
    s_waitcnt lgkmcnt(0)
    s_barrier
    ds_read_b128 v[32:35], v6
    ds_read_b128 v[36:39], v6 offset:1024
    s_waitcnt lgkmcnt(0)
    v_pk_add_f32 v[32:33], v[32:33], v[24:25]
    v_pk_add_f32 v[34:35], v[34:35], v[26:27]
    v_pk_add_f32 v[36:37], v[36:37], v[28:29]
    v_pk_add_f32 v[38:39], v[38:39], v[30:31]
L_g_k2_51:
    v_cvt_pk_bf16_f32 v32, v32, v32
    v_lshlrev_b32 v32, 16, v32
    v_add_f32 v32, v32, v64
    v_cvt_pk_bf16_f32 v32, v32, v32
    v_lshlrev_b32 v32, 16, v32
    v_cvt_pk_bf16_f32 v33, v33, v33
    v_lshlrev_b32 v33, 16, v33
    v_add_f32 v33, v33, v65
    v_cvt_pk_bf16_f32 v33, v33, v33
    v_lshlrev_b32 v33, 16, v33
    v_cvt_pk_bf16_f32 v34, v34, v34
    v_lshlrev_b32 v34, 16, v34
    v_add_f32 v34, v34, v66
    v_cvt_pk_bf16_f32 v34, v34, v34
    v_lshlrev_b32 v34, 16, v34
    v_cvt_pk_bf16_f32 v35, v35, v35
    v_lshlrev_b32 v35, 16, v35
    v_add_f32 v35, v35, v67
    v_cvt_pk_bf16_f32 v35, v35, v35
    v_lshlrev_b32 v35, 16, v35
    v_cvt_pk_bf16_f32 v36, v36, v36
    v_lshlrev_b32 v36, 16, v36
    v_add_f32 v36, v36, v68
    v_cvt_pk_bf16_f32 v36, v36, v36
    v_lshlrev_b32 v36, 16, v36
    v_cvt_pk_bf16_f32 v37, v37, v37
    v_lshlrev_b32 v37, 16, v37
    v_add_f32 v37, v37, v69
    v_cvt_pk_bf16_f32 v37, v37, v37
    v_lshlrev_b32 v37, 16, v37
    v_cvt_pk_bf16_f32 v38, v38, v38
    v_lshlrev_b32 v38, 16, v38
    v_add_f32 v38, v38, v70
    v_cvt_pk_bf16_f32 v38, v38, v38
    v_lshlrev_b32 v38, 16, v38
    v_cvt_pk_bf16_f32 v39, v39, v39
    v_lshlrev_b32 v39, 16, v39
    v_add_f32 v39, v39, v71
    v_cvt_pk_bf16_f32 v39, v39, v39
    v_lshlrev_b32 v39, 16, v39
    v_mul_f32 v40, v32, v32
    v_mul_f32 v41, v33, v33
    v_mul_f32 v42, v34, v34
    v_mul_f32 v43, v35, v35
    v_mul_f32 v44, v36, v36
    v_mul_f32 v45, v37, v37
    v_mul_f32 v46, v38, v38
    v_mul_f32 v47, v39, v39
    s_mov_b32 s54, 0x3d372713
    v_fma_f32 v40, v40, s54, 1.0
    v_fma_f32 v41, v41, s54, 1.0
    v_fma_f32 v42, v42, s54, 1.0
    v_fma_f32 v43, v43, s54, 1.0
    v_fma_f32 v44, v44, s54, 1.0
    v_fma_f32 v45, v45, s54, 1.0
    v_fma_f32 v46, v46, s54, 1.0
    v_fma_f32 v47, v47, s54, 1.0
    v_mul_f32 v40, v40, v32
    v_mul_f32 v41, v41, v33
    v_mul_f32 v42, v42, v34
    v_mul_f32 v43, v43, v35
    v_mul_f32 v44, v44, v36
    v_mul_f32 v45, v45, v37
    v_mul_f32 v46, v46, v38
    v_mul_f32 v47, v47, v39
    v_mul_f32 v40, 0xc0135761, v40
    v_mul_f32 v41, 0xc0135761, v41
    v_mul_f32 v42, 0xc0135761, v42
    v_mul_f32 v43, 0xc0135761, v43
    v_mul_f32 v44, 0xc0135761, v44
    v_mul_f32 v45, 0xc0135761, v45
    v_mul_f32 v46, 0xc0135761, v46
    v_mul_f32 v47, 0xc0135761, v47
    v_exp_f32 v40, v40
    v_exp_f32 v41, v41
    v_exp_f32 v42, v42
    v_exp_f32 v43, v43
    v_exp_f32 v44, v44
    v_exp_f32 v45, v45
    v_exp_f32 v46, v46
    v_exp_f32 v47, v47
    v_add_f32 v40, 1.0, v40
    v_add_f32 v41, 1.0, v41
    v_add_f32 v42, 1.0, v42
    v_add_f32 v43, 1.0, v43
    v_add_f32 v44, 1.0, v44
    v_add_f32 v45, 1.0, v45
    v_add_f32 v46, 1.0, v46
    v_add_f32 v47, 1.0, v47
    v_rcp_f32 v40, v40
    v_rcp_f32 v41, v41
    v_rcp_f32 v42, v42
    v_rcp_f32 v43, v43
    v_rcp_f32 v44, v44
    v_rcp_f32 v45, v45
    v_rcp_f32 v46, v46
    v_rcp_f32 v47, v47
    v_mul_f32 v32, v32, v40
    v_mul_f32 v33, v33, v41
    v_mul_f32 v34, v34, v42
    v_mul_f32 v35, v35, v43
    v_mul_f32 v36, v36, v44
    v_mul_f32 v37, v37, v45
    v_mul_f32 v38, v38, v46
    v_mul_f32 v39, v39, v47
    v_cvt_pk_bf16_f32 v40, v32, v33
    v_cvt_pk_bf16_f32 v41, v34, v35
    v_cvt_pk_bf16_f32 v42, v36, v37
    v_cvt_pk_bf16_f32 v43, v38, v39
    buffer_store_dwordx4 v[40:43], v8, s[12:15], s63 offen sc1
    s_cmp_lg_u32 s44, 0
    s_cbranch_scc1 L_g_nl_52
    s_add_u32 s54, s60, 1
    s_add_u32 s55, s60, 2
    s_and_b32 s46, s54, 1
    s_lshl_b32 s46, s46, 7
    buffer_load_dword v12, v7, s[12:15], s46 offen sc1
    s_and_b32 s46, s55, 1
    s_lshl_b32 s46, s46, 7
    buffer_load_dword v13, v7, s[12:15], s46 offen sc1
    s_waitcnt vmcnt(0)
    v_cmp_ge_u32 s[56:57], s54, v12
    v_cmp_ge_u32 vcc, s55, v13
    s_nop 3
    s_cmp_eq_u64 s[56:57], 0
    s_cselect_b32 s46, 1, 0
    s_cmp_eq_u64 vcc, 0
    s_cselect_b32 s47, 2, 0
    s_or_b32 s46, s46, s47
    v_mov_b32 v12, s46
    ds_write_b32 v15, v12
L_g_nl_52:
    s_waitcnt vmcnt(0) lgkmcnt(0)
    s_barrier
    ds_read_b32 v12, v15
    s_cmp_lg_u32 s44, 0
    s_cbranch_scc1 L_sf_53
    v_mov_b32 v10, s60
    v_add_u32 v10, 1, v10
    v_mov_b32 v11, 0
    s_mov_b64 exec, 1
    buffer_store_dword v10, v11, s[12:15], s52 offen sc1
    s_mov_b64 exec, -1
L_sf_53:
    s_cmp_eq_u32 s60, 63
    s_cbranch_scc1 L_c_done_7
    s_add_u32 s60, s60, 1
    s_add_u32 s63, s63, 229376
    s_waitcnt lgkmcnt(0)
    v_readfirstlane_b32 s66, v12
    s_cmp_eq_u32 s65, 1
    s_cbranch_scc1 L_g_top_44
    s_nop 2
    s_bitcmp1_b32 s66, 0
    s_cbranch_scc1 L_g_fetch2_42
    s_mov_b32 s66, 0
    s_branch L_g_fetch_41
L_w_f2_21:
    s_load_dwordx2 s[4:5], s[0:1], 80
    s_load_dwordx2 s[6:7], s[0:1], 72
    s_and_b32 s50, s44, 3
    s_lshr_b32 s51, s44, 2
    s_waitcnt lgkmcnt(0)
    s_mov_b32 s24, s4
    s_and_b32 s25, s5, 0xffff
    s_mov_b32 s26, 0x700000
    s_mov_b32 s27, 0x00020000
    v_lshrrev_b32 v3, 4, v1
    v_and_b32 v4, 15, v1
    v_lshlrev_b32 v5, 2, v3
    v_xor_b32 v4, v4, v5
    v_mul_u32_u24 v3, 2048, v3
    v_lshl_add_u32 v3, v4, 4, v3
    s_mul_i32 s46, s51, 448
    s_mul_i32 s47, s50, 56
    s_add_u32 s46, s46, s47
    s_mul_i32 s47, s42, 896
    s_add_u32 s46, s46, s47
    s_mul_i32 s46, s46, 2048
    s_lshl_b32 s47, s43, 8
    s_add_u32 s46, s46, s47
    s_lshl_b32 s45, s51, 16
    s_mul_i32 s47, s50, 14336
    s_add_u32 s45, s45, s47
    v_bfe_u32 v4, v1, 2, 2
    v_bfe_u32 v5, v1, 4, 1
    v_lshlrev_b32 v5, 1, v5
    v_bfe_u32 v6, v1, 1, 1
    v_add_u32 v5, v5, v6
    s_lshl_b32 s47, s50, 2
    v_add_u32 v5, s47, v5
    v_lshlrev_b32 v6, 2, v4
    v_xor_b32 v5, v5, v6
    v_lshlrev_b32 v5, 4, v5
    v_lshl_add_u32 v5, v4, 8, v5
    v_and_b32 v6, 1, v1
    v_lshl_add_u32 v5, v6, 3, v5
    v_lshrrev_b32 v6, 5, v1
    v_mul_u32_u24 v6, 1024, v6
    v_add_u32 v5, v5, v6
    s_lshl_b32 s47, s51, 16
    v_add_u32 v5, s47, v5
    s_add_u32 m0, s45, 0
    s_add_u32 s47, s46, 0x0
    buffer_load_dwordx4 v3, s[24:27], s47 offen lds
    s_add_u32 m0, s45, 1024
    s_add_u32 s47, s46, 0x2000
    buffer_load_dwordx4 v3, s[24:27], s47 offen lds
    s_add_u32 m0, s45, 2048
    s_add_u32 s47, s46, 0x4000
    buffer_load_dwordx4 v3, s[24:27], s47 offen lds
    s_add_u32 m0, s45, 3072
    s_add_u32 s47, s46, 0x6000
    buffer_load_dwordx4 v3, s[24:27], s47 offen lds
    s_add_u32 m0, s45, 4096
    s_add_u32 s47, s46, 0x8000
    buffer_load_dwordx4 v3, s[24:27], s47 offen lds
    s_add_u32 m0, s45, 5120
    s_add_u32 s47, s46, 0xa000
    buffer_load_dwordx4 v3, s[24:27], s47 offen lds
    s_add_u32 m0, s45, 6144
    s_add_u32 s47, s46, 0xc000
    buffer_load_dwordx4 v3, s[24:27], s47 offen lds
    s_add_u32 m0, s45, 7168
    s_add_u32 s47, s46, 0xe000
    buffer_load_dwordx4 v3, s[24:27], s47 offen lds
    s_add_u32 m0, s45, 8192
    s_add_u32 s47, s46, 0x10000
    buffer_load_dwordx4 v3, s[24:27], s47 offen lds
    s_add_u32 m0, s45, 9216
    s_add_u32 s47, s46, 0x12000
    buffer_load_dwordx4 v3, s[24:27], s47 offen lds
    s_add_u32 m0, s45, 10240
    s_add_u32 s47, s46, 0x14000
    buffer_load_dwordx4 v3, s[24:27], s47 offen lds
    s_add_u32 m0, s45, 11264
    s_add_u32 s47, s46, 0x16000
    buffer_load_dwordx4 v3, s[24:27], s47 offen lds
    s_add_u32 m0, s45, 12288
    s_add_u32 s47, s46, 0x18000
    buffer_load_dwordx4 v3, s[24:27], s47 offen lds
    s_add_u32 m0, s45, 13312
    s_add_u32 s47, s46, 0x1a000
    buffer_load_dwordx4 v3, s[24:27], s47 offen lds
    s_waitcnt vmcnt(0)
    s_barrier
    ds_read_b64_tr_b16 a[0:1], v5 offset:0
    ds_read_b64_tr_b16 a[2:3], v5 offset:2048
    ds_read_b64_tr_b16 a[4:5], v5 offset:4096
    ds_read_b64_tr_b16 a[6:7], v5 offset:6144
    ds_read_b64_tr_b16 a[8:9], v5 offset:8192
    ds_read_b64_tr_b16 a[10:11], v5 offset:10240
    ds_read_b64_tr_b16 a[12:13], v5 offset:12288
    ds_read_b64_tr_b16 a[14:15], v5 offset:14336
    s_waitcnt lgkmcnt(0)
    ds_read_b64_tr_b16 a[16:17], v5 offset:16384
    ds_read_b64_tr_b16 a[18:19], v5 offset:18432
    ds_read_b64_tr_b16 a[20:21], v5 offset:20480
    ds_read_b64_tr_b16 a[22:23], v5 offset:22528
    ds_read_b64_tr_b16 a[24:25], v5 offset:24576
    ds_read_b64_tr_b16 a[26:27], v5 offset:26624
    ds_read_b64_tr_b16 a[28:29], v5 offset:28672
    ds_read_b64_tr_b16 a[30:31], v5 offset:30720
    s_waitcnt lgkmcnt(0)
    ds_read_b64_tr_b16 a[32:33], v5 offset:32768
    ds_read_b64_tr_b16 a[34:35], v5 offset:34816
    ds_read_b64_tr_b16 a[36:37], v5 offset:36864
    ds_read_b64_tr_b16 a[38:39], v5 offset:38912
    ds_read_b64_tr_b16 a[40:41], v5 offset:40960
    ds_read_b64_tr_b16 a[42:43], v5 offset:43008
    ds_read_b64_tr_b16 a[44:45], v5 offset:45056
    ds_read_b64_tr_b16 a[46:47], v5 offset:47104
    s_waitcnt lgkmcnt(0)
    ds_read_b64_tr_b16 a[48:49], v5 offset:49152
    ds_read_b64_tr_b16 a[50:51], v5 offset:51200
    ds_read_b64_tr_b16 a[52:53], v5 offset:53248
    ds_read_b64_tr_b16 a[54:55], v5 offset:55296
    s_waitcnt lgkmcnt(0)
    s_barrier
    s_add_u32 m0, s45, 0
    s_add_u32 s47, s46, 0x70000
    buffer_load_dwordx4 v3, s[24:27], s47 offen lds
    s_add_u32 m0, s45, 1024
    s_add_u32 s47, s46, 0x72000
    buffer_load_dwordx4 v3, s[24:27], s47 offen lds
    s_add_u32 m0, s45, 2048
    s_add_u32 s47, s46, 0x74000
    buffer_load_dwordx4 v3, s[24:27], s47 offen lds
    s_add_u32 m0, s45, 3072
    s_add_u32 s47, s46, 0x76000
    buffer_load_dwordx4 v3, s[24:27], s47 offen lds
    s_add_u32 m0, s45, 4096
    s_add_u32 s47, s46, 0x78000
    buffer_load_dwordx4 v3, s[24:27], s47 offen lds
    s_add_u32 m0, s45, 5120
    s_add_u32 s47, s46, 0x7a000
    buffer_load_dwordx4 v3, s[24:27], s47 offen lds
    s_add_u32 m0, s45, 6144
    s_add_u32 s47, s46, 0x7c000
    buffer_load_dwordx4 v3, s[24:27], s47 offen lds
    s_add_u32 m0, s45, 7168
    s_add_u32 s47, s46, 0x7e000
    buffer_load_dwordx4 v3, s[24:27], s47 offen lds
    s_add_u32 m0, s45, 8192
    s_add_u32 s47, s46, 0x80000
    buffer_load_dwordx4 v3, s[24:27], s47 offen lds
    s_add_u32 m0, s45, 9216
    s_add_u32 s47, s46, 0x82000
    buffer_load_dwordx4 v3, s[24:27], s47 offen lds
    s_add_u32 m0, s45, 10240
    s_add_u32 s47, s46, 0x84000
    buffer_load_dwordx4 v3, s[24:27], s47 offen lds
    s_add_u32 m0, s45, 11264
    s_add_u32 s47, s46, 0x86000
    buffer_load_dwordx4 v3, s[24:27], s47 offen lds
    s_add_u32 m0, s45, 12288
    s_add_u32 s47, s46, 0x88000
    buffer_load_dwordx4 v3, s[24:27], s47 offen lds
    s_add_u32 m0, s45, 13312
    s_add_u32 s47, s46, 0x8a000
    buffer_load_dwordx4 v3, s[24:27], s47 offen lds
    s_waitcnt vmcnt(0)
    s_barrier
    ds_read_b64_tr_b16 a[56:57], v5 offset:0
    ds_read_b64_tr_b16 a[58:59], v5 offset:2048
    ds_read_b64_tr_b16 a[60:61], v5 offset:4096
    ds_read_b64_tr_b16 a[62:63], v5 offset:6144
    ds_read_b64_tr_b16 a[64:65], v5 offset:8192
    ds_read_b64_tr_b16 a[66:67], v5 offset:10240
    ds_read_b64_tr_b16 a[68:69], v5 offset:12288
    ds_read_b64_tr_b16 a[70:71], v5 offset:14336
    s_waitcnt lgkmcnt(0)
    ds_read_b64_tr_b16 a[72:73], v5 offset:16384
    ds_read_b64_tr_b16 a[74:75], v5 offset:18432
    ds_read_b64_tr_b16 a[76:77], v5 offset:20480
    ds_read_b64_tr_b16 a[78:79], v5 offset:22528
    ds_read_b64_tr_b16 a[80:81], v5 offset:24576
    ds_read_b64_tr_b16 a[82:83], v5 offset:26624
    ds_read_b64_tr_b16 a[84:85], v5 offset:28672
    ds_read_b64_tr_b16 a[86:87], v5 offset:30720
    s_waitcnt lgkmcnt(0)
    ds_read_b64_tr_b16 a[88:89], v5 offset:32768
    ds_read_b64_tr_b16 a[90:91], v5 offset:34816
    ds_read_b64_tr_b16 a[92:93], v5 offset:36864
    ds_read_b64_tr_b16 a[94:95], v5 offset:38912
    ds_read_b64_tr_b16 a[96:97], v5 offset:40960
    ds_read_b64_tr_b16 a[98:99], v5 offset:43008
    ds_read_b64_tr_b16 a[100:101], v5 offset:45056
    ds_read_b64_tr_b16 a[102:103], v5 offset:47104
    s_waitcnt lgkmcnt(0)
    ds_read_b64_tr_b16 a[104:105], v5 offset:49152
    ds_read_b64_tr_b16 a[106:107], v5 offset:51200
    ds_read_b64_tr_b16 a[108:109], v5 offset:53248
    ds_read_b64_tr_b16 a[110:111], v5 offset:55296
    s_waitcnt lgkmcnt(0)
    s_barrier
    v_lshlrev_b32 v2, 4, v1
    s_lshl_b32 s46, s44, 13
    s_add_u32 s46, s46, 0x6000000
    s_mul_i32 s47, s42, 57344
    s_add_u32 s46, s46, s47
    v_add_u32 v3, s46, v2
    s_mul_i32 s46, s51, 28672
    v_add_u32 v4, s46, v2
    s_lshl_b32 s46, s44, 11
    s_add_u32 s46, s46, 131072
    v_add_u32 v5, s46, v2
    v_xor_b32 v6, 8192, v5
    v_min_u32 v7, 6, v1
    v_lshlrev_b32 v7, 7, v7
    s_mul_i32 s46, s42, 896
    s_add_u32 s46, s46, 0x108400
    v_add_u32 v7, s46, v7
    s_lshl_b32 s46, s42, 17
    s_lshl_b32 s47, s51, 16
    s_add_u32 s46, s46, s47
    s_lshl_b32 s47, s43, 12
    s_add_u32 s46, s46, s47
    s_lshl_b32 s47, s50, 10
    s_add_u32 s46, s46, s47
    s_add_u32 s46, s46, 0xb000000
    v_add_u32 v8, s46, v2
    v_add_u32 v9, 32768, v8
    s_lshl_b32 s52, s43, 9
    s_lshl_b32 s47, s42, 7
    s_add_u32 s52, s52, s47
    s_add_u32 s52, s52, 0x10a400
    s_mov_b32 s60, 0
    s_mov_b32 s61, 0
    s_mov_b32 s62, 0
    s_mov_b32 s63, 0
    s_lshl_b32 s64, s44, 13
    s_mov_b32 s66, 0
    v_mov_b32 v15, 147456
L_g_fetch_54:
    s_cmp_lg_u32 s44, 0
    s_cbranch_scc1 L_g_nsp_56
    s_and_b32 s46, s62, 0
    s_lshl_b32 s46, s46, 7
    s_mov_b32 s70, 0
L_spin_59:
    buffer_load_dword v14, v7, s[12:15], s46 offen sc1
    s_waitcnt vmcnt(0)
    v_cmp_ge_u32 vcc, s62, v14
    s_add_u32 s70, s70, 1
    s_cbranch_vccz L_spok_60
    s_sleep 8
    s_cmp_lt_u32 s70, 524288
    s_cbranch_scc1 L_spin_59
    s_branch L_c_done_7
L_spok_60:
L_g_nsp_56:
    s_barrier
L_g_fetch2_55:
    s_cmp_eq_u32 s44, 7
    s_cbranch_scc1 L_nod_61
    s_add_u32 s47, s61, 4096
    s_add_u32 m0, s64, 0
    s_nop 0
    buffer_load_dwordx4 v3, s[12:15], s61 offen offset:0 sc1 lds
    buffer_load_dwordx4 v3, s[12:15], s61 offen offset:1024 sc1 lds
    buffer_load_dwordx4 v3, s[12:15], s61 offen offset:2048 sc1 lds
    buffer_load_dwordx4 v3, s[12:15], s61 offen offset:3072 sc1 lds
    s_add_u32 m0, s64, 4096
    s_nop 0
    buffer_load_dwordx4 v3, s[12:15], s47 offen offset:0 sc1 lds
    buffer_load_dwordx4 v3, s[12:15], s47 offen offset:1024 sc1 lds
    buffer_load_dwordx4 v3, s[12:15], s47 offen offset:2048 sc1 lds
    buffer_load_dwordx4 v3, s[12:15], s47 offen offset:3072 sc1 lds
L_nod_61:
    s_add_u32 s61, s61, 229376
    s_add_u32 s62, s62, 1
    s_xor_b32 s64, s64, 0x10000
    s_waitcnt vmcnt(0)
    s_barrier
L_g_top_57:
    s_mov_b32 s65, 0
    s_bitcmp1_b32 s66, 1
    s_cbranch_scc0 L_g_nopend_58
    s_mov_b32 s65, 1
    s_cmp_eq_u32 s44, 7
    s_cbranch_scc1 L_nod_62
    s_add_u32 s47, s61, 4096
    s_add_u32 m0, s64, 0
    s_nop 0
    buffer_load_dwordx4 v3, s[12:15], s61 offen offset:0 sc1 lds
    buffer_load_dwordx4 v3, s[12:15], s61 offen offset:1024 sc1 lds
    buffer_load_dwordx4 v3, s[12:15], s61 offen offset:2048 sc1 lds
    buffer_load_dwordx4 v3, s[12:15], s61 offen offset:3072 sc1 lds
    s_add_u32 m0, s64, 4096
    s_nop 0
    buffer_load_dwordx4 v3, s[12:15], s47 offen offset:0 sc1 lds
    buffer_load_dwordx4 v3, s[12:15], s47 offen offset:1024 sc1 lds
    buffer_load_dwordx4 v3, s[12:15], s47 offen offset:2048 sc1 lds
    buffer_load_dwordx4 v3, s[12:15], s47 offen offset:3072 sc1 lds
L_nod_62:
    s_add_u32 s61, s61, 229376
    s_add_u32 s62, s62, 1
    s_xor_b32 s64, s64, 0x10000
L_g_nopend_58:
    ds_read_b128 v[32:35], v4 offset:0
    ds_read_b128 v[36:39], v4 offset:1024
    ds_read_b128 v[40:43], v4 offset:2048
    ds_read_b128 v[44:47], v4 offset:3072
    ds_read_b128 v[48:51], v4 offset:4096
    ds_read_b128 v[52:55], v4 offset:5120
    ds_read_b128 v[56:59], v4 offset:6144
    ds_read_b128 v[60:63], v4 offset:7168
    s_waitcnt lgkmcnt(7)
    v_mfma_f32_32x32x16_bf16 v[16:31], v[32:35], a[0:3], 0
    ds_read_b128 v[32:35], v4 offset:8192
    s_waitcnt lgkmcnt(7)
    v_mfma_f32_32x32x16_bf16 v[16:31], v[36:39], a[4:7], v[16:31]
    ds_read_b128 v[36:39], v4 offset:9216
    s_waitcnt lgkmcnt(7)
    v_mfma_f32_32x32x16_bf16 v[16:31], v[40:43], a[8:11], v[16:31]
    ds_read_b128 v[40:43], v4 offset:10240
    s_waitcnt lgkmcnt(7)
    v_mfma_f32_32x32x16_bf16 v[16:31], v[44:47], a[12:15], v[16:31]
    ds_read_b128 v[44:47], v4 offset:11264
    s_waitcnt lgkmcnt(7)
    v_mfma_f32_32x32x16_bf16 v[16:31], v[48:51], a[16:19], v[16:31]
    ds_read_b128 v[48:51], v4 offset:12288
    s_waitcnt lgkmcnt(7)
    v_mfma_f32_32x32x16_bf16 v[16:31], v[52:55], a[20:23], v[16:31]
    ds_read_b128 v[52:55], v4 offset:13312
    s_waitcnt lgkmcnt(7)
    v_mfma_f32_32x32x16_bf16 v[16:31], v[56:59], a[24:27], v[16:31]
    ds_read_b128 v[56:59], v4 offset:14336
    s_waitcnt lgkmcnt(7)
    v_mfma_f32_32x32x16_bf16 v[16:31], v[60:63], a[28:31], v[16:31]
    ds_read_b128 v[60:63], v4 offset:15360
    s_waitcnt lgkmcnt(7)
    v_mfma_f32_32x32x16_bf16 v[16:31], v[32:35], a[32:35], v[16:31]
    ds_read_b128 v[32:35], v4 offset:16384
    s_waitcnt lgkmcnt(7)
    v_mfma_f32_32x32x16_bf16 v[16:31], v[36:39], a[36:39], v[16:31]
    ds_read_b128 v[36:39], v4 offset:17408
    s_waitcnt lgkmcnt(7)
    v_mfma_f32_32x32x16_bf16 v[16:31], v[40:43], a[40:43], v[16:31]
    ds_read_b128 v[40:43], v4 offset:18432
    s_waitcnt lgkmcnt(7)
    v_mfma_f32_32x32x16_bf16 v[16:31], v[44:47], a[44:47], v[16:31]
    ds_read_b128 v[44:47], v4 offset:19456
    s_waitcnt lgkmcnt(7)
    v_mfma_f32_32x32x16_bf16 v[16:31], v[48:51], a[48:51], v[16:31]
    ds_read_b128 v[48:51], v4 offset:20480
    s_waitcnt lgkmcnt(7)
    v_mfma_f32_32x32x16_bf16 v[16:31], v[52:55], a[52:55], v[16:31]
    ds_read_b128 v[52:55], v4 offset:21504
    s_waitcnt lgkmcnt(7)
    v_mfma_f32_32x32x16_bf16 v[16:31], v[56:59], a[56:59], v[16:31]
    ds_read_b128 v[56:59], v4 offset:22528
    s_waitcnt lgkmcnt(7)
    v_mfma_f32_32x32x16_bf16 v[16:31], v[60:63], a[60:63], v[16:31]
    ds_read_b128 v[60:63], v4 offset:23552
    s_waitcnt lgkmcnt(7)
    v_mfma_f32_32x32x16_bf16 v[16:31], v[32:35], a[64:67], v[16:31]
    ds_read_b128 v[32:35], v4 offset:24576
    s_waitcnt lgkmcnt(7)
    v_mfma_f32_32x32x16_bf16 v[16:31], v[36:39], a[68:71], v[16:31]
    ds_read_b128 v[36:39], v4 offset:25600
    s_waitcnt lgkmcnt(7)
    v_mfma_f32_32x32x16_bf16 v[16:31], v[40:43], a[72:75], v[16:31]
    ds_read_b128 v[40:43], v4 offset:26624
    s_waitcnt lgkmcnt(7)
    v_mfma_f32_32x32x16_bf16 v[16:31], v[44:47], a[76:79], v[16:31]
    ds_read_b128 v[44:47], v4 offset:27648
    s_waitcnt lgkmcnt(7)
    v_mfma_f32_32x32x16_bf16 v[16:31], v[48:51], a[80:83], v[16:31]
    s_waitcnt lgkmcnt(6)
    v_mfma_f32_32x32x16_bf16 v[16:31], v[52:55], a[84:87], v[16:31]
    s_waitcnt lgkmcnt(5)
    v_mfma_f32_32x32x16_bf16 v[16:31], v[56:59], a[88:91], v[16:31]
    s_waitcnt lgkmcnt(4)
    v_mfma_f32_32x32x16_bf16 v[16:31], v[60:63], a[92:95], v[16:31]
    s_waitcnt lgkmcnt(3)
    v_mfma_f32_32x32x16_bf16 v[16:31], v[32:35], a[96:99], v[16:31]
    s_waitcnt lgkmcnt(2)
    v_mfma_f32_32x32x16_bf16 v[16:31], v[36:39], a[100:103], v[16:31]
    s_waitcnt lgkmcnt(1)
    v_mfma_f32_32x32x16_bf16 v[16:31], v[40:43], a[104:107], v[16:31]
    s_waitcnt lgkmcnt(0)
    v_mfma_f32_32x32x16_bf16 v[16:31], v[44:47], a[108:111], v[16:31]
    v_xor_b32 v4, 0x10000, v4
    s_cmp_eq_u32 s51, 1
    s_nop 9
    s_cbranch_scc1 L_g_k1_63
    ds_write_b128 v5, v[24:27]
    ds_write_b128 v5, v[28:31] offset:1024
    s_waitcnt lgkmcnt(0)
    s_barrier
    ds_read_b128 v[32:35], v6
    ds_read_b128 v[36:39], v6 offset:1024
    s_waitcnt lgkmcnt(0)
    v_pk_add_f32 v[32:33], v[32:33], v[16:17]
    v_pk_add_f32 v[34:35], v[34:35], v[18:19]
    v_pk_add_f32 v[36:37], v[36:37], v[20:21]
    v_pk_add_f32 v[38:39], v[38:39], v[22:23]
    s_branch L_g_k2_64
L_g_k1_63:
    ds_write_b128 v5, v[16:19]
    ds_write_b128 v5, v[20:23] offset:1024
    s_waitcnt lgkmcnt(0)
    s_barrier
    ds_read_b128 v[32:35], v6
    ds_read_b128 v[36:39], v6 offset:1024
    s_waitcnt lgkmcnt(0)
    v_pk_add_f32 v[32:33], v[32:33], v[24:25]
    v_pk_add_f32 v[34:35], v[34:35], v[26:27]
    v_pk_add_f32 v[36:37], v[36:37], v[28:29]
    v_pk_add_f32 v[38:39], v[38:39], v[30:31]
L_g_k2_64:
    buffer_store_dwordx4 v[32:35], v8, s[12:15], s63 offen sc1
    buffer_store_dwordx4 v[36:39], v9, s[12:15], s63 offen sc1
    s_cmp_lg_u32 s44, 0
    s_cbranch_scc1 L_g_nl_65
    s_add_u32 s54, s60, 1
    s_add_u32 s55, s60, 2
    s_and_b32 s46, s54, 0
    s_lshl_b32 s46, s46, 7
    buffer_load_dword v12, v7, s[12:15], s46 offen sc1
    s_waitcnt vmcnt(0)
    v_cmp_ge_u32 s[56:57], s54, v12
    v_cmp_ge_u32 vcc, s55, v12
    s_nop 3
    s_cmp_eq_u64 s[56:57], 0
    s_cselect_b32 s46, 1, 0
    s_cmp_eq_u64 vcc, 0
    s_cselect_b32 s47, 2, 0
    s_or_b32 s46, s46, s47
    v_mov_b32 v12, s46
    ds_write_b32 v15, v12
L_g_nl_65:
    s_waitcnt vmcnt(0) lgkmcnt(0)
    s_barrier
    ds_read_b32 v12, v15
    s_cmp_lg_u32 s44, 0
    s_cbranch_scc1 L_sf_66
    v_mov_b32 v10, s60
    v_add_u32 v10, 1, v10
    v_mov_b32 v11, 0
    s_mov_b64 exec, 1
    buffer_store_dword v10, v11, s[12:15], s52 offen sc1
    s_mov_b64 exec, -1
L_sf_66:
    s_cmp_eq_u32 s60, 63
    s_cbranch_scc1 L_c_done_7
    s_add_u32 s60, s60, 1
    s_add_u32 s63, s63, 524288
    s_waitcnt lgkmcnt(0)
    v_readfirstlane_b32 s66, v12
    s_cmp_eq_u32 s65, 1
    s_cbranch_scc1 L_g_top_57
    s_nop 2
    s_bitcmp1_b32 s66, 0
    s_cbranch_scc1 L_g_fetch2_55
    s_mov_b32 s66, 0
    s_branch L_g_fetch_54
L_w_wo_20:
    s_load_dwordx2 s[4:5], s[0:1], 40
    s_load_dwordx2 s[6:7], s[0:1], 72
    s_and_b32 s50, s44, 3
    s_lshr_b32 s51, s44, 2
    s_waitcnt lgkmcnt(0)
    s_mov_b32 s24, s4
    s_and_b32 s25, s5, 0xffff
    s_mov_b32 s26, 0x800000
    s_mov_b32 s27, 0x00020000
    v_lshrrev_b32 v3, 4, v1
    v_and_b32 v4, 15, v1
    v_lshlrev_b32 v5, 2, v3
    v_xor_b32 v4, v4, v5
    v_mul_u32_u24 v3, 2048, v3
    v_lshl_add_u32 v3, v4, 4, v3
    s_mul_i32 s46, s51, 512
    s_mul_i32 s47, s50, 64
    s_add_u32 s46, s46, s47
    s_mul_i32 s47, s42, 1024
    s_add_u32 s46, s46, s47
    s_mul_i32 s46, s46, 2048
    s_lshl_b32 s47, s43, 8
    s_add_u32 s46, s46, s47
    s_lshl_b32 s45, s51, 16
    s_mul_i32 s47, s50, 16384
    s_add_u32 s45, s45, s47
    v_bfe_u32 v4, v1, 2, 2
    v_bfe_u32 v5, v1, 4, 1
    v_lshlrev_b32 v5, 1, v5
    v_bfe_u32 v6, v1, 1, 1
    v_add_u32 v5, v5, v6
    s_lshl_b32 s47, s50, 2
    v_add_u32 v5, s47, v5
    v_lshlrev_b32 v6, 2, v4
    v_xor_b32 v5, v5, v6
    v_lshlrev_b32 v5, 4, v5
    v_lshl_add_u32 v5, v4, 8, v5
    v_and_b32 v6, 1, v1
    v_lshl_add_u32 v5, v6, 3, v5
    v_lshrrev_b32 v6, 5, v1
    v_mul_u32_u24 v6, 1024, v6
    v_add_u32 v5, v5, v6
    s_lshl_b32 s47, s51, 16
    v_add_u32 v5, s47, v5
    s_add_u32 m0, s45, 0
    s_add_u32 s47, s46, 0x0
    buffer_load_dwordx4 v3, s[24:27], s47 offen lds
    s_add_u32 m0, s45, 1024
    s_add_u32 s47, s46, 0x2000
    buffer_load_dwordx4 v3, s[24:27], s47 offen lds
    s_add_u32 m0, s45, 2048
    s_add_u32 s47, s46, 0x4000
    buffer_load_dwordx4 v3, s[24:27], s47 offen lds
    s_add_u32 m0, s45, 3072
    s_add_u32 s47, s46, 0x6000
    buffer_load_dwordx4 v3, s[24:27], s47 offen lds
    s_add_u32 m0, s45, 4096
    s_add_u32 s47, s46, 0x8000
    buffer_load_dwordx4 v3, s[24:27], s47 offen lds
    s_add_u32 m0, s45, 5120
    s_add_u32 s47, s46, 0xa000
    buffer_load_dwordx4 v3, s[24:27], s47 offen lds
    s_add_u32 m0, s45, 6144
    s_add_u32 s47, s46, 0xc000
    buffer_load_dwordx4 v3, s[24:27], s47 offen lds
    s_add_u32 m0, s45, 7168
    s_add_u32 s47, s46, 0xe000
    buffer_load_dwordx4 v3, s[24:27], s47 offen lds
    s_add_u32 m0, s45, 8192
    s_add_u32 s47, s46, 0x10000
    buffer_load_dwordx4 v3, s[24:27], s47 offen lds
    s_add_u32 m0, s45, 9216
    s_add_u32 s47, s46, 0x12000
    buffer_load_dwordx4 v3, s[24:27], s47 offen lds
    s_add_u32 m0, s45, 10240
    s_add_u32 s47, s46, 0x14000
    buffer_load_dwordx4 v3, s[24:27], s47 offen lds
    s_add_u32 m0, s45, 11264
    s_add_u32 s47, s46, 0x16000
    buffer_load_dwordx4 v3, s[24:27], s47 offen lds
    s_add_u32 m0, s45, 12288
    s_add_u32 s47, s46, 0x18000
    buffer_load_dwordx4 v3, s[24:27], s47 offen lds
    s_add_u32 m0, s45, 13312
    s_add_u32 s47, s46, 0x1a000
    buffer_load_dwordx4 v3, s[24:27], s47 offen lds
    s_add_u32 m0, s45, 14336
    s_add_u32 s47, s46, 0x1c000
    buffer_load_dwordx4 v3, s[24:27], s47 offen lds
    s_add_u32 m0, s45, 15360
    s_add_u32 s47, s46, 0x1e000
    buffer_load_dwordx4 v3, s[24:27], s47 offen lds
    s_waitcnt vmcnt(0)
    s_barrier
    ds_read_b64_tr_b16 a[0:1], v5 offset:0
    ds_read_b64_tr_b16 a[2:3], v5 offset:4096
    ds_read_b64_tr_b16 a[4:5], v5 offset:2048
    ds_read_b64_tr_b16 a[6:7], v5 offset:6144
    ds_read_b64_tr_b16 a[8:9], v5 offset:8192
    ds_read_b64_tr_b16 a[10:11], v5 offset:12288
    ds_read_b64_tr_b16 a[12:13], v5 offset:10240
    ds_read_b64_tr_b16 a[14:15], v5 offset:14336
    s_waitcnt lgkmcnt(0)
    ds_read_b64_tr_b16 a[16:17], v5 offset:16384
    ds_read_b64_tr_b16 a[18:19], v5 offset:20480
    ds_read_b64_tr_b16 a[20:21], v5 offset:18432
    ds_read_b64_tr_b16 a[22:23], v5 offset:22528
    ds_read_b64_tr_b16 a[24:25], v5 offset:24576
    ds_read_b64_tr_b16 a[26:27], v5 offset:28672
    ds_read_b64_tr_b16 a[28:29], v5 offset:26624
    ds_read_b64_tr_b16 a[30:31], v5 offset:30720
    s_waitcnt lgkmcnt(0)
    ds_read_b64_tr_b16 a[32:33], v5 offset:32768
    ds_read_b64_tr_b16 a[34:35], v5 offset:36864
    ds_read_b64_tr_b16 a[36:37], v5 offset:34816
    ds_read_b64_tr_b16 a[38:39], v5 offset:38912
    ds_read_b64_tr_b16 a[40:41], v5 offset:40960
    ds_read_b64_tr_b16 a[42:43], v5 offset:45056
    ds_read_b64_tr_b16 a[44:45], v5 offset:43008
    ds_read_b64_tr_b16 a[46:47], v5 offset:47104
    s_waitcnt lgkmcnt(0)
    ds_read_b64_tr_b16 a[48:49], v5 offset:49152
    ds_read_b64_tr_b16 a[50:51], v5 offset:53248
    ds_read_b64_tr_b16 a[52:53], v5 offset:51200
    ds_read_b64_tr_b16 a[54:55], v5 offset:55296
    ds_read_b64_tr_b16 a[56:57], v5 offset:57344
    ds_read_b64_tr_b16 a[58:59], v5 offset:61440
    ds_read_b64_tr_b16 a[60:61], v5 offset:59392
    ds_read_b64_tr_b16 a[62:63], v5 offset:63488
    s_waitcnt lgkmcnt(0)
    s_waitcnt lgkmcnt(0)
    s_barrier
    s_add_u32 m0, s45, 0
    s_add_u32 s47, s46, 0x80000
    buffer_load_dwordx4 v3, s[24:27], s47 offen lds
    s_add_u32 m0, s45, 1024
    s_add_u32 s47, s46, 0x82000
    buffer_load_dwordx4 v3, s[24:27], s47 offen lds
    s_add_u32 m0, s45, 2048
    s_add_u32 s47, s46, 0x84000
    buffer_load_dwordx4 v3, s[24:27], s47 offen lds
    s_add_u32 m0, s45, 3072
    s_add_u32 s47, s46, 0x86000
    buffer_load_dwordx4 v3, s[24:27], s47 offen lds
    s_add_u32 m0, s45, 4096
    s_add_u32 s47, s46, 0x88000
    buffer_load_dwordx4 v3, s[24:27], s47 offen lds
    s_add_u32 m0, s45, 5120
    s_add_u32 s47, s46, 0x8a000
    buffer_load_dwordx4 v3, s[24:27], s47 offen lds
    s_add_u32 m0, s45, 6144
    s_add_u32 s47, s46, 0x8c000
    buffer_load_dwordx4 v3, s[24:27], s47 offen lds
    s_add_u32 m0, s45, 7168
    s_add_u32 s47, s46, 0x8e000
    buffer_load_dwordx4 v3, s[24:27], s47 offen lds
    s_add_u32 m0, s45, 8192
    s_add_u32 s47, s46, 0x90000
    buffer_load_dwordx4 v3, s[24:27], s47 offen lds
    s_add_u32 m0, s45, 9216
    s_add_u32 s47, s46, 0x92000
    buffer_load_dwordx4 v3, s[24:27], s47 offen lds
    s_add_u32 m0, s45, 10240
    s_add_u32 s47, s46, 0x94000
    buffer_load_dwordx4 v3, s[24:27], s47 offen lds
    s_add_u32 m0, s45, 11264
    s_add_u32 s47, s46, 0x96000
    buffer_load_dwordx4 v3, s[24:27], s47 offen lds
    s_add_u32 m0, s45, 12288
    s_add_u32 s47, s46, 0x98000
    buffer_load_dwordx4 v3, s[24:27], s47 offen lds
    s_add_u32 m0, s45, 13312
    s_add_u32 s47, s46, 0x9a000
    buffer_load_dwordx4 v3, s[24:27], s47 offen lds
    s_add_u32 m0, s45, 14336
    s_add_u32 s47, s46, 0x9c000
    buffer_load_dwordx4 v3, s[24:27], s47 offen lds
    s_add_u32 m0, s45, 15360
    s_add_u32 s47, s46, 0x9e000
    buffer_load_dwordx4 v3, s[24:27], s47 offen lds
    s_waitcnt vmcnt(0)
    s_barrier
    ds_read_b64_tr_b16 a[64:65], v5 offset:0
    ds_read_b64_tr_b16 a[66:67], v5 offset:4096
    ds_read_b64_tr_b16 a[68:69], v5 offset:2048
    ds_read_b64_tr_b16 a[70:71], v5 offset:6144
    ds_read_b64_tr_b16 a[72:73], v5 offset:8192
    ds_read_b64_tr_b16 a[74:75], v5 offset:12288
    ds_read_b64_tr_b16 a[76:77], v5 offset:10240
    ds_read_b64_tr_b16 a[78:79], v5 offset:14336
    s_waitcnt lgkmcnt(0)
    ds_read_b64_tr_b16 a[80:81], v5 offset:16384
    ds_read_b64_tr_b16 a[82:83], v5 offset:20480
    ds_read_b64_tr_b16 a[84:85], v5 offset:18432
    ds_read_b64_tr_b16 a[86:87], v5 offset:22528
    ds_read_b64_tr_b16 a[88:89], v5 offset:24576
    ds_read_b64_tr_b16 a[90:91], v5 offset:28672
    ds_read_b64_tr_b16 a[92:93], v5 offset:26624
    ds_read_b64_tr_b16 a[94:95], v5 offset:30720
    s_waitcnt lgkmcnt(0)
    ds_read_b64_tr_b16 a[96:97], v5 offset:32768
    ds_read_b64_tr_b16 a[98:99], v5 offset:36864
    ds_read_b64_tr_b16 a[100:101], v5 offset:34816
    ds_read_b64_tr_b16 a[102:103], v5 offset:38912
    ds_read_b64_tr_b16 a[104:105], v5 offset:40960
    ds_read_b64_tr_b16 a[106:107], v5 offset:45056
    ds_read_b64_tr_b16 a[108:109], v5 offset:43008
    ds_read_b64_tr_b16 a[110:111], v5 offset:47104
    s_waitcnt lgkmcnt(0)
    ds_read_b64_tr_b16 a[112:113], v5 offset:49152
    ds_read_b64_tr_b16 a[114:115], v5 offset:53248
    ds_read_b64_tr_b16 a[116:117], v5 offset:51200
    ds_read_b64_tr_b16 a[118:119], v5 offset:55296
    ds_read_b64_tr_b16 a[120:121], v5 offset:57344
    ds_read_b64_tr_b16 a[122:123], v5 offset:61440
    ds_read_b64_tr_b16 a[124:125], v5 offset:59392
    ds_read_b64_tr_b16 a[126:127], v5 offset:63488
    s_waitcnt lgkmcnt(0)
    s_waitcnt lgkmcnt(0)
    s_barrier
    v_lshlrev_b32 v2, 4, v1
    s_lshl_b32 s46, s44, 13
    s_add_u32 s46, s46, 0x5000000
    s_mul_i32 s47, s42, 65536
    s_add_u32 s46, s46, s47
    v_add_u32 v3, s46, v2
    s_mul_i32 s46, s51, 32768
    v_add_u32 v4, s46, v2
    s_lshl_b32 s46, s44, 11
    s_add_u32 s46, s46, 131072
    v_add_u32 v5, s46, v2
    v_xor_b32 v6, 8192, v5
    v_and_b32 v7, 7, v1
    v_lshlrev_b32 v7, 9, v7
    s_lshl_b32 s46, s42, 12
    s_add_u32 s46, s46, 0x104000
    v_add_u32 v7, s46, v7
    s_lshl_b32 s46, s42, 17
    s_lshl_b32 s47, s51, 16
    s_add_u32 s46, s46, s47
    s_lshl_b32 s47, s43, 12
    s_add_u32 s46, s46, s47
    s_lshl_b32 s47, s50, 10
    s_add_u32 s46, s46, s47
    s_add_u32 s46, s46, 0x9000000
    v_add_u32 v8, s46, v2
    v_add_u32 v9, 32768, v8
    s_lshl_b32 s52, s43, 9
    s_lshl_b32 s47, s42, 7
    s_add_u32 s52, s52, s47
    s_add_u32 s52, s52, 0x109400
    s_mov_b32 s60, 0
    s_mov_b32 s61, 0
    s_mov_b32 s62, 0
    s_mov_b32 s63, 0
    s_lshl_b32 s64, s44, 13
    s_mov_b32 s66, 0
    v_mov_b32 v15, 147456
L_g_fetch_67:
    s_cmp_lg_u32 s44, 0
    s_cbranch_scc1 L_g_nsp_69
    s_and_b32 s46, s62, 3
    s_lshl_b32 s46, s46, 7
    s_mov_b32 s70, 0
L_spin_72:
    buffer_load_dword v14, v7, s[12:15], s46 offen sc1
    s_waitcnt vmcnt(0)
    v_cmp_ge_u32 vcc, s62, v14
    s_add_u32 s70, s70, 1
    s_cbranch_vccz L_spok_73
    s_sleep 8
    s_cmp_lt_u32 s70, 524288
    s_cbranch_scc1 L_spin_72
    s_branch L_c_done_7
L_spok_73:
L_g_nsp_69:
    s_barrier
L_g_fetch2_68:
    s_add_u32 s47, s61, 4096
    s_add_u32 m0, s64, 0
    s_nop 0
    buffer_load_dwordx4 v3, s[12:15], s61 offen offset:0 sc1 lds
    buffer_load_dwordx4 v3, s[12:15], s61 offen offset:1024 sc1 lds
    buffer_load_dwordx4 v3, s[12:15], s61 offen offset:2048 sc1 lds
    buffer_load_dwordx4 v3, s[12:15], s61 offen offset:3072 sc1 lds
    s_add_u32 m0, s64, 4096
    s_nop 0
    buffer_load_dwordx4 v3, s[12:15], s47 offen offset:0 sc1 lds
    buffer_load_dwordx4 v3, s[12:15], s47 offen offset:1024 sc1 lds
    buffer_load_dwordx4 v3, s[12:15], s47 offen offset:2048 sc1 lds
    buffer_load_dwordx4 v3, s[12:15], s47 offen offset:3072 sc1 lds
L_nod_74:
    s_add_u32 s61, s61, 262144
    s_add_u32 s62, s62, 1
    s_xor_b32 s64, s64, 0x10000
    s_waitcnt vmcnt(0)
    s_barrier
L_g_top_70:
    s_mov_b32 s65, 0
    s_bitcmp1_b32 s66, 1
    s_cbranch_scc0 L_g_nopend_71
    s_mov_b32 s65, 1
    s_add_u32 s47, s61, 4096
    s_add_u32 m0, s64, 0
    s_nop 0
    buffer_load_dwordx4 v3, s[12:15], s61 offen offset:0 sc1 lds
    buffer_load_dwordx4 v3, s[12:15], s61 offen offset:1024 sc1 lds
    buffer_load_dwordx4 v3, s[12:15], s61 offen offset:2048 sc1 lds
    buffer_load_dwordx4 v3, s[12:15], s61 offen offset:3072 sc1 lds
    s_add_u32 m0, s64, 4096
    s_nop 0
    buffer_load_dwordx4 v3, s[12:15], s47 offen offset:0 sc1 lds
    buffer_load_dwordx4 v3, s[12:15], s47 offen offset:1024 sc1 lds
    buffer_load_dwordx4 v3, s[12:15], s47 offen offset:2048 sc1 lds
    buffer_load_dwordx4 v3, s[12:15], s47 offen offset:3072 sc1 lds
L_nod_75:
    s_add_u32 s61, s61, 262144
    s_add_u32 s62, s62, 1
    s_xor_b32 s64, s64, 0x10000
L_g_nopend_71:
    ds_read_b128 v[32:35], v4 offset:0
    ds_read_b128 v[36:39], v4 offset:1024
    ds_read_b128 v[40:43], v4 offset:2048
    ds_read_b128 v[44:47], v4 offset:3072
    ds_read_b128 v[48:51], v4 offset:4096
    ds_read_b128 v[52:55], v4 offset:5120
    ds_read_b128 v[56:59], v4 offset:6144
    ds_read_b128 v[60:63], v4 offset:7168
    s_waitcnt lgkmcnt(7)
    v_mfma_f32_32x32x16_bf16 v[16:31], v[32:35], a[0:3], 0
    ds_read_b128 v[32:35], v4 offset:8192
    s_waitcnt lgkmcnt(7)
    v_mfma_f32_32x32x16_bf16 v[16:31], v[36:39], a[4:7], v[16:31]
    ds_read_b128 v[36:39], v4 offset:9216
    s_waitcnt lgkmcnt(7)
    v_mfma_f32_32x32x16_bf16 v[16:31], v[40:43], a[8:11], v[16:31]
    ds_read_b128 v[40:43], v4 offset:10240
    s_waitcnt lgkmcnt(7)
    v_mfma_f32_32x32x16_bf16 v[16:31], v[44:47], a[12:15], v[16:31]
    ds_read_b128 v[44:47], v4 offset:11264
    s_waitcnt lgkmcnt(7)
    v_mfma_f32_32x32x16_bf16 v[16:31], v[48:51], a[16:19], v[16:31]
    ds_read_b128 v[48:51], v4 offset:12288
    s_waitcnt lgkmcnt(7)
    v_mfma_f32_32x32x16_bf16 v[16:31], v[52:55], a[20:23], v[16:31]
    ds_read_b128 v[52:55], v4 offset:13312
    s_waitcnt lgkmcnt(7)
    v_mfma_f32_32x32x16_bf16 v[16:31], v[56:59], a[24:27], v[16:31]
    ds_read_b128 v[56:59], v4 offset:14336
    s_waitcnt lgkmcnt(7)
    v_mfma_f32_32x32x16_bf16 v[16:31], v[60:63], a[28:31], v[16:31]
    ds_read_b128 v[60:63], v4 offset:15360
    s_waitcnt lgkmcnt(7)
    v_mfma_f32_32x32x16_bf16 v[16:31], v[32:35], a[32:35], v[16:31]
    ds_read_b128 v[32:35], v4 offset:16384
    s_waitcnt lgkmcnt(7)
    v_mfma_f32_32x32x16_bf16 v[16:31], v[36:39], a[36:39], v[16:31]
    ds_read_b128 v[36:39], v4 offset:17408
    s_waitcnt lgkmcnt(7)
    v_mfma_f32_32x32x16_bf16 v[16:31], v[40:43], a[40:43], v[16:31]
    ds_read_b128 v[40:43], v4 offset:18432
    s_waitcnt lgkmcnt(7)
    v_mfma_f32_32x32x16_bf16 v[16:31], v[44:47], a[44:47], v[16:31]
    ds_read_b128 v[44:47], v4 offset:19456
    s_waitcnt lgkmcnt(7)
    v_mfma_f32_32x32x16_bf16 v[16:31], v[48:51], a[48:51], v[16:31]
    ds_read_b128 v[48:51], v4 offset:20480
    s_waitcnt lgkmcnt(7)
    v_mfma_f32_32x32x16_bf16 v[16:31], v[52:55], a[52:55], v[16:31]
    ds_read_b128 v[52:55], v4 offset:21504
    s_waitcnt lgkmcnt(7)
    v_mfma_f32_32x32x16_bf16 v[16:31], v[56:59], a[56:59], v[16:31]
    ds_read_b128 v[56:59], v4 offset:22528
    s_waitcnt lgkmcnt(7)
    v_mfma_f32_32x32x16_bf16 v[16:31], v[60:63], a[60:63], v[16:31]
    ds_read_b128 v[60:63], v4 offset:23552
    s_waitcnt lgkmcnt(7)
    v_mfma_f32_32x32x16_bf16 v[16:31], v[32:35], a[64:67], v[16:31]
    ds_read_b128 v[32:35], v4 offset:24576
    s_waitcnt lgkmcnt(7)
    v_mfma_f32_32x32x16_bf16 v[16:31], v[36:39], a[68:71], v[16:31]
    ds_read_b128 v[36:39], v4 offset:25600
    s_waitcnt lgkmcnt(7)
    v_mfma_f32_32x32x16_bf16 v[16:31], v[40:43], a[72:75], v[16:31]
    ds_read_b128 v[40:43], v4 offset:26624
    s_waitcnt lgkmcnt(7)
    v_mfma_f32_32x32x16_bf16 v[16:31], v[44:47], a[76:79], v[16:31]
    ds_read_b128 v[44:47], v4 offset:27648
    s_waitcnt lgkmcnt(7)
    v_mfma_f32_32x32x16_bf16 v[16:31], v[48:51], a[80:83], v[16:31]
    ds_read_b128 v[48:51], v4 offset:28672
    s_waitcnt lgkmcnt(7)
    v_mfma_f32_32x32x16_bf16 v[16:31], v[52:55], a[84:87], v[16:31]
    ds_read_b128 v[52:55], v4 offset:29696
    s_waitcnt lgkmcnt(7)
    v_mfma_f32_32x32x16_bf16 v[16:31], v[56:59], a[88:91], v[16:31]
    ds_read_b128 v[56:59], v4 offset:30720
    s_waitcnt lgkmcnt(7)
    v_mfma_f32_32x32x16_bf16 v[16:31], v[60:63], a[92:95], v[16:31]
    ds_read_b128 v[60:63], v4 offset:31744
    s_waitcnt lgkmcnt(7)
    v_mfma_f32_32x32x16_bf16 v[16:31], v[32:35], a[96:99], v[16:31]
    s_waitcnt lgkmcnt(6)
    v_mfma_f32_32x32x16_bf16 v[16:31], v[36:39], a[100:103], v[16:31]
    s_waitcnt lgkmcnt(5)
    v_mfma_f32_32x32x16_bf16 v[16:31], v[40:43], a[104:107], v[16:31]
    s_waitcnt lgkmcnt(4)
    v_mfma_f32_32x32x16_bf16 v[16:31], v[44:47], a[108:111], v[16:31]
    s_waitcnt lgkmcnt(3)
    v_mfma_f32_32x32x16_bf16 v[16:31], v[48:51], a[112:115], v[16:31]
    s_waitcnt lgkmcnt(2)
    v_mfma_f32_32x32x16_bf16 v[16:31], v[52:55], a[116:119], v[16:31]
    s_waitcnt lgkmcnt(1)
    v_mfma_f32_32x32x16_bf16 v[16:31], v[56:59], a[120:123], v[16:31]
    s_waitcnt lgkmcnt(0)
    v_mfma_f32_32x32x16_bf16 v[16:31], v[60:63], a[124:127], v[16:31]
    v_xor_b32 v4, 0x10000, v4
    s_cmp_eq_u32 s51, 1
    s_nop 9
    s_cbranch_scc1 L_g_k1_76
    ds_write_b128 v5, v[24:27]
    ds_write_b128 v5, v[28:31] offset:1024
    s_waitcnt lgkmcnt(0)
    s_barrier
    ds_read_b128 v[32:35], v6
    ds_read_b128 v[36:39], v6 offset:1024
    s_waitcnt lgkmcnt(0)
    v_pk_add_f32 v[32:33], v[32:33], v[16:17]
    v_pk_add_f32 v[34:35], v[34:35], v[18:19]
    v_pk_add_f32 v[36:37], v[36:37], v[20:21]
    v_pk_add_f32 v[38:39], v[38:39], v[22:23]
    s_branch L_g_k2_77
L_g_k1_76:
    ds_write_b128 v5, v[16:19]
    ds_write_b128 v5, v[20:23] offset:1024
    s_waitcnt lgkmcnt(0)
    s_barrier
    ds_read_b128 v[32:35], v6
    ds_read_b128 v[36:39], v6 offset:1024
    s_waitcnt lgkmcnt(0)
    v_pk_add_f32 v[32:33], v[32:33], v[24:25]
    v_pk_add_f32 v[34:35], v[34:35], v[26:27]
    v_pk_add_f32 v[36:37], v[36:37], v[28:29]
    v_pk_add_f32 v[38:39], v[38:39], v[30:31]
L_g_k2_77:
    buffer_store_dwordx4 v[32:35], v8, s[12:15], s63 offen sc1
    buffer_store_dwordx4 v[36:39], v9, s[12:15], s63 offen sc1
    s_cmp_lg_u32 s44, 0
    s_cbranch_scc1 L_g_nl_78
    s_add_u32 s54, s60, 1
    s_add_u32 s55, s60, 2
    s_and_b32 s46, s54, 3
    s_lshl_b32 s46, s46, 7
    buffer_load_dword v12, v7, s[12:15], s46 offen sc1
    s_and_b32 s46, s55, 3
    s_lshl_b32 s46, s46, 7
    buffer_load_dword v13, v7, s[12:15], s46 offen sc1
    s_waitcnt vmcnt(0)
    v_cmp_ge_u32 s[56:57], s54, v12
    v_cmp_ge_u32 vcc, s55, v13
    s_nop 3
    s_cmp_eq_u64 s[56:57], 0
    s_cselect_b32 s46, 1, 0
    s_cmp_eq_u64 vcc, 0
    s_cselect_b32 s47, 2, 0
    s_or_b32 s46, s46, s47
    v_mov_b32 v12, s46
    ds_write_b32 v15, v12
L_g_nl_78:
    s_waitcnt vmcnt(0) lgkmcnt(0)
    s_barrier
    ds_read_b32 v12, v15
    s_cmp_lg_u32 s44, 0
    s_cbranch_scc1 L_sf_79
    v_mov_b32 v10, s60
    v_add_u32 v10, 1, v10
    v_mov_b32 v11, 0
    s_mov_b64 exec, 1
    buffer_store_dword v10, v11, s[12:15], s52 offen sc1
    s_mov_b64 exec, -1
L_sf_79:
    s_cmp_eq_u32 s60, 63
    s_cbranch_scc1 L_c_done_7
    s_add_u32 s60, s60, 1
    s_add_u32 s63, s63, 524288
    s_waitcnt lgkmcnt(0)
    v_readfirstlane_b32 s66, v12
    s_cmp_eq_u32 s65, 1
    s_cbranch_scc1 L_g_top_70
    s_nop 2
    s_bitcmp1_b32 s66, 0
    s_cbranch_scc1 L_g_fetch2_68
    s_mov_b32 s66, 0
    s_branch L_g_fetch_67
L_c_chain_19:
    v_mov_b32 v4, 0
    v_mov_b32 v5, 0
    v_mov_b32 v6, 0
    v_mov_b32 v7, 0
    v_mov_b32 v8, 0
    v_mov_b32 v9, 0
    v_mov_b32 v10, 0
    v_mov_b32 v11, 0
    v_mov_b32 v12, 0
    v_mov_b32 v13, 0
    v_mov_b32 v14, 0
    v_mov_b32 v15, 0
    v_lshlrev_b32 v2, 4, v1
    v_and_b32 v3, 8, v1
    v_cmp_eq_u32 vcc, 0, v3
    v_mov_b32 v3, 0xeeeeeeee
    v_mov_b32 v4, 0x44444444
    v_cndmask_b32 v3, v3, v4, vcc
    v_and_b32 v100, 15, v1
    v_lshrrev_b32 v101, 4, v1
    v_and_b32 v102, 1, v101
    v_lshrrev_b32 v103, 1, v101
    v_lshlrev_b32 v104, 2, v102
    v_lshl_add_u32 v104, v103, 1, v104
    v_and_b32 v105, 1, v1
    v_add_u32 v104, v104, v105
    v_and_b32 v106, 7, v1
    v_bfe_u32 v107, v1, 3, 1
    s_lshr_b32 s42, s41, 2
    s_and_b32 s43, s41, 3
    s_lshl_b32 s49, s40, 2
    s_add_u32 s49, s49, s42
    s_lshl_b32 s45, s44, 14
    v_lshlrev_b32 v20, 3, v101
    v_bfe_u32 v21, v1, 2, 2
    v_add_u32 v20, v20, v21
    v_lshlrev_b32 v20, 5, v20
    v_and_b32 v21, 3, v1
    v_lshl_add_u32 v20, v21, 3, v20
    v_add_u32 v20, s45, v20
    v_lshrrev_b32 v22, 1, v1
    v_lshlrev_b32 v23, 4, v105
    v_lshl_add_u32 v24, v22, 13, v23
    v_lshl_add_u32 v25, v22, 11, v23
    s_cmp_ge_u32 s44, 4
    s_cbranch_scc1 L_v_init_80
    s_lshr_b32 s50, s44, 1
    s_and_b32 s51, s44, 1
    s_lshl_b32 s46, s50, 3
    s_add_u32 s46, s46, 16
    s_load_dwordx2 s[6:7], s[0:1], s46
    s_lshl_b32 s46, s49, 8
    s_lshl_b32 s48, s43, 6
    s_add_u32 s46, s46, s48
    s_lshl_b32 s48, s51, 5
    s_add_u32 s46, s46, s48
    s_waitcnt lgkmcnt(0)
    s_mov_b32 s24, s6
    s_and_b32 s25, s7, 0xffff
    s_mov_b32 s26, 0x800000
    s_mov_b32 s27, 0x00020000
    s_lshl_b32 s52, s40, 16
    s_lshl_b32 s53, s42, 12
    s_add_u32 s52, s52, s53
    s_lshl_b32 s53, s43, 10
    s_add_u32 s52, s52, s53
    s_lshl_b32 s53, s51, 9
    s_add_u32 s52, s52, s53
    s_lshl_b32 s53, s50, 7
    s_add_u32 s52, s52, s53
    s_add_u32 s52, s52, 0x7080000
    v_lshlrev_b32 v4, 8, v107
    v_lshl_add_u32 v4, v104, 4, v4
    v_lshrrev_b32 v5, 1, v106
    v_lshl_add_u32 v4, v5, 2, v4
    v_add_u32 v4, s52, v4
    v_mov_b32 v13, -1
    s_mov_b32 s53, 0
    buffer_store_dword v13, v4, s[12:15], s53 offen sc1
    s_mov_b32 s53, 16384
    buffer_store_dword v13, v4, s[12:15], s53 offen sc1
    s_mov_b32 s53, 32768
    buffer_store_dword v13, v4, s[12:15], s53 offen sc1
    s_mov_b32 s53, 49152
    buffer_store_dword v13, v4, s[12:15], s53 offen sc1
    s_xor_b32 s52, s50, 1
    s_lshl_b32 s52, s52, 10
    s_lshl_b32 s53, s51, 8
    s_add_u32 s52, s52, s53
    s_add_u32 s52, s52, 27648
    v_lshrrev_b32 v5, 1, v106
    v_lshlrev_b32 v5, 2, v5
    v_lshl_add_u32 v5, v104, 4, v5
    v_lshl_add_u32 v5, v107, 7, v5
    v_add_u32 v5, s52, v5
    s_lshl_b32 s67, s49, 12
    s_lshl_b32 s53, s43, 10
    s_add_u32 s67, s67, s53
    s_add_u32 s67, s67, 0x1000000
    s_lshl_b32 s52, s40, 2
    s_add_u32 s52, s52, s44
    s_mul_i32 s52, s52, 24576
    s_add_u32 s52, s52, 0x2002000
    v_add_u32 v6, s52, v2
    s_lshl_b32 s52, s40, 16
    s_lshl_b32 s53, s44, 12
    s_add_u32 s52, s52, s53
    s_add_u32 s52, s52, 0x7080000
    v_add_u32 v7, s52, v2
    s_lshl_b32 s52, s44, 10
    s_add_u32 s52, s52, 16384
    v_lshlrev_b32 v8, 8, v101
    v_lshl_add_u32 v8, v106, 4, v8
    v_lshl_add_u32 v8, v107, 3, v8
    v_add_u32 v8, s52, v8
    s_lshl_b32 s52, s44, 8
    s_add_u32 s52, s52, 20480
    v_xor_b32 v9, 1, v103
    v_lshlrev_b32 v9, 7, v9
    v_lshl_add_u32 v9, v106, 4, v9
    v_lshl_add_u32 v9, v102, 3, v9
    v_lshl_add_u32 v9, v107, 2, v9
    v_add_u32 v9, s52, v9
    v_cmp_gt_u32 vcc, 32, v1
    v_mov_b32 v28, 0
    v_mov_b32 v29, 0xff800000
    v_cndmask_b32 v28, v28, v29, vcc
    v_mov_b32 v29, v28
    v_mov_b32 v30, v28
    v_mov_b32 v31, v28
    s_mov_b32 s66, 0x3e0293ee
    s_add_u32 m0, s45, 0
    s_add_u32 s48, s46, 0x0
    buffer_load_dwordx4 v24, s[24:27], s48 offen lds
    s_add_u32 m0, s45, 1024
    s_add_u32 s48, s46, 0x40000
    buffer_load_dwordx4 v24, s[24:27], s48 offen lds
    s_add_u32 m0, s45, 2048
    s_add_u32 s48, s46, 0x80000
    buffer_load_dwordx4 v24, s[24:27], s48 offen lds
    s_add_u32 m0, s45, 3072
    s_add_u32 s48, s46, 0xc0000
    buffer_load_dwordx4 v24, s[24:27], s48 offen lds
    s_add_u32 m0, s45, 4096
    s_add_u32 s48, s46, 0x100000
    buffer_load_dwordx4 v24, s[24:27], s48 offen lds
    s_add_u32 m0, s45, 5120
    s_add_u32 s48, s46, 0x140000
    buffer_load_dwordx4 v24, s[24:27], s48 offen lds
    s_add_u32 m0, s45, 6144
    s_add_u32 s48, s46, 0x180000
    buffer_load_dwordx4 v24, s[24:27], s48 offen lds
    s_add_u32 m0, s45, 7168
    s_add_u32 s48, s46, 0x1c0000
    buffer_load_dwordx4 v24, s[24:27], s48 offen lds
    s_add_u32 m0, s45, 8192
    s_add_u32 s48, s46, 0x200000
    buffer_load_dwordx4 v24, s[24:27], s48 offen lds
    s_add_u32 m0, s45, 9216
    s_add_u32 s48, s46, 0x240000
    buffer_load_dwordx4 v24, s[24:27], s48 offen lds
    s_add_u32 m0, s45, 10240
    s_add_u32 s48, s46, 0x280000
    buffer_load_dwordx4 v24, s[24:27], s48 offen lds
    s_add_u32 m0, s45, 11264
    s_add_u32 s48, s46, 0x2c0000
    buffer_load_dwordx4 v24, s[24:27], s48 offen lds
    s_add_u32 m0, s45, 12288
    s_add_u32 s48, s46, 0x300000
    buffer_load_dwordx4 v24, s[24:27], s48 offen lds
    s_add_u32 m0, s45, 13312
    s_add_u32 s48, s46, 0x340000
    buffer_load_dwordx4 v24, s[24:27], s48 offen lds
    s_add_u32 m0, s45, 14336
    s_add_u32 s48, s46, 0x380000
    buffer_load_dwordx4 v24, s[24:27], s48 offen lds
    s_add_u32 m0, s45, 15360
    s_add_u32 s48, s46, 0x3c0000
    buffer_load_dwordx4 v24, s[24:27], s48 offen lds
    s_waitcnt vmcnt(0)
    ds_read_b64_tr_b16 a[0:1], v20 offset:0
    ds_read_b64_tr_b16 a[2:3], v20 offset:128
    ds_read_b64_tr_b16 a[4:5], v20 offset:1024
    ds_read_b64_tr_b16 a[6:7], v20 offset:1152
    ds_read_b64_tr_b16 a[8:9], v20 offset:2048
    ds_read_b64_tr_b16 a[10:11], v20 offset:2176
    ds_read_b64_tr_b16 a[12:13], v20 offset:3072
    ds_read_b64_tr_b16 a[14:15], v20 offset:3200
    s_waitcnt lgkmcnt(0)
    ds_read_b64_tr_b16 a[16:17], v20 offset:4096
    ds_read_b64_tr_b16 a[18:19], v20 offset:4224
    ds_read_b64_tr_b16 a[20:21], v20 offset:5120
    ds_read_b64_tr_b16 a[22:23], v20 offset:5248
    ds_read_b64_tr_b16 a[24:25], v20 offset:6144
    ds_read_b64_tr_b16 a[26:27], v20 offset:6272
    ds_read_b64_tr_b16 a[28:29], v20 offset:7168
    ds_read_b64_tr_b16 a[30:31], v20 offset:7296
    s_waitcnt lgkmcnt(0)
    ds_read_b64_tr_b16 a[32:33], v20 offset:8192
    ds_read_b64_tr_b16 a[34:35], v20 offset:8320
    ds_read_b64_tr_b16 a[36:37], v20 offset:9216
    ds_read_b64_tr_b16 a[38:39], v20 offset:9344
    ds_read_b64_tr_b16 a[40:41], v20 offset:10240
    ds_read_b64_tr_b16 a[42:43], v20 offset:10368
    ds_read_b64_tr_b16 a[44:45], v20 offset:11264
    ds_read_b64_tr_b16 a[46:47], v20 offset:11392
    s_waitcnt lgkmcnt(0)
    ds_read_b64_tr_b16 a[48:49], v20 offset:12288
    ds_read_b64_tr_b16 a[50:51], v20 offset:12416
    ds_read_b64_tr_b16 a[52:53], v20 offset:13312
    ds_read_b64_tr_b16 a[54:55], v20 offset:13440
    ds_read_b64_tr_b16 a[56:57], v20 offset:14336
    ds_read_b64_tr_b16 a[58:59], v20 offset:14464
    ds_read_b64_tr_b16 a[60:61], v20 offset:15360
    ds_read_b64_tr_b16 a[62:63], v20 offset:15488
    s_waitcnt lgkmcnt(0)
    s_add_u32 m0, s45, 0
    s_add_u32 s48, s46, 0x400000
    buffer_load_dwordx4 v24, s[24:27], s48 offen lds
    s_add_u32 m0, s45, 1024
    s_add_u32 s48, s46, 0x440000
    buffer_load_dwordx4 v24, s[24:27], s48 offen lds
    s_add_u32 m0, s45, 2048
    s_add_u32 s48, s46, 0x480000
    buffer_load_dwordx4 v24, s[24:27], s48 offen lds
    s_add_u32 m0, s45, 3072
    s_add_u32 s48, s46, 0x4c0000
    buffer_load_dwordx4 v24, s[24:27], s48 offen lds
    s_add_u32 m0, s45, 4096
    s_add_u32 s48, s46, 0x500000
    buffer_load_dwordx4 v24, s[24:27], s48 offen lds
    s_add_u32 m0, s45, 5120
    s_add_u32 s48, s46, 0x540000
    buffer_load_dwordx4 v24, s[24:27], s48 offen lds
    s_add_u32 m0, s45, 6144
    s_add_u32 s48, s46, 0x580000
    buffer_load_dwordx4 v24, s[24:27], s48 offen lds
    s_add_u32 m0, s45, 7168
    s_add_u32 s48, s46, 0x5c0000
    buffer_load_dwordx4 v24, s[24:27], s48 offen lds
    s_add_u32 m0, s45, 8192
    s_add_u32 s48, s46, 0x600000
    buffer_load_dwordx4 v24, s[24:27], s48 offen lds
    s_add_u32 m0, s45, 9216
    s_add_u32 s48, s46, 0x640000
    buffer_load_dwordx4 v24, s[24:27], s48 offen lds
    s_add_u32 m0, s45, 10240
    s_add_u32 s48, s46, 0x680000
    buffer_load_dwordx4 v24, s[24:27], s48 offen lds
    s_add_u32 m0, s45, 11264
    s_add_u32 s48, s46, 0x6c0000
    buffer_load_dwordx4 v24, s[24:27], s48 offen lds
    s_add_u32 m0, s45, 12288
    s_add_u32 s48, s46, 0x700000
    buffer_load_dwordx4 v24, s[24:27], s48 offen lds
    s_add_u32 m0, s45, 13312
    s_add_u32 s48, s46, 0x740000
    buffer_load_dwordx4 v24, s[24:27], s48 offen lds
    s_add_u32 m0, s45, 14336
    s_add_u32 s48, s46, 0x780000
    buffer_load_dwordx4 v24, s[24:27], s48 offen lds
    s_add_u32 m0, s45, 15360
    s_add_u32 s48, s46, 0x7c0000
    buffer_load_dwordx4 v24, s[24:27], s48 offen lds
    s_waitcnt vmcnt(0)
    ds_read_b64_tr_b16 a[64:65], v20 offset:0
    ds_read_b64_tr_b16 a[66:67], v20 offset:128
    ds_read_b64_tr_b16 a[68:69], v20 offset:1024
    ds_read_b64_tr_b16 a[70:71], v20 offset:1152
    ds_read_b64_tr_b16 a[72:73], v20 offset:2048
    ds_read_b64_tr_b16 a[74:75], v20 offset:2176
    ds_read_b64_tr_b16 a[76:77], v20 offset:3072
    ds_read_b64_tr_b16 a[78:79], v20 offset:3200
    s_waitcnt lgkmcnt(0)
    ds_read_b64_tr_b16 a[80:81], v20 offset:4096
    ds_read_b64_tr_b16 a[82:83], v20 offset:4224
    ds_read_b64_tr_b16 a[84:85], v20 offset:5120
    ds_read_b64_tr_b16 a[86:87], v20 offset:5248
    ds_read_b64_tr_b16 a[88:89], v20 offset:6144
    ds_read_b64_tr_b16 a[90:91], v20 offset:6272
    ds_read_b64_tr_b16 a[92:93], v20 offset:7168
    ds_read_b64_tr_b16 a[94:95], v20 offset:7296
    s_waitcnt lgkmcnt(0)
    ds_read_b64_tr_b16 a[96:97], v20 offset:8192
    ds_read_b64_tr_b16 a[98:99], v20 offset:8320
    ds_read_b64_tr_b16 a[100:101], v20 offset:9216
    ds_read_b64_tr_b16 a[102:103], v20 offset:9344
    ds_read_b64_tr_b16 a[104:105], v20 offset:10240
    ds_read_b64_tr_b16 a[106:107], v20 offset:10368
    ds_read_b64_tr_b16 a[108:109], v20 offset:11264
    ds_read_b64_tr_b16 a[110:111], v20 offset:11392
    s_waitcnt lgkmcnt(0)
    ds_read_b64_tr_b16 a[112:113], v20 offset:12288
    ds_read_b64_tr_b16 a[114:115], v20 offset:12416
    ds_read_b64_tr_b16 a[116:117], v20 offset:13312
    ds_read_b64_tr_b16 a[118:119], v20 offset:13440
    ds_read_b64_tr_b16 a[120:121], v20 offset:14336
    ds_read_b64_tr_b16 a[122:123], v20 offset:14464
    ds_read_b64_tr_b16 a[124:125], v20 offset:15360
    ds_read_b64_tr_b16 a[126:127], v20 offset:15488
    s_waitcnt lgkmcnt(0)
    s_mov_b32 s63, 0
    s_add_u32 s46, s63, 4096
    buffer_load_dwordx4 v[32:35], v6, s[12:15], s63 offen offset:0
    buffer_load_dwordx4 v[36:39], v6, s[12:15], s63 offen offset:1024
    buffer_load_dwordx4 v[40:43], v6, s[12:15], s63 offen offset:2048
    buffer_load_dwordx4 v[44:47], v6, s[12:15], s63 offen offset:3072
    buffer_load_dwordx4 v[48:51], v6, s[12:15], s46 offen offset:0
    buffer_load_dwordx4 v[52:55], v6, s[12:15], s46 offen offset:1024
    buffer_load_dwordx4 v[56:59], v6, s[12:15], s46 offen offset:2048
    buffer_load_dwordx4 v[60:63], v6, s[12:15], s46 offen offset:3072
    s_waitcnt vmcnt(0)
    s_barrier
    s_setprio 1
    s_branch L_c_join_81
L_v_init_80:
    s_sub_u32 s54, s44, 4
    s_lshr_b32 s51, s54, 1
    s_and_b32 s50, s54, 1
    s_load_dwordx4 s[4:7], s[0:1], 32
    s_load_dwordx2 s[8:9], s[0:1], 8
    s_waitcnt lgkmcnt(0)
    s_mov_b32 s24, s4
    s_and_b32 s25, s5, 0xffff
    s_mov_b32 s26, 0x800000
    s_mov_b32 s27, 0x00020000
    s_mov_b32 s28, s6
    s_and_b32 s29, s7, 0xffff
    s_mov_b32 s30, 0x800000
    s_mov_b32 s31, 0x00020000
    s_mov_b32 s32, s8
    s_and_b32 s33, s9, 0xffff
    s_mov_b32 s34, 0x4000
    s_mov_b32 s35, 0x00020000
    s_lshl_b32 s52, s40, 15
    s_lshl_b32 s53, s42, 11
    s_add_u32 s52, s52, s53
    s_lshl_b32 s53, s43, 9
    s_add_u32 s52, s52, s53
    s_lshl_b32 s53, s51, 8
    s_add_u32 s52, s52, s53
    s_add_u32 s52, s52, 0x7100000
    v_bfe_u32 v4, v1, 1, 1
    v_lshlrev_b32 v4, 7, v4
    v_lshl_add_u32 v4, v104, 4, v4
    v_and_b32 v5, 12, v100
    v_add_u32 v4, v4, v5
    v_add_u32 v4, s52, v4
    v_mov_b32 v26, -1
    s_mov_b32 s53, 0
    buffer_store_dword v26, v4, s[12:15], s53 offen sc1
    s_mov_b32 s53, 8192
    buffer_store_dword v26, v4, s[12:15], s53 offen sc1
    s_mov_b32 s53, 16384
    buffer_store_dword v26, v4, s[12:15], s53 offen sc1
    s_mov_b32 s53, 24576
    buffer_store_dword v26, v4, s[12:15], s53 offen sc1
    s_lshl_b32 s52, s51, 5
    s_add_u32 s52, s52, 28160
    v_and_b32 v5, 14, v100
    v_lshlrev_b32 v5, 1, v5
    v_lshl_add_u32 v5, v104, 6, v5
    v_add_u32 v5, s52, v5
    s_lshl_b32 s52, s41, 14
    s_lshl_b32 s53, s54, 12
    s_add_u32 s52, s52, s53
    s_add_u32 s52, s52, 0x7800000
    v_lshlrev_b32 v6, 7, v101
    v_lshl_add_u32 v6, v106, 4, v6
    v_lshl_add_u32 v7, v107, 11, v6
    v_add_u32 v7, s52, v7
    s_lshl_b32 s53, s40, 9
    s_add_u32 s52, s52, s53
    v_add_u32 v6, s52, v6
    v_and_b32 v30, 31, v1
    v_lshlrev_b32 v30, 4, v30
    v_lshl_add_u32 v30, v103, 18, v30
    v_add_u32 v30, s52, v30
    v_mov_b32 v32, -1
    v_mov_b32 v33, -1
    v_mov_b32 v34, -1
    v_mov_b32 v35, -1
    s_mov_b32 s53, 0
    buffer_store_dwordx4 v[32:35], v30, s[12:15], s53 offen sc1
    s_mov_b32 s53, 524288
    buffer_store_dwordx4 v[32:35], v30, s[12:15], s53 offen sc1
    s_mov_b32 s53, 1048576
    buffer_store_dwordx4 v[32:35], v30, s[12:15], s53 offen sc1
    s_mov_b32 s53, 1572864
    buffer_store_dwordx4 v[32:35], v30, s[12:15], s53 offen sc1
    s_mov_b32 s53, 2097152
    buffer_store_dwordx4 v[32:35], v30, s[12:15], s53 offen sc1
    s_mov_b32 s53, 2621440
    buffer_store_dwordx4 v[32:35], v30, s[12:15], s53 offen sc1
    s_mov_b32 s53, 3145728
    buffer_store_dwordx4 v[32:35], v30, s[12:15], s53 offen sc1
    s_mov_b32 s53, 3670016
    buffer_store_dwordx4 v[32:35], v30, s[12:15], s53 offen sc1
    s_mov_b32 s53, 4194304
    buffer_store_dwordx4 v[32:35], v30, s[12:15], s53 offen sc1
    s_mov_b32 s53, 4718592
    buffer_store_dwordx4 v[32:35], v30, s[12:15], s53 offen sc1
    s_mov_b32 s53, 5242880
    buffer_store_dwordx4 v[32:35], v30, s[12:15], s53 offen sc1
    s_mov_b32 s53, 5767168
    buffer_store_dwordx4 v[32:35], v30, s[12:15], s53 offen sc1
    s_mov_b32 s53, 6291456
    buffer_store_dwordx4 v[32:35], v30, s[12:15], s53 offen sc1
    s_mov_b32 s53, 6815744
    buffer_store_dwordx4 v[32:35], v30, s[12:15], s53 offen sc1
    s_mov_b32 s53, 7340032
    buffer_store_dwordx4 v[32:35], v30, s[12:15], s53 offen sc1
    s_mov_b32 s53, 7864320
    buffer_store_dwordx4 v[32:35], v30, s[12:15], s53 offen sc1
    s_mov_b32 s53, 8388608
    buffer_store_dwordx4 v[32:35], v30, s[12:15], s53 offen sc1
    s_mov_b32 s53, 8912896
    buffer_store_dwordx4 v[32:35], v30, s[12:15], s53 offen sc1
    s_mov_b32 s53, 9437184
    buffer_store_dwordx4 v[32:35], v30, s[12:15], s53 offen sc1
    s_mov_b32 s53, 9961472
    buffer_store_dwordx4 v[32:35], v30, s[12:15], s53 offen sc1
    s_mov_b32 s53, 10485760
    buffer_store_dwordx4 v[32:35], v30, s[12:15], s53 offen sc1
    s_mov_b32 s53, 11010048
    buffer_store_dwordx4 v[32:35], v30, s[12:15], s53 offen sc1
    s_mov_b32 s53, 11534336
    buffer_store_dwordx4 v[32:35], v30, s[12:15], s53 offen sc1
    s_mov_b32 s53, 12058624
    buffer_store_dwordx4 v[32:35], v30, s[12:15], s53 offen sc1
    s_mov_b32 s53, 12582912
    buffer_store_dwordx4 v[32:35], v30, s[12:15], s53 offen sc1
    s_mov_b32 s53, 13107200
    buffer_store_dwordx4 v[32:35], v30, s[12:15], s53 offen sc1
    s_mov_b32 s53, 13631488
    buffer_store_dwordx4 v[32:35], v30, s[12:15], s53 offen sc1
    s_mov_b32 s53, 14155776
    buffer_store_dwordx4 v[32:35], v30, s[12:15], s53 offen sc1
    s_mov_b32 s53, 14680064
    buffer_store_dwordx4 v[32:35], v30, s[12:15], s53 offen sc1
    s_mov_b32 s53, 15204352
    buffer_store_dwordx4 v[32:35], v30, s[12:15], s53 offen sc1
    s_mov_b32 s53, 15728640
    buffer_store_dwordx4 v[32:35], v30, s[12:15], s53 offen sc1
    s_mov_b32 s53, 16252928
    buffer_store_dwordx4 v[32:35], v30, s[12:15], s53 offen sc1
    s_lshl_b32 s55, s40, 16
    s_add_u32 s55, s55, 0x7000000
    s_lshl_b32 s52, s41, 10
    s_lshl_b32 s53, s54, 8
    s_add_u32 s52, s52, s53
    s_add_u32 s52, s52, s55
    v_lshlrev_b32 v8, 4, v100
    v_lshl_add_u32 v8, v101, 2, v8
    v_add_u32 v8, s52, v8
    s_lshl_b32 s53, s54, 12
    v_add_u32 v10, s53, v2
    v_add_u32 v9, s55, v10
    s_lshl_b32 s52, s40, 15
    s_lshl_b32 s53, s54, 11
    s_add_u32 s52, s52, s53
    s_add_u32 s52, s52, 0x7100000
    v_add_u32 v11, s52, v2
    s_lshl_b32 s52, s54, 8
    s_add_u32 s52, s52, 21504
    v_lshlrev_b32 v12, 4, v100
    v_lshl_add_u32 v12, v102, 3, v12
    v_lshl_add_u32 v12, v103, 2, v12
    v_add_u32 v12, s52, v12
    s_lshl_b32 s52, s50, 13
    s_add_u32 s52, s52, 0
    v_add_u32 v13, s52, v2
    s_lshl_b32 s52, s51, 9
    s_add_u32 s52, s52, 25600
    v_lshlrev_b32 v14, 3, v1
    v_add_u32 v14, s52, v14
    s_lshl_b32 s52, s40, 2
    s_add_u32 s52, s52, s54
    s_mul_i32 s52, s52, 24576
    s_add_u32 s52, s52, 0x2004000
    v_add_u32 v15, s52, v2
    s_lshl_b32 s52, s54, 10
    v_add_u32 v27, s52, v2
    v_lshlrev_b32 v30, 11, v106
    v_lshl_add_u32 v30, v101, 3, v30
    v_lshl_add_u32 v30, v107, 2, v30
    s_lshl_b32 s52, s41, 7
    s_lshl_b32 s53, s54, 5
    s_add_u32 s52, s52, s53
    buffer_load_dword v31, v30, s[32:35], s52 offen
    s_waitcnt vmcnt(0)
    v_min_u32 v31, -2, v31
    buffer_store_dword v31, v8, s[12:15], 0 offen sc1
    s_mov_b32 s53, 16384
    buffer_store_dword v26, v8, s[12:15], s53 offen sc1
    s_mov_b32 s53, 32768
    buffer_store_dword v26, v8, s[12:15], s53 offen sc1
    s_mov_b32 s53, 49152
    buffer_store_dword v26, v8, s[12:15], s53 offen sc1
    s_lshl_b32 s46, s49, 8
    s_lshl_b32 s48, s43, 6
    s_add_u32 s46, s46, s48
    s_lshl_b32 s48, s51, 5
    s_add_u32 s46, s46, s48
    s_lshl_b32 s48, s50, 22
    s_add_u32 s46, s46, s48
    s_add_u32 m0, s45, 0
    s_add_u32 s48, s46, 0x0
    buffer_load_dwordx4 v24, s[24:27], s48 offen lds
    s_add_u32 m0, s45, 1024
    s_add_u32 s48, s46, 0x40000
    buffer_load_dwordx4 v24, s[24:27], s48 offen lds
    s_add_u32 m0, s45, 2048
    s_add_u32 s48, s46, 0x80000
    buffer_load_dwordx4 v24, s[24:27], s48 offen lds
    s_add_u32 m0, s45, 3072
    s_add_u32 s48, s46, 0xc0000
    buffer_load_dwordx4 v24, s[24:27], s48 offen lds
    s_add_u32 m0, s45, 4096
    s_add_u32 s48, s46, 0x100000
    buffer_load_dwordx4 v24, s[24:27], s48 offen lds
    s_add_u32 m0, s45, 5120
    s_add_u32 s48, s46, 0x140000
    buffer_load_dwordx4 v24, s[24:27], s48 offen lds
    s_add_u32 m0, s45, 6144
    s_add_u32 s48, s46, 0x180000
    buffer_load_dwordx4 v24, s[24:27], s48 offen lds
    s_add_u32 m0, s45, 7168
    s_add_u32 s48, s46, 0x1c0000
    buffer_load_dwordx4 v24, s[24:27], s48 offen lds
    s_add_u32 m0, s45, 8192
    s_add_u32 s48, s46, 0x200000
    buffer_load_dwordx4 v24, s[24:27], s48 offen lds
    s_add_u32 m0, s45, 9216
    s_add_u32 s48, s46, 0x240000
    buffer_load_dwordx4 v24, s[24:27], s48 offen lds
    s_add_u32 m0, s45, 10240
    s_add_u32 s48, s46, 0x280000
    buffer_load_dwordx4 v24, s[24:27], s48 offen lds
    s_add_u32 m0, s45, 11264
    s_add_u32 s48, s46, 0x2c0000
    buffer_load_dwordx4 v24, s[24:27], s48 offen lds
    s_add_u32 m0, s45, 12288
    s_add_u32 s48, s46, 0x300000
    buffer_load_dwordx4 v24, s[24:27], s48 offen lds
    s_add_u32 m0, s45, 13312
    s_add_u32 s48, s46, 0x340000
    buffer_load_dwordx4 v24, s[24:27], s48 offen lds
    s_add_u32 m0, s45, 14336
    s_add_u32 s48, s46, 0x380000
    buffer_load_dwordx4 v24, s[24:27], s48 offen lds
    s_add_u32 m0, s45, 15360
    s_add_u32 s48, s46, 0x3c0000
    buffer_load_dwordx4 v24, s[24:27], s48 offen lds
    s_waitcnt vmcnt(0)
    ds_read_b64_tr_b16 a[0:1], v20 offset:0
    ds_read_b64_tr_b16 a[2:3], v20 offset:128
    ds_read_b64_tr_b16 a[4:5], v20 offset:1024
    ds_read_b64_tr_b16 a[6:7], v20 offset:1152
    ds_read_b64_tr_b16 a[8:9], v20 offset:2048
    ds_read_b64_tr_b16 a[10:11], v20 offset:2176
    ds_read_b64_tr_b16 a[12:13], v20 offset:3072
    ds_read_b64_tr_b16 a[14:15], v20 offset:3200
    s_waitcnt lgkmcnt(0)
    ds_read_b64_tr_b16 a[16:17], v20 offset:4096
    ds_read_b64_tr_b16 a[18:19], v20 offset:4224
    ds_read_b64_tr_b16 a[20:21], v20 offset:5120
    ds_read_b64_tr_b16 a[22:23], v20 offset:5248
    ds_read_b64_tr_b16 a[24:25], v20 offset:6144
    ds_read_b64_tr_b16 a[26:27], v20 offset:6272
    ds_read_b64_tr_b16 a[28:29], v20 offset:7168
    ds_read_b64_tr_b16 a[30:31], v20 offset:7296
    s_waitcnt lgkmcnt(0)
    ds_read_b64_tr_b16 a[32:33], v20 offset:8192
    ds_read_b64_tr_b16 a[34:35], v20 offset:8320
    ds_read_b64_tr_b16 a[36:37], v20 offset:9216
    ds_read_b64_tr_b16 a[38:39], v20 offset:9344
    ds_read_b64_tr_b16 a[40:41], v20 offset:10240
    ds_read_b64_tr_b16 a[42:43], v20 offset:10368
    ds_read_b64_tr_b16 a[44:45], v20 offset:11264
    ds_read_b64_tr_b16 a[46:47], v20 offset:11392
    s_waitcnt lgkmcnt(0)
    ds_read_b64_tr_b16 a[48:49], v20 offset:12288
    ds_read_b64_tr_b16 a[50:51], v20 offset:12416
    ds_read_b64_tr_b16 a[52:53], v20 offset:13312
    ds_read_b64_tr_b16 a[54:55], v20 offset:13440
    ds_read_b64_tr_b16 a[56:57], v20 offset:14336
    ds_read_b64_tr_b16 a[58:59], v20 offset:14464
    ds_read_b64_tr_b16 a[60:61], v20 offset:15360
    ds_read_b64_tr_b16 a[62:63], v20 offset:15488
    s_waitcnt lgkmcnt(0)
    s_lshl_b32 s46, s40, 2
    s_add_u32 s46, s46, s54
    s_lshl_b32 s46, s46, 18
    s_lshl_b32 s48, s41, 7
    s_add_u32 s46, s46, s48
    s_add_u32 m0, s45, 0
    s_add_u32 s48, s46, 0x0
    buffer_load_dwordx4 v25, s[28:31], s48 offen lds
    s_add_u32 m0, s45, 1024
    s_add_u32 s48, s46, 0x10000
    buffer_load_dwordx4 v25, s[28:31], s48 offen lds
    s_add_u32 m0, s45, 2048
    s_add_u32 s48, s46, 0x20000
    buffer_load_dwordx4 v25, s[28:31], s48 offen lds
    s_add_u32 m0, s45, 3072
    s_add_u32 s48, s46, 0x30000
    buffer_load_dwordx4 v25, s[28:31], s48 offen lds
    s_add_u32 m0, s45, 4096
    s_add_u32 s48, s46, 0x20
    buffer_load_dwordx4 v25, s[28:31], s48 offen lds
    s_add_u32 m0, s45, 5120
    s_add_u32 s48, s46, 0x10020
    buffer_load_dwordx4 v25, s[28:31], s48 offen lds
    s_add_u32 m0, s45, 6144
    s_add_u32 s48, s46, 0x20020
    buffer_load_dwordx4 v25, s[28:31], s48 offen lds
    s_add_u32 m0, s45, 7168
    s_add_u32 s48, s46, 0x30020
    buffer_load_dwordx4 v25, s[28:31], s48 offen lds
    s_add_u32 m0, s45, 8192
    s_add_u32 s48, s46, 0x40
    buffer_load_dwordx4 v25, s[28:31], s48 offen lds
    s_add_u32 m0, s45, 9216
    s_add_u32 s48, s46, 0x10040
    buffer_load_dwordx4 v25, s[28:31], s48 offen lds
    s_add_u32 m0, s45, 10240
    s_add_u32 s48, s46, 0x20040
    buffer_load_dwordx4 v25, s[28:31], s48 offen lds
    s_add_u32 m0, s45, 11264
    s_add_u32 s48, s46, 0x30040
    buffer_load_dwordx4 v25, s[28:31], s48 offen lds
    s_add_u32 m0, s45, 12288
    s_add_u32 s48, s46, 0x60
    buffer_load_dwordx4 v25, s[28:31], s48 offen lds
    s_add_u32 m0, s45, 13312
    s_add_u32 s48, s46, 0x10060
    buffer_load_dwordx4 v25, s[28:31], s48 offen lds
    s_add_u32 m0, s45, 14336
    s_add_u32 s48, s46, 0x20060
    buffer_load_dwordx4 v25, s[28:31], s48 offen lds
    s_add_u32 m0, s45, 15360
    s_add_u32 s48, s46, 0x30060
    buffer_load_dwordx4 v25, s[28:31], s48 offen lds
    s_waitcnt vmcnt(0)
    ds_read_b64_tr_b16 a[64:65], v20 offset:0
    ds_read_b64_tr_b16 a[66:67], v20 offset:128
    ds_read_b64_tr_b16 a[68:69], v20 offset:1024
    ds_read_b64_tr_b16 a[70:71], v20 offset:1152
    ds_read_b64_tr_b16 a[72:73], v20 offset:2048
    ds_read_b64_tr_b16 a[74:75], v20 offset:2176
    ds_read_b64_tr_b16 a[76:77], v20 offset:3072
    ds_read_b64_tr_b16 a[78:79], v20 offset:3200
    s_waitcnt lgkmcnt(0)
    ds_read_b64_tr_b16 a[80:81], v20 offset:4096
    ds_read_b64_tr_b16 a[82:83], v20 offset:4224
    ds_read_b64_tr_b16 a[84:85], v20 offset:5120
    ds_read_b64_tr_b16 a[86:87], v20 offset:5248
    ds_read_b64_tr_b16 a[88:89], v20 offset:6144
    ds_read_b64_tr_b16 a[90:91], v20 offset:6272
    ds_read_b64_tr_b16 a[92:93], v20 offset:7168
    ds_read_b64_tr_b16 a[94:95], v20 offset:7296
    s_waitcnt lgkmcnt(0)
    ds_read_b64_tr_b16 a[96:97], v20 offset:8192
    ds_read_b64_tr_b16 a[98:99], v20 offset:8320
    ds_read_b64_tr_b16 a[100:101], v20 offset:9216
    ds_read_b64_tr_b16 a[102:103], v20 offset:9344
    ds_read_b64_tr_b16 a[104:105], v20 offset:10240
    ds_read_b64_tr_b16 a[106:107], v20 offset:10368
    ds_read_b64_tr_b16 a[108:109], v20 offset:11264
    ds_read_b64_tr_b16 a[110:111], v20 offset:11392
    s_waitcnt lgkmcnt(0)
    ds_read_b64_tr_b16 a[112:113], v20 offset:12288
    ds_read_b64_tr_b16 a[114:115], v20 offset:12416
    ds_read_b64_tr_b16 a[116:117], v20 offset:13312
    ds_read_b64_tr_b16 a[118:119], v20 offset:13440
    ds_read_b64_tr_b16 a[120:121], v20 offset:14336
    ds_read_b64_tr_b16 a[122:123], v20 offset:14464
    ds_read_b64_tr_b16 a[124:125], v20 offset:15360
    ds_read_b64_tr_b16 a[126:127], v20 offset:15488
    s_waitcnt lgkmcnt(0)
    s_mov_b32 s65, 0
    s_add_u32 s46, s65, 4096
    buffer_load_dwordx4 v[32:35], v15, s[12:15], s65 offen offset:0
    buffer_load_dwordx4 v[48:51], v15, s[12:15], s46 offen offset:0
    buffer_load_dwordx4 v[36:39], v15, s[12:15], s65 offen offset:1024
    buffer_load_dwordx4 v[52:55], v15, s[12:15], s46 offen offset:1024
    buffer_load_dwordx4 v[40:43], v15, s[12:15], s65 offen offset:2048
    buffer_load_dwordx4 v[56:59], v15, s[12:15], s46 offen offset:2048
    buffer_load_dwordx4 v[44:47], v15, s[12:15], s65 offen offset:3072
    buffer_load_dwordx4 v[60:63], v15, s[12:15], s46 offen offset:3072
    s_add_u32 s65, s65, 786432
    s_waitcnt vmcnt(0)
    s_barrier
    s_waitcnt vmcnt(0)
    v_mfma_f32_16x16x32_bf16 v[64:67], v[32:35], a[64:67], 0
    v_mfma_f32_16x16x32_bf16 v[68:71], v[48:51], a[64:67], 0
    v_mfma_f32_16x16x32_bf16 v[64:67], v[36:39], a[68:71], v[64:67]
    v_mfma_f32_16x16x32_bf16 v[68:71], v[52:55], a[68:71], v[68:71]
    v_mfma_f32_16x16x32_bf16 v[64:67], v[40:43], a[72:75], v[64:67]
    v_mfma_f32_16x16x32_bf16 v[68:71], v[56:59], a[72:75], v[68:71]
    v_mfma_f32_16x16x32_bf16 v[64:67], v[44:47], a[76:79], v[64:67]
    v_mfma_f32_16x16x32_bf16 v[68:71], v[60:63], a[76:79], v[68:71]
    v_mfma_f32_16x16x32_bf16 v[72:75], v[32:35], a[80:83], 0
    v_mfma_f32_16x16x32_bf16 v[76:79], v[48:51], a[80:83], 0
    v_mfma_f32_16x16x32_bf16 v[72:75], v[36:39], a[84:87], v[72:75]
    v_mfma_f32_16x16x32_bf16 v[76:79], v[52:55], a[84:87], v[76:79]
    v_mfma_f32_16x16x32_bf16 v[72:75], v[40:43], a[88:91], v[72:75]
    v_mfma_f32_16x16x32_bf16 v[76:79], v[56:59], a[88:91], v[76:79]
    v_mfma_f32_16x16x32_bf16 v[72:75], v[44:47], a[92:95], v[72:75]
    v_mfma_f32_16x16x32_bf16 v[76:79], v[60:63], a[92:95], v[76:79]
    v_cvt_pk_bf16_f32 v64, v64, v65
    v_cvt_pk_bf16_f32 v65, v66, v67
    v_cvt_pk_bf16_f32 v66, v68, v69
    v_cvt_pk_bf16_f32 v67, v70, v71
    ds_write_b128 v10, v[64:67] offset:32768
    v_mfma_f32_16x16x32_bf16 v[80:83], v[32:35], a[96:99], 0
    v_mfma_f32_16x16x32_bf16 v[84:87], v[48:51], a[96:99], 0
    v_mfma_f32_16x16x32_bf16 v[80:83], v[36:39], a[100:103], v[80:83]
    v_mfma_f32_16x16x32_bf16 v[84:87], v[52:55], a[100:103], v[84:87]
    v_mfma_f32_16x16x32_bf16 v[80:83], v[40:43], a[104:107], v[80:83]
    v_mfma_f32_16x16x32_bf16 v[84:87], v[56:59], a[104:107], v[84:87]
    v_mfma_f32_16x16x32_bf16 v[80:83], v[44:47], a[108:111], v[80:83]
    v_mfma_f32_16x16x32_bf16 v[84:87], v[60:63], a[108:111], v[84:87]
    v_cvt_pk_bf16_f32 v72, v72, v73
    v_cvt_pk_bf16_f32 v73, v74, v75
    v_cvt_pk_bf16_f32 v74, v76, v77
    v_cvt_pk_bf16_f32 v75, v78, v79
    ds_write_b128 v10, v[72:75] offset:33792
    v_mfma_f32_16x16x32_bf16 v[88:91], v[32:35], a[112:115], 0
    v_mfma_f32_16x16x32_bf16 v[92:95], v[48:51], a[112:115], 0
    v_mfma_f32_16x16x32_bf16 v[88:91], v[36:39], a[116:119], v[88:91]
    v_mfma_f32_16x16x32_bf16 v[92:95], v[52:55], a[116:119], v[92:95]
    v_mfma_f32_16x16x32_bf16 v[88:91], v[40:43], a[120:123], v[88:91]
    v_mfma_f32_16x16x32_bf16 v[92:95], v[56:59], a[120:123], v[92:95]
    v_mfma_f32_16x16x32_bf16 v[88:91], v[44:47], a[124:127], v[88:91]
    v_mfma_f32_16x16x32_bf16 v[92:95], v[60:63], a[124:127], v[92:95]
    v_cvt_pk_bf16_f32 v80, v80, v81
    v_cvt_pk_bf16_f32 v81, v82, v83
    v_cvt_pk_bf16_f32 v82, v84, v85
    v_cvt_pk_bf16_f32 v83, v86, v87
    ds_write_b128 v10, v[80:83] offset:34816
    s_nop 2
    v_cvt_pk_bf16_f32 v88, v88, v89
    v_cvt_pk_bf16_f32 v89, v90, v91
    v_cvt_pk_bf16_f32 v90, v92, v93
    v_cvt_pk_bf16_f32 v91, v94, v95
    ds_write_b128 v10, v[88:91] offset:35840
    s_mov_b32 s63, 0
L_c_join_81:
    s_mov_b32 s60, 0
    s_mov_b32 s61, 0
    s_mov_b32 s62, 0
    s_cmp_lg_u32 s44, 0
    s_cbranch_scc1 L_c_nh_82
    s_or_b32 s47, s47, 0x100
    v_mov_b32 v16, s47
    s_lshl_b32 s45, s40, 6
    s_lshl_b32 s46, s41, 2
    s_add_u32 s45, s45, s46
    s_add_u32 s45, s45, 0x101000
    v_mov_b32 v17, 0
    s_mov_b64 exec, 1
    buffer_store_dword v16, v17, s[12:15], s45 offen sc1
    s_mov_b64 exec, -1
    v_lshlrev_b32 v17, 3, v1
    s_lshl_b32 s46, s40, 3
    v_mov_b32 v21, s46
    s_mov_b32 s45, 0x101000
    s_mov_b32 s70, 0
L_c_rp_83:
    s_sleep 8
    buffer_load_dwordx2 v[18:19], v17, s[12:15], s45 offen sc1
    buffer_load_dwordx2 v[22:23], v21, s[12:15], s45 offen offset:512 sc1
    s_waitcnt vmcnt(0)
    v_min3_u32 v20, v18, v19, v22
    v_min_u32 v20, v20, v23
    v_cmp_eq_u32 vcc, 0, v20
    s_add_u32 s70, s70, 1
    s_cbranch_vccz L_ok_84
    s_cmp_lt_u32 s70, 524288
    s_cbranch_scc1 L_c_rp_83
    s_branch L_c_done_7
L_ok_84:
    v_cmp_eq_u32 s[52:53], v18, v16
    v_cmp_eq_u32 vcc, v19, v16
    v_cmp_eq_u32 s[54:55], v22, v16
    v_cmp_eq_u32 s[56:57], v23, v16
    s_lshl_b32 s46, s40, 3
    s_nop 3
    s_and_b64 s[52:53], s[52:53], vcc
    s_and_b64 s[54:55], s[54:55], s[56:57]
    s_and_b64 s[52:53], s[52:53], s[54:55]
    s_lshr_b64 s[52:53], s[52:53], s46
    s_and_b32 s52, s52, 0xff
    s_cmp_eq_u32 s52, 0xff
    s_cselect_b32 s52, 1, 0
    v_mov_b32 v16, s52
    v_mov_b32 v17, 26624
    ds_write_b32 v17, v16
L_c_nh_82:
    s_waitcnt lgkmcnt(0)
    s_barrier
    v_mov_b32 v17, 26624
    ds_read_b32 v16, v17
    s_waitcnt lgkmcnt(0)
    v_readfirstlane_b32 s52, v16
    s_nop 3
    s_cmp_ge_u32 s44, 4
    s_cbranch_scc1 L_vf_87
    s_cmp_eq_u32 s52, 0
    s_cbranch_scc1 L_ss_86
L_s_loop_89:
    v_mov_b32 v16, 0
    v_mov_b32 v17, 0
    v_mov_b32 v18, 0
    v_mov_b32 v19, 0
    s_barrier
    ds_read_b128 v[64:67], v2 offset:0
    ds_read_b128 v[68:71], v2 offset:1024
    ds_read_b128 v[72:75], v2 offset:2048
    ds_read_b128 v[76:79], v2 offset:3072
    ds_read_b128 v[80:83], v2 offset:4096
    ds_read_b128 v[84:87], v2 offset:5120
    ds_read_b128 v[88:91], v2 offset:6144
    ds_read_b128 v[92:95], v2 offset:7168
    ds_read_b128 v[96:99], v2 offset:8192
    ds_read_b128 v[100:103], v2 offset:9216
    ds_read_b128 v[104:107], v2 offset:10240
    ds_read_b128 v[108:111], v2 offset:11264
    s_add_u32 s46, s63, 4096
    buffer_load_dwordx4 v[32:35], v6, s[12:15], s63 offen offset:0
    buffer_load_dwordx4 v[36:39], v6, s[12:15], s63 offen offset:1024
    buffer_load_dwordx4 v[40:43], v6, s[12:15], s63 offen offset:2048
    buffer_load_dwordx4 v[44:47], v6, s[12:15], s63 offen offset:3072
    buffer_load_dwordx4 v[48:51], v6, s[12:15], s46 offen offset:0
    buffer_load_dwordx4 v[52:55], v6, s[12:15], s46 offen offset:1024
    buffer_load_dwordx4 v[56:59], v6, s[12:15], s46 offen offset:2048
    buffer_load_dwordx4 v[60:63], v6, s[12:15], s46 offen offset:3072
    s_waitcnt lgkmcnt(11)
    v_smfmac_f32_16x16x64_bf16 v[16:19], v[64:67], a[0:7], v3
    ds_read_b128 v[112:115], v2 offset:12288
    s_waitcnt lgkmcnt(11)
    v_smfmac_f32_16x16x64_bf16 v[16:19], v[68:71], a[8:15], v3
    ds_read_b128 v[116:119], v2 offset:13312
    s_waitcnt lgkmcnt(11)
    v_smfmac_f32_16x16x64_bf16 v[16:19], v[72:75], a[16:23], v3
    ds_read_b128 v[120:123], v2 offset:14336
    s_waitcnt lgkmcnt(11)
    v_smfmac_f32_16x16x64_bf16 v[16:19], v[76:79], a[24:31], v3
    ds_read_b128 v[124:127], v2 offset:15360
    s_waitcnt lgkmcnt(11)
    v_smfmac_f32_16x16x64_bf16 v[16:19], v[80:83], a[32:39], v3
    s_waitcnt lgkmcnt(10)
    v_smfmac_f32_16x16x64_bf16 v[16:19], v[84:87], a[40:47], v3
    s_waitcnt lgkmcnt(9)
    v_smfmac_f32_16x16x64_bf16 v[16:19], v[88:91], a[48:55], v3
    s_waitcnt lgkmcnt(8)
    v_smfmac_f32_16x16x64_bf16 v[16:19], v[92:95], a[56:63], v3
    s_waitcnt lgkmcnt(7)
    v_smfmac_f32_16x16x64_bf16 v[16:19], v[96:99], a[64:71], v3
    s_waitcnt lgkmcnt(6)
    v_smfmac_f32_16x16x64_bf16 v[16:19], v[100:103], a[72:79], v3
    s_waitcnt lgkmcnt(5)
    v_smfmac_f32_16x16x64_bf16 v[16:19], v[104:107], a[80:87], v3
    s_waitcnt lgkmcnt(4)
    v_smfmac_f32_16x16x64_bf16 v[16:19], v[108:111], a[88:95], v3
    s_waitcnt lgkmcnt(3)
    v_smfmac_f32_16x16x64_bf16 v[16:19], v[112:115], a[96:103], v3
    s_waitcnt lgkmcnt(2)
    v_smfmac_f32_16x16x64_bf16 v[16:19], v[116:119], a[104:111], v3
    s_waitcnt lgkmcnt(1)
    v_smfmac_f32_16x16x64_bf16 v[16:19], v[120:123], a[112:119], v3
    s_waitcnt lgkmcnt(0)
    v_smfmac_f32_16x16x64_bf16 v[16:19], v[124:127], a[120:127], v3
    s_nop 7
    v_permlane32_swap_b32 v16, v18
    v_permlane32_swap_b32 v17, v19
    v_add_f32 v16, v16, v18
    v_add_f32 v17, v17, v19
    s_mov_b32 vcc_lo, 0x55555555
    s_mov_b32 vcc_hi, 0x55555555
    v_cndmask_b32_dpp v18, v17, v16, vcc quad_perm:[1,0,3,2] row_mask:0xf bank_mask:0xf
    s_not_b64 vcc, vcc
    v_cndmask_b32_dpp v19, v16, v17, vcc quad_perm:[1,0,3,2] row_mask:0xf bank_mask:0xf
    v_cvt_pk_bf16_f32 v18, v18, v19
    v_min_u32 v18, -2, v18
    buffer_store_dword v18, v4, s[12:15], s61 offen
    ds_write_b32 v5, v18
    s_barrier
    s_cmp_eq_u32 s60, 63
    s_cbranch_scc1 L_s_last_90
    s_sleep 4
    s_mov_b32 s70, 0
L_s_xp_91:
    buffer_load_dwordx4 v[64:67], v7, s[12:15], s61 offen offset:0 sc1
    buffer_load_dwordx4 v[68:71], v7, s[12:15], s61 offen offset:1024 sc1
    buffer_load_dwordx4 v[72:75], v7, s[12:15], s61 offen offset:2048 sc1
    buffer_load_dwordx4 v[76:79], v7, s[12:15], s61 offen offset:3072 sc1
    s_waitcnt vmcnt(3)
    v_mfma_f32_16x16x32_bf16 v[20:23], v[48:51], v[64:67], 0
    v_mfma_f32_16x16x32_bf16 v[16:19], v[32:35], v[64:67], 0
    v_mfma_f32_16x16x32_bf16 v[24:27], v[64:67], v[64:67], v[28:31]
    s_waitcnt vmcnt(2)
    v_mfma_f32_16x16x32_bf16 v[20:23], v[52:55], v[68:71], v[20:23]
    v_mfma_f32_16x16x32_bf16 v[16:19], v[36:39], v[68:71], v[16:19]
    v_mfma_f32_16x16x32_bf16 v[24:27], v[68:71], v[68:71], v[24:27]
    s_waitcnt vmcnt(1)
    v_mfma_f32_16x16x32_bf16 v[20:23], v[56:59], v[72:75], v[20:23]
    v_mfma_f32_16x16x32_bf16 v[16:19], v[40:43], v[72:75], v[16:19]
    v_mfma_f32_16x16x32_bf16 v[24:27], v[72:75], v[72:75], v[24:27]
    s_waitcnt vmcnt(0)
    v_mfma_f32_16x16x32_bf16 v[20:23], v[60:63], v[76:79], v[20:23]
    v_mfma_f32_16x16x32_bf16 v[16:19], v[44:47], v[76:79], v[16:19]
    v_mfma_f32_16x16x32_bf16 v[24:27], v[76:79], v[76:79], v[24:27]
    v_max3_u32 v10, v64, v65, v66
    v_max3_u32 v10, v10, v67, v68
    v_max3_u32 v10, v10, v69, v70
    v_max3_u32 v10, v10, v71, v72
    v_max3_u32 v10, v10, v73, v74
    v_max3_u32 v10, v10, v75, v76
    v_max3_u32 v10, v10, v77, v78
    v_max_u32 v10, v10, v79
    v_cmp_eq_u32 vcc, -1, v10
    s_add_u32 s70, s70, 1
    s_cbranch_vccz L_ok_92
    s_cmp_lt_u32 s70, 524288
    s_cbranch_scc1 L_s_xp_91
    s_branch L_c_done_7
L_ok_92:
    v_mov_b32_dpp v16, v20 row_ror:8 row_mask:0xf bank_mask:0xc
    v_mov_b32_dpp v17, v21 row_ror:8 row_mask:0xf bank_mask:0xc
    v_mov_b32_dpp v18, v22 row_ror:8 row_mask:0xf bank_mask:0xc
    v_mov_b32_dpp v19, v23 row_ror:8 row_mask:0xf bank_mask:0xc
    v_mov_b32_dpp v24, v26 row_ror:8 row_mask:0xf bank_mask:0xc
    v_mov_b32_dpp v25, v27 row_ror:8 row_mask:0xf bank_mask:0xc
    v_max3_f32 v10, v16, v17, v18
    v_max3_f32 v10, v10, v19, v24
    v_max_f32 v10, v10, v25
    s_nop 1
    v_max_f32_dpp v11, v10, v10 row_ror:8 row_mask:0xf bank_mask:0xf
    v_max_f32_dpp v10, v10, v10 row_ror:8 row_mask:0xf bank_mask:0xf
    s_nop 1
    v_permlane16_swap_b32 v10, v11
    v_max_f32 v12, v10, v11
    v_max_f32 v10, v10, v11
    s_nop 1
    v_permlane32_swap_b32 v10, v12
    v_max_f32 v10, v10, v12
    v_mul_f32 v10, s66, v10
    v_fma_f32 v16, v16, s66, -v10
    v_fma_f32 v17, v17, s66, -v10
    v_fma_f32 v18, v18, s66, -v10
    v_fma_f32 v19, v19, s66, -v10
    v_fma_f32 v24, v24, s66, -v10
    v_fma_f32 v25, v25, s66, -v10
    v_exp_f32 v16, v16
    v_exp_f32 v17, v17
    v_exp_f32 v18, v18
    v_exp_f32 v19, v19
    v_exp_f32 v24, v24
    v_exp_f32 v25, v25
    v_add_f32 v10, v16, v17
    v_add_f32 v11, v18, v19
    v_add_f32 v10, v10, v24
    v_add_f32 v11, v11, v25
    v_add_f32 v10, v10, v11
    s_nop 1
    v_add_f32_dpp v11, v10, v10 row_ror:8 row_mask:0xf bank_mask:0xf
    v_add_f32_dpp v10, v10, v10 row_ror:8 row_mask:0xf bank_mask:0xf
    s_nop 1
    v_permlane16_swap_b32 v10, v11
    v_add_f32 v12, v10, v11
    v_add_f32 v10, v10, v11
    s_nop 1
    v_permlane32_swap_b32 v10, v12
    v_add_f32 v10, v10, v12
    v_rcp_f32 v10, v10
    s_nop 0
    v_mul_f32 v16, v16, v10
    v_mul_f32 v17, v17, v10
    v_mul_f32 v18, v18, v10
    v_mul_f32 v19, v19, v10
    v_mul_f32 v24, v24, v10
    v_mul_f32 v25, v25, v10
    v_cvt_pk_bf16_f32 v16, v16, v17
    v_cvt_pk_bf16_f32 v17, v18, v19
    v_cvt_pk_bf16_f32 v18, v24, v25
    ds_write_b64 v8, v[16:17]
    ds_write_b32 v9, v18
    s_waitcnt lgkmcnt(0)
    s_barrier
    s_add_u32 s63, s63, 786432
    s_sleep 4
    s_xor_b32 s45, s61, 0x8000
    buffer_store_dword v13, v4, s[12:15], s45 offen
    s_cmp_lg_u32 s44, 0
    s_cbranch_scc1 L_s_np_93
    ds_read_b128 v[20:23], v2 offset:27648
    s_lshl_b32 s45, s60, 17
    s_add_u32 s45, s45, s67
    s_waitcnt lgkmcnt(0)
    buffer_store_dwordx4 v[20:23], v2, s[12:15], s45 offen
L_s_np_93:
    s_add_u32 s60, s60, 1
    s_add_u32 s61, s61, 0x4000
    s_and_b32 s61, s61, 0xffff
    s_branch L_s_loop_89
L_s_last_90:
    s_waitcnt lgkmcnt(0)
    s_barrier
    s_cmp_lg_u32 s44, 0
    s_cbranch_scc1 L_s_np_94
    ds_read_b128 v[20:23], v2 offset:27648
    s_lshl_b32 s45, s60, 17
    s_add_u32 s45, s45, s67
    s_waitcnt lgkmcnt(0)
    buffer_store_dwordx4 v[20:23], v2, s[12:15], s45 offen
L_s_np_94:
    s_branch L_c_done_7
L_ss_86:
L_s_loop_95:
    v_mov_b32 v16, 0
    v_mov_b32 v17, 0
    v_mov_b32 v18, 0
    v_mov_b32 v19, 0
    s_barrier
    ds_read_b128 v[64:67], v2 offset:0
    ds_read_b128 v[68:71], v2 offset:1024
    ds_read_b128 v[72:75], v2 offset:2048
    ds_read_b128 v[76:79], v2 offset:3072
    ds_read_b128 v[80:83], v2 offset:4096
    ds_read_b128 v[84:87], v2 offset:5120
    ds_read_b128 v[88:91], v2 offset:6144
    ds_read_b128 v[92:95], v2 offset:7168
    ds_read_b128 v[96:99], v2 offset:8192
    ds_read_b128 v[100:103], v2 offset:9216
    ds_read_b128 v[104:107], v2 offset:10240
    ds_read_b128 v[108:111], v2 offset:11264
    s_add_u32 s46, s63, 4096
    buffer_load_dwordx4 v[32:35], v6, s[12:15], s63 offen offset:0
    buffer_load_dwordx4 v[36:39], v6, s[12:15], s63 offen offset:1024
    buffer_load_dwordx4 v[40:43], v6, s[12:15], s63 offen offset:2048
    buffer_load_dwordx4 v[44:47], v6, s[12:15], s63 offen offset:3072
    buffer_load_dwordx4 v[48:51], v6, s[12:15], s46 offen offset:0
    buffer_load_dwordx4 v[52:55], v6, s[12:15], s46 offen offset:1024
    buffer_load_dwordx4 v[56:59], v6, s[12:15], s46 offen offset:2048
    buffer_load_dwordx4 v[60:63], v6, s[12:15], s46 offen offset:3072
    s_waitcnt lgkmcnt(11)
    v_smfmac_f32_16x16x64_bf16 v[16:19], v[64:67], a[0:7], v3
    ds_read_b128 v[112:115], v2 offset:12288
    s_waitcnt lgkmcnt(11)
    v_smfmac_f32_16x16x64_bf16 v[16:19], v[68:71], a[8:15], v3
    ds_read_b128 v[116:119], v2 offset:13312
    s_waitcnt lgkmcnt(11)
    v_smfmac_f32_16x16x64_bf16 v[16:19], v[72:75], a[16:23], v3
    ds_read_b128 v[120:123], v2 offset:14336
    s_waitcnt lgkmcnt(11)
    v_smfmac_f32_16x16x64_bf16 v[16:19], v[76:79], a[24:31], v3
    ds_read_b128 v[124:127], v2 offset:15360
    s_waitcnt lgkmcnt(11)
    v_smfmac_f32_16x16x64_bf16 v[16:19], v[80:83], a[32:39], v3
    s_waitcnt lgkmcnt(10)
    v_smfmac_f32_16x16x64_bf16 v[16:19], v[84:87], a[40:47], v3
    s_waitcnt lgkmcnt(9)
    v_smfmac_f32_16x16x64_bf16 v[16:19], v[88:91], a[48:55], v3
    s_waitcnt lgkmcnt(8)
    v_smfmac_f32_16x16x64_bf16 v[16:19], v[92:95], a[56:63], v3
    s_waitcnt lgkmcnt(7)
    v_smfmac_f32_16x16x64_bf16 v[16:19], v[96:99], a[64:71], v3
    s_waitcnt lgkmcnt(6)
    v_smfmac_f32_16x16x64_bf16 v[16:19], v[100:103], a[72:79], v3
    s_waitcnt lgkmcnt(5)
    v_smfmac_f32_16x16x64_bf16 v[16:19], v[104:107], a[80:87], v3
    s_waitcnt lgkmcnt(4)
    v_smfmac_f32_16x16x64_bf16 v[16:19], v[108:111], a[88:95], v3
    s_waitcnt lgkmcnt(3)
    v_smfmac_f32_16x16x64_bf16 v[16:19], v[112:115], a[96:103], v3
    s_waitcnt lgkmcnt(2)
    v_smfmac_f32_16x16x64_bf16 v[16:19], v[116:119], a[104:111], v3
    s_waitcnt lgkmcnt(1)
    v_smfmac_f32_16x16x64_bf16 v[16:19], v[120:123], a[112:119], v3
    s_waitcnt lgkmcnt(0)
    v_smfmac_f32_16x16x64_bf16 v[16:19], v[124:127], a[120:127], v3
    s_nop 7
    v_permlane32_swap_b32 v16, v18
    v_permlane32_swap_b32 v17, v19
    v_add_f32 v16, v16, v18
    v_add_f32 v17, v17, v19
    s_mov_b32 vcc_lo, 0x55555555
    s_mov_b32 vcc_hi, 0x55555555
    v_cndmask_b32_dpp v18, v17, v16, vcc quad_perm:[1,0,3,2] row_mask:0xf bank_mask:0xf
    s_not_b64 vcc, vcc
    v_cndmask_b32_dpp v19, v16, v17, vcc quad_perm:[1,0,3,2] row_mask:0xf bank_mask:0xf
    v_cvt_pk_bf16_f32 v18, v18, v19
    v_min_u32 v18, -2, v18
    buffer_store_dword v18, v4, s[12:15], s61 offen sc1
    ds_write_b32 v5, v18
    s_barrier
    s_cmp_eq_u32 s60, 63
    s_cbranch_scc1 L_s_last_96
    s_sleep 4
    s_mov_b32 s70, 0
L_s_xp_97:
    buffer_load_dwordx4 v[64:67], v7, s[12:15], s61 offen offset:0 sc1
    buffer_load_dwordx4 v[68:71], v7, s[12:15], s61 offen offset:1024 sc1
    buffer_load_dwordx4 v[72:75], v7, s[12:15], s61 offen offset:2048 sc1
    buffer_load_dwordx4 v[76:79], v7, s[12:15], s61 offen offset:3072 sc1
    s_waitcnt vmcnt(3)
    v_mfma_f32_16x16x32_bf16 v[20:23], v[48:51], v[64:67], 0
    v_mfma_f32_16x16x32_bf16 v[16:19], v[32:35], v[64:67], 0
    v_mfma_f32_16x16x32_bf16 v[24:27], v[64:67], v[64:67], v[28:31]
    s_waitcnt vmcnt(2)
    v_mfma_f32_16x16x32_bf16 v[20:23], v[52:55], v[68:71], v[20:23]
    v_mfma_f32_16x16x32_bf16 v[16:19], v[36:39], v[68:71], v[16:19]
    v_mfma_f32_16x16x32_bf16 v[24:27], v[68:71], v[68:71], v[24:27]
    s_waitcnt vmcnt(1)
    v_mfma_f32_16x16x32_bf16 v[20:23], v[56:59], v[72:75], v[20:23]
    v_mfma_f32_16x16x32_bf16 v[16:19], v[40:43], v[72:75], v[16:19]
    v_mfma_f32_16x16x32_bf16 v[24:27], v[72:75], v[72:75], v[24:27]
    s_waitcnt vmcnt(0)
    v_mfma_f32_16x16x32_bf16 v[20:23], v[60:63], v[76:79], v[20:23]
    v_mfma_f32_16x16x32_bf16 v[16:19], v[44:47], v[76:79], v[16:19]
    v_mfma_f32_16x16x32_bf16 v[24:27], v[76:79], v[76:79], v[24:27]
    v_max3_u32 v10, v64, v65, v66
    v_max3_u32 v10, v10, v67, v68
    v_max3_u32 v10, v10, v69, v70
    v_max3_u32 v10, v10, v71, v72
    v_max3_u32 v10, v10, v73, v74
    v_max3_u32 v10, v10, v75, v76
    v_max3_u32 v10, v10, v77, v78
    v_max_u32 v10, v10, v79
    v_cmp_eq_u32 vcc, -1, v10
    s_add_u32 s70, s70, 1
    s_cbranch_vccz L_ok_98
    s_cmp_lt_u32 s70, 524288
    s_cbranch_scc1 L_s_xp_97
    s_branch L_c_done_7
L_ok_98:
    v_mov_b32_dpp v16, v20 row_ror:8 row_mask:0xf bank_mask:0xc
    v_mov_b32_dpp v17, v21 row_ror:8 row_mask:0xf bank_mask:0xc
    v_mov_b32_dpp v18, v22 row_ror:8 row_mask:0xf bank_mask:0xc
    v_mov_b32_dpp v19, v23 row_ror:8 row_mask:0xf bank_mask:0xc
    v_mov_b32_dpp v24, v26 row_ror:8 row_mask:0xf bank_mask:0xc
    v_mov_b32_dpp v25, v27 row_ror:8 row_mask:0xf bank_mask:0xc
    v_max3_f32 v10, v16, v17, v18
    v_max3_f32 v10, v10, v19, v24
    v_max_f32 v10, v10, v25
    s_nop 1
    v_max_f32_dpp v11, v10, v10 row_ror:8 row_mask:0xf bank_mask:0xf
    v_max_f32_dpp v10, v10, v10 row_ror:8 row_mask:0xf bank_mask:0xf
    s_nop 1
    v_permlane16_swap_b32 v10, v11
    v_max_f32 v12, v10, v11
    v_max_f32 v10, v10, v11
    s_nop 1
    v_permlane32_swap_b32 v10, v12
    v_max_f32 v10, v10, v12
    v_mul_f32 v10, s66, v10
    v_fma_f32 v16, v16, s66, -v10
    v_fma_f32 v17, v17, s66, -v10
    v_fma_f32 v18, v18, s66, -v10
    v_fma_f32 v19, v19, s66, -v10
    v_fma_f32 v24, v24, s66, -v10
    v_fma_f32 v25, v25, s66, -v10
    v_exp_f32 v16, v16
    v_exp_f32 v17, v17
    v_exp_f32 v18, v18
    v_exp_f32 v19, v19
    v_exp_f32 v24, v24
    v_exp_f32 v25, v25
    v_add_f32 v10, v16, v17
    v_add_f32 v11, v18, v19
    v_add_f32 v10, v10, v24
    v_add_f32 v11, v11, v25
    v_add_f32 v10, v10, v11
    s_nop 1
    v_add_f32_dpp v11, v10, v10 row_ror:8 row_mask:0xf bank_mask:0xf
    v_add_f32_dpp v10, v10, v10 row_ror:8 row_mask:0xf bank_mask:0xf
    s_nop 1
    v_permlane16_swap_b32 v10, v11
    v_add_f32 v12, v10, v11
    v_add_f32 v10, v10, v11
    s_nop 1
    v_permlane32_swap_b32 v10, v12
    v_add_f32 v10, v10, v12
    v_rcp_f32 v10, v10
    s_nop 0
    v_mul_f32 v16, v16, v10
    v_mul_f32 v17, v17, v10
    v_mul_f32 v18, v18, v10
    v_mul_f32 v19, v19, v10
    v_mul_f32 v24, v24, v10
    v_mul_f32 v25, v25, v10
    v_cvt_pk_bf16_f32 v16, v16, v17
    v_cvt_pk_bf16_f32 v17, v18, v19
    v_cvt_pk_bf16_f32 v18, v24, v25
    ds_write_b64 v8, v[16:17]
    ds_write_b32 v9, v18
    s_waitcnt lgkmcnt(0)
    s_barrier
    s_add_u32 s63, s63, 786432
    s_sleep 4
    s_xor_b32 s45, s61, 0x8000
    buffer_store_dword v13, v4, s[12:15], s45 offen sc1
    s_cmp_lg_u32 s44, 0
    s_cbranch_scc1 L_s_np_99
    ds_read_b128 v[20:23], v2 offset:27648
    s_lshl_b32 s45, s60, 17
    s_add_u32 s45, s45, s67
    s_waitcnt lgkmcnt(0)
    buffer_store_dwordx4 v[20:23], v2, s[12:15], s45 offen sc1
L_s_np_99:
    s_add_u32 s60, s60, 1
    s_add_u32 s61, s61, 0x4000
    s_and_b32 s61, s61, 0xffff
    s_branch L_s_loop_95
L_s_last_96:
    s_waitcnt lgkmcnt(0)
    s_barrier
    s_cmp_lg_u32 s44, 0
    s_cbranch_scc1 L_s_np_100
    ds_read_b128 v[20:23], v2 offset:27648
    s_lshl_b32 s45, s60, 17
    s_add_u32 s45, s45, s67
    s_waitcnt lgkmcnt(0)
    buffer_store_dwordx4 v[20:23], v2, s[12:15], s45 offen sc1
L_s_np_100:
    s_branch L_c_done_7
L_vf_87:
    s_cmp_eq_u32 s52, 0
    s_cbranch_scc1 L_vs_88
L_v_loop_101:
    s_mov_b32 s70, 0
L_v_l1_102:
    buffer_load_dwordx4 v[64:67], v9, s[12:15], s61 offen offset:0 sc1
    buffer_load_dwordx4 v[68:71], v9, s[12:15], s61 offen offset:1024 sc1
    buffer_load_dwordx4 v[72:75], v9, s[12:15], s61 offen offset:2048 sc1
    buffer_load_dwordx4 v[76:79], v9, s[12:15], s61 offen offset:3072 sc1
    v_mov_b32 v16, 0
    v_mov_b32 v17, 0
    v_mov_b32 v18, 0
    v_mov_b32 v19, 0
    s_waitcnt vmcnt(3)
    ds_write_b128 v10, v[64:67] offset:0
    s_waitcnt vmcnt(2)
    ds_write_b128 v10, v[68:71] offset:1024
    s_waitcnt vmcnt(1)
    ds_write_b128 v10, v[72:75] offset:2048
    s_waitcnt vmcnt(0)
    ds_write_b128 v10, v[76:79] offset:3072
    v_max3_u32 v20, v64, v65, v66
    v_max3_u32 v20, v20, v67, v68
    v_max3_u32 v20, v20, v69, v70
    v_max3_u32 v20, v20, v71, v72
    v_max3_u32 v20, v20, v73, v74
    v_max3_u32 v20, v20, v75, v76
    v_max3_u32 v20, v20, v77, v78
    v_max_u32 v20, v20, v79
    v_cmp_eq_u32 vcc, -1, v20
    s_add_u32 s70, s70, 1
    s_cbranch_vccz L_ok_103
    s_cmp_lt_u32 s70, 524288
    s_cbranch_scc1 L_v_l1_102
    s_branch L_c_done_7
L_ok_103:
    s_waitcnt lgkmcnt(0)
    s_barrier
    ds_read_b128 v[64:67], v13 offset:0
    ds_read_b128 v[68:71], v13 offset:1024
    ds_read_b128 v[72:75], v13 offset:2048
    ds_read_b128 v[76:79], v13 offset:3072
    ds_read_b128 v[80:83], v13 offset:4096
    ds_read_b128 v[84:87], v13 offset:5120
    ds_read_b128 v[88:91], v13 offset:6144
    ds_read_b128 v[92:95], v13 offset:7168
    v_mov_b32 v96, 0
    v_mov_b32 v97, 0
    v_mov_b32 v98, 0
    v_mov_b32 v99, 0
    v_mov_b32 v100, 0
    v_mov_b32 v101, 0
    v_mov_b32 v102, 0
    v_mov_b32 v103, 0
    v_mov_b32 v104, 0
    v_mov_b32 v105, 0
    v_mov_b32 v106, 0
    v_mov_b32 v107, 0
    v_mov_b32 v108, 0
    v_mov_b32 v109, 0
    v_mov_b32 v110, 0
    v_mov_b32 v111, 0
    s_waitcnt lgkmcnt(7)
    v_smfmac_f32_16x16x64_bf16 v[16:19], v[64:67], a[0:7], v3
    s_waitcnt lgkmcnt(6)
    v_smfmac_f32_16x16x64_bf16 v[16:19], v[68:71], a[8:15], v3
    s_waitcnt lgkmcnt(5)
    v_smfmac_f32_16x16x64_bf16 v[16:19], v[72:75], a[16:23], v3
    s_waitcnt lgkmcnt(4)
    v_smfmac_f32_16x16x64_bf16 v[16:19], v[76:79], a[24:31], v3
    s_waitcnt lgkmcnt(3)
    v_smfmac_f32_16x16x64_bf16 v[16:19], v[80:83], a[32:39], v3
    s_waitcnt lgkmcnt(2)
    v_smfmac_f32_16x16x64_bf16 v[16:19], v[84:87], a[40:47], v3
    s_waitcnt lgkmcnt(1)
    v_smfmac_f32_16x16x64_bf16 v[16:19], v[88:91], a[48:55], v3
    s_waitcnt lgkmcnt(0)
    v_smfmac_f32_16x16x64_bf16 v[16:19], v[92:95], a[56:63], v3
    s_nop 7
    v_permlane32_swap_b32 v16, v18
    v_permlane32_swap_b32 v17, v19
    v_add_f32 v16, v16, v18
    v_add_f32 v17, v17, v19
    s_bitcmp1_b32 s44, 0
    s_cbranch_scc0 L_v_k0_105
    ds_write_b64 v14, v[16:17]
    s_waitcnt lgkmcnt(0)
    s_barrier
    s_branch L_v_k1_106
L_v_k0_105:
    s_barrier
    ds_read_b64 v[20:21], v14
    s_waitcnt lgkmcnt(0)
    v_add_f32 v16, v16, v20
    v_add_f32 v17, v17, v21
    s_mov_b32 vcc_lo, 0x55555555
    s_mov_b32 vcc_hi, 0x55555555
    v_cndmask_b32_dpp v18, v17, v16, vcc quad_perm:[1,0,3,2] row_mask:0xf bank_mask:0xf
    s_not_b64 vcc, vcc
    v_cndmask_b32_dpp v19, v16, v17, vcc quad_perm:[1,0,3,2] row_mask:0xf bank_mask:0xf
    v_cvt_pk_bf16_f32 v18, v18, v19
    v_min_u32 v18, -2, v18
    buffer_store_dword v18, v4, s[12:15], s62 offen
    ds_write_b32 v5, v18
L_v_k1_106:
    s_cmp_eq_u32 s60, 63
    s_cbranch_scc1 L_v_last_104
    ds_read_b128 v[80:83], v27 offset:32768
    ds_read_b128 v[84:87], v27 offset:36864
    ds_read_b128 v[88:91], v27 offset:40960
    ds_read_b128 v[92:95], v27 offset:45056
    s_sleep 5
    s_mov_b32 s70, 0
L_v_vp_107:
    buffer_load_dwordx4 v[64:67], v11, s[12:15], s62 offen offset:0 sc1
    buffer_load_dwordx4 v[68:71], v11, s[12:15], s62 offen offset:1024 sc1
    s_waitcnt vmcnt(0)
    v_max3_u32 v20, v64, v65, v66
    v_max3_u32 v20, v20, v67, v68
    v_max3_u32 v20, v20, v69, v70
    v_max_u32 v20, v20, v71
    v_cmp_eq_u32 vcc, -1, v20
    s_add_u32 s70, s70, 1
    s_cbranch_vccz L_ok_108
    s_cmp_lt_u32 s70, 524288
    s_cbranch_scc1 L_v_vp_107
    s_branch L_c_done_7
L_ok_108:
    v_smfmac_f32_16x16x64_bf16 v[96:99], v[64:67], a[64:71], v3
    v_smfmac_f32_16x16x64_bf16 v[96:99], v[68:71], a[72:79], v3
    v_smfmac_f32_16x16x64_bf16 v[100:103], v[64:67], a[80:87], v3
    v_smfmac_f32_16x16x64_bf16 v[100:103], v[68:71], a[88:95], v3
    v_smfmac_f32_16x16x64_bf16 v[104:107], v[64:67], a[96:103], v3
    v_smfmac_f32_16x16x64_bf16 v[104:107], v[68:71], a[104:111], v3
    v_smfmac_f32_16x16x64_bf16 v[108:111], v[64:67], a[112:119], v3
    v_smfmac_f32_16x16x64_bf16 v[108:111], v[68:71], a[120:127], v3
    s_add_u32 s46, s65, 4096
    buffer_load_dwordx4 v[32:35], v15, s[12:15], s65 offen offset:0
    buffer_load_dwordx4 v[48:51], v15, s[12:15], s46 offen offset:0
    buffer_load_dwordx4 v[36:39], v15, s[12:15], s65 offen offset:1024
    buffer_load_dwordx4 v[52:55], v15, s[12:15], s46 offen offset:1024
    buffer_load_dwordx4 v[40:43], v15, s[12:15], s65 offen offset:2048
    buffer_load_dwordx4 v[56:59], v15, s[12:15], s46 offen offset:2048
    buffer_load_dwordx4 v[44:47], v15, s[12:15], s65 offen offset:3072
    buffer_load_dwordx4 v[60:63], v15, s[12:15], s46 offen offset:3072
    s_add_u32 s65, s65, 786432
    v_permlane32_swap_b32 v96, v98
    v_permlane32_swap_b32 v97, v99
    v_add_f32 v96, v96, v98
    v_add_f32 v97, v97, v99
    v_cvt_pk_bf16_f32 v96, v96, v97
    ds_write_b32 v12, v96 offset:0
    v_permlane32_swap_b32 v100, v102
    v_permlane32_swap_b32 v101, v103
    v_add_f32 v100, v100, v102
    v_add_f32 v101, v101, v103
    v_cvt_pk_bf16_f32 v100, v100, v101
    ds_write_b32 v12, v100 offset:1024
    v_permlane32_swap_b32 v104, v106
    v_permlane32_swap_b32 v105, v107
    v_add_f32 v104, v104, v106
    v_add_f32 v105, v105, v107
    v_cvt_pk_bf16_f32 v104, v104, v105
    ds_write_b32 v12, v104 offset:2048
    v_permlane32_swap_b32 v108, v110
    v_permlane32_swap_b32 v109, v111
    v_add_f32 v108, v108, v110
    v_add_f32 v109, v109, v111
    v_cvt_pk_bf16_f32 v108, v108, v109
    ds_write_b32 v12, v108 offset:3072
    s_waitcnt lgkmcnt(0)
    s_barrier
    ds_read_b128 v[96:99], v2 offset:16384
    ds_read_b128 v[100:103], v2 offset:17408
    ds_read_b128 v[104:107], v2 offset:18432
    ds_read_b128 v[108:111], v2 offset:19456
    ds_read_b128 v[112:115], v2 offset:20480
    ds_read_b128 v[116:119], v27 offset:21504
    s_waitcnt lgkmcnt(5)
    v_mfma_f32_16x16x32_bf16 v[16:19], v[80:83], v[96:99], 0
    s_waitcnt lgkmcnt(4)
    v_mfma_f32_16x16x32_bf16 v[16:19], v[84:87], v[100:103], v[16:19]
    s_waitcnt lgkmcnt(3)
    v_mfma_f32_16x16x32_bf16 v[16:19], v[88:91], v[104:107], v[16:19]
    s_waitcnt lgkmcnt(2)
    v_mfma_f32_16x16x32_bf16 v[16:19], v[92:95], v[108:111], v[16:19]
    s_waitcnt lgkmcnt(0)
    v_mfma_f32_16x16x32_bf16 v[16:19], v[116:119], v[112:115], v[16:19]
    s_mov_b32 exec_lo, 0x00ff00ff
    s_mov_b32 exec_hi, 0x00ff00ff
    s_nop 5
    v_min_u32 v16, -2, v16
    v_min_u32 v17, -2, v17
    v_min_u32 v18, -2, v18
    v_min_u32 v19, -2, v19
    buffer_store_dwordx4 v[16:19], v6, s[12:15], s63 offen sc1
    s_mov_b64 exec, -1
    s_add_u32 s61, s61, 0x4000
    s_and_b32 s61, s61, 0xffff
    s_mov_b32 s70, 0
    s_sleep 12
    s_waitcnt vmcnt(1)
    buffer_load_dwordx4 v[96:99], v7, s[12:15], s63 offen offset:0 sc1
    buffer_load_dwordx4 v[100:103], v7, s[12:15], s63 offen offset:512 sc1
    buffer_load_dwordx4 v[104:107], v7, s[12:15], s63 offen offset:1024 sc1
    buffer_load_dwordx4 v[108:111], v7, s[12:15], s63 offen offset:1536 sc1
    v_mfma_f32_16x16x32_bf16 v[64:67], v[32:35], a[64:67], 0
    v_mfma_f32_16x16x32_bf16 v[68:71], v[48:51], a[64:67], 0
    v_mfma_f32_16x16x32_bf16 v[64:67], v[36:39], a[68:71], v[64:67]
    v_mfma_f32_16x16x32_bf16 v[68:71], v[52:55], a[68:71], v[68:71]
    v_mfma_f32_16x16x32_bf16 v[64:67], v[40:43], a[72:75], v[64:67]
    v_mfma_f32_16x16x32_bf16 v[68:71], v[56:59], a[72:75], v[68:71]
    v_mfma_f32_16x16x32_bf16 v[64:67], v[44:47], a[76:79], v[64:67]
    v_mfma_f32_16x16x32_bf16 v[68:71], v[60:63], a[76:79], v[68:71]
    v_mfma_f32_16x16x32_bf16 v[72:75], v[32:35], a[80:83], 0
    v_mfma_f32_16x16x32_bf16 v[76:79], v[48:51], a[80:83], 0
    v_mfma_f32_16x16x32_bf16 v[72:75], v[36:39], a[84:87], v[72:75]
    v_mfma_f32_16x16x32_bf16 v[76:79], v[52:55], a[84:87], v[76:79]
    v_mfma_f32_16x16x32_bf16 v[72:75], v[40:43], a[88:91], v[72:75]
    v_mfma_f32_16x16x32_bf16 v[76:79], v[56:59], a[88:91], v[76:79]
    v_mfma_f32_16x16x32_bf16 v[72:75], v[44:47], a[92:95], v[72:75]
    v_mfma_f32_16x16x32_bf16 v[76:79], v[60:63], a[92:95], v[76:79]
    v_cvt_pk_bf16_f32 v64, v64, v65
    v_cvt_pk_bf16_f32 v65, v66, v67
    v_cvt_pk_bf16_f32 v66, v68, v69
    v_cvt_pk_bf16_f32 v67, v70, v71
    ds_write_b128 v10, v[64:67] offset:32768
    v_mfma_f32_16x16x32_bf16 v[80:83], v[32:35], a[96:99], 0
    v_mfma_f32_16x16x32_bf16 v[84:87], v[48:51], a[96:99], 0
    v_mfma_f32_16x16x32_bf16 v[80:83], v[36:39], a[100:103], v[80:83]
    v_mfma_f32_16x16x32_bf16 v[84:87], v[52:55], a[100:103], v[84:87]
    v_mfma_f32_16x16x32_bf16 v[80:83], v[40:43], a[104:107], v[80:83]
    v_mfma_f32_16x16x32_bf16 v[84:87], v[56:59], a[104:107], v[84:87]
    v_mfma_f32_16x16x32_bf16 v[80:83], v[44:47], a[108:111], v[80:83]
    v_mfma_f32_16x16x32_bf16 v[84:87], v[60:63], a[108:111], v[84:87]
    v_cvt_pk_bf16_f32 v72, v72, v73
    v_cvt_pk_bf16_f32 v73, v74, v75
    v_cvt_pk_bf16_f32 v74, v76, v77
    v_cvt_pk_bf16_f32 v75, v78, v79
    ds_write_b128 v10, v[72:75] offset:33792
    v_mfma_f32_16x16x32_bf16 v[88:91], v[32:35], a[112:115], 0
    v_mfma_f32_16x16x32_bf16 v[92:95], v[48:51], a[112:115], 0
    v_mfma_f32_16x16x32_bf16 v[88:91], v[36:39], a[116:119], v[88:91]
    v_mfma_f32_16x16x32_bf16 v[92:95], v[52:55], a[116:119], v[92:95]
    v_mfma_f32_16x16x32_bf16 v[88:91], v[40:43], a[120:123], v[88:91]
    v_mfma_f32_16x16x32_bf16 v[92:95], v[56:59], a[120:123], v[92:95]
    v_mfma_f32_16x16x32_bf16 v[88:91], v[44:47], a[124:127], v[88:91]
    v_mfma_f32_16x16x32_bf16 v[92:95], v[60:63], a[124:127], v[92:95]
    v_cvt_pk_bf16_f32 v80, v80, v81
    v_cvt_pk_bf16_f32 v81, v82, v83
    v_cvt_pk_bf16_f32 v82, v84, v85
    v_cvt_pk_bf16_f32 v83, v86, v87
    ds_write_b128 v10, v[80:83] offset:34816
    s_nop 2
    v_cvt_pk_bf16_f32 v88, v88, v89
    v_cvt_pk_bf16_f32 v89, v90, v91
    v_cvt_pk_bf16_f32 v90, v92, v93
    v_cvt_pk_bf16_f32 v91, v94, v95
    ds_write_b128 v10, v[88:91] offset:35840
L_v_gp_109:
    s_waitcnt vmcnt(2)
    v_pk_add_f32 v[16:17], v[96:97], v[100:101]
    v_pk_add_f32 v[18:19], v[98:99], v[102:103]
    s_waitcnt vmcnt(0)
    v_pk_add_f32 v[20:21], v[104:105], v[108:109]
    v_pk_add_f32 v[22:23], v[106:107], v[110:111]
    v_pk_add_f32 v[16:17], v[16:17], v[20:21]
    v_pk_add_f32 v[18:19], v[18:19], v[22:23]
    v_max3_u32 v24, v96, v97, v98
    v_max3_u32 v24, v24, v99, v100
    v_max3_u32 v24, v24, v101, v102
    v_max3_u32 v24, v24, v103, v104
    v_max3_u32 v24, v24, v105, v106
    v_max3_u32 v24, v24, v107, v108
    v_max3_u32 v24, v24, v109, v110
    v_max_u32 v24, v24, v111
    v_cmp_eq_u32 vcc, -1, v24
    s_add_u32 s70, s70, 1
    s_cbranch_vccz L_v_gok_110
    buffer_load_dwordx4 v[96:99], v7, s[12:15], s63 offen offset:0 sc1
    buffer_load_dwordx4 v[100:103], v7, s[12:15], s63 offen offset:512 sc1
    buffer_load_dwordx4 v[104:107], v7, s[12:15], s63 offen offset:1024 sc1
    buffer_load_dwordx4 v[108:111], v7, s[12:15], s63 offen offset:1536 sc1
    s_cmp_lt_u32 s70, 524288
    s_cbranch_scc1 L_v_gp_109
    s_branch L_c_done_7
L_v_gok_110:
    v_add_f32_dpp v20, v16, v16 row_ror:8 row_mask:0xf bank_mask:0x3
    v_add_f32_dpp v21, v17, v17 row_ror:8 row_mask:0xf bank_mask:0x3
    v_add_f32_dpp v20, v18, v18 row_ror:8 row_mask:0xf bank_mask:0xc
    v_add_f32_dpp v21, v19, v19 row_ror:8 row_mask:0xf bank_mask:0xc
    v_cvt_pk_bf16_f32 v20, v20, v21
    v_min_u32 v20, -2, v20
    buffer_store_dword v20, v8, s[12:15], s61 offen
    s_xor_b32 s45, s61, 0x8000
    buffer_store_dword v26, v8, s[12:15], s45 offen
    s_bitcmp1_b32 s44, 0
    s_cbranch_scc1 L_v_nr_111
    s_xor_b32 s45, s62, 0x4000
    buffer_store_dword v26, v4, s[12:15], s45 offen
L_v_nr_111:
    s_add_u32 s60, s60, 1
    s_add_u32 s62, s62, 0x2000
    s_and_b32 s62, s62, 0x7fff
    s_add_u32 s63, s63, 262144
    s_sleep 3
    s_branch L_v_loop_101
L_v_last_104:
    s_waitcnt lgkmcnt(0)
    s_barrier
    s_branch L_c_done_7
L_vs_88:
L_v_loop_112:
    s_mov_b32 s70, 0
L_v_l1_113:
    buffer_load_dwordx4 v[64:67], v9, s[12:15], s61 offen offset:0 sc1
    buffer_load_dwordx4 v[68:71], v9, s[12:15], s61 offen offset:1024 sc1
    buffer_load_dwordx4 v[72:75], v9, s[12:15], s61 offen offset:2048 sc1
    buffer_load_dwordx4 v[76:79], v9, s[12:15], s61 offen offset:3072 sc1
    v_mov_b32 v16, 0
    v_mov_b32 v17, 0
    v_mov_b32 v18, 0
    v_mov_b32 v19, 0
    s_waitcnt vmcnt(3)
    ds_write_b128 v10, v[64:67] offset:0
    s_waitcnt vmcnt(2)
    ds_write_b128 v10, v[68:71] offset:1024
    s_waitcnt vmcnt(1)
    ds_write_b128 v10, v[72:75] offset:2048
    s_waitcnt vmcnt(0)
    ds_write_b128 v10, v[76:79] offset:3072
    v_max3_u32 v20, v64, v65, v66
    v_max3_u32 v20, v20, v67, v68
    v_max3_u32 v20, v20, v69, v70
    v_max3_u32 v20, v20, v71, v72
    v_max3_u32 v20, v20, v73, v74
    v_max3_u32 v20, v20, v75, v76
    v_max3_u32 v20, v20, v77, v78
    v_max_u32 v20, v20, v79
    v_cmp_eq_u32 vcc, -1, v20
    s_add_u32 s70, s70, 1
    s_cbranch_vccz L_ok_114
    s_cmp_lt_u32 s70, 524288
    s_cbranch_scc1 L_v_l1_113
    s_branch L_c_done_7
L_ok_114:
    s_waitcnt lgkmcnt(0)
    s_barrier
    ds_read_b128 v[64:67], v13 offset:0
    ds_read_b128 v[68:71], v13 offset:1024
    ds_read_b128 v[72:75], v13 offset:2048
    ds_read_b128 v[76:79], v13 offset:3072
    ds_read_b128 v[80:83], v13 offset:4096
    ds_read_b128 v[84:87], v13 offset:5120
    ds_read_b128 v[88:91], v13 offset:6144
    ds_read_b128 v[92:95], v13 offset:7168
    v_mov_b32 v96, 0
    v_mov_b32 v97, 0
    v_mov_b32 v98, 0
    v_mov_b32 v99, 0
    v_mov_b32 v100, 0
    v_mov_b32 v101, 0
    v_mov_b32 v102, 0
    v_mov_b32 v103, 0
    v_mov_b32 v104, 0
    v_mov_b32 v105, 0
    v_mov_b32 v106, 0
    v_mov_b32 v107, 0
    v_mov_b32 v108, 0
    v_mov_b32 v109, 0
    v_mov_b32 v110, 0
    v_mov_b32 v111, 0
    s_waitcnt lgkmcnt(7)
    v_smfmac_f32_16x16x64_bf16 v[16:19], v[64:67], a[0:7], v3
    s_waitcnt lgkmcnt(6)
    v_smfmac_f32_16x16x64_bf16 v[16:19], v[68:71], a[8:15], v3
    s_waitcnt lgkmcnt(5)
    v_smfmac_f32_16x16x64_bf16 v[16:19], v[72:75], a[16:23], v3
    s_waitcnt lgkmcnt(4)
    v_smfmac_f32_16x16x64_bf16 v[16:19], v[76:79], a[24:31], v3
    s_waitcnt lgkmcnt(3)
    v_smfmac_f32_16x16x64_bf16 v[16:19], v[80:83], a[32:39], v3
    s_waitcnt lgkmcnt(2)
    v_smfmac_f32_16x16x64_bf16 v[16:19], v[84:87], a[40:47], v3
    s_waitcnt lgkmcnt(1)
    v_smfmac_f32_16x16x64_bf16 v[16:19], v[88:91], a[48:55], v3
    s_waitcnt lgkmcnt(0)
    v_smfmac_f32_16x16x64_bf16 v[16:19], v[92:95], a[56:63], v3
    s_nop 7
    v_permlane32_swap_b32 v16, v18
    v_permlane32_swap_b32 v17, v19
    v_add_f32 v16, v16, v18
    v_add_f32 v17, v17, v19
    s_bitcmp1_b32 s44, 0
    s_cbranch_scc0 L_v_k0_116
    ds_write_b64 v14, v[16:17]
    s_waitcnt lgkmcnt(0)
    s_barrier
    s_branch L_v_k1_117
L_v_k0_116:
    s_barrier
    ds_read_b64 v[20:21], v14
    s_waitcnt lgkmcnt(0)
    v_add_f32 v16, v16, v20
    v_add_f32 v17, v17, v21
    s_mov_b32 vcc_lo, 0x55555555
    s_mov_b32 vcc_hi, 0x55555555
    v_cndmask_b32_dpp v18, v17, v16, vcc quad_perm:[1,0,3,2] row_mask:0xf bank_mask:0xf
    s_not_b64 vcc, vcc
    v_cndmask_b32_dpp v19, v16, v17, vcc quad_perm:[1,0,3,2] row_mask:0xf bank_mask:0xf
    v_cvt_pk_bf16_f32 v18, v18, v19
    v_min_u32 v18, -2, v18
    buffer_store_dword v18, v4, s[12:15], s62 offen sc1
    ds_write_b32 v5, v18
L_v_k1_117:
    s_cmp_eq_u32 s60, 63
    s_cbranch_scc1 L_v_last_115
    ds_read_b128 v[80:83], v27 offset:32768
    ds_read_b128 v[84:87], v27 offset:36864
    ds_read_b128 v[88:91], v27 offset:40960
    ds_read_b128 v[92:95], v27 offset:45056
    s_sleep 5
    s_mov_b32 s70, 0
L_v_vp_118:
    buffer_load_dwordx4 v[64:67], v11, s[12:15], s62 offen offset:0 sc1
    buffer_load_dwordx4 v[68:71], v11, s[12:15], s62 offen offset:1024 sc1
    s_waitcnt vmcnt(0)
    v_max3_u32 v20, v64, v65, v66
    v_max3_u32 v20, v20, v67, v68
    v_max3_u32 v20, v20, v69, v70
    v_max_u32 v20, v20, v71
    v_cmp_eq_u32 vcc, -1, v20
    s_add_u32 s70, s70, 1
    s_cbranch_vccz L_ok_119
    s_cmp_lt_u32 s70, 524288
    s_cbranch_scc1 L_v_vp_118
    s_branch L_c_done_7
L_ok_119:
    v_smfmac_f32_16x16x64_bf16 v[96:99], v[64:67], a[64:71], v3
    v_smfmac_f32_16x16x64_bf16 v[96:99], v[68:71], a[72:79], v3
    v_smfmac_f32_16x16x64_bf16 v[100:103], v[64:67], a[80:87], v3
    v_smfmac_f32_16x16x64_bf16 v[100:103], v[68:71], a[88:95], v3
    v_smfmac_f32_16x16x64_bf16 v[104:107], v[64:67], a[96:103], v3
    v_smfmac_f32_16x16x64_bf16 v[104:107], v[68:71], a[104:111], v3
    v_smfmac_f32_16x16x64_bf16 v[108:111], v[64:67], a[112:119], v3
    v_smfmac_f32_16x16x64_bf16 v[108:111], v[68:71], a[120:127], v3
    s_add_u32 s46, s65, 4096
    buffer_load_dwordx4 v[32:35], v15, s[12:15], s65 offen offset:0
    buffer_load_dwordx4 v[48:51], v15, s[12:15], s46 offen offset:0
    buffer_load_dwordx4 v[36:39], v15, s[12:15], s65 offen offset:1024
    buffer_load_dwordx4 v[52:55], v15, s[12:15], s46 offen offset:1024
    buffer_load_dwordx4 v[40:43], v15, s[12:15], s65 offen offset:2048
    buffer_load_dwordx4 v[56:59], v15, s[12:15], s46 offen offset:2048
    buffer_load_dwordx4 v[44:47], v15, s[12:15], s65 offen offset:3072
    buffer_load_dwordx4 v[60:63], v15, s[12:15], s46 offen offset:3072
    s_add_u32 s65, s65, 786432
    v_permlane32_swap_b32 v96, v98
    v_permlane32_swap_b32 v97, v99
    v_add_f32 v96, v96, v98
    v_add_f32 v97, v97, v99
    v_cvt_pk_bf16_f32 v96, v96, v97
    ds_write_b32 v12, v96 offset:0
    v_permlane32_swap_b32 v100, v102
    v_permlane32_swap_b32 v101, v103
    v_add_f32 v100, v100, v102
    v_add_f32 v101, v101, v103
    v_cvt_pk_bf16_f32 v100, v100, v101
    ds_write_b32 v12, v100 offset:1024
    v_permlane32_swap_b32 v104, v106
    v_permlane32_swap_b32 v105, v107
    v_add_f32 v104, v104, v106
    v_add_f32 v105, v105, v107
    v_cvt_pk_bf16_f32 v104, v104, v105
    ds_write_b32 v12, v104 offset:2048
    v_permlane32_swap_b32 v108, v110
    v_permlane32_swap_b32 v109, v111
    v_add_f32 v108, v108, v110
    v_add_f32 v109, v109, v111
    v_cvt_pk_bf16_f32 v108, v108, v109
    ds_write_b32 v12, v108 offset:3072
    s_waitcnt lgkmcnt(0)
    s_barrier
    ds_read_b128 v[96:99], v2 offset:16384
    ds_read_b128 v[100:103], v2 offset:17408
    ds_read_b128 v[104:107], v2 offset:18432
    ds_read_b128 v[108:111], v2 offset:19456
    ds_read_b128 v[112:115], v2 offset:20480
    ds_read_b128 v[116:119], v27 offset:21504
    s_waitcnt lgkmcnt(5)
    v_mfma_f32_16x16x32_bf16 v[16:19], v[80:83], v[96:99], 0
    s_waitcnt lgkmcnt(4)
    v_mfma_f32_16x16x32_bf16 v[16:19], v[84:87], v[100:103], v[16:19]
    s_waitcnt lgkmcnt(3)
    v_mfma_f32_16x16x32_bf16 v[16:19], v[88:91], v[104:107], v[16:19]
    s_waitcnt lgkmcnt(2)
    v_mfma_f32_16x16x32_bf16 v[16:19], v[92:95], v[108:111], v[16:19]
    s_waitcnt lgkmcnt(0)
    v_mfma_f32_16x16x32_bf16 v[16:19], v[116:119], v[112:115], v[16:19]
    s_mov_b32 exec_lo, 0x00ff00ff
    s_mov_b32 exec_hi, 0x00ff00ff
    s_nop 5
    v_min_u32 v16, -2, v16
    v_min_u32 v17, -2, v17
    v_min_u32 v18, -2, v18
    v_min_u32 v19, -2, v19
    buffer_store_dwordx4 v[16:19], v6, s[12:15], s63 offen sc1
    s_mov_b64 exec, -1
    s_add_u32 s61, s61, 0x4000
    s_and_b32 s61, s61, 0xffff
    s_mov_b32 s70, 0
    s_sleep 12
    s_waitcnt vmcnt(1)
    buffer_load_dwordx4 v[96:99], v7, s[12:15], s63 offen offset:0 sc1
    buffer_load_dwordx4 v[100:103], v7, s[12:15], s63 offen offset:512 sc1
    buffer_load_dwordx4 v[104:107], v7, s[12:15], s63 offen offset:1024 sc1
    buffer_load_dwordx4 v[108:111], v7, s[12:15], s63 offen offset:1536 sc1
    v_mfma_f32_16x16x32_bf16 v[64:67], v[32:35], a[64:67], 0
    v_mfma_f32_16x16x32_bf16 v[68:71], v[48:51], a[64:67], 0
    v_mfma_f32_16x16x32_bf16 v[64:67], v[36:39], a[68:71], v[64:67]
    v_mfma_f32_16x16x32_bf16 v[68:71], v[52:55], a[68:71], v[68:71]
    v_mfma_f32_16x16x32_bf16 v[64:67], v[40:43], a[72:75], v[64:67]
    v_mfma_f32_16x16x32_bf16 v[68:71], v[56:59], a[72:75], v[68:71]
    v_mfma_f32_16x16x32_bf16 v[64:67], v[44:47], a[76:79], v[64:67]
    v_mfma_f32_16x16x32_bf16 v[68:71], v[60:63], a[76:79], v[68:71]
    v_mfma_f32_16x16x32_bf16 v[72:75], v[32:35], a[80:83], 0
    v_mfma_f32_16x16x32_bf16 v[76:79], v[48:51], a[80:83], 0
    v_mfma_f32_16x16x32_bf16 v[72:75], v[36:39], a[84:87], v[72:75]
    v_mfma_f32_16x16x32_bf16 v[76:79], v[52:55], a[84:87], v[76:79]
    v_mfma_f32_16x16x32_bf16 v[72:75], v[40:43], a[88:91], v[72:75]
    v_mfma_f32_16x16x32_bf16 v[76:79], v[56:59], a[88:91], v[76:79]
    v_mfma_f32_16x16x32_bf16 v[72:75], v[44:47], a[92:95], v[72:75]
    v_mfma_f32_16x16x32_bf16 v[76:79], v[60:63], a[92:95], v[76:79]
    v_cvt_pk_bf16_f32 v64, v64, v65
    v_cvt_pk_bf16_f32 v65, v66, v67
    v_cvt_pk_bf16_f32 v66, v68, v69
    v_cvt_pk_bf16_f32 v67, v70, v71
    ds_write_b128 v10, v[64:67] offset:32768
    v_mfma_f32_16x16x32_bf16 v[80:83], v[32:35], a[96:99], 0
    v_mfma_f32_16x16x32_bf16 v[84:87], v[48:51], a[96:99], 0
    v_mfma_f32_16x16x32_bf16 v[80:83], v[36:39], a[100:103], v[80:83]
    v_mfma_f32_16x16x32_bf16 v[84:87], v[52:55], a[100:103], v[84:87]
    v_mfma_f32_16x16x32_bf16 v[80:83], v[40:43], a[104:107], v[80:83]
    v_mfma_f32_16x16x32_bf16 v[84:87], v[56:59], a[104:107], v[84:87]
    v_mfma_f32_16x16x32_bf16 v[80:83], v[44:47], a[108:111], v[80:83]
    v_mfma_f32_16x16x32_bf16 v[84:87], v[60:63], a[108:111], v[84:87]
    v_cvt_pk_bf16_f32 v72, v72, v73
    v_cvt_pk_bf16_f32 v73, v74, v75
    v_cvt_pk_bf16_f32 v74, v76, v77
    v_cvt_pk_bf16_f32 v75, v78, v79
    ds_write_b128 v10, v[72:75] offset:33792
    v_mfma_f32_16x16x32_bf16 v[88:91], v[32:35], a[112:115], 0
    v_mfma_f32_16x16x32_bf16 v[92:95], v[48:51], a[112:115], 0
    v_mfma_f32_16x16x32_bf16 v[88:91], v[36:39], a[116:119], v[88:91]
    v_mfma_f32_16x16x32_bf16 v[92:95], v[52:55], a[116:119], v[92:95]
    v_mfma_f32_16x16x32_bf16 v[88:91], v[40:43], a[120:123], v[88:91]
    v_mfma_f32_16x16x32_bf16 v[92:95], v[56:59], a[120:123], v[92:95]
    v_mfma_f32_16x16x32_bf16 v[88:91], v[44:47], a[124:127], v[88:91]
    v_mfma_f32_16x16x32_bf16 v[92:95], v[60:63], a[124:127], v[92:95]
    v_cvt_pk_bf16_f32 v80, v80, v81
    v_cvt_pk_bf16_f32 v81, v82, v83
    v_cvt_pk_bf16_f32 v82, v84, v85
    v_cvt_pk_bf16_f32 v83, v86, v87
    ds_write_b128 v10, v[80:83] offset:34816
    s_nop 2
    v_cvt_pk_bf16_f32 v88, v88, v89
    v_cvt_pk_bf16_f32 v89, v90, v91
    v_cvt_pk_bf16_f32 v90, v92, v93
    v_cvt_pk_bf16_f32 v91, v94, v95
    ds_write_b128 v10, v[88:91] offset:35840
L_v_gp_120:
    s_waitcnt vmcnt(2)
    v_pk_add_f32 v[16:17], v[96:97], v[100:101]
    v_pk_add_f32 v[18:19], v[98:99], v[102:103]
    s_waitcnt vmcnt(0)
    v_pk_add_f32 v[20:21], v[104:105], v[108:109]
    v_pk_add_f32 v[22:23], v[106:107], v[110:111]
    v_pk_add_f32 v[16:17], v[16:17], v[20:21]
    v_pk_add_f32 v[18:19], v[18:19], v[22:23]
    v_max3_u32 v24, v96, v97, v98
    v_max3_u32 v24, v24, v99, v100
    v_max3_u32 v24, v24, v101, v102
    v_max3_u32 v24, v24, v103, v104
    v_max3_u32 v24, v24, v105, v106
    v_max3_u32 v24, v24, v107, v108
    v_max3_u32 v24, v24, v109, v110
    v_max_u32 v24, v24, v111
    v_cmp_eq_u32 vcc, -1, v24
    s_add_u32 s70, s70, 1
    s_cbranch_vccz L_v_gok_121
    buffer_load_dwordx4 v[96:99], v7, s[12:15], s63 offen offset:0 sc1
    buffer_load_dwordx4 v[100:103], v7, s[12:15], s63 offen offset:512 sc1
    buffer_load_dwordx4 v[104:107], v7, s[12:15], s63 offen offset:1024 sc1
    buffer_load_dwordx4 v[108:111], v7, s[12:15], s63 offen offset:1536 sc1
    s_cmp_lt_u32 s70, 524288
    s_cbranch_scc1 L_v_gp_120
    s_branch L_c_done_7
L_v_gok_121:
    v_add_f32_dpp v20, v16, v16 row_ror:8 row_mask:0xf bank_mask:0x3
    v_add_f32_dpp v21, v17, v17 row_ror:8 row_mask:0xf bank_mask:0x3
    v_add_f32_dpp v20, v18, v18 row_ror:8 row_mask:0xf bank_mask:0xc
    v_add_f32_dpp v21, v19, v19 row_ror:8 row_mask:0xf bank_mask:0xc
    v_cvt_pk_bf16_f32 v20, v20, v21
    v_min_u32 v20, -2, v20
    buffer_store_dword v20, v8, s[12:15], s61 offen sc1
    s_xor_b32 s45, s61, 0x8000
    buffer_store_dword v26, v8, s[12:15], s45 offen sc1
    s_bitcmp1_b32 s44, 0
    s_cbranch_scc1 L_v_nr_122
    s_xor_b32 s45, s62, 0x4000
    buffer_store_dword v26, v4, s[12:15], s45 offen sc1
L_v_nr_122:
    s_add_u32 s60, s60, 1
    s_add_u32 s62, s62, 0x2000
    s_and_b32 s62, s62, 0x7fff
    s_add_u32 s63, s63, 262144
    s_sleep 3
    s_branch L_v_loop_112
L_v_last_115:
    s_waitcnt lgkmcnt(0)
    s_barrier
    s_branch L_c_done_7
L_c_done_7:
    s_endpgm
.section .rodata,"a"
.p2align 6
.amdhsa_kernel k0_mod_kernel
  .amdhsa_next_free_vgpr 128
  .amdhsa_next_free_sgpr 102
  .amdhsa_accum_offset 128
  .amdhsa_group_segment_fixed_size 0
  .amdhsa_kernarg_size 136
  .amdhsa_user_sgpr_count 2
  .amdhsa_user_sgpr_kernarg_segment_ptr 1
  .amdhsa_system_sgpr_workgroup_id_x 1
.end_amdhsa_kernel
.p2align 6
.amdhsa_kernel k1_ln_kernel
  .amdhsa_next_free_vgpr 88
  .amdhsa_next_free_sgpr 102
  .amdhsa_accum_offset 88
  .amdhsa_group_segment_fixed_size 0
  .amdhsa_kernarg_size 136
  .amdhsa_user_sgpr_count 2
  .amdhsa_user_sgpr_kernarg_segment_ptr 1
  .amdhsa_system_sgpr_workgroup_id_x 1
.end_amdhsa_kernel
.p2align 6
.amdhsa_kernel k2_qkv_kernel
  .amdhsa_next_free_vgpr 128
  .amdhsa_next_free_sgpr 102
  .amdhsa_accum_offset 128
  .amdhsa_group_segment_fixed_size 0
  .amdhsa_kernarg_size 136
  .amdhsa_user_sgpr_count 2
  .amdhsa_user_sgpr_kernarg_segment_ptr 1
  .amdhsa_system_sgpr_workgroup_id_x 1
.end_amdhsa_kernel
.p2align 6
.amdhsa_kernel k3_chain_kernel
  .amdhsa_next_free_vgpr 256
  .amdhsa_next_free_sgpr 102
  .amdhsa_accum_offset 128
  .amdhsa_group_segment_fixed_size 0
  .amdhsa_kernarg_size 136
  .amdhsa_user_sgpr_count 2
  .amdhsa_user_sgpr_kernarg_segment_ptr 1
  .amdhsa_system_sgpr_workgroup_id_x 1
.end_amdhsa_kernel
```

```asm
; @launch kernel=k0_mod_kernel grid=(192,1,1) block=(256,1,1) lds=8192
; @launch kernel=k3_chain_kernel grid=(256,1,1) block=(512,1,1) lds=147712
.amdgcn_target "amdgcn-amd-amdhsa--gfx950"
.text
.globl k0_mod_kernel
.p2align 8
.type k0_mod_kernel,@function
k0_mod_kernel:
    s_cmp_ge_u32 s2, 192
    s_cbranch_scc1 L_mod_done_1
    s_load_dwordx2 s[4:5], s[0:1], 96
    s_load_dwordx2 s[6:7], s[0:1], 104
    s_load_dwordx2 s[20:21], s[0:1], 128
    s_load_dwordx2 s[22:23], s[0:1], 8
    v_and_b32 v1, 3, v0
    v_lshrrev_b32 v2, 2, v0
    s_waitcnt lgkmcnt(0)
    s_mov_b32 s8, s4
    s_and_b32 s9, s5, 0xffff
    s_mov_b32 s10, 0x800
    s_mov_b32 s11, 0x00020000
    s_mov_b32 s12, s6
    s_and_b32 s13, s7, 0xffff
    s_mov_b32 s14, 0xc00000
    s_mov_b32 s15, 0x00020000
    s_mov_b32 s16, s20
    s_and_b32 s17, s21, 0xffff
    s_mov_b32 s18, 0x10000000
    s_mov_b32 s19, 0x00020000
    s_mov_b32 s32, s22
    s_and_b32 s33, s23, 0xffff
    s_mov_b32 s34, 0x4000
    s_mov_b32 s35, 0x00020000
    v_lshlrev_b32 v3, 5, v2
    buffer_load_dwordx4 v[8:11], v3, s[8:11], 0 offen
    buffer_load_dwordx4 v[12:15], v3, s[8:11], 0 offen offset:16
    s_mov_b32 s36, 196608
    v_mul_lo_u32 v4, v2, s36
    v_lshlrev_b32 v5, 4, v1
    v_add_u32 v4, v4, v5
    s_lshl_b32 s37, s2, 6
    buffer_load_dwordx4 v[32:35], v4, s[12:15], s37 offen
    v_add_u32 v4, 12288, v4
    buffer_load_dwordx4 v[36:39], v4, s[12:15], s37 offen
    v_add_u32 v4, 12288, v4
    buffer_load_dwordx4 v[40:43], v4, s[12:15], s37 offen
    v_add_u32 v4, 12288, v4
    buffer_load_dwordx4 v[44:47], v4, s[12:15], s37 offen
    v_add_u32 v4, 12288, v4
    buffer_load_dwordx4 v[48:51], v4, s[12:15], s37 offen
    v_add_u32 v4, 12288, v4
    buffer_load_dwordx4 v[52:55], v4, s[12:15], s37 offen
    v_add_u32 v4, 12288, v4
    buffer_load_dwordx4 v[56:59], v4, s[12:15], s37 offen
    v_add_u32 v4, 12288, v4
    buffer_load_dwordx4 v[60:63], v4, s[12:15], s37 offen
    v_add_u32 v4, 12288, v4
    buffer_load_dwordx4 v[64:67], v4, s[12:15], s37 offen
    v_add_u32 v4, 12288, v4
    buffer_load_dwordx4 v[68:71], v4, s[12:15], s37 offen
    v_add_u32 v4, 12288, v4
    buffer_load_dwordx4 v[72:75], v4, s[12:15], s37 offen
    v_add_u32 v4, 12288, v4
    buffer_load_dwordx4 v[76:79], v4, s[12:15], s37 offen
    v_add_u32 v4, 12288, v4
    buffer_load_dwordx4 v[80:83], v4, s[12:15], s37 offen
    v_add_u32 v4, 12288, v4
    buffer_load_dwordx4 v[84:87], v4, s[12:15], s37 offen
    v_add_u32 v4, 12288, v4
    buffer_load_dwordx4 v[88:91], v4, s[12:15], s37 offen
    v_add_u32 v4, 12288, v4
    buffer_load_dwordx4 v[92:95], v4, s[12:15], s37 offen
    s_load_dwordx4 s[40:43], s[0:1], 16
    s_load_dwordx2 s[44:45], s[0:1], 32
    s_lshl_b32 s38, s2, 12
    v_lshlrev_b32 v7, 4, v0
    v_add_u32 v7, s38, v7
    s_waitcnt lgkmcnt(0)
    s_mov_b32 s48, s40
    s_and_b32 s49, s41, 0xffff
    s_mov_b32 s50, 0x800000
    s_mov_b32 s51, 0x00020000
    s_mov_b32 s38, 0
    buffer_load_dwordx4 v[120:123], v7, s[48:51], s38 offen
    s_mov_b32 s38, 786432
    buffer_load_dwordx4 v[124:127], v7, s[48:51], s38 offen
    s_mov_b32 s38, 1572864
    buffer_load_dwordx4 v[120:123], v7, s[48:51], s38 offen
    s_mov_b32 s38, 2359296
    buffer_load_dwordx4 v[124:127], v7, s[48:51], s38 offen
    s_mov_b32 s38, 3145728
    buffer_load_dwordx4 v[120:123], v7, s[48:51], s38 offen
    s_mov_b32 s38, 3932160
    buffer_load_dwordx4 v[124:127], v7, s[48:51], s38 offen
    s_mov_b32 s38, 4718592
    buffer_load_dwordx4 v[120:123], v7, s[48:51], s38 offen
    s_mov_b32 s38, 5505024
    buffer_load_dwordx4 v[124:127], v7, s[48:51], s38 offen
    s_mov_b32 s38, 6291456
    buffer_load_dwordx4 v[120:123], v7, s[48:51], s38 offen
    s_mov_b32 s38, 7077888
    buffer_load_dwordx4 v[124:127], v7, s[48:51], s38 offen
    s_mov_b32 s38, 7864320
    buffer_load_dwordx4 v[120:123], v7, s[48:51], s38 offen
    s_mov_b32 s48, s42
    s_and_b32 s49, s43, 0xffff
    s_mov_b32 s50, 0x800000
    s_mov_b32 s51, 0x00020000
    s_mov_b32 s38, 0
    buffer_load_dwordx4 v[120:123], v7, s[48:51], s38 offen
    s_mov_b32 s38, 786432
    buffer_load_dwordx4 v[124:127], v7, s[48:51], s38 offen
    s_mov_b32 s38, 1572864
    buffer_load_dwordx4 v[120:123], v7, s[48:51], s38 offen
    s_mov_b32 s38, 2359296
    buffer_load_dwordx4 v[124:127], v7, s[48:51], s38 offen
    s_mov_b32 s38, 3145728
    buffer_load_dwordx4 v[120:123], v7, s[48:51], s38 offen
    s_mov_b32 s38, 3932160
    buffer_load_dwordx4 v[124:127], v7, s[48:51], s38 offen
    s_mov_b32 s38, 4718592
    buffer_load_dwordx4 v[120:123], v7, s[48:51], s38 offen
    s_mov_b32 s38, 5505024
    buffer_load_dwordx4 v[124:127], v7, s[48:51], s38 offen
    s_mov_b32 s38, 6291456
    buffer_load_dwordx4 v[120:123], v7, s[48:51], s38 offen
    s_mov_b32 s38, 7077888
    buffer_load_dwordx4 v[124:127], v7, s[48:51], s38 offen
    s_mov_b32 s38, 7864320
    buffer_load_dwordx4 v[120:123], v7, s[48:51], s38 offen
    s_cmp_ge_u32 s2, 16
    s_cbranch_scc1 L_mod_skipm_2
    s_lshl_b32 s38, s2, 12
    v_lshlrev_b32 v7, 4, v0
    v_add_u32 v7, s38, v7
    v_mov_b32 v104, 0
    v_mov_b32 v105, 0
    v_mov_b32 v106, 0
    v_mov_b32 v107, 0
    s_mov_b32 s39, 0x100000
    buffer_store_dwordx4 v[104:107], v7, s[16:19], s39 offen
L_mod_skipm_2:
    s_waitcnt vmcnt(0)
    v_lshlrev_b32 v16, 16, v8
    v_and_b32 v17, 0xffff0000, v8
    v_lshlrev_b32 v18, 16, v9
    v_and_b32 v19, 0xffff0000, v9
    v_lshlrev_b32 v20, 16, v10
    v_and_b32 v21, 0xffff0000, v10
    v_lshlrev_b32 v22, 16, v11
    v_and_b32 v23, 0xffff0000, v11
    v_lshlrev_b32 v24, 16, v12
    v_and_b32 v25, 0xffff0000, v12
    v_lshlrev_b32 v26, 16, v13
    v_and_b32 v27, 0xffff0000, v13
    v_lshlrev_b32 v28, 16, v14
    v_and_b32 v29, 0xffff0000, v14
    v_lshlrev_b32 v30, 16, v15
    v_and_b32 v31, 0xffff0000, v15
    v_mul_f32 v110, 0xbfb8aa3b, v16
    v_exp_f32 v110, v110
    s_nop 0
    v_add_f32 v110, 1.0, v110
    v_rcp_f32 v110, v110
    s_nop 0
    v_mul_f32 v16, v16, v110
    v_cvt_pk_bf16_f32 v16, v16, v16
    v_lshlrev_b32 v16, 16, v16
    v_mul_f32 v110, 0xbfb8aa3b, v17
    v_exp_f32 v110, v110
    s_nop 0
    v_add_f32 v110, 1.0, v110
    v_rcp_f32 v110, v110
    s_nop 0
    v_mul_f32 v17, v17, v110
    v_cvt_pk_bf16_f32 v17, v17, v17
    v_lshlrev_b32 v17, 16, v17
    v_mul_f32 v110, 0xbfb8aa3b, v18
    v_exp_f32 v110, v110
    s_nop 0
    v_add_f32 v110, 1.0, v110
    v_rcp_f32 v110, v110
    s_nop 0
    v_mul_f32 v18, v18, v110
    v_cvt_pk_bf16_f32 v18, v18, v18
    v_lshlrev_b32 v18, 16, v18
    v_mul_f32 v110, 0xbfb8aa3b, v19
    v_exp_f32 v110, v110
    s_nop 0
    v_add_f32 v110, 1.0, v110
    v_rcp_f32 v110, v110
    s_nop 0
    v_mul_f32 v19, v19, v110
    v_cvt_pk_bf16_f32 v19, v19, v19
    v_lshlrev_b32 v19, 16, v19
    v_mul_f32 v110, 0xbfb8aa3b, v20
    v_exp_f32 v110, v110
    s_nop 0
    v_add_f32 v110, 1.0, v110
    v_rcp_f32 v110, v110
    s_nop 0
    v_mul_f32 v20, v20, v110
    v_cvt_pk_bf16_f32 v20, v20, v20
    v_lshlrev_b32 v20, 16, v20
    v_mul_f32 v110, 0xbfb8aa3b, v21
    v_exp_f32 v110, v110
    s_nop 0
    v_add_f32 v110, 1.0, v110
    v_rcp_f32 v110, v110
    s_nop 0
    v_mul_f32 v21, v21, v110
    v_cvt_pk_bf16_f32 v21, v21, v21
    v_lshlrev_b32 v21, 16, v21
    v_mul_f32 v110, 0xbfb8aa3b, v22
    v_exp_f32 v110, v110
    s_nop 0
    v_add_f32 v110, 1.0, v110
    v_rcp_f32 v110, v110
    s_nop 0
    v_mul_f32 v22, v22, v110
    v_cvt_pk_bf16_f32 v22, v22, v22
    v_lshlrev_b32 v22, 16, v22
    v_mul_f32 v110, 0xbfb8aa3b, v23
    v_exp_f32 v110, v110
    s_nop 0
    v_add_f32 v110, 1.0, v110
    v_rcp_f32 v110, v110
    s_nop 0
    v_mul_f32 v23, v23, v110
    v_cvt_pk_bf16_f32 v23, v23, v23
    v_lshlrev_b32 v23, 16, v23
    v_mul_f32 v110, 0xbfb8aa3b, v24
    v_exp_f32 v110, v110
    s_nop 0
    v_add_f32 v110, 1.0, v110
    v_rcp_f32 v110, v110
    s_nop 0
    v_mul_f32 v24, v24, v110
    v_cvt_pk_bf16_f32 v24, v24, v24
    v_lshlrev_b32 v24, 16, v24
    v_mul_f32 v110, 0xbfb8aa3b, v25
    v_exp_f32 v110, v110
    s_nop 0
    v_add_f32 v110, 1.0, v110
    v_rcp_f32 v110, v110
    s_nop 0
    v_mul_f32 v25, v25, v110
    v_cvt_pk_bf16_f32 v25, v25, v25
    v_lshlrev_b32 v25, 16, v25
    v_mul_f32 v110, 0xbfb8aa3b, v26
    v_exp_f32 v110, v110
    s_nop 0
    v_add_f32 v110, 1.0, v110
    v_rcp_f32 v110, v110
    s_nop 0
    v_mul_f32 v26, v26, v110
    v_cvt_pk_bf16_f32 v26, v26, v26
    v_lshlrev_b32 v26, 16, v26
    v_mul_f32 v110, 0xbfb8aa3b, v27
    v_exp_f32 v110, v110
    s_nop 0
    v_add_f32 v110, 1.0, v110
    v_rcp_f32 v110, v110
    s_nop 0
    v_mul_f32 v27, v27, v110
    v_cvt_pk_bf16_f32 v27, v27, v27
    v_lshlrev_b32 v27, 16, v27
    v_mul_f32 v110, 0xbfb8aa3b, v28
    v_exp_f32 v110, v110
    s_nop 0
    v_add_f32 v110, 1.0, v110
    v_rcp_f32 v110, v110
    s_nop 0
    v_mul_f32 v28, v28, v110
    v_cvt_pk_bf16_f32 v28, v28, v28
    v_lshlrev_b32 v28, 16, v28
    v_mul_f32 v110, 0xbfb8aa3b, v29
    v_exp_f32 v110, v110
    s_nop 0
    v_add_f32 v110, 1.0, v110
    v_rcp_f32 v110, v110
    s_nop 0
    v_mul_f32 v29, v29, v110
    v_cvt_pk_bf16_f32 v29, v29, v29
    v_lshlrev_b32 v29, 16, v29
    v_mul_f32 v110, 0xbfb8aa3b, v30
    v_exp_f32 v110, v110
    s_nop 0
    v_add_f32 v110, 1.0, v110
    v_rcp_f32 v110, v110
    s_nop 0
    v_mul_f32 v30, v30, v110
    v_cvt_pk_bf16_f32 v30, v30, v30
    v_lshlrev_b32 v30, 16, v30
    v_mul_f32 v110, 0xbfb8aa3b, v31
    v_exp_f32 v110, v110
    s_nop 0
    v_add_f32 v110, 1.0, v110
    v_rcp_f32 v110, v110
    s_nop 0
    v_mul_f32 v31, v31, v110
    v_cvt_pk_bf16_f32 v31, v31, v31
    v_lshlrev_b32 v31, 16, v31
    v_mov_b32 v112, 0
    v_mov_b32 v113, 0
    v_mov_b32 v114, 0
    v_mov_b32 v115, 0
    v_mov_b32 v116, 0
    v_mov_b32 v117, 0
    v_mov_b32 v118, 0
    v_mov_b32 v119, 0
    v_lshlrev_b32 v110, 16, v32
    v_and_b32 v111, 0xffff0000, v32
    v_fmac_f32 v112, v110, v16
    v_fmac_f32 v113, v111, v16
    v_lshlrev_b32 v110, 16, v33
    v_and_b32 v111, 0xffff0000, v33
    v_fmac_f32 v114, v110, v16
    v_fmac_f32 v115, v111, v16
    v_lshlrev_b32 v110, 16, v34
    v_and_b32 v111, 0xffff0000, v34
    v_fmac_f32 v116, v110, v16
    v_fmac_f32 v117, v111, v16
    v_lshlrev_b32 v110, 16, v35
    v_and_b32 v111, 0xffff0000, v35
    v_fmac_f32 v118, v110, v16
    v_fmac_f32 v119, v111, v16
    v_lshlrev_b32 v110, 16, v36
    v_and_b32 v111, 0xffff0000, v36
    v_fmac_f32 v112, v110, v17
    v_fmac_f32 v113, v111, v17
    v_lshlrev_b32 v110, 16, v37
    v_and_b32 v111, 0xffff0000, v37
    v_fmac_f32 v114, v110, v17
    v_fmac_f32 v115, v111, v17
    v_lshlrev_b32 v110, 16, v38
    v_and_b32 v111, 0xffff0000, v38
    v_fmac_f32 v116, v110, v17
    v_fmac_f32 v117, v111, v17
    v_lshlrev_b32 v110, 16, v39
    v_and_b32 v111, 0xffff0000, v39
    v_fmac_f32 v118, v110, v17
    v_fmac_f32 v119, v111, v17
    v_lshlrev_b32 v110, 16, v40
    v_and_b32 v111, 0xffff0000, v40
    v_fmac_f32 v112, v110, v18
    v_fmac_f32 v113, v111, v18
    v_lshlrev_b32 v110, 16, v41
    v_and_b32 v111, 0xffff0000, v41
    v_fmac_f32 v114, v110, v18
    v_fmac_f32 v115, v111, v18
    v_lshlrev_b32 v110, 16, v42
    v_and_b32 v111, 0xffff0000, v42
    v_fmac_f32 v116, v110, v18
    v_fmac_f32 v117, v111, v18
    v_lshlrev_b32 v110, 16, v43
    v_and_b32 v111, 0xffff0000, v43
    v_fmac_f32 v118, v110, v18
    v_fmac_f32 v119, v111, v18
    v_lshlrev_b32 v110, 16, v44
    v_and_b32 v111, 0xffff0000, v44
    v_fmac_f32 v112, v110, v19
    v_fmac_f32 v113, v111, v19
    v_lshlrev_b32 v110, 16, v45
    v_and_b32 v111, 0xffff0000, v45
    v_fmac_f32 v114, v110, v19
    v_fmac_f32 v115, v111, v19
    v_lshlrev_b32 v110, 16, v46
    v_and_b32 v111, 0xffff0000, v46
    v_fmac_f32 v116, v110, v19
    v_fmac_f32 v117, v111, v19
    v_lshlrev_b32 v110, 16, v47
    v_and_b32 v111, 0xffff0000, v47
    v_fmac_f32 v118, v110, v19
    v_fmac_f32 v119, v111, v19
    v_lshlrev_b32 v110, 16, v48
    v_and_b32 v111, 0xffff0000, v48
    v_fmac_f32 v112, v110, v20
    v_fmac_f32 v113, v111, v20
    v_lshlrev_b32 v110, 16, v49
    v_and_b32 v111, 0xffff0000, v49
    v_fmac_f32 v114, v110, v20
    v_fmac_f32 v115, v111, v20
    v_lshlrev_b32 v110, 16, v50
    v_and_b32 v111, 0xffff0000, v50
    v_fmac_f32 v116, v110, v20
    v_fmac_f32 v117, v111, v20
    v_lshlrev_b32 v110, 16, v51
    v_and_b32 v111, 0xffff0000, v51
    v_fmac_f32 v118, v110, v20
    v_fmac_f32 v119, v111, v20
    v_lshlrev_b32 v110, 16, v52
    v_and_b32 v111, 0xffff0000, v52
    v_fmac_f32 v112, v110, v21
    v_fmac_f32 v113, v111, v21
    v_lshlrev_b32 v110, 16, v53
    v_and_b32 v111, 0xffff0000, v53
    v_fmac_f32 v114, v110, v21
    v_fmac_f32 v115, v111, v21
    v_lshlrev_b32 v110, 16, v54
    v_and_b32 v111, 0xffff0000, v54
    v_fmac_f32 v116, v110, v21
    v_fmac_f32 v117, v111, v21
    v_lshlrev_b32 v110, 16, v55
    v_and_b32 v111, 0xffff0000, v55
    v_fmac_f32 v118, v110, v21
    v_fmac_f32 v119, v111, v21
    v_lshlrev_b32 v110, 16, v56
    v_and_b32 v111, 0xffff0000, v56
    v_fmac_f32 v112, v110, v22
    v_fmac_f32 v113, v111, v22
    v_lshlrev_b32 v110, 16, v57
    v_and_b32 v111, 0xffff0000, v57
    v_fmac_f32 v114, v110, v22
    v_fmac_f32 v115, v111, v22
    v_lshlrev_b32 v110, 16, v58
    v_and_b32 v111, 0xffff0000, v58
    v_fmac_f32 v116, v110, v22
    v_fmac_f32 v117, v111, v22
    v_lshlrev_b32 v110, 16, v59
    v_and_b32 v111, 0xffff0000, v59
    v_fmac_f32 v118, v110, v22
    v_fmac_f32 v119, v111, v22
    v_lshlrev_b32 v110, 16, v60
    v_and_b32 v111, 0xffff0000, v60
    v_fmac_f32 v112, v110, v23
    v_fmac_f32 v113, v111, v23
    v_lshlrev_b32 v110, 16, v61
    v_and_b32 v111, 0xffff0000, v61
    v_fmac_f32 v114, v110, v23
    v_fmac_f32 v115, v111, v23
    v_lshlrev_b32 v110, 16, v62
    v_and_b32 v111, 0xffff0000, v62
    v_fmac_f32 v116, v110, v23
    v_fmac_f32 v117, v111, v23
    v_lshlrev_b32 v110, 16, v63
    v_and_b32 v111, 0xffff0000, v63
    v_fmac_f32 v118, v110, v23
    v_fmac_f32 v119, v111, v23
    v_lshlrev_b32 v110, 16, v64
    v_and_b32 v111, 0xffff0000, v64
    v_fmac_f32 v112, v110, v24
    v_fmac_f32 v113, v111, v24
    v_lshlrev_b32 v110, 16, v65
    v_and_b32 v111, 0xffff0000, v65
    v_fmac_f32 v114, v110, v24
    v_fmac_f32 v115, v111, v24
    v_lshlrev_b32 v110, 16, v66
    v_and_b32 v111, 0xffff0000, v66
    v_fmac_f32 v116, v110, v24
    v_fmac_f32 v117, v111, v24
    v_lshlrev_b32 v110, 16, v67
    v_and_b32 v111, 0xffff0000, v67
    v_fmac_f32 v118, v110, v24
    v_fmac_f32 v119, v111, v24
    v_lshlrev_b32 v110, 16, v68
    v_and_b32 v111, 0xffff0000, v68
    v_fmac_f32 v112, v110, v25
    v_fmac_f32 v113, v111, v25
    v_lshlrev_b32 v110, 16, v69
    v_and_b32 v111, 0xffff0000, v69
    v_fmac_f32 v114, v110, v25
    v_fmac_f32 v115, v111, v25
    v_lshlrev_b32 v110, 16, v70
    v_and_b32 v111, 0xffff0000, v70
    v_fmac_f32 v116, v110, v25
    v_fmac_f32 v117, v111, v25
    v_lshlrev_b32 v110, 16, v71
    v_and_b32 v111, 0xffff0000, v71
    v_fmac_f32 v118, v110, v25
    v_fmac_f32 v119, v111, v25
    v_lshlrev_b32 v110, 16, v72
    v_and_b32 v111, 0xffff0000, v72
    v_fmac_f32 v112, v110, v26
    v_fmac_f32 v113, v111, v26
    v_lshlrev_b32 v110, 16, v73
    v_and_b32 v111, 0xffff0000, v73
    v_fmac_f32 v114, v110, v26
    v_fmac_f32 v115, v111, v26
    v_lshlrev_b32 v110, 16, v74
    v_and_b32 v111, 0xffff0000, v74
    v_fmac_f32 v116, v110, v26
    v_fmac_f32 v117, v111, v26
    v_lshlrev_b32 v110, 16, v75
    v_and_b32 v111, 0xffff0000, v75
    v_fmac_f32 v118, v110, v26
    v_fmac_f32 v119, v111, v26
    v_lshlrev_b32 v110, 16, v76
    v_and_b32 v111, 0xffff0000, v76
    v_fmac_f32 v112, v110, v27
    v_fmac_f32 v113, v111, v27
    v_lshlrev_b32 v110, 16, v77
    v_and_b32 v111, 0xffff0000, v77
    v_fmac_f32 v114, v110, v27
    v_fmac_f32 v115, v111, v27
    v_lshlrev_b32 v110, 16, v78
    v_and_b32 v111, 0xffff0000, v78
    v_fmac_f32 v116, v110, v27
    v_fmac_f32 v117, v111, v27
    v_lshlrev_b32 v110, 16, v79
    v_and_b32 v111, 0xffff0000, v79
    v_fmac_f32 v118, v110, v27
    v_fmac_f32 v119, v111, v27
    v_lshlrev_b32 v110, 16, v80
    v_and_b32 v111, 0xffff0000, v80
    v_fmac_f32 v112, v110, v28
    v_fmac_f32 v113, v111, v28
    v_lshlrev_b32 v110, 16, v81
    v_and_b32 v111, 0xffff0000, v81
    v_fmac_f32 v114, v110, v28
    v_fmac_f32 v115, v111, v28
    v_lshlrev_b32 v110, 16, v82
    v_and_b32 v111, 0xffff0000, v82
    v_fmac_f32 v116, v110, v28
    v_fmac_f32 v117, v111, v28
    v_lshlrev_b32 v110, 16, v83
    v_and_b32 v111, 0xffff0000, v83
    v_fmac_f32 v118, v110, v28
    v_fmac_f32 v119, v111, v28
    v_lshlrev_b32 v110, 16, v84
    v_and_b32 v111, 0xffff0000, v84
    v_fmac_f32 v112, v110, v29
    v_fmac_f32 v113, v111, v29
    v_lshlrev_b32 v110, 16, v85
    v_and_b32 v111, 0xffff0000, v85
    v_fmac_f32 v114, v110, v29
    v_fmac_f32 v115, v111, v29
    v_lshlrev_b32 v110, 16, v86
    v_and_b32 v111, 0xffff0000, v86
    v_fmac_f32 v116, v110, v29
    v_fmac_f32 v117, v111, v29
    v_lshlrev_b32 v110, 16, v87
    v_and_b32 v111, 0xffff0000, v87
    v_fmac_f32 v118, v110, v29
    v_fmac_f32 v119, v111, v29
    v_lshlrev_b32 v110, 16, v88
    v_and_b32 v111, 0xffff0000, v88
    v_fmac_f32 v112, v110, v30
    v_fmac_f32 v113, v111, v30
    v_lshlrev_b32 v110, 16, v89
    v_and_b32 v111, 0xffff0000, v89
    v_fmac_f32 v114, v110, v30
    v_fmac_f32 v115, v111, v30
    v_lshlrev_b32 v110, 16, v90
    v_and_b32 v111, 0xffff0000, v90
    v_fmac_f32 v116, v110, v30
    v_fmac_f32 v117, v111, v30
    v_lshlrev_b32 v110, 16, v91
    v_and_b32 v111, 0xffff0000, v91
    v_fmac_f32 v118, v110, v30
    v_fmac_f32 v119, v111, v30
    v_lshlrev_b32 v110, 16, v92
    v_and_b32 v111, 0xffff0000, v92
    v_fmac_f32 v112, v110, v31
    v_fmac_f32 v113, v111, v31
    v_lshlrev_b32 v110, 16, v93
    v_and_b32 v111, 0xffff0000, v93
    v_fmac_f32 v114, v110, v31
    v_fmac_f32 v115, v111, v31
    v_lshlrev_b32 v110, 16, v94
    v_and_b32 v111, 0xffff0000, v94
    v_fmac_f32 v116, v110, v31
    v_fmac_f32 v117, v111, v31
    v_lshlrev_b32 v110, 16, v95
    v_and_b32 v111, 0xffff0000, v95
    v_fmac_f32 v118, v110, v31
    v_fmac_f32 v119, v111, v31
    v_lshlrev_b32 v3, 5, v0
    ds_write_b128 v3, v[112:115]
    ds_write_b128 v3, v[116:119] offset:16
    s_waitcnt lgkmcnt(0)
    s_barrier
    v_cmp_gt_u32 vcc, 32, v0
    s_and_saveexec_b64 s[40:41], vcc
    s_cbranch_execz L_mod_fin_3
    v_lshlrev_b32 v3, 2, v0
    v_mov_b32 v5, 0
    ds_read_b32 v32, v3 offset:0
    ds_read_b32 v33, v3 offset:128
    ds_read_b32 v34, v3 offset:256
    ds_read_b32 v35, v3 offset:384
    ds_read_b32 v36, v3 offset:512
    ds_read_b32 v37, v3 offset:640
    ds_read_b32 v38, v3 offset:768
    ds_read_b32 v39, v3 offset:896
    ds_read_b32 v40, v3 offset:1024
    ds_read_b32 v41, v3 offset:1152
    ds_read_b32 v42, v3 offset:1280
    ds_read_b32 v43, v3 offset:1408
    ds_read_b32 v44, v3 offset:1536
    ds_read_b32 v45, v3 offset:1664
    ds_read_b32 v46, v3 offset:1792
    ds_read_b32 v47, v3 offset:1920
    s_waitcnt lgkmcnt(0)
    v_add_f32 v5, v5, v32
    v_add_f32 v5, v5, v33
    v_add_f32 v5, v5, v34
    v_add_f32 v5, v5, v35
    v_add_f32 v5, v5, v36
    v_add_f32 v5, v5, v37
    v_add_f32 v5, v5, v38
    v_add_f32 v5, v5, v39
    v_add_f32 v5, v5, v40
    v_add_f32 v5, v5, v41
    v_add_f32 v5, v5, v42
    v_add_f32 v5, v5, v43
    v_add_f32 v5, v5, v44
    v_add_f32 v5, v5, v45
    v_add_f32 v5, v5, v46
    v_add_f32 v5, v5, v47
    ds_read_b32 v32, v3 offset:2048
    ds_read_b32 v33, v3 offset:2176
    ds_read_b32 v34, v3 offset:2304
    ds_read_b32 v35, v3 offset:2432
    ds_read_b32 v36, v3 offset:2560
    ds_read_b32 v37, v3 offset:2688
    ds_read_b32 v38, v3 offset:2816
    ds_read_b32 v39, v3 offset:2944
    ds_read_b32 v40, v3 offset:3072
    ds_read_b32 v41, v3 offset:3200
    ds_read_b32 v42, v3 offset:3328
    ds_read_b32 v43, v3 offset:3456
    ds_read_b32 v44, v3 offset:3584
    ds_read_b32 v45, v3 offset:3712
    ds_read_b32 v46, v3 offset:3840
    ds_read_b32 v47, v3 offset:3968
    s_waitcnt lgkmcnt(0)
    v_add_f32 v5, v5, v32
    v_add_f32 v5, v5, v33
    v_add_f32 v5, v5, v34
    v_add_f32 v5, v5, v35
    v_add_f32 v5, v5, v36
    v_add_f32 v5, v5, v37
    v_add_f32 v5, v5, v38
    v_add_f32 v5, v5, v39
    v_add_f32 v5, v5, v40
    v_add_f32 v5, v5, v41
    v_add_f32 v5, v5, v42
    v_add_f32 v5, v5, v43
    v_add_f32 v5, v5, v44
    v_add_f32 v5, v5, v45
    v_add_f32 v5, v5, v46
    v_add_f32 v5, v5, v47
    ds_read_b32 v32, v3 offset:4096
    ds_read_b32 v33, v3 offset:4224
    ds_read_b32 v34, v3 offset:4352
    ds_read_b32 v35, v3 offset:4480
    ds_read_b32 v36, v3 offset:4608
    ds_read_b32 v37, v3 offset:4736
    ds_read_b32 v38, v3 offset:4864
    ds_read_b32 v39, v3 offset:4992
    ds_read_b32 v40, v3 offset:5120
    ds_read_b32 v41, v3 offset:5248
    ds_read_b32 v42, v3 offset:5376
    ds_read_b32 v43, v3 offset:5504
    ds_read_b32 v44, v3 offset:5632
    ds_read_b32 v45, v3 offset:5760
    ds_read_b32 v46, v3 offset:5888
    ds_read_b32 v47, v3 offset:6016
    s_waitcnt lgkmcnt(0)
    v_add_f32 v5, v5, v32
    v_add_f32 v5, v5, v33
    v_add_f32 v5, v5, v34
    v_add_f32 v5, v5, v35
    v_add_f32 v5, v5, v36
    v_add_f32 v5, v5, v37
    v_add_f32 v5, v5, v38
    v_add_f32 v5, v5, v39
    v_add_f32 v5, v5, v40
    v_add_f32 v5, v5, v41
    v_add_f32 v5, v5, v42
    v_add_f32 v5, v5, v43
    v_add_f32 v5, v5, v44
    v_add_f32 v5, v5, v45
    v_add_f32 v5, v5, v46
    v_add_f32 v5, v5, v47
    ds_read_b32 v32, v3 offset:6144
    ds_read_b32 v33, v3 offset:6272
    ds_read_b32 v34, v3 offset:6400
    ds_read_b32 v35, v3 offset:6528
    ds_read_b32 v36, v3 offset:6656
    ds_read_b32 v37, v3 offset:6784
    ds_read_b32 v38, v3 offset:6912
    ds_read_b32 v39, v3 offset:7040
    ds_read_b32 v40, v3 offset:7168
    ds_read_b32 v41, v3 offset:7296
    ds_read_b32 v42, v3 offset:7424
    ds_read_b32 v43, v3 offset:7552
    ds_read_b32 v44, v3 offset:7680
    ds_read_b32 v45, v3 offset:7808
    ds_read_b32 v46, v3 offset:7936
    ds_read_b32 v47, v3 offset:8064
    s_waitcnt lgkmcnt(0)
    v_add_f32 v5, v5, v32
    v_add_f32 v5, v5, v33
    v_add_f32 v5, v5, v34
    v_add_f32 v5, v5, v35
    v_add_f32 v5, v5, v36
    v_add_f32 v5, v5, v37
    v_add_f32 v5, v5, v38
    v_add_f32 v5, v5, v39
    v_add_f32 v5, v5, v40
    v_add_f32 v5, v5, v41
    v_add_f32 v5, v5, v42
    v_add_f32 v5, v5, v43
    v_add_f32 v5, v5, v44
    v_add_f32 v5, v5, v45
    v_add_f32 v5, v5, v46
    v_add_f32 v5, v5, v47
    v_cvt_pk_bf16_f32 v5, v5, v5
    v_lshlrev_b32 v5, 16, v5
    s_lshl_b32 s38, s2, 7
    buffer_store_dword v5, v3, s[16:19], s38 offen
L_mod_fin_3:
    s_mov_b64 exec, s[40:41]
L_mod_done_1:
    s_endpgm
.globl k3_chain_kernel
.p2align 8
.type k3_chain_kernel,@function
k3_chain_kernel:
    s_cmp_ge_u32 s2, 256
    s_cbranch_scc1 L_c_done_4
    s_load_dwordx2 s[20:21], s[0:1], 128
    v_and_b32 v1, 63, v0
    v_lshrrev_b32 v2, 6, v0
    s_nop 0
    v_readfirstlane_b32 s44, v2
    s_waitcnt lgkmcnt(0)
    s_mov_b32 s12, s20
    s_and_b32 s13, s21, 0xffff
    s_mov_b32 s14, 0x10000000
    s_mov_b32 s15, 0x00020000
    s_getreg_b32 s47, hwreg(HW_REG_XCC_ID)
    s_and_b32 s47, s47, 7
    s_mov_b32 s39, s47
    s_cmp_lg_u32 s44, 0
    s_cbranch_scc1 L_tk_5
    v_mov_b32 v3, 1
    s_lshl_b32 s45, s47, 8
    s_add_u32 s45, s45, 0x100000
    v_mov_b32 v4, 0
    s_mov_b64 exec, 1
    buffer_atomic_add v3, v4, s[12:15], s45 offen sc0
    s_waitcnt vmcnt(0)
    v_readfirstlane_b32 s41, v3
    s_mov_b32 s40, s47
    s_nop 3
    s_cmp_lt_u32 s41, 32
    s_cbranch_scc1 L_got_6
    v_mov_b32 v3, 1
    s_mov_b32 s45, 0x100800
    buffer_atomic_add v3, v4, s[12:15], s45 offen sc0
    s_waitcnt vmcnt(0)
    v_readfirstlane_b32 s46, v3
    s_mov_b64 exec, -1
    v_and_b32 v4, 7, v1
    v_lshlrev_b32 v4, 8, v4
    s_mov_b32 s45, 0x100000
    s_mov_b32 s70, 0
L_sp_7:
    s_sleep 8
    buffer_load_dword v3, v4, s[12:15], s45 offen sc1
    s_waitcnt vmcnt(0)
    s_mov_b32 s48, 0
    v_readlane_b32 s50, v3, 0
    v_readlane_b32 s51, v3, 1
    v_readlane_b32 s52, v3, 2
    v_readlane_b32 s53, v3, 3
    v_readlane_b32 s54, v3, 4
    v_readlane_b32 s55, v3, 5
    v_readlane_b32 s56, v3, 6
    v_readlane_b32 s57, v3, 7
    s_nop 3
    s_add_u32 s48, s48, s50
    s_add_u32 s48, s48, s51
    s_add_u32 s48, s48, s52
    s_add_u32 s48, s48, s53
    s_add_u32 s48, s48, s54
    s_add_u32 s48, s48, s55
    s_add_u32 s48, s48, s56
    s_add_u32 s48, s48, s57
    s_add_u32 s70, s70, 1
    s_cmp_ge_u32 s70, 524288
    s_cbranch_scc1 L_c_done_4
    s_cmp_lt_u32 s48, 256
    s_cbranch_scc1 L_sp_7
    s_min_u32 s48, s50, 32
    s_mov_b32 s40, 0
    s_add_u32 s41, s48, s46
    s_cmp_lt_u32 s41, 32
    s_cbranch_scc1 L_got_6
    s_sub_u32 s46, s41, 32
    s_min_u32 s48, s51, 32
    s_mov_b32 s40, 1
    s_add_u32 s41, s48, s46
    s_cmp_lt_u32 s41, 32
    s_cbranch_scc1 L_got_6
    s_sub_u32 s46, s41, 32
    s_min_u32 s48, s52, 32
    s_mov_b32 s40, 2
    s_add_u32 s41, s48, s46
    s_cmp_lt_u32 s41, 32
    s_cbranch_scc1 L_got_6
    s_sub_u32 s46, s41, 32
    s_min_u32 s48, s53, 32
    s_mov_b32 s40, 3
    s_add_u32 s41, s48, s46
    s_cmp_lt_u32 s41, 32
    s_cbranch_scc1 L_got_6
    s_sub_u32 s46, s41, 32
    s_min_u32 s48, s54, 32
    s_mov_b32 s40, 4
    s_add_u32 s41, s48, s46
    s_cmp_lt_u32 s41, 32
    s_cbranch_scc1 L_got_6
    s_sub_u32 s46, s41, 32
    s_min_u32 s48, s55, 32
    s_mov_b32 s40, 5
    s_add_u32 s41, s48, s46
    s_cmp_lt_u32 s41, 32
    s_cbranch_scc1 L_got_6
    s_sub_u32 s46, s41, 32
    s_min_u32 s48, s56, 32
    s_mov_b32 s40, 6
    s_add_u32 s41, s48, s46
    s_cmp_lt_u32 s41, 32
    s_cbranch_scc1 L_got_6
    s_sub_u32 s46, s41, 32
    s_min_u32 s48, s57, 32
    s_mov_b32 s40, 7
    s_add_u32 s41, s48, s46
    s_cmp_lt_u32 s41, 32
    s_cbranch_scc1 L_got_6
    s_sub_u32 s46, s41, 32
    s_branch L_c_done_4
L_got_6:
    s_mov_b64 exec, -1
    s_lshl_b32 s45, s40, 8
    s_or_b32 s45, s45, s41
    v_mov_b32 v3, s45
    v_mov_b32 v4, 26624
    ds_write_b32 v4, v3
    s_waitcnt lgkmcnt(0)
L_tk_5:
    s_barrier
    v_mov_b32 v4, 26624
    ds_read_b32 v3, v4
    s_waitcnt lgkmcnt(0)
    v_readfirstlane_b32 s45, v3
    s_nop 3
    s_lshr_b32 s40, s45, 8
    s_and_b32 s41, s45, 0xff
    s_barrier
    s_cmp_lt_u32 s41, 16
    s_cbranch_scc1 L_c_chain_16
    s_sub_u32 s48, s41, 16
    s_cmp_lt_u32 s48, 12
    s_cbranch_scc1 L_w_g_17
    s_and_b32 s42, s48, 3
    s_mov_b32 s43, s40
    s_or_b32 s45, s42, s44
    s_cmp_lg_u32 s45, 0
    s_cbranch_scc1 L_w_nx_24
    s_or_b32 s47, s39, 0x100
    v_mov_b32 v16, s47
    v_mov_b32 v17, 0
    s_lshl_b32 s46, s40, 2
    s_add_u32 s46, s46, 0x101200
    s_mov_b64 exec, 1
    buffer_store_dword v16, v17, s[12:15], s46 offen sc1
    s_mov_b64 exec, -1
L_w_nx_24:
    s_load_dwordx2 s[4:5], s[0:1], 0
    v_lshlrev_b32 v2, 4, v1
    v_lshlrev_b32 v3, 5, v1
    s_waitcnt lgkmcnt(0)
    s_mov_b32 s24, s4
    s_and_b32 s25, s5, 0xffff
    s_mov_b32 s26, 0x400000
    s_mov_b32 s27, 0x00020000
    s_lshl_b32 s46, s42, 3
    s_add_u32 s46, s46, s44
    s_lshl_b32 s46, s46, 11
    v_add_u32 v8, s46, v2
    s_lshl_b32 s63, s43, 16
    buffer_load_dwordx4 a[0:3], v8, s[24:27], s63 offen
    buffer_load_dwordx4 a[4:7], v8, s[24:27], s63 offen offset:1024
    s_add_u32 s63, s63, 524288
    buffer_load_dwordx4 a[8:11], v8, s[24:27], s63 offen
    buffer_load_dwordx4 a[12:15], v8, s[24:27], s63 offen offset:1024
    s_add_u32 s63, s63, 524288
    buffer_load_dwordx4 a[16:19], v8, s[24:27], s63 offen
    buffer_load_dwordx4 a[20:23], v8, s[24:27], s63 offen offset:1024
    s_add_u32 s63, s63, 524288
    buffer_load_dwordx4 a[24:27], v8, s[24:27], s63 offen
    buffer_load_dwordx4 a[28:31], v8, s[24:27], s63 offen offset:1024
    s_add_u32 s63, s63, 524288
    buffer_load_dwordx4 a[32:35], v8, s[24:27], s63 offen
    buffer_load_dwordx4 a[36:39], v8, s[24:27], s63 offen offset:1024
    s_add_u32 s63, s63, 524288
    buffer_load_dwordx4 a[40:43], v8, s[24:27], s63 offen
    buffer_load_dwordx4 a[44:47], v8, s[24:27], s63 offen offset:1024
    s_add_u32 s63, s63, 524288
    buffer_load_dwordx4 a[48:51], v8, s[24:27], s63 offen
    buffer_load_dwordx4 a[52:55], v8, s[24:27], s63 offen offset:1024
    s_add_u32 s63, s63, 524288
    buffer_load_dwordx4 a[56:59], v8, s[24:27], s63 offen
    buffer_load_dwordx4 a[60:63], v8, s[24:27], s63 offen offset:1024
    s_add_u32 s63, s63, 524288
    s_mov_b32 s46, 4096
    buffer_load_dwordx4 v[32:35], v3, s[12:15], s46 offen offset:0
    buffer_load_dwordx4 v[36:39], v3, s[12:15], s46 offen offset:16
    buffer_load_dwordx4 v[40:43], v3, s[12:15], s46 offen offset:2048
    buffer_load_dwordx4 v[44:47], v3, s[12:15], s46 offen offset:2064
    s_mov_b32 s46, 0
    buffer_load_dwordx4 v[48:51], v3, s[12:15], s46 offen offset:0
    buffer_load_dwordx4 v[52:55], v3, s[12:15], s46 offen offset:16
    buffer_load_dwordx4 v[56:59], v3, s[12:15], s46 offen offset:2048
    buffer_load_dwordx4 v[60:63], v3, s[12:15], s46 offen offset:2064
    s_mul_i32 s46, s44, 2064
    s_add_u32 s46, s46, 32768
    v_add_u32 v10, s46, v2
    v_and_b32 v11, 7, v1
    v_lshrrev_b32 v12, 3, v1
    v_mul_u32_u24 v13, 2064, v11
    v_lshl_add_u32 v13, v12, 4, v13
    s_lshl_b32 s46, s44, 8
    s_add_u32 s46, s46, 32768
    v_add_u32 v13, s46, v13
    v_lshlrev_b32 v11, 4, v11
    v_lshl_add_u32 v11, v12, 9, v11
    s_lshl_b32 s46, s44, 13
    s_lshl_b32 s47, s42, 7
    s_add_u32 s46, s46, s47
    s_add_u32 s46, s46, 0x400000
    v_add_u32 v11, s46, v11
    v_add_u32 v12, 4096, v11
    s_lshl_b32 s52, s43, 9
    s_lshl_b32 s47, s42, 7
    s_add_u32 s52, s52, s47
    s_add_u32 s52, s52, 0x109800
    s_mov_b32 s60, s43
    s_waitcnt vmcnt(0)
    v_add_f32 v32, 1.0, v32
    v_add_f32 v33, 1.0, v33
    v_add_f32 v34, 1.0, v34
    v_add_f32 v35, 1.0, v35
    v_add_f32 v36, 1.0, v36
    v_add_f32 v37, 1.0, v37
    v_add_f32 v38, 1.0, v38
    v_add_f32 v39, 1.0, v39
    v_add_f32 v40, 1.0, v40
    v_add_f32 v41, 1.0, v41
    v_add_f32 v42, 1.0, v42
    v_add_f32 v43, 1.0, v43
    v_add_f32 v44, 1.0, v44
    v_add_f32 v45, 1.0, v45
    v_add_f32 v46, 1.0, v46
    v_add_f32 v47, 1.0, v47
    v_cvt_pk_bf16_f32 v32, v32, v32
    v_cvt_pk_bf16_f32 v33, v33, v33
    v_cvt_pk_bf16_f32 v34, v34, v34
    v_cvt_pk_bf16_f32 v35, v35, v35
    v_cvt_pk_bf16_f32 v36, v36, v36
    v_cvt_pk_bf16_f32 v37, v37, v37
    v_cvt_pk_bf16_f32 v38, v38, v38
    v_cvt_pk_bf16_f32 v39, v39, v39
    v_cvt_pk_bf16_f32 v40, v40, v40
    v_cvt_pk_bf16_f32 v41, v41, v41
    v_cvt_pk_bf16_f32 v42, v42, v42
    v_cvt_pk_bf16_f32 v43, v43, v43
    v_cvt_pk_bf16_f32 v44, v44, v44
    v_cvt_pk_bf16_f32 v45, v45, v45
    v_cvt_pk_bf16_f32 v46, v46, v46
    v_cvt_pk_bf16_f32 v47, v47, v47
    v_lshlrev_b32 v32, 16, v32
    v_lshlrev_b32 v33, 16, v33
    v_lshlrev_b32 v34, 16, v34
    v_lshlrev_b32 v35, 16, v35
    v_lshlrev_b32 v36, 16, v36
    v_lshlrev_b32 v37, 16, v37
    v_lshlrev_b32 v38, 16, v38
    v_lshlrev_b32 v39, 16, v39
    v_lshlrev_b32 v40, 16, v40
    v_lshlrev_b32 v41, 16, v41
    v_lshlrev_b32 v42, 16, v42
    v_lshlrev_b32 v43, 16, v43
    v_lshlrev_b32 v44, 16, v44
    v_lshlrev_b32 v45, 16, v45
    v_lshlrev_b32 v46, 16, v46
    v_lshlrev_b32 v47, 16, v47
L_l_loop_25:
    s_lshl_b32 s63, s60, 16
    v_accvgpr_read_b32 v96, a0
    v_accvgpr_read_b32 v97, a1
    v_accvgpr_read_b32 v98, a2
    v_accvgpr_read_b32 v99, a3
    v_accvgpr_read_b32 v100, a4
    v_accvgpr_read_b32 v101, a5
    v_accvgpr_read_b32 v102, a6
    v_accvgpr_read_b32 v103, a7
    v_accvgpr_mov_b32 a0, a8
    v_accvgpr_mov_b32 a1, a9
    v_accvgpr_mov_b32 a2, a10
    v_accvgpr_mov_b32 a3, a11
    v_accvgpr_mov_b32 a4, a12
    v_accvgpr_mov_b32 a5, a13
    v_accvgpr_mov_b32 a6, a14
    v_accvgpr_mov_b32 a7, a15
    v_accvgpr_mov_b32 a8, a16
    v_accvgpr_mov_b32 a9, a17
    v_accvgpr_mov_b32 a10, a18
    v_accvgpr_mov_b32 a11, a19
    v_accvgpr_mov_b32 a12, a20
    v_accvgpr_mov_b32 a13, a21
    v_accvgpr_mov_b32 a14, a22
    v_accvgpr_mov_b32 a15, a23
    v_accvgpr_mov_b32 a16, a24
    v_accvgpr_mov_b32 a17, a25
    v_accvgpr_mov_b32 a18, a26
    v_accvgpr_mov_b32 a19, a27
    v_accvgpr_mov_b32 a20, a28
    v_accvgpr_mov_b32 a21, a29
    v_accvgpr_mov_b32 a22, a30
    v_accvgpr_mov_b32 a23, a31
    v_accvgpr_mov_b32 a24, a32
    v_accvgpr_mov_b32 a25, a33
    v_accvgpr_mov_b32 a26, a34
    v_accvgpr_mov_b32 a27, a35
    v_accvgpr_mov_b32 a28, a36
    v_accvgpr_mov_b32 a29, a37
    v_accvgpr_mov_b32 a30, a38
    v_accvgpr_mov_b32 a31, a39
    v_accvgpr_mov_b32 a32, a40
    v_accvgpr_mov_b32 a33, a41
    v_accvgpr_mov_b32 a34, a42
    v_accvgpr_mov_b32 a35, a43
    v_accvgpr_mov_b32 a36, a44
    v_accvgpr_mov_b32 a37, a45
    v_accvgpr_mov_b32 a38, a46
    v_accvgpr_mov_b32 a39, a47
    v_accvgpr_mov_b32 a40, a48
    v_accvgpr_mov_b32 a41, a49
    v_accvgpr_mov_b32 a42, a50
    v_accvgpr_mov_b32 a43, a51
    v_accvgpr_mov_b32 a44, a52
    v_accvgpr_mov_b32 a45, a53
    v_accvgpr_mov_b32 a46, a54
    v_accvgpr_mov_b32 a47, a55
    v_accvgpr_mov_b32 a48, a56
    v_accvgpr_mov_b32 a49, a57
    v_accvgpr_mov_b32 a50, a58
    v_accvgpr_mov_b32 a51, a59
    v_accvgpr_mov_b32 a52, a60
    v_accvgpr_mov_b32 a53, a61
    v_accvgpr_mov_b32 a54, a62
    v_accvgpr_mov_b32 a55, a63
    v_lshlrev_b32 v64, 16, v96
    v_and_b32 v65, 0xffff0000, v96
    v_lshlrev_b32 v66, 16, v97
    v_and_b32 v67, 0xffff0000, v97
    v_lshlrev_b32 v68, 16, v98
    v_and_b32 v69, 0xffff0000, v98
    v_lshlrev_b32 v70, 16, v99
    v_and_b32 v71, 0xffff0000, v99
    v_lshlrev_b32 v72, 16, v100
    v_and_b32 v73, 0xffff0000, v100
    v_lshlrev_b32 v74, 16, v101
    v_and_b32 v75, 0xffff0000, v101
    v_lshlrev_b32 v76, 16, v102
    v_and_b32 v77, 0xffff0000, v102
    v_lshlrev_b32 v78, 16, v103
    v_and_b32 v79, 0xffff0000, v103
    v_pk_add_f32 v[80:81], v[64:65], v[72:73]
    v_pk_add_f32 v[82:83], v[66:67], v[74:75]
    v_pk_add_f32 v[84:85], v[68:69], v[76:77]
    v_pk_add_f32 v[86:87], v[70:71], v[78:79]
    v_pk_add_f32 v[80:81], v[80:81], v[84:85]
    v_pk_add_f32 v[82:83], v[82:83], v[86:87]
    v_pk_add_f32 v[80:81], v[80:81], v[82:83]
    v_add_f32 v14, v80, v81
    s_nop 1
    v_add_f32_dpp v14, v14, v14 row_shr:1 row_mask:0xf bank_mask:0xf bound_ctrl:0
    s_nop 1
    v_add_f32_dpp v14, v14, v14 row_shr:2 row_mask:0xf bank_mask:0xf bound_ctrl:0
    s_nop 1
    v_add_f32_dpp v14, v14, v14 row_shr:4 row_mask:0xf bank_mask:0xf bound_ctrl:0
    s_nop 1
    v_add_f32_dpp v14, v14, v14 row_shr:8 row_mask:0xf bank_mask:0xf bound_ctrl:0
    s_nop 1
    v_add_f32_dpp v14, v14, v14 row_bcast:15 row_mask:0xa bank_mask:0xf
    s_nop 1
    v_add_f32_dpp v14, v14, v14 row_bcast:31 row_mask:0xc bank_mask:0xf
    s_nop 1
    v_readlane_b32 s46, v14, 63
    s_nop 1
    v_mov_b32 v15, s46
    v_mul_f32 v15, 0x3a800000, v15
    v_sub_f32 v80, v64, v15
    v_sub_f32 v81, v65, v15
    v_sub_f32 v82, v66, v15
    v_sub_f32 v83, v67, v15
    v_sub_f32 v84, v68, v15
    v_sub_f32 v85, v69, v15
    v_sub_f32 v86, v70, v15
    v_sub_f32 v87, v71, v15
    v_sub_f32 v88, v72, v15
    v_sub_f32 v89, v73, v15
    v_sub_f32 v90, v74, v15
    v_sub_f32 v91, v75, v15
    v_sub_f32 v92, v76, v15
    v_sub_f32 v93, v77, v15
    v_sub_f32 v94, v78, v15
    v_sub_f32 v95, v79, v15
    v_mul_f32 v14, v80, v80
    v_mul_f32 v104, v81, v81
    v_fmac_f32 v14, v82, v82
    v_fmac_f32 v104, v83, v83
    v_fmac_f32 v14, v84, v84
    v_fmac_f32 v104, v85, v85
    v_fmac_f32 v14, v86, v86
    v_fmac_f32 v104, v87, v87
    v_fmac_f32 v14, v88, v88
    v_fmac_f32 v104, v89, v89
    v_fmac_f32 v14, v90, v90
    v_fmac_f32 v104, v91, v91
    v_fmac_f32 v14, v92, v92
    v_fmac_f32 v104, v93, v93
    v_fmac_f32 v14, v94, v94
    v_fmac_f32 v104, v95, v95
    v_add_f32 v14, v14, v104
    s_nop 1
    v_add_f32_dpp v14, v14, v14 row_shr:1 row_mask:0xf bank_mask:0xf bound_ctrl:0
    s_nop 1
    v_add_f32_dpp v14, v14, v14 row_shr:2 row_mask:0xf bank_mask:0xf bound_ctrl:0
    s_nop 1
    v_add_f32_dpp v14, v14, v14 row_shr:4 row_mask:0xf bank_mask:0xf bound_ctrl:0
    s_nop 1
    v_add_f32_dpp v14, v14, v14 row_shr:8 row_mask:0xf bank_mask:0xf bound_ctrl:0
    s_nop 1
    v_add_f32_dpp v14, v14, v14 row_bcast:15 row_mask:0xa bank_mask:0xf
    s_nop 1
    v_add_f32_dpp v14, v14, v14 row_bcast:31 row_mask:0xc bank_mask:0xf
    s_nop 1
    v_readlane_b32 s47, v14, 63
    v_cvt_pk_bf16_f32 v15, v15, v15
    v_lshlrev_b32 v15, 16, v15
    v_mov_b32 v14, s47
    v_mul_f32 v14, 0x3a800000, v14
    v_cvt_pk_bf16_f32 v14, v14, v14
    v_lshlrev_b32 v14, 16, v14
    v_add_f32 v14, 0x3727c5ac, v14
    v_cvt_pk_bf16_f32 v14, v14, v14
    v_lshlrev_b32 v14, 16, v14
    v_sqrt_f32 v14, v14
    s_nop 0
    v_cvt_pk_bf16_f32 v14, v14, v14
    v_lshlrev_b32 v14, 16, v14
    v_rcp_f32 v14, v14
    v_sub_f32 v64, v64, v15
    v_sub_f32 v65, v65, v15
    v_sub_f32 v66, v66, v15
    v_sub_f32 v67, v67, v15
    v_sub_f32 v68, v68, v15
    v_sub_f32 v69, v69, v15
    v_sub_f32 v70, v70, v15
    v_sub_f32 v71, v71, v15
    v_sub_f32 v72, v72, v15
    v_sub_f32 v73, v73, v15
    v_sub_f32 v74, v74, v15
    v_sub_f32 v75, v75, v15
    v_sub_f32 v76, v76, v15
    v_sub_f32 v77, v77, v15
    v_sub_f32 v78, v78, v15
    v_sub_f32 v79, v79, v15
    v_cvt_pk_bf16_f32 v64, v64, v64
    v_cvt_pk_bf16_f32 v65, v65, v65
    v_cvt_pk_bf16_f32 v66, v66, v66
    v_cvt_pk_bf16_f32 v67, v67, v67
    v_cvt_pk_bf16_f32 v68, v68, v68
    v_cvt_pk_bf16_f32 v69, v69, v69
    v_cvt_pk_bf16_f32 v70, v70, v70
    v_cvt_pk_bf16_f32 v71, v71, v71
    v_cvt_pk_bf16_f32 v72, v72, v72
    v_cvt_pk_bf16_f32 v73, v73, v73
    v_cvt_pk_bf16_f32 v74, v74, v74
    v_cvt_pk_bf16_f32 v75, v75, v75
    v_cvt_pk_bf16_f32 v76, v76, v76
    v_cvt_pk_bf16_f32 v77, v77, v77
    v_cvt_pk_bf16_f32 v78, v78, v78
    v_cvt_pk_bf16_f32 v79, v79, v79
    v_lshlrev_b32 v64, 16, v64
    v_lshlrev_b32 v65, 16, v65
    v_lshlrev_b32 v66, 16, v66
    v_lshlrev_b32 v67, 16, v67
    v_lshlrev_b32 v68, 16, v68
    v_lshlrev_b32 v69, 16, v69
    v_lshlrev_b32 v70, 16, v70
    v_lshlrev_b32 v71, 16, v71
    v_lshlrev_b32 v72, 16, v72
    v_lshlrev_b32 v73, 16, v73
    v_lshlrev_b32 v74, 16, v74
    v_lshlrev_b32 v75, 16, v75
    v_lshlrev_b32 v76, 16, v76
    v_lshlrev_b32 v77, 16, v77
    v_lshlrev_b32 v78, 16, v78
    v_lshlrev_b32 v79, 16, v79
    v_mul_f32 v64, v64, v14
    v_mul_f32 v65, v65, v14
    v_mul_f32 v66, v66, v14
    v_mul_f32 v67, v67, v14
    v_mul_f32 v68, v68, v14
    v_mul_f32 v69, v69, v14
    v_mul_f32 v70, v70, v14
    v_mul_f32 v71, v71, v14
    v_mul_f32 v72, v72, v14
    v_mul_f32 v73, v73, v14
    v_mul_f32 v74, v74, v14
    v_mul_f32 v75, v75, v14
    v_mul_f32 v76, v76, v14
    v_mul_f32 v77, v77, v14
    v_mul_f32 v78, v78, v14
    v_mul_f32 v79, v79, v14
    v_cvt_pk_bf16_f32 v64, v64, v64
    v_cvt_pk_bf16_f32 v65, v65, v65
    v_cvt_pk_bf16_f32 v66, v66, v66
    v_cvt_pk_bf16_f32 v67, v67, v67
    v_cvt_pk_bf16_f32 v68, v68, v68
    v_cvt_pk_bf16_f32 v69, v69, v69
    v_cvt_pk_bf16_f32 v70, v70, v70
    v_cvt_pk_bf16_f32 v71, v71, v71
    v_cvt_pk_bf16_f32 v72, v72, v72
    v_cvt_pk_bf16_f32 v73, v73, v73
    v_cvt_pk_bf16_f32 v74, v74, v74
    v_cvt_pk_bf16_f32 v75, v75, v75
    v_cvt_pk_bf16_f32 v76, v76, v76
    v_cvt_pk_bf16_f32 v77, v77, v77
    v_cvt_pk_bf16_f32 v78, v78, v78
    v_cvt_pk_bf16_f32 v79, v79, v79
    v_lshlrev_b32 v64, 16, v64
    v_lshlrev_b32 v65, 16, v65
    v_lshlrev_b32 v66, 16, v66
    v_lshlrev_b32 v67, 16, v67
    v_lshlrev_b32 v68, 16, v68
    v_lshlrev_b32 v69, 16, v69
    v_lshlrev_b32 v70, 16, v70
    v_lshlrev_b32 v71, 16, v71
    v_lshlrev_b32 v72, 16, v72
    v_lshlrev_b32 v73, 16, v73
    v_lshlrev_b32 v74, 16, v74
    v_lshlrev_b32 v75, 16, v75
    v_lshlrev_b32 v76, 16, v76
    v_lshlrev_b32 v77, 16, v77
    v_lshlrev_b32 v78, 16, v78
    v_lshlrev_b32 v79, 16, v79
    v_mul_f32 v64, v64, v32
    v_mul_f32 v65, v65, v33
    v_mul_f32 v66, v66, v34
    v_mul_f32 v67, v67, v35
    v_mul_f32 v68, v68, v36
    v_mul_f32 v69, v69, v37
    v_mul_f32 v70, v70, v38
    v_mul_f32 v71, v71, v39
    v_mul_f32 v72, v72, v40
    v_mul_f32 v73, v73, v41
    v_mul_f32 v74, v74, v42
    v_mul_f32 v75, v75, v43
    v_mul_f32 v76, v76, v44
    v_mul_f32 v77, v77, v45
    v_mul_f32 v78, v78, v46
    v_mul_f32 v79, v79, v47
    v_cvt_pk_bf16_f32 v64, v64, v64
    v_cvt_pk_bf16_f32 v65, v65, v65
    v_cvt_pk_bf16_f32 v66, v66, v66
    v_cvt_pk_bf16_f32 v67, v67, v67
    v_cvt_pk_bf16_f32 v68, v68, v68
    v_cvt_pk_bf16_f32 v69, v69, v69
    v_cvt_pk_bf16_f32 v70, v70, v70
    v_cvt_pk_bf16_f32 v71, v71, v71
    v_cvt_pk_bf16_f32 v72, v72, v72
    v_cvt_pk_bf16_f32 v73, v73, v73
    v_cvt_pk_bf16_f32 v74, v74, v74
    v_cvt_pk_bf16_f32 v75, v75, v75
    v_cvt_pk_bf16_f32 v76, v76, v76
    v_cvt_pk_bf16_f32 v77, v77, v77
    v_cvt_pk_bf16_f32 v78, v78, v78
    v_cvt_pk_bf16_f32 v79, v79, v79
    v_lshlrev_b32 v64, 16, v64
    v_lshlrev_b32 v65, 16, v65
    v_lshlrev_b32 v66, 16, v66
    v_lshlrev_b32 v67, 16, v67
    v_lshlrev_b32 v68, 16, v68
    v_lshlrev_b32 v69, 16, v69
    v_lshlrev_b32 v70, 16, v70
    v_lshlrev_b32 v71, 16, v71
    v_lshlrev_b32 v72, 16, v72
    v_lshlrev_b32 v73, 16, v73
    v_lshlrev_b32 v74, 16, v74
    v_lshlrev_b32 v75, 16, v75
    v_lshlrev_b32 v76, 16, v76
    v_lshlrev_b32 v77, 16, v77
    v_lshlrev_b32 v78, 16, v78
    v_lshlrev_b32 v79, 16, v79
    v_add_f32 v64, v64, v48
    v_add_f32 v65, v65, v49
    v_add_f32 v66, v66, v50
    v_add_f32 v67, v67, v51
    v_add_f32 v68, v68, v52
    v_add_f32 v69, v69, v53
    v_add_f32 v70, v70, v54
    v_add_f32 v71, v71, v55
    v_add_f32 v72, v72, v56
    v_add_f32 v73, v73, v57
    v_add_f32 v74, v74, v58
    v_add_f32 v75, v75, v59
    v_add_f32 v76, v76, v60
    v_add_f32 v77, v77, v61
    v_add_f32 v78, v78, v62
    v_add_f32 v79, v79, v63
    v_cvt_pk_bf16_f32 v104, v64, v65
    v_cvt_pk_bf16_f32 v105, v66, v67
    v_cvt_pk_bf16_f32 v106, v68, v69
    v_cvt_pk_bf16_f32 v107, v70, v71
    v_cvt_pk_bf16_f32 v108, v72, v73
    v_cvt_pk_bf16_f32 v109, v74, v75
    v_cvt_pk_bf16_f32 v110, v76, v77
    v_cvt_pk_bf16_f32 v111, v78, v79
    ds_write_b128 v10, v[104:107]
    ds_write_b128 v10, v[108:111] offset:1024
    s_waitcnt lgkmcnt(0)
    s_barrier
    ds_read_b128 v[104:107], v13
    ds_read_b128 v[108:111], v13 offset:128
    s_waitcnt lgkmcnt(1)
    buffer_store_dwordx4 v[104:107], v11, s[12:15], s63 offen sc1
    s_waitcnt lgkmcnt(0)
    buffer_store_dwordx4 v[108:111], v12, s[12:15], s63 offen sc1
    s_waitcnt vmcnt(0)
    s_barrier
    s_cmp_lg_u32 s44, 0
    s_cbranch_scc1 L_sf_26
    v_mov_b32 v14, s60
    v_add_u32 v14, 1, v14
    v_mov_b32 v15, 0
    s_mov_b64 exec, 1
    buffer_store_dword v14, v15, s[12:15], s52 offen sc1
    s_mov_b64 exec, -1
L_sf_26:
    s_add_u32 s60, s60, 8
    s_cmp_lt_u32 s60, 64
    s_cbranch_scc1 L_l_loop_25
    s_cmp_eq_u32 s48, 12
    s_cbranch_scc1 L_w_att_22
    s_sub_u32 s45, s48, 13
    s_lshl_b32 s45, s45, 3
    s_add_u32 s45, s45, s40
    s_and_b32 s42, s45, 3
    s_lshr_b32 s43, s45, 2
    s_cmp_lt_u32 s43, 3
    s_cbranch_scc1 L_w_c_23
    s_sub_u32 s43, s43, 3
    s_load_dwordx2 s[4:5], s[0:1], 112
    s_load_dwordx2 s[6:7], s[0:1], 88
    v_lshlrev_b32 v2, 4, v1
    v_lshlrev_b32 v3, 5, v1
    s_waitcnt lgkmcnt(0)
    s_mov_b32 s24, s4
    s_and_b32 s25, s5, 0xffff
    s_mov_b32 s26, 0x400000
    s_mov_b32 s27, 0x00020000
    s_mov_b32 s28, s6
    s_and_b32 s29, s7, 0xffff
    s_mov_b32 s30, 0x800
    s_mov_b32 s31, 0x00020000
    s_mov_b32 s46, 20480
    buffer_load_dwordx4 v[16:19], v3, s[12:15], s46 offen offset:0
    buffer_load_dwordx4 v[20:23], v3, s[12:15], s46 offen offset:16
    buffer_load_dwordx4 v[24:27], v3, s[12:15], s46 offen offset:2048
    buffer_load_dwordx4 v[28:31], v3, s[12:15], s46 offen offset:2064
    buffer_load_dwordx4 v[48:51], v2, s[28:31], 0 offen
    buffer_load_dwordx4 v[52:55], v2, s[28:31], 0 offen offset:1024
    s_waitcnt vmcnt(0)
    v_lshlrev_b32 v32, 16, v48
    v_and_b32 v33, 0xffff0000, v48
    v_lshlrev_b32 v34, 16, v49
    v_and_b32 v35, 0xffff0000, v49
    v_lshlrev_b32 v36, 16, v50
    v_and_b32 v37, 0xffff0000, v50
    v_lshlrev_b32 v38, 16, v51
    v_and_b32 v39, 0xffff0000, v51
    v_lshlrev_b32 v40, 16, v52
    v_and_b32 v41, 0xffff0000, v52
    v_lshlrev_b32 v42, 16, v53
    v_and_b32 v43, 0xffff0000, v53
    v_lshlrev_b32 v44, 16, v54
    v_and_b32 v45, 0xffff0000, v54
    v_lshlrev_b32 v46, 16, v55
    v_and_b32 v47, 0xffff0000, v55
    s_lshl_b32 s46, s42, 15
    s_lshl_b32 s47, s44, 12
    s_add_u32 s46, s46, s47
    s_add_u32 s46, s46, 0xb000000
    v_add_u32 v4, s46, v2
    v_and_b32 v5, 31, v1
    v_lshlrev_b32 v5, 7, v5
    v_add_u32 v5, 0x108800, v5
    v_and_b32 v6, 31, v1
    v_lshlrev_b32 v6, 2, v6
    v_lshrrev_b32 v7, 5, v1
    v_lshl_add_u32 v6, v7, 14, v6
    s_lshl_b32 s46, s44, 9
    v_add_u32 v6, s46, v6
    s_lshl_b32 s46, s44, 12
    v_add_u32 v7, s46, v3
    s_lshl_b32 s46, s42, 3
    s_add_u32 s46, s46, s44
    s_lshl_b32 s46, s46, 11
    v_add_u32 v8, s46, v2
    v_add_u32 v9, 0x800000, v8
    s_mov_b32 s60, s43
L_r_loop_27:
    s_lshl_b32 s61, s60, 19
    s_lshl_b32 s63, s60, 16
    s_cmp_lg_u32 s44, 0
    s_cbranch_scc1 L_r_nsp_28
    s_mov_b32 s70, 0
L_spin_29:
    buffer_load_dword v14, v5, s[12:15], 0 offen sc1
    s_waitcnt vmcnt(0)
    v_cmp_ge_u32 vcc, s60, v14
    s_add_u32 s70, s70, 1
    s_cbranch_vccz L_spok_30
    s_sleep 8
    s_cmp_lt_u32 s70, 524288
    s_cbranch_scc1 L_spin_29
    s_branch L_c_done_4
L_spok_30:
L_r_nsp_28:
    s_barrier
    buffer_load_dwordx4 v[64:67], v4, s[12:15], s61 offen offset:0 sc1
    buffer_load_dwordx4 v[68:71], v4, s[12:15], s61 offen offset:1024 sc1
    buffer_load_dwordx4 v[72:75], v4, s[12:15], s61 offen offset:2048 sc1
    buffer_load_dwordx4 v[76:79], v4, s[12:15], s61 offen offset:3072 sc1
    s_add_u32 s61, s61, 131072
    buffer_load_dwordx4 v[80:83], v4, s[12:15], s61 offen offset:0 sc1
    buffer_load_dwordx4 v[84:87], v4, s[12:15], s61 offen offset:1024 sc1
    buffer_load_dwordx4 v[88:91], v4, s[12:15], s61 offen offset:2048 sc1
    buffer_load_dwordx4 v[92:95], v4, s[12:15], s61 offen offset:3072 sc1
    s_add_u32 s61, s61, 131072
    buffer_load_dwordx4 v[96:99], v4, s[12:15], s61 offen offset:0 sc1
    buffer_load_dwordx4 v[100:103], v4, s[12:15], s61 offen offset:1024 sc1
    buffer_load_dwordx4 v[104:107], v4, s[12:15], s61 offen offset:2048 sc1
    buffer_load_dwordx4 v[108:111], v4, s[12:15], s61 offen offset:3072 sc1
    s_add_u32 s61, s61, 131072
    buffer_load_dwordx4 v[112:115], v4, s[12:15], s61 offen offset:0 sc1
    buffer_load_dwordx4 v[116:119], v4, s[12:15], s61 offen offset:1024 sc1
    buffer_load_dwordx4 v[120:123], v4, s[12:15], s61 offen offset:2048 sc1
    buffer_load_dwordx4 v[124:127], v4, s[12:15], s61 offen offset:3072 sc1
    buffer_load_dwordx4 a[0:3], v9, s[12:15], s63 offen sc1
    buffer_load_dwordx4 a[4:7], v9, s[12:15], s63 offen offset:1024 sc1
    s_waitcnt vmcnt(10)
    v_pk_add_f32 v[64:65], v[64:65], v[80:81]
    v_pk_add_f32 v[66:67], v[66:67], v[82:83]
    v_pk_add_f32 v[68:69], v[68:69], v[84:85]
    v_pk_add_f32 v[70:71], v[70:71], v[86:87]
    v_pk_add_f32 v[72:73], v[72:73], v[88:89]
    v_pk_add_f32 v[74:75], v[74:75], v[90:91]
    v_pk_add_f32 v[76:77], v[76:77], v[92:93]
    v_pk_add_f32 v[78:79], v[78:79], v[94:95]
    s_waitcnt vmcnt(2)
    v_pk_add_f32 v[96:97], v[96:97], v[112:113]
    v_pk_add_f32 v[98:99], v[98:99], v[114:115]
    v_pk_add_f32 v[100:101], v[100:101], v[116:117]
    v_pk_add_f32 v[102:103], v[102:103], v[118:119]
    v_pk_add_f32 v[104:105], v[104:105], v[120:121]
    v_pk_add_f32 v[106:107], v[106:107], v[122:123]
    v_pk_add_f32 v[108:109], v[108:109], v[124:125]
    v_pk_add_f32 v[110:111], v[110:111], v[126:127]
    v_pk_add_f32 v[64:65], v[64:65], v[96:97]
    v_pk_add_f32 v[66:67], v[66:67], v[98:99]
    v_pk_add_f32 v[68:69], v[68:69], v[100:101]
    v_pk_add_f32 v[70:71], v[70:71], v[102:103]
    v_pk_add_f32 v[72:73], v[72:73], v[104:105]
    v_pk_add_f32 v[74:75], v[74:75], v[106:107]
    v_pk_add_f32 v[76:77], v[76:77], v[108:109]
    v_pk_add_f32 v[78:79], v[78:79], v[110:111]
    ds_write_b32 v6, v64 offset:0
    ds_write_b32 v6, v65 offset:4096
    ds_write_b32 v6, v66 offset:8192
    ds_write_b32 v6, v67 offset:12288
    ds_write_b32 v6, v68 offset:128
    ds_write_b32 v6, v69 offset:4224
    ds_write_b32 v6, v70 offset:8320
    ds_write_b32 v6, v71 offset:12416
    ds_write_b32 v6, v72 offset:256
    ds_write_b32 v6, v73 offset:4352
    ds_write_b32 v6, v74 offset:8448
    ds_write_b32 v6, v75 offset:12544
    ds_write_b32 v6, v76 offset:384
    ds_write_b32 v6, v77 offset:4480
    ds_write_b32 v6, v78 offset:8576
    ds_write_b32 v6, v79 offset:12672
    s_waitcnt lgkmcnt(0)
    s_barrier
    ds_read_b128 v[64:67], v7
    ds_read_b128 v[68:71], v7 offset:16
    ds_read_b128 v[72:75], v7 offset:2048
    ds_read_b128 v[76:79], v7 offset:2064
    s_waitcnt vmcnt(0)
    v_accvgpr_read_b32 v96, a0
    v_accvgpr_read_b32 v97, a1
    v_accvgpr_read_b32 v98, a2
    v_accvgpr_read_b32 v99, a3
    v_accvgpr_read_b32 v100, a4
    v_accvgpr_read_b32 v101, a5
    v_accvgpr_read_b32 v102, a6
    v_accvgpr_read_b32 v103, a7
    v_lshlrev_b32 v80, 16, v96
    v_and_b32 v81, 0xffff0000, v96
    v_lshlrev_b32 v82, 16, v97
    v_and_b32 v83, 0xffff0000, v97
    v_lshlrev_b32 v84, 16, v98
    v_and_b32 v85, 0xffff0000, v98
    v_lshlrev_b32 v86, 16, v99
    v_and_b32 v87, 0xffff0000, v99
    v_lshlrev_b32 v88, 16, v100
    v_and_b32 v89, 0xffff0000, v100
    v_lshlrev_b32 v90, 16, v101
    v_and_b32 v91, 0xffff0000, v101
    v_lshlrev_b32 v92, 16, v102
    v_and_b32 v93, 0xffff0000, v102
    v_lshlrev_b32 v94, 16, v103
    v_and_b32 v95, 0xffff0000, v103
    s_waitcnt lgkmcnt(0)
    v_cvt_pk_bf16_f32 v64, v64, v64
    v_cvt_pk_bf16_f32 v65, v65, v65
    v_cvt_pk_bf16_f32 v66, v66, v66
    v_cvt_pk_bf16_f32 v67, v67, v67
    v_cvt_pk_bf16_f32 v68, v68, v68
    v_cvt_pk_bf16_f32 v69, v69, v69
    v_cvt_pk_bf16_f32 v70, v70, v70
    v_cvt_pk_bf16_f32 v71, v71, v71
    v_cvt_pk_bf16_f32 v72, v72, v72
    v_cvt_pk_bf16_f32 v73, v73, v73
    v_cvt_pk_bf16_f32 v74, v74, v74
    v_cvt_pk_bf16_f32 v75, v75, v75
    v_cvt_pk_bf16_f32 v76, v76, v76
    v_cvt_pk_bf16_f32 v77, v77, v77
    v_cvt_pk_bf16_f32 v78, v78, v78
    v_cvt_pk_bf16_f32 v79, v79, v79
    v_lshlrev_b32 v64, 16, v64
    v_lshlrev_b32 v65, 16, v65
    v_lshlrev_b32 v66, 16, v66
    v_lshlrev_b32 v67, 16, v67
    v_lshlrev_b32 v68, 16, v68
    v_lshlrev_b32 v69, 16, v69
    v_lshlrev_b32 v70, 16, v70
    v_lshlrev_b32 v71, 16, v71
    v_lshlrev_b32 v72, 16, v72
    v_lshlrev_b32 v73, 16, v73
    v_lshlrev_b32 v74, 16, v74
    v_lshlrev_b32 v75, 16, v75
    v_lshlrev_b32 v76, 16, v76
    v_lshlrev_b32 v77, 16, v77
    v_lshlrev_b32 v78, 16, v78
    v_lshlrev_b32 v79, 16, v79
    v_add_f32 v64, v64, v32
    v_add_f32 v65, v65, v33
    v_add_f32 v66, v66, v34
    v_add_f32 v67, v67, v35
    v_add_f32 v68, v68, v36
    v_add_f32 v69, v69, v37
    v_add_f32 v70, v70, v38
    v_add_f32 v71, v71, v39
    v_add_f32 v72, v72, v40
    v_add_f32 v73, v73, v41
    v_add_f32 v74, v74, v42
    v_add_f32 v75, v75, v43
    v_add_f32 v76, v76, v44
    v_add_f32 v77, v77, v45
    v_add_f32 v78, v78, v46
    v_add_f32 v79, v79, v47
    v_cvt_pk_bf16_f32 v64, v64, v64
    v_cvt_pk_bf16_f32 v65, v65, v65
    v_cvt_pk_bf16_f32 v66, v66, v66
    v_cvt_pk_bf16_f32 v67, v67, v67
    v_cvt_pk_bf16_f32 v68, v68, v68
    v_cvt_pk_bf16_f32 v69, v69, v69
    v_cvt_pk_bf16_f32 v70, v70, v70
    v_cvt_pk_bf16_f32 v71, v71, v71
    v_cvt_pk_bf16_f32 v72, v72, v72
    v_cvt_pk_bf16_f32 v73, v73, v73
    v_cvt_pk_bf16_f32 v74, v74, v74
    v_cvt_pk_bf16_f32 v75, v75, v75
    v_cvt_pk_bf16_f32 v76, v76, v76
    v_cvt_pk_bf16_f32 v77, v77, v77
    v_cvt_pk_bf16_f32 v78, v78, v78
    v_cvt_pk_bf16_f32 v79, v79, v79
    v_lshlrev_b32 v64, 16, v64
    v_lshlrev_b32 v65, 16, v65
    v_lshlrev_b32 v66, 16, v66
    v_lshlrev_b32 v67, 16, v67
    v_lshlrev_b32 v68, 16, v68
    v_lshlrev_b32 v69, 16, v69
    v_lshlrev_b32 v70, 16, v70
    v_lshlrev_b32 v71, 16, v71
    v_lshlrev_b32 v72, 16, v72
    v_lshlrev_b32 v73, 16, v73
    v_lshlrev_b32 v74, 16, v74
    v_lshlrev_b32 v75, 16, v75
    v_lshlrev_b32 v76, 16, v76
    v_lshlrev_b32 v77, 16, v77
    v_lshlrev_b32 v78, 16, v78
    v_lshlrev_b32 v79, 16, v79
    v_mul_f32 v64, v64, v16
    v_mul_f32 v65, v65, v17
    v_mul_f32 v66, v66, v18
    v_mul_f32 v67, v67, v19
    v_mul_f32 v68, v68, v20
    v_mul_f32 v69, v69, v21
    v_mul_f32 v70, v70, v22
    v_mul_f32 v71, v71, v23
    v_mul_f32 v72, v72, v24
    v_mul_f32 v73, v73, v25
    v_mul_f32 v74, v74, v26
    v_mul_f32 v75, v75, v27
    v_mul_f32 v76, v76, v28
    v_mul_f32 v77, v77, v29
    v_mul_f32 v78, v78, v30
    v_mul_f32 v79, v79, v31
    v_cvt_pk_bf16_f32 v64, v64, v64
    v_cvt_pk_bf16_f32 v65, v65, v65
    v_cvt_pk_bf16_f32 v66, v66, v66
    v_cvt_pk_bf16_f32 v67, v67, v67
    v_cvt_pk_bf16_f32 v68, v68, v68
    v_cvt_pk_bf16_f32 v69, v69, v69
    v_cvt_pk_bf16_f32 v70, v70, v70
    v_cvt_pk_bf16_f32 v71, v71, v71
    v_cvt_pk_bf16_f32 v72, v72, v72
    v_cvt_pk_bf16_f32 v73, v73, v73
    v_cvt_pk_bf16_f32 v74, v74, v74
    v_cvt_pk_bf16_f32 v75, v75, v75
    v_cvt_pk_bf16_f32 v76, v76, v76
    v_cvt_pk_bf16_f32 v77, v77, v77
    v_cvt_pk_bf16_f32 v78, v78, v78
    v_cvt_pk_bf16_f32 v79, v79, v79
    v_lshlrev_b32 v64, 16, v64
    v_lshlrev_b32 v65, 16, v65
    v_lshlrev_b32 v66, 16, v66
    v_lshlrev_b32 v67, 16, v67
    v_lshlrev_b32 v68, 16, v68
    v_lshlrev_b32 v69, 16, v69
    v_lshlrev_b32 v70, 16, v70
    v_lshlrev_b32 v71, 16, v71
    v_lshlrev_b32 v72, 16, v72
    v_lshlrev_b32 v73, 16, v73
    v_lshlrev_b32 v74, 16, v74
    v_lshlrev_b32 v75, 16, v75
    v_lshlrev_b32 v76, 16, v76
    v_lshlrev_b32 v77, 16, v77
    v_lshlrev_b32 v78, 16, v78
    v_lshlrev_b32 v79, 16, v79
    v_add_f32 v64, v64, v80
    v_add_f32 v65, v65, v81
    v_add_f32 v66, v66, v82
    v_add_f32 v67, v67, v83
    v_add_f32 v68, v68, v84
    v_add_f32 v69, v69, v85
    v_add_f32 v70, v70, v86
    v_add_f32 v71, v71, v87
    v_add_f32 v72, v72, v88
    v_add_f32 v73, v73, v89
    v_add_f32 v74, v74, v90
    v_add_f32 v75, v75, v91
    v_add_f32 v76, v76, v92
    v_add_f32 v77, v77, v93
    v_add_f32 v78, v78, v94
    v_add_f32 v79, v79, v95
    v_cvt_pk_bf16_f32 v96, v64, v65
    v_cvt_pk_bf16_f32 v97, v66, v67
    v_cvt_pk_bf16_f32 v98, v68, v69
    v_cvt_pk_bf16_f32 v99, v70, v71
    v_cvt_pk_bf16_f32 v100, v72, v73
    v_cvt_pk_bf16_f32 v101, v74, v75
    v_cvt_pk_bf16_f32 v102, v76, v77
    v_cvt_pk_bf16_f32 v103, v78, v79
    buffer_store_dwordx4 v[96:99], v8, s[24:27], s63 offen
    buffer_store_dwordx4 v[100:103], v8, s[24:27], s63 offen offset:1024
    s_add_u32 s60, s60, 3
    s_cmp_lt_u32 s60, 64
    s_cbranch_scc1 L_r_loop_27
    s_branch L_c_done_4
L_w_c_23:
    s_load_dwordx2 s[4:5], s[0:1], 0
    s_load_dwordx2 s[6:7], s[0:1], 88
    v_lshlrev_b32 v2, 4, v1
    v_lshlrev_b32 v3, 5, v1
    s_waitcnt lgkmcnt(0)
    s_mov_b32 s24, s4
    s_and_b32 s25, s5, 0xffff
    s_mov_b32 s26, 0x400000
    s_mov_b32 s27, 0x00020000
    s_mov_b32 s28, s6
    s_and_b32 s29, s7, 0xffff
    s_mov_b32 s30, 0x800
    s_mov_b32 s31, 0x00020000
    s_mov_b32 s46, 8192
    buffer_load_dwordx4 v[16:19], v3, s[12:15], s46 offen offset:0
    buffer_load_dwordx4 v[20:23], v3, s[12:15], s46 offen offset:16
    buffer_load_dwordx4 v[24:27], v3, s[12:15], s46 offen offset:2048
    buffer_load_dwordx4 v[28:31], v3, s[12:15], s46 offen offset:2064
    s_mov_b32 s46, 16384
    buffer_load_dwordx4 v[32:35], v3, s[12:15], s46 offen offset:0
    buffer_load_dwordx4 v[36:39], v3, s[12:15], s46 offen offset:16
    buffer_load_dwordx4 v[40:43], v3, s[12:15], s46 offen offset:2048
    buffer_load_dwordx4 v[44:47], v3, s[12:15], s46 offen offset:2064
    s_mov_b32 s46, 12288
    buffer_load_dwordx4 v[48:51], v3, s[12:15], s46 offen offset:0
    buffer_load_dwordx4 v[52:55], v3, s[12:15], s46 offen offset:16
    buffer_load_dwordx4 v[56:59], v3, s[12:15], s46 offen offset:2048
    buffer_load_dwordx4 v[60:63], v3, s[12:15], s46 offen offset:2064
    s_waitcnt vmcnt(0)
    v_add_f32 v32, 1.0, v32
    v_add_f32 v33, 1.0, v33
    v_add_f32 v34, 1.0, v34
    v_add_f32 v35, 1.0, v35
    v_add_f32 v36, 1.0, v36
    v_add_f32 v37, 1.0, v37
    v_add_f32 v38, 1.0, v38
    v_add_f32 v39, 1.0, v39
    v_add_f32 v40, 1.0, v40
    v_add_f32 v41, 1.0, v41
    v_add_f32 v42, 1.0, v42
    v_add_f32 v43, 1.0, v43
    v_add_f32 v44, 1.0, v44
    v_add_f32 v45, 1.0, v45
    v_add_f32 v46, 1.0, v46
    v_add_f32 v47, 1.0, v47
    v_cvt_pk_bf16_f32 v32, v32, v32
    v_cvt_pk_bf16_f32 v33, v33, v33
    v_cvt_pk_bf16_f32 v34, v34, v34
    v_cvt_pk_bf16_f32 v35, v35, v35
    v_cvt_pk_bf16_f32 v36, v36, v36
    v_cvt_pk_bf16_f32 v37, v37, v37
    v_cvt_pk_bf16_f32 v38, v38, v38
    v_cvt_pk_bf16_f32 v39, v39, v39
    v_cvt_pk_bf16_f32 v40, v40, v40
    v_cvt_pk_bf16_f32 v41, v41, v41
    v_cvt_pk_bf16_f32 v42, v42, v42
    v_cvt_pk_bf16_f32 v43, v43, v43
    v_cvt_pk_bf16_f32 v44, v44, v44
    v_cvt_pk_bf16_f32 v45, v45, v45
    v_cvt_pk_bf16_f32 v46, v46, v46
    v_cvt_pk_bf16_f32 v47, v47, v47
    v_lshlrev_b32 v32, 16, v32
    v_lshlrev_b32 v33, 16, v33
    v_lshlrev_b32 v34, 16, v34
    v_lshlrev_b32 v35, 16, v35
    v_lshlrev_b32 v36, 16, v36
    v_lshlrev_b32 v37, 16, v37
    v_lshlrev_b32 v38, 16, v38
    v_lshlrev_b32 v39, 16, v39
    v_lshlrev_b32 v40, 16, v40
    v_lshlrev_b32 v41, 16, v41
    v_lshlrev_b32 v42, 16, v42
    v_lshlrev_b32 v43, 16, v43
    v_lshlrev_b32 v44, 16, v44
    v_lshlrev_b32 v45, 16, v45
    v_lshlrev_b32 v46, 16, v46
    v_lshlrev_b32 v47, 16, v47
    s_lshl_b32 s46, s42, 15
    s_lshl_b32 s47, s44, 12
    s_add_u32 s46, s46, s47
    s_add_u32 s46, s46, 0x9000000
    v_add_u32 v4, s46, v2
    v_and_b32 v5, 31, v1
    v_lshlrev_b32 v5, 7, v5
    v_add_u32 v5, 0x107800, v5
    v_and_b32 v6, 31, v1
    v_lshlrev_b32 v6, 2, v6
    v_lshrrev_b32 v7, 5, v1
    v_lshl_add_u32 v6, v7, 14, v6
    s_lshl_b32 s46, s44, 9
    v_add_u32 v6, s46, v6
    s_lshl_b32 s46, s44, 12
    v_add_u32 v7, s46, v3
    s_lshl_b32 s46, s42, 3
    s_add_u32 s46, s46, s44
    s_lshl_b32 s46, s46, 11
    v_add_u32 v8, s46, v2
    v_add_u32 v9, 0x800000, v8
    s_mul_i32 s46, s44, 2064
    s_add_u32 s46, s46, 32768
    v_add_u32 v10, s46, v2
    v_and_b32 v11, 7, v1
    v_lshrrev_b32 v12, 3, v1
    v_mul_u32_u24 v13, 2064, v11
    v_lshl_add_u32 v13, v12, 4, v13
    s_lshl_b32 s46, s44, 8
    s_add_u32 s46, s46, 32768
    v_add_u32 v13, s46, v13
    v_lshlrev_b32 v11, 4, v11
    v_lshl_add_u32 v11, v12, 9, v11
    s_lshl_b32 s46, s44, 13
    s_lshl_b32 s47, s42, 7
    s_add_u32 s46, s46, s47
    s_add_u32 s46, s46, 0xc00000
    v_add_u32 v11, s46, v11
    v_add_u32 v12, 4096, v11
    s_lshl_b32 s52, s43, 9
    s_lshl_b32 s47, s42, 7
    s_add_u32 s52, s52, s47
    s_add_u32 s52, s52, 0x106000
    s_mov_b32 s60, s43
L_r_loop_31:
    s_lshl_b32 s61, s60, 19
    s_lshl_b32 s63, s60, 16
    buffer_load_dwordx4 a[0:3], v8, s[24:27], s63 offen
    buffer_load_dwordx4 a[4:7], v8, s[24:27], s63 offen offset:1024
    s_cmp_lg_u32 s44, 0
    s_cbranch_scc1 L_r_nsp_32
    s_mov_b32 s70, 0
L_spin_33:
    buffer_load_dword v14, v5, s[12:15], 0 offen sc1
    s_waitcnt vmcnt(0)
    v_cmp_ge_u32 vcc, s60, v14
    s_add_u32 s70, s70, 1
    s_cbranch_vccz L_spok_34
    s_sleep 8
    s_cmp_lt_u32 s70, 524288
    s_cbranch_scc1 L_spin_33
    s_branch L_c_done_4
L_spok_34:
L_r_nsp_32:
    s_barrier
    buffer_load_dwordx4 v[64:67], v4, s[12:15], s61 offen offset:0 sc1
    buffer_load_dwordx4 v[68:71], v4, s[12:15], s61 offen offset:1024 sc1
    buffer_load_dwordx4 v[72:75], v4, s[12:15], s61 offen offset:2048 sc1
    buffer_load_dwordx4 v[76:79], v4, s[12:15], s61 offen offset:3072 sc1
    s_add_u32 s61, s61, 131072
    buffer_load_dwordx4 v[80:83], v4, s[12:15], s61 offen offset:0 sc1
    buffer_load_dwordx4 v[84:87], v4, s[12:15], s61 offen offset:1024 sc1
    buffer_load_dwordx4 v[88:91], v4, s[12:15], s61 offen offset:2048 sc1
    buffer_load_dwordx4 v[92:95], v4, s[12:15], s61 offen offset:3072 sc1
    s_add_u32 s61, s61, 131072
    buffer_load_dwordx4 v[96:99], v4, s[12:15], s61 offen offset:0 sc1
    buffer_load_dwordx4 v[100:103], v4, s[12:15], s61 offen offset:1024 sc1
    buffer_load_dwordx4 v[104:107], v4, s[12:15], s61 offen offset:2048 sc1
    buffer_load_dwordx4 v[108:111], v4, s[12:15], s61 offen offset:3072 sc1
    s_add_u32 s61, s61, 131072
    buffer_load_dwordx4 v[112:115], v4, s[12:15], s61 offen offset:0 sc1
    buffer_load_dwordx4 v[116:119], v4, s[12:15], s61 offen offset:1024 sc1
    buffer_load_dwordx4 v[120:123], v4, s[12:15], s61 offen offset:2048 sc1
    buffer_load_dwordx4 v[124:127], v4, s[12:15], s61 offen offset:3072 sc1
    s_waitcnt vmcnt(8)
    v_pk_add_f32 v[64:65], v[64:65], v[80:81]
    v_pk_add_f32 v[66:67], v[66:67], v[82:83]
    v_pk_add_f32 v[68:69], v[68:69], v[84:85]
    v_pk_add_f32 v[70:71], v[70:71], v[86:87]
    v_pk_add_f32 v[72:73], v[72:73], v[88:89]
    v_pk_add_f32 v[74:75], v[74:75], v[90:91]
    v_pk_add_f32 v[76:77], v[76:77], v[92:93]
    v_pk_add_f32 v[78:79], v[78:79], v[94:95]
    s_waitcnt vmcnt(0)
    v_pk_add_f32 v[96:97], v[96:97], v[112:113]
    v_pk_add_f32 v[98:99], v[98:99], v[114:115]
    v_pk_add_f32 v[100:101], v[100:101], v[116:117]
    v_pk_add_f32 v[102:103], v[102:103], v[118:119]
    v_pk_add_f32 v[104:105], v[104:105], v[120:121]
    v_pk_add_f32 v[106:107], v[106:107], v[122:123]
    v_pk_add_f32 v[108:109], v[108:109], v[124:125]
    v_pk_add_f32 v[110:111], v[110:111], v[126:127]
    v_pk_add_f32 v[64:65], v[64:65], v[96:97]
    v_pk_add_f32 v[66:67], v[66:67], v[98:99]
    v_pk_add_f32 v[68:69], v[68:69], v[100:101]
    v_pk_add_f32 v[70:71], v[70:71], v[102:103]
    v_pk_add_f32 v[72:73], v[72:73], v[104:105]
    v_pk_add_f32 v[74:75], v[74:75], v[106:107]
    v_pk_add_f32 v[76:77], v[76:77], v[108:109]
    v_pk_add_f32 v[78:79], v[78:79], v[110:111]
    ds_write_b32 v6, v64 offset:0
    ds_write_b32 v6, v65 offset:4096
    ds_write_b32 v6, v66 offset:8192
    ds_write_b32 v6, v67 offset:12288
    ds_write_b32 v6, v68 offset:128
    ds_write_b32 v6, v69 offset:4224
    ds_write_b32 v6, v70 offset:8320
    ds_write_b32 v6, v71 offset:12416
    ds_write_b32 v6, v72 offset:256
    ds_write_b32 v6, v73 offset:4352
    ds_write_b32 v6, v74 offset:8448
    ds_write_b32 v6, v75 offset:12544
    ds_write_b32 v6, v76 offset:384
    ds_write_b32 v6, v77 offset:4480
    ds_write_b32 v6, v78 offset:8576
    ds_write_b32 v6, v79 offset:12672
    s_waitcnt lgkmcnt(0)
    s_barrier
    ds_read_b128 v[64:67], v7
    ds_read_b128 v[68:71], v7 offset:16
    ds_read_b128 v[72:75], v7 offset:2048
    ds_read_b128 v[76:79], v7 offset:2064
    s_waitcnt vmcnt(0)
    v_accvgpr_read_b32 v96, a0
    v_accvgpr_read_b32 v97, a1
    v_accvgpr_read_b32 v98, a2
    v_accvgpr_read_b32 v99, a3
    v_accvgpr_read_b32 v100, a4
    v_accvgpr_read_b32 v101, a5
    v_accvgpr_read_b32 v102, a6
    v_accvgpr_read_b32 v103, a7
    v_lshlrev_b32 v80, 16, v96
    v_and_b32 v81, 0xffff0000, v96
    v_lshlrev_b32 v82, 16, v97
    v_and_b32 v83, 0xffff0000, v97
    v_lshlrev_b32 v84, 16, v98
    v_and_b32 v85, 0xffff0000, v98
    v_lshlrev_b32 v86, 16, v99
    v_and_b32 v87, 0xffff0000, v99
    v_lshlrev_b32 v88, 16, v100
    v_and_b32 v89, 0xffff0000, v100
    v_lshlrev_b32 v90, 16, v101
    v_and_b32 v91, 0xffff0000, v101
    v_lshlrev_b32 v92, 16, v102
    v_and_b32 v93, 0xffff0000, v102
    v_lshlrev_b32 v94, 16, v103
    v_and_b32 v95, 0xffff0000, v103
    s_waitcnt lgkmcnt(0)
    v_cvt_pk_bf16_f32 v64, v64, v64
    v_cvt_pk_bf16_f32 v65, v65, v65
    v_cvt_pk_bf16_f32 v66, v66, v66
    v_cvt_pk_bf16_f32 v67, v67, v67
    v_cvt_pk_bf16_f32 v68, v68, v68
    v_cvt_pk_bf16_f32 v69, v69, v69
    v_cvt_pk_bf16_f32 v70, v70, v70
    v_cvt_pk_bf16_f32 v71, v71, v71
    v_cvt_pk_bf16_f32 v72, v72, v72
    v_cvt_pk_bf16_f32 v73, v73, v73
    v_cvt_pk_bf16_f32 v74, v74, v74
    v_cvt_pk_bf16_f32 v75, v75, v75
    v_cvt_pk_bf16_f32 v76, v76, v76
    v_cvt_pk_bf16_f32 v77, v77, v77
    v_cvt_pk_bf16_f32 v78, v78, v78
    v_cvt_pk_bf16_f32 v79, v79, v79
    v_lshlrev_b32 v64, 16, v64
    v_lshlrev_b32 v65, 16, v65
    v_lshlrev_b32 v66, 16, v66
    v_lshlrev_b32 v67, 16, v67
    v_lshlrev_b32 v68, 16, v68
    v_lshlrev_b32 v69, 16, v69
    v_lshlrev_b32 v70, 16, v70
    v_lshlrev_b32 v71, 16, v71
    v_lshlrev_b32 v72, 16, v72
    v_lshlrev_b32 v73, 16, v73
    v_lshlrev_b32 v74, 16, v74
    v_lshlrev_b32 v75, 16, v75
    v_lshlrev_b32 v76, 16, v76
    v_lshlrev_b32 v77, 16, v77
    v_lshlrev_b32 v78, 16, v78
    v_lshlrev_b32 v79, 16, v79
    v_mul_f32 v64, v64, v16
    v_mul_f32 v65, v65, v17
    v_mul_f32 v66, v66, v18
    v_mul_f32 v67, v67, v19
    v_mul_f32 v68, v68, v20
    v_mul_f32 v69, v69, v21
    v_mul_f32 v70, v70, v22
    v_mul_f32 v71, v71, v23
    v_mul_f32 v72, v72, v24
    v_mul_f32 v73, v73, v25
    v_mul_f32 v74, v74, v26
    v_mul_f32 v75, v75, v27
    v_mul_f32 v76, v76, v28
    v_mul_f32 v77, v77, v29
    v_mul_f32 v78, v78, v30
    v_mul_f32 v79, v79, v31
    v_cvt_pk_bf16_f32 v64, v64, v64
    v_cvt_pk_bf16_f32 v65, v65, v65
    v_cvt_pk_bf16_f32 v66, v66, v66
    v_cvt_pk_bf16_f32 v67, v67, v67
    v_cvt_pk_bf16_f32 v68, v68, v68
    v_cvt_pk_bf16_f32 v69, v69, v69
    v_cvt_pk_bf16_f32 v70, v70, v70
    v_cvt_pk_bf16_f32 v71, v71, v71
    v_cvt_pk_bf16_f32 v72, v72, v72
    v_cvt_pk_bf16_f32 v73, v73, v73
    v_cvt_pk_bf16_f32 v74, v74, v74
    v_cvt_pk_bf16_f32 v75, v75, v75
    v_cvt_pk_bf16_f32 v76, v76, v76
    v_cvt_pk_bf16_f32 v77, v77, v77
    v_cvt_pk_bf16_f32 v78, v78, v78
    v_cvt_pk_bf16_f32 v79, v79, v79
    v_lshlrev_b32 v64, 16, v64
    v_lshlrev_b32 v65, 16, v65
    v_lshlrev_b32 v66, 16, v66
    v_lshlrev_b32 v67, 16, v67
    v_lshlrev_b32 v68, 16, v68
    v_lshlrev_b32 v69, 16, v69
    v_lshlrev_b32 v70, 16, v70
    v_lshlrev_b32 v71, 16, v71
    v_lshlrev_b32 v72, 16, v72
    v_lshlrev_b32 v73, 16, v73
    v_lshlrev_b32 v74, 16, v74
    v_lshlrev_b32 v75, 16, v75
    v_lshlrev_b32 v76, 16, v76
    v_lshlrev_b32 v77, 16, v77
    v_lshlrev_b32 v78, 16, v78
    v_lshlrev_b32 v79, 16, v79
    v_add_f32 v64, v64, v80
    v_add_f32 v65, v65, v81
    v_add_f32 v66, v66, v82
    v_add_f32 v67, v67, v83
    v_add_f32 v68, v68, v84
    v_add_f32 v69, v69, v85
    v_add_f32 v70, v70, v86
    v_add_f32 v71, v71, v87
    v_add_f32 v72, v72, v88
    v_add_f32 v73, v73, v89
    v_add_f32 v74, v74, v90
    v_add_f32 v75, v75, v91
    v_add_f32 v76, v76, v92
    v_add_f32 v77, v77, v93
    v_add_f32 v78, v78, v94
    v_add_f32 v79, v79, v95
    v_cvt_pk_bf16_f32 v96, v64, v65
    v_cvt_pk_bf16_f32 v97, v66, v67
    v_cvt_pk_bf16_f32 v98, v68, v69
    v_cvt_pk_bf16_f32 v99, v70, v71
    v_cvt_pk_bf16_f32 v100, v72, v73
    v_cvt_pk_bf16_f32 v101, v74, v75
    v_cvt_pk_bf16_f32 v102, v76, v77
    v_cvt_pk_bf16_f32 v103, v78, v79
    buffer_store_dwordx4 v[96:99], v9, s[12:15], s63 offen sc1
    buffer_store_dwordx4 v[100:103], v9, s[12:15], s63 offen offset:1024 sc1
    v_lshlrev_b32 v64, 16, v96
    v_and_b32 v65, 0xffff0000, v96
    v_lshlrev_b32 v66, 16, v97
    v_and_b32 v67, 0xffff0000, v97
    v_lshlrev_b32 v68, 16, v98
    v_and_b32 v69, 0xffff0000, v98
    v_lshlrev_b32 v70, 16, v99
    v_and_b32 v71, 0xffff0000, v99
    v_lshlrev_b32 v72, 16, v100
    v_and_b32 v73, 0xffff0000, v100
    v_lshlrev_b32 v74, 16, v101
    v_and_b32 v75, 0xffff0000, v101
    v_lshlrev_b32 v76, 16, v102
    v_and_b32 v77, 0xffff0000, v102
    v_lshlrev_b32 v78, 16, v103
    v_and_b32 v79, 0xffff0000, v103
    v_pk_add_f32 v[80:81], v[64:65], v[72:73]
    v_pk_add_f32 v[82:83], v[66:67], v[74:75]
    v_pk_add_f32 v[84:85], v[68:69], v[76:77]
    v_pk_add_f32 v[86:87], v[70:71], v[78:79]
    v_pk_add_f32 v[80:81], v[80:81], v[84:85]
    v_pk_add_f32 v[82:83], v[82:83], v[86:87]
    v_pk_add_f32 v[80:81], v[80:81], v[82:83]
    v_add_f32 v14, v80, v81
    s_nop 1
    v_add_f32_dpp v14, v14, v14 row_shr:1 row_mask:0xf bank_mask:0xf bound_ctrl:0
    s_nop 1
    v_add_f32_dpp v14, v14, v14 row_shr:2 row_mask:0xf bank_mask:0xf bound_ctrl:0
    s_nop 1
    v_add_f32_dpp v14, v14, v14 row_shr:4 row_mask:0xf bank_mask:0xf bound_ctrl:0
    s_nop 1
    v_add_f32_dpp v14, v14, v14 row_shr:8 row_mask:0xf bank_mask:0xf bound_ctrl:0
    s_nop 1
    v_add_f32_dpp v14, v14, v14 row_bcast:15 row_mask:0xa bank_mask:0xf
    s_nop 1
    v_add_f32_dpp v14, v14, v14 row_bcast:31 row_mask:0xc bank_mask:0xf
    s_nop 1
    v_readlane_b32 s46, v14, 63
    s_nop 1
    v_mov_b32 v15, s46
    v_mul_f32 v15, 0x3a800000, v15
    v_sub_f32 v80, v64, v15
    v_sub_f32 v81, v65, v15
    v_sub_f32 v82, v66, v15
    v_sub_f32 v83, v67, v15
    v_sub_f32 v84, v68, v15
    v_sub_f32 v85, v69, v15
    v_sub_f32 v86, v70, v15
    v_sub_f32 v87, v71, v15
    v_sub_f32 v88, v72, v15
    v_sub_f32 v89, v73, v15
    v_sub_f32 v90, v74, v15
    v_sub_f32 v91, v75, v15
    v_sub_f32 v92, v76, v15
    v_sub_f32 v93, v77, v15
    v_sub_f32 v94, v78, v15
    v_sub_f32 v95, v79, v15
    v_mul_f32 v14, v80, v80
    v_mul_f32 v104, v81, v81
    v_fmac_f32 v14, v82, v82
    v_fmac_f32 v104, v83, v83
    v_fmac_f32 v14, v84, v84
    v_fmac_f32 v104, v85, v85
    v_fmac_f32 v14, v86, v86
    v_fmac_f32 v104, v87, v87
    v_fmac_f32 v14, v88, v88
    v_fmac_f32 v104, v89, v89
    v_fmac_f32 v14, v90, v90
    v_fmac_f32 v104, v91, v91
    v_fmac_f32 v14, v92, v92
    v_fmac_f32 v104, v93, v93
    v_fmac_f32 v14, v94, v94
    v_fmac_f32 v104, v95, v95
    v_add_f32 v14, v14, v104
    s_nop 1
    v_add_f32_dpp v14, v14, v14 row_shr:1 row_mask:0xf bank_mask:0xf bound_ctrl:0
    s_nop 1
    v_add_f32_dpp v14, v14, v14 row_shr:2 row_mask:0xf bank_mask:0xf bound_ctrl:0
    s_nop 1
    v_add_f32_dpp v14, v14, v14 row_shr:4 row_mask:0xf bank_mask:0xf bound_ctrl:0
    s_nop 1
    v_add_f32_dpp v14, v14, v14 row_shr:8 row_mask:0xf bank_mask:0xf bound_ctrl:0
    s_nop 1
    v_add_f32_dpp v14, v14, v14 row_bcast:15 row_mask:0xa bank_mask:0xf
    s_nop 1
    v_add_f32_dpp v14, v14, v14 row_bcast:31 row_mask:0xc bank_mask:0xf
    s_nop 1
    v_readlane_b32 s47, v14, 63
    v_cvt_pk_bf16_f32 v15, v15, v15
    v_lshlrev_b32 v15, 16, v15
    v_mov_b32 v14, s47
    v_mul_f32 v14, 0x3a800000, v14
    v_cvt_pk_bf16_f32 v14, v14, v14
    v_lshlrev_b32 v14, 16, v14
    v_add_f32 v14, 0x3727c5ac, v14
    v_cvt_pk_bf16_f32 v14, v14, v14
    v_lshlrev_b32 v14, 16, v14
    v_sqrt_f32 v14, v14
    s_nop 0
    v_cvt_pk_bf16_f32 v14, v14, v14
    v_lshlrev_b32 v14, 16, v14
    v_rcp_f32 v14, v14
    v_sub_f32 v64, v64, v15
    v_sub_f32 v65, v65, v15
    v_sub_f32 v66, v66, v15
    v_sub_f32 v67, v67, v15
    v_sub_f32 v68, v68, v15
    v_sub_f32 v69, v69, v15
    v_sub_f32 v70, v70, v15
    v_sub_f32 v71, v71, v15
    v_sub_f32 v72, v72, v15
    v_sub_f32 v73, v73, v15
    v_sub_f32 v74, v74, v15
    v_sub_f32 v75, v75, v15
    v_sub_f32 v76, v76, v15
    v_sub_f32 v77, v77, v15
    v_sub_f32 v78, v78, v15
    v_sub_f32 v79, v79, v15
    v_cvt_pk_bf16_f32 v64, v64, v64
    v_cvt_pk_bf16_f32 v65, v65, v65
    v_cvt_pk_bf16_f32 v66, v66, v66
    v_cvt_pk_bf16_f32 v67, v67, v67
    v_cvt_pk_bf16_f32 v68, v68, v68
    v_cvt_pk_bf16_f32 v69, v69, v69
    v_cvt_pk_bf16_f32 v70, v70, v70
    v_cvt_pk_bf16_f32 v71, v71, v71
    v_cvt_pk_bf16_f32 v72, v72, v72
    v_cvt_pk_bf16_f32 v73, v73, v73
    v_cvt_pk_bf16_f32 v74, v74, v74
    v_cvt_pk_bf16_f32 v75, v75, v75
    v_cvt_pk_bf16_f32 v76, v76, v76
    v_cvt_pk_bf16_f32 v77, v77, v77
    v_cvt_pk_bf16_f32 v78, v78, v78
    v_cvt_pk_bf16_f32 v79, v79, v79
    v_lshlrev_b32 v64, 16, v64
    v_lshlrev_b32 v65, 16, v65
    v_lshlrev_b32 v66, 16, v66
    v_lshlrev_b32 v67, 16, v67
    v_lshlrev_b32 v68, 16, v68
    v_lshlrev_b32 v69, 16, v69
    v_lshlrev_b32 v70, 16, v70
    v_lshlrev_b32 v71, 16, v71
    v_lshlrev_b32 v72, 16, v72
    v_lshlrev_b32 v73, 16, v73
    v_lshlrev_b32 v74, 16, v74
    v_lshlrev_b32 v75, 16, v75
    v_lshlrev_b32 v76, 16, v76
    v_lshlrev_b32 v77, 16, v77
    v_lshlrev_b32 v78, 16, v78
    v_lshlrev_b32 v79, 16, v79
    v_mul_f32 v64, v64, v14
    v_mul_f32 v65, v65, v14
    v_mul_f32 v66, v66, v14
    v_mul_f32 v67, v67, v14
    v_mul_f32 v68, v68, v14
    v_mul_f32 v69, v69, v14
    v_mul_f32 v70, v70, v14
    v_mul_f32 v71, v71, v14
    v_mul_f32 v72, v72, v14
    v_mul_f32 v73, v73, v14
    v_mul_f32 v74, v74, v14
    v_mul_f32 v75, v75, v14
    v_mul_f32 v76, v76, v14
    v_mul_f32 v77, v77, v14
    v_mul_f32 v78, v78, v14
    v_mul_f32 v79, v79, v14
    v_cvt_pk_bf16_f32 v64, v64, v64
    v_cvt_pk_bf16_f32 v65, v65, v65
    v_cvt_pk_bf16_f32 v66, v66, v66
    v_cvt_pk_bf16_f32 v67, v67, v67
    v_cvt_pk_bf16_f32 v68, v68, v68
    v_cvt_pk_bf16_f32 v69, v69, v69
    v_cvt_pk_bf16_f32 v70, v70, v70
    v_cvt_pk_bf16_f32 v71, v71, v71
    v_cvt_pk_bf16_f32 v72, v72, v72
    v_cvt_pk_bf16_f32 v73, v73, v73
    v_cvt_pk_bf16_f32 v74, v74, v74
    v_cvt_pk_bf16_f32 v75, v75, v75
    v_cvt_pk_bf16_f32 v76, v76, v76
    v_cvt_pk_bf16_f32 v77, v77, v77
    v_cvt_pk_bf16_f32 v78, v78, v78
    v_cvt_pk_bf16_f32 v79, v79, v79
    v_lshlrev_b32 v64, 16, v64
    v_lshlrev_b32 v65, 16, v65
    v_lshlrev_b32 v66, 16, v66
    v_lshlrev_b32 v67, 16, v67
    v_lshlrev_b32 v68, 16, v68
    v_lshlrev_b32 v69, 16, v69
    v_lshlrev_b32 v70, 16, v70
    v_lshlrev_b32 v71, 16, v71
    v_lshlrev_b32 v72, 16, v72
    v_lshlrev_b32 v73, 16, v73
    v_lshlrev_b32 v74, 16, v74
    v_lshlrev_b32 v75, 16, v75
    v_lshlrev_b32 v76, 16, v76
    v_lshlrev_b32 v77, 16, v77
    v_lshlrev_b32 v78, 16, v78
    v_lshlrev_b32 v79, 16, v79
    v_mul_f32 v64, v64, v32
    v_mul_f32 v65, v65, v33
    v_mul_f32 v66, v66, v34
    v_mul_f32 v67, v67, v35
    v_mul_f32 v68, v68, v36
    v_mul_f32 v69, v69, v37
    v_mul_f32 v70, v70, v38
    v_mul_f32 v71, v71, v39
    v_mul_f32 v72, v72, v40
    v_mul_f32 v73, v73, v41
    v_mul_f32 v74, v74, v42
    v_mul_f32 v75, v75, v43
    v_mul_f32 v76, v76, v44
    v_mul_f32 v77, v77, v45
    v_mul_f32 v78, v78, v46
    v_mul_f32 v79, v79, v47
    v_cvt_pk_bf16_f32 v64, v64, v64
    v_cvt_pk_bf16_f32 v65, v65, v65
    v_cvt_pk_bf16_f32 v66, v66, v66
    v_cvt_pk_bf16_f32 v67, v67, v67
    v_cvt_pk_bf16_f32 v68, v68, v68
    v_cvt_pk_bf16_f32 v69, v69, v69
    v_cvt_pk_bf16_f32 v70, v70, v70
    v_cvt_pk_bf16_f32 v71, v71, v71
    v_cvt_pk_bf16_f32 v72, v72, v72
    v_cvt_pk_bf16_f32 v73, v73, v73
    v_cvt_pk_bf16_f32 v74, v74, v74
    v_cvt_pk_bf16_f32 v75, v75, v75
    v_cvt_pk_bf16_f32 v76, v76, v76
    v_cvt_pk_bf16_f32 v77, v77, v77
    v_cvt_pk_bf16_f32 v78, v78, v78
    v_cvt_pk_bf16_f32 v79, v79, v79
    v_lshlrev_b32 v64, 16, v64
    v_lshlrev_b32 v65, 16, v65
    v_lshlrev_b32 v66, 16, v66
    v_lshlrev_b32 v67, 16, v67
    v_lshlrev_b32 v68, 16, v68
    v_lshlrev_b32 v69, 16, v69
    v_lshlrev_b32 v70, 16, v70
    v_lshlrev_b32 v71, 16, v71
    v_lshlrev_b32 v72, 16, v72
    v_lshlrev_b32 v73, 16, v73
    v_lshlrev_b32 v74, 16, v74
    v_lshlrev_b32 v75, 16, v75
    v_lshlrev_b32 v76, 16, v76
    v_lshlrev_b32 v77, 16, v77
    v_lshlrev_b32 v78, 16, v78
    v_lshlrev_b32 v79, 16, v79
    v_add_f32 v64, v64, v48
    v_add_f32 v65, v65, v49
    v_add_f32 v66, v66, v50
    v_add_f32 v67, v67, v51
    v_add_f32 v68, v68, v52
    v_add_f32 v69, v69, v53
    v_add_f32 v70, v70, v54
    v_add_f32 v71, v71, v55
    v_add_f32 v72, v72, v56
    v_add_f32 v73, v73, v57
    v_add_f32 v74, v74, v58
    v_add_f32 v75, v75, v59
    v_add_f32 v76, v76, v60
    v_add_f32 v77, v77, v61
    v_add_f32 v78, v78, v62
    v_add_f32 v79, v79, v63
    v_cvt_pk_bf16_f32 v104, v64, v65
    v_cvt_pk_bf16_f32 v105, v66, v67
    v_cvt_pk_bf16_f32 v106, v68, v69
    v_cvt_pk_bf16_f32 v107, v70, v71
    v_cvt_pk_bf16_f32 v108, v72, v73
    v_cvt_pk_bf16_f32 v109, v74, v75
    v_cvt_pk_bf16_f32 v110, v76, v77
    v_cvt_pk_bf16_f32 v111, v78, v79
    ds_write_b128 v10, v[104:107]
    ds_write_b128 v10, v[108:111] offset:1024
    s_waitcnt lgkmcnt(0)
    s_barrier
    ds_read_b128 v[104:107], v13
    ds_read_b128 v[108:111], v13 offset:128
    s_waitcnt lgkmcnt(1)
    buffer_store_dwordx4 v[104:107], v11, s[12:15], s63 offen sc1
    s_waitcnt lgkmcnt(0)
    buffer_store_dwordx4 v[108:111], v12, s[12:15], s63 offen sc1
    s_waitcnt vmcnt(0)
    s_barrier
    s_cmp_lg_u32 s44, 0
    s_cbranch_scc1 L_sf_35
    v_mov_b32 v14, s60
    v_add_u32 v14, 1, v14
    v_mov_b32 v15, 0
    s_mov_b64 exec, 1
    buffer_store_dword v14, v15, s[12:15], s52 offen sc1
    s_mov_b64 exec, -1
L_sf_35:
    s_add_u32 s60, s60, 3
    s_cmp_lt_u32 s60, 64
    s_cbranch_scc1 L_r_loop_31
    s_branch L_c_done_4
L_w_att_22:
    s_lshl_b32 s42, s40, 2
    s_and_b32 s46, s44, 3
    s_add_u32 s42, s42, s46
    s_lshr_b32 s43, s44, 2
    s_mul_i32 s46, s42, 24576
    s_add_u32 s46, s46, 0x2000000
    v_lshlrev_b32 v2, 4, v1
    v_add_u32 v3, s46, v2
    v_add_u32 v5, 4096, v3
    v_lshrrev_b32 v4, 4, v1
    v_and_b32 v9, 15, v1
    s_lshl_b32 s46, s42, 12
    s_add_u32 s46, s46, 0x1000000
    v_and_b32 v6, 7, v1
    v_lshlrev_b32 v6, 4, v6
    v_lshl_add_u32 v6, v4, 7, v6
    v_add_u32 v6, s46, v6
    v_and_b32 v7, 31, v1
    v_lshlrev_b32 v7, 4, v7
    v_lshrrev_b32 v10, 5, v1
    v_lshl_add_u32 v7, v10, 10, v7
    v_add_u32 v7, s46, v7
    s_mul_i32 s50, s44, 13056
    v_mul_u32_u24 v8, 272, v9
    v_lshl_add_u32 v8, v4, 4, v8
    v_add_u32 v8, s50, v8
    v_bfe_u32 v11, v1, 2, 3
    v_mul_u32_u24 v11, 272, v11
    v_lshl_add_u32 v11, v10, 6, v11
    v_and_b32 v12, 3, v1
    v_lshl_add_u32 v11, v12, 4, v11
    v_add_u32 v11, s50, v11
    v_mul_u32_u24 v14, 272, v4
    v_lshl_add_u32 v14, v9, 4, v14
    v_add_u32 v14, s50, v14
    v_mov_b32 v16, 0
    v_mov_b32 v17, 0
    v_mov_b32 v18, 0
    v_mov_b32 v19, 0
    ds_write_b128 v14, v[16:19] offset:10880
    ds_write_b128 v14, v[16:19] offset:11968
    v_lshlrev_b32 v12, 2, v4
    v_bfe_u32 v13, v1, 2, 2
    v_add_u32 v12, v12, v13
    v_mul_u32_u24 v12, 272, v12
    v_and_b32 v13, 3, v1
    v_lshl_add_u32 v12, v13, 3, v12
    v_add_u32 v12, s50, v12
    v_lshlrev_b32 v13, 10, v13
    s_lshl_b32 s46, s42, 12
    s_add_u32 s46, s46, 0x1000000
    v_add_u32 v13, s46, v13
    v_lshlrev_b32 v10, 9, v4
    v_lshl_add_u32 v10, v9, 4, v10
    s_lshl_b32 s46, s42, 13
    s_add_u32 s46, s46, 0x5000000
    v_add_u32 v10, s46, v10
    s_lshl_b32 s52, s42, 8
    s_lshl_b32 s47, s43, 7
    s_add_u32 s52, s52, s47
    s_add_u32 s52, s52, 0x104000
    v_min_u32 v42, 2, v1
    v_lshlrev_b32 v42, 9, v42
    s_lshl_b32 s46, s40, 11
    s_and_b32 s47, s42, 3
    s_lshl_b32 s47, s47, 7
    s_add_u32 s46, s46, s47
    s_add_u32 s46, s46, 0x10a800
    v_add_u32 v48, s46, v42
    v_cmp_le_u32 s[56:57], 32, v1
    v_lshlrev_b32 v14, 2, v4
    s_mov_b32 s54, 0x3e0293ee
    s_mov_b32 s60, s43
    v_add_u32 v15, 0, v14
    v_cmp_gt_u32 s[84:85], v15, v9
    v_add_u32 v15, 1, v14
    v_cmp_gt_u32 s[86:87], v15, v9
    v_add_u32 v15, 2, v14
    v_cmp_gt_u32 s[88:89], v15, v9
    v_add_u32 v15, 3, v14
    v_cmp_gt_u32 s[90:91], v15, v9
    v_and_b32 v41, 15, v1
    v_lshlrev_b32 v41, 2, v41
    s_lshl_b32 s46, s40, 6
    s_add_u32 s46, s46, 0x101000
    s_mov_b32 s47, 0
    s_mov_b32 s70, 0
L_spin_36:
    buffer_load_dword v40, v41, s[12:15], s46 offen sc1
    s_waitcnt vmcnt(0)
    v_cmp_ge_u32 vcc, s47, v40
    s_add_u32 s70, s70, 1
    s_cbranch_vccz L_spok_37
    s_sleep 8
    s_cmp_lt_u32 s70, 524288
    s_cbranch_scc1 L_spin_36
    s_branch L_c_done_4
L_spok_37:
L_a_loop_38:
    s_mul_i32 s45, s60, 786432
    s_add_u32 s48, s45, 8192
    s_add_u32 s49, s45, 16384
    s_lshl_b32 s61, s60, 17
    s_lshl_b32 s63, s60, 18
    s_mov_b32 s70, 0
L_spin_39:
    buffer_load_dword v40, v48, s[12:15], 0 offen sc1
    s_waitcnt vmcnt(0)
    v_cmp_ge_u32 vcc, s60, v40
    s_add_u32 s70, s70, 1
    s_cbranch_vccz L_spok_40
    s_sleep 8
    s_cmp_lt_u32 s70, 524288
    s_cbranch_scc1 L_spin_39
    s_branch L_c_done_4
L_spok_40:
    buffer_load_dwordx4 a[0:3], v3, s[12:15], s45 offen offset:0 sc1
    buffer_load_dwordx4 a[4:7], v3, s[12:15], s45 offen offset:1024 sc1
    buffer_load_dwordx4 a[8:11], v3, s[12:15], s45 offen offset:2048 sc1
    buffer_load_dwordx4 a[12:15], v3, s[12:15], s45 offen offset:3072 sc1
    buffer_load_dwordx4 a[16:19], v5, s[12:15], s45 offen offset:0 sc1
    buffer_load_dwordx4 a[20:23], v5, s[12:15], s45 offen offset:1024 sc1
    buffer_load_dwordx4 a[24:27], v5, s[12:15], s45 offen offset:2048 sc1
    buffer_load_dwordx4 a[28:31], v5, s[12:15], s45 offen offset:3072 sc1
    buffer_load_dwordx4 a[32:35], v3, s[12:15], s48 offen offset:0 sc1
    buffer_load_dwordx4 a[36:39], v3, s[12:15], s48 offen offset:1024 sc1
    buffer_load_dwordx4 a[40:43], v3, s[12:15], s48 offen offset:2048 sc1
    buffer_load_dwordx4 a[44:47], v3, s[12:15], s48 offen offset:3072 sc1
    buffer_load_dwordx4 a[48:51], v5, s[12:15], s48 offen offset:0 sc1
    buffer_load_dwordx4 a[52:55], v5, s[12:15], s48 offen offset:1024 sc1
    buffer_load_dwordx4 a[56:59], v5, s[12:15], s48 offen offset:2048 sc1
    buffer_load_dwordx4 a[60:63], v5, s[12:15], s48 offen offset:3072 sc1
    buffer_load_dwordx4 v[16:19], v3, s[12:15], s49 offen offset:0 sc1
    buffer_load_dwordx4 v[20:23], v3, s[12:15], s49 offen offset:1024 sc1
    buffer_load_dwordx4 v[24:27], v3, s[12:15], s49 offen offset:2048 sc1
    buffer_load_dwordx4 v[28:31], v3, s[12:15], s49 offen offset:3072 sc1
    buffer_load_dwordx4 v[32:35], v5, s[12:15], s49 offen offset:0 sc1
    buffer_load_dwordx4 v[36:39], v5, s[12:15], s49 offen offset:1024 sc1
    buffer_load_dwordx4 v[40:43], v5, s[12:15], s49 offen offset:2048 sc1
    buffer_load_dwordx4 v[44:47], v5, s[12:15], s49 offen offset:3072 sc1
    s_waitcnt vmcnt(0)
    ds_write_b128 v8, v[16:19] offset:0
    ds_write_b128 v8, v[20:23] offset:64
    ds_write_b128 v8, v[24:27] offset:128
    ds_write_b128 v8, v[28:31] offset:192
    ds_write_b128 v8, v[32:35] offset:4352
    ds_write_b128 v8, v[36:39] offset:4416
    ds_write_b128 v8, v[40:43] offset:4480
    ds_write_b128 v8, v[44:47] offset:4544
    v_mfma_f32_16x16x32_bf16 v[56:59], a[32:35], a[0:3], 0
    v_mfma_f32_16x16x32_bf16 v[60:63], a[32:35], a[16:19], 0
    v_mfma_f32_16x16x32_bf16 v[68:71], a[48:51], a[16:19], 0
    v_mfma_f32_16x16x32_bf16 v[56:59], a[36:39], a[4:7], v[56:59]
    v_mfma_f32_16x16x32_bf16 v[60:63], a[36:39], a[20:23], v[60:63]
    v_mfma_f32_16x16x32_bf16 v[68:71], a[52:55], a[20:23], v[68:71]
    v_mfma_f32_16x16x32_bf16 v[56:59], a[40:43], a[8:11], v[56:59]
    v_mfma_f32_16x16x32_bf16 v[60:63], a[40:43], a[24:27], v[60:63]
    v_mfma_f32_16x16x32_bf16 v[68:71], a[56:59], a[24:27], v[68:71]
    v_mfma_f32_16x16x32_bf16 v[56:59], a[44:47], a[12:15], v[56:59]
    v_mfma_f32_16x16x32_bf16 v[60:63], a[44:47], a[28:31], v[60:63]
    v_mfma_f32_16x16x32_bf16 v[68:71], a[60:63], a[28:31], v[68:71]
    s_waitcnt lgkmcnt(0)
    ds_read_b64_tr_b16 a[80:81], v12 offset:0
    ds_read_b64_tr_b16 a[82:83], v12 offset:4352
    ds_read_b64_tr_b16 a[86:87], v12 offset:32
    ds_read_b64_tr_b16 a[88:89], v12 offset:4384
    ds_read_b64_tr_b16 a[92:93], v12 offset:64
    ds_read_b64_tr_b16 a[94:95], v12 offset:4416
    ds_read_b64_tr_b16 a[98:99], v12 offset:96
    ds_read_b64_tr_b16 a[100:101], v12 offset:4448
    s_waitcnt lgkmcnt(0)
    ds_read_b64_tr_b16 a[104:105], v12 offset:128
    ds_read_b64_tr_b16 a[106:107], v12 offset:4480
    ds_read_b64_tr_b16 a[110:111], v12 offset:160
    ds_read_b64_tr_b16 a[112:113], v12 offset:4512
    ds_read_b64_tr_b16 a[116:117], v12 offset:192
    ds_read_b64_tr_b16 a[118:119], v12 offset:4544
    ds_read_b64_tr_b16 a[122:123], v12 offset:224
    ds_read_b64_tr_b16 a[124:125], v12 offset:4576
    v_mov_b32 v15, 0xff800000
    v_cndmask_b32 v56, v56, v15, s[84:85]
    v_cndmask_b32 v68, v68, v15, s[84:85]
    v_cndmask_b32 v57, v57, v15, s[86:87]
    v_cndmask_b32 v69, v69, v15, s[86:87]
    v_cndmask_b32 v58, v58, v15, s[88:89]
    v_cndmask_b32 v70, v70, v15, s[88:89]
    v_cndmask_b32 v59, v59, v15, s[90:91]
    v_cndmask_b32 v71, v71, v15, s[90:91]
    s_mov_b32 s70, 0
L_a_cp_41:
    buffer_load_dword v40, v13, s[12:15], s61 offen sc1
    s_waitcnt vmcnt(0)
    v_cmp_eq_u32 vcc, -1, v40
    s_add_u32 s70, s70, 1
    s_cbranch_vccz L_a_fl_42
L_a_cp_41_s:
    s_sleep 16
    s_cmp_lt_u32 s70, 524288
    s_cbranch_scc1 L_a_cp_41
    s_branch L_c_done_4
L_a_fl_42:
    buffer_load_dwordx4 v[24:27], v6, s[12:15], s61 offen offset:0 sc1
    buffer_load_dwordx4 v[28:31], v6, s[12:15], s61 offen offset:1024 sc1
    buffer_load_dwordx4 v[32:35], v6, s[12:15], s61 offen offset:2048 sc1
    buffer_load_dwordx4 v[36:39], v6, s[12:15], s61 offen offset:3072 sc1
    buffer_load_dwordx4 v[16:19], v7, s[12:15], s61 offen offset:512 sc1
    buffer_load_dwordx4 v[20:23], v7, s[12:15], s61 offen offset:2560 sc1
    s_waitcnt vmcnt(0)
    v_max_u32 v40, v16, v17
    v_max3_u32 v40, v40, v18, v19
    v_max3_u32 v40, v40, v20, v21
    v_max3_u32 v40, v40, v22, v23
    v_max3_u32 v40, v40, v24, v25
    v_max3_u32 v40, v40, v26, v27
    v_max3_u32 v40, v40, v28, v29
    v_max3_u32 v40, v40, v30, v31
    v_max3_u32 v40, v40, v32, v33
    v_max3_u32 v40, v40, v34, v35
    v_max3_u32 v40, v40, v36, v37
    v_max3_u32 v40, v40, v38, v39
    v_cmp_eq_u32 vcc, -1, v40
    s_nop 0
    s_cbranch_vccnz L_a_cp_41_s
    v_mfma_f32_16x16x32_bf16 v[72:75], v[24:27], a[0:3], 0
    v_mfma_f32_16x16x32_bf16 v[76:79], v[24:27], a[16:19], 0
    v_mfma_f32_16x16x32_bf16 v[72:75], v[28:31], a[4:7], v[72:75]
    v_mfma_f32_16x16x32_bf16 v[76:79], v[28:31], a[20:23], v[76:79]
    v_mfma_f32_16x16x32_bf16 v[72:75], v[32:35], a[8:11], v[72:75]
    v_mfma_f32_16x16x32_bf16 v[76:79], v[32:35], a[24:27], v[76:79]
    v_mfma_f32_16x16x32_bf16 v[72:75], v[36:39], a[12:15], v[72:75]
    v_mfma_f32_16x16x32_bf16 v[76:79], v[36:39], a[28:31], v[76:79]
    ds_write_b128 v11, v[16:19] offset:8704
    ds_write_b128 v11, v[20:23] offset:8832
    s_waitcnt lgkmcnt(0)
    ds_read_b64_tr_b16 a[84:85], v12 offset:8704
    ds_read_b64_tr_b16 a[90:91], v12 offset:8736
    ds_read_b64_tr_b16 a[96:97], v12 offset:8768
    ds_read_b64_tr_b16 a[102:103], v12 offset:8800
    ds_read_b64_tr_b16 a[108:109], v12 offset:8832
    ds_read_b64_tr_b16 a[114:115], v12 offset:8864
    ds_read_b64_tr_b16 a[120:121], v12 offset:8896
    ds_read_b64_tr_b16 a[126:127], v12 offset:8928
    v_cndmask_b32 v72, v72, v15, s[56:57]
    v_cndmask_b32 v73, v73, v15, s[56:57]
    v_cndmask_b32 v74, v74, v15, s[56:57]
    v_cndmask_b32 v75, v75, v15, s[56:57]
    v_cndmask_b32 v76, v76, v15, s[56:57]
    v_cndmask_b32 v77, v77, v15, s[56:57]
    v_cndmask_b32 v78, v78, v15, s[56:57]
    v_cndmask_b32 v79, v79, v15, s[56:57]
    v_max_f32 v40, v56, v57
    v_max3_f32 v40, v40, v58, v59
    v_max3_f32 v40, v40, v72, v73
    v_max3_f32 v40, v40, v74, v75
    v_mov_b32 v41, v40
    s_nop 1
    v_permlane16_swap_b32 v40, v41
    v_max_f32 v40, v40, v41
    v_mov_b32 v41, v40
    s_nop 1
    v_permlane32_swap_b32 v40, v41
    v_max_f32 v40, v40, v41
    v_mul_f32 v40, s54, v40
    v_fma_f32 v56, v56, s54, -v40
    v_fma_f32 v57, v57, s54, -v40
    v_fma_f32 v58, v58, s54, -v40
    v_fma_f32 v59, v59, s54, -v40
    v_fma_f32 v72, v72, s54, -v40
    v_fma_f32 v73, v73, s54, -v40
    v_fma_f32 v74, v74, s54, -v40
    v_fma_f32 v75, v75, s54, -v40
    v_exp_f32 v56, v56
    v_exp_f32 v57, v57
    v_exp_f32 v58, v58
    v_exp_f32 v59, v59
    v_exp_f32 v72, v72
    v_exp_f32 v73, v73
    v_exp_f32 v74, v74
    v_exp_f32 v75, v75
    v_add_f32 v40, v56, v57
    v_add_f32 v40, v40, v58
    v_add_f32 v40, v40, v59
    v_add_f32 v40, v40, v72
    v_add_f32 v40, v40, v73
    v_add_f32 v40, v40, v74
    v_add_f32 v40, v40, v75
    v_mov_b32 v41, v40
    s_nop 1
    v_permlane16_swap_b32 v40, v41
    v_add_f32 v40, v40, v41
    v_mov_b32 v41, v40
    s_nop 1
    v_permlane32_swap_b32 v40, v41
    v_add_f32 v40, v40, v41
    v_rcp_f32 v40, v40
    s_nop 0
    v_mul_f32 v56, v56, v40
    v_mul_f32 v57, v57, v40
    v_mul_f32 v58, v58, v40
    v_mul_f32 v59, v59, v40
    v_mul_f32 v72, v72, v40
    v_mul_f32 v73, v73, v40
    v_mul_f32 v74, v74, v40
    v_mul_f32 v75, v75, v40
    v_cvt_pk_bf16_f32 v24, v56, v57
    v_cvt_pk_bf16_f32 v25, v58, v59
    v_cvt_pk_bf16_f32 v28, v72, v73
    v_cvt_pk_bf16_f32 v29, v74, v75
    v_max_f32 v40, v60, v61
    v_max3_f32 v40, v40, v62, v63
    v_max3_f32 v40, v40, v68, v69
    v_max3_f32 v40, v40, v70, v71
    v_max3_f32 v40, v40, v76, v77
    v_max3_f32 v40, v40, v78, v79
    v_mov_b32 v41, v40
    s_nop 1
    v_permlane16_swap_b32 v40, v41
    v_max_f32 v40, v40, v41
    v_mov_b32 v41, v40
    s_nop 1
    v_permlane32_swap_b32 v40, v41
    v_max_f32 v40, v40, v41
    v_mul_f32 v40, s54, v40
    v_fma_f32 v60, v60, s54, -v40
    v_fma_f32 v61, v61, s54, -v40
    v_fma_f32 v62, v62, s54, -v40
    v_fma_f32 v63, v63, s54, -v40
    v_fma_f32 v68, v68, s54, -v40
    v_fma_f32 v69, v69, s54, -v40
    v_fma_f32 v70, v70, s54, -v40
    v_fma_f32 v71, v71, s54, -v40
    v_fma_f32 v76, v76, s54, -v40
    v_fma_f32 v77, v77, s54, -v40
    v_fma_f32 v78, v78, s54, -v40
    v_fma_f32 v79, v79, s54, -v40
    v_exp_f32 v60, v60
    v_exp_f32 v61, v61
    v_exp_f32 v62, v62
    v_exp_f32 v63, v63
    v_exp_f32 v68, v68
    v_exp_f32 v69, v69
    v_exp_f32 v70, v70
    v_exp_f32 v71, v71
    v_exp_f32 v76, v76
    v_exp_f32 v77, v77
    v_exp_f32 v78, v78
    v_exp_f32 v79, v79
    v_add_f32 v40, v60, v61
    v_add_f32 v40, v40, v62
    v_add_f32 v40, v40, v63
    v_add_f32 v40, v40, v68
    v_add_f32 v40, v40, v69
    v_add_f32 v40, v40, v70
    v_add_f32 v40, v40, v71
    v_add_f32 v40, v40, v76
    v_add_f32 v40, v40, v77
    v_add_f32 v40, v40, v78
    v_add_f32 v40, v40, v79
    v_mov_b32 v41, v40
    s_nop 1
    v_permlane16_swap_b32 v40, v41
    v_add_f32 v40, v40, v41
    v_mov_b32 v41, v40
    s_nop 1
    v_permlane32_swap_b32 v40, v41
    v_add_f32 v40, v40, v41
    v_rcp_f32 v40, v40
    s_nop 0
    v_mul_f32 v60, v60, v40
    v_mul_f32 v61, v61, v40
    v_mul_f32 v62, v62, v40
    v_mul_f32 v63, v63, v40
    v_mul_f32 v68, v68, v40
    v_mul_f32 v69, v69, v40
    v_mul_f32 v70, v70, v40
    v_mul_f32 v71, v71, v40
    v_mul_f32 v76, v76, v40
    v_mul_f32 v77, v77, v40
    v_mul_f32 v78, v78, v40
    v_mul_f32 v79, v79, v40
    v_cvt_pk_bf16_f32 v30, v60, v61
    v_cvt_pk_bf16_f32 v31, v62, v63
    v_cvt_pk_bf16_f32 v32, v68, v69
    v_cvt_pk_bf16_f32 v33, v70, v71
    v_cvt_pk_bf16_f32 v34, v76, v77
    v_cvt_pk_bf16_f32 v35, v78, v79
    s_waitcnt lgkmcnt(0)
    s_nop 0
    v_mfma_f32_16x16x16_bf16 v[64:67], a[80:81], v[24:25], 0
    v_mfma_f32_16x16x16_bf16 v[68:71], a[86:87], v[24:25], 0
    v_mfma_f32_16x16x16_bf16 v[72:75], a[92:93], v[24:25], 0
    v_mfma_f32_16x16x16_bf16 v[76:79], a[98:99], v[24:25], 0
    v_mfma_f32_16x16x16_bf16 v[80:83], a[104:105], v[24:25], 0
    v_mfma_f32_16x16x16_bf16 v[84:87], a[110:111], v[24:25], 0
    v_mfma_f32_16x16x16_bf16 v[88:91], a[116:117], v[24:25], 0
    v_mfma_f32_16x16x16_bf16 v[92:95], a[122:123], v[24:25], 0
    v_mfma_f32_16x16x16_bf16 v[64:67], a[84:85], v[28:29], v[64:67]
    v_mfma_f32_16x16x16_bf16 v[68:71], a[90:91], v[28:29], v[68:71]
    v_mfma_f32_16x16x16_bf16 v[72:75], a[96:97], v[28:29], v[72:75]
    v_mfma_f32_16x16x16_bf16 v[76:79], a[102:103], v[28:29], v[76:79]
    v_mfma_f32_16x16x16_bf16 v[80:83], a[108:109], v[28:29], v[80:83]
    v_mfma_f32_16x16x16_bf16 v[84:87], a[114:115], v[28:29], v[84:87]
    v_mfma_f32_16x16x16_bf16 v[88:91], a[120:121], v[28:29], v[88:91]
    v_mfma_f32_16x16x16_bf16 v[92:95], a[126:127], v[28:29], v[92:95]
    v_mfma_f32_16x16x16_bf16 v[96:99], a[80:81], v[30:31], 0
    v_mfma_f32_16x16x16_bf16 v[100:103], a[86:87], v[30:31], 0
    v_mfma_f32_16x16x16_bf16 v[104:107], a[92:93], v[30:31], 0
    v_mfma_f32_16x16x16_bf16 v[108:111], a[98:99], v[30:31], 0
    v_mfma_f32_16x16x16_bf16 v[112:115], a[104:105], v[30:31], 0
    v_mfma_f32_16x16x16_bf16 v[116:119], a[110:111], v[30:31], 0
    v_mfma_f32_16x16x16_bf16 v[120:123], a[116:117], v[30:31], 0
    v_mfma_f32_16x16x16_bf16 v[124:127], a[122:123], v[30:31], 0
    v_mfma_f32_16x16x16_bf16 v[96:99], a[82:83], v[32:33], v[96:99]
    v_mfma_f32_16x16x16_bf16 v[100:103], a[88:89], v[32:33], v[100:103]
    v_mfma_f32_16x16x16_bf16 v[104:107], a[94:95], v[32:33], v[104:107]
    v_mfma_f32_16x16x16_bf16 v[108:111], a[100:101], v[32:33], v[108:111]
    v_mfma_f32_16x16x16_bf16 v[112:115], a[106:107], v[32:33], v[112:115]
    v_mfma_f32_16x16x16_bf16 v[116:119], a[112:113], v[32:33], v[116:119]
    v_mfma_f32_16x16x16_bf16 v[120:123], a[118:119], v[32:33], v[120:123]
    v_mfma_f32_16x16x16_bf16 v[124:127], a[124:125], v[32:33], v[124:127]
    v_mfma_f32_16x16x16_bf16 v[96:99], a[84:85], v[34:35], v[96:99]
    v_mfma_f32_16x16x16_bf16 v[100:103], a[90:91], v[34:35], v[100:103]
    v_mfma_f32_16x16x16_bf16 v[104:107], a[96:97], v[34:35], v[104:107]
    v_mfma_f32_16x16x16_bf16 v[108:111], a[102:103], v[34:35], v[108:111]
    v_mfma_f32_16x16x16_bf16 v[112:115], a[108:109], v[34:35], v[112:115]
    v_mfma_f32_16x16x16_bf16 v[116:119], a[114:115], v[34:35], v[116:119]
    v_mfma_f32_16x16x16_bf16 v[120:123], a[120:121], v[34:35], v[120:123]
    v_mfma_f32_16x16x16_bf16 v[124:127], a[126:127], v[34:35], v[124:127]
    s_add_u32 s46, s63, 4096
    v_cvt_pk_bf16_f32 v64, v64, v65
    v_cvt_pk_bf16_f32 v65, v66, v67
    v_cvt_pk_bf16_f32 v66, v68, v69
    v_cvt_pk_bf16_f32 v67, v70, v71
    buffer_store_dwordx4 v[64:67], v10, s[12:15], s63 offen offset:0 sc1
    v_cvt_pk_bf16_f32 v72, v72, v73
    v_cvt_pk_bf16_f32 v73, v74, v75
    v_cvt_pk_bf16_f32 v74, v76, v77
    v_cvt_pk_bf16_f32 v75, v78, v79
    buffer_store_dwordx4 v[72:75], v10, s[12:15], s63 offen offset:2048 sc1
    v_cvt_pk_bf16_f32 v80, v80, v81
    v_cvt_pk_bf16_f32 v81, v82, v83
    v_cvt_pk_bf16_f32 v82, v84, v85
    v_cvt_pk_bf16_f32 v83, v86, v87
    buffer_store_dwordx4 v[80:83], v10, s[12:15], s46 offen offset:0 sc1
    v_cvt_pk_bf16_f32 v88, v88, v89
    v_cvt_pk_bf16_f32 v89, v90, v91
    v_cvt_pk_bf16_f32 v90, v92, v93
    v_cvt_pk_bf16_f32 v91, v94, v95
    buffer_store_dwordx4 v[88:91], v10, s[12:15], s46 offen offset:2048 sc1
    v_cvt_pk_bf16_f32 v96, v96, v97
    v_cvt_pk_bf16_f32 v97, v98, v99
    v_cvt_pk_bf16_f32 v98, v100, v101
    v_cvt_pk_bf16_f32 v99, v102, v103
    buffer_store_dwordx4 v[96:99], v10, s[12:15], s63 offen offset:256 sc1
    v_cvt_pk_bf16_f32 v104, v104, v105
    v_cvt_pk_bf16_f32 v105, v106, v107
    v_cvt_pk_bf16_f32 v106, v108, v109
    v_cvt_pk_bf16_f32 v107, v110, v111
    buffer_store_dwordx4 v[104:107], v10, s[12:15], s63 offen offset:2304 sc1
    v_cvt_pk_bf16_f32 v112, v112, v113
    v_cvt_pk_bf16_f32 v113, v114, v115
    v_cvt_pk_bf16_f32 v114, v116, v117
    v_cvt_pk_bf16_f32 v115, v118, v119
    buffer_store_dwordx4 v[112:115], v10, s[12:15], s46 offen offset:256 sc1
    v_cvt_pk_bf16_f32 v120, v120, v121
    v_cvt_pk_bf16_f32 v121, v122, v123
    v_cvt_pk_bf16_f32 v122, v124, v125
    v_cvt_pk_bf16_f32 v123, v126, v127
    buffer_store_dwordx4 v[120:123], v10, s[12:15], s46 offen offset:2304 sc1
    s_waitcnt vmcnt(0)
    v_mov_b32 v16, s60
    v_add_u32 v16, 1, v16
    v_mov_b32 v17, 0
    s_mov_b64 exec, 1
    buffer_store_dword v16, v17, s[12:15], s52 offen sc1
    s_mov_b64 exec, -1
L_sf_44:
    s_add_u32 s60, s60, 2
    s_cmp_lt_u32 s60, 64
    s_cbranch_scc1 L_a_loop_38
    s_branch L_c_done_4
L_w_g_17:
    s_lshr_b32 s53, s48, 2
    s_lshl_b32 s46, s53, 3
    s_add_u32 s46, s46, 16
    s_load_dwordx2 s[4:5], s[0:1], s46
    s_lshl_b32 s49, s40, 2
    s_and_b32 s46, s48, 3
    s_add_u32 s49, s49, s46
    s_load_dwordx2 s[6:7], s[0:1], 72
    s_and_b32 s50, s44, 3
    s_lshr_b32 s51, s44, 2
    s_waitcnt lgkmcnt(0)
    s_mov_b32 s24, s4
    s_and_b32 s25, s5, 0xffff
    s_mov_b32 s26, 0x800000
    s_mov_b32 s27, 0x00020000
    v_lshrrev_b32 v3, 4, v1
    v_and_b32 v4, 15, v1
    v_lshlrev_b32 v5, 2, v3
    v_xor_b32 v4, v4, v5
    v_mul_u32_u24 v3, 8192, v3
    v_lshl_add_u32 v3, v4, 4, v3
    s_mul_i32 s46, s51, 512
    s_mul_i32 s47, s50, 64
    s_add_u32 s46, s46, s47
    s_mul_i32 s46, s46, 8192
    s_lshl_b32 s47, s49, 8
    s_add_u32 s46, s46, s47
    s_lshl_b32 s45, s51, 16
    s_mul_i32 s47, s50, 16384
    s_add_u32 s45, s45, s47
    v_bfe_u32 v4, v1, 2, 2
    v_bfe_u32 v5, v1, 4, 1
    v_lshlrev_b32 v5, 1, v5
    v_bfe_u32 v6, v1, 0, 1
    v_add_u32 v5, v5, v6
    s_lshl_b32 s47, s50, 2
    v_add_u32 v5, s47, v5
    v_lshlrev_b32 v6, 2, v4
    v_xor_b32 v5, v5, v6
    v_lshlrev_b32 v5, 4, v5
    v_lshl_add_u32 v5, v4, 8, v5
    v_bfe_u32 v6, v1, 1, 1
    v_lshl_add_u32 v5, v6, 3, v5
    v_lshrrev_b32 v6, 5, v1
    v_mul_u32_u24 v6, 2048, v6
    v_add_u32 v5, v5, v6
    s_lshl_b32 s47, s51, 16
    v_add_u32 v5, s47, v5
    s_add_u32 m0, s45, 0
    s_add_u32 s47, s46, 0x0
    buffer_load_dwordx4 v3, s[24:27], s47 offen lds
    s_add_u32 m0, s45, 1024
    s_add_u32 s47, s46, 0x8000
    buffer_load_dwordx4 v3, s[24:27], s47 offen lds
    s_add_u32 m0, s45, 2048
    s_add_u32 s47, s46, 0x10000
    buffer_load_dwordx4 v3, s[24:27], s47 offen lds
    s_add_u32 m0, s45, 3072
    s_add_u32 s47, s46, 0x18000
    buffer_load_dwordx4 v3, s[24:27], s47 offen lds
    s_add_u32 m0, s45, 4096
    s_add_u32 s47, s46, 0x20000
    buffer_load_dwordx4 v3, s[24:27], s47 offen lds
    s_add_u32 m0, s45, 5120
    s_add_u32 s47, s46, 0x28000
    buffer_load_dwordx4 v3, s[24:27], s47 offen lds
    s_add_u32 m0, s45, 6144
    s_add_u32 s47, s46, 0x30000
    buffer_load_dwordx4 v3, s[24:27], s47 offen lds
    s_add_u32 m0, s45, 7168
    s_add_u32 s47, s46, 0x38000
    buffer_load_dwordx4 v3, s[24:27], s47 offen lds
    s_add_u32 m0, s45, 8192
    s_add_u32 s47, s46, 0x40000
    buffer_load_dwordx4 v3, s[24:27], s47 offen lds
    s_add_u32 m0, s45, 9216
    s_add_u32 s47, s46, 0x48000
    buffer_load_dwordx4 v3, s[24:27], s47 offen lds
    s_add_u32 m0, s45, 10240
    s_add_u32 s47, s46, 0x50000
    buffer_load_dwordx4 v3, s[24:27], s47 offen lds
    s_add_u32 m0, s45, 11264
    s_add_u32 s47, s46, 0x58000
    buffer_load_dwordx4 v3, s[24:27], s47 offen lds
    s_add_u32 m0, s45, 12288
    s_add_u32 s47, s46, 0x60000
    buffer_load_dwordx4 v3, s[24:27], s47 offen lds
    s_add_u32 m0, s45, 13312
    s_add_u32 s47, s46, 0x68000
    buffer_load_dwordx4 v3, s[24:27], s47 offen lds
    s_add_u32 m0, s45, 14336
    s_add_u32 s47, s46, 0x70000
    buffer_load_dwordx4 v3, s[24:27], s47 offen lds
    s_add_u32 m0, s45, 15360
    s_add_u32 s47, s46, 0x78000
    buffer_load_dwordx4 v3, s[24:27], s47 offen lds
    s_waitcnt vmcnt(0)
    s_barrier
    ds_read_b64_tr_b16 a[0:1], v5 offset:0
    ds_read_b64_tr_b16 a[2:3], v5 offset:1024
    ds_read_b64_tr_b16 a[4:5], v5 offset:4096
    ds_read_b64_tr_b16 a[6:7], v5 offset:5120
    ds_read_b64_tr_b16 a[8:9], v5 offset:8192
    ds_read_b64_tr_b16 a[10:11], v5 offset:9216
    ds_read_b64_tr_b16 a[12:13], v5 offset:12288
    ds_read_b64_tr_b16 a[14:15], v5 offset:13312
    s_waitcnt lgkmcnt(0)
    ds_read_b64_tr_b16 a[16:17], v5 offset:16384
    ds_read_b64_tr_b16 a[18:19], v5 offset:17408
    ds_read_b64_tr_b16 a[20:21], v5 offset:20480
    ds_read_b64_tr_b16 a[22:23], v5 offset:21504
    ds_read_b64_tr_b16 a[24:25], v5 offset:24576
    ds_read_b64_tr_b16 a[26:27], v5 offset:25600
    ds_read_b64_tr_b16 a[28:29], v5 offset:28672
    ds_read_b64_tr_b16 a[30:31], v5 offset:29696
    s_waitcnt lgkmcnt(0)
    ds_read_b64_tr_b16 a[32:33], v5 offset:32768
    ds_read_b64_tr_b16 a[34:35], v5 offset:33792
    ds_read_b64_tr_b16 a[36:37], v5 offset:36864
    ds_read_b64_tr_b16 a[38:39], v5 offset:37888
    ds_read_b64_tr_b16 a[40:41], v5 offset:40960
    ds_read_b64_tr_b16 a[42:43], v5 offset:41984
    ds_read_b64_tr_b16 a[44:45], v5 offset:45056
    ds_read_b64_tr_b16 a[46:47], v5 offset:46080
    s_waitcnt lgkmcnt(0)
    ds_read_b64_tr_b16 a[48:49], v5 offset:49152
    ds_read_b64_tr_b16 a[50:51], v5 offset:50176
    ds_read_b64_tr_b16 a[52:53], v5 offset:53248
    ds_read_b64_tr_b16 a[54:55], v5 offset:54272
    ds_read_b64_tr_b16 a[56:57], v5 offset:57344
    ds_read_b64_tr_b16 a[58:59], v5 offset:58368
    ds_read_b64_tr_b16 a[60:61], v5 offset:61440
    ds_read_b64_tr_b16 a[62:63], v5 offset:62464
    s_waitcnt lgkmcnt(0)
    s_waitcnt lgkmcnt(0)
    s_barrier
    s_add_u32 m0, s45, 0
    s_add_u32 s47, s46, 0x200000
    buffer_load_dwordx4 v3, s[24:27], s47 offen lds
    s_add_u32 m0, s45, 1024
    s_add_u32 s47, s46, 0x208000
    buffer_load_dwordx4 v3, s[24:27], s47 offen lds
    s_add_u32 m0, s45, 2048
    s_add_u32 s47, s46, 0x210000
    buffer_load_dwordx4 v3, s[24:27], s47 offen lds
    s_add_u32 m0, s45, 3072
    s_add_u32 s47, s46, 0x218000
    buffer_load_dwordx4 v3, s[24:27], s47 offen lds
    s_add_u32 m0, s45, 4096
    s_add_u32 s47, s46, 0x220000
    buffer_load_dwordx4 v3, s[24:27], s47 offen lds
    s_add_u32 m0, s45, 5120
    s_add_u32 s47, s46, 0x228000
    buffer_load_dwordx4 v3, s[24:27], s47 offen lds
    s_add_u32 m0, s45, 6144
    s_add_u32 s47, s46, 0x230000
    buffer_load_dwordx4 v3, s[24:27], s47 offen lds
    s_add_u32 m0, s45, 7168
    s_add_u32 s47, s46, 0x238000
    buffer_load_dwordx4 v3, s[24:27], s47 offen lds
    s_add_u32 m0, s45, 8192
    s_add_u32 s47, s46, 0x240000
    buffer_load_dwordx4 v3, s[24:27], s47 offen lds
    s_add_u32 m0, s45, 9216
    s_add_u32 s47, s46, 0x248000
    buffer_load_dwordx4 v3, s[24:27], s47 offen lds
    s_add_u32 m0, s45, 10240
    s_add_u32 s47, s46, 0x250000
    buffer_load_dwordx4 v3, s[24:27], s47 offen lds
    s_add_u32 m0, s45, 11264
    s_add_u32 s47, s46, 0x258000
    buffer_load_dwordx4 v3, s[24:27], s47 offen lds
    s_add_u32 m0, s45, 12288
    s_add_u32 s47, s46, 0x260000
    buffer_load_dwordx4 v3, s[24:27], s47 offen lds
    s_add_u32 m0, s45, 13312
    s_add_u32 s47, s46, 0x268000
    buffer_load_dwordx4 v3, s[24:27], s47 offen lds
    s_add_u32 m0, s45, 14336
    s_add_u32 s47, s46, 0x270000
    buffer_load_dwordx4 v3, s[24:27], s47 offen lds
    s_add_u32 m0, s45, 15360
    s_add_u32 s47, s46, 0x278000
    buffer_load_dwordx4 v3, s[24:27], s47 offen lds
    s_waitcnt vmcnt(0)
    s_barrier
    ds_read_b64_tr_b16 a[64:65], v5 offset:0
    ds_read_b64_tr_b16 a[66:67], v5 offset:1024
    ds_read_b64_tr_b16 a[68:69], v5 offset:4096
    ds_read_b64_tr_b16 a[70:71], v5 offset:5120
    ds_read_b64_tr_b16 a[72:73], v5 offset:8192
    ds_read_b64_tr_b16 a[74:75], v5 offset:9216
    ds_read_b64_tr_b16 a[76:77], v5 offset:12288
    ds_read_b64_tr_b16 a[78:79], v5 offset:13312
    s_waitcnt lgkmcnt(0)
    ds_read_b64_tr_b16 a[80:81], v5 offset:16384
    ds_read_b64_tr_b16 a[82:83], v5 offset:17408
    ds_read_b64_tr_b16 a[84:85], v5 offset:20480
    ds_read_b64_tr_b16 a[86:87], v5 offset:21504
    ds_read_b64_tr_b16 a[88:89], v5 offset:24576
    ds_read_b64_tr_b16 a[90:91], v5 offset:25600
    ds_read_b64_tr_b16 a[92:93], v5 offset:28672
    ds_read_b64_tr_b16 a[94:95], v5 offset:29696
    s_waitcnt lgkmcnt(0)
    ds_read_b64_tr_b16 a[96:97], v5 offset:32768
    ds_read_b64_tr_b16 a[98:99], v5 offset:33792
    ds_read_b64_tr_b16 a[100:101], v5 offset:36864
    ds_read_b64_tr_b16 a[102:103], v5 offset:37888
    ds_read_b64_tr_b16 a[104:105], v5 offset:40960
    ds_read_b64_tr_b16 a[106:107], v5 offset:41984
    ds_read_b64_tr_b16 a[108:109], v5 offset:45056
    ds_read_b64_tr_b16 a[110:111], v5 offset:46080
    s_waitcnt lgkmcnt(0)
    ds_read_b64_tr_b16 a[112:113], v5 offset:49152
    ds_read_b64_tr_b16 a[114:115], v5 offset:50176
    ds_read_b64_tr_b16 a[116:117], v5 offset:53248
    ds_read_b64_tr_b16 a[118:119], v5 offset:54272
    ds_read_b64_tr_b16 a[120:121], v5 offset:57344
    ds_read_b64_tr_b16 a[122:123], v5 offset:58368
    ds_read_b64_tr_b16 a[124:125], v5 offset:61440
    ds_read_b64_tr_b16 a[126:127], v5 offset:62464
    s_waitcnt lgkmcnt(0)
    s_waitcnt lgkmcnt(0)
    s_barrier
    v_lshlrev_b32 v2, 4, v1
    s_mul_i32 s64, s44, 8192
    s_add_u32 s46, s64, 0x400000
    v_add_u32 v3, s46, v2
    s_mul_i32 s46, s51, 32768
    v_add_u32 v4, s46, v2
    s_lshl_b32 s46, s50, 12
    s_add_u32 s46, s46, 131072
    v_add_u32 v5, s46, v2
    v_and_b32 v7, 3, v1
    v_lshlrev_b32 v7, 7, v7
    v_add_u32 v7, 0x109800, v7
    s_mul_i32 s46, s49, 24576
    s_lshl_b32 s47, s53, 13
    s_add_u32 s46, s46, s47
    s_lshl_b32 s47, s50, 10
    s_add_u32 s46, s46, s47
    s_add_u32 s46, s46, 0x2000000
    v_and_b32 v8, 15, v1
    v_lshlrev_b32 v8, 4, v8
    v_bfe_u32 v9, v1, 4, 1
    v_lshl_add_u32 v8, v9, 12, v8
    v_lshrrev_b32 v9, 5, v1
    v_lshl_add_u32 v8, v9, 8, v8
    v_add_u32 v8, s46, v8
    s_lshl_b32 s52, s40, 4
    s_add_u32 s52, s52, s48
    s_lshl_b32 s52, s52, 7
    s_add_u32 s52, s52, 0x10a800
    s_mov_b32 s60, 0
    s_mov_b32 s61, 0
    s_mov_b32 s62, 0
    s_mov_b32 s63, 0
    s_mov_b32 s67, 0
    s_mov_b32 s68, 3
    v_mov_b32 v15, 147456
    v_mov_b32 v14, 0
    ds_write_b32 v15, v14 offset:4
L_g_restart_45:
    s_cmp_lg_u32 s44, 0
    s_cbranch_scc1 L_g_nsp_46
    s_mov_b32 s70, 0
L_g_sp_52:
    s_add_u32 s54, s60, 0
    s_add_u32 s55, s54, 0
    s_and_b32 s46, s55, 7
    s_lshl_b32 s46, s46, 9
    buffer_load_dword v11, v7, s[12:15], s46 offen sc1
    s_add_u32 s55, s54, 1
    s_and_b32 s46, s55, 7
    s_lshl_b32 s46, s46, 9
    buffer_load_dword v12, v7, s[12:15], s46 offen sc1
    s_add_u32 s55, s54, 2
    s_and_b32 s46, s55, 7
    s_lshl_b32 s46, s46, 9
    buffer_load_dword v13, v7, s[12:15], s46 offen sc1
    s_waitcnt vmcnt(0)
    v_cmp_ge_u32 vcc, s60, v11
    s_add_u32 s70, s70, 1
    s_cbranch_vccz L_g_sp_52_ok
    s_sleep 8
    s_cmp_lt_u32 s70, 524288
    s_cbranch_scc1 L_g_sp_52
    s_branch L_c_done_4
L_g_sp_52_ok:
    s_mov_b32 s46, s54
    v_cmp_ge_u32 vcc, s46, v11
    s_nop 0
    s_cbranch_vccnz L_g_le_53
    s_add_u32 s46, s46, 1
    v_cmp_ge_u32 vcc, s46, v12
    s_nop 0
    s_cbranch_vccnz L_g_le_53
    s_add_u32 s46, s46, 1
    v_cmp_ge_u32 vcc, s46, v13
    s_nop 0
    s_cbranch_vccnz L_g_le_53
    s_add_u32 s46, s46, 1
L_g_le_53:
    v_mov_b32 v11, s46
    ds_write_b32 v15, v11
L_g_nsp_46:
    s_waitcnt lgkmcnt(0)
    s_barrier
    ds_read_b32 v14, v15
    s_waitcnt lgkmcnt(0)
    v_readfirstlane_b32 s66, v14
    s_nop 3
    s_mov_b32 s69, 0
    s_cmp_gt_u32 s62, s60
    s_cbranch_scc1 L_g_nd_54
    s_cmp_ge_u32 s62, s66
    s_cbranch_scc1 L_g_nd_54
    s_add_u32 s47, s61, 4096
    s_add_u32 m0, s64, 0
    s_nop 0
    buffer_load_dwordx4 v3, s[12:15], s61 offen offset:0 sc1 lds
    buffer_load_dwordx4 v3, s[12:15], s61 offen offset:1024 sc1 lds
    buffer_load_dwordx4 v3, s[12:15], s61 offen offset:2048 sc1 lds
    buffer_load_dwordx4 v3, s[12:15], s61 offen offset:3072 sc1 lds
    s_add_u32 m0, s64, 4096
    s_nop 0
    buffer_load_dwordx4 v3, s[12:15], s47 offen offset:0 sc1 lds
    buffer_load_dwordx4 v3, s[12:15], s47 offen offset:1024 sc1 lds
    buffer_load_dwordx4 v3, s[12:15], s47 offen offset:2048 sc1 lds
    buffer_load_dwordx4 v3, s[12:15], s47 offen offset:3072 sc1 lds
    s_add_u32 s61, s61, 65536
    s_add_u32 s62, s62, 1
    s_xor_b32 s64, s64, 0x10000
    s_mov_b32 s69, 1
L_g_nd_54:
    s_cmp_eq_u32 s51, 1
    s_cbranch_scc1 L_g_g1r_47
    s_add_u32 s59, s60, 1
    s_mov_b32 s69, 0
    s_cmp_gt_u32 s62, s59
    s_cbranch_scc1 L_g_nd_55
    s_cmp_ge_u32 s62, s66
    s_cbranch_scc1 L_g_nd_55
    s_add_u32 s47, s61, 4096
    s_add_u32 m0, s64, 0
    s_nop 0
    buffer_load_dwordx4 v3, s[12:15], s61 offen offset:0 sc1 lds
    buffer_load_dwordx4 v3, s[12:15], s61 offen offset:1024 sc1 lds
    buffer_load_dwordx4 v3, s[12:15], s61 offen offset:2048 sc1 lds
    buffer_load_dwordx4 v3, s[12:15], s61 offen offset:3072 sc1 lds
    s_add_u32 m0, s64, 4096
    s_nop 0
    buffer_load_dwordx4 v3, s[12:15], s47 offen offset:0 sc1 lds
    buffer_load_dwordx4 v3, s[12:15], s47 offen offset:1024 sc1 lds
    buffer_load_dwordx4 v3, s[12:15], s47 offen offset:2048 sc1 lds
    buffer_load_dwordx4 v3, s[12:15], s47 offen offset:3072 sc1 lds
    s_add_u32 s61, s61, 65536
    s_add_u32 s62, s62, 1
    s_xor_b32 s64, s64, 0x10000
    s_mov_b32 s69, 1
L_g_nd_55:
    s_cmp_eq_u32 s69, 1
    s_cbranch_scc1 L_g_w0_56
    s_waitcnt vmcnt(0)
L_g_w0_56:
    s_waitcnt vmcnt(8)
    s_mov_b32 s65, 1
L_g_loop0_48:
    s_barrier
    s_cmp_eq_u32 s65, 0
    s_cbranch_scc1 L_g_pr_57
    ds_read_b128 v[32:35], v4 offset:0
    ds_read_b128 v[36:39], v4 offset:1024
    ds_read_b128 v[40:43], v4 offset:2048
    ds_read_b128 v[44:47], v4 offset:3072
    ds_read_b128 v[48:51], v4 offset:4096
    ds_read_b128 v[52:55], v4 offset:5120
    ds_read_b128 v[56:59], v4 offset:6144
    ds_read_b128 v[60:63], v4 offset:7168
L_g_pr_57:
    ds_read_b32 v14, v15
    s_cmp_lg_u32 s44, 0
    s_cbranch_scc1 L_g_nl_58
    s_add_u32 s54, s60, 1
    s_add_u32 s55, s54, 0
    s_and_b32 s46, s55, 7
    s_lshl_b32 s46, s46, 9
    buffer_load_dword v11, v7, s[12:15], s46 offen sc1
    s_add_u32 s55, s54, 1
    s_and_b32 s46, s55, 7
    s_lshl_b32 s46, s46, 9
    buffer_load_dword v12, v7, s[12:15], s46 offen sc1
    s_add_u32 s55, s54, 2
    s_and_b32 s46, s55, 7
    s_lshl_b32 s46, s46, 9
    buffer_load_dword v13, v7, s[12:15], s46 offen sc1
L_g_nl_58:
    s_setprio 1
    s_waitcnt lgkmcnt(7)
    v_mfma_f32_32x32x16_bf16 v[16:31], a[0:3], v[32:35], 0
    ds_read_b128 v[32:35], v4 offset:8192
    s_waitcnt lgkmcnt(7)
    v_mfma_f32_32x32x16_bf16 v[16:31], a[4:7], v[36:39], v[16:31]
    ds_read_b128 v[36:39], v4 offset:9216
    s_waitcnt lgkmcnt(7)
    v_mfma_f32_32x32x16_bf16 v[16:31], a[8:11], v[40:43], v[16:31]
    ds_read_b128 v[40:43], v4 offset:10240
    s_waitcnt lgkmcnt(7)
    v_mfma_f32_32x32x16_bf16 v[16:31], a[12:15], v[44:47], v[16:31]
    ds_read_b128 v[44:47], v4 offset:11264
    s_waitcnt lgkmcnt(7)
    v_mfma_f32_32x32x16_bf16 v[16:31], a[16:19], v[48:51], v[16:31]
    ds_read_b128 v[48:51], v4 offset:12288
    s_waitcnt lgkmcnt(7)
    v_mfma_f32_32x32x16_bf16 v[16:31], a[20:23], v[52:55], v[16:31]
    ds_read_b128 v[52:55], v4 offset:13312
    s_waitcnt lgkmcnt(7)
    v_mfma_f32_32x32x16_bf16 v[16:31], a[24:27], v[56:59], v[16:31]
    ds_read_b128 v[56:59], v4 offset:14336
    s_waitcnt lgkmcnt(7)
    v_mfma_f32_32x32x16_bf16 v[16:31], a[28:31], v[60:63], v[16:31]
    ds_read_b128 v[60:63], v4 offset:15360
    s_waitcnt lgkmcnt(7)
    v_mfma_f32_32x32x16_bf16 v[16:31], a[32:35], v[32:35], v[16:31]
    ds_read_b128 v[32:35], v4 offset:16384
    s_waitcnt lgkmcnt(7)
    v_mfma_f32_32x32x16_bf16 v[16:31], a[36:39], v[36:39], v[16:31]
    ds_read_b128 v[36:39], v4 offset:17408
    s_waitcnt lgkmcnt(7)
    v_mfma_f32_32x32x16_bf16 v[16:31], a[40:43], v[40:43], v[16:31]
    ds_read_b128 v[40:43], v4 offset:18432
    s_waitcnt lgkmcnt(7)
    v_mfma_f32_32x32x16_bf16 v[16:31], a[44:47], v[44:47], v[16:31]
    ds_read_b128 v[44:47], v4 offset:19456
    s_waitcnt lgkmcnt(7)
    v_mfma_f32_32x32x16_bf16 v[16:31], a[48:51], v[48:51], v[16:31]
    ds_read_b128 v[48:51], v4 offset:20480
    s_waitcnt lgkmcnt(7)
    v_mfma_f32_32x32x16_bf16 v[16:31], a[52:55], v[52:55], v[16:31]
    ds_read_b128 v[52:55], v4 offset:21504
    s_waitcnt lgkmcnt(7)
    v_mfma_f32_32x32x16_bf16 v[16:31], a[56:59], v[56:59], v[16:31]
    ds_read_b128 v[56:59], v4 offset:22528
    s_waitcnt lgkmcnt(7)
    v_mfma_f32_32x32x16_bf16 v[16:31], a[60:63], v[60:63], v[16:31]
    ds_read_b128 v[60:63], v4 offset:23552
    s_waitcnt lgkmcnt(7)
    v_mfma_f32_32x32x16_bf16 v[16:31], a[64:67], v[32:35], v[16:31]
    ds_read_b128 v[32:35], v4 offset:24576
    s_waitcnt lgkmcnt(7)
    v_mfma_f32_32x32x16_bf16 v[16:31], a[68:71], v[36:39], v[16:31]
    ds_read_b128 v[36:39], v4 offset:25600
    s_waitcnt lgkmcnt(7)
    v_mfma_f32_32x32x16_bf16 v[16:31], a[72:75], v[40:43], v[16:31]
    ds_read_b128 v[40:43], v4 offset:26624
    s_waitcnt lgkmcnt(7)
    v_mfma_f32_32x32x16_bf16 v[16:31], a[76:79], v[44:47], v[16:31]
    ds_read_b128 v[44:47], v4 offset:27648
    s_waitcnt lgkmcnt(7)
    v_mfma_f32_32x32x16_bf16 v[16:31], a[80:83], v[48:51], v[16:31]
    ds_read_b128 v[48:51], v4 offset:28672
    s_waitcnt lgkmcnt(7)
    v_mfma_f32_32x32x16_bf16 v[16:31], a[84:87], v[52:55], v[16:31]
    ds_read_b128 v[52:55], v4 offset:29696
    s_waitcnt lgkmcnt(7)
    v_mfma_f32_32x32x16_bf16 v[16:31], a[88:91], v[56:59], v[16:31]
    ds_read_b128 v[56:59], v4 offset:30720
    s_waitcnt lgkmcnt(7)
    v_mfma_f32_32x32x16_bf16 v[16:31], a[92:95], v[60:63], v[16:31]
    ds_read_b128 v[60:63], v4 offset:31744
    s_waitcnt lgkmcnt(7)
    v_mfma_f32_32x32x16_bf16 v[16:31], a[96:99], v[32:35], v[16:31]
    s_waitcnt lgkmcnt(6)
    v_mfma_f32_32x32x16_bf16 v[16:31], a[100:103], v[36:39], v[16:31]
    s_waitcnt lgkmcnt(5)
    v_mfma_f32_32x32x16_bf16 v[16:31], a[104:107], v[40:43], v[16:31]
    s_waitcnt lgkmcnt(4)
    v_mfma_f32_32x32x16_bf16 v[16:31], a[108:111], v[44:47], v[16:31]
    s_waitcnt lgkmcnt(3)
    v_mfma_f32_32x32x16_bf16 v[16:31], a[112:115], v[48:51], v[16:31]
    s_waitcnt lgkmcnt(2)
    v_mfma_f32_32x32x16_bf16 v[16:31], a[116:119], v[52:55], v[16:31]
    s_waitcnt lgkmcnt(1)
    v_mfma_f32_32x32x16_bf16 v[16:31], a[120:123], v[56:59], v[16:31]
    s_waitcnt lgkmcnt(0)
    v_mfma_f32_32x32x16_bf16 v[16:31], a[124:127], v[60:63], v[16:31]
    v_xor_b32 v4, 0x10000, v4
    s_setprio 0
    s_waitcnt vmcnt(0)
    v_readfirstlane_b32 s66, v14
    s_barrier
    s_nop 6
    ds_write_b128 v5, v[16:19] offset:0
    ds_write_b128 v5, v[20:23] offset:1024
    ds_write_b128 v5, v[24:27] offset:2048
    ds_write_b128 v5, v[28:31] offset:3072
    s_cmp_lg_u32 s44, 0
    s_cbranch_scc1 L_g_ne_59
    s_mov_b32 s46, s54
    v_cmp_ge_u32 vcc, s46, v11
    s_nop 0
    s_cbranch_vccnz L_g_le_62
    s_add_u32 s46, s46, 1
    v_cmp_ge_u32 vcc, s46, v12
    s_nop 0
    s_cbranch_vccnz L_g_le_62
    s_add_u32 s46, s46, 1
    v_cmp_ge_u32 vcc, s46, v13
    s_nop 0
    s_cbranch_vccnz L_g_le_62
    s_add_u32 s46, s46, 1
L_g_le_62:
    v_mov_b32 v11, s46
    ds_write_b32 v15, v11
L_g_ne_59:
    s_add_u32 s60, s60, 1
    s_waitcnt lgkmcnt(0)
    s_mov_b32 s69, 0
    s_cmp_gt_u32 s62, s60
    s_cbranch_scc1 L_g_nd_63
    s_cmp_ge_u32 s62, s66
    s_cbranch_scc1 L_g_nd_63
    s_add_u32 s47, s61, 4096
    s_add_u32 m0, s64, 0
    s_nop 0
    buffer_load_dwordx4 v3, s[12:15], s61 offen offset:0 sc1 lds
    buffer_load_dwordx4 v3, s[12:15], s61 offen offset:1024 sc1 lds
    buffer_load_dwordx4 v3, s[12:15], s61 offen offset:2048 sc1 lds
    buffer_load_dwordx4 v3, s[12:15], s61 offen offset:3072 sc1 lds
    s_add_u32 m0, s64, 4096
    s_nop 0
    buffer_load_dwordx4 v3, s[12:15], s47 offen offset:0 sc1 lds
    buffer_load_dwordx4 v3, s[12:15], s47 offen offset:1024 sc1 lds
    buffer_load_dwordx4 v3, s[12:15], s47 offen offset:2048 sc1 lds
    buffer_load_dwordx4 v3, s[12:15], s47 offen offset:3072 sc1 lds
    s_add_u32 s61, s61, 65536
    s_add_u32 s62, s62, 1
    s_xor_b32 s64, s64, 0x10000
    s_mov_b32 s69, 1
L_g_nd_63:
    s_mov_b32 s65, s69
    s_add_u32 s59, s60, 1
    s_mov_b32 s69, 0
    s_cmp_gt_u32 s62, s59
    s_cbranch_scc1 L_g_nd_64
    s_cmp_ge_u32 s62, s66
    s_cbranch_scc1 L_g_nd_64
    s_add_u32 s47, s61, 4096
    s_add_u32 m0, s64, 0
    s_nop 0
    buffer_load_dwordx4 v3, s[12:15], s61 offen offset:0 sc1 lds
    buffer_load_dwordx4 v3, s[12:15], s61 offen offset:1024 sc1 lds
    buffer_load_dwordx4 v3, s[12:15], s61 offen offset:2048 sc1 lds
    buffer_load_dwordx4 v3, s[12:15], s61 offen offset:3072 sc1 lds
    s_add_u32 m0, s64, 4096
    s_nop 0
    buffer_load_dwordx4 v3, s[12:15], s47 offen offset:0 sc1 lds
    buffer_load_dwordx4 v3, s[12:15], s47 offen offset:1024 sc1 lds
    buffer_load_dwordx4 v3, s[12:15], s47 offen offset:2048 sc1 lds
    buffer_load_dwordx4 v3, s[12:15], s47 offen offset:3072 sc1 lds
    s_add_u32 s61, s61, 65536
    s_add_u32 s62, s62, 1
    s_xor_b32 s64, s64, 0x10000
    s_mov_b32 s69, 1
L_g_nd_64:
    s_cmp_le_u32 s66, s60
    s_cbranch_scc1 L_g_ex0_61
    s_cmp_eq_u32 s65, 0
    s_cbranch_scc1 L_g_nw_60
    s_waitcnt vmcnt(0) lgkmcnt(0)
    s_branch L_g_loop0_48
L_g_nw_60:
    ds_read_b128 v[32:35], v4 offset:0
    ds_read_b128 v[36:39], v4 offset:1024
    ds_read_b128 v[40:43], v4 offset:2048
    ds_read_b128 v[44:47], v4 offset:3072
    ds_read_b128 v[48:51], v4 offset:4096
    ds_read_b128 v[52:55], v4 offset:5120
    ds_read_b128 v[56:59], v4 offset:6144
    ds_read_b128 v[60:63], v4 offset:7168
    s_waitcnt lgkmcnt(8)
    s_branch L_g_loop0_48
L_g_ex0_61:
    s_waitcnt lgkmcnt(0)
    s_barrier
    s_branch L_g_tail_50
L_g_g1r_47:
    s_mov_b32 s65, 1
    s_branch L_g_loop1_49_e
L_g_loop1_49:
    s_mov_b32 s65, 0
L_g_loop1_49_e:
    s_barrier
    ds_read_b32 v14, v15
    s_bitcmp1_b32 s67, 1
    s_cbranch_scc0 L_g_nfl_65
    s_sub_u32 s59, s60, 2
    s_cmp_lg_u32 s44, 4
    s_cbranch_scc1 L_sf_70
    v_mov_b32 v10, s59
    v_add_u32 v10, 1, v10
    v_mov_b32 v11, 0
    s_mov_b64 exec, 1
    buffer_store_dword v10, v11, s[12:15], s52 offen sc1
    s_mov_b64 exec, -1
L_sf_70:
L_g_nfl_65:
    s_bitcmp1_b32 s67, 0
    s_cbranch_scc0 L_g_nep_66
    ds_read_b128 v[80:83], v5 offset:0
    ds_read_b128 v[84:87], v5 offset:1024
    ds_read_b128 v[88:91], v5 offset:2048
    ds_read_b128 v[92:95], v5 offset:3072
    s_nop 7
    s_waitcnt lgkmcnt(3)
    v_add_f32 v80, v80, v16
    v_add_f32 v81, v81, v17
    v_add_f32 v82, v82, v18
    v_add_f32 v83, v83, v19
    s_waitcnt lgkmcnt(2)
    v_add_f32 v84, v84, v20
    v_add_f32 v85, v85, v21
    v_add_f32 v86, v86, v22
    v_add_f32 v87, v87, v23
    s_waitcnt lgkmcnt(1)
    v_add_f32 v88, v88, v24
    v_add_f32 v89, v89, v25
    v_add_f32 v90, v90, v26
    v_add_f32 v91, v91, v27
    s_waitcnt lgkmcnt(0)
    v_add_f32 v92, v92, v28
    v_add_f32 v93, v93, v29
    v_add_f32 v94, v94, v30
    v_add_f32 v95, v95, v31
    v_cvt_pk_bf16_f32 v104, v80, v81
    v_cvt_pk_bf16_f32 v105, v82, v83
    v_cvt_pk_bf16_f32 v106, v84, v85
    v_cvt_pk_bf16_f32 v107, v86, v87
    buffer_store_dwordx4 v[104:107], v8, s[12:15], s63 offen offset:0 sc1
    v_cvt_pk_bf16_f32 v108, v88, v89
    v_cvt_pk_bf16_f32 v109, v90, v91
    v_cvt_pk_bf16_f32 v110, v92, v93
    v_cvt_pk_bf16_f32 v111, v94, v95
    buffer_store_dwordx4 v[108:111], v8, s[12:15], s63 offen offset:512 sc1
    s_add_u32 s63, s63, 786432
L_g_nep_66:
    s_waitcnt lgkmcnt(0)
    v_readfirstlane_b32 s66, v14
    s_nop 3
    s_mov_b32 s69, 0
    s_cmp_gt_u32 s62, s60
    s_cbranch_scc1 L_g_nd_71
    s_cmp_ge_u32 s62, s66
    s_cbranch_scc1 L_g_nd_71
    s_add_u32 s47, s61, 4096
    s_add_u32 m0, s64, 0
    s_nop 0
    buffer_load_dwordx4 v3, s[12:15], s61 offen offset:0 sc1 lds
    buffer_load_dwordx4 v3, s[12:15], s61 offen offset:1024 sc1 lds
    buffer_load_dwordx4 v3, s[12:15], s61 offen offset:2048 sc1 lds
    buffer_load_dwordx4 v3, s[12:15], s61 offen offset:3072 sc1 lds
    s_add_u32 m0, s64, 4096
    s_nop 0
    buffer_load_dwordx4 v3, s[12:15], s47 offen offset:0 sc1 lds
    buffer_load_dwordx4 v3, s[12:15], s47 offen offset:1024 sc1 lds
    buffer_load_dwordx4 v3, s[12:15], s47 offen offset:2048 sc1 lds
    buffer_load_dwordx4 v3, s[12:15], s47 offen offset:3072 sc1 lds
    s_add_u32 s61, s61, 65536
    s_add_u32 s62, s62, 1
    s_xor_b32 s64, s64, 0x10000
    s_mov_b32 s69, 1
L_g_nd_71:
    s_or_b32 s65, s65, s69
    s_add_u32 s59, s60, 1
    s_mov_b32 s69, 0
    s_cmp_gt_u32 s62, s59
    s_cbranch_scc1 L_g_nd_72
    s_cmp_ge_u32 s62, s66
    s_cbranch_scc1 L_g_nd_72
    s_add_u32 s47, s61, 4096
    s_add_u32 m0, s64, 0
    s_nop 0
    buffer_load_dwordx4 v3, s[12:15], s61 offen offset:0 sc1 lds
    buffer_load_dwordx4 v3, s[12:15], s61 offen offset:1024 sc1 lds
    buffer_load_dwordx4 v3, s[12:15], s61 offen offset:2048 sc1 lds
    buffer_load_dwordx4 v3, s[12:15], s61 offen offset:3072 sc1 lds
    s_add_u32 m0, s64, 4096
    s_nop 0
    buffer_load_dwordx4 v3, s[12:15], s47 offen offset:0 sc1 lds
    buffer_load_dwordx4 v3, s[12:15], s47 offen offset:1024 sc1 lds
    buffer_load_dwordx4 v3, s[12:15], s47 offen offset:2048 sc1 lds
    buffer_load_dwordx4 v3, s[12:15], s47 offen offset:3072 sc1 lds
    s_add_u32 s61, s61, 65536
    s_add_u32 s62, s62, 1
    s_xor_b32 s64, s64, 0x10000
    s_mov_b32 s69, 1
L_g_nd_72:
    s_cmp_eq_u32 s65, 0
    s_cbranch_scc1 L_g_nw1_67
    s_waitcnt vmcnt(0)
    s_barrier
    ds_read_b128 v[32:35], v4 offset:0
    ds_read_b128 v[36:39], v4 offset:1024
    ds_read_b128 v[40:43], v4 offset:2048
    ds_read_b128 v[44:47], v4 offset:3072
    ds_read_b128 v[48:51], v4 offset:4096
    ds_read_b128 v[52:55], v4 offset:5120
    ds_read_b128 v[56:59], v4 offset:6144
    ds_read_b128 v[60:63], v4 offset:7168
    s_branch L_g_jn_69
L_g_nw1_67:
    ds_read_b128 v[32:35], v4 offset:0
    ds_read_b128 v[36:39], v4 offset:1024
    ds_read_b128 v[40:43], v4 offset:2048
    ds_read_b128 v[44:47], v4 offset:3072
    ds_read_b128 v[48:51], v4 offset:4096
    ds_read_b128 v[52:55], v4 offset:5120
    ds_read_b128 v[56:59], v4 offset:6144
    ds_read_b128 v[60:63], v4 offset:7168
    s_barrier
L_g_jn_69:
    s_setprio 1
    s_waitcnt lgkmcnt(7)
    v_mfma_f32_32x32x16_bf16 v[16:31], a[0:3], v[32:35], 0
    ds_read_b128 v[32:35], v4 offset:8192
    s_waitcnt lgkmcnt(7)
    v_mfma_f32_32x32x16_bf16 v[16:31], a[4:7], v[36:39], v[16:31]
    ds_read_b128 v[36:39], v4 offset:9216
    s_waitcnt lgkmcnt(7)
    v_mfma_f32_32x32x16_bf16 v[16:31], a[8:11], v[40:43], v[16:31]
    ds_read_b128 v[40:43], v4 offset:10240
    s_waitcnt lgkmcnt(7)
    v_mfma_f32_32x32x16_bf16 v[16:31], a[12:15], v[44:47], v[16:31]
    ds_read_b128 v[44:47], v4 offset:11264
    s_waitcnt lgkmcnt(7)
    v_mfma_f32_32x32x16_bf16 v[16:31], a[16:19], v[48:51], v[16:31]
    ds_read_b128 v[48:51], v4 offset:12288
    s_waitcnt lgkmcnt(7)
    v_mfma_f32_32x32x16_bf16 v[16:31], a[20:23], v[52:55], v[16:31]
    ds_read_b128 v[52:55], v4 offset:13312
    s_waitcnt lgkmcnt(7)
    v_mfma_f32_32x32x16_bf16 v[16:31], a[24:27], v[56:59], v[16:31]
    ds_read_b128 v[56:59], v4 offset:14336
    s_waitcnt lgkmcnt(7)
    v_mfma_f32_32x32x16_bf16 v[16:31], a[28:31], v[60:63], v[16:31]
    ds_read_b128 v[60:63], v4 offset:15360
    s_waitcnt lgkmcnt(7)
    v_mfma_f32_32x32x16_bf16 v[16:31], a[32:35], v[32:35], v[16:31]
    ds_read_b128 v[32:35], v4 offset:16384
    s_waitcnt lgkmcnt(7)
    v_mfma_f32_32x32x16_bf16 v[16:31], a[36:39], v[36:39], v[16:31]
    ds_read_b128 v[36:39], v4 offset:17408
    s_waitcnt lgkmcnt(7)
    v_mfma_f32_32x32x16_bf16 v[16:31], a[40:43], v[40:43], v[16:31]
    ds_read_b128 v[40:43], v4 offset:18432
    s_waitcnt lgkmcnt(7)
    v_mfma_f32_32x32x16_bf16 v[16:31], a[44:47], v[44:47], v[16:31]
    ds_read_b128 v[44:47], v4 offset:19456
    s_waitcnt lgkmcnt(7)
    v_mfma_f32_32x32x16_bf16 v[16:31], a[48:51], v[48:51], v[16:31]
    ds_read_b128 v[48:51], v4 offset:20480
    s_waitcnt lgkmcnt(7)
    v_mfma_f32_32x32x16_bf16 v[16:31], a[52:55], v[52:55], v[16:31]
    ds_read_b128 v[52:55], v4 offset:21504
    s_waitcnt lgkmcnt(7)
    v_mfma_f32_32x32x16_bf16 v[16:31], a[56:59], v[56:59], v[16:31]
    ds_read_b128 v[56:59], v4 offset:22528
    s_waitcnt lgkmcnt(7)
    v_mfma_f32_32x32x16_bf16 v[16:31], a[60:63], v[60:63], v[16:31]
    ds_read_b128 v[60:63], v4 offset:23552
    s_waitcnt lgkmcnt(7)
    v_mfma_f32_32x32x16_bf16 v[16:31], a[64:67], v[32:35], v[16:31]
    ds_read_b128 v[32:35], v4 offset:24576
    s_waitcnt lgkmcnt(7)
    v_mfma_f32_32x32x16_bf16 v[16:31], a[68:71], v[36:39], v[16:31]
    ds_read_b128 v[36:39], v4 offset:25600
    s_waitcnt lgkmcnt(7)
    v_mfma_f32_32x32x16_bf16 v[16:31], a[72:75], v[40:43], v[16:31]
    ds_read_b128 v[40:43], v4 offset:26624
    s_waitcnt lgkmcnt(7)
    v_mfma_f32_32x32x16_bf16 v[16:31], a[76:79], v[44:47], v[16:31]
    ds_read_b128 v[44:47], v4 offset:27648
    s_waitcnt lgkmcnt(7)
    v_mfma_f32_32x32x16_bf16 v[16:31], a[80:83], v[48:51], v[16:31]
    ds_read_b128 v[48:51], v4 offset:28672
    s_waitcnt lgkmcnt(7)
    v_mfma_f32_32x32x16_bf16 v[16:31], a[84:87], v[52:55], v[16:31]
    ds_read_b128 v[52:55], v4 offset:29696
    s_waitcnt lgkmcnt(7)
    v_mfma_f32_32x32x16_bf16 v[16:31], a[88:91], v[56:59], v[16:31]
    ds_read_b128 v[56:59], v4 offset:30720
    s_waitcnt lgkmcnt(7)
    v_mfma_f32_32x32x16_bf16 v[16:31], a[92:95], v[60:63], v[16:31]
    ds_read_b128 v[60:63], v4 offset:31744
    s_waitcnt lgkmcnt(7)
    v_mfma_f32_32x32x16_bf16 v[16:31], a[96:99], v[32:35], v[16:31]
    s_waitcnt lgkmcnt(6)
    v_mfma_f32_32x32x16_bf16 v[16:31], a[100:103], v[36:39], v[16:31]
    s_waitcnt lgkmcnt(5)
    v_mfma_f32_32x32x16_bf16 v[16:31], a[104:107], v[40:43], v[16:31]
    s_waitcnt lgkmcnt(4)
    v_mfma_f32_32x32x16_bf16 v[16:31], a[108:111], v[44:47], v[16:31]
    s_waitcnt lgkmcnt(3)
    v_mfma_f32_32x32x16_bf16 v[16:31], a[112:115], v[48:51], v[16:31]
    s_waitcnt lgkmcnt(2)
    v_mfma_f32_32x32x16_bf16 v[16:31], a[116:119], v[52:55], v[16:31]
    s_waitcnt lgkmcnt(1)
    v_mfma_f32_32x32x16_bf16 v[16:31], a[120:123], v[56:59], v[16:31]
    s_waitcnt lgkmcnt(0)
    v_mfma_f32_32x32x16_bf16 v[16:31], a[124:127], v[60:63], v[16:31]
    v_xor_b32 v4, 0x10000, v4
    s_setprio 0
    s_waitcnt vmcnt(0)
    s_lshl_b32 s67, s67, 1
    s_or_b32 s67, s67, 1
    s_add_u32 s60, s60, 1
    s_cmp_gt_u32 s66, s60
    s_cbranch_scc1 L_g_loop1_49
    s_barrier
    s_sub_u32 s59, s60, 1
    ds_read_b128 v[80:83], v5 offset:0
    ds_read_b128 v[84:87], v5 offset:1024
    ds_read_b128 v[88:91], v5 offset:2048
    ds_read_b128 v[92:95], v5 offset:3072
    s_nop 7
    s_waitcnt lgkmcnt(3)
    v_add_f32 v80, v80, v16
    v_add_f32 v81, v81, v17
    v_add_f32 v82, v82, v18
    v_add_f32 v83, v83, v19
    s_waitcnt lgkmcnt(2)
    v_add_f32 v84, v84, v20
    v_add_f32 v85, v85, v21
    v_add_f32 v86, v86, v22
    v_add_f32 v87, v87, v23
    s_waitcnt lgkmcnt(1)
    v_add_f32 v88, v88, v24
    v_add_f32 v89, v89, v25
    v_add_f32 v90, v90, v26
    v_add_f32 v91, v91, v27
    s_waitcnt lgkmcnt(0)
    v_add_f32 v92, v92, v28
    v_add_f32 v93, v93, v29
    v_add_f32 v94, v94, v30
    v_add_f32 v95, v95, v31
    v_cvt_pk_bf16_f32 v104, v80, v81
    v_cvt_pk_bf16_f32 v105, v82, v83
    v_cvt_pk_bf16_f32 v106, v84, v85
    v_cvt_pk_bf16_f32 v107, v86, v87
    buffer_store_dwordx4 v[104:107], v8, s[12:15], s63 offen offset:0 sc1
    v_cvt_pk_bf16_f32 v108, v88, v89
    v_cvt_pk_bf16_f32 v109, v90, v91
    v_cvt_pk_bf16_f32 v110, v92, v93
    v_cvt_pk_bf16_f32 v111, v94, v95
    buffer_store_dwordx4 v[108:111], v8, s[12:15], s63 offen offset:512 sc1
    s_add_u32 s63, s63, 786432
    v_mov_b32 v10, 1
    s_mov_b64 exec, 1
    s_waitcnt vmcnt(0)
    ds_add_rtn_u32 v10, v15, v10 offset:4
    s_waitcnt lgkmcnt(0)
    v_readfirstlane_b32 s46, v10
    s_mov_b64 exec, -1
    s_mov_b32 s67, 0
    s_nop 1
    s_cmp_lg_u32 s46, s68
    s_cbranch_scc1 L_g_g1f_51
    v_mov_b32 v10, s59
    v_add_u32 v10, 1, v10
    v_mov_b32 v11, 0
    s_mov_b64 exec, 1
    buffer_store_dword v10, v11, s[12:15], s52 offen sc1
    s_mov_b64 exec, -1
L_sf_73:
L_g_g1f_51:
    s_add_u32 s68, s68, 4
L_g_tail_50:
    s_cmp_lt_u32 s60, 64
    s_cbranch_scc1 L_g_restart_45
    s_barrier
    s_branch L_w_p2_18
L_w_p2_18:
    s_lshr_b32 s42, s40, 1
    s_and_b32 s43, s40, 1
    s_lshl_b32 s43, s43, 2
    s_and_b32 s46, s48, 3
    s_add_u32 s43, s43, s46
    s_cmp_lt_u32 s48, 4
    s_cbranch_scc1 L_w_wo_19
    s_cmp_lt_u32 s48, 8
    s_cbranch_scc1 L_w_f2_20
    s_cmp_eq_u32 s43, 7
    s_cbranch_scc1 L_c_done_4
    s_load_dwordx2 s[4:5], s[0:1], 64
    s_load_dwordx2 s[6:7], s[0:1], 72
    s_and_b32 s50, s44, 3
    s_lshr_b32 s51, s44, 2
    s_waitcnt lgkmcnt(0)
    s_mov_b32 s24, s4
    s_and_b32 s25, s5, 0xffff
    s_mov_b32 s26, 0x700000
    s_mov_b32 s27, 0x00020000
    s_mul_i32 s49, s42, 7
    s_add_u32 s49, s49, s43
    v_lshrrev_b32 v3, 4, v1
    v_and_b32 v4, 15, v1
    v_lshlrev_b32 v5, 2, v3
    v_xor_b32 v4, v4, v5
    v_mul_u32_u24 v3, 7168, v3
    v_lshl_add_u32 v3, v4, 4, v3
    s_mul_i32 s46, s51, 512
    s_mul_i32 s47, s50, 64
    s_add_u32 s46, s46, s47
    s_mul_i32 s46, s46, 7168
    s_lshl_b32 s47, s49, 8
    s_add_u32 s46, s46, s47
    s_lshl_b32 s45, s51, 16
    s_mul_i32 s47, s50, 16384
    s_add_u32 s45, s45, s47
    v_bfe_u32 v4, v1, 2, 2
    v_bfe_u32 v5, v1, 4, 1
    v_lshlrev_b32 v5, 1, v5
    v_bfe_u32 v6, v1, 1, 1
    v_add_u32 v5, v5, v6
    s_lshl_b32 s47, s50, 2
    v_add_u32 v5, s47, v5
    v_lshlrev_b32 v6, 2, v4
    v_xor_b32 v5, v5, v6
    v_lshlrev_b32 v5, 4, v5
    v_lshl_add_u32 v5, v4, 8, v5
    v_bfe_u32 v6, v1, 0, 1
    v_lshl_add_u32 v5, v6, 3, v5
    v_lshrrev_b32 v6, 5, v1
    v_mul_u32_u24 v6, 2048, v6
    v_add_u32 v5, v5, v6
    s_lshl_b32 s47, s51, 16
    v_add_u32 v5, s47, v5
    s_add_u32 m0, s45, 0
    s_add_u32 s47, s46, 0x0
    buffer_load_dwordx4 v3, s[24:27], s47 offen lds
    s_add_u32 m0, s45, 1024
    s_add_u32 s47, s46, 0x7000
    buffer_load_dwordx4 v3, s[24:27], s47 offen lds
    s_add_u32 m0, s45, 2048
    s_add_u32 s47, s46, 0xe000
    buffer_load_dwordx4 v3, s[24:27], s47 offen lds
    s_add_u32 m0, s45, 3072
    s_add_u32 s47, s46, 0x15000
    buffer_load_dwordx4 v3, s[24:27], s47 offen lds
    s_add_u32 m0, s45, 4096
    s_add_u32 s47, s46, 0x1c000
    buffer_load_dwordx4 v3, s[24:27], s47 offen lds
    s_add_u32 m0, s45, 5120
    s_add_u32 s47, s46, 0x23000
    buffer_load_dwordx4 v3, s[24:27], s47 offen lds
    s_add_u32 m0, s45, 6144
    s_add_u32 s47, s46, 0x2a000
    buffer_load_dwordx4 v3, s[24:27], s47 offen lds
    s_add_u32 m0, s45, 7168
    s_add_u32 s47, s46, 0x31000
    buffer_load_dwordx4 v3, s[24:27], s47 offen lds
    s_add_u32 m0, s45, 8192
    s_add_u32 s47, s46, 0x38000
    buffer_load_dwordx4 v3, s[24:27], s47 offen lds
    s_add_u32 m0, s45, 9216
    s_add_u32 s47, s46, 0x3f000
    buffer_load_dwordx4 v3, s[24:27], s47 offen lds
    s_add_u32 m0, s45, 10240
    s_add_u32 s47, s46, 0x46000
    buffer_load_dwordx4 v3, s[24:27], s47 offen lds
    s_add_u32 m0, s45, 11264
    s_add_u32 s47, s46, 0x4d000
    buffer_load_dwordx4 v3, s[24:27], s47 offen lds
    s_add_u32 m0, s45, 12288
    s_add_u32 s47, s46, 0x54000
    buffer_load_dwordx4 v3, s[24:27], s47 offen lds
    s_add_u32 m0, s45, 13312
    s_add_u32 s47, s46, 0x5b000
    buffer_load_dwordx4 v3, s[24:27], s47 offen lds
    s_add_u32 m0, s45, 14336
    s_add_u32 s47, s46, 0x62000
    buffer_load_dwordx4 v3, s[24:27], s47 offen lds
    s_add_u32 m0, s45, 15360
    s_add_u32 s47, s46, 0x69000
    buffer_load_dwordx4 v3, s[24:27], s47 offen lds
    s_waitcnt vmcnt(0)
    s_barrier
    ds_read_b64_tr_b16 a[0:1], v5 offset:0
    ds_read_b64_tr_b16 a[2:3], v5 offset:1024
    ds_read_b64_tr_b16 a[4:5], v5 offset:4096
    ds_read_b64_tr_b16 a[6:7], v5 offset:5120
    ds_read_b64_tr_b16 a[8:9], v5 offset:8192
    ds_read_b64_tr_b16 a[10:11], v5 offset:9216
    ds_read_b64_tr_b16 a[12:13], v5 offset:12288
    ds_read_b64_tr_b16 a[14:15], v5 offset:13312
    s_waitcnt lgkmcnt(0)
    ds_read_b64_tr_b16 a[16:17], v5 offset:16384
    ds_read_b64_tr_b16 a[18:19], v5 offset:17408
    ds_read_b64_tr_b16 a[20:21], v5 offset:20480
    ds_read_b64_tr_b16 a[22:23], v5 offset:21504
    ds_read_b64_tr_b16 a[24:25], v5 offset:24576
    ds_read_b64_tr_b16 a[26:27], v5 offset:25600
    ds_read_b64_tr_b16 a[28:29], v5 offset:28672
    ds_read_b64_tr_b16 a[30:31], v5 offset:29696
    s_waitcnt lgkmcnt(0)
    ds_read_b64_tr_b16 a[32:33], v5 offset:32768
    ds_read_b64_tr_b16 a[34:35], v5 offset:33792
    ds_read_b64_tr_b16 a[36:37], v5 offset:36864
    ds_read_b64_tr_b16 a[38:39], v5 offset:37888
    ds_read_b64_tr_b16 a[40:41], v5 offset:40960
    ds_read_b64_tr_b16 a[42:43], v5 offset:41984
    ds_read_b64_tr_b16 a[44:45], v5 offset:45056
    ds_read_b64_tr_b16 a[46:47], v5 offset:46080
    s_waitcnt lgkmcnt(0)
    ds_read_b64_tr_b16 a[48:49], v5 offset:49152
    ds_read_b64_tr_b16 a[50:51], v5 offset:50176
    ds_read_b64_tr_b16 a[52:53], v5 offset:53248
    ds_read_b64_tr_b16 a[54:55], v5 offset:54272
    ds_read_b64_tr_b16 a[56:57], v5 offset:57344
    ds_read_b64_tr_b16 a[58:59], v5 offset:58368
    ds_read_b64_tr_b16 a[60:61], v5 offset:61440
    ds_read_b64_tr_b16 a[62:63], v5 offset:62464
    s_waitcnt lgkmcnt(0)
    s_waitcnt lgkmcnt(0)
    s_barrier
    s_add_u32 m0, s45, 0
    s_add_u32 s47, s46, 0x1c0000
    buffer_load_dwordx4 v3, s[24:27], s47 offen lds
    s_add_u32 m0, s45, 1024
    s_add_u32 s47, s46, 0x1c7000
    buffer_load_dwordx4 v3, s[24:27], s47 offen lds
    s_add_u32 m0, s45, 2048
    s_add_u32 s47, s46, 0x1ce000
    buffer_load_dwordx4 v3, s[24:27], s47 offen lds
    s_add_u32 m0, s45, 3072
    s_add_u32 s47, s46, 0x1d5000
    buffer_load_dwordx4 v3, s[24:27], s47 offen lds
    s_add_u32 m0, s45, 4096
    s_add_u32 s47, s46, 0x1dc000
    buffer_load_dwordx4 v3, s[24:27], s47 offen lds
    s_add_u32 m0, s45, 5120
    s_add_u32 s47, s46, 0x1e3000
    buffer_load_dwordx4 v3, s[24:27], s47 offen lds
    s_add_u32 m0, s45, 6144
    s_add_u32 s47, s46, 0x1ea000
    buffer_load_dwordx4 v3, s[24:27], s47 offen lds
    s_add_u32 m0, s45, 7168
    s_add_u32 s47, s46, 0x1f1000
    buffer_load_dwordx4 v3, s[24:27], s47 offen lds
    s_add_u32 m0, s45, 8192
    s_add_u32 s47, s46, 0x1f8000
    buffer_load_dwordx4 v3, s[24:27], s47 offen lds
    s_add_u32 m0, s45, 9216
    s_add_u32 s47, s46, 0x1ff000
    buffer_load_dwordx4 v3, s[24:27], s47 offen lds
    s_add_u32 m0, s45, 10240
    s_add_u32 s47, s46, 0x206000
    buffer_load_dwordx4 v3, s[24:27], s47 offen lds
    s_add_u32 m0, s45, 11264
    s_add_u32 s47, s46, 0x20d000
    buffer_load_dwordx4 v3, s[24:27], s47 offen lds
    s_add_u32 m0, s45, 12288
    s_add_u32 s47, s46, 0x214000
    buffer_load_dwordx4 v3, s[24:27], s47 offen lds
    s_add_u32 m0, s45, 13312
    s_add_u32 s47, s46, 0x21b000
    buffer_load_dwordx4 v3, s[24:27], s47 offen lds
    s_add_u32 m0, s45, 14336
    s_add_u32 s47, s46, 0x222000
    buffer_load_dwordx4 v3, s[24:27], s47 offen lds
    s_add_u32 m0, s45, 15360
    s_add_u32 s47, s46, 0x229000
    buffer_load_dwordx4 v3, s[24:27], s47 offen lds
    s_waitcnt vmcnt(0)
    s_barrier
    ds_read_b64_tr_b16 a[64:65], v5 offset:0
    ds_read_b64_tr_b16 a[66:67], v5 offset:1024
    ds_read_b64_tr_b16 a[68:69], v5 offset:4096
    ds_read_b64_tr_b16 a[70:71], v5 offset:5120
    ds_read_b64_tr_b16 a[72:73], v5 offset:8192
    ds_read_b64_tr_b16 a[74:75], v5 offset:9216
    ds_read_b64_tr_b16 a[76:77], v5 offset:12288
    ds_read_b64_tr_b16 a[78:79], v5 offset:13312
    s_waitcnt lgkmcnt(0)
    ds_read_b64_tr_b16 a[80:81], v5 offset:16384
    ds_read_b64_tr_b16 a[82:83], v5 offset:17408
    ds_read_b64_tr_b16 a[84:85], v5 offset:20480
    ds_read_b64_tr_b16 a[86:87], v5 offset:21504
    ds_read_b64_tr_b16 a[88:89], v5 offset:24576
    ds_read_b64_tr_b16 a[90:91], v5 offset:25600
    ds_read_b64_tr_b16 a[92:93], v5 offset:28672
    ds_read_b64_tr_b16 a[94:95], v5 offset:29696
    s_waitcnt lgkmcnt(0)
    ds_read_b64_tr_b16 a[96:97], v5 offset:32768
    ds_read_b64_tr_b16 a[98:99], v5 offset:33792
    ds_read_b64_tr_b16 a[100:101], v5 offset:36864
    ds_read_b64_tr_b16 a[102:103], v5 offset:37888
    ds_read_b64_tr_b16 a[104:105], v5 offset:40960
    ds_read_b64_tr_b16 a[106:107], v5 offset:41984
    ds_read_b64_tr_b16 a[108:109], v5 offset:45056
    ds_read_b64_tr_b16 a[110:111], v5 offset:46080
    s_waitcnt lgkmcnt(0)
    ds_read_b64_tr_b16 a[112:113], v5 offset:49152
    ds_read_b64_tr_b16 a[114:115], v5 offset:50176
    ds_read_b64_tr_b16 a[116:117], v5 offset:53248
    ds_read_b64_tr_b16 a[118:119], v5 offset:54272
    ds_read_b64_tr_b16 a[120:121], v5 offset:57344
    ds_read_b64_tr_b16 a[122:123], v5 offset:58368
    ds_read_b64_tr_b16 a[124:125], v5 offset:61440
    ds_read_b64_tr_b16 a[126:127], v5 offset:62464
    s_waitcnt lgkmcnt(0)
    s_waitcnt lgkmcnt(0)
    s_barrier
    v_lshlrev_b32 v2, 4, v1
    s_mul_i32 s64, s44, 8192
    s_add_u32 s46, s64, 0xc00000
    v_add_u32 v3, s46, v2
    s_mul_i32 s46, s51, 32768
    v_add_u32 v4, s46, v2
    s_lshl_b32 s46, s50, 12
    s_add_u32 s46, s46, 131072
    v_add_u32 v5, s46, v2
    v_and_b32 v7, 3, v1
    v_lshlrev_b32 v7, 7, v7
    v_add_u32 v7, 0x106000, v7
    s_lshl_b32 s46, s49, 13
    s_lshl_b32 s47, s50, 11
    s_add_u32 s46, s46, s47
    s_add_u32 s46, s46, 0x6000000
    v_add_u32 v8, s46, v2
    s_lshl_b32 s52, s49, 7
    s_add_u32 s52, s52, 0x106800
    s_mov_b32 s28, s6
    s_and_b32 s29, s7, 0xffff
    s_mov_b32 s30, 0x1c00
    s_mov_b32 s31, 0x00020000
    s_lshl_b32 s46, s49, 8
    s_lshl_b32 s47, s50, 6
    s_add_u32 s46, s46, s47
    v_lshrrev_b32 v9, 5, v1
    v_lshlrev_b32 v9, 3, v9
    buffer_load_dwordx2 v[32:33], v9, s[28:31], s46 offen offset:0
    buffer_load_dwordx2 v[34:35], v9, s[28:31], s46 offen offset:16
    buffer_load_dwordx2 v[36:37], v9, s[28:31], s46 offen offset:32
    buffer_load_dwordx2 v[38:39], v9, s[28:31], s46 offen offset:48
    s_mov_b32 s56, 0xbdd2d3e8
    s_mov_b32 s57, 0xbdd2d3e8
    v_mov_b32 v112, 0xc0135761
    v_mov_b32 v113, 0xc0135761
    s_waitcnt vmcnt(0)
    v_lshlrev_b32 v64, 16, v32
    v_and_b32 v65, 0xffff0000, v32
    v_lshlrev_b32 v66, 16, v33
    v_and_b32 v67, 0xffff0000, v33
    v_lshlrev_b32 v68, 16, v34
    v_and_b32 v69, 0xffff0000, v34
    v_lshlrev_b32 v70, 16, v35
    v_and_b32 v71, 0xffff0000, v35
    v_lshlrev_b32 v72, 16, v36
    v_and_b32 v73, 0xffff0000, v36
    v_lshlrev_b32 v74, 16, v37
    v_and_b32 v75, 0xffff0000, v37
    v_lshlrev_b32 v76, 16, v38
    v_and_b32 v77, 0xffff0000, v38
    v_lshlrev_b32 v78, 16, v39
    v_and_b32 v79, 0xffff0000, v39
    s_mov_b32 s60, 0
    s_mov_b32 s61, 0
    s_mov_b32 s62, 0
    s_mov_b32 s63, 0
    s_mov_b32 s67, 0
    s_mov_b32 s68, 3
    v_mov_b32 v15, 147456
    v_mov_b32 v14, 0
    ds_write_b32 v15, v14 offset:4
L_g_restart_74:
    s_cmp_lg_u32 s44, 0
    s_cbranch_scc1 L_g_nsp_75
    s_mov_b32 s70, 0
L_g_sp_81:
    s_add_u32 s54, s60, 0
    s_add_u32 s55, s54, 0
    s_mul_i32 s46, s55, 171
    s_lshr_b32 s46, s46, 9
    s_mul_i32 s46, s46, 3
    s_sub_u32 s46, s55, s46
    s_lshl_b32 s46, s46, 9
    buffer_load_dword v11, v7, s[12:15], s46 offen sc1
    s_add_u32 s55, s54, 1
    s_mul_i32 s46, s55, 171
    s_lshr_b32 s46, s46, 9
    s_mul_i32 s46, s46, 3
    s_sub_u32 s46, s55, s46
    s_lshl_b32 s46, s46, 9
    buffer_load_dword v12, v7, s[12:15], s46 offen sc1
    s_add_u32 s55, s54, 2
    s_mul_i32 s46, s55, 171
    s_lshr_b32 s46, s46, 9
    s_mul_i32 s46, s46, 3
    s_sub_u32 s46, s55, s46
    s_lshl_b32 s46, s46, 9
    buffer_load_dword v13, v7, s[12:15], s46 offen sc1
    s_waitcnt vmcnt(0)
    v_cmp_ge_u32 vcc, s60, v11
    s_add_u32 s70, s70, 1
    s_cbranch_vccz L_g_sp_81_ok
    s_sleep 8
    s_cmp_lt_u32 s70, 524288
    s_cbranch_scc1 L_g_sp_81
    s_branch L_c_done_4
L_g_sp_81_ok:
    s_mov_b32 s46, s54
    v_cmp_ge_u32 vcc, s46, v11
    s_nop 0
    s_cbranch_vccnz L_g_le_82
    s_add_u32 s46, s46, 1
    v_cmp_ge_u32 vcc, s46, v12
    s_nop 0
    s_cbranch_vccnz L_g_le_82
    s_add_u32 s46, s46, 1
    v_cmp_ge_u32 vcc, s46, v13
    s_nop 0
    s_cbranch_vccnz L_g_le_82
    s_add_u32 s46, s46, 1
L_g_le_82:
    v_mov_b32 v11, s46
    ds_write_b32 v15, v11
L_g_nsp_75:
    s_waitcnt lgkmcnt(0)
    s_barrier
    ds_read_b32 v14, v15
    s_waitcnt lgkmcnt(0)
    v_readfirstlane_b32 s66, v14
    s_nop 3
    s_mov_b32 s69, 0
    s_cmp_gt_u32 s62, s60
    s_cbranch_scc1 L_g_nd_83
    s_cmp_ge_u32 s62, s66
    s_cbranch_scc1 L_g_nd_83
    s_add_u32 s47, s61, 4096
    s_add_u32 m0, s64, 0
    s_nop 0
    buffer_load_dwordx4 v3, s[12:15], s61 offen offset:0 sc1 lds
    buffer_load_dwordx4 v3, s[12:15], s61 offen offset:1024 sc1 lds
    buffer_load_dwordx4 v3, s[12:15], s61 offen offset:2048 sc1 lds
    buffer_load_dwordx4 v3, s[12:15], s61 offen offset:3072 sc1 lds
    s_add_u32 m0, s64, 4096
    s_nop 0
    buffer_load_dwordx4 v3, s[12:15], s47 offen offset:0 sc1 lds
    buffer_load_dwordx4 v3, s[12:15], s47 offen offset:1024 sc1 lds
    buffer_load_dwordx4 v3, s[12:15], s47 offen offset:2048 sc1 lds
    buffer_load_dwordx4 v3, s[12:15], s47 offen offset:3072 sc1 lds
    s_add_u32 s61, s61, 65536
    s_add_u32 s62, s62, 1
    s_xor_b32 s64, s64, 0x10000
    s_mov_b32 s69, 1
L_g_nd_83:
    s_cmp_eq_u32 s51, 1
    s_cbranch_scc1 L_g_g1r_76
    s_add_u32 s59, s60, 1
    s_mov_b32 s69, 0
    s_cmp_gt_u32 s62, s59
    s_cbranch_scc1 L_g_nd_84
    s_cmp_ge_u32 s62, s66
    s_cbranch_scc1 L_g_nd_84
    s_add_u32 s47, s61, 4096
    s_add_u32 m0, s64, 0
    s_nop 0
    buffer_load_dwordx4 v3, s[12:15], s61 offen offset:0 sc1 lds
    buffer_load_dwordx4 v3, s[12:15], s61 offen offset:1024 sc1 lds
    buffer_load_dwordx4 v3, s[12:15], s61 offen offset:2048 sc1 lds
    buffer_load_dwordx4 v3, s[12:15], s61 offen offset:3072 sc1 lds
    s_add_u32 m0, s64, 4096
    s_nop 0
    buffer_load_dwordx4 v3, s[12:15], s47 offen offset:0 sc1 lds
    buffer_load_dwordx4 v3, s[12:15], s47 offen offset:1024 sc1 lds
    buffer_load_dwordx4 v3, s[12:15], s47 offen offset:2048 sc1 lds
    buffer_load_dwordx4 v3, s[12:15], s47 offen offset:3072 sc1 lds
    s_add_u32 s61, s61, 65536
    s_add_u32 s62, s62, 1
    s_xor_b32 s64, s64, 0x10000
    s_mov_b32 s69, 1
L_g_nd_84:
    s_cmp_eq_u32 s69, 1
    s_cbranch_scc1 L_g_w0_85
    s_waitcnt vmcnt(0)
L_g_w0_85:
    s_waitcnt vmcnt(8)
    s_mov_b32 s65, 1
L_g_loop0_77:
    s_barrier
    s_cmp_eq_u32 s65, 0
    s_cbranch_scc1 L_g_pr_86
    ds_read_b128 v[32:35], v4 offset:0
    ds_read_b128 v[36:39], v4 offset:1024
    ds_read_b128 v[40:43], v4 offset:2048
    ds_read_b128 v[44:47], v4 offset:3072
    ds_read_b128 v[48:51], v4 offset:4096
    ds_read_b128 v[52:55], v4 offset:5120
    ds_read_b128 v[56:59], v4 offset:6144
    ds_read_b128 v[60:63], v4 offset:7168
L_g_pr_86:
    ds_read_b32 v14, v15
    s_cmp_lg_u32 s44, 0
    s_cbranch_scc1 L_g_nl_87
    s_add_u32 s54, s60, 1
    s_add_u32 s55, s54, 0
    s_mul_i32 s46, s55, 171
    s_lshr_b32 s46, s46, 9
    s_mul_i32 s46, s46, 3
    s_sub_u32 s46, s55, s46
    s_lshl_b32 s46, s46, 9
    buffer_load_dword v11, v7, s[12:15], s46 offen sc1
    s_add_u32 s55, s54, 1
    s_mul_i32 s46, s55, 171
    s_lshr_b32 s46, s46, 9
    s_mul_i32 s46, s46, 3
    s_sub_u32 s46, s55, s46
    s_lshl_b32 s46, s46, 9
    buffer_load_dword v12, v7, s[12:15], s46 offen sc1
    s_add_u32 s55, s54, 2
    s_mul_i32 s46, s55, 171
    s_lshr_b32 s46, s46, 9
    s_mul_i32 s46, s46, 3
    s_sub_u32 s46, s55, s46
    s_lshl_b32 s46, s46, 9
    buffer_load_dword v13, v7, s[12:15], s46 offen sc1
L_g_nl_87:
    s_setprio 1
    s_waitcnt lgkmcnt(7)
    v_mfma_f32_32x32x16_bf16 v[16:31], a[0:3], v[32:35], 0
    ds_read_b128 v[32:35], v4 offset:8192
    s_waitcnt lgkmcnt(7)
    v_mfma_f32_32x32x16_bf16 v[16:31], a[4:7], v[36:39], v[16:31]
    ds_read_b128 v[36:39], v4 offset:9216
    s_waitcnt lgkmcnt(7)
    v_mfma_f32_32x32x16_bf16 v[16:31], a[8:11], v[40:43], v[16:31]
    ds_read_b128 v[40:43], v4 offset:10240
    s_waitcnt lgkmcnt(7)
    v_mfma_f32_32x32x16_bf16 v[16:31], a[12:15], v[44:47], v[16:31]
    ds_read_b128 v[44:47], v4 offset:11264
    s_waitcnt lgkmcnt(7)
    v_mfma_f32_32x32x16_bf16 v[16:31], a[16:19], v[48:51], v[16:31]
    ds_read_b128 v[48:51], v4 offset:12288
    s_waitcnt lgkmcnt(7)
    v_mfma_f32_32x32x16_bf16 v[16:31], a[20:23], v[52:55], v[16:31]
    ds_read_b128 v[52:55], v4 offset:13312
    s_waitcnt lgkmcnt(7)
    v_mfma_f32_32x32x16_bf16 v[16:31], a[24:27], v[56:59], v[16:31]
    ds_read_b128 v[56:59], v4 offset:14336
    s_waitcnt lgkmcnt(7)
    v_mfma_f32_32x32x16_bf16 v[16:31], a[28:31], v[60:63], v[16:31]
    ds_read_b128 v[60:63], v4 offset:15360
    s_waitcnt lgkmcnt(7)
    v_mfma_f32_32x32x16_bf16 v[16:31], a[32:35], v[32:35], v[16:31]
    ds_read_b128 v[32:35], v4 offset:16384
    s_waitcnt lgkmcnt(7)
    v_mfma_f32_32x32x16_bf16 v[16:31], a[36:39], v[36:39], v[16:31]
    ds_read_b128 v[36:39], v4 offset:17408
    s_waitcnt lgkmcnt(7)
    v_mfma_f32_32x32x16_bf16 v[16:31], a[40:43], v[40:43], v[16:31]
    ds_read_b128 v[40:43], v4 offset:18432
    s_waitcnt lgkmcnt(7)
    v_mfma_f32_32x32x16_bf16 v[16:31], a[44:47], v[44:47], v[16:31]
    ds_read_b128 v[44:47], v4 offset:19456
    s_waitcnt lgkmcnt(7)
    v_mfma_f32_32x32x16_bf16 v[16:31], a[48:51], v[48:51], v[16:31]
    ds_read_b128 v[48:51], v4 offset:20480
    s_waitcnt lgkmcnt(7)
    v_mfma_f32_32x32x16_bf16 v[16:31], a[52:55], v[52:55], v[16:31]
    ds_read_b128 v[52:55], v4 offset:21504
    s_waitcnt lgkmcnt(7)
    v_mfma_f32_32x32x16_bf16 v[16:31], a[56:59], v[56:59], v[16:31]
    ds_read_b128 v[56:59], v4 offset:22528
    s_waitcnt lgkmcnt(7)
    v_mfma_f32_32x32x16_bf16 v[16:31], a[60:63], v[60:63], v[16:31]
    ds_read_b128 v[60:63], v4 offset:23552
    s_waitcnt lgkmcnt(7)
    v_mfma_f32_32x32x16_bf16 v[16:31], a[64:67], v[32:35], v[16:31]
    ds_read_b128 v[32:35], v4 offset:24576
    s_waitcnt lgkmcnt(7)
    v_mfma_f32_32x32x16_bf16 v[16:31], a[68:71], v[36:39], v[16:31]
    ds_read_b128 v[36:39], v4 offset:25600
    s_waitcnt lgkmcnt(7)
    v_mfma_f32_32x32x16_bf16 v[16:31], a[72:75], v[40:43], v[16:31]
    ds_read_b128 v[40:43], v4 offset:26624
    s_waitcnt lgkmcnt(7)
    v_mfma_f32_32x32x16_bf16 v[16:31], a[76:79], v[44:47], v[16:31]
    ds_read_b128 v[44:47], v4 offset:27648
    s_waitcnt lgkmcnt(7)
    v_mfma_f32_32x32x16_bf16 v[16:31], a[80:83], v[48:51], v[16:31]
    ds_read_b128 v[48:51], v4 offset:28672
    s_waitcnt lgkmcnt(7)
    v_mfma_f32_32x32x16_bf16 v[16:31], a[84:87], v[52:55], v[16:31]
    ds_read_b128 v[52:55], v4 offset:29696
    s_waitcnt lgkmcnt(7)
    v_mfma_f32_32x32x16_bf16 v[16:31], a[88:91], v[56:59], v[16:31]
    ds_read_b128 v[56:59], v4 offset:30720
    s_waitcnt lgkmcnt(7)
    v_mfma_f32_32x32x16_bf16 v[16:31], a[92:95], v[60:63], v[16:31]
    ds_read_b128 v[60:63], v4 offset:31744
    s_waitcnt lgkmcnt(7)
    v_mfma_f32_32x32x16_bf16 v[16:31], a[96:99], v[32:35], v[16:31]
    s_waitcnt lgkmcnt(6)
    v_mfma_f32_32x32x16_bf16 v[16:31], a[100:103], v[36:39], v[16:31]
    s_waitcnt lgkmcnt(5)
    v_mfma_f32_32x32x16_bf16 v[16:31], a[104:107], v[40:43], v[16:31]
    s_waitcnt lgkmcnt(4)
    v_mfma_f32_32x32x16_bf16 v[16:31], a[108:111], v[44:47], v[16:31]
    s_waitcnt lgkmcnt(3)
    v_mfma_f32_32x32x16_bf16 v[16:31], a[112:115], v[48:51], v[16:31]
    s_waitcnt lgkmcnt(2)
    v_mfma_f32_32x32x16_bf16 v[16:31], a[116:119], v[52:55], v[16:31]
    s_waitcnt lgkmcnt(1)
    v_mfma_f32_32x32x16_bf16 v[16:31], a[120:123], v[56:59], v[16:31]
    s_waitcnt lgkmcnt(0)
    v_mfma_f32_32x32x16_bf16 v[16:31], a[124:127], v[60:63], v[16:31]
    v_xor_b32 v4, 0x10000, v4
    s_setprio 0
    s_waitcnt vmcnt(0)
    v_readfirstlane_b32 s66, v14
    s_barrier
    s_nop 6
    ds_write_b128 v5, v[16:19] offset:0
    ds_write_b128 v5, v[20:23] offset:1024
    ds_write_b128 v5, v[24:27] offset:2048
    ds_write_b128 v5, v[28:31] offset:3072
    s_cmp_lg_u32 s44, 0
    s_cbranch_scc1 L_g_ne_88
    s_mov_b32 s46, s54
    v_cmp_ge_u32 vcc, s46, v11
    s_nop 0
    s_cbranch_vccnz L_g_le_91
    s_add_u32 s46, s46, 1
    v_cmp_ge_u32 vcc, s46, v12
    s_nop 0
    s_cbranch_vccnz L_g_le_91
    s_add_u32 s46, s46, 1
    v_cmp_ge_u32 vcc, s46, v13
    s_nop 0
    s_cbranch_vccnz L_g_le_91
    s_add_u32 s46, s46, 1
L_g_le_91:
    v_mov_b32 v11, s46
    ds_write_b32 v15, v11
L_g_ne_88:
    s_add_u32 s60, s60, 1
    s_waitcnt lgkmcnt(0)
    s_mov_b32 s69, 0
    s_cmp_gt_u32 s62, s60
    s_cbranch_scc1 L_g_nd_92
    s_cmp_ge_u32 s62, s66
    s_cbranch_scc1 L_g_nd_92
    s_add_u32 s47, s61, 4096
    s_add_u32 m0, s64, 0
    s_nop 0
    buffer_load_dwordx4 v3, s[12:15], s61 offen offset:0 sc1 lds
    buffer_load_dwordx4 v3, s[12:15], s61 offen offset:1024 sc1 lds
    buffer_load_dwordx4 v3, s[12:15], s61 offen offset:2048 sc1 lds
    buffer_load_dwordx4 v3, s[12:15], s61 offen offset:3072 sc1 lds
    s_add_u32 m0, s64, 4096
    s_nop 0
    buffer_load_dwordx4 v3, s[12:15], s47 offen offset:0 sc1 lds
    buffer_load_dwordx4 v3, s[12:15], s47 offen offset:1024 sc1 lds
    buffer_load_dwordx4 v3, s[12:15], s47 offen offset:2048 sc1 lds
    buffer_load_dwordx4 v3, s[12:15], s47 offen offset:3072 sc1 lds
    s_add_u32 s61, s61, 65536
    s_add_u32 s62, s62, 1
    s_xor_b32 s64, s64, 0x10000
    s_mov_b32 s69, 1
L_g_nd_92:
    s_mov_b32 s65, s69
    s_add_u32 s59, s60, 1
    s_mov_b32 s69, 0
    s_cmp_gt_u32 s62, s59
    s_cbranch_scc1 L_g_nd_93
    s_cmp_ge_u32 s62, s66
    s_cbranch_scc1 L_g_nd_93
    s_add_u32 s47, s61, 4096
    s_add_u32 m0, s64, 0
    s_nop 0
    buffer_load_dwordx4 v3, s[12:15], s61 offen offset:0 sc1 lds
    buffer_load_dwordx4 v3, s[12:15], s61 offen offset:1024 sc1 lds
    buffer_load_dwordx4 v3, s[12:15], s61 offen offset:2048 sc1 lds
    buffer_load_dwordx4 v3, s[12:15], s61 offen offset:3072 sc1 lds
    s_add_u32 m0, s64, 4096
    s_nop 0
    buffer_load_dwordx4 v3, s[12:15], s47 offen offset:0 sc1 lds
    buffer_load_dwordx4 v3, s[12:15], s47 offen offset:1024 sc1 lds
    buffer_load_dwordx4 v3, s[12:15], s47 offen offset:2048 sc1 lds
    buffer_load_dwordx4 v3, s[12:15], s47 offen offset:3072 sc1 lds
    s_add_u32 s61, s61, 65536
    s_add_u32 s62, s62, 1
    s_xor_b32 s64, s64, 0x10000
    s_mov_b32 s69, 1
L_g_nd_93:
    s_cmp_le_u32 s66, s60
    s_cbranch_scc1 L_g_ex0_90
    s_cmp_eq_u32 s65, 0
    s_cbranch_scc1 L_g_nw_89
    s_waitcnt vmcnt(0) lgkmcnt(0)
    s_branch L_g_loop0_77
L_g_nw_89:
    ds_read_b128 v[32:35], v4 offset:0
    ds_read_b128 v[36:39], v4 offset:1024
    ds_read_b128 v[40:43], v4 offset:2048
    ds_read_b128 v[44:47], v4 offset:3072
    ds_read_b128 v[48:51], v4 offset:4096
    ds_read_b128 v[52:55], v4 offset:5120
    ds_read_b128 v[56:59], v4 offset:6144
    ds_read_b128 v[60:63], v4 offset:7168
    s_waitcnt lgkmcnt(8)
    s_branch L_g_loop0_77
L_g_ex0_90:
    s_waitcnt lgkmcnt(0)
    s_barrier
    s_branch L_g_tail_79
L_g_g1r_76:
    s_mov_b32 s65, 1
    s_branch L_g_loop1_78_e
L_g_loop1_78:
    s_mov_b32 s65, 0
L_g_loop1_78_e:
    s_barrier
    ds_read_b32 v14, v15
    s_bitcmp1_b32 s67, 2
    s_cbranch_scc0 L_g_nfl_94
    s_sub_u32 s59, s60, 3
    s_cmp_lg_u32 s44, 4
    s_cbranch_scc1 L_sf_99
    v_mov_b32 v10, s59
    v_add_u32 v10, 1, v10
    v_mov_b32 v11, 0
    s_mov_b64 exec, 1
    buffer_store_dword v10, v11, s[12:15], s52 offen sc1
    s_mov_b64 exec, -1
L_sf_99:
L_g_nfl_94:
    s_bitcmp1_b32 s67, 0
    s_cbranch_scc0 L_g_nep_95
    ds_read_b128 v[80:83], v5 offset:0
    ds_read_b128 v[84:87], v5 offset:1024
    ds_read_b128 v[88:91], v5 offset:2048
    ds_read_b128 v[92:95], v5 offset:3072
    s_nop 7
    s_waitcnt lgkmcnt(3)
    v_add_f32 v80, v80, v16
    v_add_f32 v81, v81, v17
    v_add_f32 v82, v82, v18
    v_add_f32 v83, v83, v19
    s_waitcnt lgkmcnt(2)
    v_add_f32 v84, v84, v20
    v_add_f32 v85, v85, v21
    v_add_f32 v86, v86, v22
    v_add_f32 v87, v87, v23
    s_waitcnt lgkmcnt(1)
    v_add_f32 v88, v88, v24
    v_add_f32 v89, v89, v25
    v_add_f32 v90, v90, v26
    v_add_f32 v91, v91, v27
    s_waitcnt lgkmcnt(0)
    v_add_f32 v92, v92, v28
    v_add_f32 v93, v93, v29
    v_add_f32 v94, v94, v30
    v_add_f32 v95, v95, v31
L_g_nep_95:
    s_waitcnt lgkmcnt(0)
    v_readfirstlane_b32 s66, v14
    s_nop 3
    s_mov_b32 s69, 0
    s_cmp_gt_u32 s62, s60
    s_cbranch_scc1 L_g_nd_100
    s_cmp_ge_u32 s62, s66
    s_cbranch_scc1 L_g_nd_100
    s_add_u32 s47, s61, 4096
    s_add_u32 m0, s64, 0
    s_nop 0
    buffer_load_dwordx4 v3, s[12:15], s61 offen offset:0 sc1 lds
    buffer_load_dwordx4 v3, s[12:15], s61 offen offset:1024 sc1 lds
    buffer_load_dwordx4 v3, s[12:15], s61 offen offset:2048 sc1 lds
    buffer_load_dwordx4 v3, s[12:15], s61 offen offset:3072 sc1 lds
    s_add_u32 m0, s64, 4096
    s_nop 0
    buffer_load_dwordx4 v3, s[12:15], s47 offen offset:0 sc1 lds
    buffer_load_dwordx4 v3, s[12:15], s47 offen offset:1024 sc1 lds
    buffer_load_dwordx4 v3, s[12:15], s47 offen offset:2048 sc1 lds
    buffer_load_dwordx4 v3, s[12:15], s47 offen offset:3072 sc1 lds
    s_add_u32 s61, s61, 65536
    s_add_u32 s62, s62, 1
    s_xor_b32 s64, s64, 0x10000
    s_mov_b32 s69, 1
L_g_nd_100:
    s_or_b32 s65, s65, s69
    s_add_u32 s59, s60, 1
    s_mov_b32 s69, 0
    s_cmp_gt_u32 s62, s59
    s_cbranch_scc1 L_g_nd_101
    s_cmp_ge_u32 s62, s66
    s_cbranch_scc1 L_g_nd_101
    s_add_u32 s47, s61, 4096
    s_add_u32 m0, s64, 0
    s_nop 0
    buffer_load_dwordx4 v3, s[12:15], s61 offen offset:0 sc1 lds
    buffer_load_dwordx4 v3, s[12:15], s61 offen offset:1024 sc1 lds
    buffer_load_dwordx4 v3, s[12:15], s61 offen offset:2048 sc1 lds
    buffer_load_dwordx4 v3, s[12:15], s61 offen offset:3072 sc1 lds
    s_add_u32 m0, s64, 4096
    s_nop 0
    buffer_load_dwordx4 v3, s[12:15], s47 offen offset:0 sc1 lds
    buffer_load_dwordx4 v3, s[12:15], s47 offen offset:1024 sc1 lds
    buffer_load_dwordx4 v3, s[12:15], s47 offen offset:2048 sc1 lds
    buffer_load_dwordx4 v3, s[12:15], s47 offen offset:3072 sc1 lds
    s_add_u32 s61, s61, 65536
    s_add_u32 s62, s62, 1
    s_xor_b32 s64, s64, 0x10000
    s_mov_b32 s69, 1
L_g_nd_101:
    v_cvt_pk_bf16_f32 v96, v80, v81
    v_cvt_pk_bf16_f32 v97, v82, v83
    v_cvt_pk_bf16_f32 v98, v84, v85
    v_cvt_pk_bf16_f32 v99, v86, v87
    v_lshlrev_b32 v80, 16, v96
    v_and_b32 v81, 0xffff0000, v96
    v_lshlrev_b32 v82, 16, v97
    v_and_b32 v83, 0xffff0000, v97
    v_lshlrev_b32 v84, 16, v98
    v_and_b32 v85, 0xffff0000, v98
    v_lshlrev_b32 v86, 16, v99
    v_and_b32 v87, 0xffff0000, v99
    v_add_f32 v80, v80, v64
    v_add_f32 v81, v81, v65
    v_add_f32 v82, v82, v66
    v_add_f32 v83, v83, v67
    v_add_f32 v84, v84, v68
    v_add_f32 v85, v85, v69
    v_add_f32 v86, v86, v70
    v_add_f32 v87, v87, v71
    v_cvt_pk_bf16_f32 v96, v80, v81
    v_cvt_pk_bf16_f32 v97, v82, v83
    v_cvt_pk_bf16_f32 v98, v84, v85
    v_cvt_pk_bf16_f32 v99, v86, v87
    v_lshlrev_b32 v80, 16, v96
    v_and_b32 v81, 0xffff0000, v96
    v_lshlrev_b32 v82, 16, v97
    v_and_b32 v83, 0xffff0000, v97
    v_lshlrev_b32 v84, 16, v98
    v_and_b32 v85, 0xffff0000, v98
    v_lshlrev_b32 v86, 16, v99
    v_and_b32 v87, 0xffff0000, v99
    v_mul_f32 v96, v80, v80
    v_mul_f32 v97, v81, v81
    v_mul_f32 v98, v82, v82
    v_mul_f32 v99, v83, v83
    v_mul_f32 v100, v84, v84
    v_mul_f32 v101, v85, v85
    v_mul_f32 v102, v86, v86
    v_mul_f32 v103, v87, v87
    v_fma_f32 v96, v96, s56, v112
    v_fma_f32 v97, v97, s56, v112
    v_fma_f32 v98, v98, s56, v112
    v_fma_f32 v99, v99, s56, v112
    s_cmp_eq_u32 s65, 0
    s_cbranch_scc1 L_g_nw1_96
    s_waitcnt vmcnt(0)
    s_barrier
    ds_read_b128 v[32:35], v4 offset:0
    ds_read_b128 v[36:39], v4 offset:1024
    ds_read_b128 v[40:43], v4 offset:2048
    ds_read_b128 v[44:47], v4 offset:3072
    ds_read_b128 v[48:51], v4 offset:4096
    ds_read_b128 v[52:55], v4 offset:5120
    ds_read_b128 v[56:59], v4 offset:6144
    ds_read_b128 v[60:63], v4 offset:7168
    s_branch L_g_jn_98
L_g_nw1_96:
    ds_read_b128 v[32:35], v4 offset:0
    ds_read_b128 v[36:39], v4 offset:1024
    ds_read_b128 v[40:43], v4 offset:2048
    ds_read_b128 v[44:47], v4 offset:3072
    ds_read_b128 v[48:51], v4 offset:4096
    ds_read_b128 v[52:55], v4 offset:5120
    ds_read_b128 v[56:59], v4 offset:6144
    ds_read_b128 v[60:63], v4 offset:7168
    s_barrier
L_g_jn_98:
    s_bitcmp1_b32 s67, 0
    s_cbranch_scc1 L_g_mm2_97
    s_setprio 1
    s_waitcnt lgkmcnt(7)
    v_mfma_f32_32x32x16_bf16 v[16:31], a[0:3], v[32:35], 0
    ds_read_b128 v[32:35], v4 offset:8192
    s_waitcnt lgkmcnt(7)
    v_mfma_f32_32x32x16_bf16 v[16:31], a[4:7], v[36:39], v[16:31]
    ds_read_b128 v[36:39], v4 offset:9216
    s_waitcnt lgkmcnt(7)
    v_mfma_f32_32x32x16_bf16 v[16:31], a[8:11], v[40:43], v[16:31]
    ds_read_b128 v[40:43], v4 offset:10240
    s_waitcnt lgkmcnt(7)
    v_mfma_f32_32x32x16_bf16 v[16:31], a[12:15], v[44:47], v[16:31]
    ds_read_b128 v[44:47], v4 offset:11264
    s_waitcnt lgkmcnt(7)
    v_mfma_f32_32x32x16_bf16 v[16:31], a[16:19], v[48:51], v[16:31]
    ds_read_b128 v[48:51], v4 offset:12288
    s_waitcnt lgkmcnt(7)
    v_mfma_f32_32x32x16_bf16 v[16:31], a[20:23], v[52:55], v[16:31]
    ds_read_b128 v[52:55], v4 offset:13312
    s_waitcnt lgkmcnt(7)
    v_mfma_f32_32x32x16_bf16 v[16:31], a[24:27], v[56:59], v[16:31]
    ds_read_b128 v[56:59], v4 offset:14336
    s_waitcnt lgkmcnt(7)
    v_mfma_f32_32x32x16_bf16 v[16:31], a[28:31], v[60:63], v[16:31]
    ds_read_b128 v[60:63], v4 offset:15360
    s_waitcnt lgkmcnt(7)
    v_mfma_f32_32x32x16_bf16 v[16:31], a[32:35], v[32:35], v[16:31]
    ds_read_b128 v[32:35], v4 offset:16384
    s_waitcnt lgkmcnt(7)
    v_mfma_f32_32x32x16_bf16 v[16:31], a[36:39], v[36:39], v[16:31]
    ds_read_b128 v[36:39], v4 offset:17408
    s_waitcnt lgkmcnt(7)
    v_mfma_f32_32x32x16_bf16 v[16:31], a[40:43], v[40:43], v[16:31]
    ds_read_b128 v[40:43], v4 offset:18432
    s_waitcnt lgkmcnt(7)
    v_mfma_f32_32x32x16_bf16 v[16:31], a[44:47], v[44:47], v[16:31]
    ds_read_b128 v[44:47], v4 offset:19456
    s_waitcnt lgkmcnt(7)
    v_mfma_f32_32x32x16_bf16 v[16:31], a[48:51], v[48:51], v[16:31]
    ds_read_b128 v[48:51], v4 offset:20480
    s_waitcnt lgkmcnt(7)
    v_mfma_f32_32x32x16_bf16 v[16:31], a[52:55], v[52:55], v[16:31]
    ds_read_b128 v[52:55], v4 offset:21504
    s_waitcnt lgkmcnt(7)
    v_mfma_f32_32x32x16_bf16 v[16:31], a[56:59], v[56:59], v[16:31]
    ds_read_b128 v[56:59], v4 offset:22528
    s_waitcnt lgkmcnt(7)
    v_mfma_f32_32x32x16_bf16 v[16:31], a[60:63], v[60:63], v[16:31]
    ds_read_b128 v[60:63], v4 offset:23552
    s_waitcnt lgkmcnt(7)
    v_mfma_f32_32x32x16_bf16 v[16:31], a[64:67], v[32:35], v[16:31]
    ds_read_b128 v[32:35], v4 offset:24576
    s_waitcnt lgkmcnt(7)
    v_mfma_f32_32x32x16_bf16 v[16:31], a[68:71], v[36:39], v[16:31]
    ds_read_b128 v[36:39], v4 offset:25600
    s_waitcnt lgkmcnt(7)
    v_mfma_f32_32x32x16_bf16 v[16:31], a[72:75], v[40:43], v[16:31]
    ds_read_b128 v[40:43], v4 offset:26624
    s_waitcnt lgkmcnt(7)
    v_mfma_f32_32x32x16_bf16 v[16:31], a[76:79], v[44:47], v[16:31]
    ds_read_b128 v[44:47], v4 offset:27648
    s_waitcnt lgkmcnt(7)
    v_mfma_f32_32x32x16_bf16 v[16:31], a[80:83], v[48:51], v[16:31]
    ds_read_b128 v[48:51], v4 offset:28672
    s_waitcnt lgkmcnt(7)
    v_mfma_f32_32x32x16_bf16 v[16:31], a[84:87], v[52:55], v[16:31]
    ds_read_b128 v[52:55], v4 offset:29696
    s_waitcnt lgkmcnt(7)
    v_mfma_f32_32x32x16_bf16 v[16:31], a[88:91], v[56:59], v[16:31]
    ds_read_b128 v[56:59], v4 offset:30720
    s_waitcnt lgkmcnt(7)
    v_mfma_f32_32x32x16_bf16 v[16:31], a[92:95], v[60:63], v[16:31]
    ds_read_b128 v[60:63], v4 offset:31744
    s_waitcnt lgkmcnt(7)
    v_mfma_f32_32x32x16_bf16 v[16:31], a[96:99], v[32:35], v[16:31]
    s_waitcnt lgkmcnt(6)
    v_mfma_f32_32x32x16_bf16 v[16:31], a[100:103], v[36:39], v[16:31]
    s_waitcnt lgkmcnt(5)
    v_mfma_f32_32x32x16_bf16 v[16:31], a[104:107], v[40:43], v[16:31]
    s_waitcnt lgkmcnt(4)
    v_mfma_f32_32x32x16_bf16 v[16:31], a[108:111], v[44:47], v[16:31]
    s_waitcnt lgkmcnt(3)
    v_mfma_f32_32x32x16_bf16 v[16:31], a[112:115], v[48:51], v[16:31]
    s_waitcnt lgkmcnt(2)
    v_mfma_f32_32x32x16_bf16 v[16:31], a[116:119], v[52:55], v[16:31]
    s_waitcnt lgkmcnt(1)
    v_mfma_f32_32x32x16_bf16 v[16:31], a[120:123], v[56:59], v[16:31]
    s_waitcnt lgkmcnt(0)
    v_mfma_f32_32x32x16_bf16 v[16:31], a[124:127], v[60:63], v[16:31]
    v_xor_b32 v4, 0x10000, v4
    s_setprio 0
    s_waitcnt vmcnt(0)
    s_branch L_g_mm2_97_d
L_g_mm2_97:
    s_setprio 1
    s_waitcnt lgkmcnt(7)
    v_mfma_f32_32x32x16_bf16 v[16:31], a[0:3], v[32:35], 0
    ds_read_b128 v[32:35], v4 offset:8192
    v_fma_f32 v100, v100, s56, v112
    v_fma_f32 v101, v101, s56, v112
    v_fma_f32 v102, v102, s56, v112
    v_fma_f32 v103, v103, s56, v112
    v_mul_f32 v96, v96, v80
    v_mul_f32 v97, v97, v81
    s_waitcnt lgkmcnt(7)
    v_mfma_f32_32x32x16_bf16 v[16:31], a[4:7], v[36:39], v[16:31]
    ds_read_b128 v[36:39], v4 offset:9216
    v_mul_f32 v98, v98, v82
    v_mul_f32 v99, v99, v83
    v_mul_f32 v100, v100, v84
    v_mul_f32 v101, v101, v85
    v_mul_f32 v102, v102, v86
    v_mul_f32 v103, v103, v87
    s_waitcnt lgkmcnt(7)
    v_mfma_f32_32x32x16_bf16 v[16:31], a[8:11], v[40:43], v[16:31]
    ds_read_b128 v[40:43], v4 offset:10240
    v_exp_f32 v96, v96
    v_exp_f32 v97, v97
    v_exp_f32 v98, v98
    s_waitcnt lgkmcnt(7)
    v_mfma_f32_32x32x16_bf16 v[16:31], a[12:15], v[44:47], v[16:31]
    ds_read_b128 v[44:47], v4 offset:11264
    v_exp_f32 v99, v99
    v_exp_f32 v100, v100
    v_exp_f32 v101, v101
    s_waitcnt lgkmcnt(7)
    v_mfma_f32_32x32x16_bf16 v[16:31], a[16:19], v[48:51], v[16:31]
    ds_read_b128 v[48:51], v4 offset:12288
    v_exp_f32 v102, v102
    v_exp_f32 v103, v103
    v_add_f32 v96, 1.0, v96
    v_add_f32 v97, 1.0, v97
    s_waitcnt lgkmcnt(7)
    v_mfma_f32_32x32x16_bf16 v[16:31], a[20:23], v[52:55], v[16:31]
    ds_read_b128 v[52:55], v4 offset:13312
    v_add_f32 v98, 1.0, v98
    v_add_f32 v99, 1.0, v99
    v_add_f32 v100, 1.0, v100
    v_add_f32 v101, 1.0, v101
    v_add_f32 v102, 1.0, v102
    v_add_f32 v103, 1.0, v103
    s_waitcnt lgkmcnt(7)
    v_mfma_f32_32x32x16_bf16 v[16:31], a[24:27], v[56:59], v[16:31]
    ds_read_b128 v[56:59], v4 offset:14336
    v_rcp_f32 v96, v96
    v_rcp_f32 v97, v97
    v_rcp_f32 v98, v98
    s_waitcnt lgkmcnt(7)
    v_mfma_f32_32x32x16_bf16 v[16:31], a[28:31], v[60:63], v[16:31]
    ds_read_b128 v[60:63], v4 offset:15360
    v_rcp_f32 v99, v99
    v_rcp_f32 v100, v100
    v_rcp_f32 v101, v101
    s_waitcnt lgkmcnt(7)
    v_mfma_f32_32x32x16_bf16 v[16:31], a[32:35], v[32:35], v[16:31]
    ds_read_b128 v[32:35], v4 offset:16384
    v_rcp_f32 v102, v102
    v_rcp_f32 v103, v103
    v_mul_f32 v80, v80, v96
    v_mul_f32 v81, v81, v97
    s_waitcnt lgkmcnt(7)
    v_mfma_f32_32x32x16_bf16 v[16:31], a[36:39], v[36:39], v[16:31]
    ds_read_b128 v[36:39], v4 offset:17408
    v_mul_f32 v82, v82, v98
    v_mul_f32 v83, v83, v99
    v_mul_f32 v84, v84, v100
    v_mul_f32 v85, v85, v101
    v_mul_f32 v86, v86, v102
    v_mul_f32 v87, v87, v103
    s_waitcnt lgkmcnt(7)
    v_mfma_f32_32x32x16_bf16 v[16:31], a[40:43], v[40:43], v[16:31]
    ds_read_b128 v[40:43], v4 offset:18432
    v_cvt_pk_bf16_f32 v104, v80, v81
    v_cvt_pk_bf16_f32 v105, v82, v83
    v_cvt_pk_bf16_f32 v106, v84, v85
    v_cvt_pk_bf16_f32 v107, v86, v87
    buffer_store_dwordx4 v[104:107], v8, s[12:15], s63 offen offset:0 sc1
    v_cvt_pk_bf16_f32 v96, v88, v89
    s_waitcnt lgkmcnt(7)
    v_mfma_f32_32x32x16_bf16 v[16:31], a[44:47], v[44:47], v[16:31]
    ds_read_b128 v[44:47], v4 offset:19456
    v_cvt_pk_bf16_f32 v97, v90, v91
    v_cvt_pk_bf16_f32 v98, v92, v93
    v_cvt_pk_bf16_f32 v99, v94, v95
    v_lshlrev_b32 v88, 16, v96
    v_and_b32 v89, 0xffff0000, v96
    v_lshlrev_b32 v90, 16, v97
    s_waitcnt lgkmcnt(7)
    v_mfma_f32_32x32x16_bf16 v[16:31], a[48:51], v[48:51], v[16:31]
    ds_read_b128 v[48:51], v4 offset:20480
    v_and_b32 v91, 0xffff0000, v97
    v_lshlrev_b32 v92, 16, v98
    v_and_b32 v93, 0xffff0000, v98
    v_lshlrev_b32 v94, 16, v99
    v_and_b32 v95, 0xffff0000, v99
    v_add_f32 v88, v88, v72
    s_waitcnt lgkmcnt(7)
    v_mfma_f32_32x32x16_bf16 v[16:31], a[52:55], v[52:55], v[16:31]
    ds_read_b128 v[52:55], v4 offset:21504
    v_add_f32 v89, v89, v73
    v_add_f32 v90, v90, v74
    v_add_f32 v91, v91, v75
    v_add_f32 v92, v92, v76
    v_add_f32 v93, v93, v77
    v_add_f32 v94, v94, v78
    s_waitcnt lgkmcnt(7)
    v_mfma_f32_32x32x16_bf16 v[16:31], a[56:59], v[56:59], v[16:31]
    ds_read_b128 v[56:59], v4 offset:22528
    v_add_f32 v95, v95, v79
    v_cvt_pk_bf16_f32 v96, v88, v89
    v_cvt_pk_bf16_f32 v97, v90, v91
    v_cvt_pk_bf16_f32 v98, v92, v93
    v_cvt_pk_bf16_f32 v99, v94, v95
    v_lshlrev_b32 v88, 16, v96
    s_waitcnt lgkmcnt(7)
    v_mfma_f32_32x32x16_bf16 v[16:31], a[60:63], v[60:63], v[16:31]
    ds_read_b128 v[60:63], v4 offset:23552
    v_and_b32 v89, 0xffff0000, v96
    v_lshlrev_b32 v90, 16, v97
    v_and_b32 v91, 0xffff0000, v97
    v_lshlrev_b32 v92, 16, v98
    v_and_b32 v93, 0xffff0000, v98
    v_lshlrev_b32 v94, 16, v99
    s_waitcnt lgkmcnt(7)
    v_mfma_f32_32x32x16_bf16 v[16:31], a[64:67], v[32:35], v[16:31]
    ds_read_b128 v[32:35], v4 offset:24576
    v_and_b32 v95, 0xffff0000, v99
    v_mul_f32 v96, v88, v88
    v_mul_f32 v97, v89, v89
    v_mul_f32 v98, v90, v90
    v_mul_f32 v99, v91, v91
    v_mul_f32 v100, v92, v92
    s_waitcnt lgkmcnt(7)
    v_mfma_f32_32x32x16_bf16 v[16:31], a[68:71], v[36:39], v[16:31]
    ds_read_b128 v[36:39], v4 offset:25600
    v_mul_f32 v101, v93, v93
    v_mul_f32 v102, v94, v94
    v_mul_f32 v103, v95, v95
    v_fma_f32 v96, v96, s56, v112
    v_fma_f32 v97, v97, s56, v112
    v_fma_f32 v98, v98, s56, v112
    s_waitcnt lgkmcnt(7)
    v_mfma_f32_32x32x16_bf16 v[16:31], a[72:75], v[40:43], v[16:31]
    ds_read_b128 v[40:43], v4 offset:26624
    v_fma_f32 v99, v99, s56, v112
    v_fma_f32 v100, v100, s56, v112
    v_fma_f32 v101, v101, s56, v112
    v_fma_f32 v102, v102, s56, v112
    v_fma_f32 v103, v103, s56, v112
    v_mul_f32 v96, v96, v88
    s_waitcnt lgkmcnt(7)
    v_mfma_f32_32x32x16_bf16 v[16:31], a[76:79], v[44:47], v[16:31]
    ds_read_b128 v[44:47], v4 offset:27648
    v_mul_f32 v97, v97, v89
    v_mul_f32 v98, v98, v90
    v_mul_f32 v99, v99, v91
    v_mul_f32 v100, v100, v92
    v_mul_f32 v101, v101, v93
    v_mul_f32 v102, v102, v94
    s_waitcnt lgkmcnt(7)
    v_mfma_f32_32x32x16_bf16 v[16:31], a[80:83], v[48:51], v[16:31]
    ds_read_b128 v[48:51], v4 offset:28672
    v_mul_f32 v103, v103, v95
    v_exp_f32 v96, v96
    v_exp_f32 v97, v97
    v_exp_f32 v98, v98
    s_waitcnt lgkmcnt(7)
    v_mfma_f32_32x32x16_bf16 v[16:31], a[84:87], v[52:55], v[16:31]
    ds_read_b128 v[52:55], v4 offset:29696
    v_exp_f32 v99, v99
    v_exp_f32 v100, v100
    v_exp_f32 v101, v101
    s_waitcnt lgkmcnt(7)
    v_mfma_f32_32x32x16_bf16 v[16:31], a[88:91], v[56:59], v[16:31]
    ds_read_b128 v[56:59], v4 offset:30720
    v_exp_f32 v102, v102
    v_exp_f32 v103, v103
    v_add_f32 v96, 1.0, v96
    v_add_f32 v97, 1.0, v97
    s_waitcnt lgkmcnt(7)
    v_mfma_f32_32x32x16_bf16 v[16:31], a[92:95], v[60:63], v[16:31]
    ds_read_b128 v[60:63], v4 offset:31744
    v_add_f32 v98, 1.0, v98
    v_add_f32 v99, 1.0, v99
    v_add_f32 v100, 1.0, v100
    v_add_f32 v101, 1.0, v101
    v_add_f32 v102, 1.0, v102
    v_add_f32 v103, 1.0, v103
    s_waitcnt lgkmcnt(7)
    v_mfma_f32_32x32x16_bf16 v[16:31], a[96:99], v[32:35], v[16:31]
    v_rcp_f32 v96, v96
    v_rcp_f32 v97, v97
    v_rcp_f32 v98, v98
    s_waitcnt lgkmcnt(6)
    v_mfma_f32_32x32x16_bf16 v[16:31], a[100:103], v[36:39], v[16:31]
    v_rcp_f32 v99, v99
    v_rcp_f32 v100, v100
    v_rcp_f32 v101, v101
    s_waitcnt lgkmcnt(5)
    v_mfma_f32_32x32x16_bf16 v[16:31], a[104:107], v[40:43], v[16:31]
    v_rcp_f32 v102, v102
    v_rcp_f32 v103, v103
    v_mul_f32 v88, v88, v96
    v_mul_f32 v89, v89, v97
    s_waitcnt lgkmcnt(4)
    v_mfma_f32_32x32x16_bf16 v[16:31], a[108:111], v[44:47], v[16:31]
    v_mul_f32 v90, v90, v98
    v_mul_f32 v91, v91, v99
    v_mul_f32 v92, v92, v100
    v_mul_f32 v93, v93, v101
    v_mul_f32 v94, v94, v102
    v_mul_f32 v95, v95, v103
    s_waitcnt lgkmcnt(3)
    v_mfma_f32_32x32x16_bf16 v[16:31], a[112:115], v[48:51], v[16:31]
    v_cvt_pk_bf16_f32 v108, v88, v89
    v_cvt_pk_bf16_f32 v109, v90, v91
    v_cvt_pk_bf16_f32 v110, v92, v93
    v_cvt_pk_bf16_f32 v111, v94, v95
    buffer_store_dwordx4 v[108:111], v8, s[12:15], s63 offen offset:1024 sc1
    s_add_u32 s63, s63, 229376
    s_waitcnt lgkmcnt(2)
    v_mfma_f32_32x32x16_bf16 v[16:31], a[116:119], v[52:55], v[16:31]
    s_waitcnt lgkmcnt(1)
    v_mfma_f32_32x32x16_bf16 v[16:31], a[120:123], v[56:59], v[16:31]
    s_waitcnt lgkmcnt(0)
    v_mfma_f32_32x32x16_bf16 v[16:31], a[124:127], v[60:63], v[16:31]
    v_xor_b32 v4, 0x10000, v4
    s_setprio 0
    s_waitcnt vmcnt(2)
L_g_mm2_97_d:
    s_lshl_b32 s67, s67, 1
    s_or_b32 s67, s67, 1
    s_add_u32 s60, s60, 1
    s_cmp_gt_u32 s66, s60
    s_cbranch_scc1 L_g_loop1_78
    s_barrier
    s_sub_u32 s59, s60, 1
    ds_read_b128 v[80:83], v5 offset:0
    ds_read_b128 v[84:87], v5 offset:1024
    ds_read_b128 v[88:91], v5 offset:2048
    ds_read_b128 v[92:95], v5 offset:3072
    s_nop 7
    s_waitcnt lgkmcnt(3)
    v_add_f32 v80, v80, v16
    v_add_f32 v81, v81, v17
    v_add_f32 v82, v82, v18
    v_add_f32 v83, v83, v19
    s_waitcnt lgkmcnt(2)
    v_add_f32 v84, v84, v20
    v_add_f32 v85, v85, v21
    v_add_f32 v86, v86, v22
    v_add_f32 v87, v87, v23
    s_waitcnt lgkmcnt(1)
    v_add_f32 v88, v88, v24
    v_add_f32 v89, v89, v25
    v_add_f32 v90, v90, v26
    v_add_f32 v91, v91, v27
    s_waitcnt lgkmcnt(0)
    v_add_f32 v92, v92, v28
    v_add_f32 v93, v93, v29
    v_add_f32 v94, v94, v30
    v_add_f32 v95, v95, v31
    v_cvt_pk_bf16_f32 v96, v80, v81
    v_cvt_pk_bf16_f32 v97, v82, v83
    v_cvt_pk_bf16_f32 v98, v84, v85
    v_cvt_pk_bf16_f32 v99, v86, v87
    v_lshlrev_b32 v80, 16, v96
    v_and_b32 v81, 0xffff0000, v96
    v_lshlrev_b32 v82, 16, v97
    v_and_b32 v83, 0xffff0000, v97
    v_lshlrev_b32 v84, 16, v98
    v_and_b32 v85, 0xffff0000, v98
    v_lshlrev_b32 v86, 16, v99
    v_and_b32 v87, 0xffff0000, v99
    v_add_f32 v80, v80, v64
    v_add_f32 v81, v81, v65
    v_add_f32 v82, v82, v66
    v_add_f32 v83, v83, v67
    v_add_f32 v84, v84, v68
    v_add_f32 v85, v85, v69
    v_add_f32 v86, v86, v70
    v_add_f32 v87, v87, v71
    v_cvt_pk_bf16_f32 v96, v80, v81
    v_cvt_pk_bf16_f32 v97, v82, v83
    v_cvt_pk_bf16_f32 v98, v84, v85
    v_cvt_pk_bf16_f32 v99, v86, v87
    v_lshlrev_b32 v80, 16, v96
    v_and_b32 v81, 0xffff0000, v96
    v_lshlrev_b32 v82, 16, v97
    v_and_b32 v83, 0xffff0000, v97
    v_lshlrev_b32 v84, 16, v98
    v_and_b32 v85, 0xffff0000, v98
    v_lshlrev_b32 v86, 16, v99
    v_and_b32 v87, 0xffff0000, v99
    v_mul_f32 v96, v80, v80
    v_mul_f32 v97, v81, v81
    v_mul_f32 v98, v82, v82
    v_mul_f32 v99, v83, v83
    v_mul_f32 v100, v84, v84
    v_mul_f32 v101, v85, v85
    v_mul_f32 v102, v86, v86
    v_mul_f32 v103, v87, v87
    v_fma_f32 v96, v96, s56, v112
    v_fma_f32 v97, v97, s56, v112
    v_fma_f32 v98, v98, s56, v112
    v_fma_f32 v99, v99, s56, v112
    v_fma_f32 v100, v100, s56, v112
    v_fma_f32 v101, v101, s56, v112
    v_fma_f32 v102, v102, s56, v112
    v_fma_f32 v103, v103, s56, v112
    v_mul_f32 v96, v96, v80
    v_mul_f32 v97, v97, v81
    v_mul_f32 v98, v98, v82
    v_mul_f32 v99, v99, v83
    v_mul_f32 v100, v100, v84
    v_mul_f32 v101, v101, v85
    v_mul_f32 v102, v102, v86
    v_mul_f32 v103, v103, v87
    v_exp_f32 v96, v96
    v_exp_f32 v97, v97
    v_exp_f32 v98, v98
    v_exp_f32 v99, v99
    v_exp_f32 v100, v100
    v_exp_f32 v101, v101
    v_exp_f32 v102, v102
    v_exp_f32 v103, v103
    v_add_f32 v96, 1.0, v96
    v_add_f32 v97, 1.0, v97
    v_add_f32 v98, 1.0, v98
    v_add_f32 v99, 1.0, v99
    v_add_f32 v100, 1.0, v100
    v_add_f32 v101, 1.0, v101
    v_add_f32 v102, 1.0, v102
    v_add_f32 v103, 1.0, v103
    v_rcp_f32 v96, v96
    v_rcp_f32 v97, v97
    v_rcp_f32 v98, v98
    v_rcp_f32 v99, v99
    v_rcp_f32 v100, v100
    v_rcp_f32 v101, v101
    v_rcp_f32 v102, v102
    v_rcp_f32 v103, v103
    v_mul_f32 v80, v80, v96
    v_mul_f32 v81, v81, v97
    v_mul_f32 v82, v82, v98
    v_mul_f32 v83, v83, v99
    v_mul_f32 v84, v84, v100
    v_mul_f32 v85, v85, v101
    v_mul_f32 v86, v86, v102
    v_mul_f32 v87, v87, v103
    v_cvt_pk_bf16_f32 v104, v80, v81
    v_cvt_pk_bf16_f32 v105, v82, v83
    v_cvt_pk_bf16_f32 v106, v84, v85
    v_cvt_pk_bf16_f32 v107, v86, v87
    buffer_store_dwordx4 v[104:107], v8, s[12:15], s63 offen offset:0 sc1
    v_cvt_pk_bf16_f32 v96, v88, v89
    v_cvt_pk_bf16_f32 v97, v90, v91
    v_cvt_pk_bf16_f32 v98, v92, v93
    v_cvt_pk_bf16_f32 v99, v94, v95
    v_lshlrev_b32 v88, 16, v96
    v_and_b32 v89, 0xffff0000, v96
    v_lshlrev_b32 v90, 16, v97
    v_and_b32 v91, 0xffff0000, v97
    v_lshlrev_b32 v92, 16, v98
    v_and_b32 v93, 0xffff0000, v98
    v_lshlrev_b32 v94, 16, v99
    v_and_b32 v95, 0xffff0000, v99
    v_add_f32 v88, v88, v72
    v_add_f32 v89, v89, v73
    v_add_f32 v90, v90, v74
    v_add_f32 v91, v91, v75
    v_add_f32 v92, v92, v76
    v_add_f32 v93, v93, v77
    v_add_f32 v94, v94, v78
    v_add_f32 v95, v95, v79
    v_cvt_pk_bf16_f32 v96, v88, v89
    v_cvt_pk_bf16_f32 v97, v90, v91
    v_cvt_pk_bf16_f32 v98, v92, v93
    v_cvt_pk_bf16_f32 v99, v94, v95
    v_lshlrev_b32 v88, 16, v96
    v_and_b32 v89, 0xffff0000, v96
    v_lshlrev_b32 v90, 16, v97
    v_and_b32 v91, 0xffff0000, v97
    v_lshlrev_b32 v92, 16, v98
    v_and_b32 v93, 0xffff0000, v98
    v_lshlrev_b32 v94, 16, v99
    v_and_b32 v95, 0xffff0000, v99
    v_mul_f32 v96, v88, v88
    v_mul_f32 v97, v89, v89
    v_mul_f32 v98, v90, v90
    v_mul_f32 v99, v91, v91
    v_mul_f32 v100, v92, v92
    v_mul_f32 v101, v93, v93
    v_mul_f32 v102, v94, v94
    v_mul_f32 v103, v95, v95
    v_fma_f32 v96, v96, s56, v112
    v_fma_f32 v97, v97, s56, v112
    v_fma_f32 v98, v98, s56, v112
    v_fma_f32 v99, v99, s56, v112
    v_fma_f32 v100, v100, s56, v112
    v_fma_f32 v101, v101, s56, v112
    v_fma_f32 v102, v102, s56, v112
    v_fma_f32 v103, v103, s56, v112
    v_mul_f32 v96, v96, v88
    v_mul_f32 v97, v97, v89
    v_mul_f32 v98, v98, v90
    v_mul_f32 v99, v99, v91
    v_mul_f32 v100, v100, v92
    v_mul_f32 v101, v101, v93
    v_mul_f32 v102, v102, v94
    v_mul_f32 v103, v103, v95
    v_exp_f32 v96, v96
    v_exp_f32 v97, v97
    v_exp_f32 v98, v98
    v_exp_f32 v99, v99
    v_exp_f32 v100, v100
    v_exp_f32 v101, v101
    v_exp_f32 v102, v102
    v_exp_f32 v103, v103
    v_add_f32 v96, 1.0, v96
    v_add_f32 v97, 1.0, v97
    v_add_f32 v98, 1.0, v98
    v_add_f32 v99, 1.0, v99
    v_add_f32 v100, 1.0, v100
    v_add_f32 v101, 1.0, v101
    v_add_f32 v102, 1.0, v102
    v_add_f32 v103, 1.0, v103
    v_rcp_f32 v96, v96
    v_rcp_f32 v97, v97
    v_rcp_f32 v98, v98
    v_rcp_f32 v99, v99
    v_rcp_f32 v100, v100
    v_rcp_f32 v101, v101
    v_rcp_f32 v102, v102
    v_rcp_f32 v103, v103
    v_mul_f32 v88, v88, v96
    v_mul_f32 v89, v89, v97
    v_mul_f32 v90, v90, v98
    v_mul_f32 v91, v91, v99
    v_mul_f32 v92, v92, v100
    v_mul_f32 v93, v93, v101
    v_mul_f32 v94, v94, v102
    v_mul_f32 v95, v95, v103
    v_cvt_pk_bf16_f32 v108, v88, v89
    v_cvt_pk_bf16_f32 v109, v90, v91
    v_cvt_pk_bf16_f32 v110, v92, v93
    v_cvt_pk_bf16_f32 v111, v94, v95
    buffer_store_dwordx4 v[108:111], v8, s[12:15], s63 offen offset:1024 sc1
    s_add_u32 s63, s63, 229376
    v_mov_b32 v10, 1
    s_mov_b64 exec, 1
    s_waitcnt vmcnt(0)
    ds_add_rtn_u32 v10, v15, v10 offset:4
    s_waitcnt lgkmcnt(0)
    v_readfirstlane_b32 s46, v10
    s_mov_b64 exec, -1
    s_mov_b32 s67, 0
    s_nop 1
    s_cmp_lg_u32 s46, s68
    s_cbranch_scc1 L_g_g1f_80
    v_mov_b32 v10, s59
    v_add_u32 v10, 1, v10
    v_mov_b32 v11, 0
    s_mov_b64 exec, 1
    buffer_store_dword v10, v11, s[12:15], s52 offen sc1
    s_mov_b64 exec, -1
L_sf_102:
L_g_g1f_80:
    s_add_u32 s68, s68, 4
L_g_tail_79:
    s_cmp_lt_u32 s60, 64
    s_cbranch_scc1 L_g_restart_74
    s_barrier
    s_branch L_c_done_4
L_w_f2_20:
    s_load_dwordx2 s[4:5], s[0:1], 80
    s_load_dwordx2 s[6:7], s[0:1], 72
    s_and_b32 s50, s44, 3
    s_lshr_b32 s51, s44, 2
    s_waitcnt lgkmcnt(0)
    s_mov_b32 s24, s4
    s_and_b32 s25, s5, 0xffff
    s_mov_b32 s26, 0x700000
    s_mov_b32 s27, 0x00020000
    v_lshrrev_b32 v3, 4, v1
    v_and_b32 v4, 15, v1
    v_lshlrev_b32 v5, 2, v3
    v_xor_b32 v4, v4, v5
    v_mul_u32_u24 v3, 2048, v3
    v_lshl_add_u32 v3, v4, 4, v3
    s_mul_i32 s46, s51, 448
    s_mul_i32 s47, s50, 56
    s_add_u32 s46, s46, s47
    s_mul_i32 s47, s42, 896
    s_add_u32 s46, s46, s47
    s_mul_i32 s46, s46, 2048
    s_lshl_b32 s47, s43, 8
    s_add_u32 s46, s46, s47
    s_lshl_b32 s45, s51, 16
    s_mul_i32 s47, s50, 14336
    s_add_u32 s45, s45, s47
    v_bfe_u32 v4, v1, 2, 2
    v_bfe_u32 v5, v1, 4, 1
    v_lshlrev_b32 v5, 1, v5
    v_bfe_u32 v6, v1, 1, 1
    v_add_u32 v5, v5, v6
    s_lshl_b32 s47, s50, 2
    v_add_u32 v5, s47, v5
    v_lshlrev_b32 v6, 2, v4
    v_xor_b32 v5, v5, v6
    v_lshlrev_b32 v5, 4, v5
    v_lshl_add_u32 v5, v4, 8, v5
    v_bfe_u32 v6, v1, 0, 1
    v_lshl_add_u32 v5, v6, 3, v5
    v_lshrrev_b32 v6, 5, v1
    v_mul_u32_u24 v6, 1024, v6
    v_add_u32 v5, v5, v6
    s_lshl_b32 s47, s51, 16
    v_add_u32 v5, s47, v5
    s_add_u32 m0, s45, 0
    s_add_u32 s47, s46, 0x0
    buffer_load_dwordx4 v3, s[24:27], s47 offen lds
    s_add_u32 m0, s45, 1024
    s_add_u32 s47, s46, 0x2000
    buffer_load_dwordx4 v3, s[24:27], s47 offen lds
    s_add_u32 m0, s45, 2048
    s_add_u32 s47, s46, 0x4000
    buffer_load_dwordx4 v3, s[24:27], s47 offen lds
    s_add_u32 m0, s45, 3072
    s_add_u32 s47, s46, 0x6000
    buffer_load_dwordx4 v3, s[24:27], s47 offen lds
    s_add_u32 m0, s45, 4096
    s_add_u32 s47, s46, 0x8000
    buffer_load_dwordx4 v3, s[24:27], s47 offen lds
    s_add_u32 m0, s45, 5120
    s_add_u32 s47, s46, 0xa000
    buffer_load_dwordx4 v3, s[24:27], s47 offen lds
    s_add_u32 m0, s45, 6144
    s_add_u32 s47, s46, 0xc000
    buffer_load_dwordx4 v3, s[24:27], s47 offen lds
    s_add_u32 m0, s45, 7168
    s_add_u32 s47, s46, 0xe000
    buffer_load_dwordx4 v3, s[24:27], s47 offen lds
    s_add_u32 m0, s45, 8192
    s_add_u32 s47, s46, 0x10000
    buffer_load_dwordx4 v3, s[24:27], s47 offen lds
    s_add_u32 m0, s45, 9216
    s_add_u32 s47, s46, 0x12000
    buffer_load_dwordx4 v3, s[24:27], s47 offen lds
    s_add_u32 m0, s45, 10240
    s_add_u32 s47, s46, 0x14000
    buffer_load_dwordx4 v3, s[24:27], s47 offen lds
    s_add_u32 m0, s45, 11264
    s_add_u32 s47, s46, 0x16000
    buffer_load_dwordx4 v3, s[24:27], s47 offen lds
    s_add_u32 m0, s45, 12288
    s_add_u32 s47, s46, 0x18000
    buffer_load_dwordx4 v3, s[24:27], s47 offen lds
    s_add_u32 m0, s45, 13312
    s_add_u32 s47, s46, 0x1a000
    buffer_load_dwordx4 v3, s[24:27], s47 offen lds
    s_waitcnt vmcnt(0)
    s_barrier
    ds_read_b64_tr_b16 a[0:1], v5 offset:0
    ds_read_b64_tr_b16 a[2:3], v5 offset:2048
    ds_read_b64_tr_b16 a[4:5], v5 offset:4096
    ds_read_b64_tr_b16 a[6:7], v5 offset:6144
    ds_read_b64_tr_b16 a[8:9], v5 offset:8192
    ds_read_b64_tr_b16 a[10:11], v5 offset:10240
    ds_read_b64_tr_b16 a[12:13], v5 offset:12288
    ds_read_b64_tr_b16 a[14:15], v5 offset:14336
    s_waitcnt lgkmcnt(0)
    ds_read_b64_tr_b16 a[16:17], v5 offset:16384
    ds_read_b64_tr_b16 a[18:19], v5 offset:18432
    ds_read_b64_tr_b16 a[20:21], v5 offset:20480
    ds_read_b64_tr_b16 a[22:23], v5 offset:22528
    ds_read_b64_tr_b16 a[24:25], v5 offset:24576
    ds_read_b64_tr_b16 a[26:27], v5 offset:26624
    ds_read_b64_tr_b16 a[28:29], v5 offset:28672
    ds_read_b64_tr_b16 a[30:31], v5 offset:30720
    s_waitcnt lgkmcnt(0)
    ds_read_b64_tr_b16 a[32:33], v5 offset:32768
    ds_read_b64_tr_b16 a[34:35], v5 offset:34816
    ds_read_b64_tr_b16 a[36:37], v5 offset:36864
    ds_read_b64_tr_b16 a[38:39], v5 offset:38912
    ds_read_b64_tr_b16 a[40:41], v5 offset:40960
    ds_read_b64_tr_b16 a[42:43], v5 offset:43008
    ds_read_b64_tr_b16 a[44:45], v5 offset:45056
    ds_read_b64_tr_b16 a[46:47], v5 offset:47104
    s_waitcnt lgkmcnt(0)
    ds_read_b64_tr_b16 a[48:49], v5 offset:49152
    ds_read_b64_tr_b16 a[50:51], v5 offset:51200
    ds_read_b64_tr_b16 a[52:53], v5 offset:53248
    ds_read_b64_tr_b16 a[54:55], v5 offset:55296
    s_waitcnt lgkmcnt(0)
    s_barrier
    s_add_u32 m0, s45, 0
    s_add_u32 s47, s46, 0x70000
    buffer_load_dwordx4 v3, s[24:27], s47 offen lds
    s_add_u32 m0, s45, 1024
    s_add_u32 s47, s46, 0x72000
    buffer_load_dwordx4 v3, s[24:27], s47 offen lds
    s_add_u32 m0, s45, 2048
    s_add_u32 s47, s46, 0x74000
    buffer_load_dwordx4 v3, s[24:27], s47 offen lds
    s_add_u32 m0, s45, 3072
    s_add_u32 s47, s46, 0x76000
    buffer_load_dwordx4 v3, s[24:27], s47 offen lds
    s_add_u32 m0, s45, 4096
    s_add_u32 s47, s46, 0x78000
    buffer_load_dwordx4 v3, s[24:27], s47 offen lds
    s_add_u32 m0, s45, 5120
    s_add_u32 s47, s46, 0x7a000
    buffer_load_dwordx4 v3, s[24:27], s47 offen lds
    s_add_u32 m0, s45, 6144
    s_add_u32 s47, s46, 0x7c000
    buffer_load_dwordx4 v3, s[24:27], s47 offen lds
    s_add_u32 m0, s45, 7168
    s_add_u32 s47, s46, 0x7e000
    buffer_load_dwordx4 v3, s[24:27], s47 offen lds
    s_add_u32 m0, s45, 8192
    s_add_u32 s47, s46, 0x80000
    buffer_load_dwordx4 v3, s[24:27], s47 offen lds
    s_add_u32 m0, s45, 9216
    s_add_u32 s47, s46, 0x82000
    buffer_load_dwordx4 v3, s[24:27], s47 offen lds
    s_add_u32 m0, s45, 10240
    s_add_u32 s47, s46, 0x84000
    buffer_load_dwordx4 v3, s[24:27], s47 offen lds
    s_add_u32 m0, s45, 11264
    s_add_u32 s47, s46, 0x86000
    buffer_load_dwordx4 v3, s[24:27], s47 offen lds
    s_add_u32 m0, s45, 12288
    s_add_u32 s47, s46, 0x88000
    buffer_load_dwordx4 v3, s[24:27], s47 offen lds
    s_add_u32 m0, s45, 13312
    s_add_u32 s47, s46, 0x8a000
    buffer_load_dwordx4 v3, s[24:27], s47 offen lds
    s_waitcnt vmcnt(0)
    s_barrier
    ds_read_b64_tr_b16 a[56:57], v5 offset:0
    ds_read_b64_tr_b16 a[58:59], v5 offset:2048
    ds_read_b64_tr_b16 a[60:61], v5 offset:4096
    ds_read_b64_tr_b16 a[62:63], v5 offset:6144
    ds_read_b64_tr_b16 a[64:65], v5 offset:8192
    ds_read_b64_tr_b16 a[66:67], v5 offset:10240
    ds_read_b64_tr_b16 a[68:69], v5 offset:12288
    ds_read_b64_tr_b16 a[70:71], v5 offset:14336
    s_waitcnt lgkmcnt(0)
    ds_read_b64_tr_b16 a[72:73], v5 offset:16384
    ds_read_b64_tr_b16 a[74:75], v5 offset:18432
    ds_read_b64_tr_b16 a[76:77], v5 offset:20480
    ds_read_b64_tr_b16 a[78:79], v5 offset:22528
    ds_read_b64_tr_b16 a[80:81], v5 offset:24576
    ds_read_b64_tr_b16 a[82:83], v5 offset:26624
    ds_read_b64_tr_b16 a[84:85], v5 offset:28672
    ds_read_b64_tr_b16 a[86:87], v5 offset:30720
    s_waitcnt lgkmcnt(0)
    ds_read_b64_tr_b16 a[88:89], v5 offset:32768
    ds_read_b64_tr_b16 a[90:91], v5 offset:34816
    ds_read_b64_tr_b16 a[92:93], v5 offset:36864
    ds_read_b64_tr_b16 a[94:95], v5 offset:38912
    ds_read_b64_tr_b16 a[96:97], v5 offset:40960
    ds_read_b64_tr_b16 a[98:99], v5 offset:43008
    ds_read_b64_tr_b16 a[100:101], v5 offset:45056
    ds_read_b64_tr_b16 a[102:103], v5 offset:47104
    s_waitcnt lgkmcnt(0)
    ds_read_b64_tr_b16 a[104:105], v5 offset:49152
    ds_read_b64_tr_b16 a[106:107], v5 offset:51200
    ds_read_b64_tr_b16 a[108:109], v5 offset:53248
    ds_read_b64_tr_b16 a[110:111], v5 offset:55296
    s_waitcnt lgkmcnt(0)
    s_barrier
    v_lshlrev_b32 v2, 4, v1
    s_mul_i32 s64, s44, 7168
    s_add_u32 s46, s64, 0x6000000
    s_mul_i32 s47, s42, 57344
    s_add_u32 s46, s46, s47
    v_add_u32 v3, s46, v2
    s_mul_i32 s46, s51, 28672
    v_add_u32 v4, s46, v2
    s_lshl_b32 s46, s50, 12
    s_add_u32 s46, s46, 131072
    v_add_u32 v5, s46, v2
    v_min_u32 v7, 6, v1
    v_lshlrev_b32 v7, 7, v7
    s_mul_i32 s46, s42, 896
    s_add_u32 s46, s46, 0x106800
    v_add_u32 v7, s46, v7
    s_lshl_b32 s46, s42, 17
    s_lshl_b32 s47, s43, 12
    s_add_u32 s46, s46, s47
    s_lshl_b32 s47, s50, 10
    s_add_u32 s46, s46, s47
    s_add_u32 s46, s46, 0xb000000
    v_add_u32 v8, s46, v2
    v_add_u32 v9, 0x8000, v8
    v_add_u32 v64, 0x10000, v8
    v_add_u32 v65, 0x18000, v8
    s_lshl_b32 s52, s43, 9
    s_lshl_b32 s47, s42, 7
    s_add_u32 s52, s52, s47
    s_add_u32 s52, s52, 0x108800
    s_mov_b32 s60, 0
    s_mov_b32 s61, 0
    s_mov_b32 s62, 0
    s_mov_b32 s63, 0
    s_mov_b32 s67, 0
    s_mov_b32 s68, 3
    v_mov_b32 v15, 147456
    v_mov_b32 v14, 0
    ds_write_b32 v15, v14 offset:4
L_g_restart_103:
    s_cmp_lg_u32 s44, 0
    s_cbranch_scc1 L_g_nsp_104
    s_mov_b32 s70, 0
L_g_sp_110:
    s_add_u32 s54, s60, 0
    s_add_u32 s55, s54, 0
    s_mov_b32 s46, 0
    buffer_load_dword v11, v7, s[12:15], s46 offen sc1
    s_waitcnt vmcnt(0)
    v_cmp_ge_u32 vcc, s60, v11
    s_add_u32 s70, s70, 1
    s_cbranch_vccz L_g_sp_110_ok
    s_sleep 8
    s_cmp_lt_u32 s70, 524288
    s_cbranch_scc1 L_g_sp_110
    s_branch L_c_done_4
L_g_sp_110_ok:
    s_mov_b32 s46, s54
    v_cmp_ge_u32 vcc, s46, v11
    s_nop 0
    s_cbranch_vccnz L_g_le_111
    s_add_u32 s46, s46, 1
    v_cmp_ge_u32 vcc, s46, v11
    s_nop 0
    s_cbranch_vccnz L_g_le_111
    s_add_u32 s46, s46, 1
    v_cmp_ge_u32 vcc, s46, v11
    s_nop 0
    s_cbranch_vccnz L_g_le_111
    s_add_u32 s46, s46, 1
L_g_le_111:
    v_mov_b32 v11, s46
    ds_write_b32 v15, v11
L_g_nsp_104:
    s_waitcnt lgkmcnt(0)
    s_barrier
    ds_read_b32 v14, v15
    s_waitcnt lgkmcnt(0)
    v_readfirstlane_b32 s66, v14
    s_nop 3
    s_mov_b32 s69, 0
    s_cmp_gt_u32 s62, s60
    s_cbranch_scc1 L_g_nd_112
    s_cmp_ge_u32 s62, s66
    s_cbranch_scc1 L_g_nd_112
    s_add_u32 s47, s61, 4096
    s_add_u32 m0, s64, 0
    s_nop 0
    buffer_load_dwordx4 v3, s[12:15], s61 offen offset:0 sc1 lds
    buffer_load_dwordx4 v3, s[12:15], s61 offen offset:1024 sc1 lds
    buffer_load_dwordx4 v3, s[12:15], s61 offen offset:2048 sc1 lds
    buffer_load_dwordx4 v3, s[12:15], s61 offen offset:3072 sc1 lds
    s_add_u32 m0, s64, 4096
    s_nop 0
    buffer_load_dwordx4 v3, s[12:15], s47 offen offset:0 sc1 lds
    buffer_load_dwordx4 v3, s[12:15], s47 offen offset:1024 sc1 lds
    buffer_load_dwordx4 v3, s[12:15], s47 offen offset:2048 sc1 lds
    s_add_u32 s61, s61, 229376
    s_add_u32 s62, s62, 1
    s_xor_b32 s64, s64, 0x10000
    s_mov_b32 s69, 1
L_g_nd_112:
    s_cmp_eq_u32 s51, 1
    s_cbranch_scc1 L_g_g1r_105
    s_add_u32 s59, s60, 1
    s_mov_b32 s69, 0
    s_cmp_gt_u32 s62, s59
    s_cbranch_scc1 L_g_nd_113
    s_cmp_ge_u32 s62, s66
    s_cbranch_scc1 L_g_nd_113
    s_add_u32 s47, s61, 4096
    s_add_u32 m0, s64, 0
    s_nop 0
    buffer_load_dwordx4 v3, s[12:15], s61 offen offset:0 sc1 lds
    buffer_load_dwordx4 v3, s[12:15], s61 offen offset:1024 sc1 lds
    buffer_load_dwordx4 v3, s[12:15], s61 offen offset:2048 sc1 lds
    buffer_load_dwordx4 v3, s[12:15], s61 offen offset:3072 sc1 lds
    s_add_u32 m0, s64, 4096
    s_nop 0
    buffer_load_dwordx4 v3, s[12:15], s47 offen offset:0 sc1 lds
    buffer_load_dwordx4 v3, s[12:15], s47 offen offset:1024 sc1 lds
    buffer_load_dwordx4 v3, s[12:15], s47 offen offset:2048 sc1 lds
    s_add_u32 s61, s61, 229376
    s_add_u32 s62, s62, 1
    s_xor_b32 s64, s64, 0x10000
    s_mov_b32 s69, 1
L_g_nd_113:
    s_cmp_eq_u32 s69, 1
    s_cbranch_scc1 L_g_w0_114
    s_waitcnt vmcnt(0)
L_g_w0_114:
    s_waitcnt vmcnt(7)
    s_mov_b32 s65, 1
L_g_loop0_106:
    s_barrier
    s_cmp_eq_u32 s65, 0
    s_cbranch_scc1 L_g_pr_115
    ds_read_b128 v[32:35], v4 offset:0
    ds_read_b128 v[36:39], v4 offset:1024
    ds_read_b128 v[40:43], v4 offset:2048
    ds_read_b128 v[44:47], v4 offset:3072
    ds_read_b128 v[48:51], v4 offset:4096
    ds_read_b128 v[52:55], v4 offset:5120
    ds_read_b128 v[56:59], v4 offset:6144
    ds_read_b128 v[60:63], v4 offset:7168
L_g_pr_115:
    ds_read_b32 v14, v15
    s_cmp_lg_u32 s44, 0
    s_cbranch_scc1 L_g_nl_116
    s_add_u32 s54, s60, 1
    s_add_u32 s55, s54, 0
    s_mov_b32 s46, 0
    buffer_load_dword v11, v7, s[12:15], s46 offen sc1
L_g_nl_116:
    s_setprio 1
    s_waitcnt lgkmcnt(7)
    v_mfma_f32_32x32x16_bf16 v[16:31], v[32:35], a[0:3], 0
    ds_read_b128 v[32:35], v4 offset:8192
    s_waitcnt lgkmcnt(7)
    v_mfma_f32_32x32x16_bf16 v[16:31], v[36:39], a[4:7], v[16:31]
    ds_read_b128 v[36:39], v4 offset:9216
    s_waitcnt lgkmcnt(7)
    v_mfma_f32_32x32x16_bf16 v[16:31], v[40:43], a[8:11], v[16:31]
    ds_read_b128 v[40:43], v4 offset:10240
    s_waitcnt lgkmcnt(7)
    v_mfma_f32_32x32x16_bf16 v[16:31], v[44:47], a[12:15], v[16:31]
    ds_read_b128 v[44:47], v4 offset:11264
    s_waitcnt lgkmcnt(7)
    v_mfma_f32_32x32x16_bf16 v[16:31], v[48:51], a[16:19], v[16:31]
    ds_read_b128 v[48:51], v4 offset:12288
    s_waitcnt lgkmcnt(7)
    v_mfma_f32_32x32x16_bf16 v[16:31], v[52:55], a[20:23], v[16:31]
    ds_read_b128 v[52:55], v4 offset:13312
    s_waitcnt lgkmcnt(7)
    v_mfma_f32_32x32x16_bf16 v[16:31], v[56:59], a[24:27], v[16:31]
    ds_read_b128 v[56:59], v4 offset:14336
    s_waitcnt lgkmcnt(7)
    v_mfma_f32_32x32x16_bf16 v[16:31], v[60:63], a[28:31], v[16:31]
    ds_read_b128 v[60:63], v4 offset:15360
    s_waitcnt lgkmcnt(7)
    v_mfma_f32_32x32x16_bf16 v[16:31], v[32:35], a[32:35], v[16:31]
    ds_read_b128 v[32:35], v4 offset:16384
    s_waitcnt lgkmcnt(7)
    v_mfma_f32_32x32x16_bf16 v[16:31], v[36:39], a[36:39], v[16:31]
    ds_read_b128 v[36:39], v4 offset:17408
    s_waitcnt lgkmcnt(7)
    v_mfma_f32_32x32x16_bf16 v[16:31], v[40:43], a[40:43], v[16:31]
    ds_read_b128 v[40:43], v4 offset:18432
    s_waitcnt lgkmcnt(7)
    v_mfma_f32_32x32x16_bf16 v[16:31], v[44:47], a[44:47], v[16:31]
    ds_read_b128 v[44:47], v4 offset:19456
    s_waitcnt lgkmcnt(7)
    v_mfma_f32_32x32x16_bf16 v[16:31], v[48:51], a[48:51], v[16:31]
    ds_read_b128 v[48:51], v4 offset:20480
    s_waitcnt lgkmcnt(7)
    v_mfma_f32_32x32x16_bf16 v[16:31], v[52:55], a[52:55], v[16:31]
    ds_read_b128 v[52:55], v4 offset:21504
    s_waitcnt lgkmcnt(7)
    v_mfma_f32_32x32x16_bf16 v[16:31], v[56:59], a[56:59], v[16:31]
    ds_read_b128 v[56:59], v4 offset:22528
    s_waitcnt lgkmcnt(7)
    v_mfma_f32_32x32x16_bf16 v[16:31], v[60:63], a[60:63], v[16:31]
    ds_read_b128 v[60:63], v4 offset:23552
    s_waitcnt lgkmcnt(7)
    v_mfma_f32_32x32x16_bf16 v[16:31], v[32:35], a[64:67], v[16:31]
    ds_read_b128 v[32:35], v4 offset:24576
    s_waitcnt lgkmcnt(7)
    v_mfma_f32_32x32x16_bf16 v[16:31], v[36:39], a[68:71], v[16:31]
    ds_read_b128 v[36:39], v4 offset:25600
    s_waitcnt lgkmcnt(7)
    v_mfma_f32_32x32x16_bf16 v[16:31], v[40:43], a[72:75], v[16:31]
    ds_read_b128 v[40:43], v4 offset:26624
    s_waitcnt lgkmcnt(7)
    v_mfma_f32_32x32x16_bf16 v[16:31], v[44:47], a[76:79], v[16:31]
    ds_read_b128 v[44:47], v4 offset:27648
    s_waitcnt lgkmcnt(7)
    v_mfma_f32_32x32x16_bf16 v[16:31], v[48:51], a[80:83], v[16:31]
    s_waitcnt lgkmcnt(6)
    v_mfma_f32_32x32x16_bf16 v[16:31], v[52:55], a[84:87], v[16:31]
    s_waitcnt lgkmcnt(5)
    v_mfma_f32_32x32x16_bf16 v[16:31], v[56:59], a[88:91], v[16:31]
    s_waitcnt lgkmcnt(4)
    v_mfma_f32_32x32x16_bf16 v[16:31], v[60:63], a[92:95], v[16:31]
    s_waitcnt lgkmcnt(3)
    v_mfma_f32_32x32x16_bf16 v[16:31], v[32:35], a[96:99], v[16:31]
    s_waitcnt lgkmcnt(2)
    v_mfma_f32_32x32x16_bf16 v[16:31], v[36:39], a[100:103], v[16:31]
    s_waitcnt lgkmcnt(1)
    v_mfma_f32_32x32x16_bf16 v[16:31], v[40:43], a[104:107], v[16:31]
    s_waitcnt lgkmcnt(0)
    v_mfma_f32_32x32x16_bf16 v[16:31], v[44:47], a[108:111], v[16:31]
    v_xor_b32 v4, 0x10000, v4
    s_setprio 0
    s_waitcnt vmcnt(0)
    v_readfirstlane_b32 s66, v14
    s_barrier
    s_nop 6
    ds_write_b128 v5, v[16:19] offset:0
    ds_write_b128 v5, v[20:23] offset:1024
    ds_write_b128 v5, v[24:27] offset:2048
    ds_write_b128 v5, v[28:31] offset:3072
    s_cmp_lg_u32 s44, 0
    s_cbranch_scc1 L_g_ne_117
    s_mov_b32 s46, s54
    v_cmp_ge_u32 vcc, s46, v11
    s_nop 0
    s_cbranch_vccnz L_g_le_120
    s_add_u32 s46, s46, 1
    v_cmp_ge_u32 vcc, s46, v11
    s_nop 0
    s_cbranch_vccnz L_g_le_120
    s_add_u32 s46, s46, 1
    v_cmp_ge_u32 vcc, s46, v11
    s_nop 0
    s_cbranch_vccnz L_g_le_120
    s_add_u32 s46, s46, 1
L_g_le_120:
    v_mov_b32 v11, s46
    ds_write_b32 v15, v11
L_g_ne_117:
    s_add_u32 s60, s60, 1
    s_waitcnt lgkmcnt(0)
    s_mov_b32 s69, 0
    s_cmp_gt_u32 s62, s60
    s_cbranch_scc1 L_g_nd_121
    s_cmp_ge_u32 s62, s66
    s_cbranch_scc1 L_g_nd_121
    s_add_u32 s47, s61, 4096
    s_add_u32 m0, s64, 0
    s_nop 0
    buffer_load_dwordx4 v3, s[12:15], s61 offen offset:0 sc1 lds
    buffer_load_dwordx4 v3, s[12:15], s61 offen offset:1024 sc1 lds
    buffer_load_dwordx4 v3, s[12:15], s61 offen offset:2048 sc1 lds
    buffer_load_dwordx4 v3, s[12:15], s61 offen offset:3072 sc1 lds
    s_add_u32 m0, s64, 4096
    s_nop 0
    buffer_load_dwordx4 v3, s[12:15], s47 offen offset:0 sc1 lds
    buffer_load_dwordx4 v3, s[12:15], s47 offen offset:1024 sc1 lds
    buffer_load_dwordx4 v3, s[12:15], s47 offen offset:2048 sc1 lds
    s_add_u32 s61, s61, 229376
    s_add_u32 s62, s62, 1
    s_xor_b32 s64, s64, 0x10000
    s_mov_b32 s69, 1
L_g_nd_121:
    s_mov_b32 s65, s69
    s_add_u32 s59, s60, 1
    s_mov_b32 s69, 0
    s_cmp_gt_u32 s62, s59
    s_cbranch_scc1 L_g_nd_122
    s_cmp_ge_u32 s62, s66
    s_cbranch_scc1 L_g_nd_122
    s_add_u32 s47, s61, 4096
    s_add_u32 m0, s64, 0
    s_nop 0
    buffer_load_dwordx4 v3, s[12:15], s61 offen offset:0 sc1 lds
    buffer_load_dwordx4 v3, s[12:15], s61 offen offset:1024 sc1 lds
    buffer_load_dwordx4 v3, s[12:15], s61 offen offset:2048 sc1 lds
    buffer_load_dwordx4 v3, s[12:15], s61 offen offset:3072 sc1 lds
    s_add_u32 m0, s64, 4096
    s_nop 0
    buffer_load_dwordx4 v3, s[12:15], s47 offen offset:0 sc1 lds
    buffer_load_dwordx4 v3, s[12:15], s47 offen offset:1024 sc1 lds
    buffer_load_dwordx4 v3, s[12:15], s47 offen offset:2048 sc1 lds
    s_add_u32 s61, s61, 229376
    s_add_u32 s62, s62, 1
    s_xor_b32 s64, s64, 0x10000
    s_mov_b32 s69, 1
L_g_nd_122:
    s_cmp_le_u32 s66, s60
    s_cbranch_scc1 L_g_ex0_119
    s_cmp_eq_u32 s65, 0
    s_cbranch_scc1 L_g_nw_118
    s_waitcnt vmcnt(0) lgkmcnt(0)
    s_branch L_g_loop0_106
L_g_nw_118:
    ds_read_b128 v[32:35], v4 offset:0
    ds_read_b128 v[36:39], v4 offset:1024
    ds_read_b128 v[40:43], v4 offset:2048
    ds_read_b128 v[44:47], v4 offset:3072
    ds_read_b128 v[48:51], v4 offset:4096
    ds_read_b128 v[52:55], v4 offset:5120
    ds_read_b128 v[56:59], v4 offset:6144
    ds_read_b128 v[60:63], v4 offset:7168
    s_waitcnt lgkmcnt(8)
    s_branch L_g_loop0_106
L_g_ex0_119:
    s_waitcnt lgkmcnt(0)
    s_barrier
    s_branch L_g_tail_108
L_g_g1r_105:
    s_mov_b32 s65, 1
    s_branch L_g_loop1_107_e
L_g_loop1_107:
    s_mov_b32 s65, 0
L_g_loop1_107_e:
    s_barrier
    ds_read_b32 v14, v15
    s_bitcmp1_b32 s67, 1
    s_cbranch_scc0 L_g_nfl_123
    s_sub_u32 s59, s60, 2
    s_cmp_lg_u32 s44, 4
    s_cbranch_scc1 L_sf_128
    v_mov_b32 v10, s59
    v_add_u32 v10, 1, v10
    v_mov_b32 v11, 0
    s_mov_b64 exec, 1
    buffer_store_dword v10, v11, s[12:15], s52 offen sc1
    s_mov_b64 exec, -1
L_sf_128:
L_g_nfl_123:
    s_bitcmp1_b32 s67, 0
    s_cbranch_scc0 L_g_nep_124
    ds_read_b128 v[80:83], v5 offset:0
    ds_read_b128 v[84:87], v5 offset:1024
    ds_read_b128 v[88:91], v5 offset:2048
    ds_read_b128 v[92:95], v5 offset:3072
    s_nop 7
    s_waitcnt lgkmcnt(3)
    v_add_f32 v80, v80, v16
    v_add_f32 v81, v81, v17
    v_add_f32 v82, v82, v18
    v_add_f32 v83, v83, v19
    s_waitcnt lgkmcnt(2)
    v_add_f32 v84, v84, v20
    v_add_f32 v85, v85, v21
    v_add_f32 v86, v86, v22
    v_add_f32 v87, v87, v23
    s_waitcnt lgkmcnt(1)
    v_add_f32 v88, v88, v24
    v_add_f32 v89, v89, v25
    v_add_f32 v90, v90, v26
    v_add_f32 v91, v91, v27
    s_waitcnt lgkmcnt(0)
    v_add_f32 v92, v92, v28
    v_add_f32 v93, v93, v29
    v_add_f32 v94, v94, v30
    v_add_f32 v95, v95, v31
    buffer_store_dwordx4 v[80:83], v8, s[12:15], s63 offen sc1
    buffer_store_dwordx4 v[84:87], v9, s[12:15], s63 offen sc1
    buffer_store_dwordx4 v[88:91], v64, s[12:15], s63 offen sc1
    buffer_store_dwordx4 v[92:95], v65, s[12:15], s63 offen sc1
    s_add_u32 s63, s63, 524288
L_g_nep_124:
    s_waitcnt lgkmcnt(0)
    v_readfirstlane_b32 s66, v14
    s_nop 3
    s_mov_b32 s69, 0
    s_cmp_gt_u32 s62, s60
    s_cbranch_scc1 L_g_nd_129
    s_cmp_ge_u32 s62, s66
    s_cbranch_scc1 L_g_nd_129
    s_add_u32 s47, s61, 4096
    s_add_u32 m0, s64, 0
    s_nop 0
    buffer_load_dwordx4 v3, s[12:15], s61 offen offset:0 sc1 lds
    buffer_load_dwordx4 v3, s[12:15], s61 offen offset:1024 sc1 lds
    buffer_load_dwordx4 v3, s[12:15], s61 offen offset:2048 sc1 lds
    buffer_load_dwordx4 v3, s[12:15], s61 offen offset:3072 sc1 lds
    s_add_u32 m0, s64, 4096
    s_nop 0
    buffer_load_dwordx4 v3, s[12:15], s47 offen offset:0 sc1 lds
    buffer_load_dwordx4 v3, s[12:15], s47 offen offset:1024 sc1 lds
    buffer_load_dwordx4 v3, s[12:15], s47 offen offset:2048 sc1 lds
    s_add_u32 s61, s61, 229376
    s_add_u32 s62, s62, 1
    s_xor_b32 s64, s64, 0x10000
    s_mov_b32 s69, 1
L_g_nd_129:
    s_or_b32 s65, s65, s69
    s_add_u32 s59, s60, 1
    s_mov_b32 s69, 0
    s_cmp_gt_u32 s62, s59
    s_cbranch_scc1 L_g_nd_130
    s_cmp_ge_u32 s62, s66
    s_cbranch_scc1 L_g_nd_130
    s_add_u32 s47, s61, 4096
    s_add_u32 m0, s64, 0
    s_nop 0
    buffer_load_dwordx4 v3, s[12:15], s61 offen offset:0 sc1 lds
    buffer_load_dwordx4 v3, s[12:15], s61 offen offset:1024 sc1 lds
    buffer_load_dwordx4 v3, s[12:15], s61 offen offset:2048 sc1 lds
    buffer_load_dwordx4 v3, s[12:15], s61 offen offset:3072 sc1 lds
    s_add_u32 m0, s64, 4096
    s_nop 0
    buffer_load_dwordx4 v3, s[12:15], s47 offen offset:0 sc1 lds
    buffer_load_dwordx4 v3, s[12:15], s47 offen offset:1024 sc1 lds
    buffer_load_dwordx4 v3, s[12:15], s47 offen offset:2048 sc1 lds
    s_add_u32 s61, s61, 229376
    s_add_u32 s62, s62, 1
    s_xor_b32 s64, s64, 0x10000
    s_mov_b32 s69, 1
L_g_nd_130:
    s_cmp_eq_u32 s65, 0
    s_cbranch_scc1 L_g_nw1_125
    s_waitcnt vmcnt(0)
    s_barrier
    ds_read_b128 v[32:35], v4 offset:0
    ds_read_b128 v[36:39], v4 offset:1024
    ds_read_b128 v[40:43], v4 offset:2048
    ds_read_b128 v[44:47], v4 offset:3072
    ds_read_b128 v[48:51], v4 offset:4096
    ds_read_b128 v[52:55], v4 offset:5120
    ds_read_b128 v[56:59], v4 offset:6144
    ds_read_b128 v[60:63], v4 offset:7168
    s_branch L_g_jn_127
L_g_nw1_125:
    ds_read_b128 v[32:35], v4 offset:0
    ds_read_b128 v[36:39], v4 offset:1024
    ds_read_b128 v[40:43], v4 offset:2048
    ds_read_b128 v[44:47], v4 offset:3072
    ds_read_b128 v[48:51], v4 offset:4096
    ds_read_b128 v[52:55], v4 offset:5120
    ds_read_b128 v[56:59], v4 offset:6144
    ds_read_b128 v[60:63], v4 offset:7168
    s_barrier
L_g_jn_127:
    s_setprio 1
    s_waitcnt lgkmcnt(7)
    v_mfma_f32_32x32x16_bf16 v[16:31], v[32:35], a[0:3], 0
    ds_read_b128 v[32:35], v4 offset:8192
    s_waitcnt lgkmcnt(7)
    v_mfma_f32_32x32x16_bf16 v[16:31], v[36:39], a[4:7], v[16:31]
    ds_read_b128 v[36:39], v4 offset:9216
    s_waitcnt lgkmcnt(7)
    v_mfma_f32_32x32x16_bf16 v[16:31], v[40:43], a[8:11], v[16:31]
    ds_read_b128 v[40:43], v4 offset:10240
    s_waitcnt lgkmcnt(7)
    v_mfma_f32_32x32x16_bf16 v[16:31], v[44:47], a[12:15], v[16:31]
    ds_read_b128 v[44:47], v4 offset:11264
    s_waitcnt lgkmcnt(7)
    v_mfma_f32_32x32x16_bf16 v[16:31], v[48:51], a[16:19], v[16:31]
    ds_read_b128 v[48:51], v4 offset:12288
    s_waitcnt lgkmcnt(7)
    v_mfma_f32_32x32x16_bf16 v[16:31], v[52:55], a[20:23], v[16:31]
    ds_read_b128 v[52:55], v4 offset:13312
    s_waitcnt lgkmcnt(7)
    v_mfma_f32_32x32x16_bf16 v[16:31], v[56:59], a[24:27], v[16:31]
    ds_read_b128 v[56:59], v4 offset:14336
    s_waitcnt lgkmcnt(7)
    v_mfma_f32_32x32x16_bf16 v[16:31], v[60:63], a[28:31], v[16:31]
    ds_read_b128 v[60:63], v4 offset:15360
    s_waitcnt lgkmcnt(7)
    v_mfma_f32_32x32x16_bf16 v[16:31], v[32:35], a[32:35], v[16:31]
    ds_read_b128 v[32:35], v4 offset:16384
    s_waitcnt lgkmcnt(7)
    v_mfma_f32_32x32x16_bf16 v[16:31], v[36:39], a[36:39], v[16:31]
    ds_read_b128 v[36:39], v4 offset:17408
    s_waitcnt lgkmcnt(7)
    v_mfma_f32_32x32x16_bf16 v[16:31], v[40:43], a[40:43], v[16:31]
    ds_read_b128 v[40:43], v4 offset:18432
    s_waitcnt lgkmcnt(7)
    v_mfma_f32_32x32x16_bf16 v[16:31], v[44:47], a[44:47], v[16:31]
    ds_read_b128 v[44:47], v4 offset:19456
    s_waitcnt lgkmcnt(7)
    v_mfma_f32_32x32x16_bf16 v[16:31], v[48:51], a[48:51], v[16:31]
    ds_read_b128 v[48:51], v4 offset:20480
    s_waitcnt lgkmcnt(7)
    v_mfma_f32_32x32x16_bf16 v[16:31], v[52:55], a[52:55], v[16:31]
    ds_read_b128 v[52:55], v4 offset:21504
    s_waitcnt lgkmcnt(7)
    v_mfma_f32_32x32x16_bf16 v[16:31], v[56:59], a[56:59], v[16:31]
    ds_read_b128 v[56:59], v4 offset:22528
    s_waitcnt lgkmcnt(7)
    v_mfma_f32_32x32x16_bf16 v[16:31], v[60:63], a[60:63], v[16:31]
    ds_read_b128 v[60:63], v4 offset:23552
    s_waitcnt lgkmcnt(7)
    v_mfma_f32_32x32x16_bf16 v[16:31], v[32:35], a[64:67], v[16:31]
    ds_read_b128 v[32:35], v4 offset:24576
    s_waitcnt lgkmcnt(7)
    v_mfma_f32_32x32x16_bf16 v[16:31], v[36:39], a[68:71], v[16:31]
    ds_read_b128 v[36:39], v4 offset:25600
    s_waitcnt lgkmcnt(7)
    v_mfma_f32_32x32x16_bf16 v[16:31], v[40:43], a[72:75], v[16:31]
    ds_read_b128 v[40:43], v4 offset:26624
    s_waitcnt lgkmcnt(7)
    v_mfma_f32_32x32x16_bf16 v[16:31], v[44:47], a[76:79], v[16:31]
    ds_read_b128 v[44:47], v4 offset:27648
    s_waitcnt lgkmcnt(7)
    v_mfma_f32_32x32x16_bf16 v[16:31], v[48:51], a[80:83], v[16:31]
    s_waitcnt lgkmcnt(6)
    v_mfma_f32_32x32x16_bf16 v[16:31], v[52:55], a[84:87], v[16:31]
    s_waitcnt lgkmcnt(5)
    v_mfma_f32_32x32x16_bf16 v[16:31], v[56:59], a[88:91], v[16:31]
    s_waitcnt lgkmcnt(4)
    v_mfma_f32_32x32x16_bf16 v[16:31], v[60:63], a[92:95], v[16:31]
    s_waitcnt lgkmcnt(3)
    v_mfma_f32_32x32x16_bf16 v[16:31], v[32:35], a[96:99], v[16:31]
    s_waitcnt lgkmcnt(2)
    v_mfma_f32_32x32x16_bf16 v[16:31], v[36:39], a[100:103], v[16:31]
    s_waitcnt lgkmcnt(1)
    v_mfma_f32_32x32x16_bf16 v[16:31], v[40:43], a[104:107], v[16:31]
    s_waitcnt lgkmcnt(0)
    v_mfma_f32_32x32x16_bf16 v[16:31], v[44:47], a[108:111], v[16:31]
    v_xor_b32 v4, 0x10000, v4
    s_setprio 0
    s_waitcnt vmcnt(0)
    s_lshl_b32 s67, s67, 1
    s_or_b32 s67, s67, 1
    s_add_u32 s60, s60, 1
    s_cmp_gt_u32 s66, s60
    s_cbranch_scc1 L_g_loop1_107
    s_barrier
    s_sub_u32 s59, s60, 1
    ds_read_b128 v[80:83], v5 offset:0
    ds_read_b128 v[84:87], v5 offset:1024
    ds_read_b128 v[88:91], v5 offset:2048
    ds_read_b128 v[92:95], v5 offset:3072
    s_nop 7
    s_waitcnt lgkmcnt(3)
    v_add_f32 v80, v80, v16
    v_add_f32 v81, v81, v17
    v_add_f32 v82, v82, v18
    v_add_f32 v83, v83, v19
    s_waitcnt lgkmcnt(2)
    v_add_f32 v84, v84, v20
    v_add_f32 v85, v85, v21
    v_add_f32 v86, v86, v22
    v_add_f32 v87, v87, v23
    s_waitcnt lgkmcnt(1)
    v_add_f32 v88, v88, v24
    v_add_f32 v89, v89, v25
    v_add_f32 v90, v90, v26
    v_add_f32 v91, v91, v27
    s_waitcnt lgkmcnt(0)
    v_add_f32 v92, v92, v28
    v_add_f32 v93, v93, v29
    v_add_f32 v94, v94, v30
    v_add_f32 v95, v95, v31
    buffer_store_dwordx4 v[80:83], v8, s[12:15], s63 offen sc1
    buffer_store_dwordx4 v[84:87], v9, s[12:15], s63 offen sc1
    buffer_store_dwordx4 v[88:91], v64, s[12:15], s63 offen sc1
    buffer_store_dwordx4 v[92:95], v65, s[12:15], s63 offen sc1
    s_add_u32 s63, s63, 524288
    v_mov_b32 v10, 1
    s_mov_b64 exec, 1
    s_waitcnt vmcnt(0)
    ds_add_rtn_u32 v10, v15, v10 offset:4
    s_waitcnt lgkmcnt(0)
    v_readfirstlane_b32 s46, v10
    s_mov_b64 exec, -1
    s_mov_b32 s67, 0
    s_nop 1
    s_cmp_lg_u32 s46, s68
    s_cbranch_scc1 L_g_g1f_109
    v_mov_b32 v10, s59
    v_add_u32 v10, 1, v10
    v_mov_b32 v11, 0
    s_mov_b64 exec, 1
    buffer_store_dword v10, v11, s[12:15], s52 offen sc1
    s_mov_b64 exec, -1
L_sf_131:
L_g_g1f_109:
    s_add_u32 s68, s68, 4
L_g_tail_108:
    s_cmp_lt_u32 s60, 64
    s_cbranch_scc1 L_g_restart_103
    s_barrier
    s_branch L_c_done_4
L_w_wo_19:
    s_load_dwordx2 s[4:5], s[0:1], 40
    s_load_dwordx2 s[6:7], s[0:1], 72
    s_and_b32 s50, s44, 3
    s_lshr_b32 s51, s44, 2
    s_waitcnt lgkmcnt(0)
    s_mov_b32 s24, s4
    s_and_b32 s25, s5, 0xffff
    s_mov_b32 s26, 0x800000
    s_mov_b32 s27, 0x00020000
    v_lshrrev_b32 v3, 4, v1
    v_and_b32 v4, 15, v1
    v_lshlrev_b32 v5, 2, v3
    v_xor_b32 v4, v4, v5
    v_mul_u32_u24 v3, 2048, v3
    v_lshl_add_u32 v3, v4, 4, v3
    s_mul_i32 s46, s51, 512
    s_mul_i32 s47, s50, 64
    s_add_u32 s46, s46, s47
    s_mul_i32 s47, s42, 1024
    s_add_u32 s46, s46, s47
    s_mul_i32 s46, s46, 2048
    s_lshl_b32 s47, s43, 8
    s_add_u32 s46, s46, s47
    s_lshl_b32 s45, s51, 16
    s_mul_i32 s47, s50, 16384
    s_add_u32 s45, s45, s47
    v_bfe_u32 v4, v1, 2, 2
    v_bfe_u32 v5, v1, 4, 1
    v_lshlrev_b32 v5, 1, v5
    v_bfe_u32 v6, v1, 1, 1
    v_add_u32 v5, v5, v6
    s_lshl_b32 s47, s50, 2
    v_add_u32 v5, s47, v5
    v_lshlrev_b32 v6, 2, v4
    v_xor_b32 v5, v5, v6
    v_lshlrev_b32 v5, 4, v5
    v_lshl_add_u32 v5, v4, 8, v5
    v_bfe_u32 v6, v1, 0, 1
    v_lshl_add_u32 v5, v6, 3, v5
    v_lshrrev_b32 v6, 5, v1
    v_mul_u32_u24 v6, 1024, v6
    v_add_u32 v5, v5, v6
    s_lshl_b32 s47, s51, 16
    v_add_u32 v5, s47, v5
    s_add_u32 m0, s45, 0
    s_add_u32 s47, s46, 0x0
    buffer_load_dwordx4 v3, s[24:27], s47 offen lds
    s_add_u32 m0, s45, 1024
    s_add_u32 s47, s46, 0x2000
    buffer_load_dwordx4 v3, s[24:27], s47 offen lds
    s_add_u32 m0, s45, 2048
    s_add_u32 s47, s46, 0x4000
    buffer_load_dwordx4 v3, s[24:27], s47 offen lds
    s_add_u32 m0, s45, 3072
    s_add_u32 s47, s46, 0x6000
    buffer_load_dwordx4 v3, s[24:27], s47 offen lds
    s_add_u32 m0, s45, 4096
    s_add_u32 s47, s46, 0x8000
    buffer_load_dwordx4 v3, s[24:27], s47 offen lds
    s_add_u32 m0, s45, 5120
    s_add_u32 s47, s46, 0xa000
    buffer_load_dwordx4 v3, s[24:27], s47 offen lds
    s_add_u32 m0, s45, 6144
    s_add_u32 s47, s46, 0xc000
    buffer_load_dwordx4 v3, s[24:27], s47 offen lds
    s_add_u32 m0, s45, 7168
    s_add_u32 s47, s46, 0xe000
    buffer_load_dwordx4 v3, s[24:27], s47 offen lds
    s_add_u32 m0, s45, 8192
    s_add_u32 s47, s46, 0x10000
    buffer_load_dwordx4 v3, s[24:27], s47 offen lds
    s_add_u32 m0, s45, 9216
    s_add_u32 s47, s46, 0x12000
    buffer_load_dwordx4 v3, s[24:27], s47 offen lds
    s_add_u32 m0, s45, 10240
    s_add_u32 s47, s46, 0x14000
    buffer_load_dwordx4 v3, s[24:27], s47 offen lds
    s_add_u32 m0, s45, 11264
    s_add_u32 s47, s46, 0x16000
    buffer_load_dwordx4 v3, s[24:27], s47 offen lds
    s_add_u32 m0, s45, 12288
    s_add_u32 s47, s46, 0x18000
    buffer_load_dwordx4 v3, s[24:27], s47 offen lds
    s_add_u32 m0, s45, 13312
    s_add_u32 s47, s46, 0x1a000
    buffer_load_dwordx4 v3, s[24:27], s47 offen lds
    s_add_u32 m0, s45, 14336
    s_add_u32 s47, s46, 0x1c000
    buffer_load_dwordx4 v3, s[24:27], s47 offen lds
    s_add_u32 m0, s45, 15360
    s_add_u32 s47, s46, 0x1e000
    buffer_load_dwordx4 v3, s[24:27], s47 offen lds
    s_waitcnt vmcnt(0)
    s_barrier
    ds_read_b64_tr_b16 a[0:1], v5 offset:0
    ds_read_b64_tr_b16 a[2:3], v5 offset:4096
    ds_read_b64_tr_b16 a[4:5], v5 offset:2048
    ds_read_b64_tr_b16 a[6:7], v5 offset:6144
    ds_read_b64_tr_b16 a[8:9], v5 offset:8192
    ds_read_b64_tr_b16 a[10:11], v5 offset:12288
    ds_read_b64_tr_b16 a[12:13], v5 offset:10240
    ds_read_b64_tr_b16 a[14:15], v5 offset:14336
    s_waitcnt lgkmcnt(0)
    ds_read_b64_tr_b16 a[16:17], v5 offset:16384
    ds_read_b64_tr_b16 a[18:19], v5 offset:20480
    ds_read_b64_tr_b16 a[20:21], v5 offset:18432
    ds_read_b64_tr_b16 a[22:23], v5 offset:22528
    ds_read_b64_tr_b16 a[24:25], v5 offset:24576
    ds_read_b64_tr_b16 a[26:27], v5 offset:28672
    ds_read_b64_tr_b16 a[28:29], v5 offset:26624
    ds_read_b64_tr_b16 a[30:31], v5 offset:30720
    s_waitcnt lgkmcnt(0)
    ds_read_b64_tr_b16 a[32:33], v5 offset:32768
    ds_read_b64_tr_b16 a[34:35], v5 offset:36864
    ds_read_b64_tr_b16 a[36:37], v5 offset:34816
    ds_read_b64_tr_b16 a[38:39], v5 offset:38912
    ds_read_b64_tr_b16 a[40:41], v5 offset:40960
    ds_read_b64_tr_b16 a[42:43], v5 offset:45056
    ds_read_b64_tr_b16 a[44:45], v5 offset:43008
    ds_read_b64_tr_b16 a[46:47], v5 offset:47104
    s_waitcnt lgkmcnt(0)
    ds_read_b64_tr_b16 a[48:49], v5 offset:49152
    ds_read_b64_tr_b16 a[50:51], v5 offset:53248
    ds_read_b64_tr_b16 a[52:53], v5 offset:51200
    ds_read_b64_tr_b16 a[54:55], v5 offset:55296
    ds_read_b64_tr_b16 a[56:57], v5 offset:57344
    ds_read_b64_tr_b16 a[58:59], v5 offset:61440
    ds_read_b64_tr_b16 a[60:61], v5 offset:59392
    ds_read_b64_tr_b16 a[62:63], v5 offset:63488
    s_waitcnt lgkmcnt(0)
    s_waitcnt lgkmcnt(0)
    s_barrier
    s_add_u32 m0, s45, 0
    s_add_u32 s47, s46, 0x80000
    buffer_load_dwordx4 v3, s[24:27], s47 offen lds
    s_add_u32 m0, s45, 1024
    s_add_u32 s47, s46, 0x82000
    buffer_load_dwordx4 v3, s[24:27], s47 offen lds
    s_add_u32 m0, s45, 2048
    s_add_u32 s47, s46, 0x84000
    buffer_load_dwordx4 v3, s[24:27], s47 offen lds
    s_add_u32 m0, s45, 3072
    s_add_u32 s47, s46, 0x86000
    buffer_load_dwordx4 v3, s[24:27], s47 offen lds
    s_add_u32 m0, s45, 4096
    s_add_u32 s47, s46, 0x88000
    buffer_load_dwordx4 v3, s[24:27], s47 offen lds
    s_add_u32 m0, s45, 5120
    s_add_u32 s47, s46, 0x8a000
    buffer_load_dwordx4 v3, s[24:27], s47 offen lds
    s_add_u32 m0, s45, 6144
    s_add_u32 s47, s46, 0x8c000
    buffer_load_dwordx4 v3, s[24:27], s47 offen lds
    s_add_u32 m0, s45, 7168
    s_add_u32 s47, s46, 0x8e000
    buffer_load_dwordx4 v3, s[24:27], s47 offen lds
    s_add_u32 m0, s45, 8192
    s_add_u32 s47, s46, 0x90000
    buffer_load_dwordx4 v3, s[24:27], s47 offen lds
    s_add_u32 m0, s45, 9216
    s_add_u32 s47, s46, 0x92000
    buffer_load_dwordx4 v3, s[24:27], s47 offen lds
    s_add_u32 m0, s45, 10240
    s_add_u32 s47, s46, 0x94000
    buffer_load_dwordx4 v3, s[24:27], s47 offen lds
    s_add_u32 m0, s45, 11264
    s_add_u32 s47, s46, 0x96000
    buffer_load_dwordx4 v3, s[24:27], s47 offen lds
    s_add_u32 m0, s45, 12288
    s_add_u32 s47, s46, 0x98000
    buffer_load_dwordx4 v3, s[24:27], s47 offen lds
    s_add_u32 m0, s45, 13312
    s_add_u32 s47, s46, 0x9a000
    buffer_load_dwordx4 v3, s[24:27], s47 offen lds
    s_add_u32 m0, s45, 14336
    s_add_u32 s47, s46, 0x9c000
    buffer_load_dwordx4 v3, s[24:27], s47 offen lds
    s_add_u32 m0, s45, 15360
    s_add_u32 s47, s46, 0x9e000
    buffer_load_dwordx4 v3, s[24:27], s47 offen lds
    s_waitcnt vmcnt(0)
    s_barrier
    ds_read_b64_tr_b16 a[64:65], v5 offset:0
    ds_read_b64_tr_b16 a[66:67], v5 offset:4096
    ds_read_b64_tr_b16 a[68:69], v5 offset:2048
    ds_read_b64_tr_b16 a[70:71], v5 offset:6144
    ds_read_b64_tr_b16 a[72:73], v5 offset:8192
    ds_read_b64_tr_b16 a[74:75], v5 offset:12288
    ds_read_b64_tr_b16 a[76:77], v5 offset:10240
    ds_read_b64_tr_b16 a[78:79], v5 offset:14336
    s_waitcnt lgkmcnt(0)
    ds_read_b64_tr_b16 a[80:81], v5 offset:16384
    ds_read_b64_tr_b16 a[82:83], v5 offset:20480
    ds_read_b64_tr_b16 a[84:85], v5 offset:18432
    ds_read_b64_tr_b16 a[86:87], v5 offset:22528
    ds_read_b64_tr_b16 a[88:89], v5 offset:24576
    ds_read_b64_tr_b16 a[90:91], v5 offset:28672
    ds_read_b64_tr_b16 a[92:93], v5 offset:26624
    ds_read_b64_tr_b16 a[94:95], v5 offset:30720
    s_waitcnt lgkmcnt(0)
    ds_read_b64_tr_b16 a[96:97], v5 offset:32768
    ds_read_b64_tr_b16 a[98:99], v5 offset:36864
    ds_read_b64_tr_b16 a[100:101], v5 offset:34816
    ds_read_b64_tr_b16 a[102:103], v5 offset:38912
    ds_read_b64_tr_b16 a[104:105], v5 offset:40960
    ds_read_b64_tr_b16 a[106:107], v5 offset:45056
    ds_read_b64_tr_b16 a[108:109], v5 offset:43008
    ds_read_b64_tr_b16 a[110:111], v5 offset:47104
    s_waitcnt lgkmcnt(0)
    ds_read_b64_tr_b16 a[112:113], v5 offset:49152
    ds_read_b64_tr_b16 a[114:115], v5 offset:53248
    ds_read_b64_tr_b16 a[116:117], v5 offset:51200
    ds_read_b64_tr_b16 a[118:119], v5 offset:55296
    ds_read_b64_tr_b16 a[120:121], v5 offset:57344
    ds_read_b64_tr_b16 a[122:123], v5 offset:61440
    ds_read_b64_tr_b16 a[124:125], v5 offset:59392
    ds_read_b64_tr_b16 a[126:127], v5 offset:63488
    s_waitcnt lgkmcnt(0)
    s_waitcnt lgkmcnt(0)
    s_barrier
    v_lshlrev_b32 v2, 4, v1
    s_mul_i32 s64, s44, 8192
    s_add_u32 s46, s64, 0x5000000
    s_mul_i32 s47, s42, 65536
    s_add_u32 s46, s46, s47
    v_add_u32 v3, s46, v2
    s_mul_i32 s46, s51, 32768
    v_add_u32 v4, s46, v2
    s_lshl_b32 s46, s50, 12
    s_add_u32 s46, s46, 131072
    v_add_u32 v5, s46, v2
    v_and_b32 v7, 7, v1
    v_lshlrev_b32 v7, 8, v7
    s_lshl_b32 s46, s42, 11
    s_add_u32 s46, s46, 0x104000
    v_add_u32 v7, s46, v7
    s_lshl_b32 s46, s42, 17
    s_lshl_b32 s47, s43, 12
    s_add_u32 s46, s46, s47
    s_lshl_b32 s47, s50, 10
    s_add_u32 s46, s46, s47
    s_add_u32 s46, s46, 0x9000000
    v_add_u32 v8, s46, v2
    v_add_u32 v9, 0x8000, v8
    v_add_u32 v64, 0x10000, v8
    v_add_u32 v65, 0x18000, v8
    s_lshl_b32 s52, s43, 9
    s_lshl_b32 s47, s42, 7
    s_add_u32 s52, s52, s47
    s_add_u32 s52, s52, 0x107800
    s_mov_b32 s60, 0
    s_mov_b32 s61, 0
    s_mov_b32 s62, 0
    s_mov_b32 s63, 0
    s_mov_b32 s67, 0
    s_mov_b32 s68, 3
    v_mov_b32 v15, 147456
    v_mov_b32 v14, 0
    ds_write_b32 v15, v14 offset:4
L_g_restart_132:
    s_cmp_lg_u32 s44, 0
    s_cbranch_scc1 L_g_nsp_133
    s_mov_b32 s70, 0
L_g_sp_139:
    s_add_u32 s54, s60, 0
    s_add_u32 s55, s54, 0
    s_and_b32 s46, s55, 1
    s_lshl_b32 s46, s46, 7
    buffer_load_dword v11, v7, s[12:15], s46 offen sc1
    s_add_u32 s55, s54, 1
    s_and_b32 s46, s55, 1
    s_lshl_b32 s46, s46, 7
    buffer_load_dword v12, v7, s[12:15], s46 offen sc1
    s_add_u32 s55, s54, 2
    s_and_b32 s46, s55, 1
    s_lshl_b32 s46, s46, 7
    buffer_load_dword v13, v7, s[12:15], s46 offen sc1
    s_waitcnt vmcnt(0)
    v_cmp_ge_u32 vcc, s60, v11
    s_add_u32 s70, s70, 1
    s_cbranch_vccz L_g_sp_139_ok
    s_sleep 8
    s_cmp_lt_u32 s70, 524288
    s_cbranch_scc1 L_g_sp_139
    s_branch L_c_done_4
L_g_sp_139_ok:
    s_mov_b32 s46, s54
    v_cmp_ge_u32 vcc, s46, v11
    s_nop 0
    s_cbranch_vccnz L_g_le_140
    s_add_u32 s46, s46, 1
    v_cmp_ge_u32 vcc, s46, v12
    s_nop 0
    s_cbranch_vccnz L_g_le_140
    s_add_u32 s46, s46, 1
    v_cmp_ge_u32 vcc, s46, v13
    s_nop 0
    s_cbranch_vccnz L_g_le_140
    s_add_u32 s46, s46, 1
L_g_le_140:
    v_mov_b32 v11, s46
    ds_write_b32 v15, v11
L_g_nsp_133:
    s_waitcnt lgkmcnt(0)
    s_barrier
    ds_read_b32 v14, v15
    s_waitcnt lgkmcnt(0)
    v_readfirstlane_b32 s66, v14
    s_nop 3
    s_mov_b32 s69, 0
    s_cmp_gt_u32 s62, s60
    s_cbranch_scc1 L_g_nd_141
    s_cmp_ge_u32 s62, s66
    s_cbranch_scc1 L_g_nd_141
    s_add_u32 s47, s61, 4096
    s_add_u32 m0, s64, 0
    s_nop 0
    buffer_load_dwordx4 v3, s[12:15], s61 offen offset:0 sc1 lds
    buffer_load_dwordx4 v3, s[12:15], s61 offen offset:1024 sc1 lds
    buffer_load_dwordx4 v3, s[12:15], s61 offen offset:2048 sc1 lds
    buffer_load_dwordx4 v3, s[12:15], s61 offen offset:3072 sc1 lds
    s_add_u32 m0, s64, 4096
    s_nop 0
    buffer_load_dwordx4 v3, s[12:15], s47 offen offset:0 sc1 lds
    buffer_load_dwordx4 v3, s[12:15], s47 offen offset:1024 sc1 lds
    buffer_load_dwordx4 v3, s[12:15], s47 offen offset:2048 sc1 lds
    buffer_load_dwordx4 v3, s[12:15], s47 offen offset:3072 sc1 lds
    s_add_u32 s61, s61, 262144
    s_add_u32 s62, s62, 1
    s_xor_b32 s64, s64, 0x10000
    s_mov_b32 s69, 1
L_g_nd_141:
    s_cmp_eq_u32 s51, 1
    s_cbranch_scc1 L_g_g1r_134
    s_add_u32 s59, s60, 1
    s_mov_b32 s69, 0
    s_cmp_gt_u32 s62, s59
    s_cbranch_scc1 L_g_nd_142
    s_cmp_ge_u32 s62, s66
    s_cbranch_scc1 L_g_nd_142
    s_add_u32 s47, s61, 4096
    s_add_u32 m0, s64, 0
    s_nop 0
    buffer_load_dwordx4 v3, s[12:15], s61 offen offset:0 sc1 lds
    buffer_load_dwordx4 v3, s[12:15], s61 offen offset:1024 sc1 lds
    buffer_load_dwordx4 v3, s[12:15], s61 offen offset:2048 sc1 lds
    buffer_load_dwordx4 v3, s[12:15], s61 offen offset:3072 sc1 lds
    s_add_u32 m0, s64, 4096
    s_nop 0
    buffer_load_dwordx4 v3, s[12:15], s47 offen offset:0 sc1 lds
    buffer_load_dwordx4 v3, s[12:15], s47 offen offset:1024 sc1 lds
    buffer_load_dwordx4 v3, s[12:15], s47 offen offset:2048 sc1 lds
    buffer_load_dwordx4 v3, s[12:15], s47 offen offset:3072 sc1 lds
    s_add_u32 s61, s61, 262144
    s_add_u32 s62, s62, 1
    s_xor_b32 s64, s64, 0x10000
    s_mov_b32 s69, 1
L_g_nd_142:
    s_cmp_eq_u32 s69, 1
    s_cbranch_scc1 L_g_w0_143
    s_waitcnt vmcnt(0)
L_g_w0_143:
    s_waitcnt vmcnt(8)
    s_mov_b32 s65, 1
L_g_loop0_135:
    s_barrier
    s_cmp_eq_u32 s65, 0
    s_cbranch_scc1 L_g_pr_144
    ds_read_b128 v[32:35], v4 offset:0
    ds_read_b128 v[36:39], v4 offset:1024
    ds_read_b128 v[40:43], v4 offset:2048
    ds_read_b128 v[44:47], v4 offset:3072
    ds_read_b128 v[48:51], v4 offset:4096
    ds_read_b128 v[52:55], v4 offset:5120
    ds_read_b128 v[56:59], v4 offset:6144
    ds_read_b128 v[60:63], v4 offset:7168
L_g_pr_144:
    ds_read_b32 v14, v15
    s_cmp_lg_u32 s44, 0
    s_cbranch_scc1 L_g_nl_145
    s_add_u32 s54, s60, 1
    s_add_u32 s55, s54, 0
    s_and_b32 s46, s55, 1
    s_lshl_b32 s46, s46, 7
    buffer_load_dword v11, v7, s[12:15], s46 offen sc1
    s_add_u32 s55, s54, 1
    s_and_b32 s46, s55, 1
    s_lshl_b32 s46, s46, 7
    buffer_load_dword v12, v7, s[12:15], s46 offen sc1
    s_add_u32 s55, s54, 2
    s_and_b32 s46, s55, 1
    s_lshl_b32 s46, s46, 7
    buffer_load_dword v13, v7, s[12:15], s46 offen sc1
L_g_nl_145:
    s_setprio 1
    s_waitcnt lgkmcnt(7)
    v_mfma_f32_32x32x16_bf16 v[16:31], v[32:35], a[0:3], 0
    ds_read_b128 v[32:35], v4 offset:8192
    s_waitcnt lgkmcnt(7)
    v_mfma_f32_32x32x16_bf16 v[16:31], v[36:39], a[4:7], v[16:31]
    ds_read_b128 v[36:39], v4 offset:9216
    s_waitcnt lgkmcnt(7)
    v_mfma_f32_32x32x16_bf16 v[16:31], v[40:43], a[8:11], v[16:31]
    ds_read_b128 v[40:43], v4 offset:10240
    s_waitcnt lgkmcnt(7)
    v_mfma_f32_32x32x16_bf16 v[16:31], v[44:47], a[12:15], v[16:31]
    ds_read_b128 v[44:47], v4 offset:11264
    s_waitcnt lgkmcnt(7)
    v_mfma_f32_32x32x16_bf16 v[16:31], v[48:51], a[16:19], v[16:31]
    ds_read_b128 v[48:51], v4 offset:12288
    s_waitcnt lgkmcnt(7)
    v_mfma_f32_32x32x16_bf16 v[16:31], v[52:55], a[20:23], v[16:31]
    ds_read_b128 v[52:55], v4 offset:13312
    s_waitcnt lgkmcnt(7)
    v_mfma_f32_32x32x16_bf16 v[16:31], v[56:59], a[24:27], v[16:31]
    ds_read_b128 v[56:59], v4 offset:14336
    s_waitcnt lgkmcnt(7)
    v_mfma_f32_32x32x16_bf16 v[16:31], v[60:63], a[28:31], v[16:31]
    ds_read_b128 v[60:63], v4 offset:15360
    s_waitcnt lgkmcnt(7)
    v_mfma_f32_32x32x16_bf16 v[16:31], v[32:35], a[32:35], v[16:31]
    ds_read_b128 v[32:35], v4 offset:16384
    s_waitcnt lgkmcnt(7)
    v_mfma_f32_32x32x16_bf16 v[16:31], v[36:39], a[36:39], v[16:31]
    ds_read_b128 v[36:39], v4 offset:17408
    s_waitcnt lgkmcnt(7)
    v_mfma_f32_32x32x16_bf16 v[16:31], v[40:43], a[40:43], v[16:31]
    ds_read_b128 v[40:43], v4 offset:18432
    s_waitcnt lgkmcnt(7)
    v_mfma_f32_32x32x16_bf16 v[16:31], v[44:47], a[44:47], v[16:31]
    ds_read_b128 v[44:47], v4 offset:19456
    s_waitcnt lgkmcnt(7)
    v_mfma_f32_32x32x16_bf16 v[16:31], v[48:51], a[48:51], v[16:31]
    ds_read_b128 v[48:51], v4 offset:20480
    s_waitcnt lgkmcnt(7)
    v_mfma_f32_32x32x16_bf16 v[16:31], v[52:55], a[52:55], v[16:31]
    ds_read_b128 v[52:55], v4 offset:21504
    s_waitcnt lgkmcnt(7)
    v_mfma_f32_32x32x16_bf16 v[16:31], v[56:59], a[56:59], v[16:31]
    ds_read_b128 v[56:59], v4 offset:22528
    s_waitcnt lgkmcnt(7)
    v_mfma_f32_32x32x16_bf16 v[16:31], v[60:63], a[60:63], v[16:31]
    ds_read_b128 v[60:63], v4 offset:23552
    s_waitcnt lgkmcnt(7)
    v_mfma_f32_32x32x16_bf16 v[16:31], v[32:35], a[64:67], v[16:31]
    ds_read_b128 v[32:35], v4 offset:24576
    s_waitcnt lgkmcnt(7)
    v_mfma_f32_32x32x16_bf16 v[16:31], v[36:39], a[68:71], v[16:31]
    ds_read_b128 v[36:39], v4 offset:25600
    s_waitcnt lgkmcnt(7)
    v_mfma_f32_32x32x16_bf16 v[16:31], v[40:43], a[72:75], v[16:31]
    ds_read_b128 v[40:43], v4 offset:26624
    s_waitcnt lgkmcnt(7)
    v_mfma_f32_32x32x16_bf16 v[16:31], v[44:47], a[76:79], v[16:31]
    ds_read_b128 v[44:47], v4 offset:27648
    s_waitcnt lgkmcnt(7)
    v_mfma_f32_32x32x16_bf16 v[16:31], v[48:51], a[80:83], v[16:31]
    ds_read_b128 v[48:51], v4 offset:28672
    s_waitcnt lgkmcnt(7)
    v_mfma_f32_32x32x16_bf16 v[16:31], v[52:55], a[84:87], v[16:31]
    ds_read_b128 v[52:55], v4 offset:29696
    s_waitcnt lgkmcnt(7)
    v_mfma_f32_32x32x16_bf16 v[16:31], v[56:59], a[88:91], v[16:31]
    ds_read_b128 v[56:59], v4 offset:30720
    s_waitcnt lgkmcnt(7)
    v_mfma_f32_32x32x16_bf16 v[16:31], v[60:63], a[92:95], v[16:31]
    ds_read_b128 v[60:63], v4 offset:31744
    s_waitcnt lgkmcnt(7)
    v_mfma_f32_32x32x16_bf16 v[16:31], v[32:35], a[96:99], v[16:31]
    s_waitcnt lgkmcnt(6)
    v_mfma_f32_32x32x16_bf16 v[16:31], v[36:39], a[100:103], v[16:31]
    s_waitcnt lgkmcnt(5)
    v_mfma_f32_32x32x16_bf16 v[16:31], v[40:43], a[104:107], v[16:31]
    s_waitcnt lgkmcnt(4)
    v_mfma_f32_32x32x16_bf16 v[16:31], v[44:47], a[108:111], v[16:31]
    s_waitcnt lgkmcnt(3)
    v_mfma_f32_32x32x16_bf16 v[16:31], v[48:51], a[112:115], v[16:31]
    s_waitcnt lgkmcnt(2)
    v_mfma_f32_32x32x16_bf16 v[16:31], v[52:55], a[116:119], v[16:31]
    s_waitcnt lgkmcnt(1)
    v_mfma_f32_32x32x16_bf16 v[16:31], v[56:59], a[120:123], v[16:31]
    s_waitcnt lgkmcnt(0)
    v_mfma_f32_32x32x16_bf16 v[16:31], v[60:63], a[124:127], v[16:31]
    v_xor_b32 v4, 0x10000, v4
    s_setprio 0
    s_waitcnt vmcnt(0)
    v_readfirstlane_b32 s66, v14
    s_barrier
    s_nop 6
    ds_write_b128 v5, v[16:19] offset:0
    ds_write_b128 v5, v[20:23] offset:1024
    ds_write_b128 v5, v[24:27] offset:2048
    ds_write_b128 v5, v[28:31] offset:3072
    s_cmp_lg_u32 s44, 0
    s_cbranch_scc1 L_g_ne_146
    s_mov_b32 s46, s54
    v_cmp_ge_u32 vcc, s46, v11
    s_nop 0
    s_cbranch_vccnz L_g_le_149
    s_add_u32 s46, s46, 1
    v_cmp_ge_u32 vcc, s46, v12
    s_nop 0
    s_cbranch_vccnz L_g_le_149
    s_add_u32 s46, s46, 1
    v_cmp_ge_u32 vcc, s46, v13
    s_nop 0
    s_cbranch_vccnz L_g_le_149
    s_add_u32 s46, s46, 1
L_g_le_149:
    v_mov_b32 v11, s46
    ds_write_b32 v15, v11
L_g_ne_146:
    s_add_u32 s60, s60, 1
    s_waitcnt lgkmcnt(0)
    s_mov_b32 s69, 0
    s_cmp_gt_u32 s62, s60
    s_cbranch_scc1 L_g_nd_150
    s_cmp_ge_u32 s62, s66
    s_cbranch_scc1 L_g_nd_150
    s_add_u32 s47, s61, 4096
    s_add_u32 m0, s64, 0
    s_nop 0
    buffer_load_dwordx4 v3, s[12:15], s61 offen offset:0 sc1 lds
    buffer_load_dwordx4 v3, s[12:15], s61 offen offset:1024 sc1 lds
    buffer_load_dwordx4 v3, s[12:15], s61 offen offset:2048 sc1 lds
    buffer_load_dwordx4 v3, s[12:15], s61 offen offset:3072 sc1 lds
    s_add_u32 m0, s64, 4096
    s_nop 0
    buffer_load_dwordx4 v3, s[12:15], s47 offen offset:0 sc1 lds
    buffer_load_dwordx4 v3, s[12:15], s47 offen offset:1024 sc1 lds
    buffer_load_dwordx4 v3, s[12:15], s47 offen offset:2048 sc1 lds
    buffer_load_dwordx4 v3, s[12:15], s47 offen offset:3072 sc1 lds
    s_add_u32 s61, s61, 262144
    s_add_u32 s62, s62, 1
    s_xor_b32 s64, s64, 0x10000
    s_mov_b32 s69, 1
L_g_nd_150:
    s_mov_b32 s65, s69
    s_add_u32 s59, s60, 1
    s_mov_b32 s69, 0
    s_cmp_gt_u32 s62, s59
    s_cbranch_scc1 L_g_nd_151
    s_cmp_ge_u32 s62, s66
    s_cbranch_scc1 L_g_nd_151
    s_add_u32 s47, s61, 4096
    s_add_u32 m0, s64, 0
    s_nop 0
    buffer_load_dwordx4 v3, s[12:15], s61 offen offset:0 sc1 lds
    buffer_load_dwordx4 v3, s[12:15], s61 offen offset:1024 sc1 lds
    buffer_load_dwordx4 v3, s[12:15], s61 offen offset:2048 sc1 lds
    buffer_load_dwordx4 v3, s[12:15], s61 offen offset:3072 sc1 lds
    s_add_u32 m0, s64, 4096
    s_nop 0
    buffer_load_dwordx4 v3, s[12:15], s47 offen offset:0 sc1 lds
    buffer_load_dwordx4 v3, s[12:15], s47 offen offset:1024 sc1 lds
    buffer_load_dwordx4 v3, s[12:15], s47 offen offset:2048 sc1 lds
    buffer_load_dwordx4 v3, s[12:15], s47 offen offset:3072 sc1 lds
    s_add_u32 s61, s61, 262144
    s_add_u32 s62, s62, 1
    s_xor_b32 s64, s64, 0x10000
    s_mov_b32 s69, 1
L_g_nd_151:
    s_cmp_le_u32 s66, s60
    s_cbranch_scc1 L_g_ex0_148
    s_cmp_eq_u32 s65, 0
    s_cbranch_scc1 L_g_nw_147
    s_waitcnt vmcnt(0) lgkmcnt(0)
    s_branch L_g_loop0_135
L_g_nw_147:
    ds_read_b128 v[32:35], v4 offset:0
    ds_read_b128 v[36:39], v4 offset:1024
    ds_read_b128 v[40:43], v4 offset:2048
    ds_read_b128 v[44:47], v4 offset:3072
    ds_read_b128 v[48:51], v4 offset:4096
    ds_read_b128 v[52:55], v4 offset:5120
    ds_read_b128 v[56:59], v4 offset:6144
    ds_read_b128 v[60:63], v4 offset:7168
    s_waitcnt lgkmcnt(8)
    s_branch L_g_loop0_135
L_g_ex0_148:
    s_waitcnt lgkmcnt(0)
    s_barrier
    s_branch L_g_tail_137
L_g_g1r_134:
    s_mov_b32 s65, 1
    s_branch L_g_loop1_136_e
L_g_loop1_136:
    s_mov_b32 s65, 0
L_g_loop1_136_e:
    s_barrier
    ds_read_b32 v14, v15
    s_bitcmp1_b32 s67, 1
    s_cbranch_scc0 L_g_nfl_152
    s_sub_u32 s59, s60, 2
    s_cmp_lg_u32 s44, 4
    s_cbranch_scc1 L_sf_157
    v_mov_b32 v10, s59
    v_add_u32 v10, 1, v10
    v_mov_b32 v11, 0
    s_mov_b64 exec, 1
    buffer_store_dword v10, v11, s[12:15], s52 offen sc1
    s_mov_b64 exec, -1
L_sf_157:
L_g_nfl_152:
    s_bitcmp1_b32 s67, 0
    s_cbranch_scc0 L_g_nep_153
    ds_read_b128 v[80:83], v5 offset:0
    ds_read_b128 v[84:87], v5 offset:1024
    ds_read_b128 v[88:91], v5 offset:2048
    ds_read_b128 v[92:95], v5 offset:3072
    s_nop 7
    s_waitcnt lgkmcnt(3)
    v_add_f32 v80, v80, v16
    v_add_f32 v81, v81, v17
    v_add_f32 v82, v82, v18
    v_add_f32 v83, v83, v19
    s_waitcnt lgkmcnt(2)
    v_add_f32 v84, v84, v20
    v_add_f32 v85, v85, v21
    v_add_f32 v86, v86, v22
    v_add_f32 v87, v87, v23
    s_waitcnt lgkmcnt(1)
    v_add_f32 v88, v88, v24
    v_add_f32 v89, v89, v25
    v_add_f32 v90, v90, v26
    v_add_f32 v91, v91, v27
    s_waitcnt lgkmcnt(0)
    v_add_f32 v92, v92, v28
    v_add_f32 v93, v93, v29
    v_add_f32 v94, v94, v30
    v_add_f32 v95, v95, v31
    buffer_store_dwordx4 v[80:83], v8, s[12:15], s63 offen sc1
    buffer_store_dwordx4 v[84:87], v9, s[12:15], s63 offen sc1
    buffer_store_dwordx4 v[88:91], v64, s[12:15], s63 offen sc1
    buffer_store_dwordx4 v[92:95], v65, s[12:15], s63 offen sc1
    s_add_u32 s63, s63, 524288
L_g_nep_153:
    s_waitcnt lgkmcnt(0)
    v_readfirstlane_b32 s66, v14
    s_nop 3
    s_mov_b32 s69, 0
    s_cmp_gt_u32 s62, s60
    s_cbranch_scc1 L_g_nd_158
    s_cmp_ge_u32 s62, s66
    s_cbranch_scc1 L_g_nd_158
    s_add_u32 s47, s61, 4096
    s_add_u32 m0, s64, 0
    s_nop 0
    buffer_load_dwordx4 v3, s[12:15], s61 offen offset:0 sc1 lds
    buffer_load_dwordx4 v3, s[12:15], s61 offen offset:1024 sc1 lds
    buffer_load_dwordx4 v3, s[12:15], s61 offen offset:2048 sc1 lds
    buffer_load_dwordx4 v3, s[12:15], s61 offen offset:3072 sc1 lds
    s_add_u32 m0, s64, 4096
    s_nop 0
    buffer_load_dwordx4 v3, s[12:15], s47 offen offset:0 sc1 lds
    buffer_load_dwordx4 v3, s[12:15], s47 offen offset:1024 sc1 lds
    buffer_load_dwordx4 v3, s[12:15], s47 offen offset:2048 sc1 lds
    buffer_load_dwordx4 v3, s[12:15], s47 offen offset:3072 sc1 lds
    s_add_u32 s61, s61, 262144
    s_add_u32 s62, s62, 1
    s_xor_b32 s64, s64, 0x10000
    s_mov_b32 s69, 1
L_g_nd_158:
    s_or_b32 s65, s65, s69
    s_add_u32 s59, s60, 1
    s_mov_b32 s69, 0
    s_cmp_gt_u32 s62, s59
    s_cbranch_scc1 L_g_nd_159
    s_cmp_ge_u32 s62, s66
    s_cbranch_scc1 L_g_nd_159
    s_add_u32 s47, s61, 4096
    s_add_u32 m0, s64, 0
    s_nop 0
    buffer_load_dwordx4 v3, s[12:15], s61 offen offset:0 sc1 lds
    buffer_load_dwordx4 v3, s[12:15], s61 offen offset:1024 sc1 lds
    buffer_load_dwordx4 v3, s[12:15], s61 offen offset:2048 sc1 lds
    buffer_load_dwordx4 v3, s[12:15], s61 offen offset:3072 sc1 lds
    s_add_u32 m0, s64, 4096
    s_nop 0
    buffer_load_dwordx4 v3, s[12:15], s47 offen offset:0 sc1 lds
    buffer_load_dwordx4 v3, s[12:15], s47 offen offset:1024 sc1 lds
    buffer_load_dwordx4 v3, s[12:15], s47 offen offset:2048 sc1 lds
    buffer_load_dwordx4 v3, s[12:15], s47 offen offset:3072 sc1 lds
    s_add_u32 s61, s61, 262144
    s_add_u32 s62, s62, 1
    s_xor_b32 s64, s64, 0x10000
    s_mov_b32 s69, 1
L_g_nd_159:
    s_cmp_eq_u32 s65, 0
    s_cbranch_scc1 L_g_nw1_154
    s_waitcnt vmcnt(0)
    s_barrier
    ds_read_b128 v[32:35], v4 offset:0
    ds_read_b128 v[36:39], v4 offset:1024
    ds_read_b128 v[40:43], v4 offset:2048
    ds_read_b128 v[44:47], v4 offset:3072
    ds_read_b128 v[48:51], v4 offset:4096
    ds_read_b128 v[52:55], v4 offset:5120
    ds_read_b128 v[56:59], v4 offset:6144
    ds_read_b128 v[60:63], v4 offset:7168
    s_branch L_g_jn_156
L_g_nw1_154:
    ds_read_b128 v[32:35], v4 offset:0
    ds_read_b128 v[36:39], v4 offset:1024
    ds_read_b128 v[40:43], v4 offset:2048
    ds_read_b128 v[44:47], v4 offset:3072
    ds_read_b128 v[48:51], v4 offset:4096
    ds_read_b128 v[52:55], v4 offset:5120
    ds_read_b128 v[56:59], v4 offset:6144
    ds_read_b128 v[60:63], v4 offset:7168
    s_barrier
L_g_jn_156:
    s_setprio 1
    s_waitcnt lgkmcnt(7)
    v_mfma_f32_32x32x16_bf16 v[16:31], v[32:35], a[0:3], 0
    ds_read_b128 v[32:35], v4 offset:8192
    s_waitcnt lgkmcnt(7)
    v_mfma_f32_32x32x16_bf16 v[16:31], v[36:39], a[4:7], v[16:31]
    ds_read_b128 v[36:39], v4 offset:9216
    s_waitcnt lgkmcnt(7)
    v_mfma_f32_32x32x16_bf16 v[16:31], v[40:43], a[8:11], v[16:31]
    ds_read_b128 v[40:43], v4 offset:10240
    s_waitcnt lgkmcnt(7)
    v_mfma_f32_32x32x16_bf16 v[16:31], v[44:47], a[12:15], v[16:31]
    ds_read_b128 v[44:47], v4 offset:11264
    s_waitcnt lgkmcnt(7)
    v_mfma_f32_32x32x16_bf16 v[16:31], v[48:51], a[16:19], v[16:31]
    ds_read_b128 v[48:51], v4 offset:12288
    s_waitcnt lgkmcnt(7)
    v_mfma_f32_32x32x16_bf16 v[16:31], v[52:55], a[20:23], v[16:31]
    ds_read_b128 v[52:55], v4 offset:13312
    s_waitcnt lgkmcnt(7)
    v_mfma_f32_32x32x16_bf16 v[16:31], v[56:59], a[24:27], v[16:31]
    ds_read_b128 v[56:59], v4 offset:14336
    s_waitcnt lgkmcnt(7)
    v_mfma_f32_32x32x16_bf16 v[16:31], v[60:63], a[28:31], v[16:31]
    ds_read_b128 v[60:63], v4 offset:15360
    s_waitcnt lgkmcnt(7)
    v_mfma_f32_32x32x16_bf16 v[16:31], v[32:35], a[32:35], v[16:31]
    ds_read_b128 v[32:35], v4 offset:16384
    s_waitcnt lgkmcnt(7)
    v_mfma_f32_32x32x16_bf16 v[16:31], v[36:39], a[36:39], v[16:31]
    ds_read_b128 v[36:39], v4 offset:17408
    s_waitcnt lgkmcnt(7)
    v_mfma_f32_32x32x16_bf16 v[16:31], v[40:43], a[40:43], v[16:31]
    ds_read_b128 v[40:43], v4 offset:18432
    s_waitcnt lgkmcnt(7)
    v_mfma_f32_32x32x16_bf16 v[16:31], v[44:47], a[44:47], v[16:31]
    ds_read_b128 v[44:47], v4 offset:19456
    s_waitcnt lgkmcnt(7)
    v_mfma_f32_32x32x16_bf16 v[16:31], v[48:51], a[48:51], v[16:31]
    ds_read_b128 v[48:51], v4 offset:20480
    s_waitcnt lgkmcnt(7)
    v_mfma_f32_32x32x16_bf16 v[16:31], v[52:55], a[52:55], v[16:31]
    ds_read_b128 v[52:55], v4 offset:21504
    s_waitcnt lgkmcnt(7)
    v_mfma_f32_32x32x16_bf16 v[16:31], v[56:59], a[56:59], v[16:31]
    ds_read_b128 v[56:59], v4 offset:22528
    s_waitcnt lgkmcnt(7)
    v_mfma_f32_32x32x16_bf16 v[16:31], v[60:63], a[60:63], v[16:31]
    ds_read_b128 v[60:63], v4 offset:23552
    s_waitcnt lgkmcnt(7)
    v_mfma_f32_32x32x16_bf16 v[16:31], v[32:35], a[64:67], v[16:31]
    ds_read_b128 v[32:35], v4 offset:24576
    s_waitcnt lgkmcnt(7)
    v_mfma_f32_32x32x16_bf16 v[16:31], v[36:39], a[68:71], v[16:31]
    ds_read_b128 v[36:39], v4 offset:25600
    s_waitcnt lgkmcnt(7)
    v_mfma_f32_32x32x16_bf16 v[16:31], v[40:43], a[72:75], v[16:31]
    ds_read_b128 v[40:43], v4 offset:26624
    s_waitcnt lgkmcnt(7)
    v_mfma_f32_32x32x16_bf16 v[16:31], v[44:47], a[76:79], v[16:31]
    ds_read_b128 v[44:47], v4 offset:27648
    s_waitcnt lgkmcnt(7)
    v_mfma_f32_32x32x16_bf16 v[16:31], v[48:51], a[80:83], v[16:31]
    ds_read_b128 v[48:51], v4 offset:28672
    s_waitcnt lgkmcnt(7)
    v_mfma_f32_32x32x16_bf16 v[16:31], v[52:55], a[84:87], v[16:31]
    ds_read_b128 v[52:55], v4 offset:29696
    s_waitcnt lgkmcnt(7)
    v_mfma_f32_32x32x16_bf16 v[16:31], v[56:59], a[88:91], v[16:31]
    ds_read_b128 v[56:59], v4 offset:30720
    s_waitcnt lgkmcnt(7)
    v_mfma_f32_32x32x16_bf16 v[16:31], v[60:63], a[92:95], v[16:31]
    ds_read_b128 v[60:63], v4 offset:31744
    s_waitcnt lgkmcnt(7)
    v_mfma_f32_32x32x16_bf16 v[16:31], v[32:35], a[96:99], v[16:31]
    s_waitcnt lgkmcnt(6)
    v_mfma_f32_32x32x16_bf16 v[16:31], v[36:39], a[100:103], v[16:31]
    s_waitcnt lgkmcnt(5)
    v_mfma_f32_32x32x16_bf16 v[16:31], v[40:43], a[104:107], v[16:31]
    s_waitcnt lgkmcnt(4)
    v_mfma_f32_32x32x16_bf16 v[16:31], v[44:47], a[108:111], v[16:31]
    s_waitcnt lgkmcnt(3)
    v_mfma_f32_32x32x16_bf16 v[16:31], v[48:51], a[112:115], v[16:31]
    s_waitcnt lgkmcnt(2)
    v_mfma_f32_32x32x16_bf16 v[16:31], v[52:55], a[116:119], v[16:31]
    s_waitcnt lgkmcnt(1)
    v_mfma_f32_32x32x16_bf16 v[16:31], v[56:59], a[120:123], v[16:31]
    s_waitcnt lgkmcnt(0)
    v_mfma_f32_32x32x16_bf16 v[16:31], v[60:63], a[124:127], v[16:31]
    v_xor_b32 v4, 0x10000, v4
    s_setprio 0
    s_waitcnt vmcnt(0)
    s_lshl_b32 s67, s67, 1
    s_or_b32 s67, s67, 1
    s_add_u32 s60, s60, 1
    s_cmp_gt_u32 s66, s60
    s_cbranch_scc1 L_g_loop1_136
    s_barrier
    s_sub_u32 s59, s60, 1
    ds_read_b128 v[80:83], v5 offset:0
    ds_read_b128 v[84:87], v5 offset:1024
    ds_read_b128 v[88:91], v5 offset:2048
    ds_read_b128 v[92:95], v5 offset:3072
    s_nop 7
    s_waitcnt lgkmcnt(3)
    v_add_f32 v80, v80, v16
    v_add_f32 v81, v81, v17
    v_add_f32 v82, v82, v18
    v_add_f32 v83, v83, v19
    s_waitcnt lgkmcnt(2)
    v_add_f32 v84, v84, v20
    v_add_f32 v85, v85, v21
    v_add_f32 v86, v86, v22
    v_add_f32 v87, v87, v23
    s_waitcnt lgkmcnt(1)
    v_add_f32 v88, v88, v24
    v_add_f32 v89, v89, v25
    v_add_f32 v90, v90, v26
    v_add_f32 v91, v91, v27
    s_waitcnt lgkmcnt(0)
    v_add_f32 v92, v92, v28
    v_add_f32 v93, v93, v29
    v_add_f32 v94, v94, v30
    v_add_f32 v95, v95, v31
    buffer_store_dwordx4 v[80:83], v8, s[12:15], s63 offen sc1
    buffer_store_dwordx4 v[84:87], v9, s[12:15], s63 offen sc1
    buffer_store_dwordx4 v[88:91], v64, s[12:15], s63 offen sc1
    buffer_store_dwordx4 v[92:95], v65, s[12:15], s63 offen sc1
    s_add_u32 s63, s63, 524288
    v_mov_b32 v10, 1
    s_mov_b64 exec, 1
    s_waitcnt vmcnt(0)
    ds_add_rtn_u32 v10, v15, v10 offset:4
    s_waitcnt lgkmcnt(0)
    v_readfirstlane_b32 s46, v10
    s_mov_b64 exec, -1
    s_mov_b32 s67, 0
    s_nop 1
    s_cmp_lg_u32 s46, s68
    s_cbranch_scc1 L_g_g1f_138
    v_mov_b32 v10, s59
    v_add_u32 v10, 1, v10
    v_mov_b32 v11, 0
    s_mov_b64 exec, 1
    buffer_store_dword v10, v11, s[12:15], s52 offen sc1
    s_mov_b64 exec, -1
L_sf_160:
L_g_g1f_138:
    s_add_u32 s68, s68, 4
L_g_tail_137:
    s_cmp_lt_u32 s60, 64
    s_cbranch_scc1 L_g_restart_132
    s_barrier
    s_branch L_c_done_4
L_c_chain_16:
    v_mov_b32 v4, 0
    v_mov_b32 v5, 0
    v_mov_b32 v6, 0
    v_mov_b32 v7, 0
    v_mov_b32 v8, 0
    v_mov_b32 v9, 0
    v_mov_b32 v10, 0
    v_mov_b32 v11, 0
    v_mov_b32 v12, 0
    v_mov_b32 v13, 0
    v_mov_b32 v14, 0
    v_mov_b32 v15, 0
    v_lshlrev_b32 v2, 4, v1
    v_and_b32 v3, 8, v1
    v_cmp_eq_u32 vcc, 0, v3
    v_mov_b32 v3, 0xeeeeeeee
    v_mov_b32 v4, 0x44444444
    v_cndmask_b32 v3, v3, v4, vcc
    v_and_b32 v100, 15, v1
    v_lshrrev_b32 v101, 4, v1
    v_and_b32 v102, 1, v101
    v_lshrrev_b32 v103, 1, v101
    v_lshlrev_b32 v104, 2, v102
    v_lshl_add_u32 v104, v103, 1, v104
    v_and_b32 v105, 1, v1
    v_add_u32 v104, v104, v105
    v_and_b32 v106, 7, v1
    v_bfe_u32 v107, v1, 3, 1
    s_lshr_b32 s42, s41, 2
    s_and_b32 s43, s41, 3
    s_lshl_b32 s49, s40, 2
    s_add_u32 s49, s49, s42
    s_lshl_b32 s45, s44, 14
    v_lshlrev_b32 v20, 3, v101
    v_bfe_u32 v21, v1, 2, 2
    v_add_u32 v20, v20, v21
    v_lshlrev_b32 v20, 5, v20
    v_and_b32 v21, 3, v1
    v_lshl_add_u32 v20, v21, 3, v20
    v_add_u32 v20, s45, v20
    v_lshrrev_b32 v22, 1, v1
    v_lshlrev_b32 v23, 4, v105
    v_lshl_add_u32 v24, v22, 13, v23
    v_lshl_add_u32 v25, v22, 11, v23
    s_cmp_ge_u32 s44, 4
    s_cbranch_scc1 L_v_init_161
    s_lshr_b32 s50, s44, 1
    s_and_b32 s51, s44, 1
    s_lshl_b32 s46, s50, 3
    s_add_u32 s46, s46, 16
    s_load_dwordx2 s[6:7], s[0:1], s46
    s_lshl_b32 s46, s49, 8
    s_lshl_b32 s48, s43, 6
    s_add_u32 s46, s46, s48
    s_lshl_b32 s48, s51, 5
    s_add_u32 s46, s46, s48
    s_waitcnt lgkmcnt(0)
    s_mov_b32 s24, s6
    s_and_b32 s25, s7, 0xffff
    s_mov_b32 s26, 0x800000
    s_mov_b32 s27, 0x00020000
    s_lshl_b32 s52, s40, 16
    s_lshl_b32 s53, s42, 12
    s_add_u32 s52, s52, s53
    s_lshl_b32 s53, s43, 10
    s_add_u32 s52, s52, s53
    s_lshl_b32 s53, s51, 9
    s_add_u32 s52, s52, s53
    s_lshl_b32 s53, s50, 7
    s_add_u32 s52, s52, s53
    s_add_u32 s52, s52, 0x7080000
    v_lshlrev_b32 v4, 8, v107
    v_lshl_add_u32 v4, v104, 4, v4
    v_lshrrev_b32 v5, 1, v106
    v_lshl_add_u32 v4, v5, 2, v4
    v_add_u32 v4, s52, v4
    v_mov_b32 v13, -1
    s_mov_b32 s53, 0
    buffer_store_dword v13, v4, s[12:15], s53 offen sc1
    s_mov_b32 s53, 16384
    buffer_store_dword v13, v4, s[12:15], s53 offen sc1
    s_mov_b32 s53, 32768
    buffer_store_dword v13, v4, s[12:15], s53 offen sc1
    s_mov_b32 s53, 49152
    buffer_store_dword v13, v4, s[12:15], s53 offen sc1
    s_xor_b32 s52, s50, 1
    s_lshl_b32 s52, s52, 10
    s_lshl_b32 s53, s51, 8
    s_add_u32 s52, s52, s53
    s_add_u32 s52, s52, 27648
    v_lshrrev_b32 v5, 1, v106
    v_lshlrev_b32 v5, 2, v5
    v_lshl_add_u32 v5, v104, 4, v5
    v_lshl_add_u32 v5, v107, 7, v5
    v_add_u32 v5, s52, v5
    s_lshl_b32 s67, s49, 12
    s_lshl_b32 s53, s43, 10
    s_add_u32 s67, s67, s53
    s_add_u32 s67, s67, 0x1000000
    v_mov_b32 v32, -1
    v_mov_b32 v33, -1
    v_mov_b32 v34, -1
    v_mov_b32 v35, -1
    s_lshl_b32 s53, s44, 17
    s_add_u32 s53, s53, s67
    buffer_store_dwordx4 v[32:35], v2, s[12:15], s53 offen sc1
    s_add_u32 s53, s53, 524288
    buffer_store_dwordx4 v[32:35], v2, s[12:15], s53 offen sc1
    s_add_u32 s53, s53, 524288
    buffer_store_dwordx4 v[32:35], v2, s[12:15], s53 offen sc1
    s_add_u32 s53, s53, 524288
    buffer_store_dwordx4 v[32:35], v2, s[12:15], s53 offen sc1
    s_add_u32 s53, s53, 524288
    buffer_store_dwordx4 v[32:35], v2, s[12:15], s53 offen sc1
    s_add_u32 s53, s53, 524288
    buffer_store_dwordx4 v[32:35], v2, s[12:15], s53 offen sc1
    s_add_u32 s53, s53, 524288
    buffer_store_dwordx4 v[32:35], v2, s[12:15], s53 offen sc1
    s_add_u32 s53, s53, 524288
    buffer_store_dwordx4 v[32:35], v2, s[12:15], s53 offen sc1
    s_add_u32 s53, s53, 524288
    buffer_store_dwordx4 v[32:35], v2, s[12:15], s53 offen sc1
    s_add_u32 s53, s53, 524288
    buffer_store_dwordx4 v[32:35], v2, s[12:15], s53 offen sc1
    s_add_u32 s53, s53, 524288
    buffer_store_dwordx4 v[32:35], v2, s[12:15], s53 offen sc1
    s_add_u32 s53, s53, 524288
    buffer_store_dwordx4 v[32:35], v2, s[12:15], s53 offen sc1
    s_add_u32 s53, s53, 524288
    buffer_store_dwordx4 v[32:35], v2, s[12:15], s53 offen sc1
    s_add_u32 s53, s53, 524288
    buffer_store_dwordx4 v[32:35], v2, s[12:15], s53 offen sc1
    s_add_u32 s53, s53, 524288
    buffer_store_dwordx4 v[32:35], v2, s[12:15], s53 offen sc1
    s_add_u32 s53, s53, 524288
    buffer_store_dwordx4 v[32:35], v2, s[12:15], s53 offen sc1
    s_add_u32 s53, s53, 524288
    s_lshl_b32 s52, s40, 11
    s_lshl_b32 s53, s44, 7
    s_add_u32 s52, s52, s53
    s_add_u32 s52, s52, 0x10aa00
    v_lshlrev_b32 v14, 9, v105
    v_add_u32 v14, s52, v14
    s_mov_b32 s69, 0
    s_lshl_b32 s52, s40, 2
    s_add_u32 s52, s52, s44
    s_mul_i32 s52, s52, 24576
    s_add_u32 s52, s52, 0x2002000
    v_add_u32 v6, s52, v2
    s_lshl_b32 s52, s40, 16
    s_lshl_b32 s53, s44, 12
    s_add_u32 s52, s52, s53
    s_add_u32 s52, s52, 0x7080000
    v_add_u32 v7, s52, v2
    s_lshl_b32 s52, s44, 10
    s_add_u32 s52, s52, 16384
    v_lshlrev_b32 v8, 8, v101
    v_lshl_add_u32 v8, v106, 4, v8
    v_lshl_add_u32 v8, v107, 3, v8
    v_add_u32 v8, s52, v8
    s_lshl_b32 s52, s44, 8
    s_add_u32 s52, s52, 20480
    v_xor_b32 v9, 1, v103
    v_lshlrev_b32 v9, 7, v9
    v_lshl_add_u32 v9, v106, 4, v9
    v_lshl_add_u32 v9, v102, 3, v9
    v_lshl_add_u32 v9, v107, 2, v9
    v_add_u32 v9, s52, v9
    v_cmp_gt_u32 vcc, 32, v1
    v_mov_b32 v28, 0
    v_mov_b32 v29, 0xff800000
    v_cndmask_b32 v28, v28, v29, vcc
    v_mov_b32 v29, v28
    v_mov_b32 v30, v28
    v_mov_b32 v31, v28
    s_mov_b32 s66, 0x3e0293ee
    s_add_u32 m0, s45, 0
    s_add_u32 s48, s46, 0x0
    buffer_load_dwordx4 v24, s[24:27], s48 offen lds
    s_add_u32 m0, s45, 1024
    s_add_u32 s48, s46, 0x40000
    buffer_load_dwordx4 v24, s[24:27], s48 offen lds
    s_add_u32 m0, s45, 2048
    s_add_u32 s48, s46, 0x80000
    buffer_load_dwordx4 v24, s[24:27], s48 offen lds
    s_add_u32 m0, s45, 3072
    s_add_u32 s48, s46, 0xc0000
    buffer_load_dwordx4 v24, s[24:27], s48 offen lds
    s_add_u32 m0, s45, 4096
    s_add_u32 s48, s46, 0x100000
    buffer_load_dwordx4 v24, s[24:27], s48 offen lds
    s_add_u32 m0, s45, 5120
    s_add_u32 s48, s46, 0x140000
    buffer_load_dwordx4 v24, s[24:27], s48 offen lds
    s_add_u32 m0, s45, 6144
    s_add_u32 s48, s46, 0x180000
    buffer_load_dwordx4 v24, s[24:27], s48 offen lds
    s_add_u32 m0, s45, 7168
    s_add_u32 s48, s46, 0x1c0000
    buffer_load_dwordx4 v24, s[24:27], s48 offen lds
    s_add_u32 m0, s45, 8192
    s_add_u32 s48, s46, 0x200000
    buffer_load_dwordx4 v24, s[24:27], s48 offen lds
    s_add_u32 m0, s45, 9216
    s_add_u32 s48, s46, 0x240000
    buffer_load_dwordx4 v24, s[24:27], s48 offen lds
    s_add_u32 m0, s45, 10240
    s_add_u32 s48, s46, 0x280000
    buffer_load_dwordx4 v24, s[24:27], s48 offen lds
    s_add_u32 m0, s45, 11264
    s_add_u32 s48, s46, 0x2c0000
    buffer_load_dwordx4 v24, s[24:27], s48 offen lds
    s_add_u32 m0, s45, 12288
    s_add_u32 s48, s46, 0x300000
    buffer_load_dwordx4 v24, s[24:27], s48 offen lds
    s_add_u32 m0, s45, 13312
    s_add_u32 s48, s46, 0x340000
    buffer_load_dwordx4 v24, s[24:27], s48 offen lds
    s_add_u32 m0, s45, 14336
    s_add_u32 s48, s46, 0x380000
    buffer_load_dwordx4 v24, s[24:27], s48 offen lds
    s_add_u32 m0, s45, 15360
    s_add_u32 s48, s46, 0x3c0000
    buffer_load_dwordx4 v24, s[24:27], s48 offen lds
    s_waitcnt vmcnt(0)
    ds_read_b64_tr_b16 a[0:1], v20 offset:0
    ds_read_b64_tr_b16 a[2:3], v20 offset:128
    ds_read_b64_tr_b16 a[4:5], v20 offset:1024
    ds_read_b64_tr_b16 a[6:7], v20 offset:1152
    ds_read_b64_tr_b16 a[8:9], v20 offset:2048
    ds_read_b64_tr_b16 a[10:11], v20 offset:2176
    ds_read_b64_tr_b16 a[12:13], v20 offset:3072
    ds_read_b64_tr_b16 a[14:15], v20 offset:3200
    s_waitcnt lgkmcnt(0)
    ds_read_b64_tr_b16 a[16:17], v20 offset:4096
    ds_read_b64_tr_b16 a[18:19], v20 offset:4224
    ds_read_b64_tr_b16 a[20:21], v20 offset:5120
    ds_read_b64_tr_b16 a[22:23], v20 offset:5248
    ds_read_b64_tr_b16 a[24:25], v20 offset:6144
    ds_read_b64_tr_b16 a[26:27], v20 offset:6272
    ds_read_b64_tr_b16 a[28:29], v20 offset:7168
    ds_read_b64_tr_b16 a[30:31], v20 offset:7296
    s_waitcnt lgkmcnt(0)
    ds_read_b64_tr_b16 a[32:33], v20 offset:8192
    ds_read_b64_tr_b16 a[34:35], v20 offset:8320
    ds_read_b64_tr_b16 a[36:37], v20 offset:9216
    ds_read_b64_tr_b16 a[38:39], v20 offset:9344
    ds_read_b64_tr_b16 a[40:41], v20 offset:10240
    ds_read_b64_tr_b16 a[42:43], v20 offset:10368
    ds_read_b64_tr_b16 a[44:45], v20 offset:11264
    ds_read_b64_tr_b16 a[46:47], v20 offset:11392
    s_waitcnt lgkmcnt(0)
    ds_read_b64_tr_b16 a[48:49], v20 offset:12288
    ds_read_b64_tr_b16 a[50:51], v20 offset:12416
    ds_read_b64_tr_b16 a[52:53], v20 offset:13312
    ds_read_b64_tr_b16 a[54:55], v20 offset:13440
    ds_read_b64_tr_b16 a[56:57], v20 offset:14336
    ds_read_b64_tr_b16 a[58:59], v20 offset:14464
    ds_read_b64_tr_b16 a[60:61], v20 offset:15360
    ds_read_b64_tr_b16 a[62:63], v20 offset:15488
    s_waitcnt lgkmcnt(0)
    s_add_u32 m0, s45, 0
    s_add_u32 s48, s46, 0x400000
    buffer_load_dwordx4 v24, s[24:27], s48 offen lds
    s_add_u32 m0, s45, 1024
    s_add_u32 s48, s46, 0x440000
    buffer_load_dwordx4 v24, s[24:27], s48 offen lds
    s_add_u32 m0, s45, 2048
    s_add_u32 s48, s46, 0x480000
    buffer_load_dwordx4 v24, s[24:27], s48 offen lds
    s_add_u32 m0, s45, 3072
    s_add_u32 s48, s46, 0x4c0000
    buffer_load_dwordx4 v24, s[24:27], s48 offen lds
    s_add_u32 m0, s45, 4096
    s_add_u32 s48, s46, 0x500000
    buffer_load_dwordx4 v24, s[24:27], s48 offen lds
    s_add_u32 m0, s45, 5120
    s_add_u32 s48, s46, 0x540000
    buffer_load_dwordx4 v24, s[24:27], s48 offen lds
    s_add_u32 m0, s45, 6144
    s_add_u32 s48, s46, 0x580000
    buffer_load_dwordx4 v24, s[24:27], s48 offen lds
    s_add_u32 m0, s45, 7168
    s_add_u32 s48, s46, 0x5c0000
    buffer_load_dwordx4 v24, s[24:27], s48 offen lds
    s_add_u32 m0, s45, 8192
    s_add_u32 s48, s46, 0x600000
    buffer_load_dwordx4 v24, s[24:27], s48 offen lds
    s_add_u32 m0, s45, 9216
    s_add_u32 s48, s46, 0x640000
    buffer_load_dwordx4 v24, s[24:27], s48 offen lds
    s_add_u32 m0, s45, 10240
    s_add_u32 s48, s46, 0x680000
    buffer_load_dwordx4 v24, s[24:27], s48 offen lds
    s_add_u32 m0, s45, 11264
    s_add_u32 s48, s46, 0x6c0000
    buffer_load_dwordx4 v24, s[24:27], s48 offen lds
    s_add_u32 m0, s45, 12288
    s_add_u32 s48, s46, 0x700000
    buffer_load_dwordx4 v24, s[24:27], s48 offen lds
    s_add_u32 m0, s45, 13312
    s_add_u32 s48, s46, 0x740000
    buffer_load_dwordx4 v24, s[24:27], s48 offen lds
    s_add_u32 m0, s45, 14336
    s_add_u32 s48, s46, 0x780000
    buffer_load_dwordx4 v24, s[24:27], s48 offen lds
    s_add_u32 m0, s45, 15360
    s_add_u32 s48, s46, 0x7c0000
    buffer_load_dwordx4 v24, s[24:27], s48 offen lds
    s_waitcnt vmcnt(0)
    ds_read_b64_tr_b16 a[64:65], v20 offset:0
    ds_read_b64_tr_b16 a[66:67], v20 offset:128
    ds_read_b64_tr_b16 a[68:69], v20 offset:1024
    ds_read_b64_tr_b16 a[70:71], v20 offset:1152
    ds_read_b64_tr_b16 a[72:73], v20 offset:2048
    ds_read_b64_tr_b16 a[74:75], v20 offset:2176
    ds_read_b64_tr_b16 a[76:77], v20 offset:3072
    ds_read_b64_tr_b16 a[78:79], v20 offset:3200
    s_waitcnt lgkmcnt(0)
    ds_read_b64_tr_b16 a[80:81], v20 offset:4096
    ds_read_b64_tr_b16 a[82:83], v20 offset:4224
    ds_read_b64_tr_b16 a[84:85], v20 offset:5120
    ds_read_b64_tr_b16 a[86:87], v20 offset:5248
    ds_read_b64_tr_b16 a[88:89], v20 offset:6144
    ds_read_b64_tr_b16 a[90:91], v20 offset:6272
    ds_read_b64_tr_b16 a[92:93], v20 offset:7168
    ds_read_b64_tr_b16 a[94:95], v20 offset:7296
    s_waitcnt lgkmcnt(0)
    ds_read_b64_tr_b16 a[96:97], v20 offset:8192
    ds_read_b64_tr_b16 a[98:99], v20 offset:8320
    ds_read_b64_tr_b16 a[100:101], v20 offset:9216
    ds_read_b64_tr_b16 a[102:103], v20 offset:9344
    ds_read_b64_tr_b16 a[104:105], v20 offset:10240
    ds_read_b64_tr_b16 a[106:107], v20 offset:10368
    ds_read_b64_tr_b16 a[108:109], v20 offset:11264
    ds_read_b64_tr_b16 a[110:111], v20 offset:11392
    s_waitcnt lgkmcnt(0)
    ds_read_b64_tr_b16 a[112:113], v20 offset:12288
    ds_read_b64_tr_b16 a[114:115], v20 offset:12416
    ds_read_b64_tr_b16 a[116:117], v20 offset:13312
    ds_read_b64_tr_b16 a[118:119], v20 offset:13440
    ds_read_b64_tr_b16 a[120:121], v20 offset:14336
    ds_read_b64_tr_b16 a[122:123], v20 offset:14464
    ds_read_b64_tr_b16 a[124:125], v20 offset:15360
    ds_read_b64_tr_b16 a[126:127], v20 offset:15488
    s_waitcnt lgkmcnt(0)
    s_mov_b32 s63, 0
    s_mov_b32 s68, 1
    s_cmp_gt_u32 s69, s68
    s_cbranch_scc1 L_kv_ok_164
    s_mov_b32 s70, 0
L_kv_lp_163:
    buffer_load_dword v10, v14, s[12:15], 0 offen sc1
    s_waitcnt vmcnt(0)
    v_readlane_b32 s69, v10, 0
    v_readlane_b32 s45, v10, 1
    s_add_u32 s70, s70, 1
    s_nop 2
    s_min_u32 s69, s69, s45
    s_cmp_gt_u32 s69, s68
    s_cbranch_scc1 L_kv_ok_164
    s_sleep 4
    s_cmp_lt_u32 s70, 524288
    s_cbranch_scc1 L_kv_lp_163
    s_branch L_c_done_4
L_kv_ok_164:
    s_waitcnt vmcnt(0)
    s_barrier
    s_barrier
    s_setprio 1
    s_branch L_c_join_162
L_v_init_161:
    s_sub_u32 s54, s44, 4
    s_lshr_b32 s51, s54, 1
    s_and_b32 s50, s54, 1
    s_load_dwordx4 s[4:7], s[0:1], 32
    s_load_dwordx2 s[8:9], s[0:1], 8
    s_waitcnt lgkmcnt(0)
    s_mov_b32 s24, s4
    s_and_b32 s25, s5, 0xffff
    s_mov_b32 s26, 0x800000
    s_mov_b32 s27, 0x00020000
    s_mov_b32 s28, s6
    s_and_b32 s29, s7, 0xffff
    s_mov_b32 s30, 0x800000
    s_mov_b32 s31, 0x00020000
    s_mov_b32 s32, s8
    s_and_b32 s33, s9, 0xffff
    s_mov_b32 s34, 0x4000
    s_mov_b32 s35, 0x00020000
    s_lshl_b32 s52, s40, 15
    s_lshl_b32 s53, s42, 11
    s_add_u32 s52, s52, s53
    s_lshl_b32 s53, s43, 9
    s_add_u32 s52, s52, s53
    s_lshl_b32 s53, s51, 8
    s_add_u32 s52, s52, s53
    s_add_u32 s52, s52, 0x7100000
    v_bfe_u32 v4, v1, 1, 1
    v_lshlrev_b32 v4, 7, v4
    v_lshl_add_u32 v4, v104, 4, v4
    v_and_b32 v5, 12, v100
    v_add_u32 v4, v4, v5
    v_add_u32 v4, s52, v4
    v_mov_b32 v26, -1
    s_mov_b32 s53, 0
    buffer_store_dword v26, v4, s[12:15], s53 offen sc1
    s_mov_b32 s53, 8192
    buffer_store_dword v26, v4, s[12:15], s53 offen sc1
    s_mov_b32 s53, 16384
    buffer_store_dword v26, v4, s[12:15], s53 offen sc1
    s_mov_b32 s53, 24576
    buffer_store_dword v26, v4, s[12:15], s53 offen sc1
    s_lshl_b32 s52, s51, 5
    s_add_u32 s52, s52, 28160
    v_and_b32 v5, 14, v100
    v_lshlrev_b32 v5, 1, v5
    v_lshl_add_u32 v5, v104, 6, v5
    v_add_u32 v5, s52, v5
    s_lshl_b32 s52, s41, 14
    s_lshl_b32 s53, s54, 12
    s_add_u32 s52, s52, s53
    s_add_u32 s52, s52, 0x7800000
    v_lshlrev_b32 v6, 7, v101
    v_lshl_add_u32 v6, v106, 4, v6
    v_lshl_add_u32 v7, v107, 11, v6
    v_add_u32 v7, s52, v7
    s_lshl_b32 s53, s40, 9
    s_add_u32 s52, s52, s53
    v_add_u32 v6, s52, v6
    v_and_b32 v30, 31, v1
    v_lshlrev_b32 v30, 4, v30
    v_lshl_add_u32 v30, v103, 18, v30
    v_add_u32 v30, s52, v30
    v_mov_b32 v32, -1
    v_mov_b32 v33, -1
    v_mov_b32 v34, -1
    v_mov_b32 v35, -1
    s_mov_b32 s53, 0
    buffer_store_dwordx4 v[32:35], v30, s[12:15], s53 offen sc1
    s_mov_b32 s53, 524288
    buffer_store_dwordx4 v[32:35], v30, s[12:15], s53 offen sc1
    s_mov_b32 s53, 1048576
    buffer_store_dwordx4 v[32:35], v30, s[12:15], s53 offen sc1
    s_mov_b32 s53, 1572864
    buffer_store_dwordx4 v[32:35], v30, s[12:15], s53 offen sc1
    s_mov_b32 s53, 2097152
    buffer_store_dwordx4 v[32:35], v30, s[12:15], s53 offen sc1
    s_mov_b32 s53, 2621440
    buffer_store_dwordx4 v[32:35], v30, s[12:15], s53 offen sc1
    s_mov_b32 s53, 3145728
    buffer_store_dwordx4 v[32:35], v30, s[12:15], s53 offen sc1
    s_mov_b32 s53, 3670016
    buffer_store_dwordx4 v[32:35], v30, s[12:15], s53 offen sc1
    s_mov_b32 s53, 4194304
    buffer_store_dwordx4 v[32:35], v30, s[12:15], s53 offen sc1
    s_mov_b32 s53, 4718592
    buffer_store_dwordx4 v[32:35], v30, s[12:15], s53 offen sc1
    s_mov_b32 s53, 5242880
    buffer_store_dwordx4 v[32:35], v30, s[12:15], s53 offen sc1
    s_mov_b32 s53, 5767168
    buffer_store_dwordx4 v[32:35], v30, s[12:15], s53 offen sc1
    s_mov_b32 s53, 6291456
    buffer_store_dwordx4 v[32:35], v30, s[12:15], s53 offen sc1
    s_mov_b32 s53, 6815744
    buffer_store_dwordx4 v[32:35], v30, s[12:15], s53 offen sc1
    s_mov_b32 s53, 7340032
    buffer_store_dwordx4 v[32:35], v30, s[12:15], s53 offen sc1
    s_mov_b32 s53, 7864320
    buffer_store_dwordx4 v[32:35], v30, s[12:15], s53 offen sc1
    s_mov_b32 s53, 8388608
    buffer_store_dwordx4 v[32:35], v30, s[12:15], s53 offen sc1
    s_mov_b32 s53, 8912896
    buffer_store_dwordx4 v[32:35], v30, s[12:15], s53 offen sc1
    s_mov_b32 s53, 9437184
    buffer_store_dwordx4 v[32:35], v30, s[12:15], s53 offen sc1
    s_mov_b32 s53, 9961472
    buffer_store_dwordx4 v[32:35], v30, s[12:15], s53 offen sc1
    s_mov_b32 s53, 10485760
    buffer_store_dwordx4 v[32:35], v30, s[12:15], s53 offen sc1
    s_mov_b32 s53, 11010048
    buffer_store_dwordx4 v[32:35], v30, s[12:15], s53 offen sc1
    s_mov_b32 s53, 11534336
    buffer_store_dwordx4 v[32:35], v30, s[12:15], s53 offen sc1
    s_mov_b32 s53, 12058624
    buffer_store_dwordx4 v[32:35], v30, s[12:15], s53 offen sc1
    s_mov_b32 s53, 12582912
    buffer_store_dwordx4 v[32:35], v30, s[12:15], s53 offen sc1
    s_mov_b32 s53, 13107200
    buffer_store_dwordx4 v[32:35], v30, s[12:15], s53 offen sc1
    s_mov_b32 s53, 13631488
    buffer_store_dwordx4 v[32:35], v30, s[12:15], s53 offen sc1
    s_mov_b32 s53, 14155776
    buffer_store_dwordx4 v[32:35], v30, s[12:15], s53 offen sc1
    s_mov_b32 s53, 14680064
    buffer_store_dwordx4 v[32:35], v30, s[12:15], s53 offen sc1
    s_mov_b32 s53, 15204352
    buffer_store_dwordx4 v[32:35], v30, s[12:15], s53 offen sc1
    s_mov_b32 s53, 15728640
    buffer_store_dwordx4 v[32:35], v30, s[12:15], s53 offen sc1
    s_mov_b32 s53, 16252928
    buffer_store_dwordx4 v[32:35], v30, s[12:15], s53 offen sc1
    s_lshl_b32 s55, s40, 16
    s_add_u32 s55, s55, 0x7000000
    s_lshl_b32 s52, s41, 10
    s_lshl_b32 s53, s54, 8
    s_add_u32 s52, s52, s53
    s_add_u32 s52, s52, s55
    v_lshlrev_b32 v8, 4, v100
    v_lshl_add_u32 v8, v101, 2, v8
    v_add_u32 v8, s52, v8
    s_lshl_b32 s53, s54, 12
    v_add_u32 v10, s53, v2
    v_add_u32 v9, s55, v10
    s_lshl_b32 s52, s40, 15
    s_lshl_b32 s53, s54, 11
    s_add_u32 s52, s52, s53
    s_add_u32 s52, s52, 0x7100000
    v_add_u32 v11, s52, v2
    s_lshl_b32 s52, s54, 8
    s_add_u32 s52, s52, 21504
    v_lshlrev_b32 v12, 4, v100
    v_lshl_add_u32 v12, v102, 3, v12
    v_lshl_add_u32 v12, v103, 2, v12
    v_add_u32 v12, s52, v12
    s_lshl_b32 s52, s50, 13
    s_add_u32 s52, s52, 0
    v_add_u32 v13, s52, v2
    s_lshl_b32 s52, s51, 9
    s_add_u32 s52, s52, 25600
    v_lshlrev_b32 v14, 3, v1
    v_add_u32 v14, s52, v14
    s_lshl_b32 s52, s40, 2
    s_add_u32 s52, s52, s54
    s_mul_i32 s52, s52, 24576
    s_add_u32 s52, s52, 0x2004000
    v_add_u32 v15, s52, v2
    s_lshl_b32 s52, s54, 10
    v_add_u32 v27, s52, v2
    v_lshlrev_b32 v30, 11, v106
    v_lshl_add_u32 v30, v101, 3, v30
    v_lshl_add_u32 v30, v107, 2, v30
    s_lshl_b32 s52, s41, 7
    s_lshl_b32 s53, s54, 5
    s_add_u32 s52, s52, s53
    buffer_load_dword v31, v30, s[32:35], s52 offen
    s_waitcnt vmcnt(0)
    v_min_u32 v31, -2, v31
    buffer_store_dword v31, v8, s[12:15], 0 offen sc1
    s_mov_b32 s53, 16384
    buffer_store_dword v26, v8, s[12:15], s53 offen sc1
    s_mov_b32 s53, 32768
    buffer_store_dword v26, v8, s[12:15], s53 offen sc1
    s_mov_b32 s53, 49152
    buffer_store_dword v26, v8, s[12:15], s53 offen sc1
    s_lshl_b32 s46, s49, 8
    s_lshl_b32 s48, s43, 6
    s_add_u32 s46, s46, s48
    s_lshl_b32 s48, s51, 5
    s_add_u32 s46, s46, s48
    s_lshl_b32 s48, s50, 22
    s_add_u32 s46, s46, s48
    s_add_u32 m0, s45, 0
    s_add_u32 s48, s46, 0x0
    buffer_load_dwordx4 v24, s[24:27], s48 offen lds
    s_add_u32 m0, s45, 1024
    s_add_u32 s48, s46, 0x40000
    buffer_load_dwordx4 v24, s[24:27], s48 offen lds
    s_add_u32 m0, s45, 2048
    s_add_u32 s48, s46, 0x80000
    buffer_load_dwordx4 v24, s[24:27], s48 offen lds
    s_add_u32 m0, s45, 3072
    s_add_u32 s48, s46, 0xc0000
    buffer_load_dwordx4 v24, s[24:27], s48 offen lds
    s_add_u32 m0, s45, 4096
    s_add_u32 s48, s46, 0x100000
    buffer_load_dwordx4 v24, s[24:27], s48 offen lds
    s_add_u32 m0, s45, 5120
    s_add_u32 s48, s46, 0x140000
    buffer_load_dwordx4 v24, s[24:27], s48 offen lds
    s_add_u32 m0, s45, 6144
    s_add_u32 s48, s46, 0x180000
    buffer_load_dwordx4 v24, s[24:27], s48 offen lds
    s_add_u32 m0, s45, 7168
    s_add_u32 s48, s46, 0x1c0000
    buffer_load_dwordx4 v24, s[24:27], s48 offen lds
    s_add_u32 m0, s45, 8192
    s_add_u32 s48, s46, 0x200000
    buffer_load_dwordx4 v24, s[24:27], s48 offen lds
    s_add_u32 m0, s45, 9216
    s_add_u32 s48, s46, 0x240000
    buffer_load_dwordx4 v24, s[24:27], s48 offen lds
    s_add_u32 m0, s45, 10240
    s_add_u32 s48, s46, 0x280000
    buffer_load_dwordx4 v24, s[24:27], s48 offen lds
    s_add_u32 m0, s45, 11264
    s_add_u32 s48, s46, 0x2c0000
    buffer_load_dwordx4 v24, s[24:27], s48 offen lds
    s_add_u32 m0, s45, 12288
    s_add_u32 s48, s46, 0x300000
    buffer_load_dwordx4 v24, s[24:27], s48 offen lds
    s_add_u32 m0, s45, 13312
    s_add_u32 s48, s46, 0x340000
    buffer_load_dwordx4 v24, s[24:27], s48 offen lds
    s_add_u32 m0, s45, 14336
    s_add_u32 s48, s46, 0x380000
    buffer_load_dwordx4 v24, s[24:27], s48 offen lds
    s_add_u32 m0, s45, 15360
    s_add_u32 s48, s46, 0x3c0000
    buffer_load_dwordx4 v24, s[24:27], s48 offen lds
    s_waitcnt vmcnt(0)
    ds_read_b64_tr_b16 a[0:1], v20 offset:0
    ds_read_b64_tr_b16 a[2:3], v20 offset:128
    ds_read_b64_tr_b16 a[4:5], v20 offset:1024
    ds_read_b64_tr_b16 a[6:7], v20 offset:1152
    ds_read_b64_tr_b16 a[8:9], v20 offset:2048
    ds_read_b64_tr_b16 a[10:11], v20 offset:2176
    ds_read_b64_tr_b16 a[12:13], v20 offset:3072
    ds_read_b64_tr_b16 a[14:15], v20 offset:3200
    s_waitcnt lgkmcnt(0)
    ds_read_b64_tr_b16 a[16:17], v20 offset:4096
    ds_read_b64_tr_b16 a[18:19], v20 offset:4224
    ds_read_b64_tr_b16 a[20:21], v20 offset:5120
    ds_read_b64_tr_b16 a[22:23], v20 offset:5248
    ds_read_b64_tr_b16 a[24:25], v20 offset:6144
    ds_read_b64_tr_b16 a[26:27], v20 offset:6272
    ds_read_b64_tr_b16 a[28:29], v20 offset:7168
    ds_read_b64_tr_b16 a[30:31], v20 offset:7296
    s_waitcnt lgkmcnt(0)
    ds_read_b64_tr_b16 a[32:33], v20 offset:8192
    ds_read_b64_tr_b16 a[34:35], v20 offset:8320
    ds_read_b64_tr_b16 a[36:37], v20 offset:9216
    ds_read_b64_tr_b16 a[38:39], v20 offset:9344
    ds_read_b64_tr_b16 a[40:41], v20 offset:10240
    ds_read_b64_tr_b16 a[42:43], v20 offset:10368
    ds_read_b64_tr_b16 a[44:45], v20 offset:11264
    ds_read_b64_tr_b16 a[46:47], v20 offset:11392
    s_waitcnt lgkmcnt(0)
    ds_read_b64_tr_b16 a[48:49], v20 offset:12288
    ds_read_b64_tr_b16 a[50:51], v20 offset:12416
    ds_read_b64_tr_b16 a[52:53], v20 offset:13312
    ds_read_b64_tr_b16 a[54:55], v20 offset:13440
    ds_read_b64_tr_b16 a[56:57], v20 offset:14336
    ds_read_b64_tr_b16 a[58:59], v20 offset:14464
    ds_read_b64_tr_b16 a[60:61], v20 offset:15360
    ds_read_b64_tr_b16 a[62:63], v20 offset:15488
    s_waitcnt lgkmcnt(0)
    s_lshl_b32 s46, s40, 2
    s_add_u32 s46, s46, s54
    s_lshl_b32 s46, s46, 18
    s_lshl_b32 s48, s41, 7
    s_add_u32 s46, s46, s48
    s_add_u32 m0, s45, 0
    s_add_u32 s48, s46, 0x0
    buffer_load_dwordx4 v25, s[28:31], s48 offen lds
    s_add_u32 m0, s45, 1024
    s_add_u32 s48, s46, 0x10000
    buffer_load_dwordx4 v25, s[28:31], s48 offen lds
    s_add_u32 m0, s45, 2048
    s_add_u32 s48, s46, 0x20000
    buffer_load_dwordx4 v25, s[28:31], s48 offen lds
    s_add_u32 m0, s45, 3072
    s_add_u32 s48, s46, 0x30000
    buffer_load_dwordx4 v25, s[28:31], s48 offen lds
    s_add_u32 m0, s45, 4096
    s_add_u32 s48, s46, 0x20
    buffer_load_dwordx4 v25, s[28:31], s48 offen lds
    s_add_u32 m0, s45, 5120
    s_add_u32 s48, s46, 0x10020
    buffer_load_dwordx4 v25, s[28:31], s48 offen lds
    s_add_u32 m0, s45, 6144
    s_add_u32 s48, s46, 0x20020
    buffer_load_dwordx4 v25, s[28:31], s48 offen lds
    s_add_u32 m0, s45, 7168
    s_add_u32 s48, s46, 0x30020
    buffer_load_dwordx4 v25, s[28:31], s48 offen lds
    s_add_u32 m0, s45, 8192
    s_add_u32 s48, s46, 0x40
    buffer_load_dwordx4 v25, s[28:31], s48 offen lds
    s_add_u32 m0, s45, 9216
    s_add_u32 s48, s46, 0x10040
    buffer_load_dwordx4 v25, s[28:31], s48 offen lds
    s_add_u32 m0, s45, 10240
    s_add_u32 s48, s46, 0x20040
    buffer_load_dwordx4 v25, s[28:31], s48 offen lds
    s_add_u32 m0, s45, 11264
    s_add_u32 s48, s46, 0x30040
    buffer_load_dwordx4 v25, s[28:31], s48 offen lds
    s_add_u32 m0, s45, 12288
    s_add_u32 s48, s46, 0x60
    buffer_load_dwordx4 v25, s[28:31], s48 offen lds
    s_add_u32 m0, s45, 13312
    s_add_u32 s48, s46, 0x10060
    buffer_load_dwordx4 v25, s[28:31], s48 offen lds
    s_add_u32 m0, s45, 14336
    s_add_u32 s48, s46, 0x20060
    buffer_load_dwordx4 v25, s[28:31], s48 offen lds
    s_add_u32 m0, s45, 15360
    s_add_u32 s48, s46, 0x30060
    buffer_load_dwordx4 v25, s[28:31], s48 offen lds
    s_waitcnt vmcnt(0)
    ds_read_b64_tr_b16 a[64:65], v20 offset:0
    ds_read_b64_tr_b16 a[66:67], v20 offset:128
    ds_read_b64_tr_b16 a[68:69], v20 offset:1024
    ds_read_b64_tr_b16 a[70:71], v20 offset:1152
    ds_read_b64_tr_b16 a[72:73], v20 offset:2048
    ds_read_b64_tr_b16 a[74:75], v20 offset:2176
    ds_read_b64_tr_b16 a[76:77], v20 offset:3072
    ds_read_b64_tr_b16 a[78:79], v20 offset:3200
    s_waitcnt lgkmcnt(0)
    ds_read_b64_tr_b16 a[80:81], v20 offset:4096
    ds_read_b64_tr_b16 a[82:83], v20 offset:4224
    ds_read_b64_tr_b16 a[84:85], v20 offset:5120
    ds_read_b64_tr_b16 a[86:87], v20 offset:5248
    ds_read_b64_tr_b16 a[88:89], v20 offset:6144
    ds_read_b64_tr_b16 a[90:91], v20 offset:6272
    ds_read_b64_tr_b16 a[92:93], v20 offset:7168
    ds_read_b64_tr_b16 a[94:95], v20 offset:7296
    s_waitcnt lgkmcnt(0)
    ds_read_b64_tr_b16 a[96:97], v20 offset:8192
    ds_read_b64_tr_b16 a[98:99], v20 offset:8320
    ds_read_b64_tr_b16 a[100:101], v20 offset:9216
    ds_read_b64_tr_b16 a[102:103], v20 offset:9344
    ds_read_b64_tr_b16 a[104:105], v20 offset:10240
    ds_read_b64_tr_b16 a[106:107], v20 offset:10368
    ds_read_b64_tr_b16 a[108:109], v20 offset:11264
    ds_read_b64_tr_b16 a[110:111], v20 offset:11392
    s_waitcnt lgkmcnt(0)
    ds_read_b64_tr_b16 a[112:113], v20 offset:12288
    ds_read_b64_tr_b16 a[114:115], v20 offset:12416
    ds_read_b64_tr_b16 a[116:117], v20 offset:13312
    ds_read_b64_tr_b16 a[118:119], v20 offset:13440
    ds_read_b64_tr_b16 a[120:121], v20 offset:14336
    ds_read_b64_tr_b16 a[122:123], v20 offset:14464
    ds_read_b64_tr_b16 a[124:125], v20 offset:15360
    ds_read_b64_tr_b16 a[126:127], v20 offset:15488
    s_waitcnt lgkmcnt(0)
    s_mov_b32 s65, 0
    s_barrier
    s_add_u32 s46, s65, 4096
    buffer_load_dwordx4 v[32:35], v15, s[12:15], s65 offen offset:0 sc1
    buffer_load_dwordx4 v[48:51], v15, s[12:15], s46 offen offset:0 sc1
    buffer_load_dwordx4 v[36:39], v15, s[12:15], s65 offen offset:1024 sc1
    buffer_load_dwordx4 v[52:55], v15, s[12:15], s46 offen offset:1024 sc1
    buffer_load_dwordx4 v[40:43], v15, s[12:15], s65 offen offset:2048 sc1
    buffer_load_dwordx4 v[56:59], v15, s[12:15], s46 offen offset:2048 sc1
    buffer_load_dwordx4 v[44:47], v15, s[12:15], s65 offen offset:3072 sc1
    buffer_load_dwordx4 v[60:63], v15, s[12:15], s46 offen offset:3072 sc1
    s_add_u32 s65, s65, 786432
    s_waitcnt vmcnt(0)
    s_barrier
    s_waitcnt vmcnt(0)
    v_mfma_f32_16x16x32_bf16 v[64:67], v[32:35], a[64:67], 0
    v_mfma_f32_16x16x32_bf16 v[68:71], v[48:51], a[64:67], 0
    v_mfma_f32_16x16x32_bf16 v[64:67], v[36:39], a[68:71], v[64:67]
    v_mfma_f32_16x16x32_bf16 v[68:71], v[52:55], a[68:71], v[68:71]
    v_mfma_f32_16x16x32_bf16 v[64:67], v[40:43], a[72:75], v[64:67]
    v_mfma_f32_16x16x32_bf16 v[68:71], v[56:59], a[72:75], v[68:71]
    v_mfma_f32_16x16x32_bf16 v[64:67], v[44:47], a[76:79], v[64:67]
    v_mfma_f32_16x16x32_bf16 v[68:71], v[60:63], a[76:79], v[68:71]
    v_mfma_f32_16x16x32_bf16 v[72:75], v[32:35], a[80:83], 0
    v_mfma_f32_16x16x32_bf16 v[76:79], v[48:51], a[80:83], 0
    v_mfma_f32_16x16x32_bf16 v[72:75], v[36:39], a[84:87], v[72:75]
    v_mfma_f32_16x16x32_bf16 v[76:79], v[52:55], a[84:87], v[76:79]
    v_mfma_f32_16x16x32_bf16 v[72:75], v[40:43], a[88:91], v[72:75]
    v_mfma_f32_16x16x32_bf16 v[76:79], v[56:59], a[88:91], v[76:79]
    v_mfma_f32_16x16x32_bf16 v[72:75], v[44:47], a[92:95], v[72:75]
    v_mfma_f32_16x16x32_bf16 v[76:79], v[60:63], a[92:95], v[76:79]
    v_cvt_pk_bf16_f32 v64, v64, v65
    v_cvt_pk_bf16_f32 v65, v66, v67
    v_cvt_pk_bf16_f32 v66, v68, v69
    v_cvt_pk_bf16_f32 v67, v70, v71
    ds_write_b128 v10, v[64:67] offset:32768
    v_mfma_f32_16x16x32_bf16 v[80:83], v[32:35], a[96:99], 0
    v_mfma_f32_16x16x32_bf16 v[84:87], v[48:51], a[96:99], 0
    v_mfma_f32_16x16x32_bf16 v[80:83], v[36:39], a[100:103], v[80:83]
    v_mfma_f32_16x16x32_bf16 v[84:87], v[52:55], a[100:103], v[84:87]
    v_mfma_f32_16x16x32_bf16 v[80:83], v[40:43], a[104:107], v[80:83]
    v_mfma_f32_16x16x32_bf16 v[84:87], v[56:59], a[104:107], v[84:87]
    v_mfma_f32_16x16x32_bf16 v[80:83], v[44:47], a[108:111], v[80:83]
    v_mfma_f32_16x16x32_bf16 v[84:87], v[60:63], a[108:111], v[84:87]
    v_cvt_pk_bf16_f32 v72, v72, v73
    v_cvt_pk_bf16_f32 v73, v74, v75
    v_cvt_pk_bf16_f32 v74, v76, v77
    v_cvt_pk_bf16_f32 v75, v78, v79
    ds_write_b128 v10, v[72:75] offset:33792
    v_mfma_f32_16x16x32_bf16 v[88:91], v[32:35], a[112:115], 0
    v_mfma_f32_16x16x32_bf16 v[92:95], v[48:51], a[112:115], 0
    v_mfma_f32_16x16x32_bf16 v[88:91], v[36:39], a[116:119], v[88:91]
    v_mfma_f32_16x16x32_bf16 v[92:95], v[52:55], a[116:119], v[92:95]
    v_mfma_f32_16x16x32_bf16 v[88:91], v[40:43], a[120:123], v[88:91]
    v_mfma_f32_16x16x32_bf16 v[92:95], v[56:59], a[120:123], v[92:95]
    v_mfma_f32_16x16x32_bf16 v[88:91], v[44:47], a[124:127], v[88:91]
    v_mfma_f32_16x16x32_bf16 v[92:95], v[60:63], a[124:127], v[92:95]
    v_cvt_pk_bf16_f32 v80, v80, v81
    v_cvt_pk_bf16_f32 v81, v82, v83
    v_cvt_pk_bf16_f32 v82, v84, v85
    v_cvt_pk_bf16_f32 v83, v86, v87
    ds_write_b128 v10, v[80:83] offset:34816
    s_nop 2
    v_cvt_pk_bf16_f32 v88, v88, v89
    v_cvt_pk_bf16_f32 v89, v90, v91
    v_cvt_pk_bf16_f32 v90, v92, v93
    v_cvt_pk_bf16_f32 v91, v94, v95
    ds_write_b128 v10, v[88:91] offset:35840
    s_mov_b32 s63, 0
L_c_join_162:
    s_mov_b32 s60, 0
    s_mov_b32 s61, 0
    s_mov_b32 s62, 0
    s_cmp_lg_u32 s44, 0
    s_cbranch_scc1 L_c_nh_165
    s_or_b32 s47, s47, 0x100
    v_mov_b32 v16, s47
    s_lshl_b32 s45, s40, 6
    s_lshl_b32 s46, s41, 2
    s_add_u32 s45, s45, s46
    s_add_u32 s45, s45, 0x101000
    v_mov_b32 v17, 0
    s_mov_b64 exec, 1
    buffer_store_dword v16, v17, s[12:15], s45 offen sc1
    s_mov_b64 exec, -1
    v_lshlrev_b32 v17, 3, v1
    s_lshl_b32 s46, s40, 2
    v_mov_b32 v21, s46
    s_mov_b32 s45, 0x101000
    s_mov_b32 s70, 0
L_c_rp_166:
    s_sleep 8
    buffer_load_dwordx2 v[18:19], v17, s[12:15], s45 offen sc1
    buffer_load_dword v22, v21, s[12:15], s45 offen offset:512 sc1
    s_waitcnt vmcnt(0)
    v_min3_u32 v20, v18, v19, v22
    v_cmp_eq_u32 vcc, 0, v20
    s_add_u32 s70, s70, 1
    s_cbranch_vccz L_ok_167
    s_cmp_lt_u32 s70, 524288
    s_cbranch_scc1 L_c_rp_166
    s_branch L_c_done_4
L_ok_167:
    v_cmp_eq_u32 s[52:53], v18, v16
    v_cmp_eq_u32 vcc, v19, v16
    v_cmp_eq_u32 s[54:55], v22, v16
    s_lshl_b32 s46, s40, 3
    s_nop 3
    s_and_b64 s[52:53], s[52:53], vcc
    s_and_b64 s[52:53], s[52:53], s[54:55]
    s_lshr_b64 s[52:53], s[52:53], s46
    s_and_b32 s52, s52, 0xff
    s_cmp_eq_u32 s52, 0xff
    s_cselect_b32 s52, 1, 0
    v_mov_b32 v16, s52
    v_mov_b32 v17, 26624
    ds_write_b32 v17, v16
L_c_nh_165:
    s_waitcnt lgkmcnt(0)
    s_barrier
    v_mov_b32 v17, 26624
    ds_read_b32 v16, v17
    s_waitcnt lgkmcnt(0)
    v_readfirstlane_b32 s52, v16
    s_nop 3
    s_cmp_ge_u32 s44, 4
    s_cbranch_scc1 L_vf_170
    s_cmp_eq_u32 s52, 0
    s_cbranch_scc1 L_ss_169
L_s_loop_172:
    v_mov_b32 v16, 0
    v_mov_b32 v17, 0
    v_mov_b32 v18, 0
    v_mov_b32 v19, 0
    s_barrier
    ds_read_b128 v[64:67], v2 offset:0
    ds_read_b128 v[68:71], v2 offset:1024
    ds_read_b128 v[72:75], v2 offset:2048
    ds_read_b128 v[76:79], v2 offset:3072
    ds_read_b128 v[80:83], v2 offset:4096
    ds_read_b128 v[84:87], v2 offset:5120
    ds_read_b128 v[88:91], v2 offset:6144
    ds_read_b128 v[92:95], v2 offset:7168
    ds_read_b128 v[96:99], v2 offset:8192
    ds_read_b128 v[100:103], v2 offset:9216
    ds_read_b128 v[104:107], v2 offset:10240
    ds_read_b128 v[108:111], v2 offset:11264
    s_add_u32 s46, s63, 4096
    buffer_load_dwordx4 v[32:35], v6, s[12:15], s63 offen offset:0 sc1
    buffer_load_dwordx4 v[36:39], v6, s[12:15], s63 offen offset:1024 sc1
    buffer_load_dwordx4 v[40:43], v6, s[12:15], s63 offen offset:2048 sc1
    buffer_load_dwordx4 v[44:47], v6, s[12:15], s63 offen offset:3072 sc1
    buffer_load_dwordx4 v[48:51], v6, s[12:15], s46 offen offset:0 sc1
    buffer_load_dwordx4 v[52:55], v6, s[12:15], s46 offen offset:1024 sc1
    buffer_load_dwordx4 v[56:59], v6, s[12:15], s46 offen offset:2048 sc1
    buffer_load_dwordx4 v[60:63], v6, s[12:15], s46 offen offset:3072 sc1
    s_waitcnt lgkmcnt(11)
    v_smfmac_f32_16x16x64_bf16 v[16:19], v[64:67], a[0:7], v3
    ds_read_b128 v[112:115], v2 offset:12288
    s_waitcnt lgkmcnt(11)
    v_smfmac_f32_16x16x64_bf16 v[16:19], v[68:71], a[8:15], v3
    ds_read_b128 v[116:119], v2 offset:13312
    s_waitcnt lgkmcnt(11)
    v_smfmac_f32_16x16x64_bf16 v[16:19], v[72:75], a[16:23], v3
    ds_read_b128 v[120:123], v2 offset:14336
    s_waitcnt lgkmcnt(11)
    v_smfmac_f32_16x16x64_bf16 v[16:19], v[76:79], a[24:31], v3
    ds_read_b128 v[124:127], v2 offset:15360
    s_waitcnt lgkmcnt(11)
    v_smfmac_f32_16x16x64_bf16 v[16:19], v[80:83], a[32:39], v3
    s_waitcnt lgkmcnt(10)
    v_smfmac_f32_16x16x64_bf16 v[16:19], v[84:87], a[40:47], v3
    s_waitcnt lgkmcnt(9)
    v_smfmac_f32_16x16x64_bf16 v[16:19], v[88:91], a[48:55], v3
    s_waitcnt lgkmcnt(8)
    v_smfmac_f32_16x16x64_bf16 v[16:19], v[92:95], a[56:63], v3
    s_waitcnt lgkmcnt(7)
    v_smfmac_f32_16x16x64_bf16 v[16:19], v[96:99], a[64:71], v3
    s_waitcnt lgkmcnt(6)
    v_smfmac_f32_16x16x64_bf16 v[16:19], v[100:103], a[72:79], v3
    s_waitcnt lgkmcnt(5)
    v_smfmac_f32_16x16x64_bf16 v[16:19], v[104:107], a[80:87], v3
    s_waitcnt lgkmcnt(4)
    v_smfmac_f32_16x16x64_bf16 v[16:19], v[108:111], a[88:95], v3
    s_waitcnt lgkmcnt(3)
    v_smfmac_f32_16x16x64_bf16 v[16:19], v[112:115], a[96:103], v3
    s_waitcnt lgkmcnt(2)
    v_smfmac_f32_16x16x64_bf16 v[16:19], v[116:119], a[104:111], v3
    s_waitcnt lgkmcnt(1)
    v_smfmac_f32_16x16x64_bf16 v[16:19], v[120:123], a[112:119], v3
    s_waitcnt lgkmcnt(0)
    v_smfmac_f32_16x16x64_bf16 v[16:19], v[124:127], a[120:127], v3
    s_nop 7
    v_permlane32_swap_b32 v16, v18
    v_permlane32_swap_b32 v17, v19
    v_add_f32 v16, v16, v18
    v_add_f32 v17, v17, v19
    s_mov_b32 vcc_lo, 0x55555555
    s_mov_b32 vcc_hi, 0x55555555
    v_cndmask_b32_dpp v18, v17, v16, vcc quad_perm:[1,0,3,2] row_mask:0xf bank_mask:0xf
    s_not_b64 vcc, vcc
    v_cndmask_b32_dpp v19, v16, v17, vcc quad_perm:[1,0,3,2] row_mask:0xf bank_mask:0xf
    v_cvt_pk_bf16_f32 v18, v18, v19
    v_min_u32 v18, -2, v18
    buffer_store_dword v18, v4, s[12:15], s61 offen
    ds_write_b32 v5, v18
    s_barrier
    s_cmp_eq_u32 s60, 63
    s_cbranch_scc1 L_s_last_173
    s_sleep 4
    s_mov_b32 s70, 0
L_s_xp_174:
    buffer_load_dwordx4 v[64:67], v7, s[12:15], s61 offen offset:0 sc1
    buffer_load_dwordx4 v[68:71], v7, s[12:15], s61 offen offset:1024 sc1
    buffer_load_dwordx4 v[72:75], v7, s[12:15], s61 offen offset:2048 sc1
    buffer_load_dwordx4 v[76:79], v7, s[12:15], s61 offen offset:3072 sc1
    s_waitcnt vmcnt(3)
    v_mfma_f32_16x16x32_bf16 v[20:23], v[48:51], v[64:67], 0
    v_mfma_f32_16x16x32_bf16 v[16:19], v[32:35], v[64:67], 0
    v_mfma_f32_16x16x32_bf16 v[24:27], v[64:67], v[64:67], v[28:31]
    s_waitcnt vmcnt(2)
    v_mfma_f32_16x16x32_bf16 v[20:23], v[52:55], v[68:71], v[20:23]
    v_mfma_f32_16x16x32_bf16 v[16:19], v[36:39], v[68:71], v[16:19]
    v_mfma_f32_16x16x32_bf16 v[24:27], v[68:71], v[68:71], v[24:27]
    s_waitcnt vmcnt(1)
    v_mfma_f32_16x16x32_bf16 v[20:23], v[56:59], v[72:75], v[20:23]
    v_mfma_f32_16x16x32_bf16 v[16:19], v[40:43], v[72:75], v[16:19]
    v_mfma_f32_16x16x32_bf16 v[24:27], v[72:75], v[72:75], v[24:27]
    s_waitcnt vmcnt(0)
    v_mfma_f32_16x16x32_bf16 v[20:23], v[60:63], v[76:79], v[20:23]
    v_mfma_f32_16x16x32_bf16 v[16:19], v[44:47], v[76:79], v[16:19]
    v_mfma_f32_16x16x32_bf16 v[24:27], v[76:79], v[76:79], v[24:27]
    v_max3_u32 v10, v64, v65, v66
    v_max3_u32 v10, v10, v67, v68
    v_max3_u32 v10, v10, v69, v70
    v_max3_u32 v10, v10, v71, v72
    v_max3_u32 v10, v10, v73, v74
    v_max3_u32 v10, v10, v75, v76
    v_max3_u32 v10, v10, v77, v78
    v_max_u32 v10, v10, v79
    v_cmp_eq_u32 vcc, -1, v10
    s_add_u32 s70, s70, 1
    s_cbranch_vccz L_ok_175
    s_cmp_lt_u32 s70, 524288
    s_cbranch_scc1 L_s_xp_174
    s_branch L_c_done_4
L_ok_175:
    v_mov_b32_dpp v16, v20 row_ror:8 row_mask:0xf bank_mask:0xc
    v_mov_b32_dpp v17, v21 row_ror:8 row_mask:0xf bank_mask:0xc
    v_mov_b32_dpp v18, v22 row_ror:8 row_mask:0xf bank_mask:0xc
    v_mov_b32_dpp v19, v23 row_ror:8 row_mask:0xf bank_mask:0xc
    v_mov_b32_dpp v24, v26 row_ror:8 row_mask:0xf bank_mask:0xc
    v_mov_b32_dpp v25, v27 row_ror:8 row_mask:0xf bank_mask:0xc
    v_max3_f32 v10, v16, v17, v18
    v_max3_f32 v10, v10, v19, v24
    v_max_f32 v10, v10, v25
    s_nop 1
    v_max_f32_dpp v11, v10, v10 row_ror:8 row_mask:0xf bank_mask:0xf
    v_max_f32_dpp v10, v10, v10 row_ror:8 row_mask:0xf bank_mask:0xf
    s_nop 1
    v_permlane16_swap_b32 v10, v11
    v_max_f32 v12, v10, v11
    v_max_f32 v10, v10, v11
    s_nop 1
    v_permlane32_swap_b32 v10, v12
    v_max_f32 v10, v10, v12
    v_mul_f32 v10, s66, v10
    v_fma_f32 v16, v16, s66, -v10
    v_fma_f32 v17, v17, s66, -v10
    v_fma_f32 v18, v18, s66, -v10
    v_fma_f32 v19, v19, s66, -v10
    v_fma_f32 v24, v24, s66, -v10
    v_fma_f32 v25, v25, s66, -v10
    v_exp_f32 v16, v16
    v_exp_f32 v17, v17
    v_exp_f32 v18, v18
    v_exp_f32 v19, v19
    v_exp_f32 v24, v24
    v_exp_f32 v25, v25
    v_add_f32 v10, v16, v17
    v_add_f32 v11, v18, v19
    v_add_f32 v10, v10, v24
    v_add_f32 v11, v11, v25
    v_add_f32 v10, v10, v11
    s_nop 1
    v_add_f32_dpp v11, v10, v10 row_ror:8 row_mask:0xf bank_mask:0xf
    v_add_f32_dpp v10, v10, v10 row_ror:8 row_mask:0xf bank_mask:0xf
    s_nop 1
    v_permlane16_swap_b32 v10, v11
    v_add_f32 v12, v10, v11
    v_add_f32 v10, v10, v11
    s_nop 1
    v_permlane32_swap_b32 v10, v12
    v_add_f32 v10, v10, v12
    v_rcp_f32 v10, v10
    s_nop 0
    v_mul_f32 v16, v16, v10
    v_mul_f32 v17, v17, v10
    v_mul_f32 v18, v18, v10
    v_mul_f32 v19, v19, v10
    v_mul_f32 v24, v24, v10
    v_mul_f32 v25, v25, v10
    v_cvt_pk_bf16_f32 v16, v16, v17
    v_cvt_pk_bf16_f32 v17, v18, v19
    v_cvt_pk_bf16_f32 v18, v24, v25
    ds_write_b64 v8, v[16:17]
    ds_write_b32 v9, v18
    s_waitcnt lgkmcnt(0)
    s_barrier
    s_add_u32 s63, s63, 786432
    s_sleep 4
    s_xor_b32 s45, s61, 0x8000
    buffer_store_dword v13, v4, s[12:15], s45 offen
    s_cmp_lg_u32 s44, 0
    s_cbranch_scc1 L_s_np_176
    ds_read_b128 v[20:23], v2 offset:27648
    s_lshl_b32 s45, s60, 17
    s_add_u32 s45, s45, s67
    s_waitcnt lgkmcnt(0)
    buffer_store_dwordx4 v[20:23], v2, s[12:15], s45 offen
L_s_np_176:
    s_add_u32 s68, s60, 2
    s_min_u32 s68, s68, 63
    s_cmp_gt_u32 s69, s68
    s_cbranch_scc1 L_kv_ok_178
    s_mov_b32 s70, 0
L_kv_lp_177:
    buffer_load_dword v10, v14, s[12:15], 0 offen sc1
    s_waitcnt vmcnt(0)
    v_readlane_b32 s69, v10, 0
    v_readlane_b32 s45, v10, 1
    s_add_u32 s70, s70, 1
    s_nop 2
    s_min_u32 s69, s69, s45
    s_cmp_gt_u32 s69, s68
    s_cbranch_scc1 L_kv_ok_178
    s_sleep 4
    s_cmp_lt_u32 s70, 524288
    s_cbranch_scc1 L_kv_lp_177
    s_branch L_c_done_4
L_kv_ok_178:
    s_add_u32 s60, s60, 1
    s_add_u32 s61, s61, 0x4000
    s_and_b32 s61, s61, 0xffff
    s_branch L_s_loop_172
L_s_last_173:
    s_waitcnt lgkmcnt(0)
    s_barrier
    s_cmp_lg_u32 s44, 0
    s_cbranch_scc1 L_s_np_179
    ds_read_b128 v[20:23], v2 offset:27648
    s_lshl_b32 s45, s60, 17
    s_add_u32 s45, s45, s67
    s_waitcnt lgkmcnt(0)
    buffer_store_dwordx4 v[20:23], v2, s[12:15], s45 offen
L_s_np_179:
    s_branch L_c_done_4
L_ss_169:
L_s_loop_180:
    v_mov_b32 v16, 0
    v_mov_b32 v17, 0
    v_mov_b32 v18, 0
    v_mov_b32 v19, 0
    s_barrier
    ds_read_b128 v[64:67], v2 offset:0
    ds_read_b128 v[68:71], v2 offset:1024
    ds_read_b128 v[72:75], v2 offset:2048
    ds_read_b128 v[76:79], v2 offset:3072
    ds_read_b128 v[80:83], v2 offset:4096
    ds_read_b128 v[84:87], v2 offset:5120
    ds_read_b128 v[88:91], v2 offset:6144
    ds_read_b128 v[92:95], v2 offset:7168
    ds_read_b128 v[96:99], v2 offset:8192
    ds_read_b128 v[100:103], v2 offset:9216
    ds_read_b128 v[104:107], v2 offset:10240
    ds_read_b128 v[108:111], v2 offset:11264
    s_add_u32 s46, s63, 4096
    buffer_load_dwordx4 v[32:35], v6, s[12:15], s63 offen offset:0 sc1
    buffer_load_dwordx4 v[36:39], v6, s[12:15], s63 offen offset:1024 sc1
    buffer_load_dwordx4 v[40:43], v6, s[12:15], s63 offen offset:2048 sc1
    buffer_load_dwordx4 v[44:47], v6, s[12:15], s63 offen offset:3072 sc1
    buffer_load_dwordx4 v[48:51], v6, s[12:15], s46 offen offset:0 sc1
    buffer_load_dwordx4 v[52:55], v6, s[12:15], s46 offen offset:1024 sc1
    buffer_load_dwordx4 v[56:59], v6, s[12:15], s46 offen offset:2048 sc1
    buffer_load_dwordx4 v[60:63], v6, s[12:15], s46 offen offset:3072 sc1
    s_waitcnt lgkmcnt(11)
    v_smfmac_f32_16x16x64_bf16 v[16:19], v[64:67], a[0:7], v3
    ds_read_b128 v[112:115], v2 offset:12288
    s_waitcnt lgkmcnt(11)
    v_smfmac_f32_16x16x64_bf16 v[16:19], v[68:71], a[8:15], v3
    ds_read_b128 v[116:119], v2 offset:13312
    s_waitcnt lgkmcnt(11)
    v_smfmac_f32_16x16x64_bf16 v[16:19], v[72:75], a[16:23], v3
    ds_read_b128 v[120:123], v2 offset:14336
    s_waitcnt lgkmcnt(11)
    v_smfmac_f32_16x16x64_bf16 v[16:19], v[76:79], a[24:31], v3
    ds_read_b128 v[124:127], v2 offset:15360
    s_waitcnt lgkmcnt(11)
    v_smfmac_f32_16x16x64_bf16 v[16:19], v[80:83], a[32:39], v3
    s_waitcnt lgkmcnt(10)
    v_smfmac_f32_16x16x64_bf16 v[16:19], v[84:87], a[40:47], v3
    s_waitcnt lgkmcnt(9)
    v_smfmac_f32_16x16x64_bf16 v[16:19], v[88:91], a[48:55], v3
    s_waitcnt lgkmcnt(8)
    v_smfmac_f32_16x16x64_bf16 v[16:19], v[92:95], a[56:63], v3
    s_waitcnt lgkmcnt(7)
    v_smfmac_f32_16x16x64_bf16 v[16:19], v[96:99], a[64:71], v3
    s_waitcnt lgkmcnt(6)
    v_smfmac_f32_16x16x64_bf16 v[16:19], v[100:103], a[72:79], v3
    s_waitcnt lgkmcnt(5)
    v_smfmac_f32_16x16x64_bf16 v[16:19], v[104:107], a[80:87], v3
    s_waitcnt lgkmcnt(4)
    v_smfmac_f32_16x16x64_bf16 v[16:19], v[108:111], a[88:95], v3
    s_waitcnt lgkmcnt(3)
    v_smfmac_f32_16x16x64_bf16 v[16:19], v[112:115], a[96:103], v3
    s_waitcnt lgkmcnt(2)
    v_smfmac_f32_16x16x64_bf16 v[16:19], v[116:119], a[104:111], v3
    s_waitcnt lgkmcnt(1)
    v_smfmac_f32_16x16x64_bf16 v[16:19], v[120:123], a[112:119], v3
    s_waitcnt lgkmcnt(0)
    v_smfmac_f32_16x16x64_bf16 v[16:19], v[124:127], a[120:127], v3
    s_nop 7
    v_permlane32_swap_b32 v16, v18
    v_permlane32_swap_b32 v17, v19
    v_add_f32 v16, v16, v18
    v_add_f32 v17, v17, v19
    s_mov_b32 vcc_lo, 0x55555555
    s_mov_b32 vcc_hi, 0x55555555
    v_cndmask_b32_dpp v18, v17, v16, vcc quad_perm:[1,0,3,2] row_mask:0xf bank_mask:0xf
    s_not_b64 vcc, vcc
    v_cndmask_b32_dpp v19, v16, v17, vcc quad_perm:[1,0,3,2] row_mask:0xf bank_mask:0xf
    v_cvt_pk_bf16_f32 v18, v18, v19
    v_min_u32 v18, -2, v18
    buffer_store_dword v18, v4, s[12:15], s61 offen sc1
    ds_write_b32 v5, v18
    s_barrier
    s_cmp_eq_u32 s60, 63
    s_cbranch_scc1 L_s_last_181
    s_sleep 4
    s_mov_b32 s70, 0
L_s_xp_182:
    buffer_load_dwordx4 v[64:67], v7, s[12:15], s61 offen offset:0 sc1
    buffer_load_dwordx4 v[68:71], v7, s[12:15], s61 offen offset:1024 sc1
    buffer_load_dwordx4 v[72:75], v7, s[12:15], s61 offen offset:2048 sc1
    buffer_load_dwordx4 v[76:79], v7, s[12:15], s61 offen offset:3072 sc1
    s_waitcnt vmcnt(3)
    v_mfma_f32_16x16x32_bf16 v[20:23], v[48:51], v[64:67], 0
    v_mfma_f32_16x16x32_bf16 v[16:19], v[32:35], v[64:67], 0
    v_mfma_f32_16x16x32_bf16 v[24:27], v[64:67], v[64:67], v[28:31]
    s_waitcnt vmcnt(2)
    v_mfma_f32_16x16x32_bf16 v[20:23], v[52:55], v[68:71], v[20:23]
    v_mfma_f32_16x16x32_bf16 v[16:19], v[36:39], v[68:71], v[16:19]
    v_mfma_f32_16x16x32_bf16 v[24:27], v[68:71], v[68:71], v[24:27]
    s_waitcnt vmcnt(1)
    v_mfma_f32_16x16x32_bf16 v[20:23], v[56:59], v[72:75], v[20:23]
    v_mfma_f32_16x16x32_bf16 v[16:19], v[40:43], v[72:75], v[16:19]
    v_mfma_f32_16x16x32_bf16 v[24:27], v[72:75], v[72:75], v[24:27]
    s_waitcnt vmcnt(0)
    v_mfma_f32_16x16x32_bf16 v[20:23], v[60:63], v[76:79], v[20:23]
    v_mfma_f32_16x16x32_bf16 v[16:19], v[44:47], v[76:79], v[16:19]
    v_mfma_f32_16x16x32_bf16 v[24:27], v[76:79], v[76:79], v[24:27]
    v_max3_u32 v10, v64, v65, v66
    v_max3_u32 v10, v10, v67, v68
    v_max3_u32 v10, v10, v69, v70
    v_max3_u32 v10, v10, v71, v72
    v_max3_u32 v10, v10, v73, v74
    v_max3_u32 v10, v10, v75, v76
    v_max3_u32 v10, v10, v77, v78
    v_max_u32 v10, v10, v79
    v_cmp_eq_u32 vcc, -1, v10
    s_add_u32 s70, s70, 1
    s_cbranch_vccz L_ok_183
    s_cmp_lt_u32 s70, 524288
    s_cbranch_scc1 L_s_xp_182
    s_branch L_c_done_4
L_ok_183:
    v_mov_b32_dpp v16, v20 row_ror:8 row_mask:0xf bank_mask:0xc
    v_mov_b32_dpp v17, v21 row_ror:8 row_mask:0xf bank_mask:0xc
    v_mov_b32_dpp v18, v22 row_ror:8 row_mask:0xf bank_mask:0xc
    v_mov_b32_dpp v19, v23 row_ror:8 row_mask:0xf bank_mask:0xc
    v_mov_b32_dpp v24, v26 row_ror:8 row_mask:0xf bank_mask:0xc
    v_mov_b32_dpp v25, v27 row_ror:8 row_mask:0xf bank_mask:0xc
    v_max3_f32 v10, v16, v17, v18
    v_max3_f32 v10, v10, v19, v24
    v_max_f32 v10, v10, v25
    s_nop 1
    v_max_f32_dpp v11, v10, v10 row_ror:8 row_mask:0xf bank_mask:0xf
    v_max_f32_dpp v10, v10, v10 row_ror:8 row_mask:0xf bank_mask:0xf
    s_nop 1
    v_permlane16_swap_b32 v10, v11
    v_max_f32 v12, v10, v11
    v_max_f32 v10, v10, v11
    s_nop 1
    v_permlane32_swap_b32 v10, v12
    v_max_f32 v10, v10, v12
    v_mul_f32 v10, s66, v10
    v_fma_f32 v16, v16, s66, -v10
    v_fma_f32 v17, v17, s66, -v10
    v_fma_f32 v18, v18, s66, -v10
    v_fma_f32 v19, v19, s66, -v10
    v_fma_f32 v24, v24, s66, -v10
    v_fma_f32 v25, v25, s66, -v10
    v_exp_f32 v16, v16
    v_exp_f32 v17, v17
    v_exp_f32 v18, v18
    v_exp_f32 v19, v19
    v_exp_f32 v24, v24
    v_exp_f32 v25, v25
    v_add_f32 v10, v16, v17
    v_add_f32 v11, v18, v19
    v_add_f32 v10, v10, v24
    v_add_f32 v11, v11, v25
    v_add_f32 v10, v10, v11
    s_nop 1
    v_add_f32_dpp v11, v10, v10 row_ror:8 row_mask:0xf bank_mask:0xf
    v_add_f32_dpp v10, v10, v10 row_ror:8 row_mask:0xf bank_mask:0xf
    s_nop 1
    v_permlane16_swap_b32 v10, v11
    v_add_f32 v12, v10, v11
    v_add_f32 v10, v10, v11
    s_nop 1
    v_permlane32_swap_b32 v10, v12
    v_add_f32 v10, v10, v12
    v_rcp_f32 v10, v10
    s_nop 0
    v_mul_f32 v16, v16, v10
    v_mul_f32 v17, v17, v10
    v_mul_f32 v18, v18, v10
    v_mul_f32 v19, v19, v10
    v_mul_f32 v24, v24, v10
    v_mul_f32 v25, v25, v10
    v_cvt_pk_bf16_f32 v16, v16, v17
    v_cvt_pk_bf16_f32 v17, v18, v19
    v_cvt_pk_bf16_f32 v18, v24, v25
    ds_write_b64 v8, v[16:17]
    ds_write_b32 v9, v18
    s_waitcnt lgkmcnt(0)
    s_barrier
    s_add_u32 s63, s63, 786432
    s_sleep 4
    s_xor_b32 s45, s61, 0x8000
    buffer_store_dword v13, v4, s[12:15], s45 offen sc1
    s_cmp_lg_u32 s44, 0
    s_cbranch_scc1 L_s_np_184
    ds_read_b128 v[20:23], v2 offset:27648
    s_lshl_b32 s45, s60, 17
    s_add_u32 s45, s45, s67
    s_waitcnt lgkmcnt(0)
    buffer_store_dwordx4 v[20:23], v2, s[12:15], s45 offen sc1
L_s_np_184:
    s_add_u32 s68, s60, 2
    s_min_u32 s68, s68, 63
    s_cmp_gt_u32 s69, s68
    s_cbranch_scc1 L_kv_ok_186
    s_mov_b32 s70, 0
L_kv_lp_185:
    buffer_load_dword v10, v14, s[12:15], 0 offen sc1
    s_waitcnt vmcnt(0)
    v_readlane_b32 s69, v10, 0
    v_readlane_b32 s45, v10, 1
    s_add_u32 s70, s70, 1
    s_nop 2
    s_min_u32 s69, s69, s45
    s_cmp_gt_u32 s69, s68
    s_cbranch_scc1 L_kv_ok_186
    s_sleep 4
    s_cmp_lt_u32 s70, 524288
    s_cbranch_scc1 L_kv_lp_185
    s_branch L_c_done_4
L_kv_ok_186:
    s_add_u32 s60, s60, 1
    s_add_u32 s61, s61, 0x4000
    s_and_b32 s61, s61, 0xffff
    s_branch L_s_loop_180
L_s_last_181:
    s_waitcnt lgkmcnt(0)
    s_barrier
    s_cmp_lg_u32 s44, 0
    s_cbranch_scc1 L_s_np_187
    ds_read_b128 v[20:23], v2 offset:27648
    s_lshl_b32 s45, s60, 17
    s_add_u32 s45, s45, s67
    s_waitcnt lgkmcnt(0)
    buffer_store_dwordx4 v[20:23], v2, s[12:15], s45 offen sc1
L_s_np_187:
    s_branch L_c_done_4
L_vf_170:
    s_cmp_eq_u32 s52, 0
    s_cbranch_scc1 L_vs_171
L_v_loop_188:
    s_mov_b32 s70, 0
L_v_l1_189:
    buffer_load_dwordx4 v[64:67], v9, s[12:15], s61 offen offset:0 sc1
    buffer_load_dwordx4 v[68:71], v9, s[12:15], s61 offen offset:1024 sc1
    buffer_load_dwordx4 v[72:75], v9, s[12:15], s61 offen offset:2048 sc1
    buffer_load_dwordx4 v[76:79], v9, s[12:15], s61 offen offset:3072 sc1
    v_mov_b32 v16, 0
    v_mov_b32 v17, 0
    v_mov_b32 v18, 0
    v_mov_b32 v19, 0
    s_waitcnt vmcnt(3)
    ds_write_b128 v10, v[64:67] offset:0
    s_waitcnt vmcnt(2)
    ds_write_b128 v10, v[68:71] offset:1024
    s_waitcnt vmcnt(1)
    ds_write_b128 v10, v[72:75] offset:2048
    s_waitcnt vmcnt(0)
    ds_write_b128 v10, v[76:79] offset:3072
    v_max3_u32 v20, v64, v65, v66
    v_max3_u32 v20, v20, v67, v68
    v_max3_u32 v20, v20, v69, v70
    v_max3_u32 v20, v20, v71, v72
    v_max3_u32 v20, v20, v73, v74
    v_max3_u32 v20, v20, v75, v76
    v_max3_u32 v20, v20, v77, v78
    v_max_u32 v20, v20, v79
    v_cmp_eq_u32 vcc, -1, v20
    s_add_u32 s70, s70, 1
    s_cbranch_vccz L_ok_190
    s_cmp_lt_u32 s70, 524288
    s_cbranch_scc1 L_v_l1_189
    s_branch L_c_done_4
L_ok_190:
    s_waitcnt lgkmcnt(0)
    s_barrier
    ds_read_b128 v[64:67], v13 offset:0
    ds_read_b128 v[68:71], v13 offset:1024
    ds_read_b128 v[72:75], v13 offset:2048
    ds_read_b128 v[76:79], v13 offset:3072
    ds_read_b128 v[80:83], v13 offset:4096
    ds_read_b128 v[84:87], v13 offset:5120
    ds_read_b128 v[88:91], v13 offset:6144
    ds_read_b128 v[92:95], v13 offset:7168
    v_mov_b32 v96, 0
    v_mov_b32 v97, 0
    v_mov_b32 v98, 0
    v_mov_b32 v99, 0
    v_mov_b32 v100, 0
    v_mov_b32 v101, 0
    v_mov_b32 v102, 0
    v_mov_b32 v103, 0
    v_mov_b32 v104, 0
    v_mov_b32 v105, 0
    v_mov_b32 v106, 0
    v_mov_b32 v107, 0
    v_mov_b32 v108, 0
    v_mov_b32 v109, 0
    v_mov_b32 v110, 0
    v_mov_b32 v111, 0
    s_waitcnt lgkmcnt(7)
    v_smfmac_f32_16x16x64_bf16 v[16:19], v[64:67], a[0:7], v3
    s_waitcnt lgkmcnt(6)
    v_smfmac_f32_16x16x64_bf16 v[16:19], v[68:71], a[8:15], v3
    s_waitcnt lgkmcnt(5)
    v_smfmac_f32_16x16x64_bf16 v[16:19], v[72:75], a[16:23], v3
    s_waitcnt lgkmcnt(4)
    v_smfmac_f32_16x16x64_bf16 v[16:19], v[76:79], a[24:31], v3
    s_waitcnt lgkmcnt(3)
    v_smfmac_f32_16x16x64_bf16 v[16:19], v[80:83], a[32:39], v3
    s_waitcnt lgkmcnt(2)
    v_smfmac_f32_16x16x64_bf16 v[16:19], v[84:87], a[40:47], v3
    s_waitcnt lgkmcnt(1)
    v_smfmac_f32_16x16x64_bf16 v[16:19], v[88:91], a[48:55], v3
    s_waitcnt lgkmcnt(0)
    v_smfmac_f32_16x16x64_bf16 v[16:19], v[92:95], a[56:63], v3
    s_nop 7
    v_permlane32_swap_b32 v16, v18
    v_permlane32_swap_b32 v17, v19
    v_add_f32 v16, v16, v18
    v_add_f32 v17, v17, v19
    s_bitcmp1_b32 s44, 0
    s_cbranch_scc0 L_v_k0_192
    ds_write_b64 v14, v[16:17]
    s_waitcnt lgkmcnt(0)
    s_barrier
    s_branch L_v_k1_193
L_v_k0_192:
    s_barrier
    ds_read_b64 v[20:21], v14
    s_waitcnt lgkmcnt(0)
    v_add_f32 v16, v16, v20
    v_add_f32 v17, v17, v21
    s_mov_b32 vcc_lo, 0x55555555
    s_mov_b32 vcc_hi, 0x55555555
    v_cndmask_b32_dpp v18, v17, v16, vcc quad_perm:[1,0,3,2] row_mask:0xf bank_mask:0xf
    s_not_b64 vcc, vcc
    v_cndmask_b32_dpp v19, v16, v17, vcc quad_perm:[1,0,3,2] row_mask:0xf bank_mask:0xf
    v_cvt_pk_bf16_f32 v18, v18, v19
    v_min_u32 v18, -2, v18
    buffer_store_dword v18, v4, s[12:15], s62 offen
    ds_write_b32 v5, v18
L_v_k1_193:
    s_cmp_eq_u32 s60, 63
    s_cbranch_scc1 L_v_last_191
    ds_read_b128 v[80:83], v27 offset:32768
    ds_read_b128 v[84:87], v27 offset:36864
    ds_read_b128 v[88:91], v27 offset:40960
    ds_read_b128 v[92:95], v27 offset:45056
    s_sleep 5
    s_mov_b32 s70, 0
L_v_vp_194:
    buffer_load_dwordx4 v[64:67], v11, s[12:15], s62 offen offset:0 sc1
    buffer_load_dwordx4 v[68:71], v11, s[12:15], s62 offen offset:1024 sc1
    s_waitcnt vmcnt(0)
    v_max3_u32 v20, v64, v65, v66
    v_max3_u32 v20, v20, v67, v68
    v_max3_u32 v20, v20, v69, v70
    v_max_u32 v20, v20, v71
    v_cmp_eq_u32 vcc, -1, v20
    s_add_u32 s70, s70, 1
    s_cbranch_vccz L_ok_195
    s_cmp_lt_u32 s70, 524288
    s_cbranch_scc1 L_v_vp_194
    s_branch L_c_done_4
L_ok_195:
    v_smfmac_f32_16x16x64_bf16 v[96:99], v[64:67], a[64:71], v3
    v_smfmac_f32_16x16x64_bf16 v[96:99], v[68:71], a[72:79], v3
    v_smfmac_f32_16x16x64_bf16 v[100:103], v[64:67], a[80:87], v3
    v_smfmac_f32_16x16x64_bf16 v[100:103], v[68:71], a[88:95], v3
    v_smfmac_f32_16x16x64_bf16 v[104:107], v[64:67], a[96:103], v3
    v_smfmac_f32_16x16x64_bf16 v[104:107], v[68:71], a[104:111], v3
    v_smfmac_f32_16x16x64_bf16 v[108:111], v[64:67], a[112:119], v3
    v_smfmac_f32_16x16x64_bf16 v[108:111], v[68:71], a[120:127], v3
    s_add_u32 s46, s65, 4096
    buffer_load_dwordx4 v[32:35], v15, s[12:15], s65 offen offset:0 sc1
    buffer_load_dwordx4 v[48:51], v15, s[12:15], s46 offen offset:0 sc1
    buffer_load_dwordx4 v[36:39], v15, s[12:15], s65 offen offset:1024 sc1
    buffer_load_dwordx4 v[52:55], v15, s[12:15], s46 offen offset:1024 sc1
    buffer_load_dwordx4 v[40:43], v15, s[12:15], s65 offen offset:2048 sc1
    buffer_load_dwordx4 v[56:59], v15, s[12:15], s46 offen offset:2048 sc1
    buffer_load_dwordx4 v[44:47], v15, s[12:15], s65 offen offset:3072 sc1
    buffer_load_dwordx4 v[60:63], v15, s[12:15], s46 offen offset:3072 sc1
    s_add_u32 s65, s65, 786432
    v_permlane32_swap_b32 v96, v98
    v_permlane32_swap_b32 v97, v99
    v_add_f32 v96, v96, v98
    v_add_f32 v97, v97, v99
    v_cvt_pk_bf16_f32 v96, v96, v97
    ds_write_b32 v12, v96 offset:0
    v_permlane32_swap_b32 v100, v102
    v_permlane32_swap_b32 v101, v103
    v_add_f32 v100, v100, v102
    v_add_f32 v101, v101, v103
    v_cvt_pk_bf16_f32 v100, v100, v101
    ds_write_b32 v12, v100 offset:1024
    v_permlane32_swap_b32 v104, v106
    v_permlane32_swap_b32 v105, v107
    v_add_f32 v104, v104, v106
    v_add_f32 v105, v105, v107
    v_cvt_pk_bf16_f32 v104, v104, v105
    ds_write_b32 v12, v104 offset:2048
    v_permlane32_swap_b32 v108, v110
    v_permlane32_swap_b32 v109, v111
    v_add_f32 v108, v108, v110
    v_add_f32 v109, v109, v111
    v_cvt_pk_bf16_f32 v108, v108, v109
    ds_write_b32 v12, v108 offset:3072
    s_waitcnt lgkmcnt(0)
    s_barrier
    ds_read_b128 v[96:99], v2 offset:16384
    ds_read_b128 v[100:103], v2 offset:17408
    ds_read_b128 v[104:107], v2 offset:18432
    ds_read_b128 v[108:111], v2 offset:19456
    ds_read_b128 v[112:115], v2 offset:20480
    ds_read_b128 v[116:119], v27 offset:21504
    s_waitcnt lgkmcnt(5)
    v_mfma_f32_16x16x32_bf16 v[16:19], v[80:83], v[96:99], 0
    s_waitcnt lgkmcnt(4)
    v_mfma_f32_16x16x32_bf16 v[16:19], v[84:87], v[100:103], v[16:19]
    s_waitcnt lgkmcnt(3)
    v_mfma_f32_16x16x32_bf16 v[16:19], v[88:91], v[104:107], v[16:19]
    s_waitcnt lgkmcnt(2)
    v_mfma_f32_16x16x32_bf16 v[16:19], v[92:95], v[108:111], v[16:19]
    s_waitcnt lgkmcnt(0)
    v_mfma_f32_16x16x32_bf16 v[16:19], v[116:119], v[112:115], v[16:19]
    s_mov_b32 exec_lo, 0x00ff00ff
    s_mov_b32 exec_hi, 0x00ff00ff
    s_nop 5
    v_min_u32 v16, -2, v16
    v_min_u32 v17, -2, v17
    v_min_u32 v18, -2, v18
    v_min_u32 v19, -2, v19
    buffer_store_dwordx4 v[16:19], v6, s[12:15], s63 offen sc1
    s_mov_b64 exec, -1
    s_add_u32 s61, s61, 0x4000
    s_and_b32 s61, s61, 0xffff
    s_mov_b32 s70, 0
    s_sleep 12
    s_waitcnt vmcnt(1)
    buffer_load_dwordx4 v[96:99], v7, s[12:15], s63 offen offset:0 sc1
    buffer_load_dwordx4 v[100:103], v7, s[12:15], s63 offen offset:512 sc1
    buffer_load_dwordx4 v[104:107], v7, s[12:15], s63 offen offset:1024 sc1
    buffer_load_dwordx4 v[108:111], v7, s[12:15], s63 offen offset:1536 sc1
    v_mfma_f32_16x16x32_bf16 v[64:67], v[32:35], a[64:67], 0
    v_mfma_f32_16x16x32_bf16 v[68:71], v[48:51], a[64:67], 0
    v_mfma_f32_16x16x32_bf16 v[64:67], v[36:39], a[68:71], v[64:67]
    v_mfma_f32_16x16x32_bf16 v[68:71], v[52:55], a[68:71], v[68:71]
    v_mfma_f32_16x16x32_bf16 v[64:67], v[40:43], a[72:75], v[64:67]
    v_mfma_f32_16x16x32_bf16 v[68:71], v[56:59], a[72:75], v[68:71]
    v_mfma_f32_16x16x32_bf16 v[64:67], v[44:47], a[76:79], v[64:67]
    v_mfma_f32_16x16x32_bf16 v[68:71], v[60:63], a[76:79], v[68:71]
    v_mfma_f32_16x16x32_bf16 v[72:75], v[32:35], a[80:83], 0
    v_mfma_f32_16x16x32_bf16 v[76:79], v[48:51], a[80:83], 0
    v_mfma_f32_16x16x32_bf16 v[72:75], v[36:39], a[84:87], v[72:75]
    v_mfma_f32_16x16x32_bf16 v[76:79], v[52:55], a[84:87], v[76:79]
    v_mfma_f32_16x16x32_bf16 v[72:75], v[40:43], a[88:91], v[72:75]
    v_mfma_f32_16x16x32_bf16 v[76:79], v[56:59], a[88:91], v[76:79]
    v_mfma_f32_16x16x32_bf16 v[72:75], v[44:47], a[92:95], v[72:75]
    v_mfma_f32_16x16x32_bf16 v[76:79], v[60:63], a[92:95], v[76:79]
    v_cvt_pk_bf16_f32 v64, v64, v65
    v_cvt_pk_bf16_f32 v65, v66, v67
    v_cvt_pk_bf16_f32 v66, v68, v69
    v_cvt_pk_bf16_f32 v67, v70, v71
    ds_write_b128 v10, v[64:67] offset:32768
    v_mfma_f32_16x16x32_bf16 v[80:83], v[32:35], a[96:99], 0
    v_mfma_f32_16x16x32_bf16 v[84:87], v[48:51], a[96:99], 0
    v_mfma_f32_16x16x32_bf16 v[80:83], v[36:39], a[100:103], v[80:83]
    v_mfma_f32_16x16x32_bf16 v[84:87], v[52:55], a[100:103], v[84:87]
    v_mfma_f32_16x16x32_bf16 v[80:83], v[40:43], a[104:107], v[80:83]
    v_mfma_f32_16x16x32_bf16 v[84:87], v[56:59], a[104:107], v[84:87]
    v_mfma_f32_16x16x32_bf16 v[80:83], v[44:47], a[108:111], v[80:83]
    v_mfma_f32_16x16x32_bf16 v[84:87], v[60:63], a[108:111], v[84:87]
    v_cvt_pk_bf16_f32 v72, v72, v73
    v_cvt_pk_bf16_f32 v73, v74, v75
    v_cvt_pk_bf16_f32 v74, v76, v77
    v_cvt_pk_bf16_f32 v75, v78, v79
    ds_write_b128 v10, v[72:75] offset:33792
    v_mfma_f32_16x16x32_bf16 v[88:91], v[32:35], a[112:115], 0
    v_mfma_f32_16x16x32_bf16 v[92:95], v[48:51], a[112:115], 0
    v_mfma_f32_16x16x32_bf16 v[88:91], v[36:39], a[116:119], v[88:91]
    v_mfma_f32_16x16x32_bf16 v[92:95], v[52:55], a[116:119], v[92:95]
    v_mfma_f32_16x16x32_bf16 v[88:91], v[40:43], a[120:123], v[88:91]
    v_mfma_f32_16x16x32_bf16 v[92:95], v[56:59], a[120:123], v[92:95]
    v_mfma_f32_16x16x32_bf16 v[88:91], v[44:47], a[124:127], v[88:91]
    v_mfma_f32_16x16x32_bf16 v[92:95], v[60:63], a[124:127], v[92:95]
    v_cvt_pk_bf16_f32 v80, v80, v81
    v_cvt_pk_bf16_f32 v81, v82, v83
    v_cvt_pk_bf16_f32 v82, v84, v85
    v_cvt_pk_bf16_f32 v83, v86, v87
    ds_write_b128 v10, v[80:83] offset:34816
    s_nop 2
    v_cvt_pk_bf16_f32 v88, v88, v89
    v_cvt_pk_bf16_f32 v89, v90, v91
    v_cvt_pk_bf16_f32 v90, v92, v93
    v_cvt_pk_bf16_f32 v91, v94, v95
    ds_write_b128 v10, v[88:91] offset:35840
L_v_gp_196:
    s_waitcnt vmcnt(2)
    v_pk_add_f32 v[16:17], v[96:97], v[100:101]
    v_pk_add_f32 v[18:19], v[98:99], v[102:103]
    s_waitcnt vmcnt(0)
    v_pk_add_f32 v[20:21], v[104:105], v[108:109]
    v_pk_add_f32 v[22:23], v[106:107], v[110:111]
    v_pk_add_f32 v[16:17], v[16:17], v[20:21]
    v_pk_add_f32 v[18:19], v[18:19], v[22:23]
    v_max3_u32 v24, v96, v97, v98
    v_max3_u32 v24, v24, v99, v100
    v_max3_u32 v24, v24, v101, v102
    v_max3_u32 v24, v24, v103, v104
    v_max3_u32 v24, v24, v105, v106
    v_max3_u32 v24, v24, v107, v108
    v_max3_u32 v24, v24, v109, v110
    v_max_u32 v24, v24, v111
    v_cmp_eq_u32 vcc, -1, v24
    s_add_u32 s70, s70, 1
    s_cbranch_vccz L_v_gok_197
    buffer_load_dwordx4 v[96:99], v7, s[12:15], s63 offen offset:0 sc1
    buffer_load_dwordx4 v[100:103], v7, s[12:15], s63 offen offset:512 sc1
    buffer_load_dwordx4 v[104:107], v7, s[12:15], s63 offen offset:1024 sc1
    buffer_load_dwordx4 v[108:111], v7, s[12:15], s63 offen offset:1536 sc1
    s_cmp_lt_u32 s70, 524288
    s_cbranch_scc1 L_v_gp_196
    s_branch L_c_done_4
L_v_gok_197:
    v_add_f32_dpp v20, v16, v16 row_ror:8 row_mask:0xf bank_mask:0x3
    v_add_f32_dpp v21, v17, v17 row_ror:8 row_mask:0xf bank_mask:0x3
    v_add_f32_dpp v20, v18, v18 row_ror:8 row_mask:0xf bank_mask:0xc
    v_add_f32_dpp v21, v19, v19 row_ror:8 row_mask:0xf bank_mask:0xc
    v_cvt_pk_bf16_f32 v20, v20, v21
    v_min_u32 v20, -2, v20
    buffer_store_dword v20, v8, s[12:15], s61 offen
    s_xor_b32 s45, s61, 0x8000
    buffer_store_dword v26, v8, s[12:15], s45 offen
    s_bitcmp1_b32 s44, 0
    s_cbranch_scc1 L_v_nr_198
    s_xor_b32 s45, s62, 0x4000
    buffer_store_dword v26, v4, s[12:15], s45 offen
L_v_nr_198:
    s_add_u32 s60, s60, 1
    s_add_u32 s62, s62, 0x2000
    s_and_b32 s62, s62, 0x7fff
    s_add_u32 s63, s63, 262144
    s_sleep 3
    s_branch L_v_loop_188
L_v_last_191:
    s_waitcnt lgkmcnt(0)
    s_barrier
    s_branch L_c_done_4
L_vs_171:
L_v_loop_199:
    s_mov_b32 s70, 0
L_v_l1_200:
    buffer_load_dwordx4 v[64:67], v9, s[12:15], s61 offen offset:0 sc1
    buffer_load_dwordx4 v[68:71], v9, s[12:15], s61 offen offset:1024 sc1
    buffer_load_dwordx4 v[72:75], v9, s[12:15], s61 offen offset:2048 sc1
    buffer_load_dwordx4 v[76:79], v9, s[12:15], s61 offen offset:3072 sc1
    v_mov_b32 v16, 0
    v_mov_b32 v17, 0
    v_mov_b32 v18, 0
    v_mov_b32 v19, 0
    s_waitcnt vmcnt(3)
    ds_write_b128 v10, v[64:67] offset:0
    s_waitcnt vmcnt(2)
    ds_write_b128 v10, v[68:71] offset:1024
    s_waitcnt vmcnt(1)
    ds_write_b128 v10, v[72:75] offset:2048
    s_waitcnt vmcnt(0)
    ds_write_b128 v10, v[76:79] offset:3072
    v_max3_u32 v20, v64, v65, v66
    v_max3_u32 v20, v20, v67, v68
    v_max3_u32 v20, v20, v69, v70
    v_max3_u32 v20, v20, v71, v72
    v_max3_u32 v20, v20, v73, v74
    v_max3_u32 v20, v20, v75, v76
    v_max3_u32 v20, v20, v77, v78
    v_max_u32 v20, v20, v79
    v_cmp_eq_u32 vcc, -1, v20
    s_add_u32 s70, s70, 1
    s_cbranch_vccz L_ok_201
    s_cmp_lt_u32 s70, 524288
    s_cbranch_scc1 L_v_l1_200
    s_branch L_c_done_4
L_ok_201:
    s_waitcnt lgkmcnt(0)
    s_barrier
    ds_read_b128 v[64:67], v13 offset:0
    ds_read_b128 v[68:71], v13 offset:1024
    ds_read_b128 v[72:75], v13 offset:2048
    ds_read_b128 v[76:79], v13 offset:3072
    ds_read_b128 v[80:83], v13 offset:4096
    ds_read_b128 v[84:87], v13 offset:5120
    ds_read_b128 v[88:91], v13 offset:6144
    ds_read_b128 v[92:95], v13 offset:7168
    v_mov_b32 v96, 0
    v_mov_b32 v97, 0
    v_mov_b32 v98, 0
    v_mov_b32 v99, 0
    v_mov_b32 v100, 0
    v_mov_b32 v101, 0
    v_mov_b32 v102, 0
    v_mov_b32 v103, 0
    v_mov_b32 v104, 0
    v_mov_b32 v105, 0
    v_mov_b32 v106, 0
    v_mov_b32 v107, 0
    v_mov_b32 v108, 0
    v_mov_b32 v109, 0
    v_mov_b32 v110, 0
    v_mov_b32 v111, 0
    s_waitcnt lgkmcnt(7)
    v_smfmac_f32_16x16x64_bf16 v[16:19], v[64:67], a[0:7], v3
    s_waitcnt lgkmcnt(6)
    v_smfmac_f32_16x16x64_bf16 v[16:19], v[68:71], a[8:15], v3
    s_waitcnt lgkmcnt(5)
    v_smfmac_f32_16x16x64_bf16 v[16:19], v[72:75], a[16:23], v3
    s_waitcnt lgkmcnt(4)
    v_smfmac_f32_16x16x64_bf16 v[16:19], v[76:79], a[24:31], v3
    s_waitcnt lgkmcnt(3)
    v_smfmac_f32_16x16x64_bf16 v[16:19], v[80:83], a[32:39], v3
    s_waitcnt lgkmcnt(2)
    v_smfmac_f32_16x16x64_bf16 v[16:19], v[84:87], a[40:47], v3
    s_waitcnt lgkmcnt(1)
    v_smfmac_f32_16x16x64_bf16 v[16:19], v[88:91], a[48:55], v3
    s_waitcnt lgkmcnt(0)
    v_smfmac_f32_16x16x64_bf16 v[16:19], v[92:95], a[56:63], v3
    s_nop 7
    v_permlane32_swap_b32 v16, v18
    v_permlane32_swap_b32 v17, v19
    v_add_f32 v16, v16, v18
    v_add_f32 v17, v17, v19
    s_bitcmp1_b32 s44, 0
    s_cbranch_scc0 L_v_k0_203
    ds_write_b64 v14, v[16:17]
    s_waitcnt lgkmcnt(0)
    s_barrier
    s_branch L_v_k1_204
L_v_k0_203:
    s_barrier
    ds_read_b64 v[20:21], v14
    s_waitcnt lgkmcnt(0)
    v_add_f32 v16, v16, v20
    v_add_f32 v17, v17, v21
    s_mov_b32 vcc_lo, 0x55555555
    s_mov_b32 vcc_hi, 0x55555555
    v_cndmask_b32_dpp v18, v17, v16, vcc quad_perm:[1,0,3,2] row_mask:0xf bank_mask:0xf
    s_not_b64 vcc, vcc
    v_cndmask_b32_dpp v19, v16, v17, vcc quad_perm:[1,0,3,2] row_mask:0xf bank_mask:0xf
    v_cvt_pk_bf16_f32 v18, v18, v19
    v_min_u32 v18, -2, v18
    buffer_store_dword v18, v4, s[12:15], s62 offen sc1
    ds_write_b32 v5, v18
L_v_k1_204:
    s_cmp_eq_u32 s60, 63
    s_cbranch_scc1 L_v_last_202
    ds_read_b128 v[80:83], v27 offset:32768
    ds_read_b128 v[84:87], v27 offset:36864
    ds_read_b128 v[88:91], v27 offset:40960
    ds_read_b128 v[92:95], v27 offset:45056
    s_sleep 5
    s_mov_b32 s70, 0
L_v_vp_205:
    buffer_load_dwordx4 v[64:67], v11, s[12:15], s62 offen offset:0 sc1
    buffer_load_dwordx4 v[68:71], v11, s[12:15], s62 offen offset:1024 sc1
    s_waitcnt vmcnt(0)
    v_max3_u32 v20, v64, v65, v66
    v_max3_u32 v20, v20, v67, v68
    v_max3_u32 v20, v20, v69, v70
    v_max_u32 v20, v20, v71
    v_cmp_eq_u32 vcc, -1, v20
    s_add_u32 s70, s70, 1
    s_cbranch_vccz L_ok_206
    s_cmp_lt_u32 s70, 524288
    s_cbranch_scc1 L_v_vp_205
    s_branch L_c_done_4
L_ok_206:
    v_smfmac_f32_16x16x64_bf16 v[96:99], v[64:67], a[64:71], v3
    v_smfmac_f32_16x16x64_bf16 v[96:99], v[68:71], a[72:79], v3
    v_smfmac_f32_16x16x64_bf16 v[100:103], v[64:67], a[80:87], v3
    v_smfmac_f32_16x16x64_bf16 v[100:103], v[68:71], a[88:95], v3
    v_smfmac_f32_16x16x64_bf16 v[104:107], v[64:67], a[96:103], v3
    v_smfmac_f32_16x16x64_bf16 v[104:107], v[68:71], a[104:111], v3
    v_smfmac_f32_16x16x64_bf16 v[108:111], v[64:67], a[112:119], v3
    v_smfmac_f32_16x16x64_bf16 v[108:111], v[68:71], a[120:127], v3
    s_add_u32 s46, s65, 4096
    buffer_load_dwordx4 v[32:35], v15, s[12:15], s65 offen offset:0 sc1
    buffer_load_dwordx4 v[48:51], v15, s[12:15], s46 offen offset:0 sc1
    buffer_load_dwordx4 v[36:39], v15, s[12:15], s65 offen offset:1024 sc1
    buffer_load_dwordx4 v[52:55], v15, s[12:15], s46 offen offset:1024 sc1
    buffer_load_dwordx4 v[40:43], v15, s[12:15], s65 offen offset:2048 sc1
    buffer_load_dwordx4 v[56:59], v15, s[12:15], s46 offen offset:2048 sc1
    buffer_load_dwordx4 v[44:47], v15, s[12:15], s65 offen offset:3072 sc1
    buffer_load_dwordx4 v[60:63], v15, s[12:15], s46 offen offset:3072 sc1
    s_add_u32 s65, s65, 786432
    v_permlane32_swap_b32 v96, v98
    v_permlane32_swap_b32 v97, v99
    v_add_f32 v96, v96, v98
    v_add_f32 v97, v97, v99
    v_cvt_pk_bf16_f32 v96, v96, v97
    ds_write_b32 v12, v96 offset:0
    v_permlane32_swap_b32 v100, v102
    v_permlane32_swap_b32 v101, v103
    v_add_f32 v100, v100, v102
    v_add_f32 v101, v101, v103
    v_cvt_pk_bf16_f32 v100, v100, v101
    ds_write_b32 v12, v100 offset:1024
    v_permlane32_swap_b32 v104, v106
    v_permlane32_swap_b32 v105, v107
    v_add_f32 v104, v104, v106
    v_add_f32 v105, v105, v107
    v_cvt_pk_bf16_f32 v104, v104, v105
    ds_write_b32 v12, v104 offset:2048
    v_permlane32_swap_b32 v108, v110
    v_permlane32_swap_b32 v109, v111
    v_add_f32 v108, v108, v110
    v_add_f32 v109, v109, v111
    v_cvt_pk_bf16_f32 v108, v108, v109
    ds_write_b32 v12, v108 offset:3072
    s_waitcnt lgkmcnt(0)
    s_barrier
    ds_read_b128 v[96:99], v2 offset:16384
    ds_read_b128 v[100:103], v2 offset:17408
    ds_read_b128 v[104:107], v2 offset:18432
    ds_read_b128 v[108:111], v2 offset:19456
    ds_read_b128 v[112:115], v2 offset:20480
    ds_read_b128 v[116:119], v27 offset:21504
    s_waitcnt lgkmcnt(5)
    v_mfma_f32_16x16x32_bf16 v[16:19], v[80:83], v[96:99], 0
    s_waitcnt lgkmcnt(4)
    v_mfma_f32_16x16x32_bf16 v[16:19], v[84:87], v[100:103], v[16:19]
    s_waitcnt lgkmcnt(3)
    v_mfma_f32_16x16x32_bf16 v[16:19], v[88:91], v[104:107], v[16:19]
    s_waitcnt lgkmcnt(2)
    v_mfma_f32_16x16x32_bf16 v[16:19], v[92:95], v[108:111], v[16:19]
    s_waitcnt lgkmcnt(0)
    v_mfma_f32_16x16x32_bf16 v[16:19], v[116:119], v[112:115], v[16:19]
    s_mov_b32 exec_lo, 0x00ff00ff
    s_mov_b32 exec_hi, 0x00ff00ff
    s_nop 5
    v_min_u32 v16, -2, v16
    v_min_u32 v17, -2, v17
    v_min_u32 v18, -2, v18
    v_min_u32 v19, -2, v19
    buffer_store_dwordx4 v[16:19], v6, s[12:15], s63 offen sc1
    s_mov_b64 exec, -1
    s_add_u32 s61, s61, 0x4000
    s_and_b32 s61, s61, 0xffff
    s_mov_b32 s70, 0
    s_sleep 12
    s_waitcnt vmcnt(1)
    buffer_load_dwordx4 v[96:99], v7, s[12:15], s63 offen offset:0 sc1
    buffer_load_dwordx4 v[100:103], v7, s[12:15], s63 offen offset:512 sc1
    buffer_load_dwordx4 v[104:107], v7, s[12:15], s63 offen offset:1024 sc1
    buffer_load_dwordx4 v[108:111], v7, s[12:15], s63 offen offset:1536 sc1
    v_mfma_f32_16x16x32_bf16 v[64:67], v[32:35], a[64:67], 0
    v_mfma_f32_16x16x32_bf16 v[68:71], v[48:51], a[64:67], 0
    v_mfma_f32_16x16x32_bf16 v[64:67], v[36:39], a[68:71], v[64:67]
    v_mfma_f32_16x16x32_bf16 v[68:71], v[52:55], a[68:71], v[68:71]
    v_mfma_f32_16x16x32_bf16 v[64:67], v[40:43], a[72:75], v[64:67]
    v_mfma_f32_16x16x32_bf16 v[68:71], v[56:59], a[72:75], v[68:71]
    v_mfma_f32_16x16x32_bf16 v[64:67], v[44:47], a[76:79], v[64:67]
    v_mfma_f32_16x16x32_bf16 v[68:71], v[60:63], a[76:79], v[68:71]
    v_mfma_f32_16x16x32_bf16 v[72:75], v[32:35], a[80:83], 0
    v_mfma_f32_16x16x32_bf16 v[76:79], v[48:51], a[80:83], 0
    v_mfma_f32_16x16x32_bf16 v[72:75], v[36:39], a[84:87], v[72:75]
    v_mfma_f32_16x16x32_bf16 v[76:79], v[52:55], a[84:87], v[76:79]
    v_mfma_f32_16x16x32_bf16 v[72:75], v[40:43], a[88:91], v[72:75]
    v_mfma_f32_16x16x32_bf16 v[76:79], v[56:59], a[88:91], v[76:79]
    v_mfma_f32_16x16x32_bf16 v[72:75], v[44:47], a[92:95], v[72:75]
    v_mfma_f32_16x16x32_bf16 v[76:79], v[60:63], a[92:95], v[76:79]
    v_cvt_pk_bf16_f32 v64, v64, v65
    v_cvt_pk_bf16_f32 v65, v66, v67
    v_cvt_pk_bf16_f32 v66, v68, v69
    v_cvt_pk_bf16_f32 v67, v70, v71
    ds_write_b128 v10, v[64:67] offset:32768
    v_mfma_f32_16x16x32_bf16 v[80:83], v[32:35], a[96:99], 0
    v_mfma_f32_16x16x32_bf16 v[84:87], v[48:51], a[96:99], 0
    v_mfma_f32_16x16x32_bf16 v[80:83], v[36:39], a[100:103], v[80:83]
    v_mfma_f32_16x16x32_bf16 v[84:87], v[52:55], a[100:103], v[84:87]
    v_mfma_f32_16x16x32_bf16 v[80:83], v[40:43], a[104:107], v[80:83]
    v_mfma_f32_16x16x32_bf16 v[84:87], v[56:59], a[104:107], v[84:87]
    v_mfma_f32_16x16x32_bf16 v[80:83], v[44:47], a[108:111], v[80:83]
    v_mfma_f32_16x16x32_bf16 v[84:87], v[60:63], a[108:111], v[84:87]
    v_cvt_pk_bf16_f32 v72, v72, v73
    v_cvt_pk_bf16_f32 v73, v74, v75
    v_cvt_pk_bf16_f32 v74, v76, v77
    v_cvt_pk_bf16_f32 v75, v78, v79
    ds_write_b128 v10, v[72:75] offset:33792
    v_mfma_f32_16x16x32_bf16 v[88:91], v[32:35], a[112:115], 0
    v_mfma_f32_16x16x32_bf16 v[92:95], v[48:51], a[112:115], 0
    v_mfma_f32_16x16x32_bf16 v[88:91], v[36:39], a[116:119], v[88:91]
    v_mfma_f32_16x16x32_bf16 v[92:95], v[52:55], a[116:119], v[92:95]
    v_mfma_f32_16x16x32_bf16 v[88:91], v[40:43], a[120:123], v[88:91]
    v_mfma_f32_16x16x32_bf16 v[92:95], v[56:59], a[120:123], v[92:95]
    v_mfma_f32_16x16x32_bf16 v[88:91], v[44:47], a[124:127], v[88:91]
    v_mfma_f32_16x16x32_bf16 v[92:95], v[60:63], a[124:127], v[92:95]
    v_cvt_pk_bf16_f32 v80, v80, v81
    v_cvt_pk_bf16_f32 v81, v82, v83
    v_cvt_pk_bf16_f32 v82, v84, v85
    v_cvt_pk_bf16_f32 v83, v86, v87
    ds_write_b128 v10, v[80:83] offset:34816
    s_nop 2
    v_cvt_pk_bf16_f32 v88, v88, v89
    v_cvt_pk_bf16_f32 v89, v90, v91
    v_cvt_pk_bf16_f32 v90, v92, v93
    v_cvt_pk_bf16_f32 v91, v94, v95
    ds_write_b128 v10, v[88:91] offset:35840
L_v_gp_207:
    s_waitcnt vmcnt(2)
    v_pk_add_f32 v[16:17], v[96:97], v[100:101]
    v_pk_add_f32 v[18:19], v[98:99], v[102:103]
    s_waitcnt vmcnt(0)
    v_pk_add_f32 v[20:21], v[104:105], v[108:109]
    v_pk_add_f32 v[22:23], v[106:107], v[110:111]
    v_pk_add_f32 v[16:17], v[16:17], v[20:21]
    v_pk_add_f32 v[18:19], v[18:19], v[22:23]
    v_max3_u32 v24, v96, v97, v98
    v_max3_u32 v24, v24, v99, v100
    v_max3_u32 v24, v24, v101, v102
    v_max3_u32 v24, v24, v103, v104
    v_max3_u32 v24, v24, v105, v106
    v_max3_u32 v24, v24, v107, v108
    v_max3_u32 v24, v24, v109, v110
    v_max_u32 v24, v24, v111
    v_cmp_eq_u32 vcc, -1, v24
    s_add_u32 s70, s70, 1
    s_cbranch_vccz L_v_gok_208
    buffer_load_dwordx4 v[96:99], v7, s[12:15], s63 offen offset:0 sc1
    buffer_load_dwordx4 v[100:103], v7, s[12:15], s63 offen offset:512 sc1
    buffer_load_dwordx4 v[104:107], v7, s[12:15], s63 offen offset:1024 sc1
    buffer_load_dwordx4 v[108:111], v7, s[12:15], s63 offen offset:1536 sc1
    s_cmp_lt_u32 s70, 524288
    s_cbranch_scc1 L_v_gp_207
    s_branch L_c_done_4
L_v_gok_208:
    v_add_f32_dpp v20, v16, v16 row_ror:8 row_mask:0xf bank_mask:0x3
    v_add_f32_dpp v21, v17, v17 row_ror:8 row_mask:0xf bank_mask:0x3
    v_add_f32_dpp v20, v18, v18 row_ror:8 row_mask:0xf bank_mask:0xc
    v_add_f32_dpp v21, v19, v19 row_ror:8 row_mask:0xf bank_mask:0xc
    v_cvt_pk_bf16_f32 v20, v20, v21
    v_min_u32 v20, -2, v20
    buffer_store_dword v20, v8, s[12:15], s61 offen sc1
    s_xor_b32 s45, s61, 0x8000
    buffer_store_dword v26, v8, s[12:15], s45 offen sc1
    s_bitcmp1_b32 s44, 0
    s_cbranch_scc1 L_v_nr_209
    s_xor_b32 s45, s62, 0x4000
    buffer_store_dword v26, v4, s[12:15], s45 offen sc1
L_v_nr_209:
    s_add_u32 s60, s60, 1
    s_add_u32 s62, s62, 0x2000
    s_and_b32 s62, s62, 0x7fff
    s_add_u32 s63, s63, 262144
    s_sleep 3
    s_branch L_v_loop_199
L_v_last_202:
    s_waitcnt lgkmcnt(0)
    s_barrier
    s_branch L_c_done_4
L_c_done_4:
    s_endpgm
.section .rodata,"a"
.p2align 6
.amdhsa_kernel k0_mod_kernel
  .amdhsa_next_free_vgpr 128
  .amdhsa_next_free_sgpr 102
  .amdhsa_accum_offset 128
  .amdhsa_group_segment_fixed_size 0
  .amdhsa_kernarg_size 136
  .amdhsa_user_sgpr_count 2
  .amdhsa_user_sgpr_kernarg_segment_ptr 1
  .amdhsa_system_sgpr_workgroup_id_x 1
.end_amdhsa_kernel
.p2align 6
.amdhsa_kernel k3_chain_kernel
  .amdhsa_next_free_vgpr 256
  .amdhsa_next_free_sgpr 102
  .amdhsa_accum_offset 128
  .amdhsa_group_segment_fixed_size 0
  .amdhsa_kernarg_size 136
  .amdhsa_user_sgpr_count 2
  .amdhsa_user_sgpr_kernarg_segment_ptr 1
  .amdhsa_system_sgpr_workgroup_id_x 1
.end_amdhsa_kernel
```

```asm
; @launch kernel=k3_chain_kernel grid=(256,1,1) block=(512,1,1) lds=147712
.amdgcn_target "amdgcn-amd-amdhsa--gfx950"
.text
.globl k3_chain_kernel
.p2align 8
.type k3_chain_kernel,@function
k3_chain_kernel:
    s_cmp_ge_u32 s2, 256
    s_cbranch_scc1 L_c_done_1
    s_load_dwordx4 s[20:23], s[0:1], 120
    v_and_b32 v1, 63, v0
    v_lshrrev_b32 v2, 6, v0
    s_nop 0
    v_readfirstlane_b32 s44, v2
    s_waitcnt lgkmcnt(0)
    s_mov_b32 s12, s22
    s_and_b32 s13, s23, 0xffff
    s_mov_b32 s14, 0x10000000
    s_mov_b32 s15, 0x00020000
    s_mov_b32 s16, s20
    s_and_b32 s17, s21, 0xffff
    s_mov_b32 s18, 0x100
    s_mov_b32 s19, 0x00020000
    s_load_dwordx4 s[8:11], s[0:1], 96
    v_lshrrev_b32 v5, 3, v0
    v_mul_u32_u24 v6, 24576, v5
    v_and_b32 v7, 7, v0
    v_lshl_add_u32 v6, v7, 4, v6
    v_add_u32 v7, 12288, v6
    v_lshlrev_b32 v5, 2, v5
    s_lshr_b32 s50, s2, 5
    s_and_b32 s51, s2, 31
    s_mul_i32 s52, s50, 1572864
    s_lshl_b32 s53, s51, 7
    s_add_u32 s52, s52, s53
    s_lshl_b32 s53, s50, 8
    s_waitcnt lgkmcnt(0)
    s_mov_b32 s28, s10
    s_and_b32 s29, s11, 0xffff
    s_mov_b32 s30, 0xc00000
    s_mov_b32 s31, 0x00020000
    s_mov_b32 s32, s8
    s_and_b32 s33, s9, 0xffff
    s_mov_b32 s34, 0x800
    s_mov_b32 s35, 0x00020000
    buffer_load_dword v8, v5, s[32:35], s53 offen
    buffer_load_dwordx4 v[12:15], v6, s[28:31], s52 offen
    buffer_load_dwordx4 v[16:19], v7, s[28:31], s52 offen
    s_getreg_b32 s39, hwreg(HW_REG_XCC_ID)
    s_and_b32 s39, s39, 7
    s_cmp_lg_u32 s44, 1
    s_cbranch_scc1 L_nz_5
    v_mov_b32 v3, 0
    v_lshlrev_b32 v4, 2, v1
    s_lshl_b32 s45, s2, 8
    s_add_u32 s45, s45, 0x100000
    buffer_store_dword v3, v4, s[12:15], s45 offen sc1
L_nz_5:
    s_waitcnt vmcnt(0)
    v_lshlrev_b32 v9, 16, v8
    v_and_b32 v10, 0xffff0000, v8
    v_mul_f32 v20, 0xbfb8aa3b, v9
    v_mul_f32 v21, 0xbfb8aa3b, v10
    v_exp_f32 v20, v20
    v_exp_f32 v21, v21
    s_nop 0
    v_add_f32 v20, 1.0, v20
    v_add_f32 v21, 1.0, v21
    v_rcp_f32 v20, v20
    v_rcp_f32 v21, v21
    s_nop 0
    v_mul_f32 v9, v9, v20
    v_mul_f32 v10, v10, v21
    v_cvt_pk_bf16_f32 v9, 0, v9
    v_cvt_pk_bf16_f32 v10, 0, v10
    v_lshlrev_b32 v28, 16, v12
    v_and_b32 v29, 0xffff0000, v12
    v_lshlrev_b32 v30, 16, v16
    v_and_b32 v31, 0xffff0000, v16
    v_mul_f32 v20, v28, v9
    v_mul_f32 v21, v29, v9
    v_fmac_f32 v20, v30, v10
    v_fmac_f32 v21, v31, v10
    v_lshlrev_b32 v28, 16, v13
    v_and_b32 v29, 0xffff0000, v13
    v_lshlrev_b32 v30, 16, v17
    v_and_b32 v31, 0xffff0000, v17
    v_mul_f32 v22, v28, v9
    v_mul_f32 v23, v29, v9
    v_fmac_f32 v22, v30, v10
    v_fmac_f32 v23, v31, v10
    v_lshlrev_b32 v28, 16, v14
    v_and_b32 v29, 0xffff0000, v14
    v_lshlrev_b32 v30, 16, v18
    v_and_b32 v31, 0xffff0000, v18
    v_mul_f32 v24, v28, v9
    v_mul_f32 v25, v29, v9
    v_fmac_f32 v24, v30, v10
    v_fmac_f32 v25, v31, v10
    v_lshlrev_b32 v28, 16, v15
    v_and_b32 v29, 0xffff0000, v15
    v_lshlrev_b32 v30, 16, v19
    v_and_b32 v31, 0xffff0000, v19
    v_mul_f32 v26, v28, v9
    v_mul_f32 v27, v29, v9
    v_fmac_f32 v26, v30, v10
    v_fmac_f32 v27, v31, v10
    s_nop 1
    v_add_f32_dpp v20, v20, v20 row_ror:8 row_mask:0xf bank_mask:0xf
    v_add_f32_dpp v21, v21, v21 row_ror:8 row_mask:0xf bank_mask:0xf
    v_add_f32_dpp v22, v22, v22 row_ror:8 row_mask:0xf bank_mask:0xf
    v_add_f32_dpp v23, v23, v23 row_ror:8 row_mask:0xf bank_mask:0xf
    v_add_f32_dpp v24, v24, v24 row_ror:8 row_mask:0xf bank_mask:0xf
    v_add_f32_dpp v25, v25, v25 row_ror:8 row_mask:0xf bank_mask:0xf
    v_add_f32_dpp v26, v26, v26 row_ror:8 row_mask:0xf bank_mask:0xf
    v_add_f32_dpp v27, v27, v27 row_ror:8 row_mask:0xf bank_mask:0xf
    s_nop 1
    v_permlane16_swap_b32 v20, v24
    v_permlane16_swap_b32 v21, v25
    v_permlane16_swap_b32 v22, v26
    v_permlane16_swap_b32 v23, v27
    v_add_f32 v20, v20, v24
    v_add_f32 v21, v21, v25
    v_add_f32 v22, v22, v26
    v_add_f32 v23, v23, v27
    s_nop 1
    v_permlane32_swap_b32 v20, v22
    v_permlane32_swap_b32 v21, v23
    v_add_f32 v20, v20, v22
    v_add_f32 v21, v21, v23
    v_and_b32 v22, 7, v1
    v_lshlrev_b32 v22, 5, v22
    v_bfe_u32 v23, v1, 4, 1
    v_lshl_add_u32 v22, v23, 4, v22
    v_lshrrev_b32 v23, 5, v1
    v_lshl_add_u32 v22, v23, 3, v22
    s_lshl_b32 s52, s44, 8
    s_add_u32 s52, s52, 139776
    v_add_u32 v22, s52, v22
    ds_write_b64 v22, v[20:21]
    s_waitcnt lgkmcnt(0)
    s_barrier
    s_cmp_lg_u32 s44, 1
    s_cbranch_scc1 L_m1_6
    v_lshlrev_b32 v22, 2, v1
    v_add_u32 v23, 139776, v22
    ds_read_b32 v24, v23 offset:0
    ds_read_b32 v25, v23 offset:256
    ds_read_b32 v26, v23 offset:512
    ds_read_b32 v27, v23 offset:768
    ds_read_b32 v28, v23 offset:1024
    ds_read_b32 v29, v23 offset:1280
    ds_read_b32 v30, v23 offset:1536
    ds_read_b32 v31, v23 offset:1792
    s_waitcnt lgkmcnt(0)
    v_add_f32 v24, v24, v28
    v_add_f32 v25, v25, v29
    v_add_f32 v26, v26, v30
    v_add_f32 v27, v27, v31
    v_add_f32 v24, v24, v26
    v_add_f32 v25, v25, v27
    v_add_f32 v24, v24, v25
    s_lshl_b32 s52, s2, 8
    s_add_u32 s52, s52, 0x10000
    buffer_store_dword v24, v22, s[12:15], s52 offen sc1
L_m1_6:
    s_cmp_lg_u32 s44, 1
    s_cbranch_scc1 L_tk_2
    v_mov_b32 v3, 1
    s_lshl_b32 s45, s39, 5
    v_mov_b32 v4, 0
    s_waitcnt vmcnt(0)
    s_mov_b64 exec, 1
    buffer_atomic_add v3, v4, s[16:19], s45 offen sc0
    s_waitcnt vmcnt(0)
    v_readfirstlane_b32 s41, v3
    s_mov_b32 s40, s39
    s_nop 3
    s_cmp_lt_u32 s41, 32
    s_cbranch_scc1 L_got_3
    v_mov_b32 v3, 1
    buffer_atomic_add v3, v4, s[16:19], 0 offen offset:16 sc0
    s_waitcnt vmcnt(0)
    v_readfirstlane_b32 s46, v3
    s_mov_b64 exec, -1
    v_and_b32 v4, 7, v1
    v_lshlrev_b32 v4, 5, v4
    s_mov_b32 s70, 0
L_sp_4:
    s_sleep 8
    buffer_load_dword v3, v4, s[16:19], 0 offen sc1
    s_waitcnt vmcnt(0)
    s_mov_b32 s48, 0
    v_readlane_b32 s50, v3, 0
    v_readlane_b32 s51, v3, 1
    v_readlane_b32 s52, v3, 2
    v_readlane_b32 s53, v3, 3
    v_readlane_b32 s54, v3, 4
    v_readlane_b32 s55, v3, 5
    v_readlane_b32 s56, v3, 6
    v_readlane_b32 s57, v3, 7
    s_nop 3
    s_add_u32 s48, s48, s50
    s_add_u32 s48, s48, s51
    s_add_u32 s48, s48, s52
    s_add_u32 s48, s48, s53
    s_add_u32 s48, s48, s54
    s_add_u32 s48, s48, s55
    s_add_u32 s48, s48, s56
    s_add_u32 s48, s48, s57
    s_add_u32 s70, s70, 1
    s_cmp_ge_u32 s70, 524288
    s_cbranch_scc1 L_c_done_1
    s_cmp_lt_u32 s48, 256
    s_cbranch_scc1 L_sp_4
    s_min_u32 s48, s50, 32
    s_mov_b32 s40, 0
    s_add_u32 s41, s48, s46
    s_cmp_lt_u32 s41, 32
    s_cbranch_scc1 L_got_3
    s_sub_u32 s46, s41, 32
    s_min_u32 s48, s51, 32
    s_mov_b32 s40, 1
    s_add_u32 s41, s48, s46
    s_cmp_lt_u32 s41, 32
    s_cbranch_scc1 L_got_3
    s_sub_u32 s46, s41, 32
    s_min_u32 s48, s52, 32
    s_mov_b32 s40, 2
    s_add_u32 s41, s48, s46
    s_cmp_lt_u32 s41, 32
    s_cbranch_scc1 L_got_3
    s_sub_u32 s46, s41, 32
    s_min_u32 s48, s53, 32
    s_mov_b32 s40, 3
    s_add_u32 s41, s48, s46
    s_cmp_lt_u32 s41, 32
    s_cbranch_scc1 L_got_3
    s_sub_u32 s46, s41, 32
    s_min_u32 s48, s54, 32
    s_mov_b32 s40, 4
    s_add_u32 s41, s48, s46
    s_cmp_lt_u32 s41, 32
    s_cbranch_scc1 L_got_3
    s_sub_u32 s46, s41, 32
    s_min_u32 s48, s55, 32
    s_mov_b32 s40, 5
    s_add_u32 s41, s48, s46
    s_cmp_lt_u32 s41, 32
    s_cbranch_scc1 L_got_3
    s_sub_u32 s46, s41, 32
    s_min_u32 s48, s56, 32
    s_mov_b32 s40, 6
    s_add_u32 s41, s48, s46
    s_cmp_lt_u32 s41, 32
    s_cbranch_scc1 L_got_3
    s_sub_u32 s46, s41, 32
    s_min_u32 s48, s57, 32
    s_mov_b32 s40, 7
    s_add_u32 s41, s48, s46
    s_cmp_lt_u32 s41, 32
    s_cbranch_scc1 L_got_3
    s_sub_u32 s46, s41, 32
    s_branch L_c_done_1
L_got_3:
    s_mov_b64 exec, -1
    s_lshl_b32 s45, s40, 8
    s_or_b32 s45, s45, s41
    v_mov_b32 v3, s45
    v_mov_b32 v4, 147464
    ds_write_b32 v4, v3
    s_waitcnt lgkmcnt(0)
L_tk_2:
    s_barrier
    v_mov_b32 v4, 147464
    ds_read_b32 v3, v4
    s_waitcnt lgkmcnt(0)
    v_readfirstlane_b32 s45, v3
    s_nop 3
    s_lshr_b32 s40, s45, 8
    s_and_b32 s41, s45, 0xff
    s_cmp_lt_u32 s41, 16
    s_cbranch_scc1 L_c_chain_7
    s_sub_u32 s48, s41, 16
    s_cmp_lt_u32 s48, 12
    s_cbranch_scc1 L_w_g_8
    s_and_b32 s42, s48, 3
    s_mov_b32 s43, s40
    s_load_dwordx2 s[4:5], s[0:1], 0
    v_lshlrev_b32 v2, 4, v1
    v_lshlrev_b32 v3, 5, v1
    s_lshl_b32 s55, s43, 2
    s_add_u32 s55, s55, s42
    s_waitcnt lgkmcnt(0)
    s_mov_b32 s24, s4
    s_and_b32 s25, s5, 0xffff
    s_mov_b32 s26, 0x400000
    s_mov_b32 s27, 0x00020000
    s_lshl_b32 s46, s42, 3
    s_add_u32 s46, s46, s44
    s_lshl_b32 s46, s46, 11
    v_add_u32 v7, s46, v2
    s_lshl_b32 s63, s43, 16
    buffer_load_dwordx4 a[0:3], v7, s[24:27], s63 offen
    buffer_load_dwordx4 a[4:7], v7, s[24:27], s63 offen offset:1024
    s_cmp_lg_u32 s44, 0
    s_cbranch_scc1 L_zwok_17
    v_and_b32 v8, 7, v1
    v_lshlrev_b32 v8, 5, v8
    s_mov_b32 s70, 0
L_zw_16:
    buffer_load_dword v9, v8, s[16:19], 0 offen sc1
    s_waitcnt vmcnt(0)
    v_add_u32_dpp v9, v9, v9 row_ror:1 row_mask:0xf bank_mask:0xf
    s_nop 1
    v_add_u32_dpp v9, v9, v9 row_ror:2 row_mask:0xf bank_mask:0xf
    s_nop 1
    v_add_u32_dpp v9, v9, v9 row_ror:4 row_mask:0xf bank_mask:0xf
    v_cmp_ne_u32 vcc, 0x100, v9
    s_add_u32 s70, s70, 1
    s_cbranch_vccz L_zwok_17
    s_sleep 4
    s_cmp_lt_u32 s70, 524288
    s_cbranch_scc1 L_zw_16
    s_branch L_c_done_1
L_zwok_17:
    s_barrier
    v_lshlrev_b32 v4, 4, v0
    s_mov_b32 s46, 0x10000
    buffer_load_dwordx4 v[32:35], v4, s[12:15], s46 offen sc1
    s_mov_b32 s46, 0x12000
    buffer_load_dwordx4 v[36:39], v4, s[12:15], s46 offen sc1
    s_mov_b32 s46, 0x14000
    buffer_load_dwordx4 v[40:43], v4, s[12:15], s46 offen sc1
    s_mov_b32 s46, 0x16000
    buffer_load_dwordx4 v[44:47], v4, s[12:15], s46 offen sc1
    s_mov_b32 s46, 0x18000
    buffer_load_dwordx4 v[48:51], v4, s[12:15], s46 offen sc1
    s_mov_b32 s46, 0x1a000
    buffer_load_dwordx4 v[52:55], v4, s[12:15], s46 offen sc1
    s_mov_b32 s46, 0x1c000
    buffer_load_dwordx4 v[56:59], v4, s[12:15], s46 offen sc1
    s_mov_b32 s46, 0x1e000
    buffer_load_dwordx4 v[60:63], v4, s[12:15], s46 offen sc1
    s_cmp_lg_u32 s44, 0
    s_cbranch_scc1 L_l_nx_18
    s_cmp_ge_u32 s42, 2
    s_cbranch_scc1 L_l_nx_18
    s_or_b32 s47, s39, 0x100
    v_mov_b32 v8, s47
    v_mov_b32 v9, 0
    s_lshl_b32 s46, s40, 3
    s_lshl_b32 s47, s42, 2
    s_add_u32 s46, s46, s47
    s_add_u32 s46, s46, 0x101200
    s_mov_b64 exec, 1
    buffer_store_dword v8, v9, s[12:15], s46 offen sc1
    s_mov_b64 exec, -1
L_l_nx_18:
    s_mul_i32 s46, s44, 2064
    s_add_u32 s46, s46, 32768
    v_add_u32 v10, s46, v2
    v_and_b32 v11, 7, v1
    v_lshrrev_b32 v12, 3, v1
    v_mul_u32_u24 v13, 2064, v11
    v_lshl_add_u32 v13, v12, 4, v13
    s_lshl_b32 s46, s44, 8
    s_add_u32 s46, s46, 32768
    v_add_u32 v13, s46, v13
    v_lshlrev_b32 v11, 4, v11
    v_lshl_add_u32 v11, v12, 9, v11
    s_lshl_b32 s46, s44, 13
    s_lshl_b32 s47, s42, 7
    s_add_u32 s46, s46, s47
    s_add_u32 s46, s46, 0x400000
    v_add_u32 v11, s46, v11
    v_add_u32 v12, 4096, v11
    s_lshl_b32 s52, s43, 9
    s_lshl_b32 s47, s42, 7
    s_add_u32 s52, s52, s47
    s_add_u32 s52, s52, 0x109400
    s_mov_b32 s60, s43
    s_waitcnt vmcnt(0)
    v_add_f32 v32, v32, v48
    v_add_f32 v33, v33, v49
    v_add_f32 v34, v34, v50
    v_add_f32 v35, v35, v51
    v_add_f32 v36, v36, v52
    v_add_f32 v37, v37, v53
    v_add_f32 v38, v38, v54
    v_add_f32 v39, v39, v55
    v_add_f32 v40, v40, v56
    v_add_f32 v41, v41, v57
    v_add_f32 v42, v42, v58
    v_add_f32 v43, v43, v59
    v_add_f32 v44, v44, v60
    v_add_f32 v45, v45, v61
    v_add_f32 v46, v46, v62
    v_add_f32 v47, v47, v63
    v_add_f32 v32, v32, v40
    v_add_f32 v33, v33, v41
    v_add_f32 v34, v34, v42
    v_add_f32 v35, v35, v43
    v_add_f32 v36, v36, v44
    v_add_f32 v37, v37, v45
    v_add_f32 v38, v38, v46
    v_add_f32 v39, v39, v47
    v_add_f32 v32, v32, v36
    v_add_f32 v33, v33, v37
    v_add_f32 v34, v34, v38
    v_add_f32 v35, v35, v39
    v_cvt_pk_bf16_f32 v32, 0, v32
    v_cvt_pk_bf16_f32 v33, 0, v33
    v_cvt_pk_bf16_f32 v34, 0, v34
    v_cvt_pk_bf16_f32 v35, 0, v35
    ds_write_b128 v4, v[32:35]
    s_waitcnt lgkmcnt(0)
    s_barrier
    ds_read_b128 v[48:51], v3 offset:0
    ds_read_b128 v[52:55], v3 offset:16
    ds_read_b128 v[56:59], v3 offset:2048
    ds_read_b128 v[60:63], v3 offset:2064
    ds_read_b128 v[32:35], v3 offset:4096
    ds_read_b128 v[36:39], v3 offset:4112
    ds_read_b128 v[40:43], v3 offset:6144
    ds_read_b128 v[44:47], v3 offset:6160
    s_waitcnt lgkmcnt(0)
    v_add_f32 v32, 1.0, v32
    v_add_f32 v33, 1.0, v33
    v_add_f32 v34, 1.0, v34
    v_add_f32 v35, 1.0, v35
    v_add_f32 v36, 1.0, v36
    v_add_f32 v37, 1.0, v37
    v_add_f32 v38, 1.0, v38
    v_add_f32 v39, 1.0, v39
    v_add_f32 v40, 1.0, v40
    v_add_f32 v41, 1.0, v41
    v_add_f32 v42, 1.0, v42
    v_add_f32 v43, 1.0, v43
    v_add_f32 v44, 1.0, v44
    v_add_f32 v45, 1.0, v45
    v_add_f32 v46, 1.0, v46
    v_add_f32 v47, 1.0, v47
    v_cvt_pk_bf16_f32 v32, 0, v32
    v_cvt_pk_bf16_f32 v33, 0, v33
    v_cvt_pk_bf16_f32 v34, 0, v34
    v_cvt_pk_bf16_f32 v35, 0, v35
    v_cvt_pk_bf16_f32 v36, 0, v36
    v_cvt_pk_bf16_f32 v37, 0, v37
    v_cvt_pk_bf16_f32 v38, 0, v38
    v_cvt_pk_bf16_f32 v39, 0, v39
    v_cvt_pk_bf16_f32 v40, 0, v40
    v_cvt_pk_bf16_f32 v41, 0, v41
    v_cvt_pk_bf16_f32 v42, 0, v42
    v_cvt_pk_bf16_f32 v43, 0, v43
    v_cvt_pk_bf16_f32 v44, 0, v44
    v_cvt_pk_bf16_f32 v45, 0, v45
    v_cvt_pk_bf16_f32 v46, 0, v46
    v_cvt_pk_bf16_f32 v47, 0, v47
L_l_sub_19:
    s_lshl_b32 s63, s60, 16
    v_accvgpr_read_b32 v96, a0
    v_accvgpr_read_b32 v97, a1
    v_accvgpr_read_b32 v98, a2
    v_accvgpr_read_b32 v99, a3
    v_accvgpr_read_b32 v100, a4
    v_accvgpr_read_b32 v101, a5
    v_accvgpr_read_b32 v102, a6
    v_accvgpr_read_b32 v103, a7
    v_lshlrev_b32 v64, 16, v96
    v_and_b32 v65, 0xffff0000, v96
    v_lshlrev_b32 v66, 16, v97
    v_and_b32 v67, 0xffff0000, v97
    v_lshlrev_b32 v68, 16, v98
    v_and_b32 v69, 0xffff0000, v98
    v_lshlrev_b32 v70, 16, v99
    v_and_b32 v71, 0xffff0000, v99
    v_lshlrev_b32 v72, 16, v100
    v_and_b32 v73, 0xffff0000, v100
    v_lshlrev_b32 v74, 16, v101
    v_and_b32 v75, 0xffff0000, v101
    v_lshlrev_b32 v76, 16, v102
    v_and_b32 v77, 0xffff0000, v102
    v_lshlrev_b32 v78, 16, v103
    v_and_b32 v79, 0xffff0000, v103
    v_pk_add_f32 v[80:81], v[64:65], v[72:73]
    v_pk_add_f32 v[82:83], v[66:67], v[74:75]
    v_pk_add_f32 v[84:85], v[68:69], v[76:77]
    v_pk_add_f32 v[86:87], v[70:71], v[78:79]
    v_pk_add_f32 v[80:81], v[80:81], v[84:85]
    v_pk_add_f32 v[82:83], v[82:83], v[86:87]
    v_pk_add_f32 v[80:81], v[80:81], v[82:83]
    v_add_f32 v14, v80, v81
    s_nop 1
    v_add_f32_dpp v14, v14, v14 row_shr:1 row_mask:0xf bank_mask:0xf bound_ctrl:0
    s_nop 1
    v_add_f32_dpp v14, v14, v14 row_shr:2 row_mask:0xf bank_mask:0xf bound_ctrl:0
    s_nop 1
    v_add_f32_dpp v14, v14, v14 row_shr:4 row_mask:0xf bank_mask:0xf bound_ctrl:0
    s_nop 1
    v_add_f32_dpp v14, v14, v14 row_shr:8 row_mask:0xf bank_mask:0xf bound_ctrl:0
    s_nop 1
    v_add_f32_dpp v14, v14, v14 row_bcast:15 row_mask:0xa bank_mask:0xf
    s_nop 1
    v_add_f32_dpp v14, v14, v14 row_bcast:31 row_mask:0xc bank_mask:0xf
    s_nop 1
    v_readlane_b32 s46, v14, 63
    s_nop 1
    v_mov_b32 v15, s46
    v_mul_f32 v15, 0x3a800000, v15
    v_pk_add_f32 v[80:81], v[64:65], v[14:15] op_sel:[0,1] op_sel_hi:[1,1] neg_lo:[0,1] neg_hi:[0,1]
    v_pk_add_f32 v[82:83], v[66:67], v[14:15] op_sel:[0,1] op_sel_hi:[1,1] neg_lo:[0,1] neg_hi:[0,1]
    v_pk_add_f32 v[84:85], v[68:69], v[14:15] op_sel:[0,1] op_sel_hi:[1,1] neg_lo:[0,1] neg_hi:[0,1]
    v_pk_add_f32 v[86:87], v[70:71], v[14:15] op_sel:[0,1] op_sel_hi:[1,1] neg_lo:[0,1] neg_hi:[0,1]
    v_pk_add_f32 v[88:89], v[72:73], v[14:15] op_sel:[0,1] op_sel_hi:[1,1] neg_lo:[0,1] neg_hi:[0,1]
    v_pk_add_f32 v[90:91], v[74:75], v[14:15] op_sel:[0,1] op_sel_hi:[1,1] neg_lo:[0,1] neg_hi:[0,1]
    v_pk_add_f32 v[92:93], v[76:77], v[14:15] op_sel:[0,1] op_sel_hi:[1,1] neg_lo:[0,1] neg_hi:[0,1]
    v_pk_add_f32 v[94:95], v[78:79], v[14:15] op_sel:[0,1] op_sel_hi:[1,1] neg_lo:[0,1] neg_hi:[0,1]
    v_pk_mul_f32 v[104:105], v[80:81], v[80:81]
    v_pk_mul_f32 v[106:107], v[82:83], v[82:83]
    v_pk_fma_f32 v[104:105], v[84:85], v[84:85], v[104:105]
    v_pk_fma_f32 v[106:107], v[86:87], v[86:87], v[106:107]
    v_pk_fma_f32 v[104:105], v[88:89], v[88:89], v[104:105]
    v_pk_fma_f32 v[106:107], v[90:91], v[90:91], v[106:107]
    v_pk_fma_f32 v[104:105], v[92:93], v[92:93], v[104:105]
    v_pk_fma_f32 v[106:107], v[94:95], v[94:95], v[106:107]
    v_pk_add_f32 v[104:105], v[104:105], v[106:107]
    v_add_f32 v14, v104, v105
    v_cvt_pk_bf16_f32 v15, 0, v15
    s_nop 1
    v_add_f32_dpp v14, v14, v14 row_shr:1 row_mask:0xf bank_mask:0xf bound_ctrl:0
    s_nop 1
    v_add_f32_dpp v14, v14, v14 row_shr:2 row_mask:0xf bank_mask:0xf bound_ctrl:0
    s_nop 1
    v_add_f32_dpp v14, v14, v14 row_shr:4 row_mask:0xf bank_mask:0xf bound_ctrl:0
    s_nop 1
    v_add_f32_dpp v14, v14, v14 row_shr:8 row_mask:0xf bank_mask:0xf bound_ctrl:0
    s_nop 1
    v_add_f32_dpp v14, v14, v14 row_bcast:15 row_mask:0xa bank_mask:0xf
    s_nop 1
    v_add_f32_dpp v14, v14, v14 row_bcast:31 row_mask:0xc bank_mask:0xf
    s_nop 1
    v_readlane_b32 s47, v14, 63
    v_pk_add_f32 v[64:65], v[64:65], v[14:15] op_sel:[0,1] op_sel_hi:[1,1] neg_lo:[0,1] neg_hi:[0,1]
    v_pk_add_f32 v[66:67], v[66:67], v[14:15] op_sel:[0,1] op_sel_hi:[1,1] neg_lo:[0,1] neg_hi:[0,1]
    v_pk_add_f32 v[68:69], v[68:69], v[14:15] op_sel:[0,1] op_sel_hi:[1,1] neg_lo:[0,1] neg_hi:[0,1]
    v_pk_add_f32 v[70:71], v[70:71], v[14:15] op_sel:[0,1] op_sel_hi:[1,1] neg_lo:[0,1] neg_hi:[0,1]
    v_pk_add_f32 v[72:73], v[72:73], v[14:15] op_sel:[0,1] op_sel_hi:[1,1] neg_lo:[0,1] neg_hi:[0,1]
    v_pk_add_f32 v[74:75], v[74:75], v[14:15] op_sel:[0,1] op_sel_hi:[1,1] neg_lo:[0,1] neg_hi:[0,1]
    v_pk_add_f32 v[76:77], v[76:77], v[14:15] op_sel:[0,1] op_sel_hi:[1,1] neg_lo:[0,1] neg_hi:[0,1]
    v_pk_add_f32 v[78:79], v[78:79], v[14:15] op_sel:[0,1] op_sel_hi:[1,1] neg_lo:[0,1] neg_hi:[0,1]
    v_mov_b32 v14, s47
    v_mul_f32 v14, 0x3a800000, v14
    v_cvt_pk_bf16_f32 v14, 0, v14
    v_add_f32 v14, 0x3727c5ac, v14
    v_cvt_pk_bf16_f32 v14, 0, v14
    v_sqrt_f32 v14, v14
    s_nop 0
    v_cvt_pk_bf16_f32 v14, 0, v14
    v_rcp_f32 v14, v14
    v_cvt_pk_bf16_f32 v64, 0, v64
    v_cvt_pk_bf16_f32 v65, 0, v65
    v_cvt_pk_bf16_f32 v66, 0, v66
    v_cvt_pk_bf16_f32 v67, 0, v67
    v_cvt_pk_bf16_f32 v68, 0, v68
    v_cvt_pk_bf16_f32 v69, 0, v69
    v_cvt_pk_bf16_f32 v70, 0, v70
    v_cvt_pk_bf16_f32 v71, 0, v71
    v_cvt_pk_bf16_f32 v72, 0, v72
    v_cvt_pk_bf16_f32 v73, 0, v73
    v_cvt_pk_bf16_f32 v74, 0, v74
    v_cvt_pk_bf16_f32 v75, 0, v75
    v_cvt_pk_bf16_f32 v76, 0, v76
    v_cvt_pk_bf16_f32 v77, 0, v77
    v_cvt_pk_bf16_f32 v78, 0, v78
    v_cvt_pk_bf16_f32 v79, 0, v79
    v_pk_mul_f32 v[64:65], v[64:65], v[14:15] op_sel_hi:[1,0]
    v_pk_mul_f32 v[66:67], v[66:67], v[14:15] op_sel_hi:[1,0]
    v_pk_mul_f32 v[68:69], v[68:69], v[14:15] op_sel_hi:[1,0]
    v_pk_mul_f32 v[70:71], v[70:71], v[14:15] op_sel_hi:[1,0]
    v_pk_mul_f32 v[72:73], v[72:73], v[14:15] op_sel_hi:[1,0]
    v_pk_mul_f32 v[74:75], v[74:75], v[14:15] op_sel_hi:[1,0]
    v_pk_mul_f32 v[76:77], v[76:77], v[14:15] op_sel_hi:[1,0]
    v_pk_mul_f32 v[78:79], v[78:79], v[14:15] op_sel_hi:[1,0]
    v_cvt_pk_bf16_f32 v64, 0, v64
    v_cvt_pk_bf16_f32 v65, 0, v65
    v_cvt_pk_bf16_f32 v66, 0, v66
    v_cvt_pk_bf16_f32 v67, 0, v67
    v_cvt_pk_bf16_f32 v68, 0, v68
    v_cvt_pk_bf16_f32 v69, 0, v69
    v_cvt_pk_bf16_f32 v70, 0, v70
    v_cvt_pk_bf16_f32 v71, 0, v71
    v_cvt_pk_bf16_f32 v72, 0, v72
    v_cvt_pk_bf16_f32 v73, 0, v73
    v_cvt_pk_bf16_f32 v74, 0, v74
    v_cvt_pk_bf16_f32 v75, 0, v75
    v_cvt_pk_bf16_f32 v76, 0, v76
    v_cvt_pk_bf16_f32 v77, 0, v77
    v_cvt_pk_bf16_f32 v78, 0, v78
    v_cvt_pk_bf16_f32 v79, 0, v79
    v_pk_mul_f32 v[64:65], v[64:65], v[32:33]
    v_pk_mul_f32 v[66:67], v[66:67], v[34:35]
    v_pk_mul_f32 v[68:69], v[68:69], v[36:37]
    v_pk_mul_f32 v[70:71], v[70:71], v[38:39]
    v_pk_mul_f32 v[72:73], v[72:73], v[40:41]
    v_pk_mul_f32 v[74:75], v[74:75], v[42:43]
    v_pk_mul_f32 v[76:77], v[76:77], v[44:45]
    v_pk_mul_f32 v[78:79], v[78:79], v[46:47]
    v_cvt_pk_bf16_f32 v64, 0, v64
    v_cvt_pk_bf16_f32 v65, 0, v65
    v_cvt_pk_bf16_f32 v66, 0, v66
    v_cvt_pk_bf16_f32 v67, 0, v67
    v_cvt_pk_bf16_f32 v68, 0, v68
    v_cvt_pk_bf16_f32 v69, 0, v69
    v_cvt_pk_bf16_f32 v70, 0, v70
    v_cvt_pk_bf16_f32 v71, 0, v71
    v_cvt_pk_bf16_f32 v72, 0, v72
    v_cvt_pk_bf16_f32 v73, 0, v73
    v_cvt_pk_bf16_f32 v74, 0, v74
    v_cvt_pk_bf16_f32 v75, 0, v75
    v_cvt_pk_bf16_f32 v76, 0, v76
    v_cvt_pk_bf16_f32 v77, 0, v77
    v_cvt_pk_bf16_f32 v78, 0, v78
    v_cvt_pk_bf16_f32 v79, 0, v79
    v_pk_add_f32 v[64:65], v[64:65], v[48:49]
    v_pk_add_f32 v[66:67], v[66:67], v[50:51]
    v_pk_add_f32 v[68:69], v[68:69], v[52:53]
    v_pk_add_f32 v[70:71], v[70:71], v[54:55]
    v_pk_add_f32 v[72:73], v[72:73], v[56:57]
    v_pk_add_f32 v[74:75], v[74:75], v[58:59]
    v_pk_add_f32 v[76:77], v[76:77], v[60:61]
    v_pk_add_f32 v[78:79], v[78:79], v[62:63]
    v_cvt_pk_bf16_f32 v104, v64, v65
    v_cvt_pk_bf16_f32 v105, v66, v67
    v_cvt_pk_bf16_f32 v106, v68, v69
    v_cvt_pk_bf16_f32 v107, v70, v71
    v_cvt_pk_bf16_f32 v108, v72, v73
    v_cvt_pk_bf16_f32 v109, v74, v75
    v_cvt_pk_bf16_f32 v110, v76, v77
    v_cvt_pk_bf16_f32 v111, v78, v79
    ds_write_b128 v10, v[104:107]
    ds_write_b128 v10, v[108:111] offset:1024
    s_waitcnt lgkmcnt(0)
    s_barrier
    ds_read_b128 v[104:107], v13
    ds_read_b128 v[108:111], v13 offset:128
    s_waitcnt lgkmcnt(1)
    buffer_store_dwordx4 v[104:107], v11, s[12:15], s63 offen sc1
    s_waitcnt lgkmcnt(0)
    buffer_store_dwordx4 v[108:111], v12, s[12:15], s63 offen sc1
    s_waitcnt vmcnt(0)
    s_barrier
    s_cmp_lg_u32 s44, 0
    s_cbranch_scc1 L_sf_21
    v_mov_b32 v14, s60
    v_add_u32 v14, 1, v14
    v_mov_b32 v15, 0
    s_mov_b64 exec, 1
    buffer_store_dword v14, v15, s[12:15], s52 offen sc1
    s_mov_b64 exec, -1
L_sf_21:
    s_cmp_ge_u32 s60, 8
    s_cbranch_scc1 L_l_end_20
    s_add_u32 s63, s63, 524288
    buffer_load_dwordx4 a[8:11], v7, s[24:27], s63 offen
    buffer_load_dwordx4 a[12:15], v7, s[24:27], s63 offen offset:1024
    s_add_u32 s63, s63, 524288
    buffer_load_dwordx4 a[16:19], v7, s[24:27], s63 offen
    buffer_load_dwordx4 a[20:23], v7, s[24:27], s63 offen offset:1024
    s_add_u32 s63, s63, 524288
    buffer_load_dwordx4 a[24:27], v7, s[24:27], s63 offen
    buffer_load_dwordx4 a[28:31], v7, s[24:27], s63 offen offset:1024
    s_add_u32 s63, s63, 524288
    buffer_load_dwordx4 a[32:35], v7, s[24:27], s63 offen
    buffer_load_dwordx4 a[36:39], v7, s[24:27], s63 offen offset:1024
    s_add_u32 s63, s63, 524288
    buffer_load_dwordx4 a[40:43], v7, s[24:27], s63 offen
    buffer_load_dwordx4 a[44:47], v7, s[24:27], s63 offen offset:1024
    s_add_u32 s63, s63, 524288
    buffer_load_dwordx4 a[48:51], v7, s[24:27], s63 offen
    buffer_load_dwordx4 a[52:55], v7, s[24:27], s63 offen offset:1024
    s_add_u32 s63, s63, 524288
    buffer_load_dwordx4 a[56:59], v7, s[24:27], s63 offen
    buffer_load_dwordx4 a[60:63], v7, s[24:27], s63 offen offset:1024
    s_waitcnt vmcnt(0)
L_l_end_20:
    v_accvgpr_mov_b32 a0, a8
    v_accvgpr_mov_b32 a1, a9
    v_accvgpr_mov_b32 a2, a10
    v_accvgpr_mov_b32 a3, a11
    v_accvgpr_mov_b32 a4, a12
    v_accvgpr_mov_b32 a5, a13
    v_accvgpr_mov_b32 a6, a14
    v_accvgpr_mov_b32 a7, a15
    v_accvgpr_mov_b32 a8, a16
    v_accvgpr_mov_b32 a9, a17
    v_accvgpr_mov_b32 a10, a18
    v_accvgpr_mov_b32 a11, a19
    v_accvgpr_mov_b32 a12, a20
    v_accvgpr_mov_b32 a13, a21
    v_accvgpr_mov_b32 a14, a22
    v_accvgpr_mov_b32 a15, a23
    v_accvgpr_mov_b32 a16, a24
    v_accvgpr_mov_b32 a17, a25
    v_accvgpr_mov_b32 a18, a26
    v_accvgpr_mov_b32 a19, a27
    v_accvgpr_mov_b32 a20, a28
    v_accvgpr_mov_b32 a21, a29
    v_accvgpr_mov_b32 a22, a30
    v_accvgpr_mov_b32 a23, a31
    v_accvgpr_mov_b32 a24, a32
    v_accvgpr_mov_b32 a25, a33
    v_accvgpr_mov_b32 a26, a34
    v_accvgpr_mov_b32 a27, a35
    v_accvgpr_mov_b32 a28, a36
    v_accvgpr_mov_b32 a29, a37
    v_accvgpr_mov_b32 a30, a38
    v_accvgpr_mov_b32 a31, a39
    v_accvgpr_mov_b32 a32, a40
    v_accvgpr_mov_b32 a33, a41
    v_accvgpr_mov_b32 a34, a42
    v_accvgpr_mov_b32 a35, a43
    v_accvgpr_mov_b32 a36, a44
    v_accvgpr_mov_b32 a37, a45
    v_accvgpr_mov_b32 a38, a46
    v_accvgpr_mov_b32 a39, a47
    v_accvgpr_mov_b32 a40, a48
    v_accvgpr_mov_b32 a41, a49
    v_accvgpr_mov_b32 a42, a50
    v_accvgpr_mov_b32 a43, a51
    v_accvgpr_mov_b32 a44, a52
    v_accvgpr_mov_b32 a45, a53
    v_accvgpr_mov_b32 a46, a54
    v_accvgpr_mov_b32 a47, a55
    v_accvgpr_mov_b32 a48, a56
    v_accvgpr_mov_b32 a49, a57
    v_accvgpr_mov_b32 a50, a58
    v_accvgpr_mov_b32 a51, a59
    v_accvgpr_mov_b32 a52, a60
    v_accvgpr_mov_b32 a53, a61
    v_accvgpr_mov_b32 a54, a62
    v_accvgpr_mov_b32 a55, a63
    s_add_u32 s60, s60, 8
    s_cmp_lt_u32 s60, 64
    s_cbranch_scc1 L_l_sub_19
    s_cmp_lt_u32 s48, 14
    s_cbranch_scc1 L_w_att_13
    s_and_b32 s55, s48, 1
    s_lshl_b32 s55, s55, 3
    s_add_u32 s55, s55, s40
    s_load_dwordx4 s[8:11], s[0:1], 96
    v_lshrrev_b32 v5, 3, v0
    s_mov_b32 s46, 196608
    v_mul_lo_u32 v4, v5, s46
    v_and_b32 v6, 7, v0
    v_lshl_add_u32 v4, v6, 4, v4
    v_lshlrev_b32 v5, 5, v5
    s_waitcnt lgkmcnt(0)
    s_mov_b32 s28, s10
    s_and_b32 s29, s11, 0xffff
    s_mov_b32 s30, 0xc00000
    s_mov_b32 s31, 0x00020000
    s_mov_b32 s32, s8
    s_and_b32 s33, s9, 0xffff
    s_mov_b32 s34, 0x800
    s_mov_b32 s35, 0x00020000
    buffer_load_dwordx4 v[8:11], v5, s[32:35], 0 offen
    buffer_load_dwordx4 v[12:15], v5, s[32:35], 0 offen offset:16
    s_waitcnt vmcnt(0)
    v_lshlrev_b32 v16, 16, v8
    v_and_b32 v17, 0xffff0000, v8
    v_lshlrev_b32 v18, 16, v9
    v_and_b32 v19, 0xffff0000, v9
    v_lshlrev_b32 v20, 16, v10
    v_and_b32 v21, 0xffff0000, v10
    v_lshlrev_b32 v22, 16, v11
    v_and_b32 v23, 0xffff0000, v11
    v_lshlrev_b32 v24, 16, v12
    v_and_b32 v25, 0xffff0000, v12
    v_lshlrev_b32 v26, 16, v13
    v_and_b32 v27, 0xffff0000, v13
    v_lshlrev_b32 v28, 16, v14
    v_and_b32 v29, 0xffff0000, v14
    v_lshlrev_b32 v30, 16, v15
    v_and_b32 v31, 0xffff0000, v15
    v_mul_f32 v112, 0xbfb8aa3b, v16
    v_mul_f32 v113, 0xbfb8aa3b, v17
    v_mul_f32 v114, 0xbfb8aa3b, v18
    v_mul_f32 v115, 0xbfb8aa3b, v19
    v_mul_f32 v116, 0xbfb8aa3b, v20
    v_mul_f32 v117, 0xbfb8aa3b, v21
    v_mul_f32 v118, 0xbfb8aa3b, v22
    v_mul_f32 v119, 0xbfb8aa3b, v23
    v_mul_f32 v120, 0xbfb8aa3b, v24
    v_mul_f32 v121, 0xbfb8aa3b, v25
    v_mul_f32 v122, 0xbfb8aa3b, v26
    v_mul_f32 v123, 0xbfb8aa3b, v27
    v_mul_f32 v124, 0xbfb8aa3b, v28
    v_mul_f32 v125, 0xbfb8aa3b, v29
    v_mul_f32 v126, 0xbfb8aa3b, v30
    v_mul_f32 v127, 0xbfb8aa3b, v31
    v_exp_f32 v112, v112
    v_exp_f32 v113, v113
    v_exp_f32 v114, v114
    v_exp_f32 v115, v115
    v_exp_f32 v116, v116
    v_exp_f32 v117, v117
    v_exp_f32 v118, v118
    v_exp_f32 v119, v119
    v_exp_f32 v120, v120
    v_exp_f32 v121, v121
    v_exp_f32 v122, v122
    v_exp_f32 v123, v123
    v_exp_f32 v124, v124
    v_exp_f32 v125, v125
    v_exp_f32 v126, v126
    v_exp_f32 v127, v127
    v_add_f32 v112, 1.0, v112
    v_add_f32 v113, 1.0, v113
    v_add_f32 v114, 1.0, v114
    v_add_f32 v115, 1.0, v115
    v_add_f32 v116, 1.0, v116
    v_add_f32 v117, 1.0, v117
    v_add_f32 v118, 1.0, v118
    v_add_f32 v119, 1.0, v119
    v_add_f32 v120, 1.0, v120
    v_add_f32 v121, 1.0, v121
    v_add_f32 v122, 1.0, v122
    v_add_f32 v123, 1.0, v123
    v_add_f32 v124, 1.0, v124
    v_add_f32 v125, 1.0, v125
    v_add_f32 v126, 1.0, v126
    v_add_f32 v127, 1.0, v127
    v_rcp_f32 v112, v112
    v_rcp_f32 v113, v113
    v_rcp_f32 v114, v114
    v_rcp_f32 v115, v115
    v_rcp_f32 v116, v116
    v_rcp_f32 v117, v117
    v_rcp_f32 v118, v118
    v_rcp_f32 v119, v119
    v_rcp_f32 v120, v120
    v_rcp_f32 v121, v121
    v_rcp_f32 v122, v122
    v_rcp_f32 v123, v123
    v_rcp_f32 v124, v124
    v_rcp_f32 v125, v125
    v_rcp_f32 v126, v126
    v_rcp_f32 v127, v127
    v_mul_f32 v16, v16, v112
    v_mul_f32 v17, v17, v113
    v_mul_f32 v18, v18, v114
    v_mul_f32 v19, v19, v115
    v_mul_f32 v20, v20, v116
    v_mul_f32 v21, v21, v117
    v_mul_f32 v22, v22, v118
    v_mul_f32 v23, v23, v119
    v_mul_f32 v24, v24, v120
    v_mul_f32 v25, v25, v121
    v_mul_f32 v26, v26, v122
    v_mul_f32 v27, v27, v123
    v_mul_f32 v28, v28, v124
    v_mul_f32 v29, v29, v125
    v_mul_f32 v30, v30, v126
    v_mul_f32 v31, v31, v127
    v_cvt_pk_bf16_f32 v16, 0, v16
    v_cvt_pk_bf16_f32 v17, 0, v17
    v_cvt_pk_bf16_f32 v18, 0, v18
    v_cvt_pk_bf16_f32 v19, 0, v19
    v_cvt_pk_bf16_f32 v20, 0, v20
    v_cvt_pk_bf16_f32 v21, 0, v21
    v_cvt_pk_bf16_f32 v22, 0, v22
    v_cvt_pk_bf16_f32 v23, 0, v23
    v_cvt_pk_bf16_f32 v24, 0, v24
    v_cvt_pk_bf16_f32 v25, 0, v25
    v_cvt_pk_bf16_f32 v26, 0, v26
    v_cvt_pk_bf16_f32 v27, 0, v27
    v_cvt_pk_bf16_f32 v28, 0, v28
    v_cvt_pk_bf16_f32 v29, 0, v29
    v_cvt_pk_bf16_f32 v30, 0, v30
    v_cvt_pk_bf16_f32 v31, 0, v31
    s_lshl_b32 s53, s55, 9
    s_add_u32 s53, s53, 4096
L_m_loop_22:
    s_add_u32 s46, s53, 0
    buffer_load_dwordx4 v[32:35], v4, s[28:31], s46 offen
    s_add_u32 s46, s53, 12288
    buffer_load_dwordx4 v[36:39], v4, s[28:31], s46 offen
    s_add_u32 s46, s53, 24576
    buffer_load_dwordx4 v[40:43], v4, s[28:31], s46 offen
    s_add_u32 s46, s53, 36864
    buffer_load_dwordx4 v[44:47], v4, s[28:31], s46 offen
    s_add_u32 s46, s53, 49152
    buffer_load_dwordx4 v[48:51], v4, s[28:31], s46 offen
    s_add_u32 s46, s53, 61440
    buffer_load_dwordx4 v[52:55], v4, s[28:31], s46 offen
    s_add_u32 s46, s53, 73728
    buffer_load_dwordx4 v[56:59], v4, s[28:31], s46 offen
    s_add_u32 s46, s53, 86016
    buffer_load_dwordx4 v[60:63], v4, s[28:31], s46 offen
    s_add_u32 s46, s53, 98304
    buffer_load_dwordx4 v[64:67], v4, s[28:31], s46 offen
    s_add_u32 s46, s53, 110592
    buffer_load_dwordx4 v[68:71], v4, s[28:31], s46 offen
    s_add_u32 s46, s53, 122880
    buffer_load_dwordx4 v[72:75], v4, s[28:31], s46 offen
    s_add_u32 s46, s53, 135168
    buffer_load_dwordx4 v[76:79], v4, s[28:31], s46 offen
    s_add_u32 s46, s53, 147456
    buffer_load_dwordx4 v[80:83], v4, s[28:31], s46 offen
    s_add_u32 s46, s53, 159744
    buffer_load_dwordx4 v[84:87], v4, s[28:31], s46 offen
    s_add_u32 s46, s53, 172032
    buffer_load_dwordx4 v[88:91], v4, s[28:31], s46 offen
    s_add_u32 s46, s53, 184320
    buffer_load_dwordx4 v[92:95], v4, s[28:31], s46 offen
    s_waitcnt vmcnt(15)
    v_lshlrev_b32 v104, 16, v32
    v_and_b32 v105, 0xffff0000, v32
    v_mul_f32 v96, v104, v16
    v_mul_f32 v97, v105, v16
    v_lshlrev_b32 v104, 16, v33
    v_and_b32 v105, 0xffff0000, v33
    v_mul_f32 v98, v104, v16
    v_mul_f32 v99, v105, v16
    v_lshlrev_b32 v104, 16, v34
    v_and_b32 v105, 0xffff0000, v34
    v_mul_f32 v100, v104, v16
    v_mul_f32 v101, v105, v16
    v_lshlrev_b32 v104, 16, v35
    v_and_b32 v105, 0xffff0000, v35
    v_mul_f32 v102, v104, v16
    v_mul_f32 v103, v105, v16
    s_waitcnt vmcnt(14)
    v_lshlrev_b32 v104, 16, v36
    v_and_b32 v105, 0xffff0000, v36
    v_fmac_f32 v96, v104, v17
    v_fmac_f32 v97, v105, v17
    v_lshlrev_b32 v104, 16, v37
    v_and_b32 v105, 0xffff0000, v37
    v_fmac_f32 v98, v104, v17
    v_fmac_f32 v99, v105, v17
    v_lshlrev_b32 v104, 16, v38
    v_and_b32 v105, 0xffff0000, v38
    v_fmac_f32 v100, v104, v17
    v_fmac_f32 v101, v105, v17
    v_lshlrev_b32 v104, 16, v39
    v_and_b32 v105, 0xffff0000, v39
    v_fmac_f32 v102, v104, v17
    v_fmac_f32 v103, v105, v17
    s_waitcnt vmcnt(13)
    v_lshlrev_b32 v104, 16, v40
    v_and_b32 v105, 0xffff0000, v40
    v_fmac_f32 v96, v104, v18
    v_fmac_f32 v97, v105, v18
    v_lshlrev_b32 v104, 16, v41
    v_and_b32 v105, 0xffff0000, v41
    v_fmac_f32 v98, v104, v18
    v_fmac_f32 v99, v105, v18
    v_lshlrev_b32 v104, 16, v42
    v_and_b32 v105, 0xffff0000, v42
    v_fmac_f32 v100, v104, v18
    v_fmac_f32 v101, v105, v18
    v_lshlrev_b32 v104, 16, v43
    v_and_b32 v105, 0xffff0000, v43
    v_fmac_f32 v102, v104, v18
    v_fmac_f32 v103, v105, v18
    s_waitcnt vmcnt(12)
    v_lshlrev_b32 v104, 16, v44
    v_and_b32 v105, 0xffff0000, v44
    v_fmac_f32 v96, v104, v19
    v_fmac_f32 v97, v105, v19
    v_lshlrev_b32 v104, 16, v45
    v_and_b32 v105, 0xffff0000, v45
    v_fmac_f32 v98, v104, v19
    v_fmac_f32 v99, v105, v19
    v_lshlrev_b32 v104, 16, v46
    v_and_b32 v105, 0xffff0000, v46
    v_fmac_f32 v100, v104, v19
    v_fmac_f32 v101, v105, v19
    v_lshlrev_b32 v104, 16, v47
    v_and_b32 v105, 0xffff0000, v47
    v_fmac_f32 v102, v104, v19
    v_fmac_f32 v103, v105, v19
    s_waitcnt vmcnt(11)
    v_lshlrev_b32 v104, 16, v48
    v_and_b32 v105, 0xffff0000, v48
    v_fmac_f32 v96, v104, v20
    v_fmac_f32 v97, v105, v20
    v_lshlrev_b32 v104, 16, v49
    v_and_b32 v105, 0xffff0000, v49
    v_fmac_f32 v98, v104, v20
    v_fmac_f32 v99, v105, v20
    v_lshlrev_b32 v104, 16, v50
    v_and_b32 v105, 0xffff0000, v50
    v_fmac_f32 v100, v104, v20
    v_fmac_f32 v101, v105, v20
    v_lshlrev_b32 v104, 16, v51
    v_and_b32 v105, 0xffff0000, v51
    v_fmac_f32 v102, v104, v20
    v_fmac_f32 v103, v105, v20
    s_waitcnt vmcnt(10)
    v_lshlrev_b32 v104, 16, v52
    v_and_b32 v105, 0xffff0000, v52
    v_fmac_f32 v96, v104, v21
    v_fmac_f32 v97, v105, v21
    v_lshlrev_b32 v104, 16, v53
    v_and_b32 v105, 0xffff0000, v53
    v_fmac_f32 v98, v104, v21
    v_fmac_f32 v99, v105, v21
    v_lshlrev_b32 v104, 16, v54
    v_and_b32 v105, 0xffff0000, v54
    v_fmac_f32 v100, v104, v21
    v_fmac_f32 v101, v105, v21
    v_lshlrev_b32 v104, 16, v55
    v_and_b32 v105, 0xffff0000, v55
    v_fmac_f32 v102, v104, v21
    v_fmac_f32 v103, v105, v21
    s_waitcnt vmcnt(9)
    v_lshlrev_b32 v104, 16, v56
    v_and_b32 v105, 0xffff0000, v56
    v_fmac_f32 v96, v104, v22
    v_fmac_f32 v97, v105, v22
    v_lshlrev_b32 v104, 16, v57
    v_and_b32 v105, 0xffff0000, v57
    v_fmac_f32 v98, v104, v22
    v_fmac_f32 v99, v105, v22
    v_lshlrev_b32 v104, 16, v58
    v_and_b32 v105, 0xffff0000, v58
    v_fmac_f32 v100, v104, v22
    v_fmac_f32 v101, v105, v22
    v_lshlrev_b32 v104, 16, v59
    v_and_b32 v105, 0xffff0000, v59
    v_fmac_f32 v102, v104, v22
    v_fmac_f32 v103, v105, v22
    s_waitcnt vmcnt(8)
    v_lshlrev_b32 v104, 16, v60
    v_and_b32 v105, 0xffff0000, v60
    v_fmac_f32 v96, v104, v23
    v_fmac_f32 v97, v105, v23
    v_lshlrev_b32 v104, 16, v61
    v_and_b32 v105, 0xffff0000, v61
    v_fmac_f32 v98, v104, v23
    v_fmac_f32 v99, v105, v23
    v_lshlrev_b32 v104, 16, v62
    v_and_b32 v105, 0xffff0000, v62
    v_fmac_f32 v100, v104, v23
    v_fmac_f32 v101, v105, v23
    v_lshlrev_b32 v104, 16, v63
    v_and_b32 v105, 0xffff0000, v63
    v_fmac_f32 v102, v104, v23
    v_fmac_f32 v103, v105, v23
    s_waitcnt vmcnt(7)
    v_lshlrev_b32 v104, 16, v64
    v_and_b32 v105, 0xffff0000, v64
    v_fmac_f32 v96, v104, v24
    v_fmac_f32 v97, v105, v24
    v_lshlrev_b32 v104, 16, v65
    v_and_b32 v105, 0xffff0000, v65
    v_fmac_f32 v98, v104, v24
    v_fmac_f32 v99, v105, v24
    v_lshlrev_b32 v104, 16, v66
    v_and_b32 v105, 0xffff0000, v66
    v_fmac_f32 v100, v104, v24
    v_fmac_f32 v101, v105, v24
    v_lshlrev_b32 v104, 16, v67
    v_and_b32 v105, 0xffff0000, v67
    v_fmac_f32 v102, v104, v24
    v_fmac_f32 v103, v105, v24
    s_waitcnt vmcnt(6)
    v_lshlrev_b32 v104, 16, v68
    v_and_b32 v105, 0xffff0000, v68
    v_fmac_f32 v96, v104, v25
    v_fmac_f32 v97, v105, v25
    v_lshlrev_b32 v104, 16, v69
    v_and_b32 v105, 0xffff0000, v69
    v_fmac_f32 v98, v104, v25
    v_fmac_f32 v99, v105, v25
    v_lshlrev_b32 v104, 16, v70
    v_and_b32 v105, 0xffff0000, v70
    v_fmac_f32 v100, v104, v25
    v_fmac_f32 v101, v105, v25
    v_lshlrev_b32 v104, 16, v71
    v_and_b32 v105, 0xffff0000, v71
    v_fmac_f32 v102, v104, v25
    v_fmac_f32 v103, v105, v25
    s_waitcnt vmcnt(5)
    v_lshlrev_b32 v104, 16, v72
    v_and_b32 v105, 0xffff0000, v72
    v_fmac_f32 v96, v104, v26
    v_fmac_f32 v97, v105, v26
    v_lshlrev_b32 v104, 16, v73
    v_and_b32 v105, 0xffff0000, v73
    v_fmac_f32 v98, v104, v26
    v_fmac_f32 v99, v105, v26
    v_lshlrev_b32 v104, 16, v74
    v_and_b32 v105, 0xffff0000, v74
    v_fmac_f32 v100, v104, v26
    v_fmac_f32 v101, v105, v26
    v_lshlrev_b32 v104, 16, v75
    v_and_b32 v105, 0xffff0000, v75
    v_fmac_f32 v102, v104, v26
    v_fmac_f32 v103, v105, v26
    s_waitcnt vmcnt(4)
    v_lshlrev_b32 v104, 16, v76
    v_and_b32 v105, 0xffff0000, v76
    v_fmac_f32 v96, v104, v27
    v_fmac_f32 v97, v105, v27
    v_lshlrev_b32 v104, 16, v77
    v_and_b32 v105, 0xffff0000, v77
    v_fmac_f32 v98, v104, v27
    v_fmac_f32 v99, v105, v27
    v_lshlrev_b32 v104, 16, v78
    v_and_b32 v105, 0xffff0000, v78
    v_fmac_f32 v100, v104, v27
    v_fmac_f32 v101, v105, v27
    v_lshlrev_b32 v104, 16, v79
    v_and_b32 v105, 0xffff0000, v79
    v_fmac_f32 v102, v104, v27
    v_fmac_f32 v103, v105, v27
    s_waitcnt vmcnt(3)
    v_lshlrev_b32 v104, 16, v80
    v_and_b32 v105, 0xffff0000, v80
    v_fmac_f32 v96, v104, v28
    v_fmac_f32 v97, v105, v28
    v_lshlrev_b32 v104, 16, v81
    v_and_b32 v105, 0xffff0000, v81
    v_fmac_f32 v98, v104, v28
    v_fmac_f32 v99, v105, v28
    v_lshlrev_b32 v104, 16, v82
    v_and_b32 v105, 0xffff0000, v82
    v_fmac_f32 v100, v104, v28
    v_fmac_f32 v101, v105, v28
    v_lshlrev_b32 v104, 16, v83
    v_and_b32 v105, 0xffff0000, v83
    v_fmac_f32 v102, v104, v28
    v_fmac_f32 v103, v105, v28
    s_waitcnt vmcnt(2)
    v_lshlrev_b32 v104, 16, v84
    v_and_b32 v105, 0xffff0000, v84
    v_fmac_f32 v96, v104, v29
    v_fmac_f32 v97, v105, v29
    v_lshlrev_b32 v104, 16, v85
    v_and_b32 v105, 0xffff0000, v85
    v_fmac_f32 v98, v104, v29
    v_fmac_f32 v99, v105, v29
    v_lshlrev_b32 v104, 16, v86
    v_and_b32 v105, 0xffff0000, v86
    v_fmac_f32 v100, v104, v29
    v_fmac_f32 v101, v105, v29
    v_lshlrev_b32 v104, 16, v87
    v_and_b32 v105, 0xffff0000, v87
    v_fmac_f32 v102, v104, v29
    v_fmac_f32 v103, v105, v29
    s_waitcnt vmcnt(1)
    v_lshlrev_b32 v104, 16, v88
    v_and_b32 v105, 0xffff0000, v88
    v_fmac_f32 v96, v104, v30
    v_fmac_f32 v97, v105, v30
    v_lshlrev_b32 v104, 16, v89
    v_and_b32 v105, 0xffff0000, v89
    v_fmac_f32 v98, v104, v30
    v_fmac_f32 v99, v105, v30
    v_lshlrev_b32 v104, 16, v90
    v_and_b32 v105, 0xffff0000, v90
    v_fmac_f32 v100, v104, v30
    v_fmac_f32 v101, v105, v30
    v_lshlrev_b32 v104, 16, v91
    v_and_b32 v105, 0xffff0000, v91
    v_fmac_f32 v102, v104, v30
    v_fmac_f32 v103, v105, v30
    s_waitcnt vmcnt(0)
    v_lshlrev_b32 v104, 16, v92
    v_and_b32 v105, 0xffff0000, v92
    v_fmac_f32 v96, v104, v31
    v_fmac_f32 v97, v105, v31
    v_lshlrev_b32 v104, 16, v93
    v_and_b32 v105, 0xffff0000, v93
    v_fmac_f32 v98, v104, v31
    v_fmac_f32 v99, v105, v31
    v_lshlrev_b32 v104, 16, v94
    v_and_b32 v105, 0xffff0000, v94
    v_fmac_f32 v100, v104, v31
    v_fmac_f32 v101, v105, v31
    v_lshlrev_b32 v104, 16, v95
    v_and_b32 v105, 0xffff0000, v95
    v_fmac_f32 v102, v104, v31
    v_fmac_f32 v103, v105, v31
    v_lshlrev_b32 v104, 5, v0
    ds_write_b128 v104, v[96:99]
    ds_write_b128 v104, v[100:103] offset:16
    v_lshlrev_b32 v105, 2, v1
    s_lshl_b32 s46, s44, 11
    v_add_u32 v104, s46, v105
    s_waitcnt lgkmcnt(0)
    ds_read_b32 v96, v104 offset:0
    ds_read_b32 v97, v104 offset:256
    ds_read_b32 v98, v104 offset:512
    ds_read_b32 v99, v104 offset:768
    ds_read_b32 v100, v104 offset:1024
    ds_read_b32 v101, v104 offset:1280
    ds_read_b32 v102, v104 offset:1536
    ds_read_b32 v103, v104 offset:1792
    s_waitcnt lgkmcnt(0)
    v_add_f32 v96, v96, v100
    v_add_f32 v97, v97, v101
    v_add_f32 v98, v98, v102
    v_add_f32 v99, v99, v103
    v_add_f32 v96, v96, v98
    v_add_f32 v97, v97, v99
    v_add_f32 v96, v96, v97
    v_lshlrev_b32 v104, 2, v0
    ds_write_b32 v104, v96 offset:16384
    s_waitcnt lgkmcnt(0)
    s_barrier
    s_cmp_lg_u32 s44, 0
    s_cbranch_scc1 L_m_sk_23
    ds_read_b32 v96, v105 offset:16384
    ds_read_b32 v97, v105 offset:16640
    ds_read_b32 v98, v105 offset:16896
    ds_read_b32 v99, v105 offset:17152
    ds_read_b32 v100, v105 offset:17408
    ds_read_b32 v101, v105 offset:17664
    ds_read_b32 v102, v105 offset:17920
    ds_read_b32 v103, v105 offset:18176
    s_waitcnt lgkmcnt(0)
    v_add_f32 v96, v96, v100
    v_add_f32 v97, v97, v101
    v_add_f32 v98, v98, v102
    v_add_f32 v99, v99, v103
    v_add_f32 v96, v96, v98
    v_add_f32 v97, v97, v99
    v_add_f32 v96, v96, v97
    v_cvt_pk_bf16_f32 v96, 0, v96
    s_lshl_b32 s46, s53, 1
    buffer_store_dword v96, v105, s[12:15], s46 offen sc1
L_m_sk_23:
    s_barrier
    s_add_u32 s53, s53, 128
    s_and_b32 s46, s53, 511
    s_cmp_lg_u32 s46, 0
    s_cbranch_scc1 L_m_loop_22
    s_lshl_b32 s54, s55, 7
    s_add_u32 s54, s54, 0x10e400
    s_mov_b32 s60, 0
    s_waitcnt vmcnt(0)
    s_cmp_lg_u32 s44, 0
    s_cbranch_scc1 L_sf_24
    v_mov_b32 v8, s60
    v_add_u32 v8, 1, v8
    v_mov_b32 v9, 0
    s_mov_b64 exec, 1
    buffer_store_dword v8, v9, s[12:15], s54 offen sc1
    s_mov_b64 exec, -1
L_sf_24:
    s_and_b32 s42, s40, 3
    s_lshr_b32 s43, s40, 2
    s_cmp_eq_u32 s48, 14
    s_cbranch_scc1 L_w_c_14
    s_load_dwordx2 s[4:5], s[0:1], 112
    s_load_dwordx2 s[6:7], s[0:1], 88
    v_lshlrev_b32 v2, 4, v1
    v_lshlrev_b32 v3, 5, v1
    s_waitcnt lgkmcnt(0)
    s_mov_b32 s24, s4
    s_and_b32 s25, s5, 0xffff
    s_mov_b32 s26, 0x400000
    s_mov_b32 s27, 0x00020000
    s_mov_b32 s28, s6
    s_and_b32 s29, s7, 0xffff
    s_mov_b32 s30, 0x800
    s_mov_b32 s31, 0x00020000
    s_cmp_lg_u32 s44, 0
    s_cbranch_scc1 L_mw_25
    v_and_b32 v8, 15, v1
    v_lshlrev_b32 v8, 7, v8
    s_mov_b32 s46, 0x10e400
    s_mov_b32 s47, 0
    s_mov_b32 s70, 0
L_spin_26:
    buffer_load_dword v9, v8, s[12:15], s46 offen sc1
    s_waitcnt vmcnt(0)
    v_cmp_ge_u32 vcc, s47, v9
    s_add_u32 s70, s70, 1
    s_cbranch_vccz L_spok_27
    s_sleep 2
    s_cmp_lt_u32 s70, 524288
    s_cbranch_scc1 L_spin_26
    s_branch L_c_done_1
L_spok_27:
L_mw_25:
    s_barrier
    s_mov_b32 s46, 20480
    buffer_load_dwordx4 v[16:19], v3, s[12:15], s46 offen offset:0 sc1
    buffer_load_dwordx4 v[20:23], v3, s[12:15], s46 offen offset:16 sc1
    buffer_load_dwordx4 v[24:27], v3, s[12:15], s46 offen offset:2048 sc1
    buffer_load_dwordx4 v[28:31], v3, s[12:15], s46 offen offset:2064 sc1
    buffer_load_dwordx4 v[48:51], v2, s[28:31], 0 offen
    buffer_load_dwordx4 v[52:55], v2, s[28:31], 0 offen offset:1024
    s_waitcnt vmcnt(0)
    v_lshlrev_b32 v32, 16, v48
    v_and_b32 v33, 0xffff0000, v48
    v_lshlrev_b32 v34, 16, v49
    v_and_b32 v35, 0xffff0000, v49
    v_lshlrev_b32 v36, 16, v50
    v_and_b32 v37, 0xffff0000, v50
    v_lshlrev_b32 v38, 16, v51
    v_and_b32 v39, 0xffff0000, v51
    v_lshlrev_b32 v40, 16, v52
    v_and_b32 v41, 0xffff0000, v52
    v_lshlrev_b32 v42, 16, v53
    v_and_b32 v43, 0xffff0000, v53
    v_lshlrev_b32 v44, 16, v54
    v_and_b32 v45, 0xffff0000, v54
    v_lshlrev_b32 v46, 16, v55
    v_and_b32 v47, 0xffff0000, v55
    s_lshl_b32 s46, s42, 14
    s_lshl_b32 s47, s44, 11
    s_add_u32 s46, s46, s47
    s_add_u32 s46, s46, 0xb000000
    v_add_u32 v4, s46, v2
    v_and_b32 v5, 31, v1
    v_lshlrev_b32 v5, 7, v5
    v_add_u32 v5, 0x108400, v5
    v_lshlrev_b32 v6, 2, v1
    s_lshl_b32 s46, s44, 9
    v_add_u32 v6, s46, v6
    s_lshl_b32 s46, s44, 12
    v_add_u32 v7, s46, v3
    s_lshl_b32 s46, s42, 3
    s_add_u32 s46, s46, s44
    s_lshl_b32 s46, s46, 11
    v_add_u32 v8, s46, v2
    v_add_u32 v9, 0x800000, v8
    s_mov_b32 s60, s43
L_r_loop_28:
    s_lshl_b32 s61, s60, 18
    s_lshl_b32 s63, s60, 16
    s_cmp_lg_u32 s44, 0
    s_cbranch_scc1 L_r_nsp_29
    s_mov_b32 s70, 0
L_spin_30:
    buffer_load_dword v14, v5, s[12:15], 0 offen sc1
    s_waitcnt vmcnt(0)
    v_cmp_ge_u32 vcc, s60, v14
    s_add_u32 s70, s70, 1
    s_cbranch_vccz L_spok_31
    s_sleep 8
    s_cmp_lt_u32 s70, 524288
    s_cbranch_scc1 L_spin_30
    s_branch L_c_done_1
L_spok_31:
L_r_nsp_29:
    s_barrier
    buffer_load_dwordx4 v[96:99], v4, s[12:15], s61 offen offset:0 sc1
    buffer_load_dwordx4 v[100:103], v4, s[12:15], s61 offen offset:1024 sc1
    s_add_u32 s61, s61, 65536
    buffer_load_dwordx4 v[104:107], v4, s[12:15], s61 offen offset:0 sc1
    buffer_load_dwordx4 v[108:111], v4, s[12:15], s61 offen offset:1024 sc1
    s_add_u32 s61, s61, 65536
    buffer_load_dwordx4 v[112:115], v4, s[12:15], s61 offen offset:0 sc1
    buffer_load_dwordx4 v[116:119], v4, s[12:15], s61 offen offset:1024 sc1
    s_add_u32 s61, s61, 65536
    buffer_load_dwordx4 v[120:123], v4, s[12:15], s61 offen offset:0 sc1
    buffer_load_dwordx4 v[124:127], v4, s[12:15], s61 offen offset:1024 sc1
    buffer_load_dwordx4 a[0:3], v9, s[12:15], s63 offen sc1
    buffer_load_dwordx4 a[4:7], v9, s[12:15], s63 offen offset:1024 sc1
    s_waitcnt vmcnt(8)
    v_lshlrev_b32 v64, 16, v96
    v_and_b32 v65, 0xffff0000, v96
    v_lshlrev_b32 v66, 16, v97
    v_and_b32 v67, 0xffff0000, v97
    v_lshlrev_b32 v68, 16, v98
    v_and_b32 v69, 0xffff0000, v98
    v_lshlrev_b32 v70, 16, v99
    v_and_b32 v71, 0xffff0000, v99
    v_lshlrev_b32 v72, 16, v100
    v_and_b32 v73, 0xffff0000, v100
    v_lshlrev_b32 v74, 16, v101
    v_and_b32 v75, 0xffff0000, v101
    v_lshlrev_b32 v76, 16, v102
    v_and_b32 v77, 0xffff0000, v102
    v_lshlrev_b32 v78, 16, v103
    v_and_b32 v79, 0xffff0000, v103
    s_waitcnt vmcnt(6)
    v_lshlrev_b32 v80, 16, v104
    v_and_b32 v81, 0xffff0000, v104
    v_lshlrev_b32 v82, 16, v105
    v_and_b32 v83, 0xffff0000, v105
    v_lshlrev_b32 v84, 16, v106
    v_and_b32 v85, 0xffff0000, v106
    v_lshlrev_b32 v86, 16, v107
    v_and_b32 v87, 0xffff0000, v107
    v_lshlrev_b32 v88, 16, v108
    v_and_b32 v89, 0xffff0000, v108
    v_lshlrev_b32 v90, 16, v109
    v_and_b32 v91, 0xffff0000, v109
    v_lshlrev_b32 v92, 16, v110
    v_and_b32 v93, 0xffff0000, v110
    v_lshlrev_b32 v94, 16, v111
    v_and_b32 v95, 0xffff0000, v111
    v_pk_add_f32 v[64:65], v[64:65], v[80:81]
    v_pk_add_f32 v[66:67], v[66:67], v[82:83]
    v_pk_add_f32 v[68:69], v[68:69], v[84:85]
    v_pk_add_f32 v[70:71], v[70:71], v[86:87]
    v_pk_add_f32 v[72:73], v[72:73], v[88:89]
    v_pk_add_f32 v[74:75], v[74:75], v[90:91]
    v_pk_add_f32 v[76:77], v[76:77], v[92:93]
    v_pk_add_f32 v[78:79], v[78:79], v[94:95]
    s_waitcnt vmcnt(4)
    v_lshlrev_b32 v80, 16, v112
    v_and_b32 v81, 0xffff0000, v112
    v_lshlrev_b32 v82, 16, v113
    v_and_b32 v83, 0xffff0000, v113
    v_lshlrev_b32 v84, 16, v114
    v_and_b32 v85, 0xffff0000, v114
    v_lshlrev_b32 v86, 16, v115
    v_and_b32 v87, 0xffff0000, v115
    v_lshlrev_b32 v88, 16, v116
    v_and_b32 v89, 0xffff0000, v116
    v_lshlrev_b32 v90, 16, v117
    v_and_b32 v91, 0xffff0000, v117
    v_lshlrev_b32 v92, 16, v118
    v_and_b32 v93, 0xffff0000, v118
    v_lshlrev_b32 v94, 16, v119
    v_and_b32 v95, 0xffff0000, v119
    v_pk_add_f32 v[64:65], v[64:65], v[80:81]
    v_pk_add_f32 v[66:67], v[66:67], v[82:83]
    v_pk_add_f32 v[68:69], v[68:69], v[84:85]
    v_pk_add_f32 v[70:71], v[70:71], v[86:87]
    v_pk_add_f32 v[72:73], v[72:73], v[88:89]
    v_pk_add_f32 v[74:75], v[74:75], v[90:91]
    v_pk_add_f32 v[76:77], v[76:77], v[92:93]
    v_pk_add_f32 v[78:79], v[78:79], v[94:95]
    s_waitcnt vmcnt(2)
    v_lshlrev_b32 v80, 16, v120
    v_and_b32 v81, 0xffff0000, v120
    v_lshlrev_b32 v82, 16, v121
    v_and_b32 v83, 0xffff0000, v121
    v_lshlrev_b32 v84, 16, v122
    v_and_b32 v85, 0xffff0000, v122
    v_lshlrev_b32 v86, 16, v123
    v_and_b32 v87, 0xffff0000, v123
    v_lshlrev_b32 v88, 16, v124
    v_and_b32 v89, 0xffff0000, v124
    v_lshlrev_b32 v90, 16, v125
    v_and_b32 v91, 0xffff0000, v125
    v_lshlrev_b32 v92, 16, v126
    v_and_b32 v93, 0xffff0000, v126
    v_lshlrev_b32 v94, 16, v127
    v_and_b32 v95, 0xffff0000, v127
    v_pk_add_f32 v[64:65], v[64:65], v[80:81]
    v_pk_add_f32 v[66:67], v[66:67], v[82:83]
    v_pk_add_f32 v[68:69], v[68:69], v[84:85]
    v_pk_add_f32 v[70:71], v[70:71], v[86:87]
    v_pk_add_f32 v[72:73], v[72:73], v[88:89]
    v_pk_add_f32 v[74:75], v[74:75], v[90:91]
    v_pk_add_f32 v[76:77], v[76:77], v[92:93]
    v_pk_add_f32 v[78:79], v[78:79], v[94:95]
    ds_write_b32 v6, v64 offset:0
    ds_write_b32 v6, v65 offset:4096
    ds_write_b32 v6, v66 offset:8192
    ds_write_b32 v6, v67 offset:12288
    ds_write_b32 v6, v68 offset:16384
    ds_write_b32 v6, v69 offset:20480
    ds_write_b32 v6, v70 offset:24576
    ds_write_b32 v6, v71 offset:28672
    ds_write_b32 v6, v72 offset:256
    ds_write_b32 v6, v73 offset:4352
    ds_write_b32 v6, v74 offset:8448
    ds_write_b32 v6, v75 offset:12544
    ds_write_b32 v6, v76 offset:16640
    ds_write_b32 v6, v77 offset:20736
    ds_write_b32 v6, v78 offset:24832
    ds_write_b32 v6, v79 offset:28928
    s_waitcnt lgkmcnt(0)
    s_barrier
    ds_read_b128 v[64:67], v7
    ds_read_b128 v[68:71], v7 offset:16
    ds_read_b128 v[72:75], v7 offset:2048
    ds_read_b128 v[76:79], v7 offset:2064
    s_waitcnt vmcnt(0)
    v_accvgpr_read_b32 v96, a0
    v_accvgpr_read_b32 v97, a1
    v_accvgpr_read_b32 v98, a2
    v_accvgpr_read_b32 v99, a3
    v_accvgpr_read_b32 v100, a4
    v_accvgpr_read_b32 v101, a5
    v_accvgpr_read_b32 v102, a6
    v_accvgpr_read_b32 v103, a7
    v_lshlrev_b32 v80, 16, v96
    v_and_b32 v81, 0xffff0000, v96
    v_lshlrev_b32 v82, 16, v97
    v_and_b32 v83, 0xffff0000, v97
    v_lshlrev_b32 v84, 16, v98
    v_and_b32 v85, 0xffff0000, v98
    v_lshlrev_b32 v86, 16, v99
    v_and_b32 v87, 0xffff0000, v99
    v_lshlrev_b32 v88, 16, v100
    v_and_b32 v89, 0xffff0000, v100
    v_lshlrev_b32 v90, 16, v101
    v_and_b32 v91, 0xffff0000, v101
    v_lshlrev_b32 v92, 16, v102
    v_and_b32 v93, 0xffff0000, v102
    v_lshlrev_b32 v94, 16, v103
    v_and_b32 v95, 0xffff0000, v103
    s_waitcnt lgkmcnt(0)
    v_cvt_pk_bf16_f32 v64, 0, v64
    v_cvt_pk_bf16_f32 v65, 0, v65
    v_cvt_pk_bf16_f32 v66, 0, v66
    v_cvt_pk_bf16_f32 v67, 0, v67
    v_cvt_pk_bf16_f32 v68, 0, v68
    v_cvt_pk_bf16_f32 v69, 0, v69
    v_cvt_pk_bf16_f32 v70, 0, v70
    v_cvt_pk_bf16_f32 v71, 0, v71
    v_cvt_pk_bf16_f32 v72, 0, v72
    v_cvt_pk_bf16_f32 v73, 0, v73
    v_cvt_pk_bf16_f32 v74, 0, v74
    v_cvt_pk_bf16_f32 v75, 0, v75
    v_cvt_pk_bf16_f32 v76, 0, v76
    v_cvt_pk_bf16_f32 v77, 0, v77
    v_cvt_pk_bf16_f32 v78, 0, v78
    v_cvt_pk_bf16_f32 v79, 0, v79
    v_pk_add_f32 v[64:65], v[64:65], v[32:33]
    v_pk_add_f32 v[66:67], v[66:67], v[34:35]
    v_pk_add_f32 v[68:69], v[68:69], v[36:37]
    v_pk_add_f32 v[70:71], v[70:71], v[38:39]
    v_pk_add_f32 v[72:73], v[72:73], v[40:41]
    v_pk_add_f32 v[74:75], v[74:75], v[42:43]
    v_pk_add_f32 v[76:77], v[76:77], v[44:45]
    v_pk_add_f32 v[78:79], v[78:79], v[46:47]
    v_cvt_pk_bf16_f32 v64, 0, v64
    v_cvt_pk_bf16_f32 v65, 0, v65
    v_cvt_pk_bf16_f32 v66, 0, v66
    v_cvt_pk_bf16_f32 v67, 0, v67
    v_cvt_pk_bf16_f32 v68, 0, v68
    v_cvt_pk_bf16_f32 v69, 0, v69
    v_cvt_pk_bf16_f32 v70, 0, v70
    v_cvt_pk_bf16_f32 v71, 0, v71
    v_cvt_pk_bf16_f32 v72, 0, v72
    v_cvt_pk_bf16_f32 v73, 0, v73
    v_cvt_pk_bf16_f32 v74, 0, v74
    v_cvt_pk_bf16_f32 v75, 0, v75
    v_cvt_pk_bf16_f32 v76, 0, v76
    v_cvt_pk_bf16_f32 v77, 0, v77
    v_cvt_pk_bf16_f32 v78, 0, v78
    v_cvt_pk_bf16_f32 v79, 0, v79
    v_pk_mul_f32 v[64:65], v[64:65], v[16:17]
    v_pk_mul_f32 v[66:67], v[66:67], v[18:19]
    v_pk_mul_f32 v[68:69], v[68:69], v[20:21]
    v_pk_mul_f32 v[70:71], v[70:71], v[22:23]
    v_pk_mul_f32 v[72:73], v[72:73], v[24:25]
    v_pk_mul_f32 v[74:75], v[74:75], v[26:27]
    v_pk_mul_f32 v[76:77], v[76:77], v[28:29]
    v_pk_mul_f32 v[78:79], v[78:79], v[30:31]
    v_cvt_pk_bf16_f32 v64, 0, v64
    v_cvt_pk_bf16_f32 v65, 0, v65
    v_cvt_pk_bf16_f32 v66, 0, v66
    v_cvt_pk_bf16_f32 v67, 0, v67
    v_cvt_pk_bf16_f32 v68, 0, v68
    v_cvt_pk_bf16_f32 v69, 0, v69
    v_cvt_pk_bf16_f32 v70, 0, v70
    v_cvt_pk_bf16_f32 v71, 0, v71
    v_cvt_pk_bf16_f32 v72, 0, v72
    v_cvt_pk_bf16_f32 v73, 0, v73
    v_cvt_pk_bf16_f32 v74, 0, v74
    v_cvt_pk_bf16_f32 v75, 0, v75
    v_cvt_pk_bf16_f32 v76, 0, v76
    v_cvt_pk_bf16_f32 v77, 0, v77
    v_cvt_pk_bf16_f32 v78, 0, v78
    v_cvt_pk_bf16_f32 v79, 0, v79
    v_pk_add_f32 v[64:65], v[64:65], v[80:81]
    v_pk_add_f32 v[66:67], v[66:67], v[82:83]
    v_pk_add_f32 v[68:69], v[68:69], v[84:85]
    v_pk_add_f32 v[70:71], v[70:71], v[86:87]
    v_pk_add_f32 v[72:73], v[72:73], v[88:89]
    v_pk_add_f32 v[74:75], v[74:75], v[90:91]
    v_pk_add_f32 v[76:77], v[76:77], v[92:93]
    v_pk_add_f32 v[78:79], v[78:79], v[94:95]
    v_cvt_pk_bf16_f32 v96, v64, v65
    v_cvt_pk_bf16_f32 v97, v66, v67
    v_cvt_pk_bf16_f32 v98, v68, v69
    v_cvt_pk_bf16_f32 v99, v70, v71
    v_cvt_pk_bf16_f32 v100, v72, v73
    v_cvt_pk_bf16_f32 v101, v74, v75
    v_cvt_pk_bf16_f32 v102, v76, v77
    v_cvt_pk_bf16_f32 v103, v78, v79
    buffer_store_dwordx4 v[96:99], v8, s[24:27], s63 offen
    buffer_store_dwordx4 v[100:103], v8, s[24:27], s63 offen offset:1024
    s_add_u32 s60, s60, 2
    s_cmp_lt_u32 s60, 64
    s_cbranch_scc1 L_r_loop_28
    s_branch L_c_done_1
L_w_c_14:
    s_load_dwordx2 s[4:5], s[0:1], 0
    s_load_dwordx2 s[6:7], s[0:1], 88
    v_lshlrev_b32 v2, 4, v1
    v_lshlrev_b32 v3, 5, v1
    s_waitcnt lgkmcnt(0)
    s_mov_b32 s24, s4
    s_and_b32 s25, s5, 0xffff
    s_mov_b32 s26, 0x400000
    s_mov_b32 s27, 0x00020000
    s_mov_b32 s28, s6
    s_and_b32 s29, s7, 0xffff
    s_mov_b32 s30, 0x800
    s_mov_b32 s31, 0x00020000
    s_cmp_lg_u32 s44, 0
    s_cbranch_scc1 L_mw_32
    v_and_b32 v8, 15, v1
    v_lshlrev_b32 v8, 7, v8
    s_mov_b32 s46, 0x10e400
    s_mov_b32 s47, 0
    s_mov_b32 s70, 0
L_spin_33:
    buffer_load_dword v9, v8, s[12:15], s46 offen sc1
    s_waitcnt vmcnt(0)
    v_cmp_ge_u32 vcc, s47, v9
    s_add_u32 s70, s70, 1
    s_cbranch_vccz L_spok_34
    s_sleep 2
    s_cmp_lt_u32 s70, 524288
    s_cbranch_scc1 L_spin_33
    s_branch L_c_done_1
L_spok_34:
L_mw_32:
    s_barrier
    s_mov_b32 s46, 8192
    buffer_load_dwordx4 v[16:19], v3, s[12:15], s46 offen offset:0 sc1
    buffer_load_dwordx4 v[20:23], v3, s[12:15], s46 offen offset:16 sc1
    buffer_load_dwordx4 v[24:27], v3, s[12:15], s46 offen offset:2048 sc1
    buffer_load_dwordx4 v[28:31], v3, s[12:15], s46 offen offset:2064 sc1
    s_mov_b32 s46, 16384
    buffer_load_dwordx4 v[32:35], v3, s[12:15], s46 offen offset:0 sc1
    buffer_load_dwordx4 v[36:39], v3, s[12:15], s46 offen offset:16 sc1
    buffer_load_dwordx4 v[40:43], v3, s[12:15], s46 offen offset:2048 sc1
    buffer_load_dwordx4 v[44:47], v3, s[12:15], s46 offen offset:2064 sc1
    s_mov_b32 s46, 12288
    buffer_load_dwordx4 v[48:51], v3, s[12:15], s46 offen offset:0 sc1
    buffer_load_dwordx4 v[52:55], v3, s[12:15], s46 offen offset:16 sc1
    buffer_load_dwordx4 v[56:59], v3, s[12:15], s46 offen offset:2048 sc1
    buffer_load_dwordx4 v[60:63], v3, s[12:15], s46 offen offset:2064 sc1
    s_waitcnt vmcnt(0)
    v_add_f32 v32, 1.0, v32
    v_add_f32 v33, 1.0, v33
    v_add_f32 v34, 1.0, v34
    v_add_f32 v35, 1.0, v35
    v_add_f32 v36, 1.0, v36
    v_add_f32 v37, 1.0, v37
    v_add_f32 v38, 1.0, v38
    v_add_f32 v39, 1.0, v39
    v_add_f32 v40, 1.0, v40
    v_add_f32 v41, 1.0, v41
    v_add_f32 v42, 1.0, v42
    v_add_f32 v43, 1.0, v43
    v_add_f32 v44, 1.0, v44
    v_add_f32 v45, 1.0, v45
    v_add_f32 v46, 1.0, v46
    v_add_f32 v47, 1.0, v47
    v_cvt_pk_bf16_f32 v32, 0, v32
    v_cvt_pk_bf16_f32 v33, 0, v33
    v_cvt_pk_bf16_f32 v34, 0, v34
    v_cvt_pk_bf16_f32 v35, 0, v35
    v_cvt_pk_bf16_f32 v36, 0, v36
    v_cvt_pk_bf16_f32 v37, 0, v37
    v_cvt_pk_bf16_f32 v38, 0, v38
    v_cvt_pk_bf16_f32 v39, 0, v39
    v_cvt_pk_bf16_f32 v40, 0, v40
    v_cvt_pk_bf16_f32 v41, 0, v41
    v_cvt_pk_bf16_f32 v42, 0, v42
    v_cvt_pk_bf16_f32 v43, 0, v43
    v_cvt_pk_bf16_f32 v44, 0, v44
    v_cvt_pk_bf16_f32 v45, 0, v45
    v_cvt_pk_bf16_f32 v46, 0, v46
    v_cvt_pk_bf16_f32 v47, 0, v47
    s_lshl_b32 s46, s42, 14
    s_lshl_b32 s47, s44, 11
    s_add_u32 s46, s46, s47
    s_add_u32 s46, s46, 0x9000000
    v_add_u32 v4, s46, v2
    v_and_b32 v5, 31, v1
    v_lshlrev_b32 v5, 7, v5
    v_add_u32 v5, 0x107400, v5
    v_lshlrev_b32 v6, 2, v1
    s_lshl_b32 s46, s44, 9
    v_add_u32 v6, s46, v6
    s_lshl_b32 s46, s44, 12
    v_add_u32 v7, s46, v3
    s_lshl_b32 s46, s42, 3
    s_add_u32 s46, s46, s44
    s_lshl_b32 s46, s46, 11
    v_add_u32 v8, s46, v2
    v_add_u32 v9, 0x800000, v8
    s_mul_i32 s46, s44, 2064
    s_add_u32 s46, s46, 32768
    v_add_u32 v10, s46, v2
    v_and_b32 v11, 7, v1
    v_lshrrev_b32 v12, 3, v1
    v_mul_u32_u24 v13, 2064, v11
    v_lshl_add_u32 v13, v12, 4, v13
    s_lshl_b32 s46, s44, 8
    s_add_u32 s46, s46, 32768
    v_add_u32 v13, s46, v13
    v_lshlrev_b32 v11, 4, v11
    v_lshl_add_u32 v11, v12, 9, v11
    s_lshl_b32 s46, s44, 13
    s_lshl_b32 s47, s42, 7
    s_add_u32 s46, s46, s47
    s_add_u32 s46, s46, 0xc00000
    v_add_u32 v11, s46, v11
    v_add_u32 v12, 4096, v11
    s_lshl_b32 s52, s43, 9
    s_lshl_b32 s47, s42, 7
    s_add_u32 s52, s52, s47
    s_add_u32 s52, s52, 0x10ec00
    s_mov_b32 s60, s43
L_r_loop_35:
    s_lshl_b32 s61, s60, 18
    s_lshl_b32 s63, s60, 16
    buffer_load_dwordx4 a[0:3], v8, s[24:27], s63 offen
    buffer_load_dwordx4 a[4:7], v8, s[24:27], s63 offen offset:1024
    s_cmp_lg_u32 s44, 0
    s_cbranch_scc1 L_r_nsp_36
    s_mov_b32 s70, 0
L_spin_37:
    buffer_load_dword v14, v5, s[12:15], 0 offen sc1
    s_waitcnt vmcnt(0)
    v_cmp_ge_u32 vcc, s60, v14
    s_add_u32 s70, s70, 1
    s_cbranch_vccz L_spok_38
    s_sleep 8
    s_cmp_lt_u32 s70, 524288
    s_cbranch_scc1 L_spin_37
    s_branch L_c_done_1
L_spok_38:
L_r_nsp_36:
    s_barrier
    buffer_load_dwordx4 v[96:99], v4, s[12:15], s61 offen offset:0 sc1
    buffer_load_dwordx4 v[100:103], v4, s[12:15], s61 offen offset:1024 sc1
    s_add_u32 s61, s61, 65536
    buffer_load_dwordx4 v[104:107], v4, s[12:15], s61 offen offset:0 sc1
    buffer_load_dwordx4 v[108:111], v4, s[12:15], s61 offen offset:1024 sc1
    s_add_u32 s61, s61, 65536
    buffer_load_dwordx4 v[112:115], v4, s[12:15], s61 offen offset:0 sc1
    buffer_load_dwordx4 v[116:119], v4, s[12:15], s61 offen offset:1024 sc1
    s_add_u32 s61, s61, 65536
    buffer_load_dwordx4 v[120:123], v4, s[12:15], s61 offen offset:0 sc1
    buffer_load_dwordx4 v[124:127], v4, s[12:15], s61 offen offset:1024 sc1
    s_waitcnt vmcnt(6)
    v_lshlrev_b32 v64, 16, v96
    v_and_b32 v65, 0xffff0000, v96
    v_lshlrev_b32 v66, 16, v97
    v_and_b32 v67, 0xffff0000, v97
    v_lshlrev_b32 v68, 16, v98
    v_and_b32 v69, 0xffff0000, v98
    v_lshlrev_b32 v70, 16, v99
    v_and_b32 v71, 0xffff0000, v99
    v_lshlrev_b32 v72, 16, v100
    v_and_b32 v73, 0xffff0000, v100
    v_lshlrev_b32 v74, 16, v101
    v_and_b32 v75, 0xffff0000, v101
    v_lshlrev_b32 v76, 16, v102
    v_and_b32 v77, 0xffff0000, v102
    v_lshlrev_b32 v78, 16, v103
    v_and_b32 v79, 0xffff0000, v103
    s_waitcnt vmcnt(4)
    v_lshlrev_b32 v80, 16, v104
    v_and_b32 v81, 0xffff0000, v104
    v_lshlrev_b32 v82, 16, v105
    v_and_b32 v83, 0xffff0000, v105
    v_lshlrev_b32 v84, 16, v106
    v_and_b32 v85, 0xffff0000, v106
    v_lshlrev_b32 v86, 16, v107
    v_and_b32 v87, 0xffff0000, v107
    v_lshlrev_b32 v88, 16, v108
    v_and_b32 v89, 0xffff0000, v108
    v_lshlrev_b32 v90, 16, v109
    v_and_b32 v91, 0xffff0000, v109
    v_lshlrev_b32 v92, 16, v110
    v_and_b32 v93, 0xffff0000, v110
    v_lshlrev_b32 v94, 16, v111
    v_and_b32 v95, 0xffff0000, v111
    v_pk_add_f32 v[64:65], v[64:65], v[80:81]
    v_pk_add_f32 v[66:67], v[66:67], v[82:83]
    v_pk_add_f32 v[68:69], v[68:69], v[84:85]
    v_pk_add_f32 v[70:71], v[70:71], v[86:87]
    v_pk_add_f32 v[72:73], v[72:73], v[88:89]
    v_pk_add_f32 v[74:75], v[74:75], v[90:91]
    v_pk_add_f32 v[76:77], v[76:77], v[92:93]
    v_pk_add_f32 v[78:79], v[78:79], v[94:95]
    s_waitcnt vmcnt(2)
    v_lshlrev_b32 v80, 16, v112
    v_and_b32 v81, 0xffff0000, v112
    v_lshlrev_b32 v82, 16, v113
    v_and_b32 v83, 0xffff0000, v113
    v_lshlrev_b32 v84, 16, v114
    v_and_b32 v85, 0xffff0000, v114
    v_lshlrev_b32 v86, 16, v115
    v_and_b32 v87, 0xffff0000, v115
    v_lshlrev_b32 v88, 16, v116
    v_and_b32 v89, 0xffff0000, v116
    v_lshlrev_b32 v90, 16, v117
    v_and_b32 v91, 0xffff0000, v117
    v_lshlrev_b32 v92, 16, v118
    v_and_b32 v93, 0xffff0000, v118
    v_lshlrev_b32 v94, 16, v119
    v_and_b32 v95, 0xffff0000, v119
    v_pk_add_f32 v[64:65], v[64:65], v[80:81]
    v_pk_add_f32 v[66:67], v[66:67], v[82:83]
    v_pk_add_f32 v[68:69], v[68:69], v[84:85]
    v_pk_add_f32 v[70:71], v[70:71], v[86:87]
    v_pk_add_f32 v[72:73], v[72:73], v[88:89]
    v_pk_add_f32 v[74:75], v[74:75], v[90:91]
    v_pk_add_f32 v[76:77], v[76:77], v[92:93]
    v_pk_add_f32 v[78:79], v[78:79], v[94:95]
    s_waitcnt vmcnt(0)
    v_lshlrev_b32 v80, 16, v120
    v_and_b32 v81, 0xffff0000, v120
    v_lshlrev_b32 v82, 16, v121
    v_and_b32 v83, 0xffff0000, v121
    v_lshlrev_b32 v84, 16, v122
    v_and_b32 v85, 0xffff0000, v122
    v_lshlrev_b32 v86, 16, v123
    v_and_b32 v87, 0xffff0000, v123
    v_lshlrev_b32 v88, 16, v124
    v_and_b32 v89, 0xffff0000, v124
    v_lshlrev_b32 v90, 16, v125
    v_and_b32 v91, 0xffff0000, v125
    v_lshlrev_b32 v92, 16, v126
    v_and_b32 v93, 0xffff0000, v126
    v_lshlrev_b32 v94, 16, v127
    v_and_b32 v95, 0xffff0000, v127
    v_pk_add_f32 v[64:65], v[64:65], v[80:81]
    v_pk_add_f32 v[66:67], v[66:67], v[82:83]
    v_pk_add_f32 v[68:69], v[68:69], v[84:85]
    v_pk_add_f32 v[70:71], v[70:71], v[86:87]
    v_pk_add_f32 v[72:73], v[72:73], v[88:89]
    v_pk_add_f32 v[74:75], v[74:75], v[90:91]
    v_pk_add_f32 v[76:77], v[76:77], v[92:93]
    v_pk_add_f32 v[78:79], v[78:79], v[94:95]
    ds_write_b32 v6, v64 offset:0
    ds_write_b32 v6, v65 offset:4096
    ds_write_b32 v6, v66 offset:8192
    ds_write_b32 v6, v67 offset:12288
    ds_write_b32 v6, v68 offset:16384
    ds_write_b32 v6, v69 offset:20480
    ds_write_b32 v6, v70 offset:24576
    ds_write_b32 v6, v71 offset:28672
    ds_write_b32 v6, v72 offset:256
    ds_write_b32 v6, v73 offset:4352
    ds_write_b32 v6, v74 offset:8448
    ds_write_b32 v6, v75 offset:12544
    ds_write_b32 v6, v76 offset:16640
    ds_write_b32 v6, v77 offset:20736
    ds_write_b32 v6, v78 offset:24832
    ds_write_b32 v6, v79 offset:28928
    s_waitcnt lgkmcnt(0)
    s_barrier
    ds_read_b128 v[64:67], v7
    ds_read_b128 v[68:71], v7 offset:16
    ds_read_b128 v[72:75], v7 offset:2048
    ds_read_b128 v[76:79], v7 offset:2064
    s_waitcnt vmcnt(0)
    v_accvgpr_read_b32 v96, a0
    v_accvgpr_read_b32 v97, a1
    v_accvgpr_read_b32 v98, a2
    v_accvgpr_read_b32 v99, a3
    v_accvgpr_read_b32 v100, a4
    v_accvgpr_read_b32 v101, a5
    v_accvgpr_read_b32 v102, a6
    v_accvgpr_read_b32 v103, a7
    v_lshlrev_b32 v80, 16, v96
    v_and_b32 v81, 0xffff0000, v96
    v_lshlrev_b32 v82, 16, v97
    v_and_b32 v83, 0xffff0000, v97
    v_lshlrev_b32 v84, 16, v98
    v_and_b32 v85, 0xffff0000, v98
    v_lshlrev_b32 v86, 16, v99
    v_and_b32 v87, 0xffff0000, v99
    v_lshlrev_b32 v88, 16, v100
    v_and_b32 v89, 0xffff0000, v100
    v_lshlrev_b32 v90, 16, v101
    v_and_b32 v91, 0xffff0000, v101
    v_lshlrev_b32 v92, 16, v102
    v_and_b32 v93, 0xffff0000, v102
    v_lshlrev_b32 v94, 16, v103
    v_and_b32 v95, 0xffff0000, v103
    s_waitcnt lgkmcnt(0)
    v_cvt_pk_bf16_f32 v64, 0, v64
    v_cvt_pk_bf16_f32 v65, 0, v65
    v_cvt_pk_bf16_f32 v66, 0, v66
    v_cvt_pk_bf16_f32 v67, 0, v67
    v_cvt_pk_bf16_f32 v68, 0, v68
    v_cvt_pk_bf16_f32 v69, 0, v69
    v_cvt_pk_bf16_f32 v70, 0, v70
    v_cvt_pk_bf16_f32 v71, 0, v71
    v_cvt_pk_bf16_f32 v72, 0, v72
    v_cvt_pk_bf16_f32 v73, 0, v73
    v_cvt_pk_bf16_f32 v74, 0, v74
    v_cvt_pk_bf16_f32 v75, 0, v75
    v_cvt_pk_bf16_f32 v76, 0, v76
    v_cvt_pk_bf16_f32 v77, 0, v77
    v_cvt_pk_bf16_f32 v78, 0, v78
    v_cvt_pk_bf16_f32 v79, 0, v79
    v_pk_mul_f32 v[64:65], v[64:65], v[16:17]
    v_pk_mul_f32 v[66:67], v[66:67], v[18:19]
    v_pk_mul_f32 v[68:69], v[68:69], v[20:21]
    v_pk_mul_f32 v[70:71], v[70:71], v[22:23]
    v_pk_mul_f32 v[72:73], v[72:73], v[24:25]
    v_pk_mul_f32 v[74:75], v[74:75], v[26:27]
    v_pk_mul_f32 v[76:77], v[76:77], v[28:29]
    v_pk_mul_f32 v[78:79], v[78:79], v[30:31]
    v_cvt_pk_bf16_f32 v64, 0, v64
    v_cvt_pk_bf16_f32 v65, 0, v65
    v_cvt_pk_bf16_f32 v66, 0, v66
    v_cvt_pk_bf16_f32 v67, 0, v67
    v_cvt_pk_bf16_f32 v68, 0, v68
    v_cvt_pk_bf16_f32 v69, 0, v69
    v_cvt_pk_bf16_f32 v70, 0, v70
    v_cvt_pk_bf16_f32 v71, 0, v71
    v_cvt_pk_bf16_f32 v72, 0, v72
    v_cvt_pk_bf16_f32 v73, 0, v73
    v_cvt_pk_bf16_f32 v74, 0, v74
    v_cvt_pk_bf16_f32 v75, 0, v75
    v_cvt_pk_bf16_f32 v76, 0, v76
    v_cvt_pk_bf16_f32 v77, 0, v77
    v_cvt_pk_bf16_f32 v78, 0, v78
    v_cvt_pk_bf16_f32 v79, 0, v79
    v_pk_add_f32 v[64:65], v[64:65], v[80:81]
    v_pk_add_f32 v[66:67], v[66:67], v[82:83]
    v_pk_add_f32 v[68:69], v[68:69], v[84:85]
    v_pk_add_f32 v[70:71], v[70:71], v[86:87]
    v_pk_add_f32 v[72:73], v[72:73], v[88:89]
    v_pk_add_f32 v[74:75], v[74:75], v[90:91]
    v_pk_add_f32 v[76:77], v[76:77], v[92:93]
    v_pk_add_f32 v[78:79], v[78:79], v[94:95]
    v_cvt_pk_bf16_f32 v96, v64, v65
    v_cvt_pk_bf16_f32 v97, v66, v67
    v_cvt_pk_bf16_f32 v98, v68, v69
    v_cvt_pk_bf16_f32 v99, v70, v71
    v_cvt_pk_bf16_f32 v100, v72, v73
    v_cvt_pk_bf16_f32 v101, v74, v75
    v_cvt_pk_bf16_f32 v102, v76, v77
    v_cvt_pk_bf16_f32 v103, v78, v79
    buffer_store_dwordx4 v[96:99], v9, s[12:15], s63 offen sc1
    buffer_store_dwordx4 v[100:103], v9, s[12:15], s63 offen offset:1024 sc1
    v_lshlrev_b32 v64, 16, v96
    v_and_b32 v65, 0xffff0000, v96
    v_lshlrev_b32 v66, 16, v97
    v_and_b32 v67, 0xffff0000, v97
    v_lshlrev_b32 v68, 16, v98
    v_and_b32 v69, 0xffff0000, v98
    v_lshlrev_b32 v70, 16, v99
    v_and_b32 v71, 0xffff0000, v99
    v_lshlrev_b32 v72, 16, v100
    v_and_b32 v73, 0xffff0000, v100
    v_lshlrev_b32 v74, 16, v101
    v_and_b32 v75, 0xffff0000, v101
    v_lshlrev_b32 v76, 16, v102
    v_and_b32 v77, 0xffff0000, v102
    v_lshlrev_b32 v78, 16, v103
    v_and_b32 v79, 0xffff0000, v103
    v_pk_add_f32 v[80:81], v[64:65], v[72:73]
    v_pk_add_f32 v[82:83], v[66:67], v[74:75]
    v_pk_add_f32 v[84:85], v[68:69], v[76:77]
    v_pk_add_f32 v[86:87], v[70:71], v[78:79]
    v_pk_add_f32 v[80:81], v[80:81], v[84:85]
    v_pk_add_f32 v[82:83], v[82:83], v[86:87]
    v_pk_add_f32 v[80:81], v[80:81], v[82:83]
    v_add_f32 v14, v80, v81
    s_nop 1
    v_add_f32_dpp v14, v14, v14 row_shr:1 row_mask:0xf bank_mask:0xf bound_ctrl:0
    s_nop 1
    v_add_f32_dpp v14, v14, v14 row_shr:2 row_mask:0xf bank_mask:0xf bound_ctrl:0
    s_nop 1
    v_add_f32_dpp v14, v14, v14 row_shr:4 row_mask:0xf bank_mask:0xf bound_ctrl:0
    s_nop 1
    v_add_f32_dpp v14, v14, v14 row_shr:8 row_mask:0xf bank_mask:0xf bound_ctrl:0
    s_nop 1
    v_add_f32_dpp v14, v14, v14 row_bcast:15 row_mask:0xa bank_mask:0xf
    s_nop 1
    v_add_f32_dpp v14, v14, v14 row_bcast:31 row_mask:0xc bank_mask:0xf
    s_nop 1
    v_readlane_b32 s46, v14, 63
    s_nop 1
    v_mov_b32 v15, s46
    v_mul_f32 v15, 0x3a800000, v15
    v_pk_add_f32 v[80:81], v[64:65], v[14:15] op_sel:[0,1] op_sel_hi:[1,1] neg_lo:[0,1] neg_hi:[0,1]
    v_pk_add_f32 v[82:83], v[66:67], v[14:15] op_sel:[0,1] op_sel_hi:[1,1] neg_lo:[0,1] neg_hi:[0,1]
    v_pk_add_f32 v[84:85], v[68:69], v[14:15] op_sel:[0,1] op_sel_hi:[1,1] neg_lo:[0,1] neg_hi:[0,1]
    v_pk_add_f32 v[86:87], v[70:71], v[14:15] op_sel:[0,1] op_sel_hi:[1,1] neg_lo:[0,1] neg_hi:[0,1]
    v_pk_add_f32 v[88:89], v[72:73], v[14:15] op_sel:[0,1] op_sel_hi:[1,1] neg_lo:[0,1] neg_hi:[0,1]
    v_pk_add_f32 v[90:91], v[74:75], v[14:15] op_sel:[0,1] op_sel_hi:[1,1] neg_lo:[0,1] neg_hi:[0,1]
    v_pk_add_f32 v[92:93], v[76:77], v[14:15] op_sel:[0,1] op_sel_hi:[1,1] neg_lo:[0,1] neg_hi:[0,1]
    v_pk_add_f32 v[94:95], v[78:79], v[14:15] op_sel:[0,1] op_sel_hi:[1,1] neg_lo:[0,1] neg_hi:[0,1]
    v_pk_mul_f32 v[104:105], v[80:81], v[80:81]
    v_pk_mul_f32 v[106:107], v[82:83], v[82:83]
    v_pk_fma_f32 v[104:105], v[84:85], v[84:85], v[104:105]
    v_pk_fma_f32 v[106:107], v[86:87], v[86:87], v[106:107]
    v_pk_fma_f32 v[104:105], v[88:89], v[88:89], v[104:105]
    v_pk_fma_f32 v[106:107], v[90:91], v[90:91], v[106:107]
    v_pk_fma_f32 v[104:105], v[92:93], v[92:93], v[104:105]
    v_pk_fma_f32 v[106:107], v[94:95], v[94:95], v[106:107]
    v_pk_add_f32 v[104:105], v[104:105], v[106:107]
    v_add_f32 v14, v104, v105
    v_cvt_pk_bf16_f32 v15, 0, v15
    s_nop 1
    v_add_f32_dpp v14, v14, v14 row_shr:1 row_mask:0xf bank_mask:0xf bound_ctrl:0
    s_nop 1
    v_add_f32_dpp v14, v14, v14 row_shr:2 row_mask:0xf bank_mask:0xf bound_ctrl:0
    s_nop 1
    v_add_f32_dpp v14, v14, v14 row_shr:4 row_mask:0xf bank_mask:0xf bound_ctrl:0
    s_nop 1
    v_add_f32_dpp v14, v14, v14 row_shr:8 row_mask:0xf bank_mask:0xf bound_ctrl:0
    s_nop 1
    v_add_f32_dpp v14, v14, v14 row_bcast:15 row_mask:0xa bank_mask:0xf
    s_nop 1
    v_add_f32_dpp v14, v14, v14 row_bcast:31 row_mask:0xc bank_mask:0xf
    s_nop 1
    v_readlane_b32 s47, v14, 63
    v_pk_add_f32 v[64:65], v[64:65], v[14:15] op_sel:[0,1] op_sel_hi:[1,1] neg_lo:[0,1] neg_hi:[0,1]
    v_pk_add_f32 v[66:67], v[66:67], v[14:15] op_sel:[0,1] op_sel_hi:[1,1] neg_lo:[0,1] neg_hi:[0,1]
    v_pk_add_f32 v[68:69], v[68:69], v[14:15] op_sel:[0,1] op_sel_hi:[1,1] neg_lo:[0,1] neg_hi:[0,1]
    v_pk_add_f32 v[70:71], v[70:71], v[14:15] op_sel:[0,1] op_sel_hi:[1,1] neg_lo:[0,1] neg_hi:[0,1]
    v_pk_add_f32 v[72:73], v[72:73], v[14:15] op_sel:[0,1] op_sel_hi:[1,1] neg_lo:[0,1] neg_hi:[0,1]
    v_pk_add_f32 v[74:75], v[74:75], v[14:15] op_sel:[0,1] op_sel_hi:[1,1] neg_lo:[0,1] neg_hi:[0,1]
    v_pk_add_f32 v[76:77], v[76:77], v[14:15] op_sel:[0,1] op_sel_hi:[1,1] neg_lo:[0,1] neg_hi:[0,1]
    v_pk_add_f32 v[78:79], v[78:79], v[14:15] op_sel:[0,1] op_sel_hi:[1,1] neg_lo:[0,1] neg_hi:[0,1]
    v_mov_b32 v14, s47
    v_mul_f32 v14, 0x3a800000, v14
    v_cvt_pk_bf16_f32 v14, 0, v14
    v_add_f32 v14, 0x3727c5ac, v14
    v_cvt_pk_bf16_f32 v14, 0, v14
    v_sqrt_f32 v14, v14
    s_nop 0
    v_cvt_pk_bf16_f32 v14, 0, v14
    v_rcp_f32 v14, v14
    v_cvt_pk_bf16_f32 v64, 0, v64
    v_cvt_pk_bf16_f32 v65, 0, v65
    v_cvt_pk_bf16_f32 v66, 0, v66
    v_cvt_pk_bf16_f32 v67, 0, v67
    v_cvt_pk_bf16_f32 v68, 0, v68
    v_cvt_pk_bf16_f32 v69, 0, v69
    v_cvt_pk_bf16_f32 v70, 0, v70
    v_cvt_pk_bf16_f32 v71, 0, v71
    v_cvt_pk_bf16_f32 v72, 0, v72
    v_cvt_pk_bf16_f32 v73, 0, v73
    v_cvt_pk_bf16_f32 v74, 0, v74
    v_cvt_pk_bf16_f32 v75, 0, v75
    v_cvt_pk_bf16_f32 v76, 0, v76
    v_cvt_pk_bf16_f32 v77, 0, v77
    v_cvt_pk_bf16_f32 v78, 0, v78
    v_cvt_pk_bf16_f32 v79, 0, v79
    v_pk_mul_f32 v[64:65], v[64:65], v[14:15] op_sel_hi:[1,0]
    v_pk_mul_f32 v[66:67], v[66:67], v[14:15] op_sel_hi:[1,0]
    v_pk_mul_f32 v[68:69], v[68:69], v[14:15] op_sel_hi:[1,0]
    v_pk_mul_f32 v[70:71], v[70:71], v[14:15] op_sel_hi:[1,0]
    v_pk_mul_f32 v[72:73], v[72:73], v[14:15] op_sel_hi:[1,0]
    v_pk_mul_f32 v[74:75], v[74:75], v[14:15] op_sel_hi:[1,0]
    v_pk_mul_f32 v[76:77], v[76:77], v[14:15] op_sel_hi:[1,0]
    v_pk_mul_f32 v[78:79], v[78:79], v[14:15] op_sel_hi:[1,0]
    v_cvt_pk_bf16_f32 v64, 0, v64
    v_cvt_pk_bf16_f32 v65, 0, v65
    v_cvt_pk_bf16_f32 v66, 0, v66
    v_cvt_pk_bf16_f32 v67, 0, v67
    v_cvt_pk_bf16_f32 v68, 0, v68
    v_cvt_pk_bf16_f32 v69, 0, v69
    v_cvt_pk_bf16_f32 v70, 0, v70
    v_cvt_pk_bf16_f32 v71, 0, v71
    v_cvt_pk_bf16_f32 v72, 0, v72
    v_cvt_pk_bf16_f32 v73, 0, v73
    v_cvt_pk_bf16_f32 v74, 0, v74
    v_cvt_pk_bf16_f32 v75, 0, v75
    v_cvt_pk_bf16_f32 v76, 0, v76
    v_cvt_pk_bf16_f32 v77, 0, v77
    v_cvt_pk_bf16_f32 v78, 0, v78
    v_cvt_pk_bf16_f32 v79, 0, v79
    v_pk_mul_f32 v[64:65], v[64:65], v[32:33]
    v_pk_mul_f32 v[66:67], v[66:67], v[34:35]
    v_pk_mul_f32 v[68:69], v[68:69], v[36:37]
    v_pk_mul_f32 v[70:71], v[70:71], v[38:39]
    v_pk_mul_f32 v[72:73], v[72:73], v[40:41]
    v_pk_mul_f32 v[74:75], v[74:75], v[42:43]
    v_pk_mul_f32 v[76:77], v[76:77], v[44:45]
    v_pk_mul_f32 v[78:79], v[78:79], v[46:47]
    v_cvt_pk_bf16_f32 v64, 0, v64
    v_cvt_pk_bf16_f32 v65, 0, v65
    v_cvt_pk_bf16_f32 v66, 0, v66
    v_cvt_pk_bf16_f32 v67, 0, v67
    v_cvt_pk_bf16_f32 v68, 0, v68
    v_cvt_pk_bf16_f32 v69, 0, v69
    v_cvt_pk_bf16_f32 v70, 0, v70
    v_cvt_pk_bf16_f32 v71, 0, v71
    v_cvt_pk_bf16_f32 v72, 0, v72
    v_cvt_pk_bf16_f32 v73, 0, v73
    v_cvt_pk_bf16_f32 v74, 0, v74
    v_cvt_pk_bf16_f32 v75, 0, v75
    v_cvt_pk_bf16_f32 v76, 0, v76
    v_cvt_pk_bf16_f32 v77, 0, v77
    v_cvt_pk_bf16_f32 v78, 0, v78
    v_cvt_pk_bf16_f32 v79, 0, v79
    v_pk_add_f32 v[64:65], v[64:65], v[48:49]
    v_pk_add_f32 v[66:67], v[66:67], v[50:51]
    v_pk_add_f32 v[68:69], v[68:69], v[52:53]
    v_pk_add_f32 v[70:71], v[70:71], v[54:55]
    v_pk_add_f32 v[72:73], v[72:73], v[56:57]
    v_pk_add_f32 v[74:75], v[74:75], v[58:59]
    v_pk_add_f32 v[76:77], v[76:77], v[60:61]
    v_pk_add_f32 v[78:79], v[78:79], v[62:63]
    v_cvt_pk_bf16_f32 v104, v64, v65
    v_cvt_pk_bf16_f32 v105, v66, v67
    v_cvt_pk_bf16_f32 v106, v68, v69
    v_cvt_pk_bf16_f32 v107, v70, v71
    v_cvt_pk_bf16_f32 v108, v72, v73
    v_cvt_pk_bf16_f32 v109, v74, v75
    v_cvt_pk_bf16_f32 v110, v76, v77
    v_cvt_pk_bf16_f32 v111, v78, v79
    ds_write_b128 v10, v[104:107]
    ds_write_b128 v10, v[108:111] offset:1024
    s_waitcnt lgkmcnt(0)
    s_barrier
    ds_read_b128 v[104:107], v13
    ds_read_b128 v[108:111], v13 offset:128
    s_waitcnt lgkmcnt(1)
    buffer_store_dwordx4 v[104:107], v11, s[12:15], s63 offen sc1
    s_waitcnt lgkmcnt(0)
    buffer_store_dwordx4 v[108:111], v12, s[12:15], s63 offen sc1
    s_waitcnt vmcnt(0)
    s_barrier
    s_cmp_lg_u32 s44, 0
    s_cbranch_scc1 L_sf_39
    v_mov_b32 v14, s60
    v_add_u32 v14, 1, v14
    v_mov_b32 v15, 0
    s_mov_b64 exec, 1
    buffer_store_dword v14, v15, s[12:15], s52 offen sc1
    s_mov_b64 exec, -1
L_sf_39:
    s_add_u32 s60, s60, 3
    s_cmp_lt_u32 s60, 64
    s_cbranch_scc1 L_r_loop_35
    s_branch L_c_done_1
L_w_att_13:
    s_lshl_b32 s42, s40, 2
    s_and_b32 s46, s44, 3
    s_add_u32 s42, s42, s46
    s_and_b32 s43, s48, 1
    s_lshl_b32 s43, s43, 1
    s_lshr_b32 s46, s44, 2
    s_add_u32 s43, s43, s46
    s_mul_i32 s46, s42, 24576
    s_add_u32 s46, s46, 0x2000000
    v_lshlrev_b32 v2, 4, v1
    v_add_u32 v3, s46, v2
    v_add_u32 v5, 4096, v3
    v_lshrrev_b32 v4, 4, v1
    v_and_b32 v9, 15, v1
    s_lshl_b32 s46, s42, 12
    s_add_u32 s46, s46, 0x1000000
    v_and_b32 v6, 7, v1
    v_lshlrev_b32 v6, 4, v6
    v_lshl_add_u32 v6, v4, 7, v6
    v_add_u32 v6, s46, v6
    v_and_b32 v7, 31, v1
    v_lshlrev_b32 v7, 4, v7
    v_lshrrev_b32 v10, 5, v1
    v_lshl_add_u32 v7, v10, 10, v7
    v_add_u32 v7, s46, v7
    s_mul_i32 s50, s44, 13056
    v_mul_u32_u24 v8, 272, v9
    v_lshl_add_u32 v8, v4, 4, v8
    v_add_u32 v8, s50, v8
    v_bfe_u32 v11, v1, 2, 3
    v_mul_u32_u24 v11, 272, v11
    v_lshl_add_u32 v11, v10, 6, v11
    v_and_b32 v12, 3, v1
    v_lshl_add_u32 v11, v12, 4, v11
    v_add_u32 v11, s50, v11
    v_mul_u32_u24 v14, 272, v4
    v_lshl_add_u32 v14, v9, 4, v14
    v_add_u32 v14, s50, v14
    v_mov_b32 v16, 0
    v_mov_b32 v17, 0
    v_mov_b32 v18, 0
    v_mov_b32 v19, 0
    ds_write_b128 v14, v[16:19] offset:10880
    ds_write_b128 v14, v[16:19] offset:11968
    v_lshlrev_b32 v12, 2, v4
    v_bfe_u32 v13, v1, 2, 2
    v_add_u32 v12, v12, v13
    v_mul_u32_u24 v12, 272, v12
    v_and_b32 v13, 3, v1
    v_lshl_add_u32 v12, v13, 3, v12
    v_add_u32 v12, s50, v12
    v_lshlrev_b32 v13, 10, v13
    s_lshl_b32 s46, s42, 12
    s_add_u32 s46, s46, 0x1000000
    v_add_u32 v13, s46, v13
    v_lshlrev_b32 v10, 9, v4
    v_lshl_add_u32 v10, v9, 4, v10
    s_lshl_b32 s46, s42, 13
    s_add_u32 s46, s46, 0x5000000
    v_add_u32 v10, s46, v10
    s_lshl_b32 s52, s42, 9
    s_lshl_b32 s47, s43, 7
    s_add_u32 s52, s52, s47
    s_add_u32 s52, s52, 0x102000
    v_min_u32 v42, 2, v1
    v_lshlrev_b32 v42, 9, v42
    s_lshl_b32 s46, s40, 11
    s_and_b32 s47, s42, 3
    s_lshl_b32 s47, s47, 7
    s_add_u32 s46, s46, s47
    s_add_u32 s46, s46, 0x10a400
    v_add_u32 v48, s46, v42
    s_mul_i32 s46, s42, 24576
    s_add_u32 s46, s46, 0x2000000
    v_lshlrev_b32 v49, 7, v1
    v_add_u32 v49, s46, v49
    v_cmp_le_u32 s[56:57], 32, v1
    v_lshlrev_b32 v14, 2, v4
    s_mov_b32 s54, 0x3e0293ee
    s_mov_b32 s60, s43
    v_add_u32 v15, 0, v14
    v_cmp_gt_u32 s[84:85], v15, v9
    v_add_u32 v15, 1, v14
    v_cmp_gt_u32 s[86:87], v15, v9
    v_add_u32 v15, 2, v14
    v_cmp_gt_u32 s[88:89], v15, v9
    v_add_u32 v15, 3, v14
    v_cmp_gt_u32 s[90:91], v15, v9
    v_and_b32 v41, 15, v1
    v_lshlrev_b32 v41, 2, v41
    s_lshl_b32 s46, s40, 6
    s_add_u32 s46, s46, 0x101000
    s_mov_b32 s47, 0
    s_mov_b32 s70, 0
L_spin_40:
    buffer_load_dword v40, v41, s[12:15], s46 offen sc1
    s_waitcnt vmcnt(0)
    v_cmp_ge_u32 vcc, s47, v40
    s_add_u32 s70, s70, 1
    s_cbranch_vccz L_spok_41
    s_sleep 8
    s_cmp_lt_u32 s70, 524288
    s_cbranch_scc1 L_spin_40
    s_branch L_c_done_1
L_spok_41:
L_a_loop_42:
    s_mul_i32 s45, s60, 786432
    s_add_u32 s48, s45, 8192
    s_add_u32 s49, s45, 16384
    s_lshl_b32 s61, s60, 17
    s_lshl_b32 s63, s60, 18
    s_mov_b32 s70, 0
L_spin_43:
    buffer_load_dword v40, v48, s[12:15], 0 offen sc1
    s_waitcnt vmcnt(0)
    v_cmp_ge_u32 vcc, s60, v40
    s_add_u32 s70, s70, 1
    s_cbranch_vccz L_spok_44
    s_sleep 8
    s_cmp_lt_u32 s70, 524288
    s_cbranch_scc1 L_spin_43
    s_branch L_c_done_1
L_spok_44:
    buffer_load_dwordx4 a[0:3], v3, s[12:15], s45 offen offset:0 sc1
    buffer_load_dwordx4 a[4:7], v3, s[12:15], s45 offen offset:1024 sc1
    buffer_load_dwordx4 a[8:11], v3, s[12:15], s45 offen offset:2048 sc1
    buffer_load_dwordx4 a[12:15], v3, s[12:15], s45 offen offset:3072 sc1
    buffer_load_dwordx4 a[16:19], v5, s[12:15], s45 offen offset:0 sc1
    buffer_load_dwordx4 a[20:23], v5, s[12:15], s45 offen offset:1024 sc1
    buffer_load_dwordx4 a[24:27], v5, s[12:15], s45 offen offset:2048 sc1
    buffer_load_dwordx4 a[28:31], v5, s[12:15], s45 offen offset:3072 sc1
    buffer_load_dwordx4 a[32:35], v3, s[12:15], s48 offen offset:0 sc1
    buffer_load_dwordx4 a[36:39], v3, s[12:15], s48 offen offset:1024 sc1
    buffer_load_dwordx4 a[40:43], v3, s[12:15], s48 offen offset:2048 sc1
    buffer_load_dwordx4 a[44:47], v3, s[12:15], s48 offen offset:3072 sc1
    buffer_load_dwordx4 a[48:51], v5, s[12:15], s48 offen offset:0 sc1
    buffer_load_dwordx4 a[52:55], v5, s[12:15], s48 offen offset:1024 sc1
    buffer_load_dwordx4 a[56:59], v5, s[12:15], s48 offen offset:2048 sc1
    buffer_load_dwordx4 a[60:63], v5, s[12:15], s48 offen offset:3072 sc1
    buffer_load_dwordx4 v[16:19], v3, s[12:15], s49 offen offset:0 sc1
    buffer_load_dwordx4 v[20:23], v3, s[12:15], s49 offen offset:1024 sc1
    buffer_load_dwordx4 v[24:27], v3, s[12:15], s49 offen offset:2048 sc1
    buffer_load_dwordx4 v[28:31], v3, s[12:15], s49 offen offset:3072 sc1
    buffer_load_dwordx4 v[32:35], v5, s[12:15], s49 offen offset:0 sc1
    buffer_load_dwordx4 v[36:39], v5, s[12:15], s49 offen offset:1024 sc1
    buffer_load_dwordx4 v[40:43], v5, s[12:15], s49 offen offset:2048 sc1
    buffer_load_dwordx4 v[44:47], v5, s[12:15], s49 offen offset:3072 sc1
    s_waitcnt vmcnt(0)
    ds_write_b128 v8, v[16:19] offset:0
    ds_write_b128 v8, v[20:23] offset:64
    ds_write_b128 v8, v[24:27] offset:128
    ds_write_b128 v8, v[28:31] offset:192
    ds_write_b128 v8, v[32:35] offset:4352
    ds_write_b128 v8, v[36:39] offset:4416
    ds_write_b128 v8, v[40:43] offset:4480
    ds_write_b128 v8, v[44:47] offset:4544
    v_mfma_f32_16x16x32_bf16 v[56:59], a[32:35], a[0:3], 0
    v_mfma_f32_16x16x32_bf16 v[60:63], a[32:35], a[16:19], 0
    v_mfma_f32_16x16x32_bf16 v[68:71], a[48:51], a[16:19], 0
    v_mfma_f32_16x16x32_bf16 v[56:59], a[36:39], a[4:7], v[56:59]
    v_mfma_f32_16x16x32_bf16 v[60:63], a[36:39], a[20:23], v[60:63]
    v_mfma_f32_16x16x32_bf16 v[68:71], a[52:55], a[20:23], v[68:71]
    v_mfma_f32_16x16x32_bf16 v[56:59], a[40:43], a[8:11], v[56:59]
    v_mfma_f32_16x16x32_bf16 v[60:63], a[40:43], a[24:27], v[60:63]
    v_mfma_f32_16x16x32_bf16 v[68:71], a[56:59], a[24:27], v[68:71]
    v_mfma_f32_16x16x32_bf16 v[56:59], a[44:47], a[12:15], v[56:59]
    v_mfma_f32_16x16x32_bf16 v[60:63], a[44:47], a[28:31], v[60:63]
    v_mfma_f32_16x16x32_bf16 v[68:71], a[60:63], a[28:31], v[68:71]
    s_waitcnt lgkmcnt(0)
    ds_read_b64_tr_b16 a[80:81], v12 offset:0
    ds_read_b64_tr_b16 a[82:83], v12 offset:4352
    ds_read_b64_tr_b16 a[86:87], v12 offset:32
    ds_read_b64_tr_b16 a[88:89], v12 offset:4384
    ds_read_b64_tr_b16 a[92:93], v12 offset:64
    ds_read_b64_tr_b16 a[94:95], v12 offset:4416
    ds_read_b64_tr_b16 a[98:99], v12 offset:96
    ds_read_b64_tr_b16 a[100:101], v12 offset:4448
    s_waitcnt lgkmcnt(0)
    ds_read_b64_tr_b16 a[104:105], v12 offset:128
    ds_read_b64_tr_b16 a[106:107], v12 offset:4480
    ds_read_b64_tr_b16 a[110:111], v12 offset:160
    ds_read_b64_tr_b16 a[112:113], v12 offset:4512
    ds_read_b64_tr_b16 a[116:117], v12 offset:192
    ds_read_b64_tr_b16 a[118:119], v12 offset:4544
    ds_read_b64_tr_b16 a[122:123], v12 offset:224
    ds_read_b64_tr_b16 a[124:125], v12 offset:4576
    v_mov_b32 v15, 0xff800000
    v_cndmask_b32 v56, v56, v15, s[84:85]
    v_cndmask_b32 v68, v68, v15, s[84:85]
    v_cndmask_b32 v57, v57, v15, s[86:87]
    v_cndmask_b32 v69, v69, v15, s[86:87]
    v_cndmask_b32 v58, v58, v15, s[88:89]
    v_cndmask_b32 v70, v70, v15, s[88:89]
    v_cndmask_b32 v59, v59, v15, s[90:91]
    v_cndmask_b32 v71, v71, v15, s[90:91]
    s_mov_b32 s70, 0
L_a_cp_45:
    buffer_load_dword v40, v13, s[12:15], s61 offen sc1
    s_waitcnt vmcnt(0)
    v_cmp_eq_u32 vcc, -1, v40
    s_add_u32 s70, s70, 1
    s_cbranch_vccz L_a_fl_46
L_a_cp_45_s:
    s_sleep 16
    s_cmp_lt_u32 s70, 524288
    s_cbranch_scc1 L_a_cp_45
    s_branch L_c_done_1
L_a_fl_46:
    buffer_load_dwordx4 v[24:27], v6, s[12:15], s61 offen offset:0 sc1
    buffer_load_dwordx4 v[28:31], v6, s[12:15], s61 offen offset:1024 sc1
    buffer_load_dwordx4 v[32:35], v6, s[12:15], s61 offen offset:2048 sc1
    buffer_load_dwordx4 v[36:39], v6, s[12:15], s61 offen offset:3072 sc1
    buffer_load_dwordx4 v[16:19], v7, s[12:15], s61 offen offset:512 sc1
    buffer_load_dwordx4 v[20:23], v7, s[12:15], s61 offen offset:2560 sc1
    s_waitcnt vmcnt(0)
    v_max_u32 v40, v16, v17
    v_max3_u32 v40, v40, v18, v19
    v_max3_u32 v40, v40, v20, v21
    v_max3_u32 v40, v40, v22, v23
    v_max3_u32 v40, v40, v24, v25
    v_max3_u32 v40, v40, v26, v27
    v_max3_u32 v40, v40, v28, v29
    v_max3_u32 v40, v40, v30, v31
    v_max3_u32 v40, v40, v32, v33
    v_max3_u32 v40, v40, v34, v35
    v_max3_u32 v40, v40, v36, v37
    v_max3_u32 v40, v40, v38, v39
    v_cmp_eq_u32 vcc, -1, v40
    s_nop 0
    s_cbranch_vccnz L_a_cp_45_s
    v_mfma_f32_16x16x32_bf16 v[72:75], v[24:27], a[0:3], 0
    v_mfma_f32_16x16x32_bf16 v[76:79], v[24:27], a[16:19], 0
    v_mfma_f32_16x16x32_bf16 v[72:75], v[28:31], a[4:7], v[72:75]
    v_mfma_f32_16x16x32_bf16 v[76:79], v[28:31], a[20:23], v[76:79]
    v_mfma_f32_16x16x32_bf16 v[72:75], v[32:35], a[8:11], v[72:75]
    v_mfma_f32_16x16x32_bf16 v[76:79], v[32:35], a[24:27], v[76:79]
    v_mfma_f32_16x16x32_bf16 v[72:75], v[36:39], a[12:15], v[72:75]
    v_mfma_f32_16x16x32_bf16 v[76:79], v[36:39], a[28:31], v[76:79]
    ds_write_b128 v11, v[16:19] offset:8704
    ds_write_b128 v11, v[20:23] offset:8832
    s_waitcnt lgkmcnt(0)
    ds_read_b64_tr_b16 a[84:85], v12 offset:8704
    ds_read_b64_tr_b16 a[90:91], v12 offset:8736
    ds_read_b64_tr_b16 a[96:97], v12 offset:8768
    ds_read_b64_tr_b16 a[102:103], v12 offset:8800
    ds_read_b64_tr_b16 a[108:109], v12 offset:8832
    ds_read_b64_tr_b16 a[114:115], v12 offset:8864
    ds_read_b64_tr_b16 a[120:121], v12 offset:8896
    ds_read_b64_tr_b16 a[126:127], v12 offset:8928
    v_cndmask_b32 v72, v72, v15, s[56:57]
    v_cndmask_b32 v73, v73, v15, s[56:57]
    v_cndmask_b32 v74, v74, v15, s[56:57]
    v_cndmask_b32 v75, v75, v15, s[56:57]
    v_cndmask_b32 v76, v76, v15, s[56:57]
    v_cndmask_b32 v77, v77, v15, s[56:57]
    v_cndmask_b32 v78, v78, v15, s[56:57]
    v_cndmask_b32 v79, v79, v15, s[56:57]
    v_max_f32 v40, v56, v57
    v_max3_f32 v40, v40, v58, v59
    v_max3_f32 v40, v40, v72, v73
    v_max3_f32 v40, v40, v74, v75
    v_mov_b32 v41, v40
    s_nop 1
    v_permlane16_swap_b32 v40, v41
    v_max_f32 v40, v40, v41
    v_mov_b32 v41, v40
    s_nop 1
    v_permlane32_swap_b32 v40, v41
    v_max_f32 v40, v40, v41
    v_mul_f32 v40, s54, v40
    v_fma_f32 v56, v56, s54, -v40
    v_fma_f32 v57, v57, s54, -v40
    v_fma_f32 v58, v58, s54, -v40
    v_fma_f32 v59, v59, s54, -v40
    v_fma_f32 v72, v72, s54, -v40
    v_fma_f32 v73, v73, s54, -v40
    v_fma_f32 v74, v74, s54, -v40
    v_fma_f32 v75, v75, s54, -v40
    v_exp_f32 v56, v56
    v_exp_f32 v57, v57
    v_exp_f32 v58, v58
    v_exp_f32 v59, v59
    v_exp_f32 v72, v72
    v_exp_f32 v73, v73
    v_exp_f32 v74, v74
    v_exp_f32 v75, v75
    v_add_f32 v40, v56, v57
    v_add_f32 v40, v40, v58
    v_add_f32 v40, v40, v59
    v_add_f32 v40, v40, v72
    v_add_f32 v40, v40, v73
    v_add_f32 v40, v40, v74
    v_add_f32 v40, v40, v75
    v_mov_b32 v41, v40
    s_nop 1
    v_permlane16_swap_b32 v40, v41
    v_add_f32 v40, v40, v41
    v_mov_b32 v41, v40
    s_nop 1
    v_permlane32_swap_b32 v40, v41
    v_add_f32 v40, v40, v41
    v_rcp_f32 v40, v40
    s_nop 0
    v_mul_f32 v56, v56, v40
    v_mul_f32 v57, v57, v40
    v_mul_f32 v58, v58, v40
    v_mul_f32 v59, v59, v40
    v_mul_f32 v72, v72, v40
    v_mul_f32 v73, v73, v40
    v_mul_f32 v74, v74, v40
    v_mul_f32 v75, v75, v40
    v_cvt_pk_bf16_f32 v24, v56, v57
    v_cvt_pk_bf16_f32 v25, v58, v59
    v_cvt_pk_bf16_f32 v28, v72, v73
    v_cvt_pk_bf16_f32 v29, v74, v75
    v_max_f32 v40, v60, v61
    v_max3_f32 v40, v40, v62, v63
    v_max3_f32 v40, v40, v68, v69
    v_max3_f32 v40, v40, v70, v71
    v_max3_f32 v40, v40, v76, v77
    v_max3_f32 v40, v40, v78, v79
    v_mov_b32 v41, v40
    s_nop 1
    v_permlane16_swap_b32 v40, v41
    v_max_f32 v40, v40, v41
    v_mov_b32 v41, v40
    s_nop 1
    v_permlane32_swap_b32 v40, v41
    v_max_f32 v40, v40, v41
    v_mul_f32 v40, s54, v40
    v_fma_f32 v60, v60, s54, -v40
    v_fma_f32 v61, v61, s54, -v40
    v_fma_f32 v62, v62, s54, -v40
    v_fma_f32 v63, v63, s54, -v40
    v_fma_f32 v68, v68, s54, -v40
    v_fma_f32 v69, v69, s54, -v40
    v_fma_f32 v70, v70, s54, -v40
    v_fma_f32 v71, v71, s54, -v40
    v_fma_f32 v76, v76, s54, -v40
    v_fma_f32 v77, v77, s54, -v40
    v_fma_f32 v78, v78, s54, -v40
    v_fma_f32 v79, v79, s54, -v40
    v_exp_f32 v60, v60
    v_exp_f32 v61, v61
    v_exp_f32 v62, v62
    v_exp_f32 v63, v63
    v_exp_f32 v68, v68
    v_exp_f32 v69, v69
    v_exp_f32 v70, v70
    v_exp_f32 v71, v71
    v_exp_f32 v76, v76
    v_exp_f32 v77, v77
    v_exp_f32 v78, v78
    v_exp_f32 v79, v79
    v_add_f32 v40, v60, v61
    v_add_f32 v40, v40, v62
    v_add_f32 v40, v40, v63
    v_add_f32 v40, v40, v68
    v_add_f32 v40, v40, v69
    v_add_f32 v40, v40, v70
    v_add_f32 v40, v40, v71
    v_add_f32 v40, v40, v76
    v_add_f32 v40, v40, v77
    v_add_f32 v40, v40, v78
    v_add_f32 v40, v40, v79
    v_mov_b32 v41, v40
    s_nop 1
    v_permlane16_swap_b32 v40, v41
    v_add_f32 v40, v40, v41
    v_mov_b32 v41, v40
    s_nop 1
    v_permlane32_swap_b32 v40, v41
    v_add_f32 v40, v40, v41
    v_rcp_f32 v40, v40
    s_nop 0
    v_mul_f32 v60, v60, v40
    v_mul_f32 v61, v61, v40
    v_mul_f32 v62, v62, v40
    v_mul_f32 v63, v63, v40
    v_mul_f32 v68, v68, v40
    v_mul_f32 v69, v69, v40
    v_mul_f32 v70, v70, v40
    v_mul_f32 v71, v71, v40
    v_mul_f32 v76, v76, v40
    v_mul_f32 v77, v77, v40
    v_mul_f32 v78, v78, v40
    v_mul_f32 v79, v79, v40
    v_cvt_pk_bf16_f32 v30, v60, v61
    v_cvt_pk_bf16_f32 v31, v62, v63
    v_cvt_pk_bf16_f32 v32, v68, v69
    v_cvt_pk_bf16_f32 v33, v70, v71
    v_cvt_pk_bf16_f32 v34, v76, v77
    v_cvt_pk_bf16_f32 v35, v78, v79
    s_waitcnt lgkmcnt(0)
    s_nop 0
    v_mfma_f32_16x16x16_bf16 v[64:67], a[80:81], v[24:25], 0
    v_mfma_f32_16x16x16_bf16 v[68:71], a[86:87], v[24:25], 0
    v_mfma_f32_16x16x16_bf16 v[72:75], a[92:93], v[24:25], 0
    v_mfma_f32_16x16x16_bf16 v[76:79], a[98:99], v[24:25], 0
    v_mfma_f32_16x16x16_bf16 v[80:83], a[104:105], v[24:25], 0
    v_mfma_f32_16x16x16_bf16 v[84:87], a[110:111], v[24:25], 0
    v_mfma_f32_16x16x16_bf16 v[88:91], a[116:117], v[24:25], 0
    v_mfma_f32_16x16x16_bf16 v[92:95], a[122:123], v[24:25], 0
    v_mfma_f32_16x16x16_bf16 v[64:67], a[84:85], v[28:29], v[64:67]
    v_mfma_f32_16x16x16_bf16 v[68:71], a[90:91], v[28:29], v[68:71]
    v_mfma_f32_16x16x16_bf16 v[72:75], a[96:97], v[28:29], v[72:75]
    v_mfma_f32_16x16x16_bf16 v[76:79], a[102:103], v[28:29], v[76:79]
    v_mfma_f32_16x16x16_bf16 v[80:83], a[108:109], v[28:29], v[80:83]
    v_mfma_f32_16x16x16_bf16 v[84:87], a[114:115], v[28:29], v[84:87]
    v_mfma_f32_16x16x16_bf16 v[88:91], a[120:121], v[28:29], v[88:91]
    v_mfma_f32_16x16x16_bf16 v[92:95], a[126:127], v[28:29], v[92:95]
    v_mfma_f32_16x16x16_bf16 v[96:99], a[80:81], v[30:31], 0
    v_mfma_f32_16x16x16_bf16 v[100:103], a[86:87], v[30:31], 0
    v_mfma_f32_16x16x16_bf16 v[104:107], a[92:93], v[30:31], 0
    v_mfma_f32_16x16x16_bf16 v[108:111], a[98:99], v[30:31], 0
    v_mfma_f32_16x16x16_bf16 v[112:115], a[104:105], v[30:31], 0
    v_mfma_f32_16x16x16_bf16 v[116:119], a[110:111], v[30:31], 0
    v_mfma_f32_16x16x16_bf16 v[120:123], a[116:117], v[30:31], 0
    v_mfma_f32_16x16x16_bf16 v[124:127], a[122:123], v[30:31], 0
    v_mfma_f32_16x16x16_bf16 v[96:99], a[82:83], v[32:33], v[96:99]
    v_mfma_f32_16x16x16_bf16 v[100:103], a[88:89], v[32:33], v[100:103]
    v_mfma_f32_16x16x16_bf16 v[104:107], a[94:95], v[32:33], v[104:107]
    v_mfma_f32_16x16x16_bf16 v[108:111], a[100:101], v[32:33], v[108:111]
    v_mfma_f32_16x16x16_bf16 v[112:115], a[106:107], v[32:33], v[112:115]
    v_mfma_f32_16x16x16_bf16 v[116:119], a[112:113], v[32:33], v[116:119]
    v_mfma_f32_16x16x16_bf16 v[120:123], a[118:119], v[32:33], v[120:123]
    v_mfma_f32_16x16x16_bf16 v[124:127], a[124:125], v[32:33], v[124:127]
    v_mfma_f32_16x16x16_bf16 v[96:99], a[84:85], v[34:35], v[96:99]
    v_mfma_f32_16x16x16_bf16 v[100:103], a[90:91], v[34:35], v[100:103]
    v_mfma_f32_16x16x16_bf16 v[104:107], a[96:97], v[34:35], v[104:107]
    v_mfma_f32_16x16x16_bf16 v[108:111], a[102:103], v[34:35], v[108:111]
    v_mfma_f32_16x16x16_bf16 v[112:115], a[108:109], v[34:35], v[112:115]
    v_mfma_f32_16x16x16_bf16 v[116:119], a[114:115], v[34:35], v[116:119]
    v_mfma_f32_16x16x16_bf16 v[120:123], a[120:121], v[34:35], v[120:123]
    v_mfma_f32_16x16x16_bf16 v[124:127], a[126:127], v[34:35], v[124:127]
    s_add_u32 s46, s63, 4096
    v_cvt_pk_bf16_f32 v64, v64, v65
    v_cvt_pk_bf16_f32 v65, v66, v67
    v_cvt_pk_bf16_f32 v66, v68, v69
    v_cvt_pk_bf16_f32 v67, v70, v71
    buffer_store_dwordx4 v[64:67], v10, s[12:15], s63 offen offset:0 sc1
    v_cvt_pk_bf16_f32 v72, v72, v73
    v_cvt_pk_bf16_f32 v73, v74, v75
    v_cvt_pk_bf16_f32 v74, v76, v77
    v_cvt_pk_bf16_f32 v75, v78, v79
    buffer_store_dwordx4 v[72:75], v10, s[12:15], s63 offen offset:2048 sc1
    v_cvt_pk_bf16_f32 v80, v80, v81
    v_cvt_pk_bf16_f32 v81, v82, v83
    v_cvt_pk_bf16_f32 v82, v84, v85
    v_cvt_pk_bf16_f32 v83, v86, v87
    buffer_store_dwordx4 v[80:83], v10, s[12:15], s46 offen offset:0 sc1
    v_cvt_pk_bf16_f32 v88, v88, v89
    v_cvt_pk_bf16_f32 v89, v90, v91
    v_cvt_pk_bf16_f32 v90, v92, v93
    v_cvt_pk_bf16_f32 v91, v94, v95
    buffer_store_dwordx4 v[88:91], v10, s[12:15], s46 offen offset:2048 sc1
    v_cvt_pk_bf16_f32 v96, v96, v97
    v_cvt_pk_bf16_f32 v97, v98, v99
    v_cvt_pk_bf16_f32 v98, v100, v101
    v_cvt_pk_bf16_f32 v99, v102, v103
    buffer_store_dwordx4 v[96:99], v10, s[12:15], s63 offen offset:256 sc1
    v_cvt_pk_bf16_f32 v104, v104, v105
    v_cvt_pk_bf16_f32 v105, v106, v107
    v_cvt_pk_bf16_f32 v106, v108, v109
    v_cvt_pk_bf16_f32 v107, v110, v111
    buffer_store_dwordx4 v[104:107], v10, s[12:15], s63 offen offset:2304 sc1
    v_cvt_pk_bf16_f32 v112, v112, v113
    v_cvt_pk_bf16_f32 v113, v114, v115
    v_cvt_pk_bf16_f32 v114, v116, v117
    v_cvt_pk_bf16_f32 v115, v118, v119
    buffer_store_dwordx4 v[112:115], v10, s[12:15], s46 offen offset:256 sc1
    v_cvt_pk_bf16_f32 v120, v120, v121
    v_cvt_pk_bf16_f32 v121, v122, v123
    v_cvt_pk_bf16_f32 v122, v124, v125
    v_cvt_pk_bf16_f32 v123, v126, v127
    buffer_store_dwordx4 v[120:123], v10, s[12:15], s46 offen offset:2304 sc1
    s_waitcnt vmcnt(0)
    v_mov_b32 v16, s60
    v_add_u32 v16, 1, v16
    v_mov_b32 v17, 0
    s_mov_b64 exec, 1
    buffer_store_dword v16, v17, s[12:15], s52 offen sc1
    s_mov_b64 exec, -1
L_sf_48:
    s_add_u32 s60, s60, 4
    s_cmp_lt_u32 s60, 64
    s_cbranch_scc1 L_a_loop_42
    s_branch L_c_done_1
L_w_g_8:
    s_lshr_b32 s53, s48, 2
    s_cmp_lt_u32 s53, 2
    s_cselect_b32 s46, 1, 0
    s_xor_b32 s53, s53, s46
    s_lshl_b32 s46, s53, 3
    s_add_u32 s46, s46, 16
    s_load_dwordx2 s[4:5], s[0:1], s46
    s_lshl_b32 s49, s40, 2
    s_and_b32 s46, s48, 3
    s_add_u32 s49, s49, s46
    s_load_dwordx2 s[6:7], s[0:1], 72
    s_and_b32 s50, s44, 3
    s_lshr_b32 s51, s44, 2
    s_waitcnt lgkmcnt(0)
    s_mov_b32 s24, s4
    s_and_b32 s25, s5, 0xffff
    s_mov_b32 s26, 0x800000
    s_mov_b32 s27, 0x00020000
    s_cmp_lg_u32 s53, 0
    s_cbranch_scc1 L_g_nq_49
    s_cmp_lg_u32 s44, 0
    s_cbranch_scc1 L_zwok_52
    v_and_b32 v10, 7, v1
    v_lshlrev_b32 v10, 5, v10
    s_mov_b32 s70, 0
L_zw_51:
    buffer_load_dword v11, v10, s[16:19], 0 offen sc1
    s_waitcnt vmcnt(0)
    v_add_u32_dpp v11, v11, v11 row_ror:1 row_mask:0xf bank_mask:0xf
    s_nop 1
    v_add_u32_dpp v11, v11, v11 row_ror:2 row_mask:0xf bank_mask:0xf
    s_nop 1
    v_add_u32_dpp v11, v11, v11 row_ror:4 row_mask:0xf bank_mask:0xf
    v_cmp_ne_u32 vcc, 0x100, v11
    s_add_u32 s70, s70, 1
    s_cbranch_vccz L_zwok_52
    s_sleep 4
    s_cmp_lt_u32 s70, 524288
    s_cbranch_scc1 L_zw_51
    s_branch L_c_done_1
L_zwok_52:
    s_cmp_lg_u32 s44, 0
    s_cbranch_scc1 L_g_nq2_50
    v_mov_b32 v10, 0x109400
    s_mov_b32 s47, 0
    s_mov_b32 s70, 0
L_spin_53:
    buffer_load_dword v11, v10, s[12:15], 0 offen sc1
    s_waitcnt vmcnt(0)
    v_cmp_ge_u32 vcc, s47, v11
    s_add_u32 s70, s70, 1
    s_cbranch_vccz L_spok_54
    s_sleep 8
    s_cmp_lt_u32 s70, 524288
    s_cbranch_scc1 L_spin_53
    s_branch L_c_done_1
L_spok_54:
L_g_nq2_50:
    s_barrier
L_g_nq_49:
    v_lshrrev_b32 v3, 4, v1
    v_and_b32 v4, 15, v1
    v_lshlrev_b32 v5, 2, v3
    v_xor_b32 v4, v4, v5
    v_mul_u32_u24 v3, 8192, v3
    v_lshl_add_u32 v3, v4, 4, v3
    s_mul_i32 s46, s51, 512
    s_mul_i32 s47, s50, 64
    s_add_u32 s46, s46, s47
    s_mul_i32 s46, s46, 8192
    s_lshl_b32 s47, s49, 8
    s_add_u32 s46, s46, s47
    s_lshl_b32 s45, s51, 16
    s_mul_i32 s47, s50, 16384
    s_add_u32 s45, s45, s47
    v_bfe_u32 v4, v1, 2, 2
    v_bfe_u32 v5, v1, 4, 1
    v_lshlrev_b32 v5, 1, v5
    v_bfe_u32 v6, v1, 0, 1
    v_add_u32 v5, v5, v6
    s_lshl_b32 s47, s50, 2
    v_add_u32 v5, s47, v5
    v_lshlrev_b32 v6, 2, v4
    v_xor_b32 v5, v5, v6
    v_lshlrev_b32 v5, 4, v5
    v_lshl_add_u32 v5, v4, 8, v5
    v_bfe_u32 v6, v1, 1, 1
    v_lshl_add_u32 v5, v6, 3, v5
    v_lshrrev_b32 v6, 5, v1
    v_mul_u32_u24 v6, 2048, v6
    v_add_u32 v5, v5, v6
    s_lshl_b32 s47, s51, 16
    v_add_u32 v5, s47, v5
    v_bfe_u32 v4, v1, 2, 2
    v_xor_b32 v5, s50, v4
    v_lshlrev_b32 v5, 6, v5
    v_lshl_add_u32 v5, v4, 8, v5
    v_and_b32 v6, 3, v1
    v_lshl_add_u32 v5, v6, 4, v5
    v_lshrrev_b32 v6, 4, v1
    v_lshl_add_u32 v5, v6, 11, v5
    s_lshl_b32 s47, s51, 16
    v_add_u32 v5, s47, v5
    s_add_u32 m0, s45, 0
    s_add_u32 s47, s46, 0x0
    buffer_load_dwordx4 v3, s[24:27], s47 offen lds
    s_add_u32 m0, s45, 1024
    s_add_u32 s47, s46, 0x8000
    buffer_load_dwordx4 v3, s[24:27], s47 offen lds
    s_add_u32 m0, s45, 2048
    s_add_u32 s47, s46, 0x10000
    buffer_load_dwordx4 v3, s[24:27], s47 offen lds
    s_add_u32 m0, s45, 3072
    s_add_u32 s47, s46, 0x18000
    buffer_load_dwordx4 v3, s[24:27], s47 offen lds
    s_add_u32 m0, s45, 4096
    s_add_u32 s47, s46, 0x20000
    buffer_load_dwordx4 v3, s[24:27], s47 offen lds
    s_add_u32 m0, s45, 5120
    s_add_u32 s47, s46, 0x28000
    buffer_load_dwordx4 v3, s[24:27], s47 offen lds
    s_add_u32 m0, s45, 6144
    s_add_u32 s47, s46, 0x30000
    buffer_load_dwordx4 v3, s[24:27], s47 offen lds
    s_add_u32 m0, s45, 7168
    s_add_u32 s47, s46, 0x38000
    buffer_load_dwordx4 v3, s[24:27], s47 offen lds
    s_add_u32 m0, s45, 8192
    s_add_u32 s47, s46, 0x40000
    buffer_load_dwordx4 v3, s[24:27], s47 offen lds
    s_add_u32 m0, s45, 9216
    s_add_u32 s47, s46, 0x48000
    buffer_load_dwordx4 v3, s[24:27], s47 offen lds
    s_add_u32 m0, s45, 10240
    s_add_u32 s47, s46, 0x50000
    buffer_load_dwordx4 v3, s[24:27], s47 offen lds
    s_add_u32 m0, s45, 11264
    s_add_u32 s47, s46, 0x58000
    buffer_load_dwordx4 v3, s[24:27], s47 offen lds
    s_add_u32 m0, s45, 12288
    s_add_u32 s47, s46, 0x60000
    buffer_load_dwordx4 v3, s[24:27], s47 offen lds
    s_add_u32 m0, s45, 13312
    s_add_u32 s47, s46, 0x68000
    buffer_load_dwordx4 v3, s[24:27], s47 offen lds
    s_add_u32 m0, s45, 14336
    s_add_u32 s47, s46, 0x70000
    buffer_load_dwordx4 v3, s[24:27], s47 offen lds
    s_add_u32 m0, s45, 15360
    s_add_u32 s47, s46, 0x78000
    buffer_load_dwordx4 v3, s[24:27], s47 offen lds
    s_waitcnt vmcnt(0)
    s_barrier
    ds_read_b64_tr_b16 a[0:1], v5 offset:0
    ds_read_b64_tr_b16 a[2:3], v5 offset:1024
    ds_read_b64_tr_b16 a[4:5], v5 offset:8
    ds_read_b64_tr_b16 a[6:7], v5 offset:1032
    ds_read_b64_tr_b16 a[8:9], v5 offset:8192
    ds_read_b64_tr_b16 a[10:11], v5 offset:9216
    ds_read_b64_tr_b16 a[12:13], v5 offset:8200
    ds_read_b64_tr_b16 a[14:15], v5 offset:9224
    s_waitcnt lgkmcnt(0)
    ds_read_b64_tr_b16 a[16:17], v5 offset:16384
    ds_read_b64_tr_b16 a[18:19], v5 offset:17408
    ds_read_b64_tr_b16 a[20:21], v5 offset:16392
    ds_read_b64_tr_b16 a[22:23], v5 offset:17416
    ds_read_b64_tr_b16 a[24:25], v5 offset:24576
    ds_read_b64_tr_b16 a[26:27], v5 offset:25600
    ds_read_b64_tr_b16 a[28:29], v5 offset:24584
    ds_read_b64_tr_b16 a[30:31], v5 offset:25608
    s_waitcnt lgkmcnt(0)
    ds_read_b64_tr_b16 a[32:33], v5 offset:32768
    ds_read_b64_tr_b16 a[34:35], v5 offset:33792
    ds_read_b64_tr_b16 a[36:37], v5 offset:32776
    ds_read_b64_tr_b16 a[38:39], v5 offset:33800
    ds_read_b64_tr_b16 a[40:41], v5 offset:40960
    ds_read_b64_tr_b16 a[42:43], v5 offset:41984
    ds_read_b64_tr_b16 a[44:45], v5 offset:40968
    ds_read_b64_tr_b16 a[46:47], v5 offset:41992
    s_waitcnt lgkmcnt(0)
    ds_read_b64_tr_b16 a[48:49], v5 offset:49152
    ds_read_b64_tr_b16 a[50:51], v5 offset:50176
    ds_read_b64_tr_b16 a[52:53], v5 offset:49160
    ds_read_b64_tr_b16 a[54:55], v5 offset:50184
    ds_read_b64_tr_b16 a[56:57], v5 offset:57344
    ds_read_b64_tr_b16 a[58:59], v5 offset:58368
    ds_read_b64_tr_b16 a[60:61], v5 offset:57352
    ds_read_b64_tr_b16 a[62:63], v5 offset:58376
    s_waitcnt lgkmcnt(0)
    s_waitcnt lgkmcnt(0)
    s_barrier
    s_add_u32 m0, s45, 0
    s_add_u32 s47, s46, 0x200000
    buffer_load_dwordx4 v3, s[24:27], s47 offen lds
    s_add_u32 m0, s45, 1024
    s_add_u32 s47, s46, 0x208000
    buffer_load_dwordx4 v3, s[24:27], s47 offen lds
    s_add_u32 m0, s45, 2048
    s_add_u32 s47, s46, 0x210000
    buffer_load_dwordx4 v3, s[24:27], s47 offen lds
    s_add_u32 m0, s45, 3072
    s_add_u32 s47, s46, 0x218000
    buffer_load_dwordx4 v3, s[24:27], s47 offen lds
    s_add_u32 m0, s45, 4096
    s_add_u32 s47, s46, 0x220000
    buffer_load_dwordx4 v3, s[24:27], s47 offen lds
    s_add_u32 m0, s45, 5120
    s_add_u32 s47, s46, 0x228000
    buffer_load_dwordx4 v3, s[24:27], s47 offen lds
    s_add_u32 m0, s45, 6144
    s_add_u32 s47, s46, 0x230000
    buffer_load_dwordx4 v3, s[24:27], s47 offen lds
    s_add_u32 m0, s45, 7168
    s_add_u32 s47, s46, 0x238000
    buffer_load_dwordx4 v3, s[24:27], s47 offen lds
    s_add_u32 m0, s45, 8192
    s_add_u32 s47, s46, 0x240000
    buffer_load_dwordx4 v3, s[24:27], s47 offen lds
    s_add_u32 m0, s45, 9216
    s_add_u32 s47, s46, 0x248000
    buffer_load_dwordx4 v3, s[24:27], s47 offen lds
    s_add_u32 m0, s45, 10240
    s_add_u32 s47, s46, 0x250000
    buffer_load_dwordx4 v3, s[24:27], s47 offen lds
    s_add_u32 m0, s45, 11264
    s_add_u32 s47, s46, 0x258000
    buffer_load_dwordx4 v3, s[24:27], s47 offen lds
    s_add_u32 m0, s45, 12288
    s_add_u32 s47, s46, 0x260000
    buffer_load_dwordx4 v3, s[24:27], s47 offen lds
    s_add_u32 m0, s45, 13312
    s_add_u32 s47, s46, 0x268000
    buffer_load_dwordx4 v3, s[24:27], s47 offen lds
    s_add_u32 m0, s45, 14336
    s_add_u32 s47, s46, 0x270000
    buffer_load_dwordx4 v3, s[24:27], s47 offen lds
    s_add_u32 m0, s45, 15360
    s_add_u32 s47, s46, 0x278000
    buffer_load_dwordx4 v3, s[24:27], s47 offen lds
    s_waitcnt vmcnt(0)
    s_barrier
    ds_read_b64_tr_b16 a[64:65], v5 offset:0
    ds_read_b64_tr_b16 a[66:67], v5 offset:1024
    ds_read_b64_tr_b16 a[68:69], v5 offset:8
    ds_read_b64_tr_b16 a[70:71], v5 offset:1032
    ds_read_b64_tr_b16 a[72:73], v5 offset:8192
    ds_read_b64_tr_b16 a[74:75], v5 offset:9216
    ds_read_b64_tr_b16 a[76:77], v5 offset:8200
    ds_read_b64_tr_b16 a[78:79], v5 offset:9224
    s_waitcnt lgkmcnt(0)
    ds_read_b64_tr_b16 a[80:81], v5 offset:16384
    ds_read_b64_tr_b16 a[82:83], v5 offset:17408
    ds_read_b64_tr_b16 a[84:85], v5 offset:16392
    ds_read_b64_tr_b16 a[86:87], v5 offset:17416
    ds_read_b64_tr_b16 a[88:89], v5 offset:24576
    ds_read_b64_tr_b16 a[90:91], v5 offset:25600
    ds_read_b64_tr_b16 a[92:93], v5 offset:24584
    ds_read_b64_tr_b16 a[94:95], v5 offset:25608
    s_waitcnt lgkmcnt(0)
    ds_read_b64_tr_b16 a[96:97], v5 offset:32768
    ds_read_b64_tr_b16 a[98:99], v5 offset:33792
    ds_read_b64_tr_b16 a[100:101], v5 offset:32776
    ds_read_b64_tr_b16 a[102:103], v5 offset:33800
    ds_read_b64_tr_b16 a[104:105], v5 offset:40960
    ds_read_b64_tr_b16 a[106:107], v5 offset:41984
    ds_read_b64_tr_b16 a[108:109], v5 offset:40968
    ds_read_b64_tr_b16 a[110:111], v5 offset:41992
    s_waitcnt lgkmcnt(0)
    ds_read_b64_tr_b16 a[112:113], v5 offset:49152
    ds_read_b64_tr_b16 a[114:115], v5 offset:50176
    ds_read_b64_tr_b16 a[116:117], v5 offset:49160
    ds_read_b64_tr_b16 a[118:119], v5 offset:50184
    ds_read_b64_tr_b16 a[120:121], v5 offset:57344
    ds_read_b64_tr_b16 a[122:123], v5 offset:58368
    ds_read_b64_tr_b16 a[124:125], v5 offset:57352
    ds_read_b64_tr_b16 a[126:127], v5 offset:58376
    s_waitcnt lgkmcnt(0)
    s_waitcnt lgkmcnt(0)
    s_barrier
    v_lshlrev_b32 v2, 4, v1
    s_mul_i32 s64, s44, 8192
    s_add_u32 s46, s64, 0x400000
    v_add_u32 v3, s46, v2
    s_mul_i32 s46, s51, 32768
    v_add_u32 v4, s46, v2
    v_and_b32 v6, 15, v1
    v_lshlrev_b32 v6, 4, v6
    v_lshrrev_b32 v7, 4, v1
    v_lshl_add_u32 v6, v7, 9, v6
    v_add_u32 v4, s46, v6
    s_lshl_b32 s46, s50, 12
    s_add_u32 s46, s46, 131072
    v_add_u32 v5, s46, v2
    v_and_b32 v7, 3, v1
    v_lshlrev_b32 v7, 7, v7
    v_add_u32 v7, 0x109400, v7
    s_mul_i32 s46, s49, 24576
    s_lshl_b32 s47, s53, 13
    s_add_u32 s46, s46, s47
    s_lshl_b32 s47, s50, 10
    s_add_u32 s46, s46, s47
    s_add_u32 s46, s46, 0x2000000
    v_and_b32 v8, 15, v1
    v_lshlrev_b32 v8, 4, v8
    v_bfe_u32 v9, v1, 4, 1
    v_lshl_add_u32 v8, v9, 12, v8
    v_lshrrev_b32 v9, 5, v1
    v_lshl_add_u32 v8, v9, 8, v8
    v_add_u32 v8, s46, v2
    v_add_u32 v9, 4096, v8
    s_lshl_b32 s52, s40, 2
    s_add_u32 s52, s52, s53
    s_lshl_b32 s52, s52, 2
    s_and_b32 s47, s48, 3
    s_add_u32 s52, s52, s47
    s_lshl_b32 s52, s52, 7
    s_add_u32 s52, s52, 0x10a400
    s_mov_b32 s60, 0
    s_mov_b32 s61, 0
    s_mov_b32 s62, 0
    s_mov_b32 s63, 0
    s_mov_b32 s67, 0
    s_mov_b32 s68, 3
    v_mov_b32 v15, 147456
    v_mov_b32 v14, 0
    ds_write_b32 v15, v14 offset:4
    s_cmp_lg_u32 s44, 0
    s_cbranch_scc1 L_zwok_64
    v_and_b32 v10, 7, v1
    v_lshlrev_b32 v10, 5, v10
    s_mov_b32 s70, 0
L_zw_63:
    buffer_load_dword v11, v10, s[16:19], 0 offen sc1
    s_waitcnt vmcnt(0)
    v_add_u32_dpp v11, v11, v11 row_ror:1 row_mask:0xf bank_mask:0xf
    s_nop 1
    v_add_u32_dpp v11, v11, v11 row_ror:2 row_mask:0xf bank_mask:0xf
    s_nop 1
    v_add_u32_dpp v11, v11, v11 row_ror:4 row_mask:0xf bank_mask:0xf
    v_cmp_ne_u32 vcc, 0x100, v11
    s_add_u32 s70, s70, 1
    s_cbranch_vccz L_zwok_64
    s_sleep 4
    s_cmp_lt_u32 s70, 524288
    s_cbranch_scc1 L_zw_63
    s_branch L_c_done_1
L_zwok_64:
L_g_restart_55:
    s_cmp_lg_u32 s44, 0
    s_cbranch_scc1 L_g_nsp_56
    s_mov_b32 s70, 0
L_g_sp_62:
    s_add_u32 s54, s60, 0
    s_add_u32 s55, s54, 0
    s_and_b32 s46, s55, 7
    s_lshl_b32 s46, s46, 9
    buffer_load_dword v11, v7, s[12:15], s46 offen sc1
    s_add_u32 s55, s54, 1
    s_and_b32 s46, s55, 7
    s_lshl_b32 s46, s46, 9
    buffer_load_dword v12, v7, s[12:15], s46 offen sc1
    s_add_u32 s55, s54, 2
    s_and_b32 s46, s55, 7
    s_lshl_b32 s46, s46, 9
    buffer_load_dword v13, v7, s[12:15], s46 offen sc1
    s_waitcnt vmcnt(0)
    v_cmp_ge_u32 vcc, s60, v11
    s_add_u32 s70, s70, 1
    s_cbranch_vccz L_g_sp_62_ok
    s_sleep 8
    s_cmp_lt_u32 s70, 524288
    s_cbranch_scc1 L_g_sp_62
    s_branch L_c_done_1
L_g_sp_62_ok:
    s_mov_b32 s46, s54
    v_cmp_ge_u32 vcc, s46, v11
    s_nop 0
    s_cbranch_vccnz L_g_le_65
    s_add_u32 s46, s46, 1
    v_cmp_ge_u32 vcc, s46, v12
    s_nop 0
    s_cbranch_vccnz L_g_le_65
    s_add_u32 s46, s46, 1
    v_cmp_ge_u32 vcc, s46, v13
    s_nop 0
    s_cbranch_vccnz L_g_le_65
    s_add_u32 s46, s46, 1
L_g_le_65:
    v_mov_b32 v11, s46
    ds_write_b32 v15, v11
L_g_nsp_56:
    s_waitcnt lgkmcnt(0)
    s_barrier
    ds_read_b32 v14, v15
    s_waitcnt lgkmcnt(0)
    v_readfirstlane_b32 s66, v14
    s_nop 3
L_g_restart_55_go:
    s_mov_b32 s69, 0
    s_cmp_gt_u32 s62, s60
    s_cbranch_scc1 L_g_nd_66
    s_cmp_ge_u32 s62, s66
    s_cbranch_scc1 L_g_nd_66
    s_add_u32 s47, s61, 4096
    s_add_u32 m0, s64, 0
    s_nop 0
    buffer_load_dwordx4 v3, s[12:15], s61 offen offset:0 sc1 lds
    buffer_load_dwordx4 v3, s[12:15], s61 offen offset:1024 sc1 lds
    buffer_load_dwordx4 v3, s[12:15], s61 offen offset:2048 sc1 lds
    buffer_load_dwordx4 v3, s[12:15], s61 offen offset:3072 sc1 lds
    s_add_u32 m0, s64, 4096
    s_nop 0
    buffer_load_dwordx4 v3, s[12:15], s47 offen offset:0 sc1 lds
    buffer_load_dwordx4 v3, s[12:15], s47 offen offset:1024 sc1 lds
    buffer_load_dwordx4 v3, s[12:15], s47 offen offset:2048 sc1 lds
    buffer_load_dwordx4 v3, s[12:15], s47 offen offset:3072 sc1 lds
    s_add_u32 s61, s61, 65536
    s_add_u32 s62, s62, 1
    s_xor_b32 s64, s64, 0x10000
    s_mov_b32 s69, 1
L_g_nd_66:
    s_cmp_eq_u32 s51, 1
    s_cbranch_scc1 L_g_g1r_57
    s_add_u32 s59, s60, 1
    s_mov_b32 s69, 0
    s_cmp_gt_u32 s62, s59
    s_cbranch_scc1 L_g_nd_67
    s_cmp_ge_u32 s62, s66
    s_cbranch_scc1 L_g_nd_67
    s_add_u32 s47, s61, 4096
    s_add_u32 m0, s64, 0
    s_nop 0
    buffer_load_dwordx4 v3, s[12:15], s61 offen offset:0 sc1 lds
    buffer_load_dwordx4 v3, s[12:15], s61 offen offset:1024 sc1 lds
    buffer_load_dwordx4 v3, s[12:15], s61 offen offset:2048 sc1 lds
    buffer_load_dwordx4 v3, s[12:15], s61 offen offset:3072 sc1 lds
    s_add_u32 m0, s64, 4096
    s_nop 0
    buffer_load_dwordx4 v3, s[12:15], s47 offen offset:0 sc1 lds
    buffer_load_dwordx4 v3, s[12:15], s47 offen offset:1024 sc1 lds
    buffer_load_dwordx4 v3, s[12:15], s47 offen offset:2048 sc1 lds
    buffer_load_dwordx4 v3, s[12:15], s47 offen offset:3072 sc1 lds
    s_add_u32 s61, s61, 65536
    s_add_u32 s62, s62, 1
    s_xor_b32 s64, s64, 0x10000
    s_mov_b32 s69, 1
L_g_nd_67:
    s_cmp_eq_u32 s69, 1
    s_cbranch_scc1 L_g_w0_68
    s_waitcnt vmcnt(0)
L_g_w0_68:
    s_waitcnt vmcnt(8)
    s_mov_b32 s65, 1
L_g_loop0_58:
    s_barrier
    s_cmp_eq_u32 s65, 0
    s_cbranch_scc1 L_g_pr_69
    ds_read_b128 v[32:35], v4 offset:0
    ds_read_b128 v[36:39], v4 offset:256
    ds_read_b128 v[40:43], v4 offset:2048
    ds_read_b128 v[44:47], v4 offset:2304
    ds_read_b128 v[48:51], v4 offset:4096
    ds_read_b128 v[52:55], v4 offset:4352
    ds_read_b128 v[56:59], v4 offset:6144
    ds_read_b128 v[60:63], v4 offset:6400
L_g_pr_69:
    ds_read_b32 v14, v15
    s_cmp_lg_u32 s44, 0
    s_cbranch_scc1 L_g_nl_70
    s_add_u32 s54, s60, 1
    s_add_u32 s55, s54, 0
    s_and_b32 s46, s55, 7
    s_lshl_b32 s46, s46, 9
    buffer_load_dword v11, v7, s[12:15], s46 offen sc1
    s_add_u32 s55, s54, 1
    s_and_b32 s46, s55, 7
    s_lshl_b32 s46, s46, 9
    buffer_load_dword v12, v7, s[12:15], s46 offen sc1
    s_add_u32 s55, s54, 2
    s_and_b32 s46, s55, 7
    s_lshl_b32 s46, s46, 9
    buffer_load_dword v13, v7, s[12:15], s46 offen sc1
L_g_nl_70:
    s_setprio 1
    s_waitcnt lgkmcnt(7)
    v_mfma_f32_16x16x32_bf16 v[16:19], a[0:3], v[32:35], 0
    v_mfma_f32_16x16x32_bf16 v[20:23], a[4:7], v[32:35], 0
    ds_read_b128 v[32:35], v4 offset:8192
    s_waitcnt lgkmcnt(7)
    v_mfma_f32_16x16x32_bf16 v[24:27], a[0:3], v[36:39], 0
    v_mfma_f32_16x16x32_bf16 v[28:31], a[4:7], v[36:39], 0
    ds_read_b128 v[36:39], v4 offset:8448
    s_waitcnt lgkmcnt(7)
    v_mfma_f32_16x16x32_bf16 v[16:19], a[8:11], v[40:43], v[16:19]
    v_mfma_f32_16x16x32_bf16 v[20:23], a[12:15], v[40:43], v[20:23]
    ds_read_b128 v[40:43], v4 offset:10240
    s_waitcnt lgkmcnt(7)
    v_mfma_f32_16x16x32_bf16 v[24:27], a[8:11], v[44:47], v[24:27]
    v_mfma_f32_16x16x32_bf16 v[28:31], a[12:15], v[44:47], v[28:31]
    ds_read_b128 v[44:47], v4 offset:10496
    s_waitcnt lgkmcnt(7)
    v_mfma_f32_16x16x32_bf16 v[16:19], a[16:19], v[48:51], v[16:19]
    v_mfma_f32_16x16x32_bf16 v[20:23], a[20:23], v[48:51], v[20:23]
    ds_read_b128 v[48:51], v4 offset:12288
    s_waitcnt lgkmcnt(7)
    v_mfma_f32_16x16x32_bf16 v[24:27], a[16:19], v[52:55], v[24:27]
    v_mfma_f32_16x16x32_bf16 v[28:31], a[20:23], v[52:55], v[28:31]
    ds_read_b128 v[52:55], v4 offset:12544
    s_waitcnt lgkmcnt(7)
    v_mfma_f32_16x16x32_bf16 v[16:19], a[24:27], v[56:59], v[16:19]
    v_mfma_f32_16x16x32_bf16 v[20:23], a[28:31], v[56:59], v[20:23]
    ds_read_b128 v[56:59], v4 offset:14336
    s_waitcnt lgkmcnt(7)
    v_mfma_f32_16x16x32_bf16 v[24:27], a[24:27], v[60:63], v[24:27]
    v_mfma_f32_16x16x32_bf16 v[28:31], a[28:31], v[60:63], v[28:31]
    ds_read_b128 v[60:63], v4 offset:14592
    s_waitcnt lgkmcnt(7)
    v_mfma_f32_16x16x32_bf16 v[16:19], a[32:35], v[32:35], v[16:19]
    v_mfma_f32_16x16x32_bf16 v[20:23], a[36:39], v[32:35], v[20:23]
    ds_read_b128 v[32:35], v4 offset:16384
    s_waitcnt lgkmcnt(7)
    v_mfma_f32_16x16x32_bf16 v[24:27], a[32:35], v[36:39], v[24:27]
    v_mfma_f32_16x16x32_bf16 v[28:31], a[36:39], v[36:39], v[28:31]
    ds_read_b128 v[36:39], v4 offset:16640
    s_waitcnt lgkmcnt(7)
    v_mfma_f32_16x16x32_bf16 v[16:19], a[40:43], v[40:43], v[16:19]
    v_mfma_f32_16x16x32_bf16 v[20:23], a[44:47], v[40:43], v[20:23]
    ds_read_b128 v[40:43], v4 offset:18432
    s_waitcnt lgkmcnt(7)
    v_mfma_f32_16x16x32_bf16 v[24:27], a[40:43], v[44:47], v[24:27]
    v_mfma_f32_16x16x32_bf16 v[28:31], a[44:47], v[44:47], v[28:31]
    ds_read_b128 v[44:47], v4 offset:18688
    s_waitcnt lgkmcnt(7)
    v_mfma_f32_16x16x32_bf16 v[16:19], a[48:51], v[48:51], v[16:19]
    v_mfma_f32_16x16x32_bf16 v[20:23], a[52:55], v[48:51], v[20:23]
    ds_read_b128 v[48:51], v4 offset:20480
    s_waitcnt lgkmcnt(7)
    v_mfma_f32_16x16x32_bf16 v[24:27], a[48:51], v[52:55], v[24:27]
    v_mfma_f32_16x16x32_bf16 v[28:31], a[52:55], v[52:55], v[28:31]
    ds_read_b128 v[52:55], v4 offset:20736
    s_waitcnt lgkmcnt(7)
    v_mfma_f32_16x16x32_bf16 v[16:19], a[56:59], v[56:59], v[16:19]
    v_mfma_f32_16x16x32_bf16 v[20:23], a[60:63], v[56:59], v[20:23]
    ds_read_b128 v[56:59], v4 offset:22528
    s_waitcnt lgkmcnt(7)
    v_mfma_f32_16x16x32_bf16 v[24:27], a[56:59], v[60:63], v[24:27]
    v_mfma_f32_16x16x32_bf16 v[28:31], a[60:63], v[60:63], v[28:31]
    ds_read_b128 v[60:63], v4 offset:22784
    s_waitcnt lgkmcnt(7)
    v_mfma_f32_16x16x32_bf16 v[16:19], a[64:67], v[32:35], v[16:19]
    v_mfma_f32_16x16x32_bf16 v[20:23], a[68:71], v[32:35], v[20:23]
    ds_read_b128 v[32:35], v4 offset:24576
    s_waitcnt lgkmcnt(7)
    v_mfma_f32_16x16x32_bf16 v[24:27], a[64:67], v[36:39], v[24:27]
    v_mfma_f32_16x16x32_bf16 v[28:31], a[68:71], v[36:39], v[28:31]
    ds_read_b128 v[36:39], v4 offset:24832
    s_waitcnt lgkmcnt(7)
    v_mfma_f32_16x16x32_bf16 v[16:19], a[72:75], v[40:43], v[16:19]
    v_mfma_f32_16x16x32_bf16 v[20:23], a[76:79], v[40:43], v[20:23]
    ds_read_b128 v[40:43], v4 offset:26624
    s_waitcnt lgkmcnt(7)
    v_mfma_f32_16x16x32_bf16 v[24:27], a[72:75], v[44:47], v[24:27]
    v_mfma_f32_16x16x32_bf16 v[28:31], a[76:79], v[44:47], v[28:31]
    ds_read_b128 v[44:47], v4 offset:26880
    s_waitcnt lgkmcnt(7)
    v_mfma_f32_16x16x32_bf16 v[16:19], a[80:83], v[48:51], v[16:19]
    v_mfma_f32_16x16x32_bf16 v[20:23], a[84:87], v[48:51], v[20:23]
    ds_read_b128 v[48:51], v4 offset:28672
    s_waitcnt lgkmcnt(7)
    v_mfma_f32_16x16x32_bf16 v[24:27], a[80:83], v[52:55], v[24:27]
    v_mfma_f32_16x16x32_bf16 v[28:31], a[84:87], v[52:55], v[28:31]
    ds_read_b128 v[52:55], v4 offset:28928
    s_waitcnt lgkmcnt(7)
    v_mfma_f32_16x16x32_bf16 v[16:19], a[88:91], v[56:59], v[16:19]
    v_mfma_f32_16x16x32_bf16 v[20:23], a[92:95], v[56:59], v[20:23]
    ds_read_b128 v[56:59], v4 offset:30720
    s_waitcnt lgkmcnt(7)
    v_mfma_f32_16x16x32_bf16 v[24:27], a[88:91], v[60:63], v[24:27]
    v_mfma_f32_16x16x32_bf16 v[28:31], a[92:95], v[60:63], v[28:31]
    ds_read_b128 v[60:63], v4 offset:30976
    s_waitcnt lgkmcnt(7)
    v_mfma_f32_16x16x32_bf16 v[16:19], a[96:99], v[32:35], v[16:19]
    v_mfma_f32_16x16x32_bf16 v[20:23], a[100:103], v[32:35], v[20:23]
    s_waitcnt lgkmcnt(6)
    v_mfma_f32_16x16x32_bf16 v[24:27], a[96:99], v[36:39], v[24:27]
    v_mfma_f32_16x16x32_bf16 v[28:31], a[100:103], v[36:39], v[28:31]
    s_waitcnt lgkmcnt(5)
    v_mfma_f32_16x16x32_bf16 v[16:19], a[104:107], v[40:43], v[16:19]
    v_mfma_f32_16x16x32_bf16 v[20:23], a[108:111], v[40:43], v[20:23]
    s_waitcnt lgkmcnt(4)
    v_mfma_f32_16x16x32_bf16 v[24:27], a[104:107], v[44:47], v[24:27]
    v_mfma_f32_16x16x32_bf16 v[28:31], a[108:111], v[44:47], v[28:31]
    s_waitcnt lgkmcnt(3)
    v_mfma_f32_16x16x32_bf16 v[16:19], a[112:115], v[48:51], v[16:19]
    v_mfma_f32_16x16x32_bf16 v[20:23], a[116:119], v[48:51], v[20:23]
    s_waitcnt lgkmcnt(2)
    v_mfma_f32_16x16x32_bf16 v[24:27], a[112:115], v[52:55], v[24:27]
    v_mfma_f32_16x16x32_bf16 v[28:31], a[116:119], v[52:55], v[28:31]
    s_waitcnt lgkmcnt(1)
    v_mfma_f32_16x16x32_bf16 v[16:19], a[120:123], v[56:59], v[16:19]
    v_mfma_f32_16x16x32_bf16 v[20:23], a[124:127], v[56:59], v[20:23]
    s_waitcnt lgkmcnt(0)
    v_mfma_f32_16x16x32_bf16 v[24:27], a[120:123], v[60:63], v[24:27]
    v_mfma_f32_16x16x32_bf16 v[28:31], a[124:127], v[60:63], v[28:31]
    v_xor_b32 v4, 0x10000, v4
    s_setprio 0
    s_waitcnt vmcnt(0)
    v_readfirstlane_b32 s66, v14
    s_barrier
    s_nop 6
    ds_write_b128 v5, v[16:19] offset:0
    ds_write_b128 v5, v[20:23] offset:1024
    ds_write_b128 v5, v[24:27] offset:2048
    ds_write_b128 v5, v[28:31] offset:3072
    s_cmp_lg_u32 s44, 0
    s_cbranch_scc1 L_g_ne_71
    s_mov_b32 s46, s54
    v_cmp_ge_u32 vcc, s46, v11
    s_nop 0
    s_cbranch_vccnz L_g_le_74
    s_add_u32 s46, s46, 1
    v_cmp_ge_u32 vcc, s46, v12
    s_nop 0
    s_cbranch_vccnz L_g_le_74
    s_add_u32 s46, s46, 1
    v_cmp_ge_u32 vcc, s46, v13
    s_nop 0
    s_cbranch_vccnz L_g_le_74
    s_add_u32 s46, s46, 1
L_g_le_74:
    v_mov_b32 v11, s46
    ds_write_b32 v15, v11
L_g_ne_71:
    s_add_u32 s60, s60, 1
    s_waitcnt lgkmcnt(0)
    s_mov_b32 s69, 0
    s_cmp_gt_u32 s62, s60
    s_cbranch_scc1 L_g_nd_75
    s_cmp_ge_u32 s62, s66
    s_cbranch_scc1 L_g_nd_75
    s_add_u32 s47, s61, 4096
    s_add_u32 m0, s64, 0
    s_nop 0
    buffer_load_dwordx4 v3, s[12:15], s61 offen offset:0 sc1 lds
    buffer_load_dwordx4 v3, s[12:15], s61 offen offset:1024 sc1 lds
    buffer_load_dwordx4 v3, s[12:15], s61 offen offset:2048 sc1 lds
    buffer_load_dwordx4 v3, s[12:15], s61 offen offset:3072 sc1 lds
    s_add_u32 m0, s64, 4096
    s_nop 0
    buffer_load_dwordx4 v3, s[12:15], s47 offen offset:0 sc1 lds
    buffer_load_dwordx4 v3, s[12:15], s47 offen offset:1024 sc1 lds
    buffer_load_dwordx4 v3, s[12:15], s47 offen offset:2048 sc1 lds
    buffer_load_dwordx4 v3, s[12:15], s47 offen offset:3072 sc1 lds
    s_add_u32 s61, s61, 65536
    s_add_u32 s62, s62, 1
    s_xor_b32 s64, s64, 0x10000
    s_mov_b32 s69, 1
L_g_nd_75:
    s_mov_b32 s65, s69
    s_add_u32 s59, s60, 1
    s_mov_b32 s69, 0
    s_cmp_gt_u32 s62, s59
    s_cbranch_scc1 L_g_nd_76
    s_cmp_ge_u32 s62, s66
    s_cbranch_scc1 L_g_nd_76
    s_add_u32 s47, s61, 4096
    s_add_u32 m0, s64, 0
    s_nop 0
    buffer_load_dwordx4 v3, s[12:15], s61 offen offset:0 sc1 lds
    buffer_load_dwordx4 v3, s[12:15], s61 offen offset:1024 sc1 lds
    buffer_load_dwordx4 v3, s[12:15], s61 offen offset:2048 sc1 lds
    buffer_load_dwordx4 v3, s[12:15], s61 offen offset:3072 sc1 lds
    s_add_u32 m0, s64, 4096
    s_nop 0
    buffer_load_dwordx4 v3, s[12:15], s47 offen offset:0 sc1 lds
    buffer_load_dwordx4 v3, s[12:15], s47 offen offset:1024 sc1 lds
    buffer_load_dwordx4 v3, s[12:15], s47 offen offset:2048 sc1 lds
    buffer_load_dwordx4 v3, s[12:15], s47 offen offset:3072 sc1 lds
    s_add_u32 s61, s61, 65536
    s_add_u32 s62, s62, 1
    s_xor_b32 s64, s64, 0x10000
    s_mov_b32 s69, 1
L_g_nd_76:
    s_cmp_le_u32 s66, s60
    s_cbranch_scc1 L_g_ex0_73
    s_cmp_eq_u32 s65, 0
    s_cbranch_scc1 L_g_nw_72
    s_waitcnt vmcnt(0) lgkmcnt(0)
    s_branch L_g_loop0_58
L_g_nw_72:
    ds_read_b128 v[32:35], v4 offset:0
    ds_read_b128 v[36:39], v4 offset:256
    ds_read_b128 v[40:43], v4 offset:2048
    ds_read_b128 v[44:47], v4 offset:2304
    ds_read_b128 v[48:51], v4 offset:4096
    ds_read_b128 v[52:55], v4 offset:4352
    ds_read_b128 v[56:59], v4 offset:6144
    ds_read_b128 v[60:63], v4 offset:6400
    s_waitcnt lgkmcnt(8)
    s_branch L_g_loop0_58
L_g_ex0_73:
    s_cmp_lg_u32 s44, 0
    s_cbranch_scc1 L_g_ex0_73_n
    s_sleep 6
    s_add_u32 s54, s60, 0
    s_add_u32 s55, s54, 0
    s_and_b32 s46, s55, 7
    s_lshl_b32 s46, s46, 9
    buffer_load_dword v11, v7, s[12:15], s46 offen sc1
    s_add_u32 s55, s54, 1
    s_and_b32 s46, s55, 7
    s_lshl_b32 s46, s46, 9
    buffer_load_dword v12, v7, s[12:15], s46 offen sc1
    s_add_u32 s55, s54, 2
    s_and_b32 s46, s55, 7
    s_lshl_b32 s46, s46, 9
    buffer_load_dword v13, v7, s[12:15], s46 offen sc1
    s_waitcnt vmcnt(0)
    s_mov_b32 s46, s54
    v_cmp_ge_u32 vcc, s46, v11
    s_nop 0
    s_cbranch_vccnz L_g_le_77
    s_add_u32 s46, s46, 1
    v_cmp_ge_u32 vcc, s46, v12
    s_nop 0
    s_cbranch_vccnz L_g_le_77
    s_add_u32 s46, s46, 1
    v_cmp_ge_u32 vcc, s46, v13
    s_nop 0
    s_cbranch_vccnz L_g_le_77
    s_add_u32 s46, s46, 1
L_g_le_77:
    v_mov_b32 v11, s46
    ds_write_b32 v15, v11
L_g_ex0_73_n:
    s_waitcnt lgkmcnt(0)
    s_barrier
    ds_read_b32 v14, v15
    s_waitcnt lgkmcnt(0)
    v_readfirstlane_b32 s66, v14
    s_barrier
    s_cmp_gt_u32 s66, s60
    s_cbranch_scc1 L_g_restart_55_go
    s_branch L_g_tail_60
L_g_g1r_57:
    s_mov_b32 s65, 1
    s_branch L_g_loop1_59_e
L_g_loop1_59:
    s_mov_b32 s65, 0
L_g_loop1_59_e:
    s_barrier
    ds_read_b32 v14, v15
    s_bitcmp1_b32 s67, 1
    s_cbranch_scc0 L_g_nfl_78
    s_sub_u32 s59, s60, 2
    s_cmp_lg_u32 s44, 4
    s_cbranch_scc1 L_sf_83
    v_mov_b32 v10, s59
    v_add_u32 v10, 1, v10
    v_mov_b32 v11, 0
    s_mov_b64 exec, 1
    buffer_store_dword v10, v11, s[12:15], s52 offen sc1
    s_mov_b64 exec, -1
L_sf_83:
L_g_nfl_78:
    s_bitcmp1_b32 s67, 0
    s_cbranch_scc0 L_g_nep_79
    ds_read_b128 v[80:83], v5 offset:0
    ds_read_b128 v[84:87], v5 offset:1024
    ds_read_b128 v[88:91], v5 offset:2048
    ds_read_b128 v[92:95], v5 offset:3072
    s_nop 7
    s_waitcnt lgkmcnt(3)
    v_add_f32 v80, v80, v16
    v_add_f32 v81, v81, v17
    v_add_f32 v82, v82, v18
    v_add_f32 v83, v83, v19
    s_waitcnt lgkmcnt(2)
    v_add_f32 v84, v84, v20
    v_add_f32 v85, v85, v21
    v_add_f32 v86, v86, v22
    v_add_f32 v87, v87, v23
    s_waitcnt lgkmcnt(1)
    v_add_f32 v88, v88, v24
    v_add_f32 v89, v89, v25
    v_add_f32 v90, v90, v26
    v_add_f32 v91, v91, v27
    s_waitcnt lgkmcnt(0)
    v_add_f32 v92, v92, v28
    v_add_f32 v93, v93, v29
    v_add_f32 v94, v94, v30
    v_add_f32 v95, v95, v31
    v_cvt_pk_bf16_f32 v104, v80, v81
    v_cvt_pk_bf16_f32 v105, v82, v83
    v_cvt_pk_bf16_f32 v106, v84, v85
    v_cvt_pk_bf16_f32 v107, v86, v87
    buffer_store_dwordx4 v[104:107], v8, s[12:15], s63 offen sc1
    v_cvt_pk_bf16_f32 v108, v88, v89
    v_cvt_pk_bf16_f32 v109, v90, v91
    v_cvt_pk_bf16_f32 v110, v92, v93
    v_cvt_pk_bf16_f32 v111, v94, v95
    buffer_store_dwordx4 v[108:111], v9, s[12:15], s63 offen sc1
    s_add_u32 s63, s63, 786432
L_g_nep_79:
    s_waitcnt lgkmcnt(0)
    v_readfirstlane_b32 s66, v14
    s_nop 3
    s_mov_b32 s69, 0
    s_cmp_gt_u32 s62, s60
    s_cbranch_scc1 L_g_nd_84
    s_cmp_ge_u32 s62, s66
    s_cbranch_scc1 L_g_nd_84
    s_add_u32 s47, s61, 4096
    s_add_u32 m0, s64, 0
    s_nop 0
    buffer_load_dwordx4 v3, s[12:15], s61 offen offset:0 sc1 lds
    buffer_load_dwordx4 v3, s[12:15], s61 offen offset:1024 sc1 lds
    buffer_load_dwordx4 v3, s[12:15], s61 offen offset:2048 sc1 lds
    buffer_load_dwordx4 v3, s[12:15], s61 offen offset:3072 sc1 lds
    s_add_u32 m0, s64, 4096
    s_nop 0
    buffer_load_dwordx4 v3, s[12:15], s47 offen offset:0 sc1 lds
    buffer_load_dwordx4 v3, s[12:15], s47 offen offset:1024 sc1 lds
    buffer_load_dwordx4 v3, s[12:15], s47 offen offset:2048 sc1 lds
    buffer_load_dwordx4 v3, s[12:15], s47 offen offset:3072 sc1 lds
    s_add_u32 s61, s61, 65536
    s_add_u32 s62, s62, 1
    s_xor_b32 s64, s64, 0x10000
    s_mov_b32 s69, 1
L_g_nd_84:
    s_or_b32 s65, s65, s69
    s_add_u32 s59, s60, 1
    s_mov_b32 s69, 0
    s_cmp_gt_u32 s62, s59
    s_cbranch_scc1 L_g_nd_85
    s_cmp_ge_u32 s62, s66
    s_cbranch_scc1 L_g_nd_85
    s_add_u32 s47, s61, 4096
    s_add_u32 m0, s64, 0
    s_nop 0
    buffer_load_dwordx4 v3, s[12:15], s61 offen offset:0 sc1 lds
    buffer_load_dwordx4 v3, s[12:15], s61 offen offset:1024 sc1 lds
    buffer_load_dwordx4 v3, s[12:15], s61 offen offset:2048 sc1 lds
    buffer_load_dwordx4 v3, s[12:15], s61 offen offset:3072 sc1 lds
    s_add_u32 m0, s64, 4096
    s_nop 0
    buffer_load_dwordx4 v3, s[12:15], s47 offen offset:0 sc1 lds
    buffer_load_dwordx4 v3, s[12:15], s47 offen offset:1024 sc1 lds
    buffer_load_dwordx4 v3, s[12:15], s47 offen offset:2048 sc1 lds
    buffer_load_dwordx4 v3, s[12:15], s47 offen offset:3072 sc1 lds
    s_add_u32 s61, s61, 65536
    s_add_u32 s62, s62, 1
    s_xor_b32 s64, s64, 0x10000
    s_mov_b32 s69, 1
L_g_nd_85:
    s_cmp_eq_u32 s65, 0
    s_cbranch_scc1 L_g_nw1_80
    s_waitcnt vmcnt(0)
    s_barrier
    ds_read_b128 v[32:35], v4 offset:0
    ds_read_b128 v[36:39], v4 offset:256
    ds_read_b128 v[40:43], v4 offset:2048
    ds_read_b128 v[44:47], v4 offset:2304
    ds_read_b128 v[48:51], v4 offset:4096
    ds_read_b128 v[52:55], v4 offset:4352
    ds_read_b128 v[56:59], v4 offset:6144
    ds_read_b128 v[60:63], v4 offset:6400
    s_branch L_g_jn_82
L_g_nw1_80:
    ds_read_b128 v[32:35], v4 offset:0
    ds_read_b128 v[36:39], v4 offset:256
    ds_read_b128 v[40:43], v4 offset:2048
    ds_read_b128 v[44:47], v4 offset:2304
    ds_read_b128 v[48:51], v4 offset:4096
    ds_read_b128 v[52:55], v4 offset:4352
    ds_read_b128 v[56:59], v4 offset:6144
    ds_read_b128 v[60:63], v4 offset:6400
    s_barrier
L_g_jn_82:
    s_setprio 1
    s_waitcnt lgkmcnt(7)
    v_mfma_f32_16x16x32_bf16 v[16:19], a[0:3], v[32:35], 0
    v_mfma_f32_16x16x32_bf16 v[20:23], a[4:7], v[32:35], 0
    ds_read_b128 v[32:35], v4 offset:8192
    s_waitcnt lgkmcnt(7)
    v_mfma_f32_16x16x32_bf16 v[24:27], a[0:3], v[36:39], 0
    v_mfma_f32_16x16x32_bf16 v[28:31], a[4:7], v[36:39], 0
    ds_read_b128 v[36:39], v4 offset:8448
    s_waitcnt lgkmcnt(7)
    v_mfma_f32_16x16x32_bf16 v[16:19], a[8:11], v[40:43], v[16:19]
    v_mfma_f32_16x16x32_bf16 v[20:23], a[12:15], v[40:43], v[20:23]
    ds_read_b128 v[40:43], v4 offset:10240
    s_waitcnt lgkmcnt(7)
    v_mfma_f32_16x16x32_bf16 v[24:27], a[8:11], v[44:47], v[24:27]
    v_mfma_f32_16x16x32_bf16 v[28:31], a[12:15], v[44:47], v[28:31]
    ds_read_b128 v[44:47], v4 offset:10496
    s_waitcnt lgkmcnt(7)
    v_mfma_f32_16x16x32_bf16 v[16:19], a[16:19], v[48:51], v[16:19]
    v_mfma_f32_16x16x32_bf16 v[20:23], a[20:23], v[48:51], v[20:23]
    ds_read_b128 v[48:51], v4 offset:12288
    s_waitcnt lgkmcnt(7)
    v_mfma_f32_16x16x32_bf16 v[24:27], a[16:19], v[52:55], v[24:27]
    v_mfma_f32_16x16x32_bf16 v[28:31], a[20:23], v[52:55], v[28:31]
    ds_read_b128 v[52:55], v4 offset:12544
    s_waitcnt lgkmcnt(7)
    v_mfma_f32_16x16x32_bf16 v[16:19], a[24:27], v[56:59], v[16:19]
    v_mfma_f32_16x16x32_bf16 v[20:23], a[28:31], v[56:59], v[20:23]
    ds_read_b128 v[56:59], v4 offset:14336
    s_waitcnt lgkmcnt(7)
    v_mfma_f32_16x16x32_bf16 v[24:27], a[24:27], v[60:63], v[24:27]
    v_mfma_f32_16x16x32_bf16 v[28:31], a[28:31], v[60:63], v[28:31]
    ds_read_b128 v[60:63], v4 offset:14592
    s_waitcnt lgkmcnt(7)
    v_mfma_f32_16x16x32_bf16 v[16:19], a[32:35], v[32:35], v[16:19]
    v_mfma_f32_16x16x32_bf16 v[20:23], a[36:39], v[32:35], v[20:23]
    ds_read_b128 v[32:35], v4 offset:16384
    s_waitcnt lgkmcnt(7)
    v_mfma_f32_16x16x32_bf16 v[24:27], a[32:35], v[36:39], v[24:27]
    v_mfma_f32_16x16x32_bf16 v[28:31], a[36:39], v[36:39], v[28:31]
    ds_read_b128 v[36:39], v4 offset:16640
    s_waitcnt lgkmcnt(7)
    v_mfma_f32_16x16x32_bf16 v[16:19], a[40:43], v[40:43], v[16:19]
    v_mfma_f32_16x16x32_bf16 v[20:23], a[44:47], v[40:43], v[20:23]
    ds_read_b128 v[40:43], v4 offset:18432
    s_waitcnt lgkmcnt(7)
    v_mfma_f32_16x16x32_bf16 v[24:27], a[40:43], v[44:47], v[24:27]
    v_mfma_f32_16x16x32_bf16 v[28:31], a[44:47], v[44:47], v[28:31]
    ds_read_b128 v[44:47], v4 offset:18688
    s_waitcnt lgkmcnt(7)
    v_mfma_f32_16x16x32_bf16 v[16:19], a[48:51], v[48:51], v[16:19]
    v_mfma_f32_16x16x32_bf16 v[20:23], a[52:55], v[48:51], v[20:23]
    ds_read_b128 v[48:51], v4 offset:20480
    s_waitcnt lgkmcnt(7)
    v_mfma_f32_16x16x32_bf16 v[24:27], a[48:51], v[52:55], v[24:27]
    v_mfma_f32_16x16x32_bf16 v[28:31], a[52:55], v[52:55], v[28:31]
    ds_read_b128 v[52:55], v4 offset:20736
    s_waitcnt lgkmcnt(7)
    v_mfma_f32_16x16x32_bf16 v[16:19], a[56:59], v[56:59], v[16:19]
    v_mfma_f32_16x16x32_bf16 v[20:23], a[60:63], v[56:59], v[20:23]
    ds_read_b128 v[56:59], v4 offset:22528
    s_waitcnt lgkmcnt(7)
    v_mfma_f32_16x16x32_bf16 v[24:27], a[56:59], v[60:63], v[24:27]
    v_mfma_f32_16x16x32_bf16 v[28:31], a[60:63], v[60:63], v[28:31]
    ds_read_b128 v[60:63], v4 offset:22784
    s_waitcnt lgkmcnt(7)
    v_mfma_f32_16x16x32_bf16 v[16:19], a[64:67], v[32:35], v[16:19]
    v_mfma_f32_16x16x32_bf16 v[20:23], a[68:71], v[32:35], v[20:23]
    ds_read_b128 v[32:35], v4 offset:24576
    s_waitcnt lgkmcnt(7)
    v_mfma_f32_16x16x32_bf16 v[24:27], a[64:67], v[36:39], v[24:27]
    v_mfma_f32_16x16x32_bf16 v[28:31], a[68:71], v[36:39], v[28:31]
    ds_read_b128 v[36:39], v4 offset:24832
    s_waitcnt lgkmcnt(7)
    v_mfma_f32_16x16x32_bf16 v[16:19], a[72:75], v[40:43], v[16:19]
    v_mfma_f32_16x16x32_bf16 v[20:23], a[76:79], v[40:43], v[20:23]
    ds_read_b128 v[40:43], v4 offset:26624
    s_waitcnt lgkmcnt(7)
    v_mfma_f32_16x16x32_bf16 v[24:27], a[72:75], v[44:47], v[24:27]
    v_mfma_f32_16x16x32_bf16 v[28:31], a[76:79], v[44:47], v[28:31]
    ds_read_b128 v[44:47], v4 offset:26880
    s_waitcnt lgkmcnt(7)
    v_mfma_f32_16x16x32_bf16 v[16:19], a[80:83], v[48:51], v[16:19]
    v_mfma_f32_16x16x32_bf16 v[20:23], a[84:87], v[48:51], v[20:23]
    ds_read_b128 v[48:51], v4 offset:28672
    s_waitcnt lgkmcnt(7)
    v_mfma_f32_16x16x32_bf16 v[24:27], a[80:83], v[52:55], v[24:27]
    v_mfma_f32_16x16x32_bf16 v[28:31], a[84:87], v[52:55], v[28:31]
    ds_read_b128 v[52:55], v4 offset:28928
    s_waitcnt lgkmcnt(7)
    v_mfma_f32_16x16x32_bf16 v[16:19], a[88:91], v[56:59], v[16:19]
    v_mfma_f32_16x16x32_bf16 v[20:23], a[92:95], v[56:59], v[20:23]
    ds_read_b128 v[56:59], v4 offset:30720
    s_waitcnt lgkmcnt(7)
    v_mfma_f32_16x16x32_bf16 v[24:27], a[88:91], v[60:63], v[24:27]
    v_mfma_f32_16x16x32_bf16 v[28:31], a[92:95], v[60:63], v[28:31]
    ds_read_b128 v[60:63], v4 offset:30976
    s_waitcnt lgkmcnt(7)
    v_mfma_f32_16x16x32_bf16 v[16:19], a[96:99], v[32:35], v[16:19]
    v_mfma_f32_16x16x32_bf16 v[20:23], a[100:103], v[32:35], v[20:23]
    s_waitcnt lgkmcnt(6)
    v_mfma_f32_16x16x32_bf16 v[24:27], a[96:99], v[36:39], v[24:27]
    v_mfma_f32_16x16x32_bf16 v[28:31], a[100:103], v[36:39], v[28:31]
    s_waitcnt lgkmcnt(5)
    v_mfma_f32_16x16x32_bf16 v[16:19], a[104:107], v[40:43], v[16:19]
    v_mfma_f32_16x16x32_bf16 v[20:23], a[108:111], v[40:43], v[20:23]
    s_waitcnt lgkmcnt(4)
    v_mfma_f32_16x16x32_bf16 v[24:27], a[104:107], v[44:47], v[24:27]
    v_mfma_f32_16x16x32_bf16 v[28:31], a[108:111], v[44:47], v[28:31]
    s_waitcnt lgkmcnt(3)
    v_mfma_f32_16x16x32_bf16 v[16:19], a[112:115], v[48:51], v[16:19]
    v_mfma_f32_16x16x32_bf16 v[20:23], a[116:119], v[48:51], v[20:23]
    s_waitcnt lgkmcnt(2)
    v_mfma_f32_16x16x32_bf16 v[24:27], a[112:115], v[52:55], v[24:27]
    v_mfma_f32_16x16x32_bf16 v[28:31], a[116:119], v[52:55], v[28:31]
    s_waitcnt lgkmcnt(1)
    v_mfma_f32_16x16x32_bf16 v[16:19], a[120:123], v[56:59], v[16:19]
    v_mfma_f32_16x16x32_bf16 v[20:23], a[124:127], v[56:59], v[20:23]
    s_waitcnt lgkmcnt(0)
    v_mfma_f32_16x16x32_bf16 v[24:27], a[120:123], v[60:63], v[24:27]
    v_mfma_f32_16x16x32_bf16 v[28:31], a[124:127], v[60:63], v[28:31]
    v_xor_b32 v4, 0x10000, v4
    s_setprio 0
    s_waitcnt vmcnt(0)
    s_lshl_b32 s67, s67, 1
    s_or_b32 s67, s67, 1
    s_add_u32 s60, s60, 1
    s_cmp_gt_u32 s66, s60
    s_cbranch_scc1 L_g_loop1_59
    s_barrier
    ds_read_b32 v14, v15
    s_waitcnt lgkmcnt(0)
    v_readfirstlane_b32 s66, v14
    s_barrier
    s_mov_b32 s69, 0
    s_cmp_gt_u32 s62, s60
    s_cbranch_scc1 L_g_nd_86
    s_cmp_ge_u32 s62, s66
    s_cbranch_scc1 L_g_nd_86
    s_add_u32 s47, s61, 4096
    s_add_u32 m0, s64, 0
    s_nop 0
    buffer_load_dwordx4 v3, s[12:15], s61 offen offset:0 sc1 lds
    buffer_load_dwordx4 v3, s[12:15], s61 offen offset:1024 sc1 lds
    buffer_load_dwordx4 v3, s[12:15], s61 offen offset:2048 sc1 lds
    buffer_load_dwordx4 v3, s[12:15], s61 offen offset:3072 sc1 lds
    s_add_u32 m0, s64, 4096
    s_nop 0
    buffer_load_dwordx4 v3, s[12:15], s47 offen offset:0 sc1 lds
    buffer_load_dwordx4 v3, s[12:15], s47 offen offset:1024 sc1 lds
    buffer_load_dwordx4 v3, s[12:15], s47 offen offset:2048 sc1 lds
    buffer_load_dwordx4 v3, s[12:15], s47 offen offset:3072 sc1 lds
    s_add_u32 s61, s61, 65536
    s_add_u32 s62, s62, 1
    s_xor_b32 s64, s64, 0x10000
    s_mov_b32 s69, 1
L_g_nd_86:
    s_sub_u32 s59, s60, 1
    ds_read_b128 v[80:83], v5 offset:0
    ds_read_b128 v[84:87], v5 offset:1024
    ds_read_b128 v[88:91], v5 offset:2048
    ds_read_b128 v[92:95], v5 offset:3072
    s_nop 7
    s_waitcnt lgkmcnt(3)
    v_add_f32 v80, v80, v16
    v_add_f32 v81, v81, v17
    v_add_f32 v82, v82, v18
    v_add_f32 v83, v83, v19
    s_waitcnt lgkmcnt(2)
    v_add_f32 v84, v84, v20
    v_add_f32 v85, v85, v21
    v_add_f32 v86, v86, v22
    v_add_f32 v87, v87, v23
    s_waitcnt lgkmcnt(1)
    v_add_f32 v88, v88, v24
    v_add_f32 v89, v89, v25
    v_add_f32 v90, v90, v26
    v_add_f32 v91, v91, v27
    s_waitcnt lgkmcnt(0)
    v_add_f32 v92, v92, v28
    v_add_f32 v93, v93, v29
    v_add_f32 v94, v94, v30
    v_add_f32 v95, v95, v31
    v_cvt_pk_bf16_f32 v104, v80, v81
    v_cvt_pk_bf16_f32 v105, v82, v83
    v_cvt_pk_bf16_f32 v106, v84, v85
    v_cvt_pk_bf16_f32 v107, v86, v87
    buffer_store_dwordx4 v[104:107], v8, s[12:15], s63 offen sc1
    v_cvt_pk_bf16_f32 v108, v88, v89
    v_cvt_pk_bf16_f32 v109, v90, v91
    v_cvt_pk_bf16_f32 v110, v92, v93
    v_cvt_pk_bf16_f32 v111, v94, v95
    buffer_store_dwordx4 v[108:111], v9, s[12:15], s63 offen sc1
    s_add_u32 s63, s63, 786432
    v_mov_b32 v10, 1
    s_mov_b64 exec, 1
    s_waitcnt vmcnt(0)
    ds_add_rtn_u32 v10, v15, v10 offset:4
    s_waitcnt lgkmcnt(0)
    v_readfirstlane_b32 s46, v10
    s_mov_b64 exec, -1
    s_mov_b32 s67, 0
    s_nop 1
    s_cmp_lg_u32 s46, s68
    s_cbranch_scc1 L_g_g1f_61
    v_mov_b32 v10, s59
    v_add_u32 v10, 1, v10
    v_mov_b32 v11, 0
    s_mov_b64 exec, 1
    buffer_store_dword v10, v11, s[12:15], s52 offen sc1
    s_mov_b64 exec, -1
L_sf_87:
L_g_g1f_61:
    s_add_u32 s68, s68, 4
    s_cmp_gt_u32 s66, s60
    s_cbranch_scc1 L_g_g1r_57
L_g_tail_60:
    s_cmp_lt_u32 s60, 64
    s_cbranch_scc1 L_g_restart_55
    s_barrier
    s_branch L_w_p2_9
L_w_p2_9:
    s_lshr_b32 s42, s40, 1
    s_and_b32 s43, s40, 1
    s_lshl_b32 s43, s43, 2
    s_and_b32 s46, s48, 3
    s_add_u32 s43, s43, s46
    s_cmp_lt_u32 s48, 4
    s_cbranch_scc1 L_w_wo_10
    s_cmp_lt_u32 s48, 8
    s_cbranch_scc1 L_w_f2_11
    s_cmp_lg_u32 s43, 7
    s_cbranch_scc1 L_w_f1_12
    s_mov_b32 s43, 2
    s_branch L_w_c_14
L_w_f1_12:
    s_load_dwordx2 s[4:5], s[0:1], 64
    s_load_dwordx2 s[6:7], s[0:1], 72
    s_and_b32 s50, s44, 3
    s_lshr_b32 s51, s44, 2
    s_waitcnt lgkmcnt(0)
    s_mov_b32 s24, s4
    s_and_b32 s25, s5, 0xffff
    s_mov_b32 s26, 0x700000
    s_mov_b32 s27, 0x00020000
    s_mul_i32 s49, s42, 7
    s_add_u32 s49, s49, s43
    v_lshrrev_b32 v3, 4, v1
    v_and_b32 v4, 15, v1
    v_lshlrev_b32 v5, 2, v3
    v_xor_b32 v4, v4, v5
    v_mul_u32_u24 v3, 7168, v3
    v_lshl_add_u32 v3, v4, 4, v3
    s_mul_i32 s46, s51, 512
    s_mul_i32 s47, s50, 64
    s_add_u32 s46, s46, s47
    s_mul_i32 s46, s46, 7168
    s_lshl_b32 s47, s49, 8
    s_add_u32 s46, s46, s47
    s_lshl_b32 s45, s51, 16
    s_mul_i32 s47, s50, 16384
    s_add_u32 s45, s45, s47
    v_bfe_u32 v4, v1, 2, 2
    v_bfe_u32 v5, v1, 4, 1
    v_lshlrev_b32 v5, 1, v5
    v_bfe_u32 v6, v1, 1, 1
    v_add_u32 v5, v5, v6
    s_lshl_b32 s47, s50, 2
    v_add_u32 v5, s47, v5
    v_lshlrev_b32 v6, 2, v4
    v_xor_b32 v5, v5, v6
    v_lshlrev_b32 v5, 4, v5
    v_lshl_add_u32 v5, v4, 8, v5
    v_bfe_u32 v6, v1, 0, 1
    v_lshl_add_u32 v5, v6, 3, v5
    v_lshrrev_b32 v6, 5, v1
    v_mul_u32_u24 v6, 2048, v6
    v_add_u32 v5, v5, v6
    s_lshl_b32 s47, s51, 16
    v_add_u32 v5, s47, v5
    v_bfe_u32 v4, v1, 2, 2
    v_xor_b32 v5, s50, v4
    v_lshlrev_b32 v5, 6, v5
    v_lshl_add_u32 v5, v4, 8, v5
    v_and_b32 v6, 3, v1
    v_lshl_add_u32 v5, v6, 3, v5
    v_lshrrev_b32 v6, 4, v1
    v_lshl_add_u32 v5, v6, 11, v5
    s_lshl_b32 s47, s51, 16
    v_add_u32 v5, s47, v5
    s_add_u32 m0, s45, 0
    s_add_u32 s47, s46, 0x0
    buffer_load_dwordx4 v3, s[24:27], s47 offen lds
    s_add_u32 m0, s45, 1024
    s_add_u32 s47, s46, 0x7000
    buffer_load_dwordx4 v3, s[24:27], s47 offen lds
    s_add_u32 m0, s45, 2048
    s_add_u32 s47, s46, 0xe000
    buffer_load_dwordx4 v3, s[24:27], s47 offen lds
    s_add_u32 m0, s45, 3072
    s_add_u32 s47, s46, 0x15000
    buffer_load_dwordx4 v3, s[24:27], s47 offen lds
    s_add_u32 m0, s45, 4096
    s_add_u32 s47, s46, 0x1c000
    buffer_load_dwordx4 v3, s[24:27], s47 offen lds
    s_add_u32 m0, s45, 5120
    s_add_u32 s47, s46, 0x23000
    buffer_load_dwordx4 v3, s[24:27], s47 offen lds
    s_add_u32 m0, s45, 6144
    s_add_u32 s47, s46, 0x2a000
    buffer_load_dwordx4 v3, s[24:27], s47 offen lds
    s_add_u32 m0, s45, 7168
    s_add_u32 s47, s46, 0x31000
    buffer_load_dwordx4 v3, s[24:27], s47 offen lds
    s_add_u32 m0, s45, 8192
    s_add_u32 s47, s46, 0x38000
    buffer_load_dwordx4 v3, s[24:27], s47 offen lds
    s_add_u32 m0, s45, 9216
    s_add_u32 s47, s46, 0x3f000
    buffer_load_dwordx4 v3, s[24:27], s47 offen lds
    s_add_u32 m0, s45, 10240
    s_add_u32 s47, s46, 0x46000
    buffer_load_dwordx4 v3, s[24:27], s47 offen lds
    s_add_u32 m0, s45, 11264
    s_add_u32 s47, s46, 0x4d000
    buffer_load_dwordx4 v3, s[24:27], s47 offen lds
    s_add_u32 m0, s45, 12288
    s_add_u32 s47, s46, 0x54000
    buffer_load_dwordx4 v3, s[24:27], s47 offen lds
    s_add_u32 m0, s45, 13312
    s_add_u32 s47, s46, 0x5b000
    buffer_load_dwordx4 v3, s[24:27], s47 offen lds
    s_add_u32 m0, s45, 14336
    s_add_u32 s47, s46, 0x62000
    buffer_load_dwordx4 v3, s[24:27], s47 offen lds
    s_add_u32 m0, s45, 15360
    s_add_u32 s47, s46, 0x69000
    buffer_load_dwordx4 v3, s[24:27], s47 offen lds
    s_waitcnt vmcnt(0)
    s_barrier
    ds_read_b64_tr_b16 a[0:1], v5 offset:0
    ds_read_b64_tr_b16 a[2:3], v5 offset:1024
    ds_read_b64_tr_b16 a[4:5], v5 offset:32
    ds_read_b64_tr_b16 a[6:7], v5 offset:1056
    ds_read_b64_tr_b16 a[8:9], v5 offset:8192
    ds_read_b64_tr_b16 a[10:11], v5 offset:9216
    ds_read_b64_tr_b16 a[12:13], v5 offset:8224
    ds_read_b64_tr_b16 a[14:15], v5 offset:9248
    s_waitcnt lgkmcnt(0)
    ds_read_b64_tr_b16 a[16:17], v5 offset:16384
    ds_read_b64_tr_b16 a[18:19], v5 offset:17408
    ds_read_b64_tr_b16 a[20:21], v5 offset:16416
    ds_read_b64_tr_b16 a[22:23], v5 offset:17440
    ds_read_b64_tr_b16 a[24:25], v5 offset:24576
    ds_read_b64_tr_b16 a[26:27], v5 offset:25600
    ds_read_b64_tr_b16 a[28:29], v5 offset:24608
    ds_read_b64_tr_b16 a[30:31], v5 offset:25632
    s_waitcnt lgkmcnt(0)
    ds_read_b64_tr_b16 a[32:33], v5 offset:32768
    ds_read_b64_tr_b16 a[34:35], v5 offset:33792
    ds_read_b64_tr_b16 a[36:37], v5 offset:32800
    ds_read_b64_tr_b16 a[38:39], v5 offset:33824
    ds_read_b64_tr_b16 a[40:41], v5 offset:40960
    ds_read_b64_tr_b16 a[42:43], v5 offset:41984
    ds_read_b64_tr_b16 a[44:45], v5 offset:40992
    ds_read_b64_tr_b16 a[46:47], v5 offset:42016
    s_waitcnt lgkmcnt(0)
    ds_read_b64_tr_b16 a[48:49], v5 offset:49152
    ds_read_b64_tr_b16 a[50:51], v5 offset:50176
    ds_read_b64_tr_b16 a[52:53], v5 offset:49184
    ds_read_b64_tr_b16 a[54:55], v5 offset:50208
    ds_read_b64_tr_b16 a[56:57], v5 offset:57344
    ds_read_b64_tr_b16 a[58:59], v5 offset:58368
    ds_read_b64_tr_b16 a[60:61], v5 offset:57376
    ds_read_b64_tr_b16 a[62:63], v5 offset:58400
    s_waitcnt lgkmcnt(0)
    s_waitcnt lgkmcnt(0)
    s_barrier
    s_add_u32 m0, s45, 0
    s_add_u32 s47, s46, 0x1c0000
    buffer_load_dwordx4 v3, s[24:27], s47 offen lds
    s_add_u32 m0, s45, 1024
    s_add_u32 s47, s46, 0x1c7000
    buffer_load_dwordx4 v3, s[24:27], s47 offen lds
    s_add_u32 m0, s45, 2048
    s_add_u32 s47, s46, 0x1ce000
    buffer_load_dwordx4 v3, s[24:27], s47 offen lds
    s_add_u32 m0, s45, 3072
    s_add_u32 s47, s46, 0x1d5000
    buffer_load_dwordx4 v3, s[24:27], s47 offen lds
    s_add_u32 m0, s45, 4096
    s_add_u32 s47, s46, 0x1dc000
    buffer_load_dwordx4 v3, s[24:27], s47 offen lds
    s_add_u32 m0, s45, 5120
    s_add_u32 s47, s46, 0x1e3000
    buffer_load_dwordx4 v3, s[24:27], s47 offen lds
    s_add_u32 m0, s45, 6144
    s_add_u32 s47, s46, 0x1ea000
    buffer_load_dwordx4 v3, s[24:27], s47 offen lds
    s_add_u32 m0, s45, 7168
    s_add_u32 s47, s46, 0x1f1000
    buffer_load_dwordx4 v3, s[24:27], s47 offen lds
    s_add_u32 m0, s45, 8192
    s_add_u32 s47, s46, 0x1f8000
    buffer_load_dwordx4 v3, s[24:27], s47 offen lds
    s_add_u32 m0, s45, 9216
    s_add_u32 s47, s46, 0x1ff000
    buffer_load_dwordx4 v3, s[24:27], s47 offen lds
    s_add_u32 m0, s45, 10240
    s_add_u32 s47, s46, 0x206000
    buffer_load_dwordx4 v3, s[24:27], s47 offen lds
    s_add_u32 m0, s45, 11264
    s_add_u32 s47, s46, 0x20d000
    buffer_load_dwordx4 v3, s[24:27], s47 offen lds
    s_add_u32 m0, s45, 12288
    s_add_u32 s47, s46, 0x214000
    buffer_load_dwordx4 v3, s[24:27], s47 offen lds
    s_add_u32 m0, s45, 13312
    s_add_u32 s47, s46, 0x21b000
    buffer_load_dwordx4 v3, s[24:27], s47 offen lds
    s_add_u32 m0, s45, 14336
    s_add_u32 s47, s46, 0x222000
    buffer_load_dwordx4 v3, s[24:27], s47 offen lds
    s_add_u32 m0, s45, 15360
    s_add_u32 s47, s46, 0x229000
    buffer_load_dwordx4 v3, s[24:27], s47 offen lds
    s_waitcnt vmcnt(0)
    s_barrier
    ds_read_b64_tr_b16 a[64:65], v5 offset:0
    ds_read_b64_tr_b16 a[66:67], v5 offset:1024
    ds_read_b64_tr_b16 a[68:69], v5 offset:32
    ds_read_b64_tr_b16 a[70:71], v5 offset:1056
    ds_read_b64_tr_b16 a[72:73], v5 offset:8192
    ds_read_b64_tr_b16 a[74:75], v5 offset:9216
    ds_read_b64_tr_b16 a[76:77], v5 offset:8224
    ds_read_b64_tr_b16 a[78:79], v5 offset:9248
    s_waitcnt lgkmcnt(0)
    ds_read_b64_tr_b16 a[80:81], v5 offset:16384
    ds_read_b64_tr_b16 a[82:83], v5 offset:17408
    ds_read_b64_tr_b16 a[84:85], v5 offset:16416
    ds_read_b64_tr_b16 a[86:87], v5 offset:17440
    ds_read_b64_tr_b16 a[88:89], v5 offset:24576
    ds_read_b64_tr_b16 a[90:91], v5 offset:25600
    ds_read_b64_tr_b16 a[92:93], v5 offset:24608
    ds_read_b64_tr_b16 a[94:95], v5 offset:25632
    s_waitcnt lgkmcnt(0)
    ds_read_b64_tr_b16 a[96:97], v5 offset:32768
    ds_read_b64_tr_b16 a[98:99], v5 offset:33792
    ds_read_b64_tr_b16 a[100:101], v5 offset:32800
    ds_read_b64_tr_b16 a[102:103], v5 offset:33824
    ds_read_b64_tr_b16 a[104:105], v5 offset:40960
    ds_read_b64_tr_b16 a[106:107], v5 offset:41984
    ds_read_b64_tr_b16 a[108:109], v5 offset:40992
    ds_read_b64_tr_b16 a[110:111], v5 offset:42016
    s_waitcnt lgkmcnt(0)
    ds_read_b64_tr_b16 a[112:113], v5 offset:49152
    ds_read_b64_tr_b16 a[114:115], v5 offset:50176
    ds_read_b64_tr_b16 a[116:117], v5 offset:49184
    ds_read_b64_tr_b16 a[118:119], v5 offset:50208
    ds_read_b64_tr_b16 a[120:121], v5 offset:57344
    ds_read_b64_tr_b16 a[122:123], v5 offset:58368
    ds_read_b64_tr_b16 a[124:125], v5 offset:57376
    ds_read_b64_tr_b16 a[126:127], v5 offset:58400
    s_waitcnt lgkmcnt(0)
    s_waitcnt lgkmcnt(0)
    s_barrier
    v_lshlrev_b32 v2, 4, v1
    s_mul_i32 s64, s44, 8192
    s_add_u32 s46, s64, 0xc00000
    v_add_u32 v3, s46, v2
    s_mul_i32 s46, s51, 32768
    v_add_u32 v4, s46, v2
    v_and_b32 v6, 15, v1
    v_lshlrev_b32 v6, 4, v6
    v_lshrrev_b32 v7, 4, v1
    v_lshl_add_u32 v6, v7, 9, v6
    v_add_u32 v4, s46, v6
    s_lshl_b32 s46, s50, 12
    s_add_u32 s46, s46, 131072
    v_add_u32 v5, s46, v2
    v_and_b32 v7, 3, v1
    v_lshlrev_b32 v7, 7, v7
    v_add_u32 v7, 0x10ec00, v7
    s_lshl_b32 s46, s49, 13
    s_lshl_b32 s47, s50, 11
    s_add_u32 s46, s46, s47
    s_add_u32 s46, s46, 0x6000000
    v_add_u32 v8, s46, v6
    s_lshl_b32 s52, s49, 7
    s_add_u32 s52, s52, 0x106400
    s_mov_b32 s28, s6
    s_and_b32 s29, s7, 0xffff
    s_mov_b32 s30, 0x1c00
    s_mov_b32 s31, 0x00020000
    s_lshl_b32 s46, s49, 8
    s_lshl_b32 s47, s50, 6
    s_add_u32 s46, s46, s47
    v_lshrrev_b32 v9, 4, v1
    v_lshlrev_b32 v9, 3, v9
    buffer_load_dwordx2 v[32:33], v9, s[28:31], s46 offen offset:0
    buffer_load_dwordx2 v[34:35], v9, s[28:31], s46 offen offset:32
    buffer_load_dwordx2 v[36:37], v9, s[28:31], s46 offen offset:0
    buffer_load_dwordx2 v[38:39], v9, s[28:31], s46 offen offset:32
    v_add_u32 v9, 256, v8
    s_mov_b32 s56, 0xbdd2d3e8
    s_mov_b32 s57, 0xbdd2d3e8
    v_mov_b32 v112, 0xc0135761
    v_mov_b32 v113, 0xc0135761
    s_waitcnt vmcnt(0)
    v_lshlrev_b32 v64, 16, v32
    v_and_b32 v65, 0xffff0000, v32
    v_lshlrev_b32 v66, 16, v33
    v_and_b32 v67, 0xffff0000, v33
    v_lshlrev_b32 v68, 16, v34
    v_and_b32 v69, 0xffff0000, v34
    v_lshlrev_b32 v70, 16, v35
    v_and_b32 v71, 0xffff0000, v35
    v_lshlrev_b32 v72, 16, v36
    v_and_b32 v73, 0xffff0000, v36
    v_lshlrev_b32 v74, 16, v37
    v_and_b32 v75, 0xffff0000, v37
    v_lshlrev_b32 v76, 16, v38
    v_and_b32 v77, 0xffff0000, v38
    v_lshlrev_b32 v78, 16, v39
    v_and_b32 v79, 0xffff0000, v39
    s_mov_b32 s60, 0
    s_mov_b32 s61, 0
    s_mov_b32 s62, 0
    s_mov_b32 s63, 0
    s_mov_b32 s67, 0
    s_mov_b32 s68, 3
    v_mov_b32 v15, 147456
    v_mov_b32 v14, 0
    ds_write_b32 v15, v14 offset:4
L_g_restart_88:
    s_cmp_lg_u32 s44, 0
    s_cbranch_scc1 L_g_nsp_89
    s_mov_b32 s70, 0
L_g_sp_95:
    s_add_u32 s54, s60, 0
    s_add_u32 s55, s54, 0
    s_mul_i32 s46, s55, 171
    s_lshr_b32 s46, s46, 9
    s_mul_i32 s46, s46, 3
    s_sub_u32 s46, s55, s46
    s_lshl_b32 s46, s46, 9
    buffer_load_dword v11, v7, s[12:15], s46 offen sc1
    s_add_u32 s55, s54, 1
    s_mul_i32 s46, s55, 171
    s_lshr_b32 s46, s46, 9
    s_mul_i32 s46, s46, 3
    s_sub_u32 s46, s55, s46
    s_lshl_b32 s46, s46, 9
    buffer_load_dword v12, v7, s[12:15], s46 offen sc1
    s_add_u32 s55, s54, 2
    s_mul_i32 s46, s55, 171
    s_lshr_b32 s46, s46, 9
    s_mul_i32 s46, s46, 3
    s_sub_u32 s46, s55, s46
    s_lshl_b32 s46, s46, 9
    buffer_load_dword v13, v7, s[12:15], s46 offen sc1
    s_waitcnt vmcnt(0)
    v_cmp_ge_u32 vcc, s60, v11
    s_add_u32 s70, s70, 1
    s_cbranch_vccz L_g_sp_95_ok
    s_sleep 8
    s_cmp_lt_u32 s70, 524288
    s_cbranch_scc1 L_g_sp_95
    s_branch L_c_done_1
L_g_sp_95_ok:
    s_mov_b32 s46, s54
    v_cmp_ge_u32 vcc, s46, v11
    s_nop 0
    s_cbranch_vccnz L_g_le_96
    s_add_u32 s46, s46, 1
    v_cmp_ge_u32 vcc, s46, v12
    s_nop 0
    s_cbranch_vccnz L_g_le_96
    s_add_u32 s46, s46, 1
    v_cmp_ge_u32 vcc, s46, v13
    s_nop 0
    s_cbranch_vccnz L_g_le_96
    s_add_u32 s46, s46, 1
L_g_le_96:
    v_mov_b32 v11, s46
    ds_write_b32 v15, v11
L_g_nsp_89:
    s_waitcnt lgkmcnt(0)
    s_barrier
    ds_read_b32 v14, v15
    s_waitcnt lgkmcnt(0)
    v_readfirstlane_b32 s66, v14
    s_nop 3
L_g_restart_88_go:
    s_mov_b32 s69, 0
    s_cmp_gt_u32 s62, s60
    s_cbranch_scc1 L_g_nd_97
    s_cmp_ge_u32 s62, s66
    s_cbranch_scc1 L_g_nd_97
    s_add_u32 s47, s61, 4096
    s_add_u32 m0, s64, 0
    s_nop 0
    buffer_load_dwordx4 v3, s[12:15], s61 offen offset:0 sc1 lds
    buffer_load_dwordx4 v3, s[12:15], s61 offen offset:1024 sc1 lds
    buffer_load_dwordx4 v3, s[12:15], s61 offen offset:2048 sc1 lds
    buffer_load_dwordx4 v3, s[12:15], s61 offen offset:3072 sc1 lds
    s_add_u32 m0, s64, 4096
    s_nop 0
    buffer_load_dwordx4 v3, s[12:15], s47 offen offset:0 sc1 lds
    buffer_load_dwordx4 v3, s[12:15], s47 offen offset:1024 sc1 lds
    buffer_load_dwordx4 v3, s[12:15], s47 offen offset:2048 sc1 lds
    buffer_load_dwordx4 v3, s[12:15], s47 offen offset:3072 sc1 lds
    s_add_u32 s61, s61, 65536
    s_add_u32 s62, s62, 1
    s_xor_b32 s64, s64, 0x10000
    s_mov_b32 s69, 1
L_g_nd_97:
    s_cmp_eq_u32 s51, 1
    s_cbranch_scc1 L_g_g1r_90
    s_add_u32 s59, s60, 1
    s_mov_b32 s69, 0
    s_cmp_gt_u32 s62, s59
    s_cbranch_scc1 L_g_nd_98
    s_cmp_ge_u32 s62, s66
    s_cbranch_scc1 L_g_nd_98
    s_add_u32 s47, s61, 4096
    s_add_u32 m0, s64, 0
    s_nop 0
    buffer_load_dwordx4 v3, s[12:15], s61 offen offset:0 sc1 lds
    buffer_load_dwordx4 v3, s[12:15], s61 offen offset:1024 sc1 lds
    buffer_load_dwordx4 v3, s[12:15], s61 offen offset:2048 sc1 lds
    buffer_load_dwordx4 v3, s[12:15], s61 offen offset:3072 sc1 lds
    s_add_u32 m0, s64, 4096
    s_nop 0
    buffer_load_dwordx4 v3, s[12:15], s47 offen offset:0 sc1 lds
    buffer_load_dwordx4 v3, s[12:15], s47 offen offset:1024 sc1 lds
    buffer_load_dwordx4 v3, s[12:15], s47 offen offset:2048 sc1 lds
    buffer_load_dwordx4 v3, s[12:15], s47 offen offset:3072 sc1 lds
    s_add_u32 s61, s61, 65536
    s_add_u32 s62, s62, 1
    s_xor_b32 s64, s64, 0x10000
    s_mov_b32 s69, 1
L_g_nd_98:
    s_cmp_eq_u32 s69, 1
    s_cbranch_scc1 L_g_w0_99
    s_waitcnt vmcnt(0)
L_g_w0_99:
    s_waitcnt vmcnt(8)
    s_mov_b32 s65, 1
L_g_loop0_91:
    s_barrier
    s_cmp_eq_u32 s65, 0
    s_cbranch_scc1 L_g_pr_100
    ds_read_b128 v[32:35], v4 offset:0
    ds_read_b128 v[36:39], v4 offset:256
    ds_read_b128 v[40:43], v4 offset:2048
    ds_read_b128 v[44:47], v4 offset:2304
    ds_read_b128 v[48:51], v4 offset:4096
    ds_read_b128 v[52:55], v4 offset:4352
    ds_read_b128 v[56:59], v4 offset:6144
    ds_read_b128 v[60:63], v4 offset:6400
L_g_pr_100:
    ds_read_b32 v14, v15
    s_cmp_lg_u32 s44, 0
    s_cbranch_scc1 L_g_nl_101
    s_add_u32 s54, s60, 1
    s_add_u32 s55, s54, 0
    s_mul_i32 s46, s55, 171
    s_lshr_b32 s46, s46, 9
    s_mul_i32 s46, s46, 3
    s_sub_u32 s46, s55, s46
    s_lshl_b32 s46, s46, 9
    buffer_load_dword v11, v7, s[12:15], s46 offen sc1
    s_add_u32 s55, s54, 1
    s_mul_i32 s46, s55, 171
    s_lshr_b32 s46, s46, 9
    s_mul_i32 s46, s46, 3
    s_sub_u32 s46, s55, s46
    s_lshl_b32 s46, s46, 9
    buffer_load_dword v12, v7, s[12:15], s46 offen sc1
    s_add_u32 s55, s54, 2
    s_mul_i32 s46, s55, 171
    s_lshr_b32 s46, s46, 9
    s_mul_i32 s46, s46, 3
    s_sub_u32 s46, s55, s46
    s_lshl_b32 s46, s46, 9
    buffer_load_dword v13, v7, s[12:15], s46 offen sc1
L_g_nl_101:
    s_setprio 1
    s_waitcnt lgkmcnt(7)
    v_mfma_f32_16x16x32_bf16 v[16:19], a[0:3], v[32:35], 0
    v_mfma_f32_16x16x32_bf16 v[20:23], a[4:7], v[32:35], 0
    ds_read_b128 v[32:35], v4 offset:8192
    s_waitcnt lgkmcnt(7)
    v_mfma_f32_16x16x32_bf16 v[24:27], a[0:3], v[36:39], 0
    v_mfma_f32_16x16x32_bf16 v[28:31], a[4:7], v[36:39], 0
    ds_read_b128 v[36:39], v4 offset:8448
    s_waitcnt lgkmcnt(7)
    v_mfma_f32_16x16x32_bf16 v[16:19], a[8:11], v[40:43], v[16:19]
    v_mfma_f32_16x16x32_bf16 v[20:23], a[12:15], v[40:43], v[20:23]
    ds_read_b128 v[40:43], v4 offset:10240
    s_waitcnt lgkmcnt(7)
    v_mfma_f32_16x16x32_bf16 v[24:27], a[8:11], v[44:47], v[24:27]
    v_mfma_f32_16x16x32_bf16 v[28:31], a[12:15], v[44:47], v[28:31]
    ds_read_b128 v[44:47], v4 offset:10496
    s_waitcnt lgkmcnt(7)
    v_mfma_f32_16x16x32_bf16 v[16:19], a[16:19], v[48:51], v[16:19]
    v_mfma_f32_16x16x32_bf16 v[20:23], a[20:23], v[48:51], v[20:23]
    ds_read_b128 v[48:51], v4 offset:12288
    s_waitcnt lgkmcnt(7)
    v_mfma_f32_16x16x32_bf16 v[24:27], a[16:19], v[52:55], v[24:27]
    v_mfma_f32_16x16x32_bf16 v[28:31], a[20:23], v[52:55], v[28:31]
    ds_read_b128 v[52:55], v4 offset:12544
    s_waitcnt lgkmcnt(7)
    v_mfma_f32_16x16x32_bf16 v[16:19], a[24:27], v[56:59], v[16:19]
    v_mfma_f32_16x16x32_bf16 v[20:23], a[28:31], v[56:59], v[20:23]
    ds_read_b128 v[56:59], v4 offset:14336
    s_waitcnt lgkmcnt(7)
    v_mfma_f32_16x16x32_bf16 v[24:27], a[24:27], v[60:63], v[24:27]
    v_mfma_f32_16x16x32_bf16 v[28:31], a[28:31], v[60:63], v[28:31]
    ds_read_b128 v[60:63], v4 offset:14592
    s_waitcnt lgkmcnt(7)
    v_mfma_f32_16x16x32_bf16 v[16:19], a[32:35], v[32:35], v[16:19]
    v_mfma_f32_16x16x32_bf16 v[20:23], a[36:39], v[32:35], v[20:23]
    ds_read_b128 v[32:35], v4 offset:16384
    s_waitcnt lgkmcnt(7)
    v_mfma_f32_16x16x32_bf16 v[24:27], a[32:35], v[36:39], v[24:27]
    v_mfma_f32_16x16x32_bf16 v[28:31], a[36:39], v[36:39], v[28:31]
    ds_read_b128 v[36:39], v4 offset:16640
    s_waitcnt lgkmcnt(7)
    v_mfma_f32_16x16x32_bf16 v[16:19], a[40:43], v[40:43], v[16:19]
    v_mfma_f32_16x16x32_bf16 v[20:23], a[44:47], v[40:43], v[20:23]
    ds_read_b128 v[40:43], v4 offset:18432
    s_waitcnt lgkmcnt(7)
    v_mfma_f32_16x16x32_bf16 v[24:27], a[40:43], v[44:47], v[24:27]
    v_mfma_f32_16x16x32_bf16 v[28:31], a[44:47], v[44:47], v[28:31]
    ds_read_b128 v[44:47], v4 offset:18688
    s_waitcnt lgkmcnt(7)
    v_mfma_f32_16x16x32_bf16 v[16:19], a[48:51], v[48:51], v[16:19]
    v_mfma_f32_16x16x32_bf16 v[20:23], a[52:55], v[48:51], v[20:23]
    ds_read_b128 v[48:51], v4 offset:20480
    s_waitcnt lgkmcnt(7)
    v_mfma_f32_16x16x32_bf16 v[24:27], a[48:51], v[52:55], v[24:27]
    v_mfma_f32_16x16x32_bf16 v[28:31], a[52:55], v[52:55], v[28:31]
    ds_read_b128 v[52:55], v4 offset:20736
    s_waitcnt lgkmcnt(7)
    v_mfma_f32_16x16x32_bf16 v[16:19], a[56:59], v[56:59], v[16:19]
    v_mfma_f32_16x16x32_bf16 v[20:23], a[60:63], v[56:59], v[20:23]
    ds_read_b128 v[56:59], v4 offset:22528
    s_waitcnt lgkmcnt(7)
    v_mfma_f32_16x16x32_bf16 v[24:27], a[56:59], v[60:63], v[24:27]
    v_mfma_f32_16x16x32_bf16 v[28:31], a[60:63], v[60:63], v[28:31]
    ds_read_b128 v[60:63], v4 offset:22784
    s_waitcnt lgkmcnt(7)
    v_mfma_f32_16x16x32_bf16 v[16:19], a[64:67], v[32:35], v[16:19]
    v_mfma_f32_16x16x32_bf16 v[20:23], a[68:71], v[32:35], v[20:23]
    ds_read_b128 v[32:35], v4 offset:24576
    s_waitcnt lgkmcnt(7)
    v_mfma_f32_16x16x32_bf16 v[24:27], a[64:67], v[36:39], v[24:27]
    v_mfma_f32_16x16x32_bf16 v[28:31], a[68:71], v[36:39], v[28:31]
    ds_read_b128 v[36:39], v4 offset:24832
    s_waitcnt lgkmcnt(7)
    v_mfma_f32_16x16x32_bf16 v[16:19], a[72:75], v[40:43], v[16:19]
    v_mfma_f32_16x16x32_bf16 v[20:23], a[76:79], v[40:43], v[20:23]
    ds_read_b128 v[40:43], v4 offset:26624
    s_waitcnt lgkmcnt(7)
    v_mfma_f32_16x16x32_bf16 v[24:27], a[72:75], v[44:47], v[24:27]
    v_mfma_f32_16x16x32_bf16 v[28:31], a[76:79], v[44:47], v[28:31]
    ds_read_b128 v[44:47], v4 offset:26880
    s_waitcnt lgkmcnt(7)
    v_mfma_f32_16x16x32_bf16 v[16:19], a[80:83], v[48:51], v[16:19]
    v_mfma_f32_16x16x32_bf16 v[20:23], a[84:87], v[48:51], v[20:23]
    ds_read_b128 v[48:51], v4 offset:28672
    s_waitcnt lgkmcnt(7)
    v_mfma_f32_16x16x32_bf16 v[24:27], a[80:83], v[52:55], v[24:27]
    v_mfma_f32_16x16x32_bf16 v[28:31], a[84:87], v[52:55], v[28:31]
    ds_read_b128 v[52:55], v4 offset:28928
    s_waitcnt lgkmcnt(7)
    v_mfma_f32_16x16x32_bf16 v[16:19], a[88:91], v[56:59], v[16:19]
    v_mfma_f32_16x16x32_bf16 v[20:23], a[92:95], v[56:59], v[20:23]
    ds_read_b128 v[56:59], v4 offset:30720
    s_waitcnt lgkmcnt(7)
    v_mfma_f32_16x16x32_bf16 v[24:27], a[88:91], v[60:63], v[24:27]
    v_mfma_f32_16x16x32_bf16 v[28:31], a[92:95], v[60:63], v[28:31]
    ds_read_b128 v[60:63], v4 offset:30976
    s_waitcnt lgkmcnt(7)
    v_mfma_f32_16x16x32_bf16 v[16:19], a[96:99], v[32:35], v[16:19]
    v_mfma_f32_16x16x32_bf16 v[20:23], a[100:103], v[32:35], v[20:23]
    s_waitcnt lgkmcnt(6)
    v_mfma_f32_16x16x32_bf16 v[24:27], a[96:99], v[36:39], v[24:27]
    v_mfma_f32_16x16x32_bf16 v[28:31], a[100:103], v[36:39], v[28:31]
    s_waitcnt lgkmcnt(5)
    v_mfma_f32_16x16x32_bf16 v[16:19], a[104:107], v[40:43], v[16:19]
    v_mfma_f32_16x16x32_bf16 v[20:23], a[108:111], v[40:43], v[20:23]
    s_waitcnt lgkmcnt(4)
    v_mfma_f32_16x16x32_bf16 v[24:27], a[104:107], v[44:47], v[24:27]
    v_mfma_f32_16x16x32_bf16 v[28:31], a[108:111], v[44:47], v[28:31]
    s_waitcnt lgkmcnt(3)
    v_mfma_f32_16x16x32_bf16 v[16:19], a[112:115], v[48:51], v[16:19]
    v_mfma_f32_16x16x32_bf16 v[20:23], a[116:119], v[48:51], v[20:23]
    s_waitcnt lgkmcnt(2)
    v_mfma_f32_16x16x32_bf16 v[24:27], a[112:115], v[52:55], v[24:27]
    v_mfma_f32_16x16x32_bf16 v[28:31], a[116:119], v[52:55], v[28:31]
    s_waitcnt lgkmcnt(1)
    v_mfma_f32_16x16x32_bf16 v[16:19], a[120:123], v[56:59], v[16:19]
    v_mfma_f32_16x16x32_bf16 v[20:23], a[124:127], v[56:59], v[20:23]
    s_waitcnt lgkmcnt(0)
    v_mfma_f32_16x16x32_bf16 v[24:27], a[120:123], v[60:63], v[24:27]
    v_mfma_f32_16x16x32_bf16 v[28:31], a[124:127], v[60:63], v[28:31]
    v_xor_b32 v4, 0x10000, v4
    s_setprio 0
    s_waitcnt vmcnt(0)
    v_readfirstlane_b32 s66, v14
    s_barrier
    s_nop 6
    ds_write_b128 v5, v[16:19] offset:0
    ds_write_b128 v5, v[20:23] offset:1024
    ds_write_b128 v5, v[24:27] offset:2048
    ds_write_b128 v5, v[28:31] offset:3072
    s_cmp_lg_u32 s44, 0
    s_cbranch_scc1 L_g_ne_102
    s_mov_b32 s46, s54
    v_cmp_ge_u32 vcc, s46, v11
    s_nop 0
    s_cbranch_vccnz L_g_le_105
    s_add_u32 s46, s46, 1
    v_cmp_ge_u32 vcc, s46, v12
    s_nop 0
    s_cbranch_vccnz L_g_le_105
    s_add_u32 s46, s46, 1
    v_cmp_ge_u32 vcc, s46, v13
    s_nop 0
    s_cbranch_vccnz L_g_le_105
    s_add_u32 s46, s46, 1
L_g_le_105:
    v_mov_b32 v11, s46
    ds_write_b32 v15, v11
L_g_ne_102:
    s_add_u32 s60, s60, 1
    s_waitcnt lgkmcnt(0)
    s_mov_b32 s69, 0
    s_cmp_gt_u32 s62, s60
    s_cbranch_scc1 L_g_nd_106
    s_cmp_ge_u32 s62, s66
    s_cbranch_scc1 L_g_nd_106
    s_add_u32 s47, s61, 4096
    s_add_u32 m0, s64, 0
    s_nop 0
    buffer_load_dwordx4 v3, s[12:15], s61 offen offset:0 sc1 lds
    buffer_load_dwordx4 v3, s[12:15], s61 offen offset:1024 sc1 lds
    buffer_load_dwordx4 v3, s[12:15], s61 offen offset:2048 sc1 lds
    buffer_load_dwordx4 v3, s[12:15], s61 offen offset:3072 sc1 lds
    s_add_u32 m0, s64, 4096
    s_nop 0
    buffer_load_dwordx4 v3, s[12:15], s47 offen offset:0 sc1 lds
    buffer_load_dwordx4 v3, s[12:15], s47 offen offset:1024 sc1 lds
    buffer_load_dwordx4 v3, s[12:15], s47 offen offset:2048 sc1 lds
    buffer_load_dwordx4 v3, s[12:15], s47 offen offset:3072 sc1 lds
    s_add_u32 s61, s61, 65536
    s_add_u32 s62, s62, 1
    s_xor_b32 s64, s64, 0x10000
    s_mov_b32 s69, 1
L_g_nd_106:
    s_mov_b32 s65, s69
    s_add_u32 s59, s60, 1
    s_mov_b32 s69, 0
    s_cmp_gt_u32 s62, s59
    s_cbranch_scc1 L_g_nd_107
    s_cmp_ge_u32 s62, s66
    s_cbranch_scc1 L_g_nd_107
    s_add_u32 s47, s61, 4096
    s_add_u32 m0, s64, 0
    s_nop 0
    buffer_load_dwordx4 v3, s[12:15], s61 offen offset:0 sc1 lds
    buffer_load_dwordx4 v3, s[12:15], s61 offen offset:1024 sc1 lds
    buffer_load_dwordx4 v3, s[12:15], s61 offen offset:2048 sc1 lds
    buffer_load_dwordx4 v3, s[12:15], s61 offen offset:3072 sc1 lds
    s_add_u32 m0, s64, 4096
    s_nop 0
    buffer_load_dwordx4 v3, s[12:15], s47 offen offset:0 sc1 lds
    buffer_load_dwordx4 v3, s[12:15], s47 offen offset:1024 sc1 lds
    buffer_load_dwordx4 v3, s[12:15], s47 offen offset:2048 sc1 lds
    buffer_load_dwordx4 v3, s[12:15], s47 offen offset:3072 sc1 lds
    s_add_u32 s61, s61, 65536
    s_add_u32 s62, s62, 1
    s_xor_b32 s64, s64, 0x10000
    s_mov_b32 s69, 1
L_g_nd_107:
    s_cmp_le_u32 s66, s60
    s_cbranch_scc1 L_g_ex0_104
    s_cmp_eq_u32 s65, 0
    s_cbranch_scc1 L_g_nw_103
    s_waitcnt vmcnt(0) lgkmcnt(0)
    s_branch L_g_loop0_91
L_g_nw_103:
    ds_read_b128 v[32:35], v4 offset:0
    ds_read_b128 v[36:39], v4 offset:256
    ds_read_b128 v[40:43], v4 offset:2048
    ds_read_b128 v[44:47], v4 offset:2304
    ds_read_b128 v[48:51], v4 offset:4096
    ds_read_b128 v[52:55], v4 offset:4352
    ds_read_b128 v[56:59], v4 offset:6144
    ds_read_b128 v[60:63], v4 offset:6400
    s_waitcnt lgkmcnt(8)
    s_branch L_g_loop0_91
L_g_ex0_104:
    s_cmp_lg_u32 s44, 0
    s_cbranch_scc1 L_g_ex0_104_n
    s_sleep 6
    s_add_u32 s54, s60, 0
    s_add_u32 s55, s54, 0
    s_mul_i32 s46, s55, 171
    s_lshr_b32 s46, s46, 9
    s_mul_i32 s46, s46, 3
    s_sub_u32 s46, s55, s46
    s_lshl_b32 s46, s46, 9
    buffer_load_dword v11, v7, s[12:15], s46 offen sc1
    s_add_u32 s55, s54, 1
    s_mul_i32 s46, s55, 171
    s_lshr_b32 s46, s46, 9
    s_mul_i32 s46, s46, 3
    s_sub_u32 s46, s55, s46
    s_lshl_b32 s46, s46, 9
    buffer_load_dword v12, v7, s[12:15], s46 offen sc1
    s_add_u32 s55, s54, 2
    s_mul_i32 s46, s55, 171
    s_lshr_b32 s46, s46, 9
    s_mul_i32 s46, s46, 3
    s_sub_u32 s46, s55, s46
    s_lshl_b32 s46, s46, 9
    buffer_load_dword v13, v7, s[12:15], s46 offen sc1
    s_waitcnt vmcnt(0)
    s_mov_b32 s46, s54
    v_cmp_ge_u32 vcc, s46, v11
    s_nop 0
    s_cbranch_vccnz L_g_le_108
    s_add_u32 s46, s46, 1
    v_cmp_ge_u32 vcc, s46, v12
    s_nop 0
    s_cbranch_vccnz L_g_le_108
    s_add_u32 s46, s46, 1
    v_cmp_ge_u32 vcc, s46, v13
    s_nop 0
    s_cbranch_vccnz L_g_le_108
    s_add_u32 s46, s46, 1
L_g_le_108:
    v_mov_b32 v11, s46
    ds_write_b32 v15, v11
L_g_ex0_104_n:
    s_waitcnt lgkmcnt(0)
    s_barrier
    ds_read_b32 v14, v15
    s_waitcnt lgkmcnt(0)
    v_readfirstlane_b32 s66, v14
    s_barrier
    s_cmp_gt_u32 s66, s60
    s_cbranch_scc1 L_g_restart_88_go
    s_branch L_g_tail_93
L_g_g1r_90:
    s_mov_b32 s65, 1
    s_branch L_g_loop1_92_e
L_g_loop1_92:
    s_mov_b32 s65, 0
L_g_loop1_92_e:
    s_barrier
    ds_read_b32 v14, v15
    s_bitcmp1_b32 s67, 2
    s_cbranch_scc0 L_g_nfl_109
    s_sub_u32 s59, s60, 3
    s_cmp_lg_u32 s44, 4
    s_cbranch_scc1 L_sf_114
    v_mov_b32 v10, s59
    v_add_u32 v10, 1, v10
    v_mov_b32 v11, 0
    s_mov_b64 exec, 1
    buffer_store_dword v10, v11, s[12:15], s52 offen sc1
    s_mov_b64 exec, -1
L_sf_114:
L_g_nfl_109:
    s_bitcmp1_b32 s67, 0
    s_cbranch_scc0 L_g_nep_110
    ds_read_b128 v[80:83], v5 offset:0
    ds_read_b128 v[84:87], v5 offset:1024
    ds_read_b128 v[88:91], v5 offset:2048
    ds_read_b128 v[92:95], v5 offset:3072
    s_nop 7
    s_waitcnt lgkmcnt(3)
    v_add_f32 v80, v80, v16
    v_add_f32 v81, v81, v17
    v_add_f32 v82, v82, v18
    v_add_f32 v83, v83, v19
    s_waitcnt lgkmcnt(2)
    v_add_f32 v84, v84, v20
    v_add_f32 v85, v85, v21
    v_add_f32 v86, v86, v22
    v_add_f32 v87, v87, v23
    s_waitcnt lgkmcnt(1)
    v_add_f32 v88, v88, v24
    v_add_f32 v89, v89, v25
    v_add_f32 v90, v90, v26
    v_add_f32 v91, v91, v27
    s_waitcnt lgkmcnt(0)
    v_add_f32 v92, v92, v28
    v_add_f32 v93, v93, v29
    v_add_f32 v94, v94, v30
    v_add_f32 v95, v95, v31
L_g_nep_110:
    s_waitcnt lgkmcnt(0)
    v_readfirstlane_b32 s66, v14
    s_nop 3
    s_mov_b32 s69, 0
    s_cmp_gt_u32 s62, s60
    s_cbranch_scc1 L_g_nd_115
    s_cmp_ge_u32 s62, s66
    s_cbranch_scc1 L_g_nd_115
    s_add_u32 s47, s61, 4096
    s_add_u32 m0, s64, 0
    s_nop 0
    buffer_load_dwordx4 v3, s[12:15], s61 offen offset:0 sc1 lds
    buffer_load_dwordx4 v3, s[12:15], s61 offen offset:1024 sc1 lds
    buffer_load_dwordx4 v3, s[12:15], s61 offen offset:2048 sc1 lds
    buffer_load_dwordx4 v3, s[12:15], s61 offen offset:3072 sc1 lds
    s_add_u32 m0, s64, 4096
    s_nop 0
    buffer_load_dwordx4 v3, s[12:15], s47 offen offset:0 sc1 lds
    buffer_load_dwordx4 v3, s[12:15], s47 offen offset:1024 sc1 lds
    buffer_load_dwordx4 v3, s[12:15], s47 offen offset:2048 sc1 lds
    buffer_load_dwordx4 v3, s[12:15], s47 offen offset:3072 sc1 lds
    s_add_u32 s61, s61, 65536
    s_add_u32 s62, s62, 1
    s_xor_b32 s64, s64, 0x10000
    s_mov_b32 s69, 1
L_g_nd_115:
    s_or_b32 s65, s65, s69
    s_add_u32 s59, s60, 1
    s_mov_b32 s69, 0
    s_cmp_gt_u32 s62, s59
    s_cbranch_scc1 L_g_nd_116
    s_cmp_ge_u32 s62, s66
    s_cbranch_scc1 L_g_nd_116
    s_add_u32 s47, s61, 4096
    s_add_u32 m0, s64, 0
    s_nop 0
    buffer_load_dwordx4 v3, s[12:15], s61 offen offset:0 sc1 lds
    buffer_load_dwordx4 v3, s[12:15], s61 offen offset:1024 sc1 lds
    buffer_load_dwordx4 v3, s[12:15], s61 offen offset:2048 sc1 lds
    buffer_load_dwordx4 v3, s[12:15], s61 offen offset:3072 sc1 lds
    s_add_u32 m0, s64, 4096
    s_nop 0
    buffer_load_dwordx4 v3, s[12:15], s47 offen offset:0 sc1 lds
    buffer_load_dwordx4 v3, s[12:15], s47 offen offset:1024 sc1 lds
    buffer_load_dwordx4 v3, s[12:15], s47 offen offset:2048 sc1 lds
    buffer_load_dwordx4 v3, s[12:15], s47 offen offset:3072 sc1 lds
    s_add_u32 s61, s61, 65536
    s_add_u32 s62, s62, 1
    s_xor_b32 s64, s64, 0x10000
    s_mov_b32 s69, 1
L_g_nd_116:
    v_cvt_pk_bf16_f32 v80, 0, v80
    v_cvt_pk_bf16_f32 v81, 0, v81
    v_cvt_pk_bf16_f32 v82, 0, v82
    v_cvt_pk_bf16_f32 v83, 0, v83
    v_cvt_pk_bf16_f32 v84, 0, v84
    v_cvt_pk_bf16_f32 v85, 0, v85
    v_cvt_pk_bf16_f32 v86, 0, v86
    v_cvt_pk_bf16_f32 v87, 0, v87
    v_add_f32 v80, v80, v64
    v_add_f32 v81, v81, v65
    v_add_f32 v82, v82, v66
    v_add_f32 v83, v83, v67
    v_add_f32 v84, v84, v68
    v_add_f32 v85, v85, v69
    v_add_f32 v86, v86, v70
    v_add_f32 v87, v87, v71
    v_cvt_pk_bf16_f32 v80, 0, v80
    v_cvt_pk_bf16_f32 v81, 0, v81
    v_cvt_pk_bf16_f32 v82, 0, v82
    v_cvt_pk_bf16_f32 v83, 0, v83
    v_cvt_pk_bf16_f32 v84, 0, v84
    v_cvt_pk_bf16_f32 v85, 0, v85
    v_cvt_pk_bf16_f32 v86, 0, v86
    v_cvt_pk_bf16_f32 v87, 0, v87
    v_mul_f32 v96, v80, v80
    v_mul_f32 v97, v81, v81
    v_mul_f32 v98, v82, v82
    v_mul_f32 v99, v83, v83
    v_mul_f32 v100, v84, v84
    v_mul_f32 v101, v85, v85
    v_mul_f32 v102, v86, v86
    v_mul_f32 v103, v87, v87
    v_fma_f32 v96, v96, s56, v112
    v_fma_f32 v97, v97, s56, v112
    v_fma_f32 v98, v98, s56, v112
    v_fma_f32 v99, v99, s56, v112
    v_fma_f32 v100, v100, s56, v112
    v_fma_f32 v101, v101, s56, v112
    v_fma_f32 v102, v102, s56, v112
    v_fma_f32 v103, v103, s56, v112
    v_mul_f32 v96, v96, v80
    v_mul_f32 v97, v97, v81
    v_mul_f32 v98, v98, v82
    v_mul_f32 v99, v99, v83
    s_cmp_eq_u32 s65, 0
    s_cbranch_scc1 L_g_nw1_111
    s_waitcnt vmcnt(0)
    s_barrier
    ds_read_b128 v[32:35], v4 offset:0
    ds_read_b128 v[36:39], v4 offset:256
    ds_read_b128 v[40:43], v4 offset:2048
    ds_read_b128 v[44:47], v4 offset:2304
    ds_read_b128 v[48:51], v4 offset:4096
    ds_read_b128 v[52:55], v4 offset:4352
    ds_read_b128 v[56:59], v4 offset:6144
    ds_read_b128 v[60:63], v4 offset:6400
    s_branch L_g_jn_113
L_g_nw1_111:
    ds_read_b128 v[32:35], v4 offset:0
    ds_read_b128 v[36:39], v4 offset:256
    ds_read_b128 v[40:43], v4 offset:2048
    ds_read_b128 v[44:47], v4 offset:2304
    ds_read_b128 v[48:51], v4 offset:4096
    ds_read_b128 v[52:55], v4 offset:4352
    ds_read_b128 v[56:59], v4 offset:6144
    ds_read_b128 v[60:63], v4 offset:6400
    s_barrier
L_g_jn_113:
    s_bitcmp1_b32 s67, 0
    s_cbranch_scc1 L_g_mm2_112
    s_setprio 1
    s_waitcnt lgkmcnt(7)
    v_mfma_f32_16x16x32_bf16 v[16:19], a[0:3], v[32:35], 0
    v_mfma_f32_16x16x32_bf16 v[20:23], a[4:7], v[32:35], 0
    ds_read_b128 v[32:35], v4 offset:8192
    s_waitcnt lgkmcnt(7)
    v_mfma_f32_16x16x32_bf16 v[24:27], a[0:3], v[36:39], 0
    v_mfma_f32_16x16x32_bf16 v[28:31], a[4:7], v[36:39], 0
    ds_read_b128 v[36:39], v4 offset:8448
    s_waitcnt lgkmcnt(7)
    v_mfma_f32_16x16x32_bf16 v[16:19], a[8:11], v[40:43], v[16:19]
    v_mfma_f32_16x16x32_bf16 v[20:23], a[12:15], v[40:43], v[20:23]
    ds_read_b128 v[40:43], v4 offset:10240
    s_waitcnt lgkmcnt(7)
    v_mfma_f32_16x16x32_bf16 v[24:27], a[8:11], v[44:47], v[24:27]
    v_mfma_f32_16x16x32_bf16 v[28:31], a[12:15], v[44:47], v[28:31]
    ds_read_b128 v[44:47], v4 offset:10496
    s_waitcnt lgkmcnt(7)
    v_mfma_f32_16x16x32_bf16 v[16:19], a[16:19], v[48:51], v[16:19]
    v_mfma_f32_16x16x32_bf16 v[20:23], a[20:23], v[48:51], v[20:23]
    ds_read_b128 v[48:51], v4 offset:12288
    s_waitcnt lgkmcnt(7)
    v_mfma_f32_16x16x32_bf16 v[24:27], a[16:19], v[52:55], v[24:27]
    v_mfma_f32_16x16x32_bf16 v[28:31], a[20:23], v[52:55], v[28:31]
    ds_read_b128 v[52:55], v4 offset:12544
    s_waitcnt lgkmcnt(7)
    v_mfma_f32_16x16x32_bf16 v[16:19], a[24:27], v[56:59], v[16:19]
    v_mfma_f32_16x16x32_bf16 v[20:23], a[28:31], v[56:59], v[20:23]
    ds_read_b128 v[56:59], v4 offset:14336
    s_waitcnt lgkmcnt(7)
    v_mfma_f32_16x16x32_bf16 v[24:27], a[24:27], v[60:63], v[24:27]
    v_mfma_f32_16x16x32_bf16 v[28:31], a[28:31], v[60:63], v[28:31]
    ds_read_b128 v[60:63], v4 offset:14592
    s_waitcnt lgkmcnt(7)
    v_mfma_f32_16x16x32_bf16 v[16:19], a[32:35], v[32:35], v[16:19]
    v_mfma_f32_16x16x32_bf16 v[20:23], a[36:39], v[32:35], v[20:23]
    ds_read_b128 v[32:35], v4 offset:16384
    s_waitcnt lgkmcnt(7)
    v_mfma_f32_16x16x32_bf16 v[24:27], a[32:35], v[36:39], v[24:27]
    v_mfma_f32_16x16x32_bf16 v[28:31], a[36:39], v[36:39], v[28:31]
    ds_read_b128 v[36:39], v4 offset:16640
    s_waitcnt lgkmcnt(7)
    v_mfma_f32_16x16x32_bf16 v[16:19], a[40:43], v[40:43], v[16:19]
    v_mfma_f32_16x16x32_bf16 v[20:23], a[44:47], v[40:43], v[20:23]
    ds_read_b128 v[40:43], v4 offset:18432
    s_waitcnt lgkmcnt(7)
    v_mfma_f32_16x16x32_bf16 v[24:27], a[40:43], v[44:47], v[24:27]
    v_mfma_f32_16x16x32_bf16 v[28:31], a[44:47], v[44:47], v[28:31]
    ds_read_b128 v[44:47], v4 offset:18688
    s_waitcnt lgkmcnt(7)
    v_mfma_f32_16x16x32_bf16 v[16:19], a[48:51], v[48:51], v[16:19]
    v_mfma_f32_16x16x32_bf16 v[20:23], a[52:55], v[48:51], v[20:23]
    ds_read_b128 v[48:51], v4 offset:20480
    s_waitcnt lgkmcnt(7)
    v_mfma_f32_16x16x32_bf16 v[24:27], a[48:51], v[52:55], v[24:27]
    v_mfma_f32_16x16x32_bf16 v[28:31], a[52:55], v[52:55], v[28:31]
    ds_read_b128 v[52:55], v4 offset:20736
    s_waitcnt lgkmcnt(7)
    v_mfma_f32_16x16x32_bf16 v[16:19], a[56:59], v[56:59], v[16:19]
    v_mfma_f32_16x16x32_bf16 v[20:23], a[60:63], v[56:59], v[20:23]
    ds_read_b128 v[56:59], v4 offset:22528
    s_waitcnt lgkmcnt(7)
    v_mfma_f32_16x16x32_bf16 v[24:27], a[56:59], v[60:63], v[24:27]
    v_mfma_f32_16x16x32_bf16 v[28:31], a[60:63], v[60:63], v[28:31]
    ds_read_b128 v[60:63], v4 offset:22784
    s_waitcnt lgkmcnt(7)
    v_mfma_f32_16x16x32_bf16 v[16:19], a[64:67], v[32:35], v[16:19]
    v_mfma_f32_16x16x32_bf16 v[20:23], a[68:71], v[32:35], v[20:23]
    ds_read_b128 v[32:35], v4 offset:24576
    s_waitcnt lgkmcnt(7)
    v_mfma_f32_16x16x32_bf16 v[24:27], a[64:67], v[36:39], v[24:27]
    v_mfma_f32_16x16x32_bf16 v[28:31], a[68:71], v[36:39], v[28:31]
    ds_read_b128 v[36:39], v4 offset:24832
    s_waitcnt lgkmcnt(7)
    v_mfma_f32_16x16x32_bf16 v[16:19], a[72:75], v[40:43], v[16:19]
    v_mfma_f32_16x16x32_bf16 v[20:23], a[76:79], v[40:43], v[20:23]
    ds_read_b128 v[40:43], v4 offset:26624
    s_waitcnt lgkmcnt(7)
    v_mfma_f32_16x16x32_bf16 v[24:27], a[72:75], v[44:47], v[24:27]
    v_mfma_f32_16x16x32_bf16 v[28:31], a[76:79], v[44:47], v[28:31]
    ds_read_b128 v[44:47], v4 offset:26880
    s_waitcnt lgkmcnt(7)
    v_mfma_f32_16x16x32_bf16 v[16:19], a[80:83], v[48:51], v[16:19]
    v_mfma_f32_16x16x32_bf16 v[20:23], a[84:87], v[48:51], v[20:23]
    ds_read_b128 v[48:51], v4 offset:28672
    s_waitcnt lgkmcnt(7)
    v_mfma_f32_16x16x32_bf16 v[24:27], a[80:83], v[52:55], v[24:27]
    v_mfma_f32_16x16x32_bf16 v[28:31], a[84:87], v[52:55], v[28:31]
    ds_read_b128 v[52:55], v4 offset:28928
    s_waitcnt lgkmcnt(7)
    v_mfma_f32_16x16x32_bf16 v[16:19], a[88:91], v[56:59], v[16:19]
    v_mfma_f32_16x16x32_bf16 v[20:23], a[92:95], v[56:59], v[20:23]
    ds_read_b128 v[56:59], v4 offset:30720
    s_waitcnt lgkmcnt(7)
    v_mfma_f32_16x16x32_bf16 v[24:27], a[88:91], v[60:63], v[24:27]
    v_mfma_f32_16x16x32_bf16 v[28:31], a[92:95], v[60:63], v[28:31]
    ds_read_b128 v[60:63], v4 offset:30976
    s_waitcnt lgkmcnt(7)
    v_mfma_f32_16x16x32_bf16 v[16:19], a[96:99], v[32:35], v[16:19]
    v_mfma_f32_16x16x32_bf16 v[20:23], a[100:103], v[32:35], v[20:23]
    s_waitcnt lgkmcnt(6)
    v_mfma_f32_16x16x32_bf16 v[24:27], a[96:99], v[36:39], v[24:27]
    v_mfma_f32_16x16x32_bf16 v[28:31], a[100:103], v[36:39], v[28:31]
    s_waitcnt lgkmcnt(5)
    v_mfma_f32_16x16x32_bf16 v[16:19], a[104:107], v[40:43], v[16:19]
    v_mfma_f32_16x16x32_bf16 v[20:23], a[108:111], v[40:43], v[20:23]
    s_waitcnt lgkmcnt(4)
    v_mfma_f32_16x16x32_bf16 v[24:27], a[104:107], v[44:47], v[24:27]
    v_mfma_f32_16x16x32_bf16 v[28:31], a[108:111], v[44:47], v[28:31]
    s_waitcnt lgkmcnt(3)
    v_mfma_f32_16x16x32_bf16 v[16:19], a[112:115], v[48:51], v[16:19]
    v_mfma_f32_16x16x32_bf16 v[20:23], a[116:119], v[48:51], v[20:23]
    s_waitcnt lgkmcnt(2)
    v_mfma_f32_16x16x32_bf16 v[24:27], a[112:115], v[52:55], v[24:27]
    v_mfma_f32_16x16x32_bf16 v[28:31], a[116:119], v[52:55], v[28:31]
    s_waitcnt lgkmcnt(1)
    v_mfma_f32_16x16x32_bf16 v[16:19], a[120:123], v[56:59], v[16:19]
    v_mfma_f32_16x16x32_bf16 v[20:23], a[124:127], v[56:59], v[20:23]
    s_waitcnt lgkmcnt(0)
    v_mfma_f32_16x16x32_bf16 v[24:27], a[120:123], v[60:63], v[24:27]
    v_mfma_f32_16x16x32_bf16 v[28:31], a[124:127], v[60:63], v[28:31]
    v_xor_b32 v4, 0x10000, v4
    s_setprio 0
    s_waitcnt vmcnt(0)
    s_branch L_g_mm2_112_d
L_g_mm2_112:
    s_setprio 1
    s_waitcnt lgkmcnt(7)
    v_mfma_f32_16x16x32_bf16 v[16:19], a[0:3], v[32:35], 0
    v_mul_f32 v100, v100, v84
    v_mul_f32 v101, v101, v85
    v_mfma_f32_16x16x32_bf16 v[20:23], a[4:7], v[32:35], 0
    ds_read_b128 v[32:35], v4 offset:8192
    v_mul_f32 v102, v102, v86
    v_mul_f32 v103, v103, v87
    v_exp_f32 v96, v96
    s_waitcnt lgkmcnt(7)
    v_mfma_f32_16x16x32_bf16 v[24:27], a[0:3], v[36:39], 0
    v_exp_f32 v97, v97
    v_mfma_f32_16x16x32_bf16 v[28:31], a[4:7], v[36:39], 0
    ds_read_b128 v[36:39], v4 offset:8448
    v_exp_f32 v98, v98
    v_exp_f32 v99, v99
    s_waitcnt lgkmcnt(7)
    v_mfma_f32_16x16x32_bf16 v[16:19], a[8:11], v[40:43], v[16:19]
    v_exp_f32 v100, v100
    v_mfma_f32_16x16x32_bf16 v[20:23], a[12:15], v[40:43], v[20:23]
    ds_read_b128 v[40:43], v4 offset:10240
    v_exp_f32 v101, v101
    v_exp_f32 v102, v102
    s_waitcnt lgkmcnt(7)
    v_mfma_f32_16x16x32_bf16 v[24:27], a[8:11], v[44:47], v[24:27]
    v_exp_f32 v103, v103
    v_mfma_f32_16x16x32_bf16 v[28:31], a[12:15], v[44:47], v[28:31]
    ds_read_b128 v[44:47], v4 offset:10496
    v_add_f32 v96, 1.0, v96
    v_add_f32 v97, 1.0, v97
    v_add_f32 v98, 1.0, v98
    s_waitcnt lgkmcnt(7)
    v_mfma_f32_16x16x32_bf16 v[16:19], a[16:19], v[48:51], v[16:19]
    v_add_f32 v99, 1.0, v99
    v_add_f32 v100, 1.0, v100
    v_mfma_f32_16x16x32_bf16 v[20:23], a[20:23], v[48:51], v[20:23]
    ds_read_b128 v[48:51], v4 offset:12288
    v_add_f32 v101, 1.0, v101
    v_add_f32 v102, 1.0, v102
    v_add_f32 v103, 1.0, v103
    s_waitcnt lgkmcnt(7)
    v_mfma_f32_16x16x32_bf16 v[24:27], a[16:19], v[52:55], v[24:27]
    v_rcp_f32 v96, v96
    v_mfma_f32_16x16x32_bf16 v[28:31], a[20:23], v[52:55], v[28:31]
    ds_read_b128 v[52:55], v4 offset:12544
    v_rcp_f32 v97, v97
    v_rcp_f32 v98, v98
    s_waitcnt lgkmcnt(7)
    v_mfma_f32_16x16x32_bf16 v[16:19], a[24:27], v[56:59], v[16:19]
    v_rcp_f32 v99, v99
    v_mfma_f32_16x16x32_bf16 v[20:23], a[28:31], v[56:59], v[20:23]
    ds_read_b128 v[56:59], v4 offset:14336
    v_rcp_f32 v100, v100
    v_rcp_f32 v101, v101
    s_waitcnt lgkmcnt(7)
    v_mfma_f32_16x16x32_bf16 v[24:27], a[24:27], v[60:63], v[24:27]
    v_rcp_f32 v102, v102
    v_mfma_f32_16x16x32_bf16 v[28:31], a[28:31], v[60:63], v[28:31]
    ds_read_b128 v[60:63], v4 offset:14592
    v_rcp_f32 v103, v103
    v_mul_f32 v80, v80, v96
    s_waitcnt lgkmcnt(7)
    v_mfma_f32_16x16x32_bf16 v[16:19], a[32:35], v[32:35], v[16:19]
    v_mul_f32 v81, v81, v97
    v_mul_f32 v82, v82, v98
    v_mfma_f32_16x16x32_bf16 v[20:23], a[36:39], v[32:35], v[20:23]
    ds_read_b128 v[32:35], v4 offset:16384
    v_mul_f32 v83, v83, v99
    v_mul_f32 v84, v84, v100
    v_mul_f32 v85, v85, v101
    s_waitcnt lgkmcnt(7)
    v_mfma_f32_16x16x32_bf16 v[24:27], a[32:35], v[36:39], v[24:27]
    v_mul_f32 v86, v86, v102
    v_mul_f32 v87, v87, v103
    v_mfma_f32_16x16x32_bf16 v[28:31], a[36:39], v[36:39], v[28:31]
    ds_read_b128 v[36:39], v4 offset:16640
    v_cvt_pk_bf16_f32 v104, v80, v81
    v_cvt_pk_bf16_f32 v105, v82, v83
    v_cvt_pk_bf16_f32 v106, v84, v85
    s_waitcnt lgkmcnt(7)
    v_mfma_f32_16x16x32_bf16 v[16:19], a[40:43], v[40:43], v[16:19]
    v_cvt_pk_bf16_f32 v107, v86, v87
    buffer_store_dwordx4 v[104:107], v8, s[12:15], s63 offen sc1
    v_mfma_f32_16x16x32_bf16 v[20:23], a[44:47], v[40:43], v[20:23]
    ds_read_b128 v[40:43], v4 offset:18432
    v_cvt_pk_bf16_f32 v88, 0, v88
    v_cvt_pk_bf16_f32 v89, 0, v89
    v_cvt_pk_bf16_f32 v90, 0, v90
    s_waitcnt lgkmcnt(7)
    v_mfma_f32_16x16x32_bf16 v[24:27], a[40:43], v[44:47], v[24:27]
    v_cvt_pk_bf16_f32 v91, 0, v91
    v_cvt_pk_bf16_f32 v92, 0, v92
    v_mfma_f32_16x16x32_bf16 v[28:31], a[44:47], v[44:47], v[28:31]
    ds_read_b128 v[44:47], v4 offset:18688
    v_cvt_pk_bf16_f32 v93, 0, v93
    v_cvt_pk_bf16_f32 v94, 0, v94
    v_cvt_pk_bf16_f32 v95, 0, v95
    s_waitcnt lgkmcnt(7)
    v_mfma_f32_16x16x32_bf16 v[16:19], a[48:51], v[48:51], v[16:19]
    v_add_f32 v88, v88, v72
    v_add_f32 v89, v89, v73
    v_mfma_f32_16x16x32_bf16 v[20:23], a[52:55], v[48:51], v[20:23]
    ds_read_b128 v[48:51], v4 offset:20480
    v_add_f32 v90, v90, v74
    v_add_f32 v91, v91, v75
    v_add_f32 v92, v92, v76
    s_waitcnt lgkmcnt(7)
    v_mfma_f32_16x16x32_bf16 v[24:27], a[48:51], v[52:55], v[24:27]
    v_add_f32 v93, v93, v77
    v_add_f32 v94, v94, v78
    v_mfma_f32_16x16x32_bf16 v[28:31], a[52:55], v[52:55], v[28:31]
    ds_read_b128 v[52:55], v4 offset:20736
    v_add_f32 v95, v95, v79
    v_cvt_pk_bf16_f32 v88, 0, v88
    v_cvt_pk_bf16_f32 v89, 0, v89
    s_waitcnt lgkmcnt(7)
    v_mfma_f32_16x16x32_bf16 v[16:19], a[56:59], v[56:59], v[16:19]
    v_cvt_pk_bf16_f32 v90, 0, v90
    v_cvt_pk_bf16_f32 v91, 0, v91
    v_mfma_f32_16x16x32_bf16 v[20:23], a[60:63], v[56:59], v[20:23]
    ds_read_b128 v[56:59], v4 offset:22528
    v_cvt_pk_bf16_f32 v92, 0, v92
    v_cvt_pk_bf16_f32 v93, 0, v93
    v_cvt_pk_bf16_f32 v94, 0, v94
    s_waitcnt lgkmcnt(7)
    v_mfma_f32_16x16x32_bf16 v[24:27], a[56:59], v[60:63], v[24:27]
    v_cvt_pk_bf16_f32 v95, 0, v95
    v_mul_f32 v96, v88, v88
    v_mfma_f32_16x16x32_bf16 v[28:31], a[60:63], v[60:63], v[28:31]
    ds_read_b128 v[60:63], v4 offset:22784
    v_mul_f32 v97, v89, v89
    v_mul_f32 v98, v90, v90
    v_mul_f32 v99, v91, v91
    s_waitcnt lgkmcnt(7)
    v_mfma_f32_16x16x32_bf16 v[16:19], a[64:67], v[32:35], v[16:19]
    v_mul_f32 v100, v92, v92
    v_mul_f32 v101, v93, v93
    v_mfma_f32_16x16x32_bf16 v[20:23], a[68:71], v[32:35], v[20:23]
    ds_read_b128 v[32:35], v4 offset:24576
    v_mul_f32 v102, v94, v94
    v_mul_f32 v103, v95, v95
    v_fma_f32 v96, v96, s56, v112
    s_waitcnt lgkmcnt(7)
    v_mfma_f32_16x16x32_bf16 v[24:27], a[64:67], v[36:39], v[24:27]
    v_fma_f32 v97, v97, s56, v112
    v_fma_f32 v98, v98, s56, v112
    v_mfma_f32_16x16x32_bf16 v[28:31], a[68:71], v[36:39], v[28:31]
    ds_read_b128 v[36:39], v4 offset:24832
    v_fma_f32 v99, v99, s56, v112
    v_fma_f32 v100, v100, s56, v112
    v_fma_f32 v101, v101, s56, v112
    s_waitcnt lgkmcnt(7)
    v_mfma_f32_16x16x32_bf16 v[16:19], a[72:75], v[40:43], v[16:19]
    v_fma_f32 v102, v102, s56, v112
    v_fma_f32 v103, v103, s56, v112
    v_mfma_f32_16x16x32_bf16 v[20:23], a[76:79], v[40:43], v[20:23]
    ds_read_b128 v[40:43], v4 offset:26624
    v_mul_f32 v96, v96, v88
    v_mul_f32 v97, v97, v89
    v_mul_f32 v98, v98, v90
    s_waitcnt lgkmcnt(7)
    v_mfma_f32_16x16x32_bf16 v[24:27], a[72:75], v[44:47], v[24:27]
    v_mul_f32 v99, v99, v91
    v_mul_f32 v100, v100, v92
    v_mfma_f32_16x16x32_bf16 v[28:31], a[76:79], v[44:47], v[28:31]
    ds_read_b128 v[44:47], v4 offset:26880
    v_mul_f32 v101, v101, v93
    v_mul_f32 v102, v102, v94
    v_mul_f32 v103, v103, v95
    s_waitcnt lgkmcnt(7)
    v_mfma_f32_16x16x32_bf16 v[16:19], a[80:83], v[48:51], v[16:19]
    v_exp_f32 v96, v96
    v_mfma_f32_16x16x32_bf16 v[20:23], a[84:87], v[48:51], v[20:23]
    ds_read_b128 v[48:51], v4 offset:28672
    v_exp_f32 v97, v97
    v_exp_f32 v98, v98
    s_waitcnt lgkmcnt(7)
    v_mfma_f32_16x16x32_bf16 v[24:27], a[80:83], v[52:55], v[24:27]
    v_exp_f32 v99, v99
    v_mfma_f32_16x16x32_bf16 v[28:31], a[84:87], v[52:55], v[28:31]
    ds_read_b128 v[52:55], v4 offset:28928
    v_exp_f32 v100, v100
    v_exp_f32 v101, v101
    s_waitcnt lgkmcnt(7)
    v_mfma_f32_16x16x32_bf16 v[16:19], a[88:91], v[56:59], v[16:19]
    v_exp_f32 v102, v102
    v_mfma_f32_16x16x32_bf16 v[20:23], a[92:95], v[56:59], v[20:23]
    ds_read_b128 v[56:59], v4 offset:30720
    v_exp_f32 v103, v103
    v_add_f32 v96, 1.0, v96
    s_waitcnt lgkmcnt(7)
    v_mfma_f32_16x16x32_bf16 v[24:27], a[88:91], v[60:63], v[24:27]
    v_add_f32 v97, 1.0, v97
    v_add_f32 v98, 1.0, v98
    v_mfma_f32_16x16x32_bf16 v[28:31], a[92:95], v[60:63], v[28:31]
    ds_read_b128 v[60:63], v4 offset:30976
    v_add_f32 v99, 1.0, v99
    v_add_f32 v100, 1.0, v100
    v_add_f32 v101, 1.0, v101
    s_waitcnt lgkmcnt(7)
    v_mfma_f32_16x16x32_bf16 v[16:19], a[96:99], v[32:35], v[16:19]
    v_add_f32 v102, 1.0, v102
    v_add_f32 v103, 1.0, v103
    v_mfma_f32_16x16x32_bf16 v[20:23], a[100:103], v[32:35], v[20:23]
    v_rcp_f32 v96, v96
    v_rcp_f32 v97, v97
    s_waitcnt lgkmcnt(6)
    v_mfma_f32_16x16x32_bf16 v[24:27], a[96:99], v[36:39], v[24:27]
    v_rcp_f32 v98, v98
    v_mfma_f32_16x16x32_bf16 v[28:31], a[100:103], v[36:39], v[28:31]
    v_rcp_f32 v99, v99
    v_rcp_f32 v100, v100
    s_waitcnt lgkmcnt(5)
    v_mfma_f32_16x16x32_bf16 v[16:19], a[104:107], v[40:43], v[16:19]
    v_rcp_f32 v101, v101
    v_mfma_f32_16x16x32_bf16 v[20:23], a[108:111], v[40:43], v[20:23]
    v_rcp_f32 v102, v102
    v_rcp_f32 v103, v103
    s_waitcnt lgkmcnt(4)
    v_mfma_f32_16x16x32_bf16 v[24:27], a[104:107], v[44:47], v[24:27]
    v_mul_f32 v88, v88, v96
    v_mul_f32 v89, v89, v97
    v_mfma_f32_16x16x32_bf16 v[28:31], a[108:111], v[44:47], v[28:31]
    v_mul_f32 v90, v90, v98
    v_mul_f32 v91, v91, v99
    v_mul_f32 v92, v92, v100
    s_waitcnt lgkmcnt(3)
    v_mfma_f32_16x16x32_bf16 v[16:19], a[112:115], v[48:51], v[16:19]
    v_mul_f32 v93, v93, v101
    v_mul_f32 v94, v94, v102
    v_mfma_f32_16x16x32_bf16 v[20:23], a[116:119], v[48:51], v[20:23]
    v_mul_f32 v95, v95, v103
    v_cvt_pk_bf16_f32 v108, v88, v89
    v_cvt_pk_bf16_f32 v109, v90, v91
    s_waitcnt lgkmcnt(2)
    v_mfma_f32_16x16x32_bf16 v[24:27], a[112:115], v[52:55], v[24:27]
    v_cvt_pk_bf16_f32 v110, v92, v93
    v_cvt_pk_bf16_f32 v111, v94, v95
    v_mfma_f32_16x16x32_bf16 v[28:31], a[116:119], v[52:55], v[28:31]
    buffer_store_dwordx4 v[108:111], v9, s[12:15], s63 offen sc1
    s_add_u32 s63, s63, 229376
    s_waitcnt lgkmcnt(1)
    v_mfma_f32_16x16x32_bf16 v[16:19], a[120:123], v[56:59], v[16:19]
    v_mfma_f32_16x16x32_bf16 v[20:23], a[124:127], v[56:59], v[20:23]
    s_waitcnt lgkmcnt(0)
    v_mfma_f32_16x16x32_bf16 v[24:27], a[120:123], v[60:63], v[24:27]
    v_mfma_f32_16x16x32_bf16 v[28:31], a[124:127], v[60:63], v[28:31]
    v_xor_b32 v4, 0x10000, v4
    s_setprio 0
    s_waitcnt vmcnt(2)
L_g_mm2_112_d:
    s_lshl_b32 s67, s67, 1
    s_or_b32 s67, s67, 1
    s_add_u32 s60, s60, 1
    s_cmp_gt_u32 s66, s60
    s_cbranch_scc1 L_g_loop1_92
    s_barrier
    ds_read_b32 v14, v15
    s_waitcnt lgkmcnt(0)
    v_readfirstlane_b32 s66, v14
    s_barrier
    s_mov_b32 s69, 0
    s_cmp_gt_u32 s62, s60
    s_cbranch_scc1 L_g_nd_117
    s_cmp_ge_u32 s62, s66
    s_cbranch_scc1 L_g_nd_117
    s_add_u32 s47, s61, 4096
    s_add_u32 m0, s64, 0
    s_nop 0
    buffer_load_dwordx4 v3, s[12:15], s61 offen offset:0 sc1 lds
    buffer_load_dwordx4 v3, s[12:15], s61 offen offset:1024 sc1 lds
    buffer_load_dwordx4 v3, s[12:15], s61 offen offset:2048 sc1 lds
    buffer_load_dwordx4 v3, s[12:15], s61 offen offset:3072 sc1 lds
    s_add_u32 m0, s64, 4096
    s_nop 0
    buffer_load_dwordx4 v3, s[12:15], s47 offen offset:0 sc1 lds
    buffer_load_dwordx4 v3, s[12:15], s47 offen offset:1024 sc1 lds
    buffer_load_dwordx4 v3, s[12:15], s47 offen offset:2048 sc1 lds
    buffer_load_dwordx4 v3, s[12:15], s47 offen offset:3072 sc1 lds
    s_add_u32 s61, s61, 65536
    s_add_u32 s62, s62, 1
    s_xor_b32 s64, s64, 0x10000
    s_mov_b32 s69, 1
L_g_nd_117:
    s_sub_u32 s59, s60, 1
    ds_read_b128 v[80:83], v5 offset:0
    ds_read_b128 v[84:87], v5 offset:1024
    ds_read_b128 v[88:91], v5 offset:2048
    ds_read_b128 v[92:95], v5 offset:3072
    s_nop 7
    s_waitcnt lgkmcnt(3)
    v_add_f32 v80, v80, v16
    v_add_f32 v81, v81, v17
    v_add_f32 v82, v82, v18
    v_add_f32 v83, v83, v19
    s_waitcnt lgkmcnt(2)
    v_add_f32 v84, v84, v20
    v_add_f32 v85, v85, v21
    v_add_f32 v86, v86, v22
    v_add_f32 v87, v87, v23
    s_waitcnt lgkmcnt(1)
    v_add_f32 v88, v88, v24
    v_add_f32 v89, v89, v25
    v_add_f32 v90, v90, v26
    v_add_f32 v91, v91, v27
    s_waitcnt lgkmcnt(0)
    v_add_f32 v92, v92, v28
    v_add_f32 v93, v93, v29
    v_add_f32 v94, v94, v30
    v_add_f32 v95, v95, v31
    v_cvt_pk_bf16_f32 v80, 0, v80
    v_cvt_pk_bf16_f32 v81, 0, v81
    v_cvt_pk_bf16_f32 v82, 0, v82
    v_cvt_pk_bf16_f32 v83, 0, v83
    v_cvt_pk_bf16_f32 v84, 0, v84
    v_cvt_pk_bf16_f32 v85, 0, v85
    v_cvt_pk_bf16_f32 v86, 0, v86
    v_cvt_pk_bf16_f32 v87, 0, v87
    v_add_f32 v80, v80, v64
    v_add_f32 v81, v81, v65
    v_add_f32 v82, v82, v66
    v_add_f32 v83, v83, v67
    v_add_f32 v84, v84, v68
    v_add_f32 v85, v85, v69
    v_add_f32 v86, v86, v70
    v_add_f32 v87, v87, v71
    v_cvt_pk_bf16_f32 v80, 0, v80
    v_cvt_pk_bf16_f32 v81, 0, v81
    v_cvt_pk_bf16_f32 v82, 0, v82
    v_cvt_pk_bf16_f32 v83, 0, v83
    v_cvt_pk_bf16_f32 v84, 0, v84
    v_cvt_pk_bf16_f32 v85, 0, v85
    v_cvt_pk_bf16_f32 v86, 0, v86
    v_cvt_pk_bf16_f32 v87, 0, v87
    v_mul_f32 v96, v80, v80
    v_mul_f32 v97, v81, v81
    v_mul_f32 v98, v82, v82
    v_mul_f32 v99, v83, v83
    v_mul_f32 v100, v84, v84
    v_mul_f32 v101, v85, v85
    v_mul_f32 v102, v86, v86
    v_mul_f32 v103, v87, v87
    v_fma_f32 v96, v96, s56, v112
    v_fma_f32 v97, v97, s56, v112
    v_fma_f32 v98, v98, s56, v112
    v_fma_f32 v99, v99, s56, v112
    v_fma_f32 v100, v100, s56, v112
    v_fma_f32 v101, v101, s56, v112
    v_fma_f32 v102, v102, s56, v112
    v_fma_f32 v103, v103, s56, v112
    v_mul_f32 v96, v96, v80
    v_mul_f32 v97, v97, v81
    v_mul_f32 v98, v98, v82
    v_mul_f32 v99, v99, v83
    v_mul_f32 v100, v100, v84
    v_mul_f32 v101, v101, v85
    v_mul_f32 v102, v102, v86
    v_mul_f32 v103, v103, v87
    v_exp_f32 v96, v96
    v_exp_f32 v97, v97
    v_exp_f32 v98, v98
    v_exp_f32 v99, v99
    v_exp_f32 v100, v100
    v_exp_f32 v101, v101
    v_exp_f32 v102, v102
    v_exp_f32 v103, v103
    v_add_f32 v96, 1.0, v96
    v_add_f32 v97, 1.0, v97
    v_add_f32 v98, 1.0, v98
    v_add_f32 v99, 1.0, v99
    v_add_f32 v100, 1.0, v100
    v_add_f32 v101, 1.0, v101
    v_add_f32 v102, 1.0, v102
    v_add_f32 v103, 1.0, v103
    v_rcp_f32 v96, v96
    v_rcp_f32 v97, v97
    v_rcp_f32 v98, v98
    v_rcp_f32 v99, v99
    v_rcp_f32 v100, v100
    v_rcp_f32 v101, v101
    v_rcp_f32 v102, v102
    v_rcp_f32 v103, v103
    v_mul_f32 v80, v80, v96
    v_mul_f32 v81, v81, v97
    v_mul_f32 v82, v82, v98
    v_mul_f32 v83, v83, v99
    v_mul_f32 v84, v84, v100
    v_mul_f32 v85, v85, v101
    v_mul_f32 v86, v86, v102
    v_mul_f32 v87, v87, v103
    v_cvt_pk_bf16_f32 v104, v80, v81
    v_cvt_pk_bf16_f32 v105, v82, v83
    v_cvt_pk_bf16_f32 v106, v84, v85
    v_cvt_pk_bf16_f32 v107, v86, v87
    buffer_store_dwordx4 v[104:107], v8, s[12:15], s63 offen sc1
    v_cvt_pk_bf16_f32 v88, 0, v88
    v_cvt_pk_bf16_f32 v89, 0, v89
    v_cvt_pk_bf16_f32 v90, 0, v90
    v_cvt_pk_bf16_f32 v91, 0, v91
    v_cvt_pk_bf16_f32 v92, 0, v92
    v_cvt_pk_bf16_f32 v93, 0, v93
    v_cvt_pk_bf16_f32 v94, 0, v94
    v_cvt_pk_bf16_f32 v95, 0, v95
    v_add_f32 v88, v88, v72
    v_add_f32 v89, v89, v73
    v_add_f32 v90, v90, v74
    v_add_f32 v91, v91, v75
    v_add_f32 v92, v92, v76
    v_add_f32 v93, v93, v77
    v_add_f32 v94, v94, v78
    v_add_f32 v95, v95, v79
    v_cvt_pk_bf16_f32 v88, 0, v88
    v_cvt_pk_bf16_f32 v89, 0, v89
    v_cvt_pk_bf16_f32 v90, 0, v90
    v_cvt_pk_bf16_f32 v91, 0, v91
    v_cvt_pk_bf16_f32 v92, 0, v92
    v_cvt_pk_bf16_f32 v93, 0, v93
    v_cvt_pk_bf16_f32 v94, 0, v94
    v_cvt_pk_bf16_f32 v95, 0, v95
    v_mul_f32 v96, v88, v88
    v_mul_f32 v97, v89, v89
    v_mul_f32 v98, v90, v90
    v_mul_f32 v99, v91, v91
    v_mul_f32 v100, v92, v92
    v_mul_f32 v101, v93, v93
    v_mul_f32 v102, v94, v94
    v_mul_f32 v103, v95, v95
    v_fma_f32 v96, v96, s56, v112
    v_fma_f32 v97, v97, s56, v112
    v_fma_f32 v98, v98, s56, v112
    v_fma_f32 v99, v99, s56, v112
    v_fma_f32 v100, v100, s56, v112
    v_fma_f32 v101, v101, s56, v112
    v_fma_f32 v102, v102, s56, v112
    v_fma_f32 v103, v103, s56, v112
    v_mul_f32 v96, v96, v88
    v_mul_f32 v97, v97, v89
    v_mul_f32 v98, v98, v90
    v_mul_f32 v99, v99, v91
    v_mul_f32 v100, v100, v92
    v_mul_f32 v101, v101, v93
    v_mul_f32 v102, v102, v94
    v_mul_f32 v103, v103, v95
    v_exp_f32 v96, v96
    v_exp_f32 v97, v97
    v_exp_f32 v98, v98
    v_exp_f32 v99, v99
    v_exp_f32 v100, v100
    v_exp_f32 v101, v101
    v_exp_f32 v102, v102
    v_exp_f32 v103, v103
    v_add_f32 v96, 1.0, v96
    v_add_f32 v97, 1.0, v97
    v_add_f32 v98, 1.0, v98
    v_add_f32 v99, 1.0, v99
    v_add_f32 v100, 1.0, v100
    v_add_f32 v101, 1.0, v101
    v_add_f32 v102, 1.0, v102
    v_add_f32 v103, 1.0, v103
    v_rcp_f32 v96, v96
    v_rcp_f32 v97, v97
    v_rcp_f32 v98, v98
    v_rcp_f32 v99, v99
    v_rcp_f32 v100, v100
    v_rcp_f32 v101, v101
    v_rcp_f32 v102, v102
    v_rcp_f32 v103, v103
    v_mul_f32 v88, v88, v96
    v_mul_f32 v89, v89, v97
    v_mul_f32 v90, v90, v98
    v_mul_f32 v91, v91, v99
    v_mul_f32 v92, v92, v100
    v_mul_f32 v93, v93, v101
    v_mul_f32 v94, v94, v102
    v_mul_f32 v95, v95, v103
    v_cvt_pk_bf16_f32 v108, v88, v89
    v_cvt_pk_bf16_f32 v109, v90, v91
    v_cvt_pk_bf16_f32 v110, v92, v93
    v_cvt_pk_bf16_f32 v111, v94, v95
    buffer_store_dwordx4 v[108:111], v9, s[12:15], s63 offen sc1
    s_add_u32 s63, s63, 229376
    v_mov_b32 v10, 1
    s_mov_b64 exec, 1
    s_waitcnt vmcnt(0)
    ds_add_rtn_u32 v10, v15, v10 offset:4
    s_waitcnt lgkmcnt(0)
    v_readfirstlane_b32 s46, v10
    s_mov_b64 exec, -1
    s_mov_b32 s67, 0
    s_nop 1
    s_cmp_lg_u32 s46, s68
    s_cbranch_scc1 L_g_g1f_94
    v_mov_b32 v10, s59
    v_add_u32 v10, 1, v10
    v_mov_b32 v11, 0
    s_mov_b64 exec, 1
    buffer_store_dword v10, v11, s[12:15], s52 offen sc1
    s_mov_b64 exec, -1
L_sf_118:
L_g_g1f_94:
    s_add_u32 s68, s68, 4
    s_cmp_gt_u32 s66, s60
    s_cbranch_scc1 L_g_g1r_90
L_g_tail_93:
    s_cmp_lt_u32 s60, 64
    s_cbranch_scc1 L_g_restart_88
    s_barrier
    s_branch L_c_done_1
L_w_f2_11:
    s_load_dwordx2 s[4:5], s[0:1], 80
    s_load_dwordx2 s[6:7], s[0:1], 72
    s_and_b32 s50, s44, 3
    s_lshr_b32 s51, s44, 2
    s_waitcnt lgkmcnt(0)
    s_mov_b32 s24, s4
    s_and_b32 s25, s5, 0xffff
    s_mov_b32 s26, 0x700000
    s_mov_b32 s27, 0x00020000
    v_lshrrev_b32 v3, 4, v1
    v_and_b32 v4, 15, v1
    v_lshlrev_b32 v5, 2, v3
    v_xor_b32 v4, v4, v5
    v_mul_u32_u24 v3, 2048, v3
    v_lshl_add_u32 v3, v4, 4, v3
    s_mul_i32 s46, s51, 448
    s_mul_i32 s47, s50, 56
    s_add_u32 s46, s46, s47
    s_mul_i32 s47, s42, 896
    s_add_u32 s46, s46, s47
    s_mul_i32 s46, s46, 2048
    s_lshl_b32 s47, s43, 8
    s_add_u32 s46, s46, s47
    s_lshl_b32 s45, s51, 16
    s_mul_i32 s47, s50, 14336
    s_add_u32 s45, s45, s47
    v_bfe_u32 v4, v1, 2, 2
    v_bfe_u32 v5, v1, 4, 1
    v_lshlrev_b32 v5, 1, v5
    v_bfe_u32 v6, v1, 1, 1
    v_add_u32 v5, v5, v6
    s_lshl_b32 s47, s50, 2
    v_add_u32 v5, s47, v5
    v_lshlrev_b32 v6, 2, v4
    v_xor_b32 v5, v5, v6
    v_lshlrev_b32 v5, 4, v5
    v_lshl_add_u32 v5, v4, 8, v5
    v_bfe_u32 v6, v1, 0, 1
    v_lshl_add_u32 v5, v6, 3, v5
    v_lshrrev_b32 v6, 5, v1
    v_mul_u32_u24 v6, 1024, v6
    v_add_u32 v5, v5, v6
    s_lshl_b32 s47, s51, 16
    v_add_u32 v5, s47, v5
    v_bfe_u32 v4, v1, 2, 2
    v_xor_b32 v5, s50, v4
    v_lshlrev_b32 v5, 6, v5
    v_lshl_add_u32 v5, v4, 8, v5
    v_and_b32 v6, 3, v1
    v_lshl_add_u32 v5, v6, 3, v5
    v_lshrrev_b32 v6, 4, v1
    v_lshl_add_u32 v5, v6, 10, v5
    s_lshl_b32 s47, s51, 16
    v_add_u32 v5, s47, v5
    s_add_u32 m0, s45, 0
    s_add_u32 s47, s46, 0x0
    buffer_load_dwordx4 v3, s[24:27], s47 offen lds
    s_add_u32 m0, s45, 1024
    s_add_u32 s47, s46, 0x2000
    buffer_load_dwordx4 v3, s[24:27], s47 offen lds
    s_add_u32 m0, s45, 2048
    s_add_u32 s47, s46, 0x4000
    buffer_load_dwordx4 v3, s[24:27], s47 offen lds
    s_add_u32 m0, s45, 3072
    s_add_u32 s47, s46, 0x6000
    buffer_load_dwordx4 v3, s[24:27], s47 offen lds
    s_add_u32 m0, s45, 4096
    s_add_u32 s47, s46, 0x8000
    buffer_load_dwordx4 v3, s[24:27], s47 offen lds
    s_add_u32 m0, s45, 5120
    s_add_u32 s47, s46, 0xa000
    buffer_load_dwordx4 v3, s[24:27], s47 offen lds
    s_add_u32 m0, s45, 6144
    s_add_u32 s47, s46, 0xc000
    buffer_load_dwordx4 v3, s[24:27], s47 offen lds
    s_add_u32 m0, s45, 7168
    s_add_u32 s47, s46, 0xe000
    buffer_load_dwordx4 v3, s[24:27], s47 offen lds
    s_add_u32 m0, s45, 8192
    s_add_u32 s47, s46, 0x10000
    buffer_load_dwordx4 v3, s[24:27], s47 offen lds
    s_add_u32 m0, s45, 9216
    s_add_u32 s47, s46, 0x12000
    buffer_load_dwordx4 v3, s[24:27], s47 offen lds
    s_add_u32 m0, s45, 10240
    s_add_u32 s47, s46, 0x14000
    buffer_load_dwordx4 v3, s[24:27], s47 offen lds
    s_add_u32 m0, s45, 11264
    s_add_u32 s47, s46, 0x16000
    buffer_load_dwordx4 v3, s[24:27], s47 offen lds
    s_add_u32 m0, s45, 12288
    s_add_u32 s47, s46, 0x18000
    buffer_load_dwordx4 v3, s[24:27], s47 offen lds
    s_add_u32 m0, s45, 13312
    s_add_u32 s47, s46, 0x1a000
    buffer_load_dwordx4 v3, s[24:27], s47 offen lds
    s_waitcnt vmcnt(0)
    s_barrier
    ds_read_b64_tr_b16 a[0:1], v5 offset:0
    ds_read_b64_tr_b16 a[2:3], v5 offset:4096
    ds_read_b64_tr_b16 a[4:5], v5 offset:32
    ds_read_b64_tr_b16 a[6:7], v5 offset:4128
    ds_read_b64_tr_b16 a[8:9], v5 offset:8192
    ds_read_b64_tr_b16 a[10:11], v5 offset:12288
    ds_read_b64_tr_b16 a[12:13], v5 offset:8224
    ds_read_b64_tr_b16 a[14:15], v5 offset:12320
    s_waitcnt lgkmcnt(0)
    ds_read_b64_tr_b16 a[16:17], v5 offset:16384
    ds_read_b64_tr_b16 a[18:19], v5 offset:20480
    ds_read_b64_tr_b16 a[20:21], v5 offset:16416
    ds_read_b64_tr_b16 a[22:23], v5 offset:20512
    ds_read_b64_tr_b16 a[24:25], v5 offset:24576
    ds_read_b64_tr_b16 a[26:27], v5 offset:28672
    ds_read_b64_tr_b16 a[28:29], v5 offset:24608
    ds_read_b64_tr_b16 a[30:31], v5 offset:28704
    s_waitcnt lgkmcnt(0)
    ds_read_b64_tr_b16 a[32:33], v5 offset:32768
    ds_read_b64_tr_b16 a[34:35], v5 offset:36864
    ds_read_b64_tr_b16 a[36:37], v5 offset:32800
    ds_read_b64_tr_b16 a[38:39], v5 offset:36896
    ds_read_b64_tr_b16 a[40:41], v5 offset:40960
    ds_read_b64_tr_b16 a[42:43], v5 offset:45056
    ds_read_b64_tr_b16 a[44:45], v5 offset:40992
    ds_read_b64_tr_b16 a[46:47], v5 offset:45088
    s_waitcnt lgkmcnt(0)
    ds_read_b64_tr_b16 a[48:49], v5 offset:49152
    ds_read_b64_tr_b16 a[50:51], v5 offset:53248
    ds_read_b64_tr_b16 a[52:53], v5 offset:49184
    ds_read_b64_tr_b16 a[54:55], v5 offset:53280
    s_waitcnt lgkmcnt(0)
    s_barrier
    s_add_u32 m0, s45, 0
    s_add_u32 s47, s46, 0x70000
    buffer_load_dwordx4 v3, s[24:27], s47 offen lds
    s_add_u32 m0, s45, 1024
    s_add_u32 s47, s46, 0x72000
    buffer_load_dwordx4 v3, s[24:27], s47 offen lds
    s_add_u32 m0, s45, 2048
    s_add_u32 s47, s46, 0x74000
    buffer_load_dwordx4 v3, s[24:27], s47 offen lds
    s_add_u32 m0, s45, 3072
    s_add_u32 s47, s46, 0x76000
    buffer_load_dwordx4 v3, s[24:27], s47 offen lds
    s_add_u32 m0, s45, 4096
    s_add_u32 s47, s46, 0x78000
    buffer_load_dwordx4 v3, s[24:27], s47 offen lds
    s_add_u32 m0, s45, 5120
    s_add_u32 s47, s46, 0x7a000
    buffer_load_dwordx4 v3, s[24:27], s47 offen lds
    s_add_u32 m0, s45, 6144
    s_add_u32 s47, s46, 0x7c000
    buffer_load_dwordx4 v3, s[24:27], s47 offen lds
    s_add_u32 m0, s45, 7168
    s_add_u32 s47, s46, 0x7e000
    buffer_load_dwordx4 v3, s[24:27], s47 offen lds
    s_add_u32 m0, s45, 8192
    s_add_u32 s47, s46, 0x80000
    buffer_load_dwordx4 v3, s[24:27], s47 offen lds
    s_add_u32 m0, s45, 9216
    s_add_u32 s47, s46, 0x82000
    buffer_load_dwordx4 v3, s[24:27], s47 offen lds
    s_add_u32 m0, s45, 10240
    s_add_u32 s47, s46, 0x84000
    buffer_load_dwordx4 v3, s[24:27], s47 offen lds
    s_add_u32 m0, s45, 11264
    s_add_u32 s47, s46, 0x86000
    buffer_load_dwordx4 v3, s[24:27], s47 offen lds
    s_add_u32 m0, s45, 12288
    s_add_u32 s47, s46, 0x88000
    buffer_load_dwordx4 v3, s[24:27], s47 offen lds
    s_add_u32 m0, s45, 13312
    s_add_u32 s47, s46, 0x8a000
    buffer_load_dwordx4 v3, s[24:27], s47 offen lds
    s_waitcnt vmcnt(0)
    s_barrier
    ds_read_b64_tr_b16 a[56:57], v5 offset:0
    ds_read_b64_tr_b16 a[58:59], v5 offset:4096
    ds_read_b64_tr_b16 a[60:61], v5 offset:32
    ds_read_b64_tr_b16 a[62:63], v5 offset:4128
    ds_read_b64_tr_b16 a[64:65], v5 offset:8192
    ds_read_b64_tr_b16 a[66:67], v5 offset:12288
    ds_read_b64_tr_b16 a[68:69], v5 offset:8224
    ds_read_b64_tr_b16 a[70:71], v5 offset:12320
    s_waitcnt lgkmcnt(0)
    ds_read_b64_tr_b16 a[72:73], v5 offset:16384
    ds_read_b64_tr_b16 a[74:75], v5 offset:20480
    ds_read_b64_tr_b16 a[76:77], v5 offset:16416
    ds_read_b64_tr_b16 a[78:79], v5 offset:20512
    ds_read_b64_tr_b16 a[80:81], v5 offset:24576
    ds_read_b64_tr_b16 a[82:83], v5 offset:28672
    ds_read_b64_tr_b16 a[84:85], v5 offset:24608
    ds_read_b64_tr_b16 a[86:87], v5 offset:28704
    s_waitcnt lgkmcnt(0)
    ds_read_b64_tr_b16 a[88:89], v5 offset:32768
    ds_read_b64_tr_b16 a[90:91], v5 offset:36864
    ds_read_b64_tr_b16 a[92:93], v5 offset:32800
    ds_read_b64_tr_b16 a[94:95], v5 offset:36896
    ds_read_b64_tr_b16 a[96:97], v5 offset:40960
    ds_read_b64_tr_b16 a[98:99], v5 offset:45056
    ds_read_b64_tr_b16 a[100:101], v5 offset:40992
    ds_read_b64_tr_b16 a[102:103], v5 offset:45088
    s_waitcnt lgkmcnt(0)
    ds_read_b64_tr_b16 a[104:105], v5 offset:49152
    ds_read_b64_tr_b16 a[106:107], v5 offset:53248
    ds_read_b64_tr_b16 a[108:109], v5 offset:49184
    ds_read_b64_tr_b16 a[110:111], v5 offset:53280
    s_waitcnt lgkmcnt(0)
    s_barrier
    v_lshlrev_b32 v2, 4, v1
    s_mul_i32 s64, s44, 7168
    s_add_u32 s46, s64, 0x6000000
    s_mul_i32 s47, s42, 57344
    s_add_u32 s46, s46, s47
    v_add_u32 v3, s46, v2
    s_mul_i32 s46, s51, 28672
    v_add_u32 v4, s46, v2
    v_and_b32 v6, 15, v1
    v_lshlrev_b32 v6, 4, v6
    v_lshrrev_b32 v7, 4, v1
    v_lshl_add_u32 v6, v7, 9, v6
    v_add_u32 v4, s46, v6
    s_lshl_b32 s46, s50, 12
    s_add_u32 s46, s46, 131072
    v_add_u32 v5, s46, v2
    v_min_u32 v7, 6, v1
    v_lshlrev_b32 v7, 7, v7
    s_mul_i32 s46, s42, 896
    s_add_u32 s46, s46, 0x106400
    v_add_u32 v7, s46, v7
    s_lshl_b32 s46, s42, 16
    s_lshl_b32 s47, s43, 11
    s_add_u32 s46, s46, s47
    s_lshl_b32 s47, s50, 9
    s_add_u32 s46, s46, s47
    s_add_u32 s46, s46, 0xb000000
    v_and_b32 v8, 31, v1
    v_lshlrev_b32 v8, 4, v8
    v_lshrrev_b32 v9, 5, v1
    v_lshl_add_u32 v8, v9, 14, v8
    v_add_u32 v8, s46, v8
    v_add_u32 v9, 0x8000, v8
    s_lshl_b32 s52, s43, 9
    s_lshl_b32 s47, s42, 7
    s_add_u32 s52, s52, s47
    s_add_u32 s52, s52, 0x108400
    s_mov_b32 s60, 0
    s_mov_b32 s61, 0
    s_mov_b32 s62, 0
    s_mov_b32 s63, 0
    s_mov_b32 s67, 0
    s_mov_b32 s68, 3
    v_mov_b32 v15, 147456
    v_mov_b32 v14, 0
    ds_write_b32 v15, v14 offset:4
L_g_restart_119:
    s_cmp_lg_u32 s44, 0
    s_cbranch_scc1 L_g_nsp_120
    s_mov_b32 s70, 0
L_g_sp_126:
    s_add_u32 s54, s60, 0
    s_add_u32 s55, s54, 0
    s_mov_b32 s46, 0
    buffer_load_dword v11, v7, s[12:15], s46 offen sc1
    s_waitcnt vmcnt(0)
    v_cmp_ge_u32 vcc, s60, v11
    s_add_u32 s70, s70, 1
    s_cbranch_vccz L_g_sp_126_ok
    s_sleep 8
    s_cmp_lt_u32 s70, 524288
    s_cbranch_scc1 L_g_sp_126
    s_branch L_c_done_1
L_g_sp_126_ok:
    s_mov_b32 s46, s54
    v_cmp_ge_u32 vcc, s46, v11
    s_nop 0
    s_cbranch_vccnz L_g_le_127
    s_add_u32 s46, s46, 1
    v_cmp_ge_u32 vcc, s46, v11
    s_nop 0
    s_cbranch_vccnz L_g_le_127
    s_add_u32 s46, s46, 1
    v_cmp_ge_u32 vcc, s46, v11
    s_nop 0
    s_cbranch_vccnz L_g_le_127
    s_add_u32 s46, s46, 1
L_g_le_127:
    v_mov_b32 v11, s46
    ds_write_b32 v15, v11
L_g_nsp_120:
    s_waitcnt lgkmcnt(0)
    s_barrier
    ds_read_b32 v14, v15
    s_waitcnt lgkmcnt(0)
    v_readfirstlane_b32 s66, v14
    s_nop 3
L_g_restart_119_go:
    s_mov_b32 s69, 0
    s_cmp_gt_u32 s62, s60
    s_cbranch_scc1 L_g_nd_128
    s_cmp_ge_u32 s62, s66
    s_cbranch_scc1 L_g_nd_128
    s_add_u32 s47, s61, 4096
    s_add_u32 m0, s64, 0
    s_nop 0
    buffer_load_dwordx4 v3, s[12:15], s61 offen offset:0 sc1 lds
    buffer_load_dwordx4 v3, s[12:15], s61 offen offset:1024 sc1 lds
    buffer_load_dwordx4 v3, s[12:15], s61 offen offset:2048 sc1 lds
    buffer_load_dwordx4 v3, s[12:15], s61 offen offset:3072 sc1 lds
    s_add_u32 m0, s64, 4096
    s_nop 0
    buffer_load_dwordx4 v3, s[12:15], s47 offen offset:0 sc1 lds
    buffer_load_dwordx4 v3, s[12:15], s47 offen offset:1024 sc1 lds
    buffer_load_dwordx4 v3, s[12:15], s47 offen offset:2048 sc1 lds
    s_add_u32 s61, s61, 229376
    s_add_u32 s62, s62, 1
    s_xor_b32 s64, s64, 0x10000
    s_mov_b32 s69, 1
L_g_nd_128:
    s_cmp_eq_u32 s51, 1
    s_cbranch_scc1 L_g_g1r_121
    s_add_u32 s59, s60, 1
    s_mov_b32 s69, 0
    s_cmp_gt_u32 s62, s59
    s_cbranch_scc1 L_g_nd_129
    s_cmp_ge_u32 s62, s66
    s_cbranch_scc1 L_g_nd_129
    s_add_u32 s47, s61, 4096
    s_add_u32 m0, s64, 0
    s_nop 0
    buffer_load_dwordx4 v3, s[12:15], s61 offen offset:0 sc1 lds
    buffer_load_dwordx4 v3, s[12:15], s61 offen offset:1024 sc1 lds
    buffer_load_dwordx4 v3, s[12:15], s61 offen offset:2048 sc1 lds
    buffer_load_dwordx4 v3, s[12:15], s61 offen offset:3072 sc1 lds
    s_add_u32 m0, s64, 4096
    s_nop 0
    buffer_load_dwordx4 v3, s[12:15], s47 offen offset:0 sc1 lds
    buffer_load_dwordx4 v3, s[12:15], s47 offen offset:1024 sc1 lds
    buffer_load_dwordx4 v3, s[12:15], s47 offen offset:2048 sc1 lds
    s_add_u32 s61, s61, 229376
    s_add_u32 s62, s62, 1
    s_xor_b32 s64, s64, 0x10000
    s_mov_b32 s69, 1
L_g_nd_129:
    s_cmp_eq_u32 s69, 1
    s_cbranch_scc1 L_g_w0_130
    s_waitcnt vmcnt(0)
L_g_w0_130:
    s_waitcnt vmcnt(7)
    s_mov_b32 s65, 1
L_g_loop0_122:
    s_barrier
    s_cmp_eq_u32 s65, 0
    s_cbranch_scc1 L_g_pr_131
    ds_read_b128 v[32:35], v4 offset:0
    ds_read_b128 v[36:39], v4 offset:256
    ds_read_b128 v[40:43], v4 offset:2048
    ds_read_b128 v[44:47], v4 offset:2304
    ds_read_b128 v[48:51], v4 offset:4096
    ds_read_b128 v[52:55], v4 offset:4352
    ds_read_b128 v[56:59], v4 offset:6144
    ds_read_b128 v[60:63], v4 offset:6400
L_g_pr_131:
    ds_read_b32 v14, v15
    s_cmp_lg_u32 s44, 0
    s_cbranch_scc1 L_g_nl_132
    s_add_u32 s54, s60, 1
    s_add_u32 s55, s54, 0
    s_mov_b32 s46, 0
    buffer_load_dword v11, v7, s[12:15], s46 offen sc1
L_g_nl_132:
    s_setprio 1
    s_waitcnt lgkmcnt(7)
    v_mfma_f32_16x16x32_bf16 v[16:19], v[32:35], a[0:3], 0
    v_mfma_f32_16x16x32_bf16 v[20:23], v[32:35], a[4:7], 0
    ds_read_b128 v[32:35], v4 offset:8192
    s_waitcnt lgkmcnt(7)
    v_mfma_f32_16x16x32_bf16 v[24:27], v[36:39], a[0:3], 0
    v_mfma_f32_16x16x32_bf16 v[28:31], v[36:39], a[4:7], 0
    ds_read_b128 v[36:39], v4 offset:8448
    s_waitcnt lgkmcnt(7)
    v_mfma_f32_16x16x32_bf16 v[16:19], v[40:43], a[8:11], v[16:19]
    v_mfma_f32_16x16x32_bf16 v[20:23], v[40:43], a[12:15], v[20:23]
    ds_read_b128 v[40:43], v4 offset:10240
    s_waitcnt lgkmcnt(7)
    v_mfma_f32_16x16x32_bf16 v[24:27], v[44:47], a[8:11], v[24:27]
    v_mfma_f32_16x16x32_bf16 v[28:31], v[44:47], a[12:15], v[28:31]
    ds_read_b128 v[44:47], v4 offset:10496
    s_waitcnt lgkmcnt(7)
    v_mfma_f32_16x16x32_bf16 v[16:19], v[48:51], a[16:19], v[16:19]
    v_mfma_f32_16x16x32_bf16 v[20:23], v[48:51], a[20:23], v[20:23]
    ds_read_b128 v[48:51], v4 offset:12288
    s_waitcnt lgkmcnt(7)
    v_mfma_f32_16x16x32_bf16 v[24:27], v[52:55], a[16:19], v[24:27]
    v_mfma_f32_16x16x32_bf16 v[28:31], v[52:55], a[20:23], v[28:31]
    ds_read_b128 v[52:55], v4 offset:12544
    s_waitcnt lgkmcnt(7)
    v_mfma_f32_16x16x32_bf16 v[16:19], v[56:59], a[24:27], v[16:19]
    v_mfma_f32_16x16x32_bf16 v[20:23], v[56:59], a[28:31], v[20:23]
    ds_read_b128 v[56:59], v4 offset:14336
    s_waitcnt lgkmcnt(7)
    v_mfma_f32_16x16x32_bf16 v[24:27], v[60:63], a[24:27], v[24:27]
    v_mfma_f32_16x16x32_bf16 v[28:31], v[60:63], a[28:31], v[28:31]
    ds_read_b128 v[60:63], v4 offset:14592
    s_waitcnt lgkmcnt(7)
    v_mfma_f32_16x16x32_bf16 v[16:19], v[32:35], a[32:35], v[16:19]
    v_mfma_f32_16x16x32_bf16 v[20:23], v[32:35], a[36:39], v[20:23]
    ds_read_b128 v[32:35], v4 offset:16384
    s_waitcnt lgkmcnt(7)
    v_mfma_f32_16x16x32_bf16 v[24:27], v[36:39], a[32:35], v[24:27]
    v_mfma_f32_16x16x32_bf16 v[28:31], v[36:39], a[36:39], v[28:31]
    ds_read_b128 v[36:39], v4 offset:16640
    s_waitcnt lgkmcnt(7)
    v_mfma_f32_16x16x32_bf16 v[16:19], v[40:43], a[40:43], v[16:19]
    v_mfma_f32_16x16x32_bf16 v[20:23], v[40:43], a[44:47], v[20:23]
    ds_read_b128 v[40:43], v4 offset:18432
    s_waitcnt lgkmcnt(7)
    v_mfma_f32_16x16x32_bf16 v[24:27], v[44:47], a[40:43], v[24:27]
    v_mfma_f32_16x16x32_bf16 v[28:31], v[44:47], a[44:47], v[28:31]
    ds_read_b128 v[44:47], v4 offset:18688
    s_waitcnt lgkmcnt(7)
    v_mfma_f32_16x16x32_bf16 v[16:19], v[48:51], a[48:51], v[16:19]
    v_mfma_f32_16x16x32_bf16 v[20:23], v[48:51], a[52:55], v[20:23]
    ds_read_b128 v[48:51], v4 offset:20480
    s_waitcnt lgkmcnt(7)
    v_mfma_f32_16x16x32_bf16 v[24:27], v[52:55], a[48:51], v[24:27]
    v_mfma_f32_16x16x32_bf16 v[28:31], v[52:55], a[52:55], v[28:31]
    ds_read_b128 v[52:55], v4 offset:20736
    s_waitcnt lgkmcnt(7)
    v_mfma_f32_16x16x32_bf16 v[16:19], v[56:59], a[56:59], v[16:19]
    v_mfma_f32_16x16x32_bf16 v[20:23], v[56:59], a[60:63], v[20:23]
    ds_read_b128 v[56:59], v4 offset:22528
    s_waitcnt lgkmcnt(7)
    v_mfma_f32_16x16x32_bf16 v[24:27], v[60:63], a[56:59], v[24:27]
    v_mfma_f32_16x16x32_bf16 v[28:31], v[60:63], a[60:63], v[28:31]
    ds_read_b128 v[60:63], v4 offset:22784
    s_waitcnt lgkmcnt(7)
    v_mfma_f32_16x16x32_bf16 v[16:19], v[32:35], a[64:67], v[16:19]
    v_mfma_f32_16x16x32_bf16 v[20:23], v[32:35], a[68:71], v[20:23]
    ds_read_b128 v[32:35], v4 offset:24576
    s_waitcnt lgkmcnt(7)
    v_mfma_f32_16x16x32_bf16 v[24:27], v[36:39], a[64:67], v[24:27]
    v_mfma_f32_16x16x32_bf16 v[28:31], v[36:39], a[68:71], v[28:31]
    ds_read_b128 v[36:39], v4 offset:24832
    s_waitcnt lgkmcnt(7)
    v_mfma_f32_16x16x32_bf16 v[16:19], v[40:43], a[72:75], v[16:19]
    v_mfma_f32_16x16x32_bf16 v[20:23], v[40:43], a[76:79], v[20:23]
    ds_read_b128 v[40:43], v4 offset:26624
    s_waitcnt lgkmcnt(7)
    v_mfma_f32_16x16x32_bf16 v[24:27], v[44:47], a[72:75], v[24:27]
    v_mfma_f32_16x16x32_bf16 v[28:31], v[44:47], a[76:79], v[28:31]
    ds_read_b128 v[44:47], v4 offset:26880
    s_waitcnt lgkmcnt(7)
    v_mfma_f32_16x16x32_bf16 v[16:19], v[48:51], a[80:83], v[16:19]
    v_mfma_f32_16x16x32_bf16 v[20:23], v[48:51], a[84:87], v[20:23]
    s_waitcnt lgkmcnt(6)
    v_mfma_f32_16x16x32_bf16 v[24:27], v[52:55], a[80:83], v[24:27]
    v_mfma_f32_16x16x32_bf16 v[28:31], v[52:55], a[84:87], v[28:31]
    s_waitcnt lgkmcnt(5)
    v_mfma_f32_16x16x32_bf16 v[16:19], v[56:59], a[88:91], v[16:19]
    v_mfma_f32_16x16x32_bf16 v[20:23], v[56:59], a[92:95], v[20:23]
    s_waitcnt lgkmcnt(4)
    v_mfma_f32_16x16x32_bf16 v[24:27], v[60:63], a[88:91], v[24:27]
    v_mfma_f32_16x16x32_bf16 v[28:31], v[60:63], a[92:95], v[28:31]
    s_waitcnt lgkmcnt(3)
    v_mfma_f32_16x16x32_bf16 v[16:19], v[32:35], a[96:99], v[16:19]
    v_mfma_f32_16x16x32_bf16 v[20:23], v[32:35], a[100:103], v[20:23]
    s_waitcnt lgkmcnt(2)
    v_mfma_f32_16x16x32_bf16 v[24:27], v[36:39], a[96:99], v[24:27]
    v_mfma_f32_16x16x32_bf16 v[28:31], v[36:39], a[100:103], v[28:31]
    s_waitcnt lgkmcnt(1)
    v_mfma_f32_16x16x32_bf16 v[16:19], v[40:43], a[104:107], v[16:19]
    v_mfma_f32_16x16x32_bf16 v[20:23], v[40:43], a[108:111], v[20:23]
    s_waitcnt lgkmcnt(0)
    v_mfma_f32_16x16x32_bf16 v[24:27], v[44:47], a[104:107], v[24:27]
    v_mfma_f32_16x16x32_bf16 v[28:31], v[44:47], a[108:111], v[28:31]
    v_xor_b32 v4, 0x10000, v4
    s_setprio 0
    s_waitcnt vmcnt(0)
    v_readfirstlane_b32 s66, v14
    s_barrier
    s_nop 6
    ds_write_b128 v5, v[16:19] offset:0
    ds_write_b128 v5, v[20:23] offset:1024
    ds_write_b128 v5, v[24:27] offset:2048
    ds_write_b128 v5, v[28:31] offset:3072
    s_cmp_lg_u32 s44, 0
    s_cbranch_scc1 L_g_ne_133
    s_mov_b32 s46, s54
    v_cmp_ge_u32 vcc, s46, v11
    s_nop 0
    s_cbranch_vccnz L_g_le_136
    s_add_u32 s46, s46, 1
    v_cmp_ge_u32 vcc, s46, v11
    s_nop 0
    s_cbranch_vccnz L_g_le_136
    s_add_u32 s46, s46, 1
    v_cmp_ge_u32 vcc, s46, v11
    s_nop 0
    s_cbranch_vccnz L_g_le_136
    s_add_u32 s46, s46, 1
L_g_le_136:
    v_mov_b32 v11, s46
    ds_write_b32 v15, v11
L_g_ne_133:
    s_add_u32 s60, s60, 1
    s_waitcnt lgkmcnt(0)
    s_mov_b32 s69, 0
    s_cmp_gt_u32 s62, s60
    s_cbranch_scc1 L_g_nd_137
    s_cmp_ge_u32 s62, s66
    s_cbranch_scc1 L_g_nd_137
    s_add_u32 s47, s61, 4096
    s_add_u32 m0, s64, 0
    s_nop 0
    buffer_load_dwordx4 v3, s[12:15], s61 offen offset:0 sc1 lds
    buffer_load_dwordx4 v3, s[12:15], s61 offen offset:1024 sc1 lds
    buffer_load_dwordx4 v3, s[12:15], s61 offen offset:2048 sc1 lds
    buffer_load_dwordx4 v3, s[12:15], s61 offen offset:3072 sc1 lds
    s_add_u32 m0, s64, 4096
    s_nop 0
    buffer_load_dwordx4 v3, s[12:15], s47 offen offset:0 sc1 lds
    buffer_load_dwordx4 v3, s[12:15], s47 offen offset:1024 sc1 lds
    buffer_load_dwordx4 v3, s[12:15], s47 offen offset:2048 sc1 lds
    s_add_u32 s61, s61, 229376
    s_add_u32 s62, s62, 1
    s_xor_b32 s64, s64, 0x10000
    s_mov_b32 s69, 1
L_g_nd_137:
    s_mov_b32 s65, s69
    s_add_u32 s59, s60, 1
    s_mov_b32 s69, 0
    s_cmp_gt_u32 s62, s59
    s_cbranch_scc1 L_g_nd_138
    s_cmp_ge_u32 s62, s66
    s_cbranch_scc1 L_g_nd_138
    s_add_u32 s47, s61, 4096
    s_add_u32 m0, s64, 0
    s_nop 0
    buffer_load_dwordx4 v3, s[12:15], s61 offen offset:0 sc1 lds
    buffer_load_dwordx4 v3, s[12:15], s61 offen offset:1024 sc1 lds
    buffer_load_dwordx4 v3, s[12:15], s61 offen offset:2048 sc1 lds
    buffer_load_dwordx4 v3, s[12:15], s61 offen offset:3072 sc1 lds
    s_add_u32 m0, s64, 4096
    s_nop 0
    buffer_load_dwordx4 v3, s[12:15], s47 offen offset:0 sc1 lds
    buffer_load_dwordx4 v3, s[12:15], s47 offen offset:1024 sc1 lds
    buffer_load_dwordx4 v3, s[12:15], s47 offen offset:2048 sc1 lds
    s_add_u32 s61, s61, 229376
    s_add_u32 s62, s62, 1
    s_xor_b32 s64, s64, 0x10000
    s_mov_b32 s69, 1
L_g_nd_138:
    s_cmp_le_u32 s66, s60
    s_cbranch_scc1 L_g_ex0_135
    s_cmp_eq_u32 s65, 0
    s_cbranch_scc1 L_g_nw_134
    s_waitcnt vmcnt(0) lgkmcnt(0)
    s_branch L_g_loop0_122
L_g_nw_134:
    ds_read_b128 v[32:35], v4 offset:0
    ds_read_b128 v[36:39], v4 offset:256
    ds_read_b128 v[40:43], v4 offset:2048
    ds_read_b128 v[44:47], v4 offset:2304
    ds_read_b128 v[48:51], v4 offset:4096
    ds_read_b128 v[52:55], v4 offset:4352
    ds_read_b128 v[56:59], v4 offset:6144
    ds_read_b128 v[60:63], v4 offset:6400
    s_waitcnt lgkmcnt(8)
    s_branch L_g_loop0_122
L_g_ex0_135:
    s_cmp_lg_u32 s44, 0
    s_cbranch_scc1 L_g_ex0_135_n
    s_sleep 6
    s_add_u32 s54, s60, 0
    s_add_u32 s55, s54, 0
    s_mov_b32 s46, 0
    buffer_load_dword v11, v7, s[12:15], s46 offen sc1
    s_waitcnt vmcnt(0)
    s_mov_b32 s46, s54
    v_cmp_ge_u32 vcc, s46, v11
    s_nop 0
    s_cbranch_vccnz L_g_le_139
    s_add_u32 s46, s46, 1
    v_cmp_ge_u32 vcc, s46, v11
    s_nop 0
    s_cbranch_vccnz L_g_le_139
    s_add_u32 s46, s46, 1
    v_cmp_ge_u32 vcc, s46, v11
    s_nop 0
    s_cbranch_vccnz L_g_le_139
    s_add_u32 s46, s46, 1
L_g_le_139:
    v_mov_b32 v11, s46
    ds_write_b32 v15, v11
L_g_ex0_135_n:
    s_waitcnt lgkmcnt(0)
    s_barrier
    ds_read_b32 v14, v15
    s_waitcnt lgkmcnt(0)
    v_readfirstlane_b32 s66, v14
    s_barrier
    s_cmp_gt_u32 s66, s60
    s_cbranch_scc1 L_g_restart_119_go
    s_branch L_g_tail_124
L_g_g1r_121:
    s_mov_b32 s65, 1
    s_branch L_g_loop1_123_e
L_g_loop1_123:
    s_mov_b32 s65, 0
L_g_loop1_123_e:
    s_barrier
    ds_read_b32 v14, v15
    s_bitcmp1_b32 s67, 1
    s_cbranch_scc0 L_g_nfl_140
    s_sub_u32 s59, s60, 2
    s_cmp_lg_u32 s44, 4
    s_cbranch_scc1 L_sf_145
    v_mov_b32 v10, s59
    v_add_u32 v10, 1, v10
    v_mov_b32 v11, 0
    s_mov_b64 exec, 1
    buffer_store_dword v10, v11, s[12:15], s52 offen sc1
    s_mov_b64 exec, -1
L_sf_145:
L_g_nfl_140:
    s_bitcmp1_b32 s67, 0
    s_cbranch_scc0 L_g_nep_141
    ds_read_b128 v[80:83], v5 offset:0
    ds_read_b128 v[84:87], v5 offset:1024
    ds_read_b128 v[88:91], v5 offset:2048
    ds_read_b128 v[92:95], v5 offset:3072
    s_nop 7
    s_waitcnt lgkmcnt(3)
    v_add_f32 v80, v80, v16
    v_add_f32 v81, v81, v17
    v_add_f32 v82, v82, v18
    v_add_f32 v83, v83, v19
    s_waitcnt lgkmcnt(2)
    v_add_f32 v84, v84, v20
    v_add_f32 v85, v85, v21
    v_add_f32 v86, v86, v22
    v_add_f32 v87, v87, v23
    s_waitcnt lgkmcnt(1)
    v_add_f32 v88, v88, v24
    v_add_f32 v89, v89, v25
    v_add_f32 v90, v90, v26
    v_add_f32 v91, v91, v27
    s_waitcnt lgkmcnt(0)
    v_add_f32 v92, v92, v28
    v_add_f32 v93, v93, v29
    v_add_f32 v94, v94, v30
    v_add_f32 v95, v95, v31
    v_cvt_pk_bf16_f32 v104, v80, v81
    v_cvt_pk_bf16_f32 v105, v82, v83
    v_cvt_pk_bf16_f32 v106, v84, v85
    v_cvt_pk_bf16_f32 v107, v86, v87
    s_nop 1
    v_permlane16_swap_b32 v104, v106
    v_permlane16_swap_b32 v105, v107
    buffer_store_dwordx4 v[104:107], v8, s[12:15], s63 offen sc1
    v_cvt_pk_bf16_f32 v108, v88, v89
    v_cvt_pk_bf16_f32 v109, v90, v91
    v_cvt_pk_bf16_f32 v110, v92, v93
    v_cvt_pk_bf16_f32 v111, v94, v95
    s_nop 1
    v_permlane16_swap_b32 v108, v110
    v_permlane16_swap_b32 v109, v111
    buffer_store_dwordx4 v[108:111], v9, s[12:15], s63 offen sc1
    s_add_u32 s63, s63, 262144
L_g_nep_141:
    s_waitcnt lgkmcnt(0)
    v_readfirstlane_b32 s66, v14
    s_nop 3
    s_mov_b32 s69, 0
    s_cmp_gt_u32 s62, s60
    s_cbranch_scc1 L_g_nd_146
    s_cmp_ge_u32 s62, s66
    s_cbranch_scc1 L_g_nd_146
    s_add_u32 s47, s61, 4096
    s_add_u32 m0, s64, 0
    s_nop 0
    buffer_load_dwordx4 v3, s[12:15], s61 offen offset:0 sc1 lds
    buffer_load_dwordx4 v3, s[12:15], s61 offen offset:1024 sc1 lds
    buffer_load_dwordx4 v3, s[12:15], s61 offen offset:2048 sc1 lds
    buffer_load_dwordx4 v3, s[12:15], s61 offen offset:3072 sc1 lds
    s_add_u32 m0, s64, 4096
    s_nop 0
    buffer_load_dwordx4 v3, s[12:15], s47 offen offset:0 sc1 lds
    buffer_load_dwordx4 v3, s[12:15], s47 offen offset:1024 sc1 lds
    buffer_load_dwordx4 v3, s[12:15], s47 offen offset:2048 sc1 lds
    s_add_u32 s61, s61, 229376
    s_add_u32 s62, s62, 1
    s_xor_b32 s64, s64, 0x10000
    s_mov_b32 s69, 1
L_g_nd_146:
    s_or_b32 s65, s65, s69
    s_add_u32 s59, s60, 1
    s_mov_b32 s69, 0
    s_cmp_gt_u32 s62, s59
    s_cbranch_scc1 L_g_nd_147
    s_cmp_ge_u32 s62, s66
    s_cbranch_scc1 L_g_nd_147
    s_add_u32 s47, s61, 4096
    s_add_u32 m0, s64, 0
    s_nop 0
    buffer_load_dwordx4 v3, s[12:15], s61 offen offset:0 sc1 lds
    buffer_load_dwordx4 v3, s[12:15], s61 offen offset:1024 sc1 lds
    buffer_load_dwordx4 v3, s[12:15], s61 offen offset:2048 sc1 lds
    buffer_load_dwordx4 v3, s[12:15], s61 offen offset:3072 sc1 lds
    s_add_u32 m0, s64, 4096
    s_nop 0
    buffer_load_dwordx4 v3, s[12:15], s47 offen offset:0 sc1 lds
    buffer_load_dwordx4 v3, s[12:15], s47 offen offset:1024 sc1 lds
    buffer_load_dwordx4 v3, s[12:15], s47 offen offset:2048 sc1 lds
    s_add_u32 s61, s61, 229376
    s_add_u32 s62, s62, 1
    s_xor_b32 s64, s64, 0x10000
    s_mov_b32 s69, 1
L_g_nd_147:
    s_cmp_eq_u32 s65, 0
    s_cbranch_scc1 L_g_nw1_142
    s_waitcnt vmcnt(0)
    s_barrier
    ds_read_b128 v[32:35], v4 offset:0
    ds_read_b128 v[36:39], v4 offset:256
    ds_read_b128 v[40:43], v4 offset:2048
    ds_read_b128 v[44:47], v4 offset:2304
    ds_read_b128 v[48:51], v4 offset:4096
    ds_read_b128 v[52:55], v4 offset:4352
    ds_read_b128 v[56:59], v4 offset:6144
    ds_read_b128 v[60:63], v4 offset:6400
    s_branch L_g_jn_144
L_g_nw1_142:
    ds_read_b128 v[32:35], v4 offset:0
    ds_read_b128 v[36:39], v4 offset:256
    ds_read_b128 v[40:43], v4 offset:2048
    ds_read_b128 v[44:47], v4 offset:2304
    ds_read_b128 v[48:51], v4 offset:4096
    ds_read_b128 v[52:55], v4 offset:4352
    ds_read_b128 v[56:59], v4 offset:6144
    ds_read_b128 v[60:63], v4 offset:6400
    s_barrier
L_g_jn_144:
    s_setprio 1
    s_waitcnt lgkmcnt(7)
    v_mfma_f32_16x16x32_bf16 v[16:19], v[32:35], a[0:3], 0
    v_mfma_f32_16x16x32_bf16 v[20:23], v[32:35], a[4:7], 0
    ds_read_b128 v[32:35], v4 offset:8192
    s_waitcnt lgkmcnt(7)
    v_mfma_f32_16x16x32_bf16 v[24:27], v[36:39], a[0:3], 0
    v_mfma_f32_16x16x32_bf16 v[28:31], v[36:39], a[4:7], 0
    ds_read_b128 v[36:39], v4 offset:8448
    s_waitcnt lgkmcnt(7)
    v_mfma_f32_16x16x32_bf16 v[16:19], v[40:43], a[8:11], v[16:19]
    v_mfma_f32_16x16x32_bf16 v[20:23], v[40:43], a[12:15], v[20:23]
    ds_read_b128 v[40:43], v4 offset:10240
    s_waitcnt lgkmcnt(7)
    v_mfma_f32_16x16x32_bf16 v[24:27], v[44:47], a[8:11], v[24:27]
    v_mfma_f32_16x16x32_bf16 v[28:31], v[44:47], a[12:15], v[28:31]
    ds_read_b128 v[44:47], v4 offset:10496
    s_waitcnt lgkmcnt(7)
    v_mfma_f32_16x16x32_bf16 v[16:19], v[48:51], a[16:19], v[16:19]
    v_mfma_f32_16x16x32_bf16 v[20:23], v[48:51], a[20:23], v[20:23]
    ds_read_b128 v[48:51], v4 offset:12288
    s_waitcnt lgkmcnt(7)
    v_mfma_f32_16x16x32_bf16 v[24:27], v[52:55], a[16:19], v[24:27]
    v_mfma_f32_16x16x32_bf16 v[28:31], v[52:55], a[20:23], v[28:31]
    ds_read_b128 v[52:55], v4 offset:12544
    s_waitcnt lgkmcnt(7)
    v_mfma_f32_16x16x32_bf16 v[16:19], v[56:59], a[24:27], v[16:19]
    v_mfma_f32_16x16x32_bf16 v[20:23], v[56:59], a[28:31], v[20:23]
    ds_read_b128 v[56:59], v4 offset:14336
    s_waitcnt lgkmcnt(7)
    v_mfma_f32_16x16x32_bf16 v[24:27], v[60:63], a[24:27], v[24:27]
    v_mfma_f32_16x16x32_bf16 v[28:31], v[60:63], a[28:31], v[28:31]
    ds_read_b128 v[60:63], v4 offset:14592
    s_waitcnt lgkmcnt(7)
    v_mfma_f32_16x16x32_bf16 v[16:19], v[32:35], a[32:35], v[16:19]
    v_mfma_f32_16x16x32_bf16 v[20:23], v[32:35], a[36:39], v[20:23]
    ds_read_b128 v[32:35], v4 offset:16384
    s_waitcnt lgkmcnt(7)
    v_mfma_f32_16x16x32_bf16 v[24:27], v[36:39], a[32:35], v[24:27]
    v_mfma_f32_16x16x32_bf16 v[28:31], v[36:39], a[36:39], v[28:31]
    ds_read_b128 v[36:39], v4 offset:16640
    s_waitcnt lgkmcnt(7)
    v_mfma_f32_16x16x32_bf16 v[16:19], v[40:43], a[40:43], v[16:19]
    v_mfma_f32_16x16x32_bf16 v[20:23], v[40:43], a[44:47], v[20:23]
    ds_read_b128 v[40:43], v4 offset:18432
    s_waitcnt lgkmcnt(7)
    v_mfma_f32_16x16x32_bf16 v[24:27], v[44:47], a[40:43], v[24:27]
    v_mfma_f32_16x16x32_bf16 v[28:31], v[44:47], a[44:47], v[28:31]
    ds_read_b128 v[44:47], v4 offset:18688
    s_waitcnt lgkmcnt(7)
    v_mfma_f32_16x16x32_bf16 v[16:19], v[48:51], a[48:51], v[16:19]
    v_mfma_f32_16x16x32_bf16 v[20:23], v[48:51], a[52:55], v[20:23]
    ds_read_b128 v[48:51], v4 offset:20480
    s_waitcnt lgkmcnt(7)
    v_mfma_f32_16x16x32_bf16 v[24:27], v[52:55], a[48:51], v[24:27]
    v_mfma_f32_16x16x32_bf16 v[28:31], v[52:55], a[52:55], v[28:31]
    ds_read_b128 v[52:55], v4 offset:20736
    s_waitcnt lgkmcnt(7)
    v_mfma_f32_16x16x32_bf16 v[16:19], v[56:59], a[56:59], v[16:19]
    v_mfma_f32_16x16x32_bf16 v[20:23], v[56:59], a[60:63], v[20:23]
    ds_read_b128 v[56:59], v4 offset:22528
    s_waitcnt lgkmcnt(7)
    v_mfma_f32_16x16x32_bf16 v[24:27], v[60:63], a[56:59], v[24:27]
    v_mfma_f32_16x16x32_bf16 v[28:31], v[60:63], a[60:63], v[28:31]
    ds_read_b128 v[60:63], v4 offset:22784
    s_waitcnt lgkmcnt(7)
    v_mfma_f32_16x16x32_bf16 v[16:19], v[32:35], a[64:67], v[16:19]
    v_mfma_f32_16x16x32_bf16 v[20:23], v[32:35], a[68:71], v[20:23]
    ds_read_b128 v[32:35], v4 offset:24576
    s_waitcnt lgkmcnt(7)
    v_mfma_f32_16x16x32_bf16 v[24:27], v[36:39], a[64:67], v[24:27]
    v_mfma_f32_16x16x32_bf16 v[28:31], v[36:39], a[68:71], v[28:31]
    ds_read_b128 v[36:39], v4 offset:24832
    s_waitcnt lgkmcnt(7)
    v_mfma_f32_16x16x32_bf16 v[16:19], v[40:43], a[72:75], v[16:19]
    v_mfma_f32_16x16x32_bf16 v[20:23], v[40:43], a[76:79], v[20:23]
    ds_read_b128 v[40:43], v4 offset:26624
    s_waitcnt lgkmcnt(7)
    v_mfma_f32_16x16x32_bf16 v[24:27], v[44:47], a[72:75], v[24:27]
    v_mfma_f32_16x16x32_bf16 v[28:31], v[44:47], a[76:79], v[28:31]
    ds_read_b128 v[44:47], v4 offset:26880
    s_waitcnt lgkmcnt(7)
    v_mfma_f32_16x16x32_bf16 v[16:19], v[48:51], a[80:83], v[16:19]
    v_mfma_f32_16x16x32_bf16 v[20:23], v[48:51], a[84:87], v[20:23]
    s_waitcnt lgkmcnt(6)
    v_mfma_f32_16x16x32_bf16 v[24:27], v[52:55], a[80:83], v[24:27]
    v_mfma_f32_16x16x32_bf16 v[28:31], v[52:55], a[84:87], v[28:31]
    s_waitcnt lgkmcnt(5)
    v_mfma_f32_16x16x32_bf16 v[16:19], v[56:59], a[88:91], v[16:19]
    v_mfma_f32_16x16x32_bf16 v[20:23], v[56:59], a[92:95], v[20:23]
    s_waitcnt lgkmcnt(4)
    v_mfma_f32_16x16x32_bf16 v[24:27], v[60:63], a[88:91], v[24:27]
    v_mfma_f32_16x16x32_bf16 v[28:31], v[60:63], a[92:95], v[28:31]
    s_waitcnt lgkmcnt(3)
    v_mfma_f32_16x16x32_bf16 v[16:19], v[32:35], a[96:99], v[16:19]
    v_mfma_f32_16x16x32_bf16 v[20:23], v[32:35], a[100:103], v[20:23]
    s_waitcnt lgkmcnt(2)
    v_mfma_f32_16x16x32_bf16 v[24:27], v[36:39], a[96:99], v[24:27]
    v_mfma_f32_16x16x32_bf16 v[28:31], v[36:39], a[100:103], v[28:31]
    s_waitcnt lgkmcnt(1)
    v_mfma_f32_16x16x32_bf16 v[16:19], v[40:43], a[104:107], v[16:19]
    v_mfma_f32_16x16x32_bf16 v[20:23], v[40:43], a[108:111], v[20:23]
    s_waitcnt lgkmcnt(0)
    v_mfma_f32_16x16x32_bf16 v[24:27], v[44:47], a[104:107], v[24:27]
    v_mfma_f32_16x16x32_bf16 v[28:31], v[44:47], a[108:111], v[28:31]
    v_xor_b32 v4, 0x10000, v4
    s_setprio 0
    s_waitcnt vmcnt(0)
    s_lshl_b32 s67, s67, 1
    s_or_b32 s67, s67, 1
    s_add_u32 s60, s60, 1
    s_cmp_gt_u32 s66, s60
    s_cbranch_scc1 L_g_loop1_123
    s_barrier
    ds_read_b32 v14, v15
    s_waitcnt lgkmcnt(0)
    v_readfirstlane_b32 s66, v14
    s_barrier
    s_mov_b32 s69, 0
    s_cmp_gt_u32 s62, s60
    s_cbranch_scc1 L_g_nd_148
    s_cmp_ge_u32 s62, s66
    s_cbranch_scc1 L_g_nd_148
    s_add_u32 s47, s61, 4096
    s_add_u32 m0, s64, 0
    s_nop 0
    buffer_load_dwordx4 v3, s[12:15], s61 offen offset:0 sc1 lds
    buffer_load_dwordx4 v3, s[12:15], s61 offen offset:1024 sc1 lds
    buffer_load_dwordx4 v3, s[12:15], s61 offen offset:2048 sc1 lds
    buffer_load_dwordx4 v3, s[12:15], s61 offen offset:3072 sc1 lds
    s_add_u32 m0, s64, 4096
    s_nop 0
    buffer_load_dwordx4 v3, s[12:15], s47 offen offset:0 sc1 lds
    buffer_load_dwordx4 v3, s[12:15], s47 offen offset:1024 sc1 lds
    buffer_load_dwordx4 v3, s[12:15], s47 offen offset:2048 sc1 lds
    s_add_u32 s61, s61, 229376
    s_add_u32 s62, s62, 1
    s_xor_b32 s64, s64, 0x10000
    s_mov_b32 s69, 1
L_g_nd_148:
    s_sub_u32 s59, s60, 1
    ds_read_b128 v[80:83], v5 offset:0
    ds_read_b128 v[84:87], v5 offset:1024
    ds_read_b128 v[88:91], v5 offset:2048
    ds_read_b128 v[92:95], v5 offset:3072
    s_nop 7
    s_waitcnt lgkmcnt(3)
    v_add_f32 v80, v80, v16
    v_add_f32 v81, v81, v17
    v_add_f32 v82, v82, v18
    v_add_f32 v83, v83, v19
    s_waitcnt lgkmcnt(2)
    v_add_f32 v84, v84, v20
    v_add_f32 v85, v85, v21
    v_add_f32 v86, v86, v22
    v_add_f32 v87, v87, v23
    s_waitcnt lgkmcnt(1)
    v_add_f32 v88, v88, v24
    v_add_f32 v89, v89, v25
    v_add_f32 v90, v90, v26
    v_add_f32 v91, v91, v27
    s_waitcnt lgkmcnt(0)
    v_add_f32 v92, v92, v28
    v_add_f32 v93, v93, v29
    v_add_f32 v94, v94, v30
    v_add_f32 v95, v95, v31
    v_cvt_pk_bf16_f32 v104, v80, v81
    v_cvt_pk_bf16_f32 v105, v82, v83
    v_cvt_pk_bf16_f32 v106, v84, v85
    v_cvt_pk_bf16_f32 v107, v86, v87
    s_nop 1
    v_permlane16_swap_b32 v104, v106
    v_permlane16_swap_b32 v105, v107
    buffer_store_dwordx4 v[104:107], v8, s[12:15], s63 offen sc1
    v_cvt_pk_bf16_f32 v108, v88, v89
    v_cvt_pk_bf16_f32 v109, v90, v91
    v_cvt_pk_bf16_f32 v110, v92, v93
    v_cvt_pk_bf16_f32 v111, v94, v95
    s_nop 1
    v_permlane16_swap_b32 v108, v110
    v_permlane16_swap_b32 v109, v111
    buffer_store_dwordx4 v[108:111], v9, s[12:15], s63 offen sc1
    s_add_u32 s63, s63, 262144
    v_mov_b32 v10, 1
    s_mov_b64 exec, 1
    s_waitcnt vmcnt(0)
    ds_add_rtn_u32 v10, v15, v10 offset:4
    s_waitcnt lgkmcnt(0)
    v_readfirstlane_b32 s46, v10
    s_mov_b64 exec, -1
    s_mov_b32 s67, 0
    s_nop 1
    s_cmp_lg_u32 s46, s68
    s_cbranch_scc1 L_g_g1f_125
    v_mov_b32 v10, s59
    v_add_u32 v10, 1, v10
    v_mov_b32 v11, 0
    s_mov_b64 exec, 1
    buffer_store_dword v10, v11, s[12:15], s52 offen sc1
    s_mov_b64 exec, -1
L_sf_149:
L_g_g1f_125:
    s_add_u32 s68, s68, 4
    s_cmp_gt_u32 s66, s60
    s_cbranch_scc1 L_g_g1r_121
L_g_tail_124:
    s_cmp_lt_u32 s60, 64
    s_cbranch_scc1 L_g_restart_119
    s_barrier
    s_branch L_c_done_1
L_w_wo_10:
    s_load_dwordx2 s[4:5], s[0:1], 40
    s_load_dwordx2 s[6:7], s[0:1], 72
    s_and_b32 s50, s44, 3
    s_lshr_b32 s51, s44, 2
    s_waitcnt lgkmcnt(0)
    s_mov_b32 s24, s4
    s_and_b32 s25, s5, 0xffff
    s_mov_b32 s26, 0x800000
    s_mov_b32 s27, 0x00020000
    v_lshrrev_b32 v3, 4, v1
    v_and_b32 v4, 15, v1
    v_lshlrev_b32 v5, 2, v3
    v_xor_b32 v4, v4, v5
    v_mul_u32_u24 v3, 2048, v3
    v_lshl_add_u32 v3, v4, 4, v3
    s_mul_i32 s46, s51, 512
    s_mul_i32 s47, s50, 64
    s_add_u32 s46, s46, s47
    s_mul_i32 s47, s42, 1024
    s_add_u32 s46, s46, s47
    s_mul_i32 s46, s46, 2048
    s_lshl_b32 s47, s43, 8
    s_add_u32 s46, s46, s47
    s_lshl_b32 s45, s51, 16
    s_mul_i32 s47, s50, 16384
    s_add_u32 s45, s45, s47
    v_bfe_u32 v4, v1, 2, 2
    v_bfe_u32 v5, v1, 4, 1
    v_lshlrev_b32 v5, 1, v5
    v_bfe_u32 v6, v1, 1, 1
    v_add_u32 v5, v5, v6
    s_lshl_b32 s47, s50, 2
    v_add_u32 v5, s47, v5
    v_lshlrev_b32 v6, 2, v4
    v_xor_b32 v5, v5, v6
    v_lshlrev_b32 v5, 4, v5
    v_lshl_add_u32 v5, v4, 8, v5
    v_bfe_u32 v6, v1, 0, 1
    v_lshl_add_u32 v5, v6, 3, v5
    v_lshrrev_b32 v6, 5, v1
    v_mul_u32_u24 v6, 1024, v6
    v_add_u32 v5, v5, v6
    s_lshl_b32 s47, s51, 16
    v_add_u32 v5, s47, v5
    v_bfe_u32 v4, v1, 2, 2
    v_xor_b32 v5, s50, v4
    v_lshlrev_b32 v5, 6, v5
    v_lshl_add_u32 v5, v4, 8, v5
    v_and_b32 v6, 3, v1
    v_lshl_add_u32 v5, v6, 3, v5
    v_lshrrev_b32 v6, 4, v1
    v_lshl_add_u32 v5, v6, 10, v5
    s_lshl_b32 s47, s51, 16
    v_add_u32 v5, s47, v5
    s_add_u32 m0, s45, 0
    s_add_u32 s47, s46, 0x0
    buffer_load_dwordx4 v3, s[24:27], s47 offen lds
    s_add_u32 m0, s45, 1024
    s_add_u32 s47, s46, 0x2000
    buffer_load_dwordx4 v3, s[24:27], s47 offen lds
    s_add_u32 m0, s45, 2048
    s_add_u32 s47, s46, 0x4000
    buffer_load_dwordx4 v3, s[24:27], s47 offen lds
    s_add_u32 m0, s45, 3072
    s_add_u32 s47, s46, 0x6000
    buffer_load_dwordx4 v3, s[24:27], s47 offen lds
    s_add_u32 m0, s45, 4096
    s_add_u32 s47, s46, 0x8000
    buffer_load_dwordx4 v3, s[24:27], s47 offen lds
    s_add_u32 m0, s45, 5120
    s_add_u32 s47, s46, 0xa000
    buffer_load_dwordx4 v3, s[24:27], s47 offen lds
    s_add_u32 m0, s45, 6144
    s_add_u32 s47, s46, 0xc000
    buffer_load_dwordx4 v3, s[24:27], s47 offen lds
    s_add_u32 m0, s45, 7168
    s_add_u32 s47, s46, 0xe000
    buffer_load_dwordx4 v3, s[24:27], s47 offen lds
    s_add_u32 m0, s45, 8192
    s_add_u32 s47, s46, 0x10000
    buffer_load_dwordx4 v3, s[24:27], s47 offen lds
    s_add_u32 m0, s45, 9216
    s_add_u32 s47, s46, 0x12000
    buffer_load_dwordx4 v3, s[24:27], s47 offen lds
    s_add_u32 m0, s45, 10240
    s_add_u32 s47, s46, 0x14000
    buffer_load_dwordx4 v3, s[24:27], s47 offen lds
    s_add_u32 m0, s45, 11264
    s_add_u32 s47, s46, 0x16000
    buffer_load_dwordx4 v3, s[24:27], s47 offen lds
    s_add_u32 m0, s45, 12288
    s_add_u32 s47, s46, 0x18000
    buffer_load_dwordx4 v3, s[24:27], s47 offen lds
    s_add_u32 m0, s45, 13312
    s_add_u32 s47, s46, 0x1a000
    buffer_load_dwordx4 v3, s[24:27], s47 offen lds
    s_add_u32 m0, s45, 14336
    s_add_u32 s47, s46, 0x1c000
    buffer_load_dwordx4 v3, s[24:27], s47 offen lds
    s_add_u32 m0, s45, 15360
    s_add_u32 s47, s46, 0x1e000
    buffer_load_dwordx4 v3, s[24:27], s47 offen lds
    s_waitcnt vmcnt(0)
    s_barrier
    ds_read_b64_tr_b16 a[0:1], v5 offset:0
    ds_read_b64_tr_b16 a[2:3], v5 offset:4096
    ds_read_b64_tr_b16 a[4:5], v5 offset:32
    ds_read_b64_tr_b16 a[6:7], v5 offset:4128
    ds_read_b64_tr_b16 a[8:9], v5 offset:8192
    ds_read_b64_tr_b16 a[10:11], v5 offset:12288
    ds_read_b64_tr_b16 a[12:13], v5 offset:8224
    ds_read_b64_tr_b16 a[14:15], v5 offset:12320
    s_waitcnt lgkmcnt(0)
    ds_read_b64_tr_b16 a[16:17], v5 offset:16384
    ds_read_b64_tr_b16 a[18:19], v5 offset:20480
    ds_read_b64_tr_b16 a[20:21], v5 offset:16416
    ds_read_b64_tr_b16 a[22:23], v5 offset:20512
    ds_read_b64_tr_b16 a[24:25], v5 offset:24576
    ds_read_b64_tr_b16 a[26:27], v5 offset:28672
    ds_read_b64_tr_b16 a[28:29], v5 offset:24608
    ds_read_b64_tr_b16 a[30:31], v5 offset:28704
    s_waitcnt lgkmcnt(0)
    ds_read_b64_tr_b16 a[32:33], v5 offset:32768
    ds_read_b64_tr_b16 a[34:35], v5 offset:36864
    ds_read_b64_tr_b16 a[36:37], v5 offset:32800
    ds_read_b64_tr_b16 a[38:39], v5 offset:36896
    ds_read_b64_tr_b16 a[40:41], v5 offset:40960
    ds_read_b64_tr_b16 a[42:43], v5 offset:45056
    ds_read_b64_tr_b16 a[44:45], v5 offset:40992
    ds_read_b64_tr_b16 a[46:47], v5 offset:45088
    s_waitcnt lgkmcnt(0)
    ds_read_b64_tr_b16 a[48:49], v5 offset:49152
    ds_read_b64_tr_b16 a[50:51], v5 offset:53248
    ds_read_b64_tr_b16 a[52:53], v5 offset:49184
    ds_read_b64_tr_b16 a[54:55], v5 offset:53280
    ds_read_b64_tr_b16 a[56:57], v5 offset:57344
    ds_read_b64_tr_b16 a[58:59], v5 offset:61440
    ds_read_b64_tr_b16 a[60:61], v5 offset:57376
    ds_read_b64_tr_b16 a[62:63], v5 offset:61472
    s_waitcnt lgkmcnt(0)
    s_waitcnt lgkmcnt(0)
    s_barrier
    s_add_u32 m0, s45, 0
    s_add_u32 s47, s46, 0x80000
    buffer_load_dwordx4 v3, s[24:27], s47 offen lds
    s_add_u32 m0, s45, 1024
    s_add_u32 s47, s46, 0x82000
    buffer_load_dwordx4 v3, s[24:27], s47 offen lds
    s_add_u32 m0, s45, 2048
    s_add_u32 s47, s46, 0x84000
    buffer_load_dwordx4 v3, s[24:27], s47 offen lds
    s_add_u32 m0, s45, 3072
    s_add_u32 s47, s46, 0x86000
    buffer_load_dwordx4 v3, s[24:27], s47 offen lds
    s_add_u32 m0, s45, 4096
    s_add_u32 s47, s46, 0x88000
    buffer_load_dwordx4 v3, s[24:27], s47 offen lds
    s_add_u32 m0, s45, 5120
    s_add_u32 s47, s46, 0x8a000
    buffer_load_dwordx4 v3, s[24:27], s47 offen lds
    s_add_u32 m0, s45, 6144
    s_add_u32 s47, s46, 0x8c000
    buffer_load_dwordx4 v3, s[24:27], s47 offen lds
    s_add_u32 m0, s45, 7168
    s_add_u32 s47, s46, 0x8e000
    buffer_load_dwordx4 v3, s[24:27], s47 offen lds
    s_add_u32 m0, s45, 8192
    s_add_u32 s47, s46, 0x90000
    buffer_load_dwordx4 v3, s[24:27], s47 offen lds
    s_add_u32 m0, s45, 9216
    s_add_u32 s47, s46, 0x92000
    buffer_load_dwordx4 v3, s[24:27], s47 offen lds
    s_add_u32 m0, s45, 10240
    s_add_u32 s47, s46, 0x94000
    buffer_load_dwordx4 v3, s[24:27], s47 offen lds
    s_add_u32 m0, s45, 11264
    s_add_u32 s47, s46, 0x96000
    buffer_load_dwordx4 v3, s[24:27], s47 offen lds
    s_add_u32 m0, s45, 12288
    s_add_u32 s47, s46, 0x98000
    buffer_load_dwordx4 v3, s[24:27], s47 offen lds
    s_add_u32 m0, s45, 13312
    s_add_u32 s47, s46, 0x9a000
    buffer_load_dwordx4 v3, s[24:27], s47 offen lds
    s_add_u32 m0, s45, 14336
    s_add_u32 s47, s46, 0x9c000
    buffer_load_dwordx4 v3, s[24:27], s47 offen lds
    s_add_u32 m0, s45, 15360
    s_add_u32 s47, s46, 0x9e000
    buffer_load_dwordx4 v3, s[24:27], s47 offen lds
    s_waitcnt vmcnt(0)
    s_barrier
    ds_read_b64_tr_b16 a[64:65], v5 offset:0
    ds_read_b64_tr_b16 a[66:67], v5 offset:4096
    ds_read_b64_tr_b16 a[68:69], v5 offset:32
    ds_read_b64_tr_b16 a[70:71], v5 offset:4128
    ds_read_b64_tr_b16 a[72:73], v5 offset:8192
    ds_read_b64_tr_b16 a[74:75], v5 offset:12288
    ds_read_b64_tr_b16 a[76:77], v5 offset:8224
    ds_read_b64_tr_b16 a[78:79], v5 offset:12320
    s_waitcnt lgkmcnt(0)
    ds_read_b64_tr_b16 a[80:81], v5 offset:16384
    ds_read_b64_tr_b16 a[82:83], v5 offset:20480
    ds_read_b64_tr_b16 a[84:85], v5 offset:16416
    ds_read_b64_tr_b16 a[86:87], v5 offset:20512
    ds_read_b64_tr_b16 a[88:89], v5 offset:24576
    ds_read_b64_tr_b16 a[90:91], v5 offset:28672
    ds_read_b64_tr_b16 a[92:93], v5 offset:24608
    ds_read_b64_tr_b16 a[94:95], v5 offset:28704
    s_waitcnt lgkmcnt(0)
    ds_read_b64_tr_b16 a[96:97], v5 offset:32768
    ds_read_b64_tr_b16 a[98:99], v5 offset:36864
    ds_read_b64_tr_b16 a[100:101], v5 offset:32800
    ds_read_b64_tr_b16 a[102:103], v5 offset:36896
    ds_read_b64_tr_b16 a[104:105], v5 offset:40960
    ds_read_b64_tr_b16 a[106:107], v5 offset:45056
    ds_read_b64_tr_b16 a[108:109], v5 offset:40992
    ds_read_b64_tr_b16 a[110:111], v5 offset:45088
    s_waitcnt lgkmcnt(0)
    ds_read_b64_tr_b16 a[112:113], v5 offset:49152
    ds_read_b64_tr_b16 a[114:115], v5 offset:53248
    ds_read_b64_tr_b16 a[116:117], v5 offset:49184
    ds_read_b64_tr_b16 a[118:119], v5 offset:53280
    ds_read_b64_tr_b16 a[120:121], v5 offset:57344
    ds_read_b64_tr_b16 a[122:123], v5 offset:61440
    ds_read_b64_tr_b16 a[124:125], v5 offset:57376
    ds_read_b64_tr_b16 a[126:127], v5 offset:61472
    s_waitcnt lgkmcnt(0)
    s_waitcnt lgkmcnt(0)
    s_barrier
    v_lshlrev_b32 v2, 4, v1
    s_mul_i32 s64, s44, 8192
    s_add_u32 s46, s64, 0x5000000
    s_mul_i32 s47, s42, 65536
    s_add_u32 s46, s46, s47
    v_add_u32 v3, s46, v2
    s_mul_i32 s46, s51, 32768
    v_add_u32 v4, s46, v2
    v_and_b32 v6, 15, v1
    v_lshlrev_b32 v6, 4, v6
    v_lshrrev_b32 v7, 4, v1
    v_lshl_add_u32 v6, v7, 9, v6
    v_add_u32 v4, s46, v6
    s_lshl_b32 s46, s50, 12
    s_add_u32 s46, s46, 131072
    v_add_u32 v5, s46, v2
    v_and_b32 v7, 7, v1
    v_lshlrev_b32 v7, 9, v7
    s_lshl_b32 s46, s42, 12
    s_add_u32 s46, s46, 0x102000
    v_add_u32 v7, s46, v7
    s_lshl_b32 s46, s42, 16
    s_lshl_b32 s47, s43, 11
    s_add_u32 s46, s46, s47
    s_lshl_b32 s47, s50, 9
    s_add_u32 s46, s46, s47
    s_add_u32 s46, s46, 0x9000000
    v_and_b32 v8, 31, v1
    v_lshlrev_b32 v8, 4, v8
    v_lshrrev_b32 v9, 5, v1
    v_lshl_add_u32 v8, v9, 14, v8
    v_add_u32 v8, s46, v8
    v_add_u32 v9, 0x8000, v8
    s_lshl_b32 s52, s43, 9
    s_lshl_b32 s47, s42, 7
    s_add_u32 s52, s52, s47
    s_add_u32 s52, s52, 0x107400
    s_mov_b32 s60, 0
    s_mov_b32 s61, 0
    s_mov_b32 s62, 0
    s_mov_b32 s63, 0
    s_mov_b32 s67, 0
    s_mov_b32 s68, 3
    v_mov_b32 v15, 147456
    v_mov_b32 v14, 0
    ds_write_b32 v15, v14 offset:4
L_g_restart_150:
    s_cmp_lg_u32 s44, 0
    s_cbranch_scc1 L_g_nsp_151
    s_mov_b32 s70, 0
L_g_sp_157:
    s_add_u32 s54, s60, 0
    s_add_u32 s55, s54, 0
    s_and_b32 s46, s55, 3
    s_lshl_b32 s46, s46, 7
    buffer_load_dword v11, v7, s[12:15], s46 offen sc1
    s_add_u32 s55, s54, 1
    s_and_b32 s46, s55, 3
    s_lshl_b32 s46, s46, 7
    buffer_load_dword v12, v7, s[12:15], s46 offen sc1
    s_add_u32 s55, s54, 2
    s_and_b32 s46, s55, 3
    s_lshl_b32 s46, s46, 7
    buffer_load_dword v13, v7, s[12:15], s46 offen sc1
    s_waitcnt vmcnt(0)
    v_cmp_ge_u32 vcc, s60, v11
    s_add_u32 s70, s70, 1
    s_cbranch_vccz L_g_sp_157_ok
    s_sleep 8
    s_cmp_lt_u32 s70, 524288
    s_cbranch_scc1 L_g_sp_157
    s_branch L_c_done_1
L_g_sp_157_ok:
    s_mov_b32 s46, s54
    v_cmp_ge_u32 vcc, s46, v11
    s_nop 0
    s_cbranch_vccnz L_g_le_158
    s_add_u32 s46, s46, 1
    v_cmp_ge_u32 vcc, s46, v12
    s_nop 0
    s_cbranch_vccnz L_g_le_158
    s_add_u32 s46, s46, 1
    v_cmp_ge_u32 vcc, s46, v13
    s_nop 0
    s_cbranch_vccnz L_g_le_158
    s_add_u32 s46, s46, 1
L_g_le_158:
    v_mov_b32 v11, s46
    ds_write_b32 v15, v11
L_g_nsp_151:
    s_waitcnt lgkmcnt(0)
    s_barrier
    ds_read_b32 v14, v15
    s_waitcnt lgkmcnt(0)
    v_readfirstlane_b32 s66, v14
    s_nop 3
L_g_restart_150_go:
    s_mov_b32 s69, 0
    s_cmp_gt_u32 s62, s60
    s_cbranch_scc1 L_g_nd_159
    s_cmp_ge_u32 s62, s66
    s_cbranch_scc1 L_g_nd_159
    s_add_u32 s47, s61, 4096
    s_add_u32 m0, s64, 0
    s_nop 0
    buffer_load_dwordx4 v3, s[12:15], s61 offen offset:0 sc1 lds
    buffer_load_dwordx4 v3, s[12:15], s61 offen offset:1024 sc1 lds
    buffer_load_dwordx4 v3, s[12:15], s61 offen offset:2048 sc1 lds
    buffer_load_dwordx4 v3, s[12:15], s61 offen offset:3072 sc1 lds
    s_add_u32 m0, s64, 4096
    s_nop 0
    buffer_load_dwordx4 v3, s[12:15], s47 offen offset:0 sc1 lds
    buffer_load_dwordx4 v3, s[12:15], s47 offen offset:1024 sc1 lds
    buffer_load_dwordx4 v3, s[12:15], s47 offen offset:2048 sc1 lds
    buffer_load_dwordx4 v3, s[12:15], s47 offen offset:3072 sc1 lds
    s_add_u32 s61, s61, 262144
    s_add_u32 s62, s62, 1
    s_xor_b32 s64, s64, 0x10000
    s_mov_b32 s69, 1
L_g_nd_159:
    s_cmp_eq_u32 s51, 1
    s_cbranch_scc1 L_g_g1r_152
    s_add_u32 s59, s60, 1
    s_mov_b32 s69, 0
    s_cmp_gt_u32 s62, s59
    s_cbranch_scc1 L_g_nd_160
    s_cmp_ge_u32 s62, s66
    s_cbranch_scc1 L_g_nd_160
    s_add_u32 s47, s61, 4096
    s_add_u32 m0, s64, 0
    s_nop 0
    buffer_load_dwordx4 v3, s[12:15], s61 offen offset:0 sc1 lds
    buffer_load_dwordx4 v3, s[12:15], s61 offen offset:1024 sc1 lds
    buffer_load_dwordx4 v3, s[12:15], s61 offen offset:2048 sc1 lds
    buffer_load_dwordx4 v3, s[12:15], s61 offen offset:3072 sc1 lds
    s_add_u32 m0, s64, 4096
    s_nop 0
    buffer_load_dwordx4 v3, s[12:15], s47 offen offset:0 sc1 lds
    buffer_load_dwordx4 v3, s[12:15], s47 offen offset:1024 sc1 lds
    buffer_load_dwordx4 v3, s[12:15], s47 offen offset:2048 sc1 lds
    buffer_load_dwordx4 v3, s[12:15], s47 offen offset:3072 sc1 lds
    s_add_u32 s61, s61, 262144
    s_add_u32 s62, s62, 1
    s_xor_b32 s64, s64, 0x10000
    s_mov_b32 s69, 1
L_g_nd_160:
    s_cmp_eq_u32 s69, 1
    s_cbranch_scc1 L_g_w0_161
    s_waitcnt vmcnt(0)
L_g_w0_161:
    s_waitcnt vmcnt(8)
    s_mov_b32 s65, 1
L_g_loop0_153:
    s_barrier
    s_cmp_eq_u32 s65, 0
    s_cbranch_scc1 L_g_pr_162
    ds_read_b128 v[32:35], v4 offset:0
    ds_read_b128 v[36:39], v4 offset:256
    ds_read_b128 v[40:43], v4 offset:2048
    ds_read_b128 v[44:47], v4 offset:2304
    ds_read_b128 v[48:51], v4 offset:4096
    ds_read_b128 v[52:55], v4 offset:4352
    ds_read_b128 v[56:59], v4 offset:6144
    ds_read_b128 v[60:63], v4 offset:6400
L_g_pr_162:
    ds_read_b32 v14, v15
    s_cmp_lg_u32 s44, 0
    s_cbranch_scc1 L_g_nl_163
    s_add_u32 s54, s60, 1
    s_add_u32 s55, s54, 0
    s_and_b32 s46, s55, 3
    s_lshl_b32 s46, s46, 7
    buffer_load_dword v11, v7, s[12:15], s46 offen sc1
    s_add_u32 s55, s54, 1
    s_and_b32 s46, s55, 3
    s_lshl_b32 s46, s46, 7
    buffer_load_dword v12, v7, s[12:15], s46 offen sc1
    s_add_u32 s55, s54, 2
    s_and_b32 s46, s55, 3
    s_lshl_b32 s46, s46, 7
    buffer_load_dword v13, v7, s[12:15], s46 offen sc1
L_g_nl_163:
    s_setprio 1
    s_waitcnt lgkmcnt(7)
    v_mfma_f32_16x16x32_bf16 v[16:19], v[32:35], a[0:3], 0
    v_mfma_f32_16x16x32_bf16 v[20:23], v[32:35], a[4:7], 0
    ds_read_b128 v[32:35], v4 offset:8192
    s_waitcnt lgkmcnt(7)
    v_mfma_f32_16x16x32_bf16 v[24:27], v[36:39], a[0:3], 0
    v_mfma_f32_16x16x32_bf16 v[28:31], v[36:39], a[4:7], 0
    ds_read_b128 v[36:39], v4 offset:8448
    s_waitcnt lgkmcnt(7)
    v_mfma_f32_16x16x32_bf16 v[16:19], v[40:43], a[8:11], v[16:19]
    v_mfma_f32_16x16x32_bf16 v[20:23], v[40:43], a[12:15], v[20:23]
    ds_read_b128 v[40:43], v4 offset:10240
    s_waitcnt lgkmcnt(7)
    v_mfma_f32_16x16x32_bf16 v[24:27], v[44:47], a[8:11], v[24:27]
    v_mfma_f32_16x16x32_bf16 v[28:31], v[44:47], a[12:15], v[28:31]
    ds_read_b128 v[44:47], v4 offset:10496
    s_waitcnt lgkmcnt(7)
    v_mfma_f32_16x16x32_bf16 v[16:19], v[48:51], a[16:19], v[16:19]
    v_mfma_f32_16x16x32_bf16 v[20:23], v[48:51], a[20:23], v[20:23]
    ds_read_b128 v[48:51], v4 offset:12288
    s_waitcnt lgkmcnt(7)
    v_mfma_f32_16x16x32_bf16 v[24:27], v[52:55], a[16:19], v[24:27]
    v_mfma_f32_16x16x32_bf16 v[28:31], v[52:55], a[20:23], v[28:31]
    ds_read_b128 v[52:55], v4 offset:12544
    s_waitcnt lgkmcnt(7)
    v_mfma_f32_16x16x32_bf16 v[16:19], v[56:59], a[24:27], v[16:19]
    v_mfma_f32_16x16x32_bf16 v[20:23], v[56:59], a[28:31], v[20:23]
    ds_read_b128 v[56:59], v4 offset:14336
    s_waitcnt lgkmcnt(7)
    v_mfma_f32_16x16x32_bf16 v[24:27], v[60:63], a[24:27], v[24:27]
    v_mfma_f32_16x16x32_bf16 v[28:31], v[60:63], a[28:31], v[28:31]
    ds_read_b128 v[60:63], v4 offset:14592
    s_waitcnt lgkmcnt(7)
    v_mfma_f32_16x16x32_bf16 v[16:19], v[32:35], a[32:35], v[16:19]
    v_mfma_f32_16x16x32_bf16 v[20:23], v[32:35], a[36:39], v[20:23]
    ds_read_b128 v[32:35], v4 offset:16384
    s_waitcnt lgkmcnt(7)
    v_mfma_f32_16x16x32_bf16 v[24:27], v[36:39], a[32:35], v[24:27]
    v_mfma_f32_16x16x32_bf16 v[28:31], v[36:39], a[36:39], v[28:31]
    ds_read_b128 v[36:39], v4 offset:16640
    s_waitcnt lgkmcnt(7)
    v_mfma_f32_16x16x32_bf16 v[16:19], v[40:43], a[40:43], v[16:19]
    v_mfma_f32_16x16x32_bf16 v[20:23], v[40:43], a[44:47], v[20:23]
    ds_read_b128 v[40:43], v4 offset:18432
    s_waitcnt lgkmcnt(7)
    v_mfma_f32_16x16x32_bf16 v[24:27], v[44:47], a[40:43], v[24:27]
    v_mfma_f32_16x16x32_bf16 v[28:31], v[44:47], a[44:47], v[28:31]
    ds_read_b128 v[44:47], v4 offset:18688
    s_waitcnt lgkmcnt(7)
    v_mfma_f32_16x16x32_bf16 v[16:19], v[48:51], a[48:51], v[16:19]
    v_mfma_f32_16x16x32_bf16 v[20:23], v[48:51], a[52:55], v[20:23]
    ds_read_b128 v[48:51], v4 offset:20480
    s_waitcnt lgkmcnt(7)
    v_mfma_f32_16x16x32_bf16 v[24:27], v[52:55], a[48:51], v[24:27]
    v_mfma_f32_16x16x32_bf16 v[28:31], v[52:55], a[52:55], v[28:31]
    ds_read_b128 v[52:55], v4 offset:20736
    s_waitcnt lgkmcnt(7)
    v_mfma_f32_16x16x32_bf16 v[16:19], v[56:59], a[56:59], v[16:19]
    v_mfma_f32_16x16x32_bf16 v[20:23], v[56:59], a[60:63], v[20:23]
    ds_read_b128 v[56:59], v4 offset:22528
    s_waitcnt lgkmcnt(7)
    v_mfma_f32_16x16x32_bf16 v[24:27], v[60:63], a[56:59], v[24:27]
    v_mfma_f32_16x16x32_bf16 v[28:31], v[60:63], a[60:63], v[28:31]
    ds_read_b128 v[60:63], v4 offset:22784
    s_waitcnt lgkmcnt(7)
    v_mfma_f32_16x16x32_bf16 v[16:19], v[32:35], a[64:67], v[16:19]
    v_mfma_f32_16x16x32_bf16 v[20:23], v[32:35], a[68:71], v[20:23]
    ds_read_b128 v[32:35], v4 offset:24576
    s_waitcnt lgkmcnt(7)
    v_mfma_f32_16x16x32_bf16 v[24:27], v[36:39], a[64:67], v[24:27]
    v_mfma_f32_16x16x32_bf16 v[28:31], v[36:39], a[68:71], v[28:31]
    ds_read_b128 v[36:39], v4 offset:24832
    s_waitcnt lgkmcnt(7)
    v_mfma_f32_16x16x32_bf16 v[16:19], v[40:43], a[72:75], v[16:19]
    v_mfma_f32_16x16x32_bf16 v[20:23], v[40:43], a[76:79], v[20:23]
    ds_read_b128 v[40:43], v4 offset:26624
    s_waitcnt lgkmcnt(7)
    v_mfma_f32_16x16x32_bf16 v[24:27], v[44:47], a[72:75], v[24:27]
    v_mfma_f32_16x16x32_bf16 v[28:31], v[44:47], a[76:79], v[28:31]
    ds_read_b128 v[44:47], v4 offset:26880
    s_waitcnt lgkmcnt(7)
    v_mfma_f32_16x16x32_bf16 v[16:19], v[48:51], a[80:83], v[16:19]
    v_mfma_f32_16x16x32_bf16 v[20:23], v[48:51], a[84:87], v[20:23]
    ds_read_b128 v[48:51], v4 offset:28672
    s_waitcnt lgkmcnt(7)
    v_mfma_f32_16x16x32_bf16 v[24:27], v[52:55], a[80:83], v[24:27]
    v_mfma_f32_16x16x32_bf16 v[28:31], v[52:55], a[84:87], v[28:31]
    ds_read_b128 v[52:55], v4 offset:28928
    s_waitcnt lgkmcnt(7)
    v_mfma_f32_16x16x32_bf16 v[16:19], v[56:59], a[88:91], v[16:19]
    v_mfma_f32_16x16x32_bf16 v[20:23], v[56:59], a[92:95], v[20:23]
    ds_read_b128 v[56:59], v4 offset:30720
    s_waitcnt lgkmcnt(7)
    v_mfma_f32_16x16x32_bf16 v[24:27], v[60:63], a[88:91], v[24:27]
    v_mfma_f32_16x16x32_bf16 v[28:31], v[60:63], a[92:95], v[28:31]
    ds_read_b128 v[60:63], v4 offset:30976
    s_waitcnt lgkmcnt(7)
    v_mfma_f32_16x16x32_bf16 v[16:19], v[32:35], a[96:99], v[16:19]
    v_mfma_f32_16x16x32_bf16 v[20:23], v[32:35], a[100:103], v[20:23]
    s_waitcnt lgkmcnt(6)
    v_mfma_f32_16x16x32_bf16 v[24:27], v[36:39], a[96:99], v[24:27]
    v_mfma_f32_16x16x32_bf16 v[28:31], v[36:39], a[100:103], v[28:31]
    s_waitcnt lgkmcnt(5)
    v_mfma_f32_16x16x32_bf16 v[16:19], v[40:43], a[104:107], v[16:19]
    v_mfma_f32_16x16x32_bf16 v[20:23], v[40:43], a[108:111], v[20:23]
    s_waitcnt lgkmcnt(4)
    v_mfma_f32_16x16x32_bf16 v[24:27], v[44:47], a[104:107], v[24:27]
    v_mfma_f32_16x16x32_bf16 v[28:31], v[44:47], a[108:111], v[28:31]
    s_waitcnt lgkmcnt(3)
    v_mfma_f32_16x16x32_bf16 v[16:19], v[48:51], a[112:115], v[16:19]
    v_mfma_f32_16x16x32_bf16 v[20:23], v[48:51], a[116:119], v[20:23]
    s_waitcnt lgkmcnt(2)
    v_mfma_f32_16x16x32_bf16 v[24:27], v[52:55], a[112:115], v[24:27]
    v_mfma_f32_16x16x32_bf16 v[28:31], v[52:55], a[116:119], v[28:31]
    s_waitcnt lgkmcnt(1)
    v_mfma_f32_16x16x32_bf16 v[16:19], v[56:59], a[120:123], v[16:19]
    v_mfma_f32_16x16x32_bf16 v[20:23], v[56:59], a[124:127], v[20:23]
    s_waitcnt lgkmcnt(0)
    v_mfma_f32_16x16x32_bf16 v[24:27], v[60:63], a[120:123], v[24:27]
    v_mfma_f32_16x16x32_bf16 v[28:31], v[60:63], a[124:127], v[28:31]
    v_xor_b32 v4, 0x10000, v4
    s_setprio 0
    s_waitcnt vmcnt(0)
    v_readfirstlane_b32 s66, v14
    s_barrier
    s_nop 6
    ds_write_b128 v5, v[16:19] offset:0
    ds_write_b128 v5, v[20:23] offset:1024
    ds_write_b128 v5, v[24:27] offset:2048
    ds_write_b128 v5, v[28:31] offset:3072
    s_cmp_lg_u32 s44, 0
    s_cbranch_scc1 L_g_ne_164
    s_mov_b32 s46, s54
    v_cmp_ge_u32 vcc, s46, v11
    s_nop 0
    s_cbranch_vccnz L_g_le_167
    s_add_u32 s46, s46, 1
    v_cmp_ge_u32 vcc, s46, v12
    s_nop 0
    s_cbranch_vccnz L_g_le_167
    s_add_u32 s46, s46, 1
    v_cmp_ge_u32 vcc, s46, v13
    s_nop 0
    s_cbranch_vccnz L_g_le_167
    s_add_u32 s46, s46, 1
L_g_le_167:
    v_mov_b32 v11, s46
    ds_write_b32 v15, v11
L_g_ne_164:
    s_add_u32 s60, s60, 1
    s_waitcnt lgkmcnt(0)
    s_mov_b32 s69, 0
    s_cmp_gt_u32 s62, s60
    s_cbranch_scc1 L_g_nd_168
    s_cmp_ge_u32 s62, s66
    s_cbranch_scc1 L_g_nd_168
    s_add_u32 s47, s61, 4096
    s_add_u32 m0, s64, 0
    s_nop 0
    buffer_load_dwordx4 v3, s[12:15], s61 offen offset:0 sc1 lds
    buffer_load_dwordx4 v3, s[12:15], s61 offen offset:1024 sc1 lds
    buffer_load_dwordx4 v3, s[12:15], s61 offen offset:2048 sc1 lds
    buffer_load_dwordx4 v3, s[12:15], s61 offen offset:3072 sc1 lds
    s_add_u32 m0, s64, 4096
    s_nop 0
    buffer_load_dwordx4 v3, s[12:15], s47 offen offset:0 sc1 lds
    buffer_load_dwordx4 v3, s[12:15], s47 offen offset:1024 sc1 lds
    buffer_load_dwordx4 v3, s[12:15], s47 offen offset:2048 sc1 lds
    buffer_load_dwordx4 v3, s[12:15], s47 offen offset:3072 sc1 lds
    s_add_u32 s61, s61, 262144
    s_add_u32 s62, s62, 1
    s_xor_b32 s64, s64, 0x10000
    s_mov_b32 s69, 1
L_g_nd_168:
    s_mov_b32 s65, s69
    s_add_u32 s59, s60, 1
    s_mov_b32 s69, 0
    s_cmp_gt_u32 s62, s59
    s_cbranch_scc1 L_g_nd_169
    s_cmp_ge_u32 s62, s66
    s_cbranch_scc1 L_g_nd_169
    s_add_u32 s47, s61, 4096
    s_add_u32 m0, s64, 0
    s_nop 0
    buffer_load_dwordx4 v3, s[12:15], s61 offen offset:0 sc1 lds
    buffer_load_dwordx4 v3, s[12:15], s61 offen offset:1024 sc1 lds
    buffer_load_dwordx4 v3, s[12:15], s61 offen offset:2048 sc1 lds
    buffer_load_dwordx4 v3, s[12:15], s61 offen offset:3072 sc1 lds
    s_add_u32 m0, s64, 4096
    s_nop 0
    buffer_load_dwordx4 v3, s[12:15], s47 offen offset:0 sc1 lds
    buffer_load_dwordx4 v3, s[12:15], s47 offen offset:1024 sc1 lds
    buffer_load_dwordx4 v3, s[12:15], s47 offen offset:2048 sc1 lds
    buffer_load_dwordx4 v3, s[12:15], s47 offen offset:3072 sc1 lds
    s_add_u32 s61, s61, 262144
    s_add_u32 s62, s62, 1
    s_xor_b32 s64, s64, 0x10000
    s_mov_b32 s69, 1
L_g_nd_169:
    s_cmp_le_u32 s66, s60
    s_cbranch_scc1 L_g_ex0_166
    s_cmp_eq_u32 s65, 0
    s_cbranch_scc1 L_g_nw_165
    s_waitcnt vmcnt(0) lgkmcnt(0)
    s_branch L_g_loop0_153
L_g_nw_165:
    ds_read_b128 v[32:35], v4 offset:0
    ds_read_b128 v[36:39], v4 offset:256
    ds_read_b128 v[40:43], v4 offset:2048
    ds_read_b128 v[44:47], v4 offset:2304
    ds_read_b128 v[48:51], v4 offset:4096
    ds_read_b128 v[52:55], v4 offset:4352
    ds_read_b128 v[56:59], v4 offset:6144
    ds_read_b128 v[60:63], v4 offset:6400
    s_waitcnt lgkmcnt(8)
    s_branch L_g_loop0_153
L_g_ex0_166:
    s_cmp_lg_u32 s44, 0
    s_cbranch_scc1 L_g_ex0_166_n
    s_sleep 6
    s_add_u32 s54, s60, 0
    s_add_u32 s55, s54, 0
    s_and_b32 s46, s55, 3
    s_lshl_b32 s46, s46, 7
    buffer_load_dword v11, v7, s[12:15], s46 offen sc1
    s_add_u32 s55, s54, 1
    s_and_b32 s46, s55, 3
    s_lshl_b32 s46, s46, 7
    buffer_load_dword v12, v7, s[12:15], s46 offen sc1
    s_add_u32 s55, s54, 2
    s_and_b32 s46, s55, 3
    s_lshl_b32 s46, s46, 7
    buffer_load_dword v13, v7, s[12:15], s46 offen sc1
    s_waitcnt vmcnt(0)
    s_mov_b32 s46, s54
    v_cmp_ge_u32 vcc, s46, v11
    s_nop 0
    s_cbranch_vccnz L_g_le_170
    s_add_u32 s46, s46, 1
    v_cmp_ge_u32 vcc, s46, v12
    s_nop 0
    s_cbranch_vccnz L_g_le_170
    s_add_u32 s46, s46, 1
    v_cmp_ge_u32 vcc, s46, v13
    s_nop 0
    s_cbranch_vccnz L_g_le_170
    s_add_u32 s46, s46, 1
L_g_le_170:
    v_mov_b32 v11, s46
    ds_write_b32 v15, v11
L_g_ex0_166_n:
    s_waitcnt lgkmcnt(0)
    s_barrier
    ds_read_b32 v14, v15
    s_waitcnt lgkmcnt(0)
    v_readfirstlane_b32 s66, v14
    s_barrier
    s_cmp_gt_u32 s66, s60
    s_cbranch_scc1 L_g_restart_150_go
    s_branch L_g_tail_155
L_g_g1r_152:
    s_mov_b32 s65, 1
    s_branch L_g_loop1_154_e
L_g_loop1_154:
    s_mov_b32 s65, 0
L_g_loop1_154_e:
    s_barrier
    ds_read_b32 v14, v15
    s_bitcmp1_b32 s67, 1
    s_cbranch_scc0 L_g_nfl_171
    s_sub_u32 s59, s60, 2
    s_cmp_lg_u32 s44, 4
    s_cbranch_scc1 L_sf_176
    v_mov_b32 v10, s59
    v_add_u32 v10, 1, v10
    v_mov_b32 v11, 0
    s_mov_b64 exec, 1
    buffer_store_dword v10, v11, s[12:15], s52 offen sc1
    s_mov_b64 exec, -1
L_sf_176:
L_g_nfl_171:
    s_bitcmp1_b32 s67, 0
    s_cbranch_scc0 L_g_nep_172
    ds_read_b128 v[80:83], v5 offset:0
    ds_read_b128 v[84:87], v5 offset:1024
    ds_read_b128 v[88:91], v5 offset:2048
    ds_read_b128 v[92:95], v5 offset:3072
    s_nop 7
    s_waitcnt lgkmcnt(3)
    v_add_f32 v80, v80, v16
    v_add_f32 v81, v81, v17
    v_add_f32 v82, v82, v18
    v_add_f32 v83, v83, v19
    s_waitcnt lgkmcnt(2)
    v_add_f32 v84, v84, v20
    v_add_f32 v85, v85, v21
    v_add_f32 v86, v86, v22
    v_add_f32 v87, v87, v23
    s_waitcnt lgkmcnt(1)
    v_add_f32 v88, v88, v24
    v_add_f32 v89, v89, v25
    v_add_f32 v90, v90, v26
    v_add_f32 v91, v91, v27
    s_waitcnt lgkmcnt(0)
    v_add_f32 v92, v92, v28
    v_add_f32 v93, v93, v29
    v_add_f32 v94, v94, v30
    v_add_f32 v95, v95, v31
    v_cvt_pk_bf16_f32 v104, v80, v81
    v_cvt_pk_bf16_f32 v105, v82, v83
    v_cvt_pk_bf16_f32 v106, v84, v85
    v_cvt_pk_bf16_f32 v107, v86, v87
    s_nop 1
    v_permlane16_swap_b32 v104, v106
    v_permlane16_swap_b32 v105, v107
    buffer_store_dwordx4 v[104:107], v8, s[12:15], s63 offen sc1
    v_cvt_pk_bf16_f32 v108, v88, v89
    v_cvt_pk_bf16_f32 v109, v90, v91
    v_cvt_pk_bf16_f32 v110, v92, v93
    v_cvt_pk_bf16_f32 v111, v94, v95
    s_nop 1
    v_permlane16_swap_b32 v108, v110
    v_permlane16_swap_b32 v109, v111
    buffer_store_dwordx4 v[108:111], v9, s[12:15], s63 offen sc1
    s_add_u32 s63, s63, 262144
L_g_nep_172:
    s_waitcnt lgkmcnt(0)
    v_readfirstlane_b32 s66, v14
    s_nop 3
    s_mov_b32 s69, 0
    s_cmp_gt_u32 s62, s60
    s_cbranch_scc1 L_g_nd_177
    s_cmp_ge_u32 s62, s66
    s_cbranch_scc1 L_g_nd_177
    s_add_u32 s47, s61, 4096
    s_add_u32 m0, s64, 0
    s_nop 0
    buffer_load_dwordx4 v3, s[12:15], s61 offen offset:0 sc1 lds
    buffer_load_dwordx4 v3, s[12:15], s61 offen offset:1024 sc1 lds
    buffer_load_dwordx4 v3, s[12:15], s61 offen offset:2048 sc1 lds
    buffer_load_dwordx4 v3, s[12:15], s61 offen offset:3072 sc1 lds
    s_add_u32 m0, s64, 4096
    s_nop 0
    buffer_load_dwordx4 v3, s[12:15], s47 offen offset:0 sc1 lds
    buffer_load_dwordx4 v3, s[12:15], s47 offen offset:1024 sc1 lds
    buffer_load_dwordx4 v3, s[12:15], s47 offen offset:2048 sc1 lds
    buffer_load_dwordx4 v3, s[12:15], s47 offen offset:3072 sc1 lds
    s_add_u32 s61, s61, 262144
    s_add_u32 s62, s62, 1
    s_xor_b32 s64, s64, 0x10000
    s_mov_b32 s69, 1
L_g_nd_177:
    s_or_b32 s65, s65, s69
    s_add_u32 s59, s60, 1
    s_mov_b32 s69, 0
    s_cmp_gt_u32 s62, s59
    s_cbranch_scc1 L_g_nd_178
    s_cmp_ge_u32 s62, s66
    s_cbranch_scc1 L_g_nd_178
    s_add_u32 s47, s61, 4096
    s_add_u32 m0, s64, 0
    s_nop 0
    buffer_load_dwordx4 v3, s[12:15], s61 offen offset:0 sc1 lds
    buffer_load_dwordx4 v3, s[12:15], s61 offen offset:1024 sc1 lds
    buffer_load_dwordx4 v3, s[12:15], s61 offen offset:2048 sc1 lds
    buffer_load_dwordx4 v3, s[12:15], s61 offen offset:3072 sc1 lds
    s_add_u32 m0, s64, 4096
    s_nop 0
    buffer_load_dwordx4 v3, s[12:15], s47 offen offset:0 sc1 lds
    buffer_load_dwordx4 v3, s[12:15], s47 offen offset:1024 sc1 lds
    buffer_load_dwordx4 v3, s[12:15], s47 offen offset:2048 sc1 lds
    buffer_load_dwordx4 v3, s[12:15], s47 offen offset:3072 sc1 lds
    s_add_u32 s61, s61, 262144
    s_add_u32 s62, s62, 1
    s_xor_b32 s64, s64, 0x10000
    s_mov_b32 s69, 1
L_g_nd_178:
    s_cmp_eq_u32 s65, 0
    s_cbranch_scc1 L_g_nw1_173
    s_waitcnt vmcnt(0)
    s_barrier
    ds_read_b128 v[32:35], v4 offset:0
    ds_read_b128 v[36:39], v4 offset:256
    ds_read_b128 v[40:43], v4 offset:2048
    ds_read_b128 v[44:47], v4 offset:2304
    ds_read_b128 v[48:51], v4 offset:4096
    ds_read_b128 v[52:55], v4 offset:4352
    ds_read_b128 v[56:59], v4 offset:6144
    ds_read_b128 v[60:63], v4 offset:6400
    s_branch L_g_jn_175
L_g_nw1_173:
    ds_read_b128 v[32:35], v4 offset:0
    ds_read_b128 v[36:39], v4 offset:256
    ds_read_b128 v[40:43], v4 offset:2048
    ds_read_b128 v[44:47], v4 offset:2304
    ds_read_b128 v[48:51], v4 offset:4096
    ds_read_b128 v[52:55], v4 offset:4352
    ds_read_b128 v[56:59], v4 offset:6144
    ds_read_b128 v[60:63], v4 offset:6400
    s_barrier
L_g_jn_175:
    s_setprio 1
    s_waitcnt lgkmcnt(7)
    v_mfma_f32_16x16x32_bf16 v[16:19], v[32:35], a[0:3], 0
    v_mfma_f32_16x16x32_bf16 v[20:23], v[32:35], a[4:7], 0
    ds_read_b128 v[32:35], v4 offset:8192
    s_waitcnt lgkmcnt(7)
    v_mfma_f32_16x16x32_bf16 v[24:27], v[36:39], a[0:3], 0
    v_mfma_f32_16x16x32_bf16 v[28:31], v[36:39], a[4:7], 0
    ds_read_b128 v[36:39], v4 offset:8448
    s_waitcnt lgkmcnt(7)
    v_mfma_f32_16x16x32_bf16 v[16:19], v[40:43], a[8:11], v[16:19]
    v_mfma_f32_16x16x32_bf16 v[20:23], v[40:43], a[12:15], v[20:23]
    ds_read_b128 v[40:43], v4 offset:10240
    s_waitcnt lgkmcnt(7)
    v_mfma_f32_16x16x32_bf16 v[24:27], v[44:47], a[8:11], v[24:27]
    v_mfma_f32_16x16x32_bf16 v[28:31], v[44:47], a[12:15], v[28:31]
    ds_read_b128 v[44:47], v4 offset:10496
    s_waitcnt lgkmcnt(7)
    v_mfma_f32_16x16x32_bf16 v[16:19], v[48:51], a[16:19], v[16:19]
    v_mfma_f32_16x16x32_bf16 v[20:23], v[48:51], a[20:23], v[20:23]
    ds_read_b128 v[48:51], v4 offset:12288
    s_waitcnt lgkmcnt(7)
    v_mfma_f32_16x16x32_bf16 v[24:27], v[52:55], a[16:19], v[24:27]
    v_mfma_f32_16x16x32_bf16 v[28:31], v[52:55], a[20:23], v[28:31]
    ds_read_b128 v[52:55], v4 offset:12544
    s_waitcnt lgkmcnt(7)
    v_mfma_f32_16x16x32_bf16 v[16:19], v[56:59], a[24:27], v[16:19]
    v_mfma_f32_16x16x32_bf16 v[20:23], v[56:59], a[28:31], v[20:23]
    ds_read_b128 v[56:59], v4 offset:14336
    s_waitcnt lgkmcnt(7)
    v_mfma_f32_16x16x32_bf16 v[24:27], v[60:63], a[24:27], v[24:27]
    v_mfma_f32_16x16x32_bf16 v[28:31], v[60:63], a[28:31], v[28:31]
    ds_read_b128 v[60:63], v4 offset:14592
    s_waitcnt lgkmcnt(7)
    v_mfma_f32_16x16x32_bf16 v[16:19], v[32:35], a[32:35], v[16:19]
    v_mfma_f32_16x16x32_bf16 v[20:23], v[32:35], a[36:39], v[20:23]
    ds_read_b128 v[32:35], v4 offset:16384
    s_waitcnt lgkmcnt(7)
    v_mfma_f32_16x16x32_bf16 v[24:27], v[36:39], a[32:35], v[24:27]
    v_mfma_f32_16x16x32_bf16 v[28:31], v[36:39], a[36:39], v[28:31]
    ds_read_b128 v[36:39], v4 offset:16640
    s_waitcnt lgkmcnt(7)
    v_mfma_f32_16x16x32_bf16 v[16:19], v[40:43], a[40:43], v[16:19]
    v_mfma_f32_16x16x32_bf16 v[20:23], v[40:43], a[44:47], v[20:23]
    ds_read_b128 v[40:43], v4 offset:18432
    s_waitcnt lgkmcnt(7)
    v_mfma_f32_16x16x32_bf16 v[24:27], v[44:47], a[40:43], v[24:27]
    v_mfma_f32_16x16x32_bf16 v[28:31], v[44:47], a[44:47], v[28:31]
    ds_read_b128 v[44:47], v4 offset:18688
    s_waitcnt lgkmcnt(7)
    v_mfma_f32_16x16x32_bf16 v[16:19], v[48:51], a[48:51], v[16:19]
    v_mfma_f32_16x16x32_bf16 v[20:23], v[48:51], a[52:55], v[20:23]
    ds_read_b128 v[48:51], v4 offset:20480
    s_waitcnt lgkmcnt(7)
    v_mfma_f32_16x16x32_bf16 v[24:27], v[52:55], a[48:51], v[24:27]
    v_mfma_f32_16x16x32_bf16 v[28:31], v[52:55], a[52:55], v[28:31]
    ds_read_b128 v[52:55], v4 offset:20736
    s_waitcnt lgkmcnt(7)
    v_mfma_f32_16x16x32_bf16 v[16:19], v[56:59], a[56:59], v[16:19]
    v_mfma_f32_16x16x32_bf16 v[20:23], v[56:59], a[60:63], v[20:23]
    ds_read_b128 v[56:59], v4 offset:22528
    s_waitcnt lgkmcnt(7)
    v_mfma_f32_16x16x32_bf16 v[24:27], v[60:63], a[56:59], v[24:27]
    v_mfma_f32_16x16x32_bf16 v[28:31], v[60:63], a[60:63], v[28:31]
    ds_read_b128 v[60:63], v4 offset:22784
    s_waitcnt lgkmcnt(7)
    v_mfma_f32_16x16x32_bf16 v[16:19], v[32:35], a[64:67], v[16:19]
    v_mfma_f32_16x16x32_bf16 v[20:23], v[32:35], a[68:71], v[20:23]
    ds_read_b128 v[32:35], v4 offset:24576
    s_waitcnt lgkmcnt(7)
    v_mfma_f32_16x16x32_bf16 v[24:27], v[36:39], a[64:67], v[24:27]
    v_mfma_f32_16x16x32_bf16 v[28:31], v[36:39], a[68:71], v[28:31]
    ds_read_b128 v[36:39], v4 offset:24832
    s_waitcnt lgkmcnt(7)
    v_mfma_f32_16x16x32_bf16 v[16:19], v[40:43], a[72:75], v[16:19]
    v_mfma_f32_16x16x32_bf16 v[20:23], v[40:43], a[76:79], v[20:23]
    ds_read_b128 v[40:43], v4 offset:26624
    s_waitcnt lgkmcnt(7)
    v_mfma_f32_16x16x32_bf16 v[24:27], v[44:47], a[72:75], v[24:27]
    v_mfma_f32_16x16x32_bf16 v[28:31], v[44:47], a[76:79], v[28:31]
    ds_read_b128 v[44:47], v4 offset:26880
    s_waitcnt lgkmcnt(7)
    v_mfma_f32_16x16x32_bf16 v[16:19], v[48:51], a[80:83], v[16:19]
    v_mfma_f32_16x16x32_bf16 v[20:23], v[48:51], a[84:87], v[20:23]
    ds_read_b128 v[48:51], v4 offset:28672
    s_waitcnt lgkmcnt(7)
    v_mfma_f32_16x16x32_bf16 v[24:27], v[52:55], a[80:83], v[24:27]
    v_mfma_f32_16x16x32_bf16 v[28:31], v[52:55], a[84:87], v[28:31]
    ds_read_b128 v[52:55], v4 offset:28928
    s_waitcnt lgkmcnt(7)
    v_mfma_f32_16x16x32_bf16 v[16:19], v[56:59], a[88:91], v[16:19]
    v_mfma_f32_16x16x32_bf16 v[20:23], v[56:59], a[92:95], v[20:23]
    ds_read_b128 v[56:59], v4 offset:30720
    s_waitcnt lgkmcnt(7)
    v_mfma_f32_16x16x32_bf16 v[24:27], v[60:63], a[88:91], v[24:27]
    v_mfma_f32_16x16x32_bf16 v[28:31], v[60:63], a[92:95], v[28:31]
    ds_read_b128 v[60:63], v4 offset:30976
    s_waitcnt lgkmcnt(7)
    v_mfma_f32_16x16x32_bf16 v[16:19], v[32:35], a[96:99], v[16:19]
    v_mfma_f32_16x16x32_bf16 v[20:23], v[32:35], a[100:103], v[20:23]
    s_waitcnt lgkmcnt(6)
    v_mfma_f32_16x16x32_bf16 v[24:27], v[36:39], a[96:99], v[24:27]
    v_mfma_f32_16x16x32_bf16 v[28:31], v[36:39], a[100:103], v[28:31]
    s_waitcnt lgkmcnt(5)
    v_mfma_f32_16x16x32_bf16 v[16:19], v[40:43], a[104:107], v[16:19]
    v_mfma_f32_16x16x32_bf16 v[20:23], v[40:43], a[108:111], v[20:23]
    s_waitcnt lgkmcnt(4)
    v_mfma_f32_16x16x32_bf16 v[24:27], v[44:47], a[104:107], v[24:27]
    v_mfma_f32_16x16x32_bf16 v[28:31], v[44:47], a[108:111], v[28:31]
    s_waitcnt lgkmcnt(3)
    v_mfma_f32_16x16x32_bf16 v[16:19], v[48:51], a[112:115], v[16:19]
    v_mfma_f32_16x16x32_bf16 v[20:23], v[48:51], a[116:119], v[20:23]
    s_waitcnt lgkmcnt(2)
    v_mfma_f32_16x16x32_bf16 v[24:27], v[52:55], a[112:115], v[24:27]
    v_mfma_f32_16x16x32_bf16 v[28:31], v[52:55], a[116:119], v[28:31]
    s_waitcnt lgkmcnt(1)
    v_mfma_f32_16x16x32_bf16 v[16:19], v[56:59], a[120:123], v[16:19]
    v_mfma_f32_16x16x32_bf16 v[20:23], v[56:59], a[124:127], v[20:23]
    s_waitcnt lgkmcnt(0)
    v_mfma_f32_16x16x32_bf16 v[24:27], v[60:63], a[120:123], v[24:27]
    v_mfma_f32_16x16x32_bf16 v[28:31], v[60:63], a[124:127], v[28:31]
    v_xor_b32 v4, 0x10000, v4
    s_setprio 0
    s_waitcnt vmcnt(0)
    s_lshl_b32 s67, s67, 1
    s_or_b32 s67, s67, 1
    s_add_u32 s60, s60, 1
    s_cmp_gt_u32 s66, s60
    s_cbranch_scc1 L_g_loop1_154
    s_barrier
    ds_read_b32 v14, v15
    s_waitcnt lgkmcnt(0)
    v_readfirstlane_b32 s66, v14
    s_barrier
    s_mov_b32 s69, 0
    s_cmp_gt_u32 s62, s60
    s_cbranch_scc1 L_g_nd_179
    s_cmp_ge_u32 s62, s66
    s_cbranch_scc1 L_g_nd_179
    s_add_u32 s47, s61, 4096
    s_add_u32 m0, s64, 0
    s_nop 0
    buffer_load_dwordx4 v3, s[12:15], s61 offen offset:0 sc1 lds
    buffer_load_dwordx4 v3, s[12:15], s61 offen offset:1024 sc1 lds
    buffer_load_dwordx4 v3, s[12:15], s61 offen offset:2048 sc1 lds
    buffer_load_dwordx4 v3, s[12:15], s61 offen offset:3072 sc1 lds
    s_add_u32 m0, s64, 4096
    s_nop 0
    buffer_load_dwordx4 v3, s[12:15], s47 offen offset:0 sc1 lds
    buffer_load_dwordx4 v3, s[12:15], s47 offen offset:1024 sc1 lds
    buffer_load_dwordx4 v3, s[12:15], s47 offen offset:2048 sc1 lds
    buffer_load_dwordx4 v3, s[12:15], s47 offen offset:3072 sc1 lds
    s_add_u32 s61, s61, 262144
    s_add_u32 s62, s62, 1
    s_xor_b32 s64, s64, 0x10000
    s_mov_b32 s69, 1
L_g_nd_179:
    s_sub_u32 s59, s60, 1
    ds_read_b128 v[80:83], v5 offset:0
    ds_read_b128 v[84:87], v5 offset:1024
    ds_read_b128 v[88:91], v5 offset:2048
    ds_read_b128 v[92:95], v5 offset:3072
    s_nop 7
    s_waitcnt lgkmcnt(3)
    v_add_f32 v80, v80, v16
    v_add_f32 v81, v81, v17
    v_add_f32 v82, v82, v18
    v_add_f32 v83, v83, v19
    s_waitcnt lgkmcnt(2)
    v_add_f32 v84, v84, v20
    v_add_f32 v85, v85, v21
    v_add_f32 v86, v86, v22
    v_add_f32 v87, v87, v23
    s_waitcnt lgkmcnt(1)
    v_add_f32 v88, v88, v24
    v_add_f32 v89, v89, v25
    v_add_f32 v90, v90, v26
    v_add_f32 v91, v91, v27
    s_waitcnt lgkmcnt(0)
    v_add_f32 v92, v92, v28
    v_add_f32 v93, v93, v29
    v_add_f32 v94, v94, v30
    v_add_f32 v95, v95, v31
    v_cvt_pk_bf16_f32 v104, v80, v81
    v_cvt_pk_bf16_f32 v105, v82, v83
    v_cvt_pk_bf16_f32 v106, v84, v85
    v_cvt_pk_bf16_f32 v107, v86, v87
    s_nop 1
    v_permlane16_swap_b32 v104, v106
    v_permlane16_swap_b32 v105, v107
    buffer_store_dwordx4 v[104:107], v8, s[12:15], s63 offen sc1
    v_cvt_pk_bf16_f32 v108, v88, v89
    v_cvt_pk_bf16_f32 v109, v90, v91
    v_cvt_pk_bf16_f32 v110, v92, v93
    v_cvt_pk_bf16_f32 v111, v94, v95
    s_nop 1
    v_permlane16_swap_b32 v108, v110
    v_permlane16_swap_b32 v109, v111
    buffer_store_dwordx4 v[108:111], v9, s[12:15], s63 offen sc1
    s_add_u32 s63, s63, 262144
    v_mov_b32 v10, 1
    s_mov_b64 exec, 1
    s_waitcnt vmcnt(0)
    ds_add_rtn_u32 v10, v15, v10 offset:4
    s_waitcnt lgkmcnt(0)
    v_readfirstlane_b32 s46, v10
    s_mov_b64 exec, -1
    s_mov_b32 s67, 0
    s_nop 1
    s_cmp_lg_u32 s46, s68
    s_cbranch_scc1 L_g_g1f_156
    v_mov_b32 v10, s59
    v_add_u32 v10, 1, v10
    v_mov_b32 v11, 0
    s_mov_b64 exec, 1
    buffer_store_dword v10, v11, s[12:15], s52 offen sc1
    s_mov_b64 exec, -1
L_sf_180:
L_g_g1f_156:
    s_add_u32 s68, s68, 4
    s_cmp_gt_u32 s66, s60
    s_cbranch_scc1 L_g_g1r_152
L_g_tail_155:
    s_cmp_lt_u32 s60, 64
    s_cbranch_scc1 L_g_restart_150
    s_barrier
    s_branch L_c_done_1
L_c_chain_7:
    v_mov_b32 v4, 0
    v_mov_b32 v5, 0
    v_mov_b32 v6, 0
    v_mov_b32 v7, 0
    v_mov_b32 v8, 0
    v_mov_b32 v9, 0
    v_mov_b32 v10, 0
    v_mov_b32 v11, 0
    v_mov_b32 v12, 0
    v_mov_b32 v13, 0
    v_mov_b32 v14, 0
    v_mov_b32 v15, 0
    v_mov_b32 v32, -1
    v_mov_b32 v33, -1
    v_mov_b32 v34, -1
    v_mov_b32 v35, -1
    v_lshlrev_b32 v2, 4, v1
    s_lshl_b32 s45, s40, 16
    s_lshl_b32 s46, s41, 12
    s_add_u32 s45, s45, s46
    s_and_b32 s46, s44, 3
    s_lshl_b32 s46, s46, 10
    s_add_u32 s45, s45, s46
    s_lshr_b32 s46, s44, 2
    s_lshl_b32 s46, s46, 19
    s_add_u32 s45, s45, s46
    s_add_u32 s45, s45, 0x7000000
    buffer_store_dwordx4 v[32:35], v2, s[12:15], s45 offen sc1
    s_lshl_b32 s45, s40, 15
    s_lshl_b32 s46, s41, 11
    s_add_u32 s45, s45, s46
    s_lshl_b32 s46, s44, 8
    s_add_u32 s45, s45, s46
    s_add_u32 s45, s45, 0x7100000
    s_mov_b64 exec, 0xffff
    buffer_store_dwordx4 v[32:35], v2, s[12:15], s45 offen sc1
    s_mov_b64 exec, -1
    s_load_dwordx4 s[4:7], s[0:1], 16
    s_load_dwordx2 s[8:9], s[0:1], 32
    v_lshrrev_b32 v2, 3, v0
    v_lshlrev_b32 v2, 13, v2
    v_and_b32 v3, 7, v0
    v_lshl_add_u32 v2, v3, 7, v2
    s_lshl_b32 s45, s41, 19
    s_lshl_b32 s46, s40, 10
    s_add_u32 s45, s45, s46
    s_waitcnt lgkmcnt(0)
    s_mov_b32 s24, s6
    s_and_b32 s25, s7, 0xffff
    s_mov_b32 s26, 0x800000
    s_mov_b32 s27, 0x00020000
    buffer_load_dword v109, v2, s[24:27], s45 offen
    s_mov_b32 s24, s8
    s_and_b32 s25, s9, 0xffff
    s_mov_b32 s26, 0x800000
    s_mov_b32 s27, 0x00020000
    buffer_load_dword v110, v2, s[24:27], s45 offen
    s_mov_b32 s24, s4
    s_and_b32 s25, s5, 0xffff
    s_mov_b32 s26, 0x800000
    s_mov_b32 s27, 0x00020000
    buffer_load_dword v111, v2, s[24:27], s45 offen
    v_lshlrev_b32 v2, 4, v1
    v_and_b32 v3, 8, v1
    v_cmp_eq_u32 vcc, 0, v3
    v_mov_b32 v3, 0xeeeeeeee
    v_mov_b32 v4, 0x44444444
    v_cndmask_b32 v3, v3, v4, vcc
    v_and_b32 v100, 15, v1
    v_lshrrev_b32 v101, 4, v1
    v_and_b32 v102, 1, v101
    v_lshrrev_b32 v103, 1, v101
    v_lshlrev_b32 v104, 2, v102
    v_lshl_add_u32 v104, v103, 1, v104
    v_and_b32 v105, 1, v1
    v_add_u32 v104, v104, v105
    v_and_b32 v106, 7, v1
    v_bfe_u32 v107, v1, 3, 1
    s_lshr_b32 s42, s41, 2
    s_and_b32 s43, s41, 3
    s_lshl_b32 s49, s40, 2
    s_add_u32 s49, s49, s42
    s_lshl_b32 s45, s44, 14
    v_lshlrev_b32 v22, 3, v101
    v_bfe_u32 v23, v1, 2, 2
    v_add_u32 v22, v22, v23
    v_and_b32 v23, 3, v1
    v_lshlrev_b32 v24, 3, v23
    v_lshl_add_u32 v20, v22, 6, v24
    v_lshl_add_u32 v21, v22, 7, v24
    v_lshrrev_b32 v22, 2, v1
    v_lshlrev_b32 v23, 4, v23
    v_lshl_add_u32 v24, v22, 13, v23
    v_lshrrev_b32 v22, 3, v1
    v_lshlrev_b32 v23, 4, v106
    v_lshl_add_u32 v25, v22, 11, v23
    s_cmp_ge_u32 s44, 4
    s_cbranch_scc1 L_v_init_181
    s_lshr_b32 s50, s44, 1
    s_and_b32 s51, s44, 1
    s_load_dwordx4 s[4:7], s[0:1], 16
    s_lshl_b32 s46, s49, 8
    s_lshl_b32 s48, s43, 6
    s_add_u32 s46, s46, s48
    s_lshl_b32 s48, s44, 21
    s_add_u32 s46, s46, s48
    s_lshl_b32 s52, s51, 5
    s_xor_b32 s53, s50, 1
    s_lshl_b32 s53, s53, 16
    s_add_u32 s52, s52, s53
    v_add_u32 v20, s52, v20
    s_waitcnt lgkmcnt(0)
    s_mov_b32 s24, s6
    s_and_b32 s25, s7, 0xffff
    s_mov_b32 s26, 0x800000
    s_mov_b32 s27, 0x00020000
    s_mov_b32 s28, s4
    s_and_b32 s29, s5, 0xffff
    s_mov_b32 s30, 0x800000
    s_mov_b32 s31, 0x00020000
    s_lshl_b32 s52, s40, 16
    s_lshl_b32 s53, s42, 12
    s_add_u32 s52, s52, s53
    s_lshl_b32 s53, s43, 10
    s_add_u32 s52, s52, s53
    s_lshl_b32 s53, s51, 9
    s_add_u32 s52, s52, s53
    s_lshl_b32 s53, s50, 7
    s_add_u32 s52, s52, s53
    s_add_u32 s52, s52, 0x7080000
    v_lshlrev_b32 v4, 8, v107
    v_lshl_add_u32 v4, v104, 4, v4
    v_lshrrev_b32 v5, 1, v106
    v_lshl_add_u32 v4, v5, 2, v4
    v_add_u32 v4, s52, v4
    v_mov_b32 v13, -1
    s_xor_b32 s52, s50, 1
    s_lshl_b32 s52, s52, 10
    s_lshl_b32 s53, s51, 8
    s_add_u32 s52, s52, s53
    s_add_u32 s52, s52, 27648
    v_lshrrev_b32 v5, 1, v106
    v_lshlrev_b32 v5, 2, v5
    v_lshl_add_u32 v5, v104, 4, v5
    v_lshl_add_u32 v5, v107, 7, v5
    v_add_u32 v5, s52, v5
    s_lshl_b32 s67, s49, 12
    s_lshl_b32 s53, s43, 10
    s_add_u32 s67, s67, s53
    s_add_u32 s67, s67, 0x1000000
    v_mov_b32 v32, -1
    v_mov_b32 v33, -1
    v_mov_b32 v34, -1
    v_mov_b32 v35, -1
    s_lshl_b32 s53, s44, 17
    s_add_u32 s53, s53, s67
    buffer_store_dwordx4 v[32:35], v2, s[12:15], s53 offen sc1
    s_add_u32 s53, s53, 524288
    buffer_store_dwordx4 v[32:35], v2, s[12:15], s53 offen sc1
    s_add_u32 s53, s53, 524288
    s_lshl_b32 s52, s41, 14
    s_lshl_b32 s53, s44, 12
    s_add_u32 s52, s52, s53
    s_lshl_b32 s53, s40, 9
    s_add_u32 s52, s52, s53
    s_add_u32 s52, s52, 0x7a00000
    v_and_b32 v15, 31, v1
    v_lshlrev_b32 v15, 4, v15
    v_add_u32 v15, s52, v15
    s_lshl_b32 s52, s40, 11
    s_lshl_b32 s53, s44, 7
    s_add_u32 s52, s52, s53
    s_add_u32 s52, s52, 0x10a600
    v_lshlrev_b32 v14, 9, v105
    v_add_u32 v14, s52, v14
    s_mov_b32 s69, 0
    s_lshl_b32 s52, s40, 2
    s_add_u32 s52, s52, s44
    s_mul_i32 s52, s52, 24576
    s_add_u32 s52, s52, 0x2002000
    v_add_u32 v6, s52, v2
    s_lshl_b32 s52, s40, 16
    s_lshl_b32 s53, s44, 12
    s_add_u32 s52, s52, s53
    s_add_u32 s52, s52, 0x7080000
    v_add_u32 v7, s52, v2
    s_lshl_b32 s52, s44, 10
    s_add_u32 s52, s52, 16384
    v_lshlrev_b32 v8, 8, v101
    v_lshl_add_u32 v8, v106, 4, v8
    v_lshl_add_u32 v8, v107, 3, v8
    v_add_u32 v8, s52, v8
    s_lshl_b32 s52, s44, 8
    s_add_u32 s52, s52, 20480
    v_xor_b32 v9, 1, v103
    v_lshlrev_b32 v9, 7, v9
    v_lshl_add_u32 v9, v106, 4, v9
    v_lshl_add_u32 v9, v102, 3, v9
    v_lshl_add_u32 v9, v107, 2, v9
    v_add_u32 v9, s52, v9
    v_cmp_gt_u32 vcc, 32, v1
    v_mov_b32 v28, 0
    v_mov_b32 v29, 0xff800000
    v_cndmask_b32 v28, v28, v29, vcc
    v_mov_b32 v29, v28
    v_mov_b32 v30, v28
    v_mov_b32 v31, v28
    s_mov_b32 s66, 0x3e0293ee
    s_waitcnt vmcnt(0)
    s_add_u32 m0, s45, 0
    s_add_u32 s48, s46, 0x0
    buffer_load_dwordx4 v24, s[24:27], s48 offen lds
    s_add_u32 m0, s45, 1024
    s_add_u32 s48, s46, 0x20000
    buffer_load_dwordx4 v24, s[24:27], s48 offen lds
    s_add_u32 m0, s45, 2048
    s_add_u32 s48, s46, 0x40000
    buffer_load_dwordx4 v24, s[24:27], s48 offen lds
    s_add_u32 m0, s45, 3072
    s_add_u32 s48, s46, 0x60000
    buffer_load_dwordx4 v24, s[24:27], s48 offen lds
    s_add_u32 m0, s45, 4096
    s_add_u32 s48, s46, 0x80000
    buffer_load_dwordx4 v24, s[24:27], s48 offen lds
    s_add_u32 m0, s45, 5120
    s_add_u32 s48, s46, 0xa0000
    buffer_load_dwordx4 v24, s[24:27], s48 offen lds
    s_add_u32 m0, s45, 6144
    s_add_u32 s48, s46, 0xc0000
    buffer_load_dwordx4 v24, s[24:27], s48 offen lds
    s_add_u32 m0, s45, 7168
    s_add_u32 s48, s46, 0xe0000
    buffer_load_dwordx4 v24, s[24:27], s48 offen lds
    s_add_u32 m0, s45, 8192
    s_add_u32 s48, s46, 0x100000
    buffer_load_dwordx4 v24, s[24:27], s48 offen lds
    s_add_u32 m0, s45, 9216
    s_add_u32 s48, s46, 0x120000
    buffer_load_dwordx4 v24, s[24:27], s48 offen lds
    s_add_u32 m0, s45, 10240
    s_add_u32 s48, s46, 0x140000
    buffer_load_dwordx4 v24, s[24:27], s48 offen lds
    s_add_u32 m0, s45, 11264
    s_add_u32 s48, s46, 0x160000
    buffer_load_dwordx4 v24, s[24:27], s48 offen lds
    s_add_u32 m0, s45, 12288
    s_add_u32 s48, s46, 0x180000
    buffer_load_dwordx4 v24, s[24:27], s48 offen lds
    s_add_u32 m0, s45, 13312
    s_add_u32 s48, s46, 0x1a0000
    buffer_load_dwordx4 v24, s[24:27], s48 offen lds
    s_add_u32 m0, s45, 14336
    s_add_u32 s48, s46, 0x1c0000
    buffer_load_dwordx4 v24, s[24:27], s48 offen lds
    s_add_u32 m0, s45, 15360
    s_add_u32 s48, s46, 0x1e0000
    buffer_load_dwordx4 v24, s[24:27], s48 offen lds
    s_add_u32 s45, s45, 0x10000
    s_add_u32 m0, s45, 0
    s_add_u32 s48, s46, 0x0
    buffer_load_dwordx4 v24, s[28:31], s48 offen lds
    s_add_u32 m0, s45, 1024
    s_add_u32 s48, s46, 0x20000
    buffer_load_dwordx4 v24, s[28:31], s48 offen lds
    s_add_u32 m0, s45, 2048
    s_add_u32 s48, s46, 0x40000
    buffer_load_dwordx4 v24, s[28:31], s48 offen lds
    s_add_u32 m0, s45, 3072
    s_add_u32 s48, s46, 0x60000
    buffer_load_dwordx4 v24, s[28:31], s48 offen lds
    s_add_u32 m0, s45, 4096
    s_add_u32 s48, s46, 0x80000
    buffer_load_dwordx4 v24, s[28:31], s48 offen lds
    s_add_u32 m0, s45, 5120
    s_add_u32 s48, s46, 0xa0000
    buffer_load_dwordx4 v24, s[28:31], s48 offen lds
    s_add_u32 m0, s45, 6144
    s_add_u32 s48, s46, 0xc0000
    buffer_load_dwordx4 v24, s[28:31], s48 offen lds
    s_add_u32 m0, s45, 7168
    s_add_u32 s48, s46, 0xe0000
    buffer_load_dwordx4 v24, s[28:31], s48 offen lds
    s_add_u32 m0, s45, 8192
    s_add_u32 s48, s46, 0x100000
    buffer_load_dwordx4 v24, s[28:31], s48 offen lds
    s_add_u32 m0, s45, 9216
    s_add_u32 s48, s46, 0x120000
    buffer_load_dwordx4 v24, s[28:31], s48 offen lds
    s_add_u32 m0, s45, 10240
    s_add_u32 s48, s46, 0x140000
    buffer_load_dwordx4 v24, s[28:31], s48 offen lds
    s_add_u32 m0, s45, 11264
    s_add_u32 s48, s46, 0x160000
    buffer_load_dwordx4 v24, s[28:31], s48 offen lds
    s_add_u32 m0, s45, 12288
    s_add_u32 s48, s46, 0x180000
    buffer_load_dwordx4 v24, s[28:31], s48 offen lds
    s_add_u32 m0, s45, 13312
    s_add_u32 s48, s46, 0x1a0000
    buffer_load_dwordx4 v24, s[28:31], s48 offen lds
    s_add_u32 m0, s45, 14336
    s_add_u32 s48, s46, 0x1c0000
    buffer_load_dwordx4 v24, s[28:31], s48 offen lds
    s_add_u32 m0, s45, 15360
    s_add_u32 s48, s46, 0x1e0000
    buffer_load_dwordx4 v24, s[28:31], s48 offen lds
    s_add_u32 s45, s45, 0x10000
    s_waitcnt vmcnt(0)
    s_barrier
    s_cmp_lg_u32 s44, 0
    s_cbranch_scc1 L_zwok_184
    v_and_b32 v16, 7, v1
    v_lshlrev_b32 v16, 5, v16
    s_mov_b32 s70, 0
L_zw_183:
    buffer_load_dword v17, v16, s[16:19], 0 offen sc1
    s_waitcnt vmcnt(0)
    v_add_u32_dpp v17, v17, v17 row_ror:1 row_mask:0xf bank_mask:0xf
    s_nop 1
    v_add_u32_dpp v17, v17, v17 row_ror:2 row_mask:0xf bank_mask:0xf
    s_nop 1
    v_add_u32_dpp v17, v17, v17 row_ror:4 row_mask:0xf bank_mask:0xf
    v_cmp_ne_u32 vcc, 0x100, v17
    s_add_u32 s70, s70, 1
    s_cbranch_vccz L_zwok_184
    s_sleep 4
    s_cmp_lt_u32 s70, 524288
    s_cbranch_scc1 L_zw_183
    s_branch L_c_done_1
L_zwok_184:
    s_cmp_lg_u32 s44, 0
    s_cbranch_scc1 L_c_nr_185
    s_or_b32 s47, s39, 0x100
    v_mov_b32 v16, s47
    s_lshl_b32 s52, s40, 6
    s_lshl_b32 s53, s41, 2
    s_add_u32 s52, s52, s53
    s_add_u32 s52, s52, 0x101000
    v_mov_b32 v17, 0
    s_mov_b64 exec, 1
    buffer_store_dword v16, v17, s[12:15], s52 offen sc1
    s_mov_b64 exec, -1
L_c_nr_185:
    ds_read_b64_tr_b16 a[0:1], v20 offset:0
    ds_read_b64_tr_b16 a[2:3], v20 offset:256
    ds_read_b64_tr_b16 a[4:5], v20 offset:2048
    ds_read_b64_tr_b16 a[6:7], v20 offset:2304
    ds_read_b64_tr_b16 a[8:9], v20 offset:4096
    ds_read_b64_tr_b16 a[10:11], v20 offset:4352
    ds_read_b64_tr_b16 a[12:13], v20 offset:6144
    ds_read_b64_tr_b16 a[14:15], v20 offset:6400
    s_waitcnt lgkmcnt(0)
    ds_read_b64_tr_b16 a[16:17], v20 offset:8192
    ds_read_b64_tr_b16 a[18:19], v20 offset:8448
    ds_read_b64_tr_b16 a[20:21], v20 offset:10240
    ds_read_b64_tr_b16 a[22:23], v20 offset:10496
    ds_read_b64_tr_b16 a[24:25], v20 offset:12288
    ds_read_b64_tr_b16 a[26:27], v20 offset:12544
    ds_read_b64_tr_b16 a[28:29], v20 offset:14336
    ds_read_b64_tr_b16 a[30:31], v20 offset:14592
    s_waitcnt lgkmcnt(0)
    ds_read_b64_tr_b16 a[32:33], v20 offset:16384
    ds_read_b64_tr_b16 a[34:35], v20 offset:16640
    ds_read_b64_tr_b16 a[36:37], v20 offset:18432
    ds_read_b64_tr_b16 a[38:39], v20 offset:18688
    ds_read_b64_tr_b16 a[40:41], v20 offset:20480
    ds_read_b64_tr_b16 a[42:43], v20 offset:20736
    ds_read_b64_tr_b16 a[44:45], v20 offset:22528
    ds_read_b64_tr_b16 a[46:47], v20 offset:22784
    s_waitcnt lgkmcnt(0)
    ds_read_b64_tr_b16 a[48:49], v20 offset:24576
    ds_read_b64_tr_b16 a[50:51], v20 offset:24832
    ds_read_b64_tr_b16 a[52:53], v20 offset:26624
    ds_read_b64_tr_b16 a[54:55], v20 offset:26880
    ds_read_b64_tr_b16 a[56:57], v20 offset:28672
    ds_read_b64_tr_b16 a[58:59], v20 offset:28928
    ds_read_b64_tr_b16 a[60:61], v20 offset:30720
    ds_read_b64_tr_b16 a[62:63], v20 offset:30976
    s_waitcnt lgkmcnt(0)
    ds_read_b64_tr_b16 a[64:65], v20 offset:32768
    ds_read_b64_tr_b16 a[66:67], v20 offset:33024
    ds_read_b64_tr_b16 a[68:69], v20 offset:34816
    ds_read_b64_tr_b16 a[70:71], v20 offset:35072
    ds_read_b64_tr_b16 a[72:73], v20 offset:36864
    ds_read_b64_tr_b16 a[74:75], v20 offset:37120
    ds_read_b64_tr_b16 a[76:77], v20 offset:38912
    ds_read_b64_tr_b16 a[78:79], v20 offset:39168
    s_waitcnt lgkmcnt(0)
    ds_read_b64_tr_b16 a[80:81], v20 offset:40960
    ds_read_b64_tr_b16 a[82:83], v20 offset:41216
    ds_read_b64_tr_b16 a[84:85], v20 offset:43008
    ds_read_b64_tr_b16 a[86:87], v20 offset:43264
    ds_read_b64_tr_b16 a[88:89], v20 offset:45056
    ds_read_b64_tr_b16 a[90:91], v20 offset:45312
    ds_read_b64_tr_b16 a[92:93], v20 offset:47104
    ds_read_b64_tr_b16 a[94:95], v20 offset:47360
    s_waitcnt lgkmcnt(0)
    ds_read_b64_tr_b16 a[96:97], v20 offset:49152
    ds_read_b64_tr_b16 a[98:99], v20 offset:49408
    ds_read_b64_tr_b16 a[100:101], v20 offset:51200
    ds_read_b64_tr_b16 a[102:103], v20 offset:51456
    ds_read_b64_tr_b16 a[104:105], v20 offset:53248
    ds_read_b64_tr_b16 a[106:107], v20 offset:53504
    ds_read_b64_tr_b16 a[108:109], v20 offset:55296
    ds_read_b64_tr_b16 a[110:111], v20 offset:55552
    s_waitcnt lgkmcnt(0)
    ds_read_b64_tr_b16 a[112:113], v20 offset:57344
    ds_read_b64_tr_b16 a[114:115], v20 offset:57600
    ds_read_b64_tr_b16 a[116:117], v20 offset:59392
    ds_read_b64_tr_b16 a[118:119], v20 offset:59648
    ds_read_b64_tr_b16 a[120:121], v20 offset:61440
    ds_read_b64_tr_b16 a[122:123], v20 offset:61696
    ds_read_b64_tr_b16 a[124:125], v20 offset:63488
    ds_read_b64_tr_b16 a[126:127], v20 offset:63744
    s_waitcnt lgkmcnt(0)
    s_mov_b32 s63, 0
    s_mov_b32 s68, 1
    s_barrier
    s_cmp_gt_u32 s69, s68
    s_cbranch_scc1 L_kv_ok_187
    s_mov_b32 s70, 0
L_kv_lp_186:
    buffer_load_dword v10, v14, s[12:15], 0 offen sc1
    s_waitcnt vmcnt(0)
    v_readlane_b32 s69, v10, 0
    v_readlane_b32 s45, v10, 1
    s_add_u32 s70, s70, 1
    s_nop 2
    s_min_u32 s69, s69, s45
    s_cmp_gt_u32 s69, s68
    s_cbranch_scc1 L_kv_ok_187
    s_sleep 4
    s_cmp_lt_u32 s70, 524288
    s_cbranch_scc1 L_kv_lp_186
    s_branch L_c_done_1
L_kv_ok_187:
    s_lshl_b32 s52, s44, 13
    s_add_u32 s52, s52, 65536
    v_add_u32 v6, s52, v2
    s_barrier
    s_setprio 1
    s_branch L_c_join_182
L_v_init_181:
    s_sub_u32 s54, s44, 4
    s_lshr_b32 s51, s54, 1
    s_and_b32 s50, s54, 1
    s_load_dwordx4 s[4:7], s[0:1], 32
    s_load_dwordx2 s[8:9], s[0:1], 8
    s_waitcnt lgkmcnt(0)
    s_mov_b32 s24, s4
    s_and_b32 s25, s5, 0xffff
    s_mov_b32 s26, 0x800000
    s_mov_b32 s27, 0x00020000
    s_mov_b32 s28, s6
    s_and_b32 s29, s7, 0xffff
    s_mov_b32 s30, 0x800000
    s_mov_b32 s31, 0x00020000
    s_mov_b32 s32, s8
    s_and_b32 s33, s9, 0xffff
    s_mov_b32 s34, 0x4000
    s_mov_b32 s35, 0x00020000
    s_lshl_b32 s45, s54, 12
    s_add_u32 s45, s45, 0x20000
    v_add_u32 v20, s45, v20
    v_add_u32 v21, s45, v21
    v_add_u32 v22, s45, v2
    s_lshl_b32 s46, s40, 2
    s_add_u32 s46, s46, s54
    s_lshl_b32 s46, s46, 18
    s_lshl_b32 s48, s41, 7
    s_add_u32 s46, s46, s48
    s_add_u32 s48, s46, 0x0
    buffer_load_dwordx4 a[64:67], v25, s[28:31], s48 offen
    s_add_u32 s48, s46, 0x4000
    buffer_load_dwordx4 a[80:83], v25, s[28:31], s48 offen
    s_add_u32 s48, s46, 0x8000
    buffer_load_dwordx4 a[96:99], v25, s[28:31], s48 offen
    s_add_u32 s48, s46, 0xc000
    buffer_load_dwordx4 a[112:115], v25, s[28:31], s48 offen
    s_add_u32 s48, s46, 0x10000
    buffer_load_dwordx4 a[68:71], v25, s[28:31], s48 offen
    s_add_u32 s48, s46, 0x14000
    buffer_load_dwordx4 a[84:87], v25, s[28:31], s48 offen
    s_add_u32 s48, s46, 0x18000
    buffer_load_dwordx4 a[100:103], v25, s[28:31], s48 offen
    s_add_u32 s48, s46, 0x1c000
    buffer_load_dwordx4 a[116:119], v25, s[28:31], s48 offen
    s_add_u32 s48, s46, 0x20000
    buffer_load_dwordx4 a[72:75], v25, s[28:31], s48 offen
    s_add_u32 s48, s46, 0x24000
    buffer_load_dwordx4 a[88:91], v25, s[28:31], s48 offen
    s_add_u32 s48, s46, 0x28000
    buffer_load_dwordx4 a[104:107], v25, s[28:31], s48 offen
    s_add_u32 s48, s46, 0x2c000
    buffer_load_dwordx4 a[120:123], v25, s[28:31], s48 offen
    s_add_u32 s48, s46, 0x30000
    buffer_load_dwordx4 a[76:79], v25, s[28:31], s48 offen
    s_add_u32 s48, s46, 0x34000
    buffer_load_dwordx4 a[92:95], v25, s[28:31], s48 offen
    s_add_u32 s48, s46, 0x38000
    buffer_load_dwordx4 a[108:111], v25, s[28:31], s48 offen
    s_add_u32 s48, s46, 0x3c000
    buffer_load_dwordx4 a[124:127], v25, s[28:31], s48 offen
    s_lshl_b32 s52, s40, 15
    s_lshl_b32 s53, s42, 11
    s_add_u32 s52, s52, s53
    s_lshl_b32 s53, s43, 9
    s_add_u32 s52, s52, s53
    s_lshl_b32 s53, s51, 8
    s_add_u32 s52, s52, s53
    s_add_u32 s52, s52, 0x7100000
    v_bfe_u32 v4, v1, 1, 1
    v_lshlrev_b32 v4, 7, v4
    v_lshl_add_u32 v4, v104, 4, v4
    v_and_b32 v5, 12, v100
    v_add_u32 v4, v4, v5
    v_add_u32 v4, s52, v4
    v_mov_b32 v26, -1
    s_lshl_b32 s52, s51, 5
    s_add_u32 s52, s52, 28160
    v_and_b32 v5, 14, v100
    v_lshlrev_b32 v5, 1, v5
    v_lshl_add_u32 v5, v104, 6, v5
    v_add_u32 v5, s52, v5
    s_lshl_b32 s52, s41, 14
    s_lshl_b32 s53, s54, 12
    s_add_u32 s52, s52, s53
    s_add_u32 s52, s52, 0x7800000
    v_lshlrev_b32 v6, 7, v101
    v_lshl_add_u32 v6, v106, 4, v6
    v_lshl_add_u32 v7, v107, 11, v6
    v_add_u32 v7, s52, v7
    s_lshl_b32 s53, s40, 9
    s_add_u32 s52, s52, s53
    v_add_u32 v6, s52, v6
    v_and_b32 v30, 31, v1
    v_lshlrev_b32 v30, 4, v30
    v_lshl_add_u32 v30, v103, 18, v30
    v_add_u32 v30, s52, v30
    v_mov_b32 v32, -1
    v_mov_b32 v33, -1
    v_mov_b32 v34, -1
    v_mov_b32 v35, -1
    s_mov_b32 s53, 0
    buffer_store_dwordx4 v[32:35], v30, s[12:15], s53 offen sc1
    s_mov_b32 s53, 524288
    buffer_store_dwordx4 v[32:35], v30, s[12:15], s53 offen sc1
    s_mov_b32 s53, 1048576
    buffer_store_dwordx4 v[32:35], v30, s[12:15], s53 offen sc1
    s_mov_b32 s53, 1572864
    buffer_store_dwordx4 v[32:35], v30, s[12:15], s53 offen sc1
    s_lshl_b32 s55, s40, 16
    s_add_u32 s55, s55, 0x7000000
    s_lshl_b32 s52, s41, 10
    s_lshl_b32 s53, s54, 8
    s_add_u32 s52, s52, s53
    s_add_u32 s52, s52, s55
    v_lshlrev_b32 v8, 4, v100
    v_lshl_add_u32 v8, v101, 2, v8
    v_add_u32 v8, s52, v8
    s_lshl_b32 s53, s54, 12
    v_add_u32 v10, s53, v2
    v_add_u32 v9, s55, v10
    s_lshl_b32 s52, s40, 15
    s_lshl_b32 s53, s54, 11
    s_add_u32 s52, s52, s53
    s_add_u32 s52, s52, 0x7100000
    v_add_u32 v11, s52, v2
    s_lshl_b32 s52, s54, 9
    s_add_u32 s52, s52, 53248
    v_lshlrev_b32 v12, 4, v100
    v_lshl_add_u32 v12, v102, 3, v12
    v_lshl_add_u32 v12, v103, 8, v12
    v_add_u32 v12, s52, v12
    s_lshl_b32 s52, s51, 3
    s_add_u32 s52, s52, 49152
    v_add_u32 v13, s52, v2
    s_lshl_b32 s52, s54, 10
    s_add_u32 s52, s52, 49152
    v_add_u32 v14, s52, v2
    s_lshl_b32 s52, s40, 2
    s_add_u32 s52, s52, s54
    s_mul_i32 s52, s52, 24576
    s_add_u32 s52, s52, 0x2004000
    v_add_u32 v15, s52, v2
    s_lshl_b32 s52, s54, 10
    v_add_u32 v27, s52, v2
    v_lshlrev_b32 v30, 11, v106
    v_lshl_add_u32 v30, v101, 5, v30
    v_lshl_add_u32 v30, v107, 2, v30
    s_lshl_b32 s52, s54, 9
    buffer_load_dword v112, v30, s[32:35], s52 offen offset:0
    buffer_load_dword v113, v30, s[32:35], s52 offen offset:8
    buffer_load_dword v114, v30, s[32:35], s52 offen offset:16
    buffer_load_dword v115, v30, s[32:35], s52 offen offset:24
    buffer_load_dword v116, v30, s[32:35], s52 offen offset:128
    buffer_load_dword v117, v30, s[32:35], s52 offen offset:136
    buffer_load_dword v118, v30, s[32:35], s52 offen offset:144
    buffer_load_dword v119, v30, s[32:35], s52 offen offset:152
    buffer_load_dword v120, v30, s[32:35], s52 offen offset:256
    buffer_load_dword v121, v30, s[32:35], s52 offen offset:264
    buffer_load_dword v122, v30, s[32:35], s52 offen offset:272
    buffer_load_dword v123, v30, s[32:35], s52 offen offset:280
    buffer_load_dword v124, v30, s[32:35], s52 offen offset:384
    buffer_load_dword v125, v30, s[32:35], s52 offen offset:392
    buffer_load_dword v126, v30, s[32:35], s52 offen offset:400
    buffer_load_dword v127, v30, s[32:35], s52 offen offset:408
    s_lshl_b32 s46, s49, 8
    s_lshl_b32 s48, s43, 6
    s_add_u32 s46, s46, s48
    s_lshl_b32 s48, s54, 21
    s_add_u32 s46, s46, s48
    s_add_u32 s48, s46, 0x0
    buffer_load_dwordx4 a[0:3], v24, s[24:27], s48 offen
    s_add_u32 s48, s46, 0x20000
    buffer_load_dwordx4 a[32:35], v24, s[24:27], s48 offen
    s_add_u32 s48, s46, 0x40000
    buffer_load_dwordx4 a[4:7], v24, s[24:27], s48 offen
    s_add_u32 s48, s46, 0x60000
    buffer_load_dwordx4 a[36:39], v24, s[24:27], s48 offen
    s_add_u32 s48, s46, 0x80000
    buffer_load_dwordx4 a[8:11], v24, s[24:27], s48 offen
    s_add_u32 s48, s46, 0xa0000
    buffer_load_dwordx4 a[40:43], v24, s[24:27], s48 offen
    s_add_u32 s48, s46, 0xc0000
    buffer_load_dwordx4 a[12:15], v24, s[24:27], s48 offen
    s_add_u32 s48, s46, 0xe0000
    buffer_load_dwordx4 a[44:47], v24, s[24:27], s48 offen
    s_add_u32 s48, s46, 0x100000
    buffer_load_dwordx4 a[16:19], v24, s[24:27], s48 offen
    s_add_u32 s48, s46, 0x120000
    buffer_load_dwordx4 a[48:51], v24, s[24:27], s48 offen
    s_add_u32 s48, s46, 0x140000
    buffer_load_dwordx4 a[20:23], v24, s[24:27], s48 offen
    s_add_u32 s48, s46, 0x160000
    buffer_load_dwordx4 a[52:55], v24, s[24:27], s48 offen
    s_add_u32 s48, s46, 0x180000
    buffer_load_dwordx4 a[24:27], v24, s[24:27], s48 offen
    s_add_u32 s48, s46, 0x1a0000
    buffer_load_dwordx4 a[56:59], v24, s[24:27], s48 offen
    s_add_u32 s48, s46, 0x1c0000
    buffer_load_dwordx4 a[28:31], v24, s[24:27], s48 offen
    s_add_u32 s48, s46, 0x1e0000
    buffer_load_dwordx4 a[60:63], v24, s[24:27], s48 offen
    s_waitcnt vmcnt(16)
    ds_write_b128 v22, a[64:67] offset:0
    ds_write_b128 v22, a[80:83] offset:1024
    ds_write_b128 v22, a[96:99] offset:2048
    ds_write_b128 v22, a[112:115] offset:3072
    s_waitcnt lgkmcnt(0)
    ds_read_b64_tr_b16 a[64:65], v21 offset:0
    ds_read_b64_tr_b16 a[66:67], v21 offset:512
    ds_read_b64_tr_b16 a[80:81], v21 offset:32
    ds_read_b64_tr_b16 a[82:83], v21 offset:544
    ds_read_b64_tr_b16 a[96:97], v21 offset:64
    ds_read_b64_tr_b16 a[98:99], v21 offset:576
    ds_read_b64_tr_b16 a[112:113], v21 offset:96
    ds_read_b64_tr_b16 a[114:115], v21 offset:608
    s_waitcnt lgkmcnt(0)
    ds_write_b128 v22, a[68:71] offset:0
    ds_write_b128 v22, a[84:87] offset:1024
    ds_write_b128 v22, a[100:103] offset:2048
    ds_write_b128 v22, a[116:119] offset:3072
    s_waitcnt lgkmcnt(0)
    ds_read_b64_tr_b16 a[68:69], v21 offset:0
    ds_read_b64_tr_b16 a[70:71], v21 offset:512
    ds_read_b64_tr_b16 a[84:85], v21 offset:32
    ds_read_b64_tr_b16 a[86:87], v21 offset:544
    ds_read_b64_tr_b16 a[100:101], v21 offset:64
    ds_read_b64_tr_b16 a[102:103], v21 offset:576
    ds_read_b64_tr_b16 a[116:117], v21 offset:96
    ds_read_b64_tr_b16 a[118:119], v21 offset:608
    s_waitcnt lgkmcnt(0)
    ds_write_b128 v22, a[72:75] offset:0
    ds_write_b128 v22, a[88:91] offset:1024
    ds_write_b128 v22, a[104:107] offset:2048
    ds_write_b128 v22, a[120:123] offset:3072
    s_waitcnt lgkmcnt(0)
    ds_read_b64_tr_b16 a[72:73], v21 offset:0
    ds_read_b64_tr_b16 a[74:75], v21 offset:512
    ds_read_b64_tr_b16 a[88:89], v21 offset:32
    ds_read_b64_tr_b16 a[90:91], v21 offset:544
    ds_read_b64_tr_b16 a[104:105], v21 offset:64
    ds_read_b64_tr_b16 a[106:107], v21 offset:576
    ds_read_b64_tr_b16 a[120:121], v21 offset:96
    ds_read_b64_tr_b16 a[122:123], v21 offset:608
    s_waitcnt lgkmcnt(0)
    ds_write_b128 v22, a[76:79] offset:0
    ds_write_b128 v22, a[92:95] offset:1024
    ds_write_b128 v22, a[108:111] offset:2048
    ds_write_b128 v22, a[124:127] offset:3072
    s_waitcnt lgkmcnt(0)
    ds_read_b64_tr_b16 a[76:77], v21 offset:0
    ds_read_b64_tr_b16 a[78:79], v21 offset:512
    ds_read_b64_tr_b16 a[92:93], v21 offset:32
    ds_read_b64_tr_b16 a[94:95], v21 offset:544
    ds_read_b64_tr_b16 a[108:109], v21 offset:64
    ds_read_b64_tr_b16 a[110:111], v21 offset:576
    ds_read_b64_tr_b16 a[124:125], v21 offset:96
    ds_read_b64_tr_b16 a[126:127], v21 offset:608
    s_waitcnt lgkmcnt(0)
    s_barrier
    s_waitcnt vmcnt(0)
    ds_write_b128 v22, a[0:3] offset:0
    ds_write_b128 v22, a[32:35] offset:1024
    ds_write_b128 v22, a[4:7] offset:2048
    ds_write_b128 v22, a[36:39] offset:3072
    s_waitcnt lgkmcnt(0)
    ds_read_b64_tr_b16 a[0:1], v20 offset:0
    ds_read_b64_tr_b16 a[2:3], v20 offset:256
    ds_read_b64_tr_b16 a[32:33], v20 offset:32
    ds_read_b64_tr_b16 a[34:35], v20 offset:288
    ds_read_b64_tr_b16 a[4:5], v20 offset:2048
    ds_read_b64_tr_b16 a[6:7], v20 offset:2304
    ds_read_b64_tr_b16 a[36:37], v20 offset:2080
    ds_read_b64_tr_b16 a[38:39], v20 offset:2336
    s_waitcnt lgkmcnt(0)
    ds_write_b128 v22, a[8:11] offset:0
    ds_write_b128 v22, a[40:43] offset:1024
    ds_write_b128 v22, a[12:15] offset:2048
    ds_write_b128 v22, a[44:47] offset:3072
    s_waitcnt lgkmcnt(0)
    ds_read_b64_tr_b16 a[8:9], v20 offset:0
    ds_read_b64_tr_b16 a[10:11], v20 offset:256
    ds_read_b64_tr_b16 a[40:41], v20 offset:32
    ds_read_b64_tr_b16 a[42:43], v20 offset:288
    ds_read_b64_tr_b16 a[12:13], v20 offset:2048
    ds_read_b64_tr_b16 a[14:15], v20 offset:2304
    ds_read_b64_tr_b16 a[44:45], v20 offset:2080
    ds_read_b64_tr_b16 a[46:47], v20 offset:2336
    s_waitcnt lgkmcnt(0)
    ds_write_b128 v22, a[16:19] offset:0
    ds_write_b128 v22, a[48:51] offset:1024
    ds_write_b128 v22, a[20:23] offset:2048
    ds_write_b128 v22, a[52:55] offset:3072
    s_waitcnt lgkmcnt(0)
    ds_read_b64_tr_b16 a[16:17], v20 offset:0
    ds_read_b64_tr_b16 a[18:19], v20 offset:256
    ds_read_b64_tr_b16 a[48:49], v20 offset:32
    ds_read_b64_tr_b16 a[50:51], v20 offset:288
    ds_read_b64_tr_b16 a[20:21], v20 offset:2048
    ds_read_b64_tr_b16 a[22:23], v20 offset:2304
    ds_read_b64_tr_b16 a[52:53], v20 offset:2080
    ds_read_b64_tr_b16 a[54:55], v20 offset:2336
    s_waitcnt lgkmcnt(0)
    ds_write_b128 v22, a[24:27] offset:0
    ds_write_b128 v22, a[56:59] offset:1024
    ds_write_b128 v22, a[28:31] offset:2048
    ds_write_b128 v22, a[60:63] offset:3072
    s_waitcnt lgkmcnt(0)
    ds_read_b64_tr_b16 a[24:25], v20 offset:0
    ds_read_b64_tr_b16 a[26:27], v20 offset:256
    ds_read_b64_tr_b16 a[56:57], v20 offset:32
    ds_read_b64_tr_b16 a[58:59], v20 offset:288
    ds_read_b64_tr_b16 a[28:29], v20 offset:2048
    ds_read_b64_tr_b16 a[30:31], v20 offset:2304
    ds_read_b64_tr_b16 a[60:61], v20 offset:2080
    ds_read_b64_tr_b16 a[62:63], v20 offset:2336
    s_waitcnt lgkmcnt(0)
    s_mov_b32 s65, 0
    s_waitcnt vmcnt(0)
    s_barrier
    s_barrier
    v_subrev_u32 v28, 8192, v15
    v_lshlrev_b32 v31, 4, v100
    v_lshl_add_u32 v31, v103, 8, v31
    v_add_u32 v31, 20480, v31
    s_lshl_b32 s52, s54, 11
    s_add_u32 s52, s52, 53248
    v_add_u32 v25, s52, v2
    v_mov_b32 v29, 26640
    v_mov_b32 v30, 0
    ds_write_b32 v29, v30
    v_mov_b32 v30, 1
    s_mov_b32 s58, 0
    s_mov_b32 s64, 0
    s_lshl_b32 s59, s54, 13
    s_add_u32 s59, s59, 65536
    s_add_u32 s46, s64, 4096
    s_add_u32 m0, s59, 0
    s_nop 0
    buffer_load_dwordx4 v28, s[12:15], s64 offen offset:0 sc1 lds
    buffer_load_dwordx4 v28, s[12:15], s64 offen offset:1024 sc1 lds
    buffer_load_dwordx4 v28, s[12:15], s64 offen offset:2048 sc1 lds
    buffer_load_dwordx4 v28, s[12:15], s64 offen offset:3072 sc1 lds
    s_add_u32 m0, s59, 4096
    s_nop 0
    buffer_load_dwordx4 v28, s[12:15], s46 offen offset:0 sc1 lds
    buffer_load_dwordx4 v28, s[12:15], s46 offen offset:1024 sc1 lds
    buffer_load_dwordx4 v28, s[12:15], s46 offen offset:2048 sc1 lds
    buffer_load_dwordx4 v28, s[12:15], s46 offen offset:3072 sc1 lds
    s_add_u32 s64, s64, 786432
    s_add_u32 s46, s65, 4096
    buffer_load_dwordx4 v[32:35], v15, s[12:15], s65 offen offset:0 sc1
    buffer_load_dwordx4 v[48:51], v15, s[12:15], s46 offen offset:0 sc1
    buffer_load_dwordx4 v[36:39], v15, s[12:15], s65 offen offset:1024 sc1
    buffer_load_dwordx4 v[52:55], v15, s[12:15], s46 offen offset:1024 sc1
    buffer_load_dwordx4 v[40:43], v15, s[12:15], s65 offen offset:2048 sc1
    buffer_load_dwordx4 v[56:59], v15, s[12:15], s46 offen offset:2048 sc1
    buffer_load_dwordx4 v[44:47], v15, s[12:15], s65 offen offset:3072 sc1
    buffer_load_dwordx4 v[60:63], v15, s[12:15], s46 offen offset:3072 sc1
    s_add_u32 s65, s65, 786432
    s_waitcnt vmcnt(0)
    v_mfma_f32_16x16x32_bf16 v[64:67], v[32:35], a[64:67], 0
    v_mfma_f32_16x16x32_bf16 v[68:71], v[48:51], a[64:67], 0
    v_mfma_f32_16x16x32_bf16 v[64:67], v[36:39], a[68:71], v[64:67]
    v_mfma_f32_16x16x32_bf16 v[68:71], v[52:55], a[68:71], v[68:71]
    v_mfma_f32_16x16x32_bf16 v[64:67], v[40:43], a[72:75], v[64:67]
    v_mfma_f32_16x16x32_bf16 v[68:71], v[56:59], a[72:75], v[68:71]
    v_mfma_f32_16x16x32_bf16 v[64:67], v[44:47], a[76:79], v[64:67]
    v_mfma_f32_16x16x32_bf16 v[68:71], v[60:63], a[76:79], v[68:71]
    v_mfma_f32_16x16x32_bf16 v[72:75], v[32:35], a[80:83], 0
    v_mfma_f32_16x16x32_bf16 v[76:79], v[48:51], a[80:83], 0
    v_mfma_f32_16x16x32_bf16 v[72:75], v[36:39], a[84:87], v[72:75]
    v_mfma_f32_16x16x32_bf16 v[76:79], v[52:55], a[84:87], v[76:79]
    v_mfma_f32_16x16x32_bf16 v[72:75], v[40:43], a[88:91], v[72:75]
    v_mfma_f32_16x16x32_bf16 v[76:79], v[56:59], a[88:91], v[76:79]
    v_mfma_f32_16x16x32_bf16 v[72:75], v[44:47], a[92:95], v[72:75]
    v_mfma_f32_16x16x32_bf16 v[76:79], v[60:63], a[92:95], v[76:79]
    v_cvt_pk_bf16_f32 v64, v64, v65
    v_cvt_pk_bf16_f32 v65, v66, v67
    v_cvt_pk_bf16_f32 v66, v68, v69
    v_cvt_pk_bf16_f32 v67, v70, v71
    ds_write_b128 v10, v[64:67] offset:32768
    v_mfma_f32_16x16x32_bf16 v[80:83], v[32:35], a[96:99], 0
    v_mfma_f32_16x16x32_bf16 v[84:87], v[48:51], a[96:99], 0
    v_mfma_f32_16x16x32_bf16 v[80:83], v[36:39], a[100:103], v[80:83]
    v_mfma_f32_16x16x32_bf16 v[84:87], v[52:55], a[100:103], v[84:87]
    v_mfma_f32_16x16x32_bf16 v[80:83], v[40:43], a[104:107], v[80:83]
    v_mfma_f32_16x16x32_bf16 v[84:87], v[56:59], a[104:107], v[84:87]
    v_mfma_f32_16x16x32_bf16 v[80:83], v[44:47], a[108:111], v[80:83]
    v_mfma_f32_16x16x32_bf16 v[84:87], v[60:63], a[108:111], v[84:87]
    v_cvt_pk_bf16_f32 v72, v72, v73
    v_cvt_pk_bf16_f32 v73, v74, v75
    v_cvt_pk_bf16_f32 v74, v76, v77
    v_cvt_pk_bf16_f32 v75, v78, v79
    ds_write_b128 v10, v[72:75] offset:33792
    v_mfma_f32_16x16x32_bf16 v[88:91], v[32:35], a[112:115], 0
    v_mfma_f32_16x16x32_bf16 v[92:95], v[48:51], a[112:115], 0
    v_mfma_f32_16x16x32_bf16 v[88:91], v[36:39], a[116:119], v[88:91]
    v_mfma_f32_16x16x32_bf16 v[92:95], v[52:55], a[116:119], v[92:95]
    v_mfma_f32_16x16x32_bf16 v[88:91], v[40:43], a[120:123], v[88:91]
    v_mfma_f32_16x16x32_bf16 v[92:95], v[56:59], a[120:123], v[92:95]
    v_mfma_f32_16x16x32_bf16 v[88:91], v[44:47], a[124:127], v[88:91]
    v_mfma_f32_16x16x32_bf16 v[92:95], v[60:63], a[124:127], v[92:95]
    v_cvt_pk_bf16_f32 v80, v80, v81
    v_cvt_pk_bf16_f32 v81, v82, v83
    v_cvt_pk_bf16_f32 v82, v84, v85
    v_cvt_pk_bf16_f32 v83, v86, v87
    ds_write_b128 v10, v[80:83] offset:34816
    s_nop 2
    v_cvt_pk_bf16_f32 v88, v88, v89
    v_cvt_pk_bf16_f32 v89, v90, v91
    v_cvt_pk_bf16_f32 v90, v92, v93
    v_cvt_pk_bf16_f32 v91, v94, v95
    ds_write_b128 v10, v[88:91] offset:35840
    s_mov_b32 s63, 0
    s_waitcnt lgkmcnt(0)
    v_min_u32 v64, -2, v112
    v_min_u32 v65, -2, v113
    v_min_u32 v66, -2, v114
    v_min_u32 v67, -2, v115
    v_min_u32 v68, -2, v116
    v_min_u32 v69, -2, v117
    v_min_u32 v70, -2, v118
    v_min_u32 v71, -2, v119
    v_min_u32 v72, -2, v120
    v_min_u32 v73, -2, v121
    v_min_u32 v74, -2, v122
    v_min_u32 v75, -2, v123
    v_min_u32 v76, -2, v124
    v_min_u32 v77, -2, v125
    v_min_u32 v78, -2, v126
    v_min_u32 v79, -2, v127
    v_mov_b32 v16, 0
    v_mov_b32 v17, 0
    v_mov_b32 v18, 0
    v_mov_b32 v19, 0
    v_mov_b32 v20, 0
    v_mov_b32 v21, 0
    v_mov_b32 v22, 0
    v_mov_b32 v23, 0
L_c_join_182:
    s_mov_b32 s60, 0
    s_mov_b32 s61, 0
    s_mov_b32 s62, 0
    s_cmp_lg_u32 s44, 0
    s_cbranch_scc1 L_c_nh_188
    v_lshlrev_b32 v17, 3, v1
    s_lshl_b32 s46, s40, 3
    v_mov_b32 v21, s46
    s_mov_b32 s45, 0x101000
    s_mov_b32 s70, 0
L_c_rp_189:
    buffer_load_dwordx2 v[18:19], v17, s[12:15], s45 offen sc1
    buffer_load_dwordx2 v[22:23], v21, s[12:15], s45 offen offset:512 sc1
    s_waitcnt vmcnt(0)
    v_min3_u32 v20, v18, v19, v22
    v_min_u32 v20, v20, v23
    v_cmp_eq_u32 vcc, 0, v20
    s_add_u32 s70, s70, 1
    s_cbranch_vccz L_ok_190
    s_cmp_lt_u32 s70, 524288
    s_cbranch_scc1 L_c_rp_189
    s_branch L_c_done_1
L_ok_190:
    v_cmp_eq_u32 s[52:53], v18, v16
    v_cmp_eq_u32 vcc, v19, v16
    v_cmp_eq_u32 s[54:55], v22, v16
    v_cmp_eq_u32 s[56:57], v23, v16
    s_lshl_b32 s46, s40, 3
    s_nop 3
    s_and_b64 s[52:53], s[52:53], vcc
    s_and_b64 s[52:53], s[52:53], s[54:55]
    s_and_b64 s[52:53], s[52:53], s[56:57]
    s_lshr_b64 s[52:53], s[52:53], s46
    s_and_b32 s52, s52, 0xff
    s_cmp_eq_u32 s52, 0xff
    s_cselect_b32 s52, 1, 0
    v_mov_b32 v16, s52
    v_mov_b32 v17, 26624
    ds_write_b32 v17, v16
L_c_nh_188:
    s_waitcnt lgkmcnt(0)
    s_barrier
    v_mov_b32 v17, 26624
    ds_read_b32 v16, v17
    s_waitcnt lgkmcnt(0)
    v_readfirstlane_b32 s52, v16
    s_nop 3
    s_cmp_ge_u32 s44, 4
    s_cbranch_scc1 L_vf_193
    s_cmp_eq_u32 s52, 0
    s_cbranch_scc1 L_ss_192
L_s_loop_195:
    v_mov_b32 v16, 0
    v_mov_b32 v17, 0
    v_mov_b32 v18, 0
    v_mov_b32 v19, 0
    s_barrier
    ds_read_b128 v[64:67], v2 offset:0
    ds_read_b128 v[68:71], v2 offset:1024
    ds_read_b128 v[72:75], v2 offset:2048
    ds_read_b128 v[76:79], v2 offset:3072
    ds_read_b128 v[80:83], v2 offset:4096
    ds_read_b128 v[84:87], v2 offset:5120
    ds_read_b128 v[88:91], v2 offset:6144
    ds_read_b128 v[92:95], v2 offset:7168
    ds_read_b128 v[96:99], v2 offset:8192
    ds_read_b128 v[100:103], v2 offset:9216
    ds_read_b128 v[104:107], v2 offset:10240
    ds_read_b128 v[108:111], v2 offset:11264
    s_waitcnt lgkmcnt(11)
    v_smfmac_f32_16x16x64_bf16 v[16:19], v[64:67], a[0:7], v3
    ds_read_b128 v[112:115], v2 offset:12288
    s_waitcnt lgkmcnt(11)
    v_smfmac_f32_16x16x64_bf16 v[16:19], v[68:71], a[8:15], v3
    ds_read_b128 v[116:119], v2 offset:13312
    s_waitcnt lgkmcnt(11)
    v_smfmac_f32_16x16x64_bf16 v[16:19], v[72:75], a[16:23], v3
    ds_read_b128 v[120:123], v2 offset:14336
    s_waitcnt lgkmcnt(11)
    v_smfmac_f32_16x16x64_bf16 v[16:19], v[76:79], a[24:31], v3
    ds_read_b128 v[124:127], v2 offset:15360
    s_waitcnt lgkmcnt(11)
    v_smfmac_f32_16x16x64_bf16 v[16:19], v[80:83], a[32:39], v3
    s_waitcnt lgkmcnt(10)
    v_smfmac_f32_16x16x64_bf16 v[16:19], v[84:87], a[40:47], v3
    s_waitcnt lgkmcnt(9)
    v_smfmac_f32_16x16x64_bf16 v[16:19], v[88:91], a[48:55], v3
    s_waitcnt lgkmcnt(8)
    v_smfmac_f32_16x16x64_bf16 v[16:19], v[92:95], a[56:63], v3
    s_waitcnt lgkmcnt(7)
    v_smfmac_f32_16x16x64_bf16 v[16:19], v[96:99], a[64:71], v3
    s_waitcnt lgkmcnt(6)
    v_smfmac_f32_16x16x64_bf16 v[16:19], v[100:103], a[72:79], v3
    s_waitcnt lgkmcnt(5)
    v_smfmac_f32_16x16x64_bf16 v[16:19], v[104:107], a[80:87], v3
    s_waitcnt lgkmcnt(4)
    v_smfmac_f32_16x16x64_bf16 v[16:19], v[108:111], a[88:95], v3
    s_waitcnt lgkmcnt(3)
    v_smfmac_f32_16x16x64_bf16 v[16:19], v[112:115], a[96:103], v3
    s_waitcnt lgkmcnt(2)
    v_smfmac_f32_16x16x64_bf16 v[16:19], v[116:119], a[104:111], v3
    s_waitcnt lgkmcnt(1)
    v_smfmac_f32_16x16x64_bf16 v[16:19], v[120:123], a[112:119], v3
    s_waitcnt lgkmcnt(0)
    v_smfmac_f32_16x16x64_bf16 v[16:19], v[124:127], a[120:127], v3
    s_nop 7
    v_permlane32_swap_b32 v16, v18
    v_permlane32_swap_b32 v17, v19
    v_add_f32 v16, v16, v18
    v_add_f32 v17, v17, v19
    s_mov_b32 vcc_lo, 0x55555555
    s_mov_b32 vcc_hi, 0x55555555
    v_cndmask_b32_dpp v18, v17, v16, vcc quad_perm:[1,0,3,2] row_mask:0xf bank_mask:0xf
    s_not_b64 vcc, vcc
    v_cndmask_b32_dpp v19, v16, v17, vcc quad_perm:[1,0,3,2] row_mask:0xf bank_mask:0xf
    v_cvt_pk_bf16_f32 v18, v18, v19
    v_min_u32 v18, -2, v18
    buffer_store_dword v18, v4, s[12:15], s61 offen
    ds_write_b32 v5, v18
    s_cmp_eq_u32 s60, 63
    s_cbranch_scc1 L_s_last_196
    ds_read_b128 v[32:35], v6 offset:0
    ds_read_b128 v[36:39], v6 offset:1024
    ds_read_b128 v[40:43], v6 offset:2048
    ds_read_b128 v[44:47], v6 offset:3072
    ds_read_b128 v[48:51], v6 offset:4096
    ds_read_b128 v[52:55], v6 offset:5120
    ds_read_b128 v[56:59], v6 offset:6144
    ds_read_b128 v[60:63], v6 offset:7168
    s_sleep 4
    s_mov_b32 s70, 0
    buffer_load_dwordx4 v[64:67], v7, s[12:15], s61 offen offset:0 sc1
    buffer_load_dwordx4 v[68:71], v7, s[12:15], s61 offen offset:1024 sc1
    buffer_load_dwordx4 v[72:75], v7, s[12:15], s61 offen offset:2048 sc1
    buffer_load_dwordx4 v[76:79], v7, s[12:15], s61 offen offset:3072 sc1
    s_branch L_s_xm_198
L_s_xp_197:
    buffer_load_dwordx4 v[64:67], v7, s[12:15], s61 offen offset:0 sc1
    buffer_load_dwordx4 v[68:71], v7, s[12:15], s61 offen offset:1024 sc1
    buffer_load_dwordx4 v[72:75], v7, s[12:15], s61 offen offset:2048 sc1
    buffer_load_dwordx4 v[76:79], v7, s[12:15], s61 offen offset:3072 sc1
    s_waitcnt vmcnt(0)
L_s_xm_198:
    s_waitcnt lgkmcnt(0)
    s_waitcnt vmcnt(3)
    v_mfma_f32_16x16x32_bf16 v[20:23], v[48:51], v[64:67], 0
    v_mfma_f32_16x16x32_bf16 v[16:19], v[32:35], v[64:67], 0
    v_mfma_f32_16x16x32_bf16 v[24:27], v[64:67], v[64:67], v[28:31]
    v_max3_u32 v10, v64, v64, v65
    v_max3_u32 v10, v10, v66, v67
    s_waitcnt vmcnt(2)
    v_mfma_f32_16x16x32_bf16 v[20:23], v[52:55], v[68:71], v[20:23]
    v_mfma_f32_16x16x32_bf16 v[16:19], v[36:39], v[68:71], v[16:19]
    v_mfma_f32_16x16x32_bf16 v[24:27], v[68:71], v[68:71], v[24:27]
    v_max3_u32 v10, v10, v68, v69
    v_max3_u32 v10, v10, v70, v71
    s_waitcnt vmcnt(1)
    v_mfma_f32_16x16x32_bf16 v[20:23], v[56:59], v[72:75], v[20:23]
    v_mfma_f32_16x16x32_bf16 v[16:19], v[40:43], v[72:75], v[16:19]
    v_mfma_f32_16x16x32_bf16 v[24:27], v[72:75], v[72:75], v[24:27]
    v_max3_u32 v10, v10, v72, v73
    v_max3_u32 v10, v10, v74, v75
    s_waitcnt vmcnt(0)
    v_mfma_f32_16x16x32_bf16 v[20:23], v[60:63], v[76:79], v[20:23]
    v_mfma_f32_16x16x32_bf16 v[16:19], v[44:47], v[76:79], v[16:19]
    v_mfma_f32_16x16x32_bf16 v[24:27], v[76:79], v[76:79], v[24:27]
    v_max3_u32 v10, v10, v76, v77
    v_max3_u32 v10, v10, v78, v79
    v_cmp_eq_u32 vcc, -1, v10
    s_nop 1
    s_add_u32 s70, s70, 1
    s_cbranch_vccz L_ok_199
    s_cmp_lt_u32 s70, 524288
    s_cbranch_scc1 L_s_xp_197
    s_branch L_c_done_1
L_ok_199:
    v_mov_b32_dpp v16, v20 row_ror:8 row_mask:0xf bank_mask:0xc
    v_mov_b32_dpp v17, v21 row_ror:8 row_mask:0xf bank_mask:0xc
    v_mov_b32_dpp v18, v22 row_ror:8 row_mask:0xf bank_mask:0xc
    v_mov_b32_dpp v19, v23 row_ror:8 row_mask:0xf bank_mask:0xc
    v_mov_b32_dpp v24, v26 row_ror:8 row_mask:0xf bank_mask:0xc
    v_mov_b32_dpp v25, v27 row_ror:8 row_mask:0xf bank_mask:0xc
    v_max3_f32 v10, v16, v17, v18
    v_max3_f32 v10, v10, v19, v24
    v_max_f32 v10, v10, v25
    s_nop 1
    v_max_f32_dpp v11, v10, v10 row_ror:8 row_mask:0xf bank_mask:0xf
    v_max_f32_dpp v10, v10, v10 row_ror:8 row_mask:0xf bank_mask:0xf
    s_nop 1
    v_permlane16_swap_b32 v10, v11
    v_max_f32 v12, v10, v11
    v_max_f32 v10, v10, v11
    s_nop 1
    v_permlane32_swap_b32 v10, v12
    v_max_f32 v10, v10, v12
    v_mul_f32 v10, s66, v10
    v_fma_f32 v16, v16, s66, -v10
    v_fma_f32 v17, v17, s66, -v10
    v_fma_f32 v18, v18, s66, -v10
    v_fma_f32 v19, v19, s66, -v10
    v_fma_f32 v24, v24, s66, -v10
    v_fma_f32 v25, v25, s66, -v10
    v_exp_f32 v16, v16
    v_exp_f32 v17, v17
    v_exp_f32 v18, v18
    v_exp_f32 v19, v19
    v_exp_f32 v24, v24
    v_exp_f32 v25, v25
    v_add_f32 v10, v16, v17
    v_add_f32 v11, v18, v19
    v_add_f32 v10, v10, v24
    v_add_f32 v11, v11, v25
    v_add_f32 v10, v10, v11
    s_nop 1
    v_add_f32_dpp v11, v10, v10 row_ror:8 row_mask:0xf bank_mask:0xf
    v_add_f32_dpp v10, v10, v10 row_ror:8 row_mask:0xf bank_mask:0xf
    s_nop 1
    v_permlane16_swap_b32 v10, v11
    v_add_f32 v12, v10, v11
    v_add_f32 v10, v10, v11
    s_nop 1
    v_permlane32_swap_b32 v10, v12
    v_add_f32 v10, v10, v12
    v_rcp_f32 v10, v10
    s_nop 0
    v_mul_f32 v16, v16, v10
    v_mul_f32 v17, v17, v10
    v_mul_f32 v18, v18, v10
    v_mul_f32 v19, v19, v10
    v_mul_f32 v24, v24, v10
    v_mul_f32 v25, v25, v10
    v_cvt_pk_bf16_f32 v16, v16, v17
    v_cvt_pk_bf16_f32 v17, v18, v19
    v_cvt_pk_bf16_f32 v18, v24, v25
    ds_write_b64 v8, v[16:17]
    ds_write_b32 v9, v18
    s_waitcnt lgkmcnt(0)
    s_barrier
    s_add_u32 s63, s63, 786432
    s_sleep 4
    s_xor_b32 s45, s61, 0x8000
    buffer_store_dword v13, v4, s[12:15], s45 offen
    s_cmp_lg_u32 s44, 0
    s_cbranch_scc1 L_s_np_200
    ds_read_b128 v[20:23], v2 offset:27648
    s_lshl_b32 s45, s60, 17
    s_add_u32 s45, s45, s67
    s_waitcnt lgkmcnt(0)
    buffer_store_dwordx4 v[20:23], v2, s[12:15], s45 offen
L_s_np_200:
    v_mov_b32 v16, -1
    v_mov_b32 v17, -1
    v_mov_b32 v18, -1
    v_mov_b32 v19, -1
    s_lshl_b32 s45, s60, 18
    s_mov_b64 exec, 0xffffffff
    buffer_store_dwordx4 v[16:19], v15, s[12:15], s45 offen sc1
    s_mov_b64 exec, -1
    s_cmp_lg_u32 s44, 1
    s_cbranch_scc1 L_s_n1_201
    s_lshl_b32 s45, s60, 17
    s_add_u32 s45, s45, s67
    s_add_u32 s45, s45, 1048576
    buffer_store_dwordx4 v[16:19], v2, s[12:15], s45 offen sc1
L_s_n1_201:
    s_add_u32 s68, s60, 2
    s_min_u32 s68, s68, 63
    s_cmp_gt_u32 s69, s68
    s_cbranch_scc1 L_kv_ok_203
    s_mov_b32 s70, 0
L_kv_lp_202:
    buffer_load_dword v10, v14, s[12:15], 0 offen sc1
    s_waitcnt vmcnt(0)
    v_readlane_b32 s69, v10, 0
    v_readlane_b32 s45, v10, 1
    s_add_u32 s70, s70, 1
    s_nop 2
    s_min_u32 s69, s69, s45
    s_cmp_gt_u32 s69, s68
    s_cbranch_scc1 L_kv_ok_203
    s_sleep 4
    s_cmp_lt_u32 s70, 524288
    s_cbranch_scc1 L_kv_lp_202
    s_branch L_c_done_1
L_kv_ok_203:
    s_add_u32 s60, s60, 1
    s_add_u32 s61, s61, 0x4000
    s_and_b32 s61, s61, 0xffff
    s_branch L_s_loop_195
L_s_last_196:
    s_waitcnt lgkmcnt(0)
    s_barrier
    s_cmp_lg_u32 s44, 0
    s_cbranch_scc1 L_s_np_204
    ds_read_b128 v[20:23], v2 offset:27648
    s_lshl_b32 s45, s60, 17
    s_add_u32 s45, s45, s67
    s_waitcnt lgkmcnt(0)
    buffer_store_dwordx4 v[20:23], v2, s[12:15], s45 offen
L_s_np_204:
    s_branch L_c_done_1
L_ss_192:
L_s_loop_205:
    v_mov_b32 v16, 0
    v_mov_b32 v17, 0
    v_mov_b32 v18, 0
    v_mov_b32 v19, 0
    s_barrier
    ds_read_b128 v[64:67], v2 offset:0
    ds_read_b128 v[68:71], v2 offset:1024
    ds_read_b128 v[72:75], v2 offset:2048
    ds_read_b128 v[76:79], v2 offset:3072
    ds_read_b128 v[80:83], v2 offset:4096
    ds_read_b128 v[84:87], v2 offset:5120
    ds_read_b128 v[88:91], v2 offset:6144
    ds_read_b128 v[92:95], v2 offset:7168
    ds_read_b128 v[96:99], v2 offset:8192
    ds_read_b128 v[100:103], v2 offset:9216
    ds_read_b128 v[104:107], v2 offset:10240
    ds_read_b128 v[108:111], v2 offset:11264
    s_waitcnt lgkmcnt(11)
    v_smfmac_f32_16x16x64_bf16 v[16:19], v[64:67], a[0:7], v3
    ds_read_b128 v[112:115], v2 offset:12288
    s_waitcnt lgkmcnt(11)
    v_smfmac_f32_16x16x64_bf16 v[16:19], v[68:71], a[8:15], v3
    ds_read_b128 v[116:119], v2 offset:13312
    s_waitcnt lgkmcnt(11)
    v_smfmac_f32_16x16x64_bf16 v[16:19], v[72:75], a[16:23], v3
    ds_read_b128 v[120:123], v2 offset:14336
    s_waitcnt lgkmcnt(11)
    v_smfmac_f32_16x16x64_bf16 v[16:19], v[76:79], a[24:31], v3
    ds_read_b128 v[124:127], v2 offset:15360
    s_waitcnt lgkmcnt(11)
    v_smfmac_f32_16x16x64_bf16 v[16:19], v[80:83], a[32:39], v3
    s_waitcnt lgkmcnt(10)
    v_smfmac_f32_16x16x64_bf16 v[16:19], v[84:87], a[40:47], v3
    s_waitcnt lgkmcnt(9)
    v_smfmac_f32_16x16x64_bf16 v[16:19], v[88:91], a[48:55], v3
    s_waitcnt lgkmcnt(8)
    v_smfmac_f32_16x16x64_bf16 v[16:19], v[92:95], a[56:63], v3
    s_waitcnt lgkmcnt(7)
    v_smfmac_f32_16x16x64_bf16 v[16:19], v[96:99], a[64:71], v3
    s_waitcnt lgkmcnt(6)
    v_smfmac_f32_16x16x64_bf16 v[16:19], v[100:103], a[72:79], v3
    s_waitcnt lgkmcnt(5)
    v_smfmac_f32_16x16x64_bf16 v[16:19], v[104:107], a[80:87], v3
    s_waitcnt lgkmcnt(4)
    v_smfmac_f32_16x16x64_bf16 v[16:19], v[108:111], a[88:95], v3
    s_waitcnt lgkmcnt(3)
    v_smfmac_f32_16x16x64_bf16 v[16:19], v[112:115], a[96:103], v3
    s_waitcnt lgkmcnt(2)
    v_smfmac_f32_16x16x64_bf16 v[16:19], v[116:119], a[104:111], v3
    s_waitcnt lgkmcnt(1)
    v_smfmac_f32_16x16x64_bf16 v[16:19], v[120:123], a[112:119], v3
    s_waitcnt lgkmcnt(0)
    v_smfmac_f32_16x16x64_bf16 v[16:19], v[124:127], a[120:127], v3
    s_nop 7
    v_permlane32_swap_b32 v16, v18
    v_permlane32_swap_b32 v17, v19
    v_add_f32 v16, v16, v18
    v_add_f32 v17, v17, v19
    s_mov_b32 vcc_lo, 0x55555555
    s_mov_b32 vcc_hi, 0x55555555
    v_cndmask_b32_dpp v18, v17, v16, vcc quad_perm:[1,0,3,2] row_mask:0xf bank_mask:0xf
    s_not_b64 vcc, vcc
    v_cndmask_b32_dpp v19, v16, v17, vcc quad_perm:[1,0,3,2] row_mask:0xf bank_mask:0xf
    v_cvt_pk_bf16_f32 v18, v18, v19
    v_min_u32 v18, -2, v18
    buffer_store_dword v18, v4, s[12:15], s61 offen sc1
    ds_write_b32 v5, v18
    s_cmp_eq_u32 s60, 63
    s_cbranch_scc1 L_s_last_206
    ds_read_b128 v[32:35], v6 offset:0
    ds_read_b128 v[36:39], v6 offset:1024
    ds_read_b128 v[40:43], v6 offset:2048
    ds_read_b128 v[44:47], v6 offset:3072
    ds_read_b128 v[48:51], v6 offset:4096
    ds_read_b128 v[52:55], v6 offset:5120
    ds_read_b128 v[56:59], v6 offset:6144
    ds_read_b128 v[60:63], v6 offset:7168
    s_sleep 4
    s_mov_b32 s70, 0
    buffer_load_dwordx4 v[64:67], v7, s[12:15], s61 offen offset:0 sc1
    buffer_load_dwordx4 v[68:71], v7, s[12:15], s61 offen offset:1024 sc1
    buffer_load_dwordx4 v[72:75], v7, s[12:15], s61 offen offset:2048 sc1
    buffer_load_dwordx4 v[76:79], v7, s[12:15], s61 offen offset:3072 sc1
    s_branch L_s_xm_208
L_s_xp_207:
    buffer_load_dwordx4 v[64:67], v7, s[12:15], s61 offen offset:0 sc1
    buffer_load_dwordx4 v[68:71], v7, s[12:15], s61 offen offset:1024 sc1
    buffer_load_dwordx4 v[72:75], v7, s[12:15], s61 offen offset:2048 sc1
    buffer_load_dwordx4 v[76:79], v7, s[12:15], s61 offen offset:3072 sc1
    s_waitcnt vmcnt(0)
L_s_xm_208:
    s_waitcnt lgkmcnt(0)
    s_waitcnt vmcnt(3)
    v_mfma_f32_16x16x32_bf16 v[20:23], v[48:51], v[64:67], 0
    v_mfma_f32_16x16x32_bf16 v[16:19], v[32:35], v[64:67], 0
    v_mfma_f32_16x16x32_bf16 v[24:27], v[64:67], v[64:67], v[28:31]
    v_max3_u32 v10, v64, v64, v65
    v_max3_u32 v10, v10, v66, v67
    s_waitcnt vmcnt(2)
    v_mfma_f32_16x16x32_bf16 v[20:23], v[52:55], v[68:71], v[20:23]
    v_mfma_f32_16x16x32_bf16 v[16:19], v[36:39], v[68:71], v[16:19]
    v_mfma_f32_16x16x32_bf16 v[24:27], v[68:71], v[68:71], v[24:27]
    v_max3_u32 v10, v10, v68, v69
    v_max3_u32 v10, v10, v70, v71
    s_waitcnt vmcnt(1)
    v_mfma_f32_16x16x32_bf16 v[20:23], v[56:59], v[72:75], v[20:23]
    v_mfma_f32_16x16x32_bf16 v[16:19], v[40:43], v[72:75], v[16:19]
    v_mfma_f32_16x16x32_bf16 v[24:27], v[72:75], v[72:75], v[24:27]
    v_max3_u32 v10, v10, v72, v73
    v_max3_u32 v10, v10, v74, v75
    s_waitcnt vmcnt(0)
    v_mfma_f32_16x16x32_bf16 v[20:23], v[60:63], v[76:79], v[20:23]
    v_mfma_f32_16x16x32_bf16 v[16:19], v[44:47], v[76:79], v[16:19]
    v_mfma_f32_16x16x32_bf16 v[24:27], v[76:79], v[76:79], v[24:27]
    v_max3_u32 v10, v10, v76, v77
    v_max3_u32 v10, v10, v78, v79
    v_cmp_eq_u32 vcc, -1, v10
    s_nop 1
    s_add_u32 s70, s70, 1
    s_cbranch_vccz L_ok_209
    s_cmp_lt_u32 s70, 524288
    s_cbranch_scc1 L_s_xp_207
    s_branch L_c_done_1
L_ok_209:
    v_mov_b32_dpp v16, v20 row_ror:8 row_mask:0xf bank_mask:0xc
    v_mov_b32_dpp v17, v21 row_ror:8 row_mask:0xf bank_mask:0xc
    v_mov_b32_dpp v18, v22 row_ror:8 row_mask:0xf bank_mask:0xc
    v_mov_b32_dpp v19, v23 row_ror:8 row_mask:0xf bank_mask:0xc
    v_mov_b32_dpp v24, v26 row_ror:8 row_mask:0xf bank_mask:0xc
    v_mov_b32_dpp v25, v27 row_ror:8 row_mask:0xf bank_mask:0xc
    v_max3_f32 v10, v16, v17, v18
    v_max3_f32 v10, v10, v19, v24
    v_max_f32 v10, v10, v25
    s_nop 1
    v_max_f32_dpp v11, v10, v10 row_ror:8 row_mask:0xf bank_mask:0xf
    v_max_f32_dpp v10, v10, v10 row_ror:8 row_mask:0xf bank_mask:0xf
    s_nop 1
    v_permlane16_swap_b32 v10, v11
    v_max_f32 v12, v10, v11
    v_max_f32 v10, v10, v11
    s_nop 1
    v_permlane32_swap_b32 v10, v12
    v_max_f32 v10, v10, v12
    v_mul_f32 v10, s66, v10
    v_fma_f32 v16, v16, s66, -v10
    v_fma_f32 v17, v17, s66, -v10
    v_fma_f32 v18, v18, s66, -v10
    v_fma_f32 v19, v19, s66, -v10
    v_fma_f32 v24, v24, s66, -v10
    v_fma_f32 v25, v25, s66, -v10
    v_exp_f32 v16, v16
    v_exp_f32 v17, v17
    v_exp_f32 v18, v18
    v_exp_f32 v19, v19
    v_exp_f32 v24, v24
    v_exp_f32 v25, v25
    v_add_f32 v10, v16, v17
    v_add_f32 v11, v18, v19
    v_add_f32 v10, v10, v24
    v_add_f32 v11, v11, v25
    v_add_f32 v10, v10, v11
    s_nop 1
    v_add_f32_dpp v11, v10, v10 row_ror:8 row_mask:0xf bank_mask:0xf
    v_add_f32_dpp v10, v10, v10 row_ror:8 row_mask:0xf bank_mask:0xf
    s_nop 1
    v_permlane16_swap_b32 v10, v11
    v_add_f32 v12, v10, v11
    v_add_f32 v10, v10, v11
    s_nop 1
    v_permlane32_swap_b32 v10, v12
    v_add_f32 v10, v10, v12
    v_rcp_f32 v10, v10
    s_nop 0
    v_mul_f32 v16, v16, v10
    v_mul_f32 v17, v17, v10
    v_mul_f32 v18, v18, v10
    v_mul_f32 v19, v19, v10
    v_mul_f32 v24, v24, v10
    v_mul_f32 v25, v25, v10
    v_cvt_pk_bf16_f32 v16, v16, v17
    v_cvt_pk_bf16_f32 v17, v18, v19
    v_cvt_pk_bf16_f32 v18, v24, v25
    ds_write_b64 v8, v[16:17]
    ds_write_b32 v9, v18
    s_waitcnt lgkmcnt(0)
    s_barrier
    s_add_u32 s63, s63, 786432
    s_sleep 4
    s_xor_b32 s45, s61, 0x8000
    buffer_store_dword v13, v4, s[12:15], s45 offen sc1
    s_cmp_lg_u32 s44, 0
    s_cbranch_scc1 L_s_np_210
    ds_read_b128 v[20:23], v2 offset:27648
    s_lshl_b32 s45, s60, 17
    s_add_u32 s45, s45, s67
    s_waitcnt lgkmcnt(0)
    buffer_store_dwordx4 v[20:23], v2, s[12:15], s45 offen sc1
L_s_np_210:
    v_mov_b32 v16, -1
    v_mov_b32 v17, -1
    v_mov_b32 v18, -1
    v_mov_b32 v19, -1
    s_lshl_b32 s45, s60, 18
    s_mov_b64 exec, 0xffffffff
    buffer_store_dwordx4 v[16:19], v15, s[12:15], s45 offen sc1
    s_mov_b64 exec, -1
    s_cmp_lg_u32 s44, 1
    s_cbranch_scc1 L_s_n1_211
    s_lshl_b32 s45, s60, 17
    s_add_u32 s45, s45, s67
    s_add_u32 s45, s45, 1048576
    buffer_store_dwordx4 v[16:19], v2, s[12:15], s45 offen sc1
L_s_n1_211:
    s_add_u32 s68, s60, 2
    s_min_u32 s68, s68, 63
    s_cmp_gt_u32 s69, s68
    s_cbranch_scc1 L_kv_ok_213
    s_mov_b32 s70, 0
L_kv_lp_212:
    buffer_load_dword v10, v14, s[12:15], 0 offen sc1
    s_waitcnt vmcnt(0)
    v_readlane_b32 s69, v10, 0
    v_readlane_b32 s45, v10, 1
    s_add_u32 s70, s70, 1
    s_nop 2
    s_min_u32 s69, s69, s45
    s_cmp_gt_u32 s69, s68
    s_cbranch_scc1 L_kv_ok_213
    s_sleep 4
    s_cmp_lt_u32 s70, 524288
    s_cbranch_scc1 L_kv_lp_212
    s_branch L_c_done_1
L_kv_ok_213:
    s_add_u32 s60, s60, 1
    s_add_u32 s61, s61, 0x4000
    s_and_b32 s61, s61, 0xffff
    s_branch L_s_loop_205
L_s_last_206:
    s_waitcnt lgkmcnt(0)
    s_barrier
    s_cmp_lg_u32 s44, 0
    s_cbranch_scc1 L_s_np_214
    ds_read_b128 v[20:23], v2 offset:27648
    s_lshl_b32 s45, s60, 17
    s_add_u32 s45, s45, s67
    s_waitcnt lgkmcnt(0)
    buffer_store_dwordx4 v[20:23], v2, s[12:15], s45 offen sc1
L_s_np_214:
    s_branch L_c_done_1
L_vf_193:
    s_cmp_eq_u32 s52, 0
    s_cbranch_scc1 L_vs_194
    s_mov_b32 s70, 0
    v_mov_b32 v16, 0
    v_mov_b32 v17, 0
    s_branch L_v_l1m_217
L_v_loop_215:
    s_mov_b32 s70, 0
    buffer_load_dwordx4 v[64:67], v9, s[12:15], s61 offen offset:0 sc1
    buffer_load_dwordx4 v[68:71], v9, s[12:15], s61 offen offset:1024 sc1
    buffer_load_dwordx4 v[72:75], v9, s[12:15], s61 offen offset:2048 sc1
    buffer_load_dwordx4 v[76:79], v9, s[12:15], s61 offen offset:3072 sc1
    v_mov_b32 v16, 0
    v_mov_b32 v17, 0
    v_mov_b32 v18, 0
    v_mov_b32 v19, 0
    v_mov_b32 v20, 0
    v_mov_b32 v21, 0
    v_mov_b32 v22, 0
    v_mov_b32 v23, 0
    s_branch L_v_l1m_217
L_v_l1_216:
    buffer_load_dwordx4 v[64:67], v9, s[12:15], s61 offen offset:0 sc1
    buffer_load_dwordx4 v[68:71], v9, s[12:15], s61 offen offset:1024 sc1
    buffer_load_dwordx4 v[72:75], v9, s[12:15], s61 offen offset:2048 sc1
    buffer_load_dwordx4 v[76:79], v9, s[12:15], s61 offen offset:3072 sc1
L_v_l1m_217:
    s_waitcnt vmcnt(3)
    ds_write_b128 v10, v[64:67] offset:0
    v_max3_u32 v24, v64, v64, v65
    v_max3_u32 v24, v24, v66, v67
    s_waitcnt vmcnt(2)
    ds_write_b128 v10, v[68:71] offset:1024
    v_max3_u32 v24, v24, v68, v69
    v_max3_u32 v24, v24, v70, v71
    s_waitcnt vmcnt(1)
    ds_write_b128 v10, v[72:75] offset:2048
    v_max3_u32 v24, v24, v72, v73
    v_max3_u32 v24, v24, v74, v75
    s_waitcnt vmcnt(0)
    ds_write_b128 v10, v[76:79] offset:3072
    v_max3_u32 v24, v24, v76, v77
    v_max3_u32 v24, v24, v78, v79
    v_cmp_eq_u32 vcc, -1, v24
    s_add_u32 s70, s70, 1
    s_cbranch_vccz L_ok_218
    s_cmp_lt_u32 s70, 524288
    s_cbranch_scc1 L_v_l1_216
    s_branch L_c_done_1
L_ok_218:
    s_waitcnt lgkmcnt(0)
    s_barrier
    v_smfmac_f32_16x16x64_bf16 v[16:19], v[64:67], a[0:7], v3
    v_smfmac_f32_16x16x64_bf16 v[20:23], v[64:67], a[32:39], v3
    v_smfmac_f32_16x16x64_bf16 v[16:19], v[68:71], a[8:15], v3
    v_smfmac_f32_16x16x64_bf16 v[20:23], v[68:71], a[40:47], v3
    v_smfmac_f32_16x16x64_bf16 v[16:19], v[72:75], a[16:23], v3
    v_smfmac_f32_16x16x64_bf16 v[20:23], v[72:75], a[48:55], v3
    v_smfmac_f32_16x16x64_bf16 v[16:19], v[76:79], a[24:31], v3
    v_smfmac_f32_16x16x64_bf16 v[20:23], v[76:79], a[56:63], v3
    s_nop 6
    v_permlane32_swap_b32 v16, v18
    v_permlane32_swap_b32 v17, v19
    v_permlane32_swap_b32 v20, v22
    v_permlane32_swap_b32 v21, v23
    v_add_f32 v16, v16, v18
    v_add_f32 v17, v17, v19
    v_add_f32 v18, v20, v22
    v_add_f32 v19, v21, v23
    ds_write_b128 v14, v[16:19]
    s_mov_b64 exec, 1
    ds_add_u32 v29, v30
    s_mov_b64 exec, -1
    s_add_u32 s58, s58, 4
    s_bitcmp1_b32 s44, 0
    s_cbranch_scc1 L_v_k1_220
    s_mov_b32 s70, 0
L_v_rl_221:
    ds_read_b32 v24, v29
    ds_read_b64 v[16:17], v13 offset:0
    ds_read_b64 v[18:19], v13 offset:1024
    ds_read_b64 v[20:21], v13 offset:2048
    ds_read_b64 v[22:23], v13 offset:3072
    s_waitcnt lgkmcnt(2)
    v_cmp_ne_u32 vcc, s58, v24
    v_add_f32 v16, v16, v18
    v_add_f32 v17, v17, v19
    s_waitcnt lgkmcnt(0)
    s_add_u32 s70, s70, 1
    s_cbranch_vccz L_ok_222
    s_cmp_lt_u32 s70, 524288
    s_cbranch_scc1 L_v_rl_221
    s_branch L_c_done_1
L_ok_222:
    v_add_f32 v20, v20, v22
    v_add_f32 v21, v21, v23
    v_add_f32 v16, v16, v20
    v_add_f32 v17, v17, v21
    s_mov_b32 vcc_lo, 0x55555555
    s_mov_b32 vcc_hi, 0x55555555
    v_cndmask_b32_dpp v18, v17, v16, vcc quad_perm:[1,0,3,2] row_mask:0xf bank_mask:0xf
    s_not_b64 vcc, vcc
    v_cndmask_b32_dpp v19, v16, v17, vcc quad_perm:[1,0,3,2] row_mask:0xf bank_mask:0xf
    v_cvt_pk_bf16_f32 v18, v18, v19
    v_min_u32 v18, -2, v18
    buffer_store_dword v18, v4, s[12:15], s62 offen
    ds_write_b32 v5, v18
L_v_k1_220:
    s_cmp_eq_u32 s60, 63
    s_cbranch_scc1 L_v_last_219
    ds_read_b128 v[80:83], v27 offset:32768
    ds_read_b128 v[84:87], v27 offset:36864
    ds_read_b128 v[88:91], v27 offset:40960
    ds_read_b128 v[92:95], v27 offset:45056
    v_mov_b32 v96, 0
    v_mov_b32 v97, 0
    v_mov_b32 v98, 0
    v_mov_b32 v99, 0
    v_mov_b32 v100, 0
    v_mov_b32 v101, 0
    v_mov_b32 v102, 0
    v_mov_b32 v103, 0
    v_mov_b32 v104, 0
    v_mov_b32 v105, 0
    v_mov_b32 v106, 0
    v_mov_b32 v107, 0
    v_mov_b32 v108, 0
    v_mov_b32 v109, 0
    v_mov_b32 v110, 0
    v_mov_b32 v111, 0
    s_bitcmp1_b32 s44, 0
    s_cbranch_scc0 L_v_sv_223
    s_sleep 3
L_v_sv_223:
    s_sleep 2
    s_mov_b32 s70, 0
L_v_vp_224:
    buffer_load_dwordx4 v[64:67], v11, s[12:15], s62 offen offset:0 sc1
    buffer_load_dwordx4 v[68:71], v11, s[12:15], s62 offen offset:1024 sc1
    s_waitcnt vmcnt(0)
    v_max3_u32 v20, v64, v65, v66
    v_max3_u32 v20, v20, v67, v68
    v_max3_u32 v20, v20, v69, v70
    v_max_u32 v20, v20, v71
    v_cmp_eq_u32 vcc, -1, v20
    s_add_u32 s70, s70, 1
    s_cbranch_vccz L_ok_225
    s_cmp_lt_u32 s70, 524288
    s_cbranch_scc1 L_v_vp_224
    s_branch L_c_done_1
L_ok_225:
    v_smfmac_f32_16x16x64_bf16 v[96:99], v[64:67], a[64:71], v3
    v_smfmac_f32_16x16x64_bf16 v[96:99], v[68:71], a[72:79], v3
    v_smfmac_f32_16x16x64_bf16 v[100:103], v[64:67], a[80:87], v3
    v_smfmac_f32_16x16x64_bf16 v[100:103], v[68:71], a[88:95], v3
    v_smfmac_f32_16x16x64_bf16 v[104:107], v[64:67], a[96:103], v3
    v_smfmac_f32_16x16x64_bf16 v[104:107], v[68:71], a[104:111], v3
    v_smfmac_f32_16x16x64_bf16 v[108:111], v[64:67], a[112:119], v3
    v_smfmac_f32_16x16x64_bf16 v[108:111], v[68:71], a[120:127], v3
    s_add_u32 s46, s65, 4096
    buffer_load_dwordx4 v[32:35], v15, s[12:15], s65 offen offset:0 sc1
    buffer_load_dwordx4 v[48:51], v15, s[12:15], s46 offen offset:0 sc1
    buffer_load_dwordx4 v[36:39], v15, s[12:15], s65 offen offset:1024 sc1
    buffer_load_dwordx4 v[52:55], v15, s[12:15], s46 offen offset:1024 sc1
    buffer_load_dwordx4 v[40:43], v15, s[12:15], s65 offen offset:2048 sc1
    buffer_load_dwordx4 v[56:59], v15, s[12:15], s46 offen offset:2048 sc1
    buffer_load_dwordx4 v[44:47], v15, s[12:15], s65 offen offset:3072 sc1
    buffer_load_dwordx4 v[60:63], v15, s[12:15], s46 offen offset:3072 sc1
    s_add_u32 s65, s65, 786432
    v_cvt_pk_bf16_f32 v96, v96, v97
    v_cvt_pk_bf16_f32 v97, v98, v99
    ds_write_b64 v12, v[96:97] offset:0
    v_cvt_pk_bf16_f32 v100, v100, v101
    v_cvt_pk_bf16_f32 v101, v102, v103
    ds_write_b64 v12, v[100:101] offset:2048
    v_cvt_pk_bf16_f32 v104, v104, v105
    v_cvt_pk_bf16_f32 v105, v106, v107
    ds_write_b64 v12, v[104:105] offset:4096
    v_cvt_pk_bf16_f32 v108, v108, v109
    v_cvt_pk_bf16_f32 v109, v110, v111
    ds_write_b64 v12, v[108:109] offset:6144
    s_waitcnt lgkmcnt(0)
    s_barrier
    ds_read_b128 v[96:99], v2 offset:16384
    ds_read_b128 v[100:103], v2 offset:17408
    ds_read_b128 v[104:107], v2 offset:18432
    ds_read_b128 v[108:111], v2 offset:19456
    ds_read_b128 v[112:115], v31 offset:0
    ds_read_b128 v[116:119], v25 offset:0
    ds_read_b128 v[120:123], v31 offset:512
    ds_read_b128 v[124:127], v25 offset:1024
    s_waitcnt lgkmcnt(7)
    v_mfma_f32_16x16x32_bf16 v[16:19], v[80:83], v[96:99], 0
    s_waitcnt lgkmcnt(6)
    v_mfma_f32_16x16x32_bf16 v[16:19], v[84:87], v[100:103], v[16:19]
    s_waitcnt lgkmcnt(5)
    v_mfma_f32_16x16x32_bf16 v[16:19], v[88:91], v[104:107], v[16:19]
    s_waitcnt lgkmcnt(4)
    v_mfma_f32_16x16x32_bf16 v[16:19], v[92:95], v[108:111], v[16:19]
    s_waitcnt lgkmcnt(2)
    v_mfma_f32_16x16x32_bf16 v[16:19], v[116:119], v[112:115], v[16:19]
    s_waitcnt lgkmcnt(0)
    v_mfma_f32_16x16x32_bf16 v[16:19], v[124:127], v[120:123], v[16:19]
    s_mov_b32 exec_lo, 0x00ff00ff
    s_mov_b32 exec_hi, 0x00ff00ff
    s_nop 5
    v_min_u32 v16, -2, v16
    v_min_u32 v17, -2, v17
    v_min_u32 v18, -2, v18
    v_min_u32 v19, -2, v19
    buffer_store_dwordx4 v[16:19], v6, s[12:15], s63 offen sc1
    s_mov_b64 exec, -1
    s_add_u32 s61, s61, 0x4000
    s_and_b32 s61, s61, 0xffff
    s_mov_b32 s70, 1
    s_add_u32 s46, s64, 4096
    s_add_u32 m0, s59, 0
    s_nop 0
    buffer_load_dwordx4 v28, s[12:15], s64 offen offset:0 sc1 lds
    buffer_load_dwordx4 v28, s[12:15], s64 offen offset:1024 sc1 lds
    buffer_load_dwordx4 v28, s[12:15], s64 offen offset:2048 sc1 lds
    buffer_load_dwordx4 v28, s[12:15], s64 offen offset:3072 sc1 lds
    s_add_u32 m0, s59, 4096
    s_nop 0
    buffer_load_dwordx4 v28, s[12:15], s46 offen offset:0 sc1 lds
    buffer_load_dwordx4 v28, s[12:15], s46 offen offset:1024 sc1 lds
    buffer_load_dwordx4 v28, s[12:15], s46 offen offset:2048 sc1 lds
    buffer_load_dwordx4 v28, s[12:15], s46 offen offset:3072 sc1 lds
    s_add_u32 s64, s64, 786432
    s_waitcnt vmcnt(9)
    s_sleep 5
    buffer_load_dwordx4 v[96:99], v7, s[12:15], s63 offen offset:0 sc1
    buffer_load_dwordx4 v[100:103], v7, s[12:15], s63 offen offset:512 sc1
    buffer_load_dwordx4 v[104:107], v7, s[12:15], s63 offen offset:1024 sc1
    buffer_load_dwordx4 v[108:111], v7, s[12:15], s63 offen offset:1536 sc1
    v_mfma_f32_16x16x32_bf16 v[64:67], v[32:35], a[64:67], 0
    v_mfma_f32_16x16x32_bf16 v[68:71], v[48:51], a[64:67], 0
    v_mfma_f32_16x16x32_bf16 v[64:67], v[36:39], a[68:71], v[64:67]
    v_mfma_f32_16x16x32_bf16 v[68:71], v[52:55], a[68:71], v[68:71]
    v_mfma_f32_16x16x32_bf16 v[64:67], v[40:43], a[72:75], v[64:67]
    v_mfma_f32_16x16x32_bf16 v[68:71], v[56:59], a[72:75], v[68:71]
    v_mfma_f32_16x16x32_bf16 v[64:67], v[44:47], a[76:79], v[64:67]
    v_mfma_f32_16x16x32_bf16 v[68:71], v[60:63], a[76:79], v[68:71]
    v_mfma_f32_16x16x32_bf16 v[72:75], v[32:35], a[80:83], 0
    v_mfma_f32_16x16x32_bf16 v[76:79], v[48:51], a[80:83], 0
    v_mfma_f32_16x16x32_bf16 v[72:75], v[36:39], a[84:87], v[72:75]
    v_mfma_f32_16x16x32_bf16 v[76:79], v[52:55], a[84:87], v[76:79]
    v_mfma_f32_16x16x32_bf16 v[72:75], v[40:43], a[88:91], v[72:75]
    v_mfma_f32_16x16x32_bf16 v[76:79], v[56:59], a[88:91], v[76:79]
    v_mfma_f32_16x16x32_bf16 v[72:75], v[44:47], a[92:95], v[72:75]
    v_mfma_f32_16x16x32_bf16 v[76:79], v[60:63], a[92:95], v[76:79]
    v_cvt_pk_bf16_f32 v64, v64, v65
    v_cvt_pk_bf16_f32 v65, v66, v67
    v_cvt_pk_bf16_f32 v66, v68, v69
    v_cvt_pk_bf16_f32 v67, v70, v71
    ds_write_b128 v10, v[64:67] offset:32768
    v_mfma_f32_16x16x32_bf16 v[80:83], v[32:35], a[96:99], 0
    v_mfma_f32_16x16x32_bf16 v[84:87], v[48:51], a[96:99], 0
    v_mfma_f32_16x16x32_bf16 v[80:83], v[36:39], a[100:103], v[80:83]
    v_mfma_f32_16x16x32_bf16 v[84:87], v[52:55], a[100:103], v[84:87]
    v_mfma_f32_16x16x32_bf16 v[80:83], v[40:43], a[104:107], v[80:83]
    v_mfma_f32_16x16x32_bf16 v[84:87], v[56:59], a[104:107], v[84:87]
    v_mfma_f32_16x16x32_bf16 v[80:83], v[44:47], a[108:111], v[80:83]
    v_mfma_f32_16x16x32_bf16 v[84:87], v[60:63], a[108:111], v[84:87]
    v_cvt_pk_bf16_f32 v72, v72, v73
    v_cvt_pk_bf16_f32 v73, v74, v75
    v_cvt_pk_bf16_f32 v74, v76, v77
    v_cvt_pk_bf16_f32 v75, v78, v79
    ds_write_b128 v10, v[72:75] offset:33792
    v_mfma_f32_16x16x32_bf16 v[88:91], v[32:35], a[112:115], 0
    v_mfma_f32_16x16x32_bf16 v[92:95], v[48:51], a[112:115], 0
    v_mfma_f32_16x16x32_bf16 v[88:91], v[36:39], a[116:119], v[88:91]
    v_mfma_f32_16x16x32_bf16 v[92:95], v[52:55], a[116:119], v[92:95]
    v_mfma_f32_16x16x32_bf16 v[88:91], v[40:43], a[120:123], v[88:91]
    v_mfma_f32_16x16x32_bf16 v[92:95], v[56:59], a[120:123], v[92:95]
    v_mfma_f32_16x16x32_bf16 v[88:91], v[44:47], a[124:127], v[88:91]
    v_mfma_f32_16x16x32_bf16 v[92:95], v[60:63], a[124:127], v[92:95]
    v_cvt_pk_bf16_f32 v80, v80, v81
    v_cvt_pk_bf16_f32 v81, v82, v83
    v_cvt_pk_bf16_f32 v82, v84, v85
    v_cvt_pk_bf16_f32 v83, v86, v87
    ds_write_b128 v10, v[80:83] offset:34816
    s_nop 2
    v_cvt_pk_bf16_f32 v88, v88, v89
    v_cvt_pk_bf16_f32 v89, v90, v91
    v_cvt_pk_bf16_f32 v90, v92, v93
    v_cvt_pk_bf16_f32 v91, v94, v95
    ds_write_b128 v10, v[88:91] offset:35840
L_v_gp_226:
    s_waitcnt vmcnt(2)
    v_add_f32 v16, v96, v100
    v_add_f32 v17, v97, v101
    v_add_f32 v18, v98, v102
    v_add_f32 v19, v99, v103
    s_waitcnt vmcnt(1)
    v_add_f32 v16, v16, v104
    v_add_f32 v17, v17, v105
    v_add_f32 v18, v18, v106
    v_add_f32 v19, v19, v107
    s_waitcnt vmcnt(0)
    v_add_f32 v16, v16, v108
    v_add_f32 v17, v17, v109
    v_add_f32 v18, v18, v110
    v_add_f32 v19, v19, v111
    v_add_f32_dpp v20, v16, v16 row_ror:8 row_mask:0xf bank_mask:0x3
    v_add_f32_dpp v21, v17, v17 row_ror:8 row_mask:0xf bank_mask:0x3
    v_add_f32_dpp v20, v18, v18 row_ror:8 row_mask:0xf bank_mask:0xc
    v_add_f32_dpp v21, v19, v19 row_ror:8 row_mask:0xf bank_mask:0xc
    v_cmp_u_f32 vcc, v20, v21
    v_cvt_pk_bf16_f32 v20, v20, v21
    s_cbranch_vccz L_v_gok_227
    v_max3_u32 v24, v96, v97, v98
    v_max3_u32 v24, v24, v99, v100
    v_max3_u32 v24, v24, v101, v102
    v_max3_u32 v24, v24, v103, v104
    v_max3_u32 v24, v24, v105, v106
    v_max3_u32 v24, v24, v107, v108
    v_max3_u32 v24, v24, v109, v110
    v_max_u32 v24, v24, v111
    v_cmp_eq_u32 vcc, -1, v24
    v_min_u32 v20, -2, v20
    s_add_u32 s70, s70, 1
    s_cbranch_vccz L_v_gok_227
    buffer_load_dwordx4 v[96:99], v7, s[12:15], s63 offen offset:0 sc1
    buffer_load_dwordx4 v[100:103], v7, s[12:15], s63 offen offset:512 sc1
    buffer_load_dwordx4 v[104:107], v7, s[12:15], s63 offen offset:1024 sc1
    buffer_load_dwordx4 v[108:111], v7, s[12:15], s63 offen offset:1536 sc1
    s_cmp_lt_u32 s70, 524288
    s_cbranch_scc1 L_v_gp_226
    s_branch L_c_done_1
L_v_gok_227:
    buffer_store_dword v20, v8, s[12:15], s61 offen
    s_xor_b32 s45, s61, 0x8000
    buffer_store_dword v26, v8, s[12:15], s45 offen
    s_bitcmp1_b32 s44, 0
    s_cbranch_scc1 L_v_nr_228
    s_xor_b32 s45, s62, 0x4000
    buffer_store_dword v26, v4, s[12:15], s45 offen
L_v_nr_228:
    s_add_u32 s60, s60, 1
    s_add_u32 s62, s62, 0x2000
    s_and_b32 s62, s62, 0x7fff
    s_add_u32 s63, s63, 262144
    s_sleep 3
    s_branch L_v_loop_215
L_v_last_219:
    s_waitcnt lgkmcnt(0)
    s_barrier
    s_branch L_c_done_1
L_vs_194:
    s_mov_b32 s70, 0
    v_mov_b32 v16, 0
    v_mov_b32 v17, 0
    s_branch L_v_l1m_231
L_v_loop_229:
    s_mov_b32 s70, 0
    buffer_load_dwordx4 v[64:67], v9, s[12:15], s61 offen offset:0 sc1
    buffer_load_dwordx4 v[68:71], v9, s[12:15], s61 offen offset:1024 sc1
    buffer_load_dwordx4 v[72:75], v9, s[12:15], s61 offen offset:2048 sc1
    buffer_load_dwordx4 v[76:79], v9, s[12:15], s61 offen offset:3072 sc1
    v_mov_b32 v16, 0
    v_mov_b32 v17, 0
    v_mov_b32 v18, 0
    v_mov_b32 v19, 0
    v_mov_b32 v20, 0
    v_mov_b32 v21, 0
    v_mov_b32 v22, 0
    v_mov_b32 v23, 0
    s_branch L_v_l1m_231
L_v_l1_230:
    buffer_load_dwordx4 v[64:67], v9, s[12:15], s61 offen offset:0 sc1
    buffer_load_dwordx4 v[68:71], v9, s[12:15], s61 offen offset:1024 sc1
    buffer_load_dwordx4 v[72:75], v9, s[12:15], s61 offen offset:2048 sc1
    buffer_load_dwordx4 v[76:79], v9, s[12:15], s61 offen offset:3072 sc1
L_v_l1m_231:
    s_waitcnt vmcnt(3)
    ds_write_b128 v10, v[64:67] offset:0
    v_max3_u32 v24, v64, v64, v65
    v_max3_u32 v24, v24, v66, v67
    s_waitcnt vmcnt(2)
    ds_write_b128 v10, v[68:71] offset:1024
    v_max3_u32 v24, v24, v68, v69
    v_max3_u32 v24, v24, v70, v71
    s_waitcnt vmcnt(1)
    ds_write_b128 v10, v[72:75] offset:2048
    v_max3_u32 v24, v24, v72, v73
    v_max3_u32 v24, v24, v74, v75
    s_waitcnt vmcnt(0)
    ds_write_b128 v10, v[76:79] offset:3072
    v_max3_u32 v24, v24, v76, v77
    v_max3_u32 v24, v24, v78, v79
    v_cmp_eq_u32 vcc, -1, v24
    s_add_u32 s70, s70, 1
    s_cbranch_vccz L_ok_232
    s_cmp_lt_u32 s70, 524288
    s_cbranch_scc1 L_v_l1_230
    s_branch L_c_done_1
L_ok_232:
    s_waitcnt lgkmcnt(0)
    s_barrier
    v_smfmac_f32_16x16x64_bf16 v[16:19], v[64:67], a[0:7], v3
    v_smfmac_f32_16x16x64_bf16 v[20:23], v[64:67], a[32:39], v3
    v_smfmac_f32_16x16x64_bf16 v[16:19], v[68:71], a[8:15], v3
    v_smfmac_f32_16x16x64_bf16 v[20:23], v[68:71], a[40:47], v3
    v_smfmac_f32_16x16x64_bf16 v[16:19], v[72:75], a[16:23], v3
    v_smfmac_f32_16x16x64_bf16 v[20:23], v[72:75], a[48:55], v3
    v_smfmac_f32_16x16x64_bf16 v[16:19], v[76:79], a[24:31], v3
    v_smfmac_f32_16x16x64_bf16 v[20:23], v[76:79], a[56:63], v3
    s_nop 6
    v_permlane32_swap_b32 v16, v18
    v_permlane32_swap_b32 v17, v19
    v_permlane32_swap_b32 v20, v22
    v_permlane32_swap_b32 v21, v23
    v_add_f32 v16, v16, v18
    v_add_f32 v17, v17, v19
    v_add_f32 v18, v20, v22
    v_add_f32 v19, v21, v23
    ds_write_b128 v14, v[16:19]
    s_mov_b64 exec, 1
    ds_add_u32 v29, v30
    s_mov_b64 exec, -1
    s_add_u32 s58, s58, 4
    s_bitcmp1_b32 s44, 0
    s_cbranch_scc1 L_v_k1_234
    s_mov_b32 s70, 0
L_v_rl_235:
    ds_read_b32 v24, v29
    ds_read_b64 v[16:17], v13 offset:0
    ds_read_b64 v[18:19], v13 offset:1024
    ds_read_b64 v[20:21], v13 offset:2048
    ds_read_b64 v[22:23], v13 offset:3072
    s_waitcnt lgkmcnt(2)
    v_cmp_ne_u32 vcc, s58, v24
    v_add_f32 v16, v16, v18
    v_add_f32 v17, v17, v19
    s_waitcnt lgkmcnt(0)
    s_add_u32 s70, s70, 1
    s_cbranch_vccz L_ok_236
    s_cmp_lt_u32 s70, 524288
    s_cbranch_scc1 L_v_rl_235
    s_branch L_c_done_1
L_ok_236:
    v_add_f32 v20, v20, v22
    v_add_f32 v21, v21, v23
    v_add_f32 v16, v16, v20
    v_add_f32 v17, v17, v21
    s_mov_b32 vcc_lo, 0x55555555
    s_mov_b32 vcc_hi, 0x55555555
    v_cndmask_b32_dpp v18, v17, v16, vcc quad_perm:[1,0,3,2] row_mask:0xf bank_mask:0xf
    s_not_b64 vcc, vcc
    v_cndmask_b32_dpp v19, v16, v17, vcc quad_perm:[1,0,3,2] row_mask:0xf bank_mask:0xf
    v_cvt_pk_bf16_f32 v18, v18, v19
    v_min_u32 v18, -2, v18
    buffer_store_dword v18, v4, s[12:15], s62 offen sc1
    ds_write_b32 v5, v18
L_v_k1_234:
    s_cmp_eq_u32 s60, 63
    s_cbranch_scc1 L_v_last_233
    ds_read_b128 v[80:83], v27 offset:32768
    ds_read_b128 v[84:87], v27 offset:36864
    ds_read_b128 v[88:91], v27 offset:40960
    ds_read_b128 v[92:95], v27 offset:45056
    v_mov_b32 v96, 0
    v_mov_b32 v97, 0
    v_mov_b32 v98, 0
    v_mov_b32 v99, 0
    v_mov_b32 v100, 0
    v_mov_b32 v101, 0
    v_mov_b32 v102, 0
    v_mov_b32 v103, 0
    v_mov_b32 v104, 0
    v_mov_b32 v105, 0
    v_mov_b32 v106, 0
    v_mov_b32 v107, 0
    v_mov_b32 v108, 0
    v_mov_b32 v109, 0
    v_mov_b32 v110, 0
    v_mov_b32 v111, 0
    s_bitcmp1_b32 s44, 0
    s_cbranch_scc0 L_v_sv_237
    s_sleep 3
L_v_sv_237:
    s_sleep 2
    s_mov_b32 s70, 0
L_v_vp_238:
    buffer_load_dwordx4 v[64:67], v11, s[12:15], s62 offen offset:0 sc1
    buffer_load_dwordx4 v[68:71], v11, s[12:15], s62 offen offset:1024 sc1
    s_waitcnt vmcnt(0)
    v_max3_u32 v20, v64, v65, v66
    v_max3_u32 v20, v20, v67, v68
    v_max3_u32 v20, v20, v69, v70
    v_max_u32 v20, v20, v71
    v_cmp_eq_u32 vcc, -1, v20
    s_add_u32 s70, s70, 1
    s_cbranch_vccz L_ok_239
    s_cmp_lt_u32 s70, 524288
    s_cbranch_scc1 L_v_vp_238
    s_branch L_c_done_1
L_ok_239:
    v_smfmac_f32_16x16x64_bf16 v[96:99], v[64:67], a[64:71], v3
    v_smfmac_f32_16x16x64_bf16 v[96:99], v[68:71], a[72:79], v3
    v_smfmac_f32_16x16x64_bf16 v[100:103], v[64:67], a[80:87], v3
    v_smfmac_f32_16x16x64_bf16 v[100:103], v[68:71], a[88:95], v3
    v_smfmac_f32_16x16x64_bf16 v[104:107], v[64:67], a[96:103], v3
    v_smfmac_f32_16x16x64_bf16 v[104:107], v[68:71], a[104:111], v3
    v_smfmac_f32_16x16x64_bf16 v[108:111], v[64:67], a[112:119], v3
    v_smfmac_f32_16x16x64_bf16 v[108:111], v[68:71], a[120:127], v3
    s_add_u32 s46, s65, 4096
    buffer_load_dwordx4 v[32:35], v15, s[12:15], s65 offen offset:0 sc1
    buffer_load_dwordx4 v[48:51], v15, s[12:15], s46 offen offset:0 sc1
    buffer_load_dwordx4 v[36:39], v15, s[12:15], s65 offen offset:1024 sc1
    buffer_load_dwordx4 v[52:55], v15, s[12:15], s46 offen offset:1024 sc1
    buffer_load_dwordx4 v[40:43], v15, s[12:15], s65 offen offset:2048 sc1
    buffer_load_dwordx4 v[56:59], v15, s[12:15], s46 offen offset:2048 sc1
    buffer_load_dwordx4 v[44:47], v15, s[12:15], s65 offen offset:3072 sc1
    buffer_load_dwordx4 v[60:63], v15, s[12:15], s46 offen offset:3072 sc1
    s_add_u32 s65, s65, 786432
    v_cvt_pk_bf16_f32 v96, v96, v97
    v_cvt_pk_bf16_f32 v97, v98, v99
    ds_write_b64 v12, v[96:97] offset:0
    v_cvt_pk_bf16_f32 v100, v100, v101
    v_cvt_pk_bf16_f32 v101, v102, v103
    ds_write_b64 v12, v[100:101] offset:2048
    v_cvt_pk_bf16_f32 v104, v104, v105
    v_cvt_pk_bf16_f32 v105, v106, v107
    ds_write_b64 v12, v[104:105] offset:4096
    v_cvt_pk_bf16_f32 v108, v108, v109
    v_cvt_pk_bf16_f32 v109, v110, v111
    ds_write_b64 v12, v[108:109] offset:6144
    s_waitcnt lgkmcnt(0)
    s_barrier
    ds_read_b128 v[96:99], v2 offset:16384
    ds_read_b128 v[100:103], v2 offset:17408
    ds_read_b128 v[104:107], v2 offset:18432
    ds_read_b128 v[108:111], v2 offset:19456
    ds_read_b128 v[112:115], v31 offset:0
    ds_read_b128 v[116:119], v25 offset:0
    ds_read_b128 v[120:123], v31 offset:512
    ds_read_b128 v[124:127], v25 offset:1024
    s_waitcnt lgkmcnt(7)
    v_mfma_f32_16x16x32_bf16 v[16:19], v[80:83], v[96:99], 0
    s_waitcnt lgkmcnt(6)
    v_mfma_f32_16x16x32_bf16 v[16:19], v[84:87], v[100:103], v[16:19]
    s_waitcnt lgkmcnt(5)
    v_mfma_f32_16x16x32_bf16 v[16:19], v[88:91], v[104:107], v[16:19]
    s_waitcnt lgkmcnt(4)
    v_mfma_f32_16x16x32_bf16 v[16:19], v[92:95], v[108:111], v[16:19]
    s_waitcnt lgkmcnt(2)
    v_mfma_f32_16x16x32_bf16 v[16:19], v[116:119], v[112:115], v[16:19]
    s_waitcnt lgkmcnt(0)
    v_mfma_f32_16x16x32_bf16 v[16:19], v[124:127], v[120:123], v[16:19]
    s_mov_b32 exec_lo, 0x00ff00ff
    s_mov_b32 exec_hi, 0x00ff00ff
    s_nop 5
    v_min_u32 v16, -2, v16
    v_min_u32 v17, -2, v17
    v_min_u32 v18, -2, v18
    v_min_u32 v19, -2, v19
    buffer_store_dwordx4 v[16:19], v6, s[12:15], s63 offen sc1
    s_mov_b64 exec, -1
    s_add_u32 s61, s61, 0x4000
    s_and_b32 s61, s61, 0xffff
    s_mov_b32 s70, 1
    s_add_u32 s46, s64, 4096
    s_add_u32 m0, s59, 0
    s_nop 0
    buffer_load_dwordx4 v28, s[12:15], s64 offen offset:0 sc1 lds
    buffer_load_dwordx4 v28, s[12:15], s64 offen offset:1024 sc1 lds
    buffer_load_dwordx4 v28, s[12:15], s64 offen offset:2048 sc1 lds
    buffer_load_dwordx4 v28, s[12:15], s64 offen offset:3072 sc1 lds
    s_add_u32 m0, s59, 4096
    s_nop 0
    buffer_load_dwordx4 v28, s[12:15], s46 offen offset:0 sc1 lds
    buffer_load_dwordx4 v28, s[12:15], s46 offen offset:1024 sc1 lds
    buffer_load_dwordx4 v28, s[12:15], s46 offen offset:2048 sc1 lds
    buffer_load_dwordx4 v28, s[12:15], s46 offen offset:3072 sc1 lds
    s_add_u32 s64, s64, 786432
    s_waitcnt vmcnt(9)
    s_sleep 5
    buffer_load_dwordx4 v[96:99], v7, s[12:15], s63 offen offset:0 sc1
    buffer_load_dwordx4 v[100:103], v7, s[12:15], s63 offen offset:512 sc1
    buffer_load_dwordx4 v[104:107], v7, s[12:15], s63 offen offset:1024 sc1
    buffer_load_dwordx4 v[108:111], v7, s[12:15], s63 offen offset:1536 sc1
    v_mfma_f32_16x16x32_bf16 v[64:67], v[32:35], a[64:67], 0
    v_mfma_f32_16x16x32_bf16 v[68:71], v[48:51], a[64:67], 0
    v_mfma_f32_16x16x32_bf16 v[64:67], v[36:39], a[68:71], v[64:67]
    v_mfma_f32_16x16x32_bf16 v[68:71], v[52:55], a[68:71], v[68:71]
    v_mfma_f32_16x16x32_bf16 v[64:67], v[40:43], a[72:75], v[64:67]
    v_mfma_f32_16x16x32_bf16 v[68:71], v[56:59], a[72:75], v[68:71]
    v_mfma_f32_16x16x32_bf16 v[64:67], v[44:47], a[76:79], v[64:67]
    v_mfma_f32_16x16x32_bf16 v[68:71], v[60:63], a[76:79], v[68:71]
    v_mfma_f32_16x16x32_bf16 v[72:75], v[32:35], a[80:83], 0
    v_mfma_f32_16x16x32_bf16 v[76:79], v[48:51], a[80:83], 0
    v_mfma_f32_16x16x32_bf16 v[72:75], v[36:39], a[84:87], v[72:75]
    v_mfma_f32_16x16x32_bf16 v[76:79], v[52:55], a[84:87], v[76:79]
    v_mfma_f32_16x16x32_bf16 v[72:75], v[40:43], a[88:91], v[72:75]
    v_mfma_f32_16x16x32_bf16 v[76:79], v[56:59], a[88:91], v[76:79]
    v_mfma_f32_16x16x32_bf16 v[72:75], v[44:47], a[92:95], v[72:75]
    v_mfma_f32_16x16x32_bf16 v[76:79], v[60:63], a[92:95], v[76:79]
    v_cvt_pk_bf16_f32 v64, v64, v65
    v_cvt_pk_bf16_f32 v65, v66, v67
    v_cvt_pk_bf16_f32 v66, v68, v69
    v_cvt_pk_bf16_f32 v67, v70, v71
    ds_write_b128 v10, v[64:67] offset:32768
    v_mfma_f32_16x16x32_bf16 v[80:83], v[32:35], a[96:99], 0
    v_mfma_f32_16x16x32_bf16 v[84:87], v[48:51], a[96:99], 0
    v_mfma_f32_16x16x32_bf16 v[80:83], v[36:39], a[100:103], v[80:83]
    v_mfma_f32_16x16x32_bf16 v[84:87], v[52:55], a[100:103], v[84:87]
    v_mfma_f32_16x16x32_bf16 v[80:83], v[40:43], a[104:107], v[80:83]
    v_mfma_f32_16x16x32_bf16 v[84:87], v[56:59], a[104:107], v[84:87]
    v_mfma_f32_16x16x32_bf16 v[80:83], v[44:47], a[108:111], v[80:83]
    v_mfma_f32_16x16x32_bf16 v[84:87], v[60:63], a[108:111], v[84:87]
    v_cvt_pk_bf16_f32 v72, v72, v73
    v_cvt_pk_bf16_f32 v73, v74, v75
    v_cvt_pk_bf16_f32 v74, v76, v77
    v_cvt_pk_bf16_f32 v75, v78, v79
    ds_write_b128 v10, v[72:75] offset:33792
    v_mfma_f32_16x16x32_bf16 v[88:91], v[32:35], a[112:115], 0
    v_mfma_f32_16x16x32_bf16 v[92:95], v[48:51], a[112:115], 0
    v_mfma_f32_16x16x32_bf16 v[88:91], v[36:39], a[116:119], v[88:91]
    v_mfma_f32_16x16x32_bf16 v[92:95], v[52:55], a[116:119], v[92:95]
    v_mfma_f32_16x16x32_bf16 v[88:91], v[40:43], a[120:123], v[88:91]
    v_mfma_f32_16x16x32_bf16 v[92:95], v[56:59], a[120:123], v[92:95]
    v_mfma_f32_16x16x32_bf16 v[88:91], v[44:47], a[124:127], v[88:91]
    v_mfma_f32_16x16x32_bf16 v[92:95], v[60:63], a[124:127], v[92:95]
    v_cvt_pk_bf16_f32 v80, v80, v81
    v_cvt_pk_bf16_f32 v81, v82, v83
    v_cvt_pk_bf16_f32 v82, v84, v85
    v_cvt_pk_bf16_f32 v83, v86, v87
    ds_write_b128 v10, v[80:83] offset:34816
    s_nop 2
    v_cvt_pk_bf16_f32 v88, v88, v89
    v_cvt_pk_bf16_f32 v89, v90, v91
    v_cvt_pk_bf16_f32 v90, v92, v93
    v_cvt_pk_bf16_f32 v91, v94, v95
    ds_write_b128 v10, v[88:91] offset:35840
L_v_gp_240:
    s_waitcnt vmcnt(2)
    v_add_f32 v16, v96, v100
    v_add_f32 v17, v97, v101
    v_add_f32 v18, v98, v102
    v_add_f32 v19, v99, v103
    s_waitcnt vmcnt(1)
    v_add_f32 v16, v16, v104
    v_add_f32 v17, v17, v105
    v_add_f32 v18, v18, v106
    v_add_f32 v19, v19, v107
    s_waitcnt vmcnt(0)
    v_add_f32 v16, v16, v108
    v_add_f32 v17, v17, v109
    v_add_f32 v18, v18, v110
    v_add_f32 v19, v19, v111
    v_add_f32_dpp v20, v16, v16 row_ror:8 row_mask:0xf bank_mask:0x3
    v_add_f32_dpp v21, v17, v17 row_ror:8 row_mask:0xf bank_mask:0x3
    v_add_f32_dpp v20, v18, v18 row_ror:8 row_mask:0xf bank_mask:0xc
    v_add_f32_dpp v21, v19, v19 row_ror:8 row_mask:0xf bank_mask:0xc
    v_cmp_u_f32 vcc, v20, v21
    v_cvt_pk_bf16_f32 v20, v20, v21
    s_cbranch_vccz L_v_gok_241
    v_max3_u32 v24, v96, v97, v98
    v_max3_u32 v24, v24, v99, v100
    v_max3_u32 v24, v24, v101, v102
    v_max3_u32 v24, v24, v103, v104
    v_max3_u32 v24, v24, v105, v106
    v_max3_u32 v24, v24, v107, v108
    v_max3_u32 v24, v24, v109, v110
    v_max_u32 v24, v24, v111
    v_cmp_eq_u32 vcc, -1, v24
    v_min_u32 v20, -2, v20
    s_add_u32 s70, s70, 1
    s_cbranch_vccz L_v_gok_241
    buffer_load_dwordx4 v[96:99], v7, s[12:15], s63 offen offset:0 sc1
    buffer_load_dwordx4 v[100:103], v7, s[12:15], s63 offen offset:512 sc1
    buffer_load_dwordx4 v[104:107], v7, s[12:15], s63 offen offset:1024 sc1
    buffer_load_dwordx4 v[108:111], v7, s[12:15], s63 offen offset:1536 sc1
    s_cmp_lt_u32 s70, 524288
    s_cbranch_scc1 L_v_gp_240
    s_branch L_c_done_1
L_v_gok_241:
    buffer_store_dword v20, v8, s[12:15], s61 offen sc1
    s_xor_b32 s45, s61, 0x8000
    buffer_store_dword v26, v8, s[12:15], s45 offen sc1
    s_bitcmp1_b32 s44, 0
    s_cbranch_scc1 L_v_nr_242
    s_xor_b32 s45, s62, 0x4000
    buffer_store_dword v26, v4, s[12:15], s45 offen sc1
L_v_nr_242:
    s_add_u32 s60, s60, 1
    s_add_u32 s62, s62, 0x2000
    s_and_b32 s62, s62, 0x7fff
    s_add_u32 s63, s63, 262144
    s_sleep 3
    s_branch L_v_loop_229
L_v_last_233:
    s_waitcnt lgkmcnt(0)
    s_barrier
    s_branch L_c_done_1
L_c_done_1:
    s_endpgm
.section .rodata,"a"
.p2align 6
.amdhsa_kernel k3_chain_kernel
  .amdhsa_next_free_vgpr 256
  .amdhsa_next_free_sgpr 102
  .amdhsa_accum_offset 128
  .amdhsa_group_segment_fixed_size 0
  .amdhsa_kernarg_size 136
  .amdhsa_user_sgpr_count 2
  .amdhsa_user_sgpr_kernarg_segment_ptr 1
  .amdhsa_system_sgpr_workgroup_id_x 1
.end_amdhsa_kernel
```

```asm
; @launch kernel=k3_chain_kernel grid=(256,1,1) block=(512,1,1) lds=147712
.amdgcn_target "amdgcn-amd-amdhsa--gfx950"
.text
.globl k3_chain_kernel
.p2align 8
.type k3_chain_kernel,@function
k3_chain_kernel:
    s_cmp_ge_u32 s2, 256
    s_cbranch_scc1 L_c_done_1
    s_load_dwordx4 s[20:23], s[0:1], 120
    v_and_b32 v1, 63, v0
    v_lshrrev_b32 v2, 6, v0
    s_nop 0
    v_readfirstlane_b32 s44, v2
    s_waitcnt lgkmcnt(0)
    s_mov_b32 s12, s22
    s_and_b32 s13, s23, 0xffff
    s_mov_b32 s14, 0x10000000
    s_mov_b32 s15, 0x00020000
    s_mov_b32 s16, s20
    s_and_b32 s17, s21, 0xffff
    s_mov_b32 s18, 0x100
    s_mov_b32 s19, 0x00020000
    s_load_dwordx4 s[8:11], s[0:1], 96
    v_lshrrev_b32 v5, 3, v0
    v_mul_u32_u24 v6, 24576, v5
    v_and_b32 v7, 7, v0
    v_lshl_add_u32 v6, v7, 4, v6
    v_add_u32 v7, 12288, v6
    v_lshlrev_b32 v5, 2, v5
    s_lshr_b32 s50, s2, 5
    s_and_b32 s51, s2, 31
    s_mul_i32 s52, s50, 1572864
    s_lshl_b32 s53, s51, 7
    s_add_u32 s52, s52, s53
    s_lshl_b32 s53, s50, 8
    s_waitcnt lgkmcnt(0)
    s_mov_b32 s28, s10
    s_and_b32 s29, s11, 0xffff
    s_mov_b32 s30, 0xc00000
    s_mov_b32 s31, 0x00020000
    s_mov_b32 s32, s8
    s_and_b32 s33, s9, 0xffff
    s_mov_b32 s34, 0x800
    s_mov_b32 s35, 0x00020000
    buffer_load_dword v8, v5, s[32:35], s53 offen
    buffer_load_dwordx4 v[12:15], v6, s[28:31], s52 offen
    buffer_load_dwordx4 v[16:19], v7, s[28:31], s52 offen
    s_getreg_b32 s39, hwreg(HW_REG_XCC_ID)
    s_and_b32 s39, s39, 7
    s_cmp_lg_u32 s44, 1
    s_cbranch_scc1 L_nz_5
    v_mov_b32 v3, 0
    v_lshlrev_b32 v4, 2, v1
    s_lshl_b32 s45, s2, 8
    s_add_u32 s45, s45, 0x100000
    buffer_store_dword v3, v4, s[12:15], s45 offen sc1
L_nz_5:
    s_waitcnt vmcnt(0)
    v_lshlrev_b32 v9, 16, v8
    v_and_b32 v10, 0xffff0000, v8
    v_mul_f32 v20, 0xbfb8aa3b, v9
    v_mul_f32 v21, 0xbfb8aa3b, v10
    v_exp_f32 v20, v20
    v_exp_f32 v21, v21
    s_nop 0
    v_add_f32 v20, 1.0, v20
    v_add_f32 v21, 1.0, v21
    v_rcp_f32 v20, v20
    v_rcp_f32 v21, v21
    s_nop 0
    v_mul_f32 v9, v9, v20
    v_mul_f32 v10, v10, v21
    v_cvt_pk_bf16_f32 v9, 0, v9
    v_cvt_pk_bf16_f32 v10, 0, v10
    v_lshlrev_b32 v28, 16, v12
    v_and_b32 v29, 0xffff0000, v12
    v_lshlrev_b32 v30, 16, v16
    v_and_b32 v31, 0xffff0000, v16
    v_mul_f32 v20, v28, v9
    v_mul_f32 v21, v29, v9
    v_fmac_f32 v20, v30, v10
    v_fmac_f32 v21, v31, v10
    v_lshlrev_b32 v28, 16, v13
    v_and_b32 v29, 0xffff0000, v13
    v_lshlrev_b32 v30, 16, v17
    v_and_b32 v31, 0xffff0000, v17
    v_mul_f32 v22, v28, v9
    v_mul_f32 v23, v29, v9
    v_fmac_f32 v22, v30, v10
    v_fmac_f32 v23, v31, v10
    v_lshlrev_b32 v28, 16, v14
    v_and_b32 v29, 0xffff0000, v14
    v_lshlrev_b32 v30, 16, v18
    v_and_b32 v31, 0xffff0000, v18
    v_mul_f32 v24, v28, v9
    v_mul_f32 v25, v29, v9
    v_fmac_f32 v24, v30, v10
    v_fmac_f32 v25, v31, v10
    v_lshlrev_b32 v28, 16, v15
    v_and_b32 v29, 0xffff0000, v15
    v_lshlrev_b32 v30, 16, v19
    v_and_b32 v31, 0xffff0000, v19
    v_mul_f32 v26, v28, v9
    v_mul_f32 v27, v29, v9
    v_fmac_f32 v26, v30, v10
    v_fmac_f32 v27, v31, v10
    s_nop 1
    v_add_f32_dpp v20, v20, v20 row_ror:8 row_mask:0xf bank_mask:0xf
    v_add_f32_dpp v21, v21, v21 row_ror:8 row_mask:0xf bank_mask:0xf
    v_add_f32_dpp v22, v22, v22 row_ror:8 row_mask:0xf bank_mask:0xf
    v_add_f32_dpp v23, v23, v23 row_ror:8 row_mask:0xf bank_mask:0xf
    v_add_f32_dpp v24, v24, v24 row_ror:8 row_mask:0xf bank_mask:0xf
    v_add_f32_dpp v25, v25, v25 row_ror:8 row_mask:0xf bank_mask:0xf
    v_add_f32_dpp v26, v26, v26 row_ror:8 row_mask:0xf bank_mask:0xf
    v_add_f32_dpp v27, v27, v27 row_ror:8 row_mask:0xf bank_mask:0xf
    s_nop 1
    v_permlane16_swap_b32 v20, v24
    v_permlane16_swap_b32 v21, v25
    v_permlane16_swap_b32 v22, v26
    v_permlane16_swap_b32 v23, v27
    v_add_f32 v20, v20, v24
    v_add_f32 v21, v21, v25
    v_add_f32 v22, v22, v26
    v_add_f32 v23, v23, v27
    s_nop 1
    v_permlane32_swap_b32 v20, v22
    v_permlane32_swap_b32 v21, v23
    v_add_f32 v20, v20, v22
    v_add_f32 v21, v21, v23
    v_and_b32 v22, 7, v1
    v_lshlrev_b32 v22, 5, v22
    v_bfe_u32 v23, v1, 4, 1
    v_lshl_add_u32 v22, v23, 4, v22
    v_lshrrev_b32 v23, 5, v1
    v_lshl_add_u32 v22, v23, 3, v22
    s_lshl_b32 s52, s44, 8
    s_add_u32 s52, s52, 139776
    v_add_u32 v22, s52, v22
    ds_write_b64 v22, v[20:21]
    s_waitcnt lgkmcnt(0)
    s_barrier
    s_cmp_lg_u32 s44, 1
    s_cbranch_scc1 L_m1_6
    v_lshlrev_b32 v22, 2, v1
    v_add_u32 v23, 139776, v22
    ds_read_b32 v24, v23 offset:0
    ds_read_b32 v25, v23 offset:256
    ds_read_b32 v26, v23 offset:512
    ds_read_b32 v27, v23 offset:768
    ds_read_b32 v28, v23 offset:1024
    ds_read_b32 v29, v23 offset:1280
    ds_read_b32 v30, v23 offset:1536
    ds_read_b32 v31, v23 offset:1792
    s_waitcnt lgkmcnt(0)
    v_add_f32 v24, v24, v28
    v_add_f32 v25, v25, v29
    v_add_f32 v26, v26, v30
    v_add_f32 v27, v27, v31
    v_add_f32 v24, v24, v26
    v_add_f32 v25, v25, v27
    v_add_f32 v24, v24, v25
    s_lshl_b32 s52, s2, 8
    s_add_u32 s52, s52, 0x10000
    buffer_store_dword v24, v22, s[12:15], s52 offen sc1
L_m1_6:
    s_cmp_lg_u32 s44, 1
    s_cbranch_scc1 L_tk_2
    v_mov_b32 v3, 1
    s_lshl_b32 s45, s39, 5
    v_mov_b32 v4, 0
    s_waitcnt vmcnt(0)
    s_mov_b64 exec, 1
    buffer_atomic_add v3, v4, s[16:19], s45 offen sc0
    s_waitcnt vmcnt(0)
    v_readfirstlane_b32 s41, v3
    s_mov_b32 s40, s39
    s_nop 3
    s_cmp_lt_u32 s41, 32
    s_cbranch_scc1 L_got_3
    v_mov_b32 v3, 1
    buffer_atomic_add v3, v4, s[16:19], 0 offen offset:16 sc0
    s_waitcnt vmcnt(0)
    v_readfirstlane_b32 s46, v3
    s_mov_b64 exec, -1
    v_and_b32 v4, 7, v1
    v_lshlrev_b32 v4, 5, v4
    s_mov_b32 s70, 0
L_sp_4:
    s_sleep 8
    buffer_load_dword v3, v4, s[16:19], 0 offen sc1
    s_waitcnt vmcnt(0)
    s_mov_b32 s48, 0
    v_readlane_b32 s50, v3, 0
    v_readlane_b32 s51, v3, 1
    v_readlane_b32 s52, v3, 2
    v_readlane_b32 s53, v3, 3
    v_readlane_b32 s54, v3, 4
    v_readlane_b32 s55, v3, 5
    v_readlane_b32 s56, v3, 6
    v_readlane_b32 s57, v3, 7
    s_nop 3
    s_add_u32 s48, s48, s50
    s_add_u32 s48, s48, s51
    s_add_u32 s48, s48, s52
    s_add_u32 s48, s48, s53
    s_add_u32 s48, s48, s54
    s_add_u32 s48, s48, s55
    s_add_u32 s48, s48, s56
    s_add_u32 s48, s48, s57
    s_add_u32 s70, s70, 1
    s_cmp_ge_u32 s70, 524288
    s_cbranch_scc1 L_c_done_1
    s_cmp_lt_u32 s48, 256
    s_cbranch_scc1 L_sp_4
    s_min_u32 s48, s50, 32
    s_mov_b32 s40, 0
    s_add_u32 s41, s48, s46
    s_cmp_lt_u32 s41, 32
    s_cbranch_scc1 L_got_3
    s_sub_u32 s46, s41, 32
    s_min_u32 s48, s51, 32
    s_mov_b32 s40, 1
    s_add_u32 s41, s48, s46
    s_cmp_lt_u32 s41, 32
    s_cbranch_scc1 L_got_3
    s_sub_u32 s46, s41, 32
    s_min_u32 s48, s52, 32
    s_mov_b32 s40, 2
    s_add_u32 s41, s48, s46
    s_cmp_lt_u32 s41, 32
    s_cbranch_scc1 L_got_3
    s_sub_u32 s46, s41, 32
    s_min_u32 s48, s53, 32
    s_mov_b32 s40, 3
    s_add_u32 s41, s48, s46
    s_cmp_lt_u32 s41, 32
    s_cbranch_scc1 L_got_3
    s_sub_u32 s46, s41, 32
    s_min_u32 s48, s54, 32
    s_mov_b32 s40, 4
    s_add_u32 s41, s48, s46
    s_cmp_lt_u32 s41, 32
    s_cbranch_scc1 L_got_3
    s_sub_u32 s46, s41, 32
    s_min_u32 s48, s55, 32
    s_mov_b32 s40, 5
    s_add_u32 s41, s48, s46
    s_cmp_lt_u32 s41, 32
    s_cbranch_scc1 L_got_3
    s_sub_u32 s46, s41, 32
    s_min_u32 s48, s56, 32
    s_mov_b32 s40, 6
    s_add_u32 s41, s48, s46
    s_cmp_lt_u32 s41, 32
    s_cbranch_scc1 L_got_3
    s_sub_u32 s46, s41, 32
    s_min_u32 s48, s57, 32
    s_mov_b32 s40, 7
    s_add_u32 s41, s48, s46
    s_cmp_lt_u32 s41, 32
    s_cbranch_scc1 L_got_3
    s_sub_u32 s46, s41, 32
    s_branch L_c_done_1
L_got_3:
    s_mov_b64 exec, -1
    s_lshl_b32 s45, s40, 8
    s_or_b32 s45, s45, s41
    v_mov_b32 v3, s45
    v_mov_b32 v4, 147464
    ds_write_b32 v4, v3
    s_waitcnt lgkmcnt(0)
L_tk_2:
    s_barrier
    v_mov_b32 v4, 147464
    ds_read_b32 v3, v4
    s_waitcnt lgkmcnt(0)
    v_readfirstlane_b32 s45, v3
    s_nop 3
    s_lshr_b32 s40, s45, 8
    s_and_b32 s41, s45, 0xff
    s_cmp_lt_u32 s41, 16
    s_cbranch_scc1 L_c_chain_7
    s_sub_u32 s48, s41, 16
    s_cmp_lt_u32 s48, 12
    s_cbranch_scc1 L_w_g_8
    s_and_b32 s42, s48, 3
    s_mov_b32 s43, s40
    s_load_dwordx2 s[4:5], s[0:1], 0
    v_lshlrev_b32 v2, 4, v1
    v_lshlrev_b32 v3, 5, v1
    s_lshl_b32 s55, s43, 2
    s_add_u32 s55, s55, s42
    s_waitcnt lgkmcnt(0)
    s_mov_b32 s24, s4
    s_and_b32 s25, s5, 0xffff
    s_mov_b32 s26, 0x400000
    s_mov_b32 s27, 0x00020000
    s_lshl_b32 s46, s42, 3
    s_add_u32 s46, s46, s44
    s_lshl_b32 s46, s46, 11
    v_add_u32 v7, s46, v2
    s_lshl_b32 s63, s43, 16
    buffer_load_dwordx4 a[0:3], v7, s[24:27], s63 offen
    buffer_load_dwordx4 a[4:7], v7, s[24:27], s63 offen offset:1024
    s_cmp_lg_u32 s44, 0
    s_cbranch_scc1 L_zwok_17
    v_and_b32 v8, 7, v1
    v_lshlrev_b32 v8, 5, v8
    s_mov_b32 s70, 0
L_zw_16:
    buffer_load_dword v9, v8, s[16:19], 0 offen sc1
    s_waitcnt vmcnt(0)
    v_add_u32_dpp v9, v9, v9 row_ror:1 row_mask:0xf bank_mask:0xf
    s_nop 1
    v_add_u32_dpp v9, v9, v9 row_ror:2 row_mask:0xf bank_mask:0xf
    s_nop 1
    v_add_u32_dpp v9, v9, v9 row_ror:4 row_mask:0xf bank_mask:0xf
    v_cmp_ne_u32 vcc, 0x100, v9
    s_add_u32 s70, s70, 1
    s_cbranch_vccz L_zwok_17
    s_sleep 4
    s_cmp_lt_u32 s70, 524288
    s_cbranch_scc1 L_zw_16
    s_branch L_c_done_1
L_zwok_17:
    s_barrier
    v_lshlrev_b32 v4, 4, v0
    s_mov_b32 s46, 0x10000
    buffer_load_dwordx4 v[32:35], v4, s[12:15], s46 offen sc1
    s_mov_b32 s46, 0x12000
    buffer_load_dwordx4 v[36:39], v4, s[12:15], s46 offen sc1
    s_mov_b32 s46, 0x14000
    buffer_load_dwordx4 v[40:43], v4, s[12:15], s46 offen sc1
    s_mov_b32 s46, 0x16000
    buffer_load_dwordx4 v[44:47], v4, s[12:15], s46 offen sc1
    s_mov_b32 s46, 0x18000
    buffer_load_dwordx4 v[48:51], v4, s[12:15], s46 offen sc1
    s_mov_b32 s46, 0x1a000
    buffer_load_dwordx4 v[52:55], v4, s[12:15], s46 offen sc1
    s_mov_b32 s46, 0x1c000
    buffer_load_dwordx4 v[56:59], v4, s[12:15], s46 offen sc1
    s_mov_b32 s46, 0x1e000
    buffer_load_dwordx4 v[60:63], v4, s[12:15], s46 offen sc1
    s_cmp_lg_u32 s44, 0
    s_cbranch_scc1 L_l_nx_18
    s_cmp_ge_u32 s42, 2
    s_cbranch_scc1 L_l_nx_18
    s_or_b32 s47, s39, 0x100
    v_mov_b32 v8, s47
    v_mov_b32 v9, 0
    s_lshl_b32 s46, s40, 3
    s_lshl_b32 s47, s42, 2
    s_add_u32 s46, s46, s47
    s_add_u32 s46, s46, 0x101200
    s_mov_b64 exec, 1
    buffer_store_dword v8, v9, s[12:15], s46 offen sc1
    s_mov_b64 exec, -1
L_l_nx_18:
    s_mul_i32 s46, s44, 2064
    s_add_u32 s46, s46, 32768
    v_add_u32 v10, s46, v2
    v_and_b32 v11, 7, v1
    v_lshrrev_b32 v12, 3, v1
    v_mul_u32_u24 v13, 2064, v11
    v_lshl_add_u32 v13, v12, 4, v13
    s_lshl_b32 s46, s44, 8
    s_add_u32 s46, s46, 32768
    v_add_u32 v13, s46, v13
    v_lshlrev_b32 v11, 4, v11
    v_lshl_add_u32 v11, v12, 9, v11
    s_lshl_b32 s46, s44, 13
    s_lshl_b32 s47, s42, 7
    s_add_u32 s46, s46, s47
    s_add_u32 s46, s46, 0x400000
    v_add_u32 v11, s46, v11
    v_add_u32 v12, 4096, v11
    s_lshl_b32 s52, s43, 9
    s_lshl_b32 s47, s42, 7
    s_add_u32 s52, s52, s47
    s_add_u32 s52, s52, 0x109400
    s_mov_b32 s60, s43
    s_waitcnt vmcnt(0)
    v_add_f32 v32, v32, v48
    v_add_f32 v33, v33, v49
    v_add_f32 v34, v34, v50
    v_add_f32 v35, v35, v51
    v_add_f32 v36, v36, v52
    v_add_f32 v37, v37, v53
    v_add_f32 v38, v38, v54
    v_add_f32 v39, v39, v55
    v_add_f32 v40, v40, v56
    v_add_f32 v41, v41, v57
    v_add_f32 v42, v42, v58
    v_add_f32 v43, v43, v59
    v_add_f32 v44, v44, v60
    v_add_f32 v45, v45, v61
    v_add_f32 v46, v46, v62
    v_add_f32 v47, v47, v63
    v_add_f32 v32, v32, v40
    v_add_f32 v33, v33, v41
    v_add_f32 v34, v34, v42
    v_add_f32 v35, v35, v43
    v_add_f32 v36, v36, v44
    v_add_f32 v37, v37, v45
    v_add_f32 v38, v38, v46
    v_add_f32 v39, v39, v47
    v_add_f32 v32, v32, v36
    v_add_f32 v33, v33, v37
    v_add_f32 v34, v34, v38
    v_add_f32 v35, v35, v39
    v_cvt_pk_bf16_f32 v32, 0, v32
    v_cvt_pk_bf16_f32 v33, 0, v33
    v_cvt_pk_bf16_f32 v34, 0, v34
    v_cvt_pk_bf16_f32 v35, 0, v35
    ds_write_b128 v4, v[32:35]
    s_waitcnt lgkmcnt(0)
    s_barrier
    ds_read_b128 v[48:51], v3 offset:0
    ds_read_b128 v[52:55], v3 offset:16
    ds_read_b128 v[56:59], v3 offset:2048
    ds_read_b128 v[60:63], v3 offset:2064
    ds_read_b128 v[32:35], v3 offset:4096
    ds_read_b128 v[36:39], v3 offset:4112
    ds_read_b128 v[40:43], v3 offset:6144
    ds_read_b128 v[44:47], v3 offset:6160
    s_waitcnt lgkmcnt(0)
    v_add_f32 v32, 1.0, v32
    v_add_f32 v33, 1.0, v33
    v_add_f32 v34, 1.0, v34
    v_add_f32 v35, 1.0, v35
    v_add_f32 v36, 1.0, v36
    v_add_f32 v37, 1.0, v37
    v_add_f32 v38, 1.0, v38
    v_add_f32 v39, 1.0, v39
    v_add_f32 v40, 1.0, v40
    v_add_f32 v41, 1.0, v41
    v_add_f32 v42, 1.0, v42
    v_add_f32 v43, 1.0, v43
    v_add_f32 v44, 1.0, v44
    v_add_f32 v45, 1.0, v45
    v_add_f32 v46, 1.0, v46
    v_add_f32 v47, 1.0, v47
    v_cvt_pk_bf16_f32 v32, 0, v32
    v_cvt_pk_bf16_f32 v33, 0, v33
    v_cvt_pk_bf16_f32 v34, 0, v34
    v_cvt_pk_bf16_f32 v35, 0, v35
    v_cvt_pk_bf16_f32 v36, 0, v36
    v_cvt_pk_bf16_f32 v37, 0, v37
    v_cvt_pk_bf16_f32 v38, 0, v38
    v_cvt_pk_bf16_f32 v39, 0, v39
    v_cvt_pk_bf16_f32 v40, 0, v40
    v_cvt_pk_bf16_f32 v41, 0, v41
    v_cvt_pk_bf16_f32 v42, 0, v42
    v_cvt_pk_bf16_f32 v43, 0, v43
    v_cvt_pk_bf16_f32 v44, 0, v44
    v_cvt_pk_bf16_f32 v45, 0, v45
    v_cvt_pk_bf16_f32 v46, 0, v46
    v_cvt_pk_bf16_f32 v47, 0, v47
L_l_sub_19:
    s_lshl_b32 s63, s60, 16
    v_accvgpr_read_b32 v96, a0
    v_accvgpr_read_b32 v97, a1
    v_accvgpr_read_b32 v98, a2
    v_accvgpr_read_b32 v99, a3
    v_accvgpr_read_b32 v100, a4
    v_accvgpr_read_b32 v101, a5
    v_accvgpr_read_b32 v102, a6
    v_accvgpr_read_b32 v103, a7
    v_lshlrev_b32 v64, 16, v96
    v_and_b32 v65, 0xffff0000, v96
    v_lshlrev_b32 v66, 16, v97
    v_and_b32 v67, 0xffff0000, v97
    v_lshlrev_b32 v68, 16, v98
    v_and_b32 v69, 0xffff0000, v98
    v_lshlrev_b32 v70, 16, v99
    v_and_b32 v71, 0xffff0000, v99
    v_lshlrev_b32 v72, 16, v100
    v_and_b32 v73, 0xffff0000, v100
    v_lshlrev_b32 v74, 16, v101
    v_and_b32 v75, 0xffff0000, v101
    v_lshlrev_b32 v76, 16, v102
    v_and_b32 v77, 0xffff0000, v102
    v_lshlrev_b32 v78, 16, v103
    v_and_b32 v79, 0xffff0000, v103
    v_pk_add_f32 v[80:81], v[64:65], v[72:73]
    v_pk_add_f32 v[82:83], v[66:67], v[74:75]
    v_pk_add_f32 v[84:85], v[68:69], v[76:77]
    v_pk_add_f32 v[86:87], v[70:71], v[78:79]
    v_pk_add_f32 v[80:81], v[80:81], v[84:85]
    v_pk_add_f32 v[82:83], v[82:83], v[86:87]
    v_pk_add_f32 v[80:81], v[80:81], v[82:83]
    v_add_f32 v14, v80, v81
    s_nop 1
    v_add_f32_dpp v14, v14, v14 row_shr:1 row_mask:0xf bank_mask:0xf bound_ctrl:0
    s_nop 1
    v_add_f32_dpp v14, v14, v14 row_shr:2 row_mask:0xf bank_mask:0xf bound_ctrl:0
    s_nop 1
    v_add_f32_dpp v14, v14, v14 row_shr:4 row_mask:0xf bank_mask:0xf bound_ctrl:0
    s_nop 1
    v_add_f32_dpp v14, v14, v14 row_shr:8 row_mask:0xf bank_mask:0xf bound_ctrl:0
    s_nop 1
    v_add_f32_dpp v14, v14, v14 row_bcast:15 row_mask:0xa bank_mask:0xf
    s_nop 1
    v_add_f32_dpp v14, v14, v14 row_bcast:31 row_mask:0xc bank_mask:0xf
    s_nop 1
    v_readlane_b32 s46, v14, 63
    s_nop 1
    v_mov_b32 v15, s46
    v_mul_f32 v15, 0x3a800000, v15
    v_pk_add_f32 v[80:81], v[64:65], v[14:15] op_sel:[0,1] op_sel_hi:[1,1] neg_lo:[0,1] neg_hi:[0,1]
    v_pk_add_f32 v[82:83], v[66:67], v[14:15] op_sel:[0,1] op_sel_hi:[1,1] neg_lo:[0,1] neg_hi:[0,1]
    v_pk_add_f32 v[84:85], v[68:69], v[14:15] op_sel:[0,1] op_sel_hi:[1,1] neg_lo:[0,1] neg_hi:[0,1]
    v_pk_add_f32 v[86:87], v[70:71], v[14:15] op_sel:[0,1] op_sel_hi:[1,1] neg_lo:[0,1] neg_hi:[0,1]
    v_pk_add_f32 v[88:89], v[72:73], v[14:15] op_sel:[0,1] op_sel_hi:[1,1] neg_lo:[0,1] neg_hi:[0,1]
    v_pk_add_f32 v[90:91], v[74:75], v[14:15] op_sel:[0,1] op_sel_hi:[1,1] neg_lo:[0,1] neg_hi:[0,1]
    v_pk_add_f32 v[92:93], v[76:77], v[14:15] op_sel:[0,1] op_sel_hi:[1,1] neg_lo:[0,1] neg_hi:[0,1]
    v_pk_add_f32 v[94:95], v[78:79], v[14:15] op_sel:[0,1] op_sel_hi:[1,1] neg_lo:[0,1] neg_hi:[0,1]
    v_pk_mul_f32 v[104:105], v[80:81], v[80:81]
    v_pk_mul_f32 v[106:107], v[82:83], v[82:83]
    v_pk_fma_f32 v[104:105], v[84:85], v[84:85], v[104:105]
    v_pk_fma_f32 v[106:107], v[86:87], v[86:87], v[106:107]
    v_pk_fma_f32 v[104:105], v[88:89], v[88:89], v[104:105]
    v_pk_fma_f32 v[106:107], v[90:91], v[90:91], v[106:107]
    v_pk_fma_f32 v[104:105], v[92:93], v[92:93], v[104:105]
    v_pk_fma_f32 v[106:107], v[94:95], v[94:95], v[106:107]
    v_pk_add_f32 v[104:105], v[104:105], v[106:107]
    v_add_f32 v14, v104, v105
    v_cvt_pk_bf16_f32 v15, 0, v15
    s_nop 1
    v_add_f32_dpp v14, v14, v14 row_shr:1 row_mask:0xf bank_mask:0xf bound_ctrl:0
    s_nop 1
    v_add_f32_dpp v14, v14, v14 row_shr:2 row_mask:0xf bank_mask:0xf bound_ctrl:0
    s_nop 1
    v_add_f32_dpp v14, v14, v14 row_shr:4 row_mask:0xf bank_mask:0xf bound_ctrl:0
    s_nop 1
    v_add_f32_dpp v14, v14, v14 row_shr:8 row_mask:0xf bank_mask:0xf bound_ctrl:0
    s_nop 1
    v_add_f32_dpp v14, v14, v14 row_bcast:15 row_mask:0xa bank_mask:0xf
    s_nop 1
    v_add_f32_dpp v14, v14, v14 row_bcast:31 row_mask:0xc bank_mask:0xf
    s_nop 1
    v_readlane_b32 s47, v14, 63
    v_pk_add_f32 v[64:65], v[64:65], v[14:15] op_sel:[0,1] op_sel_hi:[1,1] neg_lo:[0,1] neg_hi:[0,1]
    v_pk_add_f32 v[66:67], v[66:67], v[14:15] op_sel:[0,1] op_sel_hi:[1,1] neg_lo:[0,1] neg_hi:[0,1]
    v_pk_add_f32 v[68:69], v[68:69], v[14:15] op_sel:[0,1] op_sel_hi:[1,1] neg_lo:[0,1] neg_hi:[0,1]
    v_pk_add_f32 v[70:71], v[70:71], v[14:15] op_sel:[0,1] op_sel_hi:[1,1] neg_lo:[0,1] neg_hi:[0,1]
    v_pk_add_f32 v[72:73], v[72:73], v[14:15] op_sel:[0,1] op_sel_hi:[1,1] neg_lo:[0,1] neg_hi:[0,1]
    v_pk_add_f32 v[74:75], v[74:75], v[14:15] op_sel:[0,1] op_sel_hi:[1,1] neg_lo:[0,1] neg_hi:[0,1]
    v_pk_add_f32 v[76:77], v[76:77], v[14:15] op_sel:[0,1] op_sel_hi:[1,1] neg_lo:[0,1] neg_hi:[0,1]
    v_pk_add_f32 v[78:79], v[78:79], v[14:15] op_sel:[0,1] op_sel_hi:[1,1] neg_lo:[0,1] neg_hi:[0,1]
    v_mov_b32 v14, s47
    v_mul_f32 v14, 0x3a800000, v14
    v_cvt_pk_bf16_f32 v14, 0, v14
    v_add_f32 v14, 0x3727c5ac, v14
    v_cvt_pk_bf16_f32 v14, 0, v14
    v_sqrt_f32 v14, v14
    s_nop 0
    v_cvt_pk_bf16_f32 v14, 0, v14
    v_rcp_f32 v14, v14
    v_cvt_pk_bf16_f32 v64, 0, v64
    v_cvt_pk_bf16_f32 v65, 0, v65
    v_cvt_pk_bf16_f32 v66, 0, v66
    v_cvt_pk_bf16_f32 v67, 0, v67
    v_cvt_pk_bf16_f32 v68, 0, v68
    v_cvt_pk_bf16_f32 v69, 0, v69
    v_cvt_pk_bf16_f32 v70, 0, v70
    v_cvt_pk_bf16_f32 v71, 0, v71
    v_cvt_pk_bf16_f32 v72, 0, v72
    v_cvt_pk_bf16_f32 v73, 0, v73
    v_cvt_pk_bf16_f32 v74, 0, v74
    v_cvt_pk_bf16_f32 v75, 0, v75
    v_cvt_pk_bf16_f32 v76, 0, v76
    v_cvt_pk_bf16_f32 v77, 0, v77
    v_cvt_pk_bf16_f32 v78, 0, v78
    v_cvt_pk_bf16_f32 v79, 0, v79
    v_pk_mul_f32 v[64:65], v[64:65], v[14:15] op_sel_hi:[1,0]
    v_pk_mul_f32 v[66:67], v[66:67], v[14:15] op_sel_hi:[1,0]
    v_pk_mul_f32 v[68:69], v[68:69], v[14:15] op_sel_hi:[1,0]
    v_pk_mul_f32 v[70:71], v[70:71], v[14:15] op_sel_hi:[1,0]
    v_pk_mul_f32 v[72:73], v[72:73], v[14:15] op_sel_hi:[1,0]
    v_pk_mul_f32 v[74:75], v[74:75], v[14:15] op_sel_hi:[1,0]
    v_pk_mul_f32 v[76:77], v[76:77], v[14:15] op_sel_hi:[1,0]
    v_pk_mul_f32 v[78:79], v[78:79], v[14:15] op_sel_hi:[1,0]
    v_cvt_pk_bf16_f32 v64, 0, v64
    v_cvt_pk_bf16_f32 v65, 0, v65
    v_cvt_pk_bf16_f32 v66, 0, v66
    v_cvt_pk_bf16_f32 v67, 0, v67
    v_cvt_pk_bf16_f32 v68, 0, v68
    v_cvt_pk_bf16_f32 v69, 0, v69
    v_cvt_pk_bf16_f32 v70, 0, v70
    v_cvt_pk_bf16_f32 v71, 0, v71
    v_cvt_pk_bf16_f32 v72, 0, v72
    v_cvt_pk_bf16_f32 v73, 0, v73
    v_cvt_pk_bf16_f32 v74, 0, v74
    v_cvt_pk_bf16_f32 v75, 0, v75
    v_cvt_pk_bf16_f32 v76, 0, v76
    v_cvt_pk_bf16_f32 v77, 0, v77
    v_cvt_pk_bf16_f32 v78, 0, v78
    v_cvt_pk_bf16_f32 v79, 0, v79
    v_pk_mul_f32 v[64:65], v[64:65], v[32:33]
    v_pk_mul_f32 v[66:67], v[66:67], v[34:35]
    v_pk_mul_f32 v[68:69], v[68:69], v[36:37]
    v_pk_mul_f32 v[70:71], v[70:71], v[38:39]
    v_pk_mul_f32 v[72:73], v[72:73], v[40:41]
    v_pk_mul_f32 v[74:75], v[74:75], v[42:43]
    v_pk_mul_f32 v[76:77], v[76:77], v[44:45]
    v_pk_mul_f32 v[78:79], v[78:79], v[46:47]
    v_cvt_pk_bf16_f32 v64, 0, v64
    v_cvt_pk_bf16_f32 v65, 0, v65
    v_cvt_pk_bf16_f32 v66, 0, v66
    v_cvt_pk_bf16_f32 v67, 0, v67
    v_cvt_pk_bf16_f32 v68, 0, v68
    v_cvt_pk_bf16_f32 v69, 0, v69
    v_cvt_pk_bf16_f32 v70, 0, v70
    v_cvt_pk_bf16_f32 v71, 0, v71
    v_cvt_pk_bf16_f32 v72, 0, v72
    v_cvt_pk_bf16_f32 v73, 0, v73
    v_cvt_pk_bf16_f32 v74, 0, v74
    v_cvt_pk_bf16_f32 v75, 0, v75
    v_cvt_pk_bf16_f32 v76, 0, v76
    v_cvt_pk_bf16_f32 v77, 0, v77
    v_cvt_pk_bf16_f32 v78, 0, v78
    v_cvt_pk_bf16_f32 v79, 0, v79
    v_pk_add_f32 v[64:65], v[64:65], v[48:49]
    v_pk_add_f32 v[66:67], v[66:67], v[50:51]
    v_pk_add_f32 v[68:69], v[68:69], v[52:53]
    v_pk_add_f32 v[70:71], v[70:71], v[54:55]
    v_pk_add_f32 v[72:73], v[72:73], v[56:57]
    v_pk_add_f32 v[74:75], v[74:75], v[58:59]
    v_pk_add_f32 v[76:77], v[76:77], v[60:61]
    v_pk_add_f32 v[78:79], v[78:79], v[62:63]
    v_cvt_pk_bf16_f32 v104, v64, v65
    v_cvt_pk_bf16_f32 v105, v66, v67
    v_cvt_pk_bf16_f32 v106, v68, v69
    v_cvt_pk_bf16_f32 v107, v70, v71
    v_cvt_pk_bf16_f32 v108, v72, v73
    v_cvt_pk_bf16_f32 v109, v74, v75
    v_cvt_pk_bf16_f32 v110, v76, v77
    v_cvt_pk_bf16_f32 v111, v78, v79
    ds_write_b128 v10, v[104:107]
    ds_write_b128 v10, v[108:111] offset:1024
    s_waitcnt lgkmcnt(0)
    s_barrier
    ds_read_b128 v[104:107], v13
    ds_read_b128 v[108:111], v13 offset:128
    s_waitcnt lgkmcnt(1)
    buffer_store_dwordx4 v[104:107], v11, s[12:15], s63 offen sc1
    s_waitcnt lgkmcnt(0)
    buffer_store_dwordx4 v[108:111], v12, s[12:15], s63 offen sc1
    s_waitcnt vmcnt(0)
    s_barrier
    s_cmp_lg_u32 s44, 0
    s_cbranch_scc1 L_sf_21
    v_mov_b32 v14, s60
    v_add_u32 v14, 1, v14
    v_mov_b32 v15, 0
    s_mov_b64 exec, 1
    buffer_store_dword v14, v15, s[12:15], s52 offen sc1
    s_mov_b64 exec, -1
L_sf_21:
    s_cmp_ge_u32 s60, 8
    s_cbranch_scc1 L_l_end_20
    s_add_u32 s63, s63, 524288
    buffer_load_dwordx4 a[8:11], v7, s[24:27], s63 offen
    buffer_load_dwordx4 a[12:15], v7, s[24:27], s63 offen offset:1024
    s_add_u32 s63, s63, 524288
    buffer_load_dwordx4 a[16:19], v7, s[24:27], s63 offen
    buffer_load_dwordx4 a[20:23], v7, s[24:27], s63 offen offset:1024
    s_add_u32 s63, s63, 524288
    buffer_load_dwordx4 a[24:27], v7, s[24:27], s63 offen
    buffer_load_dwordx4 a[28:31], v7, s[24:27], s63 offen offset:1024
    s_add_u32 s63, s63, 524288
    buffer_load_dwordx4 a[32:35], v7, s[24:27], s63 offen
    buffer_load_dwordx4 a[36:39], v7, s[24:27], s63 offen offset:1024
    s_add_u32 s63, s63, 524288
    buffer_load_dwordx4 a[40:43], v7, s[24:27], s63 offen
    buffer_load_dwordx4 a[44:47], v7, s[24:27], s63 offen offset:1024
    s_add_u32 s63, s63, 524288
    buffer_load_dwordx4 a[48:51], v7, s[24:27], s63 offen
    buffer_load_dwordx4 a[52:55], v7, s[24:27], s63 offen offset:1024
    s_add_u32 s63, s63, 524288
    buffer_load_dwordx4 a[56:59], v7, s[24:27], s63 offen
    buffer_load_dwordx4 a[60:63], v7, s[24:27], s63 offen offset:1024
    s_waitcnt vmcnt(0)
L_l_end_20:
    v_accvgpr_mov_b32 a0, a8
    v_accvgpr_mov_b32 a1, a9
    v_accvgpr_mov_b32 a2, a10
    v_accvgpr_mov_b32 a3, a11
    v_accvgpr_mov_b32 a4, a12
    v_accvgpr_mov_b32 a5, a13
    v_accvgpr_mov_b32 a6, a14
    v_accvgpr_mov_b32 a7, a15
    v_accvgpr_mov_b32 a8, a16
    v_accvgpr_mov_b32 a9, a17
    v_accvgpr_mov_b32 a10, a18
    v_accvgpr_mov_b32 a11, a19
    v_accvgpr_mov_b32 a12, a20
    v_accvgpr_mov_b32 a13, a21
    v_accvgpr_mov_b32 a14, a22
    v_accvgpr_mov_b32 a15, a23
    v_accvgpr_mov_b32 a16, a24
    v_accvgpr_mov_b32 a17, a25
    v_accvgpr_mov_b32 a18, a26
    v_accvgpr_mov_b32 a19, a27
    v_accvgpr_mov_b32 a20, a28
    v_accvgpr_mov_b32 a21, a29
    v_accvgpr_mov_b32 a22, a30
    v_accvgpr_mov_b32 a23, a31
    v_accvgpr_mov_b32 a24, a32
    v_accvgpr_mov_b32 a25, a33
    v_accvgpr_mov_b32 a26, a34
    v_accvgpr_mov_b32 a27, a35
    v_accvgpr_mov_b32 a28, a36
    v_accvgpr_mov_b32 a29, a37
    v_accvgpr_mov_b32 a30, a38
    v_accvgpr_mov_b32 a31, a39
    v_accvgpr_mov_b32 a32, a40
    v_accvgpr_mov_b32 a33, a41
    v_accvgpr_mov_b32 a34, a42
    v_accvgpr_mov_b32 a35, a43
    v_accvgpr_mov_b32 a36, a44
    v_accvgpr_mov_b32 a37, a45
    v_accvgpr_mov_b32 a38, a46
    v_accvgpr_mov_b32 a39, a47
    v_accvgpr_mov_b32 a40, a48
    v_accvgpr_mov_b32 a41, a49
    v_accvgpr_mov_b32 a42, a50
    v_accvgpr_mov_b32 a43, a51
    v_accvgpr_mov_b32 a44, a52
    v_accvgpr_mov_b32 a45, a53
    v_accvgpr_mov_b32 a46, a54
    v_accvgpr_mov_b32 a47, a55
    v_accvgpr_mov_b32 a48, a56
    v_accvgpr_mov_b32 a49, a57
    v_accvgpr_mov_b32 a50, a58
    v_accvgpr_mov_b32 a51, a59
    v_accvgpr_mov_b32 a52, a60
    v_accvgpr_mov_b32 a53, a61
    v_accvgpr_mov_b32 a54, a62
    v_accvgpr_mov_b32 a55, a63
    s_add_u32 s60, s60, 8
    s_cmp_lt_u32 s60, 64
    s_cbranch_scc1 L_l_sub_19
    s_cmp_lt_u32 s48, 14
    s_cbranch_scc1 L_w_att_13
    s_and_b32 s55, s48, 1
    s_lshl_b32 s55, s55, 3
    s_add_u32 s55, s55, s40
    s_load_dwordx4 s[8:11], s[0:1], 96
    v_lshrrev_b32 v5, 3, v0
    s_mov_b32 s46, 196608
    v_mul_lo_u32 v4, v5, s46
    v_and_b32 v6, 7, v0
    v_lshl_add_u32 v4, v6, 4, v4
    v_lshlrev_b32 v5, 5, v5
    s_waitcnt lgkmcnt(0)
    s_mov_b32 s28, s10
    s_and_b32 s29, s11, 0xffff
    s_mov_b32 s30, 0xc00000
    s_mov_b32 s31, 0x00020000
    s_mov_b32 s32, s8
    s_and_b32 s33, s9, 0xffff
    s_mov_b32 s34, 0x800
    s_mov_b32 s35, 0x00020000
    buffer_load_dwordx4 v[8:11], v5, s[32:35], 0 offen
    buffer_load_dwordx4 v[12:15], v5, s[32:35], 0 offen offset:16
    s_waitcnt vmcnt(0)
    v_lshlrev_b32 v16, 16, v8
    v_and_b32 v17, 0xffff0000, v8
    v_lshlrev_b32 v18, 16, v9
    v_and_b32 v19, 0xffff0000, v9
    v_lshlrev_b32 v20, 16, v10
    v_and_b32 v21, 0xffff0000, v10
    v_lshlrev_b32 v22, 16, v11
    v_and_b32 v23, 0xffff0000, v11
    v_lshlrev_b32 v24, 16, v12
    v_and_b32 v25, 0xffff0000, v12
    v_lshlrev_b32 v26, 16, v13
    v_and_b32 v27, 0xffff0000, v13
    v_lshlrev_b32 v28, 16, v14
    v_and_b32 v29, 0xffff0000, v14
    v_lshlrev_b32 v30, 16, v15
    v_and_b32 v31, 0xffff0000, v15
    v_mul_f32 v112, 0xbfb8aa3b, v16
    v_mul_f32 v113, 0xbfb8aa3b, v17
    v_mul_f32 v114, 0xbfb8aa3b, v18
    v_mul_f32 v115, 0xbfb8aa3b, v19
    v_mul_f32 v116, 0xbfb8aa3b, v20
    v_mul_f32 v117, 0xbfb8aa3b, v21
    v_mul_f32 v118, 0xbfb8aa3b, v22
    v_mul_f32 v119, 0xbfb8aa3b, v23
    v_mul_f32 v120, 0xbfb8aa3b, v24
    v_mul_f32 v121, 0xbfb8aa3b, v25
    v_mul_f32 v122, 0xbfb8aa3b, v26
    v_mul_f32 v123, 0xbfb8aa3b, v27
    v_mul_f32 v124, 0xbfb8aa3b, v28
    v_mul_f32 v125, 0xbfb8aa3b, v29
    v_mul_f32 v126, 0xbfb8aa3b, v30
    v_mul_f32 v127, 0xbfb8aa3b, v31
    v_exp_f32 v112, v112
    v_exp_f32 v113, v113
    v_exp_f32 v114, v114
    v_exp_f32 v115, v115
    v_exp_f32 v116, v116
    v_exp_f32 v117, v117
    v_exp_f32 v118, v118
    v_exp_f32 v119, v119
    v_exp_f32 v120, v120
    v_exp_f32 v121, v121
    v_exp_f32 v122, v122
    v_exp_f32 v123, v123
    v_exp_f32 v124, v124
    v_exp_f32 v125, v125
    v_exp_f32 v126, v126
    v_exp_f32 v127, v127
    v_add_f32 v112, 1.0, v112
    v_add_f32 v113, 1.0, v113
    v_add_f32 v114, 1.0, v114
    v_add_f32 v115, 1.0, v115
    v_add_f32 v116, 1.0, v116
    v_add_f32 v117, 1.0, v117
    v_add_f32 v118, 1.0, v118
    v_add_f32 v119, 1.0, v119
    v_add_f32 v120, 1.0, v120
    v_add_f32 v121, 1.0, v121
    v_add_f32 v122, 1.0, v122
    v_add_f32 v123, 1.0, v123
    v_add_f32 v124, 1.0, v124
    v_add_f32 v125, 1.0, v125
    v_add_f32 v126, 1.0, v126
    v_add_f32 v127, 1.0, v127
    v_rcp_f32 v112, v112
    v_rcp_f32 v113, v113
    v_rcp_f32 v114, v114
    v_rcp_f32 v115, v115
    v_rcp_f32 v116, v116
    v_rcp_f32 v117, v117
    v_rcp_f32 v118, v118
    v_rcp_f32 v119, v119
    v_rcp_f32 v120, v120
    v_rcp_f32 v121, v121
    v_rcp_f32 v122, v122
    v_rcp_f32 v123, v123
    v_rcp_f32 v124, v124
    v_rcp_f32 v125, v125
    v_rcp_f32 v126, v126
    v_rcp_f32 v127, v127
    v_mul_f32 v16, v16, v112
    v_mul_f32 v17, v17, v113
    v_mul_f32 v18, v18, v114
    v_mul_f32 v19, v19, v115
    v_mul_f32 v20, v20, v116
    v_mul_f32 v21, v21, v117
    v_mul_f32 v22, v22, v118
    v_mul_f32 v23, v23, v119
    v_mul_f32 v24, v24, v120
    v_mul_f32 v25, v25, v121
    v_mul_f32 v26, v26, v122
    v_mul_f32 v27, v27, v123
    v_mul_f32 v28, v28, v124
    v_mul_f32 v29, v29, v125
    v_mul_f32 v30, v30, v126
    v_mul_f32 v31, v31, v127
    v_cvt_pk_bf16_f32 v16, 0, v16
    v_cvt_pk_bf16_f32 v17, 0, v17
    v_cvt_pk_bf16_f32 v18, 0, v18
    v_cvt_pk_bf16_f32 v19, 0, v19
    v_cvt_pk_bf16_f32 v20, 0, v20
    v_cvt_pk_bf16_f32 v21, 0, v21
    v_cvt_pk_bf16_f32 v22, 0, v22
    v_cvt_pk_bf16_f32 v23, 0, v23
    v_cvt_pk_bf16_f32 v24, 0, v24
    v_cvt_pk_bf16_f32 v25, 0, v25
    v_cvt_pk_bf16_f32 v26, 0, v26
    v_cvt_pk_bf16_f32 v27, 0, v27
    v_cvt_pk_bf16_f32 v28, 0, v28
    v_cvt_pk_bf16_f32 v29, 0, v29
    v_cvt_pk_bf16_f32 v30, 0, v30
    v_cvt_pk_bf16_f32 v31, 0, v31
    s_lshl_b32 s53, s55, 9
    s_add_u32 s53, s53, 4096
L_m_loop_22:
    s_add_u32 s46, s53, 0
    buffer_load_dwordx4 v[32:35], v4, s[28:31], s46 offen
    s_add_u32 s46, s53, 12288
    buffer_load_dwordx4 v[36:39], v4, s[28:31], s46 offen
    s_add_u32 s46, s53, 24576
    buffer_load_dwordx4 v[40:43], v4, s[28:31], s46 offen
    s_add_u32 s46, s53, 36864
    buffer_load_dwordx4 v[44:47], v4, s[28:31], s46 offen
    s_add_u32 s46, s53, 49152
    buffer_load_dwordx4 v[48:51], v4, s[28:31], s46 offen
    s_add_u32 s46, s53, 61440
    buffer_load_dwordx4 v[52:55], v4, s[28:31], s46 offen
    s_add_u32 s46, s53, 73728
    buffer_load_dwordx4 v[56:59], v4, s[28:31], s46 offen
    s_add_u32 s46, s53, 86016
    buffer_load_dwordx4 v[60:63], v4, s[28:31], s46 offen
    s_add_u32 s46, s53, 98304
    buffer_load_dwordx4 v[64:67], v4, s[28:31], s46 offen
    s_add_u32 s46, s53, 110592
    buffer_load_dwordx4 v[68:71], v4, s[28:31], s46 offen
    s_add_u32 s46, s53, 122880
    buffer_load_dwordx4 v[72:75], v4, s[28:31], s46 offen
    s_add_u32 s46, s53, 135168
    buffer_load_dwordx4 v[76:79], v4, s[28:31], s46 offen
    s_add_u32 s46, s53, 147456
    buffer_load_dwordx4 v[80:83], v4, s[28:31], s46 offen
    s_add_u32 s46, s53, 159744
    buffer_load_dwordx4 v[84:87], v4, s[28:31], s46 offen
    s_add_u32 s46, s53, 172032
    buffer_load_dwordx4 v[88:91], v4, s[28:31], s46 offen
    s_add_u32 s46, s53, 184320
    buffer_load_dwordx4 v[92:95], v4, s[28:31], s46 offen
    s_waitcnt vmcnt(15)
    v_lshlrev_b32 v104, 16, v32
    v_and_b32 v105, 0xffff0000, v32
    v_mul_f32 v96, v104, v16
    v_mul_f32 v97, v105, v16
    v_lshlrev_b32 v104, 16, v33
    v_and_b32 v105, 0xffff0000, v33
    v_mul_f32 v98, v104, v16
    v_mul_f32 v99, v105, v16
    v_lshlrev_b32 v104, 16, v34
    v_and_b32 v105, 0xffff0000, v34
    v_mul_f32 v100, v104, v16
    v_mul_f32 v101, v105, v16
    v_lshlrev_b32 v104, 16, v35
    v_and_b32 v105, 0xffff0000, v35
    v_mul_f32 v102, v104, v16
    v_mul_f32 v103, v105, v16
    s_waitcnt vmcnt(14)
    v_lshlrev_b32 v104, 16, v36
    v_and_b32 v105, 0xffff0000, v36
    v_fmac_f32 v96, v104, v17
    v_fmac_f32 v97, v105, v17
    v_lshlrev_b32 v104, 16, v37
    v_and_b32 v105, 0xffff0000, v37
    v_fmac_f32 v98, v104, v17
    v_fmac_f32 v99, v105, v17
    v_lshlrev_b32 v104, 16, v38
    v_and_b32 v105, 0xffff0000, v38
    v_fmac_f32 v100, v104, v17
    v_fmac_f32 v101, v105, v17
    v_lshlrev_b32 v104, 16, v39
    v_and_b32 v105, 0xffff0000, v39
    v_fmac_f32 v102, v104, v17
    v_fmac_f32 v103, v105, v17
    s_waitcnt vmcnt(13)
    v_lshlrev_b32 v104, 16, v40
    v_and_b32 v105, 0xffff0000, v40
    v_fmac_f32 v96, v104, v18
    v_fmac_f32 v97, v105, v18
    v_lshlrev_b32 v104, 16, v41
    v_and_b32 v105, 0xffff0000, v41
    v_fmac_f32 v98, v104, v18
    v_fmac_f32 v99, v105, v18
    v_lshlrev_b32 v104, 16, v42
    v_and_b32 v105, 0xffff0000, v42
    v_fmac_f32 v100, v104, v18
    v_fmac_f32 v101, v105, v18
    v_lshlrev_b32 v104, 16, v43
    v_and_b32 v105, 0xffff0000, v43
    v_fmac_f32 v102, v104, v18
    v_fmac_f32 v103, v105, v18
    s_waitcnt vmcnt(12)
    v_lshlrev_b32 v104, 16, v44
    v_and_b32 v105, 0xffff0000, v44
    v_fmac_f32 v96, v104, v19
    v_fmac_f32 v97, v105, v19
    v_lshlrev_b32 v104, 16, v45
    v_and_b32 v105, 0xffff0000, v45
    v_fmac_f32 v98, v104, v19
    v_fmac_f32 v99, v105, v19
    v_lshlrev_b32 v104, 16, v46
    v_and_b32 v105, 0xffff0000, v46
    v_fmac_f32 v100, v104, v19
    v_fmac_f32 v101, v105, v19
    v_lshlrev_b32 v104, 16, v47
    v_and_b32 v105, 0xffff0000, v47
    v_fmac_f32 v102, v104, v19
    v_fmac_f32 v103, v105, v19
    s_waitcnt vmcnt(11)
    v_lshlrev_b32 v104, 16, v48
    v_and_b32 v105, 0xffff0000, v48
    v_fmac_f32 v96, v104, v20
    v_fmac_f32 v97, v105, v20
    v_lshlrev_b32 v104, 16, v49
    v_and_b32 v105, 0xffff0000, v49
    v_fmac_f32 v98, v104, v20
    v_fmac_f32 v99, v105, v20
    v_lshlrev_b32 v104, 16, v50
    v_and_b32 v105, 0xffff0000, v50
    v_fmac_f32 v100, v104, v20
    v_fmac_f32 v101, v105, v20
    v_lshlrev_b32 v104, 16, v51
    v_and_b32 v105, 0xffff0000, v51
    v_fmac_f32 v102, v104, v20
    v_fmac_f32 v103, v105, v20
    s_waitcnt vmcnt(10)
    v_lshlrev_b32 v104, 16, v52
    v_and_b32 v105, 0xffff0000, v52
    v_fmac_f32 v96, v104, v21
    v_fmac_f32 v97, v105, v21
    v_lshlrev_b32 v104, 16, v53
    v_and_b32 v105, 0xffff0000, v53
    v_fmac_f32 v98, v104, v21
    v_fmac_f32 v99, v105, v21
    v_lshlrev_b32 v104, 16, v54
    v_and_b32 v105, 0xffff0000, v54
    v_fmac_f32 v100, v104, v21
    v_fmac_f32 v101, v105, v21
    v_lshlrev_b32 v104, 16, v55
    v_and_b32 v105, 0xffff0000, v55
    v_fmac_f32 v102, v104, v21
    v_fmac_f32 v103, v105, v21
    s_waitcnt vmcnt(9)
    v_lshlrev_b32 v104, 16, v56
    v_and_b32 v105, 0xffff0000, v56
    v_fmac_f32 v96, v104, v22
    v_fmac_f32 v97, v105, v22
    v_lshlrev_b32 v104, 16, v57
    v_and_b32 v105, 0xffff0000, v57
    v_fmac_f32 v98, v104, v22
    v_fmac_f32 v99, v105, v22
    v_lshlrev_b32 v104, 16, v58
    v_and_b32 v105, 0xffff0000, v58
    v_fmac_f32 v100, v104, v22
    v_fmac_f32 v101, v105, v22
    v_lshlrev_b32 v104, 16, v59
    v_and_b32 v105, 0xffff0000, v59
    v_fmac_f32 v102, v104, v22
    v_fmac_f32 v103, v105, v22
    s_waitcnt vmcnt(8)
    v_lshlrev_b32 v104, 16, v60
    v_and_b32 v105, 0xffff0000, v60
    v_fmac_f32 v96, v104, v23
    v_fmac_f32 v97, v105, v23
    v_lshlrev_b32 v104, 16, v61
    v_and_b32 v105, 0xffff0000, v61
    v_fmac_f32 v98, v104, v23
    v_fmac_f32 v99, v105, v23
    v_lshlrev_b32 v104, 16, v62
    v_and_b32 v105, 0xffff0000, v62
    v_fmac_f32 v100, v104, v23
    v_fmac_f32 v101, v105, v23
    v_lshlrev_b32 v104, 16, v63
    v_and_b32 v105, 0xffff0000, v63
    v_fmac_f32 v102, v104, v23
    v_fmac_f32 v103, v105, v23
    s_waitcnt vmcnt(7)
    v_lshlrev_b32 v104, 16, v64
    v_and_b32 v105, 0xffff0000, v64
    v_fmac_f32 v96, v104, v24
    v_fmac_f32 v97, v105, v24
    v_lshlrev_b32 v104, 16, v65
    v_and_b32 v105, 0xffff0000, v65
    v_fmac_f32 v98, v104, v24
    v_fmac_f32 v99, v105, v24
    v_lshlrev_b32 v104, 16, v66
    v_and_b32 v105, 0xffff0000, v66
    v_fmac_f32 v100, v104, v24
    v_fmac_f32 v101, v105, v24
    v_lshlrev_b32 v104, 16, v67
    v_and_b32 v105, 0xffff0000, v67
    v_fmac_f32 v102, v104, v24
    v_fmac_f32 v103, v105, v24
    s_waitcnt vmcnt(6)
    v_lshlrev_b32 v104, 16, v68
    v_and_b32 v105, 0xffff0000, v68
    v_fmac_f32 v96, v104, v25
    v_fmac_f32 v97, v105, v25
    v_lshlrev_b32 v104, 16, v69
    v_and_b32 v105, 0xffff0000, v69
    v_fmac_f32 v98, v104, v25
    v_fmac_f32 v99, v105, v25
    v_lshlrev_b32 v104, 16, v70
    v_and_b32 v105, 0xffff0000, v70
    v_fmac_f32 v100, v104, v25
    v_fmac_f32 v101, v105, v25
    v_lshlrev_b32 v104, 16, v71
    v_and_b32 v105, 0xffff0000, v71
    v_fmac_f32 v102, v104, v25
    v_fmac_f32 v103, v105, v25
    s_waitcnt vmcnt(5)
    v_lshlrev_b32 v104, 16, v72
    v_and_b32 v105, 0xffff0000, v72
    v_fmac_f32 v96, v104, v26
    v_fmac_f32 v97, v105, v26
    v_lshlrev_b32 v104, 16, v73
    v_and_b32 v105, 0xffff0000, v73
    v_fmac_f32 v98, v104, v26
    v_fmac_f32 v99, v105, v26
    v_lshlrev_b32 v104, 16, v74
    v_and_b32 v105, 0xffff0000, v74
    v_fmac_f32 v100, v104, v26
    v_fmac_f32 v101, v105, v26
    v_lshlrev_b32 v104, 16, v75
    v_and_b32 v105, 0xffff0000, v75
    v_fmac_f32 v102, v104, v26
    v_fmac_f32 v103, v105, v26
    s_waitcnt vmcnt(4)
    v_lshlrev_b32 v104, 16, v76
    v_and_b32 v105, 0xffff0000, v76
    v_fmac_f32 v96, v104, v27
    v_fmac_f32 v97, v105, v27
    v_lshlrev_b32 v104, 16, v77
    v_and_b32 v105, 0xffff0000, v77
    v_fmac_f32 v98, v104, v27
    v_fmac_f32 v99, v105, v27
    v_lshlrev_b32 v104, 16, v78
    v_and_b32 v105, 0xffff0000, v78
    v_fmac_f32 v100, v104, v27
    v_fmac_f32 v101, v105, v27
    v_lshlrev_b32 v104, 16, v79
    v_and_b32 v105, 0xffff0000, v79
    v_fmac_f32 v102, v104, v27
    v_fmac_f32 v103, v105, v27
    s_waitcnt vmcnt(3)
    v_lshlrev_b32 v104, 16, v80
    v_and_b32 v105, 0xffff0000, v80
    v_fmac_f32 v96, v104, v28
    v_fmac_f32 v97, v105, v28
    v_lshlrev_b32 v104, 16, v81
    v_and_b32 v105, 0xffff0000, v81
    v_fmac_f32 v98, v104, v28
    v_fmac_f32 v99, v105, v28
    v_lshlrev_b32 v104, 16, v82
    v_and_b32 v105, 0xffff0000, v82
    v_fmac_f32 v100, v104, v28
    v_fmac_f32 v101, v105, v28
    v_lshlrev_b32 v104, 16, v83
    v_and_b32 v105, 0xffff0000, v83
    v_fmac_f32 v102, v104, v28
    v_fmac_f32 v103, v105, v28
    s_waitcnt vmcnt(2)
    v_lshlrev_b32 v104, 16, v84
    v_and_b32 v105, 0xffff0000, v84
    v_fmac_f32 v96, v104, v29
    v_fmac_f32 v97, v105, v29
    v_lshlrev_b32 v104, 16, v85
    v_and_b32 v105, 0xffff0000, v85
    v_fmac_f32 v98, v104, v29
    v_fmac_f32 v99, v105, v29
    v_lshlrev_b32 v104, 16, v86
    v_and_b32 v105, 0xffff0000, v86
    v_fmac_f32 v100, v104, v29
    v_fmac_f32 v101, v105, v29
    v_lshlrev_b32 v104, 16, v87
    v_and_b32 v105, 0xffff0000, v87
    v_fmac_f32 v102, v104, v29
    v_fmac_f32 v103, v105, v29
    s_waitcnt vmcnt(1)
    v_lshlrev_b32 v104, 16, v88
    v_and_b32 v105, 0xffff0000, v88
    v_fmac_f32 v96, v104, v30
    v_fmac_f32 v97, v105, v30
    v_lshlrev_b32 v104, 16, v89
    v_and_b32 v105, 0xffff0000, v89
    v_fmac_f32 v98, v104, v30
    v_fmac_f32 v99, v105, v30
    v_lshlrev_b32 v104, 16, v90
    v_and_b32 v105, 0xffff0000, v90
    v_fmac_f32 v100, v104, v30
    v_fmac_f32 v101, v105, v30
    v_lshlrev_b32 v104, 16, v91
    v_and_b32 v105, 0xffff0000, v91
    v_fmac_f32 v102, v104, v30
    v_fmac_f32 v103, v105, v30
    s_waitcnt vmcnt(0)
    v_lshlrev_b32 v104, 16, v92
    v_and_b32 v105, 0xffff0000, v92
    v_fmac_f32 v96, v104, v31
    v_fmac_f32 v97, v105, v31
    v_lshlrev_b32 v104, 16, v93
    v_and_b32 v105, 0xffff0000, v93
    v_fmac_f32 v98, v104, v31
    v_fmac_f32 v99, v105, v31
    v_lshlrev_b32 v104, 16, v94
    v_and_b32 v105, 0xffff0000, v94
    v_fmac_f32 v100, v104, v31
    v_fmac_f32 v101, v105, v31
    v_lshlrev_b32 v104, 16, v95
    v_and_b32 v105, 0xffff0000, v95
    v_fmac_f32 v102, v104, v31
    v_fmac_f32 v103, v105, v31
    v_lshlrev_b32 v104, 5, v0
    ds_write_b128 v104, v[96:99]
    ds_write_b128 v104, v[100:103] offset:16
    v_lshlrev_b32 v105, 2, v1
    s_lshl_b32 s46, s44, 11
    v_add_u32 v104, s46, v105
    s_waitcnt lgkmcnt(0)
    ds_read_b32 v96, v104 offset:0
    ds_read_b32 v97, v104 offset:256
    ds_read_b32 v98, v104 offset:512
    ds_read_b32 v99, v104 offset:768
    ds_read_b32 v100, v104 offset:1024
    ds_read_b32 v101, v104 offset:1280
    ds_read_b32 v102, v104 offset:1536
    ds_read_b32 v103, v104 offset:1792
    s_waitcnt lgkmcnt(0)
    v_add_f32 v96, v96, v100
    v_add_f32 v97, v97, v101
    v_add_f32 v98, v98, v102
    v_add_f32 v99, v99, v103
    v_add_f32 v96, v96, v98
    v_add_f32 v97, v97, v99
    v_add_f32 v96, v96, v97
    v_lshlrev_b32 v104, 2, v0
    ds_write_b32 v104, v96 offset:16384
    s_waitcnt lgkmcnt(0)
    s_barrier
    s_cmp_lg_u32 s44, 0
    s_cbranch_scc1 L_m_sk_23
    ds_read_b32 v96, v105 offset:16384
    ds_read_b32 v97, v105 offset:16640
    ds_read_b32 v98, v105 offset:16896
    ds_read_b32 v99, v105 offset:17152
    ds_read_b32 v100, v105 offset:17408
    ds_read_b32 v101, v105 offset:17664
    ds_read_b32 v102, v105 offset:17920
    ds_read_b32 v103, v105 offset:18176
    s_waitcnt lgkmcnt(0)
    v_add_f32 v96, v96, v100
    v_add_f32 v97, v97, v101
    v_add_f32 v98, v98, v102
    v_add_f32 v99, v99, v103
    v_add_f32 v96, v96, v98
    v_add_f32 v97, v97, v99
    v_add_f32 v96, v96, v97
    v_cvt_pk_bf16_f32 v96, 0, v96
    s_lshl_b32 s46, s53, 1
    buffer_store_dword v96, v105, s[12:15], s46 offen sc1
L_m_sk_23:
    s_barrier
    s_add_u32 s53, s53, 128
    s_and_b32 s46, s53, 511
    s_cmp_lg_u32 s46, 0
    s_cbranch_scc1 L_m_loop_22
    s_lshl_b32 s54, s55, 7
    s_add_u32 s54, s54, 0x10e400
    s_mov_b32 s60, 0
    s_waitcnt vmcnt(0)
    s_cmp_lg_u32 s44, 0
    s_cbranch_scc1 L_sf_24
    v_mov_b32 v8, s60
    v_add_u32 v8, 1, v8
    v_mov_b32 v9, 0
    s_mov_b64 exec, 1
    buffer_store_dword v8, v9, s[12:15], s54 offen sc1
    s_mov_b64 exec, -1
L_sf_24:
    s_load_dwordx2 s[4:5], s[0:1], 64
    s_load_dwordx2 s[6:7], s[0:1], 80
    v_lshlrev_b32 v4, 7, v0
    s_mul_i32 s46, s55, 458752
    s_waitcnt lgkmcnt(0)
    s_mov_b32 s28, s4
    s_and_b32 s29, s5, 0xffff
    s_mov_b32 s30, 0x700000
    s_mov_b32 s31, 0x00020000
    s_mov_b32 s32, s6
    s_and_b32 s33, s7, 0xffff
    s_mov_b32 s34, 0x700000
    s_mov_b32 s35, 0x00020000
    buffer_load_dword v32, v4, s[28:31], s46 offen
    buffer_load_dword v33, v4, s[32:35], s46 offen
    s_add_u32 s46, s46, 65536
    s_waitcnt vmcnt(2)
    buffer_load_dword v34, v4, s[28:31], s46 offen
    buffer_load_dword v35, v4, s[32:35], s46 offen
    s_add_u32 s46, s46, 65536
    s_waitcnt vmcnt(2)
    buffer_load_dword v36, v4, s[28:31], s46 offen
    buffer_load_dword v37, v4, s[32:35], s46 offen
    s_add_u32 s46, s46, 65536
    s_waitcnt vmcnt(2)
    buffer_load_dword v38, v4, s[28:31], s46 offen
    buffer_load_dword v39, v4, s[32:35], s46 offen
    s_add_u32 s46, s46, 65536
    s_waitcnt vmcnt(2)
    buffer_load_dword v40, v4, s[28:31], s46 offen
    buffer_load_dword v41, v4, s[32:35], s46 offen
    s_add_u32 s46, s46, 65536
    s_waitcnt vmcnt(2)
    buffer_load_dword v42, v4, s[28:31], s46 offen
    buffer_load_dword v43, v4, s[32:35], s46 offen
    s_add_u32 s46, s46, 65536
    s_waitcnt vmcnt(2)
    buffer_load_dword v44, v4, s[28:31], s46 offen
    buffer_load_dword v45, v4, s[32:35], s46 offen
    s_add_u32 s46, s46, 65536
    s_waitcnt vmcnt(2)
    s_waitcnt vmcnt(0)
    s_and_b32 s42, s40, 3
    s_lshr_b32 s43, s40, 2
    s_cmp_eq_u32 s48, 14
    s_cbranch_scc1 L_w_c_14
    s_load_dwordx2 s[4:5], s[0:1], 112
    s_load_dwordx2 s[6:7], s[0:1], 88
    v_lshlrev_b32 v2, 4, v1
    v_lshlrev_b32 v3, 5, v1
    s_waitcnt lgkmcnt(0)
    s_mov_b32 s24, s4
    s_and_b32 s25, s5, 0xffff
    s_mov_b32 s26, 0x400000
    s_mov_b32 s27, 0x00020000
    s_mov_b32 s28, s6
    s_and_b32 s29, s7, 0xffff
    s_mov_b32 s30, 0x800
    s_mov_b32 s31, 0x00020000
    s_cmp_lg_u32 s44, 0
    s_cbranch_scc1 L_mw_25
    v_and_b32 v8, 15, v1
    v_lshlrev_b32 v8, 7, v8
    s_mov_b32 s46, 0x10e400
    s_mov_b32 s47, 0
    s_mov_b32 s70, 0
L_spin_26:
    buffer_load_dword v9, v8, s[12:15], s46 offen sc1
    s_waitcnt vmcnt(0)
    v_cmp_ge_u32 vcc, s47, v9
    s_add_u32 s70, s70, 1
    s_cbranch_vccz L_spok_27
    s_sleep 2
    s_cmp_lt_u32 s70, 524288
    s_cbranch_scc1 L_spin_26
    s_branch L_c_done_1
L_spok_27:
L_mw_25:
    s_barrier
    s_mov_b32 s46, 20480
    buffer_load_dwordx4 v[16:19], v3, s[12:15], s46 offen offset:0 sc1
    buffer_load_dwordx4 v[20:23], v3, s[12:15], s46 offen offset:16 sc1
    buffer_load_dwordx4 v[24:27], v3, s[12:15], s46 offen offset:2048 sc1
    buffer_load_dwordx4 v[28:31], v3, s[12:15], s46 offen offset:2064 sc1
    buffer_load_dwordx4 v[48:51], v2, s[28:31], 0 offen
    buffer_load_dwordx4 v[52:55], v2, s[28:31], 0 offen offset:1024
    s_waitcnt vmcnt(0)
    v_lshlrev_b32 v32, 16, v48
    v_and_b32 v33, 0xffff0000, v48
    v_lshlrev_b32 v34, 16, v49
    v_and_b32 v35, 0xffff0000, v49
    v_lshlrev_b32 v36, 16, v50
    v_and_b32 v37, 0xffff0000, v50
    v_lshlrev_b32 v38, 16, v51
    v_and_b32 v39, 0xffff0000, v51
    v_lshlrev_b32 v40, 16, v52
    v_and_b32 v41, 0xffff0000, v52
    v_lshlrev_b32 v42, 16, v53
    v_and_b32 v43, 0xffff0000, v53
    v_lshlrev_b32 v44, 16, v54
    v_and_b32 v45, 0xffff0000, v54
    v_lshlrev_b32 v46, 16, v55
    v_and_b32 v47, 0xffff0000, v55
    s_lshl_b32 s46, s42, 14
    s_lshl_b32 s47, s44, 11
    s_add_u32 s46, s46, s47
    s_add_u32 s46, s46, 0xb000000
    v_add_u32 v4, s46, v2
    v_and_b32 v5, 31, v1
    v_lshlrev_b32 v5, 7, v5
    v_add_u32 v5, 0x108400, v5
    v_lshlrev_b32 v6, 2, v1
    s_lshl_b32 s46, s44, 9
    v_add_u32 v6, s46, v6
    s_lshl_b32 s46, s44, 12
    v_add_u32 v7, s46, v3
    s_lshl_b32 s46, s42, 3
    s_add_u32 s46, s46, s44
    s_lshl_b32 s46, s46, 11
    v_add_u32 v8, s46, v2
    v_add_u32 v9, 0x800000, v8
    s_mov_b32 s60, s43
L_r_loop_28:
    s_lshl_b32 s61, s60, 18
    s_lshl_b32 s63, s60, 16
    s_cmp_lg_u32 s44, 0
    s_cbranch_scc1 L_r_nsp_29
    s_mov_b32 s70, 0
L_spin_30:
    buffer_load_dword v14, v5, s[12:15], 0 offen sc1
    s_waitcnt vmcnt(0)
    v_cmp_ge_u32 vcc, s60, v14
    s_add_u32 s70, s70, 1
    s_cbranch_vccz L_spok_31
    s_sleep 3
    s_cmp_lt_u32 s70, 524288
    s_cbranch_scc1 L_spin_30
    s_branch L_c_done_1
L_spok_31:
L_r_nsp_29:
    s_barrier
    buffer_load_dwordx4 v[96:99], v4, s[12:15], s61 offen offset:0 sc1
    buffer_load_dwordx4 v[100:103], v4, s[12:15], s61 offen offset:1024 sc1
    s_add_u32 s61, s61, 65536
    buffer_load_dwordx4 v[104:107], v4, s[12:15], s61 offen offset:0 sc1
    buffer_load_dwordx4 v[108:111], v4, s[12:15], s61 offen offset:1024 sc1
    s_add_u32 s61, s61, 65536
    buffer_load_dwordx4 v[112:115], v4, s[12:15], s61 offen offset:0 sc1
    buffer_load_dwordx4 v[116:119], v4, s[12:15], s61 offen offset:1024 sc1
    s_add_u32 s61, s61, 65536
    buffer_load_dwordx4 v[120:123], v4, s[12:15], s61 offen offset:0 sc1
    buffer_load_dwordx4 v[124:127], v4, s[12:15], s61 offen offset:1024 sc1
    buffer_load_dwordx4 a[0:3], v9, s[12:15], s63 offen sc1
    buffer_load_dwordx4 a[4:7], v9, s[12:15], s63 offen offset:1024 sc1
    s_waitcnt vmcnt(8)
    v_lshlrev_b32 v64, 16, v96
    v_and_b32 v65, 0xffff0000, v96
    v_lshlrev_b32 v66, 16, v97
    v_and_b32 v67, 0xffff0000, v97
    v_lshlrev_b32 v68, 16, v98
    v_and_b32 v69, 0xffff0000, v98
    v_lshlrev_b32 v70, 16, v99
    v_and_b32 v71, 0xffff0000, v99
    v_lshlrev_b32 v72, 16, v100
    v_and_b32 v73, 0xffff0000, v100
    v_lshlrev_b32 v74, 16, v101
    v_and_b32 v75, 0xffff0000, v101
    v_lshlrev_b32 v76, 16, v102
    v_and_b32 v77, 0xffff0000, v102
    v_lshlrev_b32 v78, 16, v103
    v_and_b32 v79, 0xffff0000, v103
    s_waitcnt vmcnt(6)
    v_lshlrev_b32 v80, 16, v104
    v_and_b32 v81, 0xffff0000, v104
    v_lshlrev_b32 v82, 16, v105
    v_and_b32 v83, 0xffff0000, v105
    v_lshlrev_b32 v84, 16, v106
    v_and_b32 v85, 0xffff0000, v106
    v_lshlrev_b32 v86, 16, v107
    v_and_b32 v87, 0xffff0000, v107
    v_lshlrev_b32 v88, 16, v108
    v_and_b32 v89, 0xffff0000, v108
    v_lshlrev_b32 v90, 16, v109
    v_and_b32 v91, 0xffff0000, v109
    v_lshlrev_b32 v92, 16, v110
    v_and_b32 v93, 0xffff0000, v110
    v_lshlrev_b32 v94, 16, v111
    v_and_b32 v95, 0xffff0000, v111
    v_pk_add_f32 v[64:65], v[64:65], v[80:81]
    v_pk_add_f32 v[66:67], v[66:67], v[82:83]
    v_pk_add_f32 v[68:69], v[68:69], v[84:85]
    v_pk_add_f32 v[70:71], v[70:71], v[86:87]
    v_pk_add_f32 v[72:73], v[72:73], v[88:89]
    v_pk_add_f32 v[74:75], v[74:75], v[90:91]
    v_pk_add_f32 v[76:77], v[76:77], v[92:93]
    v_pk_add_f32 v[78:79], v[78:79], v[94:95]
    s_waitcnt vmcnt(4)
    v_lshlrev_b32 v80, 16, v112
    v_and_b32 v81, 0xffff0000, v112
    v_lshlrev_b32 v82, 16, v113
    v_and_b32 v83, 0xffff0000, v113
    v_lshlrev_b32 v84, 16, v114
    v_and_b32 v85, 0xffff0000, v114
    v_lshlrev_b32 v86, 16, v115
    v_and_b32 v87, 0xffff0000, v115
    v_lshlrev_b32 v88, 16, v116
    v_and_b32 v89, 0xffff0000, v116
    v_lshlrev_b32 v90, 16, v117
    v_and_b32 v91, 0xffff0000, v117
    v_lshlrev_b32 v92, 16, v118
    v_and_b32 v93, 0xffff0000, v118
    v_lshlrev_b32 v94, 16, v119
    v_and_b32 v95, 0xffff0000, v119
    v_pk_add_f32 v[64:65], v[64:65], v[80:81]
    v_pk_add_f32 v[66:67], v[66:67], v[82:83]
    v_pk_add_f32 v[68:69], v[68:69], v[84:85]
    v_pk_add_f32 v[70:71], v[70:71], v[86:87]
    v_pk_add_f32 v[72:73], v[72:73], v[88:89]
    v_pk_add_f32 v[74:75], v[74:75], v[90:91]
    v_pk_add_f32 v[76:77], v[76:77], v[92:93]
    v_pk_add_f32 v[78:79], v[78:79], v[94:95]
    s_waitcnt vmcnt(2)
    v_lshlrev_b32 v80, 16, v120
    v_and_b32 v81, 0xffff0000, v120
    v_lshlrev_b32 v82, 16, v121
    v_and_b32 v83, 0xffff0000, v121
    v_lshlrev_b32 v84, 16, v122
    v_and_b32 v85, 0xffff0000, v122
    v_lshlrev_b32 v86, 16, v123
    v_and_b32 v87, 0xffff0000, v123
    v_lshlrev_b32 v88, 16, v124
    v_and_b32 v89, 0xffff0000, v124
    v_lshlrev_b32 v90, 16, v125
    v_and_b32 v91, 0xffff0000, v125
    v_lshlrev_b32 v92, 16, v126
    v_and_b32 v93, 0xffff0000, v126
    v_lshlrev_b32 v94, 16, v127
    v_and_b32 v95, 0xffff0000, v127
    v_pk_add_f32 v[64:65], v[64:65], v[80:81]
    v_pk_add_f32 v[66:67], v[66:67], v[82:83]
    v_pk_add_f32 v[68:69], v[68:69], v[84:85]
    v_pk_add_f32 v[70:71], v[70:71], v[86:87]
    v_pk_add_f32 v[72:73], v[72:73], v[88:89]
    v_pk_add_f32 v[74:75], v[74:75], v[90:91]
    v_pk_add_f32 v[76:77], v[76:77], v[92:93]
    v_pk_add_f32 v[78:79], v[78:79], v[94:95]
    ds_write_b32 v6, v64 offset:0
    ds_write_b32 v6, v65 offset:4096
    ds_write_b32 v6, v66 offset:8192
    ds_write_b32 v6, v67 offset:12288
    ds_write_b32 v6, v68 offset:16384
    ds_write_b32 v6, v69 offset:20480
    ds_write_b32 v6, v70 offset:24576
    ds_write_b32 v6, v71 offset:28672
    ds_write_b32 v6, v72 offset:256
    ds_write_b32 v6, v73 offset:4352
    ds_write_b32 v6, v74 offset:8448
    ds_write_b32 v6, v75 offset:12544
    ds_write_b32 v6, v76 offset:16640
    ds_write_b32 v6, v77 offset:20736
    ds_write_b32 v6, v78 offset:24832
    ds_write_b32 v6, v79 offset:28928
    s_waitcnt lgkmcnt(0)
    s_barrier
    ds_read_b128 v[64:67], v7
    ds_read_b128 v[68:71], v7 offset:16
    ds_read_b128 v[72:75], v7 offset:2048
    ds_read_b128 v[76:79], v7 offset:2064
    s_waitcnt vmcnt(0)
    v_accvgpr_read_b32 v96, a0
    v_accvgpr_read_b32 v97, a1
    v_accvgpr_read_b32 v98, a2
    v_accvgpr_read_b32 v99, a3
    v_accvgpr_read_b32 v100, a4
    v_accvgpr_read_b32 v101, a5
    v_accvgpr_read_b32 v102, a6
    v_accvgpr_read_b32 v103, a7
    v_lshlrev_b32 v80, 16, v96
    v_and_b32 v81, 0xffff0000, v96
    v_lshlrev_b32 v82, 16, v97
    v_and_b32 v83, 0xffff0000, v97
    v_lshlrev_b32 v84, 16, v98
    v_and_b32 v85, 0xffff0000, v98
    v_lshlrev_b32 v86, 16, v99
    v_and_b32 v87, 0xffff0000, v99
    v_lshlrev_b32 v88, 16, v100
    v_and_b32 v89, 0xffff0000, v100
    v_lshlrev_b32 v90, 16, v101
    v_and_b32 v91, 0xffff0000, v101
    v_lshlrev_b32 v92, 16, v102
    v_and_b32 v93, 0xffff0000, v102
    v_lshlrev_b32 v94, 16, v103
    v_and_b32 v95, 0xffff0000, v103
    s_waitcnt lgkmcnt(0)
    v_cvt_pk_bf16_f32 v64, 0, v64
    v_cvt_pk_bf16_f32 v65, 0, v65
    v_cvt_pk_bf16_f32 v66, 0, v66
    v_cvt_pk_bf16_f32 v67, 0, v67
    v_cvt_pk_bf16_f32 v68, 0, v68
    v_cvt_pk_bf16_f32 v69, 0, v69
    v_cvt_pk_bf16_f32 v70, 0, v70
    v_cvt_pk_bf16_f32 v71, 0, v71
    v_cvt_pk_bf16_f32 v72, 0, v72
    v_cvt_pk_bf16_f32 v73, 0, v73
    v_cvt_pk_bf16_f32 v74, 0, v74
    v_cvt_pk_bf16_f32 v75, 0, v75
    v_cvt_pk_bf16_f32 v76, 0, v76
    v_cvt_pk_bf16_f32 v77, 0, v77
    v_cvt_pk_bf16_f32 v78, 0, v78
    v_cvt_pk_bf16_f32 v79, 0, v79
    v_pk_add_f32 v[64:65], v[64:65], v[32:33]
    v_pk_add_f32 v[66:67], v[66:67], v[34:35]
    v_pk_add_f32 v[68:69], v[68:69], v[36:37]
    v_pk_add_f32 v[70:71], v[70:71], v[38:39]
    v_pk_add_f32 v[72:73], v[72:73], v[40:41]
    v_pk_add_f32 v[74:75], v[74:75], v[42:43]
    v_pk_add_f32 v[76:77], v[76:77], v[44:45]
    v_pk_add_f32 v[78:79], v[78:79], v[46:47]
    v_cvt_pk_bf16_f32 v64, 0, v64
    v_cvt_pk_bf16_f32 v65, 0, v65
    v_cvt_pk_bf16_f32 v66, 0, v66
    v_cvt_pk_bf16_f32 v67, 0, v67
    v_cvt_pk_bf16_f32 v68, 0, v68
    v_cvt_pk_bf16_f32 v69, 0, v69
    v_cvt_pk_bf16_f32 v70, 0, v70
    v_cvt_pk_bf16_f32 v71, 0, v71
    v_cvt_pk_bf16_f32 v72, 0, v72
    v_cvt_pk_bf16_f32 v73, 0, v73
    v_cvt_pk_bf16_f32 v74, 0, v74
    v_cvt_pk_bf16_f32 v75, 0, v75
    v_cvt_pk_bf16_f32 v76, 0, v76
    v_cvt_pk_bf16_f32 v77, 0, v77
    v_cvt_pk_bf16_f32 v78, 0, v78
    v_cvt_pk_bf16_f32 v79, 0, v79
    v_pk_mul_f32 v[64:65], v[64:65], v[16:17]
    v_pk_mul_f32 v[66:67], v[66:67], v[18:19]
    v_pk_mul_f32 v[68:69], v[68:69], v[20:21]
    v_pk_mul_f32 v[70:71], v[70:71], v[22:23]
    v_pk_mul_f32 v[72:73], v[72:73], v[24:25]
    v_pk_mul_f32 v[74:75], v[74:75], v[26:27]
    v_pk_mul_f32 v[76:77], v[76:77], v[28:29]
    v_pk_mul_f32 v[78:79], v[78:79], v[30:31]
    v_cvt_pk_bf16_f32 v64, 0, v64
    v_cvt_pk_bf16_f32 v65, 0, v65
    v_cvt_pk_bf16_f32 v66, 0, v66
    v_cvt_pk_bf16_f32 v67, 0, v67
    v_cvt_pk_bf16_f32 v68, 0, v68
    v_cvt_pk_bf16_f32 v69, 0, v69
    v_cvt_pk_bf16_f32 v70, 0, v70
    v_cvt_pk_bf16_f32 v71, 0, v71
    v_cvt_pk_bf16_f32 v72, 0, v72
    v_cvt_pk_bf16_f32 v73, 0, v73
    v_cvt_pk_bf16_f32 v74, 0, v74
    v_cvt_pk_bf16_f32 v75, 0, v75
    v_cvt_pk_bf16_f32 v76, 0, v76
    v_cvt_pk_bf16_f32 v77, 0, v77
    v_cvt_pk_bf16_f32 v78, 0, v78
    v_cvt_pk_bf16_f32 v79, 0, v79
    v_pk_add_f32 v[64:65], v[64:65], v[80:81]
    v_pk_add_f32 v[66:67], v[66:67], v[82:83]
    v_pk_add_f32 v[68:69], v[68:69], v[84:85]
    v_pk_add_f32 v[70:71], v[70:71], v[86:87]
    v_pk_add_f32 v[72:73], v[72:73], v[88:89]
    v_pk_add_f32 v[74:75], v[74:75], v[90:91]
    v_pk_add_f32 v[76:77], v[76:77], v[92:93]
    v_pk_add_f32 v[78:79], v[78:79], v[94:95]
    v_cvt_pk_bf16_f32 v96, v64, v65
    v_cvt_pk_bf16_f32 v97, v66, v67
    v_cvt_pk_bf16_f32 v98, v68, v69
    v_cvt_pk_bf16_f32 v99, v70, v71
    v_cvt_pk_bf16_f32 v100, v72, v73
    v_cvt_pk_bf16_f32 v101, v74, v75
    v_cvt_pk_bf16_f32 v102, v76, v77
    v_cvt_pk_bf16_f32 v103, v78, v79
    buffer_store_dwordx4 v[96:99], v8, s[24:27], s63 offen
    buffer_store_dwordx4 v[100:103], v8, s[24:27], s63 offen offset:1024
    s_add_u32 s60, s60, 2
    s_cmp_lt_u32 s60, 64
    s_cbranch_scc1 L_r_loop_28
    s_branch L_c_done_1
L_w_c_14:
    s_load_dwordx2 s[4:5], s[0:1], 0
    s_load_dwordx2 s[6:7], s[0:1], 88
    v_lshlrev_b32 v2, 4, v1
    v_lshlrev_b32 v3, 5, v1
    s_waitcnt lgkmcnt(0)
    s_mov_b32 s24, s4
    s_and_b32 s25, s5, 0xffff
    s_mov_b32 s26, 0x400000
    s_mov_b32 s27, 0x00020000
    s_mov_b32 s28, s6
    s_and_b32 s29, s7, 0xffff
    s_mov_b32 s30, 0x800
    s_mov_b32 s31, 0x00020000
    s_cmp_lg_u32 s44, 0
    s_cbranch_scc1 L_mw_32
    v_and_b32 v8, 15, v1
    v_lshlrev_b32 v8, 7, v8
    s_mov_b32 s46, 0x10e400
    s_mov_b32 s47, 0
    s_mov_b32 s70, 0
L_spin_33:
    buffer_load_dword v9, v8, s[12:15], s46 offen sc1
    s_waitcnt vmcnt(0)
    v_cmp_ge_u32 vcc, s47, v9
    s_add_u32 s70, s70, 1
    s_cbranch_vccz L_spok_34
    s_sleep 2
    s_cmp_lt_u32 s70, 524288
    s_cbranch_scc1 L_spin_33
    s_branch L_c_done_1
L_spok_34:
L_mw_32:
    s_barrier
    s_mov_b32 s46, 8192
    buffer_load_dwordx4 v[16:19], v3, s[12:15], s46 offen offset:0 sc1
    buffer_load_dwordx4 v[20:23], v3, s[12:15], s46 offen offset:16 sc1
    buffer_load_dwordx4 v[24:27], v3, s[12:15], s46 offen offset:2048 sc1
    buffer_load_dwordx4 v[28:31], v3, s[12:15], s46 offen offset:2064 sc1
    s_mov_b32 s46, 16384
    buffer_load_dwordx4 v[32:35], v3, s[12:15], s46 offen offset:0 sc1
    buffer_load_dwordx4 v[36:39], v3, s[12:15], s46 offen offset:16 sc1
    buffer_load_dwordx4 v[40:43], v3, s[12:15], s46 offen offset:2048 sc1
    buffer_load_dwordx4 v[44:47], v3, s[12:15], s46 offen offset:2064 sc1
    s_mov_b32 s46, 12288
    buffer_load_dwordx4 v[48:51], v3, s[12:15], s46 offen offset:0 sc1
    buffer_load_dwordx4 v[52:55], v3, s[12:15], s46 offen offset:16 sc1
    buffer_load_dwordx4 v[56:59], v3, s[12:15], s46 offen offset:2048 sc1
    buffer_load_dwordx4 v[60:63], v3, s[12:15], s46 offen offset:2064 sc1
    s_waitcnt vmcnt(0)
    v_add_f32 v32, 1.0, v32
    v_add_f32 v33, 1.0, v33
    v_add_f32 v34, 1.0, v34
    v_add_f32 v35, 1.0, v35
    v_add_f32 v36, 1.0, v36
    v_add_f32 v37, 1.0, v37
    v_add_f32 v38, 1.0, v38
    v_add_f32 v39, 1.0, v39
    v_add_f32 v40, 1.0, v40
    v_add_f32 v41, 1.0, v41
    v_add_f32 v42, 1.0, v42
    v_add_f32 v43, 1.0, v43
    v_add_f32 v44, 1.0, v44
    v_add_f32 v45, 1.0, v45
    v_add_f32 v46, 1.0, v46
    v_add_f32 v47, 1.0, v47
    v_cvt_pk_bf16_f32 v32, 0, v32
    v_cvt_pk_bf16_f32 v33, 0, v33
    v_cvt_pk_bf16_f32 v34, 0, v34
    v_cvt_pk_bf16_f32 v35, 0, v35
    v_cvt_pk_bf16_f32 v36, 0, v36
    v_cvt_pk_bf16_f32 v37, 0, v37
    v_cvt_pk_bf16_f32 v38, 0, v38
    v_cvt_pk_bf16_f32 v39, 0, v39
    v_cvt_pk_bf16_f32 v40, 0, v40
    v_cvt_pk_bf16_f32 v41, 0, v41
    v_cvt_pk_bf16_f32 v42, 0, v42
    v_cvt_pk_bf16_f32 v43, 0, v43
    v_cvt_pk_bf16_f32 v44, 0, v44
    v_cvt_pk_bf16_f32 v45, 0, v45
    v_cvt_pk_bf16_f32 v46, 0, v46
    v_cvt_pk_bf16_f32 v47, 0, v47
    s_lshl_b32 s46, s42, 14
    s_lshl_b32 s47, s44, 11
    s_add_u32 s46, s46, s47
    s_add_u32 s46, s46, 0x9000000
    v_add_u32 v4, s46, v2
    v_and_b32 v5, 31, v1
    v_lshlrev_b32 v5, 7, v5
    v_add_u32 v5, 0x107400, v5
    v_lshlrev_b32 v6, 2, v1
    s_lshl_b32 s46, s44, 9
    v_add_u32 v6, s46, v6
    s_lshl_b32 s46, s44, 12
    v_add_u32 v7, s46, v3
    s_lshl_b32 s46, s42, 3
    s_add_u32 s46, s46, s44
    s_lshl_b32 s46, s46, 11
    v_add_u32 v8, s46, v2
    v_add_u32 v9, 0x800000, v8
    s_mul_i32 s46, s44, 2064
    s_add_u32 s46, s46, 32768
    v_add_u32 v10, s46, v2
    v_and_b32 v11, 7, v1
    v_lshrrev_b32 v12, 3, v1
    v_mul_u32_u24 v13, 2064, v11
    v_lshl_add_u32 v13, v12, 4, v13
    s_lshl_b32 s46, s44, 8
    s_add_u32 s46, s46, 32768
    v_add_u32 v13, s46, v13
    v_lshlrev_b32 v11, 4, v11
    v_lshl_add_u32 v11, v12, 9, v11
    s_lshl_b32 s46, s44, 13
    s_lshl_b32 s47, s42, 7
    s_add_u32 s46, s46, s47
    s_add_u32 s46, s46, 0xc00000
    v_add_u32 v11, s46, v11
    v_add_u32 v12, 4096, v11
    s_lshl_b32 s52, s43, 9
    s_lshl_b32 s47, s42, 7
    s_add_u32 s52, s52, s47
    s_add_u32 s52, s52, 0x10ec00
    s_mov_b32 s60, s43
L_r_loop_35:
    s_lshl_b32 s61, s60, 18
    s_lshl_b32 s63, s60, 16
    buffer_load_dwordx4 a[0:3], v8, s[24:27], s63 offen
    buffer_load_dwordx4 a[4:7], v8, s[24:27], s63 offen offset:1024
    s_cmp_lg_u32 s44, 0
    s_cbranch_scc1 L_r_nsp_36
    s_mov_b32 s70, 0
L_spin_37:
    buffer_load_dword v14, v5, s[12:15], 0 offen sc1
    s_waitcnt vmcnt(0)
    v_cmp_ge_u32 vcc, s60, v14
    s_add_u32 s70, s70, 1
    s_cbranch_vccz L_spok_38
    s_sleep 3
    s_cmp_lt_u32 s70, 524288
    s_cbranch_scc1 L_spin_37
    s_branch L_c_done_1
L_spok_38:
L_r_nsp_36:
    s_barrier
    buffer_load_dwordx4 v[96:99], v4, s[12:15], s61 offen offset:0 sc1
    buffer_load_dwordx4 v[100:103], v4, s[12:15], s61 offen offset:1024 sc1
    s_add_u32 s61, s61, 65536
    buffer_load_dwordx4 v[104:107], v4, s[12:15], s61 offen offset:0 sc1
    buffer_load_dwordx4 v[108:111], v4, s[12:15], s61 offen offset:1024 sc1
    s_add_u32 s61, s61, 65536
    buffer_load_dwordx4 v[112:115], v4, s[12:15], s61 offen offset:0 sc1
    buffer_load_dwordx4 v[116:119], v4, s[12:15], s61 offen offset:1024 sc1
    s_add_u32 s61, s61, 65536
    buffer_load_dwordx4 v[120:123], v4, s[12:15], s61 offen offset:0 sc1
    buffer_load_dwordx4 v[124:127], v4, s[12:15], s61 offen offset:1024 sc1
    s_waitcnt vmcnt(6)
    v_lshlrev_b32 v64, 16, v96
    v_and_b32 v65, 0xffff0000, v96
    v_lshlrev_b32 v66, 16, v97
    v_and_b32 v67, 0xffff0000, v97
    v_lshlrev_b32 v68, 16, v98
    v_and_b32 v69, 0xffff0000, v98
    v_lshlrev_b32 v70, 16, v99
    v_and_b32 v71, 0xffff0000, v99
    v_lshlrev_b32 v72, 16, v100
    v_and_b32 v73, 0xffff0000, v100
    v_lshlrev_b32 v74, 16, v101
    v_and_b32 v75, 0xffff0000, v101
    v_lshlrev_b32 v76, 16, v102
    v_and_b32 v77, 0xffff0000, v102
    v_lshlrev_b32 v78, 16, v103
    v_and_b32 v79, 0xffff0000, v103
    s_waitcnt vmcnt(4)
    v_lshlrev_b32 v80, 16, v104
    v_and_b32 v81, 0xffff0000, v104
    v_lshlrev_b32 v82, 16, v105
    v_and_b32 v83, 0xffff0000, v105
    v_lshlrev_b32 v84, 16, v106
    v_and_b32 v85, 0xffff0000, v106
    v_lshlrev_b32 v86, 16, v107
    v_and_b32 v87, 0xffff0000, v107
    v_lshlrev_b32 v88, 16, v108
    v_and_b32 v89, 0xffff0000, v108
    v_lshlrev_b32 v90, 16, v109
    v_and_b32 v91, 0xffff0000, v109
    v_lshlrev_b32 v92, 16, v110
    v_and_b32 v93, 0xffff0000, v110
    v_lshlrev_b32 v94, 16, v111
    v_and_b32 v95, 0xffff0000, v111
    v_pk_add_f32 v[64:65], v[64:65], v[80:81]
    v_pk_add_f32 v[66:67], v[66:67], v[82:83]
    v_pk_add_f32 v[68:69], v[68:69], v[84:85]
    v_pk_add_f32 v[70:71], v[70:71], v[86:87]
    v_pk_add_f32 v[72:73], v[72:73], v[88:89]
    v_pk_add_f32 v[74:75], v[74:75], v[90:91]
    v_pk_add_f32 v[76:77], v[76:77], v[92:93]
    v_pk_add_f32 v[78:79], v[78:79], v[94:95]
    s_waitcnt vmcnt(2)
    v_lshlrev_b32 v80, 16, v112
    v_and_b32 v81, 0xffff0000, v112
    v_lshlrev_b32 v82, 16, v113
    v_and_b32 v83, 0xffff0000, v113
    v_lshlrev_b32 v84, 16, v114
    v_and_b32 v85, 0xffff0000, v114
    v_lshlrev_b32 v86, 16, v115
    v_and_b32 v87, 0xffff0000, v115
    v_lshlrev_b32 v88, 16, v116
    v_and_b32 v89, 0xffff0000, v116
    v_lshlrev_b32 v90, 16, v117
    v_and_b32 v91, 0xffff0000, v117
    v_lshlrev_b32 v92, 16, v118
    v_and_b32 v93, 0xffff0000, v118
    v_lshlrev_b32 v94, 16, v119
    v_and_b32 v95, 0xffff0000, v119
    v_pk_add_f32 v[64:65], v[64:65], v[80:81]
    v_pk_add_f32 v[66:67], v[66:67], v[82:83]
    v_pk_add_f32 v[68:69], v[68:69], v[84:85]
    v_pk_add_f32 v[70:71], v[70:71], v[86:87]
    v_pk_add_f32 v[72:73], v[72:73], v[88:89]
    v_pk_add_f32 v[74:75], v[74:75], v[90:91]
    v_pk_add_f32 v[76:77], v[76:77], v[92:93]
    v_pk_add_f32 v[78:79], v[78:79], v[94:95]
    s_waitcnt vmcnt(0)
    v_lshlrev_b32 v80, 16, v120
    v_and_b32 v81, 0xffff0000, v120
    v_lshlrev_b32 v82, 16, v121
    v_and_b32 v83, 0xffff0000, v121
    v_lshlrev_b32 v84, 16, v122
    v_and_b32 v85, 0xffff0000, v122
    v_lshlrev_b32 v86, 16, v123
    v_and_b32 v87, 0xffff0000, v123
    v_lshlrev_b32 v88, 16, v124
    v_and_b32 v89, 0xffff0000, v124
    v_lshlrev_b32 v90, 16, v125
    v_and_b32 v91, 0xffff0000, v125
    v_lshlrev_b32 v92, 16, v126
    v_and_b32 v93, 0xffff0000, v126
    v_lshlrev_b32 v94, 16, v127
    v_and_b32 v95, 0xffff0000, v127
    v_pk_add_f32 v[64:65], v[64:65], v[80:81]
    v_pk_add_f32 v[66:67], v[66:67], v[82:83]
    v_pk_add_f32 v[68:69], v[68:69], v[84:85]
    v_pk_add_f32 v[70:71], v[70:71], v[86:87]
    v_pk_add_f32 v[72:73], v[72:73], v[88:89]
    v_pk_add_f32 v[74:75], v[74:75], v[90:91]
    v_pk_add_f32 v[76:77], v[76:77], v[92:93]
    v_pk_add_f32 v[78:79], v[78:79], v[94:95]
    ds_write_b32 v6, v64 offset:0
    ds_write_b32 v6, v65 offset:4096
    ds_write_b32 v6, v66 offset:8192
    ds_write_b32 v6, v67 offset:12288
    ds_write_b32 v6, v68 offset:16384
    ds_write_b32 v6, v69 offset:20480
    ds_write_b32 v6, v70 offset:24576
    ds_write_b32 v6, v71 offset:28672
    ds_write_b32 v6, v72 offset:256
    ds_write_b32 v6, v73 offset:4352
    ds_write_b32 v6, v74 offset:8448
    ds_write_b32 v6, v75 offset:12544
    ds_write_b32 v6, v76 offset:16640
    ds_write_b32 v6, v77 offset:20736
    ds_write_b32 v6, v78 offset:24832
    ds_write_b32 v6, v79 offset:28928
    s_waitcnt lgkmcnt(0)
    s_barrier
    ds_read_b128 v[64:67], v7
    ds_read_b128 v[68:71], v7 offset:16
    ds_read_b128 v[72:75], v7 offset:2048
    ds_read_b128 v[76:79], v7 offset:2064
    s_waitcnt vmcnt(0)
    v_accvgpr_read_b32 v96, a0
    v_accvgpr_read_b32 v97, a1
    v_accvgpr_read_b32 v98, a2
    v_accvgpr_read_b32 v99, a3
    v_accvgpr_read_b32 v100, a4
    v_accvgpr_read_b32 v101, a5
    v_accvgpr_read_b32 v102, a6
    v_accvgpr_read_b32 v103, a7
    v_lshlrev_b32 v80, 16, v96
    v_and_b32 v81, 0xffff0000, v96
    v_lshlrev_b32 v82, 16, v97
    v_and_b32 v83, 0xffff0000, v97
    v_lshlrev_b32 v84, 16, v98
    v_and_b32 v85, 0xffff0000, v98
    v_lshlrev_b32 v86, 16, v99
    v_and_b32 v87, 0xffff0000, v99
    v_lshlrev_b32 v88, 16, v100
    v_and_b32 v89, 0xffff0000, v100
    v_lshlrev_b32 v90, 16, v101
    v_and_b32 v91, 0xffff0000, v101
    v_lshlrev_b32 v92, 16, v102
    v_and_b32 v93, 0xffff0000, v102
    v_lshlrev_b32 v94, 16, v103
    v_and_b32 v95, 0xffff0000, v103
    s_waitcnt lgkmcnt(0)
    v_cvt_pk_bf16_f32 v64, 0, v64
    v_cvt_pk_bf16_f32 v65, 0, v65
    v_cvt_pk_bf16_f32 v66, 0, v66
    v_cvt_pk_bf16_f32 v67, 0, v67
    v_cvt_pk_bf16_f32 v68, 0, v68
    v_cvt_pk_bf16_f32 v69, 0, v69
    v_cvt_pk_bf16_f32 v70, 0, v70
    v_cvt_pk_bf16_f32 v71, 0, v71
    v_cvt_pk_bf16_f32 v72, 0, v72
    v_cvt_pk_bf16_f32 v73, 0, v73
    v_cvt_pk_bf16_f32 v74, 0, v74
    v_cvt_pk_bf16_f32 v75, 0, v75
    v_cvt_pk_bf16_f32 v76, 0, v76
    v_cvt_pk_bf16_f32 v77, 0, v77
    v_cvt_pk_bf16_f32 v78, 0, v78
    v_cvt_pk_bf16_f32 v79, 0, v79
    v_pk_mul_f32 v[64:65], v[64:65], v[16:17]
    v_pk_mul_f32 v[66:67], v[66:67], v[18:19]
    v_pk_mul_f32 v[68:69], v[68:69], v[20:21]
    v_pk_mul_f32 v[70:71], v[70:71], v[22:23]
    v_pk_mul_f32 v[72:73], v[72:73], v[24:25]
    v_pk_mul_f32 v[74:75], v[74:75], v[26:27]
    v_pk_mul_f32 v[76:77], v[76:77], v[28:29]
    v_pk_mul_f32 v[78:79], v[78:79], v[30:31]
    v_cvt_pk_bf16_f32 v64, 0, v64
    v_cvt_pk_bf16_f32 v65, 0, v65
    v_cvt_pk_bf16_f32 v66, 0, v66
    v_cvt_pk_bf16_f32 v67, 0, v67
    v_cvt_pk_bf16_f32 v68, 0, v68
    v_cvt_pk_bf16_f32 v69, 0, v69
    v_cvt_pk_bf16_f32 v70, 0, v70
    v_cvt_pk_bf16_f32 v71, 0, v71
    v_cvt_pk_bf16_f32 v72, 0, v72
    v_cvt_pk_bf16_f32 v73, 0, v73
    v_cvt_pk_bf16_f32 v74, 0, v74
    v_cvt_pk_bf16_f32 v75, 0, v75
    v_cvt_pk_bf16_f32 v76, 0, v76
    v_cvt_pk_bf16_f32 v77, 0, v77
    v_cvt_pk_bf16_f32 v78, 0, v78
    v_cvt_pk_bf16_f32 v79, 0, v79
    v_pk_add_f32 v[64:65], v[64:65], v[80:81]
    v_pk_add_f32 v[66:67], v[66:67], v[82:83]
    v_pk_add_f32 v[68:69], v[68:69], v[84:85]
    v_pk_add_f32 v[70:71], v[70:71], v[86:87]
    v_pk_add_f32 v[72:73], v[72:73], v[88:89]
    v_pk_add_f32 v[74:75], v[74:75], v[90:91]
    v_pk_add_f32 v[76:77], v[76:77], v[92:93]
    v_pk_add_f32 v[78:79], v[78:79], v[94:95]
    v_cvt_pk_bf16_f32 v96, v64, v65
    v_cvt_pk_bf16_f32 v97, v66, v67
    v_cvt_pk_bf16_f32 v98, v68, v69
    v_cvt_pk_bf16_f32 v99, v70, v71
    v_cvt_pk_bf16_f32 v100, v72, v73
    v_cvt_pk_bf16_f32 v101, v74, v75
    v_cvt_pk_bf16_f32 v102, v76, v77
    v_cvt_pk_bf16_f32 v103, v78, v79
    buffer_store_dwordx4 v[96:99], v9, s[12:15], s63 offen sc1
    buffer_store_dwordx4 v[100:103], v9, s[12:15], s63 offen offset:1024 sc1
    v_lshlrev_b32 v64, 16, v96
    v_and_b32 v65, 0xffff0000, v96
    v_lshlrev_b32 v66, 16, v97
    v_and_b32 v67, 0xffff0000, v97
    v_lshlrev_b32 v68, 16, v98
    v_and_b32 v69, 0xffff0000, v98
    v_lshlrev_b32 v70, 16, v99
    v_and_b32 v71, 0xffff0000, v99
    v_lshlrev_b32 v72, 16, v100
    v_and_b32 v73, 0xffff0000, v100
    v_lshlrev_b32 v74, 16, v101
    v_and_b32 v75, 0xffff0000, v101
    v_lshlrev_b32 v76, 16, v102
    v_and_b32 v77, 0xffff0000, v102
    v_lshlrev_b32 v78, 16, v103
    v_and_b32 v79, 0xffff0000, v103
    v_pk_add_f32 v[80:81], v[64:65], v[72:73]
    v_pk_add_f32 v[82:83], v[66:67], v[74:75]
    v_pk_add_f32 v[84:85], v[68:69], v[76:77]
    v_pk_add_f32 v[86:87], v[70:71], v[78:79]
    v_pk_add_f32 v[80:81], v[80:81], v[84:85]
    v_pk_add_f32 v[82:83], v[82:83], v[86:87]
    v_pk_add_f32 v[80:81], v[80:81], v[82:83]
    v_add_f32 v14, v80, v81
    s_nop 1
    v_add_f32_dpp v14, v14, v14 row_shr:1 row_mask:0xf bank_mask:0xf bound_ctrl:0
    s_nop 1
    v_add_f32_dpp v14, v14, v14 row_shr:2 row_mask:0xf bank_mask:0xf bound_ctrl:0
    s_nop 1
    v_add_f32_dpp v14, v14, v14 row_shr:4 row_mask:0xf bank_mask:0xf bound_ctrl:0
    s_nop 1
    v_add_f32_dpp v14, v14, v14 row_shr:8 row_mask:0xf bank_mask:0xf bound_ctrl:0
    s_nop 1
    v_add_f32_dpp v14, v14, v14 row_bcast:15 row_mask:0xa bank_mask:0xf
    s_nop 1
    v_add_f32_dpp v14, v14, v14 row_bcast:31 row_mask:0xc bank_mask:0xf
    s_nop 1
    v_readlane_b32 s46, v14, 63
    s_nop 1
    v_mov_b32 v15, s46
    v_mul_f32 v15, 0x3a800000, v15
    v_pk_add_f32 v[80:81], v[64:65], v[14:15] op_sel:[0,1] op_sel_hi:[1,1] neg_lo:[0,1] neg_hi:[0,1]
    v_pk_add_f32 v[82:83], v[66:67], v[14:15] op_sel:[0,1] op_sel_hi:[1,1] neg_lo:[0,1] neg_hi:[0,1]
    v_pk_add_f32 v[84:85], v[68:69], v[14:15] op_sel:[0,1] op_sel_hi:[1,1] neg_lo:[0,1] neg_hi:[0,1]
    v_pk_add_f32 v[86:87], v[70:71], v[14:15] op_sel:[0,1] op_sel_hi:[1,1] neg_lo:[0,1] neg_hi:[0,1]
    v_pk_add_f32 v[88:89], v[72:73], v[14:15] op_sel:[0,1] op_sel_hi:[1,1] neg_lo:[0,1] neg_hi:[0,1]
    v_pk_add_f32 v[90:91], v[74:75], v[14:15] op_sel:[0,1] op_sel_hi:[1,1] neg_lo:[0,1] neg_hi:[0,1]
    v_pk_add_f32 v[92:93], v[76:77], v[14:15] op_sel:[0,1] op_sel_hi:[1,1] neg_lo:[0,1] neg_hi:[0,1]
    v_pk_add_f32 v[94:95], v[78:79], v[14:15] op_sel:[0,1] op_sel_hi:[1,1] neg_lo:[0,1] neg_hi:[0,1]
    v_pk_mul_f32 v[104:105], v[80:81], v[80:81]
    v_pk_mul_f32 v[106:107], v[82:83], v[82:83]
    v_pk_fma_f32 v[104:105], v[84:85], v[84:85], v[104:105]
    v_pk_fma_f32 v[106:107], v[86:87], v[86:87], v[106:107]
    v_pk_fma_f32 v[104:105], v[88:89], v[88:89], v[104:105]
    v_pk_fma_f32 v[106:107], v[90:91], v[90:91], v[106:107]
    v_pk_fma_f32 v[104:105], v[92:93], v[92:93], v[104:105]
    v_pk_fma_f32 v[106:107], v[94:95], v[94:95], v[106:107]
    v_pk_add_f32 v[104:105], v[104:105], v[106:107]
    v_add_f32 v14, v104, v105
    v_cvt_pk_bf16_f32 v15, 0, v15
    s_nop 1
    v_add_f32_dpp v14, v14, v14 row_shr:1 row_mask:0xf bank_mask:0xf bound_ctrl:0
    s_nop 1
    v_add_f32_dpp v14, v14, v14 row_shr:2 row_mask:0xf bank_mask:0xf bound_ctrl:0
    s_nop 1
    v_add_f32_dpp v14, v14, v14 row_shr:4 row_mask:0xf bank_mask:0xf bound_ctrl:0
    s_nop 1
    v_add_f32_dpp v14, v14, v14 row_shr:8 row_mask:0xf bank_mask:0xf bound_ctrl:0
    s_nop 1
    v_add_f32_dpp v14, v14, v14 row_bcast:15 row_mask:0xa bank_mask:0xf
    s_nop 1
    v_add_f32_dpp v14, v14, v14 row_bcast:31 row_mask:0xc bank_mask:0xf
    s_nop 1
    v_readlane_b32 s47, v14, 63
    v_pk_add_f32 v[64:65], v[64:65], v[14:15] op_sel:[0,1] op_sel_hi:[1,1] neg_lo:[0,1] neg_hi:[0,1]
    v_pk_add_f32 v[66:67], v[66:67], v[14:15] op_sel:[0,1] op_sel_hi:[1,1] neg_lo:[0,1] neg_hi:[0,1]
    v_pk_add_f32 v[68:69], v[68:69], v[14:15] op_sel:[0,1] op_sel_hi:[1,1] neg_lo:[0,1] neg_hi:[0,1]
    v_pk_add_f32 v[70:71], v[70:71], v[14:15] op_sel:[0,1] op_sel_hi:[1,1] neg_lo:[0,1] neg_hi:[0,1]
    v_pk_add_f32 v[72:73], v[72:73], v[14:15] op_sel:[0,1] op_sel_hi:[1,1] neg_lo:[0,1] neg_hi:[0,1]
    v_pk_add_f32 v[74:75], v[74:75], v[14:15] op_sel:[0,1] op_sel_hi:[1,1] neg_lo:[0,1] neg_hi:[0,1]
    v_pk_add_f32 v[76:77], v[76:77], v[14:15] op_sel:[0,1] op_sel_hi:[1,1] neg_lo:[0,1] neg_hi:[0,1]
    v_pk_add_f32 v[78:79], v[78:79], v[14:15] op_sel:[0,1] op_sel_hi:[1,1] neg_lo:[0,1] neg_hi:[0,1]
    v_mov_b32 v14, s47
    v_mul_f32 v14, 0x3a800000, v14
    v_cvt_pk_bf16_f32 v14, 0, v14
    v_add_f32 v14, 0x3727c5ac, v14
    v_cvt_pk_bf16_f32 v14, 0, v14
    v_sqrt_f32 v14, v14
    s_nop 0
    v_cvt_pk_bf16_f32 v14, 0, v14
    v_rcp_f32 v14, v14
    v_cvt_pk_bf16_f32 v64, 0, v64
    v_cvt_pk_bf16_f32 v65, 0, v65
    v_cvt_pk_bf16_f32 v66, 0, v66
    v_cvt_pk_bf16_f32 v67, 0, v67
    v_cvt_pk_bf16_f32 v68, 0, v68
    v_cvt_pk_bf16_f32 v69, 0, v69
    v_cvt_pk_bf16_f32 v70, 0, v70
    v_cvt_pk_bf16_f32 v71, 0, v71
    v_cvt_pk_bf16_f32 v72, 0, v72
    v_cvt_pk_bf16_f32 v73, 0, v73
    v_cvt_pk_bf16_f32 v74, 0, v74
    v_cvt_pk_bf16_f32 v75, 0, v75
    v_cvt_pk_bf16_f32 v76, 0, v76
    v_cvt_pk_bf16_f32 v77, 0, v77
    v_cvt_pk_bf16_f32 v78, 0, v78
    v_cvt_pk_bf16_f32 v79, 0, v79
    v_pk_mul_f32 v[64:65], v[64:65], v[14:15] op_sel_hi:[1,0]
    v_pk_mul_f32 v[66:67], v[66:67], v[14:15] op_sel_hi:[1,0]
    v_pk_mul_f32 v[68:69], v[68:69], v[14:15] op_sel_hi:[1,0]
    v_pk_mul_f32 v[70:71], v[70:71], v[14:15] op_sel_hi:[1,0]
    v_pk_mul_f32 v[72:73], v[72:73], v[14:15] op_sel_hi:[1,0]
    v_pk_mul_f32 v[74:75], v[74:75], v[14:15] op_sel_hi:[1,0]
    v_pk_mul_f32 v[76:77], v[76:77], v[14:15] op_sel_hi:[1,0]
    v_pk_mul_f32 v[78:79], v[78:79], v[14:15] op_sel_hi:[1,0]
    v_cvt_pk_bf16_f32 v64, 0, v64
    v_cvt_pk_bf16_f32 v65, 0, v65
    v_cvt_pk_bf16_f32 v66, 0, v66
    v_cvt_pk_bf16_f32 v67, 0, v67
    v_cvt_pk_bf16_f32 v68, 0, v68
    v_cvt_pk_bf16_f32 v69, 0, v69
    v_cvt_pk_bf16_f32 v70, 0, v70
    v_cvt_pk_bf16_f32 v71, 0, v71
    v_cvt_pk_bf16_f32 v72, 0, v72
    v_cvt_pk_bf16_f32 v73, 0, v73
    v_cvt_pk_bf16_f32 v74, 0, v74
    v_cvt_pk_bf16_f32 v75, 0, v75
    v_cvt_pk_bf16_f32 v76, 0, v76
    v_cvt_pk_bf16_f32 v77, 0, v77
    v_cvt_pk_bf16_f32 v78, 0, v78
    v_cvt_pk_bf16_f32 v79, 0, v79
    v_pk_mul_f32 v[64:65], v[64:65], v[32:33]
    v_pk_mul_f32 v[66:67], v[66:67], v[34:35]
    v_pk_mul_f32 v[68:69], v[68:69], v[36:37]
    v_pk_mul_f32 v[70:71], v[70:71], v[38:39]
    v_pk_mul_f32 v[72:73], v[72:73], v[40:41]
    v_pk_mul_f32 v[74:75], v[74:75], v[42:43]
    v_pk_mul_f32 v[76:77], v[76:77], v[44:45]
    v_pk_mul_f32 v[78:79], v[78:79], v[46:47]
    v_cvt_pk_bf16_f32 v64, 0, v64
    v_cvt_pk_bf16_f32 v65, 0, v65
    v_cvt_pk_bf16_f32 v66, 0, v66
    v_cvt_pk_bf16_f32 v67, 0, v67
    v_cvt_pk_bf16_f32 v68, 0, v68
    v_cvt_pk_bf16_f32 v69, 0, v69
    v_cvt_pk_bf16_f32 v70, 0, v70
    v_cvt_pk_bf16_f32 v71, 0, v71
    v_cvt_pk_bf16_f32 v72, 0, v72
    v_cvt_pk_bf16_f32 v73, 0, v73
    v_cvt_pk_bf16_f32 v74, 0, v74
    v_cvt_pk_bf16_f32 v75, 0, v75
    v_cvt_pk_bf16_f32 v76, 0, v76
    v_cvt_pk_bf16_f32 v77, 0, v77
    v_cvt_pk_bf16_f32 v78, 0, v78
    v_cvt_pk_bf16_f32 v79, 0, v79
    v_pk_add_f32 v[64:65], v[64:65], v[48:49]
    v_pk_add_f32 v[66:67], v[66:67], v[50:51]
    v_pk_add_f32 v[68:69], v[68:69], v[52:53]
    v_pk_add_f32 v[70:71], v[70:71], v[54:55]
    v_pk_add_f32 v[72:73], v[72:73], v[56:57]
    v_pk_add_f32 v[74:75], v[74:75], v[58:59]
    v_pk_add_f32 v[76:77], v[76:77], v[60:61]
    v_pk_add_f32 v[78:79], v[78:79], v[62:63]
    v_cvt_pk_bf16_f32 v104, v64, v65
    v_cvt_pk_bf16_f32 v105, v66, v67
    v_cvt_pk_bf16_f32 v106, v68, v69
    v_cvt_pk_bf16_f32 v107, v70, v71
    v_cvt_pk_bf16_f32 v108, v72, v73
    v_cvt_pk_bf16_f32 v109, v74, v75
    v_cvt_pk_bf16_f32 v110, v76, v77
    v_cvt_pk_bf16_f32 v111, v78, v79
    ds_write_b128 v10, v[104:107]
    ds_write_b128 v10, v[108:111] offset:1024
    s_waitcnt lgkmcnt(0)
    s_barrier
    ds_read_b128 v[104:107], v13
    ds_read_b128 v[108:111], v13 offset:128
    s_waitcnt lgkmcnt(1)
    buffer_store_dwordx4 v[104:107], v11, s[12:15], s63 offen sc1
    s_waitcnt lgkmcnt(0)
    buffer_store_dwordx4 v[108:111], v12, s[12:15], s63 offen sc1
    s_waitcnt vmcnt(0)
    s_barrier
    s_cmp_lg_u32 s44, 0
    s_cbranch_scc1 L_sf_39
    v_mov_b32 v14, s60
    v_add_u32 v14, 1, v14
    v_mov_b32 v15, 0
    s_mov_b64 exec, 1
    buffer_store_dword v14, v15, s[12:15], s52 offen sc1
    s_mov_b64 exec, -1
L_sf_39:
    s_add_u32 s60, s60, 3
    s_cmp_lt_u32 s60, 64
    s_cbranch_scc1 L_r_loop_35
    s_branch L_c_done_1
L_w_att_13:
    s_lshl_b32 s42, s40, 2
    s_and_b32 s46, s44, 3
    s_add_u32 s42, s42, s46
    s_and_b32 s43, s48, 1
    s_lshl_b32 s43, s43, 1
    s_lshr_b32 s46, s44, 2
    s_add_u32 s43, s43, s46
    s_mul_i32 s46, s42, 24576
    s_add_u32 s46, s46, 0x2000000
    v_lshlrev_b32 v2, 4, v1
    v_add_u32 v3, s46, v2
    v_add_u32 v5, 4096, v3
    v_lshrrev_b32 v4, 4, v1
    v_and_b32 v9, 15, v1
    s_lshl_b32 s46, s42, 12
    s_add_u32 s46, s46, 0x1000000
    v_and_b32 v6, 7, v1
    v_lshlrev_b32 v6, 4, v6
    v_lshl_add_u32 v6, v4, 7, v6
    v_add_u32 v6, s46, v6
    v_and_b32 v7, 31, v1
    v_lshlrev_b32 v7, 4, v7
    v_lshrrev_b32 v10, 5, v1
    v_lshl_add_u32 v7, v10, 10, v7
    v_add_u32 v7, s46, v7
    s_mul_i32 s50, s44, 13056
    v_mul_u32_u24 v8, 272, v9
    v_lshl_add_u32 v8, v4, 4, v8
    v_add_u32 v8, s50, v8
    v_bfe_u32 v11, v1, 2, 3
    v_mul_u32_u24 v11, 272, v11
    v_lshl_add_u32 v11, v10, 6, v11
    v_and_b32 v12, 3, v1
    v_lshl_add_u32 v11, v12, 4, v11
    v_add_u32 v11, s50, v11
    v_mul_u32_u24 v14, 272, v4
    v_lshl_add_u32 v14, v9, 4, v14
    v_add_u32 v14, s50, v14
    v_mov_b32 v16, 0
    v_mov_b32 v17, 0
    v_mov_b32 v18, 0
    v_mov_b32 v19, 0
    ds_write_b128 v14, v[16:19] offset:10880
    ds_write_b128 v14, v[16:19] offset:11968
    v_lshlrev_b32 v12, 2, v4
    v_bfe_u32 v13, v1, 2, 2
    v_add_u32 v12, v12, v13
    v_mul_u32_u24 v12, 272, v12
    v_and_b32 v13, 3, v1
    v_lshl_add_u32 v12, v13, 3, v12
    v_add_u32 v12, s50, v12
    v_lshlrev_b32 v13, 10, v13
    s_lshl_b32 s46, s42, 12
    s_add_u32 s46, s46, 0x1000000
    v_add_u32 v13, s46, v13
    v_lshlrev_b32 v10, 9, v4
    v_lshl_add_u32 v10, v9, 4, v10
    s_lshl_b32 s46, s42, 13
    s_add_u32 s46, s46, 0x5000000
    v_add_u32 v10, s46, v10
    s_lshl_b32 s52, s42, 9
    s_lshl_b32 s47, s43, 7
    s_add_u32 s52, s52, s47
    s_add_u32 s52, s52, 0x102000
    v_min_u32 v42, 2, v1
    v_lshlrev_b32 v42, 9, v42
    s_lshl_b32 s46, s40, 11
    s_and_b32 s47, s42, 3
    s_lshl_b32 s47, s47, 7
    s_add_u32 s46, s46, s47
    s_add_u32 s46, s46, 0x10a400
    v_add_u32 v48, s46, v42
    s_mul_i32 s46, s42, 24576
    s_add_u32 s46, s46, 0x2000000
    v_lshlrev_b32 v49, 7, v1
    v_add_u32 v49, s46, v49
    v_cmp_le_u32 s[56:57], 32, v1
    v_lshlrev_b32 v14, 2, v4
    s_mov_b32 s54, 0x3e0293ee
    s_mov_b32 s60, s43
    v_add_u32 v15, 0, v14
    v_cmp_gt_u32 s[84:85], v15, v9
    v_add_u32 v15, 1, v14
    v_cmp_gt_u32 s[86:87], v15, v9
    v_add_u32 v15, 2, v14
    v_cmp_gt_u32 s[88:89], v15, v9
    v_add_u32 v15, 3, v14
    v_cmp_gt_u32 s[90:91], v15, v9
L_a_loop_40:
    s_mul_i32 s45, s60, 786432
    s_add_u32 s48, s45, 8192
    s_add_u32 s49, s45, 16384
    s_lshl_b32 s61, s60, 17
    s_lshl_b32 s63, s60, 18
    s_mov_b32 s70, 0
L_spin_41:
    buffer_load_dword v40, v48, s[12:15], 0 offen sc1
    s_waitcnt vmcnt(0)
    v_cmp_ge_u32 vcc, s60, v40
    s_add_u32 s70, s70, 1
    s_cbranch_vccz L_spok_42
    s_sleep 3
    s_cmp_lt_u32 s70, 524288
    s_cbranch_scc1 L_spin_41
    s_branch L_c_done_1
L_spok_42:
    buffer_load_dwordx4 a[0:3], v3, s[12:15], s45 offen offset:0 sc1
    buffer_load_dwordx4 a[4:7], v3, s[12:15], s45 offen offset:1024 sc1
    buffer_load_dwordx4 a[8:11], v3, s[12:15], s45 offen offset:2048 sc1
    buffer_load_dwordx4 a[12:15], v3, s[12:15], s45 offen offset:3072 sc1
    buffer_load_dwordx4 a[16:19], v5, s[12:15], s45 offen offset:0 sc1
    buffer_load_dwordx4 a[20:23], v5, s[12:15], s45 offen offset:1024 sc1
    buffer_load_dwordx4 a[24:27], v5, s[12:15], s45 offen offset:2048 sc1
    buffer_load_dwordx4 a[28:31], v5, s[12:15], s45 offen offset:3072 sc1
    buffer_load_dwordx4 a[32:35], v3, s[12:15], s48 offen offset:0 sc1
    buffer_load_dwordx4 a[36:39], v3, s[12:15], s48 offen offset:1024 sc1
    buffer_load_dwordx4 a[40:43], v3, s[12:15], s48 offen offset:2048 sc1
    buffer_load_dwordx4 a[44:47], v3, s[12:15], s48 offen offset:3072 sc1
    buffer_load_dwordx4 a[48:51], v5, s[12:15], s48 offen offset:0 sc1
    buffer_load_dwordx4 a[52:55], v5, s[12:15], s48 offen offset:1024 sc1
    buffer_load_dwordx4 a[56:59], v5, s[12:15], s48 offen offset:2048 sc1
    buffer_load_dwordx4 a[60:63], v5, s[12:15], s48 offen offset:3072 sc1
    buffer_load_dwordx4 v[16:19], v3, s[12:15], s49 offen offset:0 sc1
    buffer_load_dwordx4 v[20:23], v3, s[12:15], s49 offen offset:1024 sc1
    buffer_load_dwordx4 v[24:27], v3, s[12:15], s49 offen offset:2048 sc1
    buffer_load_dwordx4 v[28:31], v3, s[12:15], s49 offen offset:3072 sc1
    buffer_load_dwordx4 v[32:35], v5, s[12:15], s49 offen offset:0 sc1
    buffer_load_dwordx4 v[36:39], v5, s[12:15], s49 offen offset:1024 sc1
    buffer_load_dwordx4 v[40:43], v5, s[12:15], s49 offen offset:2048 sc1
    buffer_load_dwordx4 v[44:47], v5, s[12:15], s49 offen offset:3072 sc1
    s_waitcnt vmcnt(0)
    ds_write_b128 v8, v[16:19] offset:0
    ds_write_b128 v8, v[20:23] offset:64
    ds_write_b128 v8, v[24:27] offset:128
    ds_write_b128 v8, v[28:31] offset:192
    ds_write_b128 v8, v[32:35] offset:4352
    ds_write_b128 v8, v[36:39] offset:4416
    ds_write_b128 v8, v[40:43] offset:4480
    ds_write_b128 v8, v[44:47] offset:4544
    v_mfma_f32_16x16x32_bf16 v[56:59], a[32:35], a[0:3], 0
    v_mfma_f32_16x16x32_bf16 v[60:63], a[32:35], a[16:19], 0
    v_mfma_f32_16x16x32_bf16 v[68:71], a[48:51], a[16:19], 0
    v_mfma_f32_16x16x32_bf16 v[56:59], a[36:39], a[4:7], v[56:59]
    v_mfma_f32_16x16x32_bf16 v[60:63], a[36:39], a[20:23], v[60:63]
    v_mfma_f32_16x16x32_bf16 v[68:71], a[52:55], a[20:23], v[68:71]
    v_mfma_f32_16x16x32_bf16 v[56:59], a[40:43], a[8:11], v[56:59]
    v_mfma_f32_16x16x32_bf16 v[60:63], a[40:43], a[24:27], v[60:63]
    v_mfma_f32_16x16x32_bf16 v[68:71], a[56:59], a[24:27], v[68:71]
    v_mfma_f32_16x16x32_bf16 v[56:59], a[44:47], a[12:15], v[56:59]
    v_mfma_f32_16x16x32_bf16 v[60:63], a[44:47], a[28:31], v[60:63]
    v_mfma_f32_16x16x32_bf16 v[68:71], a[60:63], a[28:31], v[68:71]
    s_waitcnt lgkmcnt(0)
    ds_read_b64_tr_b16 a[80:81], v12 offset:0
    ds_read_b64_tr_b16 a[82:83], v12 offset:4352
    ds_read_b64_tr_b16 a[86:87], v12 offset:32
    ds_read_b64_tr_b16 a[88:89], v12 offset:4384
    ds_read_b64_tr_b16 a[92:93], v12 offset:64
    ds_read_b64_tr_b16 a[94:95], v12 offset:4416
    ds_read_b64_tr_b16 a[98:99], v12 offset:96
    ds_read_b64_tr_b16 a[100:101], v12 offset:4448
    s_waitcnt lgkmcnt(0)
    ds_read_b64_tr_b16 a[104:105], v12 offset:128
    ds_read_b64_tr_b16 a[106:107], v12 offset:4480
    ds_read_b64_tr_b16 a[110:111], v12 offset:160
    ds_read_b64_tr_b16 a[112:113], v12 offset:4512
    ds_read_b64_tr_b16 a[116:117], v12 offset:192
    ds_read_b64_tr_b16 a[118:119], v12 offset:4544
    ds_read_b64_tr_b16 a[122:123], v12 offset:224
    ds_read_b64_tr_b16 a[124:125], v12 offset:4576
    v_mov_b32 v15, 0xff800000
    v_cndmask_b32 v56, v56, v15, s[84:85]
    v_cndmask_b32 v68, v68, v15, s[84:85]
    v_cndmask_b32 v57, v57, v15, s[86:87]
    v_cndmask_b32 v69, v69, v15, s[86:87]
    v_cndmask_b32 v58, v58, v15, s[88:89]
    v_cndmask_b32 v70, v70, v15, s[88:89]
    v_cndmask_b32 v59, v59, v15, s[90:91]
    v_cndmask_b32 v71, v71, v15, s[90:91]
    s_mov_b32 s70, 0
L_a_cp_43:
    buffer_load_dword v40, v13, s[12:15], s61 offen sc1
    s_waitcnt vmcnt(0)
    v_cmp_eq_u32 vcc, -1, v40
    s_add_u32 s70, s70, 1
    s_cbranch_vccz L_a_fl_44
L_a_cp_43_s:
    s_sleep 4
    s_cmp_lt_u32 s70, 524288
    s_cbranch_scc1 L_a_cp_43
    s_branch L_c_done_1
L_a_fl_44:
    buffer_load_dwordx4 v[24:27], v6, s[12:15], s61 offen offset:0 sc1
    buffer_load_dwordx4 v[28:31], v6, s[12:15], s61 offen offset:1024 sc1
    buffer_load_dwordx4 v[32:35], v6, s[12:15], s61 offen offset:2048 sc1
    buffer_load_dwordx4 v[36:39], v6, s[12:15], s61 offen offset:3072 sc1
    buffer_load_dwordx4 v[16:19], v7, s[12:15], s61 offen offset:512 sc1
    buffer_load_dwordx4 v[20:23], v7, s[12:15], s61 offen offset:2560 sc1
    s_waitcnt vmcnt(0)
    v_max_u32 v40, v16, v17
    v_max3_u32 v40, v40, v18, v19
    v_max3_u32 v40, v40, v20, v21
    v_max3_u32 v40, v40, v22, v23
    v_max3_u32 v40, v40, v24, v25
    v_max3_u32 v40, v40, v26, v27
    v_max3_u32 v40, v40, v28, v29
    v_max3_u32 v40, v40, v30, v31
    v_max3_u32 v40, v40, v32, v33
    v_max3_u32 v40, v40, v34, v35
    v_max3_u32 v40, v40, v36, v37
    v_max3_u32 v40, v40, v38, v39
    v_cmp_eq_u32 vcc, -1, v40
    s_nop 0
    s_cbranch_vccnz L_a_cp_43_s
    v_mfma_f32_16x16x32_bf16 v[72:75], v[24:27], a[0:3], 0
    v_mfma_f32_16x16x32_bf16 v[76:79], v[24:27], a[16:19], 0
    v_mfma_f32_16x16x32_bf16 v[72:75], v[28:31], a[4:7], v[72:75]
    v_mfma_f32_16x16x32_bf16 v[76:79], v[28:31], a[20:23], v[76:79]
    v_mfma_f32_16x16x32_bf16 v[72:75], v[32:35], a[8:11], v[72:75]
    v_mfma_f32_16x16x32_bf16 v[76:79], v[32:35], a[24:27], v[76:79]
    v_mfma_f32_16x16x32_bf16 v[72:75], v[36:39], a[12:15], v[72:75]
    v_mfma_f32_16x16x32_bf16 v[76:79], v[36:39], a[28:31], v[76:79]
    ds_write_b128 v11, v[16:19] offset:8704
    ds_write_b128 v11, v[20:23] offset:8832
    s_waitcnt lgkmcnt(0)
    ds_read_b64_tr_b16 a[84:85], v12 offset:8704
    ds_read_b64_tr_b16 a[90:91], v12 offset:8736
    ds_read_b64_tr_b16 a[96:97], v12 offset:8768
    ds_read_b64_tr_b16 a[102:103], v12 offset:8800
    ds_read_b64_tr_b16 a[108:109], v12 offset:8832
    ds_read_b64_tr_b16 a[114:115], v12 offset:8864
    ds_read_b64_tr_b16 a[120:121], v12 offset:8896
    ds_read_b64_tr_b16 a[126:127], v12 offset:8928
    v_cndmask_b32 v72, v72, v15, s[56:57]
    v_cndmask_b32 v73, v73, v15, s[56:57]
    v_cndmask_b32 v74, v74, v15, s[56:57]
    v_cndmask_b32 v75, v75, v15, s[56:57]
    v_cndmask_b32 v76, v76, v15, s[56:57]
    v_cndmask_b32 v77, v77, v15, s[56:57]
    v_cndmask_b32 v78, v78, v15, s[56:57]
    v_cndmask_b32 v79, v79, v15, s[56:57]
    v_max_f32 v40, v56, v57
    v_max3_f32 v40, v40, v58, v59
    v_max3_f32 v40, v40, v72, v73
    v_max3_f32 v40, v40, v74, v75
    v_mov_b32 v41, v40
    s_nop 1
    v_permlane16_swap_b32 v40, v41
    v_max_f32 v40, v40, v41
    v_mov_b32 v41, v40
    s_nop 1
    v_permlane32_swap_b32 v40, v41
    v_max_f32 v40, v40, v41
    v_mul_f32 v40, s54, v40
    v_fma_f32 v56, v56, s54, -v40
    v_fma_f32 v57, v57, s54, -v40
    v_fma_f32 v58, v58, s54, -v40
    v_fma_f32 v59, v59, s54, -v40
    v_fma_f32 v72, v72, s54, -v40
    v_fma_f32 v73, v73, s54, -v40
    v_fma_f32 v74, v74, s54, -v40
    v_fma_f32 v75, v75, s54, -v40
    v_exp_f32 v56, v56
    v_exp_f32 v57, v57
    v_exp_f32 v58, v58
    v_exp_f32 v59, v59
    v_exp_f32 v72, v72
    v_exp_f32 v73, v73
    v_exp_f32 v74, v74
    v_exp_f32 v75, v75
    v_add_f32 v40, v56, v57
    v_add_f32 v40, v40, v58
    v_add_f32 v40, v40, v59
    v_add_f32 v40, v40, v72
    v_add_f32 v40, v40, v73
    v_add_f32 v40, v40, v74
    v_add_f32 v40, v40, v75
    v_mov_b32 v41, v40
    s_nop 1
    v_permlane16_swap_b32 v40, v41
    v_add_f32 v40, v40, v41
    v_mov_b32 v41, v40
    s_nop 1
    v_permlane32_swap_b32 v40, v41
    v_add_f32 v40, v40, v41
    v_rcp_f32 v40, v40
    s_nop 0
    v_mul_f32 v56, v56, v40
    v_mul_f32 v57, v57, v40
    v_mul_f32 v58, v58, v40
    v_mul_f32 v59, v59, v40
    v_mul_f32 v72, v72, v40
    v_mul_f32 v73, v73, v40
    v_mul_f32 v74, v74, v40
    v_mul_f32 v75, v75, v40
    v_cvt_pk_bf16_f32 v24, v56, v57
    v_cvt_pk_bf16_f32 v25, v58, v59
    v_cvt_pk_bf16_f32 v28, v72, v73
    v_cvt_pk_bf16_f32 v29, v74, v75
    v_max_f32 v40, v60, v61
    v_max3_f32 v40, v40, v62, v63
    v_max3_f32 v40, v40, v68, v69
    v_max3_f32 v40, v40, v70, v71
    v_max3_f32 v40, v40, v76, v77
    v_max3_f32 v40, v40, v78, v79
    v_mov_b32 v41, v40
    s_nop 1
    v_permlane16_swap_b32 v40, v41
    v_max_f32 v40, v40, v41
    v_mov_b32 v41, v40
    s_nop 1
    v_permlane32_swap_b32 v40, v41
    v_max_f32 v40, v40, v41
    v_mul_f32 v40, s54, v40
    v_fma_f32 v60, v60, s54, -v40
    v_fma_f32 v61, v61, s54, -v40
    v_fma_f32 v62, v62, s54, -v40
    v_fma_f32 v63, v63, s54, -v40
    v_fma_f32 v68, v68, s54, -v40
    v_fma_f32 v69, v69, s54, -v40
    v_fma_f32 v70, v70, s54, -v40
    v_fma_f32 v71, v71, s54, -v40
    v_fma_f32 v76, v76, s54, -v40
    v_fma_f32 v77, v77, s54, -v40
    v_fma_f32 v78, v78, s54, -v40
    v_fma_f32 v79, v79, s54, -v40
    v_exp_f32 v60, v60
    v_exp_f32 v61, v61
    v_exp_f32 v62, v62
    v_exp_f32 v63, v63
    v_exp_f32 v68, v68
    v_exp_f32 v69, v69
    v_exp_f32 v70, v70
    v_exp_f32 v71, v71
    v_exp_f32 v76, v76
    v_exp_f32 v77, v77
    v_exp_f32 v78, v78
    v_exp_f32 v79, v79
    v_add_f32 v40, v60, v61
    v_add_f32 v40, v40, v62
    v_add_f32 v40, v40, v63
    v_add_f32 v40, v40, v68
    v_add_f32 v40, v40, v69
    v_add_f32 v40, v40, v70
    v_add_f32 v40, v40, v71
    v_add_f32 v40, v40, v76
    v_add_f32 v40, v40, v77
    v_add_f32 v40, v40, v78
    v_add_f32 v40, v40, v79
    v_mov_b32 v41, v40
    s_nop 1
    v_permlane16_swap_b32 v40, v41
    v_add_f32 v40, v40, v41
    v_mov_b32 v41, v40
    s_nop 1
    v_permlane32_swap_b32 v40, v41
    v_add_f32 v40, v40, v41
    v_rcp_f32 v40, v40
    s_nop 0
    v_mul_f32 v60, v60, v40
    v_mul_f32 v61, v61, v40
    v_mul_f32 v62, v62, v40
    v_mul_f32 v63, v63, v40
    v_mul_f32 v68, v68, v40
    v_mul_f32 v69, v69, v40
    v_mul_f32 v70, v70, v40
    v_mul_f32 v71, v71, v40
    v_mul_f32 v76, v76, v40
    v_mul_f32 v77, v77, v40
    v_mul_f32 v78, v78, v40
    v_mul_f32 v79, v79, v40
    v_cvt_pk_bf16_f32 v30, v60, v61
    v_cvt_pk_bf16_f32 v31, v62, v63
    v_cvt_pk_bf16_f32 v32, v68, v69
    v_cvt_pk_bf16_f32 v33, v70, v71
    v_cvt_pk_bf16_f32 v34, v76, v77
    v_cvt_pk_bf16_f32 v35, v78, v79
    s_waitcnt lgkmcnt(0)
    s_nop 0
    v_mfma_f32_16x16x16_bf16 v[64:67], a[80:81], v[24:25], 0
    v_mfma_f32_16x16x16_bf16 v[68:71], a[86:87], v[24:25], 0
    v_mfma_f32_16x16x16_bf16 v[72:75], a[92:93], v[24:25], 0
    v_mfma_f32_16x16x16_bf16 v[76:79], a[98:99], v[24:25], 0
    v_mfma_f32_16x16x16_bf16 v[80:83], a[104:105], v[24:25], 0
    v_mfma_f32_16x16x16_bf16 v[84:87], a[110:111], v[24:25], 0
    v_mfma_f32_16x16x16_bf16 v[88:91], a[116:117], v[24:25], 0
    v_mfma_f32_16x16x16_bf16 v[92:95], a[122:123], v[24:25], 0
    v_mfma_f32_16x16x16_bf16 v[64:67], a[84:85], v[28:29], v[64:67]
    v_mfma_f32_16x16x16_bf16 v[68:71], a[90:91], v[28:29], v[68:71]
    v_mfma_f32_16x16x16_bf16 v[72:75], a[96:97], v[28:29], v[72:75]
    v_mfma_f32_16x16x16_bf16 v[76:79], a[102:103], v[28:29], v[76:79]
    v_mfma_f32_16x16x16_bf16 v[80:83], a[108:109], v[28:29], v[80:83]
    v_mfma_f32_16x16x16_bf16 v[84:87], a[114:115], v[28:29], v[84:87]
    v_mfma_f32_16x16x16_bf16 v[88:91], a[120:121], v[28:29], v[88:91]
    v_mfma_f32_16x16x16_bf16 v[92:95], a[126:127], v[28:29], v[92:95]
    v_mfma_f32_16x16x16_bf16 v[96:99], a[80:81], v[30:31], 0
    v_mfma_f32_16x16x16_bf16 v[100:103], a[86:87], v[30:31], 0
    v_mfma_f32_16x16x16_bf16 v[104:107], a[92:93], v[30:31], 0
    v_mfma_f32_16x16x16_bf16 v[108:111], a[98:99], v[30:31], 0
    v_mfma_f32_16x16x16_bf16 v[112:115], a[104:105], v[30:31], 0
    v_mfma_f32_16x16x16_bf16 v[116:119], a[110:111], v[30:31], 0
    v_mfma_f32_16x16x16_bf16 v[120:123], a[116:117], v[30:31], 0
    v_mfma_f32_16x16x16_bf16 v[124:127], a[122:123], v[30:31], 0
    v_mfma_f32_16x16x16_bf16 v[96:99], a[82:83], v[32:33], v[96:99]
    v_mfma_f32_16x16x16_bf16 v[100:103], a[88:89], v[32:33], v[100:103]
    v_mfma_f32_16x16x16_bf16 v[104:107], a[94:95], v[32:33], v[104:107]
    v_mfma_f32_16x16x16_bf16 v[108:111], a[100:101], v[32:33], v[108:111]
    v_mfma_f32_16x16x16_bf16 v[112:115], a[106:107], v[32:33], v[112:115]
    v_mfma_f32_16x16x16_bf16 v[116:119], a[112:113], v[32:33], v[116:119]
    v_mfma_f32_16x16x16_bf16 v[120:123], a[118:119], v[32:33], v[120:123]
    v_mfma_f32_16x16x16_bf16 v[124:127], a[124:125], v[32:33], v[124:127]
    v_mfma_f32_16x16x16_bf16 v[96:99], a[84:85], v[34:35], v[96:99]
    v_mfma_f32_16x16x16_bf16 v[100:103], a[90:91], v[34:35], v[100:103]
    v_mfma_f32_16x16x16_bf16 v[104:107], a[96:97], v[34:35], v[104:107]
    v_mfma_f32_16x16x16_bf16 v[108:111], a[102:103], v[34:35], v[108:111]
    v_mfma_f32_16x16x16_bf16 v[112:115], a[108:109], v[34:35], v[112:115]
    v_mfma_f32_16x16x16_bf16 v[116:119], a[114:115], v[34:35], v[116:119]
    v_mfma_f32_16x16x16_bf16 v[120:123], a[120:121], v[34:35], v[120:123]
    v_mfma_f32_16x16x16_bf16 v[124:127], a[126:127], v[34:35], v[124:127]
    s_add_u32 s46, s63, 4096
    v_cvt_pk_bf16_f32 v64, v64, v65
    v_cvt_pk_bf16_f32 v65, v66, v67
    v_cvt_pk_bf16_f32 v66, v68, v69
    v_cvt_pk_bf16_f32 v67, v70, v71
    buffer_store_dwordx4 v[64:67], v10, s[12:15], s63 offen offset:0 sc1
    v_cvt_pk_bf16_f32 v72, v72, v73
    v_cvt_pk_bf16_f32 v73, v74, v75
    v_cvt_pk_bf16_f32 v74, v76, v77
    v_cvt_pk_bf16_f32 v75, v78, v79
    buffer_store_dwordx4 v[72:75], v10, s[12:15], s63 offen offset:2048 sc1
    v_cvt_pk_bf16_f32 v80, v80, v81
    v_cvt_pk_bf16_f32 v81, v82, v83
    v_cvt_pk_bf16_f32 v82, v84, v85
    v_cvt_pk_bf16_f32 v83, v86, v87
    buffer_store_dwordx4 v[80:83], v10, s[12:15], s46 offen offset:0 sc1
    v_cvt_pk_bf16_f32 v88, v88, v89
    v_cvt_pk_bf16_f32 v89, v90, v91
    v_cvt_pk_bf16_f32 v90, v92, v93
    v_cvt_pk_bf16_f32 v91, v94, v95
    buffer_store_dwordx4 v[88:91], v10, s[12:15], s46 offen offset:2048 sc1
    v_cvt_pk_bf16_f32 v96, v96, v97
    v_cvt_pk_bf16_f32 v97, v98, v99
    v_cvt_pk_bf16_f32 v98, v100, v101
    v_cvt_pk_bf16_f32 v99, v102, v103
    buffer_store_dwordx4 v[96:99], v10, s[12:15], s63 offen offset:256 sc1
    v_cvt_pk_bf16_f32 v104, v104, v105
    v_cvt_pk_bf16_f32 v105, v106, v107
    v_cvt_pk_bf16_f32 v106, v108, v109
    v_cvt_pk_bf16_f32 v107, v110, v111
    buffer_store_dwordx4 v[104:107], v10, s[12:15], s63 offen offset:2304 sc1
    v_cvt_pk_bf16_f32 v112, v112, v113
    v_cvt_pk_bf16_f32 v113, v114, v115
    v_cvt_pk_bf16_f32 v114, v116, v117
    v_cvt_pk_bf16_f32 v115, v118, v119
    buffer_store_dwordx4 v[112:115], v10, s[12:15], s46 offen offset:256 sc1
    v_cvt_pk_bf16_f32 v120, v120, v121
    v_cvt_pk_bf16_f32 v121, v122, v123
    v_cvt_pk_bf16_f32 v122, v124, v125
    v_cvt_pk_bf16_f32 v123, v126, v127
    buffer_store_dwordx4 v[120:123], v10, s[12:15], s46 offen offset:2304 sc1
    s_waitcnt vmcnt(0)
    v_mov_b32 v16, s60
    v_add_u32 v16, 1, v16
    v_mov_b32 v17, 0
    s_mov_b64 exec, 1
    buffer_store_dword v16, v17, s[12:15], s52 offen sc1
    s_mov_b64 exec, -1
L_sf_46:
    s_add_u32 s60, s60, 4
    s_cmp_lt_u32 s60, 64
    s_cbranch_scc1 L_a_loop_40
    s_branch L_c_done_1
L_w_g_8:
    s_lshr_b32 s53, s48, 2
    s_cmp_lt_u32 s53, 2
    s_cselect_b32 s46, 1, 0
    s_xor_b32 s53, s53, s46
    s_lshl_b32 s46, s53, 3
    s_add_u32 s46, s46, 16
    s_load_dwordx2 s[4:5], s[0:1], s46
    s_lshl_b32 s49, s40, 2
    s_and_b32 s46, s48, 3
    s_add_u32 s49, s49, s46
    s_load_dwordx2 s[6:7], s[0:1], 72
    s_and_b32 s50, s44, 3
    s_lshr_b32 s51, s44, 2
    s_waitcnt lgkmcnt(0)
    s_mov_b32 s24, s4
    s_and_b32 s25, s5, 0xffff
    s_mov_b32 s26, 0x800000
    s_mov_b32 s27, 0x00020000
    s_cmp_lg_u32 s53, 0
    s_cbranch_scc1 L_g_nq_47
    s_cmp_lg_u32 s44, 0
    s_cbranch_scc1 L_zwok_50
    v_and_b32 v10, 7, v1
    v_lshlrev_b32 v10, 5, v10
    s_mov_b32 s70, 0
L_zw_49:
    buffer_load_dword v11, v10, s[16:19], 0 offen sc1
    s_waitcnt vmcnt(0)
    v_add_u32_dpp v11, v11, v11 row_ror:1 row_mask:0xf bank_mask:0xf
    s_nop 1
    v_add_u32_dpp v11, v11, v11 row_ror:2 row_mask:0xf bank_mask:0xf
    s_nop 1
    v_add_u32_dpp v11, v11, v11 row_ror:4 row_mask:0xf bank_mask:0xf
    v_cmp_ne_u32 vcc, 0x100, v11
    s_add_u32 s70, s70, 1
    s_cbranch_vccz L_zwok_50
    s_sleep 4
    s_cmp_lt_u32 s70, 524288
    s_cbranch_scc1 L_zw_49
    s_branch L_c_done_1
L_zwok_50:
    s_cmp_lg_u32 s44, 0
    s_cbranch_scc1 L_g_nq2_48
    v_mov_b32 v10, 0x109400
    s_mov_b32 s47, 0
    s_mov_b32 s70, 0
L_spin_51:
    buffer_load_dword v11, v10, s[12:15], 0 offen sc1
    s_waitcnt vmcnt(0)
    v_cmp_ge_u32 vcc, s47, v11
    s_add_u32 s70, s70, 1
    s_cbranch_vccz L_spok_52
    s_sleep 3
    s_cmp_lt_u32 s70, 524288
    s_cbranch_scc1 L_spin_51
    s_branch L_c_done_1
L_spok_52:
L_g_nq2_48:
    s_barrier
L_g_nq_47:
    v_lshrrev_b32 v3, 4, v1
    v_and_b32 v4, 15, v1
    v_lshlrev_b32 v5, 2, v3
    v_xor_b32 v4, v4, v5
    v_mul_u32_u24 v3, 8192, v3
    v_lshl_add_u32 v3, v4, 4, v3
    s_mul_i32 s46, s51, 512
    s_mul_i32 s47, s50, 64
    s_add_u32 s46, s46, s47
    s_mul_i32 s46, s46, 8192
    s_lshl_b32 s47, s49, 8
    s_add_u32 s46, s46, s47
    s_lshl_b32 s45, s51, 16
    s_mul_i32 s47, s50, 16384
    s_add_u32 s45, s45, s47
    v_bfe_u32 v4, v1, 2, 2
    v_bfe_u32 v5, v1, 4, 1
    v_lshlrev_b32 v5, 1, v5
    v_bfe_u32 v6, v1, 0, 1
    v_add_u32 v5, v5, v6
    s_lshl_b32 s47, s50, 2
    v_add_u32 v5, s47, v5
    v_lshlrev_b32 v6, 2, v4
    v_xor_b32 v5, v5, v6
    v_lshlrev_b32 v5, 4, v5
    v_lshl_add_u32 v5, v4, 8, v5
    v_bfe_u32 v6, v1, 1, 1
    v_lshl_add_u32 v5, v6, 3, v5
    v_lshrrev_b32 v6, 5, v1
    v_mul_u32_u24 v6, 2048, v6
    v_add_u32 v5, v5, v6
    s_lshl_b32 s47, s51, 16
    v_add_u32 v5, s47, v5
    v_bfe_u32 v4, v1, 2, 2
    v_xor_b32 v5, s50, v4
    v_lshlrev_b32 v5, 6, v5
    v_lshl_add_u32 v5, v4, 8, v5
    v_and_b32 v6, 3, v1
    v_lshl_add_u32 v5, v6, 4, v5
    v_lshrrev_b32 v6, 4, v1
    v_lshl_add_u32 v5, v6, 11, v5
    s_lshl_b32 s47, s51, 16
    v_add_u32 v5, s47, v5
    s_add_u32 m0, s45, 0
    s_add_u32 s47, s46, 0x0
    buffer_load_dwordx4 v3, s[24:27], s47 offen lds
    s_add_u32 m0, s45, 1024
    s_add_u32 s47, s46, 0x8000
    buffer_load_dwordx4 v3, s[24:27], s47 offen lds
    s_add_u32 m0, s45, 2048
    s_add_u32 s47, s46, 0x10000
    buffer_load_dwordx4 v3, s[24:27], s47 offen lds
    s_add_u32 m0, s45, 3072
    s_add_u32 s47, s46, 0x18000
    buffer_load_dwordx4 v3, s[24:27], s47 offen lds
    s_add_u32 m0, s45, 4096
    s_add_u32 s47, s46, 0x20000
    buffer_load_dwordx4 v3, s[24:27], s47 offen lds
    s_add_u32 m0, s45, 5120
    s_add_u32 s47, s46, 0x28000
    buffer_load_dwordx4 v3, s[24:27], s47 offen lds
    s_add_u32 m0, s45, 6144
    s_add_u32 s47, s46, 0x30000
    buffer_load_dwordx4 v3, s[24:27], s47 offen lds
    s_add_u32 m0, s45, 7168
    s_add_u32 s47, s46, 0x38000
    buffer_load_dwordx4 v3, s[24:27], s47 offen lds
    s_add_u32 m0, s45, 8192
    s_add_u32 s47, s46, 0x40000
    buffer_load_dwordx4 v3, s[24:27], s47 offen lds
    s_add_u32 m0, s45, 9216
    s_add_u32 s47, s46, 0x48000
    buffer_load_dwordx4 v3, s[24:27], s47 offen lds
    s_add_u32 m0, s45, 10240
    s_add_u32 s47, s46, 0x50000
    buffer_load_dwordx4 v3, s[24:27], s47 offen lds
    s_add_u32 m0, s45, 11264
    s_add_u32 s47, s46, 0x58000
    buffer_load_dwordx4 v3, s[24:27], s47 offen lds
    s_add_u32 m0, s45, 12288
    s_add_u32 s47, s46, 0x60000
    buffer_load_dwordx4 v3, s[24:27], s47 offen lds
    s_add_u32 m0, s45, 13312
    s_add_u32 s47, s46, 0x68000
    buffer_load_dwordx4 v3, s[24:27], s47 offen lds
    s_add_u32 m0, s45, 14336
    s_add_u32 s47, s46, 0x70000
    buffer_load_dwordx4 v3, s[24:27], s47 offen lds
    s_add_u32 m0, s45, 15360
    s_add_u32 s47, s46, 0x78000
    buffer_load_dwordx4 v3, s[24:27], s47 offen lds
    s_waitcnt vmcnt(0)
    s_barrier
    ds_read_b64_tr_b16 a[0:1], v5 offset:0
    ds_read_b64_tr_b16 a[2:3], v5 offset:1024
    ds_read_b64_tr_b16 a[4:5], v5 offset:8
    ds_read_b64_tr_b16 a[6:7], v5 offset:1032
    ds_read_b64_tr_b16 a[8:9], v5 offset:8192
    ds_read_b64_tr_b16 a[10:11], v5 offset:9216
    ds_read_b64_tr_b16 a[12:13], v5 offset:8200
    ds_read_b64_tr_b16 a[14:15], v5 offset:9224
    s_waitcnt lgkmcnt(0)
    ds_read_b64_tr_b16 a[16:17], v5 offset:16384
    ds_read_b64_tr_b16 a[18:19], v5 offset:17408
    ds_read_b64_tr_b16 a[20:21], v5 offset:16392
    ds_read_b64_tr_b16 a[22:23], v5 offset:17416
    ds_read_b64_tr_b16 a[24:25], v5 offset:24576
    ds_read_b64_tr_b16 a[26:27], v5 offset:25600
    ds_read_b64_tr_b16 a[28:29], v5 offset:24584
    ds_read_b64_tr_b16 a[30:31], v5 offset:25608
    s_waitcnt lgkmcnt(0)
    ds_read_b64_tr_b16 a[32:33], v5 offset:32768
    ds_read_b64_tr_b16 a[34:35], v5 offset:33792
    ds_read_b64_tr_b16 a[36:37], v5 offset:32776
    ds_read_b64_tr_b16 a[38:39], v5 offset:33800
    ds_read_b64_tr_b16 a[40:41], v5 offset:40960
    ds_read_b64_tr_b16 a[42:43], v5 offset:41984
    ds_read_b64_tr_b16 a[44:45], v5 offset:40968
    ds_read_b64_tr_b16 a[46:47], v5 offset:41992
    s_waitcnt lgkmcnt(0)
    ds_read_b64_tr_b16 a[48:49], v5 offset:49152
    ds_read_b64_tr_b16 a[50:51], v5 offset:50176
    ds_read_b64_tr_b16 a[52:53], v5 offset:49160
    ds_read_b64_tr_b16 a[54:55], v5 offset:50184
    ds_read_b64_tr_b16 a[56:57], v5 offset:57344
    ds_read_b64_tr_b16 a[58:59], v5 offset:58368
    ds_read_b64_tr_b16 a[60:61], v5 offset:57352
    ds_read_b64_tr_b16 a[62:63], v5 offset:58376
    s_waitcnt lgkmcnt(0)
    s_waitcnt lgkmcnt(0)
    s_barrier
    s_add_u32 m0, s45, 0
    s_add_u32 s47, s46, 0x200000
    buffer_load_dwordx4 v3, s[24:27], s47 offen lds
    s_add_u32 m0, s45, 1024
    s_add_u32 s47, s46, 0x208000
    buffer_load_dwordx4 v3, s[24:27], s47 offen lds
    s_add_u32 m0, s45, 2048
    s_add_u32 s47, s46, 0x210000
    buffer_load_dwordx4 v3, s[24:27], s47 offen lds
    s_add_u32 m0, s45, 3072
    s_add_u32 s47, s46, 0x218000
    buffer_load_dwordx4 v3, s[24:27], s47 offen lds
    s_add_u32 m0, s45, 4096
    s_add_u32 s47, s46, 0x220000
    buffer_load_dwordx4 v3, s[24:27], s47 offen lds
    s_add_u32 m0, s45, 5120
    s_add_u32 s47, s46, 0x228000
    buffer_load_dwordx4 v3, s[24:27], s47 offen lds
    s_add_u32 m0, s45, 6144
    s_add_u32 s47, s46, 0x230000
    buffer_load_dwordx4 v3, s[24:27], s47 offen lds
    s_add_u32 m0, s45, 7168
    s_add_u32 s47, s46, 0x238000
    buffer_load_dwordx4 v3, s[24:27], s47 offen lds
    s_add_u32 m0, s45, 8192
    s_add_u32 s47, s46, 0x240000
    buffer_load_dwordx4 v3, s[24:27], s47 offen lds
    s_add_u32 m0, s45, 9216
    s_add_u32 s47, s46, 0x248000
    buffer_load_dwordx4 v3, s[24:27], s47 offen lds
    s_add_u32 m0, s45, 10240
    s_add_u32 s47, s46, 0x250000
    buffer_load_dwordx4 v3, s[24:27], s47 offen lds
    s_add_u32 m0, s45, 11264
    s_add_u32 s47, s46, 0x258000
    buffer_load_dwordx4 v3, s[24:27], s47 offen lds
    s_add_u32 m0, s45, 12288
    s_add_u32 s47, s46, 0x260000
    buffer_load_dwordx4 v3, s[24:27], s47 offen lds
    s_add_u32 m0, s45, 13312
    s_add_u32 s47, s46, 0x268000
    buffer_load_dwordx4 v3, s[24:27], s47 offen lds
    s_add_u32 m0, s45, 14336
    s_add_u32 s47, s46, 0x270000
    buffer_load_dwordx4 v3, s[24:27], s47 offen lds
    s_add_u32 m0, s45, 15360
    s_add_u32 s47, s46, 0x278000
    buffer_load_dwordx4 v3, s[24:27], s47 offen lds
    s_waitcnt vmcnt(0)
    s_barrier
    ds_read_b64_tr_b16 a[64:65], v5 offset:0
    ds_read_b64_tr_b16 a[66:67], v5 offset:1024
    ds_read_b64_tr_b16 a[68:69], v5 offset:8
    ds_read_b64_tr_b16 a[70:71], v5 offset:1032
    ds_read_b64_tr_b16 a[72:73], v5 offset:8192
    ds_read_b64_tr_b16 a[74:75], v5 offset:9216
    ds_read_b64_tr_b16 a[76:77], v5 offset:8200
    ds_read_b64_tr_b16 a[78:79], v5 offset:9224
    s_waitcnt lgkmcnt(0)
    ds_read_b64_tr_b16 a[80:81], v5 offset:16384
    ds_read_b64_tr_b16 a[82:83], v5 offset:17408
    ds_read_b64_tr_b16 a[84:85], v5 offset:16392
    ds_read_b64_tr_b16 a[86:87], v5 offset:17416
    ds_read_b64_tr_b16 a[88:89], v5 offset:24576
    ds_read_b64_tr_b16 a[90:91], v5 offset:25600
    ds_read_b64_tr_b16 a[92:93], v5 offset:24584
    ds_read_b64_tr_b16 a[94:95], v5 offset:25608
    s_waitcnt lgkmcnt(0)
    ds_read_b64_tr_b16 a[96:97], v5 offset:32768
    ds_read_b64_tr_b16 a[98:99], v5 offset:33792
    ds_read_b64_tr_b16 a[100:101], v5 offset:32776
    ds_read_b64_tr_b16 a[102:103], v5 offset:33800
    ds_read_b64_tr_b16 a[104:105], v5 offset:40960
    ds_read_b64_tr_b16 a[106:107], v5 offset:41984
    ds_read_b64_tr_b16 a[108:109], v5 offset:40968
    ds_read_b64_tr_b16 a[110:111], v5 offset:41992
    s_waitcnt lgkmcnt(0)
    ds_read_b64_tr_b16 a[112:113], v5 offset:49152
    ds_read_b64_tr_b16 a[114:115], v5 offset:50176
    ds_read_b64_tr_b16 a[116:117], v5 offset:49160
    ds_read_b64_tr_b16 a[118:119], v5 offset:50184
    ds_read_b64_tr_b16 a[120:121], v5 offset:57344
    ds_read_b64_tr_b16 a[122:123], v5 offset:58368
    ds_read_b64_tr_b16 a[124:125], v5 offset:57352
    ds_read_b64_tr_b16 a[126:127], v5 offset:58376
    s_waitcnt lgkmcnt(0)
    s_waitcnt lgkmcnt(0)
    s_barrier
    v_lshlrev_b32 v2, 4, v1
    s_mul_i32 s64, s44, 8192
    s_add_u32 s46, s64, 0x400000
    v_add_u32 v3, s46, v2
    s_mul_i32 s46, s51, 32768
    v_add_u32 v4, s46, v2
    v_and_b32 v6, 15, v1
    v_lshlrev_b32 v6, 4, v6
    v_lshrrev_b32 v7, 4, v1
    v_lshl_add_u32 v6, v7, 9, v6
    v_add_u32 v4, s46, v6
    s_lshl_b32 s46, s50, 12
    s_add_u32 s46, s46, 131072
    v_add_u32 v5, s46, v2
    v_and_b32 v7, 3, v1
    v_lshlrev_b32 v7, 7, v7
    v_add_u32 v7, 0x109400, v7
    s_mul_i32 s46, s49, 24576
    s_lshl_b32 s47, s53, 13
    s_add_u32 s46, s46, s47
    s_lshl_b32 s47, s50, 10
    s_add_u32 s46, s46, s47
    s_add_u32 s46, s46, 0x2000000
    v_and_b32 v8, 15, v1
    v_lshlrev_b32 v8, 4, v8
    v_bfe_u32 v9, v1, 4, 1
    v_lshl_add_u32 v8, v9, 12, v8
    v_lshrrev_b32 v9, 5, v1
    v_lshl_add_u32 v8, v9, 8, v8
    v_add_u32 v8, s46, v2
    v_add_u32 v9, 4096, v8
    s_lshl_b32 s52, s40, 2
    s_add_u32 s52, s52, s53
    s_lshl_b32 s52, s52, 2
    s_and_b32 s47, s48, 3
    s_add_u32 s52, s52, s47
    s_lshl_b32 s52, s52, 7
    s_add_u32 s52, s52, 0x10a400
    v_mov_b32 v116, -1
    v_mov_b32 v117, -1
    v_mov_b32 v118, -1
    v_mov_b32 v119, -1
    s_lshl_b32 s46, s49, 12
    s_lshl_b32 s47, s50, 10
    s_add_u32 s46, s46, s47
    s_add_u32 s46, s46, 0x1000000
    v_add_u32 v64, s46, v2
    s_and_b32 s46, s48, 3
    s_lshl_b32 s46, s46, 15
    s_lshl_b32 s47, s50, 13
    s_add_u32 s46, s46, s47
    s_lshl_b32 s47, s40, 8
    s_add_u32 s46, s46, s47
    s_add_u32 s46, s46, 0x7800000
    v_and_b32 v65, 15, v1
    v_lshlrev_b32 v65, 4, v65
    v_lshrrev_b32 v66, 4, v1
    v_lshl_add_u32 v65, v66, 11, v65
    v_add_u32 v65, s46, v65
    s_cmp_eq_u32 s53, 2
    s_cselect_b64 vcc, -1, 0
    v_cndmask_b32 v64, v64, v65, vcc
    s_mov_b32 s58, 0
    s_mov_b32 s60, 0
    s_mov_b32 s61, 0
    s_mov_b32 s62, 0
    s_mov_b32 s63, 0
    s_mov_b32 s67, 0
    s_mov_b32 s68, 3
    s_mov_b32 s71, 0
    v_mov_b32 v15, 147456
    v_mov_b32 v14, 0
    ds_write_b32 v15, v14 offset:4
    s_cmp_lg_u32 s44, 0
    s_cbranch_scc1 L_zwok_62
    v_and_b32 v10, 7, v1
    v_lshlrev_b32 v10, 5, v10
    s_mov_b32 s70, 0
L_zw_61:
    buffer_load_dword v11, v10, s[16:19], 0 offen sc1
    s_waitcnt vmcnt(0)
    v_add_u32_dpp v11, v11, v11 row_ror:1 row_mask:0xf bank_mask:0xf
    s_nop 1
    v_add_u32_dpp v11, v11, v11 row_ror:2 row_mask:0xf bank_mask:0xf
    s_nop 1
    v_add_u32_dpp v11, v11, v11 row_ror:4 row_mask:0xf bank_mask:0xf
    v_cmp_ne_u32 vcc, 0x100, v11
    s_add_u32 s70, s70, 1
    s_cbranch_vccz L_zwok_62
    s_sleep 4
    s_cmp_lt_u32 s70, 524288
    s_cbranch_scc1 L_zw_61
    s_branch L_c_done_1
L_zwok_62:
L_g_restart_53:
    s_cmp_lg_u32 s44, 0
    s_cbranch_scc1 L_g_nsp_54
    s_mov_b32 s70, 0
L_g_sp_60:
    s_add_u32 s54, s60, 0
    s_add_u32 s55, s54, 0
    s_and_b32 s46, s55, 7
    s_lshl_b32 s46, s46, 9
    buffer_load_dword v11, v7, s[12:15], s46 offen sc1
    s_add_u32 s55, s54, 1
    s_and_b32 s46, s55, 7
    s_lshl_b32 s46, s46, 9
    buffer_load_dword v12, v7, s[12:15], s46 offen sc1
    s_add_u32 s55, s54, 2
    s_and_b32 s46, s55, 7
    s_lshl_b32 s46, s46, 9
    buffer_load_dword v13, v7, s[12:15], s46 offen sc1
    s_waitcnt vmcnt(0)
    v_cmp_ge_u32 vcc, s60, v11
    s_add_u32 s70, s70, 1
    s_cbranch_vccz L_g_sp_60_ok
    s_sleep 3
    s_cmp_lt_u32 s70, 524288
    s_cbranch_scc1 L_g_sp_60
    s_branch L_c_done_1
L_g_sp_60_ok:
    s_mov_b32 s46, s54
    v_cmp_ge_u32 vcc, s46, v11
    s_nop 0
    s_cbranch_vccnz L_g_le_63
    s_add_u32 s46, s46, 1
    v_cmp_ge_u32 vcc, s46, v12
    s_nop 0
    s_cbranch_vccnz L_g_le_63
    s_add_u32 s46, s46, 1
    v_cmp_ge_u32 vcc, s46, v13
    s_nop 0
    s_cbranch_vccnz L_g_le_63
    s_add_u32 s46, s46, 1
L_g_le_63:
    v_mov_b32 v11, s46
    ds_write_b32 v15, v11
L_g_nsp_54:
    s_waitcnt lgkmcnt(0)
    s_barrier
    ds_read_b32 v14, v15
    s_waitcnt lgkmcnt(0)
    v_readfirstlane_b32 s66, v14
    s_nop 3
L_g_restart_53_go:
    s_mov_b32 s69, 0
    s_cmp_gt_u32 s62, s60
    s_cbranch_scc1 L_g_nd_64
    s_cmp_ge_u32 s62, s66
    s_cbranch_scc1 L_g_nd_64
    s_add_u32 s47, s61, 4096
    s_add_u32 m0, s64, 0
    s_nop 0
    buffer_load_dwordx4 v3, s[12:15], s61 offen offset:0 sc1 lds
    buffer_load_dwordx4 v3, s[12:15], s61 offen offset:1024 sc1 lds
    buffer_load_dwordx4 v3, s[12:15], s61 offen offset:2048 sc1 lds
    buffer_load_dwordx4 v3, s[12:15], s61 offen offset:3072 sc1 lds
    s_add_u32 m0, s64, 4096
    s_nop 0
    buffer_load_dwordx4 v3, s[12:15], s47 offen offset:0 sc1 lds
    buffer_load_dwordx4 v3, s[12:15], s47 offen offset:1024 sc1 lds
    buffer_load_dwordx4 v3, s[12:15], s47 offen offset:2048 sc1 lds
    buffer_load_dwordx4 v3, s[12:15], s47 offen offset:3072 sc1 lds
    s_add_u32 s61, s61, 65536
    s_add_u32 s62, s62, 1
    s_xor_b32 s64, s64, 0x10000
    s_mov_b32 s69, 1
L_g_nd_64:
    s_cmp_eq_u32 s51, 1
    s_cbranch_scc1 L_g_g1r_55
    s_add_u32 s59, s60, 1
    s_mov_b32 s69, 0
    s_cmp_gt_u32 s62, s59
    s_cbranch_scc1 L_g_nd_65
    s_cmp_ge_u32 s62, s66
    s_cbranch_scc1 L_g_nd_65
    s_add_u32 s47, s61, 4096
    s_add_u32 m0, s64, 0
    s_nop 0
    buffer_load_dwordx4 v3, s[12:15], s61 offen offset:0 sc1 lds
    buffer_load_dwordx4 v3, s[12:15], s61 offen offset:1024 sc1 lds
    buffer_load_dwordx4 v3, s[12:15], s61 offen offset:2048 sc1 lds
    buffer_load_dwordx4 v3, s[12:15], s61 offen offset:3072 sc1 lds
    s_add_u32 m0, s64, 4096
    s_nop 0
    buffer_load_dwordx4 v3, s[12:15], s47 offen offset:0 sc1 lds
    buffer_load_dwordx4 v3, s[12:15], s47 offen offset:1024 sc1 lds
    buffer_load_dwordx4 v3, s[12:15], s47 offen offset:2048 sc1 lds
    buffer_load_dwordx4 v3, s[12:15], s47 offen offset:3072 sc1 lds
    s_add_u32 s61, s61, 65536
    s_add_u32 s62, s62, 1
    s_xor_b32 s64, s64, 0x10000
    s_mov_b32 s69, 1
L_g_nd_65:
    s_cmp_eq_u32 s69, 1
    s_cbranch_scc1 L_g_w0_66
    s_waitcnt vmcnt(0)
L_g_w0_66:
    s_waitcnt vmcnt(8)
    s_mov_b32 s65, 1
.p2align 6
L_g_loop0_56:
    s_barrier
    s_cmp_eq_u32 s65, 0
    s_cbranch_scc1 L_g_pr_67
    ds_read_b128 v[32:35], v4 offset:0
    ds_read_b128 v[36:39], v4 offset:256
    ds_read_b128 v[40:43], v4 offset:2048
    ds_read_b128 v[44:47], v4 offset:2304
    ds_read_b128 v[48:51], v4 offset:4096
    ds_read_b128 v[52:55], v4 offset:4352
    ds_read_b128 v[56:59], v4 offset:6144
    ds_read_b128 v[60:63], v4 offset:6400
L_g_pr_67:
    ds_read_b32 v14, v15
    s_cmp_lg_u32 s44, 0
    s_cbranch_scc1 L_g_nl_68
    s_add_u32 s54, s60, 1
    s_add_u32 s55, s54, 0
    s_and_b32 s46, s55, 7
    s_lshl_b32 s46, s46, 9
    buffer_load_dword v11, v7, s[12:15], s46 offen sc1
    s_add_u32 s55, s54, 1
    s_and_b32 s46, s55, 7
    s_lshl_b32 s46, s46, 9
    buffer_load_dword v12, v7, s[12:15], s46 offen sc1
    s_add_u32 s55, s54, 2
    s_and_b32 s46, s55, 7
    s_lshl_b32 s46, s46, 9
    buffer_load_dword v13, v7, s[12:15], s46 offen sc1
L_g_nl_68:
    s_setprio 1
    s_waitcnt lgkmcnt(7)
    v_mfma_f32_16x16x32_bf16 v[16:19], a[0:3], v[32:35], 0
    v_mfma_f32_16x16x32_bf16 v[20:23], a[4:7], v[32:35], 0
    ds_read_b128 v[32:35], v4 offset:8192
    s_waitcnt lgkmcnt(7)
    v_mfma_f32_16x16x32_bf16 v[24:27], a[0:3], v[36:39], 0
    v_mfma_f32_16x16x32_bf16 v[28:31], a[4:7], v[36:39], 0
    ds_read_b128 v[36:39], v4 offset:8448
    s_waitcnt lgkmcnt(7)
    v_mfma_f32_16x16x32_bf16 v[16:19], a[8:11], v[40:43], v[16:19]
    v_mfma_f32_16x16x32_bf16 v[20:23], a[12:15], v[40:43], v[20:23]
    ds_read_b128 v[40:43], v4 offset:10240
    s_waitcnt lgkmcnt(7)
    v_mfma_f32_16x16x32_bf16 v[24:27], a[8:11], v[44:47], v[24:27]
    v_mfma_f32_16x16x32_bf16 v[28:31], a[12:15], v[44:47], v[28:31]
    ds_read_b128 v[44:47], v4 offset:10496
    s_waitcnt lgkmcnt(7)
    v_mfma_f32_16x16x32_bf16 v[16:19], a[16:19], v[48:51], v[16:19]
    v_mfma_f32_16x16x32_bf16 v[20:23], a[20:23], v[48:51], v[20:23]
    ds_read_b128 v[48:51], v4 offset:12288
    s_waitcnt lgkmcnt(7)
    v_mfma_f32_16x16x32_bf16 v[24:27], a[16:19], v[52:55], v[24:27]
    v_mfma_f32_16x16x32_bf16 v[28:31], a[20:23], v[52:55], v[28:31]
    ds_read_b128 v[52:55], v4 offset:12544
    s_waitcnt lgkmcnt(7)
    v_mfma_f32_16x16x32_bf16 v[16:19], a[24:27], v[56:59], v[16:19]
    v_mfma_f32_16x16x32_bf16 v[20:23], a[28:31], v[56:59], v[20:23]
    ds_read_b128 v[56:59], v4 offset:14336
    s_waitcnt lgkmcnt(7)
    v_mfma_f32_16x16x32_bf16 v[24:27], a[24:27], v[60:63], v[24:27]
    v_mfma_f32_16x16x32_bf16 v[28:31], a[28:31], v[60:63], v[28:31]
    ds_read_b128 v[60:63], v4 offset:14592
    s_waitcnt lgkmcnt(7)
    v_mfma_f32_16x16x32_bf16 v[16:19], a[32:35], v[32:35], v[16:19]
    v_mfma_f32_16x16x32_bf16 v[20:23], a[36:39], v[32:35], v[20:23]
    ds_read_b128 v[32:35], v4 offset:16384
    s_waitcnt lgkmcnt(7)
    v_mfma_f32_16x16x32_bf16 v[24:27], a[32:35], v[36:39], v[24:27]
    v_mfma_f32_16x16x32_bf16 v[28:31], a[36:39], v[36:39], v[28:31]
    ds_read_b128 v[36:39], v4 offset:16640
    s_waitcnt lgkmcnt(7)
    v_mfma_f32_16x16x32_bf16 v[16:19], a[40:43], v[40:43], v[16:19]
    v_mfma_f32_16x16x32_bf16 v[20:23], a[44:47], v[40:43], v[20:23]
    ds_read_b128 v[40:43], v4 offset:18432
    s_waitcnt lgkmcnt(7)
    v_mfma_f32_16x16x32_bf16 v[24:27], a[40:43], v[44:47], v[24:27]
    v_mfma_f32_16x16x32_bf16 v[28:31], a[44:47], v[44:47], v[28:31]
    ds_read_b128 v[44:47], v4 offset:18688
    s_waitcnt lgkmcnt(7)
    v_mfma_f32_16x16x32_bf16 v[16:19], a[48:51], v[48:51], v[16:19]
    v_mfma_f32_16x16x32_bf16 v[20:23], a[52:55], v[48:51], v[20:23]
    ds_read_b128 v[48:51], v4 offset:20480
    s_waitcnt lgkmcnt(7)
    v_mfma_f32_16x16x32_bf16 v[24:27], a[48:51], v[52:55], v[24:27]
    v_mfma_f32_16x16x32_bf16 v[28:31], a[52:55], v[52:55], v[28:31]
    ds_read_b128 v[52:55], v4 offset:20736
    s_waitcnt lgkmcnt(7)
    v_mfma_f32_16x16x32_bf16 v[16:19], a[56:59], v[56:59], v[16:19]
    v_mfma_f32_16x16x32_bf16 v[20:23], a[60:63], v[56:59], v[20:23]
    ds_read_b128 v[56:59], v4 offset:22528
    s_waitcnt lgkmcnt(7)
    v_mfma_f32_16x16x32_bf16 v[24:27], a[56:59], v[60:63], v[24:27]
    v_mfma_f32_16x16x32_bf16 v[28:31], a[60:63], v[60:63], v[28:31]
    ds_read_b128 v[60:63], v4 offset:22784
    s_waitcnt lgkmcnt(7)
    v_mfma_f32_16x16x32_bf16 v[16:19], a[64:67], v[32:35], v[16:19]
    v_mfma_f32_16x16x32_bf16 v[20:23], a[68:71], v[32:35], v[20:23]
    ds_read_b128 v[32:35], v4 offset:24576
    s_waitcnt lgkmcnt(7)
    v_mfma_f32_16x16x32_bf16 v[24:27], a[64:67], v[36:39], v[24:27]
    v_mfma_f32_16x16x32_bf16 v[28:31], a[68:71], v[36:39], v[28:31]
    ds_read_b128 v[36:39], v4 offset:24832
    s_waitcnt lgkmcnt(7)
    v_mfma_f32_16x16x32_bf16 v[16:19], a[72:75], v[40:43], v[16:19]
    v_mfma_f32_16x16x32_bf16 v[20:23], a[76:79], v[40:43], v[20:23]
    ds_read_b128 v[40:43], v4 offset:26624
    s_waitcnt lgkmcnt(7)
    v_mfma_f32_16x16x32_bf16 v[24:27], a[72:75], v[44:47], v[24:27]
    v_mfma_f32_16x16x32_bf16 v[28:31], a[76:79], v[44:47], v[28:31]
    ds_read_b128 v[44:47], v4 offset:26880
    s_waitcnt lgkmcnt(7)
    v_mfma_f32_16x16x32_bf16 v[16:19], a[80:83], v[48:51], v[16:19]
    v_mfma_f32_16x16x32_bf16 v[20:23], a[84:87], v[48:51], v[20:23]
    ds_read_b128 v[48:51], v4 offset:28672
    s_waitcnt lgkmcnt(7)
    v_mfma_f32_16x16x32_bf16 v[24:27], a[80:83], v[52:55], v[24:27]
    v_mfma_f32_16x16x32_bf16 v[28:31], a[84:87], v[52:55], v[28:31]
    ds_read_b128 v[52:55], v4 offset:28928
    s_waitcnt lgkmcnt(7)
    v_mfma_f32_16x16x32_bf16 v[16:19], a[88:91], v[56:59], v[16:19]
    v_mfma_f32_16x16x32_bf16 v[20:23], a[92:95], v[56:59], v[20:23]
    ds_read_b128 v[56:59], v4 offset:30720
    s_waitcnt lgkmcnt(7)
    v_mfma_f32_16x16x32_bf16 v[24:27], a[88:91], v[60:63], v[24:27]
    v_mfma_f32_16x16x32_bf16 v[28:31], a[92:95], v[60:63], v[28:31]
    ds_read_b128 v[60:63], v4 offset:30976
    s_waitcnt lgkmcnt(7)
    v_mfma_f32_16x16x32_bf16 v[16:19], a[96:99], v[32:35], v[16:19]
    v_mfma_f32_16x16x32_bf16 v[20:23], a[100:103], v[32:35], v[20:23]
    s_waitcnt lgkmcnt(6)
    v_mfma_f32_16x16x32_bf16 v[24:27], a[96:99], v[36:39], v[24:27]
    v_mfma_f32_16x16x32_bf16 v[28:31], a[100:103], v[36:39], v[28:31]
    s_waitcnt lgkmcnt(5)
    v_mfma_f32_16x16x32_bf16 v[16:19], a[104:107], v[40:43], v[16:19]
    v_mfma_f32_16x16x32_bf16 v[20:23], a[108:111], v[40:43], v[20:23]
    s_waitcnt lgkmcnt(4)
    v_mfma_f32_16x16x32_bf16 v[24:27], a[104:107], v[44:47], v[24:27]
    v_mfma_f32_16x16x32_bf16 v[28:31], a[108:111], v[44:47], v[28:31]
    s_waitcnt lgkmcnt(3)
    v_mfma_f32_16x16x32_bf16 v[16:19], a[112:115], v[48:51], v[16:19]
    v_mfma_f32_16x16x32_bf16 v[20:23], a[116:119], v[48:51], v[20:23]
    s_waitcnt lgkmcnt(2)
    v_mfma_f32_16x16x32_bf16 v[24:27], a[112:115], v[52:55], v[24:27]
    v_mfma_f32_16x16x32_bf16 v[28:31], a[116:119], v[52:55], v[28:31]
    s_waitcnt lgkmcnt(1)
    v_mfma_f32_16x16x32_bf16 v[16:19], a[120:123], v[56:59], v[16:19]
    v_mfma_f32_16x16x32_bf16 v[20:23], a[124:127], v[56:59], v[20:23]
    s_waitcnt lgkmcnt(0)
    v_mfma_f32_16x16x32_bf16 v[24:27], a[120:123], v[60:63], v[24:27]
    v_mfma_f32_16x16x32_bf16 v[28:31], a[124:127], v[60:63], v[28:31]
    v_xor_b32 v4, 0x10000, v4
    s_setprio 0
    s_waitcnt vmcnt(0)
    v_readfirstlane_b32 s66, v14
    s_barrier
    s_nop 6
    ds_write_b128 v5, v[16:19] offset:0
    ds_write_b128 v5, v[20:23] offset:1024
    ds_write_b128 v5, v[24:27] offset:2048
    ds_write_b128 v5, v[28:31] offset:3072
    s_cmp_lg_u32 s44, 0
    s_cbranch_scc1 L_g_ne_69
    s_mov_b32 s46, s54
    v_cmp_ge_u32 vcc, s46, v11
    s_nop 0
    s_cbranch_vccnz L_g_le_72
    s_add_u32 s46, s46, 1
    v_cmp_ge_u32 vcc, s46, v12
    s_nop 0
    s_cbranch_vccnz L_g_le_72
    s_add_u32 s46, s46, 1
    v_cmp_ge_u32 vcc, s46, v13
    s_nop 0
    s_cbranch_vccnz L_g_le_72
    s_add_u32 s46, s46, 1
L_g_le_72:
    v_mov_b32 v11, s46
    ds_write_b32 v15, v11
L_g_ne_69:
    s_add_u32 s60, s60, 1
    s_mov_b32 s69, 0
    s_cmp_gt_u32 s62, s60
    s_cbranch_scc1 L_g_nd_73
    s_cmp_ge_u32 s62, s66
    s_cbranch_scc1 L_g_nd_73
    s_add_u32 s47, s61, 4096
    s_add_u32 m0, s64, 0
    s_nop 0
    buffer_load_dwordx4 v3, s[12:15], s61 offen offset:0 sc1 lds
    buffer_load_dwordx4 v3, s[12:15], s61 offen offset:1024 sc1 lds
    buffer_load_dwordx4 v3, s[12:15], s61 offen offset:2048 sc1 lds
    buffer_load_dwordx4 v3, s[12:15], s61 offen offset:3072 sc1 lds
    s_add_u32 m0, s64, 4096
    s_nop 0
    buffer_load_dwordx4 v3, s[12:15], s47 offen offset:0 sc1 lds
    buffer_load_dwordx4 v3, s[12:15], s47 offen offset:1024 sc1 lds
    buffer_load_dwordx4 v3, s[12:15], s47 offen offset:2048 sc1 lds
    buffer_load_dwordx4 v3, s[12:15], s47 offen offset:3072 sc1 lds
    s_add_u32 s61, s61, 65536
    s_add_u32 s62, s62, 1
    s_xor_b32 s64, s64, 0x10000
    s_mov_b32 s69, 1
L_g_nd_73:
    s_mov_b32 s65, s69
    s_add_u32 s59, s60, 1
    s_mov_b32 s69, 0
    s_cmp_gt_u32 s62, s59
    s_cbranch_scc1 L_g_nd_74
    s_cmp_ge_u32 s62, s66
    s_cbranch_scc1 L_g_nd_74
    s_add_u32 s47, s61, 4096
    s_add_u32 m0, s64, 0
    s_nop 0
    buffer_load_dwordx4 v3, s[12:15], s61 offen offset:0 sc1 lds
    buffer_load_dwordx4 v3, s[12:15], s61 offen offset:1024 sc1 lds
    buffer_load_dwordx4 v3, s[12:15], s61 offen offset:2048 sc1 lds
    buffer_load_dwordx4 v3, s[12:15], s61 offen offset:3072 sc1 lds
    s_add_u32 m0, s64, 4096
    s_nop 0
    buffer_load_dwordx4 v3, s[12:15], s47 offen offset:0 sc1 lds
    buffer_load_dwordx4 v3, s[12:15], s47 offen offset:1024 sc1 lds
    buffer_load_dwordx4 v3, s[12:15], s47 offen offset:2048 sc1 lds
    buffer_load_dwordx4 v3, s[12:15], s47 offen offset:3072 sc1 lds
    s_add_u32 s61, s61, 65536
    s_add_u32 s62, s62, 1
    s_xor_b32 s64, s64, 0x10000
    s_mov_b32 s69, 1
L_g_nd_74:
    s_cmp_le_u32 s66, s60
    s_cbranch_scc1 L_g_ex0_71
    s_cmp_eq_u32 s65, 0
    s_cbranch_scc1 L_g_nw_70
    s_waitcnt vmcnt(0) lgkmcnt(0)
    s_branch L_g_loop0_56
L_g_nw_70:
    ds_read_b128 v[32:35], v4 offset:0
    ds_read_b128 v[36:39], v4 offset:256
    ds_read_b128 v[40:43], v4 offset:2048
    ds_read_b128 v[44:47], v4 offset:2304
    ds_read_b128 v[48:51], v4 offset:4096
    ds_read_b128 v[52:55], v4 offset:4352
    ds_read_b128 v[56:59], v4 offset:6144
    ds_read_b128 v[60:63], v4 offset:6400
    s_waitcnt lgkmcnt(8)
    s_branch L_g_loop0_56
L_g_ex0_71:
    s_cmp_lg_u32 s44, 0
    s_cbranch_scc1 L_g_ex0_71_n
    s_sleep 6
    s_add_u32 s54, s60, 0
    s_add_u32 s55, s54, 0
    s_and_b32 s46, s55, 7
    s_lshl_b32 s46, s46, 9
    buffer_load_dword v11, v7, s[12:15], s46 offen sc1
    s_add_u32 s55, s54, 1
    s_and_b32 s46, s55, 7
    s_lshl_b32 s46, s46, 9
    buffer_load_dword v12, v7, s[12:15], s46 offen sc1
    s_add_u32 s55, s54, 2
    s_and_b32 s46, s55, 7
    s_lshl_b32 s46, s46, 9
    buffer_load_dword v13, v7, s[12:15], s46 offen sc1
    s_waitcnt vmcnt(0)
    s_mov_b32 s46, s54
    v_cmp_ge_u32 vcc, s46, v11
    s_nop 0
    s_cbranch_vccnz L_g_le_75
    s_add_u32 s46, s46, 1
    v_cmp_ge_u32 vcc, s46, v12
    s_nop 0
    s_cbranch_vccnz L_g_le_75
    s_add_u32 s46, s46, 1
    v_cmp_ge_u32 vcc, s46, v13
    s_nop 0
    s_cbranch_vccnz L_g_le_75
    s_add_u32 s46, s46, 1
L_g_le_75:
    v_mov_b32 v11, s46
    ds_write_b32 v15, v11
L_g_ex0_71_n:
    s_waitcnt lgkmcnt(0)
    s_barrier
    ds_read_b32 v14, v15
    s_waitcnt lgkmcnt(0)
    v_readfirstlane_b32 s66, v14
    s_barrier
    s_cmp_gt_u32 s66, s60
    s_cbranch_scc1 L_g_restart_53_go
    s_branch L_g_tail_58
L_g_g1r_55:
    s_mov_b32 s65, 1
    s_branch L_g_loop1_57_e
.p2align 6
L_g_loop1_57:
    s_mov_b32 s65, 0
L_g_loop1_57_e:
    s_barrier
    ds_read_b32 v14, v15
    s_bitcmp1_b32 s67, 1
    s_cbranch_scc0 L_g_nfl_76
    s_sub_u32 s59, s60, 2
    s_cmp_lg_u32 s44, 4
    s_cbranch_scc1 L_sf_81
    v_mov_b32 v10, s59
    v_add_u32 v10, 1, v10
    v_mov_b32 v11, 0
    s_mov_b64 exec, 1
    buffer_store_dword v10, v11, s[12:15], s52 offen sc1
    s_mov_b64 exec, -1
L_sf_81:
L_g_nfl_76:
    s_cmp_eq_u32 s71, 0
    s_cbranch_scc1 L_g_nfl_76_d
    v_mov_b32 v10, 1
    s_mov_b64 exec, 1
    s_waitcnt vmcnt(0)
    ds_add_rtn_u32 v10, v15, v10 offset:4
    s_waitcnt lgkmcnt(0)
    v_readfirstlane_b32 s46, v10
    s_mov_b64 exec, -1
    s_mov_b32 s71, 0
    s_sub_u32 s59, s60, 1
    s_cmp_lg_u32 s46, s68
    s_cbranch_scc1 L_g_df_82
    v_mov_b32 v10, s59
    v_add_u32 v10, 1, v10
    v_mov_b32 v11, 0
    s_mov_b64 exec, 1
    buffer_store_dword v10, v11, s[12:15], s52 offen sc1
    s_mov_b64 exec, -1
L_sf_83:
L_g_df_82:
    s_add_u32 s68, s68, 4
    s_mov_b32 s65, 2
L_g_nfl_76_d:
    s_waitcnt lgkmcnt(0)
    v_readfirstlane_b32 s66, v14
    s_nop 3
    s_mov_b32 s69, 0
    s_cmp_gt_u32 s62, s60
    s_cbranch_scc1 L_g_nd_84
    s_cmp_ge_u32 s62, s66
    s_cbranch_scc1 L_g_nd_84
    s_add_u32 s47, s61, 4096
    s_add_u32 m0, s64, 0
    s_nop 0
    buffer_load_dwordx4 v3, s[12:15], s61 offen offset:0 sc1 lds
    buffer_load_dwordx4 v3, s[12:15], s61 offen offset:1024 sc1 lds
    buffer_load_dwordx4 v3, s[12:15], s61 offen offset:2048 sc1 lds
    buffer_load_dwordx4 v3, s[12:15], s61 offen offset:3072 sc1 lds
    s_add_u32 m0, s64, 4096
    s_nop 0
    buffer_load_dwordx4 v3, s[12:15], s47 offen offset:0 sc1 lds
    buffer_load_dwordx4 v3, s[12:15], s47 offen offset:1024 sc1 lds
    buffer_load_dwordx4 v3, s[12:15], s47 offen offset:2048 sc1 lds
    buffer_load_dwordx4 v3, s[12:15], s47 offen offset:3072 sc1 lds
    s_add_u32 s61, s61, 65536
    s_add_u32 s62, s62, 1
    s_xor_b32 s64, s64, 0x10000
    s_mov_b32 s69, 1
L_g_nd_84:
    s_or_b32 s65, s65, s69
    s_add_u32 s59, s60, 1
    s_mov_b32 s69, 0
    s_cmp_gt_u32 s62, s59
    s_cbranch_scc1 L_g_nd_85
    s_cmp_ge_u32 s62, s66
    s_cbranch_scc1 L_g_nd_85
    s_add_u32 s47, s61, 4096
    s_add_u32 m0, s64, 0
    s_nop 0
    buffer_load_dwordx4 v3, s[12:15], s61 offen offset:0 sc1 lds
    buffer_load_dwordx4 v3, s[12:15], s61 offen offset:1024 sc1 lds
    buffer_load_dwordx4 v3, s[12:15], s61 offen offset:2048 sc1 lds
    buffer_load_dwordx4 v3, s[12:15], s61 offen offset:3072 sc1 lds
    s_add_u32 m0, s64, 4096
    s_nop 0
    buffer_load_dwordx4 v3, s[12:15], s47 offen offset:0 sc1 lds
    buffer_load_dwordx4 v3, s[12:15], s47 offen offset:1024 sc1 lds
    buffer_load_dwordx4 v3, s[12:15], s47 offen offset:2048 sc1 lds
    buffer_load_dwordx4 v3, s[12:15], s47 offen offset:3072 sc1 lds
    s_add_u32 s61, s61, 65536
    s_add_u32 s62, s62, 1
    s_xor_b32 s64, s64, 0x10000
    s_mov_b32 s69, 1
L_g_nd_85:
    s_bitcmp1_b32 s67, 0
    s_cbranch_scc0 L_g_nep_77
    ds_read_b128 v[80:83], v5 offset:0
    ds_read_b128 v[84:87], v5 offset:1024
    ds_read_b128 v[88:91], v5 offset:2048
    ds_read_b128 v[92:95], v5 offset:3072
    s_nop 7
    s_waitcnt lgkmcnt(3)
    v_add_f32 v80, v80, v16
    v_add_f32 v81, v81, v17
    v_add_f32 v82, v82, v18
    v_add_f32 v83, v83, v19
    s_waitcnt lgkmcnt(2)
    v_add_f32 v84, v84, v20
    v_add_f32 v85, v85, v21
    v_add_f32 v86, v86, v22
    v_add_f32 v87, v87, v23
    s_waitcnt lgkmcnt(1)
    v_add_f32 v88, v88, v24
    v_add_f32 v89, v89, v25
    v_add_f32 v90, v90, v26
    v_add_f32 v91, v91, v27
    s_waitcnt lgkmcnt(0)
    v_add_f32 v92, v92, v28
    v_add_f32 v93, v93, v29
    v_add_f32 v94, v94, v30
    v_add_f32 v95, v95, v31
    v_cvt_pk_bf16_f32 v104, v80, v81
    v_cvt_pk_bf16_f32 v105, v82, v83
    v_cvt_pk_bf16_f32 v106, v84, v85
    v_cvt_pk_bf16_f32 v107, v86, v87
    buffer_store_dwordx4 v[104:107], v8, s[12:15], s63 offen sc1
    v_cvt_pk_bf16_f32 v108, v88, v89
    v_cvt_pk_bf16_f32 v109, v90, v91
    v_cvt_pk_bf16_f32 v110, v92, v93
    v_cvt_pk_bf16_f32 v111, v94, v95
    buffer_store_dwordx4 v[108:111], v9, s[12:15], s63 offen sc1
    s_add_u32 s63, s63, 786432
    s_cmp_eq_u32 s53, 0
    s_cbranch_scc1 L_g_pf_86
    buffer_store_dwordx4 v[116:119], v64, s[12:15], s58 offen sc1
L_g_pf_86:
    s_add_u32 s58, s58, 131072
L_g_nep_77:
    s_cmp_eq_u32 s65, 0
    s_cbranch_scc1 L_g_nw1_78
    s_cmp_eq_u32 s65, 2
    s_cbranch_scc1 L_g_nw1_78_w
    s_waitcnt vmcnt(0)
L_g_nw1_78_w:
    s_barrier
    ds_read_b128 v[32:35], v4 offset:0
    ds_read_b128 v[36:39], v4 offset:256
    ds_read_b128 v[40:43], v4 offset:2048
    ds_read_b128 v[44:47], v4 offset:2304
    ds_read_b128 v[48:51], v4 offset:4096
    ds_read_b128 v[52:55], v4 offset:4352
    ds_read_b128 v[56:59], v4 offset:6144
    ds_read_b128 v[60:63], v4 offset:6400
    s_branch L_g_jn_80
L_g_nw1_78:
    ds_read_b128 v[32:35], v4 offset:0
    ds_read_b128 v[36:39], v4 offset:256
    ds_read_b128 v[40:43], v4 offset:2048
    ds_read_b128 v[44:47], v4 offset:2304
    ds_read_b128 v[48:51], v4 offset:4096
    ds_read_b128 v[52:55], v4 offset:4352
    ds_read_b128 v[56:59], v4 offset:6144
    ds_read_b128 v[60:63], v4 offset:6400
    s_barrier
L_g_jn_80:
    s_setprio 1
    s_waitcnt lgkmcnt(7)
    v_mfma_f32_16x16x32_bf16 v[16:19], a[0:3], v[32:35], 0
    v_mfma_f32_16x16x32_bf16 v[20:23], a[4:7], v[32:35], 0
    ds_read_b128 v[32:35], v4 offset:8192
    s_waitcnt lgkmcnt(7)
    v_mfma_f32_16x16x32_bf16 v[24:27], a[0:3], v[36:39], 0
    v_mfma_f32_16x16x32_bf16 v[28:31], a[4:7], v[36:39], 0
    ds_read_b128 v[36:39], v4 offset:8448
    s_waitcnt lgkmcnt(7)
    v_mfma_f32_16x16x32_bf16 v[16:19], a[8:11], v[40:43], v[16:19]
    v_mfma_f32_16x16x32_bf16 v[20:23], a[12:15], v[40:43], v[20:23]
    ds_read_b128 v[40:43], v4 offset:10240
    s_waitcnt lgkmcnt(7)
    v_mfma_f32_16x16x32_bf16 v[24:27], a[8:11], v[44:47], v[24:27]
    v_mfma_f32_16x16x32_bf16 v[28:31], a[12:15], v[44:47], v[28:31]
    ds_read_b128 v[44:47], v4 offset:10496
    s_waitcnt lgkmcnt(7)
    v_mfma_f32_16x16x32_bf16 v[16:19], a[16:19], v[48:51], v[16:19]
    v_mfma_f32_16x16x32_bf16 v[20:23], a[20:23], v[48:51], v[20:23]
    ds_read_b128 v[48:51], v4 offset:12288
    s_waitcnt lgkmcnt(7)
    v_mfma_f32_16x16x32_bf16 v[24:27], a[16:19], v[52:55], v[24:27]
    v_mfma_f32_16x16x32_bf16 v[28:31], a[20:23], v[52:55], v[28:31]
    ds_read_b128 v[52:55], v4 offset:12544
    s_waitcnt lgkmcnt(7)
    v_mfma_f32_16x16x32_bf16 v[16:19], a[24:27], v[56:59], v[16:19]
    v_mfma_f32_16x16x32_bf16 v[20:23], a[28:31], v[56:59], v[20:23]
    ds_read_b128 v[56:59], v4 offset:14336
    s_waitcnt lgkmcnt(7)
    v_mfma_f32_16x16x32_bf16 v[24:27], a[24:27], v[60:63], v[24:27]
    v_mfma_f32_16x16x32_bf16 v[28:31], a[28:31], v[60:63], v[28:31]
    ds_read_b128 v[60:63], v4 offset:14592
    s_waitcnt lgkmcnt(7)
    v_mfma_f32_16x16x32_bf16 v[16:19], a[32:35], v[32:35], v[16:19]
    v_mfma_f32_16x16x32_bf16 v[20:23], a[36:39], v[32:35], v[20:23]
    ds_read_b128 v[32:35], v4 offset:16384
    s_waitcnt lgkmcnt(7)
    v_mfma_f32_16x16x32_bf16 v[24:27], a[32:35], v[36:39], v[24:27]
    v_mfma_f32_16x16x32_bf16 v[28:31], a[36:39], v[36:39], v[28:31]
    ds_read_b128 v[36:39], v4 offset:16640
    s_waitcnt lgkmcnt(7)
    v_mfma_f32_16x16x32_bf16 v[16:19], a[40:43], v[40:43], v[16:19]
    v_mfma_f32_16x16x32_bf16 v[20:23], a[44:47], v[40:43], v[20:23]
    ds_read_b128 v[40:43], v4 offset:18432
    s_waitcnt lgkmcnt(7)
    v_mfma_f32_16x16x32_bf16 v[24:27], a[40:43], v[44:47], v[24:27]
    v_mfma_f32_16x16x32_bf16 v[28:31], a[44:47], v[44:47], v[28:31]
    ds_read_b128 v[44:47], v4 offset:18688
    s_waitcnt lgkmcnt(7)
    v_mfma_f32_16x16x32_bf16 v[16:19], a[48:51], v[48:51], v[16:19]
    v_mfma_f32_16x16x32_bf16 v[20:23], a[52:55], v[48:51], v[20:23]
    ds_read_b128 v[48:51], v4 offset:20480
    s_waitcnt lgkmcnt(7)
    v_mfma_f32_16x16x32_bf16 v[24:27], a[48:51], v[52:55], v[24:27]
    v_mfma_f32_16x16x32_bf16 v[28:31], a[52:55], v[52:55], v[28:31]
    ds_read_b128 v[52:55], v4 offset:20736
    s_waitcnt lgkmcnt(7)
    v_mfma_f32_16x16x32_bf16 v[16:19], a[56:59], v[56:59], v[16:19]
    v_mfma_f32_16x16x32_bf16 v[20:23], a[60:63], v[56:59], v[20:23]
    ds_read_b128 v[56:59], v4 offset:22528
    s_waitcnt lgkmcnt(7)
    v_mfma_f32_16x16x32_bf16 v[24:27], a[56:59], v[60:63], v[24:27]
    v_mfma_f32_16x16x32_bf16 v[28:31], a[60:63], v[60:63], v[28:31]
    ds_read_b128 v[60:63], v4 offset:22784
    s_waitcnt lgkmcnt(7)
    v_mfma_f32_16x16x32_bf16 v[16:19], a[64:67], v[32:35], v[16:19]
    v_mfma_f32_16x16x32_bf16 v[20:23], a[68:71], v[32:35], v[20:23]
    ds_read_b128 v[32:35], v4 offset:24576
    s_waitcnt lgkmcnt(7)
    v_mfma_f32_16x16x32_bf16 v[24:27], a[64:67], v[36:39], v[24:27]
    v_mfma_f32_16x16x32_bf16 v[28:31], a[68:71], v[36:39], v[28:31]
    ds_read_b128 v[36:39], v4 offset:24832
    s_waitcnt lgkmcnt(7)
    v_mfma_f32_16x16x32_bf16 v[16:19], a[72:75], v[40:43], v[16:19]
    v_mfma_f32_16x16x32_bf16 v[20:23], a[76:79], v[40:43], v[20:23]
    ds_read_b128 v[40:43], v4 offset:26624
    s_waitcnt lgkmcnt(7)
    v_mfma_f32_16x16x32_bf16 v[24:27], a[72:75], v[44:47], v[24:27]
    v_mfma_f32_16x16x32_bf16 v[28:31], a[76:79], v[44:47], v[28:31]
    ds_read_b128 v[44:47], v4 offset:26880
    s_waitcnt lgkmcnt(7)
    v_mfma_f32_16x16x32_bf16 v[16:19], a[80:83], v[48:51], v[16:19]
    v_mfma_f32_16x16x32_bf16 v[20:23], a[84:87], v[48:51], v[20:23]
    ds_read_b128 v[48:51], v4 offset:28672
    s_waitcnt lgkmcnt(7)
    v_mfma_f32_16x16x32_bf16 v[24:27], a[80:83], v[52:55], v[24:27]
    v_mfma_f32_16x16x32_bf16 v[28:31], a[84:87], v[52:55], v[28:31]
    ds_read_b128 v[52:55], v4 offset:28928
    s_waitcnt lgkmcnt(7)
    v_mfma_f32_16x16x32_bf16 v[16:19], a[88:91], v[56:59], v[16:19]
    v_mfma_f32_16x16x32_bf16 v[20:23], a[92:95], v[56:59], v[20:23]
    ds_read_b128 v[56:59], v4 offset:30720
    s_waitcnt lgkmcnt(7)
    v_mfma_f32_16x16x32_bf16 v[24:27], a[88:91], v[60:63], v[24:27]
    v_mfma_f32_16x16x32_bf16 v[28:31], a[92:95], v[60:63], v[28:31]
    ds_read_b128 v[60:63], v4 offset:30976
    s_waitcnt lgkmcnt(7)
    v_mfma_f32_16x16x32_bf16 v[16:19], a[96:99], v[32:35], v[16:19]
    v_mfma_f32_16x16x32_bf16 v[20:23], a[100:103], v[32:35], v[20:23]
    s_waitcnt lgkmcnt(6)
    v_mfma_f32_16x16x32_bf16 v[24:27], a[96:99], v[36:39], v[24:27]
    v_mfma_f32_16x16x32_bf16 v[28:31], a[100:103], v[36:39], v[28:31]
    s_waitcnt lgkmcnt(5)
    v_mfma_f32_16x16x32_bf16 v[16:19], a[104:107], v[40:43], v[16:19]
    v_mfma_f32_16x16x32_bf16 v[20:23], a[108:111], v[40:43], v[20:23]
    s_waitcnt lgkmcnt(4)
    v_mfma_f32_16x16x32_bf16 v[24:27], a[104:107], v[44:47], v[24:27]
    v_mfma_f32_16x16x32_bf16 v[28:31], a[108:111], v[44:47], v[28:31]
    s_waitcnt lgkmcnt(3)
    v_mfma_f32_16x16x32_bf16 v[16:19], a[112:115], v[48:51], v[16:19]
    v_mfma_f32_16x16x32_bf16 v[20:23], a[116:119], v[48:51], v[20:23]
    s_waitcnt lgkmcnt(2)
    v_mfma_f32_16x16x32_bf16 v[24:27], a[112:115], v[52:55], v[24:27]
    v_mfma_f32_16x16x32_bf16 v[28:31], a[116:119], v[52:55], v[28:31]
    s_waitcnt lgkmcnt(1)
    v_mfma_f32_16x16x32_bf16 v[16:19], a[120:123], v[56:59], v[16:19]
    v_mfma_f32_16x16x32_bf16 v[20:23], a[124:127], v[56:59], v[20:23]
    s_waitcnt lgkmcnt(0)
    v_mfma_f32_16x16x32_bf16 v[24:27], a[120:123], v[60:63], v[24:27]
    v_mfma_f32_16x16x32_bf16 v[28:31], a[124:127], v[60:63], v[28:31]
    v_xor_b32 v4, 0x10000, v4
    s_setprio 0
    s_waitcnt vmcnt(0)
    s_lshl_b32 s67, s67, 1
    s_or_b32 s67, s67, 1
    s_add_u32 s60, s60, 1
    s_cmp_gt_u32 s66, s60
    s_cbranch_scc1 L_g_loop1_57
    s_barrier
    ds_read_b32 v14, v15
    s_waitcnt lgkmcnt(0)
    v_readfirstlane_b32 s66, v14
    s_barrier
    s_mov_b32 s69, 0
    s_cmp_gt_u32 s62, s60
    s_cbranch_scc1 L_g_nd_87
    s_cmp_ge_u32 s62, s66
    s_cbranch_scc1 L_g_nd_87
    s_add_u32 s47, s61, 4096
    s_add_u32 m0, s64, 0
    s_nop 0
    buffer_load_dwordx4 v3, s[12:15], s61 offen offset:0 sc1 lds
    buffer_load_dwordx4 v3, s[12:15], s61 offen offset:1024 sc1 lds
    buffer_load_dwordx4 v3, s[12:15], s61 offen offset:2048 sc1 lds
    buffer_load_dwordx4 v3, s[12:15], s61 offen offset:3072 sc1 lds
    s_add_u32 m0, s64, 4096
    s_nop 0
    buffer_load_dwordx4 v3, s[12:15], s47 offen offset:0 sc1 lds
    buffer_load_dwordx4 v3, s[12:15], s47 offen offset:1024 sc1 lds
    buffer_load_dwordx4 v3, s[12:15], s47 offen offset:2048 sc1 lds
    buffer_load_dwordx4 v3, s[12:15], s47 offen offset:3072 sc1 lds
    s_add_u32 s61, s61, 65536
    s_add_u32 s62, s62, 1
    s_xor_b32 s64, s64, 0x10000
    s_mov_b32 s69, 1
L_g_nd_87:
    s_sub_u32 s59, s60, 1
    ds_read_b128 v[80:83], v5 offset:0
    ds_read_b128 v[84:87], v5 offset:1024
    ds_read_b128 v[88:91], v5 offset:2048
    ds_read_b128 v[92:95], v5 offset:3072
    s_nop 7
    s_waitcnt lgkmcnt(3)
    v_add_f32 v80, v80, v16
    v_add_f32 v81, v81, v17
    v_add_f32 v82, v82, v18
    v_add_f32 v83, v83, v19
    s_waitcnt lgkmcnt(2)
    v_add_f32 v84, v84, v20
    v_add_f32 v85, v85, v21
    v_add_f32 v86, v86, v22
    v_add_f32 v87, v87, v23
    s_waitcnt lgkmcnt(1)
    v_add_f32 v88, v88, v24
    v_add_f32 v89, v89, v25
    v_add_f32 v90, v90, v26
    v_add_f32 v91, v91, v27
    s_waitcnt lgkmcnt(0)
    v_add_f32 v92, v92, v28
    v_add_f32 v93, v93, v29
    v_add_f32 v94, v94, v30
    v_add_f32 v95, v95, v31
    v_cvt_pk_bf16_f32 v104, v80, v81
    v_cvt_pk_bf16_f32 v105, v82, v83
    v_cvt_pk_bf16_f32 v106, v84, v85
    v_cvt_pk_bf16_f32 v107, v86, v87
    buffer_store_dwordx4 v[104:107], v8, s[12:15], s63 offen sc1
    v_cvt_pk_bf16_f32 v108, v88, v89
    v_cvt_pk_bf16_f32 v109, v90, v91
    v_cvt_pk_bf16_f32 v110, v92, v93
    v_cvt_pk_bf16_f32 v111, v94, v95
    buffer_store_dwordx4 v[108:111], v9, s[12:15], s63 offen sc1
    s_add_u32 s63, s63, 786432
    s_cmp_eq_u32 s53, 0
    s_cbranch_scc1 L_g_pf_88
    buffer_store_dwordx4 v[116:119], v64, s[12:15], s58 offen sc1
L_g_pf_88:
    s_add_u32 s58, s58, 131072
    s_mov_b32 s67, 0
    s_mov_b32 s71, 1
    s_cmp_gt_u32 s66, s60
    s_cbranch_scc1 L_g_g1r_55
    v_mov_b32 v10, 1
    s_mov_b64 exec, 1
    s_waitcnt vmcnt(0)
    ds_add_rtn_u32 v10, v15, v10 offset:4
    s_waitcnt lgkmcnt(0)
    v_readfirstlane_b32 s46, v10
    s_mov_b64 exec, -1
    s_mov_b32 s71, 0
    s_sub_u32 s59, s60, 1
    s_cmp_lg_u32 s46, s68
    s_cbranch_scc1 L_g_df_89
    v_mov_b32 v10, s59
    v_add_u32 v10, 1, v10
    v_mov_b32 v11, 0
    s_mov_b64 exec, 1
    buffer_store_dword v10, v11, s[12:15], s52 offen sc1
    s_mov_b64 exec, -1
L_sf_90:
L_g_df_89:
    s_add_u32 s68, s68, 4
    s_cmp_gt_u32 s66, s60
    s_cbranch_scc1 L_g_g1r_55
L_g_tail_58:
    s_cmp_lt_u32 s60, 64
    s_cbranch_scc1 L_g_restart_53
    s_barrier
    s_branch L_w_p2_9
L_w_p2_9:
    s_lshr_b32 s42, s40, 1
    s_and_b32 s43, s40, 1
    s_lshl_b32 s43, s43, 2
    s_and_b32 s46, s48, 3
    s_add_u32 s43, s43, s46
    s_cmp_lt_u32 s48, 4
    s_cbranch_scc1 L_w_wo_10
    s_cmp_lt_u32 s48, 8
    s_cbranch_scc1 L_w_f2_11
    s_cmp_lg_u32 s43, 7
    s_cbranch_scc1 L_w_f1_12
    s_mov_b32 s43, 2
    s_branch L_w_c_14
L_w_f1_12:
    s_load_dwordx2 s[4:5], s[0:1], 64
    s_load_dwordx2 s[6:7], s[0:1], 72
    s_and_b32 s50, s44, 3
    s_lshr_b32 s51, s44, 2
    s_waitcnt lgkmcnt(0)
    s_mov_b32 s24, s4
    s_and_b32 s25, s5, 0xffff
    s_mov_b32 s26, 0x700000
    s_mov_b32 s27, 0x00020000
    s_mul_i32 s49, s42, 7
    s_add_u32 s49, s49, s43
    v_lshrrev_b32 v3, 4, v1
    v_and_b32 v4, 15, v1
    v_lshlrev_b32 v5, 2, v3
    v_xor_b32 v4, v4, v5
    v_mul_u32_u24 v3, 7168, v3
    v_lshl_add_u32 v3, v4, 4, v3
    s_mul_i32 s46, s51, 512
    s_mul_i32 s47, s50, 64
    s_add_u32 s46, s46, s47
    s_mul_i32 s46, s46, 7168
    s_lshl_b32 s47, s49, 8
    s_add_u32 s46, s46, s47
    s_lshl_b32 s45, s51, 16
    s_mul_i32 s47, s50, 16384
    s_add_u32 s45, s45, s47
    v_bfe_u32 v4, v1, 2, 2
    v_bfe_u32 v5, v1, 4, 1
    v_lshlrev_b32 v5, 1, v5
    v_bfe_u32 v6, v1, 1, 1
    v_add_u32 v5, v5, v6
    s_lshl_b32 s47, s50, 2
    v_add_u32 v5, s47, v5
    v_lshlrev_b32 v6, 2, v4
    v_xor_b32 v5, v5, v6
    v_lshlrev_b32 v5, 4, v5
    v_lshl_add_u32 v5, v4, 8, v5
    v_bfe_u32 v6, v1, 0, 1
    v_lshl_add_u32 v5, v6, 3, v5
    v_lshrrev_b32 v6, 5, v1
    v_mul_u32_u24 v6, 2048, v6
    v_add_u32 v5, v5, v6
    s_lshl_b32 s47, s51, 16
    v_add_u32 v5, s47, v5
    v_bfe_u32 v4, v1, 2, 2
    v_xor_b32 v5, s50, v4
    v_lshlrev_b32 v5, 6, v5
    v_lshl_add_u32 v5, v4, 8, v5
    v_and_b32 v6, 3, v1
    v_lshl_add_u32 v5, v6, 3, v5
    v_lshrrev_b32 v6, 4, v1
    v_lshl_add_u32 v5, v6, 11, v5
    s_lshl_b32 s47, s51, 16
    v_add_u32 v5, s47, v5
    s_add_u32 m0, s45, 0
    s_add_u32 s47, s46, 0x0
    buffer_load_dwordx4 v3, s[24:27], s47 offen lds
    s_add_u32 m0, s45, 1024
    s_add_u32 s47, s46, 0x7000
    buffer_load_dwordx4 v3, s[24:27], s47 offen lds
    s_add_u32 m0, s45, 2048
    s_add_u32 s47, s46, 0xe000
    buffer_load_dwordx4 v3, s[24:27], s47 offen lds
    s_add_u32 m0, s45, 3072
    s_add_u32 s47, s46, 0x15000
    buffer_load_dwordx4 v3, s[24:27], s47 offen lds
    s_add_u32 m0, s45, 4096
    s_add_u32 s47, s46, 0x1c000
    buffer_load_dwordx4 v3, s[24:27], s47 offen lds
    s_add_u32 m0, s45, 5120
    s_add_u32 s47, s46, 0x23000
    buffer_load_dwordx4 v3, s[24:27], s47 offen lds
    s_add_u32 m0, s45, 6144
    s_add_u32 s47, s46, 0x2a000
    buffer_load_dwordx4 v3, s[24:27], s47 offen lds
    s_add_u32 m0, s45, 7168
    s_add_u32 s47, s46, 0x31000
    buffer_load_dwordx4 v3, s[24:27], s47 offen lds
    s_add_u32 m0, s45, 8192
    s_add_u32 s47, s46, 0x38000
    buffer_load_dwordx4 v3, s[24:27], s47 offen lds
    s_add_u32 m0, s45, 9216
    s_add_u32 s47, s46, 0x3f000
    buffer_load_dwordx4 v3, s[24:27], s47 offen lds
    s_add_u32 m0, s45, 10240
    s_add_u32 s47, s46, 0x46000
    buffer_load_dwordx4 v3, s[24:27], s47 offen lds
    s_add_u32 m0, s45, 11264
    s_add_u32 s47, s46, 0x4d000
    buffer_load_dwordx4 v3, s[24:27], s47 offen lds
    s_add_u32 m0, s45, 12288
    s_add_u32 s47, s46, 0x54000
    buffer_load_dwordx4 v3, s[24:27], s47 offen lds
    s_add_u32 m0, s45, 13312
    s_add_u32 s47, s46, 0x5b000
    buffer_load_dwordx4 v3, s[24:27], s47 offen lds
    s_add_u32 m0, s45, 14336
    s_add_u32 s47, s46, 0x62000
    buffer_load_dwordx4 v3, s[24:27], s47 offen lds
    s_add_u32 m0, s45, 15360
    s_add_u32 s47, s46, 0x69000
    buffer_load_dwordx4 v3, s[24:27], s47 offen lds
    s_waitcnt vmcnt(0)
    s_barrier
    ds_read_b64_tr_b16 a[0:1], v5 offset:0
    ds_read_b64_tr_b16 a[2:3], v5 offset:1024
    ds_read_b64_tr_b16 a[4:5], v5 offset:32
    ds_read_b64_tr_b16 a[6:7], v5 offset:1056
    ds_read_b64_tr_b16 a[8:9], v5 offset:8192
    ds_read_b64_tr_b16 a[10:11], v5 offset:9216
    ds_read_b64_tr_b16 a[12:13], v5 offset:8224
    ds_read_b64_tr_b16 a[14:15], v5 offset:9248
    s_waitcnt lgkmcnt(0)
    ds_read_b64_tr_b16 a[16:17], v5 offset:16384
    ds_read_b64_tr_b16 a[18:19], v5 offset:17408
    ds_read_b64_tr_b16 a[20:21], v5 offset:16416
    ds_read_b64_tr_b16 a[22:23], v5 offset:17440
    ds_read_b64_tr_b16 a[24:25], v5 offset:24576
    ds_read_b64_tr_b16 a[26:27], v5 offset:25600
    ds_read_b64_tr_b16 a[28:29], v5 offset:24608
    ds_read_b64_tr_b16 a[30:31], v5 offset:25632
    s_waitcnt lgkmcnt(0)
    ds_read_b64_tr_b16 a[32:33], v5 offset:32768
    ds_read_b64_tr_b16 a[34:35], v5 offset:33792
    ds_read_b64_tr_b16 a[36:37], v5 offset:32800
    ds_read_b64_tr_b16 a[38:39], v5 offset:33824
    ds_read_b64_tr_b16 a[40:41], v5 offset:40960
    ds_read_b64_tr_b16 a[42:43], v5 offset:41984
    ds_read_b64_tr_b16 a[44:45], v5 offset:40992
    ds_read_b64_tr_b16 a[46:47], v5 offset:42016
    s_waitcnt lgkmcnt(0)
    ds_read_b64_tr_b16 a[48:49], v5 offset:49152
    ds_read_b64_tr_b16 a[50:51], v5 offset:50176
    ds_read_b64_tr_b16 a[52:53], v5 offset:49184
    ds_read_b64_tr_b16 a[54:55], v5 offset:50208
    ds_read_b64_tr_b16 a[56:57], v5 offset:57344
    ds_read_b64_tr_b16 a[58:59], v5 offset:58368
    ds_read_b64_tr_b16 a[60:61], v5 offset:57376
    ds_read_b64_tr_b16 a[62:63], v5 offset:58400
    s_waitcnt lgkmcnt(0)
    s_waitcnt lgkmcnt(0)
    s_barrier
    s_add_u32 m0, s45, 0
    s_add_u32 s47, s46, 0x1c0000
    buffer_load_dwordx4 v3, s[24:27], s47 offen lds
    s_add_u32 m0, s45, 1024
    s_add_u32 s47, s46, 0x1c7000
    buffer_load_dwordx4 v3, s[24:27], s47 offen lds
    s_add_u32 m0, s45, 2048
    s_add_u32 s47, s46, 0x1ce000
    buffer_load_dwordx4 v3, s[24:27], s47 offen lds
    s_add_u32 m0, s45, 3072
    s_add_u32 s47, s46, 0x1d5000
    buffer_load_dwordx4 v3, s[24:27], s47 offen lds
    s_add_u32 m0, s45, 4096
    s_add_u32 s47, s46, 0x1dc000
    buffer_load_dwordx4 v3, s[24:27], s47 offen lds
    s_add_u32 m0, s45, 5120
    s_add_u32 s47, s46, 0x1e3000
    buffer_load_dwordx4 v3, s[24:27], s47 offen lds
    s_add_u32 m0, s45, 6144
    s_add_u32 s47, s46, 0x1ea000
    buffer_load_dwordx4 v3, s[24:27], s47 offen lds
    s_add_u32 m0, s45, 7168
    s_add_u32 s47, s46, 0x1f1000
    buffer_load_dwordx4 v3, s[24:27], s47 offen lds
    s_add_u32 m0, s45, 8192
    s_add_u32 s47, s46, 0x1f8000
    buffer_load_dwordx4 v3, s[24:27], s47 offen lds
    s_add_u32 m0, s45, 9216
    s_add_u32 s47, s46, 0x1ff000
    buffer_load_dwordx4 v3, s[24:27], s47 offen lds
    s_add_u32 m0, s45, 10240
    s_add_u32 s47, s46, 0x206000
    buffer_load_dwordx4 v3, s[24:27], s47 offen lds
    s_add_u32 m0, s45, 11264
    s_add_u32 s47, s46, 0x20d000
    buffer_load_dwordx4 v3, s[24:27], s47 offen lds
    s_add_u32 m0, s45, 12288
    s_add_u32 s47, s46, 0x214000
    buffer_load_dwordx4 v3, s[24:27], s47 offen lds
    s_add_u32 m0, s45, 13312
    s_add_u32 s47, s46, 0x21b000
    buffer_load_dwordx4 v3, s[24:27], s47 offen lds
    s_add_u32 m0, s45, 14336
    s_add_u32 s47, s46, 0x222000
    buffer_load_dwordx4 v3, s[24:27], s47 offen lds
    s_add_u32 m0, s45, 15360
    s_add_u32 s47, s46, 0x229000
    buffer_load_dwordx4 v3, s[24:27], s47 offen lds
    s_waitcnt vmcnt(0)
    s_barrier
    ds_read_b64_tr_b16 a[64:65], v5 offset:0
    ds_read_b64_tr_b16 a[66:67], v5 offset:1024
    ds_read_b64_tr_b16 a[68:69], v5 offset:32
    ds_read_b64_tr_b16 a[70:71], v5 offset:1056
    ds_read_b64_tr_b16 a[72:73], v5 offset:8192
    ds_read_b64_tr_b16 a[74:75], v5 offset:9216
    ds_read_b64_tr_b16 a[76:77], v5 offset:8224
    ds_read_b64_tr_b16 a[78:79], v5 offset:9248
    s_waitcnt lgkmcnt(0)
    ds_read_b64_tr_b16 a[80:81], v5 offset:16384
    ds_read_b64_tr_b16 a[82:83], v5 offset:17408
    ds_read_b64_tr_b16 a[84:85], v5 offset:16416
    ds_read_b64_tr_b16 a[86:87], v5 offset:17440
    ds_read_b64_tr_b16 a[88:89], v5 offset:24576
    ds_read_b64_tr_b16 a[90:91], v5 offset:25600
    ds_read_b64_tr_b16 a[92:93], v5 offset:24608
    ds_read_b64_tr_b16 a[94:95], v5 offset:25632
    s_waitcnt lgkmcnt(0)
    ds_read_b64_tr_b16 a[96:97], v5 offset:32768
    ds_read_b64_tr_b16 a[98:99], v5 offset:33792
    ds_read_b64_tr_b16 a[100:101], v5 offset:32800
    ds_read_b64_tr_b16 a[102:103], v5 offset:33824
    ds_read_b64_tr_b16 a[104:105], v5 offset:40960
    ds_read_b64_tr_b16 a[106:107], v5 offset:41984
    ds_read_b64_tr_b16 a[108:109], v5 offset:40992
    ds_read_b64_tr_b16 a[110:111], v5 offset:42016
    s_waitcnt lgkmcnt(0)
    ds_read_b64_tr_b16 a[112:113], v5 offset:49152
    ds_read_b64_tr_b16 a[114:115], v5 offset:50176
    ds_read_b64_tr_b16 a[116:117], v5 offset:49184
    ds_read_b64_tr_b16 a[118:119], v5 offset:50208
    ds_read_b64_tr_b16 a[120:121], v5 offset:57344
    ds_read_b64_tr_b16 a[122:123], v5 offset:58368
    ds_read_b64_tr_b16 a[124:125], v5 offset:57376
    ds_read_b64_tr_b16 a[126:127], v5 offset:58400
    s_waitcnt lgkmcnt(0)
    s_waitcnt lgkmcnt(0)
    s_barrier
    v_lshlrev_b32 v2, 4, v1
    s_mul_i32 s64, s44, 8192
    s_add_u32 s46, s64, 0xc00000
    v_add_u32 v3, s46, v2
    s_mul_i32 s46, s51, 32768
    v_add_u32 v4, s46, v2
    v_and_b32 v6, 15, v1
    v_lshlrev_b32 v6, 4, v6
    v_lshrrev_b32 v7, 4, v1
    v_lshl_add_u32 v6, v7, 9, v6
    v_add_u32 v4, s46, v6
    s_lshl_b32 s46, s50, 12
    s_add_u32 s46, s46, 131072
    v_add_u32 v5, s46, v2
    v_and_b32 v7, 3, v1
    v_lshlrev_b32 v7, 7, v7
    v_add_u32 v7, 0x10ec00, v7
    s_lshl_b32 s46, s49, 13
    s_lshl_b32 s47, s50, 11
    s_add_u32 s46, s46, s47
    s_add_u32 s46, s46, 0x6000000
    v_add_u32 v8, s46, v6
    s_lshl_b32 s52, s49, 7
    s_add_u32 s52, s52, 0x106400
    s_mov_b32 s28, s6
    s_and_b32 s29, s7, 0xffff
    s_mov_b32 s30, 0x1c00
    s_mov_b32 s31, 0x00020000
    s_lshl_b32 s46, s49, 8
    s_lshl_b32 s47, s50, 6
    s_add_u32 s46, s46, s47
    v_lshrrev_b32 v9, 4, v1
    v_lshlrev_b32 v9, 3, v9
    buffer_load_dwordx2 v[32:33], v9, s[28:31], s46 offen offset:0
    buffer_load_dwordx2 v[34:35], v9, s[28:31], s46 offen offset:32
    buffer_load_dwordx2 v[36:37], v9, s[28:31], s46 offen offset:0
    buffer_load_dwordx2 v[38:39], v9, s[28:31], s46 offen offset:32
    v_add_u32 v9, 256, v8
    s_mov_b32 s56, 0xbdd2d3e8
    s_mov_b32 s57, 0xbdd2d3e8
    v_mov_b32 v112, 0xc0135761
    v_mov_b32 v113, 0xc0135761
    s_waitcnt vmcnt(0)
    v_lshlrev_b32 v64, 16, v32
    v_and_b32 v65, 0xffff0000, v32
    v_lshlrev_b32 v66, 16, v33
    v_and_b32 v67, 0xffff0000, v33
    v_lshlrev_b32 v68, 16, v34
    v_and_b32 v69, 0xffff0000, v34
    v_lshlrev_b32 v70, 16, v35
    v_and_b32 v71, 0xffff0000, v35
    v_lshlrev_b32 v72, 16, v36
    v_and_b32 v73, 0xffff0000, v36
    v_lshlrev_b32 v74, 16, v37
    v_and_b32 v75, 0xffff0000, v37
    v_lshlrev_b32 v76, 16, v38
    v_and_b32 v77, 0xffff0000, v38
    v_lshlrev_b32 v78, 16, v39
    v_and_b32 v79, 0xffff0000, v39
    s_mov_b32 s60, 0
    s_mov_b32 s61, 0
    s_mov_b32 s62, 0
    s_mov_b32 s63, 0
    s_mov_b32 s67, 0
    s_mov_b32 s68, 3
    s_mov_b32 s71, 0
    v_mov_b32 v15, 147456
    v_mov_b32 v14, 0
    ds_write_b32 v15, v14 offset:4
L_g_restart_91:
    s_cmp_lg_u32 s44, 0
    s_cbranch_scc1 L_g_nsp_92
    s_mov_b32 s70, 0
L_g_sp_98:
    s_add_u32 s54, s60, 0
    s_add_u32 s55, s54, 0
    s_mul_i32 s46, s55, 171
    s_lshr_b32 s46, s46, 9
    s_mul_i32 s46, s46, 3
    s_sub_u32 s46, s55, s46
    s_lshl_b32 s46, s46, 9
    buffer_load_dword v11, v7, s[12:15], s46 offen sc1
    s_add_u32 s55, s54, 1
    s_mul_i32 s46, s55, 171
    s_lshr_b32 s46, s46, 9
    s_mul_i32 s46, s46, 3
    s_sub_u32 s46, s55, s46
    s_lshl_b32 s46, s46, 9
    buffer_load_dword v12, v7, s[12:15], s46 offen sc1
    s_add_u32 s55, s54, 2
    s_mul_i32 s46, s55, 171
    s_lshr_b32 s46, s46, 9
    s_mul_i32 s46, s46, 3
    s_sub_u32 s46, s55, s46
    s_lshl_b32 s46, s46, 9
    buffer_load_dword v13, v7, s[12:15], s46 offen sc1
    s_waitcnt vmcnt(0)
    v_cmp_ge_u32 vcc, s60, v11
    s_add_u32 s70, s70, 1
    s_cbranch_vccz L_g_sp_98_ok
    s_sleep 3
    s_cmp_lt_u32 s70, 524288
    s_cbranch_scc1 L_g_sp_98
    s_branch L_c_done_1
L_g_sp_98_ok:
    s_mov_b32 s46, s54
    v_cmp_ge_u32 vcc, s46, v11
    s_nop 0
    s_cbranch_vccnz L_g_le_99
    s_add_u32 s46, s46, 1
    v_cmp_ge_u32 vcc, s46, v12
    s_nop 0
    s_cbranch_vccnz L_g_le_99
    s_add_u32 s46, s46, 1
    v_cmp_ge_u32 vcc, s46, v13
    s_nop 0
    s_cbranch_vccnz L_g_le_99
    s_add_u32 s46, s46, 1
L_g_le_99:
    v_mov_b32 v11, s46
    ds_write_b32 v15, v11
L_g_nsp_92:
    s_waitcnt lgkmcnt(0)
    s_barrier
    ds_read_b32 v14, v15
    s_waitcnt lgkmcnt(0)
    v_readfirstlane_b32 s66, v14
    s_nop 3
L_g_restart_91_go:
    s_mov_b32 s69, 0
    s_cmp_gt_u32 s62, s60
    s_cbranch_scc1 L_g_nd_100
    s_cmp_ge_u32 s62, s66
    s_cbranch_scc1 L_g_nd_100
    s_add_u32 s47, s61, 4096
    s_add_u32 m0, s64, 0
    s_nop 0
    buffer_load_dwordx4 v3, s[12:15], s61 offen offset:0 sc1 lds
    buffer_load_dwordx4 v3, s[12:15], s61 offen offset:1024 sc1 lds
    buffer_load_dwordx4 v3, s[12:15], s61 offen offset:2048 sc1 lds
    buffer_load_dwordx4 v3, s[12:15], s61 offen offset:3072 sc1 lds
    s_add_u32 m0, s64, 4096
    s_nop 0
    buffer_load_dwordx4 v3, s[12:15], s47 offen offset:0 sc1 lds
    buffer_load_dwordx4 v3, s[12:15], s47 offen offset:1024 sc1 lds
    buffer_load_dwordx4 v3, s[12:15], s47 offen offset:2048 sc1 lds
    buffer_load_dwordx4 v3, s[12:15], s47 offen offset:3072 sc1 lds
    s_add_u32 s61, s61, 65536
    s_add_u32 s62, s62, 1
    s_xor_b32 s64, s64, 0x10000
    s_mov_b32 s69, 1
L_g_nd_100:
    s_cmp_eq_u32 s51, 1
    s_cbranch_scc1 L_g_g1r_93
    s_add_u32 s59, s60, 1
    s_mov_b32 s69, 0
    s_cmp_gt_u32 s62, s59
    s_cbranch_scc1 L_g_nd_101
    s_cmp_ge_u32 s62, s66
    s_cbranch_scc1 L_g_nd_101
    s_add_u32 s47, s61, 4096
    s_add_u32 m0, s64, 0
    s_nop 0
    buffer_load_dwordx4 v3, s[12:15], s61 offen offset:0 sc1 lds
    buffer_load_dwordx4 v3, s[12:15], s61 offen offset:1024 sc1 lds
    buffer_load_dwordx4 v3, s[12:15], s61 offen offset:2048 sc1 lds
    buffer_load_dwordx4 v3, s[12:15], s61 offen offset:3072 sc1 lds
    s_add_u32 m0, s64, 4096
    s_nop 0
    buffer_load_dwordx4 v3, s[12:15], s47 offen offset:0 sc1 lds
    buffer_load_dwordx4 v3, s[12:15], s47 offen offset:1024 sc1 lds
    buffer_load_dwordx4 v3, s[12:15], s47 offen offset:2048 sc1 lds
    buffer_load_dwordx4 v3, s[12:15], s47 offen offset:3072 sc1 lds
    s_add_u32 s61, s61, 65536
    s_add_u32 s62, s62, 1
    s_xor_b32 s64, s64, 0x10000
    s_mov_b32 s69, 1
L_g_nd_101:
    s_cmp_eq_u32 s69, 1
    s_cbranch_scc1 L_g_w0_102
    s_waitcnt vmcnt(0)
L_g_w0_102:
    s_waitcnt vmcnt(8)
    s_mov_b32 s65, 1
.p2align 6
L_g_loop0_94:
    s_barrier
    s_cmp_eq_u32 s65, 0
    s_cbranch_scc1 L_g_pr_103
    ds_read_b128 v[32:35], v4 offset:0
    ds_read_b128 v[36:39], v4 offset:256
    ds_read_b128 v[40:43], v4 offset:2048
    ds_read_b128 v[44:47], v4 offset:2304
    ds_read_b128 v[48:51], v4 offset:4096
    ds_read_b128 v[52:55], v4 offset:4352
    ds_read_b128 v[56:59], v4 offset:6144
    ds_read_b128 v[60:63], v4 offset:6400
L_g_pr_103:
    ds_read_b32 v14, v15
    s_cmp_lg_u32 s44, 0
    s_cbranch_scc1 L_g_nl_104
    s_add_u32 s54, s60, 1
    s_add_u32 s55, s54, 0
    s_mul_i32 s46, s55, 171
    s_lshr_b32 s46, s46, 9
    s_mul_i32 s46, s46, 3
    s_sub_u32 s46, s55, s46
    s_lshl_b32 s46, s46, 9
    buffer_load_dword v11, v7, s[12:15], s46 offen sc1
    s_add_u32 s55, s54, 1
    s_mul_i32 s46, s55, 171
    s_lshr_b32 s46, s46, 9
    s_mul_i32 s46, s46, 3
    s_sub_u32 s46, s55, s46
    s_lshl_b32 s46, s46, 9
    buffer_load_dword v12, v7, s[12:15], s46 offen sc1
    s_add_u32 s55, s54, 2
    s_mul_i32 s46, s55, 171
    s_lshr_b32 s46, s46, 9
    s_mul_i32 s46, s46, 3
    s_sub_u32 s46, s55, s46
    s_lshl_b32 s46, s46, 9
    buffer_load_dword v13, v7, s[12:15], s46 offen sc1
L_g_nl_104:
    s_setprio 1
    s_waitcnt lgkmcnt(7)
    v_mfma_f32_16x16x32_bf16 v[16:19], a[0:3], v[32:35], v[64:67]
    v_mfma_f32_16x16x32_bf16 v[20:23], a[4:7], v[32:35], v[68:71]
    ds_read_b128 v[32:35], v4 offset:8192
    s_waitcnt lgkmcnt(7)
    v_mfma_f32_16x16x32_bf16 v[24:27], a[0:3], v[36:39], v[64:67]
    v_mfma_f32_16x16x32_bf16 v[28:31], a[4:7], v[36:39], v[68:71]
    ds_read_b128 v[36:39], v4 offset:8448
    s_waitcnt lgkmcnt(7)
    v_mfma_f32_16x16x32_bf16 v[16:19], a[8:11], v[40:43], v[16:19]
    v_mfma_f32_16x16x32_bf16 v[20:23], a[12:15], v[40:43], v[20:23]
    ds_read_b128 v[40:43], v4 offset:10240
    s_waitcnt lgkmcnt(7)
    v_mfma_f32_16x16x32_bf16 v[24:27], a[8:11], v[44:47], v[24:27]
    v_mfma_f32_16x16x32_bf16 v[28:31], a[12:15], v[44:47], v[28:31]
    ds_read_b128 v[44:47], v4 offset:10496
    s_waitcnt lgkmcnt(7)
    v_mfma_f32_16x16x32_bf16 v[16:19], a[16:19], v[48:51], v[16:19]
    v_mfma_f32_16x16x32_bf16 v[20:23], a[20:23], v[48:51], v[20:23]
    ds_read_b128 v[48:51], v4 offset:12288
    s_waitcnt lgkmcnt(7)
    v_mfma_f32_16x16x32_bf16 v[24:27], a[16:19], v[52:55], v[24:27]
    v_mfma_f32_16x16x32_bf16 v[28:31], a[20:23], v[52:55], v[28:31]
    ds_read_b128 v[52:55], v4 offset:12544
    s_waitcnt lgkmcnt(7)
    v_mfma_f32_16x16x32_bf16 v[16:19], a[24:27], v[56:59], v[16:19]
    v_mfma_f32_16x16x32_bf16 v[20:23], a[28:31], v[56:59], v[20:23]
    ds_read_b128 v[56:59], v4 offset:14336
    s_waitcnt lgkmcnt(7)
    v_mfma_f32_16x16x32_bf16 v[24:27], a[24:27], v[60:63], v[24:27]
    v_mfma_f32_16x16x32_bf16 v[28:31], a[28:31], v[60:63], v[28:31]
    ds_read_b128 v[60:63], v4 offset:14592
    s_waitcnt lgkmcnt(7)
    v_mfma_f32_16x16x32_bf16 v[16:19], a[32:35], v[32:35], v[16:19]
    v_mfma_f32_16x16x32_bf16 v[20:23], a[36:39], v[32:35], v[20:23]
    ds_read_b128 v[32:35], v4 offset:16384
    s_waitcnt lgkmcnt(7)
    v_mfma_f32_16x16x32_bf16 v[24:27], a[32:35], v[36:39], v[24:27]
    v_mfma_f32_16x16x32_bf16 v[28:31], a[36:39], v[36:39], v[28:31]
    ds_read_b128 v[36:39], v4 offset:16640
    s_waitcnt lgkmcnt(7)
    v_mfma_f32_16x16x32_bf16 v[16:19], a[40:43], v[40:43], v[16:19]
    v_mfma_f32_16x16x32_bf16 v[20:23], a[44:47], v[40:43], v[20:23]
    ds_read_b128 v[40:43], v4 offset:18432
    s_waitcnt lgkmcnt(7)
    v_mfma_f32_16x16x32_bf16 v[24:27], a[40:43], v[44:47], v[24:27]
    v_mfma_f32_16x16x32_bf16 v[28:31], a[44:47], v[44:47], v[28:31]
    ds_read_b128 v[44:47], v4 offset:18688
    s_waitcnt lgkmcnt(7)
    v_mfma_f32_16x16x32_bf16 v[16:19], a[48:51], v[48:51], v[16:19]
    v_mfma_f32_16x16x32_bf16 v[20:23], a[52:55], v[48:51], v[20:23]
    ds_read_b128 v[48:51], v4 offset:20480
    s_waitcnt lgkmcnt(7)
    v_mfma_f32_16x16x32_bf16 v[24:27], a[48:51], v[52:55], v[24:27]
    v_mfma_f32_16x16x32_bf16 v[28:31], a[52:55], v[52:55], v[28:31]
    ds_read_b128 v[52:55], v4 offset:20736
    s_waitcnt lgkmcnt(7)
    v_mfma_f32_16x16x32_bf16 v[16:19], a[56:59], v[56:59], v[16:19]
    v_mfma_f32_16x16x32_bf16 v[20:23], a[60:63], v[56:59], v[20:23]
    ds_read_b128 v[56:59], v4 offset:22528
    s_waitcnt lgkmcnt(7)
    v_mfma_f32_16x16x32_bf16 v[24:27], a[56:59], v[60:63], v[24:27]
    v_mfma_f32_16x16x32_bf16 v[28:31], a[60:63], v[60:63], v[28:31]
    ds_read_b128 v[60:63], v4 offset:22784
    s_waitcnt lgkmcnt(7)
    v_mfma_f32_16x16x32_bf16 v[16:19], a[64:67], v[32:35], v[16:19]
    v_mfma_f32_16x16x32_bf16 v[20:23], a[68:71], v[32:35], v[20:23]
    ds_read_b128 v[32:35], v4 offset:24576
    s_waitcnt lgkmcnt(7)
    v_mfma_f32_16x16x32_bf16 v[24:27], a[64:67], v[36:39], v[24:27]
    v_mfma_f32_16x16x32_bf16 v[28:31], a[68:71], v[36:39], v[28:31]
    ds_read_b128 v[36:39], v4 offset:24832
    s_waitcnt lgkmcnt(7)
    v_mfma_f32_16x16x32_bf16 v[16:19], a[72:75], v[40:43], v[16:19]
    v_mfma_f32_16x16x32_bf16 v[20:23], a[76:79], v[40:43], v[20:23]
    ds_read_b128 v[40:43], v4 offset:26624
    s_waitcnt lgkmcnt(7)
    v_mfma_f32_16x16x32_bf16 v[24:27], a[72:75], v[44:47], v[24:27]
    v_mfma_f32_16x16x32_bf16 v[28:31], a[76:79], v[44:47], v[28:31]
    ds_read_b128 v[44:47], v4 offset:26880
    s_waitcnt lgkmcnt(7)
    v_mfma_f32_16x16x32_bf16 v[16:19], a[80:83], v[48:51], v[16:19]
    v_mfma_f32_16x16x32_bf16 v[20:23], a[84:87], v[48:51], v[20:23]
    ds_read_b128 v[48:51], v4 offset:28672
    s_waitcnt lgkmcnt(7)
    v_mfma_f32_16x16x32_bf16 v[24:27], a[80:83], v[52:55], v[24:27]
    v_mfma_f32_16x16x32_bf16 v[28:31], a[84:87], v[52:55], v[28:31]
    ds_read_b128 v[52:55], v4 offset:28928
    s_waitcnt lgkmcnt(7)
    v_mfma_f32_16x16x32_bf16 v[16:19], a[88:91], v[56:59], v[16:19]
    v_mfma_f32_16x16x32_bf16 v[20:23], a[92:95], v[56:59], v[20:23]
    ds_read_b128 v[56:59], v4 offset:30720
    s_waitcnt lgkmcnt(7)
    v_mfma_f32_16x16x32_bf16 v[24:27], a[88:91], v[60:63], v[24:27]
    v_mfma_f32_16x16x32_bf16 v[28:31], a[92:95], v[60:63], v[28:31]
    ds_read_b128 v[60:63], v4 offset:30976
    s_waitcnt lgkmcnt(7)
    v_mfma_f32_16x16x32_bf16 v[16:19], a[96:99], v[32:35], v[16:19]
    v_mfma_f32_16x16x32_bf16 v[20:23], a[100:103], v[32:35], v[20:23]
    s_waitcnt lgkmcnt(6)
    v_mfma_f32_16x16x32_bf16 v[24:27], a[96:99], v[36:39], v[24:27]
    v_mfma_f32_16x16x32_bf16 v[28:31], a[100:103], v[36:39], v[28:31]
    s_waitcnt lgkmcnt(5)
    v_mfma_f32_16x16x32_bf16 v[16:19], a[104:107], v[40:43], v[16:19]
    v_mfma_f32_16x16x32_bf16 v[20:23], a[108:111], v[40:43], v[20:23]
    s_waitcnt lgkmcnt(4)
    v_mfma_f32_16x16x32_bf16 v[24:27], a[104:107], v[44:47], v[24:27]
    v_mfma_f32_16x16x32_bf16 v[28:31], a[108:111], v[44:47], v[28:31]
    s_waitcnt lgkmcnt(3)
    v_mfma_f32_16x16x32_bf16 v[16:19], a[112:115], v[48:51], v[16:19]
    v_mfma_f32_16x16x32_bf16 v[20:23], a[116:119], v[48:51], v[20:23]
    s_waitcnt lgkmcnt(2)
    v_mfma_f32_16x16x32_bf16 v[24:27], a[112:115], v[52:55], v[24:27]
    v_mfma_f32_16x16x32_bf16 v[28:31], a[116:119], v[52:55], v[28:31]
    s_waitcnt lgkmcnt(1)
    v_mfma_f32_16x16x32_bf16 v[16:19], a[120:123], v[56:59], v[16:19]
    v_mfma_f32_16x16x32_bf16 v[20:23], a[124:127], v[56:59], v[20:23]
    s_waitcnt lgkmcnt(0)
    v_mfma_f32_16x16x32_bf16 v[24:27], a[120:123], v[60:63], v[24:27]
    v_mfma_f32_16x16x32_bf16 v[28:31], a[124:127], v[60:63], v[28:31]
    v_xor_b32 v4, 0x10000, v4
    s_setprio 0
    s_waitcnt vmcnt(0)
    v_readfirstlane_b32 s66, v14
    s_barrier
    s_nop 6
    ds_write_b128 v5, v[16:19] offset:0
    ds_write_b128 v5, v[20:23] offset:1024
    ds_write_b128 v5, v[24:27] offset:2048
    ds_write_b128 v5, v[28:31] offset:3072
    s_cmp_lg_u32 s44, 0
    s_cbranch_scc1 L_g_ne_105
    s_mov_b32 s46, s54
    v_cmp_ge_u32 vcc, s46, v11
    s_nop 0
    s_cbranch_vccnz L_g_le_108
    s_add_u32 s46, s46, 1
    v_cmp_ge_u32 vcc, s46, v12
    s_nop 0
    s_cbranch_vccnz L_g_le_108
    s_add_u32 s46, s46, 1
    v_cmp_ge_u32 vcc, s46, v13
    s_nop 0
    s_cbranch_vccnz L_g_le_108
    s_add_u32 s46, s46, 1
L_g_le_108:
    v_mov_b32 v11, s46
    ds_write_b32 v15, v11
L_g_ne_105:
    s_add_u32 s60, s60, 1
    s_mov_b32 s69, 0
    s_cmp_gt_u32 s62, s60
    s_cbranch_scc1 L_g_nd_109
    s_cmp_ge_u32 s62, s66
    s_cbranch_scc1 L_g_nd_109
    s_add_u32 s47, s61, 4096
    s_add_u32 m0, s64, 0
    s_nop 0
    buffer_load_dwordx4 v3, s[12:15], s61 offen offset:0 sc1 lds
    buffer_load_dwordx4 v3, s[12:15], s61 offen offset:1024 sc1 lds
    buffer_load_dwordx4 v3, s[12:15], s61 offen offset:2048 sc1 lds
    buffer_load_dwordx4 v3, s[12:15], s61 offen offset:3072 sc1 lds
    s_add_u32 m0, s64, 4096
    s_nop 0
    buffer_load_dwordx4 v3, s[12:15], s47 offen offset:0 sc1 lds
    buffer_load_dwordx4 v3, s[12:15], s47 offen offset:1024 sc1 lds
    buffer_load_dwordx4 v3, s[12:15], s47 offen offset:2048 sc1 lds
    buffer_load_dwordx4 v3, s[12:15], s47 offen offset:3072 sc1 lds
    s_add_u32 s61, s61, 65536
    s_add_u32 s62, s62, 1
    s_xor_b32 s64, s64, 0x10000
    s_mov_b32 s69, 1
L_g_nd_109:
    s_mov_b32 s65, s69
    s_add_u32 s59, s60, 1
    s_mov_b32 s69, 0
    s_cmp_gt_u32 s62, s59
    s_cbranch_scc1 L_g_nd_110
    s_cmp_ge_u32 s62, s66
    s_cbranch_scc1 L_g_nd_110
    s_add_u32 s47, s61, 4096
    s_add_u32 m0, s64, 0
    s_nop 0
    buffer_load_dwordx4 v3, s[12:15], s61 offen offset:0 sc1 lds
    buffer_load_dwordx4 v3, s[12:15], s61 offen offset:1024 sc1 lds
    buffer_load_dwordx4 v3, s[12:15], s61 offen offset:2048 sc1 lds
    buffer_load_dwordx4 v3, s[12:15], s61 offen offset:3072 sc1 lds
    s_add_u32 m0, s64, 4096
    s_nop 0
    buffer_load_dwordx4 v3, s[12:15], s47 offen offset:0 sc1 lds
    buffer_load_dwordx4 v3, s[12:15], s47 offen offset:1024 sc1 lds
    buffer_load_dwordx4 v3, s[12:15], s47 offen offset:2048 sc1 lds
    buffer_load_dwordx4 v3, s[12:15], s47 offen offset:3072 sc1 lds
    s_add_u32 s61, s61, 65536
    s_add_u32 s62, s62, 1
    s_xor_b32 s64, s64, 0x10000
    s_mov_b32 s69, 1
L_g_nd_110:
    s_cmp_le_u32 s66, s60
    s_cbranch_scc1 L_g_ex0_107
    s_cmp_eq_u32 s65, 0
    s_cbranch_scc1 L_g_nw_106
    s_waitcnt vmcnt(0) lgkmcnt(0)
    s_branch L_g_loop0_94
L_g_nw_106:
    ds_read_b128 v[32:35], v4 offset:0
    ds_read_b128 v[36:39], v4 offset:256
    ds_read_b128 v[40:43], v4 offset:2048
    ds_read_b128 v[44:47], v4 offset:2304
    ds_read_b128 v[48:51], v4 offset:4096
    ds_read_b128 v[52:55], v4 offset:4352
    ds_read_b128 v[56:59], v4 offset:6144
    ds_read_b128 v[60:63], v4 offset:6400
    s_waitcnt lgkmcnt(8)
    s_branch L_g_loop0_94
L_g_ex0_107:
    s_cmp_lg_u32 s44, 0
    s_cbranch_scc1 L_g_ex0_107_n
    s_sleep 6
    s_add_u32 s54, s60, 0
    s_add_u32 s55, s54, 0
    s_mul_i32 s46, s55, 171
    s_lshr_b32 s46, s46, 9
    s_mul_i32 s46, s46, 3
    s_sub_u32 s46, s55, s46
    s_lshl_b32 s46, s46, 9
    buffer_load_dword v11, v7, s[12:15], s46 offen sc1
    s_add_u32 s55, s54, 1
    s_mul_i32 s46, s55, 171
    s_lshr_b32 s46, s46, 9
    s_mul_i32 s46, s46, 3
    s_sub_u32 s46, s55, s46
    s_lshl_b32 s46, s46, 9
    buffer_load_dword v12, v7, s[12:15], s46 offen sc1
    s_add_u32 s55, s54, 2
    s_mul_i32 s46, s55, 171
    s_lshr_b32 s46, s46, 9
    s_mul_i32 s46, s46, 3
    s_sub_u32 s46, s55, s46
    s_lshl_b32 s46, s46, 9
    buffer_load_dword v13, v7, s[12:15], s46 offen sc1
    s_waitcnt vmcnt(0)
    s_mov_b32 s46, s54
    v_cmp_ge_u32 vcc, s46, v11
    s_nop 0
    s_cbranch_vccnz L_g_le_111
    s_add_u32 s46, s46, 1
    v_cmp_ge_u32 vcc, s46, v12
    s_nop 0
    s_cbranch_vccnz L_g_le_111
    s_add_u32 s46, s46, 1
    v_cmp_ge_u32 vcc, s46, v13
    s_nop 0
    s_cbranch_vccnz L_g_le_111
    s_add_u32 s46, s46, 1
L_g_le_111:
    v_mov_b32 v11, s46
    ds_write_b32 v15, v11
L_g_ex0_107_n:
    s_waitcnt lgkmcnt(0)
    s_barrier
    ds_read_b32 v14, v15
    s_waitcnt lgkmcnt(0)
    v_readfirstlane_b32 s66, v14
    s_barrier
    s_cmp_gt_u32 s66, s60
    s_cbranch_scc1 L_g_restart_91_go
    s_branch L_g_tail_96
L_g_g1r_93:
    s_mov_b32 s65, 1
    s_branch L_g_loop1_95_e
.p2align 6
L_g_loop1_95:
    s_mov_b32 s65, 0
L_g_loop1_95_e:
    s_barrier
    ds_read_b32 v14, v15
    s_bitcmp1_b32 s67, 2
    s_cbranch_scc0 L_g_nfl_112
    s_sub_u32 s59, s60, 3
    s_cmp_lg_u32 s44, 4
    s_cbranch_scc1 L_sf_117
    v_mov_b32 v10, s59
    v_add_u32 v10, 1, v10
    v_mov_b32 v11, 0
    s_mov_b64 exec, 1
    buffer_store_dword v10, v11, s[12:15], s52 offen sc1
    s_mov_b64 exec, -1
L_sf_117:
L_g_nfl_112:
    s_cmp_eq_u32 s71, 0
    s_cbranch_scc1 L_g_nfl_112_d
    v_mov_b32 v10, 1
    s_mov_b64 exec, 1
    s_waitcnt vmcnt(0)
    ds_add_rtn_u32 v10, v15, v10 offset:4
    s_waitcnt lgkmcnt(0)
    v_readfirstlane_b32 s46, v10
    s_mov_b64 exec, -1
    s_mov_b32 s71, 0
    s_sub_u32 s59, s60, 1
    s_cmp_lg_u32 s46, s68
    s_cbranch_scc1 L_g_df_118
    v_mov_b32 v10, s59
    v_add_u32 v10, 1, v10
    v_mov_b32 v11, 0
    s_mov_b64 exec, 1
    buffer_store_dword v10, v11, s[12:15], s52 offen sc1
    s_mov_b64 exec, -1
L_sf_119:
L_g_df_118:
    s_add_u32 s68, s68, 4
    s_mov_b32 s65, 2
L_g_nfl_112_d:
    s_waitcnt lgkmcnt(0)
    v_readfirstlane_b32 s66, v14
    s_nop 3
    s_mov_b32 s69, 0
    s_cmp_gt_u32 s62, s60
    s_cbranch_scc1 L_g_nd_120
    s_cmp_ge_u32 s62, s66
    s_cbranch_scc1 L_g_nd_120
    s_add_u32 s47, s61, 4096
    s_add_u32 m0, s64, 0
    s_nop 0
    buffer_load_dwordx4 v3, s[12:15], s61 offen offset:0 sc1 lds
    buffer_load_dwordx4 v3, s[12:15], s61 offen offset:1024 sc1 lds
    buffer_load_dwordx4 v3, s[12:15], s61 offen offset:2048 sc1 lds
    buffer_load_dwordx4 v3, s[12:15], s61 offen offset:3072 sc1 lds
    s_add_u32 m0, s64, 4096
    s_nop 0
    buffer_load_dwordx4 v3, s[12:15], s47 offen offset:0 sc1 lds
    buffer_load_dwordx4 v3, s[12:15], s47 offen offset:1024 sc1 lds
    buffer_load_dwordx4 v3, s[12:15], s47 offen offset:2048 sc1 lds
    buffer_load_dwordx4 v3, s[12:15], s47 offen offset:3072 sc1 lds
    s_add_u32 s61, s61, 65536
    s_add_u32 s62, s62, 1
    s_xor_b32 s64, s64, 0x10000
    s_mov_b32 s69, 1
L_g_nd_120:
    s_or_b32 s65, s65, s69
    s_add_u32 s59, s60, 1
    s_mov_b32 s69, 0
    s_cmp_gt_u32 s62, s59
    s_cbranch_scc1 L_g_nd_121
    s_cmp_ge_u32 s62, s66
    s_cbranch_scc1 L_g_nd_121
    s_add_u32 s47, s61, 4096
    s_add_u32 m0, s64, 0
    s_nop 0
    buffer_load_dwordx4 v3, s[12:15], s61 offen offset:0 sc1 lds
    buffer_load_dwordx4 v3, s[12:15], s61 offen offset:1024 sc1 lds
    buffer_load_dwordx4 v3, s[12:15], s61 offen offset:2048 sc1 lds
    buffer_load_dwordx4 v3, s[12:15], s61 offen offset:3072 sc1 lds
    s_add_u32 m0, s64, 4096
    s_nop 0
    buffer_load_dwordx4 v3, s[12:15], s47 offen offset:0 sc1 lds
    buffer_load_dwordx4 v3, s[12:15], s47 offen offset:1024 sc1 lds
    buffer_load_dwordx4 v3, s[12:15], s47 offen offset:2048 sc1 lds
    buffer_load_dwordx4 v3, s[12:15], s47 offen offset:3072 sc1 lds
    s_add_u32 s61, s61, 65536
    s_add_u32 s62, s62, 1
    s_xor_b32 s64, s64, 0x10000
    s_mov_b32 s69, 1
L_g_nd_121:
    s_bitcmp1_b32 s67, 0
    s_cbranch_scc0 L_g_nep_113
    ds_read_b128 v[80:83], v5 offset:0
    ds_read_b128 v[84:87], v5 offset:1024
    ds_read_b128 v[88:91], v5 offset:2048
    ds_read_b128 v[92:95], v5 offset:3072
    s_nop 7
    s_waitcnt lgkmcnt(3)
    v_add_f32 v80, v80, v16
    v_add_f32 v81, v81, v17
    v_add_f32 v82, v82, v18
    v_add_f32 v83, v83, v19
    s_waitcnt lgkmcnt(2)
    v_add_f32 v84, v84, v20
    v_add_f32 v85, v85, v21
    v_add_f32 v86, v86, v22
    v_add_f32 v87, v87, v23
    s_waitcnt lgkmcnt(1)
    v_add_f32 v88, v88, v24
    v_add_f32 v89, v89, v25
    v_add_f32 v90, v90, v26
    v_add_f32 v91, v91, v27
    s_waitcnt lgkmcnt(0)
    v_add_f32 v92, v92, v28
    v_add_f32 v93, v93, v29
    v_add_f32 v94, v94, v30
    v_add_f32 v95, v95, v31
L_g_nep_113:
    v_mul_f32 v96, v80, v80
    v_mul_f32 v97, v81, v81
    v_mul_f32 v98, v82, v82
    v_mul_f32 v99, v83, v83
    v_mul_f32 v100, v84, v84
    v_mul_f32 v101, v85, v85
    v_mul_f32 v102, v86, v86
    v_mul_f32 v103, v87, v87
    v_fma_f32 v96, v96, s56, v112
    v_fma_f32 v97, v97, s56, v112
    v_fma_f32 v98, v98, s56, v112
    v_fma_f32 v99, v99, s56, v112
    v_fma_f32 v100, v100, s56, v112
    v_fma_f32 v101, v101, s56, v112
    v_fma_f32 v102, v102, s56, v112
    v_fma_f32 v103, v103, s56, v112
    v_mul_f32 v96, v96, v80
    v_mul_f32 v97, v97, v81
    v_mul_f32 v98, v98, v82
    v_mul_f32 v99, v99, v83
    v_mul_f32 v100, v100, v84
    v_mul_f32 v101, v101, v85
    v_mul_f32 v102, v102, v86
    v_mul_f32 v103, v103, v87
    v_exp_f32 v96, v96
    v_exp_f32 v97, v97
    v_exp_f32 v98, v98
    v_exp_f32 v99, v99
    v_exp_f32 v100, v100
    v_exp_f32 v101, v101
    v_exp_f32 v102, v102
    v_exp_f32 v103, v103
    v_add_f32 v96, 1.0, v96
    v_add_f32 v97, 1.0, v97
    v_add_f32 v98, 1.0, v98
    v_add_f32 v99, 1.0, v99
    s_cmp_eq_u32 s65, 0
    s_cbranch_scc1 L_g_nw1_114
    s_cmp_eq_u32 s65, 2
    s_cbranch_scc1 L_g_nw1_114_w
    s_waitcnt vmcnt(0)
L_g_nw1_114_w:
    s_barrier
    ds_read_b128 v[32:35], v4 offset:0
    ds_read_b128 v[36:39], v4 offset:256
    ds_read_b128 v[40:43], v4 offset:2048
    ds_read_b128 v[44:47], v4 offset:2304
    ds_read_b128 v[48:51], v4 offset:4096
    ds_read_b128 v[52:55], v4 offset:4352
    ds_read_b128 v[56:59], v4 offset:6144
    ds_read_b128 v[60:63], v4 offset:6400
    s_branch L_g_jn_116
L_g_nw1_114:
    ds_read_b128 v[32:35], v4 offset:0
    ds_read_b128 v[36:39], v4 offset:256
    ds_read_b128 v[40:43], v4 offset:2048
    ds_read_b128 v[44:47], v4 offset:2304
    ds_read_b128 v[48:51], v4 offset:4096
    ds_read_b128 v[52:55], v4 offset:4352
    ds_read_b128 v[56:59], v4 offset:6144
    ds_read_b128 v[60:63], v4 offset:6400
    s_barrier
L_g_jn_116:
    s_bitcmp1_b32 s67, 0
    s_cbranch_scc1 L_g_mm2_115
    s_setprio 1
    s_waitcnt lgkmcnt(7)
    v_mfma_f32_16x16x32_bf16 v[16:19], a[0:3], v[32:35], 0
    v_mfma_f32_16x16x32_bf16 v[20:23], a[4:7], v[32:35], 0
    ds_read_b128 v[32:35], v4 offset:8192
    s_waitcnt lgkmcnt(7)
    v_mfma_f32_16x16x32_bf16 v[24:27], a[0:3], v[36:39], 0
    v_mfma_f32_16x16x32_bf16 v[28:31], a[4:7], v[36:39], 0
    ds_read_b128 v[36:39], v4 offset:8448
    s_waitcnt lgkmcnt(7)
    v_mfma_f32_16x16x32_bf16 v[16:19], a[8:11], v[40:43], v[16:19]
    v_mfma_f32_16x16x32_bf16 v[20:23], a[12:15], v[40:43], v[20:23]
    ds_read_b128 v[40:43], v4 offset:10240
    s_waitcnt lgkmcnt(7)
    v_mfma_f32_16x16x32_bf16 v[24:27], a[8:11], v[44:47], v[24:27]
    v_mfma_f32_16x16x32_bf16 v[28:31], a[12:15], v[44:47], v[28:31]
    ds_read_b128 v[44:47], v4 offset:10496
    s_waitcnt lgkmcnt(7)
    v_mfma_f32_16x16x32_bf16 v[16:19], a[16:19], v[48:51], v[16:19]
    v_mfma_f32_16x16x32_bf16 v[20:23], a[20:23], v[48:51], v[20:23]
    ds_read_b128 v[48:51], v4 offset:12288
    s_waitcnt lgkmcnt(7)
    v_mfma_f32_16x16x32_bf16 v[24:27], a[16:19], v[52:55], v[24:27]
    v_mfma_f32_16x16x32_bf16 v[28:31], a[20:23], v[52:55], v[28:31]
    ds_read_b128 v[52:55], v4 offset:12544
    s_waitcnt lgkmcnt(7)
    v_mfma_f32_16x16x32_bf16 v[16:19], a[24:27], v[56:59], v[16:19]
    v_mfma_f32_16x16x32_bf16 v[20:23], a[28:31], v[56:59], v[20:23]
    ds_read_b128 v[56:59], v4 offset:14336
    s_waitcnt lgkmcnt(7)
    v_mfma_f32_16x16x32_bf16 v[24:27], a[24:27], v[60:63], v[24:27]
    v_mfma_f32_16x16x32_bf16 v[28:31], a[28:31], v[60:63], v[28:31]
    ds_read_b128 v[60:63], v4 offset:14592
    s_waitcnt lgkmcnt(7)
    v_mfma_f32_16x16x32_bf16 v[16:19], a[32:35], v[32:35], v[16:19]
    v_mfma_f32_16x16x32_bf16 v[20:23], a[36:39], v[32:35], v[20:23]
    ds_read_b128 v[32:35], v4 offset:16384
    s_waitcnt lgkmcnt(7)
    v_mfma_f32_16x16x32_bf16 v[24:27], a[32:35], v[36:39], v[24:27]
    v_mfma_f32_16x16x32_bf16 v[28:31], a[36:39], v[36:39], v[28:31]
    ds_read_b128 v[36:39], v4 offset:16640
    s_waitcnt lgkmcnt(7)
    v_mfma_f32_16x16x32_bf16 v[16:19], a[40:43], v[40:43], v[16:19]
    v_mfma_f32_16x16x32_bf16 v[20:23], a[44:47], v[40:43], v[20:23]
    ds_read_b128 v[40:43], v4 offset:18432
    s_waitcnt lgkmcnt(7)
    v_mfma_f32_16x16x32_bf16 v[24:27], a[40:43], v[44:47], v[24:27]
    v_mfma_f32_16x16x32_bf16 v[28:31], a[44:47], v[44:47], v[28:31]
    ds_read_b128 v[44:47], v4 offset:18688
    s_waitcnt lgkmcnt(7)
    v_mfma_f32_16x16x32_bf16 v[16:19], a[48:51], v[48:51], v[16:19]
    v_mfma_f32_16x16x32_bf16 v[20:23], a[52:55], v[48:51], v[20:23]
    ds_read_b128 v[48:51], v4 offset:20480
    s_waitcnt lgkmcnt(7)
    v_mfma_f32_16x16x32_bf16 v[24:27], a[48:51], v[52:55], v[24:27]
    v_mfma_f32_16x16x32_bf16 v[28:31], a[52:55], v[52:55], v[28:31]
    ds_read_b128 v[52:55], v4 offset:20736
    s_waitcnt lgkmcnt(7)
    v_mfma_f32_16x16x32_bf16 v[16:19], a[56:59], v[56:59], v[16:19]
    v_mfma_f32_16x16x32_bf16 v[20:23], a[60:63], v[56:59], v[20:23]
    ds_read_b128 v[56:59], v4 offset:22528
    s_waitcnt lgkmcnt(7)
    v_mfma_f32_16x16x32_bf16 v[24:27], a[56:59], v[60:63], v[24:27]
    v_mfma_f32_16x16x32_bf16 v[28:31], a[60:63], v[60:63], v[28:31]
    ds_read_b128 v[60:63], v4 offset:22784
    s_waitcnt lgkmcnt(7)
    v_mfma_f32_16x16x32_bf16 v[16:19], a[64:67], v[32:35], v[16:19]
    v_mfma_f32_16x16x32_bf16 v[20:23], a[68:71], v[32:35], v[20:23]
    ds_read_b128 v[32:35], v4 offset:24576
    s_waitcnt lgkmcnt(7)
    v_mfma_f32_16x16x32_bf16 v[24:27], a[64:67], v[36:39], v[24:27]
    v_mfma_f32_16x16x32_bf16 v[28:31], a[68:71], v[36:39], v[28:31]
    ds_read_b128 v[36:39], v4 offset:24832
    s_waitcnt lgkmcnt(7)
    v_mfma_f32_16x16x32_bf16 v[16:19], a[72:75], v[40:43], v[16:19]
    v_mfma_f32_16x16x32_bf16 v[20:23], a[76:79], v[40:43], v[20:23]
    ds_read_b128 v[40:43], v4 offset:26624
    s_waitcnt lgkmcnt(7)
    v_mfma_f32_16x16x32_bf16 v[24:27], a[72:75], v[44:47], v[24:27]
    v_mfma_f32_16x16x32_bf16 v[28:31], a[76:79], v[44:47], v[28:31]
    ds_read_b128 v[44:47], v4 offset:26880
    s_waitcnt lgkmcnt(7)
    v_mfma_f32_16x16x32_bf16 v[16:19], a[80:83], v[48:51], v[16:19]
    v_mfma_f32_16x16x32_bf16 v[20:23], a[84:87], v[48:51], v[20:23]
    ds_read_b128 v[48:51], v4 offset:28672
    s_waitcnt lgkmcnt(7)
    v_mfma_f32_16x16x32_bf16 v[24:27], a[80:83], v[52:55], v[24:27]
    v_mfma_f32_16x16x32_bf16 v[28:31], a[84:87], v[52:55], v[28:31]
    ds_read_b128 v[52:55], v4 offset:28928
    s_waitcnt lgkmcnt(7)
    v_mfma_f32_16x16x32_bf16 v[16:19], a[88:91], v[56:59], v[16:19]
    v_mfma_f32_16x16x32_bf16 v[20:23], a[92:95], v[56:59], v[20:23]
    ds_read_b128 v[56:59], v4 offset:30720
    s_waitcnt lgkmcnt(7)
    v_mfma_f32_16x16x32_bf16 v[24:27], a[88:91], v[60:63], v[24:27]
    v_mfma_f32_16x16x32_bf16 v[28:31], a[92:95], v[60:63], v[28:31]
    ds_read_b128 v[60:63], v4 offset:30976
    s_waitcnt lgkmcnt(7)
    v_mfma_f32_16x16x32_bf16 v[16:19], a[96:99], v[32:35], v[16:19]
    v_mfma_f32_16x16x32_bf16 v[20:23], a[100:103], v[32:35], v[20:23]
    s_waitcnt lgkmcnt(6)
    v_mfma_f32_16x16x32_bf16 v[24:27], a[96:99], v[36:39], v[24:27]
    v_mfma_f32_16x16x32_bf16 v[28:31], a[100:103], v[36:39], v[28:31]
    s_waitcnt lgkmcnt(5)
    v_mfma_f32_16x16x32_bf16 v[16:19], a[104:107], v[40:43], v[16:19]
    v_mfma_f32_16x16x32_bf16 v[20:23], a[108:111], v[40:43], v[20:23]
    s_waitcnt lgkmcnt(4)
    v_mfma_f32_16x16x32_bf16 v[24:27], a[104:107], v[44:47], v[24:27]
    v_mfma_f32_16x16x32_bf16 v[28:31], a[108:111], v[44:47], v[28:31]
    s_waitcnt lgkmcnt(3)
    v_mfma_f32_16x16x32_bf16 v[16:19], a[112:115], v[48:51], v[16:19]
    v_mfma_f32_16x16x32_bf16 v[20:23], a[116:119], v[48:51], v[20:23]
    s_waitcnt lgkmcnt(2)
    v_mfma_f32_16x16x32_bf16 v[24:27], a[112:115], v[52:55], v[24:27]
    v_mfma_f32_16x16x32_bf16 v[28:31], a[116:119], v[52:55], v[28:31]
    s_waitcnt lgkmcnt(1)
    v_mfma_f32_16x16x32_bf16 v[16:19], a[120:123], v[56:59], v[16:19]
    v_mfma_f32_16x16x32_bf16 v[20:23], a[124:127], v[56:59], v[20:23]
    s_waitcnt lgkmcnt(0)
    v_mfma_f32_16x16x32_bf16 v[24:27], a[120:123], v[60:63], v[24:27]
    v_mfma_f32_16x16x32_bf16 v[28:31], a[124:127], v[60:63], v[28:31]
    v_xor_b32 v4, 0x10000, v4
    s_setprio 0
    s_waitcnt vmcnt(0)
    s_branch L_g_mm2_115_d
L_g_mm2_115:
    s_setprio 1
    s_waitcnt lgkmcnt(7)
    v_mfma_f32_16x16x32_bf16 v[16:19], a[0:3], v[32:35], 0
    v_add_f32 v100, 1.0, v100
    v_add_f32 v101, 1.0, v101
    v_mfma_f32_16x16x32_bf16 v[20:23], a[4:7], v[32:35], 0
    ds_read_b128 v[32:35], v4 offset:8192
    v_add_f32 v102, 1.0, v102
    v_add_f32 v103, 1.0, v103
    s_waitcnt lgkmcnt(7)
    v_mfma_f32_16x16x32_bf16 v[24:27], a[0:3], v[36:39], 0
    v_rcp_f32 v96, v96
    v_mfma_f32_16x16x32_bf16 v[28:31], a[4:7], v[36:39], 0
    ds_read_b128 v[36:39], v4 offset:8448
    v_rcp_f32 v97, v97
    s_waitcnt lgkmcnt(7)
    v_mfma_f32_16x16x32_bf16 v[16:19], a[8:11], v[40:43], v[16:19]
    v_rcp_f32 v98, v98
    v_mfma_f32_16x16x32_bf16 v[20:23], a[12:15], v[40:43], v[20:23]
    ds_read_b128 v[40:43], v4 offset:10240
    v_rcp_f32 v99, v99
    s_waitcnt lgkmcnt(7)
    v_mfma_f32_16x16x32_bf16 v[24:27], a[8:11], v[44:47], v[24:27]
    v_rcp_f32 v100, v100
    v_mfma_f32_16x16x32_bf16 v[28:31], a[12:15], v[44:47], v[28:31]
    ds_read_b128 v[44:47], v4 offset:10496
    v_rcp_f32 v101, v101
    s_waitcnt lgkmcnt(7)
    v_mfma_f32_16x16x32_bf16 v[16:19], a[16:19], v[48:51], v[16:19]
    v_rcp_f32 v102, v102
    v_mfma_f32_16x16x32_bf16 v[20:23], a[20:23], v[48:51], v[20:23]
    ds_read_b128 v[48:51], v4 offset:12288
    v_rcp_f32 v103, v103
    s_waitcnt lgkmcnt(7)
    v_mfma_f32_16x16x32_bf16 v[24:27], a[16:19], v[52:55], v[24:27]
    v_mul_f32 v80, v80, v96
    v_mul_f32 v81, v81, v97
    v_mfma_f32_16x16x32_bf16 v[28:31], a[20:23], v[52:55], v[28:31]
    ds_read_b128 v[52:55], v4 offset:12544
    v_mul_f32 v82, v82, v98
    v_mul_f32 v83, v83, v99
    s_waitcnt lgkmcnt(7)
    v_mfma_f32_16x16x32_bf16 v[16:19], a[24:27], v[56:59], v[16:19]
    v_mul_f32 v84, v84, v100
    v_mul_f32 v85, v85, v101
    v_mfma_f32_16x16x32_bf16 v[20:23], a[28:31], v[56:59], v[20:23]
    ds_read_b128 v[56:59], v4 offset:14336
    v_mul_f32 v86, v86, v102
    v_mul_f32 v87, v87, v103
    s_waitcnt lgkmcnt(7)
    v_mfma_f32_16x16x32_bf16 v[24:27], a[24:27], v[60:63], v[24:27]
    v_cvt_pk_bf16_f32 v104, v80, v81
    v_cvt_pk_bf16_f32 v105, v82, v83
    v_mfma_f32_16x16x32_bf16 v[28:31], a[28:31], v[60:63], v[28:31]
    ds_read_b128 v[60:63], v4 offset:14592
    v_cvt_pk_bf16_f32 v106, v84, v85
    v_cvt_pk_bf16_f32 v107, v86, v87
    s_waitcnt lgkmcnt(7)
    v_mfma_f32_16x16x32_bf16 v[16:19], a[32:35], v[32:35], v[16:19]
    buffer_store_dwordx4 v[104:107], v8, s[12:15], s63 offen sc1
    v_mul_f32 v96, v88, v88
    v_mfma_f32_16x16x32_bf16 v[20:23], a[36:39], v[32:35], v[20:23]
    ds_read_b128 v[32:35], v4 offset:16384
    v_mul_f32 v97, v89, v89
    v_mul_f32 v98, v90, v90
    s_waitcnt lgkmcnt(7)
    v_mfma_f32_16x16x32_bf16 v[24:27], a[32:35], v[36:39], v[24:27]
    v_mul_f32 v99, v91, v91
    v_mul_f32 v100, v92, v92
    v_mfma_f32_16x16x32_bf16 v[28:31], a[36:39], v[36:39], v[28:31]
    ds_read_b128 v[36:39], v4 offset:16640
    v_mul_f32 v101, v93, v93
    v_mul_f32 v102, v94, v94
    s_waitcnt lgkmcnt(7)
    v_mfma_f32_16x16x32_bf16 v[16:19], a[40:43], v[40:43], v[16:19]
    v_mul_f32 v103, v95, v95
    v_fma_f32 v96, v96, s56, v112
    v_mfma_f32_16x16x32_bf16 v[20:23], a[44:47], v[40:43], v[20:23]
    ds_read_b128 v[40:43], v4 offset:18432
    v_fma_f32 v97, v97, s56, v112
    v_fma_f32 v98, v98, s56, v112
    s_waitcnt lgkmcnt(7)
    v_mfma_f32_16x16x32_bf16 v[24:27], a[40:43], v[44:47], v[24:27]
    v_fma_f32 v99, v99, s56, v112
    v_fma_f32 v100, v100, s56, v112
    v_mfma_f32_16x16x32_bf16 v[28:31], a[44:47], v[44:47], v[28:31]
    ds_read_b128 v[44:47], v4 offset:18688
    v_fma_f32 v101, v101, s56, v112
    v_fma_f32 v102, v102, s56, v112
    s_waitcnt lgkmcnt(7)
    v_mfma_f32_16x16x32_bf16 v[16:19], a[48:51], v[48:51], v[16:19]
    v_fma_f32 v103, v103, s56, v112
    v_mul_f32 v96, v96, v88
    v_mfma_f32_16x16x32_bf16 v[20:23], a[52:55], v[48:51], v[20:23]
    ds_read_b128 v[48:51], v4 offset:20480
    v_mul_f32 v97, v97, v89
    v_mul_f32 v98, v98, v90
    s_waitcnt lgkmcnt(7)
    v_mfma_f32_16x16x32_bf16 v[24:27], a[48:51], v[52:55], v[24:27]
    v_mul_f32 v99, v99, v91
    v_mul_f32 v100, v100, v92
    v_mfma_f32_16x16x32_bf16 v[28:31], a[52:55], v[52:55], v[28:31]
    ds_read_b128 v[52:55], v4 offset:20736
    v_mul_f32 v101, v101, v93
    v_mul_f32 v102, v102, v94
    s_waitcnt lgkmcnt(7)
    v_mfma_f32_16x16x32_bf16 v[16:19], a[56:59], v[56:59], v[16:19]
    v_mul_f32 v103, v103, v95
    v_exp_f32 v96, v96
    v_mfma_f32_16x16x32_bf16 v[20:23], a[60:63], v[56:59], v[20:23]
    ds_read_b128 v[56:59], v4 offset:22528
    v_exp_f32 v97, v97
    s_waitcnt lgkmcnt(7)
    v_mfma_f32_16x16x32_bf16 v[24:27], a[56:59], v[60:63], v[24:27]
    v_exp_f32 v98, v98
    v_mfma_f32_16x16x32_bf16 v[28:31], a[60:63], v[60:63], v[28:31]
    ds_read_b128 v[60:63], v4 offset:22784
    v_exp_f32 v99, v99
    s_waitcnt lgkmcnt(7)
    v_mfma_f32_16x16x32_bf16 v[16:19], a[64:67], v[32:35], v[16:19]
    v_exp_f32 v100, v100
    v_mfma_f32_16x16x32_bf16 v[20:23], a[68:71], v[32:35], v[20:23]
    ds_read_b128 v[32:35], v4 offset:24576
    v_exp_f32 v101, v101
    s_waitcnt lgkmcnt(7)
    v_mfma_f32_16x16x32_bf16 v[24:27], a[64:67], v[36:39], v[24:27]
    v_exp_f32 v102, v102
    v_mfma_f32_16x16x32_bf16 v[28:31], a[68:71], v[36:39], v[28:31]
    ds_read_b128 v[36:39], v4 offset:24832
    v_exp_f32 v103, v103
    s_waitcnt lgkmcnt(7)
    v_mfma_f32_16x16x32_bf16 v[16:19], a[72:75], v[40:43], v[16:19]
    v_add_f32 v96, 1.0, v96
    v_add_f32 v97, 1.0, v97
    v_mfma_f32_16x16x32_bf16 v[20:23], a[76:79], v[40:43], v[20:23]
    ds_read_b128 v[40:43], v4 offset:26624
    v_add_f32 v98, 1.0, v98
    v_add_f32 v99, 1.0, v99
    s_waitcnt lgkmcnt(7)
    v_mfma_f32_16x16x32_bf16 v[24:27], a[72:75], v[44:47], v[24:27]
    v_add_f32 v100, 1.0, v100
    v_add_f32 v101, 1.0, v101
    v_mfma_f32_16x16x32_bf16 v[28:31], a[76:79], v[44:47], v[28:31]
    ds_read_b128 v[44:47], v4 offset:26880
    v_add_f32 v102, 1.0, v102
    v_add_f32 v103, 1.0, v103
    s_waitcnt lgkmcnt(7)
    v_mfma_f32_16x16x32_bf16 v[16:19], a[80:83], v[48:51], v[16:19]
    v_rcp_f32 v96, v96
    v_mfma_f32_16x16x32_bf16 v[20:23], a[84:87], v[48:51], v[20:23]
    ds_read_b128 v[48:51], v4 offset:28672
    v_rcp_f32 v97, v97
    s_waitcnt lgkmcnt(7)
    v_mfma_f32_16x16x32_bf16 v[24:27], a[80:83], v[52:55], v[24:27]
    v_rcp_f32 v98, v98
    v_mfma_f32_16x16x32_bf16 v[28:31], a[84:87], v[52:55], v[28:31]
    ds_read_b128 v[52:55], v4 offset:28928
    v_rcp_f32 v99, v99
    s_waitcnt lgkmcnt(7)
    v_mfma_f32_16x16x32_bf16 v[16:19], a[88:91], v[56:59], v[16:19]
    v_rcp_f32 v100, v100
    v_mfma_f32_16x16x32_bf16 v[20:23], a[92:95], v[56:59], v[20:23]
    ds_read_b128 v[56:59], v4 offset:30720
    v_rcp_f32 v101, v101
    s_waitcnt lgkmcnt(7)
    v_mfma_f32_16x16x32_bf16 v[24:27], a[88:91], v[60:63], v[24:27]
    v_rcp_f32 v102, v102
    v_mfma_f32_16x16x32_bf16 v[28:31], a[92:95], v[60:63], v[28:31]
    ds_read_b128 v[60:63], v4 offset:30976
    v_rcp_f32 v103, v103
    s_waitcnt lgkmcnt(7)
    v_mfma_f32_16x16x32_bf16 v[16:19], a[96:99], v[32:35], v[16:19]
    v_mul_f32 v88, v88, v96
    v_mul_f32 v89, v89, v97
    v_mfma_f32_16x16x32_bf16 v[20:23], a[100:103], v[32:35], v[20:23]
    v_mul_f32 v90, v90, v98
    v_mul_f32 v91, v91, v99
    s_waitcnt lgkmcnt(6)
    v_mfma_f32_16x16x32_bf16 v[24:27], a[96:99], v[36:39], v[24:27]
    v_mul_f32 v92, v92, v100
    v_mul_f32 v93, v93, v101
    v_mfma_f32_16x16x32_bf16 v[28:31], a[100:103], v[36:39], v[28:31]
    v_mul_f32 v94, v94, v102
    v_mul_f32 v95, v95, v103
    s_waitcnt lgkmcnt(5)
    v_mfma_f32_16x16x32_bf16 v[16:19], a[104:107], v[40:43], v[16:19]
    v_cvt_pk_bf16_f32 v108, v88, v89
    v_cvt_pk_bf16_f32 v109, v90, v91
    v_mfma_f32_16x16x32_bf16 v[20:23], a[108:111], v[40:43], v[20:23]
    v_cvt_pk_bf16_f32 v110, v92, v93
    v_cvt_pk_bf16_f32 v111, v94, v95
    s_waitcnt lgkmcnt(4)
    v_mfma_f32_16x16x32_bf16 v[24:27], a[104:107], v[44:47], v[24:27]
    buffer_store_dwordx4 v[108:111], v9, s[12:15], s63 offen sc1
    s_add_u32 s63, s63, 229376
    v_mfma_f32_16x16x32_bf16 v[28:31], a[108:111], v[44:47], v[28:31]
    s_waitcnt lgkmcnt(3)
    v_mfma_f32_16x16x32_bf16 v[16:19], a[112:115], v[48:51], v[16:19]
    v_mfma_f32_16x16x32_bf16 v[20:23], a[116:119], v[48:51], v[20:23]
    s_waitcnt lgkmcnt(2)
    v_mfma_f32_16x16x32_bf16 v[24:27], a[112:115], v[52:55], v[24:27]
    v_mfma_f32_16x16x32_bf16 v[28:31], a[116:119], v[52:55], v[28:31]
    s_waitcnt lgkmcnt(1)
    v_mfma_f32_16x16x32_bf16 v[16:19], a[120:123], v[56:59], v[16:19]
    v_mfma_f32_16x16x32_bf16 v[20:23], a[124:127], v[56:59], v[20:23]
    s_waitcnt lgkmcnt(0)
    v_mfma_f32_16x16x32_bf16 v[24:27], a[120:123], v[60:63], v[24:27]
    v_mfma_f32_16x16x32_bf16 v[28:31], a[124:127], v[60:63], v[28:31]
    v_xor_b32 v4, 0x10000, v4
    s_setprio 0
    s_waitcnt vmcnt(2)
L_g_mm2_115_d:
    s_lshl_b32 s67, s67, 1
    s_or_b32 s67, s67, 1
    s_add_u32 s60, s60, 1
    s_cmp_gt_u32 s66, s60
    s_cbranch_scc1 L_g_loop1_95
    s_barrier
    ds_read_b32 v14, v15
    s_waitcnt lgkmcnt(0)
    v_readfirstlane_b32 s66, v14
    s_barrier
    s_mov_b32 s69, 0
    s_cmp_gt_u32 s62, s60
    s_cbranch_scc1 L_g_nd_122
    s_cmp_ge_u32 s62, s66
    s_cbranch_scc1 L_g_nd_122
    s_add_u32 s47, s61, 4096
    s_add_u32 m0, s64, 0
    s_nop 0
    buffer_load_dwordx4 v3, s[12:15], s61 offen offset:0 sc1 lds
    buffer_load_dwordx4 v3, s[12:15], s61 offen offset:1024 sc1 lds
    buffer_load_dwordx4 v3, s[12:15], s61 offen offset:2048 sc1 lds
    buffer_load_dwordx4 v3, s[12:15], s61 offen offset:3072 sc1 lds
    s_add_u32 m0, s64, 4096
    s_nop 0
    buffer_load_dwordx4 v3, s[12:15], s47 offen offset:0 sc1 lds
    buffer_load_dwordx4 v3, s[12:15], s47 offen offset:1024 sc1 lds
    buffer_load_dwordx4 v3, s[12:15], s47 offen offset:2048 sc1 lds
    buffer_load_dwordx4 v3, s[12:15], s47 offen offset:3072 sc1 lds
    s_add_u32 s61, s61, 65536
    s_add_u32 s62, s62, 1
    s_xor_b32 s64, s64, 0x10000
    s_mov_b32 s69, 1
L_g_nd_122:
    s_sub_u32 s59, s60, 1
    ds_read_b128 v[80:83], v5 offset:0
    ds_read_b128 v[84:87], v5 offset:1024
    ds_read_b128 v[88:91], v5 offset:2048
    ds_read_b128 v[92:95], v5 offset:3072
    s_nop 7
    s_waitcnt lgkmcnt(3)
    v_add_f32 v80, v80, v16
    v_add_f32 v81, v81, v17
    v_add_f32 v82, v82, v18
    v_add_f32 v83, v83, v19
    s_waitcnt lgkmcnt(2)
    v_add_f32 v84, v84, v20
    v_add_f32 v85, v85, v21
    v_add_f32 v86, v86, v22
    v_add_f32 v87, v87, v23
    s_waitcnt lgkmcnt(1)
    v_add_f32 v88, v88, v24
    v_add_f32 v89, v89, v25
    v_add_f32 v90, v90, v26
    v_add_f32 v91, v91, v27
    s_waitcnt lgkmcnt(0)
    v_add_f32 v92, v92, v28
    v_add_f32 v93, v93, v29
    v_add_f32 v94, v94, v30
    v_add_f32 v95, v95, v31
    v_mul_f32 v96, v80, v80
    v_mul_f32 v97, v81, v81
    v_mul_f32 v98, v82, v82
    v_mul_f32 v99, v83, v83
    v_mul_f32 v100, v84, v84
    v_mul_f32 v101, v85, v85
    v_mul_f32 v102, v86, v86
    v_mul_f32 v103, v87, v87
    v_fma_f32 v96, v96, s56, v112
    v_fma_f32 v97, v97, s56, v112
    v_fma_f32 v98, v98, s56, v112
    v_fma_f32 v99, v99, s56, v112
    v_fma_f32 v100, v100, s56, v112
    v_fma_f32 v101, v101, s56, v112
    v_fma_f32 v102, v102, s56, v112
    v_fma_f32 v103, v103, s56, v112
    v_mul_f32 v96, v96, v80
    v_mul_f32 v97, v97, v81
    v_mul_f32 v98, v98, v82
    v_mul_f32 v99, v99, v83
    v_mul_f32 v100, v100, v84
    v_mul_f32 v101, v101, v85
    v_mul_f32 v102, v102, v86
    v_mul_f32 v103, v103, v87
    v_exp_f32 v96, v96
    v_exp_f32 v97, v97
    v_exp_f32 v98, v98
    v_exp_f32 v99, v99
    v_exp_f32 v100, v100
    v_exp_f32 v101, v101
    v_exp_f32 v102, v102
    v_exp_f32 v103, v103
    v_add_f32 v96, 1.0, v96
    v_add_f32 v97, 1.0, v97
    v_add_f32 v98, 1.0, v98
    v_add_f32 v99, 1.0, v99
    v_add_f32 v100, 1.0, v100
    v_add_f32 v101, 1.0, v101
    v_add_f32 v102, 1.0, v102
    v_add_f32 v103, 1.0, v103
    v_rcp_f32 v96, v96
    v_rcp_f32 v97, v97
    v_rcp_f32 v98, v98
    v_rcp_f32 v99, v99
    v_rcp_f32 v100, v100
    v_rcp_f32 v101, v101
    v_rcp_f32 v102, v102
    v_rcp_f32 v103, v103
    v_mul_f32 v80, v80, v96
    v_mul_f32 v81, v81, v97
    v_mul_f32 v82, v82, v98
    v_mul_f32 v83, v83, v99
    v_mul_f32 v84, v84, v100
    v_mul_f32 v85, v85, v101
    v_mul_f32 v86, v86, v102
    v_mul_f32 v87, v87, v103
    v_cvt_pk_bf16_f32 v104, v80, v81
    v_cvt_pk_bf16_f32 v105, v82, v83
    v_cvt_pk_bf16_f32 v106, v84, v85
    v_cvt_pk_bf16_f32 v107, v86, v87
    buffer_store_dwordx4 v[104:107], v8, s[12:15], s63 offen sc1
    v_mul_f32 v96, v88, v88
    v_mul_f32 v97, v89, v89
    v_mul_f32 v98, v90, v90
    v_mul_f32 v99, v91, v91
    v_mul_f32 v100, v92, v92
    v_mul_f32 v101, v93, v93
    v_mul_f32 v102, v94, v94
    v_mul_f32 v103, v95, v95
    v_fma_f32 v96, v96, s56, v112
    v_fma_f32 v97, v97, s56, v112
    v_fma_f32 v98, v98, s56, v112
    v_fma_f32 v99, v99, s56, v112
    v_fma_f32 v100, v100, s56, v112
    v_fma_f32 v101, v101, s56, v112
    v_fma_f32 v102, v102, s56, v112
    v_fma_f32 v103, v103, s56, v112
    v_mul_f32 v96, v96, v88
    v_mul_f32 v97, v97, v89
    v_mul_f32 v98, v98, v90
    v_mul_f32 v99, v99, v91
    v_mul_f32 v100, v100, v92
    v_mul_f32 v101, v101, v93
    v_mul_f32 v102, v102, v94
    v_mul_f32 v103, v103, v95
    v_exp_f32 v96, v96
    v_exp_f32 v97, v97
    v_exp_f32 v98, v98
    v_exp_f32 v99, v99
    v_exp_f32 v100, v100
    v_exp_f32 v101, v101
    v_exp_f32 v102, v102
    v_exp_f32 v103, v103
    v_add_f32 v96, 1.0, v96
    v_add_f32 v97, 1.0, v97
    v_add_f32 v98, 1.0, v98
    v_add_f32 v99, 1.0, v99
    v_add_f32 v100, 1.0, v100
    v_add_f32 v101, 1.0, v101
    v_add_f32 v102, 1.0, v102
    v_add_f32 v103, 1.0, v103
    v_rcp_f32 v96, v96
    v_rcp_f32 v97, v97
    v_rcp_f32 v98, v98
    v_rcp_f32 v99, v99
    v_rcp_f32 v100, v100
    v_rcp_f32 v101, v101
    v_rcp_f32 v102, v102
    v_rcp_f32 v103, v103
    v_mul_f32 v88, v88, v96
    v_mul_f32 v89, v89, v97
    v_mul_f32 v90, v90, v98
    v_mul_f32 v91, v91, v99
    v_mul_f32 v92, v92, v100
    v_mul_f32 v93, v93, v101
    v_mul_f32 v94, v94, v102
    v_mul_f32 v95, v95, v103
    v_cvt_pk_bf16_f32 v108, v88, v89
    v_cvt_pk_bf16_f32 v109, v90, v91
    v_cvt_pk_bf16_f32 v110, v92, v93
    v_cvt_pk_bf16_f32 v111, v94, v95
    buffer_store_dwordx4 v[108:111], v9, s[12:15], s63 offen sc1
    s_add_u32 s63, s63, 229376
    s_mov_b32 s67, 0
    s_mov_b32 s71, 1
    s_cmp_gt_u32 s66, s60
    s_cbranch_scc1 L_g_g1r_93
    v_mov_b32 v10, 1
    s_mov_b64 exec, 1
    s_waitcnt vmcnt(0)
    ds_add_rtn_u32 v10, v15, v10 offset:4
    s_waitcnt lgkmcnt(0)
    v_readfirstlane_b32 s46, v10
    s_mov_b64 exec, -1
    s_mov_b32 s71, 0
    s_sub_u32 s59, s60, 1
    s_cmp_lg_u32 s46, s68
    s_cbranch_scc1 L_g_df_123
    v_mov_b32 v10, s59
    v_add_u32 v10, 1, v10
    v_mov_b32 v11, 0
    s_mov_b64 exec, 1
    buffer_store_dword v10, v11, s[12:15], s52 offen sc1
    s_mov_b64 exec, -1
L_sf_124:
L_g_df_123:
    s_add_u32 s68, s68, 4
    s_cmp_gt_u32 s66, s60
    s_cbranch_scc1 L_g_g1r_93
L_g_tail_96:
    s_cmp_lt_u32 s60, 64
    s_cbranch_scc1 L_g_restart_91
    s_barrier
    s_branch L_c_done_1
L_w_f2_11:
    s_load_dwordx2 s[4:5], s[0:1], 80
    s_load_dwordx2 s[6:7], s[0:1], 72
    s_and_b32 s50, s44, 3
    s_lshr_b32 s51, s44, 2
    s_waitcnt lgkmcnt(0)
    s_mov_b32 s24, s4
    s_and_b32 s25, s5, 0xffff
    s_mov_b32 s26, 0x700000
    s_mov_b32 s27, 0x00020000
    v_lshrrev_b32 v3, 4, v1
    v_and_b32 v4, 15, v1
    v_lshlrev_b32 v5, 2, v3
    v_xor_b32 v4, v4, v5
    v_mul_u32_u24 v3, 2048, v3
    v_lshl_add_u32 v3, v4, 4, v3
    s_mul_i32 s46, s51, 448
    s_mul_i32 s47, s50, 56
    s_add_u32 s46, s46, s47
    s_mul_i32 s47, s42, 896
    s_add_u32 s46, s46, s47
    s_mul_i32 s46, s46, 2048
    s_lshl_b32 s47, s43, 8
    s_add_u32 s46, s46, s47
    s_lshl_b32 s45, s51, 16
    s_mul_i32 s47, s50, 14336
    s_add_u32 s45, s45, s47
    v_bfe_u32 v4, v1, 2, 2
    v_bfe_u32 v5, v1, 4, 1
    v_lshlrev_b32 v5, 1, v5
    v_bfe_u32 v6, v1, 1, 1
    v_add_u32 v5, v5, v6
    s_lshl_b32 s47, s50, 2
    v_add_u32 v5, s47, v5
    v_lshlrev_b32 v6, 2, v4
    v_xor_b32 v5, v5, v6
    v_lshlrev_b32 v5, 4, v5
    v_lshl_add_u32 v5, v4, 8, v5
    v_bfe_u32 v6, v1, 0, 1
    v_lshl_add_u32 v5, v6, 3, v5
    v_lshrrev_b32 v6, 5, v1
    v_mul_u32_u24 v6, 1024, v6
    v_add_u32 v5, v5, v6
    s_lshl_b32 s47, s51, 16
    v_add_u32 v5, s47, v5
    v_bfe_u32 v4, v1, 2, 2
    v_xor_b32 v5, s50, v4
    v_lshlrev_b32 v5, 6, v5
    v_lshl_add_u32 v5, v4, 8, v5
    v_and_b32 v6, 3, v1
    v_lshl_add_u32 v5, v6, 3, v5
    v_lshrrev_b32 v6, 4, v1
    v_lshl_add_u32 v5, v6, 10, v5
    s_lshl_b32 s47, s51, 16
    v_add_u32 v5, s47, v5
    s_add_u32 m0, s45, 0
    s_add_u32 s47, s46, 0x0
    buffer_load_dwordx4 v3, s[24:27], s47 offen lds
    s_add_u32 m0, s45, 1024
    s_add_u32 s47, s46, 0x2000
    buffer_load_dwordx4 v3, s[24:27], s47 offen lds
    s_add_u32 m0, s45, 2048
    s_add_u32 s47, s46, 0x4000
    buffer_load_dwordx4 v3, s[24:27], s47 offen lds
    s_add_u32 m0, s45, 3072
    s_add_u32 s47, s46, 0x6000
    buffer_load_dwordx4 v3, s[24:27], s47 offen lds
    s_add_u32 m0, s45, 4096
    s_add_u32 s47, s46, 0x8000
    buffer_load_dwordx4 v3, s[24:27], s47 offen lds
    s_add_u32 m0, s45, 5120
    s_add_u32 s47, s46, 0xa000
    buffer_load_dwordx4 v3, s[24:27], s47 offen lds
    s_add_u32 m0, s45, 6144
    s_add_u32 s47, s46, 0xc000
    buffer_load_dwordx4 v3, s[24:27], s47 offen lds
    s_add_u32 m0, s45, 7168
    s_add_u32 s47, s46, 0xe000
    buffer_load_dwordx4 v3, s[24:27], s47 offen lds
    s_add_u32 m0, s45, 8192
    s_add_u32 s47, s46, 0x10000
    buffer_load_dwordx4 v3, s[24:27], s47 offen lds
    s_add_u32 m0, s45, 9216
    s_add_u32 s47, s46, 0x12000
    buffer_load_dwordx4 v3, s[24:27], s47 offen lds
    s_add_u32 m0, s45, 10240
    s_add_u32 s47, s46, 0x14000
    buffer_load_dwordx4 v3, s[24:27], s47 offen lds
    s_add_u32 m0, s45, 11264
    s_add_u32 s47, s46, 0x16000
    buffer_load_dwordx4 v3, s[24:27], s47 offen lds
    s_add_u32 m0, s45, 12288
    s_add_u32 s47, s46, 0x18000
    buffer_load_dwordx4 v3, s[24:27], s47 offen lds
    s_add_u32 m0, s45, 13312
    s_add_u32 s47, s46, 0x1a000
    buffer_load_dwordx4 v3, s[24:27], s47 offen lds
    s_waitcnt vmcnt(0)
    s_barrier
    ds_read_b64_tr_b16 a[0:1], v5 offset:0
    ds_read_b64_tr_b16 a[2:3], v5 offset:4096
    ds_read_b64_tr_b16 a[4:5], v5 offset:32
    ds_read_b64_tr_b16 a[6:7], v5 offset:4128
    ds_read_b64_tr_b16 a[8:9], v5 offset:8192
    ds_read_b64_tr_b16 a[10:11], v5 offset:12288
    ds_read_b64_tr_b16 a[12:13], v5 offset:8224
    ds_read_b64_tr_b16 a[14:15], v5 offset:12320
    s_waitcnt lgkmcnt(0)
    ds_read_b64_tr_b16 a[16:17], v5 offset:16384
    ds_read_b64_tr_b16 a[18:19], v5 offset:20480
    ds_read_b64_tr_b16 a[20:21], v5 offset:16416
    ds_read_b64_tr_b16 a[22:23], v5 offset:20512
    ds_read_b64_tr_b16 a[24:25], v5 offset:24576
    ds_read_b64_tr_b16 a[26:27], v5 offset:28672
    ds_read_b64_tr_b16 a[28:29], v5 offset:24608
    ds_read_b64_tr_b16 a[30:31], v5 offset:28704
    s_waitcnt lgkmcnt(0)
    ds_read_b64_tr_b16 a[32:33], v5 offset:32768
    ds_read_b64_tr_b16 a[34:35], v5 offset:36864
    ds_read_b64_tr_b16 a[36:37], v5 offset:32800
    ds_read_b64_tr_b16 a[38:39], v5 offset:36896
    ds_read_b64_tr_b16 a[40:41], v5 offset:40960
    ds_read_b64_tr_b16 a[42:43], v5 offset:45056
    ds_read_b64_tr_b16 a[44:45], v5 offset:40992
    ds_read_b64_tr_b16 a[46:47], v5 offset:45088
    s_waitcnt lgkmcnt(0)
    ds_read_b64_tr_b16 a[48:49], v5 offset:49152
    ds_read_b64_tr_b16 a[50:51], v5 offset:53248
    ds_read_b64_tr_b16 a[52:53], v5 offset:49184
    ds_read_b64_tr_b16 a[54:55], v5 offset:53280
    s_waitcnt lgkmcnt(0)
    s_barrier
    s_add_u32 m0, s45, 0
    s_add_u32 s47, s46, 0x70000
    buffer_load_dwordx4 v3, s[24:27], s47 offen lds
    s_add_u32 m0, s45, 1024
    s_add_u32 s47, s46, 0x72000
    buffer_load_dwordx4 v3, s[24:27], s47 offen lds
    s_add_u32 m0, s45, 2048
    s_add_u32 s47, s46, 0x74000
    buffer_load_dwordx4 v3, s[24:27], s47 offen lds
    s_add_u32 m0, s45, 3072
    s_add_u32 s47, s46, 0x76000
    buffer_load_dwordx4 v3, s[24:27], s47 offen lds
    s_add_u32 m0, s45, 4096
    s_add_u32 s47, s46, 0x78000
    buffer_load_dwordx4 v3, s[24:27], s47 offen lds
    s_add_u32 m0, s45, 5120
    s_add_u32 s47, s46, 0x7a000
    buffer_load_dwordx4 v3, s[24:27], s47 offen lds
    s_add_u32 m0, s45, 6144
    s_add_u32 s47, s46, 0x7c000
    buffer_load_dwordx4 v3, s[24:27], s47 offen lds
    s_add_u32 m0, s45, 7168
    s_add_u32 s47, s46, 0x7e000
    buffer_load_dwordx4 v3, s[24:27], s47 offen lds
    s_add_u32 m0, s45, 8192
    s_add_u32 s47, s46, 0x80000
    buffer_load_dwordx4 v3, s[24:27], s47 offen lds
    s_add_u32 m0, s45, 9216
    s_add_u32 s47, s46, 0x82000
    buffer_load_dwordx4 v3, s[24:27], s47 offen lds
    s_add_u32 m0, s45, 10240
    s_add_u32 s47, s46, 0x84000
    buffer_load_dwordx4 v3, s[24:27], s47 offen lds
    s_add_u32 m0, s45, 11264
    s_add_u32 s47, s46, 0x86000
    buffer_load_dwordx4 v3, s[24:27], s47 offen lds
    s_add_u32 m0, s45, 12288
    s_add_u32 s47, s46, 0x88000
    buffer_load_dwordx4 v3, s[24:27], s47 offen lds
    s_add_u32 m0, s45, 13312
    s_add_u32 s47, s46, 0x8a000
    buffer_load_dwordx4 v3, s[24:27], s47 offen lds
    s_waitcnt vmcnt(0)
    s_barrier
    ds_read_b64_tr_b16 a[56:57], v5 offset:0
    ds_read_b64_tr_b16 a[58:59], v5 offset:4096
    ds_read_b64_tr_b16 a[60:61], v5 offset:32
    ds_read_b64_tr_b16 a[62:63], v5 offset:4128
    ds_read_b64_tr_b16 a[64:65], v5 offset:8192
    ds_read_b64_tr_b16 a[66:67], v5 offset:12288
    ds_read_b64_tr_b16 a[68:69], v5 offset:8224
    ds_read_b64_tr_b16 a[70:71], v5 offset:12320
    s_waitcnt lgkmcnt(0)
    ds_read_b64_tr_b16 a[72:73], v5 offset:16384
    ds_read_b64_tr_b16 a[74:75], v5 offset:20480
    ds_read_b64_tr_b16 a[76:77], v5 offset:16416
    ds_read_b64_tr_b16 a[78:79], v5 offset:20512
    ds_read_b64_tr_b16 a[80:81], v5 offset:24576
    ds_read_b64_tr_b16 a[82:83], v5 offset:28672
    ds_read_b64_tr_b16 a[84:85], v5 offset:24608
    ds_read_b64_tr_b16 a[86:87], v5 offset:28704
    s_waitcnt lgkmcnt(0)
    ds_read_b64_tr_b16 a[88:89], v5 offset:32768
    ds_read_b64_tr_b16 a[90:91], v5 offset:36864
    ds_read_b64_tr_b16 a[92:93], v5 offset:32800
    ds_read_b64_tr_b16 a[94:95], v5 offset:36896
    ds_read_b64_tr_b16 a[96:97], v5 offset:40960
    ds_read_b64_tr_b16 a[98:99], v5 offset:45056
    ds_read_b64_tr_b16 a[100:101], v5 offset:40992
    ds_read_b64_tr_b16 a[102:103], v5 offset:45088
    s_waitcnt lgkmcnt(0)
    ds_read_b64_tr_b16 a[104:105], v5 offset:49152
    ds_read_b64_tr_b16 a[106:107], v5 offset:53248
    ds_read_b64_tr_b16 a[108:109], v5 offset:49184
    ds_read_b64_tr_b16 a[110:111], v5 offset:53280
    s_waitcnt lgkmcnt(0)
    s_barrier
    v_lshlrev_b32 v2, 4, v1
    s_mul_i32 s64, s44, 7168
    s_add_u32 s46, s64, 0x6000000
    s_mul_i32 s47, s42, 57344
    s_add_u32 s46, s46, s47
    v_add_u32 v3, s46, v2
    s_mul_i32 s46, s51, 28672
    v_add_u32 v4, s46, v2
    v_and_b32 v6, 15, v1
    v_lshlrev_b32 v6, 4, v6
    v_lshrrev_b32 v7, 4, v1
    v_lshl_add_u32 v6, v7, 9, v6
    v_add_u32 v4, s46, v6
    s_lshl_b32 s46, s50, 12
    s_add_u32 s46, s46, 131072
    v_add_u32 v5, s46, v2
    v_min_u32 v7, 6, v1
    v_lshlrev_b32 v7, 7, v7
    s_mul_i32 s46, s42, 896
    s_add_u32 s46, s46, 0x106400
    v_add_u32 v7, s46, v7
    s_lshl_b32 s46, s42, 16
    s_lshl_b32 s47, s43, 11
    s_add_u32 s46, s46, s47
    s_lshl_b32 s47, s50, 9
    s_add_u32 s46, s46, s47
    s_add_u32 s46, s46, 0xb000000
    v_and_b32 v8, 31, v1
    v_lshlrev_b32 v8, 4, v8
    v_lshrrev_b32 v9, 5, v1
    v_lshl_add_u32 v8, v9, 14, v8
    v_add_u32 v8, s46, v8
    v_add_u32 v9, 0x8000, v8
    s_lshl_b32 s52, s43, 9
    s_lshl_b32 s47, s42, 7
    s_add_u32 s52, s52, s47
    s_add_u32 s52, s52, 0x108400
    s_mov_b32 s60, 0
    s_mov_b32 s61, 0
    s_mov_b32 s62, 0
    s_mov_b32 s63, 0
    s_mov_b32 s67, 0
    s_mov_b32 s68, 3
    s_mov_b32 s71, 0
    v_mov_b32 v15, 147456
    v_mov_b32 v14, 0
    ds_write_b32 v15, v14 offset:4
L_g_restart_125:
    s_cmp_lg_u32 s44, 0
    s_cbranch_scc1 L_g_nsp_126
    s_mov_b32 s70, 0
L_g_sp_132:
    s_add_u32 s54, s60, 0
    s_add_u32 s55, s54, 0
    s_mov_b32 s46, 0
    buffer_load_dword v11, v7, s[12:15], s46 offen sc1
    s_waitcnt vmcnt(0)
    v_cmp_ge_u32 vcc, s60, v11
    s_add_u32 s70, s70, 1
    s_cbranch_vccz L_g_sp_132_ok
    s_sleep 3
    s_cmp_lt_u32 s70, 524288
    s_cbranch_scc1 L_g_sp_132
    s_branch L_c_done_1
L_g_sp_132_ok:
    s_mov_b32 s46, s54
    v_cmp_ge_u32 vcc, s46, v11
    s_nop 0
    s_cbranch_vccnz L_g_le_133
    s_add_u32 s46, s46, 1
    v_cmp_ge_u32 vcc, s46, v11
    s_nop 0
    s_cbranch_vccnz L_g_le_133
    s_add_u32 s46, s46, 1
    v_cmp_ge_u32 vcc, s46, v11
    s_nop 0
    s_cbranch_vccnz L_g_le_133
    s_add_u32 s46, s46, 1
L_g_le_133:
    v_mov_b32 v11, s46
    ds_write_b32 v15, v11
L_g_nsp_126:
    s_waitcnt lgkmcnt(0)
    s_barrier
    ds_read_b32 v14, v15
    s_waitcnt lgkmcnt(0)
    v_readfirstlane_b32 s66, v14
    s_nop 3
L_g_restart_125_go:
    s_mov_b32 s69, 0
    s_cmp_gt_u32 s62, s60
    s_cbranch_scc1 L_g_nd_134
    s_cmp_ge_u32 s62, s66
    s_cbranch_scc1 L_g_nd_134
    s_add_u32 s47, s61, 4096
    s_add_u32 m0, s64, 0
    s_nop 0
    buffer_load_dwordx4 v3, s[12:15], s61 offen offset:0 sc1 lds
    buffer_load_dwordx4 v3, s[12:15], s61 offen offset:1024 sc1 lds
    buffer_load_dwordx4 v3, s[12:15], s61 offen offset:2048 sc1 lds
    buffer_load_dwordx4 v3, s[12:15], s61 offen offset:3072 sc1 lds
    s_add_u32 m0, s64, 4096
    s_nop 0
    buffer_load_dwordx4 v3, s[12:15], s47 offen offset:0 sc1 lds
    buffer_load_dwordx4 v3, s[12:15], s47 offen offset:1024 sc1 lds
    buffer_load_dwordx4 v3, s[12:15], s47 offen offset:2048 sc1 lds
    s_add_u32 s61, s61, 229376
    s_add_u32 s62, s62, 1
    s_xor_b32 s64, s64, 0x10000
    s_mov_b32 s69, 1
L_g_nd_134:
    s_cmp_eq_u32 s51, 1
    s_cbranch_scc1 L_g_g1r_127
    s_add_u32 s59, s60, 1
    s_mov_b32 s69, 0
    s_cmp_gt_u32 s62, s59
    s_cbranch_scc1 L_g_nd_135
    s_cmp_ge_u32 s62, s66
    s_cbranch_scc1 L_g_nd_135
    s_add_u32 s47, s61, 4096
    s_add_u32 m0, s64, 0
    s_nop 0
    buffer_load_dwordx4 v3, s[12:15], s61 offen offset:0 sc1 lds
    buffer_load_dwordx4 v3, s[12:15], s61 offen offset:1024 sc1 lds
    buffer_load_dwordx4 v3, s[12:15], s61 offen offset:2048 sc1 lds
    buffer_load_dwordx4 v3, s[12:15], s61 offen offset:3072 sc1 lds
    s_add_u32 m0, s64, 4096
    s_nop 0
    buffer_load_dwordx4 v3, s[12:15], s47 offen offset:0 sc1 lds
    buffer_load_dwordx4 v3, s[12:15], s47 offen offset:1024 sc1 lds
    buffer_load_dwordx4 v3, s[12:15], s47 offen offset:2048 sc1 lds
    s_add_u32 s61, s61, 229376
    s_add_u32 s62, s62, 1
    s_xor_b32 s64, s64, 0x10000
    s_mov_b32 s69, 1
L_g_nd_135:
    s_cmp_eq_u32 s69, 1
    s_cbranch_scc1 L_g_w0_136
    s_waitcnt vmcnt(0)
L_g_w0_136:
    s_waitcnt vmcnt(7)
    s_mov_b32 s65, 1
.p2align 6
L_g_loop0_128:
    s_barrier
    s_cmp_eq_u32 s65, 0
    s_cbranch_scc1 L_g_pr_137
    ds_read_b128 v[32:35], v4 offset:0
    ds_read_b128 v[36:39], v4 offset:256
    ds_read_b128 v[40:43], v4 offset:2048
    ds_read_b128 v[44:47], v4 offset:2304
    ds_read_b128 v[48:51], v4 offset:4096
    ds_read_b128 v[52:55], v4 offset:4352
    ds_read_b128 v[56:59], v4 offset:6144
    ds_read_b128 v[60:63], v4 offset:6400
L_g_pr_137:
    ds_read_b32 v14, v15
    s_cmp_lg_u32 s44, 0
    s_cbranch_scc1 L_g_nl_138
    s_add_u32 s54, s60, 1
    s_add_u32 s55, s54, 0
    s_mov_b32 s46, 0
    buffer_load_dword v11, v7, s[12:15], s46 offen sc1
L_g_nl_138:
    s_setprio 1
    s_waitcnt lgkmcnt(7)
    v_mfma_f32_16x16x32_bf16 v[16:19], v[32:35], a[0:3], 0
    v_mfma_f32_16x16x32_bf16 v[20:23], v[32:35], a[4:7], 0
    ds_read_b128 v[32:35], v4 offset:8192
    s_waitcnt lgkmcnt(7)
    v_mfma_f32_16x16x32_bf16 v[24:27], v[36:39], a[0:3], 0
    v_mfma_f32_16x16x32_bf16 v[28:31], v[36:39], a[4:7], 0
    ds_read_b128 v[36:39], v4 offset:8448
    s_waitcnt lgkmcnt(7)
    v_mfma_f32_16x16x32_bf16 v[16:19], v[40:43], a[8:11], v[16:19]
    v_mfma_f32_16x16x32_bf16 v[20:23], v[40:43], a[12:15], v[20:23]
    ds_read_b128 v[40:43], v4 offset:10240
    s_waitcnt lgkmcnt(7)
    v_mfma_f32_16x16x32_bf16 v[24:27], v[44:47], a[8:11], v[24:27]
    v_mfma_f32_16x16x32_bf16 v[28:31], v[44:47], a[12:15], v[28:31]
    ds_read_b128 v[44:47], v4 offset:10496
    s_waitcnt lgkmcnt(7)
    v_mfma_f32_16x16x32_bf16 v[16:19], v[48:51], a[16:19], v[16:19]
    v_mfma_f32_16x16x32_bf16 v[20:23], v[48:51], a[20:23], v[20:23]
    ds_read_b128 v[48:51], v4 offset:12288
    s_waitcnt lgkmcnt(7)
    v_mfma_f32_16x16x32_bf16 v[24:27], v[52:55], a[16:19], v[24:27]
    v_mfma_f32_16x16x32_bf16 v[28:31], v[52:55], a[20:23], v[28:31]
    ds_read_b128 v[52:55], v4 offset:12544
    s_waitcnt lgkmcnt(7)
    v_mfma_f32_16x16x32_bf16 v[16:19], v[56:59], a[24:27], v[16:19]
    v_mfma_f32_16x16x32_bf16 v[20:23], v[56:59], a[28:31], v[20:23]
    ds_read_b128 v[56:59], v4 offset:14336
    s_waitcnt lgkmcnt(7)
    v_mfma_f32_16x16x32_bf16 v[24:27], v[60:63], a[24:27], v[24:27]
    v_mfma_f32_16x16x32_bf16 v[28:31], v[60:63], a[28:31], v[28:31]
    ds_read_b128 v[60:63], v4 offset:14592
    s_waitcnt lgkmcnt(7)
    v_mfma_f32_16x16x32_bf16 v[16:19], v[32:35], a[32:35], v[16:19]
    v_mfma_f32_16x16x32_bf16 v[20:23], v[32:35], a[36:39], v[20:23]
    ds_read_b128 v[32:35], v4 offset:16384
    s_waitcnt lgkmcnt(7)
    v_mfma_f32_16x16x32_bf16 v[24:27], v[36:39], a[32:35], v[24:27]
    v_mfma_f32_16x16x32_bf16 v[28:31], v[36:39], a[36:39], v[28:31]
    ds_read_b128 v[36:39], v4 offset:16640
    s_waitcnt lgkmcnt(7)
    v_mfma_f32_16x16x32_bf16 v[16:19], v[40:43], a[40:43], v[16:19]
    v_mfma_f32_16x16x32_bf16 v[20:23], v[40:43], a[44:47], v[20:23]
    ds_read_b128 v[40:43], v4 offset:18432
    s_waitcnt lgkmcnt(7)
    v_mfma_f32_16x16x32_bf16 v[24:27], v[44:47], a[40:43], v[24:27]
    v_mfma_f32_16x16x32_bf16 v[28:31], v[44:47], a[44:47], v[28:31]
    ds_read_b128 v[44:47], v4 offset:18688
    s_waitcnt lgkmcnt(7)
    v_mfma_f32_16x16x32_bf16 v[16:19], v[48:51], a[48:51], v[16:19]
    v_mfma_f32_16x16x32_bf16 v[20:23], v[48:51], a[52:55], v[20:23]
    ds_read_b128 v[48:51], v4 offset:20480
    s_waitcnt lgkmcnt(7)
    v_mfma_f32_16x16x32_bf16 v[24:27], v[52:55], a[48:51], v[24:27]
    v_mfma_f32_16x16x32_bf16 v[28:31], v[52:55], a[52:55], v[28:31]
    ds_read_b128 v[52:55], v4 offset:20736
    s_waitcnt lgkmcnt(7)
    v_mfma_f32_16x16x32_bf16 v[16:19], v[56:59], a[56:59], v[16:19]
    v_mfma_f32_16x16x32_bf16 v[20:23], v[56:59], a[60:63], v[20:23]
    ds_read_b128 v[56:59], v4 offset:22528
    s_waitcnt lgkmcnt(7)
    v_mfma_f32_16x16x32_bf16 v[24:27], v[60:63], a[56:59], v[24:27]
    v_mfma_f32_16x16x32_bf16 v[28:31], v[60:63], a[60:63], v[28:31]
    ds_read_b128 v[60:63], v4 offset:22784
    s_waitcnt lgkmcnt(7)
    v_mfma_f32_16x16x32_bf16 v[16:19], v[32:35], a[64:67], v[16:19]
    v_mfma_f32_16x16x32_bf16 v[20:23], v[32:35], a[68:71], v[20:23]
    ds_read_b128 v[32:35], v4 offset:24576
    s_waitcnt lgkmcnt(7)
    v_mfma_f32_16x16x32_bf16 v[24:27], v[36:39], a[64:67], v[24:27]
    v_mfma_f32_16x16x32_bf16 v[28:31], v[36:39], a[68:71], v[28:31]
    ds_read_b128 v[36:39], v4 offset:24832
    s_waitcnt lgkmcnt(7)
    v_mfma_f32_16x16x32_bf16 v[16:19], v[40:43], a[72:75], v[16:19]
    v_mfma_f32_16x16x32_bf16 v[20:23], v[40:43], a[76:79], v[20:23]
    ds_read_b128 v[40:43], v4 offset:26624
    s_waitcnt lgkmcnt(7)
    v_mfma_f32_16x16x32_bf16 v[24:27], v[44:47], a[72:75], v[24:27]
    v_mfma_f32_16x16x32_bf16 v[28:31], v[44:47], a[76:79], v[28:31]
    ds_read_b128 v[44:47], v4 offset:26880
    s_waitcnt lgkmcnt(7)
    v_mfma_f32_16x16x32_bf16 v[16:19], v[48:51], a[80:83], v[16:19]
    v_mfma_f32_16x16x32_bf16 v[20:23], v[48:51], a[84:87], v[20:23]
    s_waitcnt lgkmcnt(6)
    v_mfma_f32_16x16x32_bf16 v[24:27], v[52:55], a[80:83], v[24:27]
    v_mfma_f32_16x16x32_bf16 v[28:31], v[52:55], a[84:87], v[28:31]
    s_waitcnt lgkmcnt(5)
    v_mfma_f32_16x16x32_bf16 v[16:19], v[56:59], a[88:91], v[16:19]
    v_mfma_f32_16x16x32_bf16 v[20:23], v[56:59], a[92:95], v[20:23]
    s_waitcnt lgkmcnt(4)
    v_mfma_f32_16x16x32_bf16 v[24:27], v[60:63], a[88:91], v[24:27]
    v_mfma_f32_16x16x32_bf16 v[28:31], v[60:63], a[92:95], v[28:31]
    s_waitcnt lgkmcnt(3)
    v_mfma_f32_16x16x32_bf16 v[16:19], v[32:35], a[96:99], v[16:19]
    v_mfma_f32_16x16x32_bf16 v[20:23], v[32:35], a[100:103], v[20:23]
    s_waitcnt lgkmcnt(2)
    v_mfma_f32_16x16x32_bf16 v[24:27], v[36:39], a[96:99], v[24:27]
    v_mfma_f32_16x16x32_bf16 v[28:31], v[36:39], a[100:103], v[28:31]
    s_waitcnt lgkmcnt(1)
    v_mfma_f32_16x16x32_bf16 v[16:19], v[40:43], a[104:107], v[16:19]
    v_mfma_f32_16x16x32_bf16 v[20:23], v[40:43], a[108:111], v[20:23]
    s_waitcnt lgkmcnt(0)
    v_mfma_f32_16x16x32_bf16 v[24:27], v[44:47], a[104:107], v[24:27]
    v_mfma_f32_16x16x32_bf16 v[28:31], v[44:47], a[108:111], v[28:31]
    v_xor_b32 v4, 0x10000, v4
    s_setprio 0
    s_waitcnt vmcnt(0)
    v_readfirstlane_b32 s66, v14
    s_barrier
    s_nop 6
    ds_write_b128 v5, v[16:19] offset:0
    ds_write_b128 v5, v[20:23] offset:1024
    ds_write_b128 v5, v[24:27] offset:2048
    ds_write_b128 v5, v[28:31] offset:3072
    s_cmp_lg_u32 s44, 0
    s_cbranch_scc1 L_g_ne_139
    s_mov_b32 s46, s54
    v_cmp_ge_u32 vcc, s46, v11
    s_nop 0
    s_cbranch_vccnz L_g_le_142
    s_add_u32 s46, s46, 1
    v_cmp_ge_u32 vcc, s46, v11
    s_nop 0
    s_cbranch_vccnz L_g_le_142
    s_add_u32 s46, s46, 1
    v_cmp_ge_u32 vcc, s46, v11
    s_nop 0
    s_cbranch_vccnz L_g_le_142
    s_add_u32 s46, s46, 1
L_g_le_142:
    v_mov_b32 v11, s46
    ds_write_b32 v15, v11
L_g_ne_139:
    s_add_u32 s60, s60, 1
    s_mov_b32 s69, 0
    s_cmp_gt_u32 s62, s60
    s_cbranch_scc1 L_g_nd_143
    s_cmp_ge_u32 s62, s66
    s_cbranch_scc1 L_g_nd_143
    s_add_u32 s47, s61, 4096
    s_add_u32 m0, s64, 0
    s_nop 0
    buffer_load_dwordx4 v3, s[12:15], s61 offen offset:0 sc1 lds
    buffer_load_dwordx4 v3, s[12:15], s61 offen offset:1024 sc1 lds
    buffer_load_dwordx4 v3, s[12:15], s61 offen offset:2048 sc1 lds
    buffer_load_dwordx4 v3, s[12:15], s61 offen offset:3072 sc1 lds
    s_add_u32 m0, s64, 4096
    s_nop 0
    buffer_load_dwordx4 v3, s[12:15], s47 offen offset:0 sc1 lds
    buffer_load_dwordx4 v3, s[12:15], s47 offen offset:1024 sc1 lds
    buffer_load_dwordx4 v3, s[12:15], s47 offen offset:2048 sc1 lds
    s_add_u32 s61, s61, 229376
    s_add_u32 s62, s62, 1
    s_xor_b32 s64, s64, 0x10000
    s_mov_b32 s69, 1
L_g_nd_143:
    s_mov_b32 s65, s69
    s_add_u32 s59, s60, 1
    s_mov_b32 s69, 0
    s_cmp_gt_u32 s62, s59
    s_cbranch_scc1 L_g_nd_144
    s_cmp_ge_u32 s62, s66
    s_cbranch_scc1 L_g_nd_144
    s_add_u32 s47, s61, 4096
    s_add_u32 m0, s64, 0
    s_nop 0
    buffer_load_dwordx4 v3, s[12:15], s61 offen offset:0 sc1 lds
    buffer_load_dwordx4 v3, s[12:15], s61 offen offset:1024 sc1 lds
    buffer_load_dwordx4 v3, s[12:15], s61 offen offset:2048 sc1 lds
    buffer_load_dwordx4 v3, s[12:15], s61 offen offset:3072 sc1 lds
    s_add_u32 m0, s64, 4096
    s_nop 0
    buffer_load_dwordx4 v3, s[12:15], s47 offen offset:0 sc1 lds
    buffer_load_dwordx4 v3, s[12:15], s47 offen offset:1024 sc1 lds
    buffer_load_dwordx4 v3, s[12:15], s47 offen offset:2048 sc1 lds
    s_add_u32 s61, s61, 229376
    s_add_u32 s62, s62, 1
    s_xor_b32 s64, s64, 0x10000
    s_mov_b32 s69, 1
L_g_nd_144:
    s_cmp_le_u32 s66, s60
    s_cbranch_scc1 L_g_ex0_141
    s_cmp_eq_u32 s65, 0
    s_cbranch_scc1 L_g_nw_140
    s_waitcnt vmcnt(0) lgkmcnt(0)
    s_branch L_g_loop0_128
L_g_nw_140:
    ds_read_b128 v[32:35], v4 offset:0
    ds_read_b128 v[36:39], v4 offset:256
    ds_read_b128 v[40:43], v4 offset:2048
    ds_read_b128 v[44:47], v4 offset:2304
    ds_read_b128 v[48:51], v4 offset:4096
    ds_read_b128 v[52:55], v4 offset:4352
    ds_read_b128 v[56:59], v4 offset:6144
    ds_read_b128 v[60:63], v4 offset:6400
    s_waitcnt lgkmcnt(8)
    s_branch L_g_loop0_128
L_g_ex0_141:
    s_cmp_lg_u32 s44, 0
    s_cbranch_scc1 L_g_ex0_141_n
    s_sleep 6
    s_add_u32 s54, s60, 0
    s_add_u32 s55, s54, 0
    s_mov_b32 s46, 0
    buffer_load_dword v11, v7, s[12:15], s46 offen sc1
    s_waitcnt vmcnt(0)
    s_mov_b32 s46, s54
    v_cmp_ge_u32 vcc, s46, v11
    s_nop 0
    s_cbranch_vccnz L_g_le_145
    s_add_u32 s46, s46, 1
    v_cmp_ge_u32 vcc, s46, v11
    s_nop 0
    s_cbranch_vccnz L_g_le_145
    s_add_u32 s46, s46, 1
    v_cmp_ge_u32 vcc, s46, v11
    s_nop 0
    s_cbranch_vccnz L_g_le_145
    s_add_u32 s46, s46, 1
L_g_le_145:
    v_mov_b32 v11, s46
    ds_write_b32 v15, v11
L_g_ex0_141_n:
    s_waitcnt lgkmcnt(0)
    s_barrier
    ds_read_b32 v14, v15
    s_waitcnt lgkmcnt(0)
    v_readfirstlane_b32 s66, v14
    s_barrier
    s_cmp_gt_u32 s66, s60
    s_cbranch_scc1 L_g_restart_125_go
    s_branch L_g_tail_130
L_g_g1r_127:
    s_mov_b32 s65, 1
    s_branch L_g_loop1_129_e
.p2align 6
L_g_loop1_129:
    s_mov_b32 s65, 0
L_g_loop1_129_e:
    s_barrier
    ds_read_b32 v14, v15
    s_bitcmp1_b32 s67, 1
    s_cbranch_scc0 L_g_nfl_146
    s_sub_u32 s59, s60, 2
    s_cmp_lg_u32 s44, 4
    s_cbranch_scc1 L_sf_151
    v_mov_b32 v10, s59
    v_add_u32 v10, 1, v10
    v_mov_b32 v11, 0
    s_mov_b64 exec, 1
    buffer_store_dword v10, v11, s[12:15], s52 offen sc1
    s_mov_b64 exec, -1
L_sf_151:
L_g_nfl_146:
    s_cmp_eq_u32 s71, 0
    s_cbranch_scc1 L_g_nfl_146_d
    v_mov_b32 v10, 1
    s_mov_b64 exec, 1
    s_waitcnt vmcnt(0)
    ds_add_rtn_u32 v10, v15, v10 offset:4
    s_waitcnt lgkmcnt(0)
    v_readfirstlane_b32 s46, v10
    s_mov_b64 exec, -1
    s_mov_b32 s71, 0
    s_sub_u32 s59, s60, 1
    s_cmp_lg_u32 s46, s68
    s_cbranch_scc1 L_g_df_152
    v_mov_b32 v10, s59
    v_add_u32 v10, 1, v10
    v_mov_b32 v11, 0
    s_mov_b64 exec, 1
    buffer_store_dword v10, v11, s[12:15], s52 offen sc1
    s_mov_b64 exec, -1
L_sf_153:
L_g_df_152:
    s_add_u32 s68, s68, 4
    s_mov_b32 s65, 2
L_g_nfl_146_d:
    s_waitcnt lgkmcnt(0)
    v_readfirstlane_b32 s66, v14
    s_nop 3
    s_mov_b32 s69, 0
    s_cmp_gt_u32 s62, s60
    s_cbranch_scc1 L_g_nd_154
    s_cmp_ge_u32 s62, s66
    s_cbranch_scc1 L_g_nd_154
    s_add_u32 s47, s61, 4096
    s_add_u32 m0, s64, 0
    s_nop 0
    buffer_load_dwordx4 v3, s[12:15], s61 offen offset:0 sc1 lds
    buffer_load_dwordx4 v3, s[12:15], s61 offen offset:1024 sc1 lds
    buffer_load_dwordx4 v3, s[12:15], s61 offen offset:2048 sc1 lds
    buffer_load_dwordx4 v3, s[12:15], s61 offen offset:3072 sc1 lds
    s_add_u32 m0, s64, 4096
    s_nop 0
    buffer_load_dwordx4 v3, s[12:15], s47 offen offset:0 sc1 lds
    buffer_load_dwordx4 v3, s[12:15], s47 offen offset:1024 sc1 lds
    buffer_load_dwordx4 v3, s[12:15], s47 offen offset:2048 sc1 lds
    s_add_u32 s61, s61, 229376
    s_add_u32 s62, s62, 1
    s_xor_b32 s64, s64, 0x10000
    s_mov_b32 s69, 1
L_g_nd_154:
    s_or_b32 s65, s65, s69
    s_add_u32 s59, s60, 1
    s_mov_b32 s69, 0
    s_cmp_gt_u32 s62, s59
    s_cbranch_scc1 L_g_nd_155
    s_cmp_ge_u32 s62, s66
    s_cbranch_scc1 L_g_nd_155
    s_add_u32 s47, s61, 4096
    s_add_u32 m0, s64, 0
    s_nop 0
    buffer_load_dwordx4 v3, s[12:15], s61 offen offset:0 sc1 lds
    buffer_load_dwordx4 v3, s[12:15], s61 offen offset:1024 sc1 lds
    buffer_load_dwordx4 v3, s[12:15], s61 offen offset:2048 sc1 lds
    buffer_load_dwordx4 v3, s[12:15], s61 offen offset:3072 sc1 lds
    s_add_u32 m0, s64, 4096
    s_nop 0
    buffer_load_dwordx4 v3, s[12:15], s47 offen offset:0 sc1 lds
    buffer_load_dwordx4 v3, s[12:15], s47 offen offset:1024 sc1 lds
    buffer_load_dwordx4 v3, s[12:15], s47 offen offset:2048 sc1 lds
    s_add_u32 s61, s61, 229376
    s_add_u32 s62, s62, 1
    s_xor_b32 s64, s64, 0x10000
    s_mov_b32 s69, 1
L_g_nd_155:
    s_bitcmp1_b32 s67, 0
    s_cbranch_scc0 L_g_nep_147
    ds_read_b128 v[80:83], v5 offset:0
    ds_read_b128 v[84:87], v5 offset:1024
    ds_read_b128 v[88:91], v5 offset:2048
    ds_read_b128 v[92:95], v5 offset:3072
    s_nop 7
    s_waitcnt lgkmcnt(3)
    v_add_f32 v80, v80, v16
    v_add_f32 v81, v81, v17
    v_add_f32 v82, v82, v18
    v_add_f32 v83, v83, v19
    s_waitcnt lgkmcnt(2)
    v_add_f32 v84, v84, v20
    v_add_f32 v85, v85, v21
    v_add_f32 v86, v86, v22
    v_add_f32 v87, v87, v23
    s_waitcnt lgkmcnt(1)
    v_add_f32 v88, v88, v24
    v_add_f32 v89, v89, v25
    v_add_f32 v90, v90, v26
    v_add_f32 v91, v91, v27
    s_waitcnt lgkmcnt(0)
    v_add_f32 v92, v92, v28
    v_add_f32 v93, v93, v29
    v_add_f32 v94, v94, v30
    v_add_f32 v95, v95, v31
    v_cvt_pk_bf16_f32 v104, v80, v81
    v_cvt_pk_bf16_f32 v105, v82, v83
    v_cvt_pk_bf16_f32 v106, v84, v85
    v_cvt_pk_bf16_f32 v107, v86, v87
    s_nop 1
    v_permlane16_swap_b32 v104, v106
    v_permlane16_swap_b32 v105, v107
    buffer_store_dwordx4 v[104:107], v8, s[12:15], s63 offen sc1
    v_cvt_pk_bf16_f32 v108, v88, v89
    v_cvt_pk_bf16_f32 v109, v90, v91
    v_cvt_pk_bf16_f32 v110, v92, v93
    v_cvt_pk_bf16_f32 v111, v94, v95
    s_nop 1
    v_permlane16_swap_b32 v108, v110
    v_permlane16_swap_b32 v109, v111
    buffer_store_dwordx4 v[108:111], v9, s[12:15], s63 offen sc1
    s_add_u32 s63, s63, 262144
L_g_nep_147:
    s_cmp_eq_u32 s65, 0
    s_cbranch_scc1 L_g_nw1_148
    s_cmp_eq_u32 s65, 2
    s_cbranch_scc1 L_g_nw1_148_w
    s_waitcnt vmcnt(0)
L_g_nw1_148_w:
    s_barrier
    ds_read_b128 v[32:35], v4 offset:0
    ds_read_b128 v[36:39], v4 offset:256
    ds_read_b128 v[40:43], v4 offset:2048
    ds_read_b128 v[44:47], v4 offset:2304
    ds_read_b128 v[48:51], v4 offset:4096
    ds_read_b128 v[52:55], v4 offset:4352
    ds_read_b128 v[56:59], v4 offset:6144
    ds_read_b128 v[60:63], v4 offset:6400
    s_branch L_g_jn_150
L_g_nw1_148:
    ds_read_b128 v[32:35], v4 offset:0
    ds_read_b128 v[36:39], v4 offset:256
    ds_read_b128 v[40:43], v4 offset:2048
    ds_read_b128 v[44:47], v4 offset:2304
    ds_read_b128 v[48:51], v4 offset:4096
    ds_read_b128 v[52:55], v4 offset:4352
    ds_read_b128 v[56:59], v4 offset:6144
    ds_read_b128 v[60:63], v4 offset:6400
    s_barrier
L_g_jn_150:
    s_setprio 1
    s_waitcnt lgkmcnt(7)
    v_mfma_f32_16x16x32_bf16 v[16:19], v[32:35], a[0:3], 0
    v_mfma_f32_16x16x32_bf16 v[20:23], v[32:35], a[4:7], 0
    ds_read_b128 v[32:35], v4 offset:8192
    s_waitcnt lgkmcnt(7)
    v_mfma_f32_16x16x32_bf16 v[24:27], v[36:39], a[0:3], 0
    v_mfma_f32_16x16x32_bf16 v[28:31], v[36:39], a[4:7], 0
    ds_read_b128 v[36:39], v4 offset:8448
    s_waitcnt lgkmcnt(7)
    v_mfma_f32_16x16x32_bf16 v[16:19], v[40:43], a[8:11], v[16:19]
    v_mfma_f32_16x16x32_bf16 v[20:23], v[40:43], a[12:15], v[20:23]
    ds_read_b128 v[40:43], v4 offset:10240
    s_waitcnt lgkmcnt(7)
    v_mfma_f32_16x16x32_bf16 v[24:27], v[44:47], a[8:11], v[24:27]
    v_mfma_f32_16x16x32_bf16 v[28:31], v[44:47], a[12:15], v[28:31]
    ds_read_b128 v[44:47], v4 offset:10496
    s_waitcnt lgkmcnt(7)
    v_mfma_f32_16x16x32_bf16 v[16:19], v[48:51], a[16:19], v[16:19]
    v_mfma_f32_16x16x32_bf16 v[20:23], v[48:51], a[20:23], v[20:23]
    ds_read_b128 v[48:51], v4 offset:12288
    s_waitcnt lgkmcnt(7)
    v_mfma_f32_16x16x32_bf16 v[24:27], v[52:55], a[16:19], v[24:27]
    v_mfma_f32_16x16x32_bf16 v[28:31], v[52:55], a[20:23], v[28:31]
    ds_read_b128 v[52:55], v4 offset:12544
    s_waitcnt lgkmcnt(7)
    v_mfma_f32_16x16x32_bf16 v[16:19], v[56:59], a[24:27], v[16:19]
    v_mfma_f32_16x16x32_bf16 v[20:23], v[56:59], a[28:31], v[20:23]
    ds_read_b128 v[56:59], v4 offset:14336
    s_waitcnt lgkmcnt(7)
    v_mfma_f32_16x16x32_bf16 v[24:27], v[60:63], a[24:27], v[24:27]
    v_mfma_f32_16x16x32_bf16 v[28:31], v[60:63], a[28:31], v[28:31]
    ds_read_b128 v[60:63], v4 offset:14592
    s_waitcnt lgkmcnt(7)
    v_mfma_f32_16x16x32_bf16 v[16:19], v[32:35], a[32:35], v[16:19]
    v_mfma_f32_16x16x32_bf16 v[20:23], v[32:35], a[36:39], v[20:23]
    ds_read_b128 v[32:35], v4 offset:16384
    s_waitcnt lgkmcnt(7)
    v_mfma_f32_16x16x32_bf16 v[24:27], v[36:39], a[32:35], v[24:27]
    v_mfma_f32_16x16x32_bf16 v[28:31], v[36:39], a[36:39], v[28:31]
    ds_read_b128 v[36:39], v4 offset:16640
    s_waitcnt lgkmcnt(7)
    v_mfma_f32_16x16x32_bf16 v[16:19], v[40:43], a[40:43], v[16:19]
    v_mfma_f32_16x16x32_bf16 v[20:23], v[40:43], a[44:47], v[20:23]
    ds_read_b128 v[40:43], v4 offset:18432
    s_waitcnt lgkmcnt(7)
    v_mfma_f32_16x16x32_bf16 v[24:27], v[44:47], a[40:43], v[24:27]
    v_mfma_f32_16x16x32_bf16 v[28:31], v[44:47], a[44:47], v[28:31]
    ds_read_b128 v[44:47], v4 offset:18688
    s_waitcnt lgkmcnt(7)
    v_mfma_f32_16x16x32_bf16 v[16:19], v[48:51], a[48:51], v[16:19]
    v_mfma_f32_16x16x32_bf16 v[20:23], v[48:51], a[52:55], v[20:23]
    ds_read_b128 v[48:51], v4 offset:20480
    s_waitcnt lgkmcnt(7)
    v_mfma_f32_16x16x32_bf16 v[24:27], v[52:55], a[48:51], v[24:27]
    v_mfma_f32_16x16x32_bf16 v[28:31], v[52:55], a[52:55], v[28:31]
    ds_read_b128 v[52:55], v4 offset:20736
    s_waitcnt lgkmcnt(7)
    v_mfma_f32_16x16x32_bf16 v[16:19], v[56:59], a[56:59], v[16:19]
    v_mfma_f32_16x16x32_bf16 v[20:23], v[56:59], a[60:63], v[20:23]
    ds_read_b128 v[56:59], v4 offset:22528
    s_waitcnt lgkmcnt(7)
    v_mfma_f32_16x16x32_bf16 v[24:27], v[60:63], a[56:59], v[24:27]
    v_mfma_f32_16x16x32_bf16 v[28:31], v[60:63], a[60:63], v[28:31]
    ds_read_b128 v[60:63], v4 offset:22784
    s_waitcnt lgkmcnt(7)
    v_mfma_f32_16x16x32_bf16 v[16:19], v[32:35], a[64:67], v[16:19]
    v_mfma_f32_16x16x32_bf16 v[20:23], v[32:35], a[68:71], v[20:23]
    ds_read_b128 v[32:35], v4 offset:24576
    s_waitcnt lgkmcnt(7)
    v_mfma_f32_16x16x32_bf16 v[24:27], v[36:39], a[64:67], v[24:27]
    v_mfma_f32_16x16x32_bf16 v[28:31], v[36:39], a[68:71], v[28:31]
    ds_read_b128 v[36:39], v4 offset:24832
    s_waitcnt lgkmcnt(7)
    v_mfma_f32_16x16x32_bf16 v[16:19], v[40:43], a[72:75], v[16:19]
    v_mfma_f32_16x16x32_bf16 v[20:23], v[40:43], a[76:79], v[20:23]
    ds_read_b128 v[40:43], v4 offset:26624
    s_waitcnt lgkmcnt(7)
    v_mfma_f32_16x16x32_bf16 v[24:27], v[44:47], a[72:75], v[24:27]
    v_mfma_f32_16x16x32_bf16 v[28:31], v[44:47], a[76:79], v[28:31]
    ds_read_b128 v[44:47], v4 offset:26880
    s_waitcnt lgkmcnt(7)
    v_mfma_f32_16x16x32_bf16 v[16:19], v[48:51], a[80:83], v[16:19]
    v_mfma_f32_16x16x32_bf16 v[20:23], v[48:51], a[84:87], v[20:23]
    s_waitcnt lgkmcnt(6)
    v_mfma_f32_16x16x32_bf16 v[24:27], v[52:55], a[80:83], v[24:27]
    v_mfma_f32_16x16x32_bf16 v[28:31], v[52:55], a[84:87], v[28:31]
    s_waitcnt lgkmcnt(5)
    v_mfma_f32_16x16x32_bf16 v[16:19], v[56:59], a[88:91], v[16:19]
    v_mfma_f32_16x16x32_bf16 v[20:23], v[56:59], a[92:95], v[20:23]
    s_waitcnt lgkmcnt(4)
    v_mfma_f32_16x16x32_bf16 v[24:27], v[60:63], a[88:91], v[24:27]
    v_mfma_f32_16x16x32_bf16 v[28:31], v[60:63], a[92:95], v[28:31]
    s_waitcnt lgkmcnt(3)
    v_mfma_f32_16x16x32_bf16 v[16:19], v[32:35], a[96:99], v[16:19]
    v_mfma_f32_16x16x32_bf16 v[20:23], v[32:35], a[100:103], v[20:23]
    s_waitcnt lgkmcnt(2)
    v_mfma_f32_16x16x32_bf16 v[24:27], v[36:39], a[96:99], v[24:27]
    v_mfma_f32_16x16x32_bf16 v[28:31], v[36:39], a[100:103], v[28:31]
    s_waitcnt lgkmcnt(1)
    v_mfma_f32_16x16x32_bf16 v[16:19], v[40:43], a[104:107], v[16:19]
    v_mfma_f32_16x16x32_bf16 v[20:23], v[40:43], a[108:111], v[20:23]
    s_waitcnt lgkmcnt(0)
    v_mfma_f32_16x16x32_bf16 v[24:27], v[44:47], a[104:107], v[24:27]
    v_mfma_f32_16x16x32_bf16 v[28:31], v[44:47], a[108:111], v[28:31]
    v_xor_b32 v4, 0x10000, v4
    s_setprio 0
    s_waitcnt vmcnt(0)
    s_lshl_b32 s67, s67, 1
    s_or_b32 s67, s67, 1
    s_add_u32 s60, s60, 1
    s_cmp_gt_u32 s66, s60
    s_cbranch_scc1 L_g_loop1_129
    s_barrier
    ds_read_b32 v14, v15
    s_waitcnt lgkmcnt(0)
    v_readfirstlane_b32 s66, v14
    s_barrier
    s_mov_b32 s69, 0
    s_cmp_gt_u32 s62, s60
    s_cbranch_scc1 L_g_nd_156
    s_cmp_ge_u32 s62, s66
    s_cbranch_scc1 L_g_nd_156
    s_add_u32 s47, s61, 4096
    s_add_u32 m0, s64, 0
    s_nop 0
    buffer_load_dwordx4 v3, s[12:15], s61 offen offset:0 sc1 lds
    buffer_load_dwordx4 v3, s[12:15], s61 offen offset:1024 sc1 lds
    buffer_load_dwordx4 v3, s[12:15], s61 offen offset:2048 sc1 lds
    buffer_load_dwordx4 v3, s[12:15], s61 offen offset:3072 sc1 lds
    s_add_u32 m0, s64, 4096
    s_nop 0
    buffer_load_dwordx4 v3, s[12:15], s47 offen offset:0 sc1 lds
    buffer_load_dwordx4 v3, s[12:15], s47 offen offset:1024 sc1 lds
    buffer_load_dwordx4 v3, s[12:15], s47 offen offset:2048 sc1 lds
    s_add_u32 s61, s61, 229376
    s_add_u32 s62, s62, 1
    s_xor_b32 s64, s64, 0x10000
    s_mov_b32 s69, 1
L_g_nd_156:
    s_sub_u32 s59, s60, 1
    ds_read_b128 v[80:83], v5 offset:0
    ds_read_b128 v[84:87], v5 offset:1024
    ds_read_b128 v[88:91], v5 offset:2048
    ds_read_b128 v[92:95], v5 offset:3072
    s_nop 7
    s_waitcnt lgkmcnt(3)
    v_add_f32 v80, v80, v16
    v_add_f32 v81, v81, v17
    v_add_f32 v82, v82, v18
    v_add_f32 v83, v83, v19
    s_waitcnt lgkmcnt(2)
    v_add_f32 v84, v84, v20
    v_add_f32 v85, v85, v21
    v_add_f32 v86, v86, v22
    v_add_f32 v87, v87, v23
    s_waitcnt lgkmcnt(1)
    v_add_f32 v88, v88, v24
    v_add_f32 v89, v89, v25
    v_add_f32 v90, v90, v26
    v_add_f32 v91, v91, v27
    s_waitcnt lgkmcnt(0)
    v_add_f32 v92, v92, v28
    v_add_f32 v93, v93, v29
    v_add_f32 v94, v94, v30
    v_add_f32 v95, v95, v31
    v_cvt_pk_bf16_f32 v104, v80, v81
    v_cvt_pk_bf16_f32 v105, v82, v83
    v_cvt_pk_bf16_f32 v106, v84, v85
    v_cvt_pk_bf16_f32 v107, v86, v87
    s_nop 1
    v_permlane16_swap_b32 v104, v106
    v_permlane16_swap_b32 v105, v107
    buffer_store_dwordx4 v[104:107], v8, s[12:15], s63 offen sc1
    v_cvt_pk_bf16_f32 v108, v88, v89
    v_cvt_pk_bf16_f32 v109, v90, v91
    v_cvt_pk_bf16_f32 v110, v92, v93
    v_cvt_pk_bf16_f32 v111, v94, v95
    s_nop 1
    v_permlane16_swap_b32 v108, v110
    v_permlane16_swap_b32 v109, v111
    buffer_store_dwordx4 v[108:111], v9, s[12:15], s63 offen sc1
    s_add_u32 s63, s63, 262144
    s_mov_b32 s67, 0
    s_mov_b32 s71, 1
    s_cmp_gt_u32 s66, s60
    s_cbranch_scc1 L_g_g1r_127
    v_mov_b32 v10, 1
    s_mov_b64 exec, 1
    s_waitcnt vmcnt(0)
    ds_add_rtn_u32 v10, v15, v10 offset:4
    s_waitcnt lgkmcnt(0)
    v_readfirstlane_b32 s46, v10
    s_mov_b64 exec, -1
    s_mov_b32 s71, 0
    s_sub_u32 s59, s60, 1
    s_cmp_lg_u32 s46, s68
    s_cbranch_scc1 L_g_df_157
    v_mov_b32 v10, s59
    v_add_u32 v10, 1, v10
    v_mov_b32 v11, 0
    s_mov_b64 exec, 1
    buffer_store_dword v10, v11, s[12:15], s52 offen sc1
    s_mov_b64 exec, -1
L_sf_158:
L_g_df_157:
    s_add_u32 s68, s68, 4
    s_cmp_gt_u32 s66, s60
    s_cbranch_scc1 L_g_g1r_127
L_g_tail_130:
    s_cmp_lt_u32 s60, 64
    s_cbranch_scc1 L_g_restart_125
    s_barrier
    s_branch L_c_done_1
L_w_wo_10:
    s_load_dwordx2 s[4:5], s[0:1], 40
    s_load_dwordx2 s[6:7], s[0:1], 72
    s_and_b32 s50, s44, 3
    s_lshr_b32 s51, s44, 2
    s_waitcnt lgkmcnt(0)
    s_mov_b32 s24, s4
    s_and_b32 s25, s5, 0xffff
    s_mov_b32 s26, 0x800000
    s_mov_b32 s27, 0x00020000
    v_lshrrev_b32 v3, 4, v1
    v_and_b32 v4, 15, v1
    v_lshlrev_b32 v5, 2, v3
    v_xor_b32 v4, v4, v5
    v_mul_u32_u24 v3, 2048, v3
    v_lshl_add_u32 v3, v4, 4, v3
    s_mul_i32 s46, s51, 512
    s_mul_i32 s47, s50, 64
    s_add_u32 s46, s46, s47
    s_mul_i32 s47, s42, 1024
    s_add_u32 s46, s46, s47
    s_mul_i32 s46, s46, 2048
    s_lshl_b32 s47, s43, 8
    s_add_u32 s46, s46, s47
    s_lshl_b32 s45, s51, 16
    s_mul_i32 s47, s50, 16384
    s_add_u32 s45, s45, s47
    v_bfe_u32 v4, v1, 2, 2
    v_bfe_u32 v5, v1, 4, 1
    v_lshlrev_b32 v5, 1, v5
    v_bfe_u32 v6, v1, 1, 1
    v_add_u32 v5, v5, v6
    s_lshl_b32 s47, s50, 2
    v_add_u32 v5, s47, v5
    v_lshlrev_b32 v6, 2, v4
    v_xor_b32 v5, v5, v6
    v_lshlrev_b32 v5, 4, v5
    v_lshl_add_u32 v5, v4, 8, v5
    v_bfe_u32 v6, v1, 0, 1
    v_lshl_add_u32 v5, v6, 3, v5
    v_lshrrev_b32 v6, 5, v1
    v_mul_u32_u24 v6, 1024, v6
    v_add_u32 v5, v5, v6
    s_lshl_b32 s47, s51, 16
    v_add_u32 v5, s47, v5
    v_bfe_u32 v4, v1, 2, 2
    v_xor_b32 v5, s50, v4
    v_lshlrev_b32 v5, 6, v5
    v_lshl_add_u32 v5, v4, 8, v5
    v_and_b32 v6, 3, v1
    v_lshl_add_u32 v5, v6, 3, v5
    v_lshrrev_b32 v6, 4, v1
    v_lshl_add_u32 v5, v6, 10, v5
    s_lshl_b32 s47, s51, 16
    v_add_u32 v5, s47, v5
    s_add_u32 m0, s45, 0
    s_add_u32 s47, s46, 0x0
    buffer_load_dwordx4 v3, s[24:27], s47 offen lds
    s_add_u32 m0, s45, 1024
    s_add_u32 s47, s46, 0x2000
    buffer_load_dwordx4 v3, s[24:27], s47 offen lds
    s_add_u32 m0, s45, 2048
    s_add_u32 s47, s46, 0x4000
    buffer_load_dwordx4 v3, s[24:27], s47 offen lds
    s_add_u32 m0, s45, 3072
    s_add_u32 s47, s46, 0x6000
    buffer_load_dwordx4 v3, s[24:27], s47 offen lds
    s_add_u32 m0, s45, 4096
    s_add_u32 s47, s46, 0x8000
    buffer_load_dwordx4 v3, s[24:27], s47 offen lds
    s_add_u32 m0, s45, 5120
    s_add_u32 s47, s46, 0xa000
    buffer_load_dwordx4 v3, s[24:27], s47 offen lds
    s_add_u32 m0, s45, 6144
    s_add_u32 s47, s46, 0xc000
    buffer_load_dwordx4 v3, s[24:27], s47 offen lds
    s_add_u32 m0, s45, 7168
    s_add_u32 s47, s46, 0xe000
    buffer_load_dwordx4 v3, s[24:27], s47 offen lds
    s_add_u32 m0, s45, 8192
    s_add_u32 s47, s46, 0x10000
    buffer_load_dwordx4 v3, s[24:27], s47 offen lds
    s_add_u32 m0, s45, 9216
    s_add_u32 s47, s46, 0x12000
    buffer_load_dwordx4 v3, s[24:27], s47 offen lds
    s_add_u32 m0, s45, 10240
    s_add_u32 s47, s46, 0x14000
    buffer_load_dwordx4 v3, s[24:27], s47 offen lds
    s_add_u32 m0, s45, 11264
    s_add_u32 s47, s46, 0x16000
    buffer_load_dwordx4 v3, s[24:27], s47 offen lds
    s_add_u32 m0, s45, 12288
    s_add_u32 s47, s46, 0x18000
    buffer_load_dwordx4 v3, s[24:27], s47 offen lds
    s_add_u32 m0, s45, 13312
    s_add_u32 s47, s46, 0x1a000
    buffer_load_dwordx4 v3, s[24:27], s47 offen lds
    s_add_u32 m0, s45, 14336
    s_add_u32 s47, s46, 0x1c000
    buffer_load_dwordx4 v3, s[24:27], s47 offen lds
    s_add_u32 m0, s45, 15360
    s_add_u32 s47, s46, 0x1e000
    buffer_load_dwordx4 v3, s[24:27], s47 offen lds
    s_waitcnt vmcnt(0)
    s_barrier
    ds_read_b64_tr_b16 a[0:1], v5 offset:0
    ds_read_b64_tr_b16 a[2:3], v5 offset:4096
    ds_read_b64_tr_b16 a[4:5], v5 offset:32
    ds_read_b64_tr_b16 a[6:7], v5 offset:4128
    ds_read_b64_tr_b16 a[8:9], v5 offset:8192
    ds_read_b64_tr_b16 a[10:11], v5 offset:12288
    ds_read_b64_tr_b16 a[12:13], v5 offset:8224
    ds_read_b64_tr_b16 a[14:15], v5 offset:12320
    s_waitcnt lgkmcnt(0)
    ds_read_b64_tr_b16 a[16:17], v5 offset:16384
    ds_read_b64_tr_b16 a[18:19], v5 offset:20480
    ds_read_b64_tr_b16 a[20:21], v5 offset:16416
    ds_read_b64_tr_b16 a[22:23], v5 offset:20512
    ds_read_b64_tr_b16 a[24:25], v5 offset:24576
    ds_read_b64_tr_b16 a[26:27], v5 offset:28672
    ds_read_b64_tr_b16 a[28:29], v5 offset:24608
    ds_read_b64_tr_b16 a[30:31], v5 offset:28704
    s_waitcnt lgkmcnt(0)
    ds_read_b64_tr_b16 a[32:33], v5 offset:32768
    ds_read_b64_tr_b16 a[34:35], v5 offset:36864
    ds_read_b64_tr_b16 a[36:37], v5 offset:32800
    ds_read_b64_tr_b16 a[38:39], v5 offset:36896
    ds_read_b64_tr_b16 a[40:41], v5 offset:40960
    ds_read_b64_tr_b16 a[42:43], v5 offset:45056
    ds_read_b64_tr_b16 a[44:45], v5 offset:40992
    ds_read_b64_tr_b16 a[46:47], v5 offset:45088
    s_waitcnt lgkmcnt(0)
    ds_read_b64_tr_b16 a[48:49], v5 offset:49152
    ds_read_b64_tr_b16 a[50:51], v5 offset:53248
    ds_read_b64_tr_b16 a[52:53], v5 offset:49184
    ds_read_b64_tr_b16 a[54:55], v5 offset:53280
    ds_read_b64_tr_b16 a[56:57], v5 offset:57344
    ds_read_b64_tr_b16 a[58:59], v5 offset:61440
    ds_read_b64_tr_b16 a[60:61], v5 offset:57376
    ds_read_b64_tr_b16 a[62:63], v5 offset:61472
    s_waitcnt lgkmcnt(0)
    s_waitcnt lgkmcnt(0)
    s_barrier
    s_add_u32 m0, s45, 0
    s_add_u32 s47, s46, 0x80000
    buffer_load_dwordx4 v3, s[24:27], s47 offen lds
    s_add_u32 m0, s45, 1024
    s_add_u32 s47, s46, 0x82000
    buffer_load_dwordx4 v3, s[24:27], s47 offen lds
    s_add_u32 m0, s45, 2048
    s_add_u32 s47, s46, 0x84000
    buffer_load_dwordx4 v3, s[24:27], s47 offen lds
    s_add_u32 m0, s45, 3072
    s_add_u32 s47, s46, 0x86000
    buffer_load_dwordx4 v3, s[24:27], s47 offen lds
    s_add_u32 m0, s45, 4096
    s_add_u32 s47, s46, 0x88000
    buffer_load_dwordx4 v3, s[24:27], s47 offen lds
    s_add_u32 m0, s45, 5120
    s_add_u32 s47, s46, 0x8a000
    buffer_load_dwordx4 v3, s[24:27], s47 offen lds
    s_add_u32 m0, s45, 6144
    s_add_u32 s47, s46, 0x8c000
    buffer_load_dwordx4 v3, s[24:27], s47 offen lds
    s_add_u32 m0, s45, 7168
    s_add_u32 s47, s46, 0x8e000
    buffer_load_dwordx4 v3, s[24:27], s47 offen lds
    s_add_u32 m0, s45, 8192
    s_add_u32 s47, s46, 0x90000
    buffer_load_dwordx4 v3, s[24:27], s47 offen lds
    s_add_u32 m0, s45, 9216
    s_add_u32 s47, s46, 0x92000
    buffer_load_dwordx4 v3, s[24:27], s47 offen lds
    s_add_u32 m0, s45, 10240
    s_add_u32 s47, s46, 0x94000
    buffer_load_dwordx4 v3, s[24:27], s47 offen lds
    s_add_u32 m0, s45, 11264
    s_add_u32 s47, s46, 0x96000
    buffer_load_dwordx4 v3, s[24:27], s47 offen lds
    s_add_u32 m0, s45, 12288
    s_add_u32 s47, s46, 0x98000
    buffer_load_dwordx4 v3, s[24:27], s47 offen lds
    s_add_u32 m0, s45, 13312
    s_add_u32 s47, s46, 0x9a000
    buffer_load_dwordx4 v3, s[24:27], s47 offen lds
    s_add_u32 m0, s45, 14336
    s_add_u32 s47, s46, 0x9c000
    buffer_load_dwordx4 v3, s[24:27], s47 offen lds
    s_add_u32 m0, s45, 15360
    s_add_u32 s47, s46, 0x9e000
    buffer_load_dwordx4 v3, s[24:27], s47 offen lds
    s_waitcnt vmcnt(0)
    s_barrier
    ds_read_b64_tr_b16 a[64:65], v5 offset:0
    ds_read_b64_tr_b16 a[66:67], v5 offset:4096
    ds_read_b64_tr_b16 a[68:69], v5 offset:32
    ds_read_b64_tr_b16 a[70:71], v5 offset:4128
    ds_read_b64_tr_b16 a[72:73], v5 offset:8192
    ds_read_b64_tr_b16 a[74:75], v5 offset:12288
    ds_read_b64_tr_b16 a[76:77], v5 offset:8224
    ds_read_b64_tr_b16 a[78:79], v5 offset:12320
    s_waitcnt lgkmcnt(0)
    ds_read_b64_tr_b16 a[80:81], v5 offset:16384
    ds_read_b64_tr_b16 a[82:83], v5 offset:20480
    ds_read_b64_tr_b16 a[84:85], v5 offset:16416
    ds_read_b64_tr_b16 a[86:87], v5 offset:20512
    ds_read_b64_tr_b16 a[88:89], v5 offset:24576
    ds_read_b64_tr_b16 a[90:91], v5 offset:28672
    ds_read_b64_tr_b16 a[92:93], v5 offset:24608
    ds_read_b64_tr_b16 a[94:95], v5 offset:28704
    s_waitcnt lgkmcnt(0)
    ds_read_b64_tr_b16 a[96:97], v5 offset:32768
    ds_read_b64_tr_b16 a[98:99], v5 offset:36864
    ds_read_b64_tr_b16 a[100:101], v5 offset:32800
    ds_read_b64_tr_b16 a[102:103], v5 offset:36896
    ds_read_b64_tr_b16 a[104:105], v5 offset:40960
    ds_read_b64_tr_b16 a[106:107], v5 offset:45056
    ds_read_b64_tr_b16 a[108:109], v5 offset:40992
    ds_read_b64_tr_b16 a[110:111], v5 offset:45088
    s_waitcnt lgkmcnt(0)
    ds_read_b64_tr_b16 a[112:113], v5 offset:49152
    ds_read_b64_tr_b16 a[114:115], v5 offset:53248
    ds_read_b64_tr_b16 a[116:117], v5 offset:49184
    ds_read_b64_tr_b16 a[118:119], v5 offset:53280
    ds_read_b64_tr_b16 a[120:121], v5 offset:57344
    ds_read_b64_tr_b16 a[122:123], v5 offset:61440
    ds_read_b64_tr_b16 a[124:125], v5 offset:57376
    ds_read_b64_tr_b16 a[126:127], v5 offset:61472
    s_waitcnt lgkmcnt(0)
    s_waitcnt lgkmcnt(0)
    s_barrier
    v_lshlrev_b32 v2, 4, v1
    s_mul_i32 s64, s44, 8192
    s_add_u32 s46, s64, 0x5000000
    s_mul_i32 s47, s42, 65536
    s_add_u32 s46, s46, s47
    v_add_u32 v3, s46, v2
    s_mul_i32 s46, s51, 32768
    v_add_u32 v4, s46, v2
    v_and_b32 v6, 15, v1
    v_lshlrev_b32 v6, 4, v6
    v_lshrrev_b32 v7, 4, v1
    v_lshl_add_u32 v6, v7, 9, v6
    v_add_u32 v4, s46, v6
    s_lshl_b32 s46, s50, 12
    s_add_u32 s46, s46, 131072
    v_add_u32 v5, s46, v2
    v_and_b32 v7, 7, v1
    v_lshlrev_b32 v7, 9, v7
    s_lshl_b32 s46, s42, 12
    s_add_u32 s46, s46, 0x102000
    v_add_u32 v7, s46, v7
    s_lshl_b32 s46, s42, 16
    s_lshl_b32 s47, s43, 11
    s_add_u32 s46, s46, s47
    s_lshl_b32 s47, s50, 9
    s_add_u32 s46, s46, s47
    s_add_u32 s46, s46, 0x9000000
    v_and_b32 v8, 31, v1
    v_lshlrev_b32 v8, 4, v8
    v_lshrrev_b32 v9, 5, v1
    v_lshl_add_u32 v8, v9, 14, v8
    v_add_u32 v8, s46, v8
    v_add_u32 v9, 0x8000, v8
    s_lshl_b32 s52, s43, 9
    s_lshl_b32 s47, s42, 7
    s_add_u32 s52, s52, s47
    s_add_u32 s52, s52, 0x107400
    s_mov_b32 s60, 0
    s_mov_b32 s61, 0
    s_mov_b32 s62, 0
    s_mov_b32 s63, 0
    s_mov_b32 s67, 0
    s_mov_b32 s68, 3
    s_mov_b32 s71, 0
    v_mov_b32 v15, 147456
    v_mov_b32 v14, 0
    ds_write_b32 v15, v14 offset:4
L_g_restart_159:
    s_cmp_lg_u32 s44, 0
    s_cbranch_scc1 L_g_nsp_160
    s_mov_b32 s70, 0
L_g_sp_166:
    s_add_u32 s54, s60, 0
    s_add_u32 s55, s54, 0
    s_and_b32 s46, s55, 3
    s_lshl_b32 s46, s46, 7
    buffer_load_dword v11, v7, s[12:15], s46 offen sc1
    s_add_u32 s55, s54, 1
    s_and_b32 s46, s55, 3
    s_lshl_b32 s46, s46, 7
    buffer_load_dword v12, v7, s[12:15], s46 offen sc1
    s_add_u32 s55, s54, 2
    s_and_b32 s46, s55, 3
    s_lshl_b32 s46, s46, 7
    buffer_load_dword v13, v7, s[12:15], s46 offen sc1
    s_waitcnt vmcnt(0)
    v_cmp_ge_u32 vcc, s60, v11
    s_add_u32 s70, s70, 1
    s_cbranch_vccz L_g_sp_166_ok
    s_sleep 3
    s_cmp_lt_u32 s70, 524288
    s_cbranch_scc1 L_g_sp_166
    s_branch L_c_done_1
L_g_sp_166_ok:
    s_mov_b32 s46, s54
    v_cmp_ge_u32 vcc, s46, v11
    s_nop 0
    s_cbranch_vccnz L_g_le_167
    s_add_u32 s46, s46, 1
    v_cmp_ge_u32 vcc, s46, v12
    s_nop 0
    s_cbranch_vccnz L_g_le_167
    s_add_u32 s46, s46, 1
    v_cmp_ge_u32 vcc, s46, v13
    s_nop 0
    s_cbranch_vccnz L_g_le_167
    s_add_u32 s46, s46, 1
L_g_le_167:
    v_mov_b32 v11, s46
    ds_write_b32 v15, v11
L_g_nsp_160:
    s_waitcnt lgkmcnt(0)
    s_barrier
    ds_read_b32 v14, v15
    s_waitcnt lgkmcnt(0)
    v_readfirstlane_b32 s66, v14
    s_nop 3
L_g_restart_159_go:
    s_mov_b32 s69, 0
    s_cmp_gt_u32 s62, s60
    s_cbranch_scc1 L_g_nd_168
    s_cmp_ge_u32 s62, s66
    s_cbranch_scc1 L_g_nd_168
    s_add_u32 s47, s61, 4096
    s_add_u32 m0, s64, 0
    s_nop 0
    buffer_load_dwordx4 v3, s[12:15], s61 offen offset:0 sc1 lds
    buffer_load_dwordx4 v3, s[12:15], s61 offen offset:1024 sc1 lds
    buffer_load_dwordx4 v3, s[12:15], s61 offen offset:2048 sc1 lds
    buffer_load_dwordx4 v3, s[12:15], s61 offen offset:3072 sc1 lds
    s_add_u32 m0, s64, 4096
    s_nop 0
    buffer_load_dwordx4 v3, s[12:15], s47 offen offset:0 sc1 lds
    buffer_load_dwordx4 v3, s[12:15], s47 offen offset:1024 sc1 lds
    buffer_load_dwordx4 v3, s[12:15], s47 offen offset:2048 sc1 lds
    buffer_load_dwordx4 v3, s[12:15], s47 offen offset:3072 sc1 lds
    s_add_u32 s61, s61, 262144
    s_add_u32 s62, s62, 1
    s_xor_b32 s64, s64, 0x10000
    s_mov_b32 s69, 1
L_g_nd_168:
    s_cmp_eq_u32 s51, 1
    s_cbranch_scc1 L_g_g1r_161
    s_add_u32 s59, s60, 1
    s_mov_b32 s69, 0
    s_cmp_gt_u32 s62, s59
    s_cbranch_scc1 L_g_nd_169
    s_cmp_ge_u32 s62, s66
    s_cbranch_scc1 L_g_nd_169
    s_add_u32 s47, s61, 4096
    s_add_u32 m0, s64, 0
    s_nop 0
    buffer_load_dwordx4 v3, s[12:15], s61 offen offset:0 sc1 lds
    buffer_load_dwordx4 v3, s[12:15], s61 offen offset:1024 sc1 lds
    buffer_load_dwordx4 v3, s[12:15], s61 offen offset:2048 sc1 lds
    buffer_load_dwordx4 v3, s[12:15], s61 offen offset:3072 sc1 lds
    s_add_u32 m0, s64, 4096
    s_nop 0
    buffer_load_dwordx4 v3, s[12:15], s47 offen offset:0 sc1 lds
    buffer_load_dwordx4 v3, s[12:15], s47 offen offset:1024 sc1 lds
    buffer_load_dwordx4 v3, s[12:15], s47 offen offset:2048 sc1 lds
    buffer_load_dwordx4 v3, s[12:15], s47 offen offset:3072 sc1 lds
    s_add_u32 s61, s61, 262144
    s_add_u32 s62, s62, 1
    s_xor_b32 s64, s64, 0x10000
    s_mov_b32 s69, 1
L_g_nd_169:
    s_cmp_eq_u32 s69, 1
    s_cbranch_scc1 L_g_w0_170
    s_waitcnt vmcnt(0)
L_g_w0_170:
    s_waitcnt vmcnt(8)
    s_mov_b32 s65, 1
.p2align 6
L_g_loop0_162:
    s_barrier
    s_cmp_eq_u32 s65, 0
    s_cbranch_scc1 L_g_pr_171
    ds_read_b128 v[32:35], v4 offset:0
    ds_read_b128 v[36:39], v4 offset:256
    ds_read_b128 v[40:43], v4 offset:2048
    ds_read_b128 v[44:47], v4 offset:2304
    ds_read_b128 v[48:51], v4 offset:4096
    ds_read_b128 v[52:55], v4 offset:4352
    ds_read_b128 v[56:59], v4 offset:6144
    ds_read_b128 v[60:63], v4 offset:6400
L_g_pr_171:
    ds_read_b32 v14, v15
    s_cmp_lg_u32 s44, 0
    s_cbranch_scc1 L_g_nl_172
    s_add_u32 s54, s60, 1
    s_add_u32 s55, s54, 0
    s_and_b32 s46, s55, 3
    s_lshl_b32 s46, s46, 7
    buffer_load_dword v11, v7, s[12:15], s46 offen sc1
    s_add_u32 s55, s54, 1
    s_and_b32 s46, s55, 3
    s_lshl_b32 s46, s46, 7
    buffer_load_dword v12, v7, s[12:15], s46 offen sc1
    s_add_u32 s55, s54, 2
    s_and_b32 s46, s55, 3
    s_lshl_b32 s46, s46, 7
    buffer_load_dword v13, v7, s[12:15], s46 offen sc1
L_g_nl_172:
    s_setprio 1
    s_waitcnt lgkmcnt(7)
    v_mfma_f32_16x16x32_bf16 v[16:19], v[32:35], a[0:3], 0
    v_mfma_f32_16x16x32_bf16 v[20:23], v[32:35], a[4:7], 0
    ds_read_b128 v[32:35], v4 offset:8192
    s_waitcnt lgkmcnt(7)
    v_mfma_f32_16x16x32_bf16 v[24:27], v[36:39], a[0:3], 0
    v_mfma_f32_16x16x32_bf16 v[28:31], v[36:39], a[4:7], 0
    ds_read_b128 v[36:39], v4 offset:8448
    s_waitcnt lgkmcnt(7)
    v_mfma_f32_16x16x32_bf16 v[16:19], v[40:43], a[8:11], v[16:19]
    v_mfma_f32_16x16x32_bf16 v[20:23], v[40:43], a[12:15], v[20:23]
    ds_read_b128 v[40:43], v4 offset:10240
    s_waitcnt lgkmcnt(7)
    v_mfma_f32_16x16x32_bf16 v[24:27], v[44:47], a[8:11], v[24:27]
    v_mfma_f32_16x16x32_bf16 v[28:31], v[44:47], a[12:15], v[28:31]
    ds_read_b128 v[44:47], v4 offset:10496
    s_waitcnt lgkmcnt(7)
    v_mfma_f32_16x16x32_bf16 v[16:19], v[48:51], a[16:19], v[16:19]
    v_mfma_f32_16x16x32_bf16 v[20:23], v[48:51], a[20:23], v[20:23]
    ds_read_b128 v[48:51], v4 offset:12288
    s_waitcnt lgkmcnt(7)
    v_mfma_f32_16x16x32_bf16 v[24:27], v[52:55], a[16:19], v[24:27]
    v_mfma_f32_16x16x32_bf16 v[28:31], v[52:55], a[20:23], v[28:31]
    ds_read_b128 v[52:55], v4 offset:12544
    s_waitcnt lgkmcnt(7)
    v_mfma_f32_16x16x32_bf16 v[16:19], v[56:59], a[24:27], v[16:19]
    v_mfma_f32_16x16x32_bf16 v[20:23], v[56:59], a[28:31], v[20:23]
    ds_read_b128 v[56:59], v4 offset:14336
    s_waitcnt lgkmcnt(7)
    v_mfma_f32_16x16x32_bf16 v[24:27], v[60:63], a[24:27], v[24:27]
    v_mfma_f32_16x16x32_bf16 v[28:31], v[60:63], a[28:31], v[28:31]
    ds_read_b128 v[60:63], v4 offset:14592
    s_waitcnt lgkmcnt(7)
    v_mfma_f32_16x16x32_bf16 v[16:19], v[32:35], a[32:35], v[16:19]
    v_mfma_f32_16x16x32_bf16 v[20:23], v[32:35], a[36:39], v[20:23]
    ds_read_b128 v[32:35], v4 offset:16384
    s_waitcnt lgkmcnt(7)
    v_mfma_f32_16x16x32_bf16 v[24:27], v[36:39], a[32:35], v[24:27]
    v_mfma_f32_16x16x32_bf16 v[28:31], v[36:39], a[36:39], v[28:31]
    ds_read_b128 v[36:39], v4 offset:16640
    s_waitcnt lgkmcnt(7)
    v_mfma_f32_16x16x32_bf16 v[16:19], v[40:43], a[40:43], v[16:19]
    v_mfma_f32_16x16x32_bf16 v[20:23], v[40:43], a[44:47], v[20:23]
    ds_read_b128 v[40:43], v4 offset:18432
    s_waitcnt lgkmcnt(7)
    v_mfma_f32_16x16x32_bf16 v[24:27], v[44:47], a[40:43], v[24:27]
    v_mfma_f32_16x16x32_bf16 v[28:31], v[44:47], a[44:47], v[28:31]
    ds_read_b128 v[44:47], v4 offset:18688
    s_waitcnt lgkmcnt(7)
    v_mfma_f32_16x16x32_bf16 v[16:19], v[48:51], a[48:51], v[16:19]
    v_mfma_f32_16x16x32_bf16 v[20:23], v[48:51], a[52:55], v[20:23]
    ds_read_b128 v[48:51], v4 offset:20480
    s_waitcnt lgkmcnt(7)
    v_mfma_f32_16x16x32_bf16 v[24:27], v[52:55], a[48:51], v[24:27]
    v_mfma_f32_16x16x32_bf16 v[28:31], v[52:55], a[52:55], v[28:31]
    ds_read_b128 v[52:55], v4 offset:20736
    s_waitcnt lgkmcnt(7)
    v_mfma_f32_16x16x32_bf16 v[16:19], v[56:59], a[56:59], v[16:19]
    v_mfma_f32_16x16x32_bf16 v[20:23], v[56:59], a[60:63], v[20:23]
    ds_read_b128 v[56:59], v4 offset:22528
    s_waitcnt lgkmcnt(7)
    v_mfma_f32_16x16x32_bf16 v[24:27], v[60:63], a[56:59], v[24:27]
    v_mfma_f32_16x16x32_bf16 v[28:31], v[60:63], a[60:63], v[28:31]
    ds_read_b128 v[60:63], v4 offset:22784
    s_waitcnt lgkmcnt(7)
    v_mfma_f32_16x16x32_bf16 v[16:19], v[32:35], a[64:67], v[16:19]
    v_mfma_f32_16x16x32_bf16 v[20:23], v[32:35], a[68:71], v[20:23]
    ds_read_b128 v[32:35], v4 offset:24576
    s_waitcnt lgkmcnt(7)
    v_mfma_f32_16x16x32_bf16 v[24:27], v[36:39], a[64:67], v[24:27]
    v_mfma_f32_16x16x32_bf16 v[28:31], v[36:39], a[68:71], v[28:31]
    ds_read_b128 v[36:39], v4 offset:24832
    s_waitcnt lgkmcnt(7)
    v_mfma_f32_16x16x32_bf16 v[16:19], v[40:43], a[72:75], v[16:19]
    v_mfma_f32_16x16x32_bf16 v[20:23], v[40:43], a[76:79], v[20:23]
    ds_read_b128 v[40:43], v4 offset:26624
    s_waitcnt lgkmcnt(7)
    v_mfma_f32_16x16x32_bf16 v[24:27], v[44:47], a[72:75], v[24:27]
    v_mfma_f32_16x16x32_bf16 v[28:31], v[44:47], a[76:79], v[28:31]
    ds_read_b128 v[44:47], v4 offset:26880
    s_waitcnt lgkmcnt(7)
    v_mfma_f32_16x16x32_bf16 v[16:19], v[48:51], a[80:83], v[16:19]
    v_mfma_f32_16x16x32_bf16 v[20:23], v[48:51], a[84:87], v[20:23]
    ds_read_b128 v[48:51], v4 offset:28672
    s_waitcnt lgkmcnt(7)
    v_mfma_f32_16x16x32_bf16 v[24:27], v[52:55], a[80:83], v[24:27]
    v_mfma_f32_16x16x32_bf16 v[28:31], v[52:55], a[84:87], v[28:31]
    ds_read_b128 v[52:55], v4 offset:28928
    s_waitcnt lgkmcnt(7)
    v_mfma_f32_16x16x32_bf16 v[16:19], v[56:59], a[88:91], v[16:19]
    v_mfma_f32_16x16x32_bf16 v[20:23], v[56:59], a[92:95], v[20:23]
    ds_read_b128 v[56:59], v4 offset:30720
    s_waitcnt lgkmcnt(7)
    v_mfma_f32_16x16x32_bf16 v[24:27], v[60:63], a[88:91], v[24:27]
    v_mfma_f32_16x16x32_bf16 v[28:31], v[60:63], a[92:95], v[28:31]
    ds_read_b128 v[60:63], v4 offset:30976
    s_waitcnt lgkmcnt(7)
    v_mfma_f32_16x16x32_bf16 v[16:19], v[32:35], a[96:99], v[16:19]
    v_mfma_f32_16x16x32_bf16 v[20:23], v[32:35], a[100:103], v[20:23]
    s_waitcnt lgkmcnt(6)
    v_mfma_f32_16x16x32_bf16 v[24:27], v[36:39], a[96:99], v[24:27]
    v_mfma_f32_16x16x32_bf16 v[28:31], v[36:39], a[100:103], v[28:31]
    s_waitcnt lgkmcnt(5)
    v_mfma_f32_16x16x32_bf16 v[16:19], v[40:43], a[104:107], v[16:19]
    v_mfma_f32_16x16x32_bf16 v[20:23], v[40:43], a[108:111], v[20:23]
    s_waitcnt lgkmcnt(4)
    v_mfma_f32_16x16x32_bf16 v[24:27], v[44:47], a[104:107], v[24:27]
    v_mfma_f32_16x16x32_bf16 v[28:31], v[44:47], a[108:111], v[28:31]
    s_waitcnt lgkmcnt(3)
    v_mfma_f32_16x16x32_bf16 v[16:19], v[48:51], a[112:115], v[16:19]
    v_mfma_f32_16x16x32_bf16 v[20:23], v[48:51], a[116:119], v[20:23]
    s_waitcnt lgkmcnt(2)
    v_mfma_f32_16x16x32_bf16 v[24:27], v[52:55], a[112:115], v[24:27]
    v_mfma_f32_16x16x32_bf16 v[28:31], v[52:55], a[116:119], v[28:31]
    s_waitcnt lgkmcnt(1)
    v_mfma_f32_16x16x32_bf16 v[16:19], v[56:59], a[120:123], v[16:19]
    v_mfma_f32_16x16x32_bf16 v[20:23], v[56:59], a[124:127], v[20:23]
    s_waitcnt lgkmcnt(0)
    v_mfma_f32_16x16x32_bf16 v[24:27], v[60:63], a[120:123], v[24:27]
    v_mfma_f32_16x16x32_bf16 v[28:31], v[60:63], a[124:127], v[28:31]
    v_xor_b32 v4, 0x10000, v4
    s_setprio 0
    s_waitcnt vmcnt(0)
    v_readfirstlane_b32 s66, v14
    s_barrier
    s_nop 6
    ds_write_b128 v5, v[16:19] offset:0
    ds_write_b128 v5, v[20:23] offset:1024
    ds_write_b128 v5, v[24:27] offset:2048
    ds_write_b128 v5, v[28:31] offset:3072
    s_cmp_lg_u32 s44, 0
    s_cbranch_scc1 L_g_ne_173
    s_mov_b32 s46, s54
    v_cmp_ge_u32 vcc, s46, v11
    s_nop 0
    s_cbranch_vccnz L_g_le_176
    s_add_u32 s46, s46, 1
    v_cmp_ge_u32 vcc, s46, v12
    s_nop 0
    s_cbranch_vccnz L_g_le_176
    s_add_u32 s46, s46, 1
    v_cmp_ge_u32 vcc, s46, v13
    s_nop 0
    s_cbranch_vccnz L_g_le_176
    s_add_u32 s46, s46, 1
L_g_le_176:
    v_mov_b32 v11, s46
    ds_write_b32 v15, v11
L_g_ne_173:
    s_add_u32 s60, s60, 1
    s_mov_b32 s69, 0
    s_cmp_gt_u32 s62, s60
    s_cbranch_scc1 L_g_nd_177
    s_cmp_ge_u32 s62, s66
    s_cbranch_scc1 L_g_nd_177
    s_add_u32 s47, s61, 4096
    s_add_u32 m0, s64, 0
    s_nop 0
    buffer_load_dwordx4 v3, s[12:15], s61 offen offset:0 sc1 lds
    buffer_load_dwordx4 v3, s[12:15], s61 offen offset:1024 sc1 lds
    buffer_load_dwordx4 v3, s[12:15], s61 offen offset:2048 sc1 lds
    buffer_load_dwordx4 v3, s[12:15], s61 offen offset:3072 sc1 lds
    s_add_u32 m0, s64, 4096
    s_nop 0
    buffer_load_dwordx4 v3, s[12:15], s47 offen offset:0 sc1 lds
    buffer_load_dwordx4 v3, s[12:15], s47 offen offset:1024 sc1 lds
    buffer_load_dwordx4 v3, s[12:15], s47 offen offset:2048 sc1 lds
    buffer_load_dwordx4 v3, s[12:15], s47 offen offset:3072 sc1 lds
    s_add_u32 s61, s61, 262144
    s_add_u32 s62, s62, 1
    s_xor_b32 s64, s64, 0x10000
    s_mov_b32 s69, 1
L_g_nd_177:
    s_mov_b32 s65, s69
    s_add_u32 s59, s60, 1
    s_mov_b32 s69, 0
    s_cmp_gt_u32 s62, s59
    s_cbranch_scc1 L_g_nd_178
    s_cmp_ge_u32 s62, s66
    s_cbranch_scc1 L_g_nd_178
    s_add_u32 s47, s61, 4096
    s_add_u32 m0, s64, 0
    s_nop 0
    buffer_load_dwordx4 v3, s[12:15], s61 offen offset:0 sc1 lds
    buffer_load_dwordx4 v3, s[12:15], s61 offen offset:1024 sc1 lds
    buffer_load_dwordx4 v3, s[12:15], s61 offen offset:2048 sc1 lds
    buffer_load_dwordx4 v3, s[12:15], s61 offen offset:3072 sc1 lds
    s_add_u32 m0, s64, 4096
    s_nop 0
    buffer_load_dwordx4 v3, s[12:15], s47 offen offset:0 sc1 lds
    buffer_load_dwordx4 v3, s[12:15], s47 offen offset:1024 sc1 lds
    buffer_load_dwordx4 v3, s[12:15], s47 offen offset:2048 sc1 lds
    buffer_load_dwordx4 v3, s[12:15], s47 offen offset:3072 sc1 lds
    s_add_u32 s61, s61, 262144
    s_add_u32 s62, s62, 1
    s_xor_b32 s64, s64, 0x10000
    s_mov_b32 s69, 1
L_g_nd_178:
    s_cmp_le_u32 s66, s60
    s_cbranch_scc1 L_g_ex0_175
    s_cmp_eq_u32 s65, 0
    s_cbranch_scc1 L_g_nw_174
    s_waitcnt vmcnt(0) lgkmcnt(0)
    s_branch L_g_loop0_162
L_g_nw_174:
    ds_read_b128 v[32:35], v4 offset:0
    ds_read_b128 v[36:39], v4 offset:256
    ds_read_b128 v[40:43], v4 offset:2048
    ds_read_b128 v[44:47], v4 offset:2304
    ds_read_b128 v[48:51], v4 offset:4096
    ds_read_b128 v[52:55], v4 offset:4352
    ds_read_b128 v[56:59], v4 offset:6144
    ds_read_b128 v[60:63], v4 offset:6400
    s_waitcnt lgkmcnt(8)
    s_branch L_g_loop0_162
L_g_ex0_175:
    s_cmp_lg_u32 s44, 0
    s_cbranch_scc1 L_g_ex0_175_n
    s_sleep 6
    s_add_u32 s54, s60, 0
    s_add_u32 s55, s54, 0
    s_and_b32 s46, s55, 3
    s_lshl_b32 s46, s46, 7
    buffer_load_dword v11, v7, s[12:15], s46 offen sc1
    s_add_u32 s55, s54, 1
    s_and_b32 s46, s55, 3
    s_lshl_b32 s46, s46, 7
    buffer_load_dword v12, v7, s[12:15], s46 offen sc1
    s_add_u32 s55, s54, 2
    s_and_b32 s46, s55, 3
    s_lshl_b32 s46, s46, 7
    buffer_load_dword v13, v7, s[12:15], s46 offen sc1
    s_waitcnt vmcnt(0)
    s_mov_b32 s46, s54
    v_cmp_ge_u32 vcc, s46, v11
    s_nop 0
    s_cbranch_vccnz L_g_le_179
    s_add_u32 s46, s46, 1
    v_cmp_ge_u32 vcc, s46, v12
    s_nop 0
    s_cbranch_vccnz L_g_le_179
    s_add_u32 s46, s46, 1
    v_cmp_ge_u32 vcc, s46, v13
    s_nop 0
    s_cbranch_vccnz L_g_le_179
    s_add_u32 s46, s46, 1
L_g_le_179:
    v_mov_b32 v11, s46
    ds_write_b32 v15, v11
L_g_ex0_175_n:
    s_waitcnt lgkmcnt(0)
    s_barrier
    ds_read_b32 v14, v15
    s_waitcnt lgkmcnt(0)
    v_readfirstlane_b32 s66, v14
    s_barrier
    s_cmp_gt_u32 s66, s60
    s_cbranch_scc1 L_g_restart_159_go
    s_branch L_g_tail_164
L_g_g1r_161:
    s_mov_b32 s65, 1
    s_branch L_g_loop1_163_e
.p2align 6
L_g_loop1_163:
    s_mov_b32 s65, 0
L_g_loop1_163_e:
    s_barrier
    ds_read_b32 v14, v15
    s_bitcmp1_b32 s67, 1
    s_cbranch_scc0 L_g_nfl_180
    s_sub_u32 s59, s60, 2
    s_cmp_lg_u32 s44, 4
    s_cbranch_scc1 L_sf_185
    v_mov_b32 v10, s59
    v_add_u32 v10, 1, v10
    v_mov_b32 v11, 0
    s_mov_b64 exec, 1
    buffer_store_dword v10, v11, s[12:15], s52 offen sc1
    s_mov_b64 exec, -1
L_sf_185:
L_g_nfl_180:
    s_cmp_eq_u32 s71, 0
    s_cbranch_scc1 L_g_nfl_180_d
    v_mov_b32 v10, 1
    s_mov_b64 exec, 1
    s_waitcnt vmcnt(0)
    ds_add_rtn_u32 v10, v15, v10 offset:4
    s_waitcnt lgkmcnt(0)
    v_readfirstlane_b32 s46, v10
    s_mov_b64 exec, -1
    s_mov_b32 s71, 0
    s_sub_u32 s59, s60, 1
    s_cmp_lg_u32 s46, s68
    s_cbranch_scc1 L_g_df_186
    v_mov_b32 v10, s59
    v_add_u32 v10, 1, v10
    v_mov_b32 v11, 0
    s_mov_b64 exec, 1
    buffer_store_dword v10, v11, s[12:15], s52 offen sc1
    s_mov_b64 exec, -1
L_sf_187:
L_g_df_186:
    s_add_u32 s68, s68, 4
    s_mov_b32 s65, 2
L_g_nfl_180_d:
    s_waitcnt lgkmcnt(0)
    v_readfirstlane_b32 s66, v14
    s_nop 3
    s_mov_b32 s69, 0
    s_cmp_gt_u32 s62, s60
    s_cbranch_scc1 L_g_nd_188
    s_cmp_ge_u32 s62, s66
    s_cbranch_scc1 L_g_nd_188
    s_add_u32 s47, s61, 4096
    s_add_u32 m0, s64, 0
    s_nop 0
    buffer_load_dwordx4 v3, s[12:15], s61 offen offset:0 sc1 lds
    buffer_load_dwordx4 v3, s[12:15], s61 offen offset:1024 sc1 lds
    buffer_load_dwordx4 v3, s[12:15], s61 offen offset:2048 sc1 lds
    buffer_load_dwordx4 v3, s[12:15], s61 offen offset:3072 sc1 lds
    s_add_u32 m0, s64, 4096
    s_nop 0
    buffer_load_dwordx4 v3, s[12:15], s47 offen offset:0 sc1 lds
    buffer_load_dwordx4 v3, s[12:15], s47 offen offset:1024 sc1 lds
    buffer_load_dwordx4 v3, s[12:15], s47 offen offset:2048 sc1 lds
    buffer_load_dwordx4 v3, s[12:15], s47 offen offset:3072 sc1 lds
    s_add_u32 s61, s61, 262144
    s_add_u32 s62, s62, 1
    s_xor_b32 s64, s64, 0x10000
    s_mov_b32 s69, 1
L_g_nd_188:
    s_or_b32 s65, s65, s69
    s_add_u32 s59, s60, 1
    s_mov_b32 s69, 0
    s_cmp_gt_u32 s62, s59
    s_cbranch_scc1 L_g_nd_189
    s_cmp_ge_u32 s62, s66
    s_cbranch_scc1 L_g_nd_189
    s_add_u32 s47, s61, 4096
    s_add_u32 m0, s64, 0
    s_nop 0
    buffer_load_dwordx4 v3, s[12:15], s61 offen offset:0 sc1 lds
    buffer_load_dwordx4 v3, s[12:15], s61 offen offset:1024 sc1 lds
    buffer_load_dwordx4 v3, s[12:15], s61 offen offset:2048 sc1 lds
    buffer_load_dwordx4 v3, s[12:15], s61 offen offset:3072 sc1 lds
    s_add_u32 m0, s64, 4096
    s_nop 0
    buffer_load_dwordx4 v3, s[12:15], s47 offen offset:0 sc1 lds
    buffer_load_dwordx4 v3, s[12:15], s47 offen offset:1024 sc1 lds
    buffer_load_dwordx4 v3, s[12:15], s47 offen offset:2048 sc1 lds
    buffer_load_dwordx4 v3, s[12:15], s47 offen offset:3072 sc1 lds
    s_add_u32 s61, s61, 262144
    s_add_u32 s62, s62, 1
    s_xor_b32 s64, s64, 0x10000
    s_mov_b32 s69, 1
L_g_nd_189:
    s_bitcmp1_b32 s67, 0
    s_cbranch_scc0 L_g_nep_181
    ds_read_b128 v[80:83], v5 offset:0
    ds_read_b128 v[84:87], v5 offset:1024
    ds_read_b128 v[88:91], v5 offset:2048
    ds_read_b128 v[92:95], v5 offset:3072
    s_nop 7
    s_waitcnt lgkmcnt(3)
    v_add_f32 v80, v80, v16
    v_add_f32 v81, v81, v17
    v_add_f32 v82, v82, v18
    v_add_f32 v83, v83, v19
    s_waitcnt lgkmcnt(2)
    v_add_f32 v84, v84, v20
    v_add_f32 v85, v85, v21
    v_add_f32 v86, v86, v22
    v_add_f32 v87, v87, v23
    s_waitcnt lgkmcnt(1)
    v_add_f32 v88, v88, v24
    v_add_f32 v89, v89, v25
    v_add_f32 v90, v90, v26
    v_add_f32 v91, v91, v27
    s_waitcnt lgkmcnt(0)
    v_add_f32 v92, v92, v28
    v_add_f32 v93, v93, v29
    v_add_f32 v94, v94, v30
    v_add_f32 v95, v95, v31
    v_cvt_pk_bf16_f32 v104, v80, v81
    v_cvt_pk_bf16_f32 v105, v82, v83
    v_cvt_pk_bf16_f32 v106, v84, v85
    v_cvt_pk_bf16_f32 v107, v86, v87
    s_nop 1
    v_permlane16_swap_b32 v104, v106
    v_permlane16_swap_b32 v105, v107
    buffer_store_dwordx4 v[104:107], v8, s[12:15], s63 offen sc1
    v_cvt_pk_bf16_f32 v108, v88, v89
    v_cvt_pk_bf16_f32 v109, v90, v91
    v_cvt_pk_bf16_f32 v110, v92, v93
    v_cvt_pk_bf16_f32 v111, v94, v95
    s_nop 1
    v_permlane16_swap_b32 v108, v110
    v_permlane16_swap_b32 v109, v111
    buffer_store_dwordx4 v[108:111], v9, s[12:15], s63 offen sc1
    s_add_u32 s63, s63, 262144
L_g_nep_181:
    s_cmp_eq_u32 s65, 0
    s_cbranch_scc1 L_g_nw1_182
    s_cmp_eq_u32 s65, 2
    s_cbranch_scc1 L_g_nw1_182_w
    s_waitcnt vmcnt(0)
L_g_nw1_182_w:
    s_barrier
    ds_read_b128 v[32:35], v4 offset:0
    ds_read_b128 v[36:39], v4 offset:256
    ds_read_b128 v[40:43], v4 offset:2048
    ds_read_b128 v[44:47], v4 offset:2304
    ds_read_b128 v[48:51], v4 offset:4096
    ds_read_b128 v[52:55], v4 offset:4352
    ds_read_b128 v[56:59], v4 offset:6144
    ds_read_b128 v[60:63], v4 offset:6400
    s_branch L_g_jn_184
L_g_nw1_182:
    ds_read_b128 v[32:35], v4 offset:0
    ds_read_b128 v[36:39], v4 offset:256
    ds_read_b128 v[40:43], v4 offset:2048
    ds_read_b128 v[44:47], v4 offset:2304
    ds_read_b128 v[48:51], v4 offset:4096
    ds_read_b128 v[52:55], v4 offset:4352
    ds_read_b128 v[56:59], v4 offset:6144
    ds_read_b128 v[60:63], v4 offset:6400
    s_barrier
L_g_jn_184:
    s_setprio 1
    s_waitcnt lgkmcnt(7)
    v_mfma_f32_16x16x32_bf16 v[16:19], v[32:35], a[0:3], 0
    v_mfma_f32_16x16x32_bf16 v[20:23], v[32:35], a[4:7], 0
    ds_read_b128 v[32:35], v4 offset:8192
    s_waitcnt lgkmcnt(7)
    v_mfma_f32_16x16x32_bf16 v[24:27], v[36:39], a[0:3], 0
    v_mfma_f32_16x16x32_bf16 v[28:31], v[36:39], a[4:7], 0
    ds_read_b128 v[36:39], v4 offset:8448
    s_waitcnt lgkmcnt(7)
    v_mfma_f32_16x16x32_bf16 v[16:19], v[40:43], a[8:11], v[16:19]
    v_mfma_f32_16x16x32_bf16 v[20:23], v[40:43], a[12:15], v[20:23]
    ds_read_b128 v[40:43], v4 offset:10240
    s_waitcnt lgkmcnt(7)
    v_mfma_f32_16x16x32_bf16 v[24:27], v[44:47], a[8:11], v[24:27]
    v_mfma_f32_16x16x32_bf16 v[28:31], v[44:47], a[12:15], v[28:31]
    ds_read_b128 v[44:47], v4 offset:10496
    s_waitcnt lgkmcnt(7)
    v_mfma_f32_16x16x32_bf16 v[16:19], v[48:51], a[16:19], v[16:19]
    v_mfma_f32_16x16x32_bf16 v[20:23], v[48:51], a[20:23], v[20:23]
    ds_read_b128 v[48:51], v4 offset:12288
    s_waitcnt lgkmcnt(7)
    v_mfma_f32_16x16x32_bf16 v[24:27], v[52:55], a[16:19], v[24:27]
    v_mfma_f32_16x16x32_bf16 v[28:31], v[52:55], a[20:23], v[28:31]
    ds_read_b128 v[52:55], v4 offset:12544
    s_waitcnt lgkmcnt(7)
    v_mfma_f32_16x16x32_bf16 v[16:19], v[56:59], a[24:27], v[16:19]
    v_mfma_f32_16x16x32_bf16 v[20:23], v[56:59], a[28:31], v[20:23]
    ds_read_b128 v[56:59], v4 offset:14336
    s_waitcnt lgkmcnt(7)
    v_mfma_f32_16x16x32_bf16 v[24:27], v[60:63], a[24:27], v[24:27]
    v_mfma_f32_16x16x32_bf16 v[28:31], v[60:63], a[28:31], v[28:31]
    ds_read_b128 v[60:63], v4 offset:14592
    s_waitcnt lgkmcnt(7)
    v_mfma_f32_16x16x32_bf16 v[16:19], v[32:35], a[32:35], v[16:19]
    v_mfma_f32_16x16x32_bf16 v[20:23], v[32:35], a[36:39], v[20:23]
    ds_read_b128 v[32:35], v4 offset:16384
    s_waitcnt lgkmcnt(7)
    v_mfma_f32_16x16x32_bf16 v[24:27], v[36:39], a[32:35], v[24:27]
    v_mfma_f32_16x16x32_bf16 v[28:31], v[36:39], a[36:39], v[28:31]
    ds_read_b128 v[36:39], v4 offset:16640
    s_waitcnt lgkmcnt(7)
    v_mfma_f32_16x16x32_bf16 v[16:19], v[40:43], a[40:43], v[16:19]
    v_mfma_f32_16x16x32_bf16 v[20:23], v[40:43], a[44:47], v[20:23]
    ds_read_b128 v[40:43], v4 offset:18432
    s_waitcnt lgkmcnt(7)
    v_mfma_f32_16x16x32_bf16 v[24:27], v[44:47], a[40:43], v[24:27]
    v_mfma_f32_16x16x32_bf16 v[28:31], v[44:47], a[44:47], v[28:31]
    ds_read_b128 v[44:47], v4 offset:18688
    s_waitcnt lgkmcnt(7)
    v_mfma_f32_16x16x32_bf16 v[16:19], v[48:51], a[48:51], v[16:19]
    v_mfma_f32_16x16x32_bf16 v[20:23], v[48:51], a[52:55], v[20:23]
    ds_read_b128 v[48:51], v4 offset:20480
    s_waitcnt lgkmcnt(7)
    v_mfma_f32_16x16x32_bf16 v[24:27], v[52:55], a[48:51], v[24:27]
    v_mfma_f32_16x16x32_bf16 v[28:31], v[52:55], a[52:55], v[28:31]
    ds_read_b128 v[52:55], v4 offset:20736
    s_waitcnt lgkmcnt(7)
    v_mfma_f32_16x16x32_bf16 v[16:19], v[56:59], a[56:59], v[16:19]
    v_mfma_f32_16x16x32_bf16 v[20:23], v[56:59], a[60:63], v[20:23]
    ds_read_b128 v[56:59], v4 offset:22528
    s_waitcnt lgkmcnt(7)
    v_mfma_f32_16x16x32_bf16 v[24:27], v[60:63], a[56:59], v[24:27]
    v_mfma_f32_16x16x32_bf16 v[28:31], v[60:63], a[60:63], v[28:31]
    ds_read_b128 v[60:63], v4 offset:22784
    s_waitcnt lgkmcnt(7)
    v_mfma_f32_16x16x32_bf16 v[16:19], v[32:35], a[64:67], v[16:19]
    v_mfma_f32_16x16x32_bf16 v[20:23], v[32:35], a[68:71], v[20:23]
    ds_read_b128 v[32:35], v4 offset:24576
    s_waitcnt lgkmcnt(7)
    v_mfma_f32_16x16x32_bf16 v[24:27], v[36:39], a[64:67], v[24:27]
    v_mfma_f32_16x16x32_bf16 v[28:31], v[36:39], a[68:71], v[28:31]
    ds_read_b128 v[36:39], v4 offset:24832
    s_waitcnt lgkmcnt(7)
    v_mfma_f32_16x16x32_bf16 v[16:19], v[40:43], a[72:75], v[16:19]
    v_mfma_f32_16x16x32_bf16 v[20:23], v[40:43], a[76:79], v[20:23]
    ds_read_b128 v[40:43], v4 offset:26624
    s_waitcnt lgkmcnt(7)
    v_mfma_f32_16x16x32_bf16 v[24:27], v[44:47], a[72:75], v[24:27]
    v_mfma_f32_16x16x32_bf16 v[28:31], v[44:47], a[76:79], v[28:31]
    ds_read_b128 v[44:47], v4 offset:26880
    s_waitcnt lgkmcnt(7)
    v_mfma_f32_16x16x32_bf16 v[16:19], v[48:51], a[80:83], v[16:19]
    v_mfma_f32_16x16x32_bf16 v[20:23], v[48:51], a[84:87], v[20:23]
    ds_read_b128 v[48:51], v4 offset:28672
    s_waitcnt lgkmcnt(7)
    v_mfma_f32_16x16x32_bf16 v[24:27], v[52:55], a[80:83], v[24:27]
    v_mfma_f32_16x16x32_bf16 v[28:31], v[52:55], a[84:87], v[28:31]
    ds_read_b128 v[52:55], v4 offset:28928
    s_waitcnt lgkmcnt(7)
    v_mfma_f32_16x16x32_bf16 v[16:19], v[56:59], a[88:91], v[16:19]
    v_mfma_f32_16x16x32_bf16 v[20:23], v[56:59], a[92:95], v[20:23]
    ds_read_b128 v[56:59], v4 offset:30720
    s_waitcnt lgkmcnt(7)
    v_mfma_f32_16x16x32_bf16 v[24:27], v[60:63], a[88:91], v[24:27]
    v_mfma_f32_16x16x32_bf16 v[28:31], v[60:63], a[92:95], v[28:31]
    ds_read_b128 v[60:63], v4 offset:30976
    s_waitcnt lgkmcnt(7)
    v_mfma_f32_16x16x32_bf16 v[16:19], v[32:35], a[96:99], v[16:19]
    v_mfma_f32_16x16x32_bf16 v[20:23], v[32:35], a[100:103], v[20:23]
    s_waitcnt lgkmcnt(6)
    v_mfma_f32_16x16x32_bf16 v[24:27], v[36:39], a[96:99], v[24:27]
    v_mfma_f32_16x16x32_bf16 v[28:31], v[36:39], a[100:103], v[28:31]
    s_waitcnt lgkmcnt(5)
    v_mfma_f32_16x16x32_bf16 v[16:19], v[40:43], a[104:107], v[16:19]
    v_mfma_f32_16x16x32_bf16 v[20:23], v[40:43], a[108:111], v[20:23]
    s_waitcnt lgkmcnt(4)
    v_mfma_f32_16x16x32_bf16 v[24:27], v[44:47], a[104:107], v[24:27]
    v_mfma_f32_16x16x32_bf16 v[28:31], v[44:47], a[108:111], v[28:31]
    s_waitcnt lgkmcnt(3)
    v_mfma_f32_16x16x32_bf16 v[16:19], v[48:51], a[112:115], v[16:19]
    v_mfma_f32_16x16x32_bf16 v[20:23], v[48:51], a[116:119], v[20:23]
    s_waitcnt lgkmcnt(2)
    v_mfma_f32_16x16x32_bf16 v[24:27], v[52:55], a[112:115], v[24:27]
    v_mfma_f32_16x16x32_bf16 v[28:31], v[52:55], a[116:119], v[28:31]
    s_waitcnt lgkmcnt(1)
    v_mfma_f32_16x16x32_bf16 v[16:19], v[56:59], a[120:123], v[16:19]
    v_mfma_f32_16x16x32_bf16 v[20:23], v[56:59], a[124:127], v[20:23]
    s_waitcnt lgkmcnt(0)
    v_mfma_f32_16x16x32_bf16 v[24:27], v[60:63], a[120:123], v[24:27]
    v_mfma_f32_16x16x32_bf16 v[28:31], v[60:63], a[124:127], v[28:31]
    v_xor_b32 v4, 0x10000, v4
    s_setprio 0
    s_waitcnt vmcnt(0)
    s_lshl_b32 s67, s67, 1
    s_or_b32 s67, s67, 1
    s_add_u32 s60, s60, 1
    s_cmp_gt_u32 s66, s60
    s_cbranch_scc1 L_g_loop1_163
    s_barrier
    ds_read_b32 v14, v15
    s_waitcnt lgkmcnt(0)
    v_readfirstlane_b32 s66, v14
    s_barrier
    s_mov_b32 s69, 0
    s_cmp_gt_u32 s62, s60
    s_cbranch_scc1 L_g_nd_190
    s_cmp_ge_u32 s62, s66
    s_cbranch_scc1 L_g_nd_190
    s_add_u32 s47, s61, 4096
    s_add_u32 m0, s64, 0
    s_nop 0
    buffer_load_dwordx4 v3, s[12:15], s61 offen offset:0 sc1 lds
    buffer_load_dwordx4 v3, s[12:15], s61 offen offset:1024 sc1 lds
    buffer_load_dwordx4 v3, s[12:15], s61 offen offset:2048 sc1 lds
    buffer_load_dwordx4 v3, s[12:15], s61 offen offset:3072 sc1 lds
    s_add_u32 m0, s64, 4096
    s_nop 0
    buffer_load_dwordx4 v3, s[12:15], s47 offen offset:0 sc1 lds
    buffer_load_dwordx4 v3, s[12:15], s47 offen offset:1024 sc1 lds
    buffer_load_dwordx4 v3, s[12:15], s47 offen offset:2048 sc1 lds
    buffer_load_dwordx4 v3, s[12:15], s47 offen offset:3072 sc1 lds
    s_add_u32 s61, s61, 262144
    s_add_u32 s62, s62, 1
    s_xor_b32 s64, s64, 0x10000
    s_mov_b32 s69, 1
L_g_nd_190:
    s_sub_u32 s59, s60, 1
    ds_read_b128 v[80:83], v5 offset:0
    ds_read_b128 v[84:87], v5 offset:1024
    ds_read_b128 v[88:91], v5 offset:2048
    ds_read_b128 v[92:95], v5 offset:3072
    s_nop 7
    s_waitcnt lgkmcnt(3)
    v_add_f32 v80, v80, v16
    v_add_f32 v81, v81, v17
    v_add_f32 v82, v82, v18
    v_add_f32 v83, v83, v19
    s_waitcnt lgkmcnt(2)
    v_add_f32 v84, v84, v20
    v_add_f32 v85, v85, v21
    v_add_f32 v86, v86, v22
    v_add_f32 v87, v87, v23
    s_waitcnt lgkmcnt(1)
    v_add_f32 v88, v88, v24
    v_add_f32 v89, v89, v25
    v_add_f32 v90, v90, v26
    v_add_f32 v91, v91, v27
    s_waitcnt lgkmcnt(0)
    v_add_f32 v92, v92, v28
    v_add_f32 v93, v93, v29
    v_add_f32 v94, v94, v30
    v_add_f32 v95, v95, v31
    v_cvt_pk_bf16_f32 v104, v80, v81
    v_cvt_pk_bf16_f32 v105, v82, v83
    v_cvt_pk_bf16_f32 v106, v84, v85
    v_cvt_pk_bf16_f32 v107, v86, v87
    s_nop 1
    v_permlane16_swap_b32 v104, v106
    v_permlane16_swap_b32 v105, v107
    buffer_store_dwordx4 v[104:107], v8, s[12:15], s63 offen sc1
    v_cvt_pk_bf16_f32 v108, v88, v89
    v_cvt_pk_bf16_f32 v109, v90, v91
    v_cvt_pk_bf16_f32 v110, v92, v93
    v_cvt_pk_bf16_f32 v111, v94, v95
    s_nop 1
    v_permlane16_swap_b32 v108, v110
    v_permlane16_swap_b32 v109, v111
    buffer_store_dwordx4 v[108:111], v9, s[12:15], s63 offen sc1
    s_add_u32 s63, s63, 262144
    s_mov_b32 s67, 0
    s_mov_b32 s71, 1
    s_cmp_gt_u32 s66, s60
    s_cbranch_scc1 L_g_g1r_161
    v_mov_b32 v10, 1
    s_mov_b64 exec, 1
    s_waitcnt vmcnt(0)
    ds_add_rtn_u32 v10, v15, v10 offset:4
    s_waitcnt lgkmcnt(0)
    v_readfirstlane_b32 s46, v10
    s_mov_b64 exec, -1
    s_mov_b32 s71, 0
    s_sub_u32 s59, s60, 1
    s_cmp_lg_u32 s46, s68
    s_cbranch_scc1 L_g_df_191
    v_mov_b32 v10, s59
    v_add_u32 v10, 1, v10
    v_mov_b32 v11, 0
    s_mov_b64 exec, 1
    buffer_store_dword v10, v11, s[12:15], s52 offen sc1
    s_mov_b64 exec, -1
L_sf_192:
L_g_df_191:
    s_add_u32 s68, s68, 4
    s_cmp_gt_u32 s66, s60
    s_cbranch_scc1 L_g_g1r_161
L_g_tail_164:
    s_cmp_lt_u32 s60, 64
    s_cbranch_scc1 L_g_restart_159
    s_barrier
    s_branch L_c_done_1
L_c_chain_7:
    v_mov_b32 v4, 0
    v_mov_b32 v5, 0
    v_mov_b32 v6, 0
    v_mov_b32 v7, 0
    v_mov_b32 v8, 0
    v_mov_b32 v9, 0
    v_mov_b32 v10, 0
    v_mov_b32 v11, 0
    v_mov_b32 v12, 0
    v_mov_b32 v13, 0
    v_mov_b32 v14, 0
    v_mov_b32 v15, 0
    v_mov_b32 v32, -1
    v_mov_b32 v33, -1
    v_mov_b32 v34, -1
    v_mov_b32 v35, -1
    v_lshlrev_b32 v2, 4, v1
    s_lshl_b32 s45, s40, 16
    s_lshl_b32 s46, s41, 12
    s_add_u32 s45, s45, s46
    s_and_b32 s46, s44, 3
    s_lshl_b32 s46, s46, 10
    s_add_u32 s45, s45, s46
    s_lshr_b32 s46, s44, 2
    s_lshl_b32 s46, s46, 19
    s_add_u32 s45, s45, s46
    s_add_u32 s45, s45, 0x7000000
    buffer_store_dwordx4 v[32:35], v2, s[12:15], s45 offen sc1
    s_lshl_b32 s45, s40, 15
    s_lshl_b32 s46, s41, 11
    s_add_u32 s45, s45, s46
    s_lshl_b32 s46, s44, 8
    s_add_u32 s45, s45, s46
    s_add_u32 s45, s45, 0x7100000
    s_mov_b64 exec, 0xffff
    buffer_store_dwordx4 v[32:35], v2, s[12:15], s45 offen sc1
    s_mov_b64 exec, -1
    s_load_dwordx4 s[4:7], s[0:1], 16
    s_load_dwordx2 s[8:9], s[0:1], 32
    v_lshrrev_b32 v2, 3, v0
    v_lshlrev_b32 v2, 13, v2
    v_and_b32 v3, 7, v0
    v_lshl_add_u32 v2, v3, 7, v2
    s_lshl_b32 s45, s41, 19
    s_lshl_b32 s46, s40, 10
    s_add_u32 s45, s45, s46
    s_waitcnt lgkmcnt(0)
    s_mov_b32 s24, s6
    s_and_b32 s25, s7, 0xffff
    s_mov_b32 s26, 0x800000
    s_mov_b32 s27, 0x00020000
    buffer_load_dword v109, v2, s[24:27], s45 offen
    s_mov_b32 s24, s8
    s_and_b32 s25, s9, 0xffff
    s_mov_b32 s26, 0x800000
    s_mov_b32 s27, 0x00020000
    buffer_load_dword v110, v2, s[24:27], s45 offen
    s_mov_b32 s24, s4
    s_and_b32 s25, s5, 0xffff
    s_mov_b32 s26, 0x800000
    s_mov_b32 s27, 0x00020000
    buffer_load_dword v111, v2, s[24:27], s45 offen
    v_lshlrev_b32 v2, 4, v1
    v_and_b32 v3, 8, v1
    v_cmp_eq_u32 vcc, 0, v3
    v_mov_b32 v3, 0xeeeeeeee
    v_mov_b32 v4, 0x44444444
    v_cndmask_b32 v3, v3, v4, vcc
    v_and_b32 v100, 15, v1
    v_lshrrev_b32 v101, 4, v1
    v_and_b32 v102, 1, v101
    v_lshrrev_b32 v103, 1, v101
    v_lshlrev_b32 v104, 2, v102
    v_lshl_add_u32 v104, v103, 1, v104
    v_and_b32 v105, 1, v1
    v_add_u32 v104, v104, v105
    v_and_b32 v106, 7, v1
    v_bfe_u32 v107, v1, 3, 1
    s_lshr_b32 s42, s41, 2
    s_and_b32 s43, s41, 3
    s_lshl_b32 s49, s40, 2
    s_add_u32 s49, s49, s42
    s_lshl_b32 s45, s44, 14
    v_lshlrev_b32 v22, 3, v101
    v_bfe_u32 v23, v1, 2, 2
    v_add_u32 v22, v22, v23
    v_and_b32 v23, 3, v1
    v_lshlrev_b32 v24, 3, v23
    v_lshl_add_u32 v20, v22, 6, v24
    v_lshl_add_u32 v21, v22, 7, v24
    v_lshrrev_b32 v22, 2, v1
    v_lshlrev_b32 v23, 4, v23
    v_lshl_add_u32 v24, v22, 13, v23
    v_lshrrev_b32 v22, 3, v1
    v_lshlrev_b32 v23, 4, v106
    v_lshl_add_u32 v25, v22, 11, v23
    s_cmp_ge_u32 s44, 4
    s_cbranch_scc1 L_v_init_193
    s_lshr_b32 s50, s44, 1
    s_and_b32 s51, s44, 1
    s_load_dwordx4 s[4:7], s[0:1], 16
    s_lshl_b32 s46, s49, 8
    s_lshl_b32 s48, s43, 6
    s_add_u32 s46, s46, s48
    s_lshl_b32 s48, s44, 21
    s_add_u32 s46, s46, s48
    s_lshl_b32 s52, s51, 5
    s_xor_b32 s53, s50, 1
    s_lshl_b32 s53, s53, 16
    s_add_u32 s52, s52, s53
    v_add_u32 v20, s52, v20
    s_waitcnt lgkmcnt(0)
    s_mov_b32 s24, s6
    s_and_b32 s25, s7, 0xffff
    s_mov_b32 s26, 0x800000
    s_mov_b32 s27, 0x00020000
    s_mov_b32 s28, s4
    s_and_b32 s29, s5, 0xffff
    s_mov_b32 s30, 0x800000
    s_mov_b32 s31, 0x00020000
    s_lshl_b32 s52, s40, 16
    s_lshl_b32 s53, s42, 12
    s_add_u32 s52, s52, s53
    s_lshl_b32 s53, s43, 10
    s_add_u32 s52, s52, s53
    s_lshl_b32 s53, s51, 9
    s_add_u32 s52, s52, s53
    s_lshl_b32 s53, s50, 7
    s_add_u32 s52, s52, s53
    s_add_u32 s52, s52, 0x7080000
    v_lshlrev_b32 v4, 8, v107
    v_lshl_add_u32 v4, v104, 4, v4
    v_lshrrev_b32 v5, 1, v106
    v_lshl_add_u32 v4, v5, 2, v4
    v_add_u32 v4, s52, v4
    v_mov_b32 v13, -1
    s_xor_b32 s52, s50, 1
    s_lshl_b32 s52, s52, 10
    s_lshl_b32 s53, s51, 8
    s_add_u32 s52, s52, s53
    s_add_u32 s52, s52, 27648
    v_lshrrev_b32 v5, 1, v106
    v_lshlrev_b32 v5, 2, v5
    v_lshl_add_u32 v5, v104, 4, v5
    v_lshl_add_u32 v5, v107, 7, v5
    v_add_u32 v5, s52, v5
    s_lshl_b32 s67, s49, 12
    s_lshl_b32 s53, s43, 10
    s_add_u32 s67, s67, s53
    s_add_u32 s67, s67, 0x1000000
    s_lshl_b32 s52, s40, 2
    s_add_u32 s52, s52, s44
    s_mul_i32 s52, s52, 24576
    s_add_u32 s52, s52, 0x2002000
    v_add_u32 v6, s52, v2
    s_lshl_b32 s52, s40, 16
    s_lshl_b32 s53, s44, 12
    s_add_u32 s52, s52, s53
    s_add_u32 s52, s52, 0x7080000
    v_add_u32 v7, s52, v2
    s_lshl_b32 s52, s44, 10
    s_add_u32 s52, s52, 16384
    v_lshlrev_b32 v8, 8, v101
    v_lshl_add_u32 v8, v106, 4, v8
    v_lshl_add_u32 v8, v107, 3, v8
    v_add_u32 v8, s52, v8
    s_lshl_b32 s52, s44, 8
    s_add_u32 s52, s52, 20480
    v_xor_b32 v9, 1, v103
    v_lshlrev_b32 v9, 7, v9
    v_lshl_add_u32 v9, v106, 4, v9
    v_lshl_add_u32 v9, v102, 3, v9
    v_lshl_add_u32 v9, v107, 2, v9
    v_add_u32 v9, s52, v9
    v_cmp_gt_u32 vcc, 32, v1
    v_mov_b32 v28, 0
    v_mov_b32 v29, 0xff800000
    v_cndmask_b32 v28, v28, v29, vcc
    v_mov_b32 v29, v28
    v_mov_b32 v30, v28
    v_mov_b32 v31, v28
    s_mov_b32 s66, 0x3e0293ee
    s_waitcnt vmcnt(0)
    s_add_u32 m0, s45, 0
    s_add_u32 s48, s46, 0x0
    buffer_load_dwordx4 v24, s[24:27], s48 offen lds
    s_add_u32 m0, s45, 1024
    s_add_u32 s48, s46, 0x20000
    buffer_load_dwordx4 v24, s[24:27], s48 offen lds
    s_add_u32 m0, s45, 2048
    s_add_u32 s48, s46, 0x40000
    buffer_load_dwordx4 v24, s[24:27], s48 offen lds
    s_add_u32 m0, s45, 3072
    s_add_u32 s48, s46, 0x60000
    buffer_load_dwordx4 v24, s[24:27], s48 offen lds
    s_add_u32 m0, s45, 4096
    s_add_u32 s48, s46, 0x80000
    buffer_load_dwordx4 v24, s[24:27], s48 offen lds
    s_add_u32 m0, s45, 5120
    s_add_u32 s48, s46, 0xa0000
    buffer_load_dwordx4 v24, s[24:27], s48 offen lds
    s_add_u32 m0, s45, 6144
    s_add_u32 s48, s46, 0xc0000
    buffer_load_dwordx4 v24, s[24:27], s48 offen lds
    s_add_u32 m0, s45, 7168
    s_add_u32 s48, s46, 0xe0000
    buffer_load_dwordx4 v24, s[24:27], s48 offen lds
    s_add_u32 m0, s45, 8192
    s_add_u32 s48, s46, 0x100000
    buffer_load_dwordx4 v24, s[24:27], s48 offen lds
    s_add_u32 m0, s45, 9216
    s_add_u32 s48, s46, 0x120000
    buffer_load_dwordx4 v24, s[24:27], s48 offen lds
    s_add_u32 m0, s45, 10240
    s_add_u32 s48, s46, 0x140000
    buffer_load_dwordx4 v24, s[24:27], s48 offen lds
    s_add_u32 m0, s45, 11264
    s_add_u32 s48, s46, 0x160000
    buffer_load_dwordx4 v24, s[24:27], s48 offen lds
    s_add_u32 m0, s45, 12288
    s_add_u32 s48, s46, 0x180000
    buffer_load_dwordx4 v24, s[24:27], s48 offen lds
    s_add_u32 m0, s45, 13312
    s_add_u32 s48, s46, 0x1a0000
    buffer_load_dwordx4 v24, s[24:27], s48 offen lds
    s_add_u32 m0, s45, 14336
    s_add_u32 s48, s46, 0x1c0000
    buffer_load_dwordx4 v24, s[24:27], s48 offen lds
    s_add_u32 m0, s45, 15360
    s_add_u32 s48, s46, 0x1e0000
    buffer_load_dwordx4 v24, s[24:27], s48 offen lds
    s_add_u32 s45, s45, 0x10000
    s_add_u32 m0, s45, 0
    s_add_u32 s48, s46, 0x0
    buffer_load_dwordx4 v24, s[28:31], s48 offen lds
    s_add_u32 m0, s45, 1024
    s_add_u32 s48, s46, 0x20000
    buffer_load_dwordx4 v24, s[28:31], s48 offen lds
    s_add_u32 m0, s45, 2048
    s_add_u32 s48, s46, 0x40000
    buffer_load_dwordx4 v24, s[28:31], s48 offen lds
    s_add_u32 m0, s45, 3072
    s_add_u32 s48, s46, 0x60000
    buffer_load_dwordx4 v24, s[28:31], s48 offen lds
    s_add_u32 m0, s45, 4096
    s_add_u32 s48, s46, 0x80000
    buffer_load_dwordx4 v24, s[28:31], s48 offen lds
    s_add_u32 m0, s45, 5120
    s_add_u32 s48, s46, 0xa0000
    buffer_load_dwordx4 v24, s[28:31], s48 offen lds
    s_add_u32 m0, s45, 6144
    s_add_u32 s48, s46, 0xc0000
    buffer_load_dwordx4 v24, s[28:31], s48 offen lds
    s_add_u32 m0, s45, 7168
    s_add_u32 s48, s46, 0xe0000
    buffer_load_dwordx4 v24, s[28:31], s48 offen lds
    s_add_u32 m0, s45, 8192
    s_add_u32 s48, s46, 0x100000
    buffer_load_dwordx4 v24, s[28:31], s48 offen lds
    s_add_u32 m0, s45, 9216
    s_add_u32 s48, s46, 0x120000
    buffer_load_dwordx4 v24, s[28:31], s48 offen lds
    s_add_u32 m0, s45, 10240
    s_add_u32 s48, s46, 0x140000
    buffer_load_dwordx4 v24, s[28:31], s48 offen lds
    s_add_u32 m0, s45, 11264
    s_add_u32 s48, s46, 0x160000
    buffer_load_dwordx4 v24, s[28:31], s48 offen lds
    s_add_u32 m0, s45, 12288
    s_add_u32 s48, s46, 0x180000
    buffer_load_dwordx4 v24, s[28:31], s48 offen lds
    s_add_u32 m0, s45, 13312
    s_add_u32 s48, s46, 0x1a0000
    buffer_load_dwordx4 v24, s[28:31], s48 offen lds
    s_add_u32 m0, s45, 14336
    s_add_u32 s48, s46, 0x1c0000
    buffer_load_dwordx4 v24, s[28:31], s48 offen lds
    s_add_u32 m0, s45, 15360
    s_add_u32 s48, s46, 0x1e0000
    buffer_load_dwordx4 v24, s[28:31], s48 offen lds
    s_add_u32 s45, s45, 0x10000
    s_waitcnt vmcnt(0)
    s_barrier
    s_cmp_lg_u32 s44, 0
    s_cbranch_scc1 L_zwok_196
    v_and_b32 v16, 7, v1
    v_lshlrev_b32 v16, 5, v16
    s_mov_b32 s70, 0
L_zw_195:
    buffer_load_dword v17, v16, s[16:19], 0 offen sc1
    s_waitcnt vmcnt(0)
    v_add_u32_dpp v17, v17, v17 row_ror:1 row_mask:0xf bank_mask:0xf
    s_nop 1
    v_add_u32_dpp v17, v17, v17 row_ror:2 row_mask:0xf bank_mask:0xf
    s_nop 1
    v_add_u32_dpp v17, v17, v17 row_ror:4 row_mask:0xf bank_mask:0xf
    v_cmp_ne_u32 vcc, 0x100, v17
    s_add_u32 s70, s70, 1
    s_cbranch_vccz L_zwok_196
    s_sleep 4
    s_cmp_lt_u32 s70, 524288
    s_cbranch_scc1 L_zw_195
    s_branch L_c_done_1
L_zwok_196:
    s_cmp_lg_u32 s44, 0
    s_cbranch_scc1 L_c_nr_197
    s_or_b32 s47, s39, 0x100
    v_mov_b32 v16, s47
    s_lshl_b32 s52, s40, 6
    s_lshl_b32 s53, s41, 2
    s_add_u32 s52, s52, s53
    s_add_u32 s52, s52, 0x101000
    v_mov_b32 v17, 0
    s_mov_b64 exec, 1
    buffer_store_dword v16, v17, s[12:15], s52 offen sc1
    s_mov_b64 exec, -1
L_c_nr_197:
    ds_read_b64_tr_b16 a[0:1], v20 offset:0
    ds_read_b64_tr_b16 a[2:3], v20 offset:256
    ds_read_b64_tr_b16 a[4:5], v20 offset:2048
    ds_read_b64_tr_b16 a[6:7], v20 offset:2304
    ds_read_b64_tr_b16 a[8:9], v20 offset:4096
    ds_read_b64_tr_b16 a[10:11], v20 offset:4352
    ds_read_b64_tr_b16 a[12:13], v20 offset:6144
    ds_read_b64_tr_b16 a[14:15], v20 offset:6400
    s_waitcnt lgkmcnt(0)
    ds_read_b64_tr_b16 a[16:17], v20 offset:8192
    ds_read_b64_tr_b16 a[18:19], v20 offset:8448
    ds_read_b64_tr_b16 a[20:21], v20 offset:10240
    ds_read_b64_tr_b16 a[22:23], v20 offset:10496
    ds_read_b64_tr_b16 a[24:25], v20 offset:12288
    ds_read_b64_tr_b16 a[26:27], v20 offset:12544
    ds_read_b64_tr_b16 a[28:29], v20 offset:14336
    ds_read_b64_tr_b16 a[30:31], v20 offset:14592
    s_waitcnt lgkmcnt(0)
    ds_read_b64_tr_b16 a[32:33], v20 offset:16384
    ds_read_b64_tr_b16 a[34:35], v20 offset:16640
    ds_read_b64_tr_b16 a[36:37], v20 offset:18432
    ds_read_b64_tr_b16 a[38:39], v20 offset:18688
    ds_read_b64_tr_b16 a[40:41], v20 offset:20480
    ds_read_b64_tr_b16 a[42:43], v20 offset:20736
    ds_read_b64_tr_b16 a[44:45], v20 offset:22528
    ds_read_b64_tr_b16 a[46:47], v20 offset:22784
    s_waitcnt lgkmcnt(0)
    ds_read_b64_tr_b16 a[48:49], v20 offset:24576
    ds_read_b64_tr_b16 a[50:51], v20 offset:24832
    ds_read_b64_tr_b16 a[52:53], v20 offset:26624
    ds_read_b64_tr_b16 a[54:55], v20 offset:26880
    ds_read_b64_tr_b16 a[56:57], v20 offset:28672
    ds_read_b64_tr_b16 a[58:59], v20 offset:28928
    ds_read_b64_tr_b16 a[60:61], v20 offset:30720
    ds_read_b64_tr_b16 a[62:63], v20 offset:30976
    s_waitcnt lgkmcnt(0)
    ds_read_b64_tr_b16 a[64:65], v20 offset:32768
    ds_read_b64_tr_b16 a[66:67], v20 offset:33024
    ds_read_b64_tr_b16 a[68:69], v20 offset:34816
    ds_read_b64_tr_b16 a[70:71], v20 offset:35072
    ds_read_b64_tr_b16 a[72:73], v20 offset:36864
    ds_read_b64_tr_b16 a[74:75], v20 offset:37120
    ds_read_b64_tr_b16 a[76:77], v20 offset:38912
    ds_read_b64_tr_b16 a[78:79], v20 offset:39168
    s_waitcnt lgkmcnt(0)
    ds_read_b64_tr_b16 a[80:81], v20 offset:40960
    ds_read_b64_tr_b16 a[82:83], v20 offset:41216
    ds_read_b64_tr_b16 a[84:85], v20 offset:43008
    ds_read_b64_tr_b16 a[86:87], v20 offset:43264
    ds_read_b64_tr_b16 a[88:89], v20 offset:45056
    ds_read_b64_tr_b16 a[90:91], v20 offset:45312
    ds_read_b64_tr_b16 a[92:93], v20 offset:47104
    ds_read_b64_tr_b16 a[94:95], v20 offset:47360
    s_waitcnt lgkmcnt(0)
    ds_read_b64_tr_b16 a[96:97], v20 offset:49152
    ds_read_b64_tr_b16 a[98:99], v20 offset:49408
    ds_read_b64_tr_b16 a[100:101], v20 offset:51200
    ds_read_b64_tr_b16 a[102:103], v20 offset:51456
    ds_read_b64_tr_b16 a[104:105], v20 offset:53248
    ds_read_b64_tr_b16 a[106:107], v20 offset:53504
    ds_read_b64_tr_b16 a[108:109], v20 offset:55296
    ds_read_b64_tr_b16 a[110:111], v20 offset:55552
    s_waitcnt lgkmcnt(0)
    ds_read_b64_tr_b16 a[112:113], v20 offset:57344
    ds_read_b64_tr_b16 a[114:115], v20 offset:57600
    ds_read_b64_tr_b16 a[116:117], v20 offset:59392
    ds_read_b64_tr_b16 a[118:119], v20 offset:59648
    ds_read_b64_tr_b16 a[120:121], v20 offset:61440
    ds_read_b64_tr_b16 a[122:123], v20 offset:61696
    ds_read_b64_tr_b16 a[124:125], v20 offset:63488
    ds_read_b64_tr_b16 a[126:127], v20 offset:63744
    s_waitcnt lgkmcnt(0)
    s_mov_b32 s63, 0
    s_barrier
    s_lshl_b32 s52, s44, 13
    s_add_u32 s52, s52, 65536
    v_add_u32 v6, s52, v2
    s_lshl_b32 s58, s40, 11
    s_lshl_b32 s53, s44, 7
    s_add_u32 s58, s58, s53
    s_add_u32 s58, s58, 0x10a600
    s_mov_b32 s69, 0
    s_setprio 1
    s_branch L_c_join_194
L_v_init_193:
    s_sub_u32 s54, s44, 4
    s_lshr_b32 s51, s54, 1
    s_and_b32 s50, s54, 1
    s_load_dwordx4 s[4:7], s[0:1], 32
    s_load_dwordx2 s[8:9], s[0:1], 8
    s_waitcnt lgkmcnt(0)
    s_mov_b32 s24, s4
    s_and_b32 s25, s5, 0xffff
    s_mov_b32 s26, 0x800000
    s_mov_b32 s27, 0x00020000
    s_mov_b32 s28, s6
    s_and_b32 s29, s7, 0xffff
    s_mov_b32 s30, 0x800000
    s_mov_b32 s31, 0x00020000
    s_mov_b32 s32, s8
    s_and_b32 s33, s9, 0xffff
    s_mov_b32 s34, 0x4000
    s_mov_b32 s35, 0x00020000
    s_lshl_b32 s45, s54, 12
    s_add_u32 s45, s45, 0x20000
    v_add_u32 v20, s45, v20
    v_add_u32 v21, s45, v21
    v_add_u32 v22, s45, v2
    s_lshl_b32 s46, s40, 2
    s_add_u32 s46, s46, s54
    s_lshl_b32 s46, s46, 18
    s_lshl_b32 s48, s41, 7
    s_add_u32 s46, s46, s48
    s_add_u32 s48, s46, 0x0
    buffer_load_dwordx4 a[64:67], v25, s[28:31], s48 offen
    s_add_u32 s48, s46, 0x4000
    buffer_load_dwordx4 a[80:83], v25, s[28:31], s48 offen
    s_add_u32 s48, s46, 0x8000
    buffer_load_dwordx4 a[96:99], v25, s[28:31], s48 offen
    s_add_u32 s48, s46, 0xc000
    buffer_load_dwordx4 a[112:115], v25, s[28:31], s48 offen
    s_add_u32 s48, s46, 0x10000
    buffer_load_dwordx4 a[68:71], v25, s[28:31], s48 offen
    s_add_u32 s48, s46, 0x14000
    buffer_load_dwordx4 a[84:87], v25, s[28:31], s48 offen
    s_add_u32 s48, s46, 0x18000
    buffer_load_dwordx4 a[100:103], v25, s[28:31], s48 offen
    s_add_u32 s48, s46, 0x1c000
    buffer_load_dwordx4 a[116:119], v25, s[28:31], s48 offen
    s_add_u32 s48, s46, 0x20000
    buffer_load_dwordx4 a[72:75], v25, s[28:31], s48 offen
    s_add_u32 s48, s46, 0x24000
    buffer_load_dwordx4 a[88:91], v25, s[28:31], s48 offen
    s_add_u32 s48, s46, 0x28000
    buffer_load_dwordx4 a[104:107], v25, s[28:31], s48 offen
    s_add_u32 s48, s46, 0x2c000
    buffer_load_dwordx4 a[120:123], v25, s[28:31], s48 offen
    s_add_u32 s48, s46, 0x30000
    buffer_load_dwordx4 a[76:79], v25, s[28:31], s48 offen
    s_add_u32 s48, s46, 0x34000
    buffer_load_dwordx4 a[92:95], v25, s[28:31], s48 offen
    s_add_u32 s48, s46, 0x38000
    buffer_load_dwordx4 a[108:111], v25, s[28:31], s48 offen
    s_add_u32 s48, s46, 0x3c000
    buffer_load_dwordx4 a[124:127], v25, s[28:31], s48 offen
    s_lshl_b32 s52, s40, 15
    s_lshl_b32 s53, s42, 11
    s_add_u32 s52, s52, s53
    s_lshl_b32 s53, s43, 9
    s_add_u32 s52, s52, s53
    s_lshl_b32 s53, s51, 8
    s_add_u32 s52, s52, s53
    s_add_u32 s52, s52, 0x7100000
    v_bfe_u32 v4, v1, 1, 1
    v_lshlrev_b32 v4, 7, v4
    v_lshl_add_u32 v4, v104, 4, v4
    v_and_b32 v5, 12, v100
    v_add_u32 v4, v4, v5
    v_add_u32 v4, s52, v4
    v_mov_b32 v26, -1
    s_lshl_b32 s52, s51, 5
    s_add_u32 s52, s52, 28160
    v_and_b32 v5, 14, v100
    v_lshlrev_b32 v5, 1, v5
    v_lshl_add_u32 v5, v104, 6, v5
    v_add_u32 v5, s52, v5
    s_lshl_b32 s52, s41, 13
    s_lshl_b32 s53, s54, 11
    s_add_u32 s52, s52, s53
    s_add_u32 s52, s52, 0x7800000
    v_lshlrev_b32 v6, 3, v101
    v_lshl_add_u32 v6, v106, 5, v6
    v_and_b32 v7, 3, v1
    v_lshlrev_b32 v7, 3, v7
    v_bfe_u32 v30, v1, 2, 3
    v_lshl_add_u32 v7, v30, 5, v7
    v_lshl_add_u32 v7, v103, 2, v7
    v_add_u32 v7, s52, v7
    s_lshl_b32 s53, s40, 8
    s_add_u32 s52, s52, s53
    v_add_u32 v6, s52, v6
    v_lshlrev_b32 v30, 4, v100
    v_lshl_add_u32 v30, v101, 17, v30
    v_add_u32 v30, s52, v30
    v_mov_b32 v32, -1
    v_mov_b32 v33, -1
    v_mov_b32 v34, -1
    v_mov_b32 v35, -1
    buffer_store_dwordx4 v[32:35], v30, s[12:15], 0 offen sc1
    s_lshl_b32 s55, s40, 16
    s_add_u32 s55, s55, 0x7000000
    s_lshl_b32 s52, s41, 10
    s_lshl_b32 s53, s54, 8
    s_add_u32 s52, s52, s53
    s_add_u32 s52, s52, s55
    v_lshlrev_b32 v8, 2, v1
    v_add_u32 v8, s52, v8
    s_lshl_b32 s53, s54, 12
    v_add_u32 v10, s53, v2
    v_add_u32 v9, s55, v10
    s_lshl_b32 s52, s40, 15
    s_lshl_b32 s53, s54, 11
    s_add_u32 s52, s52, s53
    s_add_u32 s52, s52, 0x7100000
    v_add_u32 v11, s52, v2
    s_lshl_b32 s52, s54, 9
    s_add_u32 s52, s52, 53248
    v_lshlrev_b32 v12, 4, v100
    v_lshl_add_u32 v12, v102, 3, v12
    v_lshl_add_u32 v12, v103, 8, v12
    v_add_u32 v12, s52, v12
    s_lshl_b32 s52, s51, 3
    s_add_u32 s52, s52, 49152
    v_add_u32 v13, s52, v2
    s_lshl_b32 s52, s54, 10
    s_add_u32 s52, s52, 49152
    v_add_u32 v14, s52, v2
    s_lshl_b32 s52, s40, 2
    s_add_u32 s52, s52, s54
    s_mul_i32 s52, s52, 24576
    s_add_u32 s52, s52, 0x2004000
    v_add_u32 v15, s52, v2
    s_lshl_b32 s52, s54, 10
    v_add_u32 v27, s52, v2
    v_lshlrev_b32 v30, 11, v106
    v_lshl_add_u32 v30, v101, 5, v30
    v_lshl_add_u32 v30, v107, 2, v30
    s_lshl_b32 s52, s54, 9
    buffer_load_dword v112, v30, s[32:35], s52 offen offset:0
    buffer_load_dword v113, v30, s[32:35], s52 offen offset:8
    buffer_load_dword v114, v30, s[32:35], s52 offen offset:16
    buffer_load_dword v115, v30, s[32:35], s52 offen offset:24
    buffer_load_dword v116, v30, s[32:35], s52 offen offset:128
    buffer_load_dword v117, v30, s[32:35], s52 offen offset:136
    buffer_load_dword v118, v30, s[32:35], s52 offen offset:144
    buffer_load_dword v119, v30, s[32:35], s52 offen offset:152
    buffer_load_dword v120, v30, s[32:35], s52 offen offset:256
    buffer_load_dword v121, v30, s[32:35], s52 offen offset:264
    buffer_load_dword v122, v30, s[32:35], s52 offen offset:272
    buffer_load_dword v123, v30, s[32:35], s52 offen offset:280
    buffer_load_dword v124, v30, s[32:35], s52 offen offset:384
    buffer_load_dword v125, v30, s[32:35], s52 offen offset:392
    buffer_load_dword v126, v30, s[32:35], s52 offen offset:400
    buffer_load_dword v127, v30, s[32:35], s52 offen offset:408
    s_lshl_b32 s46, s49, 8
    s_lshl_b32 s48, s43, 6
    s_add_u32 s46, s46, s48
    s_lshl_b32 s48, s54, 21
    s_add_u32 s46, s46, s48
    s_add_u32 s48, s46, 0x0
    buffer_load_dwordx4 a[0:3], v24, s[24:27], s48 offen
    s_add_u32 s48, s46, 0x20000
    buffer_load_dwordx4 a[32:35], v24, s[24:27], s48 offen
    s_add_u32 s48, s46, 0x40000
    buffer_load_dwordx4 a[4:7], v24, s[24:27], s48 offen
    s_add_u32 s48, s46, 0x60000
    buffer_load_dwordx4 a[36:39], v24, s[24:27], s48 offen
    s_add_u32 s48, s46, 0x80000
    buffer_load_dwordx4 a[8:11], v24, s[24:27], s48 offen
    s_add_u32 s48, s46, 0xa0000
    buffer_load_dwordx4 a[40:43], v24, s[24:27], s48 offen
    s_add_u32 s48, s46, 0xc0000
    buffer_load_dwordx4 a[12:15], v24, s[24:27], s48 offen
    s_add_u32 s48, s46, 0xe0000
    buffer_load_dwordx4 a[44:47], v24, s[24:27], s48 offen
    s_add_u32 s48, s46, 0x100000
    buffer_load_dwordx4 a[16:19], v24, s[24:27], s48 offen
    s_add_u32 s48, s46, 0x120000
    buffer_load_dwordx4 a[48:51], v24, s[24:27], s48 offen
    s_add_u32 s48, s46, 0x140000
    buffer_load_dwordx4 a[20:23], v24, s[24:27], s48 offen
    s_add_u32 s48, s46, 0x160000
    buffer_load_dwordx4 a[52:55], v24, s[24:27], s48 offen
    s_add_u32 s48, s46, 0x180000
    buffer_load_dwordx4 a[24:27], v24, s[24:27], s48 offen
    s_add_u32 s48, s46, 0x1a0000
    buffer_load_dwordx4 a[56:59], v24, s[24:27], s48 offen
    s_add_u32 s48, s46, 0x1c0000
    buffer_load_dwordx4 a[28:31], v24, s[24:27], s48 offen
    s_add_u32 s48, s46, 0x1e0000
    buffer_load_dwordx4 a[60:63], v24, s[24:27], s48 offen
    s_waitcnt vmcnt(16)
    ds_write_b128 v22, a[64:67] offset:0
    ds_write_b128 v22, a[80:83] offset:1024
    ds_write_b128 v22, a[96:99] offset:2048
    ds_write_b128 v22, a[112:115] offset:3072
    s_waitcnt lgkmcnt(0)
    ds_read_b64_tr_b16 a[64:65], v21 offset:0
    ds_read_b64_tr_b16 a[66:67], v21 offset:512
    ds_read_b64_tr_b16 a[80:81], v21 offset:32
    ds_read_b64_tr_b16 a[82:83], v21 offset:544
    ds_read_b64_tr_b16 a[96:97], v21 offset:64
    ds_read_b64_tr_b16 a[98:99], v21 offset:576
    ds_read_b64_tr_b16 a[112:113], v21 offset:96
    ds_read_b64_tr_b16 a[114:115], v21 offset:608
    s_waitcnt lgkmcnt(0)
    ds_write_b128 v22, a[68:71] offset:0
    ds_write_b128 v22, a[84:87] offset:1024
    ds_write_b128 v22, a[100:103] offset:2048
    ds_write_b128 v22, a[116:119] offset:3072
    s_waitcnt lgkmcnt(0)
    ds_read_b64_tr_b16 a[68:69], v21 offset:0
    ds_read_b64_tr_b16 a[70:71], v21 offset:512
    ds_read_b64_tr_b16 a[84:85], v21 offset:32
    ds_read_b64_tr_b16 a[86:87], v21 offset:544
    ds_read_b64_tr_b16 a[100:101], v21 offset:64
    ds_read_b64_tr_b16 a[102:103], v21 offset:576
    ds_read_b64_tr_b16 a[116:117], v21 offset:96
    ds_read_b64_tr_b16 a[118:119], v21 offset:608
    s_waitcnt lgkmcnt(0)
    ds_write_b128 v22, a[72:75] offset:0
    ds_write_b128 v22, a[88:91] offset:1024
    ds_write_b128 v22, a[104:107] offset:2048
    ds_write_b128 v22, a[120:123] offset:3072
    s_waitcnt lgkmcnt(0)
    ds_read_b64_tr_b16 a[72:73], v21 offset:0
    ds_read_b64_tr_b16 a[74:75], v21 offset:512
    ds_read_b64_tr_b16 a[88:89], v21 offset:32
    ds_read_b64_tr_b16 a[90:91], v21 offset:544
    ds_read_b64_tr_b16 a[104:105], v21 offset:64
    ds_read_b64_tr_b16 a[106:107], v21 offset:576
    ds_read_b64_tr_b16 a[120:121], v21 offset:96
    ds_read_b64_tr_b16 a[122:123], v21 offset:608
    s_waitcnt lgkmcnt(0)
    ds_write_b128 v22, a[76:79] offset:0
    ds_write_b128 v22, a[92:95] offset:1024
    ds_write_b128 v22, a[108:111] offset:2048
    ds_write_b128 v22, a[124:127] offset:3072
    s_waitcnt lgkmcnt(0)
    ds_read_b64_tr_b16 a[76:77], v21 offset:0
    ds_read_b64_tr_b16 a[78:79], v21 offset:512
    ds_read_b64_tr_b16 a[92:93], v21 offset:32
    ds_read_b64_tr_b16 a[94:95], v21 offset:544
    ds_read_b64_tr_b16 a[108:109], v21 offset:64
    ds_read_b64_tr_b16 a[110:111], v21 offset:576
    ds_read_b64_tr_b16 a[124:125], v21 offset:96
    ds_read_b64_tr_b16 a[126:127], v21 offset:608
    s_waitcnt lgkmcnt(0)
    s_barrier
    s_waitcnt vmcnt(0)
    ds_write_b128 v22, a[0:3] offset:0
    ds_write_b128 v22, a[32:35] offset:1024
    ds_write_b128 v22, a[4:7] offset:2048
    ds_write_b128 v22, a[36:39] offset:3072
    s_waitcnt lgkmcnt(0)
    ds_read_b64_tr_b16 a[0:1], v20 offset:0
    ds_read_b64_tr_b16 a[2:3], v20 offset:256
    ds_read_b64_tr_b16 a[32:33], v20 offset:32
    ds_read_b64_tr_b16 a[34:35], v20 offset:288
    ds_read_b64_tr_b16 a[4:5], v20 offset:2048
    ds_read_b64_tr_b16 a[6:7], v20 offset:2304
    ds_read_b64_tr_b16 a[36:37], v20 offset:2080
    ds_read_b64_tr_b16 a[38:39], v20 offset:2336
    s_waitcnt lgkmcnt(0)
    ds_write_b128 v22, a[8:11] offset:0
    ds_write_b128 v22, a[40:43] offset:1024
    ds_write_b128 v22, a[12:15] offset:2048
    ds_write_b128 v22, a[44:47] offset:3072
    s_waitcnt lgkmcnt(0)
    ds_read_b64_tr_b16 a[8:9], v20 offset:0
    ds_read_b64_tr_b16 a[10:11], v20 offset:256
    ds_read_b64_tr_b16 a[40:41], v20 offset:32
    ds_read_b64_tr_b16 a[42:43], v20 offset:288
    ds_read_b64_tr_b16 a[12:13], v20 offset:2048
    ds_read_b64_tr_b16 a[14:15], v20 offset:2304
    ds_read_b64_tr_b16 a[44:45], v20 offset:2080
    ds_read_b64_tr_b16 a[46:47], v20 offset:2336
    s_waitcnt lgkmcnt(0)
    ds_write_b128 v22, a[16:19] offset:0
    ds_write_b128 v22, a[48:51] offset:1024
    ds_write_b128 v22, a[20:23] offset:2048
    ds_write_b128 v22, a[52:55] offset:3072
    s_waitcnt lgkmcnt(0)
    ds_read_b64_tr_b16 a[16:17], v20 offset:0
    ds_read_b64_tr_b16 a[18:19], v20 offset:256
    ds_read_b64_tr_b16 a[48:49], v20 offset:32
    ds_read_b64_tr_b16 a[50:51], v20 offset:288
    ds_read_b64_tr_b16 a[20:21], v20 offset:2048
    ds_read_b64_tr_b16 a[22:23], v20 offset:2304
    ds_read_b64_tr_b16 a[52:53], v20 offset:2080
    ds_read_b64_tr_b16 a[54:55], v20 offset:2336
    s_waitcnt lgkmcnt(0)
    ds_write_b128 v22, a[24:27] offset:0
    ds_write_b128 v22, a[56:59] offset:1024
    ds_write_b128 v22, a[28:31] offset:2048
    ds_write_b128 v22, a[60:63] offset:3072
    s_waitcnt lgkmcnt(0)
    ds_read_b64_tr_b16 a[24:25], v20 offset:0
    ds_read_b64_tr_b16 a[26:27], v20 offset:256
    ds_read_b64_tr_b16 a[56:57], v20 offset:32
    ds_read_b64_tr_b16 a[58:59], v20 offset:288
    ds_read_b64_tr_b16 a[28:29], v20 offset:2048
    ds_read_b64_tr_b16 a[30:31], v20 offset:2304
    ds_read_b64_tr_b16 a[60:61], v20 offset:2080
    ds_read_b64_tr_b16 a[62:63], v20 offset:2336
    s_waitcnt lgkmcnt(0)
    s_mov_b32 s65, 0
    s_waitcnt vmcnt(0)
    s_barrier
    s_lshl_b32 s57, s40, 11
    s_lshl_b32 s53, s54, 7
    s_add_u32 s57, s57, s53
    s_add_u32 s57, s57, 0x10a600
    s_mov_b32 s69, 0
    s_mov_b32 s68, 1
    s_cmp_gt_u32 s69, s68
    s_cbranch_scc1 L_kv_ok_199
    s_mov_b32 s70, 0
L_kv_lp_198:
    v_and_b32 v22, 1, v1
    v_lshlrev_b32 v22, 9, v22
    buffer_load_dword v23, v22, s[12:15], s57 offen sc1
    s_waitcnt vmcnt(0)
    v_readlane_b32 s69, v23, 0
    v_readlane_b32 s45, v23, 1
    s_add_u32 s70, s70, 1
    s_nop 2
    s_min_u32 s69, s69, s45
    s_cmp_gt_u32 s69, s68
    s_cbranch_scc1 L_kv_ok_199
    s_sleep 4
    s_cmp_lt_u32 s70, 524288
    s_cbranch_scc1 L_kv_lp_198
    s_branch L_c_done_1
L_kv_ok_199:
    v_subrev_u32 v28, 8192, v15
    v_lshlrev_b32 v31, 4, v100
    v_lshl_add_u32 v31, v103, 8, v31
    v_add_u32 v31, 20480, v31
    s_lshl_b32 s52, s54, 11
    s_add_u32 s52, s52, 53248
    v_add_u32 v25, s52, v2
    v_mov_b32 v29, 26640
    v_mov_b32 v30, 0
    ds_write_b32 v29, v30
    v_mov_b32 v30, 1
    s_mov_b32 s58, 0
    s_mov_b32 s64, 0
    s_lshl_b32 s59, s54, 13
    s_add_u32 s59, s59, 65536
    s_add_u32 s46, s64, 4096
    s_add_u32 m0, s59, 0
    s_nop 0
    buffer_load_dwordx4 v28, s[12:15], s64 offen offset:0 sc1 lds
    buffer_load_dwordx4 v28, s[12:15], s64 offen offset:1024 sc1 lds
    buffer_load_dwordx4 v28, s[12:15], s64 offen offset:2048 sc1 lds
    buffer_load_dwordx4 v28, s[12:15], s64 offen offset:3072 sc1 lds
    s_add_u32 m0, s59, 4096
    s_nop 0
    buffer_load_dwordx4 v28, s[12:15], s46 offen offset:0 sc1 lds
    buffer_load_dwordx4 v28, s[12:15], s46 offen offset:1024 sc1 lds
    buffer_load_dwordx4 v28, s[12:15], s46 offen offset:2048 sc1 lds
    buffer_load_dwordx4 v28, s[12:15], s46 offen offset:3072 sc1 lds
    s_add_u32 s64, s64, 786432
    s_add_u32 s46, s65, 4096
    buffer_load_dwordx4 v[32:35], v15, s[12:15], s65 offen offset:0 sc1
    buffer_load_dwordx4 v[48:51], v15, s[12:15], s46 offen offset:0 sc1
    buffer_load_dwordx4 v[36:39], v15, s[12:15], s65 offen offset:1024 sc1
    buffer_load_dwordx4 v[52:55], v15, s[12:15], s46 offen offset:1024 sc1
    buffer_load_dwordx4 v[40:43], v15, s[12:15], s65 offen offset:2048 sc1
    buffer_load_dwordx4 v[56:59], v15, s[12:15], s46 offen offset:2048 sc1
    buffer_load_dwordx4 v[44:47], v15, s[12:15], s65 offen offset:3072 sc1
    buffer_load_dwordx4 v[60:63], v15, s[12:15], s46 offen offset:3072 sc1
    s_add_u32 s65, s65, 786432
    s_waitcnt vmcnt(0)
    v_mfma_f32_16x16x32_bf16 v[64:67], v[32:35], a[64:67], 0
    v_mfma_f32_16x16x32_bf16 v[68:71], v[48:51], a[64:67], 0
    v_mfma_f32_16x16x32_bf16 v[64:67], v[36:39], a[68:71], v[64:67]
    v_mfma_f32_16x16x32_bf16 v[68:71], v[52:55], a[68:71], v[68:71]
    v_mfma_f32_16x16x32_bf16 v[64:67], v[40:43], a[72:75], v[64:67]
    v_mfma_f32_16x16x32_bf16 v[68:71], v[56:59], a[72:75], v[68:71]
    v_mfma_f32_16x16x32_bf16 v[64:67], v[44:47], a[76:79], v[64:67]
    v_mfma_f32_16x16x32_bf16 v[68:71], v[60:63], a[76:79], v[68:71]
    v_mfma_f32_16x16x32_bf16 v[72:75], v[32:35], a[80:83], 0
    v_mfma_f32_16x16x32_bf16 v[76:79], v[48:51], a[80:83], 0
    v_mfma_f32_16x16x32_bf16 v[72:75], v[36:39], a[84:87], v[72:75]
    v_mfma_f32_16x16x32_bf16 v[76:79], v[52:55], a[84:87], v[76:79]
    v_mfma_f32_16x16x32_bf16 v[72:75], v[40:43], a[88:91], v[72:75]
    v_mfma_f32_16x16x32_bf16 v[76:79], v[56:59], a[88:91], v[76:79]
    v_mfma_f32_16x16x32_bf16 v[72:75], v[44:47], a[92:95], v[72:75]
    v_mfma_f32_16x16x32_bf16 v[76:79], v[60:63], a[92:95], v[76:79]
    v_cvt_pk_bf16_f32 v64, v64, v65
    v_cvt_pk_bf16_f32 v65, v66, v67
    v_cvt_pk_bf16_f32 v66, v68, v69
    v_cvt_pk_bf16_f32 v67, v70, v71
    ds_write_b128 v10, v[64:67] offset:32768
    v_mfma_f32_16x16x32_bf16 v[80:83], v[32:35], a[96:99], 0
    v_mfma_f32_16x16x32_bf16 v[84:87], v[48:51], a[96:99], 0
    v_mfma_f32_16x16x32_bf16 v[80:83], v[36:39], a[100:103], v[80:83]
    v_mfma_f32_16x16x32_bf16 v[84:87], v[52:55], a[100:103], v[84:87]
    v_mfma_f32_16x16x32_bf16 v[80:83], v[40:43], a[104:107], v[80:83]
    v_mfma_f32_16x16x32_bf16 v[84:87], v[56:59], a[104:107], v[84:87]
    v_mfma_f32_16x16x32_bf16 v[80:83], v[44:47], a[108:111], v[80:83]
    v_mfma_f32_16x16x32_bf16 v[84:87], v[60:63], a[108:111], v[84:87]
    v_cvt_pk_bf16_f32 v72, v72, v73
    v_cvt_pk_bf16_f32 v73, v74, v75
    v_cvt_pk_bf16_f32 v74, v76, v77
    v_cvt_pk_bf16_f32 v75, v78, v79
    ds_write_b128 v10, v[72:75] offset:33792
    v_mfma_f32_16x16x32_bf16 v[88:91], v[32:35], a[112:115], 0
    v_mfma_f32_16x16x32_bf16 v[92:95], v[48:51], a[112:115], 0
    v_mfma_f32_16x16x32_bf16 v[88:91], v[36:39], a[116:119], v[88:91]
    v_mfma_f32_16x16x32_bf16 v[92:95], v[52:55], a[116:119], v[92:95]
    v_mfma_f32_16x16x32_bf16 v[88:91], v[40:43], a[120:123], v[88:91]
    v_mfma_f32_16x16x32_bf16 v[92:95], v[56:59], a[120:123], v[92:95]
    v_mfma_f32_16x16x32_bf16 v[88:91], v[44:47], a[124:127], v[88:91]
    v_mfma_f32_16x16x32_bf16 v[92:95], v[60:63], a[124:127], v[92:95]
    v_cvt_pk_bf16_f32 v80, v80, v81
    v_cvt_pk_bf16_f32 v81, v82, v83
    v_cvt_pk_bf16_f32 v82, v84, v85
    v_cvt_pk_bf16_f32 v83, v86, v87
    ds_write_b128 v10, v[80:83] offset:34816
    s_nop 2
    v_cvt_pk_bf16_f32 v88, v88, v89
    v_cvt_pk_bf16_f32 v89, v90, v91
    v_cvt_pk_bf16_f32 v90, v92, v93
    v_cvt_pk_bf16_f32 v91, v94, v95
    ds_write_b128 v10, v[88:91] offset:35840
    s_mov_b32 s63, 0
    s_waitcnt lgkmcnt(0)
    v_min_u32 v64, -2, v112
    v_min_u32 v65, -2, v113
    v_min_u32 v66, -2, v114
    v_min_u32 v67, -2, v115
    v_min_u32 v68, -2, v116
    v_min_u32 v69, -2, v117
    v_min_u32 v70, -2, v118
    v_min_u32 v71, -2, v119
    v_min_u32 v72, -2, v120
    v_min_u32 v73, -2, v121
    v_min_u32 v74, -2, v122
    v_min_u32 v75, -2, v123
    v_min_u32 v76, -2, v124
    v_min_u32 v77, -2, v125
    v_min_u32 v78, -2, v126
    v_min_u32 v79, -2, v127
    v_mov_b32 v16, 0
    v_mov_b32 v17, 0
    v_mov_b32 v18, 0
    v_mov_b32 v19, 0
    v_mov_b32 v20, 0
    v_mov_b32 v21, 0
    v_mov_b32 v22, 0
    v_mov_b32 v23, 0
L_c_join_194:
    s_mov_b32 s60, 0
    s_mov_b32 s61, 0
    s_mov_b32 s62, 0
    s_cmp_lg_u32 s44, 0
    s_cbranch_scc1 L_c_nh_200
    v_lshlrev_b32 v17, 3, v1
    s_lshl_b32 s46, s40, 3
    v_mov_b32 v21, s46
    s_mov_b32 s45, 0x101000
    s_mov_b32 s70, 0
L_c_rp_201:
    buffer_load_dwordx2 v[18:19], v17, s[12:15], s45 offen sc1
    buffer_load_dwordx2 v[22:23], v21, s[12:15], s45 offen offset:512 sc1
    s_waitcnt vmcnt(0)
    v_min3_u32 v20, v18, v19, v22
    v_min_u32 v20, v20, v23
    v_cmp_eq_u32 vcc, 0, v20
    s_cbranch_vccnz L_rt_202
    v_cmp_eq_u32 s[52:53], v18, v16
    v_cmp_eq_u32 vcc, v19, v16
    v_cmp_eq_u32 s[54:55], v22, v16
    v_cmp_eq_u32 s[56:57], v23, v16
    s_lshl_b32 s46, s40, 3
    s_nop 3
    s_and_b64 s[52:53], s[52:53], vcc
    s_and_b64 s[52:53], s[52:53], s[54:55]
    s_and_b64 s[52:53], s[52:53], s[56:57]
    s_lshr_b64 s[52:53], s[52:53], s46
    s_and_b32 s52, s52, 0xff
    s_cmp_eq_u32 s52, 0xff
    s_cselect_b32 s52, 1, 0
    v_mov_b32 v16, s52
    v_mov_b32 v17, 26624
    ds_write_b32 v17, v16
L_c_nh_200:
    s_waitcnt lgkmcnt(0)
    s_barrier
    v_mov_b32 v17, 26624
    ds_read_b32 v16, v17
    s_waitcnt lgkmcnt(0)
    v_readfirstlane_b32 s52, v16
    s_nop 3
    s_cmp_ge_u32 s44, 4
    s_cbranch_scc1 L_vf_205
    s_mov_b32 s57, s58
    s_cmp_eq_u32 s52, 0
    s_cbranch_scc1 L_ss_204
.p2align 6
L_s_loop_207:
    v_mov_b32 v16, 0
    v_mov_b32 v17, 0
    v_mov_b32 v18, 0
    v_mov_b32 v19, 0
    s_barrier
    ds_read_b128 v[64:67], v2 offset:0
    ds_read_b128 v[68:71], v2 offset:1024
    ds_read_b128 v[72:75], v2 offset:2048
    ds_read_b128 v[76:79], v2 offset:3072
    ds_read_b128 v[80:83], v2 offset:4096
    ds_read_b128 v[84:87], v2 offset:5120
    ds_read_b128 v[88:91], v2 offset:6144
    ds_read_b128 v[92:95], v2 offset:7168
    ds_read_b128 v[96:99], v2 offset:8192
    ds_read_b128 v[100:103], v2 offset:9216
    ds_read_b128 v[104:107], v2 offset:10240
    ds_read_b128 v[108:111], v2 offset:11264
    s_waitcnt lgkmcnt(11)
    v_smfmac_f32_16x16x64_bf16 v[16:19], v[64:67], a[0:7], v3
    ds_read_b128 v[112:115], v2 offset:12288
    s_waitcnt lgkmcnt(11)
    v_smfmac_f32_16x16x64_bf16 v[16:19], v[68:71], a[8:15], v3
    ds_read_b128 v[116:119], v2 offset:13312
    s_waitcnt lgkmcnt(11)
    v_smfmac_f32_16x16x64_bf16 v[16:19], v[72:75], a[16:23], v3
    ds_read_b128 v[120:123], v2 offset:14336
    s_waitcnt lgkmcnt(11)
    v_smfmac_f32_16x16x64_bf16 v[16:19], v[76:79], a[24:31], v3
    ds_read_b128 v[124:127], v2 offset:15360
    s_waitcnt lgkmcnt(11)
    v_smfmac_f32_16x16x64_bf16 v[16:19], v[80:83], a[32:39], v3
    s_waitcnt lgkmcnt(10)
    v_smfmac_f32_16x16x64_bf16 v[16:19], v[84:87], a[40:47], v3
    s_waitcnt lgkmcnt(9)
    v_smfmac_f32_16x16x64_bf16 v[16:19], v[88:91], a[48:55], v3
    s_waitcnt lgkmcnt(8)
    v_smfmac_f32_16x16x64_bf16 v[16:19], v[92:95], a[56:63], v3
    s_waitcnt lgkmcnt(7)
    v_smfmac_f32_16x16x64_bf16 v[16:19], v[96:99], a[64:71], v3
    s_waitcnt lgkmcnt(6)
    v_smfmac_f32_16x16x64_bf16 v[16:19], v[100:103], a[72:79], v3
    s_waitcnt lgkmcnt(5)
    v_smfmac_f32_16x16x64_bf16 v[16:19], v[104:107], a[80:87], v3
    s_waitcnt lgkmcnt(4)
    v_smfmac_f32_16x16x64_bf16 v[16:19], v[108:111], a[88:95], v3
    s_waitcnt lgkmcnt(3)
    v_smfmac_f32_16x16x64_bf16 v[16:19], v[112:115], a[96:103], v3
    s_waitcnt lgkmcnt(2)
    v_smfmac_f32_16x16x64_bf16 v[16:19], v[116:119], a[104:111], v3
    s_waitcnt lgkmcnt(1)
    v_smfmac_f32_16x16x64_bf16 v[16:19], v[120:123], a[112:119], v3
    s_waitcnt lgkmcnt(0)
    v_smfmac_f32_16x16x64_bf16 v[16:19], v[124:127], a[120:127], v3
    s_nop 7
    v_permlane32_swap_b32 v16, v18
    v_permlane32_swap_b32 v17, v19
    v_add_f32 v16, v16, v18
    v_add_f32 v17, v17, v19
    s_mov_b32 vcc_lo, 0x55555555
    s_mov_b32 vcc_hi, 0x55555555
    v_cndmask_b32_dpp v18, v17, v16, vcc quad_perm:[1,0,3,2] row_mask:0xf bank_mask:0xf
    s_not_b64 vcc, vcc
    v_cndmask_b32_dpp v19, v16, v17, vcc quad_perm:[1,0,3,2] row_mask:0xf bank_mask:0xf
    v_cvt_pk_bf16_f32 v18, v18, v19
    v_min_u32 v18, -2, v18
    buffer_store_dword v18, v4, s[12:15], s61 offen
    ds_write_b32 v5, v18
    s_cmp_eq_u32 s60, 63
    s_cbranch_scc1 L_s_last_208
    ds_read_b128 v[32:35], v6 offset:0
    ds_read_b128 v[36:39], v6 offset:1024
    ds_read_b128 v[40:43], v6 offset:2048
    ds_read_b128 v[44:47], v6 offset:3072
    ds_read_b128 v[48:51], v6 offset:4096
    ds_read_b128 v[52:55], v6 offset:5120
    ds_read_b128 v[56:59], v6 offset:6144
    ds_read_b128 v[60:63], v6 offset:7168
    s_sleep 4
    s_mov_b32 s70, 1
    buffer_load_dwordx4 v[64:67], v7, s[12:15], s61 offen offset:0 sc1
    buffer_load_dwordx4 v[68:71], v7, s[12:15], s61 offen offset:1024 sc1
    buffer_load_dwordx4 v[72:75], v7, s[12:15], s61 offen offset:2048 sc1
    buffer_load_dwordx4 v[76:79], v7, s[12:15], s61 offen offset:3072 sc1
L_s_xm_210:
    s_waitcnt lgkmcnt(0)
    s_waitcnt vmcnt(3)
    v_mfma_f32_16x16x32_bf16 v[20:23], v[48:51], v[64:67], 0
    v_mfma_f32_16x16x32_bf16 v[16:19], v[32:35], v[64:67], 0
    v_mfma_f32_16x16x32_bf16 v[24:27], v[64:67], v[64:67], v[28:31]
    v_max3_u32 v10, v64, v64, v65
    v_max3_u32 v10, v10, v66, v67
    s_waitcnt vmcnt(2)
    v_mfma_f32_16x16x32_bf16 v[20:23], v[52:55], v[68:71], v[20:23]
    v_mfma_f32_16x16x32_bf16 v[16:19], v[36:39], v[68:71], v[16:19]
    v_mfma_f32_16x16x32_bf16 v[24:27], v[68:71], v[68:71], v[24:27]
    v_max3_u32 v10, v10, v68, v69
    v_max3_u32 v10, v10, v70, v71
    s_waitcnt vmcnt(1)
    v_mfma_f32_16x16x32_bf16 v[20:23], v[56:59], v[72:75], v[20:23]
    v_mfma_f32_16x16x32_bf16 v[16:19], v[40:43], v[72:75], v[16:19]
    v_mfma_f32_16x16x32_bf16 v[24:27], v[72:75], v[72:75], v[24:27]
    v_max3_u32 v10, v10, v72, v73
    v_max3_u32 v10, v10, v74, v75
    s_waitcnt vmcnt(0)
    v_mfma_f32_16x16x32_bf16 v[20:23], v[60:63], v[76:79], v[20:23]
    v_mfma_f32_16x16x32_bf16 v[16:19], v[44:47], v[76:79], v[16:19]
    v_mfma_f32_16x16x32_bf16 v[24:27], v[76:79], v[76:79], v[24:27]
    v_max3_u32 v10, v10, v76, v77
    v_max3_u32 v10, v10, v78, v79
    v_cmp_eq_u32 vcc, -1, v10
    s_nop 2
    s_cbranch_vccnz L_rt_211
    v_mov_b32_dpp v16, v20 row_ror:8 row_mask:0xf bank_mask:0xc
    v_mov_b32_dpp v17, v21 row_ror:8 row_mask:0xf bank_mask:0xc
    v_mov_b32_dpp v18, v22 row_ror:8 row_mask:0xf bank_mask:0xc
    v_mov_b32_dpp v19, v23 row_ror:8 row_mask:0xf bank_mask:0xc
    v_mov_b32_dpp v24, v26 row_ror:8 row_mask:0xf bank_mask:0xc
    v_mov_b32_dpp v25, v27 row_ror:8 row_mask:0xf bank_mask:0xc
    v_max3_f32 v10, v16, v17, v18
    v_max3_f32 v10, v10, v19, v24
    v_max_f32 v10, v10, v25
    s_nop 1
    v_max_f32_dpp v11, v10, v10 row_ror:8 row_mask:0xf bank_mask:0xf
    v_max_f32_dpp v10, v10, v10 row_ror:8 row_mask:0xf bank_mask:0xf
    s_nop 1
    v_permlane16_swap_b32 v10, v11
    v_max_f32 v12, v10, v11
    v_max_f32 v10, v10, v11
    s_nop 1
    v_permlane32_swap_b32 v10, v12
    v_max_f32 v10, v10, v12
    v_mul_f32 v10, s66, v10
    v_fma_f32 v16, v16, s66, -v10
    v_fma_f32 v17, v17, s66, -v10
    v_fma_f32 v18, v18, s66, -v10
    v_fma_f32 v19, v19, s66, -v10
    v_fma_f32 v24, v24, s66, -v10
    v_fma_f32 v25, v25, s66, -v10
    v_exp_f32 v16, v16
    v_exp_f32 v17, v17
    v_exp_f32 v18, v18
    v_exp_f32 v19, v19
    v_exp_f32 v24, v24
    v_exp_f32 v25, v25
    v_add_f32 v10, v16, v17
    v_add_f32 v11, v18, v19
    v_add_f32 v10, v10, v24
    v_add_f32 v11, v11, v25
    v_add_f32 v10, v10, v11
    s_nop 1
    v_add_f32_dpp v11, v10, v10 row_ror:8 row_mask:0xf bank_mask:0xf
    v_add_f32_dpp v10, v10, v10 row_ror:8 row_mask:0xf bank_mask:0xf
    s_nop 1
    v_permlane16_swap_b32 v10, v11
    v_add_f32 v12, v10, v11
    v_add_f32 v10, v10, v11
    s_nop 1
    v_permlane32_swap_b32 v10, v12
    v_add_f32 v10, v10, v12
    v_rcp_f32 v10, v10
    s_nop 0
    v_mul_f32 v16, v16, v10
    v_mul_f32 v17, v17, v10
    v_mul_f32 v18, v18, v10
    v_mul_f32 v19, v19, v10
    v_mul_f32 v24, v24, v10
    v_mul_f32 v25, v25, v10
    v_cvt_pk_bf16_f32 v16, v16, v17
    v_cvt_pk_bf16_f32 v17, v18, v19
    v_cvt_pk_bf16_f32 v18, v24, v25
    ds_write_b64 v8, v[16:17]
    ds_write_b32 v9, v18
    s_waitcnt lgkmcnt(0)
    s_barrier
    s_add_u32 s63, s63, 786432
    s_sleep 4
    s_xor_b32 s45, s61, 0x8000
    buffer_store_dword v13, v4, s[12:15], s45 offen
    s_cmp_lg_u32 s44, 0
    s_cbranch_scc1 L_s_np_212
    ds_read_b128 v[20:23], v2 offset:27648
    s_lshl_b32 s45, s60, 17
    s_add_u32 s45, s45, s67
    s_waitcnt lgkmcnt(0)
    buffer_store_dwordx4 v[20:23], v2, s[12:15], s45 offen
L_s_np_212:
    s_add_u32 s68, s60, 2
    s_min_u32 s68, s68, 63
    s_cmp_gt_u32 s69, s68
    s_cbranch_scc1 L_kv_ok_214
    s_mov_b32 s70, 0
L_kv_lp_213:
    v_and_b32 v22, 1, v1
    v_lshlrev_b32 v22, 9, v22
    buffer_load_dword v23, v22, s[12:15], s57 offen sc1
    s_waitcnt vmcnt(0)
    v_readlane_b32 s69, v23, 0
    v_readlane_b32 s45, v23, 1
    s_add_u32 s70, s70, 1
    s_nop 2
    s_min_u32 s69, s69, s45
    s_cmp_gt_u32 s69, s68
    s_cbranch_scc1 L_kv_ok_214
    s_sleep 4
    s_cmp_lt_u32 s70, 524288
    s_cbranch_scc1 L_kv_lp_213
    s_branch L_c_done_1
L_kv_ok_214:
    s_add_u32 s60, s60, 1
    s_add_u32 s61, s61, 0x4000
    s_and_b32 s61, s61, 0xffff
    s_branch L_s_loop_207
L_s_last_208:
    s_waitcnt lgkmcnt(0)
    s_barrier
    s_cmp_lg_u32 s44, 0
    s_cbranch_scc1 L_s_np_215
    ds_read_b128 v[20:23], v2 offset:27648
    s_lshl_b32 s45, s60, 17
    s_add_u32 s45, s45, s67
    s_waitcnt lgkmcnt(0)
    buffer_store_dwordx4 v[20:23], v2, s[12:15], s45 offen
L_s_np_215:
    s_branch L_c_done_1
L_rt_202:
    s_add_u32 s70, s70, 1
    s_cmp_lt_u32 s70, 524288
    s_cbranch_scc1 L_c_rp_201
    s_branch L_c_done_1
L_s_xp_209:
    buffer_load_dwordx4 v[64:67], v7, s[12:15], s61 offen offset:0 sc1
    buffer_load_dwordx4 v[68:71], v7, s[12:15], s61 offen offset:1024 sc1
    buffer_load_dwordx4 v[72:75], v7, s[12:15], s61 offen offset:2048 sc1
    buffer_load_dwordx4 v[76:79], v7, s[12:15], s61 offen offset:3072 sc1
    s_branch L_s_xm_210
L_rt_211:
    s_add_u32 s70, s70, 1
    s_cmp_lt_u32 s70, 524288
    s_cbranch_scc1 L_s_xp_209
    s_branch L_c_done_1
L_ss_204:
.p2align 6
L_s_loop_216:
    v_mov_b32 v16, 0
    v_mov_b32 v17, 0
    v_mov_b32 v18, 0
    v_mov_b32 v19, 0
    s_barrier
    ds_read_b128 v[64:67], v2 offset:0
    ds_read_b128 v[68:71], v2 offset:1024
    ds_read_b128 v[72:75], v2 offset:2048
    ds_read_b128 v[76:79], v2 offset:3072
    ds_read_b128 v[80:83], v2 offset:4096
    ds_read_b128 v[84:87], v2 offset:5120
    ds_read_b128 v[88:91], v2 offset:6144
    ds_read_b128 v[92:95], v2 offset:7168
    ds_read_b128 v[96:99], v2 offset:8192
    ds_read_b128 v[100:103], v2 offset:9216
    ds_read_b128 v[104:107], v2 offset:10240
    ds_read_b128 v[108:111], v2 offset:11264
    s_waitcnt lgkmcnt(11)
    v_smfmac_f32_16x16x64_bf16 v[16:19], v[64:67], a[0:7], v3
    ds_read_b128 v[112:115], v2 offset:12288
    s_waitcnt lgkmcnt(11)
    v_smfmac_f32_16x16x64_bf16 v[16:19], v[68:71], a[8:15], v3
    ds_read_b128 v[116:119], v2 offset:13312
    s_waitcnt lgkmcnt(11)
    v_smfmac_f32_16x16x64_bf16 v[16:19], v[72:75], a[16:23], v3
    ds_read_b128 v[120:123], v2 offset:14336
    s_waitcnt lgkmcnt(11)
    v_smfmac_f32_16x16x64_bf16 v[16:19], v[76:79], a[24:31], v3
    ds_read_b128 v[124:127], v2 offset:15360
    s_waitcnt lgkmcnt(11)
    v_smfmac_f32_16x16x64_bf16 v[16:19], v[80:83], a[32:39], v3
    s_waitcnt lgkmcnt(10)
    v_smfmac_f32_16x16x64_bf16 v[16:19], v[84:87], a[40:47], v3
    s_waitcnt lgkmcnt(9)
    v_smfmac_f32_16x16x64_bf16 v[16:19], v[88:91], a[48:55], v3
    s_waitcnt lgkmcnt(8)
    v_smfmac_f32_16x16x64_bf16 v[16:19], v[92:95], a[56:63], v3
    s_waitcnt lgkmcnt(7)
    v_smfmac_f32_16x16x64_bf16 v[16:19], v[96:99], a[64:71], v3
    s_waitcnt lgkmcnt(6)
    v_smfmac_f32_16x16x64_bf16 v[16:19], v[100:103], a[72:79], v3
    s_waitcnt lgkmcnt(5)
    v_smfmac_f32_16x16x64_bf16 v[16:19], v[104:107], a[80:87], v3
    s_waitcnt lgkmcnt(4)
    v_smfmac_f32_16x16x64_bf16 v[16:19], v[108:111], a[88:95], v3
    s_waitcnt lgkmcnt(3)
    v_smfmac_f32_16x16x64_bf16 v[16:19], v[112:115], a[96:103], v3
    s_waitcnt lgkmcnt(2)
    v_smfmac_f32_16x16x64_bf16 v[16:19], v[116:119], a[104:111], v3
    s_waitcnt lgkmcnt(1)
    v_smfmac_f32_16x16x64_bf16 v[16:19], v[120:123], a[112:119], v3
    s_waitcnt lgkmcnt(0)
    v_smfmac_f32_16x16x64_bf16 v[16:19], v[124:127], a[120:127], v3
    s_nop 7
    v_permlane32_swap_b32 v16, v18
    v_permlane32_swap_b32 v17, v19
    v_add_f32 v16, v16, v18
    v_add_f32 v17, v17, v19
    s_mov_b32 vcc_lo, 0x55555555
    s_mov_b32 vcc_hi, 0x55555555
    v_cndmask_b32_dpp v18, v17, v16, vcc quad_perm:[1,0,3,2] row_mask:0xf bank_mask:0xf
    s_not_b64 vcc, vcc
    v_cndmask_b32_dpp v19, v16, v17, vcc quad_perm:[1,0,3,2] row_mask:0xf bank_mask:0xf
    v_cvt_pk_bf16_f32 v18, v18, v19
    v_min_u32 v18, -2, v18
    buffer_store_dword v18, v4, s[12:15], s61 offen sc1
    ds_write_b32 v5, v18
    s_cmp_eq_u32 s60, 63
    s_cbranch_scc1 L_s_last_217
    ds_read_b128 v[32:35], v6 offset:0
    ds_read_b128 v[36:39], v6 offset:1024
    ds_read_b128 v[40:43], v6 offset:2048
    ds_read_b128 v[44:47], v6 offset:3072
    ds_read_b128 v[48:51], v6 offset:4096
    ds_read_b128 v[52:55], v6 offset:5120
    ds_read_b128 v[56:59], v6 offset:6144
    ds_read_b128 v[60:63], v6 offset:7168
    s_sleep 4
    s_mov_b32 s70, 1
    buffer_load_dwordx4 v[64:67], v7, s[12:15], s61 offen offset:0 sc1
    buffer_load_dwordx4 v[68:71], v7, s[12:15], s61 offen offset:1024 sc1
    buffer_load_dwordx4 v[72:75], v7, s[12:15], s61 offen offset:2048 sc1
    buffer_load_dwordx4 v[76:79], v7, s[12:15], s61 offen offset:3072 sc1
L_s_xm_219:
    s_waitcnt lgkmcnt(0)
    s_waitcnt vmcnt(3)
    v_mfma_f32_16x16x32_bf16 v[20:23], v[48:51], v[64:67], 0
    v_mfma_f32_16x16x32_bf16 v[16:19], v[32:35], v[64:67], 0
    v_mfma_f32_16x16x32_bf16 v[24:27], v[64:67], v[64:67], v[28:31]
    v_max3_u32 v10, v64, v64, v65
    v_max3_u32 v10, v10, v66, v67
    s_waitcnt vmcnt(2)
    v_mfma_f32_16x16x32_bf16 v[20:23], v[52:55], v[68:71], v[20:23]
    v_mfma_f32_16x16x32_bf16 v[16:19], v[36:39], v[68:71], v[16:19]
    v_mfma_f32_16x16x32_bf16 v[24:27], v[68:71], v[68:71], v[24:27]
    v_max3_u32 v10, v10, v68, v69
    v_max3_u32 v10, v10, v70, v71
    s_waitcnt vmcnt(1)
    v_mfma_f32_16x16x32_bf16 v[20:23], v[56:59], v[72:75], v[20:23]
    v_mfma_f32_16x16x32_bf16 v[16:19], v[40:43], v[72:75], v[16:19]
    v_mfma_f32_16x16x32_bf16 v[24:27], v[72:75], v[72:75], v[24:27]
    v_max3_u32 v10, v10, v72, v73
    v_max3_u32 v10, v10, v74, v75
    s_waitcnt vmcnt(0)
    v_mfma_f32_16x16x32_bf16 v[20:23], v[60:63], v[76:79], v[20:23]
    v_mfma_f32_16x16x32_bf16 v[16:19], v[44:47], v[76:79], v[16:19]
    v_mfma_f32_16x16x32_bf16 v[24:27], v[76:79], v[76:79], v[24:27]
    v_max3_u32 v10, v10, v76, v77
    v_max3_u32 v10, v10, v78, v79
    v_cmp_eq_u32 vcc, -1, v10
    s_nop 2
    s_cbranch_vccnz L_rt_220
    v_mov_b32_dpp v16, v20 row_ror:8 row_mask:0xf bank_mask:0xc
    v_mov_b32_dpp v17, v21 row_ror:8 row_mask:0xf bank_mask:0xc
    v_mov_b32_dpp v18, v22 row_ror:8 row_mask:0xf bank_mask:0xc
    v_mov_b32_dpp v19, v23 row_ror:8 row_mask:0xf bank_mask:0xc
    v_mov_b32_dpp v24, v26 row_ror:8 row_mask:0xf bank_mask:0xc
    v_mov_b32_dpp v25, v27 row_ror:8 row_mask:0xf bank_mask:0xc
    v_max3_f32 v10, v16, v17, v18
    v_max3_f32 v10, v10, v19, v24
    v_max_f32 v10, v10, v25
    s_nop 1
    v_max_f32_dpp v11, v10, v10 row_ror:8 row_mask:0xf bank_mask:0xf
    v_max_f32_dpp v10, v10, v10 row_ror:8 row_mask:0xf bank_mask:0xf
    s_nop 1
    v_permlane16_swap_b32 v10, v11
    v_max_f32 v12, v10, v11
    v_max_f32 v10, v10, v11
    s_nop 1
    v_permlane32_swap_b32 v10, v12
    v_max_f32 v10, v10, v12
    v_mul_f32 v10, s66, v10
    v_fma_f32 v16, v16, s66, -v10
    v_fma_f32 v17, v17, s66, -v10
    v_fma_f32 v18, v18, s66, -v10
    v_fma_f32 v19, v19, s66, -v10
    v_fma_f32 v24, v24, s66, -v10
    v_fma_f32 v25, v25, s66, -v10
    v_exp_f32 v16, v16
    v_exp_f32 v17, v17
    v_exp_f32 v18, v18
    v_exp_f32 v19, v19
    v_exp_f32 v24, v24
    v_exp_f32 v25, v25
    v_add_f32 v10, v16, v17
    v_add_f32 v11, v18, v19
    v_add_f32 v10, v10, v24
    v_add_f32 v11, v11, v25
    v_add_f32 v10, v10, v11
    s_nop 1
    v_add_f32_dpp v11, v10, v10 row_ror:8 row_mask:0xf bank_mask:0xf
    v_add_f32_dpp v10, v10, v10 row_ror:8 row_mask:0xf bank_mask:0xf
    s_nop 1
    v_permlane16_swap_b32 v10, v11
    v_add_f32 v12, v10, v11
    v_add_f32 v10, v10, v11
    s_nop 1
    v_permlane32_swap_b32 v10, v12
    v_add_f32 v10, v10, v12
    v_rcp_f32 v10, v10
    s_nop 0
    v_mul_f32 v16, v16, v10
    v_mul_f32 v17, v17, v10
    v_mul_f32 v18, v18, v10
    v_mul_f32 v19, v19, v10
    v_mul_f32 v24, v24, v10
    v_mul_f32 v25, v25, v10
    v_cvt_pk_bf16_f32 v16, v16, v17
    v_cvt_pk_bf16_f32 v17, v18, v19
    v_cvt_pk_bf16_f32 v18, v24, v25
    ds_write_b64 v8, v[16:17]
    ds_write_b32 v9, v18
    s_waitcnt lgkmcnt(0)
    s_barrier
    s_add_u32 s63, s63, 786432
    s_sleep 4
    s_xor_b32 s45, s61, 0x8000
    buffer_store_dword v13, v4, s[12:15], s45 offen sc1
    s_cmp_lg_u32 s44, 0
    s_cbranch_scc1 L_s_np_221
    ds_read_b128 v[20:23], v2 offset:27648
    s_lshl_b32 s45, s60, 17
    s_add_u32 s45, s45, s67
    s_waitcnt lgkmcnt(0)
    buffer_store_dwordx4 v[20:23], v2, s[12:15], s45 offen sc1
L_s_np_221:
    s_add_u32 s68, s60, 2
    s_min_u32 s68, s68, 63
    s_cmp_gt_u32 s69, s68
    s_cbranch_scc1 L_kv_ok_223
    s_mov_b32 s70, 0
L_kv_lp_222:
    v_and_b32 v22, 1, v1
    v_lshlrev_b32 v22, 9, v22
    buffer_load_dword v23, v22, s[12:15], s57 offen sc1
    s_waitcnt vmcnt(0)
    v_readlane_b32 s69, v23, 0
    v_readlane_b32 s45, v23, 1
    s_add_u32 s70, s70, 1
    s_nop 2
    s_min_u32 s69, s69, s45
    s_cmp_gt_u32 s69, s68
    s_cbranch_scc1 L_kv_ok_223
    s_sleep 4
    s_cmp_lt_u32 s70, 524288
    s_cbranch_scc1 L_kv_lp_222
    s_branch L_c_done_1
L_kv_ok_223:
    s_add_u32 s60, s60, 1
    s_add_u32 s61, s61, 0x4000
    s_and_b32 s61, s61, 0xffff
    s_branch L_s_loop_216
L_s_last_217:
    s_waitcnt lgkmcnt(0)
    s_barrier
    s_cmp_lg_u32 s44, 0
    s_cbranch_scc1 L_s_np_224
    ds_read_b128 v[20:23], v2 offset:27648
    s_lshl_b32 s45, s60, 17
    s_add_u32 s45, s45, s67
    s_waitcnt lgkmcnt(0)
    buffer_store_dwordx4 v[20:23], v2, s[12:15], s45 offen sc1
L_s_np_224:
    s_branch L_c_done_1
L_s_xp_218:
    buffer_load_dwordx4 v[64:67], v7, s[12:15], s61 offen offset:0 sc1
    buffer_load_dwordx4 v[68:71], v7, s[12:15], s61 offen offset:1024 sc1
    buffer_load_dwordx4 v[72:75], v7, s[12:15], s61 offen offset:2048 sc1
    buffer_load_dwordx4 v[76:79], v7, s[12:15], s61 offen offset:3072 sc1
    s_branch L_s_xm_219
L_rt_220:
    s_add_u32 s70, s70, 1
    s_cmp_lt_u32 s70, 524288
    s_cbranch_scc1 L_s_xp_218
    s_branch L_c_done_1
L_vf_205:
    s_cmp_eq_u32 s52, 0
    s_cbranch_scc1 L_vs_206
    s_mov_b32 s70, 1
    v_mov_b32 v16, 0
    v_mov_b32 v17, 0
    s_branch L_v_l1m_227
.p2align 6
L_v_loop_225:
    s_mov_b32 s70, 1
    buffer_load_dwordx4 v[64:67], v9, s[12:15], s61 offen offset:0 sc1
    buffer_load_dwordx4 v[68:71], v9, s[12:15], s61 offen offset:1024 sc1
    buffer_load_dwordx4 v[72:75], v9, s[12:15], s61 offen offset:2048 sc1
    buffer_load_dwordx4 v[76:79], v9, s[12:15], s61 offen offset:3072 sc1
    v_mov_b32 v16, 0
    v_mov_b32 v17, 0
    v_mov_b32 v18, 0
    v_mov_b32 v19, 0
    v_mov_b32 v20, 0
    v_mov_b32 v21, 0
    v_mov_b32 v22, 0
    v_mov_b32 v23, 0
L_v_l1m_227:
    s_waitcnt vmcnt(3)
    ds_write_b128 v10, v[64:67] offset:0
    v_max3_u32 v24, v64, v65, v66
    v_max_u32 v24, v24, v67
    v_cmp_eq_u32 s[48:49], -1, v24
    s_waitcnt vmcnt(2)
    ds_write_b128 v10, v[68:71] offset:1024
    v_max3_u32 v24, v68, v69, v70
    v_max_u32 v24, v24, v71
    v_cmp_eq_u32 s[50:51], -1, v24
    s_waitcnt vmcnt(1)
    ds_write_b128 v10, v[72:75] offset:2048
    v_max3_u32 v24, v72, v73, v74
    v_max_u32 v24, v24, v75
    v_cmp_eq_u32 s[52:53], -1, v24
    s_waitcnt vmcnt(0)
    ds_write_b128 v10, v[76:79] offset:3072
    v_max3_u32 v24, v76, v77, v78
    v_max_u32 v24, v24, v79
    v_cmp_eq_u32 s[54:55], -1, v24
    s_or_b64 s[46:47], s[48:49], s[50:51]
    s_or_b64 vcc, s[52:53], s[54:55]
    s_or_b64 vcc, vcc, s[46:47]
    s_cbranch_scc1 L_v_l1_226
L_v_l1ok_228:
    s_waitcnt lgkmcnt(0)
    s_barrier
    v_smfmac_f32_16x16x64_bf16 v[16:19], v[64:67], a[0:7], v3
    v_smfmac_f32_16x16x64_bf16 v[20:23], v[64:67], a[32:39], v3
    v_smfmac_f32_16x16x64_bf16 v[16:19], v[68:71], a[8:15], v3
    v_smfmac_f32_16x16x64_bf16 v[20:23], v[68:71], a[40:47], v3
    v_smfmac_f32_16x16x64_bf16 v[16:19], v[72:75], a[16:23], v3
    v_smfmac_f32_16x16x64_bf16 v[20:23], v[72:75], a[48:55], v3
    v_smfmac_f32_16x16x64_bf16 v[16:19], v[76:79], a[24:31], v3
    v_smfmac_f32_16x16x64_bf16 v[20:23], v[76:79], a[56:63], v3
    s_nop 6
    v_permlane32_swap_b32 v16, v18
    v_permlane32_swap_b32 v17, v19
    v_permlane32_swap_b32 v20, v22
    v_permlane32_swap_b32 v21, v23
    v_add_f32 v16, v16, v18
    v_add_f32 v17, v17, v19
    v_add_f32 v18, v20, v22
    v_add_f32 v19, v21, v23
    ds_write_b128 v14, v[16:19]
    s_mov_b64 exec, 1
    ds_add_u32 v29, v30
    s_mov_b64 exec, -1
    s_add_u32 s58, s58, 4
    s_bitcmp1_b32 s44, 0
    s_cbranch_scc1 L_v_k1_230
    s_mov_b32 s70, 0
L_v_rl_231:
    ds_read_b32 v24, v29
    ds_read_b64 v[16:17], v13 offset:0
    ds_read_b64 v[18:19], v13 offset:1024
    ds_read_b64 v[20:21], v13 offset:2048
    ds_read_b64 v[22:23], v13 offset:3072
    s_waitcnt lgkmcnt(2)
    v_cmp_ne_u32 vcc, s58, v24
    v_add_f32 v16, v16, v18
    v_add_f32 v17, v17, v19
    s_waitcnt lgkmcnt(0)
    s_cbranch_vccnz L_rt_232
    v_add_f32 v20, v20, v22
    v_add_f32 v21, v21, v23
    v_add_f32 v16, v16, v20
    v_add_f32 v17, v17, v21
    s_mov_b32 vcc_lo, 0x55555555
    s_mov_b32 vcc_hi, 0x55555555
    v_cndmask_b32_dpp v18, v17, v16, vcc quad_perm:[1,0,3,2] row_mask:0xf bank_mask:0xf
    s_not_b64 vcc, vcc
    v_cndmask_b32_dpp v19, v16, v17, vcc quad_perm:[1,0,3,2] row_mask:0xf bank_mask:0xf
    v_cvt_pk_bf16_f32 v18, v18, v19
    v_min_u32 v18, -2, v18
    buffer_store_dword v18, v4, s[12:15], s62 offen
    ds_write_b32 v5, v18
L_v_k1_230:
    s_cmp_eq_u32 s60, 63
    s_cbranch_scc1 L_v_last_229
    ds_read_b128 v[80:83], v27 offset:32768
    ds_read_b128 v[84:87], v27 offset:36864
    ds_read_b128 v[88:91], v27 offset:40960
    ds_read_b128 v[92:95], v27 offset:45056
    v_mov_b32 v96, 0
    v_mov_b32 v97, 0
    v_mov_b32 v98, 0
    v_mov_b32 v99, 0
    v_mov_b32 v100, 0
    v_mov_b32 v101, 0
    v_mov_b32 v102, 0
    v_mov_b32 v103, 0
    v_mov_b32 v104, 0
    v_mov_b32 v105, 0
    v_mov_b32 v106, 0
    v_mov_b32 v107, 0
    v_mov_b32 v108, 0
    v_mov_b32 v109, 0
    v_mov_b32 v110, 0
    v_mov_b32 v111, 0
    s_bitcmp1_b32 s44, 0
    s_cbranch_scc0 L_v_sv_233
    s_sleep 3
L_v_sv_233:
    s_sleep 2
    s_mov_b32 s70, 1
L_v_vp_234:
    buffer_load_dwordx4 v[64:67], v11, s[12:15], s62 offen offset:0 sc1
    buffer_load_dwordx4 v[68:71], v11, s[12:15], s62 offen offset:1024 sc1
    s_waitcnt vmcnt(0)
    v_max3_u32 v20, v64, v65, v66
    v_max3_u32 v20, v20, v67, v68
    v_max3_u32 v20, v20, v69, v70
    v_max_u32 v20, v20, v71
    v_cmp_eq_u32 vcc, -1, v20
    s_cbranch_vccnz L_rt_235
    v_smfmac_f32_16x16x64_bf16 v[96:99], v[64:67], a[64:71], v3
    v_smfmac_f32_16x16x64_bf16 v[96:99], v[68:71], a[72:79], v3
    v_smfmac_f32_16x16x64_bf16 v[100:103], v[64:67], a[80:87], v3
    v_smfmac_f32_16x16x64_bf16 v[100:103], v[68:71], a[88:95], v3
    v_smfmac_f32_16x16x64_bf16 v[104:107], v[64:67], a[96:103], v3
    v_smfmac_f32_16x16x64_bf16 v[104:107], v[68:71], a[104:111], v3
    v_smfmac_f32_16x16x64_bf16 v[108:111], v[64:67], a[112:119], v3
    v_smfmac_f32_16x16x64_bf16 v[108:111], v[68:71], a[120:127], v3
    s_add_u32 s46, s65, 4096
    buffer_load_dwordx4 v[32:35], v15, s[12:15], s65 offen offset:0 sc1
    buffer_load_dwordx4 v[48:51], v15, s[12:15], s46 offen offset:0 sc1
    buffer_load_dwordx4 v[36:39], v15, s[12:15], s65 offen offset:1024 sc1
    buffer_load_dwordx4 v[52:55], v15, s[12:15], s46 offen offset:1024 sc1
    buffer_load_dwordx4 v[40:43], v15, s[12:15], s65 offen offset:2048 sc1
    buffer_load_dwordx4 v[56:59], v15, s[12:15], s46 offen offset:2048 sc1
    buffer_load_dwordx4 v[44:47], v15, s[12:15], s65 offen offset:3072 sc1
    buffer_load_dwordx4 v[60:63], v15, s[12:15], s46 offen offset:3072 sc1
    s_add_u32 s65, s65, 786432
    v_cvt_pk_bf16_f32 v96, v96, v97
    v_cvt_pk_bf16_f32 v97, v98, v99
    ds_write_b64 v12, v[96:97] offset:0
    v_cvt_pk_bf16_f32 v100, v100, v101
    v_cvt_pk_bf16_f32 v101, v102, v103
    ds_write_b64 v12, v[100:101] offset:2048
    v_cvt_pk_bf16_f32 v104, v104, v105
    v_cvt_pk_bf16_f32 v105, v106, v107
    ds_write_b64 v12, v[104:105] offset:4096
    v_cvt_pk_bf16_f32 v108, v108, v109
    v_cvt_pk_bf16_f32 v109, v110, v111
    ds_write_b64 v12, v[108:109] offset:6144
    s_waitcnt lgkmcnt(0)
    s_barrier
    ds_read_b128 v[96:99], v2 offset:16384
    ds_read_b128 v[100:103], v2 offset:17408
    ds_read_b128 v[104:107], v2 offset:18432
    ds_read_b128 v[108:111], v2 offset:19456
    ds_read_b128 v[112:115], v31 offset:0
    ds_read_b128 v[116:119], v25 offset:0
    ds_read_b128 v[120:123], v31 offset:512
    ds_read_b128 v[124:127], v25 offset:1024
    s_waitcnt lgkmcnt(7)
    v_mfma_f32_16x16x32_bf16 v[16:19], v[80:83], v[96:99], 0
    s_waitcnt lgkmcnt(6)
    v_mfma_f32_16x16x32_bf16 v[16:19], v[84:87], v[100:103], v[16:19]
    s_waitcnt lgkmcnt(5)
    v_mfma_f32_16x16x32_bf16 v[16:19], v[88:91], v[104:107], v[16:19]
    s_waitcnt lgkmcnt(4)
    v_mfma_f32_16x16x32_bf16 v[16:19], v[92:95], v[108:111], v[16:19]
    s_waitcnt lgkmcnt(2)
    v_mfma_f32_16x16x32_bf16 v[16:19], v[116:119], v[112:115], v[16:19]
    s_waitcnt lgkmcnt(0)
    v_mfma_f32_16x16x32_bf16 v[16:19], v[124:127], v[120:123], v[16:19]
    s_mov_b32 exec_lo, 0x00ff00ff
    s_mov_b32 exec_hi, 0x00ff00ff
    s_nop 5
    v_cvt_pk_bf16_f32 v16, v16, v17
    v_cvt_pk_bf16_f32 v17, v18, v19
    v_min_u32 v16, -2, v16
    v_min_u32 v17, -2, v17
    buffer_store_dwordx2 v[16:17], v6, s[12:15], s63 offen sc1
    s_mov_b64 exec, -1
    s_add_u32 s61, s61, 0x4000
    s_and_b32 s61, s61, 0xffff
    s_mov_b32 s70, 1
    s_add_u32 s46, s64, 4096
    s_add_u32 m0, s59, 0
    s_nop 0
    buffer_load_dwordx4 v28, s[12:15], s64 offen offset:0 sc1 lds
    buffer_load_dwordx4 v28, s[12:15], s64 offen offset:1024 sc1 lds
    buffer_load_dwordx4 v28, s[12:15], s64 offen offset:2048 sc1 lds
    buffer_load_dwordx4 v28, s[12:15], s64 offen offset:3072 sc1 lds
    s_add_u32 m0, s59, 4096
    s_nop 0
    buffer_load_dwordx4 v28, s[12:15], s46 offen offset:0 sc1 lds
    buffer_load_dwordx4 v28, s[12:15], s46 offen offset:1024 sc1 lds
    buffer_load_dwordx4 v28, s[12:15], s46 offen offset:2048 sc1 lds
    buffer_load_dwordx4 v28, s[12:15], s46 offen offset:3072 sc1 lds
    s_add_u32 s64, s64, 786432
    s_waitcnt vmcnt(9)
    s_sleep 5
    buffer_load_dword v96, v7, s[12:15], s63 offen offset:0 sc1
    buffer_load_dword v97, v7, s[12:15], s63 offen offset:256 sc1
    buffer_load_dword v98, v7, s[12:15], s63 offen offset:512 sc1
    buffer_load_dword v99, v7, s[12:15], s63 offen offset:768 sc1
    buffer_load_dword v100, v7, s[12:15], s63 offen offset:1024 sc1
    buffer_load_dword v101, v7, s[12:15], s63 offen offset:1280 sc1
    buffer_load_dword v102, v7, s[12:15], s63 offen offset:1536 sc1
    buffer_load_dword v103, v7, s[12:15], s63 offen offset:1792 sc1
    v_mfma_f32_16x16x32_bf16 v[64:67], v[32:35], a[64:67], 0
    v_mfma_f32_16x16x32_bf16 v[68:71], v[48:51], a[64:67], 0
    v_mfma_f32_16x16x32_bf16 v[64:67], v[36:39], a[68:71], v[64:67]
    v_mfma_f32_16x16x32_bf16 v[68:71], v[52:55], a[68:71], v[68:71]
    v_mfma_f32_16x16x32_bf16 v[64:67], v[40:43], a[72:75], v[64:67]
    v_mfma_f32_16x16x32_bf16 v[68:71], v[56:59], a[72:75], v[68:71]
    v_mfma_f32_16x16x32_bf16 v[64:67], v[44:47], a[76:79], v[64:67]
    v_mfma_f32_16x16x32_bf16 v[68:71], v[60:63], a[76:79], v[68:71]
    v_mfma_f32_16x16x32_bf16 v[72:75], v[32:35], a[80:83], 0
    v_mfma_f32_16x16x32_bf16 v[76:79], v[48:51], a[80:83], 0
    v_mfma_f32_16x16x32_bf16 v[72:75], v[36:39], a[84:87], v[72:75]
    v_mfma_f32_16x16x32_bf16 v[76:79], v[52:55], a[84:87], v[76:79]
    v_mfma_f32_16x16x32_bf16 v[72:75], v[40:43], a[88:91], v[72:75]
    v_mfma_f32_16x16x32_bf16 v[76:79], v[56:59], a[88:91], v[76:79]
    v_mfma_f32_16x16x32_bf16 v[72:75], v[44:47], a[92:95], v[72:75]
    v_mfma_f32_16x16x32_bf16 v[76:79], v[60:63], a[92:95], v[76:79]
    v_cvt_pk_bf16_f32 v64, v64, v65
    v_cvt_pk_bf16_f32 v65, v66, v67
    v_cvt_pk_bf16_f32 v66, v68, v69
    v_cvt_pk_bf16_f32 v67, v70, v71
    ds_write_b128 v10, v[64:67] offset:32768
    v_mfma_f32_16x16x32_bf16 v[80:83], v[32:35], a[96:99], 0
    v_mfma_f32_16x16x32_bf16 v[84:87], v[48:51], a[96:99], 0
    v_mfma_f32_16x16x32_bf16 v[80:83], v[36:39], a[100:103], v[80:83]
    v_mfma_f32_16x16x32_bf16 v[84:87], v[52:55], a[100:103], v[84:87]
    v_mfma_f32_16x16x32_bf16 v[80:83], v[40:43], a[104:107], v[80:83]
    v_mfma_f32_16x16x32_bf16 v[84:87], v[56:59], a[104:107], v[84:87]
    v_mfma_f32_16x16x32_bf16 v[80:83], v[44:47], a[108:111], v[80:83]
    v_mfma_f32_16x16x32_bf16 v[84:87], v[60:63], a[108:111], v[84:87]
    v_cvt_pk_bf16_f32 v72, v72, v73
    v_cvt_pk_bf16_f32 v73, v74, v75
    v_cvt_pk_bf16_f32 v74, v76, v77
    v_cvt_pk_bf16_f32 v75, v78, v79
    ds_write_b128 v10, v[72:75] offset:33792
    v_mfma_f32_16x16x32_bf16 v[88:91], v[32:35], a[112:115], 0
    v_mfma_f32_16x16x32_bf16 v[92:95], v[48:51], a[112:115], 0
    v_mfma_f32_16x16x32_bf16 v[88:91], v[36:39], a[116:119], v[88:91]
    v_mfma_f32_16x16x32_bf16 v[92:95], v[52:55], a[116:119], v[92:95]
    v_mfma_f32_16x16x32_bf16 v[88:91], v[40:43], a[120:123], v[88:91]
    v_mfma_f32_16x16x32_bf16 v[92:95], v[56:59], a[120:123], v[92:95]
    v_mfma_f32_16x16x32_bf16 v[88:91], v[44:47], a[124:127], v[88:91]
    v_mfma_f32_16x16x32_bf16 v[92:95], v[60:63], a[124:127], v[92:95]
    v_cvt_pk_bf16_f32 v80, v80, v81
    v_cvt_pk_bf16_f32 v81, v82, v83
    v_cvt_pk_bf16_f32 v82, v84, v85
    v_cvt_pk_bf16_f32 v83, v86, v87
    ds_write_b128 v10, v[80:83] offset:34816
    s_nop 2
    v_cvt_pk_bf16_f32 v88, v88, v89
    v_cvt_pk_bf16_f32 v89, v90, v91
    v_cvt_pk_bf16_f32 v90, v92, v93
    v_cvt_pk_bf16_f32 v91, v94, v95
    ds_write_b128 v10, v[88:91] offset:35840
L_v_gp_236:
    s_waitcnt vmcnt(7)
    v_lshlrev_b32 v20, 16, v96
    v_and_b32 v21, 0xffff0000, v96
    s_waitcnt vmcnt(6)
    v_lshlrev_b32 v22, 16, v97
    v_and_b32 v23, 0xffff0000, v97
    v_add_f32 v20, v20, v22
    v_add_f32 v21, v21, v23
    s_waitcnt vmcnt(5)
    v_lshlrev_b32 v22, 16, v98
    v_and_b32 v23, 0xffff0000, v98
    v_add_f32 v20, v20, v22
    v_add_f32 v21, v21, v23
    s_waitcnt vmcnt(4)
    v_lshlrev_b32 v22, 16, v99
    v_and_b32 v23, 0xffff0000, v99
    v_add_f32 v20, v20, v22
    v_add_f32 v21, v21, v23
    s_waitcnt vmcnt(3)
    v_lshlrev_b32 v22, 16, v100
    v_and_b32 v23, 0xffff0000, v100
    v_add_f32 v20, v20, v22
    v_add_f32 v21, v21, v23
    s_waitcnt vmcnt(2)
    v_lshlrev_b32 v22, 16, v101
    v_and_b32 v23, 0xffff0000, v101
    v_add_f32 v20, v20, v22
    v_add_f32 v21, v21, v23
    s_waitcnt vmcnt(1)
    v_lshlrev_b32 v22, 16, v102
    v_and_b32 v23, 0xffff0000, v102
    v_add_f32 v20, v20, v22
    v_add_f32 v21, v21, v23
    s_waitcnt vmcnt(0)
    v_lshlrev_b32 v22, 16, v103
    v_and_b32 v23, 0xffff0000, v103
    v_add_f32 v20, v20, v22
    v_add_f32 v21, v21, v23
    v_cmp_u_f32 vcc, v20, v21
    v_cvt_pk_bf16_f32 v20, v20, v21
    s_cbranch_vccnz L_v_gf_238
L_v_gok_237:
    buffer_store_dword v20, v8, s[12:15], s61 offen
    s_xor_b32 s45, s61, 0x8000
    buffer_store_dword v26, v8, s[12:15], s45 offen
    s_bitcmp1_b32 s44, 0
    s_cbranch_scc1 L_v_nr_239
    s_xor_b32 s45, s62, 0x4000
    buffer_store_dword v26, v4, s[12:15], s45 offen
L_v_nr_239:
    s_add_u32 s60, s60, 1
    s_add_u32 s62, s62, 0x2000
    s_and_b32 s62, s62, 0x7fff
    s_add_u32 s63, s63, 131072
    s_sleep 3
    s_branch L_v_loop_225
L_v_last_229:
    s_waitcnt lgkmcnt(0)
    s_barrier
    s_branch L_c_done_1
L_v_l1_226:
    s_mov_b64 exec, s[48:49]
    s_cbranch_execz L_v_ls_240
    buffer_load_dwordx4 v[64:67], v9, s[12:15], s61 offen offset:0 sc1
L_v_ls_240:
    s_mov_b64 exec, s[50:51]
    s_cbranch_execz L_v_ls_241
    buffer_load_dwordx4 v[68:71], v9, s[12:15], s61 offen offset:1024 sc1
L_v_ls_241:
    s_mov_b64 exec, s[52:53]
    s_cbranch_execz L_v_ls_242
    buffer_load_dwordx4 v[72:75], v9, s[12:15], s61 offen offset:2048 sc1
L_v_ls_242:
    s_mov_b64 exec, s[54:55]
    s_cbranch_execz L_v_ls_243
    buffer_load_dwordx4 v[76:79], v9, s[12:15], s61 offen offset:3072 sc1
L_v_ls_243:
    s_mov_b64 exec, -1
    s_add_u32 s70, s70, 1
    s_cmp_ge_u32 s70, 524288
    s_cbranch_scc1 L_c_done_1
    s_waitcnt vmcnt(0)
    s_cmp_eq_u64 s[48:49], 0
    s_cbranch_scc1 L_v_lc_244
    ds_write_b128 v10, v[64:67] offset:0
    v_max3_u32 v24, v64, v65, v66
    v_max_u32 v24, v24, v67
    v_cmp_eq_u32 s[48:49], -1, v24
L_v_lc_244:
    s_cmp_eq_u64 s[50:51], 0
    s_cbranch_scc1 L_v_lc_245
    ds_write_b128 v10, v[68:71] offset:1024
    v_max3_u32 v24, v68, v69, v70
    v_max_u32 v24, v24, v71
    v_cmp_eq_u32 s[50:51], -1, v24
L_v_lc_245:
    s_cmp_eq_u64 s[52:53], 0
    s_cbranch_scc1 L_v_lc_246
    ds_write_b128 v10, v[72:75] offset:2048
    v_max3_u32 v24, v72, v73, v74
    v_max_u32 v24, v24, v75
    v_cmp_eq_u32 s[52:53], -1, v24
L_v_lc_246:
    s_cmp_eq_u64 s[54:55], 0
    s_cbranch_scc1 L_v_lc_247
    ds_write_b128 v10, v[76:79] offset:3072
    v_max3_u32 v24, v76, v77, v78
    v_max_u32 v24, v24, v79
    v_cmp_eq_u32 s[54:55], -1, v24
L_v_lc_247:
    s_or_b64 s[46:47], s[48:49], s[50:51]
    s_or_b64 vcc, s[52:53], s[54:55]
    s_or_b64 vcc, vcc, s[46:47]
    s_cbranch_scc1 L_v_l1_226
    s_branch L_v_l1ok_228
L_rt_232:
    s_add_u32 s70, s70, 1
    s_cmp_lt_u32 s70, 524288
    s_cbranch_scc1 L_v_rl_231
    s_branch L_c_done_1
L_rt_235:
    s_add_u32 s70, s70, 1
    s_cmp_lt_u32 s70, 524288
    s_cbranch_scc1 L_v_vp_234
    s_branch L_c_done_1
L_v_gf_238:
    v_max3_u32 v24, v96, v97, v98
    v_max3_u32 v24, v24, v99, v100
    v_max3_u32 v24, v24, v101, v102
    v_max_u32 v24, v24, v103
    v_cmp_eq_u32 vcc, -1, v24
    v_min_u32 v20, -2, v20
    s_add_u32 s70, s70, 1
    s_cbranch_vccz L_v_gok_237
    buffer_load_dword v96, v7, s[12:15], s63 offen offset:0 sc1
    buffer_load_dword v97, v7, s[12:15], s63 offen offset:256 sc1
    buffer_load_dword v98, v7, s[12:15], s63 offen offset:512 sc1
    buffer_load_dword v99, v7, s[12:15], s63 offen offset:768 sc1
    buffer_load_dword v100, v7, s[12:15], s63 offen offset:1024 sc1
    buffer_load_dword v101, v7, s[12:15], s63 offen offset:1280 sc1
    buffer_load_dword v102, v7, s[12:15], s63 offen offset:1536 sc1
    buffer_load_dword v103, v7, s[12:15], s63 offen offset:1792 sc1
    s_cmp_lt_u32 s70, 524288
    s_cbranch_scc1 L_v_gp_236
    s_branch L_c_done_1
L_vs_206:
    s_mov_b32 s70, 1
    v_mov_b32 v16, 0
    v_mov_b32 v17, 0
    s_branch L_v_l1m_250
.p2align 6
L_v_loop_248:
    s_mov_b32 s70, 1
    buffer_load_dwordx4 v[64:67], v9, s[12:15], s61 offen offset:0 sc1
    buffer_load_dwordx4 v[68:71], v9, s[12:15], s61 offen offset:1024 sc1
    buffer_load_dwordx4 v[72:75], v9, s[12:15], s61 offen offset:2048 sc1
    buffer_load_dwordx4 v[76:79], v9, s[12:15], s61 offen offset:3072 sc1
    v_mov_b32 v16, 0
    v_mov_b32 v17, 0
    v_mov_b32 v18, 0
    v_mov_b32 v19, 0
    v_mov_b32 v20, 0
    v_mov_b32 v21, 0
    v_mov_b32 v22, 0
    v_mov_b32 v23, 0
L_v_l1m_250:
    s_waitcnt vmcnt(3)
    ds_write_b128 v10, v[64:67] offset:0
    v_max3_u32 v24, v64, v65, v66
    v_max_u32 v24, v24, v67
    v_cmp_eq_u32 s[48:49], -1, v24
    s_waitcnt vmcnt(2)
    ds_write_b128 v10, v[68:71] offset:1024
    v_max3_u32 v24, v68, v69, v70
    v_max_u32 v24, v24, v71
    v_cmp_eq_u32 s[50:51], -1, v24
    s_waitcnt vmcnt(1)
    ds_write_b128 v10, v[72:75] offset:2048
    v_max3_u32 v24, v72, v73, v74
    v_max_u32 v24, v24, v75
    v_cmp_eq_u32 s[52:53], -1, v24
    s_waitcnt vmcnt(0)
    ds_write_b128 v10, v[76:79] offset:3072
    v_max3_u32 v24, v76, v77, v78
    v_max_u32 v24, v24, v79
    v_cmp_eq_u32 s[54:55], -1, v24
    s_or_b64 s[46:47], s[48:49], s[50:51]
    s_or_b64 vcc, s[52:53], s[54:55]
    s_or_b64 vcc, vcc, s[46:47]
    s_cbranch_scc1 L_v_l1_249
L_v_l1ok_251:
    s_waitcnt lgkmcnt(0)
    s_barrier
    v_smfmac_f32_16x16x64_bf16 v[16:19], v[64:67], a[0:7], v3
    v_smfmac_f32_16x16x64_bf16 v[20:23], v[64:67], a[32:39], v3
    v_smfmac_f32_16x16x64_bf16 v[16:19], v[68:71], a[8:15], v3
    v_smfmac_f32_16x16x64_bf16 v[20:23], v[68:71], a[40:47], v3
    v_smfmac_f32_16x16x64_bf16 v[16:19], v[72:75], a[16:23], v3
    v_smfmac_f32_16x16x64_bf16 v[20:23], v[72:75], a[48:55], v3
    v_smfmac_f32_16x16x64_bf16 v[16:19], v[76:79], a[24:31], v3
    v_smfmac_f32_16x16x64_bf16 v[20:23], v[76:79], a[56:63], v3
    s_nop 6
    v_permlane32_swap_b32 v16, v18
    v_permlane32_swap_b32 v17, v19
    v_permlane32_swap_b32 v20, v22
    v_permlane32_swap_b32 v21, v23
    v_add_f32 v16, v16, v18
    v_add_f32 v17, v17, v19
    v_add_f32 v18, v20, v22
    v_add_f32 v19, v21, v23
    ds_write_b128 v14, v[16:19]
    s_mov_b64 exec, 1
    ds_add_u32 v29, v30
    s_mov_b64 exec, -1
    s_add_u32 s58, s58, 4
    s_bitcmp1_b32 s44, 0
    s_cbranch_scc1 L_v_k1_253
    s_mov_b32 s70, 0
L_v_rl_254:
    ds_read_b32 v24, v29
    ds_read_b64 v[16:17], v13 offset:0
    ds_read_b64 v[18:19], v13 offset:1024
    ds_read_b64 v[20:21], v13 offset:2048
    ds_read_b64 v[22:23], v13 offset:3072
    s_waitcnt lgkmcnt(2)
    v_cmp_ne_u32 vcc, s58, v24
    v_add_f32 v16, v16, v18
    v_add_f32 v17, v17, v19
    s_waitcnt lgkmcnt(0)
    s_cbranch_vccnz L_rt_255
    v_add_f32 v20, v20, v22
    v_add_f32 v21, v21, v23
    v_add_f32 v16, v16, v20
    v_add_f32 v17, v17, v21
    s_mov_b32 vcc_lo, 0x55555555
    s_mov_b32 vcc_hi, 0x55555555
    v_cndmask_b32_dpp v18, v17, v16, vcc quad_perm:[1,0,3,2] row_mask:0xf bank_mask:0xf
    s_not_b64 vcc, vcc
    v_cndmask_b32_dpp v19, v16, v17, vcc quad_perm:[1,0,3,2] row_mask:0xf bank_mask:0xf
    v_cvt_pk_bf16_f32 v18, v18, v19
    v_min_u32 v18, -2, v18
    buffer_store_dword v18, v4, s[12:15], s62 offen sc1
    ds_write_b32 v5, v18
L_v_k1_253:
    s_cmp_eq_u32 s60, 63
    s_cbranch_scc1 L_v_last_252
    ds_read_b128 v[80:83], v27 offset:32768
    ds_read_b128 v[84:87], v27 offset:36864
    ds_read_b128 v[88:91], v27 offset:40960
    ds_read_b128 v[92:95], v27 offset:45056
    v_mov_b32 v96, 0
    v_mov_b32 v97, 0
    v_mov_b32 v98, 0
    v_mov_b32 v99, 0
    v_mov_b32 v100, 0
    v_mov_b32 v101, 0
    v_mov_b32 v102, 0
    v_mov_b32 v103, 0
    v_mov_b32 v104, 0
    v_mov_b32 v105, 0
    v_mov_b32 v106, 0
    v_mov_b32 v107, 0
    v_mov_b32 v108, 0
    v_mov_b32 v109, 0
    v_mov_b32 v110, 0
    v_mov_b32 v111, 0
    s_bitcmp1_b32 s44, 0
    s_cbranch_scc0 L_v_sv_256
    s_sleep 3
L_v_sv_256:
    s_sleep 2
    s_mov_b32 s70, 1
L_v_vp_257:
    buffer_load_dwordx4 v[64:67], v11, s[12:15], s62 offen offset:0 sc1
    buffer_load_dwordx4 v[68:71], v11, s[12:15], s62 offen offset:1024 sc1
    s_waitcnt vmcnt(0)
    v_max3_u32 v20, v64, v65, v66
    v_max3_u32 v20, v20, v67, v68
    v_max3_u32 v20, v20, v69, v70
    v_max_u32 v20, v20, v71
    v_cmp_eq_u32 vcc, -1, v20
    s_cbranch_vccnz L_rt_258
    v_smfmac_f32_16x16x64_bf16 v[96:99], v[64:67], a[64:71], v3
    v_smfmac_f32_16x16x64_bf16 v[96:99], v[68:71], a[72:79], v3
    v_smfmac_f32_16x16x64_bf16 v[100:103], v[64:67], a[80:87], v3
    v_smfmac_f32_16x16x64_bf16 v[100:103], v[68:71], a[88:95], v3
    v_smfmac_f32_16x16x64_bf16 v[104:107], v[64:67], a[96:103], v3
    v_smfmac_f32_16x16x64_bf16 v[104:107], v[68:71], a[104:111], v3
    v_smfmac_f32_16x16x64_bf16 v[108:111], v[64:67], a[112:119], v3
    v_smfmac_f32_16x16x64_bf16 v[108:111], v[68:71], a[120:127], v3
    s_add_u32 s46, s65, 4096
    buffer_load_dwordx4 v[32:35], v15, s[12:15], s65 offen offset:0 sc1
    buffer_load_dwordx4 v[48:51], v15, s[12:15], s46 offen offset:0 sc1
    buffer_load_dwordx4 v[36:39], v15, s[12:15], s65 offen offset:1024 sc1
    buffer_load_dwordx4 v[52:55], v15, s[12:15], s46 offen offset:1024 sc1
    buffer_load_dwordx4 v[40:43], v15, s[12:15], s65 offen offset:2048 sc1
    buffer_load_dwordx4 v[56:59], v15, s[12:15], s46 offen offset:2048 sc1
    buffer_load_dwordx4 v[44:47], v15, s[12:15], s65 offen offset:3072 sc1
    buffer_load_dwordx4 v[60:63], v15, s[12:15], s46 offen offset:3072 sc1
    s_add_u32 s65, s65, 786432
    v_cvt_pk_bf16_f32 v96, v96, v97
    v_cvt_pk_bf16_f32 v97, v98, v99
    ds_write_b64 v12, v[96:97] offset:0
    v_cvt_pk_bf16_f32 v100, v100, v101
    v_cvt_pk_bf16_f32 v101, v102, v103
    ds_write_b64 v12, v[100:101] offset:2048
    v_cvt_pk_bf16_f32 v104, v104, v105
    v_cvt_pk_bf16_f32 v105, v106, v107
    ds_write_b64 v12, v[104:105] offset:4096
    v_cvt_pk_bf16_f32 v108, v108, v109
    v_cvt_pk_bf16_f32 v109, v110, v111
    ds_write_b64 v12, v[108:109] offset:6144
    s_waitcnt lgkmcnt(0)
    s_barrier
    ds_read_b128 v[96:99], v2 offset:16384
    ds_read_b128 v[100:103], v2 offset:17408
    ds_read_b128 v[104:107], v2 offset:18432
    ds_read_b128 v[108:111], v2 offset:19456
    ds_read_b128 v[112:115], v31 offset:0
    ds_read_b128 v[116:119], v25 offset:0
    ds_read_b128 v[120:123], v31 offset:512
    ds_read_b128 v[124:127], v25 offset:1024
    s_waitcnt lgkmcnt(7)
    v_mfma_f32_16x16x32_bf16 v[16:19], v[80:83], v[96:99], 0
    s_waitcnt lgkmcnt(6)
    v_mfma_f32_16x16x32_bf16 v[16:19], v[84:87], v[100:103], v[16:19]
    s_waitcnt lgkmcnt(5)
    v_mfma_f32_16x16x32_bf16 v[16:19], v[88:91], v[104:107], v[16:19]
    s_waitcnt lgkmcnt(4)
    v_mfma_f32_16x16x32_bf16 v[16:19], v[92:95], v[108:111], v[16:19]
    s_waitcnt lgkmcnt(2)
    v_mfma_f32_16x16x32_bf16 v[16:19], v[116:119], v[112:115], v[16:19]
    s_waitcnt lgkmcnt(0)
    v_mfma_f32_16x16x32_bf16 v[16:19], v[124:127], v[120:123], v[16:19]
    s_mov_b32 exec_lo, 0x00ff00ff
    s_mov_b32 exec_hi, 0x00ff00ff
    s_nop 5
    v_cvt_pk_bf16_f32 v16, v16, v17
    v_cvt_pk_bf16_f32 v17, v18, v19
    v_min_u32 v16, -2, v16
    v_min_u32 v17, -2, v17
    buffer_store_dwordx2 v[16:17], v6, s[12:15], s63 offen sc1
    s_mov_b64 exec, -1
    s_add_u32 s61, s61, 0x4000
    s_and_b32 s61, s61, 0xffff
    s_mov_b32 s70, 1
    s_add_u32 s46, s64, 4096
    s_add_u32 m0, s59, 0
    s_nop 0
    buffer_load_dwordx4 v28, s[12:15], s64 offen offset:0 sc1 lds
    buffer_load_dwordx4 v28, s[12:15], s64 offen offset:1024 sc1 lds
    buffer_load_dwordx4 v28, s[12:15], s64 offen offset:2048 sc1 lds
    buffer_load_dwordx4 v28, s[12:15], s64 offen offset:3072 sc1 lds
    s_add_u32 m0, s59, 4096
    s_nop 0
    buffer_load_dwordx4 v28, s[12:15], s46 offen offset:0 sc1 lds
    buffer_load_dwordx4 v28, s[12:15], s46 offen offset:1024 sc1 lds
    buffer_load_dwordx4 v28, s[12:15], s46 offen offset:2048 sc1 lds
    buffer_load_dwordx4 v28, s[12:15], s46 offen offset:3072 sc1 lds
    s_add_u32 s64, s64, 786432
    s_waitcnt vmcnt(9)
    s_sleep 5
    buffer_load_dword v96, v7, s[12:15], s63 offen offset:0 sc1
    buffer_load_dword v97, v7, s[12:15], s63 offen offset:256 sc1
    buffer_load_dword v98, v7, s[12:15], s63 offen offset:512 sc1
    buffer_load_dword v99, v7, s[12:15], s63 offen offset:768 sc1
    buffer_load_dword v100, v7, s[12:15], s63 offen offset:1024 sc1
    buffer_load_dword v101, v7, s[12:15], s63 offen offset:1280 sc1
    buffer_load_dword v102, v7, s[12:15], s63 offen offset:1536 sc1
    buffer_load_dword v103, v7, s[12:15], s63 offen offset:1792 sc1
    v_mfma_f32_16x16x32_bf16 v[64:67], v[32:35], a[64:67], 0
    v_mfma_f32_16x16x32_bf16 v[68:71], v[48:51], a[64:67], 0
    v_mfma_f32_16x16x32_bf16 v[64:67], v[36:39], a[68:71], v[64:67]
    v_mfma_f32_16x16x32_bf16 v[68:71], v[52:55], a[68:71], v[68:71]
    v_mfma_f32_16x16x32_bf16 v[64:67], v[40:43], a[72:75], v[64:67]
    v_mfma_f32_16x16x32_bf16 v[68:71], v[56:59], a[72:75], v[68:71]
    v_mfma_f32_16x16x32_bf16 v[64:67], v[44:47], a[76:79], v[64:67]
    v_mfma_f32_16x16x32_bf16 v[68:71], v[60:63], a[76:79], v[68:71]
    v_mfma_f32_16x16x32_bf16 v[72:75], v[32:35], a[80:83], 0
    v_mfma_f32_16x16x32_bf16 v[76:79], v[48:51], a[80:83], 0
    v_mfma_f32_16x16x32_bf16 v[72:75], v[36:39], a[84:87], v[72:75]
    v_mfma_f32_16x16x32_bf16 v[76:79], v[52:55], a[84:87], v[76:79]
    v_mfma_f32_16x16x32_bf16 v[72:75], v[40:43], a[88:91], v[72:75]
    v_mfma_f32_16x16x32_bf16 v[76:79], v[56:59], a[88:91], v[76:79]
    v_mfma_f32_16x16x32_bf16 v[72:75], v[44:47], a[92:95], v[72:75]
    v_mfma_f32_16x16x32_bf16 v[76:79], v[60:63], a[92:95], v[76:79]
    v_cvt_pk_bf16_f32 v64, v64, v65
    v_cvt_pk_bf16_f32 v65, v66, v67
    v_cvt_pk_bf16_f32 v66, v68, v69
    v_cvt_pk_bf16_f32 v67, v70, v71
    ds_write_b128 v10, v[64:67] offset:32768
    v_mfma_f32_16x16x32_bf16 v[80:83], v[32:35], a[96:99], 0
    v_mfma_f32_16x16x32_bf16 v[84:87], v[48:51], a[96:99], 0
    v_mfma_f32_16x16x32_bf16 v[80:83], v[36:39], a[100:103], v[80:83]
    v_mfma_f32_16x16x32_bf16 v[84:87], v[52:55], a[100:103], v[84:87]
    v_mfma_f32_16x16x32_bf16 v[80:83], v[40:43], a[104:107], v[80:83]
    v_mfma_f32_16x16x32_bf16 v[84:87], v[56:59], a[104:107], v[84:87]
    v_mfma_f32_16x16x32_bf16 v[80:83], v[44:47], a[108:111], v[80:83]
    v_mfma_f32_16x16x32_bf16 v[84:87], v[60:63], a[108:111], v[84:87]
    v_cvt_pk_bf16_f32 v72, v72, v73
    v_cvt_pk_bf16_f32 v73, v74, v75
    v_cvt_pk_bf16_f32 v74, v76, v77
    v_cvt_pk_bf16_f32 v75, v78, v79
    ds_write_b128 v10, v[72:75] offset:33792
    v_mfma_f32_16x16x32_bf16 v[88:91], v[32:35], a[112:115], 0
    v_mfma_f32_16x16x32_bf16 v[92:95], v[48:51], a[112:115], 0
    v_mfma_f32_16x16x32_bf16 v[88:91], v[36:39], a[116:119], v[88:91]
    v_mfma_f32_16x16x32_bf16 v[92:95], v[52:55], a[116:119], v[92:95]
    v_mfma_f32_16x16x32_bf16 v[88:91], v[40:43], a[120:123], v[88:91]
    v_mfma_f32_16x16x32_bf16 v[92:95], v[56:59], a[120:123], v[92:95]
    v_mfma_f32_16x16x32_bf16 v[88:91], v[44:47], a[124:127], v[88:91]
    v_mfma_f32_16x16x32_bf16 v[92:95], v[60:63], a[124:127], v[92:95]
    v_cvt_pk_bf16_f32 v80, v80, v81
    v_cvt_pk_bf16_f32 v81, v82, v83
    v_cvt_pk_bf16_f32 v82, v84, v85
    v_cvt_pk_bf16_f32 v83, v86, v87
    ds_write_b128 v10, v[80:83] offset:34816
    s_nop 2
    v_cvt_pk_bf16_f32 v88, v88, v89
    v_cvt_pk_bf16_f32 v89, v90, v91
    v_cvt_pk_bf16_f32 v90, v92, v93
    v_cvt_pk_bf16_f32 v91, v94, v95
    ds_write_b128 v10, v[88:91] offset:35840
L_v_gp_259:
    s_waitcnt vmcnt(7)
    v_lshlrev_b32 v20, 16, v96
    v_and_b32 v21, 0xffff0000, v96
    s_waitcnt vmcnt(6)
    v_lshlrev_b32 v22, 16, v97
    v_and_b32 v23, 0xffff0000, v97
    v_add_f32 v20, v20, v22
    v_add_f32 v21, v21, v23
    s_waitcnt vmcnt(5)
    v_lshlrev_b32 v22, 16, v98
    v_and_b32 v23, 0xffff0000, v98
    v_add_f32 v20, v20, v22
    v_add_f32 v21, v21, v23
    s_waitcnt vmcnt(4)
    v_lshlrev_b32 v22, 16, v99
    v_and_b32 v23, 0xffff0000, v99
    v_add_f32 v20, v20, v22
    v_add_f32 v21, v21, v23
    s_waitcnt vmcnt(3)
    v_lshlrev_b32 v22, 16, v100
    v_and_b32 v23, 0xffff0000, v100
    v_add_f32 v20, v20, v22
    v_add_f32 v21, v21, v23
    s_waitcnt vmcnt(2)
    v_lshlrev_b32 v22, 16, v101
    v_and_b32 v23, 0xffff0000, v101
    v_add_f32 v20, v20, v22
    v_add_f32 v21, v21, v23
    s_waitcnt vmcnt(1)
    v_lshlrev_b32 v22, 16, v102
    v_and_b32 v23, 0xffff0000, v102
    v_add_f32 v20, v20, v22
    v_add_f32 v21, v21, v23
    s_waitcnt vmcnt(0)
    v_lshlrev_b32 v22, 16, v103
    v_and_b32 v23, 0xffff0000, v103
    v_add_f32 v20, v20, v22
    v_add_f32 v21, v21, v23
    v_cmp_u_f32 vcc, v20, v21
    v_cvt_pk_bf16_f32 v20, v20, v21
    s_cbranch_vccnz L_v_gf_261
L_v_gok_260:
    buffer_store_dword v20, v8, s[12:15], s61 offen sc1
    s_xor_b32 s45, s61, 0x8000
    buffer_store_dword v26, v8, s[12:15], s45 offen sc1
    s_bitcmp1_b32 s44, 0
    s_cbranch_scc1 L_v_nr_262
    s_xor_b32 s45, s62, 0x4000
    buffer_store_dword v26, v4, s[12:15], s45 offen sc1
L_v_nr_262:
    s_add_u32 s60, s60, 1
    s_add_u32 s62, s62, 0x2000
    s_and_b32 s62, s62, 0x7fff
    s_add_u32 s63, s63, 131072
    s_sleep 3
    s_branch L_v_loop_248
L_v_last_252:
    s_waitcnt lgkmcnt(0)
    s_barrier
    s_branch L_c_done_1
L_v_l1_249:
    s_mov_b64 exec, s[48:49]
    s_cbranch_execz L_v_ls_263
    buffer_load_dwordx4 v[64:67], v9, s[12:15], s61 offen offset:0 sc1
L_v_ls_263:
    s_mov_b64 exec, s[50:51]
    s_cbranch_execz L_v_ls_264
    buffer_load_dwordx4 v[68:71], v9, s[12:15], s61 offen offset:1024 sc1
L_v_ls_264:
    s_mov_b64 exec, s[52:53]
    s_cbranch_execz L_v_ls_265
    buffer_load_dwordx4 v[72:75], v9, s[12:15], s61 offen offset:2048 sc1
L_v_ls_265:
    s_mov_b64 exec, s[54:55]
    s_cbranch_execz L_v_ls_266
    buffer_load_dwordx4 v[76:79], v9, s[12:15], s61 offen offset:3072 sc1
L_v_ls_266:
    s_mov_b64 exec, -1
    s_add_u32 s70, s70, 1
    s_cmp_ge_u32 s70, 524288
    s_cbranch_scc1 L_c_done_1
    s_waitcnt vmcnt(0)
    s_cmp_eq_u64 s[48:49], 0
    s_cbranch_scc1 L_v_lc_267
    ds_write_b128 v10, v[64:67] offset:0
    v_max3_u32 v24, v64, v65, v66
    v_max_u32 v24, v24, v67
    v_cmp_eq_u32 s[48:49], -1, v24
L_v_lc_267:
    s_cmp_eq_u64 s[50:51], 0
    s_cbranch_scc1 L_v_lc_268
    ds_write_b128 v10, v[68:71] offset:1024
    v_max3_u32 v24, v68, v69, v70
    v_max_u32 v24, v24, v71
    v_cmp_eq_u32 s[50:51], -1, v24
L_v_lc_268:
    s_cmp_eq_u64 s[52:53], 0
    s_cbranch_scc1 L_v_lc_269
    ds_write_b128 v10, v[72:75] offset:2048
    v_max3_u32 v24, v72, v73, v74
    v_max_u32 v24, v24, v75
    v_cmp_eq_u32 s[52:53], -1, v24
L_v_lc_269:
    s_cmp_eq_u64 s[54:55], 0
    s_cbranch_scc1 L_v_lc_270
    ds_write_b128 v10, v[76:79] offset:3072
    v_max3_u32 v24, v76, v77, v78
    v_max_u32 v24, v24, v79
    v_cmp_eq_u32 s[54:55], -1, v24
L_v_lc_270:
    s_or_b64 s[46:47], s[48:49], s[50:51]
    s_or_b64 vcc, s[52:53], s[54:55]
    s_or_b64 vcc, vcc, s[46:47]
    s_cbranch_scc1 L_v_l1_249
    s_branch L_v_l1ok_251
L_rt_255:
    s_add_u32 s70, s70, 1
    s_cmp_lt_u32 s70, 524288
    s_cbranch_scc1 L_v_rl_254
    s_branch L_c_done_1
L_rt_258:
    s_add_u32 s70, s70, 1
    s_cmp_lt_u32 s70, 524288
    s_cbranch_scc1 L_v_vp_257
    s_branch L_c_done_1
L_v_gf_261:
    v_max3_u32 v24, v96, v97, v98
    v_max3_u32 v24, v24, v99, v100
    v_max3_u32 v24, v24, v101, v102
    v_max_u32 v24, v24, v103
    v_cmp_eq_u32 vcc, -1, v24
    v_min_u32 v20, -2, v20
    s_add_u32 s70, s70, 1
    s_cbranch_vccz L_v_gok_260
    buffer_load_dword v96, v7, s[12:15], s63 offen offset:0 sc1
    buffer_load_dword v97, v7, s[12:15], s63 offen offset:256 sc1
    buffer_load_dword v98, v7, s[12:15], s63 offen offset:512 sc1
    buffer_load_dword v99, v7, s[12:15], s63 offen offset:768 sc1
    buffer_load_dword v100, v7, s[12:15], s63 offen offset:1024 sc1
    buffer_load_dword v101, v7, s[12:15], s63 offen offset:1280 sc1
    buffer_load_dword v102, v7, s[12:15], s63 offen offset:1536 sc1
    buffer_load_dword v103, v7, s[12:15], s63 offen offset:1792 sc1
    s_cmp_lt_u32 s70, 524288
    s_cbranch_scc1 L_v_gp_259
    s_branch L_c_done_1
L_c_done_1:
    s_endpgm
.section .rodata,"a"
.p2align 6
.amdhsa_kernel k3_chain_kernel
  .amdhsa_next_free_vgpr 256
  .amdhsa_next_free_sgpr 102
  .amdhsa_accum_offset 128
  .amdhsa_group_segment_fixed_size 0
  .amdhsa_kernarg_size 136
  .amdhsa_user_sgpr_count 2
  .amdhsa_user_sgpr_kernarg_segment_ptr 1
  .amdhsa_system_sgpr_workgroup_id_x 1
.end_amdhsa_kernel
```

```asm
; @launch kernel=k3_chain_kernel grid=(256,1,1) block=(512,1,1) lds=147712
.amdgcn_target "amdgcn-amd-amdhsa--gfx950"
.text
.globl k3_chain_kernel
.p2align 8
.type k3_chain_kernel,@function
k3_chain_kernel:
    s_cmp_ge_u32 s2, 256
    s_cbranch_scc1 L_c_done_1
    s_load_dwordx4 s[20:23], s[0:1], 120
    v_and_b32 v1, 63, v0
    v_lshrrev_b32 v2, 6, v0
    s_nop 0
    v_readfirstlane_b32 s44, v2
    s_waitcnt lgkmcnt(0)
    s_mov_b32 s12, s22
    s_and_b32 s13, s23, 0xffff
    s_mov_b32 s14, 0x10000000
    s_mov_b32 s15, 0x00020000
    s_mov_b32 s16, s20
    s_and_b32 s17, s21, 0xffff
    s_mov_b32 s18, 0x100
    s_mov_b32 s19, 0x00020000
    s_load_dwordx4 s[8:11], s[0:1], 96
    v_lshrrev_b32 v5, 3, v0
    v_mul_u32_u24 v6, 24576, v5
    v_and_b32 v7, 7, v0
    v_lshl_add_u32 v6, v7, 4, v6
    v_add_u32 v7, 12288, v6
    v_lshlrev_b32 v5, 2, v5
    s_lshr_b32 s50, s2, 5
    s_and_b32 s51, s2, 31
    s_mul_i32 s52, s50, 1572864
    s_lshl_b32 s53, s51, 7
    s_add_u32 s52, s52, s53
    s_lshl_b32 s53, s50, 8
    s_waitcnt lgkmcnt(0)
    s_mov_b32 s28, s10
    s_and_b32 s29, s11, 0xffff
    s_mov_b32 s30, 0xc00000
    s_mov_b32 s31, 0x00020000
    s_mov_b32 s32, s8
    s_and_b32 s33, s9, 0xffff
    s_mov_b32 s34, 0x800
    s_mov_b32 s35, 0x00020000
    buffer_load_dword v8, v5, s[32:35], s53 offen
    buffer_load_dwordx4 v[12:15], v6, s[28:31], s52 offen
    buffer_load_dwordx4 v[16:19], v7, s[28:31], s52 offen
    s_getreg_b32 s39, hwreg(HW_REG_XCC_ID)
    s_and_b32 s39, s39, 7
    s_cmp_lg_u32 s44, 1
    s_cbranch_scc1 L_nz_5
    v_mov_b32 v32, 0
    v_mov_b32 v33, 0
    v_mov_b32 v34, 0
    v_mov_b32 v35, 0
    v_lshlrev_b32 v4, 4, v1
    s_lshl_b32 s45, s2, 10
    s_add_u32 s45, s45, 0x100000
    buffer_store_dwordx4 v[32:35], v4, s[12:15], s45 offen sc1
L_nz_5:
    s_waitcnt vmcnt(0)
    v_lshlrev_b32 v9, 16, v8
    v_and_b32 v10, 0xffff0000, v8
    v_mul_f32 v20, 0xbfb8aa3b, v9
    v_mul_f32 v21, 0xbfb8aa3b, v10
    v_exp_f32 v20, v20
    v_exp_f32 v21, v21
    s_nop 0
    v_add_f32 v20, 1.0, v20
    v_add_f32 v21, 1.0, v21
    v_rcp_f32 v20, v20
    v_rcp_f32 v21, v21
    s_nop 0
    v_mul_f32 v9, v9, v20
    v_mul_f32 v10, v10, v21
    v_cvt_pk_bf16_f32 v9, 0, v9
    v_cvt_pk_bf16_f32 v10, 0, v10
    v_lshlrev_b32 v28, 16, v12
    v_and_b32 v29, 0xffff0000, v12
    v_lshlrev_b32 v30, 16, v16
    v_and_b32 v31, 0xffff0000, v16
    v_mul_f32 v20, v28, v9
    v_mul_f32 v21, v29, v9
    v_fmac_f32 v20, v30, v10
    v_fmac_f32 v21, v31, v10
    v_lshlrev_b32 v28, 16, v13
    v_and_b32 v29, 0xffff0000, v13
    v_lshlrev_b32 v30, 16, v17
    v_and_b32 v31, 0xffff0000, v17
    v_mul_f32 v22, v28, v9
    v_mul_f32 v23, v29, v9
    v_fmac_f32 v22, v30, v10
    v_fmac_f32 v23, v31, v10
    v_lshlrev_b32 v28, 16, v14
    v_and_b32 v29, 0xffff0000, v14
    v_lshlrev_b32 v30, 16, v18
    v_and_b32 v31, 0xffff0000, v18
    v_mul_f32 v24, v28, v9
    v_mul_f32 v25, v29, v9
    v_fmac_f32 v24, v30, v10
    v_fmac_f32 v25, v31, v10
    v_lshlrev_b32 v28, 16, v15
    v_and_b32 v29, 0xffff0000, v15
    v_lshlrev_b32 v30, 16, v19
    v_and_b32 v31, 0xffff0000, v19
    v_mul_f32 v26, v28, v9
    v_mul_f32 v27, v29, v9
    v_fmac_f32 v26, v30, v10
    v_fmac_f32 v27, v31, v10
    s_nop 1
    v_add_f32_dpp v20, v20, v20 row_ror:8 row_mask:0xf bank_mask:0xf
    v_add_f32_dpp v21, v21, v21 row_ror:8 row_mask:0xf bank_mask:0xf
    v_add_f32_dpp v22, v22, v22 row_ror:8 row_mask:0xf bank_mask:0xf
    v_add_f32_dpp v23, v23, v23 row_ror:8 row_mask:0xf bank_mask:0xf
    v_add_f32_dpp v24, v24, v24 row_ror:8 row_mask:0xf bank_mask:0xf
    v_add_f32_dpp v25, v25, v25 row_ror:8 row_mask:0xf bank_mask:0xf
    v_add_f32_dpp v26, v26, v26 row_ror:8 row_mask:0xf bank_mask:0xf
    v_add_f32_dpp v27, v27, v27 row_ror:8 row_mask:0xf bank_mask:0xf
    s_nop 1
    v_permlane16_swap_b32 v20, v24
    v_permlane16_swap_b32 v21, v25
    v_permlane16_swap_b32 v22, v26
    v_permlane16_swap_b32 v23, v27
    v_add_f32 v20, v20, v24
    v_add_f32 v21, v21, v25
    v_add_f32 v22, v22, v26
    v_add_f32 v23, v23, v27
    s_nop 1
    v_permlane32_swap_b32 v20, v22
    v_permlane32_swap_b32 v21, v23
    v_add_f32 v20, v20, v22
    v_add_f32 v21, v21, v23
    v_and_b32 v22, 7, v1
    v_lshlrev_b32 v22, 5, v22
    v_bfe_u32 v23, v1, 4, 1
    v_lshl_add_u32 v22, v23, 4, v22
    v_lshrrev_b32 v23, 5, v1
    v_lshl_add_u32 v22, v23, 3, v22
    s_lshl_b32 s52, s44, 8
    s_add_u32 s52, s52, 139776
    v_add_u32 v22, s52, v22
    ds_write_b64 v22, v[20:21]
    s_waitcnt lgkmcnt(0)
    s_barrier
    s_cmp_lg_u32 s44, 1
    s_cbranch_scc1 L_m1_6
    v_lshlrev_b32 v22, 2, v1
    v_add_u32 v23, 139776, v22
    ds_read_b32 v24, v23 offset:0
    ds_read_b32 v25, v23 offset:256
    ds_read_b32 v26, v23 offset:512
    ds_read_b32 v27, v23 offset:768
    ds_read_b32 v28, v23 offset:1024
    ds_read_b32 v29, v23 offset:1280
    ds_read_b32 v30, v23 offset:1536
    ds_read_b32 v31, v23 offset:1792
    s_waitcnt lgkmcnt(0)
    v_add_f32 v24, v24, v28
    v_add_f32 v25, v25, v29
    v_add_f32 v26, v26, v30
    v_add_f32 v27, v27, v31
    v_add_f32 v24, v24, v26
    v_add_f32 v25, v25, v27
    v_add_f32 v24, v24, v25
    s_lshl_b32 s52, s2, 8
    s_add_u32 s52, s52, 0x10000
    buffer_store_dword v24, v22, s[12:15], s52 offen sc1
L_m1_6:
    s_cmp_lg_u32 s44, 1
    s_cbranch_scc1 L_tk_2
    v_mov_b32 v3, 1
    s_mov_b32 s40, s39
    s_lshl_b32 s45, s40, 5
    v_mov_b32 v4, 0
    s_waitcnt vmcnt(0)
    s_mov_b64 exec, 1
    buffer_atomic_add v3, v4, s[16:19], s45 offen sc0
    s_waitcnt vmcnt(0)
    v_readfirstlane_b32 s41, v3
    s_nop 3
    s_cmp_lt_u32 s41, 32
    s_cbranch_scc1 L_got_3
    v_mov_b32 v3, 1
    buffer_atomic_add v3, v4, s[16:19], 0 offen offset:16 sc0
    s_waitcnt vmcnt(0)
    v_readfirstlane_b32 s46, v3
    s_mov_b64 exec, -1
    v_and_b32 v4, 7, v1
    v_lshlrev_b32 v4, 5, v4
    s_mov_b32 s70, 0
L_sp_4:
    s_sleep 8
    buffer_load_dword v3, v4, s[16:19], 0 offen sc1
    s_waitcnt vmcnt(0)
    s_mov_b32 s48, 0
    v_readlane_b32 s50, v3, 0
    v_readlane_b32 s51, v3, 1
    v_readlane_b32 s52, v3, 2
    v_readlane_b32 s53, v3, 3
    v_readlane_b32 s54, v3, 4
    v_readlane_b32 s55, v3, 5
    v_readlane_b32 s56, v3, 6
    v_readlane_b32 s57, v3, 7
    s_nop 3
    s_add_u32 s48, s48, s50
    s_add_u32 s48, s48, s51
    s_add_u32 s48, s48, s52
    s_add_u32 s48, s48, s53
    s_add_u32 s48, s48, s54
    s_add_u32 s48, s48, s55
    s_add_u32 s48, s48, s56
    s_add_u32 s48, s48, s57
    s_add_u32 s70, s70, 1
    s_cmp_ge_u32 s70, 524288
    s_cbranch_scc1 L_c_done_1
    s_cmp_lt_u32 s48, 256
    s_cbranch_scc1 L_sp_4
    s_min_u32 s48, s50, 32
    s_mov_b32 s40, 0
    s_add_u32 s41, s48, s46
    s_cmp_lt_u32 s41, 32
    s_cbranch_scc1 L_got_3
    s_sub_u32 s46, s41, 32
    s_min_u32 s48, s51, 32
    s_mov_b32 s40, 1
    s_add_u32 s41, s48, s46
    s_cmp_lt_u32 s41, 32
    s_cbranch_scc1 L_got_3
    s_sub_u32 s46, s41, 32
    s_min_u32 s48, s52, 32
    s_mov_b32 s40, 2
    s_add_u32 s41, s48, s46
    s_cmp_lt_u32 s41, 32
    s_cbranch_scc1 L_got_3
    s_sub_u32 s46, s41, 32
    s_min_u32 s48, s53, 32
    s_mov_b32 s40, 3
    s_add_u32 s41, s48, s46
    s_cmp_lt_u32 s41, 32
    s_cbranch_scc1 L_got_3
    s_sub_u32 s46, s41, 32
    s_min_u32 s48, s54, 32
    s_mov_b32 s40, 4
    s_add_u32 s41, s48, s46
    s_cmp_lt_u32 s41, 32
    s_cbranch_scc1 L_got_3
    s_sub_u32 s46, s41, 32
    s_min_u32 s48, s55, 32
    s_mov_b32 s40, 5
    s_add_u32 s41, s48, s46
    s_cmp_lt_u32 s41, 32
    s_cbranch_scc1 L_got_3
    s_sub_u32 s46, s41, 32
    s_min_u32 s48, s56, 32
    s_mov_b32 s40, 6
    s_add_u32 s41, s48, s46
    s_cmp_lt_u32 s41, 32
    s_cbranch_scc1 L_got_3
    s_sub_u32 s46, s41, 32
    s_min_u32 s48, s57, 32
    s_mov_b32 s40, 7
    s_add_u32 s41, s48, s46
    s_cmp_lt_u32 s41, 32
    s_cbranch_scc1 L_got_3
    s_sub_u32 s46, s41, 32
    s_branch L_c_done_1
L_got_3:
    s_mov_b64 exec, -1
    s_lshl_b32 s45, s40, 8
    s_or_b32 s45, s45, s41
    v_mov_b32 v3, s45
    v_mov_b32 v4, 147464
    ds_write_b32 v4, v3
    s_waitcnt lgkmcnt(0)
L_tk_2:
    s_barrier
    v_mov_b32 v4, 147464
    ds_read_b32 v3, v4
    s_waitcnt lgkmcnt(0)
    v_readfirstlane_b32 s45, v3
    s_nop 3
    s_lshr_b32 s40, s45, 8
    s_and_b32 s41, s45, 0xff
    s_lshr_b32 s45, s40, 2
    s_xor_b32 s45, s45, 1
    s_lshl_b32 s45, s45, 4
    s_and_b32 s40, s40, 3
    s_lshl_b32 s40, s40, 1
    s_lshr_b32 s46, s41, 4
    s_add_u32 s40, s40, s46
    s_and_b32 s41, s41, 15
    s_add_u32 s41, s41, s45
    s_cmp_lt_u32 s41, 16
    s_cbranch_scc1 L_c_chain_7
    s_sub_u32 s48, s41, 16
    s_cmp_lt_u32 s48, 12
    s_cbranch_scc1 L_w_g_8
    s_and_b32 s42, s48, 3
    s_mov_b32 s43, s40
    s_load_dwordx2 s[4:5], s[0:1], 0
    v_lshlrev_b32 v2, 4, v1
    v_lshlrev_b32 v3, 5, v1
    s_lshl_b32 s55, s43, 2
    s_add_u32 s55, s55, s42
    s_waitcnt lgkmcnt(0)
    s_mov_b32 s24, s4
    s_and_b32 s25, s5, 0xffff
    s_mov_b32 s26, 0x400000
    s_mov_b32 s27, 0x00020000
    s_lshl_b32 s46, s42, 3
    s_add_u32 s46, s46, s44
    s_lshl_b32 s46, s46, 11
    v_add_u32 v7, s46, v2
    s_lshl_b32 s63, s43, 16
    buffer_load_dwordx4 a[0:3], v7, s[24:27], s63 offen
    buffer_load_dwordx4 a[4:7], v7, s[24:27], s63 offen offset:1024
    s_cmp_lg_u32 s44, 0
    s_cbranch_scc1 L_zwok_17
    v_and_b32 v8, 7, v1
    v_lshlrev_b32 v8, 5, v8
    s_mov_b32 s70, 0
L_zw_16:
    buffer_load_dword v9, v8, s[16:19], 0 offen sc1
    s_waitcnt vmcnt(0)
    v_add_u32_dpp v9, v9, v9 row_ror:1 row_mask:0xf bank_mask:0xf
    s_nop 1
    v_add_u32_dpp v9, v9, v9 row_ror:2 row_mask:0xf bank_mask:0xf
    s_nop 1
    v_add_u32_dpp v9, v9, v9 row_ror:4 row_mask:0xf bank_mask:0xf
    v_cmp_ne_u32 vcc, 0x100, v9
    s_add_u32 s70, s70, 1
    s_cbranch_vccz L_zwok_17
    s_sleep 4
    s_cmp_lt_u32 s70, 524288
    s_cbranch_scc1 L_zw_16
    s_branch L_c_done_1
L_zwok_17:
    s_barrier
    v_lshlrev_b32 v4, 4, v0
    s_mov_b32 s46, 0x10000
    buffer_load_dwordx4 v[32:35], v4, s[12:15], s46 offen sc1
    s_mov_b32 s46, 0x12000
    buffer_load_dwordx4 v[36:39], v4, s[12:15], s46 offen sc1
    s_mov_b32 s46, 0x14000
    buffer_load_dwordx4 v[40:43], v4, s[12:15], s46 offen sc1
    s_mov_b32 s46, 0x16000
    buffer_load_dwordx4 v[44:47], v4, s[12:15], s46 offen sc1
    s_mov_b32 s46, 0x18000
    buffer_load_dwordx4 v[48:51], v4, s[12:15], s46 offen sc1
    s_mov_b32 s46, 0x1a000
    buffer_load_dwordx4 v[52:55], v4, s[12:15], s46 offen sc1
    s_mov_b32 s46, 0x1c000
    buffer_load_dwordx4 v[56:59], v4, s[12:15], s46 offen sc1
    s_mov_b32 s46, 0x1e000
    buffer_load_dwordx4 v[60:63], v4, s[12:15], s46 offen sc1
    s_cmp_lg_u32 s44, 0
    s_cbranch_scc1 L_l_nx_18
    s_cmp_ge_u32 s42, 2
    s_cbranch_scc1 L_l_nx_18
    s_or_b32 s47, s39, 0x100
    v_mov_b32 v8, s47
    v_mov_b32 v9, 0
    s_lshl_b32 s46, s40, 3
    s_lshl_b32 s47, s42, 2
    s_add_u32 s46, s46, s47
    s_add_u32 s46, s46, 0x101200
    s_mov_b64 exec, 1
    buffer_store_dword v8, v9, s[12:15], s46 offen sc1
    s_mov_b64 exec, -1
L_l_nx_18:
    s_mul_i32 s46, s44, 2064
    s_add_u32 s46, s46, 32768
    v_add_u32 v10, s46, v2
    v_and_b32 v11, 7, v1
    v_lshrrev_b32 v12, 3, v1
    v_mul_u32_u24 v13, 2064, v11
    v_lshl_add_u32 v13, v12, 4, v13
    s_lshl_b32 s46, s44, 8
    s_add_u32 s46, s46, 32768
    v_add_u32 v13, s46, v13
    v_lshlrev_b32 v11, 4, v11
    v_lshl_add_u32 v11, v12, 9, v11
    s_lshl_b32 s46, s44, 13
    s_lshl_b32 s47, s42, 7
    s_add_u32 s46, s46, s47
    s_add_u32 s46, s46, 0x400000
    v_add_u32 v11, s46, v11
    v_add_u32 v12, 4096, v11
    s_lshl_b32 s52, s43, 9
    s_lshl_b32 s47, s42, 7
    s_add_u32 s52, s52, s47
    s_add_u32 s52, s52, 0x109400
    s_mov_b32 s60, s43
    s_waitcnt vmcnt(0)
    v_add_f32 v32, v32, v48
    v_add_f32 v33, v33, v49
    v_add_f32 v34, v34, v50
    v_add_f32 v35, v35, v51
    v_add_f32 v36, v36, v52
    v_add_f32 v37, v37, v53
    v_add_f32 v38, v38, v54
    v_add_f32 v39, v39, v55
    v_add_f32 v40, v40, v56
    v_add_f32 v41, v41, v57
    v_add_f32 v42, v42, v58
    v_add_f32 v43, v43, v59
    v_add_f32 v44, v44, v60
    v_add_f32 v45, v45, v61
    v_add_f32 v46, v46, v62
    v_add_f32 v47, v47, v63
    v_add_f32 v32, v32, v40
    v_add_f32 v33, v33, v41
    v_add_f32 v34, v34, v42
    v_add_f32 v35, v35, v43
    v_add_f32 v36, v36, v44
    v_add_f32 v37, v37, v45
    v_add_f32 v38, v38, v46
    v_add_f32 v39, v39, v47
    v_add_f32 v32, v32, v36
    v_add_f32 v33, v33, v37
    v_add_f32 v34, v34, v38
    v_add_f32 v35, v35, v39
    v_cvt_pk_bf16_f32 v32, 0, v32
    v_cvt_pk_bf16_f32 v33, 0, v33
    v_cvt_pk_bf16_f32 v34, 0, v34
    v_cvt_pk_bf16_f32 v35, 0, v35
    ds_write_b128 v4, v[32:35]
    s_waitcnt lgkmcnt(0)
    s_barrier
    ds_read_b128 v[48:51], v3 offset:0
    ds_read_b128 v[52:55], v3 offset:16
    ds_read_b128 v[56:59], v3 offset:2048
    ds_read_b128 v[60:63], v3 offset:2064
    ds_read_b128 v[32:35], v3 offset:4096
    ds_read_b128 v[36:39], v3 offset:4112
    ds_read_b128 v[40:43], v3 offset:6144
    ds_read_b128 v[44:47], v3 offset:6160
    s_waitcnt lgkmcnt(0)
    v_add_f32 v32, 1.0, v32
    v_add_f32 v33, 1.0, v33
    v_add_f32 v34, 1.0, v34
    v_add_f32 v35, 1.0, v35
    v_add_f32 v36, 1.0, v36
    v_add_f32 v37, 1.0, v37
    v_add_f32 v38, 1.0, v38
    v_add_f32 v39, 1.0, v39
    v_add_f32 v40, 1.0, v40
    v_add_f32 v41, 1.0, v41
    v_add_f32 v42, 1.0, v42
    v_add_f32 v43, 1.0, v43
    v_add_f32 v44, 1.0, v44
    v_add_f32 v45, 1.0, v45
    v_add_f32 v46, 1.0, v46
    v_add_f32 v47, 1.0, v47
    v_cvt_pk_bf16_f32 v32, 0, v32
    v_cvt_pk_bf16_f32 v33, 0, v33
    v_cvt_pk_bf16_f32 v34, 0, v34
    v_cvt_pk_bf16_f32 v35, 0, v35
    v_cvt_pk_bf16_f32 v36, 0, v36
    v_cvt_pk_bf16_f32 v37, 0, v37
    v_cvt_pk_bf16_f32 v38, 0, v38
    v_cvt_pk_bf16_f32 v39, 0, v39
    v_cvt_pk_bf16_f32 v40, 0, v40
    v_cvt_pk_bf16_f32 v41, 0, v41
    v_cvt_pk_bf16_f32 v42, 0, v42
    v_cvt_pk_bf16_f32 v43, 0, v43
    v_cvt_pk_bf16_f32 v44, 0, v44
    v_cvt_pk_bf16_f32 v45, 0, v45
    v_cvt_pk_bf16_f32 v46, 0, v46
    v_cvt_pk_bf16_f32 v47, 0, v47
L_l_sub_19:
    s_lshl_b32 s63, s60, 16
    v_accvgpr_read_b32 v96, a0
    v_accvgpr_read_b32 v97, a1
    v_accvgpr_read_b32 v98, a2
    v_accvgpr_read_b32 v99, a3
    v_accvgpr_read_b32 v100, a4
    v_accvgpr_read_b32 v101, a5
    v_accvgpr_read_b32 v102, a6
    v_accvgpr_read_b32 v103, a7
    v_lshlrev_b32 v64, 16, v96
    v_and_b32 v65, 0xffff0000, v96
    v_lshlrev_b32 v66, 16, v97
    v_and_b32 v67, 0xffff0000, v97
    v_lshlrev_b32 v68, 16, v98
    v_and_b32 v69, 0xffff0000, v98
    v_lshlrev_b32 v70, 16, v99
    v_and_b32 v71, 0xffff0000, v99
    v_lshlrev_b32 v72, 16, v100
    v_and_b32 v73, 0xffff0000, v100
    v_lshlrev_b32 v74, 16, v101
    v_and_b32 v75, 0xffff0000, v101
    v_lshlrev_b32 v76, 16, v102
    v_and_b32 v77, 0xffff0000, v102
    v_lshlrev_b32 v78, 16, v103
    v_and_b32 v79, 0xffff0000, v103
    v_pk_add_f32 v[80:81], v[64:65], v[72:73]
    v_pk_add_f32 v[82:83], v[66:67], v[74:75]
    v_pk_add_f32 v[84:85], v[68:69], v[76:77]
    v_pk_add_f32 v[86:87], v[70:71], v[78:79]
    v_pk_add_f32 v[80:81], v[80:81], v[84:85]
    v_pk_add_f32 v[82:83], v[82:83], v[86:87]
    v_pk_add_f32 v[80:81], v[80:81], v[82:83]
    v_add_f32 v14, v80, v81
    s_nop 1
    v_add_f32_dpp v14, v14, v14 row_shr:1 row_mask:0xf bank_mask:0xf bound_ctrl:0
    s_nop 1
    v_add_f32_dpp v14, v14, v14 row_shr:2 row_mask:0xf bank_mask:0xf bound_ctrl:0
    s_nop 1
    v_add_f32_dpp v14, v14, v14 row_shr:4 row_mask:0xf bank_mask:0xf bound_ctrl:0
    s_nop 1
    v_add_f32_dpp v14, v14, v14 row_shr:8 row_mask:0xf bank_mask:0xf bound_ctrl:0
    s_nop 1
    v_add_f32_dpp v14, v14, v14 row_bcast:15 row_mask:0xa bank_mask:0xf
    s_nop 1
    v_add_f32_dpp v14, v14, v14 row_bcast:31 row_mask:0xc bank_mask:0xf
    s_nop 1
    v_readlane_b32 s46, v14, 63
    s_nop 1
    v_mov_b32 v15, s46
    v_mul_f32 v15, 0x3a800000, v15
    v_pk_add_f32 v[80:81], v[64:65], v[14:15] op_sel:[0,1] op_sel_hi:[1,1] neg_lo:[0,1] neg_hi:[0,1]
    v_pk_add_f32 v[82:83], v[66:67], v[14:15] op_sel:[0,1] op_sel_hi:[1,1] neg_lo:[0,1] neg_hi:[0,1]
    v_pk_add_f32 v[84:85], v[68:69], v[14:15] op_sel:[0,1] op_sel_hi:[1,1] neg_lo:[0,1] neg_hi:[0,1]
    v_pk_add_f32 v[86:87], v[70:71], v[14:15] op_sel:[0,1] op_sel_hi:[1,1] neg_lo:[0,1] neg_hi:[0,1]
    v_pk_add_f32 v[88:89], v[72:73], v[14:15] op_sel:[0,1] op_sel_hi:[1,1] neg_lo:[0,1] neg_hi:[0,1]
    v_pk_add_f32 v[90:91], v[74:75], v[14:15] op_sel:[0,1] op_sel_hi:[1,1] neg_lo:[0,1] neg_hi:[0,1]
    v_pk_add_f32 v[92:93], v[76:77], v[14:15] op_sel:[0,1] op_sel_hi:[1,1] neg_lo:[0,1] neg_hi:[0,1]
    v_pk_add_f32 v[94:95], v[78:79], v[14:15] op_sel:[0,1] op_sel_hi:[1,1] neg_lo:[0,1] neg_hi:[0,1]
    v_pk_mul_f32 v[104:105], v[80:81], v[80:81]
    v_pk_mul_f32 v[106:107], v[82:83], v[82:83]
    v_pk_fma_f32 v[104:105], v[84:85], v[84:85], v[104:105]
    v_pk_fma_f32 v[106:107], v[86:87], v[86:87], v[106:107]
    v_pk_fma_f32 v[104:105], v[88:89], v[88:89], v[104:105]
    v_pk_fma_f32 v[106:107], v[90:91], v[90:91], v[106:107]
    v_pk_fma_f32 v[104:105], v[92:93], v[92:93], v[104:105]
    v_pk_fma_f32 v[106:107], v[94:95], v[94:95], v[106:107]
    v_pk_add_f32 v[104:105], v[104:105], v[106:107]
    v_add_f32 v14, v104, v105
    v_cvt_pk_bf16_f32 v15, 0, v15
    s_nop 1
    v_add_f32_dpp v14, v14, v14 row_shr:1 row_mask:0xf bank_mask:0xf bound_ctrl:0
    s_nop 1
    v_add_f32_dpp v14, v14, v14 row_shr:2 row_mask:0xf bank_mask:0xf bound_ctrl:0
    s_nop 1
    v_add_f32_dpp v14, v14, v14 row_shr:4 row_mask:0xf bank_mask:0xf bound_ctrl:0
    s_nop 1
    v_add_f32_dpp v14, v14, v14 row_shr:8 row_mask:0xf bank_mask:0xf bound_ctrl:0
    s_nop 1
    v_add_f32_dpp v14, v14, v14 row_bcast:15 row_mask:0xa bank_mask:0xf
    s_nop 1
    v_add_f32_dpp v14, v14, v14 row_bcast:31 row_mask:0xc bank_mask:0xf
    s_nop 1
    v_readlane_b32 s47, v14, 63
    v_pk_add_f32 v[64:65], v[64:65], v[14:15] op_sel:[0,1] op_sel_hi:[1,1] neg_lo:[0,1] neg_hi:[0,1]
    v_pk_add_f32 v[66:67], v[66:67], v[14:15] op_sel:[0,1] op_sel_hi:[1,1] neg_lo:[0,1] neg_hi:[0,1]
    v_pk_add_f32 v[68:69], v[68:69], v[14:15] op_sel:[0,1] op_sel_hi:[1,1] neg_lo:[0,1] neg_hi:[0,1]
    v_pk_add_f32 v[70:71], v[70:71], v[14:15] op_sel:[0,1] op_sel_hi:[1,1] neg_lo:[0,1] neg_hi:[0,1]
    v_pk_add_f32 v[72:73], v[72:73], v[14:15] op_sel:[0,1] op_sel_hi:[1,1] neg_lo:[0,1] neg_hi:[0,1]
    v_pk_add_f32 v[74:75], v[74:75], v[14:15] op_sel:[0,1] op_sel_hi:[1,1] neg_lo:[0,1] neg_hi:[0,1]
    v_pk_add_f32 v[76:77], v[76:77], v[14:15] op_sel:[0,1] op_sel_hi:[1,1] neg_lo:[0,1] neg_hi:[0,1]
    v_pk_add_f32 v[78:79], v[78:79], v[14:15] op_sel:[0,1] op_sel_hi:[1,1] neg_lo:[0,1] neg_hi:[0,1]
    v_mov_b32 v14, s47
    v_mul_f32 v14, 0x3a800000, v14
    v_cvt_pk_bf16_f32 v14, 0, v14
    v_add_f32 v14, 0x3727c5ac, v14
    v_cvt_pk_bf16_f32 v14, 0, v14
    v_sqrt_f32 v14, v14
    s_nop 0
    v_cvt_pk_bf16_f32 v14, 0, v14
    v_rcp_f32 v14, v14
    v_cvt_pk_bf16_f32 v64, 0, v64
    v_cvt_pk_bf16_f32 v65, 0, v65
    v_cvt_pk_bf16_f32 v66, 0, v66
    v_cvt_pk_bf16_f32 v67, 0, v67
    v_cvt_pk_bf16_f32 v68, 0, v68
    v_cvt_pk_bf16_f32 v69, 0, v69
    v_cvt_pk_bf16_f32 v70, 0, v70
    v_cvt_pk_bf16_f32 v71, 0, v71
    v_cvt_pk_bf16_f32 v72, 0, v72
    v_cvt_pk_bf16_f32 v73, 0, v73
    v_cvt_pk_bf16_f32 v74, 0, v74
    v_cvt_pk_bf16_f32 v75, 0, v75
    v_cvt_pk_bf16_f32 v76, 0, v76
    v_cvt_pk_bf16_f32 v77, 0, v77
    v_cvt_pk_bf16_f32 v78, 0, v78
    v_cvt_pk_bf16_f32 v79, 0, v79
    v_pk_mul_f32 v[64:65], v[64:65], v[14:15] op_sel_hi:[1,0]
    v_pk_mul_f32 v[66:67], v[66:67], v[14:15] op_sel_hi:[1,0]
    v_pk_mul_f32 v[68:69], v[68:69], v[14:15] op_sel_hi:[1,0]
    v_pk_mul_f32 v[70:71], v[70:71], v[14:15] op_sel_hi:[1,0]
    v_pk_mul_f32 v[72:73], v[72:73], v[14:15] op_sel_hi:[1,0]
    v_pk_mul_f32 v[74:75], v[74:75], v[14:15] op_sel_hi:[1,0]
    v_pk_mul_f32 v[76:77], v[76:77], v[14:15] op_sel_hi:[1,0]
    v_pk_mul_f32 v[78:79], v[78:79], v[14:15] op_sel_hi:[1,0]
    v_cvt_pk_bf16_f32 v64, 0, v64
    v_cvt_pk_bf16_f32 v65, 0, v65
    v_cvt_pk_bf16_f32 v66, 0, v66
    v_cvt_pk_bf16_f32 v67, 0, v67
    v_cvt_pk_bf16_f32 v68, 0, v68
    v_cvt_pk_bf16_f32 v69, 0, v69
    v_cvt_pk_bf16_f32 v70, 0, v70
    v_cvt_pk_bf16_f32 v71, 0, v71
    v_cvt_pk_bf16_f32 v72, 0, v72
    v_cvt_pk_bf16_f32 v73, 0, v73
    v_cvt_pk_bf16_f32 v74, 0, v74
    v_cvt_pk_bf16_f32 v75, 0, v75
    v_cvt_pk_bf16_f32 v76, 0, v76
    v_cvt_pk_bf16_f32 v77, 0, v77
    v_cvt_pk_bf16_f32 v78, 0, v78
    v_cvt_pk_bf16_f32 v79, 0, v79
    v_pk_mul_f32 v[64:65], v[64:65], v[32:33]
    v_pk_mul_f32 v[66:67], v[66:67], v[34:35]
    v_pk_mul_f32 v[68:69], v[68:69], v[36:37]
    v_pk_mul_f32 v[70:71], v[70:71], v[38:39]
    v_pk_mul_f32 v[72:73], v[72:73], v[40:41]
    v_pk_mul_f32 v[74:75], v[74:75], v[42:43]
    v_pk_mul_f32 v[76:77], v[76:77], v[44:45]
    v_pk_mul_f32 v[78:79], v[78:79], v[46:47]
    v_cvt_pk_bf16_f32 v64, 0, v64
    v_cvt_pk_bf16_f32 v65, 0, v65
    v_cvt_pk_bf16_f32 v66, 0, v66
    v_cvt_pk_bf16_f32 v67, 0, v67
    v_cvt_pk_bf16_f32 v68, 0, v68
    v_cvt_pk_bf16_f32 v69, 0, v69
    v_cvt_pk_bf16_f32 v70, 0, v70
    v_cvt_pk_bf16_f32 v71, 0, v71
    v_cvt_pk_bf16_f32 v72, 0, v72
    v_cvt_pk_bf16_f32 v73, 0, v73
    v_cvt_pk_bf16_f32 v74, 0, v74
    v_cvt_pk_bf16_f32 v75, 0, v75
    v_cvt_pk_bf16_f32 v76, 0, v76
    v_cvt_pk_bf16_f32 v77, 0, v77
    v_cvt_pk_bf16_f32 v78, 0, v78
    v_cvt_pk_bf16_f32 v79, 0, v79
    v_pk_add_f32 v[64:65], v[64:65], v[48:49]
    v_pk_add_f32 v[66:67], v[66:67], v[50:51]
    v_pk_add_f32 v[68:69], v[68:69], v[52:53]
    v_pk_add_f32 v[70:71], v[70:71], v[54:55]
    v_pk_add_f32 v[72:73], v[72:73], v[56:57]
    v_pk_add_f32 v[74:75], v[74:75], v[58:59]
    v_pk_add_f32 v[76:77], v[76:77], v[60:61]
    v_pk_add_f32 v[78:79], v[78:79], v[62:63]
    v_cvt_pk_bf16_f32 v104, v64, v65
    v_cvt_pk_bf16_f32 v105, v66, v67
    v_cvt_pk_bf16_f32 v106, v68, v69
    v_cvt_pk_bf16_f32 v107, v70, v71
    v_cvt_pk_bf16_f32 v108, v72, v73
    v_cvt_pk_bf16_f32 v109, v74, v75
    v_cvt_pk_bf16_f32 v110, v76, v77
    v_cvt_pk_bf16_f32 v111, v78, v79
    ds_write_b128 v10, v[104:107]
    ds_write_b128 v10, v[108:111] offset:1024
    s_waitcnt lgkmcnt(0)
    s_barrier
    ds_read_b128 v[104:107], v13
    ds_read_b128 v[108:111], v13 offset:128
    s_waitcnt lgkmcnt(1)
    buffer_store_dwordx4 v[104:107], v11, s[12:15], s63 offen sc1
    s_waitcnt lgkmcnt(0)
    buffer_store_dwordx4 v[108:111], v12, s[12:15], s63 offen sc1
    s_waitcnt vmcnt(0)
    s_barrier
    s_cmp_lg_u32 s44, 0
    s_cbranch_scc1 L_sf_21
    v_mov_b32 v14, s60
    v_add_u32 v14, 1, v14
    v_mov_b32 v15, 0
    s_mov_b64 exec, 1
    buffer_store_dword v14, v15, s[12:15], s52 offen sc1
    s_mov_b64 exec, -1
L_sf_21:
    s_cmp_ge_u32 s60, 8
    s_cbranch_scc1 L_l_end_20
    s_add_u32 s63, s63, 524288
    buffer_load_dwordx4 a[8:11], v7, s[24:27], s63 offen
    buffer_load_dwordx4 a[12:15], v7, s[24:27], s63 offen offset:1024
    s_add_u32 s63, s63, 524288
    buffer_load_dwordx4 a[16:19], v7, s[24:27], s63 offen
    buffer_load_dwordx4 a[20:23], v7, s[24:27], s63 offen offset:1024
    s_add_u32 s63, s63, 524288
    buffer_load_dwordx4 a[24:27], v7, s[24:27], s63 offen
    buffer_load_dwordx4 a[28:31], v7, s[24:27], s63 offen offset:1024
    s_add_u32 s63, s63, 524288
    buffer_load_dwordx4 a[32:35], v7, s[24:27], s63 offen
    buffer_load_dwordx4 a[36:39], v7, s[24:27], s63 offen offset:1024
    s_add_u32 s63, s63, 524288
    buffer_load_dwordx4 a[40:43], v7, s[24:27], s63 offen
    buffer_load_dwordx4 a[44:47], v7, s[24:27], s63 offen offset:1024
    s_add_u32 s63, s63, 524288
    buffer_load_dwordx4 a[48:51], v7, s[24:27], s63 offen
    buffer_load_dwordx4 a[52:55], v7, s[24:27], s63 offen offset:1024
    s_add_u32 s63, s63, 524288
    buffer_load_dwordx4 a[56:59], v7, s[24:27], s63 offen
    buffer_load_dwordx4 a[60:63], v7, s[24:27], s63 offen offset:1024
    s_waitcnt vmcnt(0)
L_l_end_20:
    v_accvgpr_mov_b32 a0, a8
    v_accvgpr_mov_b32 a1, a9
    v_accvgpr_mov_b32 a2, a10
    v_accvgpr_mov_b32 a3, a11
    v_accvgpr_mov_b32 a4, a12
    v_accvgpr_mov_b32 a5, a13
    v_accvgpr_mov_b32 a6, a14
    v_accvgpr_mov_b32 a7, a15
    v_accvgpr_mov_b32 a8, a16
    v_accvgpr_mov_b32 a9, a17
    v_accvgpr_mov_b32 a10, a18
    v_accvgpr_mov_b32 a11, a19
    v_accvgpr_mov_b32 a12, a20
    v_accvgpr_mov_b32 a13, a21
    v_accvgpr_mov_b32 a14, a22
    v_accvgpr_mov_b32 a15, a23
    v_accvgpr_mov_b32 a16, a24
    v_accvgpr_mov_b32 a17, a25
    v_accvgpr_mov_b32 a18, a26
    v_accvgpr_mov_b32 a19, a27
    v_accvgpr_mov_b32 a20, a28
    v_accvgpr_mov_b32 a21, a29
    v_accvgpr_mov_b32 a22, a30
    v_accvgpr_mov_b32 a23, a31
    v_accvgpr_mov_b32 a24, a32
    v_accvgpr_mov_b32 a25, a33
    v_accvgpr_mov_b32 a26, a34
    v_accvgpr_mov_b32 a27, a35
    v_accvgpr_mov_b32 a28, a36
    v_accvgpr_mov_b32 a29, a37
    v_accvgpr_mov_b32 a30, a38
    v_accvgpr_mov_b32 a31, a39
    v_accvgpr_mov_b32 a32, a40
    v_accvgpr_mov_b32 a33, a41
    v_accvgpr_mov_b32 a34, a42
    v_accvgpr_mov_b32 a35, a43
    v_accvgpr_mov_b32 a36, a44
    v_accvgpr_mov_b32 a37, a45
    v_accvgpr_mov_b32 a38, a46
    v_accvgpr_mov_b32 a39, a47
    v_accvgpr_mov_b32 a40, a48
    v_accvgpr_mov_b32 a41, a49
    v_accvgpr_mov_b32 a42, a50
    v_accvgpr_mov_b32 a43, a51
    v_accvgpr_mov_b32 a44, a52
    v_accvgpr_mov_b32 a45, a53
    v_accvgpr_mov_b32 a46, a54
    v_accvgpr_mov_b32 a47, a55
    v_accvgpr_mov_b32 a48, a56
    v_accvgpr_mov_b32 a49, a57
    v_accvgpr_mov_b32 a50, a58
    v_accvgpr_mov_b32 a51, a59
    v_accvgpr_mov_b32 a52, a60
    v_accvgpr_mov_b32 a53, a61
    v_accvgpr_mov_b32 a54, a62
    v_accvgpr_mov_b32 a55, a63
    s_add_u32 s60, s60, 8
    s_cmp_lt_u32 s60, 64
    s_cbranch_scc1 L_l_sub_19
    s_cmp_lt_u32 s48, 14
    s_cbranch_scc1 L_w_att_13
    s_and_b32 s55, s48, 1
    s_lshl_b32 s55, s55, 3
    s_add_u32 s55, s55, s40
    s_load_dwordx4 s[8:11], s[0:1], 96
    v_lshrrev_b32 v5, 3, v0
    s_mov_b32 s46, 196608
    v_mul_lo_u32 v4, v5, s46
    v_and_b32 v6, 7, v0
    v_lshl_add_u32 v4, v6, 4, v4
    v_lshlrev_b32 v5, 5, v5
    s_waitcnt lgkmcnt(0)
    s_mov_b32 s28, s10
    s_and_b32 s29, s11, 0xffff
    s_mov_b32 s30, 0xc00000
    s_mov_b32 s31, 0x00020000
    s_mov_b32 s32, s8
    s_and_b32 s33, s9, 0xffff
    s_mov_b32 s34, 0x800
    s_mov_b32 s35, 0x00020000
    buffer_load_dwordx4 v[8:11], v5, s[32:35], 0 offen
    buffer_load_dwordx4 v[12:15], v5, s[32:35], 0 offen offset:16
    s_waitcnt vmcnt(0)
    v_lshlrev_b32 v16, 16, v8
    v_and_b32 v17, 0xffff0000, v8
    v_lshlrev_b32 v18, 16, v9
    v_and_b32 v19, 0xffff0000, v9
    v_lshlrev_b32 v20, 16, v10
    v_and_b32 v21, 0xffff0000, v10
    v_lshlrev_b32 v22, 16, v11
    v_and_b32 v23, 0xffff0000, v11
    v_lshlrev_b32 v24, 16, v12
    v_and_b32 v25, 0xffff0000, v12
    v_lshlrev_b32 v26, 16, v13
    v_and_b32 v27, 0xffff0000, v13
    v_lshlrev_b32 v28, 16, v14
    v_and_b32 v29, 0xffff0000, v14
    v_lshlrev_b32 v30, 16, v15
    v_and_b32 v31, 0xffff0000, v15
    v_mul_f32 v112, 0xbfb8aa3b, v16
    v_mul_f32 v113, 0xbfb8aa3b, v17
    v_mul_f32 v114, 0xbfb8aa3b, v18
    v_mul_f32 v115, 0xbfb8aa3b, v19
    v_mul_f32 v116, 0xbfb8aa3b, v20
    v_mul_f32 v117, 0xbfb8aa3b, v21
    v_mul_f32 v118, 0xbfb8aa3b, v22
    v_mul_f32 v119, 0xbfb8aa3b, v23
    v_mul_f32 v120, 0xbfb8aa3b, v24
    v_mul_f32 v121, 0xbfb8aa3b, v25
    v_mul_f32 v122, 0xbfb8aa3b, v26
    v_mul_f32 v123, 0xbfb8aa3b, v27
    v_mul_f32 v124, 0xbfb8aa3b, v28
    v_mul_f32 v125, 0xbfb8aa3b, v29
    v_mul_f32 v126, 0xbfb8aa3b, v30
    v_mul_f32 v127, 0xbfb8aa3b, v31
    v_exp_f32 v112, v112
    v_exp_f32 v113, v113
    v_exp_f32 v114, v114
    v_exp_f32 v115, v115
    v_exp_f32 v116, v116
    v_exp_f32 v117, v117
    v_exp_f32 v118, v118
    v_exp_f32 v119, v119
    v_exp_f32 v120, v120
    v_exp_f32 v121, v121
    v_exp_f32 v122, v122
    v_exp_f32 v123, v123
    v_exp_f32 v124, v124
    v_exp_f32 v125, v125
    v_exp_f32 v126, v126
    v_exp_f32 v127, v127
    v_add_f32 v112, 1.0, v112
    v_add_f32 v113, 1.0, v113
    v_add_f32 v114, 1.0, v114
    v_add_f32 v115, 1.0, v115
    v_add_f32 v116, 1.0, v116
    v_add_f32 v117, 1.0, v117
    v_add_f32 v118, 1.0, v118
    v_add_f32 v119, 1.0, v119
    v_add_f32 v120, 1.0, v120
    v_add_f32 v121, 1.0, v121
    v_add_f32 v122, 1.0, v122
    v_add_f32 v123, 1.0, v123
    v_add_f32 v124, 1.0, v124
    v_add_f32 v125, 1.0, v125
    v_add_f32 v126, 1.0, v126
    v_add_f32 v127, 1.0, v127
    v_rcp_f32 v112, v112
    v_rcp_f32 v113, v113
    v_rcp_f32 v114, v114
    v_rcp_f32 v115, v115
    v_rcp_f32 v116, v116
    v_rcp_f32 v117, v117
    v_rcp_f32 v118, v118
    v_rcp_f32 v119, v119
    v_rcp_f32 v120, v120
    v_rcp_f32 v121, v121
    v_rcp_f32 v122, v122
    v_rcp_f32 v123, v123
    v_rcp_f32 v124, v124
    v_rcp_f32 v125, v125
    v_rcp_f32 v126, v126
    v_rcp_f32 v127, v127
    v_mul_f32 v16, v16, v112
    v_mul_f32 v17, v17, v113
    v_mul_f32 v18, v18, v114
    v_mul_f32 v19, v19, v115
    v_mul_f32 v20, v20, v116
    v_mul_f32 v21, v21, v117
    v_mul_f32 v22, v22, v118
    v_mul_f32 v23, v23, v119
    v_mul_f32 v24, v24, v120
    v_mul_f32 v25, v25, v121
    v_mul_f32 v26, v26, v122
    v_mul_f32 v27, v27, v123
    v_mul_f32 v28, v28, v124
    v_mul_f32 v29, v29, v125
    v_mul_f32 v30, v30, v126
    v_mul_f32 v31, v31, v127
    v_cvt_pk_bf16_f32 v16, 0, v16
    v_cvt_pk_bf16_f32 v17, 0, v17
    v_cvt_pk_bf16_f32 v18, 0, v18
    v_cvt_pk_bf16_f32 v19, 0, v19
    v_cvt_pk_bf16_f32 v20, 0, v20
    v_cvt_pk_bf16_f32 v21, 0, v21
    v_cvt_pk_bf16_f32 v22, 0, v22
    v_cvt_pk_bf16_f32 v23, 0, v23
    v_cvt_pk_bf16_f32 v24, 0, v24
    v_cvt_pk_bf16_f32 v25, 0, v25
    v_cvt_pk_bf16_f32 v26, 0, v26
    v_cvt_pk_bf16_f32 v27, 0, v27
    v_cvt_pk_bf16_f32 v28, 0, v28
    v_cvt_pk_bf16_f32 v29, 0, v29
    v_cvt_pk_bf16_f32 v30, 0, v30
    v_cvt_pk_bf16_f32 v31, 0, v31
    s_lshl_b32 s53, s55, 9
    s_add_u32 s53, s53, 4096
L_m_loop_22:
    s_add_u32 s46, s53, 0
    buffer_load_dwordx4 v[32:35], v4, s[28:31], s46 offen
    s_add_u32 s46, s53, 12288
    buffer_load_dwordx4 v[36:39], v4, s[28:31], s46 offen
    s_add_u32 s46, s53, 24576
    buffer_load_dwordx4 v[40:43], v4, s[28:31], s46 offen
    s_add_u32 s46, s53, 36864
    buffer_load_dwordx4 v[44:47], v4, s[28:31], s46 offen
    s_add_u32 s46, s53, 49152
    buffer_load_dwordx4 v[48:51], v4, s[28:31], s46 offen
    s_add_u32 s46, s53, 61440
    buffer_load_dwordx4 v[52:55], v4, s[28:31], s46 offen
    s_add_u32 s46, s53, 73728
    buffer_load_dwordx4 v[56:59], v4, s[28:31], s46 offen
    s_add_u32 s46, s53, 86016
    buffer_load_dwordx4 v[60:63], v4, s[28:31], s46 offen
    s_add_u32 s46, s53, 98304
    buffer_load_dwordx4 v[64:67], v4, s[28:31], s46 offen
    s_add_u32 s46, s53, 110592
    buffer_load_dwordx4 v[68:71], v4, s[28:31], s46 offen
    s_add_u32 s46, s53, 122880
    buffer_load_dwordx4 v[72:75], v4, s[28:31], s46 offen
    s_add_u32 s46, s53, 135168
    buffer_load_dwordx4 v[76:79], v4, s[28:31], s46 offen
    s_add_u32 s46, s53, 147456
    buffer_load_dwordx4 v[80:83], v4, s[28:31], s46 offen
    s_add_u32 s46, s53, 159744
    buffer_load_dwordx4 v[84:87], v4, s[28:31], s46 offen
    s_add_u32 s46, s53, 172032
    buffer_load_dwordx4 v[88:91], v4, s[28:31], s46 offen
    s_add_u32 s46, s53, 184320
    buffer_load_dwordx4 v[92:95], v4, s[28:31], s46 offen
    s_waitcnt vmcnt(15)
    v_lshlrev_b32 v104, 16, v32
    v_and_b32 v105, 0xffff0000, v32
    v_mul_f32 v96, v104, v16
    v_mul_f32 v97, v105, v16
    v_lshlrev_b32 v104, 16, v33
    v_and_b32 v105, 0xffff0000, v33
    v_mul_f32 v98, v104, v16
    v_mul_f32 v99, v105, v16
    v_lshlrev_b32 v104, 16, v34
    v_and_b32 v105, 0xffff0000, v34
    v_mul_f32 v100, v104, v16
    v_mul_f32 v101, v105, v16
    v_lshlrev_b32 v104, 16, v35
    v_and_b32 v105, 0xffff0000, v35
    v_mul_f32 v102, v104, v16
    v_mul_f32 v103, v105, v16
    s_waitcnt vmcnt(14)
    v_lshlrev_b32 v104, 16, v36
    v_and_b32 v105, 0xffff0000, v36
    v_fmac_f32 v96, v104, v17
    v_fmac_f32 v97, v105, v17
    v_lshlrev_b32 v104, 16, v37
    v_and_b32 v105, 0xffff0000, v37
    v_fmac_f32 v98, v104, v17
    v_fmac_f32 v99, v105, v17
    v_lshlrev_b32 v104, 16, v38
    v_and_b32 v105, 0xffff0000, v38
    v_fmac_f32 v100, v104, v17
    v_fmac_f32 v101, v105, v17
    v_lshlrev_b32 v104, 16, v39
    v_and_b32 v105, 0xffff0000, v39
    v_fmac_f32 v102, v104, v17
    v_fmac_f32 v103, v105, v17
    s_waitcnt vmcnt(13)
    v_lshlrev_b32 v104, 16, v40
    v_and_b32 v105, 0xffff0000, v40
    v_fmac_f32 v96, v104, v18
    v_fmac_f32 v97, v105, v18
    v_lshlrev_b32 v104, 16, v41
    v_and_b32 v105, 0xffff0000, v41
    v_fmac_f32 v98, v104, v18
    v_fmac_f32 v99, v105, v18
    v_lshlrev_b32 v104, 16, v42
    v_and_b32 v105, 0xffff0000, v42
    v_fmac_f32 v100, v104, v18
    v_fmac_f32 v101, v105, v18
    v_lshlrev_b32 v104, 16, v43
    v_and_b32 v105, 0xffff0000, v43
    v_fmac_f32 v102, v104, v18
    v_fmac_f32 v103, v105, v18
    s_waitcnt vmcnt(12)
    v_lshlrev_b32 v104, 16, v44
    v_and_b32 v105, 0xffff0000, v44
    v_fmac_f32 v96, v104, v19
    v_fmac_f32 v97, v105, v19
    v_lshlrev_b32 v104, 16, v45
    v_and_b32 v105, 0xffff0000, v45
    v_fmac_f32 v98, v104, v19
    v_fmac_f32 v99, v105, v19
    v_lshlrev_b32 v104, 16, v46
    v_and_b32 v105, 0xffff0000, v46
    v_fmac_f32 v100, v104, v19
    v_fmac_f32 v101, v105, v19
    v_lshlrev_b32 v104, 16, v47
    v_and_b32 v105, 0xffff0000, v47
    v_fmac_f32 v102, v104, v19
    v_fmac_f32 v103, v105, v19
    s_waitcnt vmcnt(11)
    v_lshlrev_b32 v104, 16, v48
    v_and_b32 v105, 0xffff0000, v48
    v_fmac_f32 v96, v104, v20
    v_fmac_f32 v97, v105, v20
    v_lshlrev_b32 v104, 16, v49
    v_and_b32 v105, 0xffff0000, v49
    v_fmac_f32 v98, v104, v20
    v_fmac_f32 v99, v105, v20
    v_lshlrev_b32 v104, 16, v50
    v_and_b32 v105, 0xffff0000, v50
    v_fmac_f32 v100, v104, v20
    v_fmac_f32 v101, v105, v20
    v_lshlrev_b32 v104, 16, v51
    v_and_b32 v105, 0xffff0000, v51
    v_fmac_f32 v102, v104, v20
    v_fmac_f32 v103, v105, v20
    s_waitcnt vmcnt(10)
    v_lshlrev_b32 v104, 16, v52
    v_and_b32 v105, 0xffff0000, v52
    v_fmac_f32 v96, v104, v21
    v_fmac_f32 v97, v105, v21
    v_lshlrev_b32 v104, 16, v53
    v_and_b32 v105, 0xffff0000, v53
    v_fmac_f32 v98, v104, v21
    v_fmac_f32 v99, v105, v21
    v_lshlrev_b32 v104, 16, v54
    v_and_b32 v105, 0xffff0000, v54
    v_fmac_f32 v100, v104, v21
    v_fmac_f32 v101, v105, v21
    v_lshlrev_b32 v104, 16, v55
    v_and_b32 v105, 0xffff0000, v55
    v_fmac_f32 v102, v104, v21
    v_fmac_f32 v103, v105, v21
    s_waitcnt vmcnt(9)
    v_lshlrev_b32 v104, 16, v56
    v_and_b32 v105, 0xffff0000, v56
    v_fmac_f32 v96, v104, v22
    v_fmac_f32 v97, v105, v22
    v_lshlrev_b32 v104, 16, v57
    v_and_b32 v105, 0xffff0000, v57
    v_fmac_f32 v98, v104, v22
    v_fmac_f32 v99, v105, v22
    v_lshlrev_b32 v104, 16, v58
    v_and_b32 v105, 0xffff0000, v58
    v_fmac_f32 v100, v104, v22
    v_fmac_f32 v101, v105, v22
    v_lshlrev_b32 v104, 16, v59
    v_and_b32 v105, 0xffff0000, v59
    v_fmac_f32 v102, v104, v22
    v_fmac_f32 v103, v105, v22
    s_waitcnt vmcnt(8)
    v_lshlrev_b32 v104, 16, v60
    v_and_b32 v105, 0xffff0000, v60
    v_fmac_f32 v96, v104, v23
    v_fmac_f32 v97, v105, v23
    v_lshlrev_b32 v104, 16, v61
    v_and_b32 v105, 0xffff0000, v61
    v_fmac_f32 v98, v104, v23
    v_fmac_f32 v99, v105, v23
    v_lshlrev_b32 v104, 16, v62
    v_and_b32 v105, 0xffff0000, v62
    v_fmac_f32 v100, v104, v23
    v_fmac_f32 v101, v105, v23
    v_lshlrev_b32 v104, 16, v63
    v_and_b32 v105, 0xffff0000, v63
    v_fmac_f32 v102, v104, v23
    v_fmac_f32 v103, v105, v23
    s_waitcnt vmcnt(7)
    v_lshlrev_b32 v104, 16, v64
    v_and_b32 v105, 0xffff0000, v64
    v_fmac_f32 v96, v104, v24
    v_fmac_f32 v97, v105, v24
    v_lshlrev_b32 v104, 16, v65
    v_and_b32 v105, 0xffff0000, v65
    v_fmac_f32 v98, v104, v24
    v_fmac_f32 v99, v105, v24
    v_lshlrev_b32 v104, 16, v66
    v_and_b32 v105, 0xffff0000, v66
    v_fmac_f32 v100, v104, v24
    v_fmac_f32 v101, v105, v24
    v_lshlrev_b32 v104, 16, v67
    v_and_b32 v105, 0xffff0000, v67
    v_fmac_f32 v102, v104, v24
    v_fmac_f32 v103, v105, v24
    s_waitcnt vmcnt(6)
    v_lshlrev_b32 v104, 16, v68
    v_and_b32 v105, 0xffff0000, v68
    v_fmac_f32 v96, v104, v25
    v_fmac_f32 v97, v105, v25
    v_lshlrev_b32 v104, 16, v69
    v_and_b32 v105, 0xffff0000, v69
    v_fmac_f32 v98, v104, v25
    v_fmac_f32 v99, v105, v25
    v_lshlrev_b32 v104, 16, v70
    v_and_b32 v105, 0xffff0000, v70
    v_fmac_f32 v100, v104, v25
    v_fmac_f32 v101, v105, v25
    v_lshlrev_b32 v104, 16, v71
    v_and_b32 v105, 0xffff0000, v71
    v_fmac_f32 v102, v104, v25
    v_fmac_f32 v103, v105, v25
    s_waitcnt vmcnt(5)
    v_lshlrev_b32 v104, 16, v72
    v_and_b32 v105, 0xffff0000, v72
    v_fmac_f32 v96, v104, v26
    v_fmac_f32 v97, v105, v26
    v_lshlrev_b32 v104, 16, v73
    v_and_b32 v105, 0xffff0000, v73
    v_fmac_f32 v98, v104, v26
    v_fmac_f32 v99, v105, v26
    v_lshlrev_b32 v104, 16, v74
    v_and_b32 v105, 0xffff0000, v74
    v_fmac_f32 v100, v104, v26
    v_fmac_f32 v101, v105, v26
    v_lshlrev_b32 v104, 16, v75
    v_and_b32 v105, 0xffff0000, v75
    v_fmac_f32 v102, v104, v26
    v_fmac_f32 v103, v105, v26
    s_waitcnt vmcnt(4)
    v_lshlrev_b32 v104, 16, v76
    v_and_b32 v105, 0xffff0000, v76
    v_fmac_f32 v96, v104, v27
    v_fmac_f32 v97, v105, v27
    v_lshlrev_b32 v104, 16, v77
    v_and_b32 v105, 0xffff0000, v77
    v_fmac_f32 v98, v104, v27
    v_fmac_f32 v99, v105, v27
    v_lshlrev_b32 v104, 16, v78
    v_and_b32 v105, 0xffff0000, v78
    v_fmac_f32 v100, v104, v27
    v_fmac_f32 v101, v105, v27
    v_lshlrev_b32 v104, 16, v79
    v_and_b32 v105, 0xffff0000, v79
    v_fmac_f32 v102, v104, v27
    v_fmac_f32 v103, v105, v27
    s_waitcnt vmcnt(3)
    v_lshlrev_b32 v104, 16, v80
    v_and_b32 v105, 0xffff0000, v80
    v_fmac_f32 v96, v104, v28
    v_fmac_f32 v97, v105, v28
    v_lshlrev_b32 v104, 16, v81
    v_and_b32 v105, 0xffff0000, v81
    v_fmac_f32 v98, v104, v28
    v_fmac_f32 v99, v105, v28
    v_lshlrev_b32 v104, 16, v82
    v_and_b32 v105, 0xffff0000, v82
    v_fmac_f32 v100, v104, v28
    v_fmac_f32 v101, v105, v28
    v_lshlrev_b32 v104, 16, v83
    v_and_b32 v105, 0xffff0000, v83
    v_fmac_f32 v102, v104, v28
    v_fmac_f32 v103, v105, v28
    s_waitcnt vmcnt(2)
    v_lshlrev_b32 v104, 16, v84
    v_and_b32 v105, 0xffff0000, v84
    v_fmac_f32 v96, v104, v29
    v_fmac_f32 v97, v105, v29
    v_lshlrev_b32 v104, 16, v85
    v_and_b32 v105, 0xffff0000, v85
    v_fmac_f32 v98, v104, v29
    v_fmac_f32 v99, v105, v29
    v_lshlrev_b32 v104, 16, v86
    v_and_b32 v105, 0xffff0000, v86
    v_fmac_f32 v100, v104, v29
    v_fmac_f32 v101, v105, v29
    v_lshlrev_b32 v104, 16, v87
    v_and_b32 v105, 0xffff0000, v87
    v_fmac_f32 v102, v104, v29
    v_fmac_f32 v103, v105, v29
    s_waitcnt vmcnt(1)
    v_lshlrev_b32 v104, 16, v88
    v_and_b32 v105, 0xffff0000, v88
    v_fmac_f32 v96, v104, v30
    v_fmac_f32 v97, v105, v30
    v_lshlrev_b32 v104, 16, v89
    v_and_b32 v105, 0xffff0000, v89
    v_fmac_f32 v98, v104, v30
    v_fmac_f32 v99, v105, v30
    v_lshlrev_b32 v104, 16, v90
    v_and_b32 v105, 0xffff0000, v90
    v_fmac_f32 v100, v104, v30
    v_fmac_f32 v101, v105, v30
    v_lshlrev_b32 v104, 16, v91
    v_and_b32 v105, 0xffff0000, v91
    v_fmac_f32 v102, v104, v30
    v_fmac_f32 v103, v105, v30
    s_waitcnt vmcnt(0)
    v_lshlrev_b32 v104, 16, v92
    v_and_b32 v105, 0xffff0000, v92
    v_fmac_f32 v96, v104, v31
    v_fmac_f32 v97, v105, v31
    v_lshlrev_b32 v104, 16, v93
    v_and_b32 v105, 0xffff0000, v93
    v_fmac_f32 v98, v104, v31
    v_fmac_f32 v99, v105, v31
    v_lshlrev_b32 v104, 16, v94
    v_and_b32 v105, 0xffff0000, v94
    v_fmac_f32 v100, v104, v31
    v_fmac_f32 v101, v105, v31
    v_lshlrev_b32 v104, 16, v95
    v_and_b32 v105, 0xffff0000, v95
    v_fmac_f32 v102, v104, v31
    v_fmac_f32 v103, v105, v31
    v_lshlrev_b32 v104, 5, v0
    ds_write_b128 v104, v[96:99]
    ds_write_b128 v104, v[100:103] offset:16
    v_lshlrev_b32 v105, 2, v1
    s_lshl_b32 s46, s44, 11
    v_add_u32 v104, s46, v105
    s_waitcnt lgkmcnt(0)
    ds_read_b32 v96, v104 offset:0
    ds_read_b32 v97, v104 offset:256
    ds_read_b32 v98, v104 offset:512
    ds_read_b32 v99, v104 offset:768
    ds_read_b32 v100, v104 offset:1024
    ds_read_b32 v101, v104 offset:1280
    ds_read_b32 v102, v104 offset:1536
    ds_read_b32 v103, v104 offset:1792
    s_waitcnt lgkmcnt(0)
    v_add_f32 v96, v96, v100
    v_add_f32 v97, v97, v101
    v_add_f32 v98, v98, v102
    v_add_f32 v99, v99, v103
    v_add_f32 v96, v96, v98
    v_add_f32 v97, v97, v99
    v_add_f32 v96, v96, v97
    v_lshlrev_b32 v104, 2, v0
    ds_write_b32 v104, v96 offset:16384
    s_waitcnt lgkmcnt(0)
    s_barrier
    s_cmp_lg_u32 s44, 0
    s_cbranch_scc1 L_m_sk_23
    ds_read_b32 v96, v105 offset:16384
    ds_read_b32 v97, v105 offset:16640
    ds_read_b32 v98, v105 offset:16896
    ds_read_b32 v99, v105 offset:17152
    ds_read_b32 v100, v105 offset:17408
    ds_read_b32 v101, v105 offset:17664
    ds_read_b32 v102, v105 offset:17920
    ds_read_b32 v103, v105 offset:18176
    s_waitcnt lgkmcnt(0)
    v_add_f32 v96, v96, v100
    v_add_f32 v97, v97, v101
    v_add_f32 v98, v98, v102
    v_add_f32 v99, v99, v103
    v_add_f32 v96, v96, v98
    v_add_f32 v97, v97, v99
    v_add_f32 v96, v96, v97
    v_cvt_pk_bf16_f32 v96, 0, v96
    s_lshl_b32 s46, s53, 1
    buffer_store_dword v96, v105, s[12:15], s46 offen sc1
L_m_sk_23:
    s_barrier
    s_add_u32 s53, s53, 128
    s_and_b32 s46, s53, 511
    s_cmp_lg_u32 s46, 0
    s_cbranch_scc1 L_m_loop_22
    s_lshl_b32 s54, s55, 7
    s_add_u32 s54, s54, 0x10e400
    s_mov_b32 s60, 0
    s_waitcnt vmcnt(0)
    s_cmp_lg_u32 s44, 0
    s_cbranch_scc1 L_sf_24
    v_mov_b32 v8, s60
    v_add_u32 v8, 1, v8
    v_mov_b32 v9, 0
    s_mov_b64 exec, 1
    buffer_store_dword v8, v9, s[12:15], s54 offen sc1
    s_mov_b64 exec, -1
L_sf_24:
    s_load_dwordx2 s[4:5], s[0:1], 64
    s_load_dwordx2 s[6:7], s[0:1], 80
    v_lshlrev_b32 v4, 7, v0
    s_mul_i32 s46, s55, 458752
    s_waitcnt lgkmcnt(0)
    s_mov_b32 s28, s4
    s_and_b32 s29, s5, 0xffff
    s_mov_b32 s30, 0x700000
    s_mov_b32 s31, 0x00020000
    s_mov_b32 s32, s6
    s_and_b32 s33, s7, 0xffff
    s_mov_b32 s34, 0x700000
    s_mov_b32 s35, 0x00020000
    buffer_load_dword v32, v4, s[28:31], s46 offen
    buffer_load_dword v33, v4, s[32:35], s46 offen
    s_add_u32 s46, s46, 65536
    s_waitcnt vmcnt(2)
    buffer_load_dword v34, v4, s[28:31], s46 offen
    buffer_load_dword v35, v4, s[32:35], s46 offen
    s_add_u32 s46, s46, 65536
    s_waitcnt vmcnt(2)
    buffer_load_dword v36, v4, s[28:31], s46 offen
    buffer_load_dword v37, v4, s[32:35], s46 offen
    s_add_u32 s46, s46, 65536
    s_waitcnt vmcnt(2)
    buffer_load_dword v38, v4, s[28:31], s46 offen
    buffer_load_dword v39, v4, s[32:35], s46 offen
    s_add_u32 s46, s46, 65536
    s_waitcnt vmcnt(2)
    buffer_load_dword v40, v4, s[28:31], s46 offen
    buffer_load_dword v41, v4, s[32:35], s46 offen
    s_add_u32 s46, s46, 65536
    s_waitcnt vmcnt(2)
    buffer_load_dword v42, v4, s[28:31], s46 offen
    buffer_load_dword v43, v4, s[32:35], s46 offen
    s_add_u32 s46, s46, 65536
    s_waitcnt vmcnt(2)
    buffer_load_dword v44, v4, s[28:31], s46 offen
    buffer_load_dword v45, v4, s[32:35], s46 offen
    s_add_u32 s46, s46, 65536
    s_waitcnt vmcnt(2)
    s_waitcnt vmcnt(0)
    s_and_b32 s42, s40, 3
    s_lshr_b32 s43, s40, 2
    s_cmp_eq_u32 s48, 14
    s_cbranch_scc1 L_w_c_14
    s_load_dwordx2 s[4:5], s[0:1], 112
    s_load_dwordx2 s[6:7], s[0:1], 88
    v_lshlrev_b32 v2, 4, v1
    v_lshlrev_b32 v3, 5, v1
    s_waitcnt lgkmcnt(0)
    s_mov_b32 s24, s4
    s_and_b32 s25, s5, 0xffff
    s_mov_b32 s26, 0x400000
    s_mov_b32 s27, 0x00020000
    s_mov_b32 s28, s6
    s_and_b32 s29, s7, 0xffff
    s_mov_b32 s30, 0x800
    s_mov_b32 s31, 0x00020000
    s_cmp_lg_u32 s44, 0
    s_cbranch_scc1 L_mw_25
    v_and_b32 v8, 15, v1
    v_lshlrev_b32 v8, 7, v8
    s_mov_b32 s46, 0x10e400
    s_mov_b32 s47, 0
    s_mov_b32 s70, 0
L_spin_26:
    buffer_load_dword v9, v8, s[12:15], s46 offen sc1
    s_waitcnt vmcnt(0)
    v_cmp_ge_u32 vcc, s47, v9
    s_add_u32 s70, s70, 1
    s_cbranch_vccz L_spok_27
    s_sleep 2
    s_cmp_lt_u32 s70, 524288
    s_cbranch_scc1 L_spin_26
    s_branch L_c_done_1
L_spok_27:
L_mw_25:
    s_barrier
    s_mov_b32 s46, 20480
    buffer_load_dwordx4 v[16:19], v3, s[12:15], s46 offen offset:0 sc1
    buffer_load_dwordx4 v[20:23], v3, s[12:15], s46 offen offset:16 sc1
    buffer_load_dwordx4 v[24:27], v3, s[12:15], s46 offen offset:2048 sc1
    buffer_load_dwordx4 v[28:31], v3, s[12:15], s46 offen offset:2064 sc1
    buffer_load_dwordx4 v[48:51], v2, s[28:31], 0 offen
    buffer_load_dwordx4 v[52:55], v2, s[28:31], 0 offen offset:1024
    s_waitcnt vmcnt(0)
    v_lshlrev_b32 v32, 16, v48
    v_and_b32 v33, 0xffff0000, v48
    v_lshlrev_b32 v34, 16, v49
    v_and_b32 v35, 0xffff0000, v49
    v_lshlrev_b32 v36, 16, v50
    v_and_b32 v37, 0xffff0000, v50
    v_lshlrev_b32 v38, 16, v51
    v_and_b32 v39, 0xffff0000, v51
    v_lshlrev_b32 v40, 16, v52
    v_and_b32 v41, 0xffff0000, v52
    v_lshlrev_b32 v42, 16, v53
    v_and_b32 v43, 0xffff0000, v53
    v_lshlrev_b32 v44, 16, v54
    v_and_b32 v45, 0xffff0000, v54
    v_lshlrev_b32 v46, 16, v55
    v_and_b32 v47, 0xffff0000, v55
    s_lshl_b32 s46, s42, 14
    s_lshl_b32 s47, s44, 11
    s_add_u32 s46, s46, s47
    s_add_u32 s46, s46, 0xb000000
    v_add_u32 v4, s46, v2
    v_and_b32 v5, 31, v1
    v_lshlrev_b32 v5, 7, v5
    v_add_u32 v5, 0x108400, v5
    v_lshlrev_b32 v6, 2, v1
    s_lshl_b32 s46, s44, 9
    v_add_u32 v6, s46, v6
    s_lshl_b32 s46, s44, 12
    v_add_u32 v7, s46, v3
    s_lshl_b32 s46, s42, 3
    s_add_u32 s46, s46, s44
    s_lshl_b32 s46, s46, 11
    v_add_u32 v8, s46, v2
    v_add_u32 v9, 0x800000, v8
    s_mov_b32 s60, s43
L_r_loop_28:
    s_lshl_b32 s61, s60, 18
    s_lshl_b32 s63, s60, 16
    s_cmp_lg_u32 s44, 0
    s_cbranch_scc1 L_r_nsp_29
    s_cmp_ge_u32 s60, 60
    s_cselect_b32 s46, 65536, 0
    s_cmp_ge_u32 s60, 62
    s_cselect_b32 s46, 131072, s46
    s_mov_b32 s70, 0
L_spin_30:
    buffer_load_dword v14, v5, s[12:15], s46 offen sc1
    s_waitcnt vmcnt(0)
    v_cmp_ge_u32 vcc, s60, v14
    s_add_u32 s70, s70, 1
    s_cbranch_vccz L_spok_31
    s_sleep 3
    s_cmp_lt_u32 s70, 524288
    s_cbranch_scc1 L_spin_30
    s_branch L_c_done_1
L_spok_31:
L_r_nsp_29:
    s_barrier
    buffer_load_dwordx4 v[96:99], v4, s[12:15], s61 offen offset:0 sc1
    buffer_load_dwordx4 v[100:103], v4, s[12:15], s61 offen offset:1024 sc1
    s_add_u32 s61, s61, 65536
    buffer_load_dwordx4 v[104:107], v4, s[12:15], s61 offen offset:0 sc1
    buffer_load_dwordx4 v[108:111], v4, s[12:15], s61 offen offset:1024 sc1
    s_add_u32 s61, s61, 65536
    buffer_load_dwordx4 v[112:115], v4, s[12:15], s61 offen offset:0 sc1
    buffer_load_dwordx4 v[116:119], v4, s[12:15], s61 offen offset:1024 sc1
    s_add_u32 s61, s61, 65536
    buffer_load_dwordx4 v[120:123], v4, s[12:15], s61 offen offset:0 sc1
    buffer_load_dwordx4 v[124:127], v4, s[12:15], s61 offen offset:1024 sc1
    buffer_load_dwordx4 a[0:3], v9, s[12:15], s63 offen sc1
    buffer_load_dwordx4 a[4:7], v9, s[12:15], s63 offen offset:1024 sc1
    s_waitcnt vmcnt(8)
    v_lshlrev_b32 v64, 16, v96
    v_and_b32 v65, 0xffff0000, v96
    v_lshlrev_b32 v66, 16, v97
    v_and_b32 v67, 0xffff0000, v97
    v_lshlrev_b32 v68, 16, v98
    v_and_b32 v69, 0xffff0000, v98
    v_lshlrev_b32 v70, 16, v99
    v_and_b32 v71, 0xffff0000, v99
    v_lshlrev_b32 v72, 16, v100
    v_and_b32 v73, 0xffff0000, v100
    v_lshlrev_b32 v74, 16, v101
    v_and_b32 v75, 0xffff0000, v101
    v_lshlrev_b32 v76, 16, v102
    v_and_b32 v77, 0xffff0000, v102
    v_lshlrev_b32 v78, 16, v103
    v_and_b32 v79, 0xffff0000, v103
    s_waitcnt vmcnt(6)
    v_lshlrev_b32 v80, 16, v104
    v_and_b32 v81, 0xffff0000, v104
    v_lshlrev_b32 v82, 16, v105
    v_and_b32 v83, 0xffff0000, v105
    v_lshlrev_b32 v84, 16, v106
    v_and_b32 v85, 0xffff0000, v106
    v_lshlrev_b32 v86, 16, v107
    v_and_b32 v87, 0xffff0000, v107
    v_lshlrev_b32 v88, 16, v108
    v_and_b32 v89, 0xffff0000, v108
    v_lshlrev_b32 v90, 16, v109
    v_and_b32 v91, 0xffff0000, v109
    v_lshlrev_b32 v92, 16, v110
    v_and_b32 v93, 0xffff0000, v110
    v_lshlrev_b32 v94, 16, v111
    v_and_b32 v95, 0xffff0000, v111
    v_pk_add_f32 v[64:65], v[64:65], v[80:81]
    v_pk_add_f32 v[66:67], v[66:67], v[82:83]
    v_pk_add_f32 v[68:69], v[68:69], v[84:85]
    v_pk_add_f32 v[70:71], v[70:71], v[86:87]
    v_pk_add_f32 v[72:73], v[72:73], v[88:89]
    v_pk_add_f32 v[74:75], v[74:75], v[90:91]
    v_pk_add_f32 v[76:77], v[76:77], v[92:93]
    v_pk_add_f32 v[78:79], v[78:79], v[94:95]
    s_waitcnt vmcnt(4)
    v_lshlrev_b32 v80, 16, v112
    v_and_b32 v81, 0xffff0000, v112
    v_lshlrev_b32 v82, 16, v113
    v_and_b32 v83, 0xffff0000, v113
    v_lshlrev_b32 v84, 16, v114
    v_and_b32 v85, 0xffff0000, v114
    v_lshlrev_b32 v86, 16, v115
    v_and_b32 v87, 0xffff0000, v115
    v_lshlrev_b32 v88, 16, v116
    v_and_b32 v89, 0xffff0000, v116
    v_lshlrev_b32 v90, 16, v117
    v_and_b32 v91, 0xffff0000, v117
    v_lshlrev_b32 v92, 16, v118
    v_and_b32 v93, 0xffff0000, v118
    v_lshlrev_b32 v94, 16, v119
    v_and_b32 v95, 0xffff0000, v119
    v_pk_add_f32 v[64:65], v[64:65], v[80:81]
    v_pk_add_f32 v[66:67], v[66:67], v[82:83]
    v_pk_add_f32 v[68:69], v[68:69], v[84:85]
    v_pk_add_f32 v[70:71], v[70:71], v[86:87]
    v_pk_add_f32 v[72:73], v[72:73], v[88:89]
    v_pk_add_f32 v[74:75], v[74:75], v[90:91]
    v_pk_add_f32 v[76:77], v[76:77], v[92:93]
    v_pk_add_f32 v[78:79], v[78:79], v[94:95]
    s_waitcnt vmcnt(2)
    v_lshlrev_b32 v80, 16, v120
    v_and_b32 v81, 0xffff0000, v120
    v_lshlrev_b32 v82, 16, v121
    v_and_b32 v83, 0xffff0000, v121
    v_lshlrev_b32 v84, 16, v122
    v_and_b32 v85, 0xffff0000, v122
    v_lshlrev_b32 v86, 16, v123
    v_and_b32 v87, 0xffff0000, v123
    v_lshlrev_b32 v88, 16, v124
    v_and_b32 v89, 0xffff0000, v124
    v_lshlrev_b32 v90, 16, v125
    v_and_b32 v91, 0xffff0000, v125
    v_lshlrev_b32 v92, 16, v126
    v_and_b32 v93, 0xffff0000, v126
    v_lshlrev_b32 v94, 16, v127
    v_and_b32 v95, 0xffff0000, v127
    v_pk_add_f32 v[64:65], v[64:65], v[80:81]
    v_pk_add_f32 v[66:67], v[66:67], v[82:83]
    v_pk_add_f32 v[68:69], v[68:69], v[84:85]
    v_pk_add_f32 v[70:71], v[70:71], v[86:87]
    v_pk_add_f32 v[72:73], v[72:73], v[88:89]
    v_pk_add_f32 v[74:75], v[74:75], v[90:91]
    v_pk_add_f32 v[76:77], v[76:77], v[92:93]
    v_pk_add_f32 v[78:79], v[78:79], v[94:95]
    ds_write_b32 v6, v64 offset:0
    ds_write_b32 v6, v65 offset:4096
    ds_write_b32 v6, v66 offset:8192
    ds_write_b32 v6, v67 offset:12288
    ds_write_b32 v6, v68 offset:16384
    ds_write_b32 v6, v69 offset:20480
    ds_write_b32 v6, v70 offset:24576
    ds_write_b32 v6, v71 offset:28672
    ds_write_b32 v6, v72 offset:256
    ds_write_b32 v6, v73 offset:4352
    ds_write_b32 v6, v74 offset:8448
    ds_write_b32 v6, v75 offset:12544
    ds_write_b32 v6, v76 offset:16640
    ds_write_b32 v6, v77 offset:20736
    ds_write_b32 v6, v78 offset:24832
    ds_write_b32 v6, v79 offset:28928
    s_waitcnt lgkmcnt(0)
    s_barrier
    ds_read_b128 v[64:67], v7
    ds_read_b128 v[68:71], v7 offset:16
    ds_read_b128 v[72:75], v7 offset:2048
    ds_read_b128 v[76:79], v7 offset:2064
    s_waitcnt vmcnt(0)
    v_accvgpr_read_b32 v96, a0
    v_accvgpr_read_b32 v97, a1
    v_accvgpr_read_b32 v98, a2
    v_accvgpr_read_b32 v99, a3
    v_accvgpr_read_b32 v100, a4
    v_accvgpr_read_b32 v101, a5
    v_accvgpr_read_b32 v102, a6
    v_accvgpr_read_b32 v103, a7
    v_lshlrev_b32 v80, 16, v96
    v_and_b32 v81, 0xffff0000, v96
    v_lshlrev_b32 v82, 16, v97
    v_and_b32 v83, 0xffff0000, v97
    v_lshlrev_b32 v84, 16, v98
    v_and_b32 v85, 0xffff0000, v98
    v_lshlrev_b32 v86, 16, v99
    v_and_b32 v87, 0xffff0000, v99
    v_lshlrev_b32 v88, 16, v100
    v_and_b32 v89, 0xffff0000, v100
    v_lshlrev_b32 v90, 16, v101
    v_and_b32 v91, 0xffff0000, v101
    v_lshlrev_b32 v92, 16, v102
    v_and_b32 v93, 0xffff0000, v102
    v_lshlrev_b32 v94, 16, v103
    v_and_b32 v95, 0xffff0000, v103
    s_waitcnt lgkmcnt(0)
    v_cvt_pk_bf16_f32 v64, 0, v64
    v_cvt_pk_bf16_f32 v65, 0, v65
    v_cvt_pk_bf16_f32 v66, 0, v66
    v_cvt_pk_bf16_f32 v67, 0, v67
    v_cvt_pk_bf16_f32 v68, 0, v68
    v_cvt_pk_bf16_f32 v69, 0, v69
    v_cvt_pk_bf16_f32 v70, 0, v70
    v_cvt_pk_bf16_f32 v71, 0, v71
    v_cvt_pk_bf16_f32 v72, 0, v72
    v_cvt_pk_bf16_f32 v73, 0, v73
    v_cvt_pk_bf16_f32 v74, 0, v74
    v_cvt_pk_bf16_f32 v75, 0, v75
    v_cvt_pk_bf16_f32 v76, 0, v76
    v_cvt_pk_bf16_f32 v77, 0, v77
    v_cvt_pk_bf16_f32 v78, 0, v78
    v_cvt_pk_bf16_f32 v79, 0, v79
    v_pk_add_f32 v[64:65], v[64:65], v[32:33]
    v_pk_add_f32 v[66:67], v[66:67], v[34:35]
    v_pk_add_f32 v[68:69], v[68:69], v[36:37]
    v_pk_add_f32 v[70:71], v[70:71], v[38:39]
    v_pk_add_f32 v[72:73], v[72:73], v[40:41]
    v_pk_add_f32 v[74:75], v[74:75], v[42:43]
    v_pk_add_f32 v[76:77], v[76:77], v[44:45]
    v_pk_add_f32 v[78:79], v[78:79], v[46:47]
    v_cvt_pk_bf16_f32 v64, 0, v64
    v_cvt_pk_bf16_f32 v65, 0, v65
    v_cvt_pk_bf16_f32 v66, 0, v66
    v_cvt_pk_bf16_f32 v67, 0, v67
    v_cvt_pk_bf16_f32 v68, 0, v68
    v_cvt_pk_bf16_f32 v69, 0, v69
    v_cvt_pk_bf16_f32 v70, 0, v70
    v_cvt_pk_bf16_f32 v71, 0, v71
    v_cvt_pk_bf16_f32 v72, 0, v72
    v_cvt_pk_bf16_f32 v73, 0, v73
    v_cvt_pk_bf16_f32 v74, 0, v74
    v_cvt_pk_bf16_f32 v75, 0, v75
    v_cvt_pk_bf16_f32 v76, 0, v76
    v_cvt_pk_bf16_f32 v77, 0, v77
    v_cvt_pk_bf16_f32 v78, 0, v78
    v_cvt_pk_bf16_f32 v79, 0, v79
    v_pk_mul_f32 v[64:65], v[64:65], v[16:17]
    v_pk_mul_f32 v[66:67], v[66:67], v[18:19]
    v_pk_mul_f32 v[68:69], v[68:69], v[20:21]
    v_pk_mul_f32 v[70:71], v[70:71], v[22:23]
    v_pk_mul_f32 v[72:73], v[72:73], v[24:25]
    v_pk_mul_f32 v[74:75], v[74:75], v[26:27]
    v_pk_mul_f32 v[76:77], v[76:77], v[28:29]
    v_pk_mul_f32 v[78:79], v[78:79], v[30:31]
    v_cvt_pk_bf16_f32 v64, 0, v64
    v_cvt_pk_bf16_f32 v65, 0, v65
    v_cvt_pk_bf16_f32 v66, 0, v66
    v_cvt_pk_bf16_f32 v67, 0, v67
    v_cvt_pk_bf16_f32 v68, 0, v68
    v_cvt_pk_bf16_f32 v69, 0, v69
    v_cvt_pk_bf16_f32 v70, 0, v70
    v_cvt_pk_bf16_f32 v71, 0, v71
    v_cvt_pk_bf16_f32 v72, 0, v72
    v_cvt_pk_bf16_f32 v73, 0, v73
    v_cvt_pk_bf16_f32 v74, 0, v74
    v_cvt_pk_bf16_f32 v75, 0, v75
    v_cvt_pk_bf16_f32 v76, 0, v76
    v_cvt_pk_bf16_f32 v77, 0, v77
    v_cvt_pk_bf16_f32 v78, 0, v78
    v_cvt_pk_bf16_f32 v79, 0, v79
    v_pk_add_f32 v[64:65], v[64:65], v[80:81]
    v_pk_add_f32 v[66:67], v[66:67], v[82:83]
    v_pk_add_f32 v[68:69], v[68:69], v[84:85]
    v_pk_add_f32 v[70:71], v[70:71], v[86:87]
    v_pk_add_f32 v[72:73], v[72:73], v[88:89]
    v_pk_add_f32 v[74:75], v[74:75], v[90:91]
    v_pk_add_f32 v[76:77], v[76:77], v[92:93]
    v_pk_add_f32 v[78:79], v[78:79], v[94:95]
    v_cvt_pk_bf16_f32 v96, v64, v65
    v_cvt_pk_bf16_f32 v97, v66, v67
    v_cvt_pk_bf16_f32 v98, v68, v69
    v_cvt_pk_bf16_f32 v99, v70, v71
    v_cvt_pk_bf16_f32 v100, v72, v73
    v_cvt_pk_bf16_f32 v101, v74, v75
    v_cvt_pk_bf16_f32 v102, v76, v77
    v_cvt_pk_bf16_f32 v103, v78, v79
    buffer_store_dwordx4 v[96:99], v8, s[24:27], s63 offen
    buffer_store_dwordx4 v[100:103], v8, s[24:27], s63 offen offset:1024
    s_add_u32 s60, s60, 2
    s_cmp_lt_u32 s60, 64
    s_cbranch_scc1 L_r_loop_28
    s_branch L_c_done_1
L_w_c_14:
    s_load_dwordx2 s[4:5], s[0:1], 0
    s_load_dwordx2 s[6:7], s[0:1], 88
    v_lshlrev_b32 v2, 4, v1
    v_lshlrev_b32 v3, 5, v1
    s_waitcnt lgkmcnt(0)
    s_mov_b32 s24, s4
    s_and_b32 s25, s5, 0xffff
    s_mov_b32 s26, 0x400000
    s_mov_b32 s27, 0x00020000
    s_mov_b32 s28, s6
    s_and_b32 s29, s7, 0xffff
    s_mov_b32 s30, 0x800
    s_mov_b32 s31, 0x00020000
    s_cmp_lg_u32 s44, 0
    s_cbranch_scc1 L_mw_32
    v_and_b32 v8, 15, v1
    v_lshlrev_b32 v8, 7, v8
    s_mov_b32 s46, 0x10e400
    s_mov_b32 s47, 0
    s_mov_b32 s70, 0
L_spin_33:
    buffer_load_dword v9, v8, s[12:15], s46 offen sc1
    s_waitcnt vmcnt(0)
    v_cmp_ge_u32 vcc, s47, v9
    s_add_u32 s70, s70, 1
    s_cbranch_vccz L_spok_34
    s_sleep 2
    s_cmp_lt_u32 s70, 524288
    s_cbranch_scc1 L_spin_33
    s_branch L_c_done_1
L_spok_34:
L_mw_32:
    s_barrier
    s_mov_b32 s46, 8192
    buffer_load_dwordx4 v[16:19], v3, s[12:15], s46 offen offset:0 sc1
    buffer_load_dwordx4 v[20:23], v3, s[12:15], s46 offen offset:16 sc1
    buffer_load_dwordx4 v[24:27], v3, s[12:15], s46 offen offset:2048 sc1
    buffer_load_dwordx4 v[28:31], v3, s[12:15], s46 offen offset:2064 sc1
    s_mov_b32 s46, 16384
    buffer_load_dwordx4 v[32:35], v3, s[12:15], s46 offen offset:0 sc1
    buffer_load_dwordx4 v[36:39], v3, s[12:15], s46 offen offset:16 sc1
    buffer_load_dwordx4 v[40:43], v3, s[12:15], s46 offen offset:2048 sc1
    buffer_load_dwordx4 v[44:47], v3, s[12:15], s46 offen offset:2064 sc1
    s_mov_b32 s46, 12288
    buffer_load_dwordx4 v[48:51], v3, s[12:15], s46 offen offset:0 sc1
    buffer_load_dwordx4 v[52:55], v3, s[12:15], s46 offen offset:16 sc1
    buffer_load_dwordx4 v[56:59], v3, s[12:15], s46 offen offset:2048 sc1
    buffer_load_dwordx4 v[60:63], v3, s[12:15], s46 offen offset:2064 sc1
    s_waitcnt vmcnt(0)
    v_add_f32 v32, 1.0, v32
    v_add_f32 v33, 1.0, v33
    v_add_f32 v34, 1.0, v34
    v_add_f32 v35, 1.0, v35
    v_add_f32 v36, 1.0, v36
    v_add_f32 v37, 1.0, v37
    v_add_f32 v38, 1.0, v38
    v_add_f32 v39, 1.0, v39
    v_add_f32 v40, 1.0, v40
    v_add_f32 v41, 1.0, v41
    v_add_f32 v42, 1.0, v42
    v_add_f32 v43, 1.0, v43
    v_add_f32 v44, 1.0, v44
    v_add_f32 v45, 1.0, v45
    v_add_f32 v46, 1.0, v46
    v_add_f32 v47, 1.0, v47
    v_cvt_pk_bf16_f32 v32, 0, v32
    v_cvt_pk_bf16_f32 v33, 0, v33
    v_cvt_pk_bf16_f32 v34, 0, v34
    v_cvt_pk_bf16_f32 v35, 0, v35
    v_cvt_pk_bf16_f32 v36, 0, v36
    v_cvt_pk_bf16_f32 v37, 0, v37
    v_cvt_pk_bf16_f32 v38, 0, v38
    v_cvt_pk_bf16_f32 v39, 0, v39
    v_cvt_pk_bf16_f32 v40, 0, v40
    v_cvt_pk_bf16_f32 v41, 0, v41
    v_cvt_pk_bf16_f32 v42, 0, v42
    v_cvt_pk_bf16_f32 v43, 0, v43
    v_cvt_pk_bf16_f32 v44, 0, v44
    v_cvt_pk_bf16_f32 v45, 0, v45
    v_cvt_pk_bf16_f32 v46, 0, v46
    v_cvt_pk_bf16_f32 v47, 0, v47
    s_lshl_b32 s46, s42, 14
    s_lshl_b32 s47, s44, 11
    s_add_u32 s46, s46, s47
    s_add_u32 s46, s46, 0x9000000
    v_add_u32 v4, s46, v2
    v_and_b32 v5, 31, v1
    v_lshlrev_b32 v5, 7, v5
    v_add_u32 v5, 0x107400, v5
    v_lshlrev_b32 v6, 2, v1
    s_lshl_b32 s46, s44, 9
    v_add_u32 v6, s46, v6
    s_lshl_b32 s46, s44, 12
    v_add_u32 v7, s46, v3
    s_lshl_b32 s46, s42, 3
    s_add_u32 s46, s46, s44
    s_lshl_b32 s46, s46, 11
    v_add_u32 v8, s46, v2
    v_add_u32 v9, 0x800000, v8
    s_mul_i32 s46, s44, 2064
    s_add_u32 s46, s46, 32768
    v_add_u32 v10, s46, v2
    v_and_b32 v11, 7, v1
    v_lshrrev_b32 v12, 3, v1
    v_mul_u32_u24 v13, 2064, v11
    v_lshl_add_u32 v13, v12, 4, v13
    s_lshl_b32 s46, s44, 8
    s_add_u32 s46, s46, 32768
    v_add_u32 v13, s46, v13
    v_lshlrev_b32 v11, 4, v11
    v_lshl_add_u32 v11, v12, 9, v11
    s_lshl_b32 s46, s44, 13
    s_lshl_b32 s47, s42, 7
    s_add_u32 s46, s46, s47
    s_add_u32 s46, s46, 0xc00000
    v_add_u32 v11, s46, v11
    v_add_u32 v12, 4096, v11
    s_lshl_b32 s52, s43, 9
    s_lshl_b32 s47, s42, 7
    s_add_u32 s52, s52, s47
    s_add_u32 s52, s52, 0x10ec00
    s_mov_b32 s60, s43
L_r_loop_35:
    s_lshl_b32 s61, s60, 18
    s_lshl_b32 s63, s60, 16
    buffer_load_dwordx4 a[0:3], v8, s[24:27], s63 offen
    buffer_load_dwordx4 a[4:7], v8, s[24:27], s63 offen offset:1024
    s_cmp_lg_u32 s44, 0
    s_cbranch_scc1 L_r_nsp_36
    s_mov_b32 s70, 0
L_spin_37:
    buffer_load_dword v14, v5, s[12:15], 0 offen sc1
    s_waitcnt vmcnt(0)
    v_cmp_ge_u32 vcc, s60, v14
    s_add_u32 s70, s70, 1
    s_cbranch_vccz L_spok_38
    s_sleep 3
    s_cmp_lt_u32 s70, 524288
    s_cbranch_scc1 L_spin_37
    s_branch L_c_done_1
L_spok_38:
L_r_nsp_36:
    s_barrier
    buffer_load_dwordx4 v[96:99], v4, s[12:15], s61 offen offset:0 sc1
    buffer_load_dwordx4 v[100:103], v4, s[12:15], s61 offen offset:1024 sc1
    s_add_u32 s61, s61, 65536
    buffer_load_dwordx4 v[104:107], v4, s[12:15], s61 offen offset:0 sc1
    buffer_load_dwordx4 v[108:111], v4, s[12:15], s61 offen offset:1024 sc1
    s_add_u32 s61, s61, 65536
    buffer_load_dwordx4 v[112:115], v4, s[12:15], s61 offen offset:0 sc1
    buffer_load_dwordx4 v[116:119], v4, s[12:15], s61 offen offset:1024 sc1
    s_add_u32 s61, s61, 65536
    buffer_load_dwordx4 v[120:123], v4, s[12:15], s61 offen offset:0 sc1
    buffer_load_dwordx4 v[124:127], v4, s[12:15], s61 offen offset:1024 sc1
    s_waitcnt vmcnt(6)
    v_lshlrev_b32 v64, 16, v96
    v_and_b32 v65, 0xffff0000, v96
    v_lshlrev_b32 v66, 16, v97
    v_and_b32 v67, 0xffff0000, v97
    v_lshlrev_b32 v68, 16, v98
    v_and_b32 v69, 0xffff0000, v98
    v_lshlrev_b32 v70, 16, v99
    v_and_b32 v71, 0xffff0000, v99
    v_lshlrev_b32 v72, 16, v100
    v_and_b32 v73, 0xffff0000, v100
    v_lshlrev_b32 v74, 16, v101
    v_and_b32 v75, 0xffff0000, v101
    v_lshlrev_b32 v76, 16, v102
    v_and_b32 v77, 0xffff0000, v102
    v_lshlrev_b32 v78, 16, v103
    v_and_b32 v79, 0xffff0000, v103
    s_waitcnt vmcnt(4)
    v_lshlrev_b32 v80, 16, v104
    v_and_b32 v81, 0xffff0000, v104
    v_lshlrev_b32 v82, 16, v105
    v_and_b32 v83, 0xffff0000, v105
    v_lshlrev_b32 v84, 16, v106
    v_and_b32 v85, 0xffff0000, v106
    v_lshlrev_b32 v86, 16, v107
    v_and_b32 v87, 0xffff0000, v107
    v_lshlrev_b32 v88, 16, v108
    v_and_b32 v89, 0xffff0000, v108
    v_lshlrev_b32 v90, 16, v109
    v_and_b32 v91, 0xffff0000, v109
    v_lshlrev_b32 v92, 16, v110
    v_and_b32 v93, 0xffff0000, v110
    v_lshlrev_b32 v94, 16, v111
    v_and_b32 v95, 0xffff0000, v111
    v_pk_add_f32 v[64:65], v[64:65], v[80:81]
    v_pk_add_f32 v[66:67], v[66:67], v[82:83]
    v_pk_add_f32 v[68:69], v[68:69], v[84:85]
    v_pk_add_f32 v[70:71], v[70:71], v[86:87]
    v_pk_add_f32 v[72:73], v[72:73], v[88:89]
    v_pk_add_f32 v[74:75], v[74:75], v[90:91]
    v_pk_add_f32 v[76:77], v[76:77], v[92:93]
    v_pk_add_f32 v[78:79], v[78:79], v[94:95]
    s_waitcnt vmcnt(2)
    v_lshlrev_b32 v80, 16, v112
    v_and_b32 v81, 0xffff0000, v112
    v_lshlrev_b32 v82, 16, v113
    v_and_b32 v83, 0xffff0000, v113
    v_lshlrev_b32 v84, 16, v114
    v_and_b32 v85, 0xffff0000, v114
    v_lshlrev_b32 v86, 16, v115
    v_and_b32 v87, 0xffff0000, v115
    v_lshlrev_b32 v88, 16, v116
    v_and_b32 v89, 0xffff0000, v116
    v_lshlrev_b32 v90, 16, v117
    v_and_b32 v91, 0xffff0000, v117
    v_lshlrev_b32 v92, 16, v118
    v_and_b32 v93, 0xffff0000, v118
    v_lshlrev_b32 v94, 16, v119
    v_and_b32 v95, 0xffff0000, v119
    v_pk_add_f32 v[64:65], v[64:65], v[80:81]
    v_pk_add_f32 v[66:67], v[66:67], v[82:83]
    v_pk_add_f32 v[68:69], v[68:69], v[84:85]
    v_pk_add_f32 v[70:71], v[70:71], v[86:87]
    v_pk_add_f32 v[72:73], v[72:73], v[88:89]
    v_pk_add_f32 v[74:75], v[74:75], v[90:91]
    v_pk_add_f32 v[76:77], v[76:77], v[92:93]
    v_pk_add_f32 v[78:79], v[78:79], v[94:95]
    s_waitcnt vmcnt(0)
    v_lshlrev_b32 v80, 16, v120
    v_and_b32 v81, 0xffff0000, v120
    v_lshlrev_b32 v82, 16, v121
    v_and_b32 v83, 0xffff0000, v121
    v_lshlrev_b32 v84, 16, v122
    v_and_b32 v85, 0xffff0000, v122
    v_lshlrev_b32 v86, 16, v123
    v_and_b32 v87, 0xffff0000, v123
    v_lshlrev_b32 v88, 16, v124
    v_and_b32 v89, 0xffff0000, v124
    v_lshlrev_b32 v90, 16, v125
    v_and_b32 v91, 0xffff0000, v125
    v_lshlrev_b32 v92, 16, v126
    v_and_b32 v93, 0xffff0000, v126
    v_lshlrev_b32 v94, 16, v127
    v_and_b32 v95, 0xffff0000, v127
    v_pk_add_f32 v[64:65], v[64:65], v[80:81]
    v_pk_add_f32 v[66:67], v[66:67], v[82:83]
    v_pk_add_f32 v[68:69], v[68:69], v[84:85]
    v_pk_add_f32 v[70:71], v[70:71], v[86:87]
    v_pk_add_f32 v[72:73], v[72:73], v[88:89]
    v_pk_add_f32 v[74:75], v[74:75], v[90:91]
    v_pk_add_f32 v[76:77], v[76:77], v[92:93]
    v_pk_add_f32 v[78:79], v[78:79], v[94:95]
    ds_write_b32 v6, v64 offset:0
    ds_write_b32 v6, v65 offset:4096
    ds_write_b32 v6, v66 offset:8192
    ds_write_b32 v6, v67 offset:12288
    ds_write_b32 v6, v68 offset:16384
    ds_write_b32 v6, v69 offset:20480
    ds_write_b32 v6, v70 offset:24576
    ds_write_b32 v6, v71 offset:28672
    ds_write_b32 v6, v72 offset:256
    ds_write_b32 v6, v73 offset:4352
    ds_write_b32 v6, v74 offset:8448
    ds_write_b32 v6, v75 offset:12544
    ds_write_b32 v6, v76 offset:16640
    ds_write_b32 v6, v77 offset:20736
    ds_write_b32 v6, v78 offset:24832
    ds_write_b32 v6, v79 offset:28928
    s_waitcnt lgkmcnt(0)
    s_barrier
    ds_read_b128 v[64:67], v7
    ds_read_b128 v[68:71], v7 offset:16
    ds_read_b128 v[72:75], v7 offset:2048
    ds_read_b128 v[76:79], v7 offset:2064
    s_waitcnt vmcnt(0)
    v_accvgpr_read_b32 v96, a0
    v_accvgpr_read_b32 v97, a1
    v_accvgpr_read_b32 v98, a2
    v_accvgpr_read_b32 v99, a3
    v_accvgpr_read_b32 v100, a4
    v_accvgpr_read_b32 v101, a5
    v_accvgpr_read_b32 v102, a6
    v_accvgpr_read_b32 v103, a7
    v_lshlrev_b32 v80, 16, v96
    v_and_b32 v81, 0xffff0000, v96
    v_lshlrev_b32 v82, 16, v97
    v_and_b32 v83, 0xffff0000, v97
    v_lshlrev_b32 v84, 16, v98
    v_and_b32 v85, 0xffff0000, v98
    v_lshlrev_b32 v86, 16, v99
    v_and_b32 v87, 0xffff0000, v99
    v_lshlrev_b32 v88, 16, v100
    v_and_b32 v89, 0xffff0000, v100
    v_lshlrev_b32 v90, 16, v101
    v_and_b32 v91, 0xffff0000, v101
    v_lshlrev_b32 v92, 16, v102
    v_and_b32 v93, 0xffff0000, v102
    v_lshlrev_b32 v94, 16, v103
    v_and_b32 v95, 0xffff0000, v103
    s_waitcnt lgkmcnt(0)
    v_cvt_pk_bf16_f32 v64, 0, v64
    v_cvt_pk_bf16_f32 v65, 0, v65
    v_cvt_pk_bf16_f32 v66, 0, v66
    v_cvt_pk_bf16_f32 v67, 0, v67
    v_cvt_pk_bf16_f32 v68, 0, v68
    v_cvt_pk_bf16_f32 v69, 0, v69
    v_cvt_pk_bf16_f32 v70, 0, v70
    v_cvt_pk_bf16_f32 v71, 0, v71
    v_cvt_pk_bf16_f32 v72, 0, v72
    v_cvt_pk_bf16_f32 v73, 0, v73
    v_cvt_pk_bf16_f32 v74, 0, v74
    v_cvt_pk_bf16_f32 v75, 0, v75
    v_cvt_pk_bf16_f32 v76, 0, v76
    v_cvt_pk_bf16_f32 v77, 0, v77
    v_cvt_pk_bf16_f32 v78, 0, v78
    v_cvt_pk_bf16_f32 v79, 0, v79
    v_pk_mul_f32 v[64:65], v[64:65], v[16:17]
    v_pk_mul_f32 v[66:67], v[66:67], v[18:19]
    v_pk_mul_f32 v[68:69], v[68:69], v[20:21]
    v_pk_mul_f32 v[70:71], v[70:71], v[22:23]
    v_pk_mul_f32 v[72:73], v[72:73], v[24:25]
    v_pk_mul_f32 v[74:75], v[74:75], v[26:27]
    v_pk_mul_f32 v[76:77], v[76:77], v[28:29]
    v_pk_mul_f32 v[78:79], v[78:79], v[30:31]
    v_cvt_pk_bf16_f32 v64, 0, v64
    v_cvt_pk_bf16_f32 v65, 0, v65
    v_cvt_pk_bf16_f32 v66, 0, v66
    v_cvt_pk_bf16_f32 v67, 0, v67
    v_cvt_pk_bf16_f32 v68, 0, v68
    v_cvt_pk_bf16_f32 v69, 0, v69
    v_cvt_pk_bf16_f32 v70, 0, v70
    v_cvt_pk_bf16_f32 v71, 0, v71
    v_cvt_pk_bf16_f32 v72, 0, v72
    v_cvt_pk_bf16_f32 v73, 0, v73
    v_cvt_pk_bf16_f32 v74, 0, v74
    v_cvt_pk_bf16_f32 v75, 0, v75
    v_cvt_pk_bf16_f32 v76, 0, v76
    v_cvt_pk_bf16_f32 v77, 0, v77
    v_cvt_pk_bf16_f32 v78, 0, v78
    v_cvt_pk_bf16_f32 v79, 0, v79
    v_pk_add_f32 v[64:65], v[64:65], v[80:81]
    v_pk_add_f32 v[66:67], v[66:67], v[82:83]
    v_pk_add_f32 v[68:69], v[68:69], v[84:85]
    v_pk_add_f32 v[70:71], v[70:71], v[86:87]
    v_pk_add_f32 v[72:73], v[72:73], v[88:89]
    v_pk_add_f32 v[74:75], v[74:75], v[90:91]
    v_pk_add_f32 v[76:77], v[76:77], v[92:93]
    v_pk_add_f32 v[78:79], v[78:79], v[94:95]
    v_cvt_pk_bf16_f32 v96, v64, v65
    v_cvt_pk_bf16_f32 v97, v66, v67
    v_cvt_pk_bf16_f32 v98, v68, v69
    v_cvt_pk_bf16_f32 v99, v70, v71
    v_cvt_pk_bf16_f32 v100, v72, v73
    v_cvt_pk_bf16_f32 v101, v74, v75
    v_cvt_pk_bf16_f32 v102, v76, v77
    v_cvt_pk_bf16_f32 v103, v78, v79
    buffer_store_dwordx4 v[96:99], v9, s[12:15], s63 offen sc1
    buffer_store_dwordx4 v[100:103], v9, s[12:15], s63 offen offset:1024 sc1
    v_lshlrev_b32 v64, 16, v96
    v_and_b32 v65, 0xffff0000, v96
    v_lshlrev_b32 v66, 16, v97
    v_and_b32 v67, 0xffff0000, v97
    v_lshlrev_b32 v68, 16, v98
    v_and_b32 v69, 0xffff0000, v98
    v_lshlrev_b32 v70, 16, v99
    v_and_b32 v71, 0xffff0000, v99
    v_lshlrev_b32 v72, 16, v100
    v_and_b32 v73, 0xffff0000, v100
    v_lshlrev_b32 v74, 16, v101
    v_and_b32 v75, 0xffff0000, v101
    v_lshlrev_b32 v76, 16, v102
    v_and_b32 v77, 0xffff0000, v102
    v_lshlrev_b32 v78, 16, v103
    v_and_b32 v79, 0xffff0000, v103
    v_pk_add_f32 v[80:81], v[64:65], v[72:73]
    v_pk_add_f32 v[82:83], v[66:67], v[74:75]
    v_pk_add_f32 v[84:85], v[68:69], v[76:77]
    v_pk_add_f32 v[86:87], v[70:71], v[78:79]
    v_pk_add_f32 v[80:81], v[80:81], v[84:85]
    v_pk_add_f32 v[82:83], v[82:83], v[86:87]
    v_pk_add_f32 v[80:81], v[80:81], v[82:83]
    v_add_f32 v14, v80, v81
    s_nop 1
    v_add_f32_dpp v14, v14, v14 row_shr:1 row_mask:0xf bank_mask:0xf bound_ctrl:0
    s_nop 1
    v_add_f32_dpp v14, v14, v14 row_shr:2 row_mask:0xf bank_mask:0xf bound_ctrl:0
    s_nop 1
    v_add_f32_dpp v14, v14, v14 row_shr:4 row_mask:0xf bank_mask:0xf bound_ctrl:0
    s_nop 1
    v_add_f32_dpp v14, v14, v14 row_shr:8 row_mask:0xf bank_mask:0xf bound_ctrl:0
    s_nop 1
    v_add_f32_dpp v14, v14, v14 row_bcast:15 row_mask:0xa bank_mask:0xf
    s_nop 1
    v_add_f32_dpp v14, v14, v14 row_bcast:31 row_mask:0xc bank_mask:0xf
    s_nop 1
    v_readlane_b32 s46, v14, 63
    s_nop 1
    v_mov_b32 v15, s46
    v_mul_f32 v15, 0x3a800000, v15
    v_pk_add_f32 v[80:81], v[64:65], v[14:15] op_sel:[0,1] op_sel_hi:[1,1] neg_lo:[0,1] neg_hi:[0,1]
    v_pk_add_f32 v[82:83], v[66:67], v[14:15] op_sel:[0,1] op_sel_hi:[1,1] neg_lo:[0,1] neg_hi:[0,1]
    v_pk_add_f32 v[84:85], v[68:69], v[14:15] op_sel:[0,1] op_sel_hi:[1,1] neg_lo:[0,1] neg_hi:[0,1]
    v_pk_add_f32 v[86:87], v[70:71], v[14:15] op_sel:[0,1] op_sel_hi:[1,1] neg_lo:[0,1] neg_hi:[0,1]
    v_pk_add_f32 v[88:89], v[72:73], v[14:15] op_sel:[0,1] op_sel_hi:[1,1] neg_lo:[0,1] neg_hi:[0,1]
    v_pk_add_f32 v[90:91], v[74:75], v[14:15] op_sel:[0,1] op_sel_hi:[1,1] neg_lo:[0,1] neg_hi:[0,1]
    v_pk_add_f32 v[92:93], v[76:77], v[14:15] op_sel:[0,1] op_sel_hi:[1,1] neg_lo:[0,1] neg_hi:[0,1]
    v_pk_add_f32 v[94:95], v[78:79], v[14:15] op_sel:[0,1] op_sel_hi:[1,1] neg_lo:[0,1] neg_hi:[0,1]
    v_pk_mul_f32 v[104:105], v[80:81], v[80:81]
    v_pk_mul_f32 v[106:107], v[82:83], v[82:83]
    v_pk_fma_f32 v[104:105], v[84:85], v[84:85], v[104:105]
    v_pk_fma_f32 v[106:107], v[86:87], v[86:87], v[106:107]
    v_pk_fma_f32 v[104:105], v[88:89], v[88:89], v[104:105]
    v_pk_fma_f32 v[106:107], v[90:91], v[90:91], v[106:107]
    v_pk_fma_f32 v[104:105], v[92:93], v[92:93], v[104:105]
    v_pk_fma_f32 v[106:107], v[94:95], v[94:95], v[106:107]
    v_pk_add_f32 v[104:105], v[104:105], v[106:107]
    v_add_f32 v14, v104, v105
    v_cvt_pk_bf16_f32 v15, 0, v15
    s_nop 1
    v_add_f32_dpp v14, v14, v14 row_shr:1 row_mask:0xf bank_mask:0xf bound_ctrl:0
    s_nop 1
    v_add_f32_dpp v14, v14, v14 row_shr:2 row_mask:0xf bank_mask:0xf bound_ctrl:0
    s_nop 1
    v_add_f32_dpp v14, v14, v14 row_shr:4 row_mask:0xf bank_mask:0xf bound_ctrl:0
    s_nop 1
    v_add_f32_dpp v14, v14, v14 row_shr:8 row_mask:0xf bank_mask:0xf bound_ctrl:0
    s_nop 1
    v_add_f32_dpp v14, v14, v14 row_bcast:15 row_mask:0xa bank_mask:0xf
    s_nop 1
    v_add_f32_dpp v14, v14, v14 row_bcast:31 row_mask:0xc bank_mask:0xf
    s_nop 1
    v_readlane_b32 s47, v14, 63
    v_pk_add_f32 v[64:65], v[64:65], v[14:15] op_sel:[0,1] op_sel_hi:[1,1] neg_lo:[0,1] neg_hi:[0,1]
    v_pk_add_f32 v[66:67], v[66:67], v[14:15] op_sel:[0,1] op_sel_hi:[1,1] neg_lo:[0,1] neg_hi:[0,1]
    v_pk_add_f32 v[68:69], v[68:69], v[14:15] op_sel:[0,1] op_sel_hi:[1,1] neg_lo:[0,1] neg_hi:[0,1]
    v_pk_add_f32 v[70:71], v[70:71], v[14:15] op_sel:[0,1] op_sel_hi:[1,1] neg_lo:[0,1] neg_hi:[0,1]
    v_pk_add_f32 v[72:73], v[72:73], v[14:15] op_sel:[0,1] op_sel_hi:[1,1] neg_lo:[0,1] neg_hi:[0,1]
    v_pk_add_f32 v[74:75], v[74:75], v[14:15] op_sel:[0,1] op_sel_hi:[1,1] neg_lo:[0,1] neg_hi:[0,1]
    v_pk_add_f32 v[76:77], v[76:77], v[14:15] op_sel:[0,1] op_sel_hi:[1,1] neg_lo:[0,1] neg_hi:[0,1]
    v_pk_add_f32 v[78:79], v[78:79], v[14:15] op_sel:[0,1] op_sel_hi:[1,1] neg_lo:[0,1] neg_hi:[0,1]
    v_mov_b32 v14, s47
    v_mul_f32 v14, 0x3a800000, v14
    v_cvt_pk_bf16_f32 v14, 0, v14
    v_add_f32 v14, 0x3727c5ac, v14
    v_cvt_pk_bf16_f32 v14, 0, v14
    v_sqrt_f32 v14, v14
    s_nop 0
    v_cvt_pk_bf16_f32 v14, 0, v14
    v_rcp_f32 v14, v14
    v_cvt_pk_bf16_f32 v64, 0, v64
    v_cvt_pk_bf16_f32 v65, 0, v65
    v_cvt_pk_bf16_f32 v66, 0, v66
    v_cvt_pk_bf16_f32 v67, 0, v67
    v_cvt_pk_bf16_f32 v68, 0, v68
    v_cvt_pk_bf16_f32 v69, 0, v69
    v_cvt_pk_bf16_f32 v70, 0, v70
    v_cvt_pk_bf16_f32 v71, 0, v71
    v_cvt_pk_bf16_f32 v72, 0, v72
    v_cvt_pk_bf16_f32 v73, 0, v73
    v_cvt_pk_bf16_f32 v74, 0, v74
    v_cvt_pk_bf16_f32 v75, 0, v75
    v_cvt_pk_bf16_f32 v76, 0, v76
    v_cvt_pk_bf16_f32 v77, 0, v77
    v_cvt_pk_bf16_f32 v78, 0, v78
    v_cvt_pk_bf16_f32 v79, 0, v79
    v_pk_mul_f32 v[64:65], v[64:65], v[14:15] op_sel_hi:[1,0]
    v_pk_mul_f32 v[66:67], v[66:67], v[14:15] op_sel_hi:[1,0]
    v_pk_mul_f32 v[68:69], v[68:69], v[14:15] op_sel_hi:[1,0]
    v_pk_mul_f32 v[70:71], v[70:71], v[14:15] op_sel_hi:[1,0]
    v_pk_mul_f32 v[72:73], v[72:73], v[14:15] op_sel_hi:[1,0]
    v_pk_mul_f32 v[74:75], v[74:75], v[14:15] op_sel_hi:[1,0]
    v_pk_mul_f32 v[76:77], v[76:77], v[14:15] op_sel_hi:[1,0]
    v_pk_mul_f32 v[78:79], v[78:79], v[14:15] op_sel_hi:[1,0]
    v_cvt_pk_bf16_f32 v64, 0, v64
    v_cvt_pk_bf16_f32 v65, 0, v65
    v_cvt_pk_bf16_f32 v66, 0, v66
    v_cvt_pk_bf16_f32 v67, 0, v67
    v_cvt_pk_bf16_f32 v68, 0, v68
    v_cvt_pk_bf16_f32 v69, 0, v69
    v_cvt_pk_bf16_f32 v70, 0, v70
    v_cvt_pk_bf16_f32 v71, 0, v71
    v_cvt_pk_bf16_f32 v72, 0, v72
    v_cvt_pk_bf16_f32 v73, 0, v73
    v_cvt_pk_bf16_f32 v74, 0, v74
    v_cvt_pk_bf16_f32 v75, 0, v75
    v_cvt_pk_bf16_f32 v76, 0, v76
    v_cvt_pk_bf16_f32 v77, 0, v77
    v_cvt_pk_bf16_f32 v78, 0, v78
    v_cvt_pk_bf16_f32 v79, 0, v79
    v_pk_mul_f32 v[64:65], v[64:65], v[32:33]
    v_pk_mul_f32 v[66:67], v[66:67], v[34:35]
    v_pk_mul_f32 v[68:69], v[68:69], v[36:37]
    v_pk_mul_f32 v[70:71], v[70:71], v[38:39]
    v_pk_mul_f32 v[72:73], v[72:73], v[40:41]
    v_pk_mul_f32 v[74:75], v[74:75], v[42:43]
    v_pk_mul_f32 v[76:77], v[76:77], v[44:45]
    v_pk_mul_f32 v[78:79], v[78:79], v[46:47]
    v_cvt_pk_bf16_f32 v64, 0, v64
    v_cvt_pk_bf16_f32 v65, 0, v65
    v_cvt_pk_bf16_f32 v66, 0, v66
    v_cvt_pk_bf16_f32 v67, 0, v67
    v_cvt_pk_bf16_f32 v68, 0, v68
    v_cvt_pk_bf16_f32 v69, 0, v69
    v_cvt_pk_bf16_f32 v70, 0, v70
    v_cvt_pk_bf16_f32 v71, 0, v71
    v_cvt_pk_bf16_f32 v72, 0, v72
    v_cvt_pk_bf16_f32 v73, 0, v73
    v_cvt_pk_bf16_f32 v74, 0, v74
    v_cvt_pk_bf16_f32 v75, 0, v75
    v_cvt_pk_bf16_f32 v76, 0, v76
    v_cvt_pk_bf16_f32 v77, 0, v77
    v_cvt_pk_bf16_f32 v78, 0, v78
    v_cvt_pk_bf16_f32 v79, 0, v79
    v_pk_add_f32 v[64:65], v[64:65], v[48:49]
    v_pk_add_f32 v[66:67], v[66:67], v[50:51]
    v_pk_add_f32 v[68:69], v[68:69], v[52:53]
    v_pk_add_f32 v[70:71], v[70:71], v[54:55]
    v_pk_add_f32 v[72:73], v[72:73], v[56:57]
    v_pk_add_f32 v[74:75], v[74:75], v[58:59]
    v_pk_add_f32 v[76:77], v[76:77], v[60:61]
    v_pk_add_f32 v[78:79], v[78:79], v[62:63]
    v_cvt_pk_bf16_f32 v104, v64, v65
    v_cvt_pk_bf16_f32 v105, v66, v67
    v_cvt_pk_bf16_f32 v106, v68, v69
    v_cvt_pk_bf16_f32 v107, v70, v71
    v_cvt_pk_bf16_f32 v108, v72, v73
    v_cvt_pk_bf16_f32 v109, v74, v75
    v_cvt_pk_bf16_f32 v110, v76, v77
    v_cvt_pk_bf16_f32 v111, v78, v79
    ds_write_b128 v10, v[104:107]
    ds_write_b128 v10, v[108:111] offset:1024
    s_waitcnt lgkmcnt(0)
    s_barrier
    ds_read_b128 v[104:107], v13
    ds_read_b128 v[108:111], v13 offset:128
    s_waitcnt lgkmcnt(1)
    buffer_store_dwordx4 v[104:107], v11, s[12:15], s63 offen sc1
    s_waitcnt lgkmcnt(0)
    buffer_store_dwordx4 v[108:111], v12, s[12:15], s63 offen sc1
    s_waitcnt vmcnt(0)
    s_barrier
    s_cmp_lg_u32 s44, 0
    s_cbranch_scc1 L_sf_39
    v_mov_b32 v14, s60
    v_add_u32 v14, 1, v14
    v_mov_b32 v15, 0
    s_mov_b64 exec, 1
    buffer_store_dword v14, v15, s[12:15], s52 offen sc1
    s_mov_b64 exec, -1
L_sf_39:
    s_add_u32 s60, s60, 3
    s_cmp_lt_u32 s60, 64
    s_cbranch_scc1 L_r_loop_35
    s_branch L_c_done_1
L_w_att_13:
    s_lshl_b32 s42, s40, 2
    s_and_b32 s46, s44, 3
    s_add_u32 s42, s42, s46
    s_and_b32 s43, s48, 1
    s_lshl_b32 s43, s43, 1
    s_lshr_b32 s46, s44, 2
    s_add_u32 s43, s43, s46
    s_mul_i32 s46, s42, 24576
    s_add_u32 s46, s46, 0x2000000
    v_lshlrev_b32 v2, 4, v1
    v_add_u32 v3, s46, v2
    v_add_u32 v5, 4096, v3
    v_lshrrev_b32 v4, 4, v1
    v_and_b32 v9, 15, v1
    s_lshl_b32 s46, s42, 12
    s_add_u32 s46, s46, 0x1000000
    v_and_b32 v6, 7, v1
    v_lshlrev_b32 v6, 4, v6
    v_lshl_add_u32 v6, v4, 7, v6
    v_add_u32 v6, s46, v6
    v_and_b32 v7, 31, v1
    v_lshlrev_b32 v7, 4, v7
    v_lshrrev_b32 v10, 5, v1
    v_lshl_add_u32 v7, v10, 10, v7
    v_add_u32 v7, s46, v7
    s_mul_i32 s50, s44, 13056
    v_mul_u32_u24 v8, 272, v9
    v_lshl_add_u32 v8, v4, 4, v8
    v_add_u32 v8, s50, v8
    v_bfe_u32 v11, v1, 2, 3
    v_mul_u32_u24 v11, 272, v11
    v_lshl_add_u32 v11, v10, 6, v11
    v_and_b32 v12, 3, v1
    v_lshl_add_u32 v11, v12, 4, v11
    v_add_u32 v11, s50, v11
    v_mul_u32_u24 v14, 272, v4
    v_lshl_add_u32 v14, v9, 4, v14
    v_add_u32 v14, s50, v14
    v_mov_b32 v16, 0
    v_mov_b32 v17, 0
    v_mov_b32 v18, 0
    v_mov_b32 v19, 0
    ds_write_b128 v14, v[16:19] offset:10880
    ds_write_b128 v14, v[16:19] offset:11968
    v_lshlrev_b32 v12, 2, v4
    v_bfe_u32 v13, v1, 2, 2
    v_add_u32 v12, v12, v13
    v_mul_u32_u24 v12, 272, v12
    v_and_b32 v13, 3, v1
    v_lshl_add_u32 v12, v13, 3, v12
    v_add_u32 v12, s50, v12
    v_lshlrev_b32 v13, 10, v13
    s_lshl_b32 s46, s42, 12
    s_add_u32 s46, s46, 0x1000000
    v_add_u32 v13, s46, v13
    v_lshlrev_b32 v10, 9, v4
    v_lshl_add_u32 v10, v9, 4, v10
    s_lshl_b32 s46, s42, 13
    s_add_u32 s46, s46, 0x5000000
    v_add_u32 v10, s46, v10
    s_lshl_b32 s52, s42, 9
    s_lshl_b32 s47, s43, 7
    s_add_u32 s52, s52, s47
    s_add_u32 s52, s52, 0x102000
    v_min_u32 v42, 2, v1
    v_lshlrev_b32 v42, 9, v42
    s_lshl_b32 s46, s40, 11
    s_and_b32 s47, s42, 3
    s_lshl_b32 s47, s47, 7
    s_add_u32 s46, s46, s47
    s_add_u32 s46, s46, 0x10a400
    v_add_u32 v48, s46, v42
    s_mul_i32 s46, s42, 24576
    s_add_u32 s46, s46, 0x2000000
    v_lshlrev_b32 v49, 7, v1
    v_add_u32 v49, s46, v49
    v_cmp_le_u32 s[56:57], 32, v1
    v_lshlrev_b32 v14, 2, v4
    s_mov_b32 s54, 0x3e0293ee
    s_mov_b32 s60, s43
    v_add_u32 v15, 0, v14
    v_cmp_gt_u32 s[84:85], v15, v9
    v_add_u32 v15, 1, v14
    v_cmp_gt_u32 s[86:87], v15, v9
    v_add_u32 v15, 2, v14
    v_cmp_gt_u32 s[88:89], v15, v9
    v_add_u32 v15, 3, v14
    v_cmp_gt_u32 s[90:91], v15, v9
L_a_loop_40:
    s_mul_i32 s45, s60, 786432
    s_add_u32 s48, s45, 8192
    s_add_u32 s49, s45, 16384
    s_lshl_b32 s61, s60, 17
    s_lshl_b32 s63, s60, 18
    s_mov_b32 s70, 0
L_spin_41:
    buffer_load_dword v40, v48, s[12:15], 0 offen sc1
    s_waitcnt vmcnt(0)
    v_cmp_ge_u32 vcc, s60, v40
    s_add_u32 s70, s70, 1
    s_cbranch_vccz L_spok_42
    s_sleep 3
    s_cmp_lt_u32 s70, 524288
    s_cbranch_scc1 L_spin_41
    s_branch L_c_done_1
L_spok_42:
    buffer_load_dwordx4 a[0:3], v3, s[12:15], s45 offen offset:0 sc1
    buffer_load_dwordx4 a[4:7], v3, s[12:15], s45 offen offset:1024 sc1
    buffer_load_dwordx4 a[8:11], v3, s[12:15], s45 offen offset:2048 sc1
    buffer_load_dwordx4 a[12:15], v3, s[12:15], s45 offen offset:3072 sc1
    buffer_load_dwordx4 a[16:19], v5, s[12:15], s45 offen offset:0 sc1
    buffer_load_dwordx4 a[20:23], v5, s[12:15], s45 offen offset:1024 sc1
    buffer_load_dwordx4 a[24:27], v5, s[12:15], s45 offen offset:2048 sc1
    buffer_load_dwordx4 a[28:31], v5, s[12:15], s45 offen offset:3072 sc1
    buffer_load_dwordx4 a[32:35], v3, s[12:15], s48 offen offset:0 sc1
    buffer_load_dwordx4 a[36:39], v3, s[12:15], s48 offen offset:1024 sc1
    buffer_load_dwordx4 a[40:43], v3, s[12:15], s48 offen offset:2048 sc1
    buffer_load_dwordx4 a[44:47], v3, s[12:15], s48 offen offset:3072 sc1
    buffer_load_dwordx4 a[48:51], v5, s[12:15], s48 offen offset:0 sc1
    buffer_load_dwordx4 a[52:55], v5, s[12:15], s48 offen offset:1024 sc1
    buffer_load_dwordx4 a[56:59], v5, s[12:15], s48 offen offset:2048 sc1
    buffer_load_dwordx4 a[60:63], v5, s[12:15], s48 offen offset:3072 sc1
    buffer_load_dwordx4 v[16:19], v3, s[12:15], s49 offen offset:0 sc1
    buffer_load_dwordx4 v[20:23], v3, s[12:15], s49 offen offset:1024 sc1
    buffer_load_dwordx4 v[24:27], v3, s[12:15], s49 offen offset:2048 sc1
    buffer_load_dwordx4 v[28:31], v3, s[12:15], s49 offen offset:3072 sc1
    buffer_load_dwordx4 v[32:35], v5, s[12:15], s49 offen offset:0 sc1
    buffer_load_dwordx4 v[36:39], v5, s[12:15], s49 offen offset:1024 sc1
    buffer_load_dwordx4 v[40:43], v5, s[12:15], s49 offen offset:2048 sc1
    buffer_load_dwordx4 v[44:47], v5, s[12:15], s49 offen offset:3072 sc1
    s_waitcnt vmcnt(0)
    ds_write_b128 v8, v[16:19] offset:0
    ds_write_b128 v8, v[20:23] offset:64
    ds_write_b128 v8, v[24:27] offset:128
    ds_write_b128 v8, v[28:31] offset:192
    ds_write_b128 v8, v[32:35] offset:4352
    ds_write_b128 v8, v[36:39] offset:4416
    ds_write_b128 v8, v[40:43] offset:4480
    ds_write_b128 v8, v[44:47] offset:4544
    v_mfma_f32_16x16x32_bf16 v[56:59], a[32:35], a[0:3], 0
    v_mfma_f32_16x16x32_bf16 v[60:63], a[32:35], a[16:19], 0
    v_mfma_f32_16x16x32_bf16 v[68:71], a[48:51], a[16:19], 0
    v_mfma_f32_16x16x32_bf16 v[56:59], a[36:39], a[4:7], v[56:59]
    v_mfma_f32_16x16x32_bf16 v[60:63], a[36:39], a[20:23], v[60:63]
    v_mfma_f32_16x16x32_bf16 v[68:71], a[52:55], a[20:23], v[68:71]
    v_mfma_f32_16x16x32_bf16 v[56:59], a[40:43], a[8:11], v[56:59]
    v_mfma_f32_16x16x32_bf16 v[60:63], a[40:43], a[24:27], v[60:63]
    v_mfma_f32_16x16x32_bf16 v[68:71], a[56:59], a[24:27], v[68:71]
    v_mfma_f32_16x16x32_bf16 v[56:59], a[44:47], a[12:15], v[56:59]
    v_mfma_f32_16x16x32_bf16 v[60:63], a[44:47], a[28:31], v[60:63]
    v_mfma_f32_16x16x32_bf16 v[68:71], a[60:63], a[28:31], v[68:71]
    s_waitcnt lgkmcnt(0)
    ds_read_b64_tr_b16 a[80:81], v12 offset:0
    ds_read_b64_tr_b16 a[82:83], v12 offset:4352
    ds_read_b64_tr_b16 a[86:87], v12 offset:32
    ds_read_b64_tr_b16 a[88:89], v12 offset:4384
    ds_read_b64_tr_b16 a[92:93], v12 offset:64
    ds_read_b64_tr_b16 a[94:95], v12 offset:4416
    ds_read_b64_tr_b16 a[98:99], v12 offset:96
    ds_read_b64_tr_b16 a[100:101], v12 offset:4448
    s_waitcnt lgkmcnt(0)
    ds_read_b64_tr_b16 a[104:105], v12 offset:128
    ds_read_b64_tr_b16 a[106:107], v12 offset:4480
    ds_read_b64_tr_b16 a[110:111], v12 offset:160
    ds_read_b64_tr_b16 a[112:113], v12 offset:4512
    ds_read_b64_tr_b16 a[116:117], v12 offset:192
    ds_read_b64_tr_b16 a[118:119], v12 offset:4544
    ds_read_b64_tr_b16 a[122:123], v12 offset:224
    ds_read_b64_tr_b16 a[124:125], v12 offset:4576
    v_mov_b32 v15, 0xff800000
    v_cndmask_b32 v56, v56, v15, s[84:85]
    v_cndmask_b32 v68, v68, v15, s[84:85]
    v_cndmask_b32 v57, v57, v15, s[86:87]
    v_cndmask_b32 v69, v69, v15, s[86:87]
    v_cndmask_b32 v58, v58, v15, s[88:89]
    v_cndmask_b32 v70, v70, v15, s[88:89]
    v_cndmask_b32 v59, v59, v15, s[90:91]
    v_cndmask_b32 v71, v71, v15, s[90:91]
    s_mov_b32 s70, 0
L_a_cp_43:
    buffer_load_dword v40, v13, s[12:15], s61 offen sc1
    s_waitcnt vmcnt(0)
    v_cmp_eq_u32 vcc, -1, v40
    s_add_u32 s70, s70, 1
    s_cbranch_vccz L_a_fl_44
L_a_cp_43_s:
    s_sleep 4
    s_cmp_lt_u32 s70, 524288
    s_cbranch_scc1 L_a_cp_43
    s_branch L_c_done_1
L_a_fl_44:
    buffer_load_dwordx4 v[24:27], v6, s[12:15], s61 offen offset:0 sc1
    buffer_load_dwordx4 v[28:31], v6, s[12:15], s61 offen offset:1024 sc1
    buffer_load_dwordx4 v[32:35], v6, s[12:15], s61 offen offset:2048 sc1
    buffer_load_dwordx4 v[36:39], v6, s[12:15], s61 offen offset:3072 sc1
    buffer_load_dwordx4 v[16:19], v7, s[12:15], s61 offen offset:512 sc1
    buffer_load_dwordx4 v[20:23], v7, s[12:15], s61 offen offset:2560 sc1
    s_waitcnt vmcnt(0)
    v_max_u32 v40, v16, v17
    v_max3_u32 v40, v40, v18, v19
    v_max3_u32 v40, v40, v20, v21
    v_max3_u32 v40, v40, v22, v23
    v_max3_u32 v40, v40, v24, v25
    v_max3_u32 v40, v40, v26, v27
    v_max3_u32 v40, v40, v28, v29
    v_max3_u32 v40, v40, v30, v31
    v_max3_u32 v40, v40, v32, v33
    v_max3_u32 v40, v40, v34, v35
    v_max3_u32 v40, v40, v36, v37
    v_max3_u32 v40, v40, v38, v39
    v_cmp_eq_u32 vcc, -1, v40
    s_nop 0
    s_cbranch_vccnz L_a_cp_43_s
    v_mfma_f32_16x16x32_bf16 v[72:75], v[24:27], a[0:3], 0
    v_mfma_f32_16x16x32_bf16 v[76:79], v[24:27], a[16:19], 0
    v_mfma_f32_16x16x32_bf16 v[72:75], v[28:31], a[4:7], v[72:75]
    v_mfma_f32_16x16x32_bf16 v[76:79], v[28:31], a[20:23], v[76:79]
    v_mfma_f32_16x16x32_bf16 v[72:75], v[32:35], a[8:11], v[72:75]
    v_mfma_f32_16x16x32_bf16 v[76:79], v[32:35], a[24:27], v[76:79]
    v_mfma_f32_16x16x32_bf16 v[72:75], v[36:39], a[12:15], v[72:75]
    v_mfma_f32_16x16x32_bf16 v[76:79], v[36:39], a[28:31], v[76:79]
    ds_write_b128 v11, v[16:19] offset:8704
    ds_write_b128 v11, v[20:23] offset:8832
    s_waitcnt lgkmcnt(0)
    ds_read_b64_tr_b16 a[84:85], v12 offset:8704
    ds_read_b64_tr_b16 a[90:91], v12 offset:8736
    ds_read_b64_tr_b16 a[96:97], v12 offset:8768
    ds_read_b64_tr_b16 a[102:103], v12 offset:8800
    ds_read_b64_tr_b16 a[108:109], v12 offset:8832
    ds_read_b64_tr_b16 a[114:115], v12 offset:8864
    ds_read_b64_tr_b16 a[120:121], v12 offset:8896
    ds_read_b64_tr_b16 a[126:127], v12 offset:8928
    v_cndmask_b32 v72, v72, v15, s[56:57]
    v_cndmask_b32 v73, v73, v15, s[56:57]
    v_cndmask_b32 v74, v74, v15, s[56:57]
    v_cndmask_b32 v75, v75, v15, s[56:57]
    v_cndmask_b32 v76, v76, v15, s[56:57]
    v_cndmask_b32 v77, v77, v15, s[56:57]
    v_cndmask_b32 v78, v78, v15, s[56:57]
    v_cndmask_b32 v79, v79, v15, s[56:57]
    v_max_f32 v40, v56, v57
    v_max3_f32 v40, v40, v58, v59
    v_max3_f32 v40, v40, v72, v73
    v_max3_f32 v40, v40, v74, v75
    v_mov_b32 v41, v40
    s_nop 1
    v_permlane16_swap_b32 v40, v41
    v_max_f32 v40, v40, v41
    v_mov_b32 v41, v40
    s_nop 1
    v_permlane32_swap_b32 v40, v41
    v_max_f32 v40, v40, v41
    v_mul_f32 v40, s54, v40
    v_fma_f32 v56, v56, s54, -v40
    v_fma_f32 v57, v57, s54, -v40
    v_fma_f32 v58, v58, s54, -v40
    v_fma_f32 v59, v59, s54, -v40
    v_fma_f32 v72, v72, s54, -v40
    v_fma_f32 v73, v73, s54, -v40
    v_fma_f32 v74, v74, s54, -v40
    v_fma_f32 v75, v75, s54, -v40
    v_exp_f32 v56, v56
    v_exp_f32 v57, v57
    v_exp_f32 v58, v58
    v_exp_f32 v59, v59
    v_exp_f32 v72, v72
    v_exp_f32 v73, v73
    v_exp_f32 v74, v74
    v_exp_f32 v75, v75
    v_add_f32 v40, v56, v57
    v_add_f32 v40, v40, v58
    v_add_f32 v40, v40, v59
    v_add_f32 v40, v40, v72
    v_add_f32 v40, v40, v73
    v_add_f32 v40, v40, v74
    v_add_f32 v40, v40, v75
    v_mov_b32 v41, v40
    s_nop 1
    v_permlane16_swap_b32 v40, v41
    v_add_f32 v40, v40, v41
    v_mov_b32 v41, v40
    s_nop 1
    v_permlane32_swap_b32 v40, v41
    v_add_f32 v40, v40, v41
    v_rcp_f32 v40, v40
    s_nop 0
    v_mul_f32 v56, v56, v40
    v_mul_f32 v57, v57, v40
    v_mul_f32 v58, v58, v40
    v_mul_f32 v59, v59, v40
    v_mul_f32 v72, v72, v40
    v_mul_f32 v73, v73, v40
    v_mul_f32 v74, v74, v40
    v_mul_f32 v75, v75, v40
    v_cvt_pk_bf16_f32 v24, v56, v57
    v_cvt_pk_bf16_f32 v25, v58, v59
    v_cvt_pk_bf16_f32 v28, v72, v73
    v_cvt_pk_bf16_f32 v29, v74, v75
    v_max_f32 v40, v60, v61
    v_max3_f32 v40, v40, v62, v63
    v_max3_f32 v40, v40, v68, v69
    v_max3_f32 v40, v40, v70, v71
    v_max3_f32 v40, v40, v76, v77
    v_max3_f32 v40, v40, v78, v79
    v_mov_b32 v41, v40
    s_nop 1
    v_permlane16_swap_b32 v40, v41
    v_max_f32 v40, v40, v41
    v_mov_b32 v41, v40
    s_nop 1
    v_permlane32_swap_b32 v40, v41
    v_max_f32 v40, v40, v41
    v_mul_f32 v40, s54, v40
    v_fma_f32 v60, v60, s54, -v40
    v_fma_f32 v61, v61, s54, -v40
    v_fma_f32 v62, v62, s54, -v40
    v_fma_f32 v63, v63, s54, -v40
    v_fma_f32 v68, v68, s54, -v40
    v_fma_f32 v69, v69, s54, -v40
    v_fma_f32 v70, v70, s54, -v40
    v_fma_f32 v71, v71, s54, -v40
    v_fma_f32 v76, v76, s54, -v40
    v_fma_f32 v77, v77, s54, -v40
    v_fma_f32 v78, v78, s54, -v40
    v_fma_f32 v79, v79, s54, -v40
    v_exp_f32 v60, v60
    v_exp_f32 v61, v61
    v_exp_f32 v62, v62
    v_exp_f32 v63, v63
    v_exp_f32 v68, v68
    v_exp_f32 v69, v69
    v_exp_f32 v70, v70
    v_exp_f32 v71, v71
    v_exp_f32 v76, v76
    v_exp_f32 v77, v77
    v_exp_f32 v78, v78
    v_exp_f32 v79, v79
    v_add_f32 v40, v60, v61
    v_add_f32 v40, v40, v62
    v_add_f32 v40, v40, v63
    v_add_f32 v40, v40, v68
    v_add_f32 v40, v40, v69
    v_add_f32 v40, v40, v70
    v_add_f32 v40, v40, v71
    v_add_f32 v40, v40, v76
    v_add_f32 v40, v40, v77
    v_add_f32 v40, v40, v78
    v_add_f32 v40, v40, v79
    v_mov_b32 v41, v40
    s_nop 1
    v_permlane16_swap_b32 v40, v41
    v_add_f32 v40, v40, v41
    v_mov_b32 v41, v40
    s_nop 1
    v_permlane32_swap_b32 v40, v41
    v_add_f32 v40, v40, v41
    v_rcp_f32 v40, v40
    s_nop 0
    v_mul_f32 v60, v60, v40
    v_mul_f32 v61, v61, v40
    v_mul_f32 v62, v62, v40
    v_mul_f32 v63, v63, v40
    v_mul_f32 v68, v68, v40
    v_mul_f32 v69, v69, v40
    v_mul_f32 v70, v70, v40
    v_mul_f32 v71, v71, v40
    v_mul_f32 v76, v76, v40
    v_mul_f32 v77, v77, v40
    v_mul_f32 v78, v78, v40
    v_mul_f32 v79, v79, v40
    v_cvt_pk_bf16_f32 v30, v60, v61
    v_cvt_pk_bf16_f32 v31, v62, v63
    v_cvt_pk_bf16_f32 v32, v68, v69
    v_cvt_pk_bf16_f32 v33, v70, v71
    v_cvt_pk_bf16_f32 v34, v76, v77
    v_cvt_pk_bf16_f32 v35, v78, v79
    s_waitcnt lgkmcnt(0)
    s_nop 0
    v_mfma_f32_16x16x16_bf16 v[64:67], a[80:81], v[24:25], 0
    v_mfma_f32_16x16x16_bf16 v[68:71], a[86:87], v[24:25], 0
    v_mfma_f32_16x16x16_bf16 v[72:75], a[92:93], v[24:25], 0
    v_mfma_f32_16x16x16_bf16 v[76:79], a[98:99], v[24:25], 0
    v_mfma_f32_16x16x16_bf16 v[80:83], a[104:105], v[24:25], 0
    v_mfma_f32_16x16x16_bf16 v[84:87], a[110:111], v[24:25], 0
    v_mfma_f32_16x16x16_bf16 v[88:91], a[116:117], v[24:25], 0
    v_mfma_f32_16x16x16_bf16 v[92:95], a[122:123], v[24:25], 0
    v_mfma_f32_16x16x16_bf16 v[64:67], a[84:85], v[28:29], v[64:67]
    v_mfma_f32_16x16x16_bf16 v[68:71], a[90:91], v[28:29], v[68:71]
    v_mfma_f32_16x16x16_bf16 v[72:75], a[96:97], v[28:29], v[72:75]
    v_mfma_f32_16x16x16_bf16 v[76:79], a[102:103], v[28:29], v[76:79]
    v_mfma_f32_16x16x16_bf16 v[80:83], a[108:109], v[28:29], v[80:83]
    v_mfma_f32_16x16x16_bf16 v[84:87], a[114:115], v[28:29], v[84:87]
    v_mfma_f32_16x16x16_bf16 v[88:91], a[120:121], v[28:29], v[88:91]
    v_mfma_f32_16x16x16_bf16 v[92:95], a[126:127], v[28:29], v[92:95]
    v_mfma_f32_16x16x16_bf16 v[96:99], a[80:81], v[30:31], 0
    v_mfma_f32_16x16x16_bf16 v[100:103], a[86:87], v[30:31], 0
    v_mfma_f32_16x16x16_bf16 v[104:107], a[92:93], v[30:31], 0
    v_mfma_f32_16x16x16_bf16 v[108:111], a[98:99], v[30:31], 0
    v_mfma_f32_16x16x16_bf16 v[112:115], a[104:105], v[30:31], 0
    v_mfma_f32_16x16x16_bf16 v[116:119], a[110:111], v[30:31], 0
    v_mfma_f32_16x16x16_bf16 v[120:123], a[116:117], v[30:31], 0
    v_mfma_f32_16x16x16_bf16 v[124:127], a[122:123], v[30:31], 0
    v_mfma_f32_16x16x16_bf16 v[96:99], a[82:83], v[32:33], v[96:99]
    v_mfma_f32_16x16x16_bf16 v[100:103], a[88:89], v[32:33], v[100:103]
    v_mfma_f32_16x16x16_bf16 v[104:107], a[94:95], v[32:33], v[104:107]
    v_mfma_f32_16x16x16_bf16 v[108:111], a[100:101], v[32:33], v[108:111]
    v_mfma_f32_16x16x16_bf16 v[112:115], a[106:107], v[32:33], v[112:115]
    v_mfma_f32_16x16x16_bf16 v[116:119], a[112:113], v[32:33], v[116:119]
    v_mfma_f32_16x16x16_bf16 v[120:123], a[118:119], v[32:33], v[120:123]
    v_mfma_f32_16x16x16_bf16 v[124:127], a[124:125], v[32:33], v[124:127]
    v_mfma_f32_16x16x16_bf16 v[96:99], a[84:85], v[34:35], v[96:99]
    v_mfma_f32_16x16x16_bf16 v[100:103], a[90:91], v[34:35], v[100:103]
    v_mfma_f32_16x16x16_bf16 v[104:107], a[96:97], v[34:35], v[104:107]
    v_mfma_f32_16x16x16_bf16 v[108:111], a[102:103], v[34:35], v[108:111]
    v_mfma_f32_16x16x16_bf16 v[112:115], a[108:109], v[34:35], v[112:115]
    v_mfma_f32_16x16x16_bf16 v[116:119], a[114:115], v[34:35], v[116:119]
    v_mfma_f32_16x16x16_bf16 v[120:123], a[120:121], v[34:35], v[120:123]
    v_mfma_f32_16x16x16_bf16 v[124:127], a[126:127], v[34:35], v[124:127]
    s_add_u32 s46, s63, 4096
    v_cvt_pk_bf16_f32 v64, v64, v65
    v_cvt_pk_bf16_f32 v65, v66, v67
    v_cvt_pk_bf16_f32 v66, v68, v69
    v_cvt_pk_bf16_f32 v67, v70, v71
    buffer_store_dwordx4 v[64:67], v10, s[12:15], s63 offen offset:0 sc1
    v_cvt_pk_bf16_f32 v72, v72, v73
    v_cvt_pk_bf16_f32 v73, v74, v75
    v_cvt_pk_bf16_f32 v74, v76, v77
    v_cvt_pk_bf16_f32 v75, v78, v79
    buffer_store_dwordx4 v[72:75], v10, s[12:15], s63 offen offset:2048 sc1
    v_cvt_pk_bf16_f32 v80, v80, v81
    v_cvt_pk_bf16_f32 v81, v82, v83
    v_cvt_pk_bf16_f32 v82, v84, v85
    v_cvt_pk_bf16_f32 v83, v86, v87
    buffer_store_dwordx4 v[80:83], v10, s[12:15], s46 offen offset:0 sc1
    v_cvt_pk_bf16_f32 v88, v88, v89
    v_cvt_pk_bf16_f32 v89, v90, v91
    v_cvt_pk_bf16_f32 v90, v92, v93
    v_cvt_pk_bf16_f32 v91, v94, v95
    buffer_store_dwordx4 v[88:91], v10, s[12:15], s46 offen offset:2048 sc1
    v_cvt_pk_bf16_f32 v96, v96, v97
    v_cvt_pk_bf16_f32 v97, v98, v99
    v_cvt_pk_bf16_f32 v98, v100, v101
    v_cvt_pk_bf16_f32 v99, v102, v103
    buffer_store_dwordx4 v[96:99], v10, s[12:15], s63 offen offset:256 sc1
    v_cvt_pk_bf16_f32 v104, v104, v105
    v_cvt_pk_bf16_f32 v105, v106, v107
    v_cvt_pk_bf16_f32 v106, v108, v109
    v_cvt_pk_bf16_f32 v107, v110, v111
    buffer_store_dwordx4 v[104:107], v10, s[12:15], s63 offen offset:2304 sc1
    v_cvt_pk_bf16_f32 v112, v112, v113
    v_cvt_pk_bf16_f32 v113, v114, v115
    v_cvt_pk_bf16_f32 v114, v116, v117
    v_cvt_pk_bf16_f32 v115, v118, v119
    buffer_store_dwordx4 v[112:115], v10, s[12:15], s46 offen offset:256 sc1
    v_cvt_pk_bf16_f32 v120, v120, v121
    v_cvt_pk_bf16_f32 v121, v122, v123
    v_cvt_pk_bf16_f32 v122, v124, v125
    v_cvt_pk_bf16_f32 v123, v126, v127
    buffer_store_dwordx4 v[120:123], v10, s[12:15], s46 offen offset:2304 sc1
    s_waitcnt vmcnt(0)
    v_mov_b32 v16, s60
    v_add_u32 v16, 1, v16
    v_mov_b32 v17, 0
    s_mov_b64 exec, 1
    buffer_store_dword v16, v17, s[12:15], s52 offen sc1
    s_mov_b64 exec, -1
L_sf_46:
    s_add_u32 s60, s60, 4
    s_cmp_lt_u32 s60, 64
    s_cbranch_scc1 L_a_loop_40
    s_branch L_c_done_1
L_w_g_8:
    s_lshr_b32 s53, s48, 2
    s_cmp_lt_u32 s53, 2
    s_cselect_b32 s46, 1, 0
    s_xor_b32 s53, s53, s46
    s_mov_b32 s74, 0
    s_cmp_eq_u32 s53, 1
    s_cselect_b32 s75, 58, 64
L_w_g_8_e:
    s_lshl_b32 s46, s53, 3
    s_add_u32 s46, s46, 16
    s_load_dwordx2 s[4:5], s[0:1], s46
    s_lshl_b32 s49, s40, 2
    s_and_b32 s46, s48, 3
    s_add_u32 s49, s49, s46
    s_load_dwordx2 s[6:7], s[0:1], 72
    s_and_b32 s50, s44, 3
    s_lshr_b32 s51, s44, 2
    s_waitcnt lgkmcnt(0)
    s_mov_b32 s24, s4
    s_and_b32 s25, s5, 0xffff
    s_mov_b32 s26, 0x800000
    s_mov_b32 s27, 0x00020000
    s_cmp_lg_u32 s53, 0
    s_cbranch_scc1 L_g_nq_47
    s_load_dwordx4 s[8:11], s[0:1], 24
    v_and_b32 v10, 255, v0
    v_lshlrev_b32 v10, 13, v10
    s_and_b32 s46, s48, 3
    s_lshl_b32 s46, s46, 21
    s_lshl_b32 s47, s40, 10
    s_add_u32 s46, s46, s47
    s_add_u32 s46, s46, 384
    s_waitcnt lgkmcnt(0)
    s_cmp_eq_u32 s51, 1
    s_cselect_b32 s8, s10, s8
    s_cselect_b32 s9, s11, s9
    s_mov_b32 s28, s8
    s_and_b32 s29, s9, 0xffff
    s_mov_b32 s30, 0x800000
    s_mov_b32 s31, 0x00020000
    buffer_load_dword v11, v10, s[28:31], s46 offen
    s_cmp_eq_u32 s51, 1
    s_cbranch_scc1 L_g_nq_47
    buffer_load_dword v12, v10, s[24:27], s46 offen
L_g_nq_47:
    v_lshrrev_b32 v3, 4, v1
    v_and_b32 v4, 15, v1
    v_lshlrev_b32 v5, 2, v3
    v_xor_b32 v4, v4, v5
    v_mul_u32_u24 v3, 8192, v3
    v_lshl_add_u32 v3, v4, 4, v3
    s_mul_i32 s46, s51, 512
    s_mul_i32 s47, s50, 64
    s_add_u32 s46, s46, s47
    s_mul_i32 s46, s46, 8192
    s_lshl_b32 s47, s49, 8
    s_add_u32 s46, s46, s47
    s_lshl_b32 s45, s51, 16
    s_mul_i32 s47, s50, 16384
    s_add_u32 s45, s45, s47
    v_bfe_u32 v4, v1, 2, 2
    v_bfe_u32 v5, v1, 4, 1
    v_lshlrev_b32 v5, 1, v5
    v_bfe_u32 v6, v1, 0, 1
    v_add_u32 v5, v5, v6
    s_lshl_b32 s47, s50, 2
    v_add_u32 v5, s47, v5
    v_lshlrev_b32 v6, 2, v4
    v_xor_b32 v5, v5, v6
    v_lshlrev_b32 v5, 4, v5
    v_lshl_add_u32 v5, v4, 8, v5
    v_bfe_u32 v6, v1, 1, 1
    v_lshl_add_u32 v5, v6, 3, v5
    v_lshrrev_b32 v6, 5, v1
    v_mul_u32_u24 v6, 2048, v6
    v_add_u32 v5, v5, v6
    s_lshl_b32 s47, s51, 16
    v_add_u32 v5, s47, v5
    v_bfe_u32 v4, v1, 2, 2
    v_xor_b32 v5, s50, v4
    v_lshlrev_b32 v5, 6, v5
    v_lshl_add_u32 v5, v4, 8, v5
    v_and_b32 v6, 3, v1
    v_lshl_add_u32 v5, v6, 4, v5
    v_lshrrev_b32 v6, 4, v1
    v_lshl_add_u32 v5, v6, 11, v5
    v_lshrrev_b32 v6, 5, v1
    s_lshl_b32 s47, s51, 16
    v_add_u32 v5, s47, v5
    s_add_u32 m0, s45, 0
    s_add_u32 s47, s46, 0x0
    buffer_load_dwordx4 v3, s[24:27], s47 offen lds
    s_add_u32 m0, s45, 1024
    s_add_u32 s47, s46, 0x8000
    buffer_load_dwordx4 v3, s[24:27], s47 offen lds
    s_add_u32 m0, s45, 2048
    s_add_u32 s47, s46, 0x10000
    buffer_load_dwordx4 v3, s[24:27], s47 offen lds
    s_add_u32 m0, s45, 3072
    s_add_u32 s47, s46, 0x18000
    buffer_load_dwordx4 v3, s[24:27], s47 offen lds
    s_add_u32 m0, s45, 4096
    s_add_u32 s47, s46, 0x20000
    buffer_load_dwordx4 v3, s[24:27], s47 offen lds
    s_add_u32 m0, s45, 5120
    s_add_u32 s47, s46, 0x28000
    buffer_load_dwordx4 v3, s[24:27], s47 offen lds
    s_add_u32 m0, s45, 6144
    s_add_u32 s47, s46, 0x30000
    buffer_load_dwordx4 v3, s[24:27], s47 offen lds
    s_add_u32 m0, s45, 7168
    s_add_u32 s47, s46, 0x38000
    buffer_load_dwordx4 v3, s[24:27], s47 offen lds
    s_add_u32 m0, s45, 8192
    s_add_u32 s47, s46, 0x40000
    buffer_load_dwordx4 v3, s[24:27], s47 offen lds
    s_add_u32 m0, s45, 9216
    s_add_u32 s47, s46, 0x48000
    buffer_load_dwordx4 v3, s[24:27], s47 offen lds
    s_add_u32 m0, s45, 10240
    s_add_u32 s47, s46, 0x50000
    buffer_load_dwordx4 v3, s[24:27], s47 offen lds
    s_add_u32 m0, s45, 11264
    s_add_u32 s47, s46, 0x58000
    buffer_load_dwordx4 v3, s[24:27], s47 offen lds
    s_add_u32 m0, s45, 12288
    s_add_u32 s47, s46, 0x60000
    buffer_load_dwordx4 v3, s[24:27], s47 offen lds
    s_add_u32 m0, s45, 13312
    s_add_u32 s47, s46, 0x68000
    buffer_load_dwordx4 v3, s[24:27], s47 offen lds
    s_add_u32 m0, s45, 14336
    s_add_u32 s47, s46, 0x70000
    buffer_load_dwordx4 v3, s[24:27], s47 offen lds
    s_add_u32 m0, s45, 15360
    s_add_u32 s47, s46, 0x78000
    buffer_load_dwordx4 v3, s[24:27], s47 offen lds
    s_waitcnt vmcnt(0)
    s_barrier
    ds_read_b64_tr_b16 a[0:1], v5 offset:0
    ds_read_b64_tr_b16 a[2:3], v5 offset:1024
    ds_read_b64_tr_b16 a[4:5], v5 offset:8
    ds_read_b64_tr_b16 a[6:7], v5 offset:1032
    ds_read_b64_tr_b16 a[8:9], v5 offset:8192
    ds_read_b64_tr_b16 a[10:11], v5 offset:9216
    ds_read_b64_tr_b16 a[12:13], v5 offset:8200
    ds_read_b64_tr_b16 a[14:15], v5 offset:9224
    s_waitcnt lgkmcnt(0)
    ds_read_b64_tr_b16 a[16:17], v5 offset:16384
    ds_read_b64_tr_b16 a[18:19], v5 offset:17408
    ds_read_b64_tr_b16 a[20:21], v5 offset:16392
    ds_read_b64_tr_b16 a[22:23], v5 offset:17416
    ds_read_b64_tr_b16 a[24:25], v5 offset:24576
    ds_read_b64_tr_b16 a[26:27], v5 offset:25600
    ds_read_b64_tr_b16 a[28:29], v5 offset:24584
    ds_read_b64_tr_b16 a[30:31], v5 offset:25608
    s_waitcnt lgkmcnt(0)
    ds_read_b64_tr_b16 a[32:33], v5 offset:32768
    ds_read_b64_tr_b16 a[34:35], v5 offset:33792
    ds_read_b64_tr_b16 a[36:37], v5 offset:32776
    ds_read_b64_tr_b16 a[38:39], v5 offset:33800
    ds_read_b64_tr_b16 a[40:41], v5 offset:40960
    ds_read_b64_tr_b16 a[42:43], v5 offset:41984
    ds_read_b64_tr_b16 a[44:45], v5 offset:40968
    ds_read_b64_tr_b16 a[46:47], v5 offset:41992
    s_waitcnt lgkmcnt(0)
    ds_read_b64_tr_b16 a[48:49], v5 offset:49152
    ds_read_b64_tr_b16 a[50:51], v5 offset:50176
    ds_read_b64_tr_b16 a[52:53], v5 offset:49160
    ds_read_b64_tr_b16 a[54:55], v5 offset:50184
    ds_read_b64_tr_b16 a[56:57], v5 offset:57344
    ds_read_b64_tr_b16 a[58:59], v5 offset:58368
    ds_read_b64_tr_b16 a[60:61], v5 offset:57352
    ds_read_b64_tr_b16 a[62:63], v5 offset:58376
    s_waitcnt lgkmcnt(0)
    s_waitcnt lgkmcnt(0)
    s_barrier
    s_add_u32 m0, s45, 0
    s_add_u32 s47, s46, 0x200000
    buffer_load_dwordx4 v3, s[24:27], s47 offen lds
    s_add_u32 m0, s45, 1024
    s_add_u32 s47, s46, 0x208000
    buffer_load_dwordx4 v3, s[24:27], s47 offen lds
    s_add_u32 m0, s45, 2048
    s_add_u32 s47, s46, 0x210000
    buffer_load_dwordx4 v3, s[24:27], s47 offen lds
    s_add_u32 m0, s45, 3072
    s_add_u32 s47, s46, 0x218000
    buffer_load_dwordx4 v3, s[24:27], s47 offen lds
    s_add_u32 m0, s45, 4096
    s_add_u32 s47, s46, 0x220000
    buffer_load_dwordx4 v3, s[24:27], s47 offen lds
    s_add_u32 m0, s45, 5120
    s_add_u32 s47, s46, 0x228000
    buffer_load_dwordx4 v3, s[24:27], s47 offen lds
    s_add_u32 m0, s45, 6144
    s_add_u32 s47, s46, 0x230000
    buffer_load_dwordx4 v3, s[24:27], s47 offen lds
    s_add_u32 m0, s45, 7168
    s_add_u32 s47, s46, 0x238000
    buffer_load_dwordx4 v3, s[24:27], s47 offen lds
    s_add_u32 m0, s45, 8192
    s_add_u32 s47, s46, 0x240000
    buffer_load_dwordx4 v3, s[24:27], s47 offen lds
    s_add_u32 m0, s45, 9216
    s_add_u32 s47, s46, 0x248000
    buffer_load_dwordx4 v3, s[24:27], s47 offen lds
    s_add_u32 m0, s45, 10240
    s_add_u32 s47, s46, 0x250000
    buffer_load_dwordx4 v3, s[24:27], s47 offen lds
    s_add_u32 m0, s45, 11264
    s_add_u32 s47, s46, 0x258000
    buffer_load_dwordx4 v3, s[24:27], s47 offen lds
    s_add_u32 m0, s45, 12288
    s_add_u32 s47, s46, 0x260000
    buffer_load_dwordx4 v3, s[24:27], s47 offen lds
    s_add_u32 m0, s45, 13312
    s_add_u32 s47, s46, 0x268000
    buffer_load_dwordx4 v3, s[24:27], s47 offen lds
    s_add_u32 m0, s45, 14336
    s_add_u32 s47, s46, 0x270000
    buffer_load_dwordx4 v3, s[24:27], s47 offen lds
    s_add_u32 m0, s45, 15360
    s_add_u32 s47, s46, 0x278000
    buffer_load_dwordx4 v3, s[24:27], s47 offen lds
    s_waitcnt vmcnt(0)
    s_barrier
    ds_read_b64_tr_b16 a[64:65], v5 offset:0
    ds_read_b64_tr_b16 a[66:67], v5 offset:1024
    ds_read_b64_tr_b16 a[68:69], v5 offset:8
    ds_read_b64_tr_b16 a[70:71], v5 offset:1032
    ds_read_b64_tr_b16 a[72:73], v5 offset:8192
    ds_read_b64_tr_b16 a[74:75], v5 offset:9216
    ds_read_b64_tr_b16 a[76:77], v5 offset:8200
    ds_read_b64_tr_b16 a[78:79], v5 offset:9224
    s_waitcnt lgkmcnt(0)
    ds_read_b64_tr_b16 a[80:81], v5 offset:16384
    ds_read_b64_tr_b16 a[82:83], v5 offset:17408
    ds_read_b64_tr_b16 a[84:85], v5 offset:16392
    ds_read_b64_tr_b16 a[86:87], v5 offset:17416
    ds_read_b64_tr_b16 a[88:89], v5 offset:24576
    ds_read_b64_tr_b16 a[90:91], v5 offset:25600
    ds_read_b64_tr_b16 a[92:93], v5 offset:24584
    ds_read_b64_tr_b16 a[94:95], v5 offset:25608
    s_waitcnt lgkmcnt(0)
    ds_read_b64_tr_b16 a[96:97], v5 offset:32768
    ds_read_b64_tr_b16 a[98:99], v5 offset:33792
    ds_read_b64_tr_b16 a[100:101], v5 offset:32776
    ds_read_b64_tr_b16 a[102:103], v5 offset:33800
    ds_read_b64_tr_b16 a[104:105], v5 offset:40960
    ds_read_b64_tr_b16 a[106:107], v5 offset:41984
    ds_read_b64_tr_b16 a[108:109], v5 offset:40968
    ds_read_b64_tr_b16 a[110:111], v5 offset:41992
    s_waitcnt lgkmcnt(0)
    ds_read_b64_tr_b16 a[112:113], v5 offset:49152
    ds_read_b64_tr_b16 a[114:115], v5 offset:50176
    ds_read_b64_tr_b16 a[116:117], v5 offset:49160
    ds_read_b64_tr_b16 a[118:119], v5 offset:50184
    ds_read_b64_tr_b16 a[120:121], v5 offset:57344
    ds_read_b64_tr_b16 a[122:123], v5 offset:58368
    ds_read_b64_tr_b16 a[124:125], v5 offset:57352
    ds_read_b64_tr_b16 a[126:127], v5 offset:58376
    s_waitcnt lgkmcnt(0)
    s_waitcnt lgkmcnt(0)
    s_barrier
    v_lshlrev_b32 v2, 4, v1
    s_mul_i32 s64, s44, 8192
    s_add_u32 s46, s64, 0x400000
    v_add_u32 v3, s46, v2
    s_mul_i32 s46, s51, 32768
    v_add_u32 v4, s46, v2
    v_and_b32 v6, 15, v1
    v_lshlrev_b32 v6, 4, v6
    v_lshrrev_b32 v7, 4, v1
    v_lshl_add_u32 v6, v7, 9, v6
    v_add_u32 v4, s46, v6
    s_lshl_b32 s46, s50, 12
    s_add_u32 s46, s46, 131072
    v_add_u32 v5, s46, v2
    v_and_b32 v7, 3, v1
    v_lshlrev_b32 v7, 7, v7
    v_add_u32 v7, 0x109400, v7
    s_mul_i32 s46, s49, 24576
    s_lshl_b32 s47, s53, 13
    s_add_u32 s46, s46, s47
    s_lshl_b32 s47, s50, 10
    s_add_u32 s46, s46, s47
    s_add_u32 s46, s46, 0x2000000
    v_and_b32 v8, 15, v1
    v_lshlrev_b32 v8, 4, v8
    v_bfe_u32 v9, v1, 4, 1
    v_lshl_add_u32 v8, v9, 12, v8
    v_lshrrev_b32 v9, 5, v1
    v_lshl_add_u32 v8, v9, 8, v8
    v_add_u32 v8, s46, v2
    v_add_u32 v9, 4096, v8
    s_lshl_b32 s52, s40, 2
    s_add_u32 s52, s52, s53
    s_lshl_b32 s52, s52, 2
    s_and_b32 s47, s48, 3
    s_add_u32 s52, s52, s47
    s_lshl_b32 s52, s52, 7
    s_add_u32 s52, s52, 0x10a400
    v_mov_b32 v116, -1
    v_mov_b32 v117, -1
    v_mov_b32 v118, -1
    v_mov_b32 v119, -1
    s_lshl_b32 s46, s49, 12
    s_lshl_b32 s47, s50, 10
    s_add_u32 s46, s46, s47
    s_add_u32 s46, s46, 0x1000000
    v_add_u32 v64, s46, v2
    s_and_b32 s46, s48, 3
    s_lshl_b32 s46, s46, 15
    s_lshl_b32 s47, s50, 13
    s_add_u32 s46, s46, s47
    s_lshl_b32 s47, s40, 8
    s_add_u32 s46, s46, s47
    s_add_u32 s46, s46, 0x7800000
    v_and_b32 v65, 15, v1
    v_lshlrev_b32 v65, 4, v65
    v_lshrrev_b32 v66, 4, v1
    v_lshl_add_u32 v65, v66, 11, v65
    v_add_u32 v65, s46, v65
    s_cmp_eq_u32 s53, 2
    s_cselect_b64 vcc, -1, 0
    v_cndmask_b32 v64, v64, v65, vcc
    s_lshl_b32 s58, s74, 17
    s_mov_b32 s60, s74
    s_mul_i32 s61, s74, 65536
    s_mov_b32 s62, s74
    s_mul_i32 s63, s74, 786432
    s_mov_b32 s67, 0
    s_mov_b32 s68, 3
    s_mov_b32 s71, 0
    v_mov_b32 v15, 147456
    v_mov_b32 v14, 0
    ds_write_b32 v15, v14 offset:4
    ds_write_b32 v15, v14 offset:12
    ds_write_b32 v15, v14 offset:16
    v_mov_b32 v114, 1
    s_mov_b32 s72, 0
    s_cmp_lg_u32 s44, 0
    s_cbranch_scc1 L_zwok_57
    v_and_b32 v10, 7, v1
    v_lshlrev_b32 v10, 5, v10
    s_mov_b32 s70, 0
L_zw_56:
    buffer_load_dword v11, v10, s[16:19], 0 offen sc1
    s_waitcnt vmcnt(0)
    v_add_u32_dpp v11, v11, v11 row_ror:1 row_mask:0xf bank_mask:0xf
    s_nop 1
    v_add_u32_dpp v11, v11, v11 row_ror:2 row_mask:0xf bank_mask:0xf
    s_nop 1
    v_add_u32_dpp v11, v11, v11 row_ror:4 row_mask:0xf bank_mask:0xf
    v_cmp_ne_u32 vcc, 0x100, v11
    s_add_u32 s70, s70, 1
    s_cbranch_vccz L_zwok_57
    s_sleep 4
    s_cmp_lt_u32 s70, 524288
    s_cbranch_scc1 L_zw_56
    s_branch L_c_done_1
L_zwok_57:
    s_cmp_eq_u32 s74, 0
    s_cbranch_scc1 L_g_nh_58
    s_cmp_lg_u32 s44, 0
    s_cbranch_scc1 L_g_nh_58
    v_mov_b32 v10, 0
    s_sub_u32 s47, s74, 1
    s_mov_b32 s70, 0
L_spin_59:
    buffer_load_dword v11, v10, s[12:15], s52 offen sc1
    s_waitcnt vmcnt(0)
    v_cmp_ge_u32 vcc, s47, v11
    s_add_u32 s70, s70, 1
    s_cbranch_vccz L_spok_60
    s_sleep 3
    s_cmp_lt_u32 s70, 524288
    s_cbranch_scc1 L_spin_59
    s_branch L_c_done_1
L_spok_60:
L_g_nh_58:
L_g_restart_48:
    s_cmp_lg_u32 s44, 0
    s_cbranch_scc1 L_g_nsp_49
    s_mov_b32 s70, 0
L_g_sp_55:
    s_add_u32 s54, s60, 0
    s_add_u32 s55, s54, 0
    s_and_b32 s46, s55, 7
    s_lshl_b32 s46, s46, 9
    buffer_load_dword v11, v7, s[12:15], s46 offen sc1
    s_add_u32 s55, s54, 1
    s_and_b32 s46, s55, 7
    s_lshl_b32 s46, s46, 9
    buffer_load_dword v12, v7, s[12:15], s46 offen sc1
    s_add_u32 s55, s54, 2
    s_and_b32 s46, s55, 7
    s_lshl_b32 s46, s46, 9
    buffer_load_dword v13, v7, s[12:15], s46 offen sc1
    s_waitcnt vmcnt(0)
    v_cmp_ge_u32 vcc, s60, v11
    s_add_u32 s70, s70, 1
    s_cbranch_vccz L_g_sp_55_ok
    s_sleep 3
    s_cmp_lt_u32 s70, 524288
    s_cbranch_scc1 L_g_sp_55
    s_branch L_c_done_1
L_g_sp_55_ok:
    s_mov_b32 s46, s54
    v_cmp_ge_u32 vcc, s46, v11
    s_nop 0
    s_cbranch_vccnz L_g_le_61
    s_add_u32 s46, s46, 1
    v_cmp_ge_u32 vcc, s46, v12
    s_nop 0
    s_cbranch_vccnz L_g_le_61
    s_add_u32 s46, s46, 1
    v_cmp_ge_u32 vcc, s46, v13
    s_nop 0
    s_cbranch_vccnz L_g_le_61
    s_add_u32 s46, s46, 1
L_g_le_61:
    s_min_u32 s46, s46, s75
    v_mov_b32 v11, s46
    ds_write_b32 v15, v11
L_g_nsp_49:
    s_waitcnt lgkmcnt(0)
    s_barrier
    ds_read_b32 v14, v15
    s_waitcnt lgkmcnt(0)
    v_readfirstlane_b32 s66, v14
    s_nop 3
L_g_restart_48_go:
    s_mov_b32 s69, 0
    s_cmp_gt_u32 s62, s60
    s_cbranch_scc1 L_g_nd_62
    s_cmp_ge_u32 s62, s66
    s_cbranch_scc1 L_g_nd_62
    s_add_u32 s47, s61, 4096
    s_add_u32 m0, s64, 0
    s_nop 0
    buffer_load_dwordx4 v3, s[12:15], s61 offen offset:0 sc1 lds
    buffer_load_dwordx4 v3, s[12:15], s61 offen offset:1024 sc1 lds
    buffer_load_dwordx4 v3, s[12:15], s61 offen offset:2048 sc1 lds
    buffer_load_dwordx4 v3, s[12:15], s61 offen offset:3072 sc1 lds
    s_add_u32 m0, s64, 4096
    s_nop 0
    buffer_load_dwordx4 v3, s[12:15], s47 offen offset:0 sc1 lds
    buffer_load_dwordx4 v3, s[12:15], s47 offen offset:1024 sc1 lds
    buffer_load_dwordx4 v3, s[12:15], s47 offen offset:2048 sc1 lds
    buffer_load_dwordx4 v3, s[12:15], s47 offen offset:3072 sc1 lds
    s_add_u32 s61, s61, 65536
    s_add_u32 s62, s62, 1
    s_xor_b32 s64, s64, 0x10000
    s_mov_b32 s69, 1
L_g_nd_62:
    s_cmp_eq_u32 s51, 1
    s_cbranch_scc1 L_g_g1r_50
    s_add_u32 s59, s60, 1
    s_mov_b32 s69, 0
    s_cmp_gt_u32 s62, s59
    s_cbranch_scc1 L_g_nd_63
    s_cmp_ge_u32 s62, s66
    s_cbranch_scc1 L_g_nd_63
    s_add_u32 s47, s61, 4096
    s_add_u32 m0, s64, 0
    s_nop 0
    buffer_load_dwordx4 v3, s[12:15], s61 offen offset:0 sc1 lds
    buffer_load_dwordx4 v3, s[12:15], s61 offen offset:1024 sc1 lds
    buffer_load_dwordx4 v3, s[12:15], s61 offen offset:2048 sc1 lds
    buffer_load_dwordx4 v3, s[12:15], s61 offen offset:3072 sc1 lds
    s_add_u32 m0, s64, 4096
    s_nop 0
    buffer_load_dwordx4 v3, s[12:15], s47 offen offset:0 sc1 lds
    buffer_load_dwordx4 v3, s[12:15], s47 offen offset:1024 sc1 lds
    buffer_load_dwordx4 v3, s[12:15], s47 offen offset:2048 sc1 lds
    buffer_load_dwordx4 v3, s[12:15], s47 offen offset:3072 sc1 lds
    s_add_u32 s61, s61, 65536
    s_add_u32 s62, s62, 1
    s_xor_b32 s64, s64, 0x10000
    s_mov_b32 s69, 1
L_g_nd_63:
    s_cmp_eq_u32 s69, 1
    s_cbranch_scc1 L_g_w0_64
    s_waitcnt vmcnt(0)
L_g_w0_64:
    s_waitcnt vmcnt(8)
    s_mov_b32 s65, 1
.p2align 6
L_g_loop0_51:
    s_barrier
    s_cmp_eq_u32 s65, 0
    s_cbranch_scc1 L_g_pr_65
    ds_read_b128 v[32:35], v4 offset:0
    ds_read_b128 v[36:39], v4 offset:256
    ds_read_b128 v[40:43], v4 offset:2048
    ds_read_b128 v[44:47], v4 offset:2304
    ds_read_b128 v[48:51], v4 offset:4096
    ds_read_b128 v[52:55], v4 offset:4352
    ds_read_b128 v[56:59], v4 offset:6144
    ds_read_b128 v[60:63], v4 offset:6400
    ds_read_b128 v[72:75], v4 offset:8192
    ds_read_b128 v[76:79], v4 offset:8448
    ds_read_b128 v[120:123], v4 offset:10240
    ds_read_b128 v[124:127], v4 offset:10496
L_g_pr_65:
    ds_read_b32 v14, v15
    s_cmp_lg_u32 s44, 0
    s_cbranch_scc1 L_g_nl_66
    s_add_u32 s54, s60, 1
    s_add_u32 s55, s54, 0
    s_and_b32 s46, s55, 7
    s_lshl_b32 s46, s46, 9
    buffer_load_dword v11, v7, s[12:15], s46 offen sc1
    s_add_u32 s55, s54, 1
    s_and_b32 s46, s55, 7
    s_lshl_b32 s46, s46, 9
    buffer_load_dword v12, v7, s[12:15], s46 offen sc1
    s_add_u32 s55, s54, 2
    s_and_b32 s46, s55, 7
    s_lshl_b32 s46, s46, 9
    buffer_load_dword v13, v7, s[12:15], s46 offen sc1
L_g_nl_66:
    s_setprio 2
    s_waitcnt lgkmcnt(8)
    v_mfma_f32_16x16x32_bf16 v[16:19], a[0:3], v[32:35], 0
    v_mfma_f32_16x16x32_bf16 v[20:23], a[4:7], v[32:35], 0
    ds_read_b128 v[32:35], v4 offset:12288
    v_mfma_f32_16x16x32_bf16 v[28:31], a[4:7], v[36:39], 0
    v_mfma_f32_16x16x32_bf16 v[24:27], a[0:3], v[36:39], 0
    ds_read_b128 v[36:39], v4 offset:12544
    v_mfma_f32_16x16x32_bf16 v[16:19], a[8:11], v[40:43], v[16:19]
    v_mfma_f32_16x16x32_bf16 v[20:23], a[12:15], v[40:43], v[20:23]
    ds_read_b128 v[40:43], v4 offset:14336
    v_mfma_f32_16x16x32_bf16 v[28:31], a[12:15], v[44:47], v[28:31]
    v_mfma_f32_16x16x32_bf16 v[24:27], a[8:11], v[44:47], v[24:27]
    ds_read_b128 v[44:47], v4 offset:14592
    s_waitcnt lgkmcnt(8)
    v_mfma_f32_16x16x32_bf16 v[16:19], a[16:19], v[48:51], v[16:19]
    v_mfma_f32_16x16x32_bf16 v[20:23], a[20:23], v[48:51], v[20:23]
    ds_read_b128 v[48:51], v4 offset:16384
    v_mfma_f32_16x16x32_bf16 v[28:31], a[20:23], v[52:55], v[28:31]
    v_mfma_f32_16x16x32_bf16 v[24:27], a[16:19], v[52:55], v[24:27]
    ds_read_b128 v[52:55], v4 offset:16640
    v_mfma_f32_16x16x32_bf16 v[16:19], a[24:27], v[56:59], v[16:19]
    v_mfma_f32_16x16x32_bf16 v[20:23], a[28:31], v[56:59], v[20:23]
    ds_read_b128 v[56:59], v4 offset:18432
    v_mfma_f32_16x16x32_bf16 v[28:31], a[28:31], v[60:63], v[28:31]
    v_mfma_f32_16x16x32_bf16 v[24:27], a[24:27], v[60:63], v[24:27]
    ds_read_b128 v[60:63], v4 offset:18688
    s_waitcnt lgkmcnt(8)
    v_mfma_f32_16x16x32_bf16 v[16:19], a[32:35], v[72:75], v[16:19]
    v_mfma_f32_16x16x32_bf16 v[20:23], a[36:39], v[72:75], v[20:23]
    ds_read_b128 v[72:75], v4 offset:20480
    v_mfma_f32_16x16x32_bf16 v[28:31], a[36:39], v[76:79], v[28:31]
    v_mfma_f32_16x16x32_bf16 v[24:27], a[32:35], v[76:79], v[24:27]
    ds_read_b128 v[76:79], v4 offset:20736
    v_mfma_f32_16x16x32_bf16 v[16:19], a[40:43], v[120:123], v[16:19]
    v_mfma_f32_16x16x32_bf16 v[20:23], a[44:47], v[120:123], v[20:23]
    ds_read_b128 v[120:123], v4 offset:22528
    v_mfma_f32_16x16x32_bf16 v[28:31], a[44:47], v[124:127], v[28:31]
    v_mfma_f32_16x16x32_bf16 v[24:27], a[40:43], v[124:127], v[24:27]
    ds_read_b128 v[124:127], v4 offset:22784
    s_waitcnt lgkmcnt(8)
    v_mfma_f32_16x16x32_bf16 v[16:19], a[48:51], v[32:35], v[16:19]
    v_mfma_f32_16x16x32_bf16 v[20:23], a[52:55], v[32:35], v[20:23]
    ds_read_b128 v[32:35], v4 offset:24576
    v_mfma_f32_16x16x32_bf16 v[28:31], a[52:55], v[36:39], v[28:31]
    v_mfma_f32_16x16x32_bf16 v[24:27], a[48:51], v[36:39], v[24:27]
    ds_read_b128 v[36:39], v4 offset:24832
    v_mfma_f32_16x16x32_bf16 v[16:19], a[56:59], v[40:43], v[16:19]
    v_mfma_f32_16x16x32_bf16 v[20:23], a[60:63], v[40:43], v[20:23]
    ds_read_b128 v[40:43], v4 offset:26624
    v_mfma_f32_16x16x32_bf16 v[28:31], a[60:63], v[44:47], v[28:31]
    v_mfma_f32_16x16x32_bf16 v[24:27], a[56:59], v[44:47], v[24:27]
    ds_read_b128 v[44:47], v4 offset:26880
    s_waitcnt lgkmcnt(8)
    v_mfma_f32_16x16x32_bf16 v[16:19], a[64:67], v[48:51], v[16:19]
    v_mfma_f32_16x16x32_bf16 v[20:23], a[68:71], v[48:51], v[20:23]
    ds_read_b128 v[48:51], v4 offset:28672
    v_mfma_f32_16x16x32_bf16 v[28:31], a[68:71], v[52:55], v[28:31]
    v_mfma_f32_16x16x32_bf16 v[24:27], a[64:67], v[52:55], v[24:27]
    ds_read_b128 v[52:55], v4 offset:28928
    v_mfma_f32_16x16x32_bf16 v[16:19], a[72:75], v[56:59], v[16:19]
    v_mfma_f32_16x16x32_bf16 v[20:23], a[76:79], v[56:59], v[20:23]
    ds_read_b128 v[56:59], v4 offset:30720
    v_mfma_f32_16x16x32_bf16 v[28:31], a[76:79], v[60:63], v[28:31]
    v_mfma_f32_16x16x32_bf16 v[24:27], a[72:75], v[60:63], v[24:27]
    ds_read_b128 v[60:63], v4 offset:30976
    s_waitcnt lgkmcnt(8)
    v_mfma_f32_16x16x32_bf16 v[16:19], a[80:83], v[72:75], v[16:19]
    v_mfma_f32_16x16x32_bf16 v[20:23], a[84:87], v[72:75], v[20:23]
    v_mfma_f32_16x16x32_bf16 v[28:31], a[84:87], v[76:79], v[28:31]
    v_mfma_f32_16x16x32_bf16 v[24:27], a[80:83], v[76:79], v[24:27]
    v_mfma_f32_16x16x32_bf16 v[16:19], a[88:91], v[120:123], v[16:19]
    v_mfma_f32_16x16x32_bf16 v[20:23], a[92:95], v[120:123], v[20:23]
    v_mfma_f32_16x16x32_bf16 v[28:31], a[92:95], v[124:127], v[28:31]
    v_mfma_f32_16x16x32_bf16 v[24:27], a[88:91], v[124:127], v[24:27]
    s_waitcnt lgkmcnt(4)
    v_mfma_f32_16x16x32_bf16 v[16:19], a[96:99], v[32:35], v[16:19]
    v_mfma_f32_16x16x32_bf16 v[20:23], a[100:103], v[32:35], v[20:23]
    v_mfma_f32_16x16x32_bf16 v[28:31], a[100:103], v[36:39], v[28:31]
    v_mfma_f32_16x16x32_bf16 v[24:27], a[96:99], v[36:39], v[24:27]
    v_mfma_f32_16x16x32_bf16 v[16:19], a[104:107], v[40:43], v[16:19]
    v_mfma_f32_16x16x32_bf16 v[20:23], a[108:111], v[40:43], v[20:23]
    v_mfma_f32_16x16x32_bf16 v[28:31], a[108:111], v[44:47], v[28:31]
    v_mfma_f32_16x16x32_bf16 v[24:27], a[104:107], v[44:47], v[24:27]
    s_waitcnt lgkmcnt(0)
    v_mfma_f32_16x16x32_bf16 v[16:19], a[112:115], v[48:51], v[16:19]
    v_mfma_f32_16x16x32_bf16 v[20:23], a[116:119], v[48:51], v[20:23]
    v_mfma_f32_16x16x32_bf16 v[28:31], a[116:119], v[52:55], v[28:31]
    v_mfma_f32_16x16x32_bf16 v[24:27], a[112:115], v[52:55], v[24:27]
    v_mfma_f32_16x16x32_bf16 v[16:19], a[120:123], v[56:59], v[16:19]
    v_mfma_f32_16x16x32_bf16 v[20:23], a[124:127], v[56:59], v[20:23]
    v_mfma_f32_16x16x32_bf16 v[28:31], a[124:127], v[60:63], v[28:31]
    v_mfma_f32_16x16x32_bf16 v[24:27], a[120:123], v[60:63], v[24:27]
    v_xor_b32 v4, 0x10000, v4
    s_setprio 0
    s_waitcnt vmcnt(0)
    v_readfirstlane_b32 s66, v14
    s_barrier
    s_nop 6
    ds_write_b128 v5, v[16:19] offset:0
    ds_write_b128 v5, v[20:23] offset:1024
    ds_write_b128 v5, v[24:27] offset:2048
    ds_write_b128 v5, v[28:31] offset:3072
    s_cmp_lg_u32 s44, 0
    s_cbranch_scc1 L_g_ne_67
    s_mov_b32 s46, s54
    v_cmp_ge_u32 vcc, s46, v11
    s_nop 0
    s_cbranch_vccnz L_g_le_70
    s_add_u32 s46, s46, 1
    v_cmp_ge_u32 vcc, s46, v12
    s_nop 0
    s_cbranch_vccnz L_g_le_70
    s_add_u32 s46, s46, 1
    v_cmp_ge_u32 vcc, s46, v13
    s_nop 0
    s_cbranch_vccnz L_g_le_70
    s_add_u32 s46, s46, 1
L_g_le_70:
    s_min_u32 s46, s46, s75
    v_mov_b32 v11, s46
    ds_write_b32 v15, v11
L_g_ne_67:
    s_add_u32 s60, s60, 1
    s_mov_b32 s69, 0
    s_cmp_gt_u32 s62, s60
    s_cbranch_scc1 L_g_nd_71
    s_cmp_ge_u32 s62, s66
    s_cbranch_scc1 L_g_nd_71
    s_add_u32 s47, s61, 4096
    s_add_u32 m0, s64, 0
    s_nop 0
    buffer_load_dwordx4 v3, s[12:15], s61 offen offset:0 sc1 lds
    buffer_load_dwordx4 v3, s[12:15], s61 offen offset:1024 sc1 lds
    buffer_load_dwordx4 v3, s[12:15], s61 offen offset:2048 sc1 lds
    buffer_load_dwordx4 v3, s[12:15], s61 offen offset:3072 sc1 lds
    s_add_u32 m0, s64, 4096
    s_nop 0
    buffer_load_dwordx4 v3, s[12:15], s47 offen offset:0 sc1 lds
    buffer_load_dwordx4 v3, s[12:15], s47 offen offset:1024 sc1 lds
    buffer_load_dwordx4 v3, s[12:15], s47 offen offset:2048 sc1 lds
    buffer_load_dwordx4 v3, s[12:15], s47 offen offset:3072 sc1 lds
    s_add_u32 s61, s61, 65536
    s_add_u32 s62, s62, 1
    s_xor_b32 s64, s64, 0x10000
    s_mov_b32 s69, 1
L_g_nd_71:
    s_mov_b32 s65, s69
    s_add_u32 s59, s60, 1
    s_mov_b32 s69, 0
    s_cmp_gt_u32 s62, s59
    s_cbranch_scc1 L_g_nd_72
    s_cmp_ge_u32 s62, s66
    s_cbranch_scc1 L_g_nd_72
    s_add_u32 s47, s61, 4096
    s_add_u32 m0, s64, 0
    s_nop 0
    buffer_load_dwordx4 v3, s[12:15], s61 offen offset:0 sc1 lds
    buffer_load_dwordx4 v3, s[12:15], s61 offen offset:1024 sc1 lds
    buffer_load_dwordx4 v3, s[12:15], s61 offen offset:2048 sc1 lds
    buffer_load_dwordx4 v3, s[12:15], s61 offen offset:3072 sc1 lds
    s_add_u32 m0, s64, 4096
    s_nop 0
    buffer_load_dwordx4 v3, s[12:15], s47 offen offset:0 sc1 lds
    buffer_load_dwordx4 v3, s[12:15], s47 offen offset:1024 sc1 lds
    buffer_load_dwordx4 v3, s[12:15], s47 offen offset:2048 sc1 lds
    buffer_load_dwordx4 v3, s[12:15], s47 offen offset:3072 sc1 lds
    s_add_u32 s61, s61, 65536
    s_add_u32 s62, s62, 1
    s_xor_b32 s64, s64, 0x10000
    s_mov_b32 s69, 1
L_g_nd_72:
    s_cmp_le_u32 s66, s60
    s_cbranch_scc1 L_g_ex0_69
    s_cmp_eq_u32 s65, 0
    s_cbranch_scc1 L_g_nw_68
    s_waitcnt vmcnt(0) lgkmcnt(0)
    s_branch L_g_loop0_51
L_g_nw_68:
    ds_read_b128 v[32:35], v4 offset:0
    ds_read_b128 v[36:39], v4 offset:256
    ds_read_b128 v[40:43], v4 offset:2048
    ds_read_b128 v[44:47], v4 offset:2304
    ds_read_b128 v[48:51], v4 offset:4096
    ds_read_b128 v[52:55], v4 offset:4352
    ds_read_b128 v[56:59], v4 offset:6144
    ds_read_b128 v[60:63], v4 offset:6400
    ds_read_b128 v[72:75], v4 offset:8192
    ds_read_b128 v[76:79], v4 offset:8448
    ds_read_b128 v[120:123], v4 offset:10240
    ds_read_b128 v[124:127], v4 offset:10496
    s_waitcnt lgkmcnt(12)
    s_branch L_g_loop0_51
L_g_ex0_69:
    s_cmp_lg_u32 s44, 0
    s_cbranch_scc1 L_g_ex0_69_n
    s_sleep 6
    s_add_u32 s54, s60, 0
    s_add_u32 s55, s54, 0
    s_and_b32 s46, s55, 7
    s_lshl_b32 s46, s46, 9
    buffer_load_dword v11, v7, s[12:15], s46 offen sc1
    s_add_u32 s55, s54, 1
    s_and_b32 s46, s55, 7
    s_lshl_b32 s46, s46, 9
    buffer_load_dword v12, v7, s[12:15], s46 offen sc1
    s_add_u32 s55, s54, 2
    s_and_b32 s46, s55, 7
    s_lshl_b32 s46, s46, 9
    buffer_load_dword v13, v7, s[12:15], s46 offen sc1
    s_waitcnt vmcnt(0)
    s_mov_b32 s46, s54
    v_cmp_ge_u32 vcc, s46, v11
    s_nop 0
    s_cbranch_vccnz L_g_le_73
    s_add_u32 s46, s46, 1
    v_cmp_ge_u32 vcc, s46, v12
    s_nop 0
    s_cbranch_vccnz L_g_le_73
    s_add_u32 s46, s46, 1
    v_cmp_ge_u32 vcc, s46, v13
    s_nop 0
    s_cbranch_vccnz L_g_le_73
    s_add_u32 s46, s46, 1
L_g_le_73:
    s_min_u32 s46, s46, s75
    v_mov_b32 v11, s46
    ds_write_b32 v15, v11
L_g_ex0_69_n:
    s_waitcnt lgkmcnt(0)
    s_barrier
    ds_read_b32 v14, v15
    s_waitcnt lgkmcnt(0)
    v_readfirstlane_b32 s66, v14
    s_barrier
    s_cmp_gt_u32 s66, s60
    s_cbranch_scc1 L_g_restart_48_go
    s_branch L_g_tail_53
L_g_g1r_50:
    s_mov_b32 s65, 1
    s_branch L_g_loop1_52_e
.p2align 6
L_g_loop1_52:
    s_mov_b32 s65, 0
L_g_loop1_52_e:
    s_barrier
    ds_read_b32 v14, v15
    s_bitcmp1_b32 s67, 1
    s_cbranch_scc0 L_g_nfl_74
    s_sub_u32 s59, s60, 2
    s_cmp_lg_u32 s44, 4
    s_cbranch_scc1 L_sf_79
    v_mov_b32 v10, s59
    v_add_u32 v10, 1, v10
    v_mov_b32 v11, 0
    s_mov_b64 exec, 1
    buffer_store_dword v10, v11, s[12:15], s52 offen sc1
    s_mov_b64 exec, -1
L_sf_79:
L_g_nfl_74:
    s_cmp_eq_u32 s71, 0
    s_cbranch_scc1 L_g_nfl_74_d
    v_mov_b32 v10, 1
    s_mov_b64 exec, 1
    s_waitcnt vmcnt(0)
    ds_add_rtn_u32 v10, v15, v10 offset:4
    s_waitcnt lgkmcnt(0)
    v_readfirstlane_b32 s46, v10
    s_mov_b64 exec, -1
    s_mov_b32 s71, 0
    s_sub_u32 s59, s60, 1
    s_cmp_lg_u32 s46, s68
    s_cbranch_scc1 L_g_df_80
    v_mov_b32 v10, s59
    v_add_u32 v10, 1, v10
    v_mov_b32 v11, 0
    s_mov_b64 exec, 1
    buffer_store_dword v10, v11, s[12:15], s52 offen sc1
    s_mov_b64 exec, -1
L_sf_81:
L_g_df_80:
    s_add_u32 s68, s68, 4
    s_mov_b32 s65, 2
L_g_nfl_74_d:
    s_waitcnt lgkmcnt(0)
    v_readfirstlane_b32 s66, v14
    s_nop 3
    s_mov_b32 s69, 0
    s_cmp_gt_u32 s62, s60
    s_cbranch_scc1 L_g_nd_82
    s_cmp_ge_u32 s62, s66
    s_cbranch_scc1 L_g_nd_82
    s_add_u32 s47, s61, 4096
    s_add_u32 m0, s64, 0
    s_nop 0
    buffer_load_dwordx4 v3, s[12:15], s61 offen offset:0 sc1 lds
    buffer_load_dwordx4 v3, s[12:15], s61 offen offset:1024 sc1 lds
    buffer_load_dwordx4 v3, s[12:15], s61 offen offset:2048 sc1 lds
    buffer_load_dwordx4 v3, s[12:15], s61 offen offset:3072 sc1 lds
    s_add_u32 m0, s64, 4096
    s_nop 0
    buffer_load_dwordx4 v3, s[12:15], s47 offen offset:0 sc1 lds
    buffer_load_dwordx4 v3, s[12:15], s47 offen offset:1024 sc1 lds
    buffer_load_dwordx4 v3, s[12:15], s47 offen offset:2048 sc1 lds
    buffer_load_dwordx4 v3, s[12:15], s47 offen offset:3072 sc1 lds
    s_add_u32 s61, s61, 65536
    s_add_u32 s62, s62, 1
    s_xor_b32 s64, s64, 0x10000
    s_mov_b32 s69, 1
L_g_nd_82:
    s_or_b32 s65, s65, s69
    s_add_u32 s59, s60, 1
    s_mov_b32 s69, 0
    s_cmp_gt_u32 s62, s59
    s_cbranch_scc1 L_g_nd_83
    s_cmp_ge_u32 s62, s66
    s_cbranch_scc1 L_g_nd_83
    s_add_u32 s47, s61, 4096
    s_add_u32 m0, s64, 0
    s_nop 0
    buffer_load_dwordx4 v3, s[12:15], s61 offen offset:0 sc1 lds
    buffer_load_dwordx4 v3, s[12:15], s61 offen offset:1024 sc1 lds
    buffer_load_dwordx4 v3, s[12:15], s61 offen offset:2048 sc1 lds
    buffer_load_dwordx4 v3, s[12:15], s61 offen offset:3072 sc1 lds
    s_add_u32 m0, s64, 4096
    s_nop 0
    buffer_load_dwordx4 v3, s[12:15], s47 offen offset:0 sc1 lds
    buffer_load_dwordx4 v3, s[12:15], s47 offen offset:1024 sc1 lds
    buffer_load_dwordx4 v3, s[12:15], s47 offen offset:2048 sc1 lds
    buffer_load_dwordx4 v3, s[12:15], s47 offen offset:3072 sc1 lds
    s_add_u32 s61, s61, 65536
    s_add_u32 s62, s62, 1
    s_xor_b32 s64, s64, 0x10000
    s_mov_b32 s69, 1
L_g_nd_83:
    s_bitcmp1_b32 s67, 0
    s_cbranch_scc0 L_g_nep_75
    ds_read_b128 v[80:83], v5 offset:0
    ds_read_b128 v[84:87], v5 offset:1024
    ds_read_b128 v[88:91], v5 offset:2048
    ds_read_b128 v[92:95], v5 offset:3072
    s_nop 7
    s_waitcnt lgkmcnt(3)
    v_add_f32 v80, v80, v16
    v_add_f32 v81, v81, v17
    v_add_f32 v82, v82, v18
    v_add_f32 v83, v83, v19
    s_waitcnt lgkmcnt(2)
    v_add_f32 v84, v84, v20
    v_add_f32 v85, v85, v21
    v_add_f32 v86, v86, v22
    v_add_f32 v87, v87, v23
    s_waitcnt lgkmcnt(1)
    v_add_f32 v88, v88, v24
    v_add_f32 v89, v89, v25
    v_add_f32 v90, v90, v26
    v_add_f32 v91, v91, v27
    s_waitcnt lgkmcnt(0)
    v_add_f32 v92, v92, v28
    v_add_f32 v93, v93, v29
    v_add_f32 v94, v94, v30
    v_add_f32 v95, v95, v31
    v_cvt_pk_bf16_f32 v104, v80, v81
    v_cvt_pk_bf16_f32 v105, v82, v83
    v_cvt_pk_bf16_f32 v106, v84, v85
    v_cvt_pk_bf16_f32 v107, v86, v87
    buffer_store_dwordx4 v[104:107], v8, s[12:15], s63 offen sc1
    v_cvt_pk_bf16_f32 v108, v88, v89
    v_cvt_pk_bf16_f32 v109, v90, v91
    v_cvt_pk_bf16_f32 v110, v92, v93
    v_cvt_pk_bf16_f32 v111, v94, v95
    buffer_store_dwordx4 v[108:111], v9, s[12:15], s63 offen sc1
    s_add_u32 s63, s63, 786432
    s_cmp_eq_u32 s53, 0
    s_cbranch_scc1 L_g_pf_84
    buffer_store_dwordx4 v[116:119], v64, s[12:15], s58 offen sc1
L_g_pf_84:
    s_add_u32 s58, s58, 131072
    s_cmp_gt_u32 s60, 2
    s_cbranch_scc1 L_g_nep_75
    v_mov_b32 v10, 1
    s_mov_b64 exec, 1
    s_waitcnt vmcnt(0)
    ds_add_rtn_u32 v10, v15, v10 offset:4
    s_waitcnt lgkmcnt(0)
    v_readfirstlane_b32 s46, v10
    s_mov_b64 exec, -1
    s_mov_b32 s71, 0
    s_sub_u32 s59, s60, 1
    s_cmp_lg_u32 s46, s68
    s_cbranch_scc1 L_g_df_85
    v_mov_b32 v10, s59
    v_add_u32 v10, 1, v10
    v_mov_b32 v11, 0
    s_mov_b64 exec, 1
    buffer_store_dword v10, v11, s[12:15], s52 offen sc1
    s_mov_b64 exec, -1
L_sf_86:
L_g_df_85:
    s_add_u32 s68, s68, 4
L_g_nep_75:
    s_cmp_eq_u32 s65, 0
    s_cbranch_scc1 L_g_nw1_76
    s_cmp_eq_u32 s65, 2
    s_cbranch_scc1 L_g_nw1_76_w
    s_waitcnt vmcnt(0)
L_g_nw1_76_w:
    s_barrier
    ds_read_b128 v[32:35], v4 offset:0
    ds_read_b128 v[36:39], v4 offset:256
    ds_read_b128 v[40:43], v4 offset:2048
    ds_read_b128 v[44:47], v4 offset:2304
    ds_read_b128 v[48:51], v4 offset:4096
    ds_read_b128 v[52:55], v4 offset:4352
    ds_read_b128 v[56:59], v4 offset:6144
    ds_read_b128 v[60:63], v4 offset:6400
    ds_read_b128 v[72:75], v4 offset:8192
    ds_read_b128 v[76:79], v4 offset:8448
    ds_read_b128 v[120:123], v4 offset:10240
    ds_read_b128 v[124:127], v4 offset:10496
    s_branch L_g_jn_78
L_g_nw1_76:
    ds_read_b128 v[32:35], v4 offset:0
    ds_read_b128 v[36:39], v4 offset:256
    ds_read_b128 v[40:43], v4 offset:2048
    ds_read_b128 v[44:47], v4 offset:2304
    ds_read_b128 v[48:51], v4 offset:4096
    ds_read_b128 v[52:55], v4 offset:4352
    ds_read_b128 v[56:59], v4 offset:6144
    ds_read_b128 v[60:63], v4 offset:6400
    ds_read_b128 v[72:75], v4 offset:8192
    ds_read_b128 v[76:79], v4 offset:8448
    ds_read_b128 v[120:123], v4 offset:10240
    ds_read_b128 v[124:127], v4 offset:10496
    s_barrier
L_g_jn_78:
    s_setprio 1
    s_waitcnt lgkmcnt(8)
    v_mfma_f32_16x16x32_bf16 v[16:19], a[0:3], v[32:35], 0
    v_mfma_f32_16x16x32_bf16 v[20:23], a[4:7], v[32:35], 0
    ds_read_b128 v[32:35], v4 offset:12288
    v_mfma_f32_16x16x32_bf16 v[28:31], a[4:7], v[36:39], 0
    v_mfma_f32_16x16x32_bf16 v[24:27], a[0:3], v[36:39], 0
    ds_read_b128 v[36:39], v4 offset:12544
    v_mfma_f32_16x16x32_bf16 v[16:19], a[8:11], v[40:43], v[16:19]
    v_mfma_f32_16x16x32_bf16 v[20:23], a[12:15], v[40:43], v[20:23]
    ds_read_b128 v[40:43], v4 offset:14336
    v_mfma_f32_16x16x32_bf16 v[28:31], a[12:15], v[44:47], v[28:31]
    v_mfma_f32_16x16x32_bf16 v[24:27], a[8:11], v[44:47], v[24:27]
    ds_read_b128 v[44:47], v4 offset:14592
    s_waitcnt lgkmcnt(8)
    v_mfma_f32_16x16x32_bf16 v[16:19], a[16:19], v[48:51], v[16:19]
    v_mfma_f32_16x16x32_bf16 v[20:23], a[20:23], v[48:51], v[20:23]
    ds_read_b128 v[48:51], v4 offset:16384
    v_mfma_f32_16x16x32_bf16 v[28:31], a[20:23], v[52:55], v[28:31]
    v_mfma_f32_16x16x32_bf16 v[24:27], a[16:19], v[52:55], v[24:27]
    ds_read_b128 v[52:55], v4 offset:16640
    v_mfma_f32_16x16x32_bf16 v[16:19], a[24:27], v[56:59], v[16:19]
    v_mfma_f32_16x16x32_bf16 v[20:23], a[28:31], v[56:59], v[20:23]
    ds_read_b128 v[56:59], v4 offset:18432
    v_mfma_f32_16x16x32_bf16 v[28:31], a[28:31], v[60:63], v[28:31]
    v_mfma_f32_16x16x32_bf16 v[24:27], a[24:27], v[60:63], v[24:27]
    ds_read_b128 v[60:63], v4 offset:18688
    s_waitcnt lgkmcnt(8)
    v_mfma_f32_16x16x32_bf16 v[16:19], a[32:35], v[72:75], v[16:19]
    v_mfma_f32_16x16x32_bf16 v[20:23], a[36:39], v[72:75], v[20:23]
    ds_read_b128 v[72:75], v4 offset:20480
    v_mfma_f32_16x16x32_bf16 v[28:31], a[36:39], v[76:79], v[28:31]
    v_mfma_f32_16x16x32_bf16 v[24:27], a[32:35], v[76:79], v[24:27]
    ds_read_b128 v[76:79], v4 offset:20736
    v_mfma_f32_16x16x32_bf16 v[16:19], a[40:43], v[120:123], v[16:19]
    v_mfma_f32_16x16x32_bf16 v[20:23], a[44:47], v[120:123], v[20:23]
    ds_read_b128 v[120:123], v4 offset:22528
    v_mfma_f32_16x16x32_bf16 v[28:31], a[44:47], v[124:127], v[28:31]
    v_mfma_f32_16x16x32_bf16 v[24:27], a[40:43], v[124:127], v[24:27]
    ds_read_b128 v[124:127], v4 offset:22784
    s_waitcnt lgkmcnt(8)
    v_mfma_f32_16x16x32_bf16 v[16:19], a[48:51], v[32:35], v[16:19]
    v_mfma_f32_16x16x32_bf16 v[20:23], a[52:55], v[32:35], v[20:23]
    ds_read_b128 v[32:35], v4 offset:24576
    v_mfma_f32_16x16x32_bf16 v[28:31], a[52:55], v[36:39], v[28:31]
    v_mfma_f32_16x16x32_bf16 v[24:27], a[48:51], v[36:39], v[24:27]
    ds_read_b128 v[36:39], v4 offset:24832
    v_mfma_f32_16x16x32_bf16 v[16:19], a[56:59], v[40:43], v[16:19]
    v_mfma_f32_16x16x32_bf16 v[20:23], a[60:63], v[40:43], v[20:23]
    ds_read_b128 v[40:43], v4 offset:26624
    v_mfma_f32_16x16x32_bf16 v[28:31], a[60:63], v[44:47], v[28:31]
    v_mfma_f32_16x16x32_bf16 v[24:27], a[56:59], v[44:47], v[24:27]
    ds_read_b128 v[44:47], v4 offset:26880
    s_waitcnt lgkmcnt(8)
    v_mfma_f32_16x16x32_bf16 v[16:19], a[64:67], v[48:51], v[16:19]
    v_mfma_f32_16x16x32_bf16 v[20:23], a[68:71], v[48:51], v[20:23]
    ds_read_b128 v[48:51], v4 offset:28672
    v_mfma_f32_16x16x32_bf16 v[28:31], a[68:71], v[52:55], v[28:31]
    v_mfma_f32_16x16x32_bf16 v[24:27], a[64:67], v[52:55], v[24:27]
    ds_read_b128 v[52:55], v4 offset:28928
    v_mfma_f32_16x16x32_bf16 v[16:19], a[72:75], v[56:59], v[16:19]
    v_mfma_f32_16x16x32_bf16 v[20:23], a[76:79], v[56:59], v[20:23]
    ds_read_b128 v[56:59], v4 offset:30720
    v_mfma_f32_16x16x32_bf16 v[28:31], a[76:79], v[60:63], v[28:31]
    v_mfma_f32_16x16x32_bf16 v[24:27], a[72:75], v[60:63], v[24:27]
    ds_read_b128 v[60:63], v4 offset:30976
    s_waitcnt lgkmcnt(8)
    v_mfma_f32_16x16x32_bf16 v[16:19], a[80:83], v[72:75], v[16:19]
    v_mfma_f32_16x16x32_bf16 v[20:23], a[84:87], v[72:75], v[20:23]
    v_mfma_f32_16x16x32_bf16 v[28:31], a[84:87], v[76:79], v[28:31]
    v_mfma_f32_16x16x32_bf16 v[24:27], a[80:83], v[76:79], v[24:27]
    v_mfma_f32_16x16x32_bf16 v[16:19], a[88:91], v[120:123], v[16:19]
    v_mfma_f32_16x16x32_bf16 v[20:23], a[92:95], v[120:123], v[20:23]
    v_mfma_f32_16x16x32_bf16 v[28:31], a[92:95], v[124:127], v[28:31]
    v_mfma_f32_16x16x32_bf16 v[24:27], a[88:91], v[124:127], v[24:27]
    s_waitcnt lgkmcnt(4)
    v_mfma_f32_16x16x32_bf16 v[16:19], a[96:99], v[32:35], v[16:19]
    v_mfma_f32_16x16x32_bf16 v[20:23], a[100:103], v[32:35], v[20:23]
    v_mfma_f32_16x16x32_bf16 v[28:31], a[100:103], v[36:39], v[28:31]
    v_mfma_f32_16x16x32_bf16 v[24:27], a[96:99], v[36:39], v[24:27]
    v_mfma_f32_16x16x32_bf16 v[16:19], a[104:107], v[40:43], v[16:19]
    v_mfma_f32_16x16x32_bf16 v[20:23], a[108:111], v[40:43], v[20:23]
    v_mfma_f32_16x16x32_bf16 v[28:31], a[108:111], v[44:47], v[28:31]
    v_mfma_f32_16x16x32_bf16 v[24:27], a[104:107], v[44:47], v[24:27]
    s_waitcnt lgkmcnt(0)
    v_mfma_f32_16x16x32_bf16 v[16:19], a[112:115], v[48:51], v[16:19]
    v_mfma_f32_16x16x32_bf16 v[20:23], a[116:119], v[48:51], v[20:23]
    v_mfma_f32_16x16x32_bf16 v[28:31], a[116:119], v[52:55], v[28:31]
    v_mfma_f32_16x16x32_bf16 v[24:27], a[112:115], v[52:55], v[24:27]
    v_mfma_f32_16x16x32_bf16 v[16:19], a[120:123], v[56:59], v[16:19]
    v_mfma_f32_16x16x32_bf16 v[20:23], a[124:127], v[56:59], v[20:23]
    v_mfma_f32_16x16x32_bf16 v[28:31], a[124:127], v[60:63], v[28:31]
    v_mfma_f32_16x16x32_bf16 v[24:27], a[120:123], v[60:63], v[24:27]
    v_xor_b32 v4, 0x10000, v4
    s_setprio 0
    s_waitcnt vmcnt(0)
    s_lshl_b32 s67, s67, 1
    s_or_b32 s67, s67, 1
    s_add_u32 s60, s60, 1
    s_cmp_gt_u32 s66, s60
    s_cbranch_scc1 L_g_loop1_52
    s_barrier
    ds_read_b32 v14, v15
    s_waitcnt lgkmcnt(0)
    v_readfirstlane_b32 s66, v14
    s_barrier
    s_mov_b32 s69, 0
    s_cmp_gt_u32 s62, s60
    s_cbranch_scc1 L_g_nd_87
    s_cmp_ge_u32 s62, s66
    s_cbranch_scc1 L_g_nd_87
    s_add_u32 s47, s61, 4096
    s_add_u32 m0, s64, 0
    s_nop 0
    buffer_load_dwordx4 v3, s[12:15], s61 offen offset:0 sc1 lds
    buffer_load_dwordx4 v3, s[12:15], s61 offen offset:1024 sc1 lds
    buffer_load_dwordx4 v3, s[12:15], s61 offen offset:2048 sc1 lds
    buffer_load_dwordx4 v3, s[12:15], s61 offen offset:3072 sc1 lds
    s_add_u32 m0, s64, 4096
    s_nop 0
    buffer_load_dwordx4 v3, s[12:15], s47 offen offset:0 sc1 lds
    buffer_load_dwordx4 v3, s[12:15], s47 offen offset:1024 sc1 lds
    buffer_load_dwordx4 v3, s[12:15], s47 offen offset:2048 sc1 lds
    buffer_load_dwordx4 v3, s[12:15], s47 offen offset:3072 sc1 lds
    s_add_u32 s61, s61, 65536
    s_add_u32 s62, s62, 1
    s_xor_b32 s64, s64, 0x10000
    s_mov_b32 s69, 1
L_g_nd_87:
    s_sub_u32 s59, s60, 1
    ds_read_b128 v[80:83], v5 offset:0
    ds_read_b128 v[84:87], v5 offset:1024
    ds_read_b128 v[88:91], v5 offset:2048
    ds_read_b128 v[92:95], v5 offset:3072
    s_nop 7
    s_waitcnt lgkmcnt(3)
    v_add_f32 v80, v80, v16
    v_add_f32 v81, v81, v17
    v_add_f32 v82, v82, v18
    v_add_f32 v83, v83, v19
    s_waitcnt lgkmcnt(2)
    v_add_f32 v84, v84, v20
    v_add_f32 v85, v85, v21
    v_add_f32 v86, v86, v22
    v_add_f32 v87, v87, v23
    s_waitcnt lgkmcnt(1)
    v_add_f32 v88, v88, v24
    v_add_f32 v89, v89, v25
    v_add_f32 v90, v90, v26
    v_add_f32 v91, v91, v27
    s_waitcnt lgkmcnt(0)
    v_add_f32 v92, v92, v28
    v_add_f32 v93, v93, v29
    v_add_f32 v94, v94, v30
    v_add_f32 v95, v95, v31
    v_cvt_pk_bf16_f32 v104, v80, v81
    v_cvt_pk_bf16_f32 v105, v82, v83
    v_cvt_pk_bf16_f32 v106, v84, v85
    v_cvt_pk_bf16_f32 v107, v86, v87
    buffer_store_dwordx4 v[104:107], v8, s[12:15], s63 offen sc1
    v_cvt_pk_bf16_f32 v108, v88, v89
    v_cvt_pk_bf16_f32 v109, v90, v91
    v_cvt_pk_bf16_f32 v110, v92, v93
    v_cvt_pk_bf16_f32 v111, v94, v95
    buffer_store_dwordx4 v[108:111], v9, s[12:15], s63 offen sc1
    s_add_u32 s63, s63, 786432
    s_cmp_eq_u32 s53, 0
    s_cbranch_scc1 L_g_pf_88
    buffer_store_dwordx4 v[116:119], v64, s[12:15], s58 offen sc1
L_g_pf_88:
    s_add_u32 s58, s58, 131072
    s_mov_b32 s67, 0
    s_mov_b32 s71, 1
    s_cmp_gt_u32 s66, s60
    s_cbranch_scc1 L_g_g1r_50
    v_mov_b32 v10, 1
    s_mov_b64 exec, 1
    s_waitcnt vmcnt(0)
    ds_add_rtn_u32 v10, v15, v10 offset:4
    s_waitcnt lgkmcnt(0)
    v_readfirstlane_b32 s46, v10
    s_mov_b64 exec, -1
    s_mov_b32 s71, 0
    s_sub_u32 s59, s60, 1
    s_cmp_lg_u32 s46, s68
    s_cbranch_scc1 L_g_df_89
    v_mov_b32 v10, s59
    v_add_u32 v10, 1, v10
    v_mov_b32 v11, 0
    s_mov_b64 exec, 1
    buffer_store_dword v10, v11, s[12:15], s52 offen sc1
    s_mov_b64 exec, -1
L_sf_90:
L_g_df_89:
    s_add_u32 s68, s68, 4
    s_cmp_gt_u32 s66, s60
    s_cbranch_scc1 L_g_g1r_50
L_g_tail_53:
    s_cmp_lt_u32 s60, s75
    s_cbranch_scc1 L_g_restart_48
    s_barrier
    s_branch L_w_p2_9
L_w_p2_9:
    s_cmp_lg_u32 s53, 0
    s_cbranch_scc1 L_w_p2_9_n
    s_mov_b32 s53, 1
    s_mov_b32 s74, 58
    s_branch L_w_g_8_e
L_w_p2_9_n:
    s_mov_b32 s74, 0
    s_mov_b32 s76, 0
    s_cmp_lt_u32 s48, 4
    s_cselect_b32 s75, 64, 60
L_w_p2_9_r:
    s_lshr_b32 s42, s40, 1
    s_and_b32 s43, s40, 1
    s_lshl_b32 s43, s43, 2
    s_and_b32 s46, s48, 3
    s_add_u32 s43, s43, s46
    s_cmp_lt_u32 s48, 4
    s_cbranch_scc1 L_w_wo_10
    s_cmp_lt_u32 s48, 8
    s_cbranch_scc1 L_w_f2_11
    s_cmp_lg_u32 s43, 7
    s_cbranch_scc1 L_w_f1_12
    s_cmp_lg_u32 s76, 0
    s_cbranch_scc1 L_c_done_1
    s_mov_b32 s43, 2
    s_branch L_w_c_14
L_replica:
    s_setprio 0
    s_barrier
    s_and_b32 s48, s41, 7
    s_add_u32 s48, s48, 4
    s_cmp_lt_u32 s41, 8
    s_cselect_b32 s74, 60, 62
    s_cselect_b32 s75, 62, 64
    s_cselect_b32 s76, 1, 2
    s_mul_i32 s76, s76, 65536
    s_cmp_lt_u32 s74, s75
    s_cbranch_scc1 L_w_p2_9_r
    s_branch L_c_done_1
L_w_f1_12:
    s_load_dwordx2 s[4:5], s[0:1], 64
    s_load_dwordx2 s[6:7], s[0:1], 72
    s_and_b32 s50, s44, 3
    s_lshr_b32 s51, s44, 2
    s_waitcnt lgkmcnt(0)
    s_mov_b32 s24, s4
    s_and_b32 s25, s5, 0xffff
    s_mov_b32 s26, 0x700000
    s_mov_b32 s27, 0x00020000
    s_mul_i32 s49, s42, 7
    s_add_u32 s49, s49, s43
    v_lshrrev_b32 v3, 4, v1
    v_and_b32 v4, 15, v1
    v_lshlrev_b32 v5, 2, v3
    v_xor_b32 v4, v4, v5
    v_mul_u32_u24 v3, 7168, v3
    v_lshl_add_u32 v3, v4, 4, v3
    s_mul_i32 s46, s51, 512
    s_mul_i32 s47, s50, 64
    s_add_u32 s46, s46, s47
    s_mul_i32 s46, s46, 7168
    s_lshl_b32 s47, s49, 8
    s_add_u32 s46, s46, s47
    s_lshl_b32 s45, s51, 16
    s_mul_i32 s47, s50, 16384
    s_add_u32 s45, s45, s47
    v_bfe_u32 v4, v1, 2, 2
    v_bfe_u32 v5, v1, 4, 1
    v_lshlrev_b32 v5, 1, v5
    v_bfe_u32 v6, v1, 1, 1
    v_add_u32 v5, v5, v6
    s_lshl_b32 s47, s50, 2
    v_add_u32 v5, s47, v5
    v_lshlrev_b32 v6, 2, v4
    v_xor_b32 v5, v5, v6
    v_lshlrev_b32 v5, 4, v5
    v_lshl_add_u32 v5, v4, 8, v5
    v_bfe_u32 v6, v1, 0, 1
    v_lshl_add_u32 v5, v6, 3, v5
    v_lshrrev_b32 v6, 5, v1
    v_mul_u32_u24 v6, 2048, v6
    v_add_u32 v5, v5, v6
    s_lshl_b32 s47, s51, 16
    v_add_u32 v5, s47, v5
    s_add_u32 m0, s45, 0
    s_add_u32 s47, s46, 0x0
    buffer_load_dwordx4 v3, s[24:27], s47 offen lds
    s_add_u32 m0, s45, 1024
    s_add_u32 s47, s46, 0x7000
    buffer_load_dwordx4 v3, s[24:27], s47 offen lds
    s_add_u32 m0, s45, 2048
    s_add_u32 s47, s46, 0xe000
    buffer_load_dwordx4 v3, s[24:27], s47 offen lds
    s_add_u32 m0, s45, 3072
    s_add_u32 s47, s46, 0x15000
    buffer_load_dwordx4 v3, s[24:27], s47 offen lds
    s_add_u32 m0, s45, 4096
    s_add_u32 s47, s46, 0x1c000
    buffer_load_dwordx4 v3, s[24:27], s47 offen lds
    s_add_u32 m0, s45, 5120
    s_add_u32 s47, s46, 0x23000
    buffer_load_dwordx4 v3, s[24:27], s47 offen lds
    s_add_u32 m0, s45, 6144
    s_add_u32 s47, s46, 0x2a000
    buffer_load_dwordx4 v3, s[24:27], s47 offen lds
    s_add_u32 m0, s45, 7168
    s_add_u32 s47, s46, 0x31000
    buffer_load_dwordx4 v3, s[24:27], s47 offen lds
    s_add_u32 m0, s45, 8192
    s_add_u32 s47, s46, 0x38000
    buffer_load_dwordx4 v3, s[24:27], s47 offen lds
    s_add_u32 m0, s45, 9216
    s_add_u32 s47, s46, 0x3f000
    buffer_load_dwordx4 v3, s[24:27], s47 offen lds
    s_add_u32 m0, s45, 10240
    s_add_u32 s47, s46, 0x46000
    buffer_load_dwordx4 v3, s[24:27], s47 offen lds
    s_add_u32 m0, s45, 11264
    s_add_u32 s47, s46, 0x4d000
    buffer_load_dwordx4 v3, s[24:27], s47 offen lds
    s_add_u32 m0, s45, 12288
    s_add_u32 s47, s46, 0x54000
    buffer_load_dwordx4 v3, s[24:27], s47 offen lds
    s_add_u32 m0, s45, 13312
    s_add_u32 s47, s46, 0x5b000
    buffer_load_dwordx4 v3, s[24:27], s47 offen lds
    s_add_u32 m0, s45, 14336
    s_add_u32 s47, s46, 0x62000
    buffer_load_dwordx4 v3, s[24:27], s47 offen lds
    s_add_u32 m0, s45, 15360
    s_add_u32 s47, s46, 0x69000
    buffer_load_dwordx4 v3, s[24:27], s47 offen lds
    s_waitcnt vmcnt(0)
    s_barrier
    ds_read_b64_tr_b16 a[0:1], v5 offset:0
    ds_read_b64_tr_b16 a[2:3], v5 offset:1024
    ds_read_b64_tr_b16 a[4:5], v5 offset:4096
    ds_read_b64_tr_b16 a[6:7], v5 offset:5120
    ds_read_b64_tr_b16 a[8:9], v5 offset:8192
    ds_read_b64_tr_b16 a[10:11], v5 offset:9216
    ds_read_b64_tr_b16 a[12:13], v5 offset:12288
    ds_read_b64_tr_b16 a[14:15], v5 offset:13312
    s_waitcnt lgkmcnt(0)
    ds_read_b64_tr_b16 a[16:17], v5 offset:16384
    ds_read_b64_tr_b16 a[18:19], v5 offset:17408
    ds_read_b64_tr_b16 a[20:21], v5 offset:20480
    ds_read_b64_tr_b16 a[22:23], v5 offset:21504
    ds_read_b64_tr_b16 a[24:25], v5 offset:24576
    ds_read_b64_tr_b16 a[26:27], v5 offset:25600
    ds_read_b64_tr_b16 a[28:29], v5 offset:28672
    ds_read_b64_tr_b16 a[30:31], v5 offset:29696
    s_waitcnt lgkmcnt(0)
    ds_read_b64_tr_b16 a[32:33], v5 offset:32768
    ds_read_b64_tr_b16 a[34:35], v5 offset:33792
    ds_read_b64_tr_b16 a[36:37], v5 offset:36864
    ds_read_b64_tr_b16 a[38:39], v5 offset:37888
    ds_read_b64_tr_b16 a[40:41], v5 offset:40960
    ds_read_b64_tr_b16 a[42:43], v5 offset:41984
    ds_read_b64_tr_b16 a[44:45], v5 offset:45056
    ds_read_b64_tr_b16 a[46:47], v5 offset:46080
    s_waitcnt lgkmcnt(0)
    ds_read_b64_tr_b16 a[48:49], v5 offset:49152
    ds_read_b64_tr_b16 a[50:51], v5 offset:50176
    ds_read_b64_tr_b16 a[52:53], v5 offset:53248
    ds_read_b64_tr_b16 a[54:55], v5 offset:54272
    ds_read_b64_tr_b16 a[56:57], v5 offset:57344
    ds_read_b64_tr_b16 a[58:59], v5 offset:58368
    ds_read_b64_tr_b16 a[60:61], v5 offset:61440
    ds_read_b64_tr_b16 a[62:63], v5 offset:62464
    s_waitcnt lgkmcnt(0)
    s_waitcnt lgkmcnt(0)
    s_barrier
    s_add_u32 m0, s45, 0
    s_add_u32 s47, s46, 0x1c0000
    buffer_load_dwordx4 v3, s[24:27], s47 offen lds
    s_add_u32 m0, s45, 1024
    s_add_u32 s47, s46, 0x1c7000
    buffer_load_dwordx4 v3, s[24:27], s47 offen lds
    s_add_u32 m0, s45, 2048
    s_add_u32 s47, s46, 0x1ce000
    buffer_load_dwordx4 v3, s[24:27], s47 offen lds
    s_add_u32 m0, s45, 3072
    s_add_u32 s47, s46, 0x1d5000
    buffer_load_dwordx4 v3, s[24:27], s47 offen lds
    s_add_u32 m0, s45, 4096
    s_add_u32 s47, s46, 0x1dc000
    buffer_load_dwordx4 v3, s[24:27], s47 offen lds
    s_add_u32 m0, s45, 5120
    s_add_u32 s47, s46, 0x1e3000
    buffer_load_dwordx4 v3, s[24:27], s47 offen lds
    s_add_u32 m0, s45, 6144
    s_add_u32 s47, s46, 0x1ea000
    buffer_load_dwordx4 v3, s[24:27], s47 offen lds
    s_add_u32 m0, s45, 7168
    s_add_u32 s47, s46, 0x1f1000
    buffer_load_dwordx4 v3, s[24:27], s47 offen lds
    s_add_u32 m0, s45, 8192
    s_add_u32 s47, s46, 0x1f8000
    buffer_load_dwordx4 v3, s[24:27], s47 offen lds
    s_add_u32 m0, s45, 9216
    s_add_u32 s47, s46, 0x1ff000
    buffer_load_dwordx4 v3, s[24:27], s47 offen lds
    s_add_u32 m0, s45, 10240
    s_add_u32 s47, s46, 0x206000
    buffer_load_dwordx4 v3, s[24:27], s47 offen lds
    s_add_u32 m0, s45, 11264
    s_add_u32 s47, s46, 0x20d000
    buffer_load_dwordx4 v3, s[24:27], s47 offen lds
    s_add_u32 m0, s45, 12288
    s_add_u32 s47, s46, 0x214000
    buffer_load_dwordx4 v3, s[24:27], s47 offen lds
    s_add_u32 m0, s45, 13312
    s_add_u32 s47, s46, 0x21b000
    buffer_load_dwordx4 v3, s[24:27], s47 offen lds
    s_add_u32 m0, s45, 14336
    s_add_u32 s47, s46, 0x222000
    buffer_load_dwordx4 v3, s[24:27], s47 offen lds
    s_add_u32 m0, s45, 15360
    s_add_u32 s47, s46, 0x229000
    buffer_load_dwordx4 v3, s[24:27], s47 offen lds
    s_waitcnt vmcnt(0)
    s_barrier
    ds_read_b64_tr_b16 a[64:65], v5 offset:0
    ds_read_b64_tr_b16 a[66:67], v5 offset:1024
    ds_read_b64_tr_b16 a[68:69], v5 offset:4096
    ds_read_b64_tr_b16 a[70:71], v5 offset:5120
    ds_read_b64_tr_b16 a[72:73], v5 offset:8192
    ds_read_b64_tr_b16 a[74:75], v5 offset:9216
    ds_read_b64_tr_b16 a[76:77], v5 offset:12288
    ds_read_b64_tr_b16 a[78:79], v5 offset:13312
    s_waitcnt lgkmcnt(0)
    ds_read_b64_tr_b16 a[80:81], v5 offset:16384
    ds_read_b64_tr_b16 a[82:83], v5 offset:17408
    ds_read_b64_tr_b16 a[84:85], v5 offset:20480
    ds_read_b64_tr_b16 a[86:87], v5 offset:21504
    ds_read_b64_tr_b16 a[88:89], v5 offset:24576
    ds_read_b64_tr_b16 a[90:91], v5 offset:25600
    ds_read_b64_tr_b16 a[92:93], v5 offset:28672
    ds_read_b64_tr_b16 a[94:95], v5 offset:29696
    s_waitcnt lgkmcnt(0)
    ds_read_b64_tr_b16 a[96:97], v5 offset:32768
    ds_read_b64_tr_b16 a[98:99], v5 offset:33792
    ds_read_b64_tr_b16 a[100:101], v5 offset:36864
    ds_read_b64_tr_b16 a[102:103], v5 offset:37888
    ds_read_b64_tr_b16 a[104:105], v5 offset:40960
    ds_read_b64_tr_b16 a[106:107], v5 offset:41984
    ds_read_b64_tr_b16 a[108:109], v5 offset:45056
    ds_read_b64_tr_b16 a[110:111], v5 offset:46080
    s_waitcnt lgkmcnt(0)
    ds_read_b64_tr_b16 a[112:113], v5 offset:49152
    ds_read_b64_tr_b16 a[114:115], v5 offset:50176
    ds_read_b64_tr_b16 a[116:117], v5 offset:53248
    ds_read_b64_tr_b16 a[118:119], v5 offset:54272
    ds_read_b64_tr_b16 a[120:121], v5 offset:57344
    ds_read_b64_tr_b16 a[122:123], v5 offset:58368
    ds_read_b64_tr_b16 a[124:125], v5 offset:61440
    ds_read_b64_tr_b16 a[126:127], v5 offset:62464
    s_waitcnt lgkmcnt(0)
    s_waitcnt lgkmcnt(0)
    s_barrier
    v_lshlrev_b32 v2, 4, v1
    s_mul_i32 s64, s44, 8192
    s_add_u32 s46, s64, 0xc00000
    v_add_u32 v3, s46, v2
    s_mul_i32 s46, s51, 32768
    v_add_u32 v4, s46, v2
    v_and_b32 v6, 15, v1
    v_lshlrev_b32 v6, 4, v6
    v_lshrrev_b32 v7, 4, v1
    v_lshl_add_u32 v6, v7, 9, v6
    s_lshl_b32 s46, s50, 12
    s_add_u32 s46, s46, 131072
    v_add_u32 v5, s46, v2
    v_and_b32 v7, 3, v1
    v_lshlrev_b32 v7, 7, v7
    v_add_u32 v7, 0x10ec00, v7
    s_lshl_b32 s46, s49, 13
    s_lshl_b32 s47, s50, 11
    s_add_u32 s46, s46, s47
    s_add_u32 s46, s46, 0x6000000
    v_add_u32 v8, s46, v2
    s_lshl_b32 s52, s49, 7
    s_add_u32 s52, s52, 0x106400
    s_add_u32 s52, s52, s76
    s_mov_b32 s28, s6
    s_and_b32 s29, s7, 0xffff
    s_mov_b32 s30, 0x1c00
    s_mov_b32 s31, 0x00020000
    s_lshl_b32 s46, s49, 8
    s_lshl_b32 s47, s50, 6
    s_add_u32 s46, s46, s47
    v_lshrrev_b32 v9, 5, v1
    v_lshlrev_b32 v9, 3, v9
    buffer_load_dwordx2 v[32:33], v9, s[28:31], s46 offen offset:0
    buffer_load_dwordx2 v[34:35], v9, s[28:31], s46 offen offset:16
    buffer_load_dwordx2 v[36:37], v9, s[28:31], s46 offen offset:32
    buffer_load_dwordx2 v[38:39], v9, s[28:31], s46 offen offset:48
    v_add_u32 v9, 1024, v8
    s_mov_b32 s56, 0xbdd2d3e8
    s_mov_b32 s57, 0xbdd2d3e8
    v_mov_b32 v112, 0xc0135761
    v_mov_b32 v113, 0xc0135761
    s_waitcnt vmcnt(0)
    v_lshlrev_b32 v64, 16, v32
    v_and_b32 v65, 0xffff0000, v32
    v_lshlrev_b32 v66, 16, v33
    v_and_b32 v67, 0xffff0000, v33
    v_lshlrev_b32 v68, 16, v34
    v_and_b32 v69, 0xffff0000, v34
    v_lshlrev_b32 v70, 16, v35
    v_and_b32 v71, 0xffff0000, v35
    v_lshlrev_b32 v72, 16, v36
    v_and_b32 v73, 0xffff0000, v36
    v_lshlrev_b32 v74, 16, v37
    v_and_b32 v75, 0xffff0000, v37
    v_lshlrev_b32 v76, 16, v38
    v_and_b32 v77, 0xffff0000, v38
    v_lshlrev_b32 v78, 16, v39
    v_and_b32 v79, 0xffff0000, v39
    s_mov_b32 s60, s74
    s_mul_i32 s61, s74, 65536
    s_mov_b32 s62, s74
    s_mul_i32 s63, s74, 229376
    s_mov_b32 s67, 0
    s_mov_b32 s68, 3
    s_mov_b32 s71, 0
    v_mov_b32 v15, 147456
    v_mov_b32 v14, 0
    ds_write_b32 v15, v14 offset:4
    ds_write_b32 v15, v14 offset:12
    ds_write_b32 v15, v14 offset:16
    v_mov_b32 v114, 1
    s_mov_b32 s72, 0
L_g_restart_91:
    s_cmp_lg_u32 s44, 0
    s_cbranch_scc1 L_g_nsp_92
    s_mov_b32 s70, 0
L_g_sp_98:
    s_add_u32 s54, s60, 0
    s_add_u32 s55, s54, 0
    s_mul_i32 s46, s55, 171
    s_lshr_b32 s46, s46, 9
    s_mul_i32 s46, s46, 3
    s_sub_u32 s46, s55, s46
    s_lshl_b32 s46, s46, 9
    buffer_load_dword v11, v7, s[12:15], s46 offen sc1
    s_add_u32 s55, s54, 1
    s_mul_i32 s46, s55, 171
    s_lshr_b32 s46, s46, 9
    s_mul_i32 s46, s46, 3
    s_sub_u32 s46, s55, s46
    s_lshl_b32 s46, s46, 9
    buffer_load_dword v12, v7, s[12:15], s46 offen sc1
    s_add_u32 s55, s54, 2
    s_mul_i32 s46, s55, 171
    s_lshr_b32 s46, s46, 9
    s_mul_i32 s46, s46, 3
    s_sub_u32 s46, s55, s46
    s_lshl_b32 s46, s46, 9
    buffer_load_dword v13, v7, s[12:15], s46 offen sc1
    s_waitcnt vmcnt(0)
    v_cmp_ge_u32 vcc, s60, v11
    s_add_u32 s70, s70, 1
    s_cbranch_vccz L_g_sp_98_ok
    s_sleep 3
    s_cmp_lt_u32 s70, 524288
    s_cbranch_scc1 L_g_sp_98
    s_branch L_c_done_1
L_g_sp_98_ok:
    s_mov_b32 s46, s54
    v_cmp_ge_u32 vcc, s46, v11
    s_nop 0
    s_cbranch_vccnz L_g_le_99
    s_add_u32 s46, s46, 1
    v_cmp_ge_u32 vcc, s46, v12
    s_nop 0
    s_cbranch_vccnz L_g_le_99
    s_add_u32 s46, s46, 1
    v_cmp_ge_u32 vcc, s46, v13
    s_nop 0
    s_cbranch_vccnz L_g_le_99
    s_add_u32 s46, s46, 1
L_g_le_99:
    s_min_u32 s46, s46, s75
    v_mov_b32 v11, s46
    ds_write_b32 v15, v11
L_g_nsp_92:
    s_waitcnt lgkmcnt(0)
    s_barrier
    ds_read_b32 v14, v15
    s_waitcnt lgkmcnt(0)
    v_readfirstlane_b32 s66, v14
    s_nop 3
L_g_restart_91_go:
    s_mov_b32 s69, 0
    s_cmp_gt_u32 s62, s60
    s_cbranch_scc1 L_g_nd_100
    s_cmp_ge_u32 s62, s66
    s_cbranch_scc1 L_g_nd_100
    s_add_u32 s47, s61, 4096
    s_add_u32 m0, s64, 0
    s_nop 0
    buffer_load_dwordx4 v3, s[12:15], s61 offen offset:0 sc1 lds
    buffer_load_dwordx4 v3, s[12:15], s61 offen offset:1024 sc1 lds
    buffer_load_dwordx4 v3, s[12:15], s61 offen offset:2048 sc1 lds
    buffer_load_dwordx4 v3, s[12:15], s61 offen offset:3072 sc1 lds
    s_add_u32 m0, s64, 4096
    s_nop 0
    buffer_load_dwordx4 v3, s[12:15], s47 offen offset:0 sc1 lds
    buffer_load_dwordx4 v3, s[12:15], s47 offen offset:1024 sc1 lds
    buffer_load_dwordx4 v3, s[12:15], s47 offen offset:2048 sc1 lds
    buffer_load_dwordx4 v3, s[12:15], s47 offen offset:3072 sc1 lds
    s_add_u32 s61, s61, 65536
    s_add_u32 s62, s62, 1
    s_xor_b32 s64, s64, 0x10000
    s_mov_b32 s69, 1
L_g_nd_100:
    s_cmp_eq_u32 s51, 1
    s_cbranch_scc1 L_g_g1r_93
    s_add_u32 s59, s60, 1
    s_mov_b32 s69, 0
    s_cmp_gt_u32 s62, s59
    s_cbranch_scc1 L_g_nd_101
    s_cmp_ge_u32 s62, s66
    s_cbranch_scc1 L_g_nd_101
    s_add_u32 s47, s61, 4096
    s_add_u32 m0, s64, 0
    s_nop 0
    buffer_load_dwordx4 v3, s[12:15], s61 offen offset:0 sc1 lds
    buffer_load_dwordx4 v3, s[12:15], s61 offen offset:1024 sc1 lds
    buffer_load_dwordx4 v3, s[12:15], s61 offen offset:2048 sc1 lds
    buffer_load_dwordx4 v3, s[12:15], s61 offen offset:3072 sc1 lds
    s_add_u32 m0, s64, 4096
    s_nop 0
    buffer_load_dwordx4 v3, s[12:15], s47 offen offset:0 sc1 lds
    buffer_load_dwordx4 v3, s[12:15], s47 offen offset:1024 sc1 lds
    buffer_load_dwordx4 v3, s[12:15], s47 offen offset:2048 sc1 lds
    buffer_load_dwordx4 v3, s[12:15], s47 offen offset:3072 sc1 lds
    s_add_u32 s61, s61, 65536
    s_add_u32 s62, s62, 1
    s_xor_b32 s64, s64, 0x10000
    s_mov_b32 s69, 1
L_g_nd_101:
    s_cmp_eq_u32 s69, 1
    s_cbranch_scc1 L_g_w0_102
    s_waitcnt vmcnt(0)
L_g_w0_102:
    s_waitcnt vmcnt(8)
    s_mov_b32 s65, 1
.p2align 6
L_g_loop0_94:
    s_barrier
    s_cmp_eq_u32 s65, 0
    s_cbranch_scc1 L_g_pr_103
    ds_read_b128 v[32:35], v4 offset:0
    ds_read_b128 v[36:39], v4 offset:1024
    ds_read_b128 v[40:43], v4 offset:2048
    ds_read_b128 v[44:47], v4 offset:3072
    ds_read_b128 v[48:51], v4 offset:4096
    ds_read_b128 v[52:55], v4 offset:5120
    ds_read_b128 v[56:59], v4 offset:6144
    ds_read_b128 v[60:63], v4 offset:7168
L_g_pr_103:
    ds_read_b32 v14, v15
    s_cmp_lg_u32 s44, 0
    s_cbranch_scc1 L_g_nl_104
    s_add_u32 s54, s60, 1
    s_add_u32 s55, s54, 0
    s_mul_i32 s46, s55, 171
    s_lshr_b32 s46, s46, 9
    s_mul_i32 s46, s46, 3
    s_sub_u32 s46, s55, s46
    s_lshl_b32 s46, s46, 9
    buffer_load_dword v11, v7, s[12:15], s46 offen sc1
    s_add_u32 s55, s54, 1
    s_mul_i32 s46, s55, 171
    s_lshr_b32 s46, s46, 9
    s_mul_i32 s46, s46, 3
    s_sub_u32 s46, s55, s46
    s_lshl_b32 s46, s46, 9
    buffer_load_dword v12, v7, s[12:15], s46 offen sc1
    s_add_u32 s55, s54, 2
    s_mul_i32 s46, s55, 171
    s_lshr_b32 s46, s46, 9
    s_mul_i32 s46, s46, 3
    s_sub_u32 s46, s55, s46
    s_lshl_b32 s46, s46, 9
    buffer_load_dword v13, v7, s[12:15], s46 offen sc1
L_g_nl_104:
    s_setprio 2
    s_waitcnt lgkmcnt(6)
    v_mfma_f32_32x32x16_bf16 v[16:31], a[0:3], v[32:35], v[64:79]
    ds_read_b128 v[32:35], v4 offset:8192
    v_mfma_f32_32x32x16_bf16 v[16:31], a[4:7], v[36:39], v[16:31]
    ds_read_b128 v[36:39], v4 offset:9216
    s_waitcnt lgkmcnt(6)
    v_mfma_f32_32x32x16_bf16 v[16:31], a[8:11], v[40:43], v[16:31]
    ds_read_b128 v[40:43], v4 offset:10240
    v_mfma_f32_32x32x16_bf16 v[16:31], a[12:15], v[44:47], v[16:31]
    ds_read_b128 v[44:47], v4 offset:11264
    s_waitcnt lgkmcnt(6)
    v_mfma_f32_32x32x16_bf16 v[16:31], a[16:19], v[48:51], v[16:31]
    ds_read_b128 v[48:51], v4 offset:12288
    v_mfma_f32_32x32x16_bf16 v[16:31], a[20:23], v[52:55], v[16:31]
    ds_read_b128 v[52:55], v4 offset:13312
    s_waitcnt lgkmcnt(6)
    v_mfma_f32_32x32x16_bf16 v[16:31], a[24:27], v[56:59], v[16:31]
    ds_read_b128 v[56:59], v4 offset:14336
    v_mfma_f32_32x32x16_bf16 v[16:31], a[28:31], v[60:63], v[16:31]
    ds_read_b128 v[60:63], v4 offset:15360
    s_waitcnt lgkmcnt(6)
    v_mfma_f32_32x32x16_bf16 v[16:31], a[32:35], v[32:35], v[16:31]
    ds_read_b128 v[32:35], v4 offset:16384
    v_mfma_f32_32x32x16_bf16 v[16:31], a[36:39], v[36:39], v[16:31]
    ds_read_b128 v[36:39], v4 offset:17408
    s_waitcnt lgkmcnt(6)
    v_mfma_f32_32x32x16_bf16 v[16:31], a[40:43], v[40:43], v[16:31]
    ds_read_b128 v[40:43], v4 offset:18432
    v_mfma_f32_32x32x16_bf16 v[16:31], a[44:47], v[44:47], v[16:31]
    ds_read_b128 v[44:47], v4 offset:19456
    s_waitcnt lgkmcnt(6)
    v_mfma_f32_32x32x16_bf16 v[16:31], a[48:51], v[48:51], v[16:31]
    ds_read_b128 v[48:51], v4 offset:20480
    v_mfma_f32_32x32x16_bf16 v[16:31], a[52:55], v[52:55], v[16:31]
    ds_read_b128 v[52:55], v4 offset:21504
    s_waitcnt lgkmcnt(6)
    v_mfma_f32_32x32x16_bf16 v[16:31], a[56:59], v[56:59], v[16:31]
    ds_read_b128 v[56:59], v4 offset:22528
    v_mfma_f32_32x32x16_bf16 v[16:31], a[60:63], v[60:63], v[16:31]
    ds_read_b128 v[60:63], v4 offset:23552
    s_waitcnt lgkmcnt(6)
    v_mfma_f32_32x32x16_bf16 v[16:31], a[64:67], v[32:35], v[16:31]
    ds_read_b128 v[32:35], v4 offset:24576
    v_mfma_f32_32x32x16_bf16 v[16:31], a[68:71], v[36:39], v[16:31]
    ds_read_b128 v[36:39], v4 offset:25600
    s_waitcnt lgkmcnt(6)
    v_mfma_f32_32x32x16_bf16 v[16:31], a[72:75], v[40:43], v[16:31]
    ds_read_b128 v[40:43], v4 offset:26624
    v_mfma_f32_32x32x16_bf16 v[16:31], a[76:79], v[44:47], v[16:31]
    ds_read_b128 v[44:47], v4 offset:27648
    s_waitcnt lgkmcnt(6)
    v_mfma_f32_32x32x16_bf16 v[16:31], a[80:83], v[48:51], v[16:31]
    ds_read_b128 v[48:51], v4 offset:28672
    v_mfma_f32_32x32x16_bf16 v[16:31], a[84:87], v[52:55], v[16:31]
    ds_read_b128 v[52:55], v4 offset:29696
    s_waitcnt lgkmcnt(6)
    v_mfma_f32_32x32x16_bf16 v[16:31], a[88:91], v[56:59], v[16:31]
    ds_read_b128 v[56:59], v4 offset:30720
    v_mfma_f32_32x32x16_bf16 v[16:31], a[92:95], v[60:63], v[16:31]
    ds_read_b128 v[60:63], v4 offset:31744
    s_waitcnt lgkmcnt(6)
    v_mfma_f32_32x32x16_bf16 v[16:31], a[96:99], v[32:35], v[16:31]
    v_mfma_f32_32x32x16_bf16 v[16:31], a[100:103], v[36:39], v[16:31]
    s_waitcnt lgkmcnt(4)
    v_mfma_f32_32x32x16_bf16 v[16:31], a[104:107], v[40:43], v[16:31]
    v_mfma_f32_32x32x16_bf16 v[16:31], a[108:111], v[44:47], v[16:31]
    s_waitcnt lgkmcnt(2)
    v_mfma_f32_32x32x16_bf16 v[16:31], a[112:115], v[48:51], v[16:31]
    v_mfma_f32_32x32x16_bf16 v[16:31], a[116:119], v[52:55], v[16:31]
    s_waitcnt lgkmcnt(0)
    v_mfma_f32_32x32x16_bf16 v[16:31], a[120:123], v[56:59], v[16:31]
    v_mfma_f32_32x32x16_bf16 v[16:31], a[124:127], v[60:63], v[16:31]
    v_xor_b32 v4, 0x10000, v4
    s_setprio 0
    s_waitcnt vmcnt(0)
    v_readfirstlane_b32 s66, v14
    s_barrier
    s_nop 6
    ds_write_b128 v5, v[16:19] offset:0
    ds_write_b128 v5, v[20:23] offset:1024
    ds_write_b128 v5, v[24:27] offset:2048
    ds_write_b128 v5, v[28:31] offset:3072
    s_cmp_lg_u32 s44, 0
    s_cbranch_scc1 L_g_ne_105
    s_mov_b32 s46, s54
    v_cmp_ge_u32 vcc, s46, v11
    s_nop 0
    s_cbranch_vccnz L_g_le_108
    s_add_u32 s46, s46, 1
    v_cmp_ge_u32 vcc, s46, v12
    s_nop 0
    s_cbranch_vccnz L_g_le_108
    s_add_u32 s46, s46, 1
    v_cmp_ge_u32 vcc, s46, v13
    s_nop 0
    s_cbranch_vccnz L_g_le_108
    s_add_u32 s46, s46, 1
L_g_le_108:
    s_min_u32 s46, s46, s75
    v_mov_b32 v11, s46
    ds_write_b32 v15, v11
L_g_ne_105:
    s_add_u32 s60, s60, 1
    s_mov_b32 s69, 0
    s_cmp_gt_u32 s62, s60
    s_cbranch_scc1 L_g_nd_109
    s_cmp_ge_u32 s62, s66
    s_cbranch_scc1 L_g_nd_109
    s_add_u32 s47, s61, 4096
    s_add_u32 m0, s64, 0
    s_nop 0
    buffer_load_dwordx4 v3, s[12:15], s61 offen offset:0 sc1 lds
    buffer_load_dwordx4 v3, s[12:15], s61 offen offset:1024 sc1 lds
    buffer_load_dwordx4 v3, s[12:15], s61 offen offset:2048 sc1 lds
    buffer_load_dwordx4 v3, s[12:15], s61 offen offset:3072 sc1 lds
    s_add_u32 m0, s64, 4096
    s_nop 0
    buffer_load_dwordx4 v3, s[12:15], s47 offen offset:0 sc1 lds
    buffer_load_dwordx4 v3, s[12:15], s47 offen offset:1024 sc1 lds
    buffer_load_dwordx4 v3, s[12:15], s47 offen offset:2048 sc1 lds
    buffer_load_dwordx4 v3, s[12:15], s47 offen offset:3072 sc1 lds
    s_add_u32 s61, s61, 65536
    s_add_u32 s62, s62, 1
    s_xor_b32 s64, s64, 0x10000
    s_mov_b32 s69, 1
L_g_nd_109:
    s_mov_b32 s65, s69
    s_add_u32 s59, s60, 1
    s_mov_b32 s69, 0
    s_cmp_gt_u32 s62, s59
    s_cbranch_scc1 L_g_nd_110
    s_cmp_ge_u32 s62, s66
    s_cbranch_scc1 L_g_nd_110
    s_add_u32 s47, s61, 4096
    s_add_u32 m0, s64, 0
    s_nop 0
    buffer_load_dwordx4 v3, s[12:15], s61 offen offset:0 sc1 lds
    buffer_load_dwordx4 v3, s[12:15], s61 offen offset:1024 sc1 lds
    buffer_load_dwordx4 v3, s[12:15], s61 offen offset:2048 sc1 lds
    buffer_load_dwordx4 v3, s[12:15], s61 offen offset:3072 sc1 lds
    s_add_u32 m0, s64, 4096
    s_nop 0
    buffer_load_dwordx4 v3, s[12:15], s47 offen offset:0 sc1 lds
    buffer_load_dwordx4 v3, s[12:15], s47 offen offset:1024 sc1 lds
    buffer_load_dwordx4 v3, s[12:15], s47 offen offset:2048 sc1 lds
    buffer_load_dwordx4 v3, s[12:15], s47 offen offset:3072 sc1 lds
    s_add_u32 s61, s61, 65536
    s_add_u32 s62, s62, 1
    s_xor_b32 s64, s64, 0x10000
    s_mov_b32 s69, 1
L_g_nd_110:
    s_cmp_le_u32 s66, s60
    s_cbranch_scc1 L_g_ex0_107
    s_cmp_eq_u32 s65, 0
    s_cbranch_scc1 L_g_nw_106
    s_waitcnt vmcnt(0) lgkmcnt(0)
    s_branch L_g_loop0_94
L_g_nw_106:
    ds_read_b128 v[32:35], v4 offset:0
    ds_read_b128 v[36:39], v4 offset:1024
    ds_read_b128 v[40:43], v4 offset:2048
    ds_read_b128 v[44:47], v4 offset:3072
    ds_read_b128 v[48:51], v4 offset:4096
    ds_read_b128 v[52:55], v4 offset:5120
    ds_read_b128 v[56:59], v4 offset:6144
    ds_read_b128 v[60:63], v4 offset:7168
    s_waitcnt lgkmcnt(8)
    s_branch L_g_loop0_94
L_g_ex0_107:
    s_cmp_lg_u32 s44, 0
    s_cbranch_scc1 L_g_ex0_107_n
    s_sleep 6
    s_add_u32 s54, s60, 0
    s_add_u32 s55, s54, 0
    s_mul_i32 s46, s55, 171
    s_lshr_b32 s46, s46, 9
    s_mul_i32 s46, s46, 3
    s_sub_u32 s46, s55, s46
    s_lshl_b32 s46, s46, 9
    buffer_load_dword v11, v7, s[12:15], s46 offen sc1
    s_add_u32 s55, s54, 1
    s_mul_i32 s46, s55, 171
    s_lshr_b32 s46, s46, 9
    s_mul_i32 s46, s46, 3
    s_sub_u32 s46, s55, s46
    s_lshl_b32 s46, s46, 9
    buffer_load_dword v12, v7, s[12:15], s46 offen sc1
    s_add_u32 s55, s54, 2
    s_mul_i32 s46, s55, 171
    s_lshr_b32 s46, s46, 9
    s_mul_i32 s46, s46, 3
    s_sub_u32 s46, s55, s46
    s_lshl_b32 s46, s46, 9
    buffer_load_dword v13, v7, s[12:15], s46 offen sc1
    s_waitcnt vmcnt(0)
    s_mov_b32 s46, s54
    v_cmp_ge_u32 vcc, s46, v11
    s_nop 0
    s_cbranch_vccnz L_g_le_111
    s_add_u32 s46, s46, 1
    v_cmp_ge_u32 vcc, s46, v12
    s_nop 0
    s_cbranch_vccnz L_g_le_111
    s_add_u32 s46, s46, 1
    v_cmp_ge_u32 vcc, s46, v13
    s_nop 0
    s_cbranch_vccnz L_g_le_111
    s_add_u32 s46, s46, 1
L_g_le_111:
    s_min_u32 s46, s46, s75
    v_mov_b32 v11, s46
    ds_write_b32 v15, v11
L_g_ex0_107_n:
    s_waitcnt lgkmcnt(0)
    s_barrier
    ds_read_b32 v14, v15
    s_waitcnt lgkmcnt(0)
    v_readfirstlane_b32 s66, v14
    s_barrier
    s_cmp_gt_u32 s66, s60
    s_cbranch_scc1 L_g_restart_91_go
    s_branch L_g_tail_96
L_g_g1r_93:
    s_mov_b32 s65, 1
    s_branch L_g_loop1_95_e
.p2align 6
L_g_loop1_95:
    s_mov_b32 s65, 0
L_g_loop1_95_e:
    s_barrier
    ds_read_b32 v14, v15
    s_bitcmp1_b32 s67, 2
    s_cbranch_scc0 L_g_nfl_112
    s_sub_u32 s59, s60, 3
    s_cmp_lg_u32 s44, 4
    s_cbranch_scc1 L_sf_117
    v_mov_b32 v10, s59
    v_add_u32 v10, 1, v10
    v_mov_b32 v11, 0
    s_mov_b64 exec, 1
    buffer_store_dword v10, v11, s[12:15], s52 offen sc1
    s_mov_b64 exec, -1
L_sf_117:
L_g_nfl_112:
    s_cmp_eq_u32 s71, 0
    s_cbranch_scc1 L_g_nfl_112_d
    v_mov_b32 v10, 1
    s_mov_b64 exec, 1
    s_waitcnt vmcnt(0)
    ds_add_rtn_u32 v10, v15, v10 offset:4
    s_waitcnt lgkmcnt(0)
    v_readfirstlane_b32 s46, v10
    s_mov_b64 exec, -1
    s_mov_b32 s71, 0
    s_sub_u32 s59, s60, 1
    s_cmp_lg_u32 s46, s68
    s_cbranch_scc1 L_g_df_118
    v_mov_b32 v10, s59
    v_add_u32 v10, 1, v10
    v_mov_b32 v11, 0
    s_mov_b64 exec, 1
    buffer_store_dword v10, v11, s[12:15], s52 offen sc1
    s_mov_b64 exec, -1
L_sf_119:
L_g_df_118:
    s_add_u32 s68, s68, 4
    s_mov_b32 s65, 2
L_g_nfl_112_d:
    s_waitcnt lgkmcnt(0)
    v_readfirstlane_b32 s66, v14
    s_nop 3
    s_mov_b32 s69, 0
    s_cmp_gt_u32 s62, s60
    s_cbranch_scc1 L_g_nd_120
    s_cmp_ge_u32 s62, s66
    s_cbranch_scc1 L_g_nd_120
    s_add_u32 s47, s61, 4096
    s_add_u32 m0, s64, 0
    s_nop 0
    buffer_load_dwordx4 v3, s[12:15], s61 offen offset:0 sc1 lds
    buffer_load_dwordx4 v3, s[12:15], s61 offen offset:1024 sc1 lds
    buffer_load_dwordx4 v3, s[12:15], s61 offen offset:2048 sc1 lds
    buffer_load_dwordx4 v3, s[12:15], s61 offen offset:3072 sc1 lds
    s_add_u32 m0, s64, 4096
    s_nop 0
    buffer_load_dwordx4 v3, s[12:15], s47 offen offset:0 sc1 lds
    buffer_load_dwordx4 v3, s[12:15], s47 offen offset:1024 sc1 lds
    buffer_load_dwordx4 v3, s[12:15], s47 offen offset:2048 sc1 lds
    buffer_load_dwordx4 v3, s[12:15], s47 offen offset:3072 sc1 lds
    s_add_u32 s61, s61, 65536
    s_add_u32 s62, s62, 1
    s_xor_b32 s64, s64, 0x10000
    s_mov_b32 s69, 1
L_g_nd_120:
    s_or_b32 s65, s65, s69
    s_add_u32 s59, s60, 1
    s_mov_b32 s69, 0
    s_cmp_gt_u32 s62, s59
    s_cbranch_scc1 L_g_nd_121
    s_cmp_ge_u32 s62, s66
    s_cbranch_scc1 L_g_nd_121
    s_add_u32 s47, s61, 4096
    s_add_u32 m0, s64, 0
    s_nop 0
    buffer_load_dwordx4 v3, s[12:15], s61 offen offset:0 sc1 lds
    buffer_load_dwordx4 v3, s[12:15], s61 offen offset:1024 sc1 lds
    buffer_load_dwordx4 v3, s[12:15], s61 offen offset:2048 sc1 lds
    buffer_load_dwordx4 v3, s[12:15], s61 offen offset:3072 sc1 lds
    s_add_u32 m0, s64, 4096
    s_nop 0
    buffer_load_dwordx4 v3, s[12:15], s47 offen offset:0 sc1 lds
    buffer_load_dwordx4 v3, s[12:15], s47 offen offset:1024 sc1 lds
    buffer_load_dwordx4 v3, s[12:15], s47 offen offset:2048 sc1 lds
    buffer_load_dwordx4 v3, s[12:15], s47 offen offset:3072 sc1 lds
    s_add_u32 s61, s61, 65536
    s_add_u32 s62, s62, 1
    s_xor_b32 s64, s64, 0x10000
    s_mov_b32 s69, 1
L_g_nd_121:
    s_bitcmp1_b32 s67, 0
    s_cbranch_scc0 L_g_nep_113
    ds_read_b128 v[80:83], v5 offset:0
    ds_read_b128 v[84:87], v5 offset:1024
    ds_read_b128 v[88:91], v5 offset:2048
    ds_read_b128 v[92:95], v5 offset:3072
    s_nop 7
    s_waitcnt lgkmcnt(3)
    v_add_f32 v80, v80, v16
    v_add_f32 v81, v81, v17
    v_add_f32 v82, v82, v18
    v_add_f32 v83, v83, v19
    s_waitcnt lgkmcnt(2)
    v_add_f32 v84, v84, v20
    v_add_f32 v85, v85, v21
    v_add_f32 v86, v86, v22
    v_add_f32 v87, v87, v23
    s_waitcnt lgkmcnt(1)
    v_add_f32 v88, v88, v24
    v_add_f32 v89, v89, v25
    v_add_f32 v90, v90, v26
    v_add_f32 v91, v91, v27
    s_waitcnt lgkmcnt(0)
    v_add_f32 v92, v92, v28
    v_add_f32 v93, v93, v29
    v_add_f32 v94, v94, v30
    v_add_f32 v95, v95, v31
L_g_nep_113:
    v_mul_f32 v96, v80, v80
    v_mul_f32 v97, v81, v81
    v_mul_f32 v98, v82, v82
    v_mul_f32 v99, v83, v83
    v_mul_f32 v100, v84, v84
    v_mul_f32 v101, v85, v85
    v_mul_f32 v102, v86, v86
    v_mul_f32 v103, v87, v87
    v_fma_f32 v96, v96, s56, v112
    v_fma_f32 v97, v97, s56, v112
    v_fma_f32 v98, v98, s56, v112
    v_fma_f32 v99, v99, s56, v112
    v_fma_f32 v100, v100, s56, v112
    v_fma_f32 v101, v101, s56, v112
    v_fma_f32 v102, v102, s56, v112
    v_fma_f32 v103, v103, s56, v112
    v_mul_f32 v96, v96, v80
    v_mul_f32 v97, v97, v81
    v_mul_f32 v98, v98, v82
    v_mul_f32 v99, v99, v83
    v_mul_f32 v100, v100, v84
    v_mul_f32 v101, v101, v85
    v_mul_f32 v102, v102, v86
    v_mul_f32 v103, v103, v87
    v_exp_f32 v96, v96
    v_exp_f32 v97, v97
    v_exp_f32 v98, v98
    v_exp_f32 v99, v99
    v_exp_f32 v100, v100
    v_exp_f32 v101, v101
    v_exp_f32 v102, v102
    v_exp_f32 v103, v103
    v_add_f32 v96, 1.0, v96
    v_add_f32 v97, 1.0, v97
    v_add_f32 v98, 1.0, v98
    v_add_f32 v99, 1.0, v99
    s_cmp_eq_u32 s65, 0
    s_cbranch_scc1 L_g_nw1_114
    s_cmp_eq_u32 s65, 2
    s_cbranch_scc1 L_g_nw1_114_w
    s_waitcnt vmcnt(0)
L_g_nw1_114_w:
    s_barrier
    ds_read_b128 v[32:35], v4 offset:0
    ds_read_b128 v[36:39], v4 offset:1024
    ds_read_b128 v[40:43], v4 offset:2048
    ds_read_b128 v[44:47], v4 offset:3072
    ds_read_b128 v[48:51], v4 offset:4096
    ds_read_b128 v[52:55], v4 offset:5120
    ds_read_b128 v[56:59], v4 offset:6144
    ds_read_b128 v[60:63], v4 offset:7168
    s_branch L_g_jn_116
L_g_nw1_114:
    ds_read_b128 v[32:35], v4 offset:0
    ds_read_b128 v[36:39], v4 offset:1024
    ds_read_b128 v[40:43], v4 offset:2048
    ds_read_b128 v[44:47], v4 offset:3072
    ds_read_b128 v[48:51], v4 offset:4096
    ds_read_b128 v[52:55], v4 offset:5120
    ds_read_b128 v[56:59], v4 offset:6144
    ds_read_b128 v[60:63], v4 offset:7168
    s_barrier
L_g_jn_116:
    s_bitcmp1_b32 s67, 0
    s_cbranch_scc1 L_g_mm2_115
    s_setprio 1
    s_waitcnt lgkmcnt(6)
    v_mfma_f32_32x32x16_bf16 v[16:31], a[0:3], v[32:35], 0
    ds_read_b128 v[32:35], v4 offset:8192
    v_mfma_f32_32x32x16_bf16 v[16:31], a[4:7], v[36:39], v[16:31]
    ds_read_b128 v[36:39], v4 offset:9216
    s_waitcnt lgkmcnt(6)
    v_mfma_f32_32x32x16_bf16 v[16:31], a[8:11], v[40:43], v[16:31]
    ds_read_b128 v[40:43], v4 offset:10240
    v_mfma_f32_32x32x16_bf16 v[16:31], a[12:15], v[44:47], v[16:31]
    ds_read_b128 v[44:47], v4 offset:11264
    s_waitcnt lgkmcnt(6)
    v_mfma_f32_32x32x16_bf16 v[16:31], a[16:19], v[48:51], v[16:31]
    ds_read_b128 v[48:51], v4 offset:12288
    v_mfma_f32_32x32x16_bf16 v[16:31], a[20:23], v[52:55], v[16:31]
    ds_read_b128 v[52:55], v4 offset:13312
    s_waitcnt lgkmcnt(6)
    v_mfma_f32_32x32x16_bf16 v[16:31], a[24:27], v[56:59], v[16:31]
    ds_read_b128 v[56:59], v4 offset:14336
    v_mfma_f32_32x32x16_bf16 v[16:31], a[28:31], v[60:63], v[16:31]
    ds_read_b128 v[60:63], v4 offset:15360
    s_waitcnt lgkmcnt(6)
    v_mfma_f32_32x32x16_bf16 v[16:31], a[32:35], v[32:35], v[16:31]
    ds_read_b128 v[32:35], v4 offset:16384
    v_mfma_f32_32x32x16_bf16 v[16:31], a[36:39], v[36:39], v[16:31]
    ds_read_b128 v[36:39], v4 offset:17408
    s_waitcnt lgkmcnt(6)
    v_mfma_f32_32x32x16_bf16 v[16:31], a[40:43], v[40:43], v[16:31]
    ds_read_b128 v[40:43], v4 offset:18432
    v_mfma_f32_32x32x16_bf16 v[16:31], a[44:47], v[44:47], v[16:31]
    ds_read_b128 v[44:47], v4 offset:19456
    s_waitcnt lgkmcnt(6)
    v_mfma_f32_32x32x16_bf16 v[16:31], a[48:51], v[48:51], v[16:31]
    ds_read_b128 v[48:51], v4 offset:20480
    v_mfma_f32_32x32x16_bf16 v[16:31], a[52:55], v[52:55], v[16:31]
    ds_read_b128 v[52:55], v4 offset:21504
    s_waitcnt lgkmcnt(6)
    v_mfma_f32_32x32x16_bf16 v[16:31], a[56:59], v[56:59], v[16:31]
    ds_read_b128 v[56:59], v4 offset:22528
    v_mfma_f32_32x32x16_bf16 v[16:31], a[60:63], v[60:63], v[16:31]
    ds_read_b128 v[60:63], v4 offset:23552
    s_waitcnt lgkmcnt(6)
    v_mfma_f32_32x32x16_bf16 v[16:31], a[64:67], v[32:35], v[16:31]
    ds_read_b128 v[32:35], v4 offset:24576
    v_mfma_f32_32x32x16_bf16 v[16:31], a[68:71], v[36:39], v[16:31]
    ds_read_b128 v[36:39], v4 offset:25600
    s_waitcnt lgkmcnt(6)
    v_mfma_f32_32x32x16_bf16 v[16:31], a[72:75], v[40:43], v[16:31]
    ds_read_b128 v[40:43], v4 offset:26624
    v_mfma_f32_32x32x16_bf16 v[16:31], a[76:79], v[44:47], v[16:31]
    ds_read_b128 v[44:47], v4 offset:27648
    s_waitcnt lgkmcnt(6)
    v_mfma_f32_32x32x16_bf16 v[16:31], a[80:83], v[48:51], v[16:31]
    ds_read_b128 v[48:51], v4 offset:28672
    v_mfma_f32_32x32x16_bf16 v[16:31], a[84:87], v[52:55], v[16:31]
    ds_read_b128 v[52:55], v4 offset:29696
    s_waitcnt lgkmcnt(6)
    v_mfma_f32_32x32x16_bf16 v[16:31], a[88:91], v[56:59], v[16:31]
    ds_read_b128 v[56:59], v4 offset:30720
    v_mfma_f32_32x32x16_bf16 v[16:31], a[92:95], v[60:63], v[16:31]
    ds_read_b128 v[60:63], v4 offset:31744
    s_waitcnt lgkmcnt(6)
    v_mfma_f32_32x32x16_bf16 v[16:31], a[96:99], v[32:35], v[16:31]
    v_mfma_f32_32x32x16_bf16 v[16:31], a[100:103], v[36:39], v[16:31]
    s_waitcnt lgkmcnt(4)
    v_mfma_f32_32x32x16_bf16 v[16:31], a[104:107], v[40:43], v[16:31]
    v_mfma_f32_32x32x16_bf16 v[16:31], a[108:111], v[44:47], v[16:31]
    s_waitcnt lgkmcnt(2)
    v_mfma_f32_32x32x16_bf16 v[16:31], a[112:115], v[48:51], v[16:31]
    v_mfma_f32_32x32x16_bf16 v[16:31], a[116:119], v[52:55], v[16:31]
    s_waitcnt lgkmcnt(0)
    v_mfma_f32_32x32x16_bf16 v[16:31], a[120:123], v[56:59], v[16:31]
    v_mfma_f32_32x32x16_bf16 v[16:31], a[124:127], v[60:63], v[16:31]
    v_xor_b32 v4, 0x10000, v4
    s_setprio 0
    s_waitcnt vmcnt(0)
    s_branch L_g_mm2_115_d
L_g_mm2_115:
    s_setprio 1
    s_waitcnt lgkmcnt(6)
    v_mfma_f32_32x32x16_bf16 v[16:31], a[0:3], v[32:35], 0
    ds_read_b128 v[32:35], v4 offset:8192
    v_add_f32 v100, 1.0, v100
    v_add_f32 v101, 1.0, v101
    v_add_f32 v102, 1.0, v102
    v_add_f32 v103, 1.0, v103
    v_mfma_f32_32x32x16_bf16 v[16:31], a[4:7], v[36:39], v[16:31]
    ds_read_b128 v[36:39], v4 offset:9216
    v_rcp_f32 v96, v96
    v_rcp_f32 v97, v97
    s_waitcnt lgkmcnt(6)
    v_mfma_f32_32x32x16_bf16 v[16:31], a[8:11], v[40:43], v[16:31]
    ds_read_b128 v[40:43], v4 offset:10240
    v_rcp_f32 v98, v98
    v_rcp_f32 v99, v99
    v_mfma_f32_32x32x16_bf16 v[16:31], a[12:15], v[44:47], v[16:31]
    ds_read_b128 v[44:47], v4 offset:11264
    v_rcp_f32 v100, v100
    v_rcp_f32 v101, v101
    s_waitcnt lgkmcnt(6)
    v_mfma_f32_32x32x16_bf16 v[16:31], a[16:19], v[48:51], v[16:31]
    ds_read_b128 v[48:51], v4 offset:12288
    v_rcp_f32 v102, v102
    v_rcp_f32 v103, v103
    v_mfma_f32_32x32x16_bf16 v[16:31], a[20:23], v[52:55], v[16:31]
    ds_read_b128 v[52:55], v4 offset:13312
    v_mul_f32 v80, v80, v96
    v_mul_f32 v81, v81, v97
    v_mul_f32 v82, v82, v98
    v_mul_f32 v83, v83, v99
    s_waitcnt lgkmcnt(6)
    v_mfma_f32_32x32x16_bf16 v[16:31], a[24:27], v[56:59], v[16:31]
    ds_read_b128 v[56:59], v4 offset:14336
    v_mul_f32 v84, v84, v100
    v_mul_f32 v85, v85, v101
    v_mul_f32 v86, v86, v102
    v_mul_f32 v87, v87, v103
    v_mfma_f32_32x32x16_bf16 v[16:31], a[28:31], v[60:63], v[16:31]
    ds_read_b128 v[60:63], v4 offset:15360
    v_cvt_pk_bf16_f32 v104, v80, v81
    v_cvt_pk_bf16_f32 v105, v82, v83
    v_cvt_pk_bf16_f32 v106, v84, v85
    v_cvt_pk_bf16_f32 v107, v86, v87
    s_waitcnt lgkmcnt(6)
    v_mfma_f32_32x32x16_bf16 v[16:31], a[32:35], v[32:35], v[16:31]
    ds_read_b128 v[32:35], v4 offset:16384
    buffer_store_dwordx4 v[104:107], v8, s[12:15], s63 offen sc1
    v_mul_f32 v96, v88, v88
    v_mul_f32 v97, v89, v89
    v_mul_f32 v98, v90, v90
    v_mfma_f32_32x32x16_bf16 v[16:31], a[36:39], v[36:39], v[16:31]
    ds_read_b128 v[36:39], v4 offset:17408
    v_mul_f32 v99, v91, v91
    v_mul_f32 v100, v92, v92
    v_mul_f32 v101, v93, v93
    v_mul_f32 v102, v94, v94
    s_waitcnt lgkmcnt(6)
    v_mfma_f32_32x32x16_bf16 v[16:31], a[40:43], v[40:43], v[16:31]
    ds_read_b128 v[40:43], v4 offset:18432
    v_mul_f32 v103, v95, v95
    v_fma_f32 v96, v96, s56, v112
    v_fma_f32 v97, v97, s56, v112
    v_fma_f32 v98, v98, s56, v112
    v_mfma_f32_32x32x16_bf16 v[16:31], a[44:47], v[44:47], v[16:31]
    ds_read_b128 v[44:47], v4 offset:19456
    v_fma_f32 v99, v99, s56, v112
    v_fma_f32 v100, v100, s56, v112
    v_fma_f32 v101, v101, s56, v112
    v_fma_f32 v102, v102, s56, v112
    s_waitcnt lgkmcnt(6)
    v_mfma_f32_32x32x16_bf16 v[16:31], a[48:51], v[48:51], v[16:31]
    ds_read_b128 v[48:51], v4 offset:20480
    v_fma_f32 v103, v103, s56, v112
    v_mul_f32 v96, v96, v88
    v_mul_f32 v97, v97, v89
    v_mul_f32 v98, v98, v90
    v_mfma_f32_32x32x16_bf16 v[16:31], a[52:55], v[52:55], v[16:31]
    ds_read_b128 v[52:55], v4 offset:21504
    v_mul_f32 v99, v99, v91
    v_mul_f32 v100, v100, v92
    v_mul_f32 v101, v101, v93
    v_mul_f32 v102, v102, v94
    s_waitcnt lgkmcnt(6)
    v_mfma_f32_32x32x16_bf16 v[16:31], a[56:59], v[56:59], v[16:31]
    ds_read_b128 v[56:59], v4 offset:22528
    v_mul_f32 v103, v103, v95
    v_exp_f32 v96, v96
    v_exp_f32 v97, v97
    v_mfma_f32_32x32x16_bf16 v[16:31], a[60:63], v[60:63], v[16:31]
    ds_read_b128 v[60:63], v4 offset:23552
    v_exp_f32 v98, v98
    v_exp_f32 v99, v99
    s_waitcnt lgkmcnt(6)
    v_mfma_f32_32x32x16_bf16 v[16:31], a[64:67], v[32:35], v[16:31]
    ds_read_b128 v[32:35], v4 offset:24576
    v_exp_f32 v100, v100
    v_exp_f32 v101, v101
    v_mfma_f32_32x32x16_bf16 v[16:31], a[68:71], v[36:39], v[16:31]
    ds_read_b128 v[36:39], v4 offset:25600
    v_exp_f32 v102, v102
    v_exp_f32 v103, v103
    s_waitcnt lgkmcnt(6)
    v_mfma_f32_32x32x16_bf16 v[16:31], a[72:75], v[40:43], v[16:31]
    ds_read_b128 v[40:43], v4 offset:26624
    v_add_f32 v96, 1.0, v96
    v_add_f32 v97, 1.0, v97
    v_add_f32 v98, 1.0, v98
    v_add_f32 v99, 1.0, v99
    v_mfma_f32_32x32x16_bf16 v[16:31], a[76:79], v[44:47], v[16:31]
    ds_read_b128 v[44:47], v4 offset:27648
    v_add_f32 v100, 1.0, v100
    v_add_f32 v101, 1.0, v101
    v_add_f32 v102, 1.0, v102
    v_add_f32 v103, 1.0, v103
    s_waitcnt lgkmcnt(6)
    v_mfma_f32_32x32x16_bf16 v[16:31], a[80:83], v[48:51], v[16:31]
    ds_read_b128 v[48:51], v4 offset:28672
    v_rcp_f32 v96, v96
    v_rcp_f32 v97, v97
    v_mfma_f32_32x32x16_bf16 v[16:31], a[84:87], v[52:55], v[16:31]
    ds_read_b128 v[52:55], v4 offset:29696
    v_rcp_f32 v98, v98
    v_rcp_f32 v99, v99
    s_waitcnt lgkmcnt(6)
    v_mfma_f32_32x32x16_bf16 v[16:31], a[88:91], v[56:59], v[16:31]
    ds_read_b128 v[56:59], v4 offset:30720
    v_rcp_f32 v100, v100
    v_rcp_f32 v101, v101
    v_mfma_f32_32x32x16_bf16 v[16:31], a[92:95], v[60:63], v[16:31]
    ds_read_b128 v[60:63], v4 offset:31744
    v_rcp_f32 v102, v102
    v_rcp_f32 v103, v103
    s_waitcnt lgkmcnt(6)
    v_mfma_f32_32x32x16_bf16 v[16:31], a[96:99], v[32:35], v[16:31]
    v_mul_f32 v88, v88, v96
    v_mul_f32 v89, v89, v97
    v_mul_f32 v90, v90, v98
    v_mul_f32 v91, v91, v99
    v_mfma_f32_32x32x16_bf16 v[16:31], a[100:103], v[36:39], v[16:31]
    v_mul_f32 v92, v92, v100
    v_mul_f32 v93, v93, v101
    v_mul_f32 v94, v94, v102
    v_mul_f32 v95, v95, v103
    s_waitcnt lgkmcnt(4)
    v_mfma_f32_32x32x16_bf16 v[16:31], a[104:107], v[40:43], v[16:31]
    v_cvt_pk_bf16_f32 v108, v88, v89
    v_cvt_pk_bf16_f32 v109, v90, v91
    v_cvt_pk_bf16_f32 v110, v92, v93
    v_cvt_pk_bf16_f32 v111, v94, v95
    v_mfma_f32_32x32x16_bf16 v[16:31], a[108:111], v[44:47], v[16:31]
    buffer_store_dwordx4 v[108:111], v9, s[12:15], s63 offen sc1
    s_add_u32 s63, s63, 229376
    s_waitcnt lgkmcnt(2)
    v_mfma_f32_32x32x16_bf16 v[16:31], a[112:115], v[48:51], v[16:31]
    v_mfma_f32_32x32x16_bf16 v[16:31], a[116:119], v[52:55], v[16:31]
    s_waitcnt lgkmcnt(0)
    v_mfma_f32_32x32x16_bf16 v[16:31], a[120:123], v[56:59], v[16:31]
    v_mfma_f32_32x32x16_bf16 v[16:31], a[124:127], v[60:63], v[16:31]
    v_xor_b32 v4, 0x10000, v4
    s_setprio 0
    s_waitcnt vmcnt(2)
L_g_mm2_115_d:
    s_lshl_b32 s67, s67, 1
    s_or_b32 s67, s67, 1
    s_add_u32 s60, s60, 1
    s_cmp_gt_u32 s66, s60
    s_cbranch_scc1 L_g_loop1_95
    s_barrier
    ds_read_b32 v14, v15
    s_waitcnt lgkmcnt(0)
    v_readfirstlane_b32 s66, v14
    s_barrier
    s_mov_b32 s69, 0
    s_cmp_gt_u32 s62, s60
    s_cbranch_scc1 L_g_nd_122
    s_cmp_ge_u32 s62, s66
    s_cbranch_scc1 L_g_nd_122
    s_add_u32 s47, s61, 4096
    s_add_u32 m0, s64, 0
    s_nop 0
    buffer_load_dwordx4 v3, s[12:15], s61 offen offset:0 sc1 lds
    buffer_load_dwordx4 v3, s[12:15], s61 offen offset:1024 sc1 lds
    buffer_load_dwordx4 v3, s[12:15], s61 offen offset:2048 sc1 lds
    buffer_load_dwordx4 v3, s[12:15], s61 offen offset:3072 sc1 lds
    s_add_u32 m0, s64, 4096
    s_nop 0
    buffer_load_dwordx4 v3, s[12:15], s47 offen offset:0 sc1 lds
    buffer_load_dwordx4 v3, s[12:15], s47 offen offset:1024 sc1 lds
    buffer_load_dwordx4 v3, s[12:15], s47 offen offset:2048 sc1 lds
    buffer_load_dwordx4 v3, s[12:15], s47 offen offset:3072 sc1 lds
    s_add_u32 s61, s61, 65536
    s_add_u32 s62, s62, 1
    s_xor_b32 s64, s64, 0x10000
    s_mov_b32 s69, 1
L_g_nd_122:
    s_sub_u32 s59, s60, 1
    ds_read_b128 v[80:83], v5 offset:0
    ds_read_b128 v[84:87], v5 offset:1024
    ds_read_b128 v[88:91], v5 offset:2048
    ds_read_b128 v[92:95], v5 offset:3072
    s_nop 7
    s_waitcnt lgkmcnt(3)
    v_add_f32 v80, v80, v16
    v_add_f32 v81, v81, v17
    v_add_f32 v82, v82, v18
    v_add_f32 v83, v83, v19
    s_waitcnt lgkmcnt(2)
    v_add_f32 v84, v84, v20
    v_add_f32 v85, v85, v21
    v_add_f32 v86, v86, v22
    v_add_f32 v87, v87, v23
    s_waitcnt lgkmcnt(1)
    v_add_f32 v88, v88, v24
    v_add_f32 v89, v89, v25
    v_add_f32 v90, v90, v26
    v_add_f32 v91, v91, v27
    s_waitcnt lgkmcnt(0)
    v_add_f32 v92, v92, v28
    v_add_f32 v93, v93, v29
    v_add_f32 v94, v94, v30
    v_add_f32 v95, v95, v31
    v_mul_f32 v96, v80, v80
    v_mul_f32 v97, v81, v81
    v_mul_f32 v98, v82, v82
    v_mul_f32 v99, v83, v83
    v_mul_f32 v100, v84, v84
    v_mul_f32 v101, v85, v85
    v_mul_f32 v102, v86, v86
    v_mul_f32 v103, v87, v87
    v_fma_f32 v96, v96, s56, v112
    v_fma_f32 v97, v97, s56, v112
    v_fma_f32 v98, v98, s56, v112
    v_fma_f32 v99, v99, s56, v112
    v_fma_f32 v100, v100, s56, v112
    v_fma_f32 v101, v101, s56, v112
    v_fma_f32 v102, v102, s56, v112
    v_fma_f32 v103, v103, s56, v112
    v_mul_f32 v96, v96, v80
    v_mul_f32 v97, v97, v81
    v_mul_f32 v98, v98, v82
    v_mul_f32 v99, v99, v83
    v_mul_f32 v100, v100, v84
    v_mul_f32 v101, v101, v85
    v_mul_f32 v102, v102, v86
    v_mul_f32 v103, v103, v87
    v_exp_f32 v96, v96
    v_exp_f32 v97, v97
    v_exp_f32 v98, v98
    v_exp_f32 v99, v99
    v_exp_f32 v100, v100
    v_exp_f32 v101, v101
    v_exp_f32 v102, v102
    v_exp_f32 v103, v103
    v_add_f32 v96, 1.0, v96
    v_add_f32 v97, 1.0, v97
    v_add_f32 v98, 1.0, v98
    v_add_f32 v99, 1.0, v99
    v_add_f32 v100, 1.0, v100
    v_add_f32 v101, 1.0, v101
    v_add_f32 v102, 1.0, v102
    v_add_f32 v103, 1.0, v103
    v_rcp_f32 v96, v96
    v_rcp_f32 v97, v97
    v_rcp_f32 v98, v98
    v_rcp_f32 v99, v99
    v_rcp_f32 v100, v100
    v_rcp_f32 v101, v101
    v_rcp_f32 v102, v102
    v_rcp_f32 v103, v103
    v_mul_f32 v80, v80, v96
    v_mul_f32 v81, v81, v97
    v_mul_f32 v82, v82, v98
    v_mul_f32 v83, v83, v99
    v_mul_f32 v84, v84, v100
    v_mul_f32 v85, v85, v101
    v_mul_f32 v86, v86, v102
    v_mul_f32 v87, v87, v103
    v_cvt_pk_bf16_f32 v104, v80, v81
    v_cvt_pk_bf16_f32 v105, v82, v83
    v_cvt_pk_bf16_f32 v106, v84, v85
    v_cvt_pk_bf16_f32 v107, v86, v87
    buffer_store_dwordx4 v[104:107], v8, s[12:15], s63 offen sc1
    v_mul_f32 v96, v88, v88
    v_mul_f32 v97, v89, v89
    v_mul_f32 v98, v90, v90
    v_mul_f32 v99, v91, v91
    v_mul_f32 v100, v92, v92
    v_mul_f32 v101, v93, v93
    v_mul_f32 v102, v94, v94
    v_mul_f32 v103, v95, v95
    v_fma_f32 v96, v96, s56, v112
    v_fma_f32 v97, v97, s56, v112
    v_fma_f32 v98, v98, s56, v112
    v_fma_f32 v99, v99, s56, v112
    v_fma_f32 v100, v100, s56, v112
    v_fma_f32 v101, v101, s56, v112
    v_fma_f32 v102, v102, s56, v112
    v_fma_f32 v103, v103, s56, v112
    v_mul_f32 v96, v96, v88
    v_mul_f32 v97, v97, v89
    v_mul_f32 v98, v98, v90
    v_mul_f32 v99, v99, v91
    v_mul_f32 v100, v100, v92
    v_mul_f32 v101, v101, v93
    v_mul_f32 v102, v102, v94
    v_mul_f32 v103, v103, v95
    v_exp_f32 v96, v96
    v_exp_f32 v97, v97
    v_exp_f32 v98, v98
    v_exp_f32 v99, v99
    v_exp_f32 v100, v100
    v_exp_f32 v101, v101
    v_exp_f32 v102, v102
    v_exp_f32 v103, v103
    v_add_f32 v96, 1.0, v96
    v_add_f32 v97, 1.0, v97
    v_add_f32 v98, 1.0, v98
    v_add_f32 v99, 1.0, v99
    v_add_f32 v100, 1.0, v100
    v_add_f32 v101, 1.0, v101
    v_add_f32 v102, 1.0, v102
    v_add_f32 v103, 1.0, v103
    v_rcp_f32 v96, v96
    v_rcp_f32 v97, v97
    v_rcp_f32 v98, v98
    v_rcp_f32 v99, v99
    v_rcp_f32 v100, v100
    v_rcp_f32 v101, v101
    v_rcp_f32 v102, v102
    v_rcp_f32 v103, v103
    v_mul_f32 v88, v88, v96
    v_mul_f32 v89, v89, v97
    v_mul_f32 v90, v90, v98
    v_mul_f32 v91, v91, v99
    v_mul_f32 v92, v92, v100
    v_mul_f32 v93, v93, v101
    v_mul_f32 v94, v94, v102
    v_mul_f32 v95, v95, v103
    v_cvt_pk_bf16_f32 v108, v88, v89
    v_cvt_pk_bf16_f32 v109, v90, v91
    v_cvt_pk_bf16_f32 v110, v92, v93
    v_cvt_pk_bf16_f32 v111, v94, v95
    buffer_store_dwordx4 v[108:111], v9, s[12:15], s63 offen sc1
    s_add_u32 s63, s63, 229376
    s_mov_b32 s67, 0
    s_mov_b32 s71, 1
    s_cmp_gt_u32 s66, s60
    s_cbranch_scc1 L_g_g1r_93
    v_mov_b32 v10, 1
    s_mov_b64 exec, 1
    s_waitcnt vmcnt(0)
    ds_add_rtn_u32 v10, v15, v10 offset:4
    s_waitcnt lgkmcnt(0)
    v_readfirstlane_b32 s46, v10
    s_mov_b64 exec, -1
    s_mov_b32 s71, 0
    s_sub_u32 s59, s60, 1
    s_cmp_lg_u32 s46, s68
    s_cbranch_scc1 L_g_df_123
    v_mov_b32 v10, s59
    v_add_u32 v10, 1, v10
    v_mov_b32 v11, 0
    s_mov_b64 exec, 1
    buffer_store_dword v10, v11, s[12:15], s52 offen sc1
    s_mov_b64 exec, -1
L_sf_124:
L_g_df_123:
    s_add_u32 s68, s68, 4
    s_cmp_gt_u32 s66, s60
    s_cbranch_scc1 L_g_g1r_93
L_g_tail_96:
    s_cmp_lt_u32 s60, s75
    s_cbranch_scc1 L_g_restart_91
    s_barrier
    s_branch L_c_done_1
L_w_f2_11:
    s_load_dwordx2 s[4:5], s[0:1], 80
    s_load_dwordx2 s[6:7], s[0:1], 72
    s_and_b32 s50, s44, 3
    s_lshr_b32 s51, s44, 2
    s_waitcnt lgkmcnt(0)
    s_mov_b32 s24, s4
    s_and_b32 s25, s5, 0xffff
    s_mov_b32 s26, 0x700000
    s_mov_b32 s27, 0x00020000
    v_lshrrev_b32 v3, 4, v1
    v_and_b32 v4, 15, v1
    v_lshlrev_b32 v5, 2, v3
    v_xor_b32 v4, v4, v5
    v_mul_u32_u24 v3, 2048, v3
    v_lshl_add_u32 v3, v4, 4, v3
    s_mul_i32 s46, s51, 448
    s_mul_i32 s47, s50, 56
    s_add_u32 s46, s46, s47
    s_mul_i32 s47, s42, 896
    s_add_u32 s46, s46, s47
    s_mul_i32 s46, s46, 2048
    s_lshl_b32 s47, s43, 8
    s_add_u32 s46, s46, s47
    s_lshl_b32 s45, s51, 16
    s_mul_i32 s47, s50, 14336
    s_add_u32 s45, s45, s47
    v_bfe_u32 v4, v1, 2, 2
    v_bfe_u32 v5, v1, 4, 1
    v_lshlrev_b32 v5, 1, v5
    v_bfe_u32 v6, v1, 1, 1
    v_add_u32 v5, v5, v6
    s_lshl_b32 s47, s50, 2
    v_add_u32 v5, s47, v5
    v_lshlrev_b32 v6, 2, v4
    v_xor_b32 v5, v5, v6
    v_lshlrev_b32 v5, 4, v5
    v_lshl_add_u32 v5, v4, 8, v5
    v_bfe_u32 v6, v1, 0, 1
    v_lshl_add_u32 v5, v6, 3, v5
    v_lshrrev_b32 v6, 5, v1
    v_mul_u32_u24 v6, 1024, v6
    v_add_u32 v5, v5, v6
    s_lshl_b32 s47, s51, 16
    v_add_u32 v5, s47, v5
    v_bfe_u32 v4, v1, 2, 2
    v_xor_b32 v5, s50, v4
    v_lshlrev_b32 v5, 6, v5
    v_lshl_add_u32 v5, v4, 8, v5
    v_and_b32 v6, 3, v1
    v_lshl_add_u32 v5, v6, 3, v5
    v_lshrrev_b32 v6, 4, v1
    v_lshl_add_u32 v5, v6, 10, v5
    v_lshrrev_b32 v6, 5, v1
    v_lshl_add_u32 v5, v6, 11, v5
    s_lshl_b32 s47, s51, 16
    v_add_u32 v5, s47, v5
    s_add_u32 m0, s45, 0
    s_add_u32 s47, s46, 0x0
    buffer_load_dwordx4 v3, s[24:27], s47 offen lds
    s_add_u32 m0, s45, 1024
    s_add_u32 s47, s46, 0x2000
    buffer_load_dwordx4 v3, s[24:27], s47 offen lds
    s_add_u32 m0, s45, 2048
    s_add_u32 s47, s46, 0x4000
    buffer_load_dwordx4 v3, s[24:27], s47 offen lds
    s_add_u32 m0, s45, 3072
    s_add_u32 s47, s46, 0x6000
    buffer_load_dwordx4 v3, s[24:27], s47 offen lds
    s_add_u32 m0, s45, 4096
    s_add_u32 s47, s46, 0x8000
    buffer_load_dwordx4 v3, s[24:27], s47 offen lds
    s_add_u32 m0, s45, 5120
    s_add_u32 s47, s46, 0xa000
    buffer_load_dwordx4 v3, s[24:27], s47 offen lds
    s_add_u32 m0, s45, 6144
    s_add_u32 s47, s46, 0xc000
    buffer_load_dwordx4 v3, s[24:27], s47 offen lds
    s_add_u32 m0, s45, 7168
    s_add_u32 s47, s46, 0xe000
    buffer_load_dwordx4 v3, s[24:27], s47 offen lds
    s_add_u32 m0, s45, 8192
    s_add_u32 s47, s46, 0x10000
    buffer_load_dwordx4 v3, s[24:27], s47 offen lds
    s_add_u32 m0, s45, 9216
    s_add_u32 s47, s46, 0x12000
    buffer_load_dwordx4 v3, s[24:27], s47 offen lds
    s_add_u32 m0, s45, 10240
    s_add_u32 s47, s46, 0x14000
    buffer_load_dwordx4 v3, s[24:27], s47 offen lds
    s_add_u32 m0, s45, 11264
    s_add_u32 s47, s46, 0x16000
    buffer_load_dwordx4 v3, s[24:27], s47 offen lds
    s_add_u32 m0, s45, 12288
    s_add_u32 s47, s46, 0x18000
    buffer_load_dwordx4 v3, s[24:27], s47 offen lds
    s_add_u32 m0, s45, 13312
    s_add_u32 s47, s46, 0x1a000
    buffer_load_dwordx4 v3, s[24:27], s47 offen lds
    s_waitcnt vmcnt(0)
    s_barrier
    ds_read_b64_tr_b16 a[0:1], v5 offset:0
    ds_read_b64_tr_b16 a[2:3], v5 offset:2048
    ds_read_b64_tr_b16 a[4:5], v5 offset:32
    ds_read_b64_tr_b16 a[6:7], v5 offset:2080
    ds_read_b64_tr_b16 a[8:9], v5 offset:8192
    ds_read_b64_tr_b16 a[10:11], v5 offset:10240
    ds_read_b64_tr_b16 a[12:13], v5 offset:8224
    ds_read_b64_tr_b16 a[14:15], v5 offset:10272
    s_waitcnt lgkmcnt(0)
    ds_read_b64_tr_b16 a[16:17], v5 offset:16384
    ds_read_b64_tr_b16 a[18:19], v5 offset:18432
    ds_read_b64_tr_b16 a[20:21], v5 offset:16416
    ds_read_b64_tr_b16 a[22:23], v5 offset:18464
    ds_read_b64_tr_b16 a[24:25], v5 offset:24576
    ds_read_b64_tr_b16 a[26:27], v5 offset:26624
    ds_read_b64_tr_b16 a[28:29], v5 offset:24608
    ds_read_b64_tr_b16 a[30:31], v5 offset:26656
    s_waitcnt lgkmcnt(0)
    ds_read_b64_tr_b16 a[32:33], v5 offset:32768
    ds_read_b64_tr_b16 a[34:35], v5 offset:34816
    ds_read_b64_tr_b16 a[36:37], v5 offset:32800
    ds_read_b64_tr_b16 a[38:39], v5 offset:34848
    ds_read_b64_tr_b16 a[40:41], v5 offset:40960
    ds_read_b64_tr_b16 a[42:43], v5 offset:43008
    ds_read_b64_tr_b16 a[44:45], v5 offset:40992
    ds_read_b64_tr_b16 a[46:47], v5 offset:43040
    s_waitcnt lgkmcnt(0)
    ds_read_b64_tr_b16 a[48:49], v5 offset:49152
    ds_read_b64_tr_b16 a[50:51], v5 offset:51200
    ds_read_b64_tr_b16 a[52:53], v5 offset:49184
    ds_read_b64_tr_b16 a[54:55], v5 offset:51232
    s_waitcnt lgkmcnt(0)
    s_barrier
    s_add_u32 m0, s45, 0
    s_add_u32 s47, s46, 0x70000
    buffer_load_dwordx4 v3, s[24:27], s47 offen lds
    s_add_u32 m0, s45, 1024
    s_add_u32 s47, s46, 0x72000
    buffer_load_dwordx4 v3, s[24:27], s47 offen lds
    s_add_u32 m0, s45, 2048
    s_add_u32 s47, s46, 0x74000
    buffer_load_dwordx4 v3, s[24:27], s47 offen lds
    s_add_u32 m0, s45, 3072
    s_add_u32 s47, s46, 0x76000
    buffer_load_dwordx4 v3, s[24:27], s47 offen lds
    s_add_u32 m0, s45, 4096
    s_add_u32 s47, s46, 0x78000
    buffer_load_dwordx4 v3, s[24:27], s47 offen lds
    s_add_u32 m0, s45, 5120
    s_add_u32 s47, s46, 0x7a000
    buffer_load_dwordx4 v3, s[24:27], s47 offen lds
    s_add_u32 m0, s45, 6144
    s_add_u32 s47, s46, 0x7c000
    buffer_load_dwordx4 v3, s[24:27], s47 offen lds
    s_add_u32 m0, s45, 7168
    s_add_u32 s47, s46, 0x7e000
    buffer_load_dwordx4 v3, s[24:27], s47 offen lds
    s_add_u32 m0, s45, 8192
    s_add_u32 s47, s46, 0x80000
    buffer_load_dwordx4 v3, s[24:27], s47 offen lds
    s_add_u32 m0, s45, 9216
    s_add_u32 s47, s46, 0x82000
    buffer_load_dwordx4 v3, s[24:27], s47 offen lds
    s_add_u32 m0, s45, 10240
    s_add_u32 s47, s46, 0x84000
    buffer_load_dwordx4 v3, s[24:27], s47 offen lds
    s_add_u32 m0, s45, 11264
    s_add_u32 s47, s46, 0x86000
    buffer_load_dwordx4 v3, s[24:27], s47 offen lds
    s_add_u32 m0, s45, 12288
    s_add_u32 s47, s46, 0x88000
    buffer_load_dwordx4 v3, s[24:27], s47 offen lds
    s_add_u32 m0, s45, 13312
    s_add_u32 s47, s46, 0x8a000
    buffer_load_dwordx4 v3, s[24:27], s47 offen lds
    s_waitcnt vmcnt(0)
    s_barrier
    ds_read_b64_tr_b16 a[56:57], v5 offset:0
    ds_read_b64_tr_b16 a[58:59], v5 offset:2048
    ds_read_b64_tr_b16 a[60:61], v5 offset:32
    ds_read_b64_tr_b16 a[62:63], v5 offset:2080
    ds_read_b64_tr_b16 a[64:65], v5 offset:8192
    ds_read_b64_tr_b16 a[66:67], v5 offset:10240
    ds_read_b64_tr_b16 a[68:69], v5 offset:8224
    ds_read_b64_tr_b16 a[70:71], v5 offset:10272
    s_waitcnt lgkmcnt(0)
    ds_read_b64_tr_b16 a[72:73], v5 offset:16384
    ds_read_b64_tr_b16 a[74:75], v5 offset:18432
    ds_read_b64_tr_b16 a[76:77], v5 offset:16416
    ds_read_b64_tr_b16 a[78:79], v5 offset:18464
    ds_read_b64_tr_b16 a[80:81], v5 offset:24576
    ds_read_b64_tr_b16 a[82:83], v5 offset:26624
    ds_read_b64_tr_b16 a[84:85], v5 offset:24608
    ds_read_b64_tr_b16 a[86:87], v5 offset:26656
    s_waitcnt lgkmcnt(0)
    ds_read_b64_tr_b16 a[88:89], v5 offset:32768
    ds_read_b64_tr_b16 a[90:91], v5 offset:34816
    ds_read_b64_tr_b16 a[92:93], v5 offset:32800
    ds_read_b64_tr_b16 a[94:95], v5 offset:34848
    ds_read_b64_tr_b16 a[96:97], v5 offset:40960
    ds_read_b64_tr_b16 a[98:99], v5 offset:43008
    ds_read_b64_tr_b16 a[100:101], v5 offset:40992
    ds_read_b64_tr_b16 a[102:103], v5 offset:43040
    s_waitcnt lgkmcnt(0)
    ds_read_b64_tr_b16 a[104:105], v5 offset:49152
    ds_read_b64_tr_b16 a[106:107], v5 offset:51200
    ds_read_b64_tr_b16 a[108:109], v5 offset:49184
    ds_read_b64_tr_b16 a[110:111], v5 offset:51232
    s_waitcnt lgkmcnt(0)
    s_barrier
    v_lshlrev_b32 v2, 4, v1
    s_mul_i32 s64, s44, 7168
    s_add_u32 s46, s64, 0x6000000
    s_mul_i32 s47, s42, 57344
    s_add_u32 s46, s46, s47
    v_add_u32 v3, s46, v2
    s_mul_i32 s46, s51, 28672
    v_add_u32 v4, s46, v2
    v_and_b32 v6, 15, v1
    v_lshlrev_b32 v6, 4, v6
    v_lshrrev_b32 v7, 4, v1
    v_lshl_add_u32 v6, v7, 9, v6
    v_add_u32 v4, s46, v6
    s_lshl_b32 s46, s50, 12
    s_add_u32 s46, s46, 131072
    v_add_u32 v5, s46, v2
    v_min_u32 v7, 6, v1
    v_lshlrev_b32 v7, 7, v7
    s_mul_i32 s46, s42, 896
    s_add_u32 s46, s46, 0x106400
    s_add_u32 s46, s46, s76
    v_add_u32 v7, s46, v7
    s_lshl_b32 s46, s42, 16
    s_lshl_b32 s47, s43, 11
    s_add_u32 s46, s46, s47
    s_lshl_b32 s47, s50, 9
    s_add_u32 s46, s46, s47
    s_add_u32 s46, s46, 0xb000000
    v_and_b32 v8, 31, v1
    v_lshlrev_b32 v8, 4, v8
    v_lshrrev_b32 v9, 5, v1
    v_lshl_add_u32 v8, v9, 14, v8
    v_add_u32 v8, s46, v8
    v_add_u32 v9, 0x8000, v8
    s_lshl_b32 s52, s43, 9
    s_lshl_b32 s47, s42, 7
    s_add_u32 s52, s52, s47
    s_add_u32 s52, s52, 0x108400
    s_add_u32 s52, s52, s76
    s_mov_b32 s60, s74
    s_mul_i32 s61, s74, 229376
    s_mov_b32 s62, s74
    s_mul_i32 s63, s74, 262144
    s_mov_b32 s67, 0
    s_mov_b32 s68, 3
    s_mov_b32 s71, 0
    v_mov_b32 v15, 147456
    v_mov_b32 v14, 0
    ds_write_b32 v15, v14 offset:4
    ds_write_b32 v15, v14 offset:12
    ds_write_b32 v15, v14 offset:16
    v_mov_b32 v114, 1
    s_mov_b32 s72, 0
L_g_restart_125:
    s_cmp_lg_u32 s44, 0
    s_cbranch_scc1 L_g_nsp_126
    s_mov_b32 s70, 0
L_g_sp_132:
    s_add_u32 s54, s60, 0
    s_add_u32 s55, s54, 0
    s_mov_b32 s46, 0
    buffer_load_dword v11, v7, s[12:15], s46 offen sc1
    s_waitcnt vmcnt(0)
    v_cmp_ge_u32 vcc, s60, v11
    s_add_u32 s70, s70, 1
    s_cbranch_vccz L_g_sp_132_ok
    s_sleep 3
    s_cmp_lt_u32 s70, 524288
    s_cbranch_scc1 L_g_sp_132
    s_branch L_c_done_1
L_g_sp_132_ok:
    s_mov_b32 s46, s54
    v_cmp_ge_u32 vcc, s46, v11
    s_nop 0
    s_cbranch_vccnz L_g_le_133
    s_add_u32 s46, s46, 1
    v_cmp_ge_u32 vcc, s46, v11
    s_nop 0
    s_cbranch_vccnz L_g_le_133
    s_add_u32 s46, s46, 1
    v_cmp_ge_u32 vcc, s46, v11
    s_nop 0
    s_cbranch_vccnz L_g_le_133
    s_add_u32 s46, s46, 1
L_g_le_133:
    s_min_u32 s46, s46, s75
    v_mov_b32 v11, s46
    ds_write_b32 v15, v11
L_g_nsp_126:
    s_waitcnt lgkmcnt(0)
    s_barrier
    ds_read_b32 v14, v15
    s_waitcnt lgkmcnt(0)
    v_readfirstlane_b32 s66, v14
    s_nop 3
L_g_restart_125_go:
    s_mov_b32 s69, 0
    s_cmp_gt_u32 s62, s60
    s_cbranch_scc1 L_g_nd_134
    s_cmp_ge_u32 s62, s66
    s_cbranch_scc1 L_g_nd_134
    s_add_u32 s47, s61, 4096
    s_add_u32 m0, s64, 0
    s_nop 0
    buffer_load_dwordx4 v3, s[12:15], s61 offen offset:0 sc1 lds
    buffer_load_dwordx4 v3, s[12:15], s61 offen offset:1024 sc1 lds
    buffer_load_dwordx4 v3, s[12:15], s61 offen offset:2048 sc1 lds
    buffer_load_dwordx4 v3, s[12:15], s61 offen offset:3072 sc1 lds
    s_add_u32 m0, s64, 4096
    s_nop 0
    buffer_load_dwordx4 v3, s[12:15], s47 offen offset:0 sc1 lds
    buffer_load_dwordx4 v3, s[12:15], s47 offen offset:1024 sc1 lds
    buffer_load_dwordx4 v3, s[12:15], s47 offen offset:2048 sc1 lds
    s_add_u32 s61, s61, 229376
    s_add_u32 s62, s62, 1
    s_xor_b32 s64, s64, 0x10000
    s_mov_b32 s69, 1
L_g_nd_134:
    s_cmp_eq_u32 s51, 1
    s_cbranch_scc1 L_g_g1r_127
    s_add_u32 s59, s60, 1
    s_mov_b32 s69, 0
    s_cmp_gt_u32 s62, s59
    s_cbranch_scc1 L_g_nd_135
    s_cmp_ge_u32 s62, s66
    s_cbranch_scc1 L_g_nd_135
    s_add_u32 s47, s61, 4096
    s_add_u32 m0, s64, 0
    s_nop 0
    buffer_load_dwordx4 v3, s[12:15], s61 offen offset:0 sc1 lds
    buffer_load_dwordx4 v3, s[12:15], s61 offen offset:1024 sc1 lds
    buffer_load_dwordx4 v3, s[12:15], s61 offen offset:2048 sc1 lds
    buffer_load_dwordx4 v3, s[12:15], s61 offen offset:3072 sc1 lds
    s_add_u32 m0, s64, 4096
    s_nop 0
    buffer_load_dwordx4 v3, s[12:15], s47 offen offset:0 sc1 lds
    buffer_load_dwordx4 v3, s[12:15], s47 offen offset:1024 sc1 lds
    buffer_load_dwordx4 v3, s[12:15], s47 offen offset:2048 sc1 lds
    s_add_u32 s61, s61, 229376
    s_add_u32 s62, s62, 1
    s_xor_b32 s64, s64, 0x10000
    s_mov_b32 s69, 1
L_g_nd_135:
    s_cmp_eq_u32 s69, 1
    s_cbranch_scc1 L_g_w0_136
    s_waitcnt vmcnt(0)
L_g_w0_136:
    s_waitcnt vmcnt(7)
    s_mov_b32 s65, 1
.p2align 6
L_g_loop0_128:
    s_barrier
    s_cmp_eq_u32 s65, 0
    s_cbranch_scc1 L_g_pr_137
    ds_read_b128 v[32:35], v4 offset:0
    ds_read_b128 v[36:39], v4 offset:256
    ds_read_b128 v[40:43], v4 offset:2048
    ds_read_b128 v[44:47], v4 offset:2304
    ds_read_b128 v[48:51], v4 offset:4096
    ds_read_b128 v[52:55], v4 offset:4352
    ds_read_b128 v[56:59], v4 offset:6144
    ds_read_b128 v[60:63], v4 offset:6400
    ds_read_b128 v[72:75], v4 offset:8192
    ds_read_b128 v[76:79], v4 offset:8448
    ds_read_b128 v[120:123], v4 offset:10240
    ds_read_b128 v[124:127], v4 offset:10496
L_g_pr_137:
    ds_read_b32 v14, v15
    s_cmp_lg_u32 s44, 0
    s_cbranch_scc1 L_g_nl_138
    s_add_u32 s54, s60, 1
    s_add_u32 s55, s54, 0
    s_mov_b32 s46, 0
    buffer_load_dword v11, v7, s[12:15], s46 offen sc1
L_g_nl_138:
    s_setprio 2
    s_waitcnt lgkmcnt(8)
    v_mfma_f32_16x16x32_bf16 v[16:19], v[32:35], a[0:3], 0
    v_mfma_f32_16x16x32_bf16 v[20:23], v[32:35], a[4:7], 0
    ds_read_b128 v[32:35], v4 offset:12288
    v_mfma_f32_16x16x32_bf16 v[28:31], v[36:39], a[4:7], 0
    v_mfma_f32_16x16x32_bf16 v[24:27], v[36:39], a[0:3], 0
    ds_read_b128 v[36:39], v4 offset:12544
    v_mfma_f32_16x16x32_bf16 v[16:19], v[40:43], a[8:11], v[16:19]
    v_mfma_f32_16x16x32_bf16 v[20:23], v[40:43], a[12:15], v[20:23]
    ds_read_b128 v[40:43], v4 offset:14336
    v_mfma_f32_16x16x32_bf16 v[28:31], v[44:47], a[12:15], v[28:31]
    v_mfma_f32_16x16x32_bf16 v[24:27], v[44:47], a[8:11], v[24:27]
    ds_read_b128 v[44:47], v4 offset:14592
    s_waitcnt lgkmcnt(8)
    v_mfma_f32_16x16x32_bf16 v[16:19], v[48:51], a[16:19], v[16:19]
    v_mfma_f32_16x16x32_bf16 v[20:23], v[48:51], a[20:23], v[20:23]
    ds_read_b128 v[48:51], v4 offset:16384
    v_mfma_f32_16x16x32_bf16 v[28:31], v[52:55], a[20:23], v[28:31]
    v_mfma_f32_16x16x32_bf16 v[24:27], v[52:55], a[16:19], v[24:27]
    ds_read_b128 v[52:55], v4 offset:16640
    v_mfma_f32_16x16x32_bf16 v[16:19], v[56:59], a[24:27], v[16:19]
    v_mfma_f32_16x16x32_bf16 v[20:23], v[56:59], a[28:31], v[20:23]
    ds_read_b128 v[56:59], v4 offset:18432
    v_mfma_f32_16x16x32_bf16 v[28:31], v[60:63], a[28:31], v[28:31]
    v_mfma_f32_16x16x32_bf16 v[24:27], v[60:63], a[24:27], v[24:27]
    ds_read_b128 v[60:63], v4 offset:18688
    s_waitcnt lgkmcnt(8)
    v_mfma_f32_16x16x32_bf16 v[16:19], v[72:75], a[32:35], v[16:19]
    v_mfma_f32_16x16x32_bf16 v[20:23], v[72:75], a[36:39], v[20:23]
    ds_read_b128 v[72:75], v4 offset:20480
    v_mfma_f32_16x16x32_bf16 v[28:31], v[76:79], a[36:39], v[28:31]
    v_mfma_f32_16x16x32_bf16 v[24:27], v[76:79], a[32:35], v[24:27]
    ds_read_b128 v[76:79], v4 offset:20736
    v_mfma_f32_16x16x32_bf16 v[16:19], v[120:123], a[40:43], v[16:19]
    v_mfma_f32_16x16x32_bf16 v[20:23], v[120:123], a[44:47], v[20:23]
    ds_read_b128 v[120:123], v4 offset:22528
    v_mfma_f32_16x16x32_bf16 v[28:31], v[124:127], a[44:47], v[28:31]
    v_mfma_f32_16x16x32_bf16 v[24:27], v[124:127], a[40:43], v[24:27]
    ds_read_b128 v[124:127], v4 offset:22784
    s_waitcnt lgkmcnt(8)
    v_mfma_f32_16x16x32_bf16 v[16:19], v[32:35], a[48:51], v[16:19]
    v_mfma_f32_16x16x32_bf16 v[20:23], v[32:35], a[52:55], v[20:23]
    ds_read_b128 v[32:35], v4 offset:24576
    v_mfma_f32_16x16x32_bf16 v[28:31], v[36:39], a[52:55], v[28:31]
    v_mfma_f32_16x16x32_bf16 v[24:27], v[36:39], a[48:51], v[24:27]
    ds_read_b128 v[36:39], v4 offset:24832
    v_mfma_f32_16x16x32_bf16 v[16:19], v[40:43], a[56:59], v[16:19]
    v_mfma_f32_16x16x32_bf16 v[20:23], v[40:43], a[60:63], v[20:23]
    ds_read_b128 v[40:43], v4 offset:26624
    v_mfma_f32_16x16x32_bf16 v[28:31], v[44:47], a[60:63], v[28:31]
    v_mfma_f32_16x16x32_bf16 v[24:27], v[44:47], a[56:59], v[24:27]
    ds_read_b128 v[44:47], v4 offset:26880
    s_waitcnt lgkmcnt(8)
    v_mfma_f32_16x16x32_bf16 v[16:19], v[48:51], a[64:67], v[16:19]
    v_mfma_f32_16x16x32_bf16 v[20:23], v[48:51], a[68:71], v[20:23]
    v_mfma_f32_16x16x32_bf16 v[28:31], v[52:55], a[68:71], v[28:31]
    v_mfma_f32_16x16x32_bf16 v[24:27], v[52:55], a[64:67], v[24:27]
    v_mfma_f32_16x16x32_bf16 v[16:19], v[56:59], a[72:75], v[16:19]
    v_mfma_f32_16x16x32_bf16 v[20:23], v[56:59], a[76:79], v[20:23]
    v_mfma_f32_16x16x32_bf16 v[28:31], v[60:63], a[76:79], v[28:31]
    v_mfma_f32_16x16x32_bf16 v[24:27], v[60:63], a[72:75], v[24:27]
    s_waitcnt lgkmcnt(4)
    v_mfma_f32_16x16x32_bf16 v[16:19], v[72:75], a[80:83], v[16:19]
    v_mfma_f32_16x16x32_bf16 v[20:23], v[72:75], a[84:87], v[20:23]
    v_mfma_f32_16x16x32_bf16 v[28:31], v[76:79], a[84:87], v[28:31]
    v_mfma_f32_16x16x32_bf16 v[24:27], v[76:79], a[80:83], v[24:27]
    v_mfma_f32_16x16x32_bf16 v[16:19], v[120:123], a[88:91], v[16:19]
    v_mfma_f32_16x16x32_bf16 v[20:23], v[120:123], a[92:95], v[20:23]
    v_mfma_f32_16x16x32_bf16 v[28:31], v[124:127], a[92:95], v[28:31]
    v_mfma_f32_16x16x32_bf16 v[24:27], v[124:127], a[88:91], v[24:27]
    s_waitcnt lgkmcnt(0)
    v_mfma_f32_16x16x32_bf16 v[16:19], v[32:35], a[96:99], v[16:19]
    v_mfma_f32_16x16x32_bf16 v[20:23], v[32:35], a[100:103], v[20:23]
    v_mfma_f32_16x16x32_bf16 v[28:31], v[36:39], a[100:103], v[28:31]
    v_mfma_f32_16x16x32_bf16 v[24:27], v[36:39], a[96:99], v[24:27]
    v_mfma_f32_16x16x32_bf16 v[16:19], v[40:43], a[104:107], v[16:19]
    v_mfma_f32_16x16x32_bf16 v[20:23], v[40:43], a[108:111], v[20:23]
    v_mfma_f32_16x16x32_bf16 v[28:31], v[44:47], a[108:111], v[28:31]
    v_mfma_f32_16x16x32_bf16 v[24:27], v[44:47], a[104:107], v[24:27]
    v_xor_b32 v4, 0x10000, v4
    s_setprio 0
    s_waitcnt vmcnt(0)
    v_readfirstlane_b32 s66, v14
    s_barrier
    s_nop 6
    ds_write_b128 v5, v[16:19] offset:0
    ds_write_b128 v5, v[20:23] offset:1024
    ds_write_b128 v5, v[24:27] offset:2048
    ds_write_b128 v5, v[28:31] offset:3072
    s_cmp_lg_u32 s44, 0
    s_cbranch_scc1 L_g_ne_139
    s_mov_b32 s46, s54
    v_cmp_ge_u32 vcc, s46, v11
    s_nop 0
    s_cbranch_vccnz L_g_le_142
    s_add_u32 s46, s46, 1
    v_cmp_ge_u32 vcc, s46, v11
    s_nop 0
    s_cbranch_vccnz L_g_le_142
    s_add_u32 s46, s46, 1
    v_cmp_ge_u32 vcc, s46, v11
    s_nop 0
    s_cbranch_vccnz L_g_le_142
    s_add_u32 s46, s46, 1
L_g_le_142:
    s_min_u32 s46, s46, s75
    v_mov_b32 v11, s46
    ds_write_b32 v15, v11
L_g_ne_139:
    s_add_u32 s60, s60, 1
    s_mov_b32 s69, 0
    s_cmp_gt_u32 s62, s60
    s_cbranch_scc1 L_g_nd_143
    s_cmp_ge_u32 s62, s66
    s_cbranch_scc1 L_g_nd_143
    s_add_u32 s47, s61, 4096
    s_add_u32 m0, s64, 0
    s_nop 0
    buffer_load_dwordx4 v3, s[12:15], s61 offen offset:0 sc1 lds
    buffer_load_dwordx4 v3, s[12:15], s61 offen offset:1024 sc1 lds
    buffer_load_dwordx4 v3, s[12:15], s61 offen offset:2048 sc1 lds
    buffer_load_dwordx4 v3, s[12:15], s61 offen offset:3072 sc1 lds
    s_add_u32 m0, s64, 4096
    s_nop 0
    buffer_load_dwordx4 v3, s[12:15], s47 offen offset:0 sc1 lds
    buffer_load_dwordx4 v3, s[12:15], s47 offen offset:1024 sc1 lds
    buffer_load_dwordx4 v3, s[12:15], s47 offen offset:2048 sc1 lds
    s_add_u32 s61, s61, 229376
    s_add_u32 s62, s62, 1
    s_xor_b32 s64, s64, 0x10000
    s_mov_b32 s69, 1
L_g_nd_143:
    s_mov_b32 s65, s69
    s_add_u32 s59, s60, 1
    s_mov_b32 s69, 0
    s_cmp_gt_u32 s62, s59
    s_cbranch_scc1 L_g_nd_144
    s_cmp_ge_u32 s62, s66
    s_cbranch_scc1 L_g_nd_144
    s_add_u32 s47, s61, 4096
    s_add_u32 m0, s64, 0
    s_nop 0
    buffer_load_dwordx4 v3, s[12:15], s61 offen offset:0 sc1 lds
    buffer_load_dwordx4 v3, s[12:15], s61 offen offset:1024 sc1 lds
    buffer_load_dwordx4 v3, s[12:15], s61 offen offset:2048 sc1 lds
    buffer_load_dwordx4 v3, s[12:15], s61 offen offset:3072 sc1 lds
    s_add_u32 m0, s64, 4096
    s_nop 0
    buffer_load_dwordx4 v3, s[12:15], s47 offen offset:0 sc1 lds
    buffer_load_dwordx4 v3, s[12:15], s47 offen offset:1024 sc1 lds
    buffer_load_dwordx4 v3, s[12:15], s47 offen offset:2048 sc1 lds
    s_add_u32 s61, s61, 229376
    s_add_u32 s62, s62, 1
    s_xor_b32 s64, s64, 0x10000
    s_mov_b32 s69, 1
L_g_nd_144:
    s_cmp_le_u32 s66, s60
    s_cbranch_scc1 L_g_ex0_141
    s_cmp_eq_u32 s65, 0
    s_cbranch_scc1 L_g_nw_140
    s_waitcnt vmcnt(0) lgkmcnt(0)
    s_branch L_g_loop0_128
L_g_nw_140:
    ds_read_b128 v[32:35], v4 offset:0
    ds_read_b128 v[36:39], v4 offset:256
    ds_read_b128 v[40:43], v4 offset:2048
    ds_read_b128 v[44:47], v4 offset:2304
    ds_read_b128 v[48:51], v4 offset:4096
    ds_read_b128 v[52:55], v4 offset:4352
    ds_read_b128 v[56:59], v4 offset:6144
    ds_read_b128 v[60:63], v4 offset:6400
    ds_read_b128 v[72:75], v4 offset:8192
    ds_read_b128 v[76:79], v4 offset:8448
    ds_read_b128 v[120:123], v4 offset:10240
    ds_read_b128 v[124:127], v4 offset:10496
    s_waitcnt lgkmcnt(12)
    s_branch L_g_loop0_128
L_g_ex0_141:
    s_cmp_lg_u32 s44, 0
    s_cbranch_scc1 L_g_ex0_141_n
    s_sleep 6
    s_add_u32 s54, s60, 0
    s_add_u32 s55, s54, 0
    s_mov_b32 s46, 0
    buffer_load_dword v11, v7, s[12:15], s46 offen sc1
    s_waitcnt vmcnt(0)
    s_mov_b32 s46, s54
    v_cmp_ge_u32 vcc, s46, v11
    s_nop 0
    s_cbranch_vccnz L_g_le_145
    s_add_u32 s46, s46, 1
    v_cmp_ge_u32 vcc, s46, v11
    s_nop 0
    s_cbranch_vccnz L_g_le_145
    s_add_u32 s46, s46, 1
    v_cmp_ge_u32 vcc, s46, v11
    s_nop 0
    s_cbranch_vccnz L_g_le_145
    s_add_u32 s46, s46, 1
L_g_le_145:
    s_min_u32 s46, s46, s75
    v_mov_b32 v11, s46
    ds_write_b32 v15, v11
L_g_ex0_141_n:
    s_waitcnt lgkmcnt(0)
    s_barrier
    ds_read_b32 v14, v15
    s_waitcnt lgkmcnt(0)
    v_readfirstlane_b32 s66, v14
    s_barrier
    s_cmp_gt_u32 s66, s60
    s_cbranch_scc1 L_g_restart_125_go
    s_branch L_g_tail_130
L_g_g1r_127:
    s_mov_b32 s65, 1
    s_branch L_g_loop1_129_e
.p2align 6
L_g_loop1_129:
    s_mov_b32 s65, 0
L_g_loop1_129_e:
    s_barrier
    ds_read_b32 v14, v15
    s_bitcmp1_b32 s67, 1
    s_cbranch_scc0 L_g_nfl_146
    s_sub_u32 s59, s60, 2
    s_cmp_lg_u32 s44, 4
    s_cbranch_scc1 L_sf_151
    v_mov_b32 v10, s59
    v_add_u32 v10, 1, v10
    v_mov_b32 v11, 0
    s_mov_b64 exec, 1
    buffer_store_dword v10, v11, s[12:15], s52 offen sc1
    s_mov_b64 exec, -1
L_sf_151:
L_g_nfl_146:
    s_cmp_eq_u32 s71, 0
    s_cbranch_scc1 L_g_nfl_146_d
    v_mov_b32 v10, 1
    s_mov_b64 exec, 1
    s_waitcnt vmcnt(0)
    ds_add_rtn_u32 v10, v15, v10 offset:4
    s_waitcnt lgkmcnt(0)
    v_readfirstlane_b32 s46, v10
    s_mov_b64 exec, -1
    s_mov_b32 s71, 0
    s_sub_u32 s59, s60, 1
    s_cmp_lg_u32 s46, s68
    s_cbranch_scc1 L_g_df_152
    v_mov_b32 v10, s59
    v_add_u32 v10, 1, v10
    v_mov_b32 v11, 0
    s_mov_b64 exec, 1
    buffer_store_dword v10, v11, s[12:15], s52 offen sc1
    s_mov_b64 exec, -1
L_sf_153:
L_g_df_152:
    s_add_u32 s68, s68, 4
    s_mov_b32 s65, 2
L_g_nfl_146_d:
    s_waitcnt lgkmcnt(0)
    v_readfirstlane_b32 s66, v14
    s_nop 3
    s_mov_b32 s69, 0
    s_cmp_gt_u32 s62, s60
    s_cbranch_scc1 L_g_nd_154
    s_cmp_ge_u32 s62, s66
    s_cbranch_scc1 L_g_nd_154
    s_add_u32 s47, s61, 4096
    s_add_u32 m0, s64, 0
    s_nop 0
    buffer_load_dwordx4 v3, s[12:15], s61 offen offset:0 sc1 lds
    buffer_load_dwordx4 v3, s[12:15], s61 offen offset:1024 sc1 lds
    buffer_load_dwordx4 v3, s[12:15], s61 offen offset:2048 sc1 lds
    buffer_load_dwordx4 v3, s[12:15], s61 offen offset:3072 sc1 lds
    s_add_u32 m0, s64, 4096
    s_nop 0
    buffer_load_dwordx4 v3, s[12:15], s47 offen offset:0 sc1 lds
    buffer_load_dwordx4 v3, s[12:15], s47 offen offset:1024 sc1 lds
    buffer_load_dwordx4 v3, s[12:15], s47 offen offset:2048 sc1 lds
    s_add_u32 s61, s61, 229376
    s_add_u32 s62, s62, 1
    s_xor_b32 s64, s64, 0x10000
    s_mov_b32 s69, 1
L_g_nd_154:
    s_or_b32 s65, s65, s69
    s_add_u32 s59, s60, 1
    s_mov_b32 s69, 0
    s_cmp_gt_u32 s62, s59
    s_cbranch_scc1 L_g_nd_155
    s_cmp_ge_u32 s62, s66
    s_cbranch_scc1 L_g_nd_155
    s_add_u32 s47, s61, 4096
    s_add_u32 m0, s64, 0
    s_nop 0
    buffer_load_dwordx4 v3, s[12:15], s61 offen offset:0 sc1 lds
    buffer_load_dwordx4 v3, s[12:15], s61 offen offset:1024 sc1 lds
    buffer_load_dwordx4 v3, s[12:15], s61 offen offset:2048 sc1 lds
    buffer_load_dwordx4 v3, s[12:15], s61 offen offset:3072 sc1 lds
    s_add_u32 m0, s64, 4096
    s_nop 0
    buffer_load_dwordx4 v3, s[12:15], s47 offen offset:0 sc1 lds
    buffer_load_dwordx4 v3, s[12:15], s47 offen offset:1024 sc1 lds
    buffer_load_dwordx4 v3, s[12:15], s47 offen offset:2048 sc1 lds
    s_add_u32 s61, s61, 229376
    s_add_u32 s62, s62, 1
    s_xor_b32 s64, s64, 0x10000
    s_mov_b32 s69, 1
L_g_nd_155:
    s_bitcmp1_b32 s67, 0
    s_cbranch_scc0 L_g_nep_147
    ds_read_b128 v[80:83], v5 offset:0
    ds_read_b128 v[84:87], v5 offset:1024
    ds_read_b128 v[88:91], v5 offset:2048
    ds_read_b128 v[92:95], v5 offset:3072
    s_nop 7
    s_waitcnt lgkmcnt(3)
    v_add_f32 v80, v80, v16
    v_add_f32 v81, v81, v17
    v_add_f32 v82, v82, v18
    v_add_f32 v83, v83, v19
    s_waitcnt lgkmcnt(2)
    v_add_f32 v84, v84, v20
    v_add_f32 v85, v85, v21
    v_add_f32 v86, v86, v22
    v_add_f32 v87, v87, v23
    s_waitcnt lgkmcnt(1)
    v_add_f32 v88, v88, v24
    v_add_f32 v89, v89, v25
    v_add_f32 v90, v90, v26
    v_add_f32 v91, v91, v27
    s_waitcnt lgkmcnt(0)
    v_add_f32 v92, v92, v28
    v_add_f32 v93, v93, v29
    v_add_f32 v94, v94, v30
    v_add_f32 v95, v95, v31
    v_cvt_pk_bf16_f32 v104, v80, v81
    v_cvt_pk_bf16_f32 v105, v82, v83
    v_cvt_pk_bf16_f32 v106, v84, v85
    v_cvt_pk_bf16_f32 v107, v86, v87
    s_nop 1
    v_permlane16_swap_b32 v104, v106
    v_permlane16_swap_b32 v105, v107
    buffer_store_dwordx4 v[104:107], v8, s[12:15], s63 offen sc1
    v_cvt_pk_bf16_f32 v108, v88, v89
    v_cvt_pk_bf16_f32 v109, v90, v91
    v_cvt_pk_bf16_f32 v110, v92, v93
    v_cvt_pk_bf16_f32 v111, v94, v95
    s_nop 1
    v_permlane16_swap_b32 v108, v110
    v_permlane16_swap_b32 v109, v111
    buffer_store_dwordx4 v[108:111], v9, s[12:15], s63 offen sc1
    s_add_u32 s63, s63, 262144
L_g_nep_147:
    s_cmp_eq_u32 s65, 0
    s_cbranch_scc1 L_g_nw1_148
    s_cmp_eq_u32 s65, 2
    s_cbranch_scc1 L_g_nw1_148_w
    s_waitcnt vmcnt(0)
L_g_nw1_148_w:
    s_barrier
    ds_read_b128 v[32:35], v4 offset:0
    ds_read_b128 v[36:39], v4 offset:256
    ds_read_b128 v[40:43], v4 offset:2048
    ds_read_b128 v[44:47], v4 offset:2304
    ds_read_b128 v[48:51], v4 offset:4096
    ds_read_b128 v[52:55], v4 offset:4352
    ds_read_b128 v[56:59], v4 offset:6144
    ds_read_b128 v[60:63], v4 offset:6400
    ds_read_b128 v[72:75], v4 offset:8192
    ds_read_b128 v[76:79], v4 offset:8448
    ds_read_b128 v[120:123], v4 offset:10240
    ds_read_b128 v[124:127], v4 offset:10496
    s_branch L_g_jn_150
L_g_nw1_148:
    ds_read_b128 v[32:35], v4 offset:0
    ds_read_b128 v[36:39], v4 offset:256
    ds_read_b128 v[40:43], v4 offset:2048
    ds_read_b128 v[44:47], v4 offset:2304
    ds_read_b128 v[48:51], v4 offset:4096
    ds_read_b128 v[52:55], v4 offset:4352
    ds_read_b128 v[56:59], v4 offset:6144
    ds_read_b128 v[60:63], v4 offset:6400
    ds_read_b128 v[72:75], v4 offset:8192
    ds_read_b128 v[76:79], v4 offset:8448
    ds_read_b128 v[120:123], v4 offset:10240
    ds_read_b128 v[124:127], v4 offset:10496
    s_barrier
L_g_jn_150:
    s_setprio 1
    s_waitcnt lgkmcnt(8)
    v_mfma_f32_16x16x32_bf16 v[16:19], v[32:35], a[0:3], 0
    v_mfma_f32_16x16x32_bf16 v[20:23], v[32:35], a[4:7], 0
    ds_read_b128 v[32:35], v4 offset:12288
    v_mfma_f32_16x16x32_bf16 v[28:31], v[36:39], a[4:7], 0
    v_mfma_f32_16x16x32_bf16 v[24:27], v[36:39], a[0:3], 0
    ds_read_b128 v[36:39], v4 offset:12544
    v_mfma_f32_16x16x32_bf16 v[16:19], v[40:43], a[8:11], v[16:19]
    v_mfma_f32_16x16x32_bf16 v[20:23], v[40:43], a[12:15], v[20:23]
    ds_read_b128 v[40:43], v4 offset:14336
    v_mfma_f32_16x16x32_bf16 v[28:31], v[44:47], a[12:15], v[28:31]
    v_mfma_f32_16x16x32_bf16 v[24:27], v[44:47], a[8:11], v[24:27]
    ds_read_b128 v[44:47], v4 offset:14592
    s_waitcnt lgkmcnt(8)
    v_mfma_f32_16x16x32_bf16 v[16:19], v[48:51], a[16:19], v[16:19]
    v_mfma_f32_16x16x32_bf16 v[20:23], v[48:51], a[20:23], v[20:23]
    ds_read_b128 v[48:51], v4 offset:16384
    v_mfma_f32_16x16x32_bf16 v[28:31], v[52:55], a[20:23], v[28:31]
    v_mfma_f32_16x16x32_bf16 v[24:27], v[52:55], a[16:19], v[24:27]
    ds_read_b128 v[52:55], v4 offset:16640
    v_mfma_f32_16x16x32_bf16 v[16:19], v[56:59], a[24:27], v[16:19]
    v_mfma_f32_16x16x32_bf16 v[20:23], v[56:59], a[28:31], v[20:23]
    ds_read_b128 v[56:59], v4 offset:18432
    v_mfma_f32_16x16x32_bf16 v[28:31], v[60:63], a[28:31], v[28:31]
    v_mfma_f32_16x16x32_bf16 v[24:27], v[60:63], a[24:27], v[24:27]
    ds_read_b128 v[60:63], v4 offset:18688
    s_waitcnt lgkmcnt(8)
    v_mfma_f32_16x16x32_bf16 v[16:19], v[72:75], a[32:35], v[16:19]
    v_mfma_f32_16x16x32_bf16 v[20:23], v[72:75], a[36:39], v[20:23]
    ds_read_b128 v[72:75], v4 offset:20480
    v_mfma_f32_16x16x32_bf16 v[28:31], v[76:79], a[36:39], v[28:31]
    v_mfma_f32_16x16x32_bf16 v[24:27], v[76:79], a[32:35], v[24:27]
    ds_read_b128 v[76:79], v4 offset:20736
    v_mfma_f32_16x16x32_bf16 v[16:19], v[120:123], a[40:43], v[16:19]
    v_mfma_f32_16x16x32_bf16 v[20:23], v[120:123], a[44:47], v[20:23]
    ds_read_b128 v[120:123], v4 offset:22528
    v_mfma_f32_16x16x32_bf16 v[28:31], v[124:127], a[44:47], v[28:31]
    v_mfma_f32_16x16x32_bf16 v[24:27], v[124:127], a[40:43], v[24:27]
    ds_read_b128 v[124:127], v4 offset:22784
    s_waitcnt lgkmcnt(8)
    v_mfma_f32_16x16x32_bf16 v[16:19], v[32:35], a[48:51], v[16:19]
    v_mfma_f32_16x16x32_bf16 v[20:23], v[32:35], a[52:55], v[20:23]
    ds_read_b128 v[32:35], v4 offset:24576
    v_mfma_f32_16x16x32_bf16 v[28:31], v[36:39], a[52:55], v[28:31]
    v_mfma_f32_16x16x32_bf16 v[24:27], v[36:39], a[48:51], v[24:27]
    ds_read_b128 v[36:39], v4 offset:24832
    v_mfma_f32_16x16x32_bf16 v[16:19], v[40:43], a[56:59], v[16:19]
    v_mfma_f32_16x16x32_bf16 v[20:23], v[40:43], a[60:63], v[20:23]
    ds_read_b128 v[40:43], v4 offset:26624
    v_mfma_f32_16x16x32_bf16 v[28:31], v[44:47], a[60:63], v[28:31]
    v_mfma_f32_16x16x32_bf16 v[24:27], v[44:47], a[56:59], v[24:27]
    ds_read_b128 v[44:47], v4 offset:26880
    s_waitcnt lgkmcnt(8)
    v_mfma_f32_16x16x32_bf16 v[16:19], v[48:51], a[64:67], v[16:19]
    v_mfma_f32_16x16x32_bf16 v[20:23], v[48:51], a[68:71], v[20:23]
    v_mfma_f32_16x16x32_bf16 v[28:31], v[52:55], a[68:71], v[28:31]
    v_mfma_f32_16x16x32_bf16 v[24:27], v[52:55], a[64:67], v[24:27]
    v_mfma_f32_16x16x32_bf16 v[16:19], v[56:59], a[72:75], v[16:19]
    v_mfma_f32_16x16x32_bf16 v[20:23], v[56:59], a[76:79], v[20:23]
    v_mfma_f32_16x16x32_bf16 v[28:31], v[60:63], a[76:79], v[28:31]
    v_mfma_f32_16x16x32_bf16 v[24:27], v[60:63], a[72:75], v[24:27]
    s_waitcnt lgkmcnt(4)
    v_mfma_f32_16x16x32_bf16 v[16:19], v[72:75], a[80:83], v[16:19]
    v_mfma_f32_16x16x32_bf16 v[20:23], v[72:75], a[84:87], v[20:23]
    v_mfma_f32_16x16x32_bf16 v[28:31], v[76:79], a[84:87], v[28:31]
    v_mfma_f32_16x16x32_bf16 v[24:27], v[76:79], a[80:83], v[24:27]
    v_mfma_f32_16x16x32_bf16 v[16:19], v[120:123], a[88:91], v[16:19]
    v_mfma_f32_16x16x32_bf16 v[20:23], v[120:123], a[92:95], v[20:23]
    v_mfma_f32_16x16x32_bf16 v[28:31], v[124:127], a[92:95], v[28:31]
    v_mfma_f32_16x16x32_bf16 v[24:27], v[124:127], a[88:91], v[24:27]
    s_waitcnt lgkmcnt(0)
    v_mfma_f32_16x16x32_bf16 v[16:19], v[32:35], a[96:99], v[16:19]
    v_mfma_f32_16x16x32_bf16 v[20:23], v[32:35], a[100:103], v[20:23]
    v_mfma_f32_16x16x32_bf16 v[28:31], v[36:39], a[100:103], v[28:31]
    v_mfma_f32_16x16x32_bf16 v[24:27], v[36:39], a[96:99], v[24:27]
    v_mfma_f32_16x16x32_bf16 v[16:19], v[40:43], a[104:107], v[16:19]
    v_mfma_f32_16x16x32_bf16 v[20:23], v[40:43], a[108:111], v[20:23]
    v_mfma_f32_16x16x32_bf16 v[28:31], v[44:47], a[108:111], v[28:31]
    v_mfma_f32_16x16x32_bf16 v[24:27], v[44:47], a[104:107], v[24:27]
    v_xor_b32 v4, 0x10000, v4
    s_setprio 0
    s_waitcnt vmcnt(0)
    s_lshl_b32 s67, s67, 1
    s_or_b32 s67, s67, 1
    s_add_u32 s60, s60, 1
    s_cmp_gt_u32 s66, s60
    s_cbranch_scc1 L_g_loop1_129
    s_barrier
    ds_read_b32 v14, v15
    s_waitcnt lgkmcnt(0)
    v_readfirstlane_b32 s66, v14
    s_barrier
    s_mov_b32 s69, 0
    s_cmp_gt_u32 s62, s60
    s_cbranch_scc1 L_g_nd_156
    s_cmp_ge_u32 s62, s66
    s_cbranch_scc1 L_g_nd_156
    s_add_u32 s47, s61, 4096
    s_add_u32 m0, s64, 0
    s_nop 0
    buffer_load_dwordx4 v3, s[12:15], s61 offen offset:0 sc1 lds
    buffer_load_dwordx4 v3, s[12:15], s61 offen offset:1024 sc1 lds
    buffer_load_dwordx4 v3, s[12:15], s61 offen offset:2048 sc1 lds
    buffer_load_dwordx4 v3, s[12:15], s61 offen offset:3072 sc1 lds
    s_add_u32 m0, s64, 4096
    s_nop 0
    buffer_load_dwordx4 v3, s[12:15], s47 offen offset:0 sc1 lds
    buffer_load_dwordx4 v3, s[12:15], s47 offen offset:1024 sc1 lds
    buffer_load_dwordx4 v3, s[12:15], s47 offen offset:2048 sc1 lds
    s_add_u32 s61, s61, 229376
    s_add_u32 s62, s62, 1
    s_xor_b32 s64, s64, 0x10000
    s_mov_b32 s69, 1
L_g_nd_156:
    s_sub_u32 s59, s60, 1
    ds_read_b128 v[80:83], v5 offset:0
    ds_read_b128 v[84:87], v5 offset:1024
    ds_read_b128 v[88:91], v5 offset:2048
    ds_read_b128 v[92:95], v5 offset:3072
    s_nop 7
    s_waitcnt lgkmcnt(3)
    v_add_f32 v80, v80, v16
    v_add_f32 v81, v81, v17
    v_add_f32 v82, v82, v18
    v_add_f32 v83, v83, v19
    s_waitcnt lgkmcnt(2)
    v_add_f32 v84, v84, v20
    v_add_f32 v85, v85, v21
    v_add_f32 v86, v86, v22
    v_add_f32 v87, v87, v23
    s_waitcnt lgkmcnt(1)
    v_add_f32 v88, v88, v24
    v_add_f32 v89, v89, v25
    v_add_f32 v90, v90, v26
    v_add_f32 v91, v91, v27
    s_waitcnt lgkmcnt(0)
    v_add_f32 v92, v92, v28
    v_add_f32 v93, v93, v29
    v_add_f32 v94, v94, v30
    v_add_f32 v95, v95, v31
    v_cvt_pk_bf16_f32 v104, v80, v81
    v_cvt_pk_bf16_f32 v105, v82, v83
    v_cvt_pk_bf16_f32 v106, v84, v85
    v_cvt_pk_bf16_f32 v107, v86, v87
    s_nop 1
    v_permlane16_swap_b32 v104, v106
    v_permlane16_swap_b32 v105, v107
    buffer_store_dwordx4 v[104:107], v8, s[12:15], s63 offen sc1
    v_cvt_pk_bf16_f32 v108, v88, v89
    v_cvt_pk_bf16_f32 v109, v90, v91
    v_cvt_pk_bf16_f32 v110, v92, v93
    v_cvt_pk_bf16_f32 v111, v94, v95
    s_nop 1
    v_permlane16_swap_b32 v108, v110
    v_permlane16_swap_b32 v109, v111
    buffer_store_dwordx4 v[108:111], v9, s[12:15], s63 offen sc1
    s_add_u32 s63, s63, 262144
    s_mov_b32 s67, 0
    s_mov_b32 s71, 1
    s_cmp_gt_u32 s66, s60
    s_cbranch_scc1 L_g_g1r_127
    v_mov_b32 v10, 1
    s_mov_b64 exec, 1
    s_waitcnt vmcnt(0)
    ds_add_rtn_u32 v10, v15, v10 offset:4
    s_waitcnt lgkmcnt(0)
    v_readfirstlane_b32 s46, v10
    s_mov_b64 exec, -1
    s_mov_b32 s71, 0
    s_sub_u32 s59, s60, 1
    s_cmp_lg_u32 s46, s68
    s_cbranch_scc1 L_g_df_157
    v_mov_b32 v10, s59
    v_add_u32 v10, 1, v10
    v_mov_b32 v11, 0
    s_mov_b64 exec, 1
    buffer_store_dword v10, v11, s[12:15], s52 offen sc1
    s_mov_b64 exec, -1
L_sf_158:
L_g_df_157:
    s_add_u32 s68, s68, 4
    s_cmp_gt_u32 s66, s60
    s_cbranch_scc1 L_g_g1r_127
L_g_tail_130:
    s_cmp_lt_u32 s60, s75
    s_cbranch_scc1 L_g_restart_125
    s_barrier
    s_branch L_c_done_1
L_w_wo_10:
    s_load_dwordx2 s[4:5], s[0:1], 40
    s_load_dwordx2 s[6:7], s[0:1], 72
    s_and_b32 s50, s44, 3
    s_lshr_b32 s51, s44, 2
    s_waitcnt lgkmcnt(0)
    s_mov_b32 s24, s4
    s_and_b32 s25, s5, 0xffff
    s_mov_b32 s26, 0x800000
    s_mov_b32 s27, 0x00020000
    v_lshrrev_b32 v3, 4, v1
    v_and_b32 v4, 15, v1
    v_lshlrev_b32 v5, 2, v3
    v_xor_b32 v4, v4, v5
    v_mul_u32_u24 v3, 2048, v3
    v_lshl_add_u32 v3, v4, 4, v3
    s_mul_i32 s46, s51, 512
    s_mul_i32 s47, s50, 64
    s_add_u32 s46, s46, s47
    s_mul_i32 s47, s42, 1024
    s_add_u32 s46, s46, s47
    s_mul_i32 s46, s46, 2048
    s_lshl_b32 s47, s43, 8
    s_add_u32 s46, s46, s47
    s_lshl_b32 s45, s51, 16
    s_mul_i32 s47, s50, 16384
    s_add_u32 s45, s45, s47
    v_bfe_u32 v4, v1, 2, 2
    v_bfe_u32 v5, v1, 4, 1
    v_lshlrev_b32 v5, 1, v5
    v_bfe_u32 v6, v1, 1, 1
    v_add_u32 v5, v5, v6
    s_lshl_b32 s47, s50, 2
    v_add_u32 v5, s47, v5
    v_lshlrev_b32 v6, 2, v4
    v_xor_b32 v5, v5, v6
    v_lshlrev_b32 v5, 4, v5
    v_lshl_add_u32 v5, v4, 8, v5
    v_bfe_u32 v6, v1, 0, 1
    v_lshl_add_u32 v5, v6, 3, v5
    v_lshrrev_b32 v6, 5, v1
    v_mul_u32_u24 v6, 1024, v6
    v_add_u32 v5, v5, v6
    s_lshl_b32 s47, s51, 16
    v_add_u32 v5, s47, v5
    v_bfe_u32 v4, v1, 2, 2
    v_xor_b32 v5, s50, v4
    v_lshlrev_b32 v5, 6, v5
    v_lshl_add_u32 v5, v4, 8, v5
    v_and_b32 v6, 3, v1
    v_lshl_add_u32 v5, v6, 3, v5
    v_lshrrev_b32 v6, 4, v1
    v_lshl_add_u32 v5, v6, 10, v5
    v_lshrrev_b32 v6, 5, v1
    s_lshl_b32 s47, s51, 16
    v_add_u32 v5, s47, v5
    s_add_u32 m0, s45, 0
    s_add_u32 s47, s46, 0x0
    buffer_load_dwordx4 v3, s[24:27], s47 offen lds
    s_add_u32 m0, s45, 1024
    s_add_u32 s47, s46, 0x2000
    buffer_load_dwordx4 v3, s[24:27], s47 offen lds
    s_add_u32 m0, s45, 2048
    s_add_u32 s47, s46, 0x4000
    buffer_load_dwordx4 v3, s[24:27], s47 offen lds
    s_add_u32 m0, s45, 3072
    s_add_u32 s47, s46, 0x6000
    buffer_load_dwordx4 v3, s[24:27], s47 offen lds
    s_add_u32 m0, s45, 4096
    s_add_u32 s47, s46, 0x8000
    buffer_load_dwordx4 v3, s[24:27], s47 offen lds
    s_add_u32 m0, s45, 5120
    s_add_u32 s47, s46, 0xa000
    buffer_load_dwordx4 v3, s[24:27], s47 offen lds
    s_add_u32 m0, s45, 6144
    s_add_u32 s47, s46, 0xc000
    buffer_load_dwordx4 v3, s[24:27], s47 offen lds
    s_add_u32 m0, s45, 7168
    s_add_u32 s47, s46, 0xe000
    buffer_load_dwordx4 v3, s[24:27], s47 offen lds
    s_add_u32 m0, s45, 8192
    s_add_u32 s47, s46, 0x10000
    buffer_load_dwordx4 v3, s[24:27], s47 offen lds
    s_add_u32 m0, s45, 9216
    s_add_u32 s47, s46, 0x12000
    buffer_load_dwordx4 v3, s[24:27], s47 offen lds
    s_add_u32 m0, s45, 10240
    s_add_u32 s47, s46, 0x14000
    buffer_load_dwordx4 v3, s[24:27], s47 offen lds
    s_add_u32 m0, s45, 11264
    s_add_u32 s47, s46, 0x16000
    buffer_load_dwordx4 v3, s[24:27], s47 offen lds
    s_add_u32 m0, s45, 12288
    s_add_u32 s47, s46, 0x18000
    buffer_load_dwordx4 v3, s[24:27], s47 offen lds
    s_add_u32 m0, s45, 13312
    s_add_u32 s47, s46, 0x1a000
    buffer_load_dwordx4 v3, s[24:27], s47 offen lds
    s_add_u32 m0, s45, 14336
    s_add_u32 s47, s46, 0x1c000
    buffer_load_dwordx4 v3, s[24:27], s47 offen lds
    s_add_u32 m0, s45, 15360
    s_add_u32 s47, s46, 0x1e000
    buffer_load_dwordx4 v3, s[24:27], s47 offen lds
    s_waitcnt vmcnt(0)
    s_barrier
    ds_read_b64_tr_b16 a[0:1], v5 offset:0
    ds_read_b64_tr_b16 a[2:3], v5 offset:4096
    ds_read_b64_tr_b16 a[4:5], v5 offset:32
    ds_read_b64_tr_b16 a[6:7], v5 offset:4128
    ds_read_b64_tr_b16 a[8:9], v5 offset:8192
    ds_read_b64_tr_b16 a[10:11], v5 offset:12288
    ds_read_b64_tr_b16 a[12:13], v5 offset:8224
    ds_read_b64_tr_b16 a[14:15], v5 offset:12320
    s_waitcnt lgkmcnt(0)
    ds_read_b64_tr_b16 a[16:17], v5 offset:16384
    ds_read_b64_tr_b16 a[18:19], v5 offset:20480
    ds_read_b64_tr_b16 a[20:21], v5 offset:16416
    ds_read_b64_tr_b16 a[22:23], v5 offset:20512
    ds_read_b64_tr_b16 a[24:25], v5 offset:24576
    ds_read_b64_tr_b16 a[26:27], v5 offset:28672
    ds_read_b64_tr_b16 a[28:29], v5 offset:24608
    ds_read_b64_tr_b16 a[30:31], v5 offset:28704
    s_waitcnt lgkmcnt(0)
    ds_read_b64_tr_b16 a[32:33], v5 offset:32768
    ds_read_b64_tr_b16 a[34:35], v5 offset:36864
    ds_read_b64_tr_b16 a[36:37], v5 offset:32800
    ds_read_b64_tr_b16 a[38:39], v5 offset:36896
    ds_read_b64_tr_b16 a[40:41], v5 offset:40960
    ds_read_b64_tr_b16 a[42:43], v5 offset:45056
    ds_read_b64_tr_b16 a[44:45], v5 offset:40992
    ds_read_b64_tr_b16 a[46:47], v5 offset:45088
    s_waitcnt lgkmcnt(0)
    ds_read_b64_tr_b16 a[48:49], v5 offset:49152
    ds_read_b64_tr_b16 a[50:51], v5 offset:53248
    ds_read_b64_tr_b16 a[52:53], v5 offset:49184
    ds_read_b64_tr_b16 a[54:55], v5 offset:53280
    ds_read_b64_tr_b16 a[56:57], v5 offset:57344
    ds_read_b64_tr_b16 a[58:59], v5 offset:61440
    ds_read_b64_tr_b16 a[60:61], v5 offset:57376
    ds_read_b64_tr_b16 a[62:63], v5 offset:61472
    s_waitcnt lgkmcnt(0)
    s_waitcnt lgkmcnt(0)
    s_barrier
    s_add_u32 m0, s45, 0
    s_add_u32 s47, s46, 0x80000
    buffer_load_dwordx4 v3, s[24:27], s47 offen lds
    s_add_u32 m0, s45, 1024
    s_add_u32 s47, s46, 0x82000
    buffer_load_dwordx4 v3, s[24:27], s47 offen lds
    s_add_u32 m0, s45, 2048
    s_add_u32 s47, s46, 0x84000
    buffer_load_dwordx4 v3, s[24:27], s47 offen lds
    s_add_u32 m0, s45, 3072
    s_add_u32 s47, s46, 0x86000
    buffer_load_dwordx4 v3, s[24:27], s47 offen lds
    s_add_u32 m0, s45, 4096
    s_add_u32 s47, s46, 0x88000
    buffer_load_dwordx4 v3, s[24:27], s47 offen lds
    s_add_u32 m0, s45, 5120
    s_add_u32 s47, s46, 0x8a000
    buffer_load_dwordx4 v3, s[24:27], s47 offen lds
    s_add_u32 m0, s45, 6144
    s_add_u32 s47, s46, 0x8c000
    buffer_load_dwordx4 v3, s[24:27], s47 offen lds
    s_add_u32 m0, s45, 7168
    s_add_u32 s47, s46, 0x8e000
    buffer_load_dwordx4 v3, s[24:27], s47 offen lds
    s_add_u32 m0, s45, 8192
    s_add_u32 s47, s46, 0x90000
    buffer_load_dwordx4 v3, s[24:27], s47 offen lds
    s_add_u32 m0, s45, 9216
    s_add_u32 s47, s46, 0x92000
    buffer_load_dwordx4 v3, s[24:27], s47 offen lds
    s_add_u32 m0, s45, 10240
    s_add_u32 s47, s46, 0x94000
    buffer_load_dwordx4 v3, s[24:27], s47 offen lds
    s_add_u32 m0, s45, 11264
    s_add_u32 s47, s46, 0x96000
    buffer_load_dwordx4 v3, s[24:27], s47 offen lds
    s_add_u32 m0, s45, 12288
    s_add_u32 s47, s46, 0x98000
    buffer_load_dwordx4 v3, s[24:27], s47 offen lds
    s_add_u32 m0, s45, 13312
    s_add_u32 s47, s46, 0x9a000
    buffer_load_dwordx4 v3, s[24:27], s47 offen lds
    s_add_u32 m0, s45, 14336
    s_add_u32 s47, s46, 0x9c000
    buffer_load_dwordx4 v3, s[24:27], s47 offen lds
    s_add_u32 m0, s45, 15360
    s_add_u32 s47, s46, 0x9e000
    buffer_load_dwordx4 v3, s[24:27], s47 offen lds
    s_waitcnt vmcnt(0)
    s_barrier
    ds_read_b64_tr_b16 a[64:65], v5 offset:0
    ds_read_b64_tr_b16 a[66:67], v5 offset:4096
    ds_read_b64_tr_b16 a[68:69], v5 offset:32
    ds_read_b64_tr_b16 a[70:71], v5 offset:4128
    ds_read_b64_tr_b16 a[72:73], v5 offset:8192
    ds_read_b64_tr_b16 a[74:75], v5 offset:12288
    ds_read_b64_tr_b16 a[76:77], v5 offset:8224
    ds_read_b64_tr_b16 a[78:79], v5 offset:12320
    s_waitcnt lgkmcnt(0)
    ds_read_b64_tr_b16 a[80:81], v5 offset:16384
    ds_read_b64_tr_b16 a[82:83], v5 offset:20480
    ds_read_b64_tr_b16 a[84:85], v5 offset:16416
    ds_read_b64_tr_b16 a[86:87], v5 offset:20512
    ds_read_b64_tr_b16 a[88:89], v5 offset:24576
    ds_read_b64_tr_b16 a[90:91], v5 offset:28672
    ds_read_b64_tr_b16 a[92:93], v5 offset:24608
    ds_read_b64_tr_b16 a[94:95], v5 offset:28704
    s_waitcnt lgkmcnt(0)
    ds_read_b64_tr_b16 a[96:97], v5 offset:32768
    ds_read_b64_tr_b16 a[98:99], v5 offset:36864
    ds_read_b64_tr_b16 a[100:101], v5 offset:32800
    ds_read_b64_tr_b16 a[102:103], v5 offset:36896
    ds_read_b64_tr_b16 a[104:105], v5 offset:40960
    ds_read_b64_tr_b16 a[106:107], v5 offset:45056
    ds_read_b64_tr_b16 a[108:109], v5 offset:40992
    ds_read_b64_tr_b16 a[110:111], v5 offset:45088
    s_waitcnt lgkmcnt(0)
    ds_read_b64_tr_b16 a[112:113], v5 offset:49152
    ds_read_b64_tr_b16 a[114:115], v5 offset:53248
    ds_read_b64_tr_b16 a[116:117], v5 offset:49184
    ds_read_b64_tr_b16 a[118:119], v5 offset:53280
    ds_read_b64_tr_b16 a[120:121], v5 offset:57344
    ds_read_b64_tr_b16 a[122:123], v5 offset:61440
    ds_read_b64_tr_b16 a[124:125], v5 offset:57376
    ds_read_b64_tr_b16 a[126:127], v5 offset:61472
    s_waitcnt lgkmcnt(0)
    s_waitcnt lgkmcnt(0)
    s_barrier
    v_lshlrev_b32 v2, 4, v1
    s_mul_i32 s64, s44, 8192
    s_add_u32 s46, s64, 0x5000000
    s_mul_i32 s47, s42, 65536
    s_add_u32 s46, s46, s47
    v_add_u32 v3, s46, v2
    s_mul_i32 s46, s51, 32768
    v_add_u32 v4, s46, v2
    v_and_b32 v6, 15, v1
    v_lshlrev_b32 v6, 4, v6
    v_lshrrev_b32 v7, 4, v1
    v_lshl_add_u32 v6, v7, 9, v6
    v_add_u32 v4, s46, v6
    s_lshl_b32 s46, s50, 12
    s_add_u32 s46, s46, 131072
    v_add_u32 v5, s46, v2
    v_and_b32 v7, 7, v1
    v_lshlrev_b32 v7, 9, v7
    s_lshl_b32 s46, s42, 12
    s_add_u32 s46, s46, 0x102000
    v_add_u32 v7, s46, v7
    s_lshl_b32 s46, s42, 16
    s_lshl_b32 s47, s43, 11
    s_add_u32 s46, s46, s47
    s_lshl_b32 s47, s50, 9
    s_add_u32 s46, s46, s47
    s_add_u32 s46, s46, 0x9000000
    v_and_b32 v8, 31, v1
    v_lshlrev_b32 v8, 4, v8
    v_lshrrev_b32 v9, 5, v1
    v_lshl_add_u32 v8, v9, 14, v8
    v_add_u32 v8, s46, v8
    v_add_u32 v9, 0x8000, v8
    s_lshl_b32 s52, s43, 9
    s_lshl_b32 s47, s42, 7
    s_add_u32 s52, s52, s47
    s_add_u32 s52, s52, 0x107400
    s_add_u32 s52, s52, s76
    s_mov_b32 s60, s74
    s_mul_i32 s61, s74, 262144
    s_mov_b32 s62, s74
    s_mul_i32 s63, s74, 262144
    s_mov_b32 s67, 0
    s_mov_b32 s68, 3
    s_mov_b32 s71, 0
    v_mov_b32 v15, 147456
    v_mov_b32 v14, 0
    ds_write_b32 v15, v14 offset:4
    ds_write_b32 v15, v14 offset:12
    ds_write_b32 v15, v14 offset:16
    v_mov_b32 v114, 1
    s_mov_b32 s72, 0
L_g_restart_159:
    s_cmp_lg_u32 s44, 0
    s_cbranch_scc1 L_g_nsp_160
    s_mov_b32 s70, 0
L_g_sp_166:
    s_add_u32 s54, s60, 0
    s_add_u32 s55, s54, 0
    s_and_b32 s46, s55, 3
    s_lshl_b32 s46, s46, 7
    buffer_load_dword v11, v7, s[12:15], s46 offen sc1
    s_add_u32 s55, s54, 1
    s_and_b32 s46, s55, 3
    s_lshl_b32 s46, s46, 7
    buffer_load_dword v12, v7, s[12:15], s46 offen sc1
    s_add_u32 s55, s54, 2
    s_and_b32 s46, s55, 3
    s_lshl_b32 s46, s46, 7
    buffer_load_dword v13, v7, s[12:15], s46 offen sc1
    s_waitcnt vmcnt(0)
    v_cmp_ge_u32 vcc, s60, v11
    s_add_u32 s70, s70, 1
    s_cbranch_vccz L_g_sp_166_ok
    s_sleep 3
    s_cmp_lt_u32 s70, 524288
    s_cbranch_scc1 L_g_sp_166
    s_branch L_c_done_1
L_g_sp_166_ok:
    s_mov_b32 s46, s54
    v_cmp_ge_u32 vcc, s46, v11
    s_nop 0
    s_cbranch_vccnz L_g_le_167
    s_add_u32 s46, s46, 1
    v_cmp_ge_u32 vcc, s46, v12
    s_nop 0
    s_cbranch_vccnz L_g_le_167
    s_add_u32 s46, s46, 1
    v_cmp_ge_u32 vcc, s46, v13
    s_nop 0
    s_cbranch_vccnz L_g_le_167
    s_add_u32 s46, s46, 1
L_g_le_167:
    s_min_u32 s46, s46, s75
    v_mov_b32 v11, s46
    ds_write_b32 v15, v11
L_g_nsp_160:
    s_waitcnt lgkmcnt(0)
    s_barrier
    ds_read_b32 v14, v15
    s_waitcnt lgkmcnt(0)
    v_readfirstlane_b32 s66, v14
    s_nop 3
L_g_restart_159_go:
    s_mov_b32 s69, 0
    s_cmp_gt_u32 s62, s60
    s_cbranch_scc1 L_g_nd_168
    s_cmp_ge_u32 s62, s66
    s_cbranch_scc1 L_g_nd_168
    s_add_u32 s47, s61, 4096
    s_add_u32 m0, s64, 0
    s_nop 0
    buffer_load_dwordx4 v3, s[12:15], s61 offen offset:0 sc1 lds
    buffer_load_dwordx4 v3, s[12:15], s61 offen offset:1024 sc1 lds
    buffer_load_dwordx4 v3, s[12:15], s61 offen offset:2048 sc1 lds
    buffer_load_dwordx4 v3, s[12:15], s61 offen offset:3072 sc1 lds
    s_add_u32 m0, s64, 4096
    s_nop 0
    buffer_load_dwordx4 v3, s[12:15], s47 offen offset:0 sc1 lds
    buffer_load_dwordx4 v3, s[12:15], s47 offen offset:1024 sc1 lds
    buffer_load_dwordx4 v3, s[12:15], s47 offen offset:2048 sc1 lds
    buffer_load_dwordx4 v3, s[12:15], s47 offen offset:3072 sc1 lds
    s_add_u32 s61, s61, 262144
    s_add_u32 s62, s62, 1
    s_xor_b32 s64, s64, 0x10000
    s_mov_b32 s69, 1
L_g_nd_168:
    s_cmp_eq_u32 s51, 1
    s_cbranch_scc1 L_g_g1r_161
    s_add_u32 s59, s60, 1
    s_mov_b32 s69, 0
    s_cmp_gt_u32 s62, s59
    s_cbranch_scc1 L_g_nd_169
    s_cmp_ge_u32 s62, s66
    s_cbranch_scc1 L_g_nd_169
    s_add_u32 s47, s61, 4096
    s_add_u32 m0, s64, 0
    s_nop 0
    buffer_load_dwordx4 v3, s[12:15], s61 offen offset:0 sc1 lds
    buffer_load_dwordx4 v3, s[12:15], s61 offen offset:1024 sc1 lds
    buffer_load_dwordx4 v3, s[12:15], s61 offen offset:2048 sc1 lds
    buffer_load_dwordx4 v3, s[12:15], s61 offen offset:3072 sc1 lds
    s_add_u32 m0, s64, 4096
    s_nop 0
    buffer_load_dwordx4 v3, s[12:15], s47 offen offset:0 sc1 lds
    buffer_load_dwordx4 v3, s[12:15], s47 offen offset:1024 sc1 lds
    buffer_load_dwordx4 v3, s[12:15], s47 offen offset:2048 sc1 lds
    buffer_load_dwordx4 v3, s[12:15], s47 offen offset:3072 sc1 lds
    s_add_u32 s61, s61, 262144
    s_add_u32 s62, s62, 1
    s_xor_b32 s64, s64, 0x10000
    s_mov_b32 s69, 1
L_g_nd_169:
    s_cmp_eq_u32 s69, 1
    s_cbranch_scc1 L_g_w0_170
    s_waitcnt vmcnt(0)
L_g_w0_170:
    s_waitcnt vmcnt(8)
    s_mov_b32 s65, 1
.p2align 6
L_g_loop0_162:
    s_barrier
    s_cmp_eq_u32 s65, 0
    s_cbranch_scc1 L_g_pr_171
    ds_read_b128 v[32:35], v4 offset:0
    ds_read_b128 v[36:39], v4 offset:256
    ds_read_b128 v[40:43], v4 offset:2048
    ds_read_b128 v[44:47], v4 offset:2304
    ds_read_b128 v[48:51], v4 offset:4096
    ds_read_b128 v[52:55], v4 offset:4352
    ds_read_b128 v[56:59], v4 offset:6144
    ds_read_b128 v[60:63], v4 offset:6400
    ds_read_b128 v[72:75], v4 offset:8192
    ds_read_b128 v[76:79], v4 offset:8448
    ds_read_b128 v[120:123], v4 offset:10240
    ds_read_b128 v[124:127], v4 offset:10496
L_g_pr_171:
    ds_read_b32 v14, v15
    s_cmp_lg_u32 s44, 0
    s_cbranch_scc1 L_g_nl_172
    s_add_u32 s54, s60, 1
    s_add_u32 s55, s54, 0
    s_and_b32 s46, s55, 3
    s_lshl_b32 s46, s46, 7
    buffer_load_dword v11, v7, s[12:15], s46 offen sc1
    s_add_u32 s55, s54, 1
    s_and_b32 s46, s55, 3
    s_lshl_b32 s46, s46, 7
    buffer_load_dword v12, v7, s[12:15], s46 offen sc1
    s_add_u32 s55, s54, 2
    s_and_b32 s46, s55, 3
    s_lshl_b32 s46, s46, 7
    buffer_load_dword v13, v7, s[12:15], s46 offen sc1
L_g_nl_172:
    s_setprio 2
    s_waitcnt lgkmcnt(8)
    v_mfma_f32_16x16x32_bf16 v[16:19], v[32:35], a[0:3], 0
    v_mfma_f32_16x16x32_bf16 v[20:23], v[32:35], a[4:7], 0
    ds_read_b128 v[32:35], v4 offset:12288
    v_mfma_f32_16x16x32_bf16 v[28:31], v[36:39], a[4:7], 0
    v_mfma_f32_16x16x32_bf16 v[24:27], v[36:39], a[0:3], 0
    ds_read_b128 v[36:39], v4 offset:12544
    v_mfma_f32_16x16x32_bf16 v[16:19], v[40:43], a[8:11], v[16:19]
    v_mfma_f32_16x16x32_bf16 v[20:23], v[40:43], a[12:15], v[20:23]
    ds_read_b128 v[40:43], v4 offset:14336
    v_mfma_f32_16x16x32_bf16 v[28:31], v[44:47], a[12:15], v[28:31]
    v_mfma_f32_16x16x32_bf16 v[24:27], v[44:47], a[8:11], v[24:27]
    ds_read_b128 v[44:47], v4 offset:14592
    s_waitcnt lgkmcnt(8)
    v_mfma_f32_16x16x32_bf16 v[16:19], v[48:51], a[16:19], v[16:19]
    v_mfma_f32_16x16x32_bf16 v[20:23], v[48:51], a[20:23], v[20:23]
    ds_read_b128 v[48:51], v4 offset:16384
    v_mfma_f32_16x16x32_bf16 v[28:31], v[52:55], a[20:23], v[28:31]
    v_mfma_f32_16x16x32_bf16 v[24:27], v[52:55], a[16:19], v[24:27]
    ds_read_b128 v[52:55], v4 offset:16640
    v_mfma_f32_16x16x32_bf16 v[16:19], v[56:59], a[24:27], v[16:19]
    v_mfma_f32_16x16x32_bf16 v[20:23], v[56:59], a[28:31], v[20:23]
    ds_read_b128 v[56:59], v4 offset:18432
    v_mfma_f32_16x16x32_bf16 v[28:31], v[60:63], a[28:31], v[28:31]
    v_mfma_f32_16x16x32_bf16 v[24:27], v[60:63], a[24:27], v[24:27]
    ds_read_b128 v[60:63], v4 offset:18688
    s_waitcnt lgkmcnt(8)
    v_mfma_f32_16x16x32_bf16 v[16:19], v[72:75], a[32:35], v[16:19]
    v_mfma_f32_16x16x32_bf16 v[20:23], v[72:75], a[36:39], v[20:23]
    ds_read_b128 v[72:75], v4 offset:20480
    v_mfma_f32_16x16x32_bf16 v[28:31], v[76:79], a[36:39], v[28:31]
    v_mfma_f32_16x16x32_bf16 v[24:27], v[76:79], a[32:35], v[24:27]
    ds_read_b128 v[76:79], v4 offset:20736
    v_mfma_f32_16x16x32_bf16 v[16:19], v[120:123], a[40:43], v[16:19]
    v_mfma_f32_16x16x32_bf16 v[20:23], v[120:123], a[44:47], v[20:23]
    ds_read_b128 v[120:123], v4 offset:22528
    v_mfma_f32_16x16x32_bf16 v[28:31], v[124:127], a[44:47], v[28:31]
    v_mfma_f32_16x16x32_bf16 v[24:27], v[124:127], a[40:43], v[24:27]
    ds_read_b128 v[124:127], v4 offset:22784
    s_waitcnt lgkmcnt(8)
    v_mfma_f32_16x16x32_bf16 v[16:19], v[32:35], a[48:51], v[16:19]
    v_mfma_f32_16x16x32_bf16 v[20:23], v[32:35], a[52:55], v[20:23]
    ds_read_b128 v[32:35], v4 offset:24576
    v_mfma_f32_16x16x32_bf16 v[28:31], v[36:39], a[52:55], v[28:31]
    v_mfma_f32_16x16x32_bf16 v[24:27], v[36:39], a[48:51], v[24:27]
    ds_read_b128 v[36:39], v4 offset:24832
    v_mfma_f32_16x16x32_bf16 v[16:19], v[40:43], a[56:59], v[16:19]
    v_mfma_f32_16x16x32_bf16 v[20:23], v[40:43], a[60:63], v[20:23]
    ds_read_b128 v[40:43], v4 offset:26624
    v_mfma_f32_16x16x32_bf16 v[28:31], v[44:47], a[60:63], v[28:31]
    v_mfma_f32_16x16x32_bf16 v[24:27], v[44:47], a[56:59], v[24:27]
    ds_read_b128 v[44:47], v4 offset:26880
    s_waitcnt lgkmcnt(8)
    v_mfma_f32_16x16x32_bf16 v[16:19], v[48:51], a[64:67], v[16:19]
    v_mfma_f32_16x16x32_bf16 v[20:23], v[48:51], a[68:71], v[20:23]
    ds_read_b128 v[48:51], v4 offset:28672
    v_mfma_f32_16x16x32_bf16 v[28:31], v[52:55], a[68:71], v[28:31]
    v_mfma_f32_16x16x32_bf16 v[24:27], v[52:55], a[64:67], v[24:27]
    ds_read_b128 v[52:55], v4 offset:28928
    v_mfma_f32_16x16x32_bf16 v[16:19], v[56:59], a[72:75], v[16:19]
    v_mfma_f32_16x16x32_bf16 v[20:23], v[56:59], a[76:79], v[20:23]
    ds_read_b128 v[56:59], v4 offset:30720
    v_mfma_f32_16x16x32_bf16 v[28:31], v[60:63], a[76:79], v[28:31]
    v_mfma_f32_16x16x32_bf16 v[24:27], v[60:63], a[72:75], v[24:27]
    ds_read_b128 v[60:63], v4 offset:30976
    s_waitcnt lgkmcnt(8)
    v_mfma_f32_16x16x32_bf16 v[16:19], v[72:75], a[80:83], v[16:19]
    v_mfma_f32_16x16x32_bf16 v[20:23], v[72:75], a[84:87], v[20:23]
    v_mfma_f32_16x16x32_bf16 v[28:31], v[76:79], a[84:87], v[28:31]
    v_mfma_f32_16x16x32_bf16 v[24:27], v[76:79], a[80:83], v[24:27]
    v_mfma_f32_16x16x32_bf16 v[16:19], v[120:123], a[88:91], v[16:19]
    v_mfma_f32_16x16x32_bf16 v[20:23], v[120:123], a[92:95], v[20:23]
    v_mfma_f32_16x16x32_bf16 v[28:31], v[124:127], a[92:95], v[28:31]
    v_mfma_f32_16x16x32_bf16 v[24:27], v[124:127], a[88:91], v[24:27]
    s_waitcnt lgkmcnt(4)
    v_mfma_f32_16x16x32_bf16 v[16:19], v[32:35], a[96:99], v[16:19]
    v_mfma_f32_16x16x32_bf16 v[20:23], v[32:35], a[100:103], v[20:23]
    v_mfma_f32_16x16x32_bf16 v[28:31], v[36:39], a[100:103], v[28:31]
    v_mfma_f32_16x16x32_bf16 v[24:27], v[36:39], a[96:99], v[24:27]
    v_mfma_f32_16x16x32_bf16 v[16:19], v[40:43], a[104:107], v[16:19]
    v_mfma_f32_16x16x32_bf16 v[20:23], v[40:43], a[108:111], v[20:23]
    v_mfma_f32_16x16x32_bf16 v[28:31], v[44:47], a[108:111], v[28:31]
    v_mfma_f32_16x16x32_bf16 v[24:27], v[44:47], a[104:107], v[24:27]
    s_waitcnt lgkmcnt(0)
    v_mfma_f32_16x16x32_bf16 v[16:19], v[48:51], a[112:115], v[16:19]
    v_mfma_f32_16x16x32_bf16 v[20:23], v[48:51], a[116:119], v[20:23]
    v_mfma_f32_16x16x32_bf16 v[28:31], v[52:55], a[116:119], v[28:31]
    v_mfma_f32_16x16x32_bf16 v[24:27], v[52:55], a[112:115], v[24:27]
    v_mfma_f32_16x16x32_bf16 v[16:19], v[56:59], a[120:123], v[16:19]
    v_mfma_f32_16x16x32_bf16 v[20:23], v[56:59], a[124:127], v[20:23]
    v_mfma_f32_16x16x32_bf16 v[28:31], v[60:63], a[124:127], v[28:31]
    v_mfma_f32_16x16x32_bf16 v[24:27], v[60:63], a[120:123], v[24:27]
    v_xor_b32 v4, 0x10000, v4
    s_setprio 0
    s_waitcnt vmcnt(0)
    v_readfirstlane_b32 s66, v14
    s_barrier
    s_nop 6
    ds_write_b128 v5, v[16:19] offset:0
    ds_write_b128 v5, v[20:23] offset:1024
    ds_write_b128 v5, v[24:27] offset:2048
    ds_write_b128 v5, v[28:31] offset:3072
    s_cmp_lg_u32 s44, 0
    s_cbranch_scc1 L_g_ne_173
    s_mov_b32 s46, s54
    v_cmp_ge_u32 vcc, s46, v11
    s_nop 0
    s_cbranch_vccnz L_g_le_176
    s_add_u32 s46, s46, 1
    v_cmp_ge_u32 vcc, s46, v12
    s_nop 0
    s_cbranch_vccnz L_g_le_176
    s_add_u32 s46, s46, 1
    v_cmp_ge_u32 vcc, s46, v13
    s_nop 0
    s_cbranch_vccnz L_g_le_176
    s_add_u32 s46, s46, 1
L_g_le_176:
    s_min_u32 s46, s46, s75
    v_mov_b32 v11, s46
    ds_write_b32 v15, v11
L_g_ne_173:
    s_add_u32 s60, s60, 1
    s_mov_b32 s69, 0
    s_cmp_gt_u32 s62, s60
    s_cbranch_scc1 L_g_nd_177
    s_cmp_ge_u32 s62, s66
    s_cbranch_scc1 L_g_nd_177
    s_add_u32 s47, s61, 4096
    s_add_u32 m0, s64, 0
    s_nop 0
    buffer_load_dwordx4 v3, s[12:15], s61 offen offset:0 sc1 lds
    buffer_load_dwordx4 v3, s[12:15], s61 offen offset:1024 sc1 lds
    buffer_load_dwordx4 v3, s[12:15], s61 offen offset:2048 sc1 lds
    buffer_load_dwordx4 v3, s[12:15], s61 offen offset:3072 sc1 lds
    s_add_u32 m0, s64, 4096
    s_nop 0
    buffer_load_dwordx4 v3, s[12:15], s47 offen offset:0 sc1 lds
    buffer_load_dwordx4 v3, s[12:15], s47 offen offset:1024 sc1 lds
    buffer_load_dwordx4 v3, s[12:15], s47 offen offset:2048 sc1 lds
    buffer_load_dwordx4 v3, s[12:15], s47 offen offset:3072 sc1 lds
    s_add_u32 s61, s61, 262144
    s_add_u32 s62, s62, 1
    s_xor_b32 s64, s64, 0x10000
    s_mov_b32 s69, 1
L_g_nd_177:
    s_mov_b32 s65, s69
    s_add_u32 s59, s60, 1
    s_mov_b32 s69, 0
    s_cmp_gt_u32 s62, s59
    s_cbranch_scc1 L_g_nd_178
    s_cmp_ge_u32 s62, s66
    s_cbranch_scc1 L_g_nd_178
    s_add_u32 s47, s61, 4096
    s_add_u32 m0, s64, 0
    s_nop 0
    buffer_load_dwordx4 v3, s[12:15], s61 offen offset:0 sc1 lds
    buffer_load_dwordx4 v3, s[12:15], s61 offen offset:1024 sc1 lds
    buffer_load_dwordx4 v3, s[12:15], s61 offen offset:2048 sc1 lds
    buffer_load_dwordx4 v3, s[12:15], s61 offen offset:3072 sc1 lds
    s_add_u32 m0, s64, 4096
    s_nop 0
    buffer_load_dwordx4 v3, s[12:15], s47 offen offset:0 sc1 lds
    buffer_load_dwordx4 v3, s[12:15], s47 offen offset:1024 sc1 lds
    buffer_load_dwordx4 v3, s[12:15], s47 offen offset:2048 sc1 lds
    buffer_load_dwordx4 v3, s[12:15], s47 offen offset:3072 sc1 lds
    s_add_u32 s61, s61, 262144
    s_add_u32 s62, s62, 1
    s_xor_b32 s64, s64, 0x10000
    s_mov_b32 s69, 1
L_g_nd_178:
    s_cmp_le_u32 s66, s60
    s_cbranch_scc1 L_g_ex0_175
    s_cmp_eq_u32 s65, 0
    s_cbranch_scc1 L_g_nw_174
    s_waitcnt vmcnt(0) lgkmcnt(0)
    s_branch L_g_loop0_162
L_g_nw_174:
    ds_read_b128 v[32:35], v4 offset:0
    ds_read_b128 v[36:39], v4 offset:256
    ds_read_b128 v[40:43], v4 offset:2048
    ds_read_b128 v[44:47], v4 offset:2304
    ds_read_b128 v[48:51], v4 offset:4096
    ds_read_b128 v[52:55], v4 offset:4352
    ds_read_b128 v[56:59], v4 offset:6144
    ds_read_b128 v[60:63], v4 offset:6400
    ds_read_b128 v[72:75], v4 offset:8192
    ds_read_b128 v[76:79], v4 offset:8448
    ds_read_b128 v[120:123], v4 offset:10240
    ds_read_b128 v[124:127], v4 offset:10496
    s_waitcnt lgkmcnt(12)
    s_branch L_g_loop0_162
L_g_ex0_175:
    s_cmp_lg_u32 s44, 0
    s_cbranch_scc1 L_g_ex0_175_n
    s_sleep 6
    s_add_u32 s54, s60, 0
    s_add_u32 s55, s54, 0
    s_and_b32 s46, s55, 3
    s_lshl_b32 s46, s46, 7
    buffer_load_dword v11, v7, s[12:15], s46 offen sc1
    s_add_u32 s55, s54, 1
    s_and_b32 s46, s55, 3
    s_lshl_b32 s46, s46, 7
    buffer_load_dword v12, v7, s[12:15], s46 offen sc1
    s_add_u32 s55, s54, 2
    s_and_b32 s46, s55, 3
    s_lshl_b32 s46, s46, 7
    buffer_load_dword v13, v7, s[12:15], s46 offen sc1
    s_waitcnt vmcnt(0)
    s_mov_b32 s46, s54
    v_cmp_ge_u32 vcc, s46, v11
    s_nop 0
    s_cbranch_vccnz L_g_le_179
    s_add_u32 s46, s46, 1
    v_cmp_ge_u32 vcc, s46, v12
    s_nop 0
    s_cbranch_vccnz L_g_le_179
    s_add_u32 s46, s46, 1
    v_cmp_ge_u32 vcc, s46, v13
    s_nop 0
    s_cbranch_vccnz L_g_le_179
    s_add_u32 s46, s46, 1
L_g_le_179:
    s_min_u32 s46, s46, s75
    v_mov_b32 v11, s46
    ds_write_b32 v15, v11
L_g_ex0_175_n:
    s_waitcnt lgkmcnt(0)
    s_barrier
    ds_read_b32 v14, v15
    s_waitcnt lgkmcnt(0)
    v_readfirstlane_b32 s66, v14
    s_barrier
    s_cmp_gt_u32 s66, s60
    s_cbranch_scc1 L_g_restart_159_go
    s_branch L_g_tail_164
L_g_g1r_161:
    s_mov_b32 s65, 1
    s_branch L_g_loop1_163_e
.p2align 6
L_g_loop1_163:
    s_mov_b32 s65, 0
L_g_loop1_163_e:
    s_barrier
    ds_read_b32 v14, v15
    s_bitcmp1_b32 s67, 1
    s_cbranch_scc0 L_g_nfl_180
    s_sub_u32 s59, s60, 2
    s_cmp_lg_u32 s44, 4
    s_cbranch_scc1 L_sf_185
    v_mov_b32 v10, s59
    v_add_u32 v10, 1, v10
    v_mov_b32 v11, 0
    s_mov_b64 exec, 1
    buffer_store_dword v10, v11, s[12:15], s52 offen sc1
    s_mov_b64 exec, -1
L_sf_185:
L_g_nfl_180:
    s_cmp_eq_u32 s71, 0
    s_cbranch_scc1 L_g_nfl_180_d
    v_mov_b32 v10, 1
    s_mov_b64 exec, 1
    s_waitcnt vmcnt(0)
    ds_add_rtn_u32 v10, v15, v10 offset:4
    s_waitcnt lgkmcnt(0)
    v_readfirstlane_b32 s46, v10
    s_mov_b64 exec, -1
    s_mov_b32 s71, 0
    s_sub_u32 s59, s60, 1
    s_cmp_lg_u32 s46, s68
    s_cbranch_scc1 L_g_df_186
    v_mov_b32 v10, s59
    v_add_u32 v10, 1, v10
    v_mov_b32 v11, 0
    s_mov_b64 exec, 1
    buffer_store_dword v10, v11, s[12:15], s52 offen sc1
    s_mov_b64 exec, -1
L_sf_187:
L_g_df_186:
    s_add_u32 s68, s68, 4
    s_mov_b32 s65, 2
L_g_nfl_180_d:
    s_waitcnt lgkmcnt(0)
    v_readfirstlane_b32 s66, v14
    s_nop 3
    s_mov_b32 s69, 0
    s_cmp_gt_u32 s62, s60
    s_cbranch_scc1 L_g_nd_188
    s_cmp_ge_u32 s62, s66
    s_cbranch_scc1 L_g_nd_188
    s_add_u32 s47, s61, 4096
    s_add_u32 m0, s64, 0
    s_nop 0
    buffer_load_dwordx4 v3, s[12:15], s61 offen offset:0 sc1 lds
    buffer_load_dwordx4 v3, s[12:15], s61 offen offset:1024 sc1 lds
    buffer_load_dwordx4 v3, s[12:15], s61 offen offset:2048 sc1 lds
    buffer_load_dwordx4 v3, s[12:15], s61 offen offset:3072 sc1 lds
    s_add_u32 m0, s64, 4096
    s_nop 0
    buffer_load_dwordx4 v3, s[12:15], s47 offen offset:0 sc1 lds
    buffer_load_dwordx4 v3, s[12:15], s47 offen offset:1024 sc1 lds
    buffer_load_dwordx4 v3, s[12:15], s47 offen offset:2048 sc1 lds
    buffer_load_dwordx4 v3, s[12:15], s47 offen offset:3072 sc1 lds
    s_add_u32 s61, s61, 262144
    s_add_u32 s62, s62, 1
    s_xor_b32 s64, s64, 0x10000
    s_mov_b32 s69, 1
L_g_nd_188:
    s_or_b32 s65, s65, s69
    s_add_u32 s59, s60, 1
    s_mov_b32 s69, 0
    s_cmp_gt_u32 s62, s59
    s_cbranch_scc1 L_g_nd_189
    s_cmp_ge_u32 s62, s66
    s_cbranch_scc1 L_g_nd_189
    s_add_u32 s47, s61, 4096
    s_add_u32 m0, s64, 0
    s_nop 0
    buffer_load_dwordx4 v3, s[12:15], s61 offen offset:0 sc1 lds
    buffer_load_dwordx4 v3, s[12:15], s61 offen offset:1024 sc1 lds
    buffer_load_dwordx4 v3, s[12:15], s61 offen offset:2048 sc1 lds
    buffer_load_dwordx4 v3, s[12:15], s61 offen offset:3072 sc1 lds
    s_add_u32 m0, s64, 4096
    s_nop 0
    buffer_load_dwordx4 v3, s[12:15], s47 offen offset:0 sc1 lds
    buffer_load_dwordx4 v3, s[12:15], s47 offen offset:1024 sc1 lds
    buffer_load_dwordx4 v3, s[12:15], s47 offen offset:2048 sc1 lds
    buffer_load_dwordx4 v3, s[12:15], s47 offen offset:3072 sc1 lds
    s_add_u32 s61, s61, 262144
    s_add_u32 s62, s62, 1
    s_xor_b32 s64, s64, 0x10000
    s_mov_b32 s69, 1
L_g_nd_189:
    s_bitcmp1_b32 s67, 0
    s_cbranch_scc0 L_g_nep_181
    ds_read_b128 v[80:83], v5 offset:0
    ds_read_b128 v[84:87], v5 offset:1024
    ds_read_b128 v[88:91], v5 offset:2048
    ds_read_b128 v[92:95], v5 offset:3072
    s_nop 7
    s_waitcnt lgkmcnt(3)
    v_add_f32 v80, v80, v16
    v_add_f32 v81, v81, v17
    v_add_f32 v82, v82, v18
    v_add_f32 v83, v83, v19
    s_waitcnt lgkmcnt(2)
    v_add_f32 v84, v84, v20
    v_add_f32 v85, v85, v21
    v_add_f32 v86, v86, v22
    v_add_f32 v87, v87, v23
    s_waitcnt lgkmcnt(1)
    v_add_f32 v88, v88, v24
    v_add_f32 v89, v89, v25
    v_add_f32 v90, v90, v26
    v_add_f32 v91, v91, v27
    s_waitcnt lgkmcnt(0)
    v_add_f32 v92, v92, v28
    v_add_f32 v93, v93, v29
    v_add_f32 v94, v94, v30
    v_add_f32 v95, v95, v31
    v_cvt_pk_bf16_f32 v104, v80, v81
    v_cvt_pk_bf16_f32 v105, v82, v83
    v_cvt_pk_bf16_f32 v106, v84, v85
    v_cvt_pk_bf16_f32 v107, v86, v87
    s_nop 1
    v_permlane16_swap_b32 v104, v106
    v_permlane16_swap_b32 v105, v107
    buffer_store_dwordx4 v[104:107], v8, s[12:15], s63 offen sc1
    v_cvt_pk_bf16_f32 v108, v88, v89
    v_cvt_pk_bf16_f32 v109, v90, v91
    v_cvt_pk_bf16_f32 v110, v92, v93
    v_cvt_pk_bf16_f32 v111, v94, v95
    s_nop 1
    v_permlane16_swap_b32 v108, v110
    v_permlane16_swap_b32 v109, v111
    buffer_store_dwordx4 v[108:111], v9, s[12:15], s63 offen sc1
    s_add_u32 s63, s63, 262144
L_g_nep_181:
    s_cmp_eq_u32 s65, 0
    s_cbranch_scc1 L_g_nw1_182
    s_cmp_eq_u32 s65, 2
    s_cbranch_scc1 L_g_nw1_182_w
    s_waitcnt vmcnt(0)
L_g_nw1_182_w:
    s_barrier
    ds_read_b128 v[32:35], v4 offset:0
    ds_read_b128 v[36:39], v4 offset:256
    ds_read_b128 v[40:43], v4 offset:2048
    ds_read_b128 v[44:47], v4 offset:2304
    ds_read_b128 v[48:51], v4 offset:4096
    ds_read_b128 v[52:55], v4 offset:4352
    ds_read_b128 v[56:59], v4 offset:6144
    ds_read_b128 v[60:63], v4 offset:6400
    ds_read_b128 v[72:75], v4 offset:8192
    ds_read_b128 v[76:79], v4 offset:8448
    ds_read_b128 v[120:123], v4 offset:10240
    ds_read_b128 v[124:127], v4 offset:10496
    s_branch L_g_jn_184
L_g_nw1_182:
    ds_read_b128 v[32:35], v4 offset:0
    ds_read_b128 v[36:39], v4 offset:256
    ds_read_b128 v[40:43], v4 offset:2048
    ds_read_b128 v[44:47], v4 offset:2304
    ds_read_b128 v[48:51], v4 offset:4096
    ds_read_b128 v[52:55], v4 offset:4352
    ds_read_b128 v[56:59], v4 offset:6144
    ds_read_b128 v[60:63], v4 offset:6400
    ds_read_b128 v[72:75], v4 offset:8192
    ds_read_b128 v[76:79], v4 offset:8448
    ds_read_b128 v[120:123], v4 offset:10240
    ds_read_b128 v[124:127], v4 offset:10496
    s_barrier
L_g_jn_184:
    s_setprio 1
    s_waitcnt lgkmcnt(8)
    v_mfma_f32_16x16x32_bf16 v[16:19], v[32:35], a[0:3], 0
    v_mfma_f32_16x16x32_bf16 v[20:23], v[32:35], a[4:7], 0
    ds_read_b128 v[32:35], v4 offset:12288
    v_mfma_f32_16x16x32_bf16 v[28:31], v[36:39], a[4:7], 0
    v_mfma_f32_16x16x32_bf16 v[24:27], v[36:39], a[0:3], 0
    ds_read_b128 v[36:39], v4 offset:12544
    v_mfma_f32_16x16x32_bf16 v[16:19], v[40:43], a[8:11], v[16:19]
    v_mfma_f32_16x16x32_bf16 v[20:23], v[40:43], a[12:15], v[20:23]
    ds_read_b128 v[40:43], v4 offset:14336
    v_mfma_f32_16x16x32_bf16 v[28:31], v[44:47], a[12:15], v[28:31]
    v_mfma_f32_16x16x32_bf16 v[24:27], v[44:47], a[8:11], v[24:27]
    ds_read_b128 v[44:47], v4 offset:14592
    s_waitcnt lgkmcnt(8)
    v_mfma_f32_16x16x32_bf16 v[16:19], v[48:51], a[16:19], v[16:19]
    v_mfma_f32_16x16x32_bf16 v[20:23], v[48:51], a[20:23], v[20:23]
    ds_read_b128 v[48:51], v4 offset:16384
    v_mfma_f32_16x16x32_bf16 v[28:31], v[52:55], a[20:23], v[28:31]
    v_mfma_f32_16x16x32_bf16 v[24:27], v[52:55], a[16:19], v[24:27]
    ds_read_b128 v[52:55], v4 offset:16640
    v_mfma_f32_16x16x32_bf16 v[16:19], v[56:59], a[24:27], v[16:19]
    v_mfma_f32_16x16x32_bf16 v[20:23], v[56:59], a[28:31], v[20:23]
    ds_read_b128 v[56:59], v4 offset:18432
    v_mfma_f32_16x16x32_bf16 v[28:31], v[60:63], a[28:31], v[28:31]
    v_mfma_f32_16x16x32_bf16 v[24:27], v[60:63], a[24:27], v[24:27]
    ds_read_b128 v[60:63], v4 offset:18688
    s_waitcnt lgkmcnt(8)
    v_mfma_f32_16x16x32_bf16 v[16:19], v[72:75], a[32:35], v[16:19]
    v_mfma_f32_16x16x32_bf16 v[20:23], v[72:75], a[36:39], v[20:23]
    ds_read_b128 v[72:75], v4 offset:20480
    v_mfma_f32_16x16x32_bf16 v[28:31], v[76:79], a[36:39], v[28:31]
    v_mfma_f32_16x16x32_bf16 v[24:27], v[76:79], a[32:35], v[24:27]
    ds_read_b128 v[76:79], v4 offset:20736
    v_mfma_f32_16x16x32_bf16 v[16:19], v[120:123], a[40:43], v[16:19]
    v_mfma_f32_16x16x32_bf16 v[20:23], v[120:123], a[44:47], v[20:23]
    ds_read_b128 v[120:123], v4 offset:22528
    v_mfma_f32_16x16x32_bf16 v[28:31], v[124:127], a[44:47], v[28:31]
    v_mfma_f32_16x16x32_bf16 v[24:27], v[124:127], a[40:43], v[24:27]
    ds_read_b128 v[124:127], v4 offset:22784
    s_waitcnt lgkmcnt(8)
    v_mfma_f32_16x16x32_bf16 v[16:19], v[32:35], a[48:51], v[16:19]
    v_mfma_f32_16x16x32_bf16 v[20:23], v[32:35], a[52:55], v[20:23]
    ds_read_b128 v[32:35], v4 offset:24576
    v_mfma_f32_16x16x32_bf16 v[28:31], v[36:39], a[52:55], v[28:31]
    v_mfma_f32_16x16x32_bf16 v[24:27], v[36:39], a[48:51], v[24:27]
    ds_read_b128 v[36:39], v4 offset:24832
    v_mfma_f32_16x16x32_bf16 v[16:19], v[40:43], a[56:59], v[16:19]
    v_mfma_f32_16x16x32_bf16 v[20:23], v[40:43], a[60:63], v[20:23]
    ds_read_b128 v[40:43], v4 offset:26624
    v_mfma_f32_16x16x32_bf16 v[28:31], v[44:47], a[60:63], v[28:31]
    v_mfma_f32_16x16x32_bf16 v[24:27], v[44:47], a[56:59], v[24:27]
    ds_read_b128 v[44:47], v4 offset:26880
    s_waitcnt lgkmcnt(8)
    v_mfma_f32_16x16x32_bf16 v[16:19], v[48:51], a[64:67], v[16:19]
    v_mfma_f32_16x16x32_bf16 v[20:23], v[48:51], a[68:71], v[20:23]
    ds_read_b128 v[48:51], v4 offset:28672
    v_mfma_f32_16x16x32_bf16 v[28:31], v[52:55], a[68:71], v[28:31]
    v_mfma_f32_16x16x32_bf16 v[24:27], v[52:55], a[64:67], v[24:27]
    ds_read_b128 v[52:55], v4 offset:28928
    v_mfma_f32_16x16x32_bf16 v[16:19], v[56:59], a[72:75], v[16:19]
    v_mfma_f32_16x16x32_bf16 v[20:23], v[56:59], a[76:79], v[20:23]
    ds_read_b128 v[56:59], v4 offset:30720
    v_mfma_f32_16x16x32_bf16 v[28:31], v[60:63], a[76:79], v[28:31]
    v_mfma_f32_16x16x32_bf16 v[24:27], v[60:63], a[72:75], v[24:27]
    ds_read_b128 v[60:63], v4 offset:30976
    s_waitcnt lgkmcnt(8)
    v_mfma_f32_16x16x32_bf16 v[16:19], v[72:75], a[80:83], v[16:19]
    v_mfma_f32_16x16x32_bf16 v[20:23], v[72:75], a[84:87], v[20:23]
    v_mfma_f32_16x16x32_bf16 v[28:31], v[76:79], a[84:87], v[28:31]
    v_mfma_f32_16x16x32_bf16 v[24:27], v[76:79], a[80:83], v[24:27]
    v_mfma_f32_16x16x32_bf16 v[16:19], v[120:123], a[88:91], v[16:19]
    v_mfma_f32_16x16x32_bf16 v[20:23], v[120:123], a[92:95], v[20:23]
    v_mfma_f32_16x16x32_bf16 v[28:31], v[124:127], a[92:95], v[28:31]
    v_mfma_f32_16x16x32_bf16 v[24:27], v[124:127], a[88:91], v[24:27]
    s_waitcnt lgkmcnt(4)
    v_mfma_f32_16x16x32_bf16 v[16:19], v[32:35], a[96:99], v[16:19]
    v_mfma_f32_16x16x32_bf16 v[20:23], v[32:35], a[100:103], v[20:23]
    v_mfma_f32_16x16x32_bf16 v[28:31], v[36:39], a[100:103], v[28:31]
    v_mfma_f32_16x16x32_bf16 v[24:27], v[36:39], a[96:99], v[24:27]
    v_mfma_f32_16x16x32_bf16 v[16:19], v[40:43], a[104:107], v[16:19]
    v_mfma_f32_16x16x32_bf16 v[20:23], v[40:43], a[108:111], v[20:23]
    v_mfma_f32_16x16x32_bf16 v[28:31], v[44:47], a[108:111], v[28:31]
    v_mfma_f32_16x16x32_bf16 v[24:27], v[44:47], a[104:107], v[24:27]
    s_waitcnt lgkmcnt(0)
    v_mfma_f32_16x16x32_bf16 v[16:19], v[48:51], a[112:115], v[16:19]
    v_mfma_f32_16x16x32_bf16 v[20:23], v[48:51], a[116:119], v[20:23]
    v_mfma_f32_16x16x32_bf16 v[28:31], v[52:55], a[116:119], v[28:31]
    v_mfma_f32_16x16x32_bf16 v[24:27], v[52:55], a[112:115], v[24:27]
    v_mfma_f32_16x16x32_bf16 v[16:19], v[56:59], a[120:123], v[16:19]
    v_mfma_f32_16x16x32_bf16 v[20:23], v[56:59], a[124:127], v[20:23]
    v_mfma_f32_16x16x32_bf16 v[28:31], v[60:63], a[124:127], v[28:31]
    v_mfma_f32_16x16x32_bf16 v[24:27], v[60:63], a[120:123], v[24:27]
    v_xor_b32 v4, 0x10000, v4
    s_setprio 0
    s_waitcnt vmcnt(0)
    s_lshl_b32 s67, s67, 1
    s_or_b32 s67, s67, 1
    s_add_u32 s60, s60, 1
    s_cmp_gt_u32 s66, s60
    s_cbranch_scc1 L_g_loop1_163
    s_barrier
    ds_read_b32 v14, v15
    s_waitcnt lgkmcnt(0)
    v_readfirstlane_b32 s66, v14
    s_barrier
    s_mov_b32 s69, 0
    s_cmp_gt_u32 s62, s60
    s_cbranch_scc1 L_g_nd_190
    s_cmp_ge_u32 s62, s66
    s_cbranch_scc1 L_g_nd_190
    s_add_u32 s47, s61, 4096
    s_add_u32 m0, s64, 0
    s_nop 0
    buffer_load_dwordx4 v3, s[12:15], s61 offen offset:0 sc1 lds
    buffer_load_dwordx4 v3, s[12:15], s61 offen offset:1024 sc1 lds
    buffer_load_dwordx4 v3, s[12:15], s61 offen offset:2048 sc1 lds
    buffer_load_dwordx4 v3, s[12:15], s61 offen offset:3072 sc1 lds
    s_add_u32 m0, s64, 4096
    s_nop 0
    buffer_load_dwordx4 v3, s[12:15], s47 offen offset:0 sc1 lds
    buffer_load_dwordx4 v3, s[12:15], s47 offen offset:1024 sc1 lds
    buffer_load_dwordx4 v3, s[12:15], s47 offen offset:2048 sc1 lds
    buffer_load_dwordx4 v3, s[12:15], s47 offen offset:3072 sc1 lds
    s_add_u32 s61, s61, 262144
    s_add_u32 s62, s62, 1
    s_xor_b32 s64, s64, 0x10000
    s_mov_b32 s69, 1
L_g_nd_190:
    s_sub_u32 s59, s60, 1
    ds_read_b128 v[80:83], v5 offset:0
    ds_read_b128 v[84:87], v5 offset:1024
    ds_read_b128 v[88:91], v5 offset:2048
    ds_read_b128 v[92:95], v5 offset:3072
    s_nop 7
    s_waitcnt lgkmcnt(3)
    v_add_f32 v80, v80, v16
    v_add_f32 v81, v81, v17
    v_add_f32 v82, v82, v18
    v_add_f32 v83, v83, v19
    s_waitcnt lgkmcnt(2)
    v_add_f32 v84, v84, v20
    v_add_f32 v85, v85, v21
    v_add_f32 v86, v86, v22
    v_add_f32 v87, v87, v23
    s_waitcnt lgkmcnt(1)
    v_add_f32 v88, v88, v24
    v_add_f32 v89, v89, v25
    v_add_f32 v90, v90, v26
    v_add_f32 v91, v91, v27
    s_waitcnt lgkmcnt(0)
    v_add_f32 v92, v92, v28
    v_add_f32 v93, v93, v29
    v_add_f32 v94, v94, v30
    v_add_f32 v95, v95, v31
    v_cvt_pk_bf16_f32 v104, v80, v81
    v_cvt_pk_bf16_f32 v105, v82, v83
    v_cvt_pk_bf16_f32 v106, v84, v85
    v_cvt_pk_bf16_f32 v107, v86, v87
    s_nop 1
    v_permlane16_swap_b32 v104, v106
    v_permlane16_swap_b32 v105, v107
    buffer_store_dwordx4 v[104:107], v8, s[12:15], s63 offen sc1
    v_cvt_pk_bf16_f32 v108, v88, v89
    v_cvt_pk_bf16_f32 v109, v90, v91
    v_cvt_pk_bf16_f32 v110, v92, v93
    v_cvt_pk_bf16_f32 v111, v94, v95
    s_nop 1
    v_permlane16_swap_b32 v108, v110
    v_permlane16_swap_b32 v109, v111
    buffer_store_dwordx4 v[108:111], v9, s[12:15], s63 offen sc1
    s_add_u32 s63, s63, 262144
    s_mov_b32 s67, 0
    s_mov_b32 s71, 1
    s_cmp_gt_u32 s66, s60
    s_cbranch_scc1 L_g_g1r_161
    v_mov_b32 v10, 1
    s_mov_b64 exec, 1
    s_waitcnt vmcnt(0)
    ds_add_rtn_u32 v10, v15, v10 offset:4
    s_waitcnt lgkmcnt(0)
    v_readfirstlane_b32 s46, v10
    s_mov_b64 exec, -1
    s_mov_b32 s71, 0
    s_sub_u32 s59, s60, 1
    s_cmp_lg_u32 s46, s68
    s_cbranch_scc1 L_g_df_191
    v_mov_b32 v10, s59
    v_add_u32 v10, 1, v10
    v_mov_b32 v11, 0
    s_mov_b64 exec, 1
    buffer_store_dword v10, v11, s[12:15], s52 offen sc1
    s_mov_b64 exec, -1
L_sf_192:
L_g_df_191:
    s_add_u32 s68, s68, 4
    s_cmp_gt_u32 s66, s60
    s_cbranch_scc1 L_g_g1r_161
L_g_tail_164:
    s_cmp_lt_u32 s60, s75
    s_cbranch_scc1 L_g_restart_159
    s_barrier
    s_branch L_c_done_1
L_c_chain_7:
    v_mov_b32 v4, 0
    v_mov_b32 v5, 0
    v_mov_b32 v6, 0
    v_mov_b32 v7, 0
    v_mov_b32 v8, 0
    v_mov_b32 v9, 0
    v_mov_b32 v10, 0
    v_mov_b32 v11, 0
    v_mov_b32 v12, 0
    v_mov_b32 v13, 0
    v_mov_b32 v14, 0
    v_mov_b32 v15, 0
    v_mov_b32 v32, -1
    v_mov_b32 v33, -1
    v_mov_b32 v34, -1
    v_mov_b32 v35, -1
    v_lshlrev_b32 v2, 4, v1
    s_lshl_b32 s45, s40, 16
    s_lshl_b32 s46, s41, 12
    s_add_u32 s45, s45, s46
    s_and_b32 s46, s44, 3
    s_lshl_b32 s46, s46, 10
    s_add_u32 s45, s45, s46
    s_lshr_b32 s46, s44, 2
    s_lshl_b32 s46, s46, 19
    s_add_u32 s45, s45, s46
    s_add_u32 s45, s45, 0x7000000
    buffer_store_dwordx4 v[32:35], v2, s[12:15], s45 offen sc1
    s_lshl_b32 s45, s40, 15
    s_lshl_b32 s46, s41, 11
    s_add_u32 s45, s45, s46
    s_lshl_b32 s46, s44, 8
    s_add_u32 s45, s45, s46
    s_add_u32 s45, s45, 0x7100000
    s_mov_b64 exec, 0xffff
    buffer_store_dwordx4 v[32:35], v2, s[12:15], s45 offen sc1
    s_mov_b64 exec, -1
    v_lshlrev_b32 v2, 4, v1
    v_and_b32 v3, 8, v1
    v_cmp_eq_u32 vcc, 0, v3
    v_mov_b32 v3, 0xeeeeeeee
    v_mov_b32 v4, 0x44444444
    v_cndmask_b32 v3, v3, v4, vcc
    v_and_b32 v100, 15, v1
    v_lshrrev_b32 v101, 4, v1
    v_and_b32 v102, 1, v101
    v_lshrrev_b32 v103, 1, v101
    v_lshlrev_b32 v104, 2, v102
    v_lshl_add_u32 v104, v103, 1, v104
    v_and_b32 v105, 1, v1
    v_add_u32 v104, v104, v105
    v_and_b32 v106, 7, v1
    v_bfe_u32 v107, v1, 3, 1
    s_lshr_b32 s42, s41, 2
    s_and_b32 s43, s41, 3
    s_lshl_b32 s49, s40, 2
    s_add_u32 s49, s49, s42
    s_lshl_b32 s45, s44, 14
    v_lshlrev_b32 v22, 3, v101
    v_bfe_u32 v23, v1, 2, 2
    v_add_u32 v22, v22, v23
    v_and_b32 v23, 3, v1
    v_lshlrev_b32 v24, 3, v23
    v_lshl_add_u32 v20, v22, 6, v24
    v_lshl_add_u32 v21, v22, 7, v24
    v_lshrrev_b32 v22, 2, v1
    v_lshlrev_b32 v23, 4, v23
    v_lshl_add_u32 v24, v22, 13, v23
    v_lshrrev_b32 v22, 3, v1
    v_lshlrev_b32 v23, 4, v106
    v_lshl_add_u32 v25, v22, 11, v23
    s_cmp_ge_u32 s44, 4
    s_cbranch_scc1 L_v_init_193
    s_lshr_b32 s50, s44, 1
    s_and_b32 s51, s44, 1
    s_load_dwordx4 s[4:7], s[0:1], 16
    s_lshl_b32 s46, s49, 8
    s_lshl_b32 s48, s43, 6
    s_add_u32 s46, s46, s48
    s_lshl_b32 s48, s44, 21
    s_add_u32 s46, s46, s48
    s_lshl_b32 s52, s51, 5
    s_xor_b32 s53, s50, 1
    s_lshl_b32 s53, s53, 16
    s_add_u32 s52, s52, s53
    v_add_u32 v20, s52, v20
    s_waitcnt lgkmcnt(0)
    s_mov_b32 s24, s6
    s_and_b32 s25, s7, 0xffff
    s_mov_b32 s26, 0x800000
    s_mov_b32 s27, 0x00020000
    s_mov_b32 s28, s4
    s_and_b32 s29, s5, 0xffff
    s_mov_b32 s30, 0x800000
    s_mov_b32 s31, 0x00020000
    s_lshl_b32 s52, s40, 16
    s_lshl_b32 s53, s42, 12
    s_add_u32 s52, s52, s53
    s_lshl_b32 s53, s43, 10
    s_add_u32 s52, s52, s53
    s_lshl_b32 s53, s51, 9
    s_add_u32 s52, s52, s53
    s_lshl_b32 s53, s50, 7
    s_add_u32 s52, s52, s53
    s_add_u32 s52, s52, 0x7080000
    v_lshlrev_b32 v4, 8, v107
    v_lshl_add_u32 v4, v104, 4, v4
    v_lshrrev_b32 v5, 1, v106
    v_lshl_add_u32 v4, v5, 2, v4
    v_add_u32 v4, s52, v4
    v_mov_b32 v13, -1
    s_xor_b32 s52, s50, 1
    s_lshl_b32 s52, s52, 10
    s_lshl_b32 s53, s51, 8
    s_add_u32 s52, s52, s53
    s_add_u32 s52, s52, 27648
    v_lshrrev_b32 v5, 1, v106
    v_lshlrev_b32 v5, 2, v5
    v_lshl_add_u32 v5, v104, 4, v5
    v_lshl_add_u32 v5, v107, 7, v5
    v_add_u32 v5, s52, v5
    s_lshl_b32 s67, s49, 12
    s_lshl_b32 s53, s43, 10
    s_add_u32 s67, s67, s53
    s_add_u32 s67, s67, 0x1000000
    s_lshl_b32 s52, s40, 2
    s_add_u32 s52, s52, s44
    s_mul_i32 s52, s52, 24576
    s_add_u32 s52, s52, 0x2002000
    v_add_u32 v6, s52, v2
    s_lshl_b32 s52, s40, 16
    s_lshl_b32 s53, s44, 12
    s_add_u32 s52, s52, s53
    s_add_u32 s52, s52, 0x7080000
    v_add_u32 v7, s52, v2
    s_lshl_b32 s52, s44, 10
    s_add_u32 s52, s52, 16384
    v_lshlrev_b32 v8, 8, v101
    v_lshl_add_u32 v8, v106, 4, v8
    v_lshl_add_u32 v8, v107, 3, v8
    v_add_u32 v8, s52, v8
    s_lshl_b32 s52, s44, 8
    s_add_u32 s52, s52, 20480
    v_xor_b32 v9, 1, v103
    v_lshlrev_b32 v9, 7, v9
    v_lshl_add_u32 v9, v106, 4, v9
    v_lshl_add_u32 v9, v102, 3, v9
    v_lshl_add_u32 v9, v107, 2, v9
    v_add_u32 v9, s52, v9
    v_cmp_gt_u32 vcc, 32, v1
    v_mov_b32 v28, 0
    v_mov_b32 v29, 0xff800000
    v_cndmask_b32 v28, v28, v29, vcc
    v_mov_b32 v29, v28
    v_mov_b32 v30, v28
    v_mov_b32 v31, v28
    s_mov_b32 s66, 0x3e0293ee
    s_add_u32 m0, s45, 0
    s_add_u32 s48, s46, 0x0
    buffer_load_dwordx4 v24, s[24:27], s48 offen lds
    s_add_u32 m0, s45, 1024
    s_add_u32 s48, s46, 0x20000
    buffer_load_dwordx4 v24, s[24:27], s48 offen lds
    s_add_u32 m0, s45, 2048
    s_add_u32 s48, s46, 0x40000
    buffer_load_dwordx4 v24, s[24:27], s48 offen lds
    s_add_u32 m0, s45, 3072
    s_add_u32 s48, s46, 0x60000
    buffer_load_dwordx4 v24, s[24:27], s48 offen lds
    s_add_u32 m0, s45, 4096
    s_add_u32 s48, s46, 0x80000
    buffer_load_dwordx4 v24, s[24:27], s48 offen lds
    s_add_u32 m0, s45, 5120
    s_add_u32 s48, s46, 0xa0000
    buffer_load_dwordx4 v24, s[24:27], s48 offen lds
    s_add_u32 m0, s45, 6144
    s_add_u32 s48, s46, 0xc0000
    buffer_load_dwordx4 v24, s[24:27], s48 offen lds
    s_add_u32 m0, s45, 7168
    s_add_u32 s48, s46, 0xe0000
    buffer_load_dwordx4 v24, s[24:27], s48 offen lds
    s_add_u32 m0, s45, 8192
    s_add_u32 s48, s46, 0x100000
    buffer_load_dwordx4 v24, s[24:27], s48 offen lds
    s_add_u32 m0, s45, 9216
    s_add_u32 s48, s46, 0x120000
    buffer_load_dwordx4 v24, s[24:27], s48 offen lds
    s_add_u32 m0, s45, 10240
    s_add_u32 s48, s46, 0x140000
    buffer_load_dwordx4 v24, s[24:27], s48 offen lds
    s_add_u32 m0, s45, 11264
    s_add_u32 s48, s46, 0x160000
    buffer_load_dwordx4 v24, s[24:27], s48 offen lds
    s_add_u32 m0, s45, 12288
    s_add_u32 s48, s46, 0x180000
    buffer_load_dwordx4 v24, s[24:27], s48 offen lds
    s_add_u32 m0, s45, 13312
    s_add_u32 s48, s46, 0x1a0000
    buffer_load_dwordx4 v24, s[24:27], s48 offen lds
    s_add_u32 m0, s45, 14336
    s_add_u32 s48, s46, 0x1c0000
    buffer_load_dwordx4 v24, s[24:27], s48 offen lds
    s_add_u32 m0, s45, 15360
    s_add_u32 s48, s46, 0x1e0000
    buffer_load_dwordx4 v24, s[24:27], s48 offen lds
    s_add_u32 s45, s45, 0x10000
    s_add_u32 m0, s45, 0
    s_add_u32 s48, s46, 0x0
    buffer_load_dwordx4 v24, s[28:31], s48 offen lds
    s_add_u32 m0, s45, 1024
    s_add_u32 s48, s46, 0x20000
    buffer_load_dwordx4 v24, s[28:31], s48 offen lds
    s_add_u32 m0, s45, 2048
    s_add_u32 s48, s46, 0x40000
    buffer_load_dwordx4 v24, s[28:31], s48 offen lds
    s_add_u32 m0, s45, 3072
    s_add_u32 s48, s46, 0x60000
    buffer_load_dwordx4 v24, s[28:31], s48 offen lds
    s_add_u32 m0, s45, 4096
    s_add_u32 s48, s46, 0x80000
    buffer_load_dwordx4 v24, s[28:31], s48 offen lds
    s_add_u32 m0, s45, 5120
    s_add_u32 s48, s46, 0xa0000
    buffer_load_dwordx4 v24, s[28:31], s48 offen lds
    s_add_u32 m0, s45, 6144
    s_add_u32 s48, s46, 0xc0000
    buffer_load_dwordx4 v24, s[28:31], s48 offen lds
    s_add_u32 m0, s45, 7168
    s_add_u32 s48, s46, 0xe0000
    buffer_load_dwordx4 v24, s[28:31], s48 offen lds
    s_add_u32 m0, s45, 8192
    s_add_u32 s48, s46, 0x100000
    buffer_load_dwordx4 v24, s[28:31], s48 offen lds
    s_add_u32 m0, s45, 9216
    s_add_u32 s48, s46, 0x120000
    buffer_load_dwordx4 v24, s[28:31], s48 offen lds
    s_add_u32 m0, s45, 10240
    s_add_u32 s48, s46, 0x140000
    buffer_load_dwordx4 v24, s[28:31], s48 offen lds
    s_add_u32 m0, s45, 11264
    s_add_u32 s48, s46, 0x160000
    buffer_load_dwordx4 v24, s[28:31], s48 offen lds
    s_add_u32 m0, s45, 12288
    s_add_u32 s48, s46, 0x180000
    buffer_load_dwordx4 v24, s[28:31], s48 offen lds
    s_add_u32 m0, s45, 13312
    s_add_u32 s48, s46, 0x1a0000
    buffer_load_dwordx4 v24, s[28:31], s48 offen lds
    s_add_u32 m0, s45, 14336
    s_add_u32 s48, s46, 0x1c0000
    buffer_load_dwordx4 v24, s[28:31], s48 offen lds
    s_add_u32 m0, s45, 15360
    s_add_u32 s48, s46, 0x1e0000
    buffer_load_dwordx4 v24, s[28:31], s48 offen lds
    s_add_u32 s45, s45, 0x10000
    s_waitcnt vmcnt(0)
    s_barrier
    s_cmp_lg_u32 s44, 0
    s_cbranch_scc1 L_zwok_196
    v_and_b32 v16, 7, v1
    v_lshlrev_b32 v16, 5, v16
    s_mov_b32 s70, 0
L_zw_195:
    buffer_load_dword v17, v16, s[16:19], 0 offen sc1
    s_waitcnt vmcnt(0)
    v_add_u32_dpp v17, v17, v17 row_ror:1 row_mask:0xf bank_mask:0xf
    s_nop 1
    v_add_u32_dpp v17, v17, v17 row_ror:2 row_mask:0xf bank_mask:0xf
    s_nop 1
    v_add_u32_dpp v17, v17, v17 row_ror:4 row_mask:0xf bank_mask:0xf
    v_cmp_ne_u32 vcc, 0x100, v17
    s_add_u32 s70, s70, 1
    s_cbranch_vccz L_zwok_196
    s_sleep 4
    s_cmp_lt_u32 s70, 524288
    s_cbranch_scc1 L_zw_195
    s_branch L_c_done_1
L_zwok_196:
    s_cmp_lg_u32 s44, 0
    s_cbranch_scc1 L_c_nr_197
    s_or_b32 s47, s39, 0x100
    v_mov_b32 v16, s47
    s_lshl_b32 s52, s40, 6
    s_lshl_b32 s53, s41, 2
    s_add_u32 s52, s52, s53
    s_add_u32 s52, s52, 0x101000
    v_mov_b32 v17, 0
    s_mov_b64 exec, 1
    buffer_store_dword v16, v17, s[12:15], s52 offen sc1
    s_mov_b64 exec, -1
L_c_nr_197:
    ds_read_b64_tr_b16 a[0:1], v20 offset:0
    ds_read_b64_tr_b16 a[2:3], v20 offset:256
    ds_read_b64_tr_b16 a[4:5], v20 offset:2048
    ds_read_b64_tr_b16 a[6:7], v20 offset:2304
    ds_read_b64_tr_b16 a[8:9], v20 offset:4096
    ds_read_b64_tr_b16 a[10:11], v20 offset:4352
    ds_read_b64_tr_b16 a[12:13], v20 offset:6144
    ds_read_b64_tr_b16 a[14:15], v20 offset:6400
    s_waitcnt lgkmcnt(0)
    ds_read_b64_tr_b16 a[16:17], v20 offset:8192
    ds_read_b64_tr_b16 a[18:19], v20 offset:8448
    ds_read_b64_tr_b16 a[20:21], v20 offset:10240
    ds_read_b64_tr_b16 a[22:23], v20 offset:10496
    ds_read_b64_tr_b16 a[24:25], v20 offset:12288
    ds_read_b64_tr_b16 a[26:27], v20 offset:12544
    ds_read_b64_tr_b16 a[28:29], v20 offset:14336
    ds_read_b64_tr_b16 a[30:31], v20 offset:14592
    s_waitcnt lgkmcnt(0)
    ds_read_b64_tr_b16 a[32:33], v20 offset:16384
    ds_read_b64_tr_b16 a[34:35], v20 offset:16640
    ds_read_b64_tr_b16 a[36:37], v20 offset:18432
    ds_read_b64_tr_b16 a[38:39], v20 offset:18688
    ds_read_b64_tr_b16 a[40:41], v20 offset:20480
    ds_read_b64_tr_b16 a[42:43], v20 offset:20736
    ds_read_b64_tr_b16 a[44:45], v20 offset:22528
    ds_read_b64_tr_b16 a[46:47], v20 offset:22784
    s_waitcnt lgkmcnt(0)
    ds_read_b64_tr_b16 a[48:49], v20 offset:24576
    ds_read_b64_tr_b16 a[50:51], v20 offset:24832
    ds_read_b64_tr_b16 a[52:53], v20 offset:26624
    ds_read_b64_tr_b16 a[54:55], v20 offset:26880
    ds_read_b64_tr_b16 a[56:57], v20 offset:28672
    ds_read_b64_tr_b16 a[58:59], v20 offset:28928
    ds_read_b64_tr_b16 a[60:61], v20 offset:30720
    ds_read_b64_tr_b16 a[62:63], v20 offset:30976
    s_waitcnt lgkmcnt(0)
    ds_read_b64_tr_b16 a[64:65], v20 offset:32768
    ds_read_b64_tr_b16 a[66:67], v20 offset:33024
    ds_read_b64_tr_b16 a[68:69], v20 offset:34816
    ds_read_b64_tr_b16 a[70:71], v20 offset:35072
    ds_read_b64_tr_b16 a[72:73], v20 offset:36864
    ds_read_b64_tr_b16 a[74:75], v20 offset:37120
    ds_read_b64_tr_b16 a[76:77], v20 offset:38912
    ds_read_b64_tr_b16 a[78:79], v20 offset:39168
    s_waitcnt lgkmcnt(0)
    ds_read_b64_tr_b16 a[80:81], v20 offset:40960
    ds_read_b64_tr_b16 a[82:83], v20 offset:41216
    ds_read_b64_tr_b16 a[84:85], v20 offset:43008
    ds_read_b64_tr_b16 a[86:87], v20 offset:43264
    ds_read_b64_tr_b16 a[88:89], v20 offset:45056
    ds_read_b64_tr_b16 a[90:91], v20 offset:45312
    ds_read_b64_tr_b16 a[92:93], v20 offset:47104
    ds_read_b64_tr_b16 a[94:95], v20 offset:47360
    s_waitcnt lgkmcnt(0)
    ds_read_b64_tr_b16 a[96:97], v20 offset:49152
    ds_read_b64_tr_b16 a[98:99], v20 offset:49408
    ds_read_b64_tr_b16 a[100:101], v20 offset:51200
    ds_read_b64_tr_b16 a[102:103], v20 offset:51456
    ds_read_b64_tr_b16 a[104:105], v20 offset:53248
    ds_read_b64_tr_b16 a[106:107], v20 offset:53504
    ds_read_b64_tr_b16 a[108:109], v20 offset:55296
    ds_read_b64_tr_b16 a[110:111], v20 offset:55552
    s_waitcnt lgkmcnt(0)
    ds_read_b64_tr_b16 a[112:113], v20 offset:57344
    ds_read_b64_tr_b16 a[114:115], v20 offset:57600
    ds_read_b64_tr_b16 a[116:117], v20 offset:59392
    ds_read_b64_tr_b16 a[118:119], v20 offset:59648
    ds_read_b64_tr_b16 a[120:121], v20 offset:61440
    ds_read_b64_tr_b16 a[122:123], v20 offset:61696
    ds_read_b64_tr_b16 a[124:125], v20 offset:63488
    ds_read_b64_tr_b16 a[126:127], v20 offset:63744
    s_waitcnt lgkmcnt(0)
    s_mov_b32 s63, 0
    s_barrier
    s_lshl_b32 s52, s44, 13
    s_add_u32 s52, s52, 65536
    v_add_u32 v6, s52, v2
    s_lshl_b32 s52, s40, 2
    s_add_u32 s52, s52, s44
    s_mul_i32 s52, s52, 24576
    s_lshl_b32 s53, s41, 10
    s_add_u32 s52, s52, s53
    s_add_u32 s52, s52, 0x2002000
    v_lshlrev_b32 v14, 7, v106
    v_add_u32 v14, s52, v14
    s_lshl_b32 s58, s40, 11
    s_lshl_b32 s53, s44, 7
    s_add_u32 s58, s58, s53
    s_add_u32 s58, s58, 0x10a600
    s_mov_b32 s69, 0
    s_load_dwordx2 s[4:5], s[0:1], 64
    s_and_b32 s59, s40, 1
    s_lshl_b32 s59, s59, 5
    s_lshl_b32 s53, s41, 1
    s_add_u32 s59, s59, s53
    s_add_u32 s59, s59, s50
    s_mul_i32 s59, s59, 7168
    s_lshr_b32 s53, s40, 1
    s_mul_i32 s53, s53, 1792
    s_add_u32 s59, s59, s53
    s_mul_i32 s53, s51, 896
    s_add_u32 s59, s59, s53
    s_waitcnt lgkmcnt(0)
    s_mov_b32 s24, s4
    s_and_b32 s25, s5, 0xffff
    s_mov_b32 s26, 0x700000
    s_mov_b32 s27, 0x00020000
    s_setprio 1
    s_branch L_c_join_194
L_v_init_193:
    s_sub_u32 s54, s44, 4
    s_lshr_b32 s51, s54, 1
    s_and_b32 s50, s54, 1
    s_load_dwordx4 s[4:7], s[0:1], 32
    s_load_dwordx2 s[8:9], s[0:1], 8
    s_waitcnt lgkmcnt(0)
    s_mov_b32 s24, s4
    s_and_b32 s25, s5, 0xffff
    s_mov_b32 s26, 0x800000
    s_mov_b32 s27, 0x00020000
    s_mov_b32 s28, s6
    s_and_b32 s29, s7, 0xffff
    s_mov_b32 s30, 0x800000
    s_mov_b32 s31, 0x00020000
    s_mov_b32 s32, s8
    s_and_b32 s33, s9, 0xffff
    s_mov_b32 s34, 0x4000
    s_mov_b32 s35, 0x00020000
    s_lshl_b32 s45, s54, 12
    s_add_u32 s45, s45, 0x20000
    v_add_u32 v20, s45, v20
    v_add_u32 v21, s45, v21
    v_add_u32 v22, s45, v2
    s_lshl_b32 s46, s49, 8
    s_lshl_b32 s48, s43, 6
    s_add_u32 s46, s46, s48
    s_lshl_b32 s48, s54, 21
    s_add_u32 s46, s46, s48
    s_add_u32 s48, s46, 0x0
    buffer_load_dwordx4 a[0:3], v24, s[24:27], s48 offen
    s_add_u32 s48, s46, 0x20000
    buffer_load_dwordx4 a[32:35], v24, s[24:27], s48 offen
    s_add_u32 s48, s46, 0x40000
    buffer_load_dwordx4 a[4:7], v24, s[24:27], s48 offen
    s_add_u32 s48, s46, 0x60000
    buffer_load_dwordx4 a[36:39], v24, s[24:27], s48 offen
    s_add_u32 s48, s46, 0x80000
    buffer_load_dwordx4 a[8:11], v24, s[24:27], s48 offen
    s_add_u32 s48, s46, 0xa0000
    buffer_load_dwordx4 a[40:43], v24, s[24:27], s48 offen
    s_add_u32 s48, s46, 0xc0000
    buffer_load_dwordx4 a[12:15], v24, s[24:27], s48 offen
    s_add_u32 s48, s46, 0xe0000
    buffer_load_dwordx4 a[44:47], v24, s[24:27], s48 offen
    s_add_u32 s48, s46, 0x100000
    buffer_load_dwordx4 a[16:19], v24, s[24:27], s48 offen
    s_add_u32 s48, s46, 0x120000
    buffer_load_dwordx4 a[48:51], v24, s[24:27], s48 offen
    s_add_u32 s48, s46, 0x140000
    buffer_load_dwordx4 a[20:23], v24, s[24:27], s48 offen
    s_add_u32 s48, s46, 0x160000
    buffer_load_dwordx4 a[52:55], v24, s[24:27], s48 offen
    s_add_u32 s48, s46, 0x180000
    buffer_load_dwordx4 a[24:27], v24, s[24:27], s48 offen
    s_add_u32 s48, s46, 0x1a0000
    buffer_load_dwordx4 a[56:59], v24, s[24:27], s48 offen
    s_add_u32 s48, s46, 0x1c0000
    buffer_load_dwordx4 a[28:31], v24, s[24:27], s48 offen
    s_add_u32 s48, s46, 0x1e0000
    buffer_load_dwordx4 a[60:63], v24, s[24:27], s48 offen
    s_lshl_b32 s52, s40, 15
    s_lshl_b32 s53, s42, 11
    s_add_u32 s52, s52, s53
    s_lshl_b32 s53, s43, 9
    s_add_u32 s52, s52, s53
    s_lshl_b32 s53, s51, 8
    s_add_u32 s52, s52, s53
    s_add_u32 s52, s52, 0x7100000
    v_bfe_u32 v4, v1, 1, 1
    v_lshlrev_b32 v4, 7, v4
    v_lshl_add_u32 v4, v104, 4, v4
    v_and_b32 v5, 12, v100
    v_add_u32 v4, v4, v5
    v_add_u32 v4, s52, v4
    v_mov_b32 v26, -1
    s_lshl_b32 s52, s51, 5
    s_add_u32 s52, s52, 28160
    v_and_b32 v5, 14, v100
    v_lshlrev_b32 v5, 1, v5
    v_lshl_add_u32 v5, v104, 6, v5
    v_add_u32 v5, s52, v5
    s_lshl_b32 s52, s41, 13
    s_lshl_b32 s53, s54, 11
    s_add_u32 s52, s52, s53
    s_add_u32 s52, s52, 0x7800000
    v_lshlrev_b32 v6, 3, v101
    v_lshl_add_u32 v6, v106, 5, v6
    v_and_b32 v7, 3, v1
    v_lshlrev_b32 v7, 3, v7
    v_bfe_u32 v30, v1, 2, 3
    v_lshl_add_u32 v7, v30, 5, v7
    v_lshl_add_u32 v7, v103, 2, v7
    v_add_u32 v7, s52, v7
    s_lshl_b32 s53, s40, 8
    s_add_u32 s52, s52, s53
    v_add_u32 v6, s52, v6
    v_lshlrev_b32 v30, 4, v100
    v_lshl_add_u32 v30, v101, 17, v30
    v_add_u32 v30, s52, v30
    v_mov_b32 v32, -1
    v_mov_b32 v33, -1
    v_mov_b32 v34, -1
    v_mov_b32 v35, -1
    buffer_store_dwordx4 v[32:35], v30, s[12:15], 0 offen sc1
    s_lshl_b32 s55, s40, 16
    s_add_u32 s55, s55, 0x7000000
    s_lshl_b32 s52, s41, 10
    s_lshl_b32 s53, s54, 8
    s_add_u32 s52, s52, s53
    s_add_u32 s52, s52, s55
    v_lshlrev_b32 v8, 2, v1
    v_add_u32 v8, s52, v8
    s_lshl_b32 s53, s54, 12
    v_add_u32 v10, s53, v2
    v_add_u32 v9, s55, v10
    s_lshl_b32 s52, s40, 15
    s_lshl_b32 s53, s54, 11
    s_add_u32 s52, s52, s53
    s_add_u32 s52, s52, 0x7100000
    v_add_u32 v11, s52, v2
    s_lshl_b32 s52, s54, 9
    s_add_u32 s52, s52, 53248
    v_lshlrev_b32 v12, 4, v100
    v_lshl_add_u32 v12, v102, 3, v12
    v_lshl_add_u32 v12, v103, 8, v12
    v_add_u32 v12, s52, v12
    s_lshl_b32 s52, s51, 3
    s_add_u32 s52, s52, 49152
    v_add_u32 v13, s52, v2
    s_lshl_b32 s52, s54, 10
    s_add_u32 s52, s52, 49152
    v_add_u32 v14, s52, v2
    s_lshl_b32 s52, s40, 2
    s_add_u32 s52, s52, s54
    s_mul_i32 s52, s52, 24576
    s_add_u32 s52, s52, 0x2004000
    v_add_u32 v15, s52, v2
    s_lshl_b32 s52, s54, 10
    v_add_u32 v27, s52, v2
    v_lshlrev_b32 v30, 11, v106
    v_lshl_add_u32 v30, v101, 5, v30
    v_lshl_add_u32 v30, v107, 2, v30
    s_lshl_b32 s52, s54, 9
    buffer_load_dword v112, v30, s[32:35], s52 offen offset:0
    buffer_load_dword v113, v30, s[32:35], s52 offen offset:8
    buffer_load_dword v114, v30, s[32:35], s52 offen offset:16
    buffer_load_dword v115, v30, s[32:35], s52 offen offset:24
    buffer_load_dword v116, v30, s[32:35], s52 offen offset:128
    buffer_load_dword v117, v30, s[32:35], s52 offen offset:136
    buffer_load_dword v118, v30, s[32:35], s52 offen offset:144
    buffer_load_dword v119, v30, s[32:35], s52 offen offset:152
    buffer_load_dword v120, v30, s[32:35], s52 offen offset:256
    buffer_load_dword v121, v30, s[32:35], s52 offen offset:264
    buffer_load_dword v122, v30, s[32:35], s52 offen offset:272
    buffer_load_dword v123, v30, s[32:35], s52 offen offset:280
    buffer_load_dword v124, v30, s[32:35], s52 offen offset:384
    buffer_load_dword v125, v30, s[32:35], s52 offen offset:392
    buffer_load_dword v126, v30, s[32:35], s52 offen offset:400
    buffer_load_dword v127, v30, s[32:35], s52 offen offset:408
    s_lshl_b32 s46, s40, 2
    s_add_u32 s46, s46, s54
    s_lshl_b32 s46, s46, 18
    s_lshl_b32 s48, s41, 7
    s_add_u32 s46, s46, s48
    s_add_u32 s48, s46, 0x0
    buffer_load_dwordx4 a[64:67], v25, s[28:31], s48 offen
    s_add_u32 s48, s46, 0x4000
    buffer_load_dwordx4 a[80:83], v25, s[28:31], s48 offen
    s_add_u32 s48, s46, 0x8000
    buffer_load_dwordx4 a[96:99], v25, s[28:31], s48 offen
    s_add_u32 s48, s46, 0xc000
    buffer_load_dwordx4 a[112:115], v25, s[28:31], s48 offen
    s_add_u32 s48, s46, 0x10000
    buffer_load_dwordx4 a[68:71], v25, s[28:31], s48 offen
    s_add_u32 s48, s46, 0x14000
    buffer_load_dwordx4 a[84:87], v25, s[28:31], s48 offen
    s_add_u32 s48, s46, 0x18000
    buffer_load_dwordx4 a[100:103], v25, s[28:31], s48 offen
    s_add_u32 s48, s46, 0x1c000
    buffer_load_dwordx4 a[116:119], v25, s[28:31], s48 offen
    s_add_u32 s48, s46, 0x20000
    buffer_load_dwordx4 a[72:75], v25, s[28:31], s48 offen
    s_add_u32 s48, s46, 0x24000
    buffer_load_dwordx4 a[88:91], v25, s[28:31], s48 offen
    s_add_u32 s48, s46, 0x28000
    buffer_load_dwordx4 a[104:107], v25, s[28:31], s48 offen
    s_add_u32 s48, s46, 0x2c000
    buffer_load_dwordx4 a[120:123], v25, s[28:31], s48 offen
    s_add_u32 s48, s46, 0x30000
    buffer_load_dwordx4 a[76:79], v25, s[28:31], s48 offen
    s_add_u32 s48, s46, 0x34000
    buffer_load_dwordx4 a[92:95], v25, s[28:31], s48 offen
    s_add_u32 s48, s46, 0x38000
    buffer_load_dwordx4 a[108:111], v25, s[28:31], s48 offen
    s_add_u32 s48, s46, 0x3c000
    buffer_load_dwordx4 a[124:127], v25, s[28:31], s48 offen
    s_waitcnt vmcnt(16)
    ds_write_b128 v22, a[0:3] offset:0
    ds_write_b128 v22, a[32:35] offset:1024
    ds_write_b128 v22, a[4:7] offset:2048
    ds_write_b128 v22, a[36:39] offset:3072
    s_waitcnt lgkmcnt(0)
    ds_read_b64_tr_b16 a[0:1], v20 offset:0
    ds_read_b64_tr_b16 a[2:3], v20 offset:256
    ds_read_b64_tr_b16 a[32:33], v20 offset:32
    ds_read_b64_tr_b16 a[34:35], v20 offset:288
    ds_read_b64_tr_b16 a[4:5], v20 offset:2048
    ds_read_b64_tr_b16 a[6:7], v20 offset:2304
    ds_read_b64_tr_b16 a[36:37], v20 offset:2080
    ds_read_b64_tr_b16 a[38:39], v20 offset:2336
    s_waitcnt lgkmcnt(0)
    ds_write_b128 v22, a[8:11] offset:0
    ds_write_b128 v22, a[40:43] offset:1024
    ds_write_b128 v22, a[12:15] offset:2048
    ds_write_b128 v22, a[44:47] offset:3072
    s_waitcnt lgkmcnt(0)
    ds_read_b64_tr_b16 a[8:9], v20 offset:0
    ds_read_b64_tr_b16 a[10:11], v20 offset:256
    ds_read_b64_tr_b16 a[40:41], v20 offset:32
    ds_read_b64_tr_b16 a[42:43], v20 offset:288
    ds_read_b64_tr_b16 a[12:13], v20 offset:2048
    ds_read_b64_tr_b16 a[14:15], v20 offset:2304
    ds_read_b64_tr_b16 a[44:45], v20 offset:2080
    ds_read_b64_tr_b16 a[46:47], v20 offset:2336
    s_waitcnt lgkmcnt(0)
    ds_write_b128 v22, a[16:19] offset:0
    ds_write_b128 v22, a[48:51] offset:1024
    ds_write_b128 v22, a[20:23] offset:2048
    ds_write_b128 v22, a[52:55] offset:3072
    s_waitcnt lgkmcnt(0)
    ds_read_b64_tr_b16 a[16:17], v20 offset:0
    ds_read_b64_tr_b16 a[18:19], v20 offset:256
    ds_read_b64_tr_b16 a[48:49], v20 offset:32
    ds_read_b64_tr_b16 a[50:51], v20 offset:288
    ds_read_b64_tr_b16 a[20:21], v20 offset:2048
    ds_read_b64_tr_b16 a[22:23], v20 offset:2304
    ds_read_b64_tr_b16 a[52:53], v20 offset:2080
    ds_read_b64_tr_b16 a[54:55], v20 offset:2336
    s_waitcnt lgkmcnt(0)
    ds_write_b128 v22, a[24:27] offset:0
    ds_write_b128 v22, a[56:59] offset:1024
    ds_write_b128 v22, a[28:31] offset:2048
    ds_write_b128 v22, a[60:63] offset:3072
    s_waitcnt lgkmcnt(0)
    ds_read_b64_tr_b16 a[24:25], v20 offset:0
    ds_read_b64_tr_b16 a[26:27], v20 offset:256
    ds_read_b64_tr_b16 a[56:57], v20 offset:32
    ds_read_b64_tr_b16 a[58:59], v20 offset:288
    ds_read_b64_tr_b16 a[28:29], v20 offset:2048
    ds_read_b64_tr_b16 a[30:31], v20 offset:2304
    ds_read_b64_tr_b16 a[60:61], v20 offset:2080
    ds_read_b64_tr_b16 a[62:63], v20 offset:2336
    s_waitcnt lgkmcnt(0)
    s_barrier
    s_waitcnt vmcnt(0)
    ds_write_b128 v22, a[64:67] offset:0
    ds_write_b128 v22, a[80:83] offset:1024
    ds_write_b128 v22, a[96:99] offset:2048
    ds_write_b128 v22, a[112:115] offset:3072
    s_waitcnt lgkmcnt(0)
    ds_read_b64_tr_b16 a[64:65], v21 offset:0
    ds_read_b64_tr_b16 a[66:67], v21 offset:512
    ds_read_b64_tr_b16 a[80:81], v21 offset:32
    ds_read_b64_tr_b16 a[82:83], v21 offset:544
    ds_read_b64_tr_b16 a[96:97], v21 offset:64
    ds_read_b64_tr_b16 a[98:99], v21 offset:576
    ds_read_b64_tr_b16 a[112:113], v21 offset:96
    ds_read_b64_tr_b16 a[114:115], v21 offset:608
    s_waitcnt lgkmcnt(0)
    ds_write_b128 v22, a[68:71] offset:0
    ds_write_b128 v22, a[84:87] offset:1024
    ds_write_b128 v22, a[100:103] offset:2048
    ds_write_b128 v22, a[116:119] offset:3072
    s_waitcnt lgkmcnt(0)
    ds_read_b64_tr_b16 a[68:69], v21 offset:0
    ds_read_b64_tr_b16 a[70:71], v21 offset:512
    ds_read_b64_tr_b16 a[84:85], v21 offset:32
    ds_read_b64_tr_b16 a[86:87], v21 offset:544
    ds_read_b64_tr_b16 a[100:101], v21 offset:64
    ds_read_b64_tr_b16 a[102:103], v21 offset:576
    ds_read_b64_tr_b16 a[116:117], v21 offset:96
    ds_read_b64_tr_b16 a[118:119], v21 offset:608
    s_waitcnt lgkmcnt(0)
    ds_write_b128 v22, a[72:75] offset:0
    ds_write_b128 v22, a[88:91] offset:1024
    ds_write_b128 v22, a[104:107] offset:2048
    ds_write_b128 v22, a[120:123] offset:3072
    s_waitcnt lgkmcnt(0)
    ds_read_b64_tr_b16 a[72:73], v21 offset:0
    ds_read_b64_tr_b16 a[74:75], v21 offset:512
    ds_read_b64_tr_b16 a[88:89], v21 offset:32
    ds_read_b64_tr_b16 a[90:91], v21 offset:544
    ds_read_b64_tr_b16 a[104:105], v21 offset:64
    ds_read_b64_tr_b16 a[106:107], v21 offset:576
    ds_read_b64_tr_b16 a[120:121], v21 offset:96
    ds_read_b64_tr_b16 a[122:123], v21 offset:608
    s_waitcnt lgkmcnt(0)
    ds_write_b128 v22, a[76:79] offset:0
    ds_write_b128 v22, a[92:95] offset:1024
    ds_write_b128 v22, a[108:111] offset:2048
    ds_write_b128 v22, a[124:127] offset:3072
    s_waitcnt lgkmcnt(0)
    ds_read_b64_tr_b16 a[76:77], v21 offset:0
    ds_read_b64_tr_b16 a[78:79], v21 offset:512
    ds_read_b64_tr_b16 a[92:93], v21 offset:32
    ds_read_b64_tr_b16 a[94:95], v21 offset:544
    ds_read_b64_tr_b16 a[108:109], v21 offset:64
    ds_read_b64_tr_b16 a[110:111], v21 offset:576
    ds_read_b64_tr_b16 a[124:125], v21 offset:96
    ds_read_b64_tr_b16 a[126:127], v21 offset:608
    s_waitcnt lgkmcnt(0)
    s_mov_b32 s65, 0
    s_waitcnt vmcnt(0)
    s_barrier
    s_lshl_b32 s57, s40, 11
    s_lshl_b32 s53, s54, 7
    s_add_u32 s57, s57, s53
    s_add_u32 s57, s57, 0x10a600
    s_mov_b32 s69, 0
    s_mov_b32 s68, 0
    s_cmp_gt_u32 s69, s68
    s_cbranch_scc1 L_kv_ok_199
    s_mov_b32 s70, 0
L_kv_lp_198:
    v_and_b32 v22, 1, v1
    v_lshlrev_b32 v22, 9, v22
    buffer_load_dword v23, v22, s[12:15], s57 offen sc1
    s_waitcnt vmcnt(0)
    v_readlane_b32 s69, v23, 0
    v_readlane_b32 s45, v23, 1
    s_add_u32 s70, s70, 1
    s_nop 2
    s_min_u32 s69, s69, s45
    s_cmp_gt_u32 s69, s68
    s_cbranch_scc1 L_kv_ok_199
    s_sleep 4
    s_cmp_lt_u32 s70, 524288
    s_cbranch_scc1 L_kv_lp_198
    s_branch L_c_done_1
L_kv_ok_199:
    v_subrev_u32 v28, 8192, v15
    v_lshlrev_b32 v31, 4, v100
    v_lshl_add_u32 v31, v103, 8, v31
    v_add_u32 v31, 20480, v31
    s_lshl_b32 s52, s54, 11
    s_add_u32 s52, s52, 53248
    v_add_u32 v25, s52, v2
    v_mov_b32 v29, 26640
    v_mov_b32 v30, 0
    ds_write_b32 v29, v30
    v_mov_b32 v30, 1
    s_mov_b32 s58, 0
    s_mov_b32 s64, 0
    s_lshl_b32 s59, s54, 13
    s_add_u32 s59, s59, 65536
    s_add_u32 s46, s64, 4096
    s_add_u32 m0, s59, 0
    s_nop 0
    buffer_load_dwordx4 v28, s[12:15], s64 offen offset:0 sc1 lds
    buffer_load_dwordx4 v28, s[12:15], s64 offen offset:1024 sc1 lds
    buffer_load_dwordx4 v28, s[12:15], s64 offen offset:2048 sc1 lds
    buffer_load_dwordx4 v28, s[12:15], s64 offen offset:3072 sc1 lds
    s_add_u32 m0, s59, 4096
    s_nop 0
    buffer_load_dwordx4 v28, s[12:15], s46 offen offset:0 sc1 lds
    buffer_load_dwordx4 v28, s[12:15], s46 offen offset:1024 sc1 lds
    buffer_load_dwordx4 v28, s[12:15], s46 offen offset:2048 sc1 lds
    buffer_load_dwordx4 v28, s[12:15], s46 offen offset:3072 sc1 lds
    s_add_u32 s64, s64, 786432
    s_add_u32 s46, s65, 4096
    buffer_load_dwordx4 v[32:35], v15, s[12:15], s65 offen offset:0 sc1
    buffer_load_dwordx4 v[48:51], v15, s[12:15], s46 offen offset:0 sc1
    buffer_load_dwordx4 v[36:39], v15, s[12:15], s65 offen offset:1024 sc1
    buffer_load_dwordx4 v[52:55], v15, s[12:15], s46 offen offset:1024 sc1
    buffer_load_dwordx4 v[40:43], v15, s[12:15], s65 offen offset:2048 sc1
    buffer_load_dwordx4 v[56:59], v15, s[12:15], s46 offen offset:2048 sc1
    buffer_load_dwordx4 v[44:47], v15, s[12:15], s65 offen offset:3072 sc1
    buffer_load_dwordx4 v[60:63], v15, s[12:15], s46 offen offset:3072 sc1
    s_add_u32 s65, s65, 786432
    s_waitcnt vmcnt(0)
    v_mfma_f32_16x16x32_bf16 v[64:67], v[32:35], a[64:67], 0
    v_mfma_f32_16x16x32_bf16 v[68:71], v[48:51], a[64:67], 0
    v_mfma_f32_16x16x32_bf16 v[64:67], v[36:39], a[68:71], v[64:67]
    v_mfma_f32_16x16x32_bf16 v[68:71], v[52:55], a[68:71], v[68:71]
    v_mfma_f32_16x16x32_bf16 v[64:67], v[40:43], a[72:75], v[64:67]
    v_mfma_f32_16x16x32_bf16 v[68:71], v[56:59], a[72:75], v[68:71]
    v_mfma_f32_16x16x32_bf16 v[64:67], v[44:47], a[76:79], v[64:67]
    v_mfma_f32_16x16x32_bf16 v[68:71], v[60:63], a[76:79], v[68:71]
    v_mfma_f32_16x16x32_bf16 v[72:75], v[32:35], a[80:83], 0
    v_mfma_f32_16x16x32_bf16 v[76:79], v[48:51], a[80:83], 0
    v_mfma_f32_16x16x32_bf16 v[72:75], v[36:39], a[84:87], v[72:75]
    v_mfma_f32_16x16x32_bf16 v[76:79], v[52:55], a[84:87], v[76:79]
    v_mfma_f32_16x16x32_bf16 v[72:75], v[40:43], a[88:91], v[72:75]
    v_mfma_f32_16x16x32_bf16 v[76:79], v[56:59], a[88:91], v[76:79]
    v_mfma_f32_16x16x32_bf16 v[72:75], v[44:47], a[92:95], v[72:75]
    v_mfma_f32_16x16x32_bf16 v[76:79], v[60:63], a[92:95], v[76:79]
    v_cvt_pk_bf16_f32 v64, v64, v65
    v_cvt_pk_bf16_f32 v65, v66, v67
    v_cvt_pk_bf16_f32 v66, v68, v69
    v_cvt_pk_bf16_f32 v67, v70, v71
    ds_write_b128 v10, v[64:67] offset:32768
    v_mfma_f32_16x16x32_bf16 v[80:83], v[32:35], a[96:99], 0
    v_mfma_f32_16x16x32_bf16 v[84:87], v[48:51], a[96:99], 0
    v_mfma_f32_16x16x32_bf16 v[80:83], v[36:39], a[100:103], v[80:83]
    v_mfma_f32_16x16x32_bf16 v[84:87], v[52:55], a[100:103], v[84:87]
    v_mfma_f32_16x16x32_bf16 v[80:83], v[40:43], a[104:107], v[80:83]
    v_mfma_f32_16x16x32_bf16 v[84:87], v[56:59], a[104:107], v[84:87]
    v_mfma_f32_16x16x32_bf16 v[80:83], v[44:47], a[108:111], v[80:83]
    v_mfma_f32_16x16x32_bf16 v[84:87], v[60:63], a[108:111], v[84:87]
    v_cvt_pk_bf16_f32 v72, v72, v73
    v_cvt_pk_bf16_f32 v73, v74, v75
    v_cvt_pk_bf16_f32 v74, v76, v77
    v_cvt_pk_bf16_f32 v75, v78, v79
    ds_write_b128 v10, v[72:75] offset:33792
    v_mfma_f32_16x16x32_bf16 v[88:91], v[32:35], a[112:115], 0
    v_mfma_f32_16x16x32_bf16 v[92:95], v[48:51], a[112:115], 0
    v_mfma_f32_16x16x32_bf16 v[88:91], v[36:39], a[116:119], v[88:91]
    v_mfma_f32_16x16x32_bf16 v[92:95], v[52:55], a[116:119], v[92:95]
    v_mfma_f32_16x16x32_bf16 v[88:91], v[40:43], a[120:123], v[88:91]
    v_mfma_f32_16x16x32_bf16 v[92:95], v[56:59], a[120:123], v[92:95]
    v_mfma_f32_16x16x32_bf16 v[88:91], v[44:47], a[124:127], v[88:91]
    v_mfma_f32_16x16x32_bf16 v[92:95], v[60:63], a[124:127], v[92:95]
    v_cvt_pk_bf16_f32 v80, v80, v81
    v_cvt_pk_bf16_f32 v81, v82, v83
    v_cvt_pk_bf16_f32 v82, v84, v85
    v_cvt_pk_bf16_f32 v83, v86, v87
    ds_write_b128 v10, v[80:83] offset:34816
    s_nop 2
    v_cvt_pk_bf16_f32 v88, v88, v89
    v_cvt_pk_bf16_f32 v89, v90, v91
    v_cvt_pk_bf16_f32 v90, v92, v93
    v_cvt_pk_bf16_f32 v91, v94, v95
    ds_write_b128 v10, v[88:91] offset:35840
    s_mov_b32 s63, 0
    s_waitcnt lgkmcnt(0)
    v_min_u32 v64, -2, v112
    v_min_u32 v65, -2, v113
    v_min_u32 v66, -2, v114
    v_min_u32 v67, -2, v115
    v_min_u32 v68, -2, v116
    v_min_u32 v69, -2, v117
    v_min_u32 v70, -2, v118
    v_min_u32 v71, -2, v119
    v_min_u32 v72, -2, v120
    v_min_u32 v73, -2, v121
    v_min_u32 v74, -2, v122
    v_min_u32 v75, -2, v123
    v_min_u32 v76, -2, v124
    v_min_u32 v77, -2, v125
    v_min_u32 v78, -2, v126
    v_min_u32 v79, -2, v127
    v_mov_b32 v16, 0
    v_mov_b32 v17, 0
    v_mov_b32 v18, 0
    v_mov_b32 v19, 0
    v_mov_b32 v20, 0
    v_mov_b32 v21, 0
    v_mov_b32 v22, 0
    v_mov_b32 v23, 0
L_c_join_194:
    s_mov_b32 s60, 0
    s_mov_b32 s61, 0
    s_mov_b32 s62, 0
    s_cmp_lg_u32 s44, 0
    s_cbranch_scc1 L_c_nh_200
    v_lshlrev_b32 v17, 3, v1
    s_lshl_b32 s46, s40, 3
    v_mov_b32 v21, s46
    s_mov_b32 s45, 0x101000
    s_mov_b32 s70, 0
L_c_rp_201:
    buffer_load_dwordx2 v[18:19], v17, s[12:15], s45 offen sc1
    buffer_load_dwordx2 v[22:23], v21, s[12:15], s45 offen offset:512 sc1
    s_waitcnt vmcnt(0)
    v_min3_u32 v20, v18, v19, v22
    v_min_u32 v20, v20, v23
    v_cmp_eq_u32 vcc, 0, v20
    s_cbranch_vccnz L_rt_202
    v_cmp_eq_u32 s[52:53], v18, v16
    v_cmp_eq_u32 vcc, v19, v16
    v_cmp_eq_u32 s[54:55], v22, v16
    v_cmp_eq_u32 s[56:57], v23, v16
    s_lshl_b32 s46, s40, 3
    s_nop 3
    s_and_b64 s[52:53], s[52:53], vcc
    s_lshr_b64 s[52:53], s[52:53], s46
    s_and_b32 s52, s52, 0xff
    s_cmp_eq_u32 s52, 0xff
    s_cselect_b32 s52, 1, 0
    v_mov_b32 v16, s52
    v_mov_b32 v17, 26624
    ds_write_b32 v17, v16
L_c_nh_200:
    s_waitcnt lgkmcnt(0)
    s_barrier
    v_mov_b32 v17, 26624
    ds_read_b32 v16, v17
    s_waitcnt lgkmcnt(0)
    v_readfirstlane_b32 s52, v16
    s_nop 3
    s_cmp_ge_u32 s44, 4
    s_cbranch_scc1 L_vf_205
    s_mov_b32 s57, s58
    s_cmp_eq_u32 s52, 0
    s_cbranch_scc1 L_ss_204
.p2align 6
L_s_loop_207:
    v_mov_b32 v16, 0
    v_mov_b32 v17, 0
    v_mov_b32 v18, 0
    v_mov_b32 v19, 0
    s_barrier
    ds_read_b128 v[64:67], v2 offset:0
    ds_read_b128 v[68:71], v2 offset:1024
    ds_read_b128 v[72:75], v2 offset:2048
    ds_read_b128 v[76:79], v2 offset:3072
    ds_read_b128 v[80:83], v2 offset:4096
    ds_read_b128 v[84:87], v2 offset:5120
    ds_read_b128 v[88:91], v2 offset:6144
    ds_read_b128 v[92:95], v2 offset:7168
    ds_read_b128 v[96:99], v2 offset:8192
    ds_read_b128 v[100:103], v2 offset:9216
    ds_read_b128 v[104:107], v2 offset:10240
    ds_read_b128 v[108:111], v2 offset:11264
    s_waitcnt lgkmcnt(11)
    v_smfmac_f32_16x16x64_bf16 v[16:19], v[64:67], a[0:7], v3
    ds_read_b128 v[112:115], v2 offset:12288
    s_waitcnt lgkmcnt(11)
    v_smfmac_f32_16x16x64_bf16 v[16:19], v[68:71], a[8:15], v3
    ds_read_b128 v[116:119], v2 offset:13312
    s_waitcnt lgkmcnt(11)
    v_smfmac_f32_16x16x64_bf16 v[16:19], v[72:75], a[16:23], v3
    ds_read_b128 v[120:123], v2 offset:14336
    s_waitcnt lgkmcnt(11)
    v_smfmac_f32_16x16x64_bf16 v[16:19], v[76:79], a[24:31], v3
    ds_read_b128 v[124:127], v2 offset:15360
    s_waitcnt lgkmcnt(11)
    v_smfmac_f32_16x16x64_bf16 v[16:19], v[80:83], a[32:39], v3
    s_waitcnt lgkmcnt(10)
    v_smfmac_f32_16x16x64_bf16 v[16:19], v[84:87], a[40:47], v3
    s_waitcnt lgkmcnt(9)
    v_smfmac_f32_16x16x64_bf16 v[16:19], v[88:91], a[48:55], v3
    s_waitcnt lgkmcnt(8)
    v_smfmac_f32_16x16x64_bf16 v[16:19], v[92:95], a[56:63], v3
    s_waitcnt lgkmcnt(7)
    v_smfmac_f32_16x16x64_bf16 v[16:19], v[96:99], a[64:71], v3
    s_waitcnt lgkmcnt(6)
    v_smfmac_f32_16x16x64_bf16 v[16:19], v[100:103], a[72:79], v3
    s_waitcnt lgkmcnt(5)
    v_smfmac_f32_16x16x64_bf16 v[16:19], v[104:107], a[80:87], v3
    s_waitcnt lgkmcnt(4)
    v_smfmac_f32_16x16x64_bf16 v[16:19], v[108:111], a[88:95], v3
    s_waitcnt lgkmcnt(3)
    v_smfmac_f32_16x16x64_bf16 v[16:19], v[112:115], a[96:103], v3
    s_waitcnt lgkmcnt(2)
    v_smfmac_f32_16x16x64_bf16 v[16:19], v[116:119], a[104:111], v3
    s_waitcnt lgkmcnt(1)
    v_smfmac_f32_16x16x64_bf16 v[16:19], v[120:123], a[112:119], v3
    s_waitcnt lgkmcnt(0)
    v_smfmac_f32_16x16x64_bf16 v[16:19], v[124:127], a[120:127], v3
    s_nop 7
    v_permlane32_swap_b32 v16, v18
    v_permlane32_swap_b32 v17, v19
    v_add_f32 v16, v16, v18
    v_add_f32 v17, v17, v19
    s_mov_b32 vcc_lo, 0x55555555
    s_mov_b32 vcc_hi, 0x55555555
    v_cndmask_b32_dpp v18, v17, v16, vcc quad_perm:[1,0,3,2] row_mask:0xf bank_mask:0xf
    s_not_b64 vcc, vcc
    v_cndmask_b32_dpp v19, v16, v17, vcc quad_perm:[1,0,3,2] row_mask:0xf bank_mask:0xf
    v_cvt_pk_bf16_f32 v18, v18, v19
    v_min_u32 v18, -2, v18
    buffer_store_dword v18, v4, s[12:15], s61 offen
    ds_write_b32 v5, v18
    s_cmp_eq_u32 s60, 63
    s_cbranch_scc1 L_s_last_208
    ds_read_b128 v[32:35], v6 offset:0
    ds_read_b128 v[36:39], v6 offset:1024
    ds_read_b128 v[40:43], v6 offset:2048
    ds_read_b128 v[44:47], v6 offset:3072
    ds_read_b128 v[48:51], v6 offset:4096
    ds_read_b128 v[52:55], v6 offset:5120
    ds_read_b128 v[56:59], v6 offset:6144
    ds_read_b128 v[60:63], v6 offset:7168
    s_sleep 5
    s_mov_b32 s70, 1
    buffer_load_dwordx4 v[64:67], v7, s[12:15], s61 offen offset:0 sc1
    buffer_load_dwordx4 v[68:71], v7, s[12:15], s61 offen offset:1024 sc1
    buffer_load_dwordx4 v[72:75], v7, s[12:15], s61 offen offset:2048 sc1
    buffer_load_dwordx4 v[76:79], v7, s[12:15], s61 offen offset:3072 sc1
L_s_xm_210:
    s_waitcnt lgkmcnt(0)
    s_waitcnt vmcnt(3)
    v_mfma_f32_16x16x32_bf16 v[20:23], v[48:51], v[64:67], 0
    v_mfma_f32_16x16x32_bf16 v[16:19], v[32:35], v[64:67], 0
    v_mfma_f32_16x16x32_bf16 v[24:27], v[64:67], v[64:67], v[28:31]
    v_max3_u32 v10, v64, v64, v65
    v_max3_u32 v10, v10, v66, v67
    s_waitcnt vmcnt(2)
    v_mfma_f32_16x16x32_bf16 v[20:23], v[52:55], v[68:71], v[20:23]
    v_mfma_f32_16x16x32_bf16 v[16:19], v[36:39], v[68:71], v[16:19]
    v_mfma_f32_16x16x32_bf16 v[24:27], v[68:71], v[68:71], v[24:27]
    v_max3_u32 v10, v10, v68, v69
    v_max3_u32 v10, v10, v70, v71
    s_waitcnt vmcnt(1)
    v_mfma_f32_16x16x32_bf16 v[20:23], v[56:59], v[72:75], v[20:23]
    v_mfma_f32_16x16x32_bf16 v[16:19], v[40:43], v[72:75], v[16:19]
    v_mfma_f32_16x16x32_bf16 v[24:27], v[72:75], v[72:75], v[24:27]
    v_max3_u32 v10, v10, v72, v73
    v_max3_u32 v10, v10, v74, v75
    s_waitcnt vmcnt(0)
    v_mfma_f32_16x16x32_bf16 v[20:23], v[60:63], v[76:79], v[20:23]
    v_mfma_f32_16x16x32_bf16 v[16:19], v[44:47], v[76:79], v[16:19]
    v_mfma_f32_16x16x32_bf16 v[24:27], v[76:79], v[76:79], v[24:27]
    v_max3_u32 v10, v10, v76, v77
    v_max3_u32 v10, v10, v78, v79
    v_cmp_eq_u32 vcc, -1, v10
    s_nop 2
    s_cbranch_vccnz L_rt_211
    v_mov_b32_dpp v16, v20 row_ror:8 row_mask:0xf bank_mask:0xc
    v_mov_b32_dpp v17, v21 row_ror:8 row_mask:0xf bank_mask:0xc
    v_mov_b32_dpp v18, v22 row_ror:8 row_mask:0xf bank_mask:0xc
    v_mov_b32_dpp v19, v23 row_ror:8 row_mask:0xf bank_mask:0xc
    v_mov_b32_dpp v24, v26 row_ror:8 row_mask:0xf bank_mask:0xc
    v_mov_b32_dpp v25, v27 row_ror:8 row_mask:0xf bank_mask:0xc
    v_max3_f32 v10, v16, v17, v18
    v_max3_f32 v10, v10, v19, v24
    v_max_f32 v10, v10, v25
    s_nop 1
    v_max_f32_dpp v11, v10, v10 row_ror:8 row_mask:0xf bank_mask:0xf
    v_max_f32_dpp v10, v10, v10 row_ror:8 row_mask:0xf bank_mask:0xf
    s_nop 1
    v_permlane16_swap_b32 v10, v11
    v_max_f32 v12, v10, v11
    v_max_f32 v10, v10, v11
    s_nop 1
    v_permlane32_swap_b32 v10, v12
    v_max_f32 v10, v10, v12
    v_mul_f32 v10, s66, v10
    v_fma_f32 v16, v16, s66, -v10
    v_fma_f32 v17, v17, s66, -v10
    v_fma_f32 v18, v18, s66, -v10
    v_fma_f32 v19, v19, s66, -v10
    v_fma_f32 v24, v24, s66, -v10
    v_fma_f32 v25, v25, s66, -v10
    v_exp_f32 v16, v16
    v_exp_f32 v17, v17
    v_exp_f32 v18, v18
    v_exp_f32 v19, v19
    v_exp_f32 v24, v24
    v_exp_f32 v25, v25
    v_add_f32 v10, v16, v17
    v_add_f32 v11, v18, v19
    v_add_f32 v10, v10, v24
    v_add_f32 v11, v11, v25
    v_add_f32 v10, v10, v11
    s_nop 1
    v_add_f32_dpp v11, v10, v10 row_ror:8 row_mask:0xf bank_mask:0xf
    v_add_f32_dpp v10, v10, v10 row_ror:8 row_mask:0xf bank_mask:0xf
    s_nop 1
    v_permlane16_swap_b32 v10, v11
    v_add_f32 v12, v10, v11
    v_add_f32 v10, v10, v11
    s_nop 1
    v_permlane32_swap_b32 v10, v12
    v_add_f32 v10, v10, v12
    v_rcp_f32 v10, v10
    s_nop 0
    v_mul_f32 v16, v16, v10
    v_mul_f32 v17, v17, v10
    v_mul_f32 v18, v18, v10
    v_mul_f32 v19, v19, v10
    v_mul_f32 v24, v24, v10
    v_mul_f32 v25, v25, v10
    v_cvt_pk_bf16_f32 v16, v16, v17
    v_cvt_pk_bf16_f32 v17, v18, v19
    v_cvt_pk_bf16_f32 v18, v24, v25
    ds_write_b64 v8, v[16:17]
    ds_write_b32 v9, v18
    s_waitcnt lgkmcnt(0)
    s_barrier
    s_add_u32 s63, s63, 786432
    s_xor_b32 s45, s61, 0x8000
    buffer_store_dword v13, v4, s[12:15], s45 offen
    s_cmp_lg_u32 s44, 0
    s_cbranch_scc1 L_s_np_212
    ds_read_b128 v[20:23], v2 offset:27648
    s_lshl_b32 s45, s60, 17
    s_add_u32 s45, s45, s67
    s_waitcnt lgkmcnt(0)
    buffer_store_dwordx4 v[20:23], v2, s[12:15], s45 offen sc1
L_s_np_212:
    s_add_u32 s68, s60, 2
    s_min_u32 s68, s68, 63
    s_cmp_gt_u32 s69, s68
    s_cbranch_scc1 L_kv_ok_214
    s_mov_b32 s70, 0
L_kv_lp_213:
    v_and_b32 v22, 1, v1
    v_lshlrev_b32 v22, 9, v22
    buffer_load_dword v23, v22, s[12:15], s57 offen sc1
    s_waitcnt vmcnt(0)
    v_readlane_b32 s69, v23, 0
    v_readlane_b32 s45, v23, 1
    s_add_u32 s70, s70, 1
    s_nop 2
    s_min_u32 s69, s69, s45
    s_cmp_gt_u32 s69, s68
    s_cbranch_scc1 L_kv_ok_214
    s_sleep 4
    s_cmp_lt_u32 s70, 524288
    s_cbranch_scc1 L_kv_lp_213
    s_branch L_c_done_1
L_kv_ok_214:
    s_add_u32 s45, s63, 786432
    s_mov_b64 exec, 0xff
    buffer_load_dword v15, v14, s[12:15], s45 offen sc1
    s_mov_b64 exec, -1
    s_add_u32 s60, s60, 1
    s_add_u32 s61, s61, 0x4000
    s_and_b32 s61, s61, 0xffff
    s_branch L_s_loop_207
L_s_last_208:
    s_waitcnt lgkmcnt(0)
    s_barrier
    s_cmp_lg_u32 s44, 0
    s_cbranch_scc1 L_s_np_215
    ds_read_b128 v[20:23], v2 offset:27648
    s_lshl_b32 s45, s60, 17
    s_add_u32 s45, s45, s67
    s_waitcnt lgkmcnt(0)
    buffer_store_dwordx4 v[20:23], v2, s[12:15], s45 offen sc1
L_s_np_215:
    s_branch L_replica
L_rt_202:
    s_add_u32 s70, s70, 1
    s_cmp_lt_u32 s70, 524288
    s_cbranch_scc1 L_c_rp_201
    s_branch L_c_done_1
L_s_xp_209:
    buffer_load_dwordx4 v[64:67], v7, s[12:15], s61 offen offset:0 sc1
    buffer_load_dwordx4 v[68:71], v7, s[12:15], s61 offen offset:1024 sc1
    buffer_load_dwordx4 v[72:75], v7, s[12:15], s61 offen offset:2048 sc1
    buffer_load_dwordx4 v[76:79], v7, s[12:15], s61 offen offset:3072 sc1
    s_branch L_s_xm_210
L_rt_211:
    s_add_u32 s70, s70, 1
    s_cmp_lt_u32 s70, 524288
    s_cbranch_scc1 L_s_xp_209
    s_branch L_c_done_1
L_ss_204:
.p2align 6
L_s_loop_216:
    v_mov_b32 v16, 0
    v_mov_b32 v17, 0
    v_mov_b32 v18, 0
    v_mov_b32 v19, 0
    s_barrier
    ds_read_b128 v[64:67], v2 offset:0
    ds_read_b128 v[68:71], v2 offset:1024
    ds_read_b128 v[72:75], v2 offset:2048
    ds_read_b128 v[76:79], v2 offset:3072
    ds_read_b128 v[80:83], v2 offset:4096
    ds_read_b128 v[84:87], v2 offset:5120
    ds_read_b128 v[88:91], v2 offset:6144
    ds_read_b128 v[92:95], v2 offset:7168
    ds_read_b128 v[96:99], v2 offset:8192
    ds_read_b128 v[100:103], v2 offset:9216
    ds_read_b128 v[104:107], v2 offset:10240
    ds_read_b128 v[108:111], v2 offset:11264
    s_waitcnt lgkmcnt(11)
    v_smfmac_f32_16x16x64_bf16 v[16:19], v[64:67], a[0:7], v3
    ds_read_b128 v[112:115], v2 offset:12288
    s_waitcnt lgkmcnt(11)
    v_smfmac_f32_16x16x64_bf16 v[16:19], v[68:71], a[8:15], v3
    ds_read_b128 v[116:119], v2 offset:13312
    s_waitcnt lgkmcnt(11)
    v_smfmac_f32_16x16x64_bf16 v[16:19], v[72:75], a[16:23], v3
    ds_read_b128 v[120:123], v2 offset:14336
    s_waitcnt lgkmcnt(11)
    v_smfmac_f32_16x16x64_bf16 v[16:19], v[76:79], a[24:31], v3
    ds_read_b128 v[124:127], v2 offset:15360
    s_waitcnt lgkmcnt(11)
    v_smfmac_f32_16x16x64_bf16 v[16:19], v[80:83], a[32:39], v3
    s_waitcnt lgkmcnt(10)
    v_smfmac_f32_16x16x64_bf16 v[16:19], v[84:87], a[40:47], v3
    s_waitcnt lgkmcnt(9)
    v_smfmac_f32_16x16x64_bf16 v[16:19], v[88:91], a[48:55], v3
    s_waitcnt lgkmcnt(8)
    v_smfmac_f32_16x16x64_bf16 v[16:19], v[92:95], a[56:63], v3
    s_waitcnt lgkmcnt(7)
    v_smfmac_f32_16x16x64_bf16 v[16:19], v[96:99], a[64:71], v3
    s_waitcnt lgkmcnt(6)
    v_smfmac_f32_16x16x64_bf16 v[16:19], v[100:103], a[72:79], v3
    s_waitcnt lgkmcnt(5)
    v_smfmac_f32_16x16x64_bf16 v[16:19], v[104:107], a[80:87], v3
    s_waitcnt lgkmcnt(4)
    v_smfmac_f32_16x16x64_bf16 v[16:19], v[108:111], a[88:95], v3
    s_waitcnt lgkmcnt(3)
    v_smfmac_f32_16x16x64_bf16 v[16:19], v[112:115], a[96:103], v3
    s_waitcnt lgkmcnt(2)
    v_smfmac_f32_16x16x64_bf16 v[16:19], v[116:119], a[104:111], v3
    s_waitcnt lgkmcnt(1)
    v_smfmac_f32_16x16x64_bf16 v[16:19], v[120:123], a[112:119], v3
    s_waitcnt lgkmcnt(0)
    v_smfmac_f32_16x16x64_bf16 v[16:19], v[124:127], a[120:127], v3
    s_nop 7
    v_permlane32_swap_b32 v16, v18
    v_permlane32_swap_b32 v17, v19
    v_add_f32 v16, v16, v18
    v_add_f32 v17, v17, v19
    s_mov_b32 vcc_lo, 0x55555555
    s_mov_b32 vcc_hi, 0x55555555
    v_cndmask_b32_dpp v18, v17, v16, vcc quad_perm:[1,0,3,2] row_mask:0xf bank_mask:0xf
    s_not_b64 vcc, vcc
    v_cndmask_b32_dpp v19, v16, v17, vcc quad_perm:[1,0,3,2] row_mask:0xf bank_mask:0xf
    v_cvt_pk_bf16_f32 v18, v18, v19
    v_min_u32 v18, -2, v18
    buffer_store_dword v18, v4, s[12:15], s61 offen sc1
    ds_write_b32 v5, v18
    s_cmp_eq_u32 s60, 63
    s_cbranch_scc1 L_s_last_217
    ds_read_b128 v[32:35], v6 offset:0
    ds_read_b128 v[36:39], v6 offset:1024
    ds_read_b128 v[40:43], v6 offset:2048
    ds_read_b128 v[44:47], v6 offset:3072
    ds_read_b128 v[48:51], v6 offset:4096
    ds_read_b128 v[52:55], v6 offset:5120
    ds_read_b128 v[56:59], v6 offset:6144
    ds_read_b128 v[60:63], v6 offset:7168
    s_sleep 5
    s_mov_b32 s70, 1
    buffer_load_dwordx4 v[64:67], v7, s[12:15], s61 offen offset:0 sc1
    buffer_load_dwordx4 v[68:71], v7, s[12:15], s61 offen offset:1024 sc1
    buffer_load_dwordx4 v[72:75], v7, s[12:15], s61 offen offset:2048 sc1
    buffer_load_dwordx4 v[76:79], v7, s[12:15], s61 offen offset:3072 sc1
L_s_xm_219:
    s_waitcnt lgkmcnt(0)
    s_waitcnt vmcnt(3)
    v_mfma_f32_16x16x32_bf16 v[20:23], v[48:51], v[64:67], 0
    v_mfma_f32_16x16x32_bf16 v[16:19], v[32:35], v[64:67], 0
    v_mfma_f32_16x16x32_bf16 v[24:27], v[64:67], v[64:67], v[28:31]
    v_max3_u32 v10, v64, v64, v65
    v_max3_u32 v10, v10, v66, v67
    s_waitcnt vmcnt(2)
    v_mfma_f32_16x16x32_bf16 v[20:23], v[52:55], v[68:71], v[20:23]
    v_mfma_f32_16x16x32_bf16 v[16:19], v[36:39], v[68:71], v[16:19]
    v_mfma_f32_16x16x32_bf16 v[24:27], v[68:71], v[68:71], v[24:27]
    v_max3_u32 v10, v10, v68, v69
    v_max3_u32 v10, v10, v70, v71
    s_waitcnt vmcnt(1)
    v_mfma_f32_16x16x32_bf16 v[20:23], v[56:59], v[72:75], v[20:23]
    v_mfma_f32_16x16x32_bf16 v[16:19], v[40:43], v[72:75], v[16:19]
    v_mfma_f32_16x16x32_bf16 v[24:27], v[72:75], v[72:75], v[24:27]
    v_max3_u32 v10, v10, v72, v73
    v_max3_u32 v10, v10, v74, v75
    s_waitcnt vmcnt(0)
    v_mfma_f32_16x16x32_bf16 v[20:23], v[60:63], v[76:79], v[20:23]
    v_mfma_f32_16x16x32_bf16 v[16:19], v[44:47], v[76:79], v[16:19]
    v_mfma_f32_16x16x32_bf16 v[24:27], v[76:79], v[76:79], v[24:27]
    v_max3_u32 v10, v10, v76, v77
    v_max3_u32 v10, v10, v78, v79
    v_cmp_eq_u32 vcc, -1, v10
    s_nop 2
    s_cbranch_vccnz L_rt_220
    v_mov_b32_dpp v16, v20 row_ror:8 row_mask:0xf bank_mask:0xc
    v_mov_b32_dpp v17, v21 row_ror:8 row_mask:0xf bank_mask:0xc
    v_mov_b32_dpp v18, v22 row_ror:8 row_mask:0xf bank_mask:0xc
    v_mov_b32_dpp v19, v23 row_ror:8 row_mask:0xf bank_mask:0xc
    v_mov_b32_dpp v24, v26 row_ror:8 row_mask:0xf bank_mask:0xc
    v_mov_b32_dpp v25, v27 row_ror:8 row_mask:0xf bank_mask:0xc
    v_max3_f32 v10, v16, v17, v18
    v_max3_f32 v10, v10, v19, v24
    v_max_f32 v10, v10, v25
    s_nop 1
    v_max_f32_dpp v11, v10, v10 row_ror:8 row_mask:0xf bank_mask:0xf
    v_max_f32_dpp v10, v10, v10 row_ror:8 row_mask:0xf bank_mask:0xf
    s_nop 1
    v_permlane16_swap_b32 v10, v11
    v_max_f32 v12, v10, v11
    v_max_f32 v10, v10, v11
    s_nop 1
    v_permlane32_swap_b32 v10, v12
    v_max_f32 v10, v10, v12
    v_mul_f32 v10, s66, v10
    v_fma_f32 v16, v16, s66, -v10
    v_fma_f32 v17, v17, s66, -v10
    v_fma_f32 v18, v18, s66, -v10
    v_fma_f32 v19, v19, s66, -v10
    v_fma_f32 v24, v24, s66, -v10
    v_fma_f32 v25, v25, s66, -v10
    v_exp_f32 v16, v16
    v_exp_f32 v17, v17
    v_exp_f32 v18, v18
    v_exp_f32 v19, v19
    v_exp_f32 v24, v24
    v_exp_f32 v25, v25
    v_add_f32 v10, v16, v17
    v_add_f32 v11, v18, v19
    v_add_f32 v10, v10, v24
    v_add_f32 v11, v11, v25
    v_add_f32 v10, v10, v11
    s_nop 1
    v_add_f32_dpp v11, v10, v10 row_ror:8 row_mask:0xf bank_mask:0xf
    v_add_f32_dpp v10, v10, v10 row_ror:8 row_mask:0xf bank_mask:0xf
    s_nop 1
    v_permlane16_swap_b32 v10, v11
    v_add_f32 v12, v10, v11
    v_add_f32 v10, v10, v11
    s_nop 1
    v_permlane32_swap_b32 v10, v12
    v_add_f32 v10, v10, v12
    v_rcp_f32 v10, v10
    s_nop 0
    v_mul_f32 v16, v16, v10
    v_mul_f32 v17, v17, v10
    v_mul_f32 v18, v18, v10
    v_mul_f32 v19, v19, v10
    v_mul_f32 v24, v24, v10
    v_mul_f32 v25, v25, v10
    v_cvt_pk_bf16_f32 v16, v16, v17
    v_cvt_pk_bf16_f32 v17, v18, v19
    v_cvt_pk_bf16_f32 v18, v24, v25
    ds_write_b64 v8, v[16:17]
    ds_write_b32 v9, v18
    s_waitcnt lgkmcnt(0)
    s_barrier
    s_add_u32 s63, s63, 786432
    s_xor_b32 s45, s61, 0x8000
    buffer_store_dword v13, v4, s[12:15], s45 offen sc1
    s_cmp_lg_u32 s44, 0
    s_cbranch_scc1 L_s_np_221
    ds_read_b128 v[20:23], v2 offset:27648
    s_lshl_b32 s45, s60, 17
    s_add_u32 s45, s45, s67
    s_waitcnt lgkmcnt(0)
    buffer_store_dwordx4 v[20:23], v2, s[12:15], s45 offen sc1
L_s_np_221:
    s_add_u32 s68, s60, 2
    s_min_u32 s68, s68, 63
    s_cmp_gt_u32 s69, s68
    s_cbranch_scc1 L_kv_ok_223
    s_mov_b32 s70, 0
L_kv_lp_222:
    v_and_b32 v22, 1, v1
    v_lshlrev_b32 v22, 9, v22
    buffer_load_dword v23, v22, s[12:15], s57 offen sc1
    s_waitcnt vmcnt(0)
    v_readlane_b32 s69, v23, 0
    v_readlane_b32 s45, v23, 1
    s_add_u32 s70, s70, 1
    s_nop 2
    s_min_u32 s69, s69, s45
    s_cmp_gt_u32 s69, s68
    s_cbranch_scc1 L_kv_ok_223
    s_sleep 4
    s_cmp_lt_u32 s70, 524288
    s_cbranch_scc1 L_kv_lp_222
    s_branch L_c_done_1
L_kv_ok_223:
    s_add_u32 s45, s63, 786432
    s_mov_b64 exec, 0xff
    buffer_load_dword v15, v14, s[12:15], s45 offen sc1
    s_mov_b64 exec, -1
    s_add_u32 s60, s60, 1
    s_add_u32 s61, s61, 0x4000
    s_and_b32 s61, s61, 0xffff
    s_branch L_s_loop_216
L_s_last_217:
    s_waitcnt lgkmcnt(0)
    s_barrier
    s_cmp_lg_u32 s44, 0
    s_cbranch_scc1 L_s_np_224
    ds_read_b128 v[20:23], v2 offset:27648
    s_lshl_b32 s45, s60, 17
    s_add_u32 s45, s45, s67
    s_waitcnt lgkmcnt(0)
    buffer_store_dwordx4 v[20:23], v2, s[12:15], s45 offen sc1
L_s_np_224:
    s_branch L_replica
L_s_xp_218:
    buffer_load_dwordx4 v[64:67], v7, s[12:15], s61 offen offset:0 sc1
    buffer_load_dwordx4 v[68:71], v7, s[12:15], s61 offen offset:1024 sc1
    buffer_load_dwordx4 v[72:75], v7, s[12:15], s61 offen offset:2048 sc1
    buffer_load_dwordx4 v[76:79], v7, s[12:15], s61 offen offset:3072 sc1
    s_branch L_s_xm_219
L_rt_220:
    s_add_u32 s70, s70, 1
    s_cmp_lt_u32 s70, 524288
    s_cbranch_scc1 L_s_xp_218
    s_branch L_c_done_1
L_vf_205:
    s_cmp_eq_u32 s52, 0
    s_cbranch_scc1 L_vs_206
    s_mov_b32 s70, 1
    v_mov_b32 v16, 0
    v_mov_b32 v17, 0
    s_branch L_v_l1m_227
.p2align 6
L_v_loop_225:
    s_mov_b32 s70, 1
    buffer_load_dwordx4 v[64:67], v9, s[12:15], s61 offen offset:0 sc1
    buffer_load_dwordx4 v[68:71], v9, s[12:15], s61 offen offset:1024 sc1
    buffer_load_dwordx4 v[72:75], v9, s[12:15], s61 offen offset:2048 sc1
    buffer_load_dwordx4 v[76:79], v9, s[12:15], s61 offen offset:3072 sc1
    v_mov_b32 v16, 0
    v_mov_b32 v17, 0
    v_mov_b32 v18, 0
    v_mov_b32 v19, 0
    v_mov_b32 v20, 0
    v_mov_b32 v21, 0
    v_mov_b32 v22, 0
    v_mov_b32 v23, 0
L_v_l1m_227:
    s_waitcnt vmcnt(3)
    ds_write_b128 v10, v[64:67] offset:0
    v_max3_u32 v24, v64, v65, v66
    v_max_u32 v24, v24, v67
    v_cmp_eq_u32 s[48:49], -1, v24
    s_waitcnt vmcnt(2)
    ds_write_b128 v10, v[68:71] offset:1024
    v_max3_u32 v24, v68, v69, v70
    v_max_u32 v24, v24, v71
    v_cmp_eq_u32 s[50:51], -1, v24
    s_waitcnt vmcnt(1)
    ds_write_b128 v10, v[72:75] offset:2048
    v_max3_u32 v24, v72, v73, v74
    v_max_u32 v24, v24, v75
    v_cmp_eq_u32 s[52:53], -1, v24
    s_waitcnt vmcnt(0)
    ds_write_b128 v10, v[76:79] offset:3072
    v_max3_u32 v24, v76, v77, v78
    v_max_u32 v24, v24, v79
    v_cmp_eq_u32 s[54:55], -1, v24
    s_or_b64 s[46:47], s[48:49], s[50:51]
    s_or_b64 vcc, s[52:53], s[54:55]
    s_or_b64 vcc, vcc, s[46:47]
    s_cbranch_scc1 L_v_l1_226
L_v_l1ok_228:
    s_waitcnt lgkmcnt(0)
    s_barrier
    v_smfmac_f32_16x16x64_bf16 v[16:19], v[64:67], a[0:7], v3
    v_smfmac_f32_16x16x64_bf16 v[20:23], v[64:67], a[32:39], v3
    v_smfmac_f32_16x16x64_bf16 v[16:19], v[68:71], a[8:15], v3
    v_smfmac_f32_16x16x64_bf16 v[20:23], v[68:71], a[40:47], v3
    v_smfmac_f32_16x16x64_bf16 v[16:19], v[72:75], a[16:23], v3
    v_smfmac_f32_16x16x64_bf16 v[20:23], v[72:75], a[48:55], v3
    v_smfmac_f32_16x16x64_bf16 v[16:19], v[76:79], a[24:31], v3
    v_smfmac_f32_16x16x64_bf16 v[20:23], v[76:79], a[56:63], v3
    s_nop 6
    v_permlane32_swap_b32 v16, v18
    v_permlane32_swap_b32 v17, v19
    v_permlane32_swap_b32 v20, v22
    v_permlane32_swap_b32 v21, v23
    v_add_f32 v16, v16, v18
    v_add_f32 v17, v17, v19
    v_add_f32 v18, v20, v22
    v_add_f32 v19, v21, v23
    ds_write_b128 v14, v[16:19]
    s_mov_b64 exec, 1
    ds_add_u32 v29, v30
    s_mov_b64 exec, -1
    s_add_u32 s58, s58, 4
    s_bitcmp1_b32 s44, 0
    s_cbranch_scc1 L_v_k1_230
    s_mov_b32 s70, 0
L_v_rl_231:
    ds_read_b32 v24, v29
    ds_read_b64 v[16:17], v13 offset:0
    ds_read_b64 v[18:19], v13 offset:1024
    ds_read_b64 v[20:21], v13 offset:2048
    ds_read_b64 v[22:23], v13 offset:3072
    s_waitcnt lgkmcnt(2)
    v_cmp_ne_u32 vcc, s58, v24
    v_add_f32 v16, v16, v18
    v_add_f32 v17, v17, v19
    s_waitcnt lgkmcnt(0)
    s_cbranch_vccnz L_rt_232
    v_add_f32 v20, v20, v22
    v_add_f32 v21, v21, v23
    v_add_f32 v16, v16, v20
    v_add_f32 v17, v17, v21
    s_mov_b32 vcc_lo, 0x55555555
    s_mov_b32 vcc_hi, 0x55555555
    v_cndmask_b32_dpp v18, v17, v16, vcc quad_perm:[1,0,3,2] row_mask:0xf bank_mask:0xf
    s_not_b64 vcc, vcc
    v_cndmask_b32_dpp v19, v16, v17, vcc quad_perm:[1,0,3,2] row_mask:0xf bank_mask:0xf
    v_cvt_pk_bf16_f32 v18, v18, v19
    v_min_u32 v18, -2, v18
    buffer_store_dword v18, v4, s[12:15], s62 offen
    ds_write_b32 v5, v18
L_v_k1_230:
    s_cmp_eq_u32 s60, 63
    s_cbranch_scc1 L_v_last_229
    ds_read_b128 v[80:83], v27 offset:32768
    ds_read_b128 v[84:87], v27 offset:36864
    ds_read_b128 v[88:91], v27 offset:40960
    ds_read_b128 v[92:95], v27 offset:45056
    v_mov_b32 v96, 0
    v_mov_b32 v97, 0
    v_mov_b32 v98, 0
    v_mov_b32 v99, 0
    v_mov_b32 v100, 0
    v_mov_b32 v101, 0
    v_mov_b32 v102, 0
    v_mov_b32 v103, 0
    v_mov_b32 v104, 0
    v_mov_b32 v105, 0
    v_mov_b32 v106, 0
    v_mov_b32 v107, 0
    v_mov_b32 v108, 0
    v_mov_b32 v109, 0
    v_mov_b32 v110, 0
    v_mov_b32 v111, 0
    s_bitcmp1_b32 s44, 0
    s_cbranch_scc0 L_v_sv_233
    s_sleep 3
L_v_sv_233:
    s_sleep 4
    s_mov_b32 s70, 1
L_v_vp_234:
    buffer_load_dwordx4 v[64:67], v11, s[12:15], s62 offen offset:0 sc1
    buffer_load_dwordx4 v[68:71], v11, s[12:15], s62 offen offset:1024 sc1
    s_waitcnt vmcnt(0)
    v_max3_u32 v20, v64, v65, v66
    v_max3_u32 v20, v20, v67, v68
    v_max3_u32 v20, v20, v69, v70
    v_max_u32 v20, v20, v71
    v_cmp_eq_u32 vcc, -1, v20
    s_cbranch_vccnz L_rt_235
    v_smfmac_f32_16x16x64_bf16 v[96:99], v[64:67], a[64:71], v3
    v_smfmac_f32_16x16x64_bf16 v[96:99], v[68:71], a[72:79], v3
    v_smfmac_f32_16x16x64_bf16 v[100:103], v[64:67], a[80:87], v3
    v_smfmac_f32_16x16x64_bf16 v[100:103], v[68:71], a[88:95], v3
    v_smfmac_f32_16x16x64_bf16 v[104:107], v[64:67], a[96:103], v3
    v_smfmac_f32_16x16x64_bf16 v[104:107], v[68:71], a[104:111], v3
    v_smfmac_f32_16x16x64_bf16 v[108:111], v[64:67], a[112:119], v3
    v_smfmac_f32_16x16x64_bf16 v[108:111], v[68:71], a[120:127], v3
    s_mov_b32 s68, 1
    s_cmp_gt_u32 s69, s68
    s_cbranch_scc1 L_kv_ok_237
    s_mov_b32 s70, 0
L_kv_lp_236:
    v_and_b32 v22, 1, v1
    v_lshlrev_b32 v22, 9, v22
    buffer_load_dword v23, v22, s[12:15], s57 offen sc1
    s_waitcnt vmcnt(0)
    v_readlane_b32 s69, v23, 0
    v_readlane_b32 s45, v23, 1
    s_add_u32 s70, s70, 1
    s_nop 2
    s_min_u32 s69, s69, s45
    s_cmp_gt_u32 s69, s68
    s_cbranch_scc1 L_kv_ok_237
    s_sleep 4
    s_cmp_lt_u32 s70, 524288
    s_cbranch_scc1 L_kv_lp_236
    s_branch L_c_done_1
L_kv_ok_237:
    s_add_u32 s46, s65, 4096
    buffer_load_dwordx4 v[32:35], v15, s[12:15], s65 offen offset:0 sc1
    buffer_load_dwordx4 v[48:51], v15, s[12:15], s46 offen offset:0 sc1
    buffer_load_dwordx4 v[36:39], v15, s[12:15], s65 offen offset:1024 sc1
    buffer_load_dwordx4 v[52:55], v15, s[12:15], s46 offen offset:1024 sc1
    buffer_load_dwordx4 v[40:43], v15, s[12:15], s65 offen offset:2048 sc1
    buffer_load_dwordx4 v[56:59], v15, s[12:15], s46 offen offset:2048 sc1
    buffer_load_dwordx4 v[44:47], v15, s[12:15], s65 offen offset:3072 sc1
    buffer_load_dwordx4 v[60:63], v15, s[12:15], s46 offen offset:3072 sc1
    s_add_u32 s65, s65, 786432
    v_cvt_pk_bf16_f32 v96, v96, v97
    v_cvt_pk_bf16_f32 v97, v98, v99
    ds_write_b64 v12, v[96:97] offset:0
    v_cvt_pk_bf16_f32 v100, v100, v101
    v_cvt_pk_bf16_f32 v101, v102, v103
    ds_write_b64 v12, v[100:101] offset:2048
    v_cvt_pk_bf16_f32 v104, v104, v105
    v_cvt_pk_bf16_f32 v105, v106, v107
    ds_write_b64 v12, v[104:105] offset:4096
    v_cvt_pk_bf16_f32 v108, v108, v109
    v_cvt_pk_bf16_f32 v109, v110, v111
    ds_write_b64 v12, v[108:109] offset:6144
    s_waitcnt lgkmcnt(0)
    s_barrier
    ds_read_b128 v[96:99], v2 offset:16384
    ds_read_b128 v[100:103], v2 offset:17408
    ds_read_b128 v[104:107], v2 offset:18432
    ds_read_b128 v[108:111], v2 offset:19456
    ds_read_b128 v[112:115], v31 offset:0
    ds_read_b128 v[116:119], v25 offset:0
    ds_read_b128 v[120:123], v31 offset:512
    ds_read_b128 v[124:127], v25 offset:1024
    s_waitcnt lgkmcnt(7)
    v_mfma_f32_16x16x32_bf16 v[16:19], v[80:83], v[96:99], 0
    s_waitcnt lgkmcnt(6)
    v_mfma_f32_16x16x32_bf16 v[16:19], v[84:87], v[100:103], v[16:19]
    s_waitcnt lgkmcnt(5)
    v_mfma_f32_16x16x32_bf16 v[16:19], v[88:91], v[104:107], v[16:19]
    s_waitcnt lgkmcnt(4)
    v_mfma_f32_16x16x32_bf16 v[16:19], v[92:95], v[108:111], v[16:19]
    s_waitcnt lgkmcnt(2)
    v_mfma_f32_16x16x32_bf16 v[16:19], v[116:119], v[112:115], v[16:19]
    s_waitcnt lgkmcnt(0)
    v_mfma_f32_16x16x32_bf16 v[16:19], v[124:127], v[120:123], v[16:19]
    s_mov_b32 exec_lo, 0x00ff00ff
    s_mov_b32 exec_hi, 0x00ff00ff
    s_nop 5
    v_cvt_pk_bf16_f32 v16, v16, v17
    v_cvt_pk_bf16_f32 v17, v18, v19
    v_min_u32 v16, -2, v16
    v_min_u32 v17, -2, v17
    buffer_store_dwordx2 v[16:17], v6, s[12:15], s63 offen sc1
    s_mov_b64 exec, -1
    s_add_u32 s61, s61, 0x4000
    s_and_b32 s61, s61, 0xffff
    s_mov_b32 s70, 1
    s_add_u32 s46, s64, 4096
    s_add_u32 m0, s59, 0
    s_nop 0
    buffer_load_dwordx4 v28, s[12:15], s64 offen offset:0 sc1 lds
    buffer_load_dwordx4 v28, s[12:15], s64 offen offset:1024 sc1 lds
    buffer_load_dwordx4 v28, s[12:15], s64 offen offset:2048 sc1 lds
    buffer_load_dwordx4 v28, s[12:15], s64 offen offset:3072 sc1 lds
    s_add_u32 m0, s59, 4096
    s_nop 0
    buffer_load_dwordx4 v28, s[12:15], s46 offen offset:0 sc1 lds
    buffer_load_dwordx4 v28, s[12:15], s46 offen offset:1024 sc1 lds
    buffer_load_dwordx4 v28, s[12:15], s46 offen offset:2048 sc1 lds
    buffer_load_dwordx4 v28, s[12:15], s46 offen offset:3072 sc1 lds
    s_add_u32 s64, s64, 786432
    s_waitcnt vmcnt(9)
    s_sleep 7
    buffer_load_dword v96, v7, s[12:15], s63 offen offset:0 sc1
    buffer_load_dword v97, v7, s[12:15], s63 offen offset:256 sc1
    buffer_load_dword v98, v7, s[12:15], s63 offen offset:512 sc1
    buffer_load_dword v99, v7, s[12:15], s63 offen offset:768 sc1
    buffer_load_dword v100, v7, s[12:15], s63 offen offset:1024 sc1
    buffer_load_dword v101, v7, s[12:15], s63 offen offset:1280 sc1
    buffer_load_dword v102, v7, s[12:15], s63 offen offset:1536 sc1
    buffer_load_dword v103, v7, s[12:15], s63 offen offset:1792 sc1
    v_mfma_f32_16x16x32_bf16 v[64:67], v[32:35], a[64:67], 0
    v_mfma_f32_16x16x32_bf16 v[68:71], v[48:51], a[64:67], 0
    v_mfma_f32_16x16x32_bf16 v[64:67], v[36:39], a[68:71], v[64:67]
    v_mfma_f32_16x16x32_bf16 v[68:71], v[52:55], a[68:71], v[68:71]
    v_mfma_f32_16x16x32_bf16 v[64:67], v[40:43], a[72:75], v[64:67]
    v_mfma_f32_16x16x32_bf16 v[68:71], v[56:59], a[72:75], v[68:71]
    v_mfma_f32_16x16x32_bf16 v[64:67], v[44:47], a[76:79], v[64:67]
    v_mfma_f32_16x16x32_bf16 v[68:71], v[60:63], a[76:79], v[68:71]
    v_mfma_f32_16x16x32_bf16 v[72:75], v[32:35], a[80:83], 0
    v_mfma_f32_16x16x32_bf16 v[76:79], v[48:51], a[80:83], 0
    v_mfma_f32_16x16x32_bf16 v[72:75], v[36:39], a[84:87], v[72:75]
    v_mfma_f32_16x16x32_bf16 v[76:79], v[52:55], a[84:87], v[76:79]
    v_mfma_f32_16x16x32_bf16 v[72:75], v[40:43], a[88:91], v[72:75]
    v_mfma_f32_16x16x32_bf16 v[76:79], v[56:59], a[88:91], v[76:79]
    v_mfma_f32_16x16x32_bf16 v[72:75], v[44:47], a[92:95], v[72:75]
    v_mfma_f32_16x16x32_bf16 v[76:79], v[60:63], a[92:95], v[76:79]
    v_cvt_pk_bf16_f32 v64, v64, v65
    v_cvt_pk_bf16_f32 v65, v66, v67
    v_cvt_pk_bf16_f32 v66, v68, v69
    v_cvt_pk_bf16_f32 v67, v70, v71
    ds_write_b128 v10, v[64:67] offset:32768
    v_mfma_f32_16x16x32_bf16 v[80:83], v[32:35], a[96:99], 0
    v_mfma_f32_16x16x32_bf16 v[84:87], v[48:51], a[96:99], 0
    v_mfma_f32_16x16x32_bf16 v[80:83], v[36:39], a[100:103], v[80:83]
    v_mfma_f32_16x16x32_bf16 v[84:87], v[52:55], a[100:103], v[84:87]
    v_mfma_f32_16x16x32_bf16 v[80:83], v[40:43], a[104:107], v[80:83]
    v_mfma_f32_16x16x32_bf16 v[84:87], v[56:59], a[104:107], v[84:87]
    v_mfma_f32_16x16x32_bf16 v[80:83], v[44:47], a[108:111], v[80:83]
    v_mfma_f32_16x16x32_bf16 v[84:87], v[60:63], a[108:111], v[84:87]
    v_cvt_pk_bf16_f32 v72, v72, v73
    v_cvt_pk_bf16_f32 v73, v74, v75
    v_cvt_pk_bf16_f32 v74, v76, v77
    v_cvt_pk_bf16_f32 v75, v78, v79
    ds_write_b128 v10, v[72:75] offset:33792
    v_mfma_f32_16x16x32_bf16 v[88:91], v[32:35], a[112:115], 0
    v_mfma_f32_16x16x32_bf16 v[92:95], v[48:51], a[112:115], 0
    v_mfma_f32_16x16x32_bf16 v[88:91], v[36:39], a[116:119], v[88:91]
    v_mfma_f32_16x16x32_bf16 v[92:95], v[52:55], a[116:119], v[92:95]
    v_mfma_f32_16x16x32_bf16 v[88:91], v[40:43], a[120:123], v[88:91]
    v_mfma_f32_16x16x32_bf16 v[92:95], v[56:59], a[120:123], v[92:95]
    v_mfma_f32_16x16x32_bf16 v[88:91], v[44:47], a[124:127], v[88:91]
    v_mfma_f32_16x16x32_bf16 v[92:95], v[60:63], a[124:127], v[92:95]
    v_cvt_pk_bf16_f32 v80, v80, v81
    v_cvt_pk_bf16_f32 v81, v82, v83
    v_cvt_pk_bf16_f32 v82, v84, v85
    v_cvt_pk_bf16_f32 v83, v86, v87
    ds_write_b128 v10, v[80:83] offset:34816
    s_nop 2
    v_cvt_pk_bf16_f32 v88, v88, v89
    v_cvt_pk_bf16_f32 v89, v90, v91
    v_cvt_pk_bf16_f32 v90, v92, v93
    v_cvt_pk_bf16_f32 v91, v94, v95
    ds_write_b128 v10, v[88:91] offset:35840
L_v_gp_238:
    s_waitcnt vmcnt(7)
    v_lshlrev_b32 v20, 16, v96
    v_and_b32 v21, 0xffff0000, v96
    s_waitcnt vmcnt(6)
    v_lshlrev_b32 v22, 16, v97
    v_and_b32 v23, 0xffff0000, v97
    v_add_f32 v20, v20, v22
    v_add_f32 v21, v21, v23
    s_waitcnt vmcnt(5)
    v_lshlrev_b32 v22, 16, v98
    v_and_b32 v23, 0xffff0000, v98
    v_add_f32 v20, v20, v22
    v_add_f32 v21, v21, v23
    s_waitcnt vmcnt(4)
    v_lshlrev_b32 v22, 16, v99
    v_and_b32 v23, 0xffff0000, v99
    v_add_f32 v20, v20, v22
    v_add_f32 v21, v21, v23
    s_waitcnt vmcnt(3)
    v_lshlrev_b32 v22, 16, v100
    v_and_b32 v23, 0xffff0000, v100
    v_add_f32 v20, v20, v22
    v_add_f32 v21, v21, v23
    s_waitcnt vmcnt(2)
    v_lshlrev_b32 v22, 16, v101
    v_and_b32 v23, 0xffff0000, v101
    v_add_f32 v20, v20, v22
    v_add_f32 v21, v21, v23
    s_waitcnt vmcnt(1)
    v_lshlrev_b32 v22, 16, v102
    v_and_b32 v23, 0xffff0000, v102
    v_add_f32 v20, v20, v22
    v_add_f32 v21, v21, v23
    s_waitcnt vmcnt(0)
    v_lshlrev_b32 v22, 16, v103
    v_and_b32 v23, 0xffff0000, v103
    v_add_f32 v20, v20, v22
    v_add_f32 v21, v21, v23
    v_cmp_u_f32 vcc, v20, v21
    v_cvt_pk_bf16_f32 v20, v20, v21
    s_cbranch_vccnz L_v_gf_240
L_v_gok_239:
    buffer_store_dword v20, v8, s[12:15], s61 offen
    s_xor_b32 s45, s61, 0x8000
    buffer_store_dword v26, v8, s[12:15], s45 offen
    s_bitcmp1_b32 s44, 0
    s_cbranch_scc1 L_v_nr_241
    s_xor_b32 s45, s62, 0x4000
    buffer_store_dword v26, v4, s[12:15], s45 offen
L_v_nr_241:
    s_add_u32 s60, s60, 1
    s_add_u32 s62, s62, 0x2000
    s_and_b32 s62, s62, 0x7fff
    s_add_u32 s63, s63, 131072
    s_sleep 7
    s_branch L_v_loop_225
L_v_last_229:
    s_waitcnt lgkmcnt(0)
    s_barrier
    s_branch L_replica
L_v_l1_226:
    s_mov_b64 exec, s[48:49]
    s_cbranch_execz L_v_ls_242
    buffer_load_dwordx4 v[64:67], v9, s[12:15], s61 offen offset:0 sc1
L_v_ls_242:
    s_mov_b64 exec, s[50:51]
    s_cbranch_execz L_v_ls_243
    buffer_load_dwordx4 v[68:71], v9, s[12:15], s61 offen offset:1024 sc1
L_v_ls_243:
    s_mov_b64 exec, s[52:53]
    s_cbranch_execz L_v_ls_244
    buffer_load_dwordx4 v[72:75], v9, s[12:15], s61 offen offset:2048 sc1
L_v_ls_244:
    s_mov_b64 exec, s[54:55]
    s_cbranch_execz L_v_ls_245
    buffer_load_dwordx4 v[76:79], v9, s[12:15], s61 offen offset:3072 sc1
L_v_ls_245:
    s_mov_b64 exec, -1
    s_add_u32 s70, s70, 1
    s_cmp_ge_u32 s70, 524288
    s_cbranch_scc1 L_c_done_1
    s_waitcnt vmcnt(0)
    s_cmp_eq_u64 s[48:49], 0
    s_cbranch_scc1 L_v_lc_246
    ds_write_b128 v10, v[64:67] offset:0
    v_max3_u32 v24, v64, v65, v66
    v_max_u32 v24, v24, v67
    v_cmp_eq_u32 s[48:49], -1, v24
L_v_lc_246:
    s_cmp_eq_u64 s[50:51], 0
    s_cbranch_scc1 L_v_lc_247
    ds_write_b128 v10, v[68:71] offset:1024
    v_max3_u32 v24, v68, v69, v70
    v_max_u32 v24, v24, v71
    v_cmp_eq_u32 s[50:51], -1, v24
L_v_lc_247:
    s_cmp_eq_u64 s[52:53], 0
    s_cbranch_scc1 L_v_lc_248
    ds_write_b128 v10, v[72:75] offset:2048
    v_max3_u32 v24, v72, v73, v74
    v_max_u32 v24, v24, v75
    v_cmp_eq_u32 s[52:53], -1, v24
L_v_lc_248:
    s_cmp_eq_u64 s[54:55], 0
    s_cbranch_scc1 L_v_lc_249
    ds_write_b128 v10, v[76:79] offset:3072
    v_max3_u32 v24, v76, v77, v78
    v_max_u32 v24, v24, v79
    v_cmp_eq_u32 s[54:55], -1, v24
L_v_lc_249:
    s_or_b64 s[46:47], s[48:49], s[50:51]
    s_or_b64 vcc, s[52:53], s[54:55]
    s_or_b64 vcc, vcc, s[46:47]
    s_cbranch_scc1 L_v_l1_226
    s_branch L_v_l1ok_228
L_rt_232:
    s_add_u32 s70, s70, 1
    s_cmp_lt_u32 s70, 524288
    s_cbranch_scc1 L_v_rl_231
    s_branch L_c_done_1
L_rt_235:
    s_add_u32 s70, s70, 1
    s_cmp_lt_u32 s70, 524288
    s_cbranch_scc1 L_v_vp_234
    s_branch L_c_done_1
L_v_gf_240:
    v_max3_u32 v24, v96, v97, v98
    v_max3_u32 v24, v24, v99, v100
    v_max3_u32 v24, v24, v101, v102
    v_max_u32 v24, v24, v103
    v_cmp_eq_u32 vcc, -1, v24
    v_min_u32 v20, -2, v20
    s_add_u32 s70, s70, 1
    s_cbranch_vccz L_v_gok_239
    buffer_load_dword v96, v7, s[12:15], s63 offen offset:0 sc1
    buffer_load_dword v97, v7, s[12:15], s63 offen offset:256 sc1
    buffer_load_dword v98, v7, s[12:15], s63 offen offset:512 sc1
    buffer_load_dword v99, v7, s[12:15], s63 offen offset:768 sc1
    buffer_load_dword v100, v7, s[12:15], s63 offen offset:1024 sc1
    buffer_load_dword v101, v7, s[12:15], s63 offen offset:1280 sc1
    buffer_load_dword v102, v7, s[12:15], s63 offen offset:1536 sc1
    buffer_load_dword v103, v7, s[12:15], s63 offen offset:1792 sc1
    s_cmp_lt_u32 s70, 524288
    s_cbranch_scc1 L_v_gp_238
    s_branch L_c_done_1
L_vs_206:
    s_mov_b32 s70, 1
    v_mov_b32 v16, 0
    v_mov_b32 v17, 0
    s_branch L_v_l1m_252
.p2align 6
L_v_loop_250:
    s_mov_b32 s70, 1
    buffer_load_dwordx4 v[64:67], v9, s[12:15], s61 offen offset:0 sc1
    buffer_load_dwordx4 v[68:71], v9, s[12:15], s61 offen offset:1024 sc1
    buffer_load_dwordx4 v[72:75], v9, s[12:15], s61 offen offset:2048 sc1
    buffer_load_dwordx4 v[76:79], v9, s[12:15], s61 offen offset:3072 sc1
    v_mov_b32 v16, 0
    v_mov_b32 v17, 0
    v_mov_b32 v18, 0
    v_mov_b32 v19, 0
    v_mov_b32 v20, 0
    v_mov_b32 v21, 0
    v_mov_b32 v22, 0
    v_mov_b32 v23, 0
L_v_l1m_252:
    s_waitcnt vmcnt(3)
    ds_write_b128 v10, v[64:67] offset:0
    v_max3_u32 v24, v64, v65, v66
    v_max_u32 v24, v24, v67
    v_cmp_eq_u32 s[48:49], -1, v24
    s_waitcnt vmcnt(2)
    ds_write_b128 v10, v[68:71] offset:1024
    v_max3_u32 v24, v68, v69, v70
    v_max_u32 v24, v24, v71
    v_cmp_eq_u32 s[50:51], -1, v24
    s_waitcnt vmcnt(1)
    ds_write_b128 v10, v[72:75] offset:2048
    v_max3_u32 v24, v72, v73, v74
    v_max_u32 v24, v24, v75
    v_cmp_eq_u32 s[52:53], -1, v24
    s_waitcnt vmcnt(0)
    ds_write_b128 v10, v[76:79] offset:3072
    v_max3_u32 v24, v76, v77, v78
    v_max_u32 v24, v24, v79
    v_cmp_eq_u32 s[54:55], -1, v24
    s_or_b64 s[46:47], s[48:49], s[50:51]
    s_or_b64 vcc, s[52:53], s[54:55]
    s_or_b64 vcc, vcc, s[46:47]
    s_cbranch_scc1 L_v_l1_251
L_v_l1ok_253:
    s_waitcnt lgkmcnt(0)
    s_barrier
    v_smfmac_f32_16x16x64_bf16 v[16:19], v[64:67], a[0:7], v3
    v_smfmac_f32_16x16x64_bf16 v[20:23], v[64:67], a[32:39], v3
    v_smfmac_f32_16x16x64_bf16 v[16:19], v[68:71], a[8:15], v3
    v_smfmac_f32_16x16x64_bf16 v[20:23], v[68:71], a[40:47], v3
    v_smfmac_f32_16x16x64_bf16 v[16:19], v[72:75], a[16:23], v3
    v_smfmac_f32_16x16x64_bf16 v[20:23], v[72:75], a[48:55], v3
    v_smfmac_f32_16x16x64_bf16 v[16:19], v[76:79], a[24:31], v3
    v_smfmac_f32_16x16x64_bf16 v[20:23], v[76:79], a[56:63], v3
    s_nop 6
    v_permlane32_swap_b32 v16, v18
    v_permlane32_swap_b32 v17, v19
    v_permlane32_swap_b32 v20, v22
    v_permlane32_swap_b32 v21, v23
    v_add_f32 v16, v16, v18
    v_add_f32 v17, v17, v19
    v_add_f32 v18, v20, v22
    v_add_f32 v19, v21, v23
    ds_write_b128 v14, v[16:19]
    s_mov_b64 exec, 1
    ds_add_u32 v29, v30
    s_mov_b64 exec, -1
    s_add_u32 s58, s58, 4
    s_bitcmp1_b32 s44, 0
    s_cbranch_scc1 L_v_k1_255
    s_mov_b32 s70, 0
L_v_rl_256:
    ds_read_b32 v24, v29
    ds_read_b64 v[16:17], v13 offset:0
    ds_read_b64 v[18:19], v13 offset:1024
    ds_read_b64 v[20:21], v13 offset:2048
    ds_read_b64 v[22:23], v13 offset:3072
    s_waitcnt lgkmcnt(2)
    v_cmp_ne_u32 vcc, s58, v24
    v_add_f32 v16, v16, v18
    v_add_f32 v17, v17, v19
    s_waitcnt lgkmcnt(0)
    s_cbranch_vccnz L_rt_257
    v_add_f32 v20, v20, v22
    v_add_f32 v21, v21, v23
    v_add_f32 v16, v16, v20
    v_add_f32 v17, v17, v21
    s_mov_b32 vcc_lo, 0x55555555
    s_mov_b32 vcc_hi, 0x55555555
    v_cndmask_b32_dpp v18, v17, v16, vcc quad_perm:[1,0,3,2] row_mask:0xf bank_mask:0xf
    s_not_b64 vcc, vcc
    v_cndmask_b32_dpp v19, v16, v17, vcc quad_perm:[1,0,3,2] row_mask:0xf bank_mask:0xf
    v_cvt_pk_bf16_f32 v18, v18, v19
    v_min_u32 v18, -2, v18
    buffer_store_dword v18, v4, s[12:15], s62 offen sc1
    ds_write_b32 v5, v18
L_v_k1_255:
    s_cmp_eq_u32 s60, 63
    s_cbranch_scc1 L_v_last_254
    ds_read_b128 v[80:83], v27 offset:32768
    ds_read_b128 v[84:87], v27 offset:36864
    ds_read_b128 v[88:91], v27 offset:40960
    ds_read_b128 v[92:95], v27 offset:45056
    v_mov_b32 v96, 0
    v_mov_b32 v97, 0
    v_mov_b32 v98, 0
    v_mov_b32 v99, 0
    v_mov_b32 v100, 0
    v_mov_b32 v101, 0
    v_mov_b32 v102, 0
    v_mov_b32 v103, 0
    v_mov_b32 v104, 0
    v_mov_b32 v105, 0
    v_mov_b32 v106, 0
    v_mov_b32 v107, 0
    v_mov_b32 v108, 0
    v_mov_b32 v109, 0
    v_mov_b32 v110, 0
    v_mov_b32 v111, 0
    s_bitcmp1_b32 s44, 0
    s_cbranch_scc0 L_v_sv_258
    s_sleep 3
L_v_sv_258:
    s_sleep 4
    s_mov_b32 s70, 1
L_v_vp_259:
    buffer_load_dwordx4 v[64:67], v11, s[12:15], s62 offen offset:0 sc1
    buffer_load_dwordx4 v[68:71], v11, s[12:15], s62 offen offset:1024 sc1
    s_waitcnt vmcnt(0)
    v_max3_u32 v20, v64, v65, v66
    v_max3_u32 v20, v20, v67, v68
    v_max3_u32 v20, v20, v69, v70
    v_max_u32 v20, v20, v71
    v_cmp_eq_u32 vcc, -1, v20
    s_cbranch_vccnz L_rt_260
    v_smfmac_f32_16x16x64_bf16 v[96:99], v[64:67], a[64:71], v3
    v_smfmac_f32_16x16x64_bf16 v[96:99], v[68:71], a[72:79], v3
    v_smfmac_f32_16x16x64_bf16 v[100:103], v[64:67], a[80:87], v3
    v_smfmac_f32_16x16x64_bf16 v[100:103], v[68:71], a[88:95], v3
    v_smfmac_f32_16x16x64_bf16 v[104:107], v[64:67], a[96:103], v3
    v_smfmac_f32_16x16x64_bf16 v[104:107], v[68:71], a[104:111], v3
    v_smfmac_f32_16x16x64_bf16 v[108:111], v[64:67], a[112:119], v3
    v_smfmac_f32_16x16x64_bf16 v[108:111], v[68:71], a[120:127], v3
    s_mov_b32 s68, 1
    s_cmp_gt_u32 s69, s68
    s_cbranch_scc1 L_kv_ok_262
    s_mov_b32 s70, 0
L_kv_lp_261:
    v_and_b32 v22, 1, v1
    v_lshlrev_b32 v22, 9, v22
    buffer_load_dword v23, v22, s[12:15], s57 offen sc1
    s_waitcnt vmcnt(0)
    v_readlane_b32 s69, v23, 0
    v_readlane_b32 s45, v23, 1
    s_add_u32 s70, s70, 1
    s_nop 2
    s_min_u32 s69, s69, s45
    s_cmp_gt_u32 s69, s68
    s_cbranch_scc1 L_kv_ok_262
    s_sleep 4
    s_cmp_lt_u32 s70, 524288
    s_cbranch_scc1 L_kv_lp_261
    s_branch L_c_done_1
L_kv_ok_262:
    s_add_u32 s46, s65, 4096
    buffer_load_dwordx4 v[32:35], v15, s[12:15], s65 offen offset:0 sc1
    buffer_load_dwordx4 v[48:51], v15, s[12:15], s46 offen offset:0 sc1
    buffer_load_dwordx4 v[36:39], v15, s[12:15], s65 offen offset:1024 sc1
    buffer_load_dwordx4 v[52:55], v15, s[12:15], s46 offen offset:1024 sc1
    buffer_load_dwordx4 v[40:43], v15, s[12:15], s65 offen offset:2048 sc1
    buffer_load_dwordx4 v[56:59], v15, s[12:15], s46 offen offset:2048 sc1
    buffer_load_dwordx4 v[44:47], v15, s[12:15], s65 offen offset:3072 sc1
    buffer_load_dwordx4 v[60:63], v15, s[12:15], s46 offen offset:3072 sc1
    s_add_u32 s65, s65, 786432
    v_cvt_pk_bf16_f32 v96, v96, v97
    v_cvt_pk_bf16_f32 v97, v98, v99
    ds_write_b64 v12, v[96:97] offset:0
    v_cvt_pk_bf16_f32 v100, v100, v101
    v_cvt_pk_bf16_f32 v101, v102, v103
    ds_write_b64 v12, v[100:101] offset:2048
    v_cvt_pk_bf16_f32 v104, v104, v105
    v_cvt_pk_bf16_f32 v105, v106, v107
    ds_write_b64 v12, v[104:105] offset:4096
    v_cvt_pk_bf16_f32 v108, v108, v109
    v_cvt_pk_bf16_f32 v109, v110, v111
    ds_write_b64 v12, v[108:109] offset:6144
    s_waitcnt lgkmcnt(0)
    s_barrier
    ds_read_b128 v[96:99], v2 offset:16384
    ds_read_b128 v[100:103], v2 offset:17408
    ds_read_b128 v[104:107], v2 offset:18432
    ds_read_b128 v[108:111], v2 offset:19456
    ds_read_b128 v[112:115], v31 offset:0
    ds_read_b128 v[116:119], v25 offset:0
    ds_read_b128 v[120:123], v31 offset:512
    ds_read_b128 v[124:127], v25 offset:1024
    s_waitcnt lgkmcnt(7)
    v_mfma_f32_16x16x32_bf16 v[16:19], v[80:83], v[96:99], 0
    s_waitcnt lgkmcnt(6)
    v_mfma_f32_16x16x32_bf16 v[16:19], v[84:87], v[100:103], v[16:19]
    s_waitcnt lgkmcnt(5)
    v_mfma_f32_16x16x32_bf16 v[16:19], v[88:91], v[104:107], v[16:19]
    s_waitcnt lgkmcnt(4)
    v_mfma_f32_16x16x32_bf16 v[16:19], v[92:95], v[108:111], v[16:19]
    s_waitcnt lgkmcnt(2)
    v_mfma_f32_16x16x32_bf16 v[16:19], v[116:119], v[112:115], v[16:19]
    s_waitcnt lgkmcnt(0)
    v_mfma_f32_16x16x32_bf16 v[16:19], v[124:127], v[120:123], v[16:19]
    s_mov_b32 exec_lo, 0x00ff00ff
    s_mov_b32 exec_hi, 0x00ff00ff
    s_nop 5
    v_cvt_pk_bf16_f32 v16, v16, v17
    v_cvt_pk_bf16_f32 v17, v18, v19
    v_min_u32 v16, -2, v16
    v_min_u32 v17, -2, v17
    buffer_store_dwordx2 v[16:17], v6, s[12:15], s63 offen sc1
    s_mov_b64 exec, -1
    s_add_u32 s61, s61, 0x4000
    s_and_b32 s61, s61, 0xffff
    s_mov_b32 s70, 1
    s_add_u32 s46, s64, 4096
    s_add_u32 m0, s59, 0
    s_nop 0
    buffer_load_dwordx4 v28, s[12:15], s64 offen offset:0 sc1 lds
    buffer_load_dwordx4 v28, s[12:15], s64 offen offset:1024 sc1 lds
    buffer_load_dwordx4 v28, s[12:15], s64 offen offset:2048 sc1 lds
    buffer_load_dwordx4 v28, s[12:15], s64 offen offset:3072 sc1 lds
    s_add_u32 m0, s59, 4096
    s_nop 0
    buffer_load_dwordx4 v28, s[12:15], s46 offen offset:0 sc1 lds
    buffer_load_dwordx4 v28, s[12:15], s46 offen offset:1024 sc1 lds
    buffer_load_dwordx4 v28, s[12:15], s46 offen offset:2048 sc1 lds
    buffer_load_dwordx4 v28, s[12:15], s46 offen offset:3072 sc1 lds
    s_add_u32 s64, s64, 786432
    s_waitcnt vmcnt(9)
    s_sleep 7
    buffer_load_dword v96, v7, s[12:15], s63 offen offset:0 sc1
    buffer_load_dword v97, v7, s[12:15], s63 offen offset:256 sc1
    buffer_load_dword v98, v7, s[12:15], s63 offen offset:512 sc1
    buffer_load_dword v99, v7, s[12:15], s63 offen offset:768 sc1
    buffer_load_dword v100, v7, s[12:15], s63 offen offset:1024 sc1
    buffer_load_dword v101, v7, s[12:15], s63 offen offset:1280 sc1
    buffer_load_dword v102, v7, s[12:15], s63 offen offset:1536 sc1
    buffer_load_dword v103, v7, s[12:15], s63 offen offset:1792 sc1
    v_mfma_f32_16x16x32_bf16 v[64:67], v[32:35], a[64:67], 0
    v_mfma_f32_16x16x32_bf16 v[68:71], v[48:51], a[64:67], 0
    v_mfma_f32_16x16x32_bf16 v[64:67], v[36:39], a[68:71], v[64:67]
    v_mfma_f32_16x16x32_bf16 v[68:71], v[52:55], a[68:71], v[68:71]
    v_mfma_f32_16x16x32_bf16 v[64:67], v[40:43], a[72:75], v[64:67]
    v_mfma_f32_16x16x32_bf16 v[68:71], v[56:59], a[72:75], v[68:71]
    v_mfma_f32_16x16x32_bf16 v[64:67], v[44:47], a[76:79], v[64:67]
    v_mfma_f32_16x16x32_bf16 v[68:71], v[60:63], a[76:79], v[68:71]
    v_mfma_f32_16x16x32_bf16 v[72:75], v[32:35], a[80:83], 0
    v_mfma_f32_16x16x32_bf16 v[76:79], v[48:51], a[80:83], 0
    v_mfma_f32_16x16x32_bf16 v[72:75], v[36:39], a[84:87], v[72:75]
    v_mfma_f32_16x16x32_bf16 v[76:79], v[52:55], a[84:87], v[76:79]
    v_mfma_f32_16x16x32_bf16 v[72:75], v[40:43], a[88:91], v[72:75]
    v_mfma_f32_16x16x32_bf16 v[76:79], v[56:59], a[88:91], v[76:79]
    v_mfma_f32_16x16x32_bf16 v[72:75], v[44:47], a[92:95], v[72:75]
    v_mfma_f32_16x16x32_bf16 v[76:79], v[60:63], a[92:95], v[76:79]
    v_cvt_pk_bf16_f32 v64, v64, v65
    v_cvt_pk_bf16_f32 v65, v66, v67
    v_cvt_pk_bf16_f32 v66, v68, v69
    v_cvt_pk_bf16_f32 v67, v70, v71
    ds_write_b128 v10, v[64:67] offset:32768
    v_mfma_f32_16x16x32_bf16 v[80:83], v[32:35], a[96:99], 0
    v_mfma_f32_16x16x32_bf16 v[84:87], v[48:51], a[96:99], 0
    v_mfma_f32_16x16x32_bf16 v[80:83], v[36:39], a[100:103], v[80:83]
    v_mfma_f32_16x16x32_bf16 v[84:87], v[52:55], a[100:103], v[84:87]
    v_mfma_f32_16x16x32_bf16 v[80:83], v[40:43], a[104:107], v[80:83]
    v_mfma_f32_16x16x32_bf16 v[84:87], v[56:59], a[104:107], v[84:87]
    v_mfma_f32_16x16x32_bf16 v[80:83], v[44:47], a[108:111], v[80:83]
    v_mfma_f32_16x16x32_bf16 v[84:87], v[60:63], a[108:111], v[84:87]
    v_cvt_pk_bf16_f32 v72, v72, v73
    v_cvt_pk_bf16_f32 v73, v74, v75
    v_cvt_pk_bf16_f32 v74, v76, v77
    v_cvt_pk_bf16_f32 v75, v78, v79
    ds_write_b128 v10, v[72:75] offset:33792
    v_mfma_f32_16x16x32_bf16 v[88:91], v[32:35], a[112:115], 0
    v_mfma_f32_16x16x32_bf16 v[92:95], v[48:51], a[112:115], 0
    v_mfma_f32_16x16x32_bf16 v[88:91], v[36:39], a[116:119], v[88:91]
    v_mfma_f32_16x16x32_bf16 v[92:95], v[52:55], a[116:119], v[92:95]
    v_mfma_f32_16x16x32_bf16 v[88:91], v[40:43], a[120:123], v[88:91]
    v_mfma_f32_16x16x32_bf16 v[92:95], v[56:59], a[120:123], v[92:95]
    v_mfma_f32_16x16x32_bf16 v[88:91], v[44:47], a[124:127], v[88:91]
    v_mfma_f32_16x16x32_bf16 v[92:95], v[60:63], a[124:127], v[92:95]
    v_cvt_pk_bf16_f32 v80, v80, v81
    v_cvt_pk_bf16_f32 v81, v82, v83
    v_cvt_pk_bf16_f32 v82, v84, v85
    v_cvt_pk_bf16_f32 v83, v86, v87
    ds_write_b128 v10, v[80:83] offset:34816
    s_nop 2
    v_cvt_pk_bf16_f32 v88, v88, v89
    v_cvt_pk_bf16_f32 v89, v90, v91
    v_cvt_pk_bf16_f32 v90, v92, v93
    v_cvt_pk_bf16_f32 v91, v94, v95
    ds_write_b128 v10, v[88:91] offset:35840
L_v_gp_263:
    s_waitcnt vmcnt(7)
    v_lshlrev_b32 v20, 16, v96
    v_and_b32 v21, 0xffff0000, v96
    s_waitcnt vmcnt(6)
    v_lshlrev_b32 v22, 16, v97
    v_and_b32 v23, 0xffff0000, v97
    v_add_f32 v20, v20, v22
    v_add_f32 v21, v21, v23
    s_waitcnt vmcnt(5)
    v_lshlrev_b32 v22, 16, v98
    v_and_b32 v23, 0xffff0000, v98
    v_add_f32 v20, v20, v22
    v_add_f32 v21, v21, v23
    s_waitcnt vmcnt(4)
    v_lshlrev_b32 v22, 16, v99
    v_and_b32 v23, 0xffff0000, v99
    v_add_f32 v20, v20, v22
    v_add_f32 v21, v21, v23
    s_waitcnt vmcnt(3)
    v_lshlrev_b32 v22, 16, v100
    v_and_b32 v23, 0xffff0000, v100
    v_add_f32 v20, v20, v22
    v_add_f32 v21, v21, v23
    s_waitcnt vmcnt(2)
    v_lshlrev_b32 v22, 16, v101
    v_and_b32 v23, 0xffff0000, v101
    v_add_f32 v20, v20, v22
    v_add_f32 v21, v21, v23
    s_waitcnt vmcnt(1)
    v_lshlrev_b32 v22, 16, v102
    v_and_b32 v23, 0xffff0000, v102
    v_add_f32 v20, v20, v22
    v_add_f32 v21, v21, v23
    s_waitcnt vmcnt(0)
    v_lshlrev_b32 v22, 16, v103
    v_and_b32 v23, 0xffff0000, v103
    v_add_f32 v20, v20, v22
    v_add_f32 v21, v21, v23
    v_cmp_u_f32 vcc, v20, v21
    v_cvt_pk_bf16_f32 v20, v20, v21
    s_cbranch_vccnz L_v_gf_265
L_v_gok_264:
    buffer_store_dword v20, v8, s[12:15], s61 offen sc1
    s_xor_b32 s45, s61, 0x8000
    buffer_store_dword v26, v8, s[12:15], s45 offen sc1
    s_bitcmp1_b32 s44, 0
    s_cbranch_scc1 L_v_nr_266
    s_xor_b32 s45, s62, 0x4000
    buffer_store_dword v26, v4, s[12:15], s45 offen sc1
L_v_nr_266:
    s_add_u32 s60, s60, 1
    s_add_u32 s62, s62, 0x2000
    s_and_b32 s62, s62, 0x7fff
    s_add_u32 s63, s63, 131072
    s_sleep 7
    s_branch L_v_loop_250
L_v_last_254:
    s_waitcnt lgkmcnt(0)
    s_barrier
    s_branch L_replica
L_v_l1_251:
    s_mov_b64 exec, s[48:49]
    s_cbranch_execz L_v_ls_267
    buffer_load_dwordx4 v[64:67], v9, s[12:15], s61 offen offset:0 sc1
L_v_ls_267:
    s_mov_b64 exec, s[50:51]
    s_cbranch_execz L_v_ls_268
    buffer_load_dwordx4 v[68:71], v9, s[12:15], s61 offen offset:1024 sc1
L_v_ls_268:
    s_mov_b64 exec, s[52:53]
    s_cbranch_execz L_v_ls_269
    buffer_load_dwordx4 v[72:75], v9, s[12:15], s61 offen offset:2048 sc1
L_v_ls_269:
    s_mov_b64 exec, s[54:55]
    s_cbranch_execz L_v_ls_270
    buffer_load_dwordx4 v[76:79], v9, s[12:15], s61 offen offset:3072 sc1
L_v_ls_270:
    s_mov_b64 exec, -1
    s_add_u32 s70, s70, 1
    s_cmp_ge_u32 s70, 524288
    s_cbranch_scc1 L_c_done_1
    s_waitcnt vmcnt(0)
    s_cmp_eq_u64 s[48:49], 0
    s_cbranch_scc1 L_v_lc_271
    ds_write_b128 v10, v[64:67] offset:0
    v_max3_u32 v24, v64, v65, v66
    v_max_u32 v24, v24, v67
    v_cmp_eq_u32 s[48:49], -1, v24
L_v_lc_271:
    s_cmp_eq_u64 s[50:51], 0
    s_cbranch_scc1 L_v_lc_272
    ds_write_b128 v10, v[68:71] offset:1024
    v_max3_u32 v24, v68, v69, v70
    v_max_u32 v24, v24, v71
    v_cmp_eq_u32 s[50:51], -1, v24
L_v_lc_272:
    s_cmp_eq_u64 s[52:53], 0
    s_cbranch_scc1 L_v_lc_273
    ds_write_b128 v10, v[72:75] offset:2048
    v_max3_u32 v24, v72, v73, v74
    v_max_u32 v24, v24, v75
    v_cmp_eq_u32 s[52:53], -1, v24
L_v_lc_273:
    s_cmp_eq_u64 s[54:55], 0
    s_cbranch_scc1 L_v_lc_274
    ds_write_b128 v10, v[76:79] offset:3072
    v_max3_u32 v24, v76, v77, v78
    v_max_u32 v24, v24, v79
    v_cmp_eq_u32 s[54:55], -1, v24
L_v_lc_274:
    s_or_b64 s[46:47], s[48:49], s[50:51]
    s_or_b64 vcc, s[52:53], s[54:55]
    s_or_b64 vcc, vcc, s[46:47]
    s_cbranch_scc1 L_v_l1_251
    s_branch L_v_l1ok_253
L_rt_257:
    s_add_u32 s70, s70, 1
    s_cmp_lt_u32 s70, 524288
    s_cbranch_scc1 L_v_rl_256
    s_branch L_c_done_1
L_rt_260:
    s_add_u32 s70, s70, 1
    s_cmp_lt_u32 s70, 524288
    s_cbranch_scc1 L_v_vp_259
    s_branch L_c_done_1
L_v_gf_265:
    v_max3_u32 v24, v96, v97, v98
    v_max3_u32 v24, v24, v99, v100
    v_max3_u32 v24, v24, v101, v102
    v_max_u32 v24, v24, v103
    v_cmp_eq_u32 vcc, -1, v24
    v_min_u32 v20, -2, v20
    s_add_u32 s70, s70, 1
    s_cbranch_vccz L_v_gok_264
    buffer_load_dword v96, v7, s[12:15], s63 offen offset:0 sc1
    buffer_load_dword v97, v7, s[12:15], s63 offen offset:256 sc1
    buffer_load_dword v98, v7, s[12:15], s63 offen offset:512 sc1
    buffer_load_dword v99, v7, s[12:15], s63 offen offset:768 sc1
    buffer_load_dword v100, v7, s[12:15], s63 offen offset:1024 sc1
    buffer_load_dword v101, v7, s[12:15], s63 offen offset:1280 sc1
    buffer_load_dword v102, v7, s[12:15], s63 offen offset:1536 sc1
    buffer_load_dword v103, v7, s[12:15], s63 offen offset:1792 sc1
    s_cmp_lt_u32 s70, 524288
    s_cbranch_scc1 L_v_gp_263
    s_branch L_c_done_1
L_c_done_1:
    s_endpgm
.section .rodata,"a"
.p2align 6
.amdhsa_kernel k3_chain_kernel
  .amdhsa_next_free_vgpr 256
  .amdhsa_next_free_sgpr 102
  .amdhsa_accum_offset 128
  .amdhsa_group_segment_fixed_size 0
  .amdhsa_kernarg_size 136
  .amdhsa_user_sgpr_count 2
  .amdhsa_user_sgpr_kernarg_segment_ptr 1
  .amdhsa_system_sgpr_workgroup_id_x 1
.end_amdhsa_kernel
```

```asm
; @launch kernel=k3_chain_kernel grid=(256,1,1) block=(512,1,1) lds=147712
.amdgcn_target "amdgcn-amd-amdhsa--gfx950"
.text
.globl k3_chain_kernel
.p2align 8
.type k3_chain_kernel,@function
k3_chain_kernel:
    s_cmp_ge_u32 s2, 256
    s_cbranch_scc1 L_c_done_1
    s_load_dwordx4 s[20:23], s[0:1], 120
    v_and_b32 v1, 63, v0
    v_lshrrev_b32 v2, 6, v0
    s_nop 0
    v_readfirstlane_b32 s44, v2
    s_waitcnt lgkmcnt(0)
    s_mov_b32 s12, s22
    s_and_b32 s13, s23, 0xffff
    s_mov_b32 s14, 0x10000000
    s_mov_b32 s15, 0x00020000
    s_mov_b32 s16, s20
    s_and_b32 s17, s21, 0xffff
    s_mov_b32 s18, 0x100
    s_mov_b32 s19, 0x00020000
    s_and_b32 s59, s2, 7
    s_lshl_b32 s59, s59, 21
    s_lshr_b32 s46, s2, 3
    s_lshl_b32 s46, s46, 16
    s_add_u32 s59, s59, s46
    s_lshl_b32 s46, s44, 8
    s_add_u32 s59, s59, s46
    s_add_u32 s59, s59, 0x7804000
    s_load_dword s47, s[22:23], s59
    s_load_dwordx4 s[8:11], s[0:1], 96
    v_lshrrev_b32 v5, 3, v0
    v_mul_u32_u24 v6, 24576, v5
    v_and_b32 v7, 7, v0
    v_lshl_add_u32 v6, v7, 4, v6
    v_add_u32 v7, 12288, v6
    v_lshlrev_b32 v5, 2, v5
    s_lshr_b32 s50, s2, 5
    s_and_b32 s51, s2, 31
    s_mul_i32 s52, s50, 1572864
    s_lshl_b32 s53, s51, 7
    s_add_u32 s52, s52, s53
    s_lshl_b32 s53, s50, 8
    s_waitcnt lgkmcnt(0)
    s_mov_b32 s28, s10
    s_and_b32 s29, s11, 0xffff
    s_mov_b32 s30, 0xc00000
    s_mov_b32 s31, 0x00020000
    s_mov_b32 s32, s8
    s_and_b32 s33, s9, 0xffff
    s_mov_b32 s34, 0x800
    s_mov_b32 s35, 0x00020000
    buffer_load_dword v8, v5, s[32:35], s53 offen
    buffer_load_dwordx4 v[12:15], v6, s[28:31], s52 offen
    buffer_load_dwordx4 v[16:19], v7, s[28:31], s52 offen
    s_getreg_b32 s39, hwreg(HW_REG_XCC_ID)
    s_and_b32 s39, s39, 7
    s_cmp_lg_u32 s44, 1
    s_cbranch_scc1 L_nz_5
    v_mov_b32 v32, 0
    v_mov_b32 v33, 0
    v_mov_b32 v34, 0
    v_mov_b32 v35, 0
    v_lshlrev_b32 v4, 4, v1
    s_lshl_b32 s45, s2, 10
    s_add_u32 s45, s45, 0x100000
    buffer_store_dwordx4 v[32:35], v4, s[12:15], s45 offen sc1
L_nz_5:
    s_cmp_lt_u32 s44, 4
    s_cbranch_scc1 L_nv_6
    s_mov_b32 s45, s59
    s_and_b32 s46, s44, 1
    s_lshl_b32 s46, s46, 13
    s_add_u32 s45, s45, s46
    s_add_u32 s45, s45, 0x4000
    s_xor_b32 s46, s45, 0x2000
    s_waitcnt lgkmcnt(0)
    s_memtime s[60:61]
    s_waitcnt lgkmcnt(0)
    s_load_dword s47, s[22:23], s45
    s_waitcnt lgkmcnt(0)
    s_memtime s[62:63]
    s_waitcnt lgkmcnt(0)
    s_load_dword s47, s[22:23], s46
    s_waitcnt lgkmcnt(0)
    s_memtime s[64:65]
    s_waitcnt lgkmcnt(0)
    s_sub_u32 s64, s64, s62
    s_sub_u32 s62, s62, s60
    s_cmp_gt_u32 s62, s64
    s_cselect_b32 s45, 1, 0
    s_xor_b32 s45, s45, s44
    s_lshr_b32 s46, s39, 2
    s_xor_b32 s45, s45, s46
    s_xor_b32 s45, s45, 1
    s_and_b32 s45, s45, 1
    v_mov_b32 v3, s45
    s_lshl_b32 s46, s44, 2
    s_add_u32 s46, s46, 147472
    v_mov_b32 v4, s46
    ds_write_b32 v4, v3
L_nv_6:
    s_waitcnt vmcnt(0)
    v_lshlrev_b32 v9, 16, v8
    v_and_b32 v10, 0xffff0000, v8
    v_mul_f32 v20, 0xbfb8aa3b, v9
    v_mul_f32 v21, 0xbfb8aa3b, v10
    v_exp_f32 v20, v20
    v_exp_f32 v21, v21
    s_nop 0
    v_add_f32 v20, 1.0, v20
    v_add_f32 v21, 1.0, v21
    v_rcp_f32 v20, v20
    v_rcp_f32 v21, v21
    s_nop 0
    v_mul_f32 v9, v9, v20
    v_mul_f32 v10, v10, v21
    v_cvt_pk_bf16_f32 v9, 0, v9
    v_cvt_pk_bf16_f32 v10, 0, v10
    v_lshlrev_b32 v28, 16, v12
    v_and_b32 v29, 0xffff0000, v12
    v_lshlrev_b32 v30, 16, v16
    v_and_b32 v31, 0xffff0000, v16
    v_mul_f32 v20, v28, v9
    v_mul_f32 v21, v29, v9
    v_fmac_f32 v20, v30, v10
    v_fmac_f32 v21, v31, v10
    v_lshlrev_b32 v28, 16, v13
    v_and_b32 v29, 0xffff0000, v13
    v_lshlrev_b32 v30, 16, v17
    v_and_b32 v31, 0xffff0000, v17
    v_mul_f32 v22, v28, v9
    v_mul_f32 v23, v29, v9
    v_fmac_f32 v22, v30, v10
    v_fmac_f32 v23, v31, v10
    v_lshlrev_b32 v28, 16, v14
    v_and_b32 v29, 0xffff0000, v14
    v_lshlrev_b32 v30, 16, v18
    v_and_b32 v31, 0xffff0000, v18
    v_mul_f32 v24, v28, v9
    v_mul_f32 v25, v29, v9
    v_fmac_f32 v24, v30, v10
    v_fmac_f32 v25, v31, v10
    v_lshlrev_b32 v28, 16, v15
    v_and_b32 v29, 0xffff0000, v15
    v_lshlrev_b32 v30, 16, v19
    v_and_b32 v31, 0xffff0000, v19
    v_mul_f32 v26, v28, v9
    v_mul_f32 v27, v29, v9
    v_fmac_f32 v26, v30, v10
    v_fmac_f32 v27, v31, v10
    s_nop 1
    v_add_f32_dpp v20, v20, v20 row_ror:8 row_mask:0xf bank_mask:0xf
    v_add_f32_dpp v21, v21, v21 row_ror:8 row_mask:0xf bank_mask:0xf
    v_add_f32_dpp v22, v22, v22 row_ror:8 row_mask:0xf bank_mask:0xf
    v_add_f32_dpp v23, v23, v23 row_ror:8 row_mask:0xf bank_mask:0xf
    v_add_f32_dpp v24, v24, v24 row_ror:8 row_mask:0xf bank_mask:0xf
    v_add_f32_dpp v25, v25, v25 row_ror:8 row_mask:0xf bank_mask:0xf
    v_add_f32_dpp v26, v26, v26 row_ror:8 row_mask:0xf bank_mask:0xf
    v_add_f32_dpp v27, v27, v27 row_ror:8 row_mask:0xf bank_mask:0xf
    s_nop 1
    v_permlane16_swap_b32 v20, v24
    v_permlane16_swap_b32 v21, v25
    v_permlane16_swap_b32 v22, v26
    v_permlane16_swap_b32 v23, v27
    v_add_f32 v20, v20, v24
    v_add_f32 v21, v21, v25
    v_add_f32 v22, v22, v26
    v_add_f32 v23, v23, v27
    s_nop 1
    v_permlane32_swap_b32 v20, v22
    v_permlane32_swap_b32 v21, v23
    v_add_f32 v20, v20, v22
    v_add_f32 v21, v21, v23
    v_and_b32 v22, 7, v1
    v_lshlrev_b32 v22, 5, v22
    v_bfe_u32 v23, v1, 4, 1
    v_lshl_add_u32 v22, v23, 4, v22
    v_lshrrev_b32 v23, 5, v1
    v_lshl_add_u32 v22, v23, 3, v22
    s_lshl_b32 s52, s44, 8
    s_add_u32 s52, s52, 139776
    v_add_u32 v22, s52, v22
    ds_write_b64 v22, v[20:21]
    s_waitcnt lgkmcnt(0)
    s_barrier
    s_cmp_lg_u32 s44, 1
    s_cbranch_scc1 L_m1_7
    v_lshlrev_b32 v22, 2, v1
    v_add_u32 v23, 139776, v22
    ds_read_b32 v24, v23 offset:0
    ds_read_b32 v25, v23 offset:256
    ds_read_b32 v26, v23 offset:512
    ds_read_b32 v27, v23 offset:768
    ds_read_b32 v28, v23 offset:1024
    ds_read_b32 v29, v23 offset:1280
    ds_read_b32 v30, v23 offset:1536
    ds_read_b32 v31, v23 offset:1792
    s_waitcnt lgkmcnt(0)
    v_add_f32 v24, v24, v28
    v_add_f32 v25, v25, v29
    v_add_f32 v26, v26, v30
    v_add_f32 v27, v27, v31
    v_add_f32 v24, v24, v26
    v_add_f32 v25, v25, v27
    v_add_f32 v24, v24, v25
    s_lshl_b32 s52, s2, 8
    s_add_u32 s52, s52, 0x10000
    buffer_store_dword v24, v22, s[12:15], s52 offen sc1
L_m1_7:
    s_cmp_lg_u32 s44, 1
    s_cbranch_scc1 L_tk_2
    v_mov_b32 v4, 147488
    ds_read_b128 v[32:35], v4
    s_and_b32 s45, s2, 7
    s_lshl_b32 s45, s45, 7
    s_lshr_b32 s46, s2, 3
    s_lshl_b32 s46, s46, 2
    s_add_u32 s45, s45, s46
    s_add_u32 s45, s45, 0x20000
    v_mov_b32 v4, 0
    s_waitcnt lgkmcnt(0)
    v_add3_u32 v32, v32, v33, v34
    v_add_u32 v32, v32, v35
    s_mov_b64 exec, 1
    buffer_store_dword v32, v4, s[12:15], s45 offen sc1
    s_mov_b64 exec, -1
    v_mov_b32 v3, 1
    s_mov_b32 s40, s39
    s_lshl_b32 s45, s40, 5
    v_mov_b32 v4, 0
    s_waitcnt vmcnt(0)
    s_mov_b64 exec, 1
    buffer_atomic_add v3, v4, s[16:19], s45 offen sc0
    s_waitcnt vmcnt(0)
    v_readfirstlane_b32 s41, v3
    s_nop 3
    s_cmp_lt_u32 s41, 32
    s_cbranch_scc1 L_got_3
    v_mov_b32 v3, 1
    buffer_atomic_add v3, v4, s[16:19], 0 offen offset:16 sc0
    s_waitcnt vmcnt(0)
    v_readfirstlane_b32 s46, v3
    s_mov_b64 exec, -1
    v_and_b32 v4, 7, v1
    v_lshlrev_b32 v4, 5, v4
    s_mov_b32 s70, 0
L_sp_4:
    s_sleep 8
    buffer_load_dword v3, v4, s[16:19], 0 offen sc1
    s_waitcnt vmcnt(0)
    s_mov_b32 s48, 0
    v_readlane_b32 s50, v3, 0
    v_readlane_b32 s51, v3, 1
    v_readlane_b32 s52, v3, 2
    v_readlane_b32 s53, v3, 3
    v_readlane_b32 s54, v3, 4
    v_readlane_b32 s55, v3, 5
    v_readlane_b32 s56, v3, 6
    v_readlane_b32 s57, v3, 7
    s_nop 3
    s_add_u32 s48, s48, s50
    s_add_u32 s48, s48, s51
    s_add_u32 s48, s48, s52
    s_add_u32 s48, s48, s53
    s_add_u32 s48, s48, s54
    s_add_u32 s48, s48, s55
    s_add_u32 s48, s48, s56
    s_add_u32 s48, s48, s57
    s_add_u32 s70, s70, 1
    s_cmp_ge_u32 s70, 524288
    s_cbranch_scc1 L_c_done_1
    s_cmp_lt_u32 s48, 256
    s_cbranch_scc1 L_sp_4
    s_min_u32 s48, s50, 32
    s_mov_b32 s40, 0
    s_add_u32 s41, s48, s46
    s_cmp_lt_u32 s41, 32
    s_cbranch_scc1 L_got_3
    s_sub_u32 s46, s41, 32
    s_min_u32 s48, s51, 32
    s_mov_b32 s40, 1
    s_add_u32 s41, s48, s46
    s_cmp_lt_u32 s41, 32
    s_cbranch_scc1 L_got_3
    s_sub_u32 s46, s41, 32
    s_min_u32 s48, s52, 32
    s_mov_b32 s40, 2
    s_add_u32 s41, s48, s46
    s_cmp_lt_u32 s41, 32
    s_cbranch_scc1 L_got_3
    s_sub_u32 s46, s41, 32
    s_min_u32 s48, s53, 32
    s_mov_b32 s40, 3
    s_add_u32 s41, s48, s46
    s_cmp_lt_u32 s41, 32
    s_cbranch_scc1 L_got_3
    s_sub_u32 s46, s41, 32
    s_min_u32 s48, s54, 32
    s_mov_b32 s40, 4
    s_add_u32 s41, s48, s46
    s_cmp_lt_u32 s41, 32
    s_cbranch_scc1 L_got_3
    s_sub_u32 s46, s41, 32
    s_min_u32 s48, s55, 32
    s_mov_b32 s40, 5
    s_add_u32 s41, s48, s46
    s_cmp_lt_u32 s41, 32
    s_cbranch_scc1 L_got_3
    s_sub_u32 s46, s41, 32
    s_min_u32 s48, s56, 32
    s_mov_b32 s40, 6
    s_add_u32 s41, s48, s46
    s_cmp_lt_u32 s41, 32
    s_cbranch_scc1 L_got_3
    s_sub_u32 s46, s41, 32
    s_min_u32 s48, s57, 32
    s_mov_b32 s40, 7
    s_add_u32 s41, s48, s46
    s_cmp_lt_u32 s41, 32
    s_cbranch_scc1 L_got_3
    s_sub_u32 s46, s41, 32
    s_branch L_c_done_1
L_got_3:
    s_mov_b64 exec, -1
    s_lshl_b32 s45, s40, 8
    s_or_b32 s45, s45, s41
    v_mov_b32 v3, s45
    v_mov_b32 v4, 147464
    ds_write_b32 v4, v3
    s_waitcnt lgkmcnt(0)
L_tk_2:
    s_barrier
    v_mov_b32 v4, 147464
    ds_read_b32 v3, v4
    s_waitcnt lgkmcnt(0)
    v_readfirstlane_b32 s45, v3
    s_nop 3
    s_lshr_b32 s40, s45, 8
    s_and_b32 s41, s45, 0xff
    s_lshr_b32 s45, s40, 2
    s_xor_b32 s45, s45, 1
    s_lshl_b32 s45, s45, 4
    s_and_b32 s40, s40, 3
    s_lshl_b32 s40, s40, 1
    s_lshr_b32 s46, s41, 4
    s_add_u32 s40, s40, s46
    s_and_b32 s41, s41, 15
    s_add_u32 s41, s41, s45
    s_cmp_lt_u32 s41, 16
    s_cbranch_scc1 L_c_chain_8
    s_sub_u32 s48, s41, 16
    s_cmp_lt_u32 s48, 12
    s_cbranch_scc1 L_w_g_9
    s_and_b32 s42, s48, 3
    s_mov_b32 s43, s40
    s_load_dwordx2 s[4:5], s[0:1], 0
    v_lshlrev_b32 v2, 4, v1
    v_lshlrev_b32 v3, 5, v1
    s_lshl_b32 s55, s43, 2
    s_add_u32 s55, s55, s42
    s_waitcnt lgkmcnt(0)
    s_mov_b32 s24, s4
    s_and_b32 s25, s5, 0xffff
    s_mov_b32 s26, 0x400000
    s_mov_b32 s27, 0x00020000
    s_lshl_b32 s46, s42, 3
    s_add_u32 s46, s46, s44
    s_lshl_b32 s46, s46, 11
    v_add_u32 v7, s46, v2
    s_lshl_b32 s63, s43, 16
    buffer_load_dwordx4 a[0:3], v7, s[24:27], s63 offen
    buffer_load_dwordx4 a[4:7], v7, s[24:27], s63 offen offset:1024
    s_cmp_lg_u32 s44, 0
    s_cbranch_scc1 L_zwok_18
    v_and_b32 v8, 7, v1
    v_lshlrev_b32 v8, 5, v8
    s_mov_b32 s70, 0
L_zw_17:
    buffer_load_dword v9, v8, s[16:19], 0 offen sc1
    s_waitcnt vmcnt(0)
    v_add_u32_dpp v9, v9, v9 row_ror:1 row_mask:0xf bank_mask:0xf
    s_nop 1
    v_add_u32_dpp v9, v9, v9 row_ror:2 row_mask:0xf bank_mask:0xf
    s_nop 1
    v_add_u32_dpp v9, v9, v9 row_ror:4 row_mask:0xf bank_mask:0xf
    v_cmp_ne_u32 vcc, 0x100, v9
    s_add_u32 s70, s70, 1
    s_cbranch_vccz L_zwok_18
    s_sleep 4
    s_cmp_lt_u32 s70, 524288
    s_cbranch_scc1 L_zw_17
    s_branch L_c_done_1
L_zwok_18:
    s_barrier
    v_lshlrev_b32 v4, 4, v0
    s_mov_b32 s46, 0x10000
    buffer_load_dwordx4 v[32:35], v4, s[12:15], s46 offen sc1
    s_mov_b32 s46, 0x12000
    buffer_load_dwordx4 v[36:39], v4, s[12:15], s46 offen sc1
    s_mov_b32 s46, 0x14000
    buffer_load_dwordx4 v[40:43], v4, s[12:15], s46 offen sc1
    s_mov_b32 s46, 0x16000
    buffer_load_dwordx4 v[44:47], v4, s[12:15], s46 offen sc1
    s_mov_b32 s46, 0x18000
    buffer_load_dwordx4 v[48:51], v4, s[12:15], s46 offen sc1
    s_mov_b32 s46, 0x1a000
    buffer_load_dwordx4 v[52:55], v4, s[12:15], s46 offen sc1
    s_mov_b32 s46, 0x1c000
    buffer_load_dwordx4 v[56:59], v4, s[12:15], s46 offen sc1
    s_mov_b32 s46, 0x1e000
    buffer_load_dwordx4 v[60:63], v4, s[12:15], s46 offen sc1
    s_cmp_lg_u32 s44, 0
    s_cbranch_scc1 L_l_nx_19
    s_cmp_ge_u32 s42, 2
    s_cbranch_scc1 L_l_nx_19
    s_or_b32 s47, s39, 0x100
    v_mov_b32 v8, s47
    v_mov_b32 v9, 0
    s_lshl_b32 s46, s40, 3
    s_lshl_b32 s47, s42, 2
    s_add_u32 s46, s46, s47
    s_add_u32 s46, s46, 0x101200
    s_mov_b64 exec, 1
    buffer_store_dword v8, v9, s[12:15], s46 offen sc1
    s_mov_b64 exec, -1
L_l_nx_19:
    s_mul_i32 s46, s44, 2064
    s_add_u32 s46, s46, 32768
    v_add_u32 v10, s46, v2
    v_and_b32 v11, 7, v1
    v_lshrrev_b32 v12, 3, v1
    v_mul_u32_u24 v13, 2064, v11
    v_lshl_add_u32 v13, v12, 4, v13
    s_lshl_b32 s46, s44, 8
    s_add_u32 s46, s46, 32768
    v_add_u32 v13, s46, v13
    v_lshlrev_b32 v11, 4, v11
    v_lshl_add_u32 v11, v12, 9, v11
    s_lshl_b32 s46, s44, 13
    s_lshl_b32 s47, s42, 7
    s_add_u32 s46, s46, s47
    s_add_u32 s46, s46, 0x400000
    v_add_u32 v11, s46, v11
    v_add_u32 v12, 4096, v11
    s_lshl_b32 s52, s43, 9
    s_lshl_b32 s47, s42, 7
    s_add_u32 s52, s52, s47
    s_add_u32 s52, s52, 0x109400
    s_mov_b32 s60, s43
    s_waitcnt vmcnt(0)
    v_add_f32 v32, v32, v48
    v_add_f32 v33, v33, v49
    v_add_f32 v34, v34, v50
    v_add_f32 v35, v35, v51
    v_add_f32 v36, v36, v52
    v_add_f32 v37, v37, v53
    v_add_f32 v38, v38, v54
    v_add_f32 v39, v39, v55
    v_add_f32 v40, v40, v56
    v_add_f32 v41, v41, v57
    v_add_f32 v42, v42, v58
    v_add_f32 v43, v43, v59
    v_add_f32 v44, v44, v60
    v_add_f32 v45, v45, v61
    v_add_f32 v46, v46, v62
    v_add_f32 v47, v47, v63
    v_add_f32 v32, v32, v40
    v_add_f32 v33, v33, v41
    v_add_f32 v34, v34, v42
    v_add_f32 v35, v35, v43
    v_add_f32 v36, v36, v44
    v_add_f32 v37, v37, v45
    v_add_f32 v38, v38, v46
    v_add_f32 v39, v39, v47
    v_add_f32 v32, v32, v36
    v_add_f32 v33, v33, v37
    v_add_f32 v34, v34, v38
    v_add_f32 v35, v35, v39
    v_cvt_pk_bf16_f32 v32, 0, v32
    v_cvt_pk_bf16_f32 v33, 0, v33
    v_cvt_pk_bf16_f32 v34, 0, v34
    v_cvt_pk_bf16_f32 v35, 0, v35
    ds_write_b128 v4, v[32:35]
    s_waitcnt lgkmcnt(0)
    s_barrier
    ds_read_b128 v[48:51], v3 offset:0
    ds_read_b128 v[52:55], v3 offset:16
    ds_read_b128 v[56:59], v3 offset:2048
    ds_read_b128 v[60:63], v3 offset:2064
    ds_read_b128 v[32:35], v3 offset:4096
    ds_read_b128 v[36:39], v3 offset:4112
    ds_read_b128 v[40:43], v3 offset:6144
    ds_read_b128 v[44:47], v3 offset:6160
    s_waitcnt lgkmcnt(0)
    v_add_f32 v32, 1.0, v32
    v_add_f32 v33, 1.0, v33
    v_add_f32 v34, 1.0, v34
    v_add_f32 v35, 1.0, v35
    v_add_f32 v36, 1.0, v36
    v_add_f32 v37, 1.0, v37
    v_add_f32 v38, 1.0, v38
    v_add_f32 v39, 1.0, v39
    v_add_f32 v40, 1.0, v40
    v_add_f32 v41, 1.0, v41
    v_add_f32 v42, 1.0, v42
    v_add_f32 v43, 1.0, v43
    v_add_f32 v44, 1.0, v44
    v_add_f32 v45, 1.0, v45
    v_add_f32 v46, 1.0, v46
    v_add_f32 v47, 1.0, v47
    v_cvt_pk_bf16_f32 v32, 0, v32
    v_cvt_pk_bf16_f32 v33, 0, v33
    v_cvt_pk_bf16_f32 v34, 0, v34
    v_cvt_pk_bf16_f32 v35, 0, v35
    v_cvt_pk_bf16_f32 v36, 0, v36
    v_cvt_pk_bf16_f32 v37, 0, v37
    v_cvt_pk_bf16_f32 v38, 0, v38
    v_cvt_pk_bf16_f32 v39, 0, v39
    v_cvt_pk_bf16_f32 v40, 0, v40
    v_cvt_pk_bf16_f32 v41, 0, v41
    v_cvt_pk_bf16_f32 v42, 0, v42
    v_cvt_pk_bf16_f32 v43, 0, v43
    v_cvt_pk_bf16_f32 v44, 0, v44
    v_cvt_pk_bf16_f32 v45, 0, v45
    v_cvt_pk_bf16_f32 v46, 0, v46
    v_cvt_pk_bf16_f32 v47, 0, v47
L_l_sub_20:
    s_lshl_b32 s63, s60, 16
    v_accvgpr_read_b32 v96, a0
    v_accvgpr_read_b32 v97, a1
    v_accvgpr_read_b32 v98, a2
    v_accvgpr_read_b32 v99, a3
    v_accvgpr_read_b32 v100, a4
    v_accvgpr_read_b32 v101, a5
    v_accvgpr_read_b32 v102, a6
    v_accvgpr_read_b32 v103, a7
    v_lshlrev_b32 v64, 16, v96
    v_and_b32 v65, 0xffff0000, v96
    v_lshlrev_b32 v66, 16, v97
    v_and_b32 v67, 0xffff0000, v97
    v_lshlrev_b32 v68, 16, v98
    v_and_b32 v69, 0xffff0000, v98
    v_lshlrev_b32 v70, 16, v99
    v_and_b32 v71, 0xffff0000, v99
    v_lshlrev_b32 v72, 16, v100
    v_and_b32 v73, 0xffff0000, v100
    v_lshlrev_b32 v74, 16, v101
    v_and_b32 v75, 0xffff0000, v101
    v_lshlrev_b32 v76, 16, v102
    v_and_b32 v77, 0xffff0000, v102
    v_lshlrev_b32 v78, 16, v103
    v_and_b32 v79, 0xffff0000, v103
    v_pk_add_f32 v[80:81], v[64:65], v[72:73]
    v_pk_add_f32 v[82:83], v[66:67], v[74:75]
    v_pk_add_f32 v[84:85], v[68:69], v[76:77]
    v_pk_add_f32 v[86:87], v[70:71], v[78:79]
    v_pk_add_f32 v[80:81], v[80:81], v[84:85]
    v_pk_add_f32 v[82:83], v[82:83], v[86:87]
    v_pk_add_f32 v[80:81], v[80:81], v[82:83]
    v_add_f32 v14, v80, v81
    s_nop 1
    v_add_f32_dpp v14, v14, v14 row_shr:1 row_mask:0xf bank_mask:0xf bound_ctrl:0
    s_nop 1
    v_add_f32_dpp v14, v14, v14 row_shr:2 row_mask:0xf bank_mask:0xf bound_ctrl:0
    s_nop 1
    v_add_f32_dpp v14, v14, v14 row_shr:4 row_mask:0xf bank_mask:0xf bound_ctrl:0
    s_nop 1
    v_add_f32_dpp v14, v14, v14 row_shr:8 row_mask:0xf bank_mask:0xf bound_ctrl:0
    s_nop 1
    v_add_f32_dpp v14, v14, v14 row_bcast:15 row_mask:0xa bank_mask:0xf
    s_nop 1
    v_add_f32_dpp v14, v14, v14 row_bcast:31 row_mask:0xc bank_mask:0xf
    s_nop 1
    v_readlane_b32 s46, v14, 63
    s_nop 1
    v_mov_b32 v15, s46
    v_mul_f32 v15, 0x3a800000, v15
    v_pk_add_f32 v[80:81], v[64:65], v[14:15] op_sel:[0,1] op_sel_hi:[1,1] neg_lo:[0,1] neg_hi:[0,1]
    v_pk_add_f32 v[82:83], v[66:67], v[14:15] op_sel:[0,1] op_sel_hi:[1,1] neg_lo:[0,1] neg_hi:[0,1]
    v_pk_add_f32 v[84:85], v[68:69], v[14:15] op_sel:[0,1] op_sel_hi:[1,1] neg_lo:[0,1] neg_hi:[0,1]
    v_pk_add_f32 v[86:87], v[70:71], v[14:15] op_sel:[0,1] op_sel_hi:[1,1] neg_lo:[0,1] neg_hi:[0,1]
    v_pk_add_f32 v[88:89], v[72:73], v[14:15] op_sel:[0,1] op_sel_hi:[1,1] neg_lo:[0,1] neg_hi:[0,1]
    v_pk_add_f32 v[90:91], v[74:75], v[14:15] op_sel:[0,1] op_sel_hi:[1,1] neg_lo:[0,1] neg_hi:[0,1]
    v_pk_add_f32 v[92:93], v[76:77], v[14:15] op_sel:[0,1] op_sel_hi:[1,1] neg_lo:[0,1] neg_hi:[0,1]
    v_pk_add_f32 v[94:95], v[78:79], v[14:15] op_sel:[0,1] op_sel_hi:[1,1] neg_lo:[0,1] neg_hi:[0,1]
    v_pk_mul_f32 v[104:105], v[80:81], v[80:81]
    v_pk_mul_f32 v[106:107], v[82:83], v[82:83]
    v_pk_fma_f32 v[104:105], v[84:85], v[84:85], v[104:105]
    v_pk_fma_f32 v[106:107], v[86:87], v[86:87], v[106:107]
    v_pk_fma_f32 v[104:105], v[88:89], v[88:89], v[104:105]
    v_pk_fma_f32 v[106:107], v[90:91], v[90:91], v[106:107]
    v_pk_fma_f32 v[104:105], v[92:93], v[92:93], v[104:105]
    v_pk_fma_f32 v[106:107], v[94:95], v[94:95], v[106:107]
    v_pk_add_f32 v[104:105], v[104:105], v[106:107]
    v_add_f32 v14, v104, v105
    v_cvt_pk_bf16_f32 v15, 0, v15
    s_nop 1
    v_add_f32_dpp v14, v14, v14 row_shr:1 row_mask:0xf bank_mask:0xf bound_ctrl:0
    s_nop 1
    v_add_f32_dpp v14, v14, v14 row_shr:2 row_mask:0xf bank_mask:0xf bound_ctrl:0
    s_nop 1
    v_add_f32_dpp v14, v14, v14 row_shr:4 row_mask:0xf bank_mask:0xf bound_ctrl:0
    s_nop 1
    v_add_f32_dpp v14, v14, v14 row_shr:8 row_mask:0xf bank_mask:0xf bound_ctrl:0
    s_nop 1
    v_add_f32_dpp v14, v14, v14 row_bcast:15 row_mask:0xa bank_mask:0xf
    s_nop 1
    v_add_f32_dpp v14, v14, v14 row_bcast:31 row_mask:0xc bank_mask:0xf
    s_nop 1
    v_readlane_b32 s47, v14, 63
    v_pk_add_f32 v[64:65], v[64:65], v[14:15] op_sel:[0,1] op_sel_hi:[1,1] neg_lo:[0,1] neg_hi:[0,1]
    v_pk_add_f32 v[66:67], v[66:67], v[14:15] op_sel:[0,1] op_sel_hi:[1,1] neg_lo:[0,1] neg_hi:[0,1]
    v_pk_add_f32 v[68:69], v[68:69], v[14:15] op_sel:[0,1] op_sel_hi:[1,1] neg_lo:[0,1] neg_hi:[0,1]
    v_pk_add_f32 v[70:71], v[70:71], v[14:15] op_sel:[0,1] op_sel_hi:[1,1] neg_lo:[0,1] neg_hi:[0,1]
    v_pk_add_f32 v[72:73], v[72:73], v[14:15] op_sel:[0,1] op_sel_hi:[1,1] neg_lo:[0,1] neg_hi:[0,1]
    v_pk_add_f32 v[74:75], v[74:75], v[14:15] op_sel:[0,1] op_sel_hi:[1,1] neg_lo:[0,1] neg_hi:[0,1]
    v_pk_add_f32 v[76:77], v[76:77], v[14:15] op_sel:[0,1] op_sel_hi:[1,1] neg_lo:[0,1] neg_hi:[0,1]
    v_pk_add_f32 v[78:79], v[78:79], v[14:15] op_sel:[0,1] op_sel_hi:[1,1] neg_lo:[0,1] neg_hi:[0,1]
    v_mov_b32 v14, s47
    v_mul_f32 v14, 0x3a800000, v14
    v_cvt_pk_bf16_f32 v14, 0, v14
    v_add_f32 v14, 0x3727c5ac, v14
    v_cvt_pk_bf16_f32 v14, 0, v14
    v_sqrt_f32 v14, v14
    s_nop 0
    v_cvt_pk_bf16_f32 v14, 0, v14
    v_rcp_f32 v14, v14
    v_cvt_pk_bf16_f32 v64, 0, v64
    v_cvt_pk_bf16_f32 v65, 0, v65
    v_cvt_pk_bf16_f32 v66, 0, v66
    v_cvt_pk_bf16_f32 v67, 0, v67
    v_cvt_pk_bf16_f32 v68, 0, v68
    v_cvt_pk_bf16_f32 v69, 0, v69
    v_cvt_pk_bf16_f32 v70, 0, v70
    v_cvt_pk_bf16_f32 v71, 0, v71
    v_cvt_pk_bf16_f32 v72, 0, v72
    v_cvt_pk_bf16_f32 v73, 0, v73
    v_cvt_pk_bf16_f32 v74, 0, v74
    v_cvt_pk_bf16_f32 v75, 0, v75
    v_cvt_pk_bf16_f32 v76, 0, v76
    v_cvt_pk_bf16_f32 v77, 0, v77
    v_cvt_pk_bf16_f32 v78, 0, v78
    v_cvt_pk_bf16_f32 v79, 0, v79
    v_pk_mul_f32 v[64:65], v[64:65], v[14:15] op_sel_hi:[1,0]
    v_pk_mul_f32 v[66:67], v[66:67], v[14:15] op_sel_hi:[1,0]
    v_pk_mul_f32 v[68:69], v[68:69], v[14:15] op_sel_hi:[1,0]
    v_pk_mul_f32 v[70:71], v[70:71], v[14:15] op_sel_hi:[1,0]
    v_pk_mul_f32 v[72:73], v[72:73], v[14:15] op_sel_hi:[1,0]
    v_pk_mul_f32 v[74:75], v[74:75], v[14:15] op_sel_hi:[1,0]
    v_pk_mul_f32 v[76:77], v[76:77], v[14:15] op_sel_hi:[1,0]
    v_pk_mul_f32 v[78:79], v[78:79], v[14:15] op_sel_hi:[1,0]
    v_cvt_pk_bf16_f32 v64, 0, v64
    v_cvt_pk_bf16_f32 v65, 0, v65
    v_cvt_pk_bf16_f32 v66, 0, v66
    v_cvt_pk_bf16_f32 v67, 0, v67
    v_cvt_pk_bf16_f32 v68, 0, v68
    v_cvt_pk_bf16_f32 v69, 0, v69
    v_cvt_pk_bf16_f32 v70, 0, v70
    v_cvt_pk_bf16_f32 v71, 0, v71
    v_cvt_pk_bf16_f32 v72, 0, v72
    v_cvt_pk_bf16_f32 v73, 0, v73
    v_cvt_pk_bf16_f32 v74, 0, v74
    v_cvt_pk_bf16_f32 v75, 0, v75
    v_cvt_pk_bf16_f32 v76, 0, v76
    v_cvt_pk_bf16_f32 v77, 0, v77
    v_cvt_pk_bf16_f32 v78, 0, v78
    v_cvt_pk_bf16_f32 v79, 0, v79
    v_pk_mul_f32 v[64:65], v[64:65], v[32:33]
    v_pk_mul_f32 v[66:67], v[66:67], v[34:35]
    v_pk_mul_f32 v[68:69], v[68:69], v[36:37]
    v_pk_mul_f32 v[70:71], v[70:71], v[38:39]
    v_pk_mul_f32 v[72:73], v[72:73], v[40:41]
    v_pk_mul_f32 v[74:75], v[74:75], v[42:43]
    v_pk_mul_f32 v[76:77], v[76:77], v[44:45]
    v_pk_mul_f32 v[78:79], v[78:79], v[46:47]
    v_cvt_pk_bf16_f32 v64, 0, v64
    v_cvt_pk_bf16_f32 v65, 0, v65
    v_cvt_pk_bf16_f32 v66, 0, v66
    v_cvt_pk_bf16_f32 v67, 0, v67
    v_cvt_pk_bf16_f32 v68, 0, v68
    v_cvt_pk_bf16_f32 v69, 0, v69
    v_cvt_pk_bf16_f32 v70, 0, v70
    v_cvt_pk_bf16_f32 v71, 0, v71
    v_cvt_pk_bf16_f32 v72, 0, v72
    v_cvt_pk_bf16_f32 v73, 0, v73
    v_cvt_pk_bf16_f32 v74, 0, v74
    v_cvt_pk_bf16_f32 v75, 0, v75
    v_cvt_pk_bf16_f32 v76, 0, v76
    v_cvt_pk_bf16_f32 v77, 0, v77
    v_cvt_pk_bf16_f32 v78, 0, v78
    v_cvt_pk_bf16_f32 v79, 0, v79
    v_pk_add_f32 v[64:65], v[64:65], v[48:49]
    v_pk_add_f32 v[66:67], v[66:67], v[50:51]
    v_pk_add_f32 v[68:69], v[68:69], v[52:53]
    v_pk_add_f32 v[70:71], v[70:71], v[54:55]
    v_pk_add_f32 v[72:73], v[72:73], v[56:57]
    v_pk_add_f32 v[74:75], v[74:75], v[58:59]
    v_pk_add_f32 v[76:77], v[76:77], v[60:61]
    v_pk_add_f32 v[78:79], v[78:79], v[62:63]
    v_cvt_pk_bf16_f32 v104, v64, v65
    v_cvt_pk_bf16_f32 v105, v66, v67
    v_cvt_pk_bf16_f32 v106, v68, v69
    v_cvt_pk_bf16_f32 v107, v70, v71
    v_cvt_pk_bf16_f32 v108, v72, v73
    v_cvt_pk_bf16_f32 v109, v74, v75
    v_cvt_pk_bf16_f32 v110, v76, v77
    v_cvt_pk_bf16_f32 v111, v78, v79
    ds_write_b128 v10, v[104:107]
    ds_write_b128 v10, v[108:111] offset:1024
    s_waitcnt lgkmcnt(0)
    s_barrier
    ds_read_b128 v[104:107], v13
    ds_read_b128 v[108:111], v13 offset:128
    s_waitcnt lgkmcnt(1)
    buffer_store_dwordx4 v[104:107], v11, s[12:15], s63 offen sc1
    s_waitcnt lgkmcnt(0)
    buffer_store_dwordx4 v[108:111], v12, s[12:15], s63 offen sc1
    s_waitcnt vmcnt(0)
    s_barrier
    s_cmp_lg_u32 s44, 0
    s_cbranch_scc1 L_sf_22
    v_mov_b32 v14, s60
    v_add_u32 v14, 1, v14
    v_mov_b32 v15, 0
    s_mov_b64 exec, 1
    buffer_store_dword v14, v15, s[12:15], s52 offen sc1
    s_mov_b64 exec, -1
L_sf_22:
    s_cmp_ge_u32 s60, 8
    s_cbranch_scc1 L_l_end_21
    s_add_u32 s63, s63, 524288
    buffer_load_dwordx4 a[8:11], v7, s[24:27], s63 offen
    buffer_load_dwordx4 a[12:15], v7, s[24:27], s63 offen offset:1024
    s_add_u32 s63, s63, 524288
    buffer_load_dwordx4 a[16:19], v7, s[24:27], s63 offen
    buffer_load_dwordx4 a[20:23], v7, s[24:27], s63 offen offset:1024
    s_add_u32 s63, s63, 524288
    buffer_load_dwordx4 a[24:27], v7, s[24:27], s63 offen
    buffer_load_dwordx4 a[28:31], v7, s[24:27], s63 offen offset:1024
    s_add_u32 s63, s63, 524288
    buffer_load_dwordx4 a[32:35], v7, s[24:27], s63 offen
    buffer_load_dwordx4 a[36:39], v7, s[24:27], s63 offen offset:1024
    s_add_u32 s63, s63, 524288
    buffer_load_dwordx4 a[40:43], v7, s[24:27], s63 offen
    buffer_load_dwordx4 a[44:47], v7, s[24:27], s63 offen offset:1024
    s_add_u32 s63, s63, 524288
    buffer_load_dwordx4 a[48:51], v7, s[24:27], s63 offen
    buffer_load_dwordx4 a[52:55], v7, s[24:27], s63 offen offset:1024
    s_add_u32 s63, s63, 524288
    buffer_load_dwordx4 a[56:59], v7, s[24:27], s63 offen
    buffer_load_dwordx4 a[60:63], v7, s[24:27], s63 offen offset:1024
    s_waitcnt vmcnt(0)
L_l_end_21:
    v_accvgpr_mov_b32 a0, a8
    v_accvgpr_mov_b32 a1, a9
    v_accvgpr_mov_b32 a2, a10
    v_accvgpr_mov_b32 a3, a11
    v_accvgpr_mov_b32 a4, a12
    v_accvgpr_mov_b32 a5, a13
    v_accvgpr_mov_b32 a6, a14
    v_accvgpr_mov_b32 a7, a15
    v_accvgpr_mov_b32 a8, a16
    v_accvgpr_mov_b32 a9, a17
    v_accvgpr_mov_b32 a10, a18
    v_accvgpr_mov_b32 a11, a19
    v_accvgpr_mov_b32 a12, a20
    v_accvgpr_mov_b32 a13, a21
    v_accvgpr_mov_b32 a14, a22
    v_accvgpr_mov_b32 a15, a23
    v_accvgpr_mov_b32 a16, a24
    v_accvgpr_mov_b32 a17, a25
    v_accvgpr_mov_b32 a18, a26
    v_accvgpr_mov_b32 a19, a27
    v_accvgpr_mov_b32 a20, a28
    v_accvgpr_mov_b32 a21, a29
    v_accvgpr_mov_b32 a22, a30
    v_accvgpr_mov_b32 a23, a31
    v_accvgpr_mov_b32 a24, a32
    v_accvgpr_mov_b32 a25, a33
    v_accvgpr_mov_b32 a26, a34
    v_accvgpr_mov_b32 a27, a35
    v_accvgpr_mov_b32 a28, a36
    v_accvgpr_mov_b32 a29, a37
    v_accvgpr_mov_b32 a30, a38
    v_accvgpr_mov_b32 a31, a39
    v_accvgpr_mov_b32 a32, a40
    v_accvgpr_mov_b32 a33, a41
    v_accvgpr_mov_b32 a34, a42
    v_accvgpr_mov_b32 a35, a43
    v_accvgpr_mov_b32 a36, a44
    v_accvgpr_mov_b32 a37, a45
    v_accvgpr_mov_b32 a38, a46
    v_accvgpr_mov_b32 a39, a47
    v_accvgpr_mov_b32 a40, a48
    v_accvgpr_mov_b32 a41, a49
    v_accvgpr_mov_b32 a42, a50
    v_accvgpr_mov_b32 a43, a51
    v_accvgpr_mov_b32 a44, a52
    v_accvgpr_mov_b32 a45, a53
    v_accvgpr_mov_b32 a46, a54
    v_accvgpr_mov_b32 a47, a55
    v_accvgpr_mov_b32 a48, a56
    v_accvgpr_mov_b32 a49, a57
    v_accvgpr_mov_b32 a50, a58
    v_accvgpr_mov_b32 a51, a59
    v_accvgpr_mov_b32 a52, a60
    v_accvgpr_mov_b32 a53, a61
    v_accvgpr_mov_b32 a54, a62
    v_accvgpr_mov_b32 a55, a63
    s_add_u32 s60, s60, 8
    s_cmp_lt_u32 s60, 64
    s_cbranch_scc1 L_l_sub_20
    s_cmp_lt_u32 s48, 14
    s_cbranch_scc1 L_w_h_16_s
    s_and_b32 s55, s48, 1
    s_lshl_b32 s55, s55, 3
    s_add_u32 s55, s55, s40
    s_load_dwordx4 s[8:11], s[0:1], 96
    v_lshrrev_b32 v5, 3, v0
    s_mov_b32 s46, 196608
    v_mul_lo_u32 v4, v5, s46
    v_and_b32 v6, 7, v0
    v_lshl_add_u32 v4, v6, 4, v4
    v_lshlrev_b32 v5, 5, v5
    s_waitcnt lgkmcnt(0)
    s_mov_b32 s28, s10
    s_and_b32 s29, s11, 0xffff
    s_mov_b32 s30, 0xc00000
    s_mov_b32 s31, 0x00020000
    s_mov_b32 s32, s8
    s_and_b32 s33, s9, 0xffff
    s_mov_b32 s34, 0x800
    s_mov_b32 s35, 0x00020000
    buffer_load_dwordx4 v[8:11], v5, s[32:35], 0 offen
    buffer_load_dwordx4 v[12:15], v5, s[32:35], 0 offen offset:16
    s_waitcnt vmcnt(0)
    v_lshlrev_b32 v16, 16, v8
    v_and_b32 v17, 0xffff0000, v8
    v_lshlrev_b32 v18, 16, v9
    v_and_b32 v19, 0xffff0000, v9
    v_lshlrev_b32 v20, 16, v10
    v_and_b32 v21, 0xffff0000, v10
    v_lshlrev_b32 v22, 16, v11
    v_and_b32 v23, 0xffff0000, v11
    v_lshlrev_b32 v24, 16, v12
    v_and_b32 v25, 0xffff0000, v12
    v_lshlrev_b32 v26, 16, v13
    v_and_b32 v27, 0xffff0000, v13
    v_lshlrev_b32 v28, 16, v14
    v_and_b32 v29, 0xffff0000, v14
    v_lshlrev_b32 v30, 16, v15
    v_and_b32 v31, 0xffff0000, v15
    v_mul_f32 v112, 0xbfb8aa3b, v16
    v_mul_f32 v113, 0xbfb8aa3b, v17
    v_mul_f32 v114, 0xbfb8aa3b, v18
    v_mul_f32 v115, 0xbfb8aa3b, v19
    v_mul_f32 v116, 0xbfb8aa3b, v20
    v_mul_f32 v117, 0xbfb8aa3b, v21
    v_mul_f32 v118, 0xbfb8aa3b, v22
    v_mul_f32 v119, 0xbfb8aa3b, v23
    v_mul_f32 v120, 0xbfb8aa3b, v24
    v_mul_f32 v121, 0xbfb8aa3b, v25
    v_mul_f32 v122, 0xbfb8aa3b, v26
    v_mul_f32 v123, 0xbfb8aa3b, v27
    v_mul_f32 v124, 0xbfb8aa3b, v28
    v_mul_f32 v125, 0xbfb8aa3b, v29
    v_mul_f32 v126, 0xbfb8aa3b, v30
    v_mul_f32 v127, 0xbfb8aa3b, v31
    v_exp_f32 v112, v112
    v_exp_f32 v113, v113
    v_exp_f32 v114, v114
    v_exp_f32 v115, v115
    v_exp_f32 v116, v116
    v_exp_f32 v117, v117
    v_exp_f32 v118, v118
    v_exp_f32 v119, v119
    v_exp_f32 v120, v120
    v_exp_f32 v121, v121
    v_exp_f32 v122, v122
    v_exp_f32 v123, v123
    v_exp_f32 v124, v124
    v_exp_f32 v125, v125
    v_exp_f32 v126, v126
    v_exp_f32 v127, v127
    v_add_f32 v112, 1.0, v112
    v_add_f32 v113, 1.0, v113
    v_add_f32 v114, 1.0, v114
    v_add_f32 v115, 1.0, v115
    v_add_f32 v116, 1.0, v116
    v_add_f32 v117, 1.0, v117
    v_add_f32 v118, 1.0, v118
    v_add_f32 v119, 1.0, v119
    v_add_f32 v120, 1.0, v120
    v_add_f32 v121, 1.0, v121
    v_add_f32 v122, 1.0, v122
    v_add_f32 v123, 1.0, v123
    v_add_f32 v124, 1.0, v124
    v_add_f32 v125, 1.0, v125
    v_add_f32 v126, 1.0, v126
    v_add_f32 v127, 1.0, v127
    v_rcp_f32 v112, v112
    v_rcp_f32 v113, v113
    v_rcp_f32 v114, v114
    v_rcp_f32 v115, v115
    v_rcp_f32 v116, v116
    v_rcp_f32 v117, v117
    v_rcp_f32 v118, v118
    v_rcp_f32 v119, v119
    v_rcp_f32 v120, v120
    v_rcp_f32 v121, v121
    v_rcp_f32 v122, v122
    v_rcp_f32 v123, v123
    v_rcp_f32 v124, v124
    v_rcp_f32 v125, v125
    v_rcp_f32 v126, v126
    v_rcp_f32 v127, v127
    v_mul_f32 v16, v16, v112
    v_mul_f32 v17, v17, v113
    v_mul_f32 v18, v18, v114
    v_mul_f32 v19, v19, v115
    v_mul_f32 v20, v20, v116
    v_mul_f32 v21, v21, v117
    v_mul_f32 v22, v22, v118
    v_mul_f32 v23, v23, v119
    v_mul_f32 v24, v24, v120
    v_mul_f32 v25, v25, v121
    v_mul_f32 v26, v26, v122
    v_mul_f32 v27, v27, v123
    v_mul_f32 v28, v28, v124
    v_mul_f32 v29, v29, v125
    v_mul_f32 v30, v30, v126
    v_mul_f32 v31, v31, v127
    v_cvt_pk_bf16_f32 v16, 0, v16
    v_cvt_pk_bf16_f32 v17, 0, v17
    v_cvt_pk_bf16_f32 v18, 0, v18
    v_cvt_pk_bf16_f32 v19, 0, v19
    v_cvt_pk_bf16_f32 v20, 0, v20
    v_cvt_pk_bf16_f32 v21, 0, v21
    v_cvt_pk_bf16_f32 v22, 0, v22
    v_cvt_pk_bf16_f32 v23, 0, v23
    v_cvt_pk_bf16_f32 v24, 0, v24
    v_cvt_pk_bf16_f32 v25, 0, v25
    v_cvt_pk_bf16_f32 v26, 0, v26
    v_cvt_pk_bf16_f32 v27, 0, v27
    v_cvt_pk_bf16_f32 v28, 0, v28
    v_cvt_pk_bf16_f32 v29, 0, v29
    v_cvt_pk_bf16_f32 v30, 0, v30
    v_cvt_pk_bf16_f32 v31, 0, v31
    s_lshl_b32 s53, s55, 9
    s_add_u32 s53, s53, 4096
L_m_loop_23:
    s_add_u32 s46, s53, 0
    buffer_load_dwordx4 v[32:35], v4, s[28:31], s46 offen
    s_add_u32 s46, s53, 12288
    buffer_load_dwordx4 v[36:39], v4, s[28:31], s46 offen
    s_add_u32 s46, s53, 24576
    buffer_load_dwordx4 v[40:43], v4, s[28:31], s46 offen
    s_add_u32 s46, s53, 36864
    buffer_load_dwordx4 v[44:47], v4, s[28:31], s46 offen
    s_add_u32 s46, s53, 49152
    buffer_load_dwordx4 v[48:51], v4, s[28:31], s46 offen
    s_add_u32 s46, s53, 61440
    buffer_load_dwordx4 v[52:55], v4, s[28:31], s46 offen
    s_add_u32 s46, s53, 73728
    buffer_load_dwordx4 v[56:59], v4, s[28:31], s46 offen
    s_add_u32 s46, s53, 86016
    buffer_load_dwordx4 v[60:63], v4, s[28:31], s46 offen
    s_add_u32 s46, s53, 98304
    buffer_load_dwordx4 v[64:67], v4, s[28:31], s46 offen
    s_add_u32 s46, s53, 110592
    buffer_load_dwordx4 v[68:71], v4, s[28:31], s46 offen
    s_add_u32 s46, s53, 122880
    buffer_load_dwordx4 v[72:75], v4, s[28:31], s46 offen
    s_add_u32 s46, s53, 135168
    buffer_load_dwordx4 v[76:79], v4, s[28:31], s46 offen
    s_add_u32 s46, s53, 147456
    buffer_load_dwordx4 v[80:83], v4, s[28:31], s46 offen
    s_add_u32 s46, s53, 159744
    buffer_load_dwordx4 v[84:87], v4, s[28:31], s46 offen
    s_add_u32 s46, s53, 172032
    buffer_load_dwordx4 v[88:91], v4, s[28:31], s46 offen
    s_add_u32 s46, s53, 184320
    buffer_load_dwordx4 v[92:95], v4, s[28:31], s46 offen
    s_waitcnt vmcnt(15)
    v_lshlrev_b32 v104, 16, v32
    v_and_b32 v105, 0xffff0000, v32
    v_mul_f32 v96, v104, v16
    v_mul_f32 v97, v105, v16
    v_lshlrev_b32 v104, 16, v33
    v_and_b32 v105, 0xffff0000, v33
    v_mul_f32 v98, v104, v16
    v_mul_f32 v99, v105, v16
    v_lshlrev_b32 v104, 16, v34
    v_and_b32 v105, 0xffff0000, v34
    v_mul_f32 v100, v104, v16
    v_mul_f32 v101, v105, v16
    v_lshlrev_b32 v104, 16, v35
    v_and_b32 v105, 0xffff0000, v35
    v_mul_f32 v102, v104, v16
    v_mul_f32 v103, v105, v16
    s_waitcnt vmcnt(14)
    v_lshlrev_b32 v104, 16, v36
    v_and_b32 v105, 0xffff0000, v36
    v_fmac_f32 v96, v104, v17
    v_fmac_f32 v97, v105, v17
    v_lshlrev_b32 v104, 16, v37
    v_and_b32 v105, 0xffff0000, v37
    v_fmac_f32 v98, v104, v17
    v_fmac_f32 v99, v105, v17
    v_lshlrev_b32 v104, 16, v38
    v_and_b32 v105, 0xffff0000, v38
    v_fmac_f32 v100, v104, v17
    v_fmac_f32 v101, v105, v17
    v_lshlrev_b32 v104, 16, v39
    v_and_b32 v105, 0xffff0000, v39
    v_fmac_f32 v102, v104, v17
    v_fmac_f32 v103, v105, v17
    s_waitcnt vmcnt(13)
    v_lshlrev_b32 v104, 16, v40
    v_and_b32 v105, 0xffff0000, v40
    v_fmac_f32 v96, v104, v18
    v_fmac_f32 v97, v105, v18
    v_lshlrev_b32 v104, 16, v41
    v_and_b32 v105, 0xffff0000, v41
    v_fmac_f32 v98, v104, v18
    v_fmac_f32 v99, v105, v18
    v_lshlrev_b32 v104, 16, v42
    v_and_b32 v105, 0xffff0000, v42
    v_fmac_f32 v100, v104, v18
    v_fmac_f32 v101, v105, v18
    v_lshlrev_b32 v104, 16, v43
    v_and_b32 v105, 0xffff0000, v43
    v_fmac_f32 v102, v104, v18
    v_fmac_f32 v103, v105, v18
    s_waitcnt vmcnt(12)
    v_lshlrev_b32 v104, 16, v44
    v_and_b32 v105, 0xffff0000, v44
    v_fmac_f32 v96, v104, v19
    v_fmac_f32 v97, v105, v19
    v_lshlrev_b32 v104, 16, v45
    v_and_b32 v105, 0xffff0000, v45
    v_fmac_f32 v98, v104, v19
    v_fmac_f32 v99, v105, v19
    v_lshlrev_b32 v104, 16, v46
    v_and_b32 v105, 0xffff0000, v46
    v_fmac_f32 v100, v104, v19
    v_fmac_f32 v101, v105, v19
    v_lshlrev_b32 v104, 16, v47
    v_and_b32 v105, 0xffff0000, v47
    v_fmac_f32 v102, v104, v19
    v_fmac_f32 v103, v105, v19
    s_waitcnt vmcnt(11)
    v_lshlrev_b32 v104, 16, v48
    v_and_b32 v105, 0xffff0000, v48
    v_fmac_f32 v96, v104, v20
    v_fmac_f32 v97, v105, v20
    v_lshlrev_b32 v104, 16, v49
    v_and_b32 v105, 0xffff0000, v49
    v_fmac_f32 v98, v104, v20
    v_fmac_f32 v99, v105, v20
    v_lshlrev_b32 v104, 16, v50
    v_and_b32 v105, 0xffff0000, v50
    v_fmac_f32 v100, v104, v20
    v_fmac_f32 v101, v105, v20
    v_lshlrev_b32 v104, 16, v51
    v_and_b32 v105, 0xffff0000, v51
    v_fmac_f32 v102, v104, v20
    v_fmac_f32 v103, v105, v20
    s_waitcnt vmcnt(10)
    v_lshlrev_b32 v104, 16, v52
    v_and_b32 v105, 0xffff0000, v52
    v_fmac_f32 v96, v104, v21
    v_fmac_f32 v97, v105, v21
    v_lshlrev_b32 v104, 16, v53
    v_and_b32 v105, 0xffff0000, v53
    v_fmac_f32 v98, v104, v21
    v_fmac_f32 v99, v105, v21
    v_lshlrev_b32 v104, 16, v54
    v_and_b32 v105, 0xffff0000, v54
    v_fmac_f32 v100, v104, v21
    v_fmac_f32 v101, v105, v21
    v_lshlrev_b32 v104, 16, v55
    v_and_b32 v105, 0xffff0000, v55
    v_fmac_f32 v102, v104, v21
    v_fmac_f32 v103, v105, v21
    s_waitcnt vmcnt(9)
    v_lshlrev_b32 v104, 16, v56
    v_and_b32 v105, 0xffff0000, v56
    v_fmac_f32 v96, v104, v22
    v_fmac_f32 v97, v105, v22
    v_lshlrev_b32 v104, 16, v57
    v_and_b32 v105, 0xffff0000, v57
    v_fmac_f32 v98, v104, v22
    v_fmac_f32 v99, v105, v22
    v_lshlrev_b32 v104, 16, v58
    v_and_b32 v105, 0xffff0000, v58
    v_fmac_f32 v100, v104, v22
    v_fmac_f32 v101, v105, v22
    v_lshlrev_b32 v104, 16, v59
    v_and_b32 v105, 0xffff0000, v59
    v_fmac_f32 v102, v104, v22
    v_fmac_f32 v103, v105, v22
    s_waitcnt vmcnt(8)
    v_lshlrev_b32 v104, 16, v60
    v_and_b32 v105, 0xffff0000, v60
    v_fmac_f32 v96, v104, v23
    v_fmac_f32 v97, v105, v23
    v_lshlrev_b32 v104, 16, v61
    v_and_b32 v105, 0xffff0000, v61
    v_fmac_f32 v98, v104, v23
    v_fmac_f32 v99, v105, v23
    v_lshlrev_b32 v104, 16, v62
    v_and_b32 v105, 0xffff0000, v62
    v_fmac_f32 v100, v104, v23
    v_fmac_f32 v101, v105, v23
    v_lshlrev_b32 v104, 16, v63
    v_and_b32 v105, 0xffff0000, v63
    v_fmac_f32 v102, v104, v23
    v_fmac_f32 v103, v105, v23
    s_waitcnt vmcnt(7)
    v_lshlrev_b32 v104, 16, v64
    v_and_b32 v105, 0xffff0000, v64
    v_fmac_f32 v96, v104, v24
    v_fmac_f32 v97, v105, v24
    v_lshlrev_b32 v104, 16, v65
    v_and_b32 v105, 0xffff0000, v65
    v_fmac_f32 v98, v104, v24
    v_fmac_f32 v99, v105, v24
    v_lshlrev_b32 v104, 16, v66
    v_and_b32 v105, 0xffff0000, v66
    v_fmac_f32 v100, v104, v24
    v_fmac_f32 v101, v105, v24
    v_lshlrev_b32 v104, 16, v67
    v_and_b32 v105, 0xffff0000, v67
    v_fmac_f32 v102, v104, v24
    v_fmac_f32 v103, v105, v24
    s_waitcnt vmcnt(6)
    v_lshlrev_b32 v104, 16, v68
    v_and_b32 v105, 0xffff0000, v68
    v_fmac_f32 v96, v104, v25
    v_fmac_f32 v97, v105, v25
    v_lshlrev_b32 v104, 16, v69
    v_and_b32 v105, 0xffff0000, v69
    v_fmac_f32 v98, v104, v25
    v_fmac_f32 v99, v105, v25
    v_lshlrev_b32 v104, 16, v70
    v_and_b32 v105, 0xffff0000, v70
    v_fmac_f32 v100, v104, v25
    v_fmac_f32 v101, v105, v25
    v_lshlrev_b32 v104, 16, v71
    v_and_b32 v105, 0xffff0000, v71
    v_fmac_f32 v102, v104, v25
    v_fmac_f32 v103, v105, v25
    s_waitcnt vmcnt(5)
    v_lshlrev_b32 v104, 16, v72
    v_and_b32 v105, 0xffff0000, v72
    v_fmac_f32 v96, v104, v26
    v_fmac_f32 v97, v105, v26
    v_lshlrev_b32 v104, 16, v73
    v_and_b32 v105, 0xffff0000, v73
    v_fmac_f32 v98, v104, v26
    v_fmac_f32 v99, v105, v26
    v_lshlrev_b32 v104, 16, v74
    v_and_b32 v105, 0xffff0000, v74
    v_fmac_f32 v100, v104, v26
    v_fmac_f32 v101, v105, v26
    v_lshlrev_b32 v104, 16, v75
    v_and_b32 v105, 0xffff0000, v75
    v_fmac_f32 v102, v104, v26
    v_fmac_f32 v103, v105, v26
    s_waitcnt vmcnt(4)
    v_lshlrev_b32 v104, 16, v76
    v_and_b32 v105, 0xffff0000, v76
    v_fmac_f32 v96, v104, v27
    v_fmac_f32 v97, v105, v27
    v_lshlrev_b32 v104, 16, v77
    v_and_b32 v105, 0xffff0000, v77
    v_fmac_f32 v98, v104, v27
    v_fmac_f32 v99, v105, v27
    v_lshlrev_b32 v104, 16, v78
    v_and_b32 v105, 0xffff0000, v78
    v_fmac_f32 v100, v104, v27
    v_fmac_f32 v101, v105, v27
    v_lshlrev_b32 v104, 16, v79
    v_and_b32 v105, 0xffff0000, v79
    v_fmac_f32 v102, v104, v27
    v_fmac_f32 v103, v105, v27
    s_waitcnt vmcnt(3)
    v_lshlrev_b32 v104, 16, v80
    v_and_b32 v105, 0xffff0000, v80
    v_fmac_f32 v96, v104, v28
    v_fmac_f32 v97, v105, v28
    v_lshlrev_b32 v104, 16, v81
    v_and_b32 v105, 0xffff0000, v81
    v_fmac_f32 v98, v104, v28
    v_fmac_f32 v99, v105, v28
    v_lshlrev_b32 v104, 16, v82
    v_and_b32 v105, 0xffff0000, v82
    v_fmac_f32 v100, v104, v28
    v_fmac_f32 v101, v105, v28
    v_lshlrev_b32 v104, 16, v83
    v_and_b32 v105, 0xffff0000, v83
    v_fmac_f32 v102, v104, v28
    v_fmac_f32 v103, v105, v28
    s_waitcnt vmcnt(2)
    v_lshlrev_b32 v104, 16, v84
    v_and_b32 v105, 0xffff0000, v84
    v_fmac_f32 v96, v104, v29
    v_fmac_f32 v97, v105, v29
    v_lshlrev_b32 v104, 16, v85
    v_and_b32 v105, 0xffff0000, v85
    v_fmac_f32 v98, v104, v29
    v_fmac_f32 v99, v105, v29
    v_lshlrev_b32 v104, 16, v86
    v_and_b32 v105, 0xffff0000, v86
    v_fmac_f32 v100, v104, v29
    v_fmac_f32 v101, v105, v29
    v_lshlrev_b32 v104, 16, v87
    v_and_b32 v105, 0xffff0000, v87
    v_fmac_f32 v102, v104, v29
    v_fmac_f32 v103, v105, v29
    s_waitcnt vmcnt(1)
    v_lshlrev_b32 v104, 16, v88
    v_and_b32 v105, 0xffff0000, v88
    v_fmac_f32 v96, v104, v30
    v_fmac_f32 v97, v105, v30
    v_lshlrev_b32 v104, 16, v89
    v_and_b32 v105, 0xffff0000, v89
    v_fmac_f32 v98, v104, v30
    v_fmac_f32 v99, v105, v30
    v_lshlrev_b32 v104, 16, v90
    v_and_b32 v105, 0xffff0000, v90
    v_fmac_f32 v100, v104, v30
    v_fmac_f32 v101, v105, v30
    v_lshlrev_b32 v104, 16, v91
    v_and_b32 v105, 0xffff0000, v91
    v_fmac_f32 v102, v104, v30
    v_fmac_f32 v103, v105, v30
    s_waitcnt vmcnt(0)
    v_lshlrev_b32 v104, 16, v92
    v_and_b32 v105, 0xffff0000, v92
    v_fmac_f32 v96, v104, v31
    v_fmac_f32 v97, v105, v31
    v_lshlrev_b32 v104, 16, v93
    v_and_b32 v105, 0xffff0000, v93
    v_fmac_f32 v98, v104, v31
    v_fmac_f32 v99, v105, v31
    v_lshlrev_b32 v104, 16, v94
    v_and_b32 v105, 0xffff0000, v94
    v_fmac_f32 v100, v104, v31
    v_fmac_f32 v101, v105, v31
    v_lshlrev_b32 v104, 16, v95
    v_and_b32 v105, 0xffff0000, v95
    v_fmac_f32 v102, v104, v31
    v_fmac_f32 v103, v105, v31
    v_lshlrev_b32 v104, 5, v0
    ds_write_b128 v104, v[96:99]
    ds_write_b128 v104, v[100:103] offset:16
    v_lshlrev_b32 v105, 2, v1
    s_lshl_b32 s46, s44, 11
    v_add_u32 v104, s46, v105
    s_waitcnt lgkmcnt(0)
    ds_read_b32 v96, v104 offset:0
    ds_read_b32 v97, v104 offset:256
    ds_read_b32 v98, v104 offset:512
    ds_read_b32 v99, v104 offset:768
    ds_read_b32 v100, v104 offset:1024
    ds_read_b32 v101, v104 offset:1280
    ds_read_b32 v102, v104 offset:1536
    ds_read_b32 v103, v104 offset:1792
    s_waitcnt lgkmcnt(0)
    v_add_f32 v96, v96, v100
    v_add_f32 v97, v97, v101
    v_add_f32 v98, v98, v102
    v_add_f32 v99, v99, v103
    v_add_f32 v96, v96, v98
    v_add_f32 v97, v97, v99
    v_add_f32 v96, v96, v97
    v_lshlrev_b32 v104, 2, v0
    ds_write_b32 v104, v96 offset:16384
    s_waitcnt lgkmcnt(0)
    s_barrier
    s_cmp_lg_u32 s44, 0
    s_cbranch_scc1 L_m_sk_24
    ds_read_b32 v96, v105 offset:16384
    ds_read_b32 v97, v105 offset:16640
    ds_read_b32 v98, v105 offset:16896
    ds_read_b32 v99, v105 offset:17152
    ds_read_b32 v100, v105 offset:17408
    ds_read_b32 v101, v105 offset:17664
    ds_read_b32 v102, v105 offset:17920
    ds_read_b32 v103, v105 offset:18176
    s_waitcnt lgkmcnt(0)
    v_add_f32 v96, v96, v100
    v_add_f32 v97, v97, v101
    v_add_f32 v98, v98, v102
    v_add_f32 v99, v99, v103
    v_add_f32 v96, v96, v98
    v_add_f32 v97, v97, v99
    v_add_f32 v96, v96, v97
    v_cvt_pk_bf16_f32 v96, 0, v96
    s_lshl_b32 s46, s53, 1
    buffer_store_dword v96, v105, s[12:15], s46 offen sc1
L_m_sk_24:
    s_barrier
    s_add_u32 s53, s53, 128
    s_and_b32 s46, s53, 511
    s_cmp_lg_u32 s46, 0
    s_cbranch_scc1 L_m_loop_23
    s_lshl_b32 s54, s55, 7
    s_add_u32 s54, s54, 0x10e400
    s_mov_b32 s60, 0
    s_waitcnt vmcnt(0)
    s_cmp_lg_u32 s44, 0
    s_cbranch_scc1 L_sf_25
    v_mov_b32 v8, s60
    v_add_u32 v8, 1, v8
    v_mov_b32 v9, 0
    s_mov_b64 exec, 1
    buffer_store_dword v8, v9, s[12:15], s54 offen sc1
    s_mov_b64 exec, -1
L_sf_25:
    s_barrier
L_w_h_16_s:
    s_mov_b32 s77, s48
    s_cmp_lt_u32 s48, 14
    s_cselect_b32 s53, 1, 2
    s_cselect_b32 s74, 50, 53
    s_mov_b32 s75, 64
    s_mov_b32 s76, 65536
    s_and_b32 s48, s48, 1
    s_lshl_b32 s48, s48, 1
    s_add_u32 s79, s48, 2
    s_cmp_lt_u32 s74, s75
    s_cbranch_scc1 L_w_g_9_e
L_w_h_16:
    s_mov_b32 s48, s77
    s_cmp_lt_u32 s48, 14
    s_cbranch_scc1 L_w_att_14
    s_and_b32 s42, s40, 3
    s_lshr_b32 s43, s40, 2
    s_cmp_eq_u32 s48, 14
    s_cbranch_scc1 L_w_c_15
    s_mov_b32 s75, 60
    s_mov_b32 s76, 0
    s_mov_b32 s78, 2
L_w_h_16_f:
    s_load_dwordx2 s[4:5], s[0:1], 112
    s_load_dwordx2 s[6:7], s[0:1], 88
    v_lshlrev_b32 v2, 4, v1
    v_lshlrev_b32 v3, 5, v1
    s_waitcnt lgkmcnt(0)
    s_mov_b32 s24, s4
    s_and_b32 s25, s5, 0xffff
    s_mov_b32 s26, 0x400000
    s_mov_b32 s27, 0x00020000
    s_mov_b32 s28, s6
    s_and_b32 s29, s7, 0xffff
    s_mov_b32 s30, 0x800
    s_mov_b32 s31, 0x00020000
    s_cmp_lg_u32 s44, 0
    s_cbranch_scc1 L_mw_26
    v_and_b32 v8, 15, v1
    v_lshlrev_b32 v8, 7, v8
    s_mov_b32 s46, 0x10e400
    s_mov_b32 s47, 0
    s_mov_b32 s70, 0
L_spin_27:
    buffer_load_dword v9, v8, s[12:15], s46 offen sc1
    s_waitcnt vmcnt(0)
    v_cmp_ge_u32 vcc, s47, v9
    s_add_u32 s70, s70, 1
    s_cbranch_vccz L_spok_28
    s_sleep 2
    s_cmp_lt_u32 s70, 524288
    s_cbranch_scc1 L_spin_27
    s_branch L_c_done_1
L_spok_28:
L_mw_26:
    s_barrier
    s_mov_b32 s46, 20480
    buffer_load_dwordx4 v[16:19], v3, s[12:15], s46 offen offset:0 sc1
    buffer_load_dwordx4 v[20:23], v3, s[12:15], s46 offen offset:16 sc1
    buffer_load_dwordx4 v[24:27], v3, s[12:15], s46 offen offset:2048 sc1
    buffer_load_dwordx4 v[28:31], v3, s[12:15], s46 offen offset:2064 sc1
    buffer_load_dwordx4 v[48:51], v2, s[28:31], 0 offen
    buffer_load_dwordx4 v[52:55], v2, s[28:31], 0 offen offset:1024
    s_waitcnt vmcnt(0)
    v_lshlrev_b32 v32, 16, v48
    v_and_b32 v33, 0xffff0000, v48
    v_lshlrev_b32 v34, 16, v49
    v_and_b32 v35, 0xffff0000, v49
    v_lshlrev_b32 v36, 16, v50
    v_and_b32 v37, 0xffff0000, v50
    v_lshlrev_b32 v38, 16, v51
    v_and_b32 v39, 0xffff0000, v51
    v_lshlrev_b32 v40, 16, v52
    v_and_b32 v41, 0xffff0000, v52
    v_lshlrev_b32 v42, 16, v53
    v_and_b32 v43, 0xffff0000, v53
    v_lshlrev_b32 v44, 16, v54
    v_and_b32 v45, 0xffff0000, v54
    v_lshlrev_b32 v46, 16, v55
    v_and_b32 v47, 0xffff0000, v55
    s_lshl_b32 s46, s42, 14
    s_lshl_b32 s47, s44, 11
    s_add_u32 s46, s46, s47
    s_add_u32 s46, s46, 0xb000000
    v_add_u32 v4, s46, v2
    v_and_b32 v5, 31, v1
    v_lshlrev_b32 v5, 7, v5
    v_add_u32 v5, 0x108400, v5
    v_lshlrev_b32 v6, 2, v1
    s_lshl_b32 s46, s44, 9
    v_add_u32 v6, s46, v6
    s_lshl_b32 s46, s44, 12
    v_add_u32 v7, s46, v3
    s_lshl_b32 s46, s42, 3
    s_add_u32 s46, s46, s44
    s_lshl_b32 s46, s46, 11
    v_add_u32 v8, s46, v2
    v_add_u32 v9, 0x800000, v8
    s_mov_b32 s60, s43
L_r_loop_29:
    s_lshl_b32 s61, s60, 18
    s_lshl_b32 s63, s60, 16
    s_cmp_lg_u32 s44, 0
    s_cbranch_scc1 L_r_nsp_30
    s_mov_b32 s70, 0
L_spin_31:
    buffer_load_dword v14, v5, s[12:15], s76 offen sc1
    s_waitcnt vmcnt(0)
    v_cmp_ge_u32 vcc, s60, v14
    s_add_u32 s70, s70, 1
    s_cbranch_vccz L_spok_32
    s_sleep 3
    s_cmp_lt_u32 s70, 524288
    s_cbranch_scc1 L_spin_31
    s_branch L_c_done_1
L_spok_32:
L_r_nsp_30:
    s_barrier
    buffer_load_dwordx4 v[96:99], v4, s[12:15], s61 offen offset:0 sc1
    buffer_load_dwordx4 v[100:103], v4, s[12:15], s61 offen offset:1024 sc1
    s_add_u32 s61, s61, 65536
    buffer_load_dwordx4 v[104:107], v4, s[12:15], s61 offen offset:0 sc1
    buffer_load_dwordx4 v[108:111], v4, s[12:15], s61 offen offset:1024 sc1
    s_add_u32 s61, s61, 65536
    buffer_load_dwordx4 v[112:115], v4, s[12:15], s61 offen offset:0 sc1
    buffer_load_dwordx4 v[116:119], v4, s[12:15], s61 offen offset:1024 sc1
    s_add_u32 s61, s61, 65536
    buffer_load_dwordx4 v[120:123], v4, s[12:15], s61 offen offset:0 sc1
    buffer_load_dwordx4 v[124:127], v4, s[12:15], s61 offen offset:1024 sc1
    buffer_load_dwordx4 a[0:3], v9, s[12:15], s63 offen sc1
    buffer_load_dwordx4 a[4:7], v9, s[12:15], s63 offen offset:1024 sc1
    s_waitcnt vmcnt(8)
    v_lshlrev_b32 v64, 16, v96
    v_and_b32 v65, 0xffff0000, v96
    v_lshlrev_b32 v66, 16, v97
    v_and_b32 v67, 0xffff0000, v97
    v_lshlrev_b32 v68, 16, v98
    v_and_b32 v69, 0xffff0000, v98
    v_lshlrev_b32 v70, 16, v99
    v_and_b32 v71, 0xffff0000, v99
    v_lshlrev_b32 v72, 16, v100
    v_and_b32 v73, 0xffff0000, v100
    v_lshlrev_b32 v74, 16, v101
    v_and_b32 v75, 0xffff0000, v101
    v_lshlrev_b32 v76, 16, v102
    v_and_b32 v77, 0xffff0000, v102
    v_lshlrev_b32 v78, 16, v103
    v_and_b32 v79, 0xffff0000, v103
    s_waitcnt vmcnt(6)
    v_lshlrev_b32 v80, 16, v104
    v_and_b32 v81, 0xffff0000, v104
    v_lshlrev_b32 v82, 16, v105
    v_and_b32 v83, 0xffff0000, v105
    v_lshlrev_b32 v84, 16, v106
    v_and_b32 v85, 0xffff0000, v106
    v_lshlrev_b32 v86, 16, v107
    v_and_b32 v87, 0xffff0000, v107
    v_lshlrev_b32 v88, 16, v108
    v_and_b32 v89, 0xffff0000, v108
    v_lshlrev_b32 v90, 16, v109
    v_and_b32 v91, 0xffff0000, v109
    v_lshlrev_b32 v92, 16, v110
    v_and_b32 v93, 0xffff0000, v110
    v_lshlrev_b32 v94, 16, v111
    v_and_b32 v95, 0xffff0000, v111
    v_pk_add_f32 v[64:65], v[64:65], v[80:81]
    v_pk_add_f32 v[66:67], v[66:67], v[82:83]
    v_pk_add_f32 v[68:69], v[68:69], v[84:85]
    v_pk_add_f32 v[70:71], v[70:71], v[86:87]
    v_pk_add_f32 v[72:73], v[72:73], v[88:89]
    v_pk_add_f32 v[74:75], v[74:75], v[90:91]
    v_pk_add_f32 v[76:77], v[76:77], v[92:93]
    v_pk_add_f32 v[78:79], v[78:79], v[94:95]
    s_waitcnt vmcnt(4)
    v_lshlrev_b32 v80, 16, v112
    v_and_b32 v81, 0xffff0000, v112
    v_lshlrev_b32 v82, 16, v113
    v_and_b32 v83, 0xffff0000, v113
    v_lshlrev_b32 v84, 16, v114
    v_and_b32 v85, 0xffff0000, v114
    v_lshlrev_b32 v86, 16, v115
    v_and_b32 v87, 0xffff0000, v115
    v_lshlrev_b32 v88, 16, v116
    v_and_b32 v89, 0xffff0000, v116
    v_lshlrev_b32 v90, 16, v117
    v_and_b32 v91, 0xffff0000, v117
    v_lshlrev_b32 v92, 16, v118
    v_and_b32 v93, 0xffff0000, v118
    v_lshlrev_b32 v94, 16, v119
    v_and_b32 v95, 0xffff0000, v119
    v_pk_add_f32 v[64:65], v[64:65], v[80:81]
    v_pk_add_f32 v[66:67], v[66:67], v[82:83]
    v_pk_add_f32 v[68:69], v[68:69], v[84:85]
    v_pk_add_f32 v[70:71], v[70:71], v[86:87]
    v_pk_add_f32 v[72:73], v[72:73], v[88:89]
    v_pk_add_f32 v[74:75], v[74:75], v[90:91]
    v_pk_add_f32 v[76:77], v[76:77], v[92:93]
    v_pk_add_f32 v[78:79], v[78:79], v[94:95]
    s_waitcnt vmcnt(2)
    v_lshlrev_b32 v80, 16, v120
    v_and_b32 v81, 0xffff0000, v120
    v_lshlrev_b32 v82, 16, v121
    v_and_b32 v83, 0xffff0000, v121
    v_lshlrev_b32 v84, 16, v122
    v_and_b32 v85, 0xffff0000, v122
    v_lshlrev_b32 v86, 16, v123
    v_and_b32 v87, 0xffff0000, v123
    v_lshlrev_b32 v88, 16, v124
    v_and_b32 v89, 0xffff0000, v124
    v_lshlrev_b32 v90, 16, v125
    v_and_b32 v91, 0xffff0000, v125
    v_lshlrev_b32 v92, 16, v126
    v_and_b32 v93, 0xffff0000, v126
    v_lshlrev_b32 v94, 16, v127
    v_and_b32 v95, 0xffff0000, v127
    v_pk_add_f32 v[64:65], v[64:65], v[80:81]
    v_pk_add_f32 v[66:67], v[66:67], v[82:83]
    v_pk_add_f32 v[68:69], v[68:69], v[84:85]
    v_pk_add_f32 v[70:71], v[70:71], v[86:87]
    v_pk_add_f32 v[72:73], v[72:73], v[88:89]
    v_pk_add_f32 v[74:75], v[74:75], v[90:91]
    v_pk_add_f32 v[76:77], v[76:77], v[92:93]
    v_pk_add_f32 v[78:79], v[78:79], v[94:95]
    ds_write_b32 v6, v64 offset:0
    ds_write_b32 v6, v65 offset:4096
    ds_write_b32 v6, v66 offset:8192
    ds_write_b32 v6, v67 offset:12288
    ds_write_b32 v6, v68 offset:16384
    ds_write_b32 v6, v69 offset:20480
    ds_write_b32 v6, v70 offset:24576
    ds_write_b32 v6, v71 offset:28672
    ds_write_b32 v6, v72 offset:256
    ds_write_b32 v6, v73 offset:4352
    ds_write_b32 v6, v74 offset:8448
    ds_write_b32 v6, v75 offset:12544
    ds_write_b32 v6, v76 offset:16640
    ds_write_b32 v6, v77 offset:20736
    ds_write_b32 v6, v78 offset:24832
    ds_write_b32 v6, v79 offset:28928
    s_waitcnt lgkmcnt(0)
    s_barrier
    ds_read_b128 v[64:67], v7
    ds_read_b128 v[68:71], v7 offset:16
    ds_read_b128 v[72:75], v7 offset:2048
    ds_read_b128 v[76:79], v7 offset:2064
    s_waitcnt vmcnt(0)
    v_accvgpr_read_b32 v96, a0
    v_accvgpr_read_b32 v97, a1
    v_accvgpr_read_b32 v98, a2
    v_accvgpr_read_b32 v99, a3
    v_accvgpr_read_b32 v100, a4
    v_accvgpr_read_b32 v101, a5
    v_accvgpr_read_b32 v102, a6
    v_accvgpr_read_b32 v103, a7
    v_lshlrev_b32 v80, 16, v96
    v_and_b32 v81, 0xffff0000, v96
    v_lshlrev_b32 v82, 16, v97
    v_and_b32 v83, 0xffff0000, v97
    v_lshlrev_b32 v84, 16, v98
    v_and_b32 v85, 0xffff0000, v98
    v_lshlrev_b32 v86, 16, v99
    v_and_b32 v87, 0xffff0000, v99
    v_lshlrev_b32 v88, 16, v100
    v_and_b32 v89, 0xffff0000, v100
    v_lshlrev_b32 v90, 16, v101
    v_and_b32 v91, 0xffff0000, v101
    v_lshlrev_b32 v92, 16, v102
    v_and_b32 v93, 0xffff0000, v102
    v_lshlrev_b32 v94, 16, v103
    v_and_b32 v95, 0xffff0000, v103
    s_waitcnt lgkmcnt(0)
    v_cvt_pk_bf16_f32 v64, 0, v64
    v_cvt_pk_bf16_f32 v65, 0, v65
    v_cvt_pk_bf16_f32 v66, 0, v66
    v_cvt_pk_bf16_f32 v67, 0, v67
    v_cvt_pk_bf16_f32 v68, 0, v68
    v_cvt_pk_bf16_f32 v69, 0, v69
    v_cvt_pk_bf16_f32 v70, 0, v70
    v_cvt_pk_bf16_f32 v71, 0, v71
    v_cvt_pk_bf16_f32 v72, 0, v72
    v_cvt_pk_bf16_f32 v73, 0, v73
    v_cvt_pk_bf16_f32 v74, 0, v74
    v_cvt_pk_bf16_f32 v75, 0, v75
    v_cvt_pk_bf16_f32 v76, 0, v76
    v_cvt_pk_bf16_f32 v77, 0, v77
    v_cvt_pk_bf16_f32 v78, 0, v78
    v_cvt_pk_bf16_f32 v79, 0, v79
    v_pk_add_f32 v[64:65], v[64:65], v[32:33]
    v_pk_add_f32 v[66:67], v[66:67], v[34:35]
    v_pk_add_f32 v[68:69], v[68:69], v[36:37]
    v_pk_add_f32 v[70:71], v[70:71], v[38:39]
    v_pk_add_f32 v[72:73], v[72:73], v[40:41]
    v_pk_add_f32 v[74:75], v[74:75], v[42:43]
    v_pk_add_f32 v[76:77], v[76:77], v[44:45]
    v_pk_add_f32 v[78:79], v[78:79], v[46:47]
    v_cvt_pk_bf16_f32 v64, 0, v64
    v_cvt_pk_bf16_f32 v65, 0, v65
    v_cvt_pk_bf16_f32 v66, 0, v66
    v_cvt_pk_bf16_f32 v67, 0, v67
    v_cvt_pk_bf16_f32 v68, 0, v68
    v_cvt_pk_bf16_f32 v69, 0, v69
    v_cvt_pk_bf16_f32 v70, 0, v70
    v_cvt_pk_bf16_f32 v71, 0, v71
    v_cvt_pk_bf16_f32 v72, 0, v72
    v_cvt_pk_bf16_f32 v73, 0, v73
    v_cvt_pk_bf16_f32 v74, 0, v74
    v_cvt_pk_bf16_f32 v75, 0, v75
    v_cvt_pk_bf16_f32 v76, 0, v76
    v_cvt_pk_bf16_f32 v77, 0, v77
    v_cvt_pk_bf16_f32 v78, 0, v78
    v_cvt_pk_bf16_f32 v79, 0, v79
    v_pk_mul_f32 v[64:65], v[64:65], v[16:17]
    v_pk_mul_f32 v[66:67], v[66:67], v[18:19]
    v_pk_mul_f32 v[68:69], v[68:69], v[20:21]
    v_pk_mul_f32 v[70:71], v[70:71], v[22:23]
    v_pk_mul_f32 v[72:73], v[72:73], v[24:25]
    v_pk_mul_f32 v[74:75], v[74:75], v[26:27]
    v_pk_mul_f32 v[76:77], v[76:77], v[28:29]
    v_pk_mul_f32 v[78:79], v[78:79], v[30:31]
    v_cvt_pk_bf16_f32 v64, 0, v64
    v_cvt_pk_bf16_f32 v65, 0, v65
    v_cvt_pk_bf16_f32 v66, 0, v66
    v_cvt_pk_bf16_f32 v67, 0, v67
    v_cvt_pk_bf16_f32 v68, 0, v68
    v_cvt_pk_bf16_f32 v69, 0, v69
    v_cvt_pk_bf16_f32 v70, 0, v70
    v_cvt_pk_bf16_f32 v71, 0, v71
    v_cvt_pk_bf16_f32 v72, 0, v72
    v_cvt_pk_bf16_f32 v73, 0, v73
    v_cvt_pk_bf16_f32 v74, 0, v74
    v_cvt_pk_bf16_f32 v75, 0, v75
    v_cvt_pk_bf16_f32 v76, 0, v76
    v_cvt_pk_bf16_f32 v77, 0, v77
    v_cvt_pk_bf16_f32 v78, 0, v78
    v_cvt_pk_bf16_f32 v79, 0, v79
    v_pk_add_f32 v[64:65], v[64:65], v[80:81]
    v_pk_add_f32 v[66:67], v[66:67], v[82:83]
    v_pk_add_f32 v[68:69], v[68:69], v[84:85]
    v_pk_add_f32 v[70:71], v[70:71], v[86:87]
    v_pk_add_f32 v[72:73], v[72:73], v[88:89]
    v_pk_add_f32 v[74:75], v[74:75], v[90:91]
    v_pk_add_f32 v[76:77], v[76:77], v[92:93]
    v_pk_add_f32 v[78:79], v[78:79], v[94:95]
    v_cvt_pk_bf16_f32 v96, v64, v65
    v_cvt_pk_bf16_f32 v97, v66, v67
    v_cvt_pk_bf16_f32 v98, v68, v69
    v_cvt_pk_bf16_f32 v99, v70, v71
    v_cvt_pk_bf16_f32 v100, v72, v73
    v_cvt_pk_bf16_f32 v101, v74, v75
    v_cvt_pk_bf16_f32 v102, v76, v77
    v_cvt_pk_bf16_f32 v103, v78, v79
    buffer_store_dwordx4 v[96:99], v8, s[24:27], s63 offen
    buffer_store_dwordx4 v[100:103], v8, s[24:27], s63 offen offset:1024
    s_add_u32 s60, s60, s78
    s_cmp_lt_u32 s60, s75
    s_cbranch_scc1 L_r_loop_29
    s_branch L_c_done_1
L_w_c_15:
    s_load_dwordx2 s[4:5], s[0:1], 0
    s_load_dwordx2 s[6:7], s[0:1], 88
    v_lshlrev_b32 v2, 4, v1
    v_lshlrev_b32 v3, 5, v1
    s_waitcnt lgkmcnt(0)
    s_mov_b32 s24, s4
    s_and_b32 s25, s5, 0xffff
    s_mov_b32 s26, 0x400000
    s_mov_b32 s27, 0x00020000
    s_mov_b32 s28, s6
    s_and_b32 s29, s7, 0xffff
    s_mov_b32 s30, 0x800
    s_mov_b32 s31, 0x00020000
    s_cmp_lg_u32 s44, 0
    s_cbranch_scc1 L_mw_33
    v_and_b32 v8, 15, v1
    v_lshlrev_b32 v8, 7, v8
    s_mov_b32 s46, 0x10e400
    s_mov_b32 s47, 0
    s_mov_b32 s70, 0
L_spin_34:
    buffer_load_dword v9, v8, s[12:15], s46 offen sc1
    s_waitcnt vmcnt(0)
    v_cmp_ge_u32 vcc, s47, v9
    s_add_u32 s70, s70, 1
    s_cbranch_vccz L_spok_35
    s_sleep 2
    s_cmp_lt_u32 s70, 524288
    s_cbranch_scc1 L_spin_34
    s_branch L_c_done_1
L_spok_35:
L_mw_33:
    s_barrier
    s_mov_b32 s46, 8192
    buffer_load_dwordx4 v[16:19], v3, s[12:15], s46 offen offset:0 sc1
    buffer_load_dwordx4 v[20:23], v3, s[12:15], s46 offen offset:16 sc1
    buffer_load_dwordx4 v[24:27], v3, s[12:15], s46 offen offset:2048 sc1
    buffer_load_dwordx4 v[28:31], v3, s[12:15], s46 offen offset:2064 sc1
    s_mov_b32 s46, 16384
    buffer_load_dwordx4 v[32:35], v3, s[12:15], s46 offen offset:0 sc1
    buffer_load_dwordx4 v[36:39], v3, s[12:15], s46 offen offset:16 sc1
    buffer_load_dwordx4 v[40:43], v3, s[12:15], s46 offen offset:2048 sc1
    buffer_load_dwordx4 v[44:47], v3, s[12:15], s46 offen offset:2064 sc1
    s_mov_b32 s46, 12288
    buffer_load_dwordx4 v[48:51], v3, s[12:15], s46 offen offset:0 sc1
    buffer_load_dwordx4 v[52:55], v3, s[12:15], s46 offen offset:16 sc1
    buffer_load_dwordx4 v[56:59], v3, s[12:15], s46 offen offset:2048 sc1
    buffer_load_dwordx4 v[60:63], v3, s[12:15], s46 offen offset:2064 sc1
    s_waitcnt vmcnt(0)
    v_add_f32 v32, 1.0, v32
    v_add_f32 v33, 1.0, v33
    v_add_f32 v34, 1.0, v34
    v_add_f32 v35, 1.0, v35
    v_add_f32 v36, 1.0, v36
    v_add_f32 v37, 1.0, v37
    v_add_f32 v38, 1.0, v38
    v_add_f32 v39, 1.0, v39
    v_add_f32 v40, 1.0, v40
    v_add_f32 v41, 1.0, v41
    v_add_f32 v42, 1.0, v42
    v_add_f32 v43, 1.0, v43
    v_add_f32 v44, 1.0, v44
    v_add_f32 v45, 1.0, v45
    v_add_f32 v46, 1.0, v46
    v_add_f32 v47, 1.0, v47
    v_cvt_pk_bf16_f32 v32, 0, v32
    v_cvt_pk_bf16_f32 v33, 0, v33
    v_cvt_pk_bf16_f32 v34, 0, v34
    v_cvt_pk_bf16_f32 v35, 0, v35
    v_cvt_pk_bf16_f32 v36, 0, v36
    v_cvt_pk_bf16_f32 v37, 0, v37
    v_cvt_pk_bf16_f32 v38, 0, v38
    v_cvt_pk_bf16_f32 v39, 0, v39
    v_cvt_pk_bf16_f32 v40, 0, v40
    v_cvt_pk_bf16_f32 v41, 0, v41
    v_cvt_pk_bf16_f32 v42, 0, v42
    v_cvt_pk_bf16_f32 v43, 0, v43
    v_cvt_pk_bf16_f32 v44, 0, v44
    v_cvt_pk_bf16_f32 v45, 0, v45
    v_cvt_pk_bf16_f32 v46, 0, v46
    v_cvt_pk_bf16_f32 v47, 0, v47
    s_lshl_b32 s46, s42, 14
    s_lshl_b32 s47, s44, 11
    s_add_u32 s46, s46, s47
    s_add_u32 s46, s46, 0x9000000
    v_add_u32 v4, s46, v2
    v_and_b32 v5, 31, v1
    v_lshlrev_b32 v5, 7, v5
    v_add_u32 v5, 0x107400, v5
    v_lshlrev_b32 v6, 2, v1
    s_lshl_b32 s46, s44, 9
    v_add_u32 v6, s46, v6
    s_lshl_b32 s46, s44, 12
    v_add_u32 v7, s46, v3
    s_lshl_b32 s46, s42, 3
    s_add_u32 s46, s46, s44
    s_lshl_b32 s46, s46, 11
    v_add_u32 v8, s46, v2
    v_add_u32 v9, 0x800000, v8
    s_mul_i32 s46, s44, 2064
    s_add_u32 s46, s46, 32768
    v_add_u32 v10, s46, v2
    v_and_b32 v11, 7, v1
    v_lshrrev_b32 v12, 3, v1
    v_mul_u32_u24 v13, 2064, v11
    v_lshl_add_u32 v13, v12, 4, v13
    s_lshl_b32 s46, s44, 8
    s_add_u32 s46, s46, 32768
    v_add_u32 v13, s46, v13
    v_lshlrev_b32 v11, 4, v11
    v_lshl_add_u32 v11, v12, 9, v11
    s_lshl_b32 s46, s44, 13
    s_lshl_b32 s47, s42, 7
    s_add_u32 s46, s46, s47
    s_add_u32 s46, s46, 0xc00000
    v_add_u32 v11, s46, v11
    v_add_u32 v12, 4096, v11
    s_lshl_b32 s52, s43, 9
    s_lshl_b32 s47, s42, 7
    s_add_u32 s52, s52, s47
    s_add_u32 s52, s52, 0x10ec00
    s_mov_b32 s60, s43
L_r_loop_36:
    s_lshl_b32 s61, s60, 18
    s_lshl_b32 s63, s60, 16
    buffer_load_dwordx4 a[0:3], v8, s[24:27], s63 offen
    buffer_load_dwordx4 a[4:7], v8, s[24:27], s63 offen offset:1024
    s_cmp_lg_u32 s44, 0
    s_cbranch_scc1 L_r_nsp_37
    s_mov_b32 s70, 0
L_spin_38:
    buffer_load_dword v14, v5, s[12:15], 0 offen sc1
    s_waitcnt vmcnt(0)
    v_cmp_ge_u32 vcc, s60, v14
    s_add_u32 s70, s70, 1
    s_cbranch_vccz L_spok_39
    s_sleep 3
    s_cmp_lt_u32 s70, 524288
    s_cbranch_scc1 L_spin_38
    s_branch L_c_done_1
L_spok_39:
L_r_nsp_37:
    s_barrier
    buffer_load_dwordx4 v[96:99], v4, s[12:15], s61 offen offset:0 sc1
    buffer_load_dwordx4 v[100:103], v4, s[12:15], s61 offen offset:1024 sc1
    s_add_u32 s61, s61, 65536
    buffer_load_dwordx4 v[104:107], v4, s[12:15], s61 offen offset:0 sc1
    buffer_load_dwordx4 v[108:111], v4, s[12:15], s61 offen offset:1024 sc1
    s_add_u32 s61, s61, 65536
    buffer_load_dwordx4 v[112:115], v4, s[12:15], s61 offen offset:0 sc1
    buffer_load_dwordx4 v[116:119], v4, s[12:15], s61 offen offset:1024 sc1
    s_add_u32 s61, s61, 65536
    buffer_load_dwordx4 v[120:123], v4, s[12:15], s61 offen offset:0 sc1
    buffer_load_dwordx4 v[124:127], v4, s[12:15], s61 offen offset:1024 sc1
    s_waitcnt vmcnt(6)
    v_lshlrev_b32 v64, 16, v96
    v_and_b32 v65, 0xffff0000, v96
    v_lshlrev_b32 v66, 16, v97
    v_and_b32 v67, 0xffff0000, v97
    v_lshlrev_b32 v68, 16, v98
    v_and_b32 v69, 0xffff0000, v98
    v_lshlrev_b32 v70, 16, v99
    v_and_b32 v71, 0xffff0000, v99
    v_lshlrev_b32 v72, 16, v100
    v_and_b32 v73, 0xffff0000, v100
    v_lshlrev_b32 v74, 16, v101
    v_and_b32 v75, 0xffff0000, v101
    v_lshlrev_b32 v76, 16, v102
    v_and_b32 v77, 0xffff0000, v102
    v_lshlrev_b32 v78, 16, v103
    v_and_b32 v79, 0xffff0000, v103
    s_waitcnt vmcnt(4)
    v_lshlrev_b32 v80, 16, v104
    v_and_b32 v81, 0xffff0000, v104
    v_lshlrev_b32 v82, 16, v105
    v_and_b32 v83, 0xffff0000, v105
    v_lshlrev_b32 v84, 16, v106
    v_and_b32 v85, 0xffff0000, v106
    v_lshlrev_b32 v86, 16, v107
    v_and_b32 v87, 0xffff0000, v107
    v_lshlrev_b32 v88, 16, v108
    v_and_b32 v89, 0xffff0000, v108
    v_lshlrev_b32 v90, 16, v109
    v_and_b32 v91, 0xffff0000, v109
    v_lshlrev_b32 v92, 16, v110
    v_and_b32 v93, 0xffff0000, v110
    v_lshlrev_b32 v94, 16, v111
    v_and_b32 v95, 0xffff0000, v111
    v_pk_add_f32 v[64:65], v[64:65], v[80:81]
    v_pk_add_f32 v[66:67], v[66:67], v[82:83]
    v_pk_add_f32 v[68:69], v[68:69], v[84:85]
    v_pk_add_f32 v[70:71], v[70:71], v[86:87]
    v_pk_add_f32 v[72:73], v[72:73], v[88:89]
    v_pk_add_f32 v[74:75], v[74:75], v[90:91]
    v_pk_add_f32 v[76:77], v[76:77], v[92:93]
    v_pk_add_f32 v[78:79], v[78:79], v[94:95]
    s_waitcnt vmcnt(2)
    v_lshlrev_b32 v80, 16, v112
    v_and_b32 v81, 0xffff0000, v112
    v_lshlrev_b32 v82, 16, v113
    v_and_b32 v83, 0xffff0000, v113
    v_lshlrev_b32 v84, 16, v114
    v_and_b32 v85, 0xffff0000, v114
    v_lshlrev_b32 v86, 16, v115
    v_and_b32 v87, 0xffff0000, v115
    v_lshlrev_b32 v88, 16, v116
    v_and_b32 v89, 0xffff0000, v116
    v_lshlrev_b32 v90, 16, v117
    v_and_b32 v91, 0xffff0000, v117
    v_lshlrev_b32 v92, 16, v118
    v_and_b32 v93, 0xffff0000, v118
    v_lshlrev_b32 v94, 16, v119
    v_and_b32 v95, 0xffff0000, v119
    v_pk_add_f32 v[64:65], v[64:65], v[80:81]
    v_pk_add_f32 v[66:67], v[66:67], v[82:83]
    v_pk_add_f32 v[68:69], v[68:69], v[84:85]
    v_pk_add_f32 v[70:71], v[70:71], v[86:87]
    v_pk_add_f32 v[72:73], v[72:73], v[88:89]
    v_pk_add_f32 v[74:75], v[74:75], v[90:91]
    v_pk_add_f32 v[76:77], v[76:77], v[92:93]
    v_pk_add_f32 v[78:79], v[78:79], v[94:95]
    s_waitcnt vmcnt(0)
    v_lshlrev_b32 v80, 16, v120
    v_and_b32 v81, 0xffff0000, v120
    v_lshlrev_b32 v82, 16, v121
    v_and_b32 v83, 0xffff0000, v121
    v_lshlrev_b32 v84, 16, v122
    v_and_b32 v85, 0xffff0000, v122
    v_lshlrev_b32 v86, 16, v123
    v_and_b32 v87, 0xffff0000, v123
    v_lshlrev_b32 v88, 16, v124
    v_and_b32 v89, 0xffff0000, v124
    v_lshlrev_b32 v90, 16, v125
    v_and_b32 v91, 0xffff0000, v125
    v_lshlrev_b32 v92, 16, v126
    v_and_b32 v93, 0xffff0000, v126
    v_lshlrev_b32 v94, 16, v127
    v_and_b32 v95, 0xffff0000, v127
    v_pk_add_f32 v[64:65], v[64:65], v[80:81]
    v_pk_add_f32 v[66:67], v[66:67], v[82:83]
    v_pk_add_f32 v[68:69], v[68:69], v[84:85]
    v_pk_add_f32 v[70:71], v[70:71], v[86:87]
    v_pk_add_f32 v[72:73], v[72:73], v[88:89]
    v_pk_add_f32 v[74:75], v[74:75], v[90:91]
    v_pk_add_f32 v[76:77], v[76:77], v[92:93]
    v_pk_add_f32 v[78:79], v[78:79], v[94:95]
    ds_write_b32 v6, v64 offset:0
    ds_write_b32 v6, v65 offset:4096
    ds_write_b32 v6, v66 offset:8192
    ds_write_b32 v6, v67 offset:12288
    ds_write_b32 v6, v68 offset:16384
    ds_write_b32 v6, v69 offset:20480
    ds_write_b32 v6, v70 offset:24576
    ds_write_b32 v6, v71 offset:28672
    ds_write_b32 v6, v72 offset:256
    ds_write_b32 v6, v73 offset:4352
    ds_write_b32 v6, v74 offset:8448
    ds_write_b32 v6, v75 offset:12544
    ds_write_b32 v6, v76 offset:16640
    ds_write_b32 v6, v77 offset:20736
    ds_write_b32 v6, v78 offset:24832
    ds_write_b32 v6, v79 offset:28928
    s_waitcnt lgkmcnt(0)
    s_barrier
    ds_read_b128 v[64:67], v7
    ds_read_b128 v[68:71], v7 offset:16
    ds_read_b128 v[72:75], v7 offset:2048
    ds_read_b128 v[76:79], v7 offset:2064
    s_waitcnt vmcnt(0)
    v_accvgpr_read_b32 v96, a0
    v_accvgpr_read_b32 v97, a1
    v_accvgpr_read_b32 v98, a2
    v_accvgpr_read_b32 v99, a3
    v_accvgpr_read_b32 v100, a4
    v_accvgpr_read_b32 v101, a5
    v_accvgpr_read_b32 v102, a6
    v_accvgpr_read_b32 v103, a7
    v_lshlrev_b32 v80, 16, v96
    v_and_b32 v81, 0xffff0000, v96
    v_lshlrev_b32 v82, 16, v97
    v_and_b32 v83, 0xffff0000, v97
    v_lshlrev_b32 v84, 16, v98
    v_and_b32 v85, 0xffff0000, v98
    v_lshlrev_b32 v86, 16, v99
    v_and_b32 v87, 0xffff0000, v99
    v_lshlrev_b32 v88, 16, v100
    v_and_b32 v89, 0xffff0000, v100
    v_lshlrev_b32 v90, 16, v101
    v_and_b32 v91, 0xffff0000, v101
    v_lshlrev_b32 v92, 16, v102
    v_and_b32 v93, 0xffff0000, v102
    v_lshlrev_b32 v94, 16, v103
    v_and_b32 v95, 0xffff0000, v103
    s_waitcnt lgkmcnt(0)
    v_cvt_pk_bf16_f32 v64, 0, v64
    v_cvt_pk_bf16_f32 v65, 0, v65
    v_cvt_pk_bf16_f32 v66, 0, v66
    v_cvt_pk_bf16_f32 v67, 0, v67
    v_cvt_pk_bf16_f32 v68, 0, v68
    v_cvt_pk_bf16_f32 v69, 0, v69
    v_cvt_pk_bf16_f32 v70, 0, v70
    v_cvt_pk_bf16_f32 v71, 0, v71
    v_cvt_pk_bf16_f32 v72, 0, v72
    v_cvt_pk_bf16_f32 v73, 0, v73
    v_cvt_pk_bf16_f32 v74, 0, v74
    v_cvt_pk_bf16_f32 v75, 0, v75
    v_cvt_pk_bf16_f32 v76, 0, v76
    v_cvt_pk_bf16_f32 v77, 0, v77
    v_cvt_pk_bf16_f32 v78, 0, v78
    v_cvt_pk_bf16_f32 v79, 0, v79
    v_pk_mul_f32 v[64:65], v[64:65], v[16:17]
    v_pk_mul_f32 v[66:67], v[66:67], v[18:19]
    v_pk_mul_f32 v[68:69], v[68:69], v[20:21]
    v_pk_mul_f32 v[70:71], v[70:71], v[22:23]
    v_pk_mul_f32 v[72:73], v[72:73], v[24:25]
    v_pk_mul_f32 v[74:75], v[74:75], v[26:27]
    v_pk_mul_f32 v[76:77], v[76:77], v[28:29]
    v_pk_mul_f32 v[78:79], v[78:79], v[30:31]
    v_cvt_pk_bf16_f32 v64, 0, v64
    v_cvt_pk_bf16_f32 v65, 0, v65
    v_cvt_pk_bf16_f32 v66, 0, v66
    v_cvt_pk_bf16_f32 v67, 0, v67
    v_cvt_pk_bf16_f32 v68, 0, v68
    v_cvt_pk_bf16_f32 v69, 0, v69
    v_cvt_pk_bf16_f32 v70, 0, v70
    v_cvt_pk_bf16_f32 v71, 0, v71
    v_cvt_pk_bf16_f32 v72, 0, v72
    v_cvt_pk_bf16_f32 v73, 0, v73
    v_cvt_pk_bf16_f32 v74, 0, v74
    v_cvt_pk_bf16_f32 v75, 0, v75
    v_cvt_pk_bf16_f32 v76, 0, v76
    v_cvt_pk_bf16_f32 v77, 0, v77
    v_cvt_pk_bf16_f32 v78, 0, v78
    v_cvt_pk_bf16_f32 v79, 0, v79
    v_pk_add_f32 v[64:65], v[64:65], v[80:81]
    v_pk_add_f32 v[66:67], v[66:67], v[82:83]
    v_pk_add_f32 v[68:69], v[68:69], v[84:85]
    v_pk_add_f32 v[70:71], v[70:71], v[86:87]
    v_pk_add_f32 v[72:73], v[72:73], v[88:89]
    v_pk_add_f32 v[74:75], v[74:75], v[90:91]
    v_pk_add_f32 v[76:77], v[76:77], v[92:93]
    v_pk_add_f32 v[78:79], v[78:79], v[94:95]
    v_cvt_pk_bf16_f32 v96, v64, v65
    v_cvt_pk_bf16_f32 v97, v66, v67
    v_cvt_pk_bf16_f32 v98, v68, v69
    v_cvt_pk_bf16_f32 v99, v70, v71
    v_cvt_pk_bf16_f32 v100, v72, v73
    v_cvt_pk_bf16_f32 v101, v74, v75
    v_cvt_pk_bf16_f32 v102, v76, v77
    v_cvt_pk_bf16_f32 v103, v78, v79
    buffer_store_dwordx4 v[96:99], v9, s[12:15], s63 offen sc1
    buffer_store_dwordx4 v[100:103], v9, s[12:15], s63 offen offset:1024 sc1
    v_lshlrev_b32 v64, 16, v96
    v_and_b32 v65, 0xffff0000, v96
    v_lshlrev_b32 v66, 16, v97
    v_and_b32 v67, 0xffff0000, v97
    v_lshlrev_b32 v68, 16, v98
    v_and_b32 v69, 0xffff0000, v98
    v_lshlrev_b32 v70, 16, v99
    v_and_b32 v71, 0xffff0000, v99
    v_lshlrev_b32 v72, 16, v100
    v_and_b32 v73, 0xffff0000, v100
    v_lshlrev_b32 v74, 16, v101
    v_and_b32 v75, 0xffff0000, v101
    v_lshlrev_b32 v76, 16, v102
    v_and_b32 v77, 0xffff0000, v102
    v_lshlrev_b32 v78, 16, v103
    v_and_b32 v79, 0xffff0000, v103
    v_pk_add_f32 v[80:81], v[64:65], v[72:73]
    v_pk_add_f32 v[82:83], v[66:67], v[74:75]
    v_pk_add_f32 v[84:85], v[68:69], v[76:77]
    v_pk_add_f32 v[86:87], v[70:71], v[78:79]
    v_pk_add_f32 v[80:81], v[80:81], v[84:85]
    v_pk_add_f32 v[82:83], v[82:83], v[86:87]
    v_pk_add_f32 v[80:81], v[80:81], v[82:83]
    v_add_f32 v14, v80, v81
    s_nop 1
    v_add_f32_dpp v14, v14, v14 row_shr:1 row_mask:0xf bank_mask:0xf bound_ctrl:0
    s_nop 1
    v_add_f32_dpp v14, v14, v14 row_shr:2 row_mask:0xf bank_mask:0xf bound_ctrl:0
    s_nop 1
    v_add_f32_dpp v14, v14, v14 row_shr:4 row_mask:0xf bank_mask:0xf bound_ctrl:0
    s_nop 1
    v_add_f32_dpp v14, v14, v14 row_shr:8 row_mask:0xf bank_mask:0xf bound_ctrl:0
    s_nop 1
    v_add_f32_dpp v14, v14, v14 row_bcast:15 row_mask:0xa bank_mask:0xf
    s_nop 1
    v_add_f32_dpp v14, v14, v14 row_bcast:31 row_mask:0xc bank_mask:0xf
    s_nop 1
    v_readlane_b32 s46, v14, 63
    s_nop 1
    v_mov_b32 v15, s46
    v_mul_f32 v15, 0x3a800000, v15
    v_pk_add_f32 v[80:81], v[64:65], v[14:15] op_sel:[0,1] op_sel_hi:[1,1] neg_lo:[0,1] neg_hi:[0,1]
    v_pk_add_f32 v[82:83], v[66:67], v[14:15] op_sel:[0,1] op_sel_hi:[1,1] neg_lo:[0,1] neg_hi:[0,1]
    v_pk_add_f32 v[84:85], v[68:69], v[14:15] op_sel:[0,1] op_sel_hi:[1,1] neg_lo:[0,1] neg_hi:[0,1]
    v_pk_add_f32 v[86:87], v[70:71], v[14:15] op_sel:[0,1] op_sel_hi:[1,1] neg_lo:[0,1] neg_hi:[0,1]
    v_pk_add_f32 v[88:89], v[72:73], v[14:15] op_sel:[0,1] op_sel_hi:[1,1] neg_lo:[0,1] neg_hi:[0,1]
    v_pk_add_f32 v[90:91], v[74:75], v[14:15] op_sel:[0,1] op_sel_hi:[1,1] neg_lo:[0,1] neg_hi:[0,1]
    v_pk_add_f32 v[92:93], v[76:77], v[14:15] op_sel:[0,1] op_sel_hi:[1,1] neg_lo:[0,1] neg_hi:[0,1]
    v_pk_add_f32 v[94:95], v[78:79], v[14:15] op_sel:[0,1] op_sel_hi:[1,1] neg_lo:[0,1] neg_hi:[0,1]
    v_pk_mul_f32 v[104:105], v[80:81], v[80:81]
    v_pk_mul_f32 v[106:107], v[82:83], v[82:83]
    v_pk_fma_f32 v[104:105], v[84:85], v[84:85], v[104:105]
    v_pk_fma_f32 v[106:107], v[86:87], v[86:87], v[106:107]
    v_pk_fma_f32 v[104:105], v[88:89], v[88:89], v[104:105]
    v_pk_fma_f32 v[106:107], v[90:91], v[90:91], v[106:107]
    v_pk_fma_f32 v[104:105], v[92:93], v[92:93], v[104:105]
    v_pk_fma_f32 v[106:107], v[94:95], v[94:95], v[106:107]
    v_pk_add_f32 v[104:105], v[104:105], v[106:107]
    v_add_f32 v14, v104, v105
    v_cvt_pk_bf16_f32 v15, 0, v15
    s_nop 1
    v_add_f32_dpp v14, v14, v14 row_shr:1 row_mask:0xf bank_mask:0xf bound_ctrl:0
    s_nop 1
    v_add_f32_dpp v14, v14, v14 row_shr:2 row_mask:0xf bank_mask:0xf bound_ctrl:0
    s_nop 1
    v_add_f32_dpp v14, v14, v14 row_shr:4 row_mask:0xf bank_mask:0xf bound_ctrl:0
    s_nop 1
    v_add_f32_dpp v14, v14, v14 row_shr:8 row_mask:0xf bank_mask:0xf bound_ctrl:0
    s_nop 1
    v_add_f32_dpp v14, v14, v14 row_bcast:15 row_mask:0xa bank_mask:0xf
    s_nop 1
    v_add_f32_dpp v14, v14, v14 row_bcast:31 row_mask:0xc bank_mask:0xf
    s_nop 1
    v_readlane_b32 s47, v14, 63
    v_pk_add_f32 v[64:65], v[64:65], v[14:15] op_sel:[0,1] op_sel_hi:[1,1] neg_lo:[0,1] neg_hi:[0,1]
    v_pk_add_f32 v[66:67], v[66:67], v[14:15] op_sel:[0,1] op_sel_hi:[1,1] neg_lo:[0,1] neg_hi:[0,1]
    v_pk_add_f32 v[68:69], v[68:69], v[14:15] op_sel:[0,1] op_sel_hi:[1,1] neg_lo:[0,1] neg_hi:[0,1]
    v_pk_add_f32 v[70:71], v[70:71], v[14:15] op_sel:[0,1] op_sel_hi:[1,1] neg_lo:[0,1] neg_hi:[0,1]
    v_pk_add_f32 v[72:73], v[72:73], v[14:15] op_sel:[0,1] op_sel_hi:[1,1] neg_lo:[0,1] neg_hi:[0,1]
    v_pk_add_f32 v[74:75], v[74:75], v[14:15] op_sel:[0,1] op_sel_hi:[1,1] neg_lo:[0,1] neg_hi:[0,1]
    v_pk_add_f32 v[76:77], v[76:77], v[14:15] op_sel:[0,1] op_sel_hi:[1,1] neg_lo:[0,1] neg_hi:[0,1]
    v_pk_add_f32 v[78:79], v[78:79], v[14:15] op_sel:[0,1] op_sel_hi:[1,1] neg_lo:[0,1] neg_hi:[0,1]
    v_mov_b32 v14, s47
    v_mul_f32 v14, 0x3a800000, v14
    v_cvt_pk_bf16_f32 v14, 0, v14
    v_add_f32 v14, 0x3727c5ac, v14
    v_cvt_pk_bf16_f32 v14, 0, v14
    v_sqrt_f32 v14, v14
    s_nop 0
    v_cvt_pk_bf16_f32 v14, 0, v14
    v_rcp_f32 v14, v14
    v_cvt_pk_bf16_f32 v64, 0, v64
    v_cvt_pk_bf16_f32 v65, 0, v65
    v_cvt_pk_bf16_f32 v66, 0, v66
    v_cvt_pk_bf16_f32 v67, 0, v67
    v_cvt_pk_bf16_f32 v68, 0, v68
    v_cvt_pk_bf16_f32 v69, 0, v69
    v_cvt_pk_bf16_f32 v70, 0, v70
    v_cvt_pk_bf16_f32 v71, 0, v71
    v_cvt_pk_bf16_f32 v72, 0, v72
    v_cvt_pk_bf16_f32 v73, 0, v73
    v_cvt_pk_bf16_f32 v74, 0, v74
    v_cvt_pk_bf16_f32 v75, 0, v75
    v_cvt_pk_bf16_f32 v76, 0, v76
    v_cvt_pk_bf16_f32 v77, 0, v77
    v_cvt_pk_bf16_f32 v78, 0, v78
    v_cvt_pk_bf16_f32 v79, 0, v79
    v_pk_mul_f32 v[64:65], v[64:65], v[14:15] op_sel_hi:[1,0]
    v_pk_mul_f32 v[66:67], v[66:67], v[14:15] op_sel_hi:[1,0]
    v_pk_mul_f32 v[68:69], v[68:69], v[14:15] op_sel_hi:[1,0]
    v_pk_mul_f32 v[70:71], v[70:71], v[14:15] op_sel_hi:[1,0]
    v_pk_mul_f32 v[72:73], v[72:73], v[14:15] op_sel_hi:[1,0]
    v_pk_mul_f32 v[74:75], v[74:75], v[14:15] op_sel_hi:[1,0]
    v_pk_mul_f32 v[76:77], v[76:77], v[14:15] op_sel_hi:[1,0]
    v_pk_mul_f32 v[78:79], v[78:79], v[14:15] op_sel_hi:[1,0]
    v_cvt_pk_bf16_f32 v64, 0, v64
    v_cvt_pk_bf16_f32 v65, 0, v65
    v_cvt_pk_bf16_f32 v66, 0, v66
    v_cvt_pk_bf16_f32 v67, 0, v67
    v_cvt_pk_bf16_f32 v68, 0, v68
    v_cvt_pk_bf16_f32 v69, 0, v69
    v_cvt_pk_bf16_f32 v70, 0, v70
    v_cvt_pk_bf16_f32 v71, 0, v71
    v_cvt_pk_bf16_f32 v72, 0, v72
    v_cvt_pk_bf16_f32 v73, 0, v73
    v_cvt_pk_bf16_f32 v74, 0, v74
    v_cvt_pk_bf16_f32 v75, 0, v75
    v_cvt_pk_bf16_f32 v76, 0, v76
    v_cvt_pk_bf16_f32 v77, 0, v77
    v_cvt_pk_bf16_f32 v78, 0, v78
    v_cvt_pk_bf16_f32 v79, 0, v79
    v_pk_mul_f32 v[64:65], v[64:65], v[32:33]
    v_pk_mul_f32 v[66:67], v[66:67], v[34:35]
    v_pk_mul_f32 v[68:69], v[68:69], v[36:37]
    v_pk_mul_f32 v[70:71], v[70:71], v[38:39]
    v_pk_mul_f32 v[72:73], v[72:73], v[40:41]
    v_pk_mul_f32 v[74:75], v[74:75], v[42:43]
    v_pk_mul_f32 v[76:77], v[76:77], v[44:45]
    v_pk_mul_f32 v[78:79], v[78:79], v[46:47]
    v_cvt_pk_bf16_f32 v64, 0, v64
    v_cvt_pk_bf16_f32 v65, 0, v65
    v_cvt_pk_bf16_f32 v66, 0, v66
    v_cvt_pk_bf16_f32 v67, 0, v67
    v_cvt_pk_bf16_f32 v68, 0, v68
    v_cvt_pk_bf16_f32 v69, 0, v69
    v_cvt_pk_bf16_f32 v70, 0, v70
    v_cvt_pk_bf16_f32 v71, 0, v71
    v_cvt_pk_bf16_f32 v72, 0, v72
    v_cvt_pk_bf16_f32 v73, 0, v73
    v_cvt_pk_bf16_f32 v74, 0, v74
    v_cvt_pk_bf16_f32 v75, 0, v75
    v_cvt_pk_bf16_f32 v76, 0, v76
    v_cvt_pk_bf16_f32 v77, 0, v77
    v_cvt_pk_bf16_f32 v78, 0, v78
    v_cvt_pk_bf16_f32 v79, 0, v79
    v_pk_add_f32 v[64:65], v[64:65], v[48:49]
    v_pk_add_f32 v[66:67], v[66:67], v[50:51]
    v_pk_add_f32 v[68:69], v[68:69], v[52:53]
    v_pk_add_f32 v[70:71], v[70:71], v[54:55]
    v_pk_add_f32 v[72:73], v[72:73], v[56:57]
    v_pk_add_f32 v[74:75], v[74:75], v[58:59]
    v_pk_add_f32 v[76:77], v[76:77], v[60:61]
    v_pk_add_f32 v[78:79], v[78:79], v[62:63]
    v_cvt_pk_bf16_f32 v104, v64, v65
    v_cvt_pk_bf16_f32 v105, v66, v67
    v_cvt_pk_bf16_f32 v106, v68, v69
    v_cvt_pk_bf16_f32 v107, v70, v71
    v_cvt_pk_bf16_f32 v108, v72, v73
    v_cvt_pk_bf16_f32 v109, v74, v75
    v_cvt_pk_bf16_f32 v110, v76, v77
    v_cvt_pk_bf16_f32 v111, v78, v79
    ds_write_b128 v10, v[104:107]
    ds_write_b128 v10, v[108:111] offset:1024
    s_waitcnt lgkmcnt(0)
    s_barrier
    ds_read_b128 v[104:107], v13
    ds_read_b128 v[108:111], v13 offset:128
    s_waitcnt lgkmcnt(1)
    buffer_store_dwordx4 v[104:107], v11, s[12:15], s63 offen sc1
    s_waitcnt lgkmcnt(0)
    buffer_store_dwordx4 v[108:111], v12, s[12:15], s63 offen sc1
    s_waitcnt vmcnt(0)
    s_barrier
    s_cmp_lg_u32 s44, 0
    s_cbranch_scc1 L_sf_40
    v_mov_b32 v14, s60
    v_add_u32 v14, 1, v14
    v_mov_b32 v15, 0
    s_mov_b64 exec, 1
    buffer_store_dword v14, v15, s[12:15], s52 offen sc1
    s_mov_b64 exec, -1
L_sf_40:
    s_add_u32 s60, s60, 3
    s_cmp_lt_u32 s60, 64
    s_cbranch_scc1 L_r_loop_36
    s_branch L_c_done_1
L_w_att_14:
    s_lshl_b32 s42, s40, 2
    s_and_b32 s46, s44, 3
    s_add_u32 s42, s42, s46
    s_and_b32 s43, s48, 1
    s_lshl_b32 s43, s43, 1
    s_lshr_b32 s46, s44, 2
    s_add_u32 s43, s43, s46
    s_mul_i32 s46, s42, 24576
    s_add_u32 s46, s46, 0x2000000
    v_lshlrev_b32 v2, 4, v1
    v_add_u32 v3, s46, v2
    v_add_u32 v5, 4096, v3
    v_lshrrev_b32 v4, 4, v1
    v_and_b32 v9, 15, v1
    s_lshl_b32 s46, s42, 12
    s_add_u32 s46, s46, 0x1000000
    v_and_b32 v6, 7, v1
    v_lshlrev_b32 v6, 4, v6
    v_lshl_add_u32 v6, v4, 7, v6
    v_add_u32 v6, s46, v6
    v_and_b32 v7, 31, v1
    v_lshlrev_b32 v7, 4, v7
    v_lshrrev_b32 v10, 5, v1
    v_lshl_add_u32 v7, v10, 10, v7
    v_add_u32 v7, s46, v7
    s_mul_i32 s50, s44, 13056
    v_mul_u32_u24 v8, 272, v9
    v_lshl_add_u32 v8, v4, 4, v8
    v_add_u32 v8, s50, v8
    v_bfe_u32 v11, v1, 2, 3
    v_mul_u32_u24 v11, 272, v11
    v_lshl_add_u32 v11, v10, 6, v11
    v_and_b32 v12, 3, v1
    v_lshl_add_u32 v11, v12, 4, v11
    v_add_u32 v11, s50, v11
    v_mul_u32_u24 v14, 272, v4
    v_lshl_add_u32 v14, v9, 4, v14
    v_add_u32 v14, s50, v14
    v_mov_b32 v16, 0
    v_mov_b32 v17, 0
    v_mov_b32 v18, 0
    v_mov_b32 v19, 0
    ds_write_b128 v14, v[16:19] offset:10880
    ds_write_b128 v14, v[16:19] offset:11968
    v_lshlrev_b32 v12, 2, v4
    v_bfe_u32 v13, v1, 2, 2
    v_add_u32 v12, v12, v13
    v_mul_u32_u24 v12, 272, v12
    v_and_b32 v13, 3, v1
    v_lshl_add_u32 v12, v13, 3, v12
    v_add_u32 v12, s50, v12
    v_lshlrev_b32 v13, 10, v13
    s_lshl_b32 s46, s42, 12
    s_add_u32 s46, s46, 0x1000000
    v_add_u32 v13, s46, v13
    v_lshlrev_b32 v10, 9, v4
    v_lshl_add_u32 v10, v9, 4, v10
    s_lshl_b32 s46, s42, 13
    s_add_u32 s46, s46, 0x5000000
    v_add_u32 v10, s46, v10
    s_lshl_b32 s52, s42, 9
    s_lshl_b32 s47, s43, 7
    s_add_u32 s52, s52, s47
    s_add_u32 s52, s52, 0x102000
    v_min_u32 v42, 2, v1
    v_lshlrev_b32 v42, 9, v42
    s_lshl_b32 s46, s40, 11
    s_and_b32 s47, s42, 3
    s_lshl_b32 s47, s47, 7
    s_add_u32 s46, s46, s47
    s_add_u32 s46, s46, 0x10a400
    v_add_u32 v48, s46, v42
    s_mul_i32 s46, s42, 24576
    s_add_u32 s46, s46, 0x2000000
    v_lshlrev_b32 v49, 7, v1
    v_add_u32 v49, s46, v49
    v_cmp_le_u32 s[56:57], 32, v1
    v_lshlrev_b32 v14, 2, v4
    s_mov_b32 s54, 0x3e0293ee
    s_mov_b32 s60, s43
    v_add_u32 v15, 0, v14
    v_cmp_gt_u32 s[84:85], v15, v9
    v_add_u32 v15, 1, v14
    v_cmp_gt_u32 s[86:87], v15, v9
    v_add_u32 v15, 2, v14
    v_cmp_gt_u32 s[88:89], v15, v9
    v_add_u32 v15, 3, v14
    v_cmp_gt_u32 s[90:91], v15, v9
L_a_loop_41:
    s_mul_i32 s45, s60, 786432
    s_add_u32 s48, s45, 8192
    s_add_u32 s49, s45, 16384
    s_lshl_b32 s61, s60, 17
    s_lshl_b32 s63, s60, 18
    s_mov_b32 s70, 0
L_spin_42:
    buffer_load_dword v40, v48, s[12:15], 0 offen sc1
    s_waitcnt vmcnt(0)
    v_cmp_ge_u32 vcc, s60, v40
    s_add_u32 s70, s70, 1
    s_cbranch_vccz L_spok_43
    s_sleep 3
    s_cmp_lt_u32 s70, 524288
    s_cbranch_scc1 L_spin_42
    s_branch L_c_done_1
L_spok_43:
    buffer_load_dwordx4 a[0:3], v3, s[12:15], s45 offen offset:0 sc1
    buffer_load_dwordx4 a[4:7], v3, s[12:15], s45 offen offset:1024 sc1
    buffer_load_dwordx4 a[8:11], v3, s[12:15], s45 offen offset:2048 sc1
    buffer_load_dwordx4 a[12:15], v3, s[12:15], s45 offen offset:3072 sc1
    buffer_load_dwordx4 a[16:19], v5, s[12:15], s45 offen offset:0 sc1
    buffer_load_dwordx4 a[20:23], v5, s[12:15], s45 offen offset:1024 sc1
    buffer_load_dwordx4 a[24:27], v5, s[12:15], s45 offen offset:2048 sc1
    buffer_load_dwordx4 a[28:31], v5, s[12:15], s45 offen offset:3072 sc1
    buffer_load_dwordx4 a[32:35], v3, s[12:15], s48 offen offset:0 sc1
    buffer_load_dwordx4 a[36:39], v3, s[12:15], s48 offen offset:1024 sc1
    buffer_load_dwordx4 a[40:43], v3, s[12:15], s48 offen offset:2048 sc1
    buffer_load_dwordx4 a[44:47], v3, s[12:15], s48 offen offset:3072 sc1
    buffer_load_dwordx4 a[48:51], v5, s[12:15], s48 offen offset:0 sc1
    buffer_load_dwordx4 a[52:55], v5, s[12:15], s48 offen offset:1024 sc1
    buffer_load_dwordx4 a[56:59], v5, s[12:15], s48 offen offset:2048 sc1
    buffer_load_dwordx4 a[60:63], v5, s[12:15], s48 offen offset:3072 sc1
    buffer_load_dwordx4 v[16:19], v3, s[12:15], s49 offen offset:0 sc1
    buffer_load_dwordx4 v[20:23], v3, s[12:15], s49 offen offset:1024 sc1
    buffer_load_dwordx4 v[24:27], v3, s[12:15], s49 offen offset:2048 sc1
    buffer_load_dwordx4 v[28:31], v3, s[12:15], s49 offen offset:3072 sc1
    buffer_load_dwordx4 v[32:35], v5, s[12:15], s49 offen offset:0 sc1
    buffer_load_dwordx4 v[36:39], v5, s[12:15], s49 offen offset:1024 sc1
    buffer_load_dwordx4 v[40:43], v5, s[12:15], s49 offen offset:2048 sc1
    buffer_load_dwordx4 v[44:47], v5, s[12:15], s49 offen offset:3072 sc1
    s_waitcnt vmcnt(0)
    ds_write_b128 v8, v[16:19] offset:0
    ds_write_b128 v8, v[20:23] offset:64
    ds_write_b128 v8, v[24:27] offset:128
    ds_write_b128 v8, v[28:31] offset:192
    ds_write_b128 v8, v[32:35] offset:4352
    ds_write_b128 v8, v[36:39] offset:4416
    ds_write_b128 v8, v[40:43] offset:4480
    ds_write_b128 v8, v[44:47] offset:4544
    v_mfma_f32_16x16x32_bf16 v[56:59], a[32:35], a[0:3], 0
    v_mfma_f32_16x16x32_bf16 v[60:63], a[32:35], a[16:19], 0
    v_mfma_f32_16x16x32_bf16 v[68:71], a[48:51], a[16:19], 0
    v_mfma_f32_16x16x32_bf16 v[56:59], a[36:39], a[4:7], v[56:59]
    v_mfma_f32_16x16x32_bf16 v[60:63], a[36:39], a[20:23], v[60:63]
    v_mfma_f32_16x16x32_bf16 v[68:71], a[52:55], a[20:23], v[68:71]
    v_mfma_f32_16x16x32_bf16 v[56:59], a[40:43], a[8:11], v[56:59]
    v_mfma_f32_16x16x32_bf16 v[60:63], a[40:43], a[24:27], v[60:63]
    v_mfma_f32_16x16x32_bf16 v[68:71], a[56:59], a[24:27], v[68:71]
    v_mfma_f32_16x16x32_bf16 v[56:59], a[44:47], a[12:15], v[56:59]
    v_mfma_f32_16x16x32_bf16 v[60:63], a[44:47], a[28:31], v[60:63]
    v_mfma_f32_16x16x32_bf16 v[68:71], a[60:63], a[28:31], v[68:71]
    s_waitcnt lgkmcnt(0)
    ds_read_b64_tr_b16 a[80:81], v12 offset:0
    ds_read_b64_tr_b16 a[82:83], v12 offset:4352
    ds_read_b64_tr_b16 a[86:87], v12 offset:32
    ds_read_b64_tr_b16 a[88:89], v12 offset:4384
    ds_read_b64_tr_b16 a[92:93], v12 offset:64
    ds_read_b64_tr_b16 a[94:95], v12 offset:4416
    ds_read_b64_tr_b16 a[98:99], v12 offset:96
    ds_read_b64_tr_b16 a[100:101], v12 offset:4448
    s_waitcnt lgkmcnt(0)
    ds_read_b64_tr_b16 a[104:105], v12 offset:128
    ds_read_b64_tr_b16 a[106:107], v12 offset:4480
    ds_read_b64_tr_b16 a[110:111], v12 offset:160
    ds_read_b64_tr_b16 a[112:113], v12 offset:4512
    ds_read_b64_tr_b16 a[116:117], v12 offset:192
    ds_read_b64_tr_b16 a[118:119], v12 offset:4544
    ds_read_b64_tr_b16 a[122:123], v12 offset:224
    ds_read_b64_tr_b16 a[124:125], v12 offset:4576
    v_mov_b32 v15, 0xff800000
    v_cndmask_b32 v56, v56, v15, s[84:85]
    v_cndmask_b32 v68, v68, v15, s[84:85]
    v_cndmask_b32 v57, v57, v15, s[86:87]
    v_cndmask_b32 v69, v69, v15, s[86:87]
    v_cndmask_b32 v58, v58, v15, s[88:89]
    v_cndmask_b32 v70, v70, v15, s[88:89]
    v_cndmask_b32 v59, v59, v15, s[90:91]
    v_cndmask_b32 v71, v71, v15, s[90:91]
    s_mov_b32 s70, 0
L_a_cp_44:
    buffer_load_dword v40, v13, s[12:15], s61 offen sc1
    s_waitcnt vmcnt(0)
    v_cmp_eq_u32 vcc, -1, v40
    s_add_u32 s70, s70, 1
    s_cbranch_vccz L_a_fl_45
L_a_cp_44_s:
    s_sleep 4
    s_cmp_lt_u32 s70, 524288
    s_cbranch_scc1 L_a_cp_44
    s_branch L_c_done_1
L_a_fl_45:
    buffer_load_dwordx4 v[24:27], v6, s[12:15], s61 offen offset:0 sc1
    buffer_load_dwordx4 v[28:31], v6, s[12:15], s61 offen offset:1024 sc1
    buffer_load_dwordx4 v[32:35], v6, s[12:15], s61 offen offset:2048 sc1
    buffer_load_dwordx4 v[36:39], v6, s[12:15], s61 offen offset:3072 sc1
    buffer_load_dwordx4 v[16:19], v7, s[12:15], s61 offen offset:512 sc1
    buffer_load_dwordx4 v[20:23], v7, s[12:15], s61 offen offset:2560 sc1
    s_waitcnt vmcnt(0)
    v_max_u32 v40, v16, v17
    v_max3_u32 v40, v40, v18, v19
    v_max3_u32 v40, v40, v20, v21
    v_max3_u32 v40, v40, v22, v23
    v_max3_u32 v40, v40, v24, v25
    v_max3_u32 v40, v40, v26, v27
    v_max3_u32 v40, v40, v28, v29
    v_max3_u32 v40, v40, v30, v31
    v_max3_u32 v40, v40, v32, v33
    v_max3_u32 v40, v40, v34, v35
    v_max3_u32 v40, v40, v36, v37
    v_max3_u32 v40, v40, v38, v39
    v_cmp_eq_u32 vcc, -1, v40
    s_nop 0
    s_cbranch_vccnz L_a_cp_44_s
    v_mfma_f32_16x16x32_bf16 v[72:75], v[24:27], a[0:3], 0
    v_mfma_f32_16x16x32_bf16 v[76:79], v[24:27], a[16:19], 0
    v_mfma_f32_16x16x32_bf16 v[72:75], v[28:31], a[4:7], v[72:75]
    v_mfma_f32_16x16x32_bf16 v[76:79], v[28:31], a[20:23], v[76:79]
    v_mfma_f32_16x16x32_bf16 v[72:75], v[32:35], a[8:11], v[72:75]
    v_mfma_f32_16x16x32_bf16 v[76:79], v[32:35], a[24:27], v[76:79]
    v_mfma_f32_16x16x32_bf16 v[72:75], v[36:39], a[12:15], v[72:75]
    v_mfma_f32_16x16x32_bf16 v[76:79], v[36:39], a[28:31], v[76:79]
    ds_write_b128 v11, v[16:19] offset:8704
    ds_write_b128 v11, v[20:23] offset:8832
    s_waitcnt lgkmcnt(0)
    ds_read_b64_tr_b16 a[84:85], v12 offset:8704
    ds_read_b64_tr_b16 a[90:91], v12 offset:8736
    ds_read_b64_tr_b16 a[96:97], v12 offset:8768
    ds_read_b64_tr_b16 a[102:103], v12 offset:8800
    ds_read_b64_tr_b16 a[108:109], v12 offset:8832
    ds_read_b64_tr_b16 a[114:115], v12 offset:8864
    ds_read_b64_tr_b16 a[120:121], v12 offset:8896
    ds_read_b64_tr_b16 a[126:127], v12 offset:8928
    v_cndmask_b32 v72, v72, v15, s[56:57]
    v_cndmask_b32 v73, v73, v15, s[56:57]
    v_cndmask_b32 v74, v74, v15, s[56:57]
    v_cndmask_b32 v75, v75, v15, s[56:57]
    v_cndmask_b32 v76, v76, v15, s[56:57]
    v_cndmask_b32 v77, v77, v15, s[56:57]
    v_cndmask_b32 v78, v78, v15, s[56:57]
    v_cndmask_b32 v79, v79, v15, s[56:57]
    v_max_f32 v40, v56, v57
    v_max3_f32 v40, v40, v58, v59
    v_max3_f32 v40, v40, v72, v73
    v_max3_f32 v40, v40, v74, v75
    v_mov_b32 v41, v40
    s_nop 1
    v_permlane16_swap_b32 v40, v41
    v_max_f32 v40, v40, v41
    v_mov_b32 v41, v40
    s_nop 1
    v_permlane32_swap_b32 v40, v41
    v_max_f32 v40, v40, v41
    v_mul_f32 v40, s54, v40
    v_fma_f32 v56, v56, s54, -v40
    v_fma_f32 v57, v57, s54, -v40
    v_fma_f32 v58, v58, s54, -v40
    v_fma_f32 v59, v59, s54, -v40
    v_fma_f32 v72, v72, s54, -v40
    v_fma_f32 v73, v73, s54, -v40
    v_fma_f32 v74, v74, s54, -v40
    v_fma_f32 v75, v75, s54, -v40
    v_exp_f32 v56, v56
    v_exp_f32 v57, v57
    v_exp_f32 v58, v58
    v_exp_f32 v59, v59
    v_exp_f32 v72, v72
    v_exp_f32 v73, v73
    v_exp_f32 v74, v74
    v_exp_f32 v75, v75
    v_add_f32 v40, v56, v57
    v_add_f32 v40, v40, v58
    v_add_f32 v40, v40, v59
    v_add_f32 v40, v40, v72
    v_add_f32 v40, v40, v73
    v_add_f32 v40, v40, v74
    v_add_f32 v40, v40, v75
    v_mov_b32 v41, v40
    s_nop 1
    v_permlane16_swap_b32 v40, v41
    v_add_f32 v40, v40, v41
    v_mov_b32 v41, v40
    s_nop 1
    v_permlane32_swap_b32 v40, v41
    v_add_f32 v40, v40, v41
    v_rcp_f32 v40, v40
    s_nop 0
    v_mul_f32 v56, v56, v40
    v_mul_f32 v57, v57, v40
    v_mul_f32 v58, v58, v40
    v_mul_f32 v59, v59, v40
    v_mul_f32 v72, v72, v40
    v_mul_f32 v73, v73, v40
    v_mul_f32 v74, v74, v40
    v_mul_f32 v75, v75, v40
    v_cvt_pk_bf16_f32 v24, v56, v57
    v_cvt_pk_bf16_f32 v25, v58, v59
    v_cvt_pk_bf16_f32 v28, v72, v73
    v_cvt_pk_bf16_f32 v29, v74, v75
    v_max_f32 v40, v60, v61
    v_max3_f32 v40, v40, v62, v63
    v_max3_f32 v40, v40, v68, v69
    v_max3_f32 v40, v40, v70, v71
    v_max3_f32 v40, v40, v76, v77
    v_max3_f32 v40, v40, v78, v79
    v_mov_b32 v41, v40
    s_nop 1
    v_permlane16_swap_b32 v40, v41
    v_max_f32 v40, v40, v41
    v_mov_b32 v41, v40
    s_nop 1
    v_permlane32_swap_b32 v40, v41
    v_max_f32 v40, v40, v41
    v_mul_f32 v40, s54, v40
    v_fma_f32 v60, v60, s54, -v40
    v_fma_f32 v61, v61, s54, -v40
    v_fma_f32 v62, v62, s54, -v40
    v_fma_f32 v63, v63, s54, -v40
    v_fma_f32 v68, v68, s54, -v40
    v_fma_f32 v69, v69, s54, -v40
    v_fma_f32 v70, v70, s54, -v40
    v_fma_f32 v71, v71, s54, -v40
    v_fma_f32 v76, v76, s54, -v40
    v_fma_f32 v77, v77, s54, -v40
    v_fma_f32 v78, v78, s54, -v40
    v_fma_f32 v79, v79, s54, -v40
    v_exp_f32 v60, v60
    v_exp_f32 v61, v61
    v_exp_f32 v62, v62
    v_exp_f32 v63, v63
    v_exp_f32 v68, v68
    v_exp_f32 v69, v69
    v_exp_f32 v70, v70
    v_exp_f32 v71, v71
    v_exp_f32 v76, v76
    v_exp_f32 v77, v77
    v_exp_f32 v78, v78
    v_exp_f32 v79, v79
    v_add_f32 v40, v60, v61
    v_add_f32 v40, v40, v62
    v_add_f32 v40, v40, v63
    v_add_f32 v40, v40, v68
    v_add_f32 v40, v40, v69
    v_add_f32 v40, v40, v70
    v_add_f32 v40, v40, v71
    v_add_f32 v40, v40, v76
    v_add_f32 v40, v40, v77
    v_add_f32 v40, v40, v78
    v_add_f32 v40, v40, v79
    v_mov_b32 v41, v40
    s_nop 1
    v_permlane16_swap_b32 v40, v41
    v_add_f32 v40, v40, v41
    v_mov_b32 v41, v40
    s_nop 1
    v_permlane32_swap_b32 v40, v41
    v_add_f32 v40, v40, v41
    v_rcp_f32 v40, v40
    s_nop 0
    v_mul_f32 v60, v60, v40
    v_mul_f32 v61, v61, v40
    v_mul_f32 v62, v62, v40
    v_mul_f32 v63, v63, v40
    v_mul_f32 v68, v68, v40
    v_mul_f32 v69, v69, v40
    v_mul_f32 v70, v70, v40
    v_mul_f32 v71, v71, v40
    v_mul_f32 v76, v76, v40
    v_mul_f32 v77, v77, v40
    v_mul_f32 v78, v78, v40
    v_mul_f32 v79, v79, v40
    v_cvt_pk_bf16_f32 v30, v60, v61
    v_cvt_pk_bf16_f32 v31, v62, v63
    v_cvt_pk_bf16_f32 v32, v68, v69
    v_cvt_pk_bf16_f32 v33, v70, v71
    v_cvt_pk_bf16_f32 v34, v76, v77
    v_cvt_pk_bf16_f32 v35, v78, v79
    s_waitcnt lgkmcnt(0)
    s_nop 0
    v_mfma_f32_16x16x16_bf16 v[64:67], a[80:81], v[24:25], 0
    v_mfma_f32_16x16x16_bf16 v[68:71], a[86:87], v[24:25], 0
    v_mfma_f32_16x16x16_bf16 v[72:75], a[92:93], v[24:25], 0
    v_mfma_f32_16x16x16_bf16 v[76:79], a[98:99], v[24:25], 0
    v_mfma_f32_16x16x16_bf16 v[80:83], a[104:105], v[24:25], 0
    v_mfma_f32_16x16x16_bf16 v[84:87], a[110:111], v[24:25], 0
    v_mfma_f32_16x16x16_bf16 v[88:91], a[116:117], v[24:25], 0
    v_mfma_f32_16x16x16_bf16 v[92:95], a[122:123], v[24:25], 0
    v_mfma_f32_16x16x16_bf16 v[64:67], a[84:85], v[28:29], v[64:67]
    v_mfma_f32_16x16x16_bf16 v[68:71], a[90:91], v[28:29], v[68:71]
    v_mfma_f32_16x16x16_bf16 v[72:75], a[96:97], v[28:29], v[72:75]
    v_mfma_f32_16x16x16_bf16 v[76:79], a[102:103], v[28:29], v[76:79]
    v_mfma_f32_16x16x16_bf16 v[80:83], a[108:109], v[28:29], v[80:83]
    v_mfma_f32_16x16x16_bf16 v[84:87], a[114:115], v[28:29], v[84:87]
    v_mfma_f32_16x16x16_bf16 v[88:91], a[120:121], v[28:29], v[88:91]
    v_mfma_f32_16x16x16_bf16 v[92:95], a[126:127], v[28:29], v[92:95]
    v_mfma_f32_16x16x16_bf16 v[96:99], a[80:81], v[30:31], 0
    v_mfma_f32_16x16x16_bf16 v[100:103], a[86:87], v[30:31], 0
    v_mfma_f32_16x16x16_bf16 v[104:107], a[92:93], v[30:31], 0
    v_mfma_f32_16x16x16_bf16 v[108:111], a[98:99], v[30:31], 0
    v_mfma_f32_16x16x16_bf16 v[112:115], a[104:105], v[30:31], 0
    v_mfma_f32_16x16x16_bf16 v[116:119], a[110:111], v[30:31], 0
    v_mfma_f32_16x16x16_bf16 v[120:123], a[116:117], v[30:31], 0
    v_mfma_f32_16x16x16_bf16 v[124:127], a[122:123], v[30:31], 0
    v_mfma_f32_16x16x16_bf16 v[96:99], a[82:83], v[32:33], v[96:99]
    v_mfma_f32_16x16x16_bf16 v[100:103], a[88:89], v[32:33], v[100:103]
    v_mfma_f32_16x16x16_bf16 v[104:107], a[94:95], v[32:33], v[104:107]
    v_mfma_f32_16x16x16_bf16 v[108:111], a[100:101], v[32:33], v[108:111]
    v_mfma_f32_16x16x16_bf16 v[112:115], a[106:107], v[32:33], v[112:115]
    v_mfma_f32_16x16x16_bf16 v[116:119], a[112:113], v[32:33], v[116:119]
    v_mfma_f32_16x16x16_bf16 v[120:123], a[118:119], v[32:33], v[120:123]
    v_mfma_f32_16x16x16_bf16 v[124:127], a[124:125], v[32:33], v[124:127]
    v_mfma_f32_16x16x16_bf16 v[96:99], a[84:85], v[34:35], v[96:99]
    v_mfma_f32_16x16x16_bf16 v[100:103], a[90:91], v[34:35], v[100:103]
    v_mfma_f32_16x16x16_bf16 v[104:107], a[96:97], v[34:35], v[104:107]
    v_mfma_f32_16x16x16_bf16 v[108:111], a[102:103], v[34:35], v[108:111]
    v_mfma_f32_16x16x16_bf16 v[112:115], a[108:109], v[34:35], v[112:115]
    v_mfma_f32_16x16x16_bf16 v[116:119], a[114:115], v[34:35], v[116:119]
    v_mfma_f32_16x16x16_bf16 v[120:123], a[120:121], v[34:35], v[120:123]
    v_mfma_f32_16x16x16_bf16 v[124:127], a[126:127], v[34:35], v[124:127]
    s_add_u32 s46, s63, 4096
    v_cvt_pk_bf16_f32 v64, v64, v65
    v_cvt_pk_bf16_f32 v65, v66, v67
    v_cvt_pk_bf16_f32 v66, v68, v69
    v_cvt_pk_bf16_f32 v67, v70, v71
    buffer_store_dwordx4 v[64:67], v10, s[12:15], s63 offen offset:0 sc1
    v_cvt_pk_bf16_f32 v72, v72, v73
    v_cvt_pk_bf16_f32 v73, v74, v75
    v_cvt_pk_bf16_f32 v74, v76, v77
    v_cvt_pk_bf16_f32 v75, v78, v79
    buffer_store_dwordx4 v[72:75], v10, s[12:15], s63 offen offset:2048 sc1
    v_cvt_pk_bf16_f32 v80, v80, v81
    v_cvt_pk_bf16_f32 v81, v82, v83
    v_cvt_pk_bf16_f32 v82, v84, v85
    v_cvt_pk_bf16_f32 v83, v86, v87
    buffer_store_dwordx4 v[80:83], v10, s[12:15], s46 offen offset:0 sc1
    v_cvt_pk_bf16_f32 v88, v88, v89
    v_cvt_pk_bf16_f32 v89, v90, v91
    v_cvt_pk_bf16_f32 v90, v92, v93
    v_cvt_pk_bf16_f32 v91, v94, v95
    buffer_store_dwordx4 v[88:91], v10, s[12:15], s46 offen offset:2048 sc1
    v_cvt_pk_bf16_f32 v96, v96, v97
    v_cvt_pk_bf16_f32 v97, v98, v99
    v_cvt_pk_bf16_f32 v98, v100, v101
    v_cvt_pk_bf16_f32 v99, v102, v103
    buffer_store_dwordx4 v[96:99], v10, s[12:15], s63 offen offset:256 sc1
    v_cvt_pk_bf16_f32 v104, v104, v105
    v_cvt_pk_bf16_f32 v105, v106, v107
    v_cvt_pk_bf16_f32 v106, v108, v109
    v_cvt_pk_bf16_f32 v107, v110, v111
    buffer_store_dwordx4 v[104:107], v10, s[12:15], s63 offen offset:2304 sc1
    v_cvt_pk_bf16_f32 v112, v112, v113
    v_cvt_pk_bf16_f32 v113, v114, v115
    v_cvt_pk_bf16_f32 v114, v116, v117
    v_cvt_pk_bf16_f32 v115, v118, v119
    buffer_store_dwordx4 v[112:115], v10, s[12:15], s46 offen offset:256 sc1
    v_cvt_pk_bf16_f32 v120, v120, v121
    v_cvt_pk_bf16_f32 v121, v122, v123
    v_cvt_pk_bf16_f32 v122, v124, v125
    v_cvt_pk_bf16_f32 v123, v126, v127
    buffer_store_dwordx4 v[120:123], v10, s[12:15], s46 offen offset:2304 sc1
    s_waitcnt vmcnt(0)
    v_mov_b32 v16, s60
    v_add_u32 v16, 1, v16
    v_mov_b32 v17, 0
    s_mov_b64 exec, 1
    buffer_store_dword v16, v17, s[12:15], s52 offen sc1
    s_mov_b64 exec, -1
L_sf_47:
    s_add_u32 s60, s60, 4
    s_cmp_lt_u32 s60, 64
    s_cbranch_scc1 L_a_loop_41
    s_branch L_c_done_1
L_w_g_9:
    s_lshr_b32 s53, s48, 2
    s_cmp_lt_u32 s53, 2
    s_cselect_b32 s46, 1, 0
    s_xor_b32 s53, s53, s46
    s_mov_b32 s74, 0
    s_mov_b32 s76, 0
    s_cmp_eq_u32 s53, 1
    s_cselect_b32 s75, 50, 64
    s_cmp_eq_u32 s53, 2
    s_cselect_b32 s75, 53, s75
L_w_g_9_e:
    s_lshl_b32 s46, s53, 3
    s_add_u32 s46, s46, 16
    s_load_dwordx2 s[4:5], s[0:1], s46
    s_lshl_b32 s49, s40, 2
    s_and_b32 s46, s48, 3
    s_add_u32 s49, s49, s46
    s_load_dwordx2 s[6:7], s[0:1], 72
    s_and_b32 s50, s44, 3
    s_lshr_b32 s51, s44, 2
    s_waitcnt lgkmcnt(0)
    s_mov_b32 s24, s4
    s_and_b32 s25, s5, 0xffff
    s_mov_b32 s26, 0x800000
    s_mov_b32 s27, 0x00020000
    s_cmp_lg_u32 s53, 0
    s_cbranch_scc1 L_g_nq_48
    s_load_dwordx4 s[8:11], s[0:1], 24
    v_and_b32 v10, 255, v0
    v_lshlrev_b32 v10, 13, v10
    s_and_b32 s46, s48, 3
    s_lshl_b32 s46, s46, 21
    s_lshl_b32 s47, s40, 10
    s_add_u32 s46, s46, s47
    s_add_u32 s46, s46, 384
    s_waitcnt lgkmcnt(0)
    s_cmp_eq_u32 s51, 1
    s_cselect_b32 s8, s10, s8
    s_cselect_b32 s9, s11, s9
    s_mov_b32 s28, s8
    s_and_b32 s29, s9, 0xffff
    s_mov_b32 s30, 0x800000
    s_mov_b32 s31, 0x00020000
    buffer_load_dword v11, v10, s[28:31], s46 offen
    s_cmp_eq_u32 s51, 1
    s_cbranch_scc1 L_g_nq_48
    buffer_load_dword v12, v10, s[24:27], s46 offen
L_g_nq_48:
    v_lshrrev_b32 v3, 4, v1
    v_and_b32 v4, 15, v1
    v_lshlrev_b32 v5, 2, v3
    v_xor_b32 v4, v4, v5
    v_mul_u32_u24 v3, 8192, v3
    v_lshl_add_u32 v3, v4, 4, v3
    s_mul_i32 s46, s51, 512
    s_mul_i32 s47, s50, 64
    s_add_u32 s46, s46, s47
    s_mul_i32 s46, s46, 8192
    s_lshl_b32 s47, s49, 8
    s_add_u32 s46, s46, s47
    s_lshl_b32 s45, s51, 16
    s_mul_i32 s47, s50, 16384
    s_add_u32 s45, s45, s47
    v_bfe_u32 v4, v1, 2, 2
    v_bfe_u32 v5, v1, 4, 1
    v_lshlrev_b32 v5, 1, v5
    v_bfe_u32 v6, v1, 0, 1
    v_add_u32 v5, v5, v6
    s_lshl_b32 s47, s50, 2
    v_add_u32 v5, s47, v5
    v_lshlrev_b32 v6, 2, v4
    v_xor_b32 v5, v5, v6
    v_lshlrev_b32 v5, 4, v5
    v_lshl_add_u32 v5, v4, 8, v5
    v_bfe_u32 v6, v1, 1, 1
    v_lshl_add_u32 v5, v6, 3, v5
    v_lshrrev_b32 v6, 5, v1
    v_mul_u32_u24 v6, 2048, v6
    v_add_u32 v5, v5, v6
    s_lshl_b32 s47, s51, 16
    v_add_u32 v5, s47, v5
    v_bfe_u32 v4, v1, 2, 2
    v_xor_b32 v5, s50, v4
    v_lshlrev_b32 v5, 6, v5
    v_lshl_add_u32 v5, v4, 8, v5
    v_and_b32 v6, 3, v1
    v_lshl_add_u32 v5, v6, 4, v5
    v_lshrrev_b32 v6, 4, v1
    v_lshl_add_u32 v5, v6, 11, v5
    v_lshrrev_b32 v6, 5, v1
    s_lshl_b32 s47, s51, 16
    v_add_u32 v5, s47, v5
    s_add_u32 m0, s45, 0
    s_add_u32 s47, s46, 0x0
    buffer_load_dwordx4 v3, s[24:27], s47 offen lds
    s_add_u32 m0, s45, 1024
    s_add_u32 s47, s46, 0x8000
    buffer_load_dwordx4 v3, s[24:27], s47 offen lds
    s_add_u32 m0, s45, 2048
    s_add_u32 s47, s46, 0x10000
    buffer_load_dwordx4 v3, s[24:27], s47 offen lds
    s_add_u32 m0, s45, 3072
    s_add_u32 s47, s46, 0x18000
    buffer_load_dwordx4 v3, s[24:27], s47 offen lds
    s_add_u32 m0, s45, 4096
    s_add_u32 s47, s46, 0x20000
    buffer_load_dwordx4 v3, s[24:27], s47 offen lds
    s_add_u32 m0, s45, 5120
    s_add_u32 s47, s46, 0x28000
    buffer_load_dwordx4 v3, s[24:27], s47 offen lds
    s_add_u32 m0, s45, 6144
    s_add_u32 s47, s46, 0x30000
    buffer_load_dwordx4 v3, s[24:27], s47 offen lds
    s_add_u32 m0, s45, 7168
    s_add_u32 s47, s46, 0x38000
    buffer_load_dwordx4 v3, s[24:27], s47 offen lds
    s_add_u32 m0, s45, 8192
    s_add_u32 s47, s46, 0x40000
    buffer_load_dwordx4 v3, s[24:27], s47 offen lds
    s_add_u32 m0, s45, 9216
    s_add_u32 s47, s46, 0x48000
    buffer_load_dwordx4 v3, s[24:27], s47 offen lds
    s_add_u32 m0, s45, 10240
    s_add_u32 s47, s46, 0x50000
    buffer_load_dwordx4 v3, s[24:27], s47 offen lds
    s_add_u32 m0, s45, 11264
    s_add_u32 s47, s46, 0x58000
    buffer_load_dwordx4 v3, s[24:27], s47 offen lds
    s_add_u32 m0, s45, 12288
    s_add_u32 s47, s46, 0x60000
    buffer_load_dwordx4 v3, s[24:27], s47 offen lds
    s_add_u32 m0, s45, 13312
    s_add_u32 s47, s46, 0x68000
    buffer_load_dwordx4 v3, s[24:27], s47 offen lds
    s_add_u32 m0, s45, 14336
    s_add_u32 s47, s46, 0x70000
    buffer_load_dwordx4 v3, s[24:27], s47 offen lds
    s_add_u32 m0, s45, 15360
    s_add_u32 s47, s46, 0x78000
    buffer_load_dwordx4 v3, s[24:27], s47 offen lds
    s_waitcnt vmcnt(0)
    s_barrier
    ds_read_b64_tr_b16 a[0:1], v5 offset:0
    ds_read_b64_tr_b16 a[2:3], v5 offset:1024
    ds_read_b64_tr_b16 a[4:5], v5 offset:8
    ds_read_b64_tr_b16 a[6:7], v5 offset:1032
    ds_read_b64_tr_b16 a[8:9], v5 offset:8192
    ds_read_b64_tr_b16 a[10:11], v5 offset:9216
    ds_read_b64_tr_b16 a[12:13], v5 offset:8200
    ds_read_b64_tr_b16 a[14:15], v5 offset:9224
    s_waitcnt lgkmcnt(0)
    ds_read_b64_tr_b16 a[16:17], v5 offset:16384
    ds_read_b64_tr_b16 a[18:19], v5 offset:17408
    ds_read_b64_tr_b16 a[20:21], v5 offset:16392
    ds_read_b64_tr_b16 a[22:23], v5 offset:17416
    ds_read_b64_tr_b16 a[24:25], v5 offset:24576
    ds_read_b64_tr_b16 a[26:27], v5 offset:25600
    ds_read_b64_tr_b16 a[28:29], v5 offset:24584
    ds_read_b64_tr_b16 a[30:31], v5 offset:25608
    s_waitcnt lgkmcnt(0)
    ds_read_b64_tr_b16 a[32:33], v5 offset:32768
    ds_read_b64_tr_b16 a[34:35], v5 offset:33792
    ds_read_b64_tr_b16 a[36:37], v5 offset:32776
    ds_read_b64_tr_b16 a[38:39], v5 offset:33800
    ds_read_b64_tr_b16 a[40:41], v5 offset:40960
    ds_read_b64_tr_b16 a[42:43], v5 offset:41984
    ds_read_b64_tr_b16 a[44:45], v5 offset:40968
    ds_read_b64_tr_b16 a[46:47], v5 offset:41992
    s_waitcnt lgkmcnt(0)
    ds_read_b64_tr_b16 a[48:49], v5 offset:49152
    ds_read_b64_tr_b16 a[50:51], v5 offset:50176
    ds_read_b64_tr_b16 a[52:53], v5 offset:49160
    ds_read_b64_tr_b16 a[54:55], v5 offset:50184
    ds_read_b64_tr_b16 a[56:57], v5 offset:57344
    ds_read_b64_tr_b16 a[58:59], v5 offset:58368
    ds_read_b64_tr_b16 a[60:61], v5 offset:57352
    ds_read_b64_tr_b16 a[62:63], v5 offset:58376
    s_waitcnt lgkmcnt(0)
    s_waitcnt lgkmcnt(0)
    s_barrier
    s_add_u32 m0, s45, 0
    s_add_u32 s47, s46, 0x200000
    buffer_load_dwordx4 v3, s[24:27], s47 offen lds
    s_add_u32 m0, s45, 1024
    s_add_u32 s47, s46, 0x208000
    buffer_load_dwordx4 v3, s[24:27], s47 offen lds
    s_add_u32 m0, s45, 2048
    s_add_u32 s47, s46, 0x210000
    buffer_load_dwordx4 v3, s[24:27], s47 offen lds
    s_add_u32 m0, s45, 3072
    s_add_u32 s47, s46, 0x218000
    buffer_load_dwordx4 v3, s[24:27], s47 offen lds
    s_add_u32 m0, s45, 4096
    s_add_u32 s47, s46, 0x220000
    buffer_load_dwordx4 v3, s[24:27], s47 offen lds
    s_add_u32 m0, s45, 5120
    s_add_u32 s47, s46, 0x228000
    buffer_load_dwordx4 v3, s[24:27], s47 offen lds
    s_add_u32 m0, s45, 6144
    s_add_u32 s47, s46, 0x230000
    buffer_load_dwordx4 v3, s[24:27], s47 offen lds
    s_add_u32 m0, s45, 7168
    s_add_u32 s47, s46, 0x238000
    buffer_load_dwordx4 v3, s[24:27], s47 offen lds
    s_add_u32 m0, s45, 8192
    s_add_u32 s47, s46, 0x240000
    buffer_load_dwordx4 v3, s[24:27], s47 offen lds
    s_add_u32 m0, s45, 9216
    s_add_u32 s47, s46, 0x248000
    buffer_load_dwordx4 v3, s[24:27], s47 offen lds
    s_add_u32 m0, s45, 10240
    s_add_u32 s47, s46, 0x250000
    buffer_load_dwordx4 v3, s[24:27], s47 offen lds
    s_add_u32 m0, s45, 11264
    s_add_u32 s47, s46, 0x258000
    buffer_load_dwordx4 v3, s[24:27], s47 offen lds
    s_add_u32 m0, s45, 12288
    s_add_u32 s47, s46, 0x260000
    buffer_load_dwordx4 v3, s[24:27], s47 offen lds
    s_add_u32 m0, s45, 13312
    s_add_u32 s47, s46, 0x268000
    buffer_load_dwordx4 v3, s[24:27], s47 offen lds
    s_add_u32 m0, s45, 14336
    s_add_u32 s47, s46, 0x270000
    buffer_load_dwordx4 v3, s[24:27], s47 offen lds
    s_add_u32 m0, s45, 15360
    s_add_u32 s47, s46, 0x278000
    buffer_load_dwordx4 v3, s[24:27], s47 offen lds
    s_waitcnt vmcnt(0)
    s_barrier
    ds_read_b64_tr_b16 a[64:65], v5 offset:0
    ds_read_b64_tr_b16 a[66:67], v5 offset:1024
    ds_read_b64_tr_b16 a[68:69], v5 offset:8
    ds_read_b64_tr_b16 a[70:71], v5 offset:1032
    ds_read_b64_tr_b16 a[72:73], v5 offset:8192
    ds_read_b64_tr_b16 a[74:75], v5 offset:9216
    ds_read_b64_tr_b16 a[76:77], v5 offset:8200
    ds_read_b64_tr_b16 a[78:79], v5 offset:9224
    s_waitcnt lgkmcnt(0)
    ds_read_b64_tr_b16 a[80:81], v5 offset:16384
    ds_read_b64_tr_b16 a[82:83], v5 offset:17408
    ds_read_b64_tr_b16 a[84:85], v5 offset:16392
    ds_read_b64_tr_b16 a[86:87], v5 offset:17416
    ds_read_b64_tr_b16 a[88:89], v5 offset:24576
    ds_read_b64_tr_b16 a[90:91], v5 offset:25600
    ds_read_b64_tr_b16 a[92:93], v5 offset:24584
    ds_read_b64_tr_b16 a[94:95], v5 offset:25608
    s_waitcnt lgkmcnt(0)
    ds_read_b64_tr_b16 a[96:97], v5 offset:32768
    ds_read_b64_tr_b16 a[98:99], v5 offset:33792
    ds_read_b64_tr_b16 a[100:101], v5 offset:32776
    ds_read_b64_tr_b16 a[102:103], v5 offset:33800
    ds_read_b64_tr_b16 a[104:105], v5 offset:40960
    ds_read_b64_tr_b16 a[106:107], v5 offset:41984
    ds_read_b64_tr_b16 a[108:109], v5 offset:40968
    ds_read_b64_tr_b16 a[110:111], v5 offset:41992
    s_waitcnt lgkmcnt(0)
    ds_read_b64_tr_b16 a[112:113], v5 offset:49152
    ds_read_b64_tr_b16 a[114:115], v5 offset:50176
    ds_read_b64_tr_b16 a[116:117], v5 offset:49160
    ds_read_b64_tr_b16 a[118:119], v5 offset:50184
    ds_read_b64_tr_b16 a[120:121], v5 offset:57344
    ds_read_b64_tr_b16 a[122:123], v5 offset:58368
    ds_read_b64_tr_b16 a[124:125], v5 offset:57352
    ds_read_b64_tr_b16 a[126:127], v5 offset:58376
    s_waitcnt lgkmcnt(0)
    s_waitcnt lgkmcnt(0)
    s_barrier
    v_lshlrev_b32 v2, 4, v1
    s_mul_i32 s64, s44, 8192
    s_add_u32 s46, s64, 0x400000
    v_add_u32 v3, s46, v2
    s_mul_i32 s46, s51, 32768
    v_add_u32 v4, s46, v2
    v_and_b32 v6, 15, v1
    v_lshlrev_b32 v6, 4, v6
    v_lshrrev_b32 v7, 4, v1
    v_lshl_add_u32 v6, v7, 9, v6
    v_add_u32 v4, s46, v6
    s_lshl_b32 s46, s50, 12
    s_add_u32 s46, s46, 131072
    v_add_u32 v5, s46, v2
    v_and_b32 v7, 3, v1
    v_lshlrev_b32 v7, 7, v7
    v_add_u32 v7, 0x109400, v7
    s_mul_i32 s46, s49, 24576
    s_lshl_b32 s47, s53, 13
    s_add_u32 s46, s46, s47
    s_lshl_b32 s47, s50, 10
    s_add_u32 s46, s46, s47
    s_add_u32 s46, s46, 0x2000000
    v_and_b32 v8, 15, v1
    v_lshlrev_b32 v8, 4, v8
    v_bfe_u32 v9, v1, 4, 1
    v_lshl_add_u32 v8, v9, 12, v8
    v_lshrrev_b32 v9, 5, v1
    v_lshl_add_u32 v8, v9, 8, v8
    v_add_u32 v8, s46, v2
    v_add_u32 v9, 4096, v8
    s_lshl_b32 s52, s40, 2
    s_add_u32 s52, s52, s53
    s_lshl_b32 s52, s52, 2
    s_and_b32 s47, s48, 3
    s_add_u32 s52, s52, s47
    s_lshl_b32 s52, s52, 7
    s_add_u32 s52, s52, 0x10a400
    s_add_u32 s52, s52, s76
    v_mov_b32 v116, -1
    v_mov_b32 v117, -1
    v_mov_b32 v118, -1
    v_mov_b32 v119, -1
    s_lshl_b32 s46, s49, 12
    s_lshl_b32 s47, s50, 10
    s_add_u32 s46, s46, s47
    s_add_u32 s46, s46, 0x1000000
    v_add_u32 v64, s46, v2
    s_and_b32 s46, s48, 3
    s_lshl_b32 s46, s46, 16
    s_lshl_b32 s47, s50, 14
    s_add_u32 s46, s46, s47
    s_lshl_b32 s47, s40, 8
    s_add_u32 s46, s46, s47
    s_add_u32 s46, s46, 0x7800000
    v_and_b32 v65, 15, v1
    v_lshlrev_b32 v65, 4, v65
    v_lshrrev_b32 v66, 4, v1
    v_lshl_add_u32 v65, v66, 11, v65
    v_add_u32 v65, s46, v65
    s_cmp_eq_u32 s53, 2
    s_cselect_b64 vcc, -1, 0
    v_cndmask_b32 v64, v64, v65, vcc
    v_add_u32 v65, 8192, v64
    s_lshl_b32 s73, s53, 17
    s_mul_i32 s58, s74, s73
    s_lshl_b32 s46, s53, 3
    s_sub_u32 s46, 80, s46
    s_load_dwordx2 s[8:9], s[0:1], s46
    v_lshlrev_b32 v66, 7, v1
    s_mul_i32 s57, s49, 229376
    s_waitcnt lgkmcnt(0)
    s_mov_b32 s32, s8
    s_and_b32 s33, s9, 0xffff
    s_mov_b32 s34, 0x700000
    s_mov_b32 s35, 0x00020000
    s_mov_b32 s60, s74
    s_mul_i32 s61, s74, 65536
    s_mov_b32 s62, s74
    s_mul_i32 s63, s74, 786432
    s_mov_b32 s67, 0
    s_mov_b32 s68, 3
    s_mov_b32 s71, 0
    v_mov_b32 v15, 147456
    v_mov_b32 v14, 0
    ds_write_b32 v15, v14 offset:4
    ds_write_b32 v15, v14 offset:12
    ds_write_b32 v15, v14 offset:16
    v_mov_b32 v114, 1
    s_mov_b32 s72, 0
    s_cmp_lg_u32 s44, 0
    s_cbranch_scc1 L_zwok_58
    v_and_b32 v10, 7, v1
    v_lshlrev_b32 v10, 5, v10
    s_mov_b32 s70, 0
L_zw_57:
    buffer_load_dword v11, v10, s[16:19], 0 offen sc1
    s_waitcnt vmcnt(0)
    v_add_u32_dpp v11, v11, v11 row_ror:1 row_mask:0xf bank_mask:0xf
    s_nop 1
    v_add_u32_dpp v11, v11, v11 row_ror:2 row_mask:0xf bank_mask:0xf
    s_nop 1
    v_add_u32_dpp v11, v11, v11 row_ror:4 row_mask:0xf bank_mask:0xf
    v_cmp_ne_u32 vcc, 0x100, v11
    s_add_u32 s70, s70, 1
    s_cbranch_vccz L_zwok_58
    s_sleep 4
    s_cmp_lt_u32 s70, 524288
    s_cbranch_scc1 L_zw_57
    s_branch L_c_done_1
L_zwok_58:
L_g_restart_49:
    s_cmp_lg_u32 s44, 0
    s_cbranch_scc1 L_g_nsp_50
    s_mov_b32 s70, 0
L_g_sp_56:
    s_add_u32 s54, s60, 0
    s_add_u32 s55, s54, 0
    s_and_b32 s46, s55, 7
    s_lshl_b32 s46, s46, 9
    buffer_load_dword v11, v7, s[12:15], s46 offen sc1
    s_add_u32 s55, s54, 1
    s_and_b32 s46, s55, 7
    s_lshl_b32 s46, s46, 9
    buffer_load_dword v12, v7, s[12:15], s46 offen sc1
    s_add_u32 s55, s54, 2
    s_and_b32 s46, s55, 7
    s_lshl_b32 s46, s46, 9
    buffer_load_dword v13, v7, s[12:15], s46 offen sc1
    s_waitcnt vmcnt(0)
    v_cmp_ge_u32 vcc, s60, v11
    s_add_u32 s70, s70, 1
    s_cbranch_vccz L_g_sp_56_ok
    s_sleep 3
    s_cmp_lt_u32 s70, 524288
    s_cbranch_scc1 L_g_sp_56
    s_branch L_c_done_1
L_g_sp_56_ok:
    s_mov_b32 s46, s54
    v_cmp_ge_u32 vcc, s46, v11
    s_nop 0
    s_cbranch_vccnz L_g_le_59
    s_add_u32 s46, s46, 1
    v_cmp_ge_u32 vcc, s46, v12
    s_nop 0
    s_cbranch_vccnz L_g_le_59
    s_add_u32 s46, s46, 1
    v_cmp_ge_u32 vcc, s46, v13
    s_nop 0
    s_cbranch_vccnz L_g_le_59
    s_add_u32 s46, s46, 1
L_g_le_59:
    s_min_u32 s46, s46, s75
    v_mov_b32 v11, s46
    ds_write_b32 v15, v11
L_g_nsp_50:
    s_waitcnt lgkmcnt(0)
    s_barrier
    ds_read_b32 v14, v15
    s_waitcnt lgkmcnt(0)
    v_readfirstlane_b32 s66, v14
    s_nop 3
L_g_restart_49_go:
    s_mov_b32 s69, 0
    s_cmp_gt_u32 s62, s60
    s_cbranch_scc1 L_g_nd_60
    s_cmp_ge_u32 s62, s66
    s_cbranch_scc1 L_g_nd_60
    s_add_u32 s47, s61, 4096
    s_add_u32 m0, s64, 0
    s_nop 0
    buffer_load_dwordx4 v3, s[12:15], s61 offen offset:0 sc1 lds
    buffer_load_dwordx4 v3, s[12:15], s61 offen offset:1024 sc1 lds
    buffer_load_dwordx4 v3, s[12:15], s61 offen offset:2048 sc1 lds
    buffer_load_dwordx4 v3, s[12:15], s61 offen offset:3072 sc1 lds
    s_add_u32 m0, s64, 4096
    s_nop 0
    buffer_load_dwordx4 v3, s[12:15], s47 offen offset:0 sc1 lds
    buffer_load_dwordx4 v3, s[12:15], s47 offen offset:1024 sc1 lds
    buffer_load_dwordx4 v3, s[12:15], s47 offen offset:2048 sc1 lds
    buffer_load_dwordx4 v3, s[12:15], s47 offen offset:3072 sc1 lds
    s_add_u32 s61, s61, 65536
    s_add_u32 s62, s62, 1
    s_xor_b32 s64, s64, 0x10000
    s_mov_b32 s69, 1
L_g_nd_60:
    s_cmp_eq_u32 s51, 1
    s_cbranch_scc1 L_g_g1r_51
    s_add_u32 s59, s60, 1
    s_mov_b32 s69, 0
    s_cmp_gt_u32 s62, s59
    s_cbranch_scc1 L_g_nd_61
    s_cmp_ge_u32 s62, s66
    s_cbranch_scc1 L_g_nd_61
    s_add_u32 s47, s61, 4096
    s_add_u32 m0, s64, 0
    s_nop 0
    buffer_load_dwordx4 v3, s[12:15], s61 offen offset:0 sc1 lds
    buffer_load_dwordx4 v3, s[12:15], s61 offen offset:1024 sc1 lds
    buffer_load_dwordx4 v3, s[12:15], s61 offen offset:2048 sc1 lds
    buffer_load_dwordx4 v3, s[12:15], s61 offen offset:3072 sc1 lds
    s_add_u32 m0, s64, 4096
    s_nop 0
    buffer_load_dwordx4 v3, s[12:15], s47 offen offset:0 sc1 lds
    buffer_load_dwordx4 v3, s[12:15], s47 offen offset:1024 sc1 lds
    buffer_load_dwordx4 v3, s[12:15], s47 offen offset:2048 sc1 lds
    buffer_load_dwordx4 v3, s[12:15], s47 offen offset:3072 sc1 lds
    s_add_u32 s61, s61, 65536
    s_add_u32 s62, s62, 1
    s_xor_b32 s64, s64, 0x10000
    s_mov_b32 s69, 1
L_g_nd_61:
    s_cmp_eq_u32 s69, 1
    s_cbranch_scc1 L_g_w0_62
    s_waitcnt vmcnt(0)
L_g_w0_62:
    s_waitcnt vmcnt(8)
    s_mov_b32 s65, 1
.p2align 6
L_g_loop0_52:
    s_barrier
    s_cmp_eq_u32 s65, 0
    s_cbranch_scc1 L_g_pr_63
    ds_read_b128 v[32:35], v4 offset:0
    ds_read_b128 v[36:39], v4 offset:256
    ds_read_b128 v[40:43], v4 offset:2048
    ds_read_b128 v[44:47], v4 offset:2304
    ds_read_b128 v[48:51], v4 offset:4096
    ds_read_b128 v[52:55], v4 offset:4352
    ds_read_b128 v[56:59], v4 offset:6144
    ds_read_b128 v[60:63], v4 offset:6400
    ds_read_b128 v[72:75], v4 offset:8192
    ds_read_b128 v[76:79], v4 offset:8448
    ds_read_b128 v[120:123], v4 offset:10240
    ds_read_b128 v[124:127], v4 offset:10496
L_g_pr_63:
    ds_read_b32 v14, v15
    s_cmp_lg_u32 s44, 0
    s_cbranch_scc1 L_g_nl_64
    s_add_u32 s54, s60, 1
    s_add_u32 s55, s54, 0
    s_and_b32 s46, s55, 7
    s_lshl_b32 s46, s46, 9
    buffer_load_dword v11, v7, s[12:15], s46 offen sc1
    s_add_u32 s55, s54, 1
    s_and_b32 s46, s55, 7
    s_lshl_b32 s46, s46, 9
    buffer_load_dword v12, v7, s[12:15], s46 offen sc1
    s_add_u32 s55, s54, 2
    s_and_b32 s46, s55, 7
    s_lshl_b32 s46, s46, 9
    buffer_load_dword v13, v7, s[12:15], s46 offen sc1
L_g_nl_64:
    s_setprio 2
    s_waitcnt lgkmcnt(8)
    v_mfma_f32_16x16x32_bf16 v[16:19], a[0:3], v[32:35], 0
    v_mfma_f32_16x16x32_bf16 v[20:23], a[4:7], v[32:35], 0
    ds_read_b128 v[32:35], v4 offset:12288
    v_mfma_f32_16x16x32_bf16 v[28:31], a[4:7], v[36:39], 0
    v_mfma_f32_16x16x32_bf16 v[24:27], a[0:3], v[36:39], 0
    ds_read_b128 v[36:39], v4 offset:12544
    v_mfma_f32_16x16x32_bf16 v[16:19], a[8:11], v[40:43], v[16:19]
    v_mfma_f32_16x16x32_bf16 v[20:23], a[12:15], v[40:43], v[20:23]
    ds_read_b128 v[40:43], v4 offset:14336
    v_mfma_f32_16x16x32_bf16 v[28:31], a[12:15], v[44:47], v[28:31]
    v_mfma_f32_16x16x32_bf16 v[24:27], a[8:11], v[44:47], v[24:27]
    ds_read_b128 v[44:47], v4 offset:14592
    s_waitcnt lgkmcnt(8)
    v_mfma_f32_16x16x32_bf16 v[16:19], a[16:19], v[48:51], v[16:19]
    v_mfma_f32_16x16x32_bf16 v[20:23], a[20:23], v[48:51], v[20:23]
    ds_read_b128 v[48:51], v4 offset:16384
    v_mfma_f32_16x16x32_bf16 v[28:31], a[20:23], v[52:55], v[28:31]
    v_mfma_f32_16x16x32_bf16 v[24:27], a[16:19], v[52:55], v[24:27]
    ds_read_b128 v[52:55], v4 offset:16640
    v_mfma_f32_16x16x32_bf16 v[16:19], a[24:27], v[56:59], v[16:19]
    v_mfma_f32_16x16x32_bf16 v[20:23], a[28:31], v[56:59], v[20:23]
    ds_read_b128 v[56:59], v4 offset:18432
    v_mfma_f32_16x16x32_bf16 v[28:31], a[28:31], v[60:63], v[28:31]
    v_mfma_f32_16x16x32_bf16 v[24:27], a[24:27], v[60:63], v[24:27]
    ds_read_b128 v[60:63], v4 offset:18688
    s_waitcnt lgkmcnt(8)
    v_mfma_f32_16x16x32_bf16 v[16:19], a[32:35], v[72:75], v[16:19]
    v_mfma_f32_16x16x32_bf16 v[20:23], a[36:39], v[72:75], v[20:23]
    ds_read_b128 v[72:75], v4 offset:20480
    v_mfma_f32_16x16x32_bf16 v[28:31], a[36:39], v[76:79], v[28:31]
    v_mfma_f32_16x16x32_bf16 v[24:27], a[32:35], v[76:79], v[24:27]
    ds_read_b128 v[76:79], v4 offset:20736
    v_mfma_f32_16x16x32_bf16 v[16:19], a[40:43], v[120:123], v[16:19]
    v_mfma_f32_16x16x32_bf16 v[20:23], a[44:47], v[120:123], v[20:23]
    ds_read_b128 v[120:123], v4 offset:22528
    v_mfma_f32_16x16x32_bf16 v[28:31], a[44:47], v[124:127], v[28:31]
    v_mfma_f32_16x16x32_bf16 v[24:27], a[40:43], v[124:127], v[24:27]
    ds_read_b128 v[124:127], v4 offset:22784
    s_waitcnt lgkmcnt(8)
    v_mfma_f32_16x16x32_bf16 v[16:19], a[48:51], v[32:35], v[16:19]
    v_mfma_f32_16x16x32_bf16 v[20:23], a[52:55], v[32:35], v[20:23]
    ds_read_b128 v[32:35], v4 offset:24576
    v_mfma_f32_16x16x32_bf16 v[28:31], a[52:55], v[36:39], v[28:31]
    v_mfma_f32_16x16x32_bf16 v[24:27], a[48:51], v[36:39], v[24:27]
    ds_read_b128 v[36:39], v4 offset:24832
    v_mfma_f32_16x16x32_bf16 v[16:19], a[56:59], v[40:43], v[16:19]
    v_mfma_f32_16x16x32_bf16 v[20:23], a[60:63], v[40:43], v[20:23]
    ds_read_b128 v[40:43], v4 offset:26624
    v_mfma_f32_16x16x32_bf16 v[28:31], a[60:63], v[44:47], v[28:31]
    v_mfma_f32_16x16x32_bf16 v[24:27], a[56:59], v[44:47], v[24:27]
    ds_read_b128 v[44:47], v4 offset:26880
    s_waitcnt lgkmcnt(8)
    v_mfma_f32_16x16x32_bf16 v[16:19], a[64:67], v[48:51], v[16:19]
    v_mfma_f32_16x16x32_bf16 v[20:23], a[68:71], v[48:51], v[20:23]
    ds_read_b128 v[48:51], v4 offset:28672
    v_mfma_f32_16x16x32_bf16 v[28:31], a[68:71], v[52:55], v[28:31]
    v_mfma_f32_16x16x32_bf16 v[24:27], a[64:67], v[52:55], v[24:27]
    ds_read_b128 v[52:55], v4 offset:28928
    v_mfma_f32_16x16x32_bf16 v[16:19], a[72:75], v[56:59], v[16:19]
    v_mfma_f32_16x16x32_bf16 v[20:23], a[76:79], v[56:59], v[20:23]
    ds_read_b128 v[56:59], v4 offset:30720
    v_mfma_f32_16x16x32_bf16 v[28:31], a[76:79], v[60:63], v[28:31]
    v_mfma_f32_16x16x32_bf16 v[24:27], a[72:75], v[60:63], v[24:27]
    ds_read_b128 v[60:63], v4 offset:30976
    s_waitcnt lgkmcnt(8)
    v_mfma_f32_16x16x32_bf16 v[16:19], a[80:83], v[72:75], v[16:19]
    v_mfma_f32_16x16x32_bf16 v[20:23], a[84:87], v[72:75], v[20:23]
    v_mfma_f32_16x16x32_bf16 v[28:31], a[84:87], v[76:79], v[28:31]
    v_mfma_f32_16x16x32_bf16 v[24:27], a[80:83], v[76:79], v[24:27]
    v_mfma_f32_16x16x32_bf16 v[16:19], a[88:91], v[120:123], v[16:19]
    v_mfma_f32_16x16x32_bf16 v[20:23], a[92:95], v[120:123], v[20:23]
    v_mfma_f32_16x16x32_bf16 v[28:31], a[92:95], v[124:127], v[28:31]
    v_mfma_f32_16x16x32_bf16 v[24:27], a[88:91], v[124:127], v[24:27]
    s_waitcnt lgkmcnt(4)
    v_mfma_f32_16x16x32_bf16 v[16:19], a[96:99], v[32:35], v[16:19]
    v_mfma_f32_16x16x32_bf16 v[20:23], a[100:103], v[32:35], v[20:23]
    v_mfma_f32_16x16x32_bf16 v[28:31], a[100:103], v[36:39], v[28:31]
    v_mfma_f32_16x16x32_bf16 v[24:27], a[96:99], v[36:39], v[24:27]
    v_mfma_f32_16x16x32_bf16 v[16:19], a[104:107], v[40:43], v[16:19]
    v_mfma_f32_16x16x32_bf16 v[20:23], a[108:111], v[40:43], v[20:23]
    v_mfma_f32_16x16x32_bf16 v[28:31], a[108:111], v[44:47], v[28:31]
    v_mfma_f32_16x16x32_bf16 v[24:27], a[104:107], v[44:47], v[24:27]
    s_waitcnt lgkmcnt(0)
    v_mfma_f32_16x16x32_bf16 v[16:19], a[112:115], v[48:51], v[16:19]
    v_mfma_f32_16x16x32_bf16 v[20:23], a[116:119], v[48:51], v[20:23]
    v_mfma_f32_16x16x32_bf16 v[28:31], a[116:119], v[52:55], v[28:31]
    v_mfma_f32_16x16x32_bf16 v[24:27], a[112:115], v[52:55], v[24:27]
    v_mfma_f32_16x16x32_bf16 v[16:19], a[120:123], v[56:59], v[16:19]
    v_mfma_f32_16x16x32_bf16 v[20:23], a[124:127], v[56:59], v[20:23]
    v_mfma_f32_16x16x32_bf16 v[28:31], a[124:127], v[60:63], v[28:31]
    v_mfma_f32_16x16x32_bf16 v[24:27], a[120:123], v[60:63], v[24:27]
    v_xor_b32 v4, 0x10000, v4
    s_setprio 0
    s_waitcnt vmcnt(0)
    v_readfirstlane_b32 s66, v14
    s_barrier
    s_nop 6
    ds_write_b128 v5, v[16:19] offset:0
    ds_write_b128 v5, v[20:23] offset:1024
    ds_write_b128 v5, v[24:27] offset:2048
    ds_write_b128 v5, v[28:31] offset:3072
    s_cmp_lg_u32 s44, 0
    s_cbranch_scc1 L_g_ne_65
    s_mov_b32 s46, s54
    v_cmp_ge_u32 vcc, s46, v11
    s_nop 0
    s_cbranch_vccnz L_g_le_68
    s_add_u32 s46, s46, 1
    v_cmp_ge_u32 vcc, s46, v12
    s_nop 0
    s_cbranch_vccnz L_g_le_68
    s_add_u32 s46, s46, 1
    v_cmp_ge_u32 vcc, s46, v13
    s_nop 0
    s_cbranch_vccnz L_g_le_68
    s_add_u32 s46, s46, 1
L_g_le_68:
    s_min_u32 s46, s46, s75
    v_mov_b32 v11, s46
    ds_write_b32 v15, v11
L_g_ne_65:
    s_add_u32 s60, s60, 1
    s_mov_b32 s69, 0
    s_cmp_gt_u32 s62, s60
    s_cbranch_scc1 L_g_nd_69
    s_cmp_ge_u32 s62, s66
    s_cbranch_scc1 L_g_nd_69
    s_add_u32 s47, s61, 4096
    s_add_u32 m0, s64, 0
    s_nop 0
    buffer_load_dwordx4 v3, s[12:15], s61 offen offset:0 sc1 lds
    buffer_load_dwordx4 v3, s[12:15], s61 offen offset:1024 sc1 lds
    buffer_load_dwordx4 v3, s[12:15], s61 offen offset:2048 sc1 lds
    buffer_load_dwordx4 v3, s[12:15], s61 offen offset:3072 sc1 lds
    s_add_u32 m0, s64, 4096
    s_nop 0
    buffer_load_dwordx4 v3, s[12:15], s47 offen offset:0 sc1 lds
    buffer_load_dwordx4 v3, s[12:15], s47 offen offset:1024 sc1 lds
    buffer_load_dwordx4 v3, s[12:15], s47 offen offset:2048 sc1 lds
    buffer_load_dwordx4 v3, s[12:15], s47 offen offset:3072 sc1 lds
    s_add_u32 s61, s61, 65536
    s_add_u32 s62, s62, 1
    s_xor_b32 s64, s64, 0x10000
    s_mov_b32 s69, 1
L_g_nd_69:
    s_mov_b32 s65, s69
    s_add_u32 s59, s60, 1
    s_mov_b32 s69, 0
    s_cmp_gt_u32 s62, s59
    s_cbranch_scc1 L_g_nd_70
    s_cmp_ge_u32 s62, s66
    s_cbranch_scc1 L_g_nd_70
    s_add_u32 s47, s61, 4096
    s_add_u32 m0, s64, 0
    s_nop 0
    buffer_load_dwordx4 v3, s[12:15], s61 offen offset:0 sc1 lds
    buffer_load_dwordx4 v3, s[12:15], s61 offen offset:1024 sc1 lds
    buffer_load_dwordx4 v3, s[12:15], s61 offen offset:2048 sc1 lds
    buffer_load_dwordx4 v3, s[12:15], s61 offen offset:3072 sc1 lds
    s_add_u32 m0, s64, 4096
    s_nop 0
    buffer_load_dwordx4 v3, s[12:15], s47 offen offset:0 sc1 lds
    buffer_load_dwordx4 v3, s[12:15], s47 offen offset:1024 sc1 lds
    buffer_load_dwordx4 v3, s[12:15], s47 offen offset:2048 sc1 lds
    buffer_load_dwordx4 v3, s[12:15], s47 offen offset:3072 sc1 lds
    s_add_u32 s61, s61, 65536
    s_add_u32 s62, s62, 1
    s_xor_b32 s64, s64, 0x10000
    s_mov_b32 s69, 1
L_g_nd_70:
    s_cmp_le_u32 s66, s60
    s_cbranch_scc1 L_g_ex0_67
    s_cmp_eq_u32 s65, 0
    s_cbranch_scc1 L_g_nw_66
    s_waitcnt vmcnt(0) lgkmcnt(0)
    s_branch L_g_loop0_52
L_g_nw_66:
    ds_read_b128 v[32:35], v4 offset:0
    ds_read_b128 v[36:39], v4 offset:256
    ds_read_b128 v[40:43], v4 offset:2048
    ds_read_b128 v[44:47], v4 offset:2304
    ds_read_b128 v[48:51], v4 offset:4096
    ds_read_b128 v[52:55], v4 offset:4352
    ds_read_b128 v[56:59], v4 offset:6144
    ds_read_b128 v[60:63], v4 offset:6400
    ds_read_b128 v[72:75], v4 offset:8192
    ds_read_b128 v[76:79], v4 offset:8448
    ds_read_b128 v[120:123], v4 offset:10240
    ds_read_b128 v[124:127], v4 offset:10496
    s_waitcnt lgkmcnt(12)
    s_branch L_g_loop0_52
L_g_ex0_67:
    s_cmp_lg_u32 s44, 0
    s_cbranch_scc1 L_g_ex0_67_n
    s_sleep 6
    s_add_u32 s54, s60, 0
    s_add_u32 s55, s54, 0
    s_and_b32 s46, s55, 7
    s_lshl_b32 s46, s46, 9
    buffer_load_dword v11, v7, s[12:15], s46 offen sc1
    s_add_u32 s55, s54, 1
    s_and_b32 s46, s55, 7
    s_lshl_b32 s46, s46, 9
    buffer_load_dword v12, v7, s[12:15], s46 offen sc1
    s_add_u32 s55, s54, 2
    s_and_b32 s46, s55, 7
    s_lshl_b32 s46, s46, 9
    buffer_load_dword v13, v7, s[12:15], s46 offen sc1
    s_waitcnt vmcnt(0)
    s_mov_b32 s46, s54
    v_cmp_ge_u32 vcc, s46, v11
    s_nop 0
    s_cbranch_vccnz L_g_le_71
    s_add_u32 s46, s46, 1
    v_cmp_ge_u32 vcc, s46, v12
    s_nop 0
    s_cbranch_vccnz L_g_le_71
    s_add_u32 s46, s46, 1
    v_cmp_ge_u32 vcc, s46, v13
    s_nop 0
    s_cbranch_vccnz L_g_le_71
    s_add_u32 s46, s46, 1
L_g_le_71:
    s_min_u32 s46, s46, s75
    v_mov_b32 v11, s46
    ds_write_b32 v15, v11
L_g_ex0_67_n:
    s_waitcnt lgkmcnt(0)
    s_barrier
    ds_read_b32 v14, v15
    s_waitcnt lgkmcnt(0)
    v_readfirstlane_b32 s66, v14
    s_barrier
    s_cmp_gt_u32 s66, s60
    s_cbranch_scc1 L_g_restart_49_go
    s_branch L_g_tail_54
L_g_g1r_51:
    s_mov_b32 s65, 1
    s_branch L_g_loop1_53_e
.p2align 6
L_g_loop1_53:
    s_mov_b32 s65, 0
L_g_loop1_53_e:
    s_barrier
    ds_read_b32 v14, v15
    s_bitcmp1_b32 s67, 1
    s_cbranch_scc0 L_g_nfl_72
    s_sub_u32 s59, s60, 2
    s_cmp_lg_u32 s44, 4
    s_cbranch_scc1 L_sf_77
    v_mov_b32 v10, s59
    v_add_u32 v10, 1, v10
    v_mov_b32 v11, 0
    s_mov_b64 exec, 1
    buffer_store_dword v10, v11, s[12:15], s52 offen sc1
    s_mov_b64 exec, -1
L_sf_77:
L_g_nfl_72:
    s_cmp_eq_u32 s71, 0
    s_cbranch_scc1 L_g_nfl_72_d
    v_mov_b32 v10, 1
    s_mov_b64 exec, 1
    s_waitcnt vmcnt(0)
    ds_add_rtn_u32 v10, v15, v10 offset:4
    s_waitcnt lgkmcnt(0)
    v_readfirstlane_b32 s46, v10
    s_mov_b64 exec, -1
    s_mov_b32 s71, 0
    s_sub_u32 s59, s60, 1
    s_cmp_lg_u32 s46, s68
    s_cbranch_scc1 L_g_df_78
    v_mov_b32 v10, s59
    v_add_u32 v10, 1, v10
    v_mov_b32 v11, 0
    s_mov_b64 exec, 1
    buffer_store_dword v10, v11, s[12:15], s52 offen sc1
    s_mov_b64 exec, -1
L_sf_79:
L_g_df_78:
    s_add_u32 s68, s68, 4
    s_mov_b32 s65, 2
L_g_nfl_72_d:
    s_waitcnt lgkmcnt(0)
    v_readfirstlane_b32 s66, v14
    s_nop 3
    s_mov_b32 s69, 0
    s_cmp_gt_u32 s62, s60
    s_cbranch_scc1 L_g_nd_80
    s_cmp_ge_u32 s62, s66
    s_cbranch_scc1 L_g_nd_80
    s_add_u32 s47, s61, 4096
    s_add_u32 m0, s64, 0
    s_nop 0
    buffer_load_dwordx4 v3, s[12:15], s61 offen offset:0 sc1 lds
    buffer_load_dwordx4 v3, s[12:15], s61 offen offset:1024 sc1 lds
    buffer_load_dwordx4 v3, s[12:15], s61 offen offset:2048 sc1 lds
    buffer_load_dwordx4 v3, s[12:15], s61 offen offset:3072 sc1 lds
    s_add_u32 m0, s64, 4096
    s_nop 0
    buffer_load_dwordx4 v3, s[12:15], s47 offen offset:0 sc1 lds
    buffer_load_dwordx4 v3, s[12:15], s47 offen offset:1024 sc1 lds
    buffer_load_dwordx4 v3, s[12:15], s47 offen offset:2048 sc1 lds
    buffer_load_dwordx4 v3, s[12:15], s47 offen offset:3072 sc1 lds
    s_add_u32 s61, s61, 65536
    s_add_u32 s62, s62, 1
    s_xor_b32 s64, s64, 0x10000
    s_mov_b32 s69, 1
L_g_nd_80:
    s_or_b32 s65, s65, s69
    s_add_u32 s59, s60, 1
    s_mov_b32 s69, 0
    s_cmp_gt_u32 s62, s59
    s_cbranch_scc1 L_g_nd_81
    s_cmp_ge_u32 s62, s66
    s_cbranch_scc1 L_g_nd_81
    s_add_u32 s47, s61, 4096
    s_add_u32 m0, s64, 0
    s_nop 0
    buffer_load_dwordx4 v3, s[12:15], s61 offen offset:0 sc1 lds
    buffer_load_dwordx4 v3, s[12:15], s61 offen offset:1024 sc1 lds
    buffer_load_dwordx4 v3, s[12:15], s61 offen offset:2048 sc1 lds
    buffer_load_dwordx4 v3, s[12:15], s61 offen offset:3072 sc1 lds
    s_add_u32 m0, s64, 4096
    s_nop 0
    buffer_load_dwordx4 v3, s[12:15], s47 offen offset:0 sc1 lds
    buffer_load_dwordx4 v3, s[12:15], s47 offen offset:1024 sc1 lds
    buffer_load_dwordx4 v3, s[12:15], s47 offen offset:2048 sc1 lds
    buffer_load_dwordx4 v3, s[12:15], s47 offen offset:3072 sc1 lds
    s_add_u32 s61, s61, 65536
    s_add_u32 s62, s62, 1
    s_xor_b32 s64, s64, 0x10000
    s_mov_b32 s69, 1
L_g_nd_81:
    s_bitcmp1_b32 s67, 0
    s_cbranch_scc0 L_g_nep_73
    ds_read_b128 v[80:83], v5 offset:0
    ds_read_b128 v[84:87], v5 offset:1024
    ds_read_b128 v[88:91], v5 offset:2048
    ds_read_b128 v[92:95], v5 offset:3072
    s_nop 7
    s_waitcnt lgkmcnt(3)
    v_add_f32 v80, v80, v16
    v_add_f32 v81, v81, v17
    v_add_f32 v82, v82, v18
    v_add_f32 v83, v83, v19
    s_waitcnt lgkmcnt(2)
    v_add_f32 v84, v84, v20
    v_add_f32 v85, v85, v21
    v_add_f32 v86, v86, v22
    v_add_f32 v87, v87, v23
    s_waitcnt lgkmcnt(1)
    v_add_f32 v88, v88, v24
    v_add_f32 v89, v89, v25
    v_add_f32 v90, v90, v26
    v_add_f32 v91, v91, v27
    s_waitcnt lgkmcnt(0)
    v_add_f32 v92, v92, v28
    v_add_f32 v93, v93, v29
    v_add_f32 v94, v94, v30
    v_add_f32 v95, v95, v31
    v_cvt_pk_bf16_f32 v104, v80, v81
    v_cvt_pk_bf16_f32 v105, v82, v83
    v_cvt_pk_bf16_f32 v106, v84, v85
    v_cvt_pk_bf16_f32 v107, v86, v87
    buffer_store_dwordx4 v[104:107], v8, s[12:15], s63 offen sc1
    v_cvt_pk_bf16_f32 v108, v88, v89
    v_cvt_pk_bf16_f32 v109, v90, v91
    v_cvt_pk_bf16_f32 v110, v92, v93
    v_cvt_pk_bf16_f32 v111, v94, v95
    buffer_store_dwordx4 v[108:111], v9, s[12:15], s63 offen sc1
    s_add_u32 s63, s63, 786432
    s_cmp_eq_u32 s53, 0
    s_cbranch_scc1 L_g_pf_82
    buffer_store_dwordx4 v[116:119], v64, s[12:15], s58 offen sc1
    s_cmp_eq_u32 s53, 1
    s_cbranch_scc1 L_g_pf_82
    buffer_store_dwordx4 v[116:119], v65, s[12:15], s58 offen sc1
L_g_pf_82:
    s_add_u32 s58, s58, s73
    s_cmp_gt_u32 s60, 2
    s_cbranch_scc1 L_g_nep_73
    v_mov_b32 v10, 1
    s_mov_b64 exec, 1
    s_waitcnt vmcnt(0)
    ds_add_rtn_u32 v10, v15, v10 offset:4
    s_waitcnt lgkmcnt(0)
    v_readfirstlane_b32 s46, v10
    s_mov_b64 exec, -1
    s_mov_b32 s71, 0
    s_sub_u32 s59, s60, 1
    s_cmp_lg_u32 s46, s68
    s_cbranch_scc1 L_g_df_83
    v_mov_b32 v10, s59
    v_add_u32 v10, 1, v10
    v_mov_b32 v11, 0
    s_mov_b64 exec, 1
    buffer_store_dword v10, v11, s[12:15], s52 offen sc1
    s_mov_b64 exec, -1
L_sf_84:
L_g_df_83:
    s_add_u32 s68, s68, 4
L_g_nep_73:
    s_cmp_eq_u32 s65, 0
    s_cbranch_scc1 L_g_nw1_74
    s_cmp_eq_u32 s65, 2
    s_cbranch_scc1 L_g_nw1_74_w
    s_waitcnt vmcnt(0)
L_g_nw1_74_w:
    s_barrier
    ds_read_b128 v[32:35], v4 offset:0
    ds_read_b128 v[36:39], v4 offset:256
    ds_read_b128 v[40:43], v4 offset:2048
    ds_read_b128 v[44:47], v4 offset:2304
    ds_read_b128 v[48:51], v4 offset:4096
    ds_read_b128 v[52:55], v4 offset:4352
    ds_read_b128 v[56:59], v4 offset:6144
    ds_read_b128 v[60:63], v4 offset:6400
    ds_read_b128 v[72:75], v4 offset:8192
    ds_read_b128 v[76:79], v4 offset:8448
    ds_read_b128 v[120:123], v4 offset:10240
    ds_read_b128 v[124:127], v4 offset:10496
    s_branch L_g_jn_76
L_g_nw1_74:
    ds_read_b128 v[32:35], v4 offset:0
    ds_read_b128 v[36:39], v4 offset:256
    ds_read_b128 v[40:43], v4 offset:2048
    ds_read_b128 v[44:47], v4 offset:2304
    ds_read_b128 v[48:51], v4 offset:4096
    ds_read_b128 v[52:55], v4 offset:4352
    ds_read_b128 v[56:59], v4 offset:6144
    ds_read_b128 v[60:63], v4 offset:6400
    ds_read_b128 v[72:75], v4 offset:8192
    ds_read_b128 v[76:79], v4 offset:8448
    ds_read_b128 v[120:123], v4 offset:10240
    ds_read_b128 v[124:127], v4 offset:10496
    s_barrier
L_g_jn_76:
    s_setprio 1
    s_waitcnt lgkmcnt(8)
    v_mfma_f32_16x16x32_bf16 v[16:19], a[0:3], v[32:35], 0
    v_mfma_f32_16x16x32_bf16 v[20:23], a[4:7], v[32:35], 0
    ds_read_b128 v[32:35], v4 offset:12288
    v_mfma_f32_16x16x32_bf16 v[28:31], a[4:7], v[36:39], 0
    v_mfma_f32_16x16x32_bf16 v[24:27], a[0:3], v[36:39], 0
    ds_read_b128 v[36:39], v4 offset:12544
    v_mfma_f32_16x16x32_bf16 v[16:19], a[8:11], v[40:43], v[16:19]
    v_mfma_f32_16x16x32_bf16 v[20:23], a[12:15], v[40:43], v[20:23]
    ds_read_b128 v[40:43], v4 offset:14336
    v_mfma_f32_16x16x32_bf16 v[28:31], a[12:15], v[44:47], v[28:31]
    v_mfma_f32_16x16x32_bf16 v[24:27], a[8:11], v[44:47], v[24:27]
    ds_read_b128 v[44:47], v4 offset:14592
    s_waitcnt lgkmcnt(8)
    v_mfma_f32_16x16x32_bf16 v[16:19], a[16:19], v[48:51], v[16:19]
    v_mfma_f32_16x16x32_bf16 v[20:23], a[20:23], v[48:51], v[20:23]
    ds_read_b128 v[48:51], v4 offset:16384
    v_mfma_f32_16x16x32_bf16 v[28:31], a[20:23], v[52:55], v[28:31]
    v_mfma_f32_16x16x32_bf16 v[24:27], a[16:19], v[52:55], v[24:27]
    ds_read_b128 v[52:55], v4 offset:16640
    v_mfma_f32_16x16x32_bf16 v[16:19], a[24:27], v[56:59], v[16:19]
    v_mfma_f32_16x16x32_bf16 v[20:23], a[28:31], v[56:59], v[20:23]
    ds_read_b128 v[56:59], v4 offset:18432
    v_mfma_f32_16x16x32_bf16 v[28:31], a[28:31], v[60:63], v[28:31]
    v_mfma_f32_16x16x32_bf16 v[24:27], a[24:27], v[60:63], v[24:27]
    ds_read_b128 v[60:63], v4 offset:18688
    s_waitcnt lgkmcnt(8)
    v_mfma_f32_16x16x32_bf16 v[16:19], a[32:35], v[72:75], v[16:19]
    v_mfma_f32_16x16x32_bf16 v[20:23], a[36:39], v[72:75], v[20:23]
    ds_read_b128 v[72:75], v4 offset:20480
    v_mfma_f32_16x16x32_bf16 v[28:31], a[36:39], v[76:79], v[28:31]
    v_mfma_f32_16x16x32_bf16 v[24:27], a[32:35], v[76:79], v[24:27]
    ds_read_b128 v[76:79], v4 offset:20736
    v_mfma_f32_16x16x32_bf16 v[16:19], a[40:43], v[120:123], v[16:19]
    v_mfma_f32_16x16x32_bf16 v[20:23], a[44:47], v[120:123], v[20:23]
    ds_read_b128 v[120:123], v4 offset:22528
    v_mfma_f32_16x16x32_bf16 v[28:31], a[44:47], v[124:127], v[28:31]
    v_mfma_f32_16x16x32_bf16 v[24:27], a[40:43], v[124:127], v[24:27]
    ds_read_b128 v[124:127], v4 offset:22784
    s_waitcnt lgkmcnt(8)
    v_mfma_f32_16x16x32_bf16 v[16:19], a[48:51], v[32:35], v[16:19]
    v_mfma_f32_16x16x32_bf16 v[20:23], a[52:55], v[32:35], v[20:23]
    ds_read_b128 v[32:35], v4 offset:24576
    v_mfma_f32_16x16x32_bf16 v[28:31], a[52:55], v[36:39], v[28:31]
    v_mfma_f32_16x16x32_bf16 v[24:27], a[48:51], v[36:39], v[24:27]
    ds_read_b128 v[36:39], v4 offset:24832
    v_mfma_f32_16x16x32_bf16 v[16:19], a[56:59], v[40:43], v[16:19]
    v_mfma_f32_16x16x32_bf16 v[20:23], a[60:63], v[40:43], v[20:23]
    ds_read_b128 v[40:43], v4 offset:26624
    v_mfma_f32_16x16x32_bf16 v[28:31], a[60:63], v[44:47], v[28:31]
    v_mfma_f32_16x16x32_bf16 v[24:27], a[56:59], v[44:47], v[24:27]
    ds_read_b128 v[44:47], v4 offset:26880
    s_waitcnt lgkmcnt(8)
    v_mfma_f32_16x16x32_bf16 v[16:19], a[64:67], v[48:51], v[16:19]
    v_mfma_f32_16x16x32_bf16 v[20:23], a[68:71], v[48:51], v[20:23]
    ds_read_b128 v[48:51], v4 offset:28672
    v_mfma_f32_16x16x32_bf16 v[28:31], a[68:71], v[52:55], v[28:31]
    v_mfma_f32_16x16x32_bf16 v[24:27], a[64:67], v[52:55], v[24:27]
    ds_read_b128 v[52:55], v4 offset:28928
    v_mfma_f32_16x16x32_bf16 v[16:19], a[72:75], v[56:59], v[16:19]
    v_mfma_f32_16x16x32_bf16 v[20:23], a[76:79], v[56:59], v[20:23]
    ds_read_b128 v[56:59], v4 offset:30720
    v_mfma_f32_16x16x32_bf16 v[28:31], a[76:79], v[60:63], v[28:31]
    v_mfma_f32_16x16x32_bf16 v[24:27], a[72:75], v[60:63], v[24:27]
    ds_read_b128 v[60:63], v4 offset:30976
    s_waitcnt lgkmcnt(8)
    v_mfma_f32_16x16x32_bf16 v[16:19], a[80:83], v[72:75], v[16:19]
    v_mfma_f32_16x16x32_bf16 v[20:23], a[84:87], v[72:75], v[20:23]
    v_mfma_f32_16x16x32_bf16 v[28:31], a[84:87], v[76:79], v[28:31]
    v_mfma_f32_16x16x32_bf16 v[24:27], a[80:83], v[76:79], v[24:27]
    v_mfma_f32_16x16x32_bf16 v[16:19], a[88:91], v[120:123], v[16:19]
    v_mfma_f32_16x16x32_bf16 v[20:23], a[92:95], v[120:123], v[20:23]
    v_mfma_f32_16x16x32_bf16 v[28:31], a[92:95], v[124:127], v[28:31]
    v_mfma_f32_16x16x32_bf16 v[24:27], a[88:91], v[124:127], v[24:27]
    s_waitcnt lgkmcnt(4)
    v_mfma_f32_16x16x32_bf16 v[16:19], a[96:99], v[32:35], v[16:19]
    v_mfma_f32_16x16x32_bf16 v[20:23], a[100:103], v[32:35], v[20:23]
    v_mfma_f32_16x16x32_bf16 v[28:31], a[100:103], v[36:39], v[28:31]
    v_mfma_f32_16x16x32_bf16 v[24:27], a[96:99], v[36:39], v[24:27]
    v_mfma_f32_16x16x32_bf16 v[16:19], a[104:107], v[40:43], v[16:19]
    v_mfma_f32_16x16x32_bf16 v[20:23], a[108:111], v[40:43], v[20:23]
    v_mfma_f32_16x16x32_bf16 v[28:31], a[108:111], v[44:47], v[28:31]
    v_mfma_f32_16x16x32_bf16 v[24:27], a[104:107], v[44:47], v[24:27]
    s_waitcnt lgkmcnt(0)
    v_mfma_f32_16x16x32_bf16 v[16:19], a[112:115], v[48:51], v[16:19]
    v_mfma_f32_16x16x32_bf16 v[20:23], a[116:119], v[48:51], v[20:23]
    v_mfma_f32_16x16x32_bf16 v[28:31], a[116:119], v[52:55], v[28:31]
    v_mfma_f32_16x16x32_bf16 v[24:27], a[112:115], v[52:55], v[24:27]
    v_mfma_f32_16x16x32_bf16 v[16:19], a[120:123], v[56:59], v[16:19]
    v_mfma_f32_16x16x32_bf16 v[20:23], a[124:127], v[56:59], v[20:23]
    v_mfma_f32_16x16x32_bf16 v[28:31], a[124:127], v[60:63], v[28:31]
    v_mfma_f32_16x16x32_bf16 v[24:27], a[120:123], v[60:63], v[24:27]
    v_xor_b32 v4, 0x10000, v4
    s_setprio 0
    s_waitcnt vmcnt(0)
    s_lshl_b32 s67, s67, 1
    s_or_b32 s67, s67, 1
    s_add_u32 s60, s60, 1
    s_cmp_gt_u32 s66, s60
    s_cbranch_scc1 L_g_loop1_53
    s_barrier
    ds_read_b32 v14, v15
    s_waitcnt lgkmcnt(0)
    v_readfirstlane_b32 s66, v14
    s_barrier
    s_mov_b32 s69, 0
    s_cmp_gt_u32 s62, s60
    s_cbranch_scc1 L_g_nd_85
    s_cmp_ge_u32 s62, s66
    s_cbranch_scc1 L_g_nd_85
    s_add_u32 s47, s61, 4096
    s_add_u32 m0, s64, 0
    s_nop 0
    buffer_load_dwordx4 v3, s[12:15], s61 offen offset:0 sc1 lds
    buffer_load_dwordx4 v3, s[12:15], s61 offen offset:1024 sc1 lds
    buffer_load_dwordx4 v3, s[12:15], s61 offen offset:2048 sc1 lds
    buffer_load_dwordx4 v3, s[12:15], s61 offen offset:3072 sc1 lds
    s_add_u32 m0, s64, 4096
    s_nop 0
    buffer_load_dwordx4 v3, s[12:15], s47 offen offset:0 sc1 lds
    buffer_load_dwordx4 v3, s[12:15], s47 offen offset:1024 sc1 lds
    buffer_load_dwordx4 v3, s[12:15], s47 offen offset:2048 sc1 lds
    buffer_load_dwordx4 v3, s[12:15], s47 offen offset:3072 sc1 lds
    s_add_u32 s61, s61, 65536
    s_add_u32 s62, s62, 1
    s_xor_b32 s64, s64, 0x10000
    s_mov_b32 s69, 1
L_g_nd_85:
    s_sub_u32 s59, s60, 1
    ds_read_b128 v[80:83], v5 offset:0
    ds_read_b128 v[84:87], v5 offset:1024
    ds_read_b128 v[88:91], v5 offset:2048
    ds_read_b128 v[92:95], v5 offset:3072
    s_nop 7
    s_waitcnt lgkmcnt(3)
    v_add_f32 v80, v80, v16
    v_add_f32 v81, v81, v17
    v_add_f32 v82, v82, v18
    v_add_f32 v83, v83, v19
    s_waitcnt lgkmcnt(2)
    v_add_f32 v84, v84, v20
    v_add_f32 v85, v85, v21
    v_add_f32 v86, v86, v22
    v_add_f32 v87, v87, v23
    s_waitcnt lgkmcnt(1)
    v_add_f32 v88, v88, v24
    v_add_f32 v89, v89, v25
    v_add_f32 v90, v90, v26
    v_add_f32 v91, v91, v27
    s_waitcnt lgkmcnt(0)
    v_add_f32 v92, v92, v28
    v_add_f32 v93, v93, v29
    v_add_f32 v94, v94, v30
    v_add_f32 v95, v95, v31
    v_cvt_pk_bf16_f32 v104, v80, v81
    v_cvt_pk_bf16_f32 v105, v82, v83
    v_cvt_pk_bf16_f32 v106, v84, v85
    v_cvt_pk_bf16_f32 v107, v86, v87
    buffer_store_dwordx4 v[104:107], v8, s[12:15], s63 offen sc1
    v_cvt_pk_bf16_f32 v108, v88, v89
    v_cvt_pk_bf16_f32 v109, v90, v91
    v_cvt_pk_bf16_f32 v110, v92, v93
    v_cvt_pk_bf16_f32 v111, v94, v95
    buffer_store_dwordx4 v[108:111], v9, s[12:15], s63 offen sc1
    s_add_u32 s63, s63, 786432
    s_cmp_eq_u32 s53, 0
    s_cbranch_scc1 L_g_pf_86
    buffer_store_dwordx4 v[116:119], v64, s[12:15], s58 offen sc1
    s_cmp_eq_u32 s53, 1
    s_cbranch_scc1 L_g_pf_86
    buffer_store_dwordx4 v[116:119], v65, s[12:15], s58 offen sc1
L_g_pf_86:
    s_add_u32 s58, s58, s73
    s_mov_b32 s67, 0
    s_mov_b32 s71, 1
    s_cmp_gt_u32 s66, s60
    s_cbranch_scc1 L_g_g1r_51
    v_mov_b32 v10, 1
    s_mov_b64 exec, 1
    s_waitcnt vmcnt(0)
    ds_add_rtn_u32 v10, v15, v10 offset:4
    s_waitcnt lgkmcnt(0)
    v_readfirstlane_b32 s46, v10
    s_mov_b64 exec, -1
    s_mov_b32 s71, 0
    s_sub_u32 s59, s60, 1
    s_cmp_lg_u32 s46, s68
    s_cbranch_scc1 L_g_df_87
    v_mov_b32 v10, s59
    v_add_u32 v10, 1, v10
    v_mov_b32 v11, 0
    s_mov_b64 exec, 1
    buffer_store_dword v10, v11, s[12:15], s52 offen sc1
    s_mov_b64 exec, -1
L_sf_88:
L_g_df_87:
    s_add_u32 s68, s68, 4
    s_cmp_gt_u32 s66, s60
    s_cbranch_scc1 L_g_g1r_51
L_g_tail_54:
    s_cmp_lt_u32 s60, s75
    s_cbranch_scc1 L_g_restart_49
    s_waitcnt vmcnt(0)
    s_barrier
    s_branch L_w_p2_10
L_w_p2_10:
    s_cmp_eq_u32 s76, 0
    s_cbranch_scc1 L_w_p2_10_m
    s_add_u32 s48, s48, 1
    s_cmp_lt_u32 s48, s79
    s_cbranch_scc1 L_w_g_9_e
    s_cmp_lg_u32 s44, 0
    s_cbranch_scc1 L_w_h_16
    s_cmp_eq_u32 s53, 1
    s_cbranch_scc1 L_w_h_16
    v_and_b32 v10, 1, v1
    v_lshlrev_b32 v10, 7, v10
    s_sub_u32 s52, s52, 65664
    s_sub_u32 s47, s74, 1
    s_mov_b32 s70, 0
L_spin_89:
    buffer_load_dword v11, v10, s[12:15], s52 offen sc1
    s_waitcnt vmcnt(0)
    v_cmp_ge_u32 vcc, s47, v11
    s_add_u32 s70, s70, 1
    s_cbranch_vccz L_spok_90
    s_sleep 3
    s_cmp_lt_u32 s70, 524288
    s_cbranch_scc1 L_spin_89
    s_branch L_c_done_1
L_spok_90:
    v_mov_b32 v11, s75
    s_mov_b64 exec, 3
    buffer_store_dword v11, v10, s[12:15], s52 offen sc1
    s_mov_b64 exec, -1
    s_branch L_w_h_16
L_w_p2_10_m:
    s_cmp_lg_u32 s53, 1
    s_cbranch_scc1 L_w_p2_10_h
    s_cmp_lg_u32 s44, 0
    s_cbranch_scc1 L_w_p2_10_h
    v_mov_b32 v10, 65536
    s_mov_b32 s47, 63
    s_mov_b32 s70, 0
L_spin_91:
    buffer_load_dword v11, v10, s[12:15], s52 offen sc1
    s_waitcnt vmcnt(0)
    v_cmp_ge_u32 vcc, s47, v11
    s_add_u32 s70, s70, 1
    s_cbranch_vccz L_spok_92
    s_sleep 3
    s_cmp_lt_u32 s70, 524288
    s_cbranch_scc1 L_spin_91
    s_branch L_c_done_1
L_spok_92:
    v_mov_b32 v10, s47
    v_add_u32 v10, 1, v10
    v_mov_b32 v11, 0
    s_mov_b64 exec, 1
    buffer_store_dword v10, v11, s[12:15], s52 offen sc1
    s_mov_b64 exec, -1
L_sf_93:
L_w_p2_10_h:
    s_cmp_lt_u32 s48, 8
    s_cselect_b32 s75, 60, 60
    s_cmp_lt_u32 s48, 4
    s_cselect_b32 s75, 64, s75
L_w_p2_10_r:
    s_lshr_b32 s42, s40, 1
    s_and_b32 s43, s40, 1
    s_lshl_b32 s43, s43, 2
    s_and_b32 s46, s48, 3
    s_add_u32 s43, s43, s46
    s_cmp_lt_u32 s48, 4
    s_cbranch_scc1 L_w_wo_11
    s_cmp_lt_u32 s48, 8
    s_cbranch_scc1 L_w_f2_12
    s_cmp_lg_u32 s43, 7
    s_cbranch_scc1 L_w_f1_13
    s_mov_b32 s43, 2
    s_cmp_eq_u32 s76, 0
    s_cbranch_scc1 L_w_c_15
    s_mov_b32 s43, 7
    s_mov_b32 s78, 1
L_w_f1_13_t:
    s_cmp_lt_u32 s41, 8
    s_cselect_b32 s74, 60, 62
    s_cselect_b32 s75, 62, 64
    s_add_u32 s43, s43, s74
    s_cmp_lt_u32 s43, s75
    s_cbranch_scc1 L_w_h_16_f
    s_branch L_c_done_1
L_w_f1_13_d:
    s_cmp_eq_u32 s76, 0
    s_cbranch_scc1 L_c_done_1
    s_and_b32 s42, s49, 3
    s_lshr_b32 s43, s49, 2
    s_mov_b32 s78, 64
    s_branch L_w_f1_13_t
L_replica:
    s_setprio 0
    s_barrier
    s_and_b32 s48, s41, 7
    s_add_u32 s48, s48, 4
    s_cmp_lt_u32 s41, 8
    s_cselect_b32 s74, 60, 62
    s_cselect_b32 s75, 62, 64
    s_cselect_b32 s76, 1, 2
    s_cselect_b32 s46, 60, 62
    s_cselect_b32 s47, 62, 64
    s_mul_i32 s76, s76, 65536
    s_cmp_lt_u32 s48, 8
    s_cselect_b32 s74, s46, s74
    s_cselect_b32 s75, s47, s75
    s_branch L_w_p2_10_r
L_w_f1_13:
    s_load_dwordx2 s[4:5], s[0:1], 64
    s_load_dwordx2 s[6:7], s[0:1], 72
    s_and_b32 s50, s44, 3
    s_lshr_b32 s51, s44, 2
    s_waitcnt lgkmcnt(0)
    s_mov_b32 s24, s4
    s_and_b32 s25, s5, 0xffff
    s_mov_b32 s26, 0x700000
    s_mov_b32 s27, 0x00020000
    s_mul_i32 s49, s42, 7
    s_add_u32 s49, s49, s43
    v_lshrrev_b32 v3, 4, v1
    v_and_b32 v4, 15, v1
    v_lshlrev_b32 v5, 2, v3
    v_xor_b32 v4, v4, v5
    v_mul_u32_u24 v3, 7168, v3
    v_lshl_add_u32 v3, v4, 4, v3
    s_mul_i32 s46, s51, 512
    s_mul_i32 s47, s50, 64
    s_add_u32 s46, s46, s47
    s_mul_i32 s46, s46, 7168
    s_lshl_b32 s47, s49, 8
    s_add_u32 s46, s46, s47
    s_lshl_b32 s45, s51, 16
    s_mul_i32 s47, s50, 16384
    s_add_u32 s45, s45, s47
    v_bfe_u32 v4, v1, 2, 2
    v_bfe_u32 v5, v1, 4, 1
    v_lshlrev_b32 v5, 1, v5
    v_bfe_u32 v6, v1, 1, 1
    v_add_u32 v5, v5, v6
    s_lshl_b32 s47, s50, 2
    v_add_u32 v5, s47, v5
    v_lshlrev_b32 v6, 2, v4
    v_xor_b32 v5, v5, v6
    v_lshlrev_b32 v5, 4, v5
    v_lshl_add_u32 v5, v4, 8, v5
    v_bfe_u32 v6, v1, 0, 1
    v_lshl_add_u32 v5, v6, 3, v5
    v_lshrrev_b32 v6, 5, v1
    v_mul_u32_u24 v6, 2048, v6
    v_add_u32 v5, v5, v6
    s_lshl_b32 s47, s51, 16
    v_add_u32 v5, s47, v5
    s_add_u32 m0, s45, 0
    s_add_u32 s47, s46, 0x0
    buffer_load_dwordx4 v3, s[24:27], s47 offen lds
    s_add_u32 m0, s45, 1024
    s_add_u32 s47, s46, 0x7000
    buffer_load_dwordx4 v3, s[24:27], s47 offen lds
    s_add_u32 m0, s45, 2048
    s_add_u32 s47, s46, 0xe000
    buffer_load_dwordx4 v3, s[24:27], s47 offen lds
    s_add_u32 m0, s45, 3072
    s_add_u32 s47, s46, 0x15000
    buffer_load_dwordx4 v3, s[24:27], s47 offen lds
    s_add_u32 m0, s45, 4096
    s_add_u32 s47, s46, 0x1c000
    buffer_load_dwordx4 v3, s[24:27], s47 offen lds
    s_add_u32 m0, s45, 5120
    s_add_u32 s47, s46, 0x23000
    buffer_load_dwordx4 v3, s[24:27], s47 offen lds
    s_add_u32 m0, s45, 6144
    s_add_u32 s47, s46, 0x2a000
    buffer_load_dwordx4 v3, s[24:27], s47 offen lds
    s_add_u32 m0, s45, 7168
    s_add_u32 s47, s46, 0x31000
    buffer_load_dwordx4 v3, s[24:27], s47 offen lds
    s_add_u32 m0, s45, 8192
    s_add_u32 s47, s46, 0x38000
    buffer_load_dwordx4 v3, s[24:27], s47 offen lds
    s_add_u32 m0, s45, 9216
    s_add_u32 s47, s46, 0x3f000
    buffer_load_dwordx4 v3, s[24:27], s47 offen lds
    s_add_u32 m0, s45, 10240
    s_add_u32 s47, s46, 0x46000
    buffer_load_dwordx4 v3, s[24:27], s47 offen lds
    s_add_u32 m0, s45, 11264
    s_add_u32 s47, s46, 0x4d000
    buffer_load_dwordx4 v3, s[24:27], s47 offen lds
    s_add_u32 m0, s45, 12288
    s_add_u32 s47, s46, 0x54000
    buffer_load_dwordx4 v3, s[24:27], s47 offen lds
    s_add_u32 m0, s45, 13312
    s_add_u32 s47, s46, 0x5b000
    buffer_load_dwordx4 v3, s[24:27], s47 offen lds
    s_add_u32 m0, s45, 14336
    s_add_u32 s47, s46, 0x62000
    buffer_load_dwordx4 v3, s[24:27], s47 offen lds
    s_add_u32 m0, s45, 15360
    s_add_u32 s47, s46, 0x69000
    buffer_load_dwordx4 v3, s[24:27], s47 offen lds
    s_waitcnt vmcnt(0)
    s_barrier
    ds_read_b64_tr_b16 a[0:1], v5 offset:0
    ds_read_b64_tr_b16 a[2:3], v5 offset:1024
    ds_read_b64_tr_b16 a[4:5], v5 offset:4096
    ds_read_b64_tr_b16 a[6:7], v5 offset:5120
    ds_read_b64_tr_b16 a[8:9], v5 offset:8192
    ds_read_b64_tr_b16 a[10:11], v5 offset:9216
    ds_read_b64_tr_b16 a[12:13], v5 offset:12288
    ds_read_b64_tr_b16 a[14:15], v5 offset:13312
    s_waitcnt lgkmcnt(0)
    ds_read_b64_tr_b16 a[16:17], v5 offset:16384
    ds_read_b64_tr_b16 a[18:19], v5 offset:17408
    ds_read_b64_tr_b16 a[20:21], v5 offset:20480
    ds_read_b64_tr_b16 a[22:23], v5 offset:21504
    ds_read_b64_tr_b16 a[24:25], v5 offset:24576
    ds_read_b64_tr_b16 a[26:27], v5 offset:25600
    ds_read_b64_tr_b16 a[28:29], v5 offset:28672
    ds_read_b64_tr_b16 a[30:31], v5 offset:29696
    s_waitcnt lgkmcnt(0)
    ds_read_b64_tr_b16 a[32:33], v5 offset:32768
    ds_read_b64_tr_b16 a[34:35], v5 offset:33792
    ds_read_b64_tr_b16 a[36:37], v5 offset:36864
    ds_read_b64_tr_b16 a[38:39], v5 offset:37888
    ds_read_b64_tr_b16 a[40:41], v5 offset:40960
    ds_read_b64_tr_b16 a[42:43], v5 offset:41984
    ds_read_b64_tr_b16 a[44:45], v5 offset:45056
    ds_read_b64_tr_b16 a[46:47], v5 offset:46080
    s_waitcnt lgkmcnt(0)
    ds_read_b64_tr_b16 a[48:49], v5 offset:49152
    ds_read_b64_tr_b16 a[50:51], v5 offset:50176
    ds_read_b64_tr_b16 a[52:53], v5 offset:53248
    ds_read_b64_tr_b16 a[54:55], v5 offset:54272
    ds_read_b64_tr_b16 a[56:57], v5 offset:57344
    ds_read_b64_tr_b16 a[58:59], v5 offset:58368
    ds_read_b64_tr_b16 a[60:61], v5 offset:61440
    ds_read_b64_tr_b16 a[62:63], v5 offset:62464
    s_waitcnt lgkmcnt(0)
    s_waitcnt lgkmcnt(0)
    s_barrier
    s_add_u32 m0, s45, 0
    s_add_u32 s47, s46, 0x1c0000
    buffer_load_dwordx4 v3, s[24:27], s47 offen lds
    s_add_u32 m0, s45, 1024
    s_add_u32 s47, s46, 0x1c7000
    buffer_load_dwordx4 v3, s[24:27], s47 offen lds
    s_add_u32 m0, s45, 2048
    s_add_u32 s47, s46, 0x1ce000
    buffer_load_dwordx4 v3, s[24:27], s47 offen lds
    s_add_u32 m0, s45, 3072
    s_add_u32 s47, s46, 0x1d5000
    buffer_load_dwordx4 v3, s[24:27], s47 offen lds
    s_add_u32 m0, s45, 4096
    s_add_u32 s47, s46, 0x1dc000
    buffer_load_dwordx4 v3, s[24:27], s47 offen lds
    s_add_u32 m0, s45, 5120
    s_add_u32 s47, s46, 0x1e3000
    buffer_load_dwordx4 v3, s[24:27], s47 offen lds
    s_add_u32 m0, s45, 6144
    s_add_u32 s47, s46, 0x1ea000
    buffer_load_dwordx4 v3, s[24:27], s47 offen lds
    s_add_u32 m0, s45, 7168
    s_add_u32 s47, s46, 0x1f1000
    buffer_load_dwordx4 v3, s[24:27], s47 offen lds
    s_add_u32 m0, s45, 8192
    s_add_u32 s47, s46, 0x1f8000
    buffer_load_dwordx4 v3, s[24:27], s47 offen lds
    s_add_u32 m0, s45, 9216
    s_add_u32 s47, s46, 0x1ff000
    buffer_load_dwordx4 v3, s[24:27], s47 offen lds
    s_add_u32 m0, s45, 10240
    s_add_u32 s47, s46, 0x206000
    buffer_load_dwordx4 v3, s[24:27], s47 offen lds
    s_add_u32 m0, s45, 11264
    s_add_u32 s47, s46, 0x20d000
    buffer_load_dwordx4 v3, s[24:27], s47 offen lds
    s_add_u32 m0, s45, 12288
    s_add_u32 s47, s46, 0x214000
    buffer_load_dwordx4 v3, s[24:27], s47 offen lds
    s_add_u32 m0, s45, 13312
    s_add_u32 s47, s46, 0x21b000
    buffer_load_dwordx4 v3, s[24:27], s47 offen lds
    s_add_u32 m0, s45, 14336
    s_add_u32 s47, s46, 0x222000
    buffer_load_dwordx4 v3, s[24:27], s47 offen lds
    s_add_u32 m0, s45, 15360
    s_add_u32 s47, s46, 0x229000
    buffer_load_dwordx4 v3, s[24:27], s47 offen lds
    s_waitcnt vmcnt(0)
    s_barrier
    ds_read_b64_tr_b16 a[64:65], v5 offset:0
    ds_read_b64_tr_b16 a[66:67], v5 offset:1024
    ds_read_b64_tr_b16 a[68:69], v5 offset:4096
    ds_read_b64_tr_b16 a[70:71], v5 offset:5120
    ds_read_b64_tr_b16 a[72:73], v5 offset:8192
    ds_read_b64_tr_b16 a[74:75], v5 offset:9216
    ds_read_b64_tr_b16 a[76:77], v5 offset:12288
    ds_read_b64_tr_b16 a[78:79], v5 offset:13312
    s_waitcnt lgkmcnt(0)
    ds_read_b64_tr_b16 a[80:81], v5 offset:16384
    ds_read_b64_tr_b16 a[82:83], v5 offset:17408
    ds_read_b64_tr_b16 a[84:85], v5 offset:20480
    ds_read_b64_tr_b16 a[86:87], v5 offset:21504
    ds_read_b64_tr_b16 a[88:89], v5 offset:24576
    ds_read_b64_tr_b16 a[90:91], v5 offset:25600
    ds_read_b64_tr_b16 a[92:93], v5 offset:28672
    ds_read_b64_tr_b16 a[94:95], v5 offset:29696
    s_waitcnt lgkmcnt(0)
    ds_read_b64_tr_b16 a[96:97], v5 offset:32768
    ds_read_b64_tr_b16 a[98:99], v5 offset:33792
    ds_read_b64_tr_b16 a[100:101], v5 offset:36864
    ds_read_b64_tr_b16 a[102:103], v5 offset:37888
    ds_read_b64_tr_b16 a[104:105], v5 offset:40960
    ds_read_b64_tr_b16 a[106:107], v5 offset:41984
    ds_read_b64_tr_b16 a[108:109], v5 offset:45056
    ds_read_b64_tr_b16 a[110:111], v5 offset:46080
    s_waitcnt lgkmcnt(0)
    ds_read_b64_tr_b16 a[112:113], v5 offset:49152
    ds_read_b64_tr_b16 a[114:115], v5 offset:50176
    ds_read_b64_tr_b16 a[116:117], v5 offset:53248
    ds_read_b64_tr_b16 a[118:119], v5 offset:54272
    ds_read_b64_tr_b16 a[120:121], v5 offset:57344
    ds_read_b64_tr_b16 a[122:123], v5 offset:58368
    ds_read_b64_tr_b16 a[124:125], v5 offset:61440
    ds_read_b64_tr_b16 a[126:127], v5 offset:62464
    s_waitcnt lgkmcnt(0)
    s_waitcnt lgkmcnt(0)
    s_barrier
    v_lshlrev_b32 v2, 4, v1
    s_mul_i32 s64, s44, 8192
    s_add_u32 s46, s64, 0xc00000
    v_add_u32 v3, s46, v2
    s_mul_i32 s46, s51, 32768
    v_add_u32 v4, s46, v2
    v_and_b32 v6, 15, v1
    v_lshlrev_b32 v6, 4, v6
    v_lshrrev_b32 v7, 4, v1
    v_lshl_add_u32 v6, v7, 9, v6
    s_lshl_b32 s46, s50, 12
    s_add_u32 s46, s46, 131072
    v_add_u32 v5, s46, v2
    v_and_b32 v7, 3, v1
    v_lshlrev_b32 v7, 7, v7
    v_add_u32 v7, 0x10ec00, v7
    s_lshl_b32 s46, s49, 13
    s_lshl_b32 s47, s50, 11
    s_add_u32 s46, s46, s47
    s_add_u32 s46, s46, 0x6000000
    v_add_u32 v8, s46, v2
    s_lshl_b32 s52, s49, 7
    s_add_u32 s52, s52, 0x106400
    s_add_u32 s52, s52, s76
    s_mov_b32 s28, s6
    s_and_b32 s29, s7, 0xffff
    s_mov_b32 s30, 0x1c00
    s_mov_b32 s31, 0x00020000
    s_lshl_b32 s46, s49, 8
    s_lshl_b32 s47, s50, 6
    s_add_u32 s46, s46, s47
    v_lshrrev_b32 v9, 5, v1
    v_lshlrev_b32 v9, 3, v9
    buffer_load_dwordx2 v[32:33], v9, s[28:31], s46 offen offset:0
    buffer_load_dwordx2 v[34:35], v9, s[28:31], s46 offen offset:16
    buffer_load_dwordx2 v[36:37], v9, s[28:31], s46 offen offset:32
    buffer_load_dwordx2 v[38:39], v9, s[28:31], s46 offen offset:48
    v_add_u32 v9, 1024, v8
    s_mov_b32 s56, 0xbdd2d3e8
    s_mov_b32 s57, 0xbdd2d3e8
    v_mov_b32 v112, 0xc0135761
    v_mov_b32 v113, 0xc0135761
    s_waitcnt vmcnt(0)
    v_lshlrev_b32 v64, 16, v32
    v_and_b32 v65, 0xffff0000, v32
    v_lshlrev_b32 v66, 16, v33
    v_and_b32 v67, 0xffff0000, v33
    v_lshlrev_b32 v68, 16, v34
    v_and_b32 v69, 0xffff0000, v34
    v_lshlrev_b32 v70, 16, v35
    v_and_b32 v71, 0xffff0000, v35
    v_lshlrev_b32 v72, 16, v36
    v_and_b32 v73, 0xffff0000, v36
    v_lshlrev_b32 v74, 16, v37
    v_and_b32 v75, 0xffff0000, v37
    v_lshlrev_b32 v76, 16, v38
    v_and_b32 v77, 0xffff0000, v38
    v_lshlrev_b32 v78, 16, v39
    v_and_b32 v79, 0xffff0000, v39
    s_mov_b32 s60, s74
    s_mul_i32 s61, s74, 65536
    s_mov_b32 s62, s74
    s_mul_i32 s63, s74, 229376
    s_mov_b32 s67, 0
    s_mov_b32 s68, 3
    s_mov_b32 s71, 0
    v_mov_b32 v15, 147456
    v_mov_b32 v14, 0
    ds_write_b32 v15, v14 offset:4
    ds_write_b32 v15, v14 offset:12
    ds_write_b32 v15, v14 offset:16
    v_mov_b32 v114, 1
    s_mov_b32 s72, 0
L_g_restart_94:
    s_cmp_lg_u32 s44, 0
    s_cbranch_scc1 L_g_nsp_95
    s_mov_b32 s70, 0
L_g_sp_101:
    s_add_u32 s54, s60, 0
    s_add_u32 s55, s54, 0
    s_mul_i32 s46, s55, 171
    s_lshr_b32 s46, s46, 9
    s_mul_i32 s46, s46, 3
    s_sub_u32 s46, s55, s46
    s_lshl_b32 s46, s46, 9
    buffer_load_dword v11, v7, s[12:15], s46 offen sc1
    s_add_u32 s55, s54, 1
    s_mul_i32 s46, s55, 171
    s_lshr_b32 s46, s46, 9
    s_mul_i32 s46, s46, 3
    s_sub_u32 s46, s55, s46
    s_lshl_b32 s46, s46, 9
    buffer_load_dword v12, v7, s[12:15], s46 offen sc1
    s_add_u32 s55, s54, 2
    s_mul_i32 s46, s55, 171
    s_lshr_b32 s46, s46, 9
    s_mul_i32 s46, s46, 3
    s_sub_u32 s46, s55, s46
    s_lshl_b32 s46, s46, 9
    buffer_load_dword v13, v7, s[12:15], s46 offen sc1
    s_waitcnt vmcnt(0)
    v_cmp_ge_u32 vcc, s60, v11
    s_add_u32 s70, s70, 1
    s_cbranch_vccz L_g_sp_101_ok
    s_sleep 3
    s_cmp_lt_u32 s70, 524288
    s_cbranch_scc1 L_g_sp_101
    s_branch L_c_done_1
L_g_sp_101_ok:
    s_mov_b32 s46, s54
    v_cmp_ge_u32 vcc, s46, v11
    s_nop 0
    s_cbranch_vccnz L_g_le_102
    s_add_u32 s46, s46, 1
    v_cmp_ge_u32 vcc, s46, v12
    s_nop 0
    s_cbranch_vccnz L_g_le_102
    s_add_u32 s46, s46, 1
    v_cmp_ge_u32 vcc, s46, v13
    s_nop 0
    s_cbranch_vccnz L_g_le_102
    s_add_u32 s46, s46, 1
L_g_le_102:
    s_min_u32 s46, s46, s75
    v_mov_b32 v11, s46
    ds_write_b32 v15, v11
L_g_nsp_95:
    s_waitcnt lgkmcnt(0)
    s_barrier
    ds_read_b32 v14, v15
    s_waitcnt lgkmcnt(0)
    v_readfirstlane_b32 s66, v14
    s_nop 3
L_g_restart_94_go:
    s_mov_b32 s69, 0
    s_cmp_gt_u32 s62, s60
    s_cbranch_scc1 L_g_nd_103
    s_cmp_ge_u32 s62, s66
    s_cbranch_scc1 L_g_nd_103
    s_add_u32 s47, s61, 4096
    s_add_u32 m0, s64, 0
    s_nop 0
    buffer_load_dwordx4 v3, s[12:15], s61 offen offset:0 sc1 lds
    buffer_load_dwordx4 v3, s[12:15], s61 offen offset:1024 sc1 lds
    buffer_load_dwordx4 v3, s[12:15], s61 offen offset:2048 sc1 lds
    buffer_load_dwordx4 v3, s[12:15], s61 offen offset:3072 sc1 lds
    s_add_u32 m0, s64, 4096
    s_nop 0
    buffer_load_dwordx4 v3, s[12:15], s47 offen offset:0 sc1 lds
    buffer_load_dwordx4 v3, s[12:15], s47 offen offset:1024 sc1 lds
    buffer_load_dwordx4 v3, s[12:15], s47 offen offset:2048 sc1 lds
    buffer_load_dwordx4 v3, s[12:15], s47 offen offset:3072 sc1 lds
    s_add_u32 s61, s61, 65536
    s_add_u32 s62, s62, 1
    s_xor_b32 s64, s64, 0x10000
    s_mov_b32 s69, 1
L_g_nd_103:
    s_cmp_eq_u32 s51, 1
    s_cbranch_scc1 L_g_g1r_96
    s_add_u32 s59, s60, 1
    s_mov_b32 s69, 0
    s_cmp_gt_u32 s62, s59
    s_cbranch_scc1 L_g_nd_104
    s_cmp_ge_u32 s62, s66
    s_cbranch_scc1 L_g_nd_104
    s_add_u32 s47, s61, 4096
    s_add_u32 m0, s64, 0
    s_nop 0
    buffer_load_dwordx4 v3, s[12:15], s61 offen offset:0 sc1 lds
    buffer_load_dwordx4 v3, s[12:15], s61 offen offset:1024 sc1 lds
    buffer_load_dwordx4 v3, s[12:15], s61 offen offset:2048 sc1 lds
    buffer_load_dwordx4 v3, s[12:15], s61 offen offset:3072 sc1 lds
    s_add_u32 m0, s64, 4096
    s_nop 0
    buffer_load_dwordx4 v3, s[12:15], s47 offen offset:0 sc1 lds
    buffer_load_dwordx4 v3, s[12:15], s47 offen offset:1024 sc1 lds
    buffer_load_dwordx4 v3, s[12:15], s47 offen offset:2048 sc1 lds
    buffer_load_dwordx4 v3, s[12:15], s47 offen offset:3072 sc1 lds
    s_add_u32 s61, s61, 65536
    s_add_u32 s62, s62, 1
    s_xor_b32 s64, s64, 0x10000
    s_mov_b32 s69, 1
L_g_nd_104:
    s_cmp_eq_u32 s69, 1
    s_cbranch_scc1 L_g_w0_105
    s_waitcnt vmcnt(0)
L_g_w0_105:
    s_waitcnt vmcnt(8)
    s_mov_b32 s65, 1
.p2align 6
L_g_loop0_97:
    s_barrier
    s_cmp_eq_u32 s65, 0
    s_cbranch_scc1 L_g_pr_106
    ds_read_b128 v[32:35], v4 offset:0
    ds_read_b128 v[36:39], v4 offset:1024
    ds_read_b128 v[40:43], v4 offset:2048
    ds_read_b128 v[44:47], v4 offset:3072
    ds_read_b128 v[48:51], v4 offset:4096
    ds_read_b128 v[52:55], v4 offset:5120
    ds_read_b128 v[56:59], v4 offset:6144
    ds_read_b128 v[60:63], v4 offset:7168
L_g_pr_106:
    ds_read_b32 v14, v15
    s_cmp_lg_u32 s44, 0
    s_cbranch_scc1 L_g_nl_107
    s_add_u32 s54, s60, 1
    s_add_u32 s55, s54, 0
    s_mul_i32 s46, s55, 171
    s_lshr_b32 s46, s46, 9
    s_mul_i32 s46, s46, 3
    s_sub_u32 s46, s55, s46
    s_lshl_b32 s46, s46, 9
    buffer_load_dword v11, v7, s[12:15], s46 offen sc1
    s_add_u32 s55, s54, 1
    s_mul_i32 s46, s55, 171
    s_lshr_b32 s46, s46, 9
    s_mul_i32 s46, s46, 3
    s_sub_u32 s46, s55, s46
    s_lshl_b32 s46, s46, 9
    buffer_load_dword v12, v7, s[12:15], s46 offen sc1
    s_add_u32 s55, s54, 2
    s_mul_i32 s46, s55, 171
    s_lshr_b32 s46, s46, 9
    s_mul_i32 s46, s46, 3
    s_sub_u32 s46, s55, s46
    s_lshl_b32 s46, s46, 9
    buffer_load_dword v13, v7, s[12:15], s46 offen sc1
L_g_nl_107:
    s_setprio 2
    s_waitcnt lgkmcnt(6)
    v_mfma_f32_32x32x16_bf16 v[16:31], a[0:3], v[32:35], v[64:79]
    ds_read_b128 v[32:35], v4 offset:8192
    v_mfma_f32_32x32x16_bf16 v[16:31], a[4:7], v[36:39], v[16:31]
    ds_read_b128 v[36:39], v4 offset:9216
    s_waitcnt lgkmcnt(6)
    v_mfma_f32_32x32x16_bf16 v[16:31], a[8:11], v[40:43], v[16:31]
    ds_read_b128 v[40:43], v4 offset:10240
    v_mfma_f32_32x32x16_bf16 v[16:31], a[12:15], v[44:47], v[16:31]
    ds_read_b128 v[44:47], v4 offset:11264
    s_waitcnt lgkmcnt(6)
    v_mfma_f32_32x32x16_bf16 v[16:31], a[16:19], v[48:51], v[16:31]
    ds_read_b128 v[48:51], v4 offset:12288
    v_mfma_f32_32x32x16_bf16 v[16:31], a[20:23], v[52:55], v[16:31]
    ds_read_b128 v[52:55], v4 offset:13312
    s_waitcnt lgkmcnt(6)
    v_mfma_f32_32x32x16_bf16 v[16:31], a[24:27], v[56:59], v[16:31]
    ds_read_b128 v[56:59], v4 offset:14336
    v_mfma_f32_32x32x16_bf16 v[16:31], a[28:31], v[60:63], v[16:31]
    ds_read_b128 v[60:63], v4 offset:15360
    s_waitcnt lgkmcnt(6)
    v_mfma_f32_32x32x16_bf16 v[16:31], a[32:35], v[32:35], v[16:31]
    ds_read_b128 v[32:35], v4 offset:16384
    v_mfma_f32_32x32x16_bf16 v[16:31], a[36:39], v[36:39], v[16:31]
    ds_read_b128 v[36:39], v4 offset:17408
    s_waitcnt lgkmcnt(6)
    v_mfma_f32_32x32x16_bf16 v[16:31], a[40:43], v[40:43], v[16:31]
    ds_read_b128 v[40:43], v4 offset:18432
    v_mfma_f32_32x32x16_bf16 v[16:31], a[44:47], v[44:47], v[16:31]
    ds_read_b128 v[44:47], v4 offset:19456
    s_waitcnt lgkmcnt(6)
    v_mfma_f32_32x32x16_bf16 v[16:31], a[48:51], v[48:51], v[16:31]
    ds_read_b128 v[48:51], v4 offset:20480
    v_mfma_f32_32x32x16_bf16 v[16:31], a[52:55], v[52:55], v[16:31]
    ds_read_b128 v[52:55], v4 offset:21504
    s_waitcnt lgkmcnt(6)
    v_mfma_f32_32x32x16_bf16 v[16:31], a[56:59], v[56:59], v[16:31]
    ds_read_b128 v[56:59], v4 offset:22528
    v_mfma_f32_32x32x16_bf16 v[16:31], a[60:63], v[60:63], v[16:31]
    ds_read_b128 v[60:63], v4 offset:23552
    s_waitcnt lgkmcnt(6)
    v_mfma_f32_32x32x16_bf16 v[16:31], a[64:67], v[32:35], v[16:31]
    ds_read_b128 v[32:35], v4 offset:24576
    v_mfma_f32_32x32x16_bf16 v[16:31], a[68:71], v[36:39], v[16:31]
    ds_read_b128 v[36:39], v4 offset:25600
    s_waitcnt lgkmcnt(6)
    v_mfma_f32_32x32x16_bf16 v[16:31], a[72:75], v[40:43], v[16:31]
    ds_read_b128 v[40:43], v4 offset:26624
    v_mfma_f32_32x32x16_bf16 v[16:31], a[76:79], v[44:47], v[16:31]
    ds_read_b128 v[44:47], v4 offset:27648
    s_waitcnt lgkmcnt(6)
    v_mfma_f32_32x32x16_bf16 v[16:31], a[80:83], v[48:51], v[16:31]
    ds_read_b128 v[48:51], v4 offset:28672
    v_mfma_f32_32x32x16_bf16 v[16:31], a[84:87], v[52:55], v[16:31]
    ds_read_b128 v[52:55], v4 offset:29696
    s_waitcnt lgkmcnt(6)
    v_mfma_f32_32x32x16_bf16 v[16:31], a[88:91], v[56:59], v[16:31]
    ds_read_b128 v[56:59], v4 offset:30720
    v_mfma_f32_32x32x16_bf16 v[16:31], a[92:95], v[60:63], v[16:31]
    ds_read_b128 v[60:63], v4 offset:31744
    s_waitcnt lgkmcnt(6)
    v_mfma_f32_32x32x16_bf16 v[16:31], a[96:99], v[32:35], v[16:31]
    v_mfma_f32_32x32x16_bf16 v[16:31], a[100:103], v[36:39], v[16:31]
    s_waitcnt lgkmcnt(4)
    v_mfma_f32_32x32x16_bf16 v[16:31], a[104:107], v[40:43], v[16:31]
    v_mfma_f32_32x32x16_bf16 v[16:31], a[108:111], v[44:47], v[16:31]
    s_waitcnt lgkmcnt(2)
    v_mfma_f32_32x32x16_bf16 v[16:31], a[112:115], v[48:51], v[16:31]
    v_mfma_f32_32x32x16_bf16 v[16:31], a[116:119], v[52:55], v[16:31]
    s_waitcnt lgkmcnt(0)
    v_mfma_f32_32x32x16_bf16 v[16:31], a[120:123], v[56:59], v[16:31]
    v_mfma_f32_32x32x16_bf16 v[16:31], a[124:127], v[60:63], v[16:31]
    v_xor_b32 v4, 0x10000, v4
    s_setprio 0
    s_waitcnt vmcnt(0)
    v_readfirstlane_b32 s66, v14
    s_barrier
    s_nop 6
    ds_write_b128 v5, v[16:19] offset:0
    ds_write_b128 v5, v[20:23] offset:1024
    ds_write_b128 v5, v[24:27] offset:2048
    ds_write_b128 v5, v[28:31] offset:3072
    s_cmp_lg_u32 s44, 0
    s_cbranch_scc1 L_g_ne_108
    s_mov_b32 s46, s54
    v_cmp_ge_u32 vcc, s46, v11
    s_nop 0
    s_cbranch_vccnz L_g_le_111
    s_add_u32 s46, s46, 1
    v_cmp_ge_u32 vcc, s46, v12
    s_nop 0
    s_cbranch_vccnz L_g_le_111
    s_add_u32 s46, s46, 1
    v_cmp_ge_u32 vcc, s46, v13
    s_nop 0
    s_cbranch_vccnz L_g_le_111
    s_add_u32 s46, s46, 1
L_g_le_111:
    s_min_u32 s46, s46, s75
    v_mov_b32 v11, s46
    ds_write_b32 v15, v11
L_g_ne_108:
    s_add_u32 s60, s60, 1
    s_mov_b32 s69, 0
    s_cmp_gt_u32 s62, s60
    s_cbranch_scc1 L_g_nd_112
    s_cmp_ge_u32 s62, s66
    s_cbranch_scc1 L_g_nd_112
    s_add_u32 s47, s61, 4096
    s_add_u32 m0, s64, 0
    s_nop 0
    buffer_load_dwordx4 v3, s[12:15], s61 offen offset:0 sc1 lds
    buffer_load_dwordx4 v3, s[12:15], s61 offen offset:1024 sc1 lds
    buffer_load_dwordx4 v3, s[12:15], s61 offen offset:2048 sc1 lds
    buffer_load_dwordx4 v3, s[12:15], s61 offen offset:3072 sc1 lds
    s_add_u32 m0, s64, 4096
    s_nop 0
    buffer_load_dwordx4 v3, s[12:15], s47 offen offset:0 sc1 lds
    buffer_load_dwordx4 v3, s[12:15], s47 offen offset:1024 sc1 lds
    buffer_load_dwordx4 v3, s[12:15], s47 offen offset:2048 sc1 lds
    buffer_load_dwordx4 v3, s[12:15], s47 offen offset:3072 sc1 lds
    s_add_u32 s61, s61, 65536
    s_add_u32 s62, s62, 1
    s_xor_b32 s64, s64, 0x10000
    s_mov_b32 s69, 1
L_g_nd_112:
    s_mov_b32 s65, s69
    s_add_u32 s59, s60, 1
    s_mov_b32 s69, 0
    s_cmp_gt_u32 s62, s59
    s_cbranch_scc1 L_g_nd_113
    s_cmp_ge_u32 s62, s66
    s_cbranch_scc1 L_g_nd_113
    s_add_u32 s47, s61, 4096
    s_add_u32 m0, s64, 0
    s_nop 0
    buffer_load_dwordx4 v3, s[12:15], s61 offen offset:0 sc1 lds
    buffer_load_dwordx4 v3, s[12:15], s61 offen offset:1024 sc1 lds
    buffer_load_dwordx4 v3, s[12:15], s61 offen offset:2048 sc1 lds
    buffer_load_dwordx4 v3, s[12:15], s61 offen offset:3072 sc1 lds
    s_add_u32 m0, s64, 4096
    s_nop 0
    buffer_load_dwordx4 v3, s[12:15], s47 offen offset:0 sc1 lds
    buffer_load_dwordx4 v3, s[12:15], s47 offen offset:1024 sc1 lds
    buffer_load_dwordx4 v3, s[12:15], s47 offen offset:2048 sc1 lds
    buffer_load_dwordx4 v3, s[12:15], s47 offen offset:3072 sc1 lds
    s_add_u32 s61, s61, 65536
    s_add_u32 s62, s62, 1
    s_xor_b32 s64, s64, 0x10000
    s_mov_b32 s69, 1
L_g_nd_113:
    s_cmp_le_u32 s66, s60
    s_cbranch_scc1 L_g_ex0_110
    s_cmp_eq_u32 s65, 0
    s_cbranch_scc1 L_g_nw_109
    s_waitcnt vmcnt(0) lgkmcnt(0)
    s_branch L_g_loop0_97
L_g_nw_109:
    ds_read_b128 v[32:35], v4 offset:0
    ds_read_b128 v[36:39], v4 offset:1024
    ds_read_b128 v[40:43], v4 offset:2048
    ds_read_b128 v[44:47], v4 offset:3072
    ds_read_b128 v[48:51], v4 offset:4096
    ds_read_b128 v[52:55], v4 offset:5120
    ds_read_b128 v[56:59], v4 offset:6144
    ds_read_b128 v[60:63], v4 offset:7168
    s_waitcnt lgkmcnt(8)
    s_branch L_g_loop0_97
L_g_ex0_110:
    s_cmp_lg_u32 s44, 0
    s_cbranch_scc1 L_g_ex0_110_n
    s_sleep 6
    s_add_u32 s54, s60, 0
    s_add_u32 s55, s54, 0
    s_mul_i32 s46, s55, 171
    s_lshr_b32 s46, s46, 9
    s_mul_i32 s46, s46, 3
    s_sub_u32 s46, s55, s46
    s_lshl_b32 s46, s46, 9
    buffer_load_dword v11, v7, s[12:15], s46 offen sc1
    s_add_u32 s55, s54, 1
    s_mul_i32 s46, s55, 171
    s_lshr_b32 s46, s46, 9
    s_mul_i32 s46, s46, 3
    s_sub_u32 s46, s55, s46
    s_lshl_b32 s46, s46, 9
    buffer_load_dword v12, v7, s[12:15], s46 offen sc1
    s_add_u32 s55, s54, 2
    s_mul_i32 s46, s55, 171
    s_lshr_b32 s46, s46, 9
    s_mul_i32 s46, s46, 3
    s_sub_u32 s46, s55, s46
    s_lshl_b32 s46, s46, 9
    buffer_load_dword v13, v7, s[12:15], s46 offen sc1
    s_waitcnt vmcnt(0)
    s_mov_b32 s46, s54
    v_cmp_ge_u32 vcc, s46, v11
    s_nop 0
    s_cbranch_vccnz L_g_le_114
    s_add_u32 s46, s46, 1
    v_cmp_ge_u32 vcc, s46, v12
    s_nop 0
    s_cbranch_vccnz L_g_le_114
    s_add_u32 s46, s46, 1
    v_cmp_ge_u32 vcc, s46, v13
    s_nop 0
    s_cbranch_vccnz L_g_le_114
    s_add_u32 s46, s46, 1
L_g_le_114:
    s_min_u32 s46, s46, s75
    v_mov_b32 v11, s46
    ds_write_b32 v15, v11
L_g_ex0_110_n:
    s_waitcnt lgkmcnt(0)
    s_barrier
    ds_read_b32 v14, v15
    s_waitcnt lgkmcnt(0)
    v_readfirstlane_b32 s66, v14
    s_barrier
    s_cmp_gt_u32 s66, s60
    s_cbranch_scc1 L_g_restart_94_go
    s_branch L_g_tail_99
L_g_g1r_96:
    s_mov_b32 s65, 1
    s_branch L_g_loop1_98_e
.p2align 6
L_g_loop1_98:
    s_mov_b32 s65, 0
L_g_loop1_98_e:
    s_barrier
    ds_read_b32 v14, v15
    s_bitcmp1_b32 s67, 2
    s_cbranch_scc0 L_g_nfl_115
    s_sub_u32 s59, s60, 3
    s_cmp_lg_u32 s44, 4
    s_cbranch_scc1 L_sf_120
    v_mov_b32 v10, s59
    v_add_u32 v10, 1, v10
    v_mov_b32 v11, 0
    s_mov_b64 exec, 1
    buffer_store_dword v10, v11, s[12:15], s52 offen sc1
    s_mov_b64 exec, -1
L_sf_120:
L_g_nfl_115:
    s_cmp_eq_u32 s71, 0
    s_cbranch_scc1 L_g_nfl_115_d
    v_mov_b32 v10, 1
    s_mov_b64 exec, 1
    s_waitcnt vmcnt(0)
    ds_add_rtn_u32 v10, v15, v10 offset:4
    s_waitcnt lgkmcnt(0)
    v_readfirstlane_b32 s46, v10
    s_mov_b64 exec, -1
    s_mov_b32 s71, 0
    s_sub_u32 s59, s60, 1
    s_cmp_lg_u32 s46, s68
    s_cbranch_scc1 L_g_df_121
    v_mov_b32 v10, s59
    v_add_u32 v10, 1, v10
    v_mov_b32 v11, 0
    s_mov_b64 exec, 1
    buffer_store_dword v10, v11, s[12:15], s52 offen sc1
    s_mov_b64 exec, -1
L_sf_122:
L_g_df_121:
    s_add_u32 s68, s68, 4
    s_mov_b32 s65, 2
L_g_nfl_115_d:
    s_waitcnt lgkmcnt(0)
    v_readfirstlane_b32 s66, v14
    s_nop 3
    s_mov_b32 s69, 0
    s_cmp_gt_u32 s62, s60
    s_cbranch_scc1 L_g_nd_123
    s_cmp_ge_u32 s62, s66
    s_cbranch_scc1 L_g_nd_123
    s_add_u32 s47, s61, 4096
    s_add_u32 m0, s64, 0
    s_nop 0
    buffer_load_dwordx4 v3, s[12:15], s61 offen offset:0 sc1 lds
    buffer_load_dwordx4 v3, s[12:15], s61 offen offset:1024 sc1 lds
    buffer_load_dwordx4 v3, s[12:15], s61 offen offset:2048 sc1 lds
    buffer_load_dwordx4 v3, s[12:15], s61 offen offset:3072 sc1 lds
    s_add_u32 m0, s64, 4096
    s_nop 0
    buffer_load_dwordx4 v3, s[12:15], s47 offen offset:0 sc1 lds
    buffer_load_dwordx4 v3, s[12:15], s47 offen offset:1024 sc1 lds
    buffer_load_dwordx4 v3, s[12:15], s47 offen offset:2048 sc1 lds
    buffer_load_dwordx4 v3, s[12:15], s47 offen offset:3072 sc1 lds
    s_add_u32 s61, s61, 65536
    s_add_u32 s62, s62, 1
    s_xor_b32 s64, s64, 0x10000
    s_mov_b32 s69, 1
L_g_nd_123:
    s_or_b32 s65, s65, s69
    s_add_u32 s59, s60, 1
    s_mov_b32 s69, 0
    s_cmp_gt_u32 s62, s59
    s_cbranch_scc1 L_g_nd_124
    s_cmp_ge_u32 s62, s66
    s_cbranch_scc1 L_g_nd_124
    s_add_u32 s47, s61, 4096
    s_add_u32 m0, s64, 0
    s_nop 0
    buffer_load_dwordx4 v3, s[12:15], s61 offen offset:0 sc1 lds
    buffer_load_dwordx4 v3, s[12:15], s61 offen offset:1024 sc1 lds
    buffer_load_dwordx4 v3, s[12:15], s61 offen offset:2048 sc1 lds
    buffer_load_dwordx4 v3, s[12:15], s61 offen offset:3072 sc1 lds
    s_add_u32 m0, s64, 4096
    s_nop 0
    buffer_load_dwordx4 v3, s[12:15], s47 offen offset:0 sc1 lds
    buffer_load_dwordx4 v3, s[12:15], s47 offen offset:1024 sc1 lds
    buffer_load_dwordx4 v3, s[12:15], s47 offen offset:2048 sc1 lds
    buffer_load_dwordx4 v3, s[12:15], s47 offen offset:3072 sc1 lds
    s_add_u32 s61, s61, 65536
    s_add_u32 s62, s62, 1
    s_xor_b32 s64, s64, 0x10000
    s_mov_b32 s69, 1
L_g_nd_124:
    s_bitcmp1_b32 s67, 0
    s_cbranch_scc0 L_g_nep_116
    ds_read_b128 v[80:83], v5 offset:0
    ds_read_b128 v[84:87], v5 offset:1024
    ds_read_b128 v[88:91], v5 offset:2048
    ds_read_b128 v[92:95], v5 offset:3072
    s_nop 7
    s_waitcnt lgkmcnt(3)
    v_add_f32 v80, v80, v16
    v_add_f32 v81, v81, v17
    v_add_f32 v82, v82, v18
    v_add_f32 v83, v83, v19
    s_waitcnt lgkmcnt(2)
    v_add_f32 v84, v84, v20
    v_add_f32 v85, v85, v21
    v_add_f32 v86, v86, v22
    v_add_f32 v87, v87, v23
    s_waitcnt lgkmcnt(1)
    v_add_f32 v88, v88, v24
    v_add_f32 v89, v89, v25
    v_add_f32 v90, v90, v26
    v_add_f32 v91, v91, v27
    s_waitcnt lgkmcnt(0)
    v_add_f32 v92, v92, v28
    v_add_f32 v93, v93, v29
    v_add_f32 v94, v94, v30
    v_add_f32 v95, v95, v31
L_g_nep_116:
    v_mul_f32 v96, v80, v80
    v_mul_f32 v97, v81, v81
    v_mul_f32 v98, v82, v82
    v_mul_f32 v99, v83, v83
    v_mul_f32 v100, v84, v84
    v_mul_f32 v101, v85, v85
    v_mul_f32 v102, v86, v86
    v_mul_f32 v103, v87, v87
    v_fma_f32 v96, v96, s56, v112
    v_fma_f32 v97, v97, s56, v112
    v_fma_f32 v98, v98, s56, v112
    v_fma_f32 v99, v99, s56, v112
    v_fma_f32 v100, v100, s56, v112
    v_fma_f32 v101, v101, s56, v112
    v_fma_f32 v102, v102, s56, v112
    v_fma_f32 v103, v103, s56, v112
    v_mul_f32 v96, v96, v80
    v_mul_f32 v97, v97, v81
    v_mul_f32 v98, v98, v82
    v_mul_f32 v99, v99, v83
    v_mul_f32 v100, v100, v84
    v_mul_f32 v101, v101, v85
    v_mul_f32 v102, v102, v86
    v_mul_f32 v103, v103, v87
    v_exp_f32 v96, v96
    v_exp_f32 v97, v97
    v_exp_f32 v98, v98
    v_exp_f32 v99, v99
    v_exp_f32 v100, v100
    v_exp_f32 v101, v101
    v_exp_f32 v102, v102
    v_exp_f32 v103, v103
    v_add_f32 v96, 1.0, v96
    v_add_f32 v97, 1.0, v97
    v_add_f32 v98, 1.0, v98
    v_add_f32 v99, 1.0, v99
    s_cmp_eq_u32 s65, 0
    s_cbranch_scc1 L_g_nw1_117
    s_cmp_eq_u32 s65, 2
    s_cbranch_scc1 L_g_nw1_117_w
    s_waitcnt vmcnt(0)
L_g_nw1_117_w:
    s_barrier
    ds_read_b128 v[32:35], v4 offset:0
    ds_read_b128 v[36:39], v4 offset:1024
    ds_read_b128 v[40:43], v4 offset:2048
    ds_read_b128 v[44:47], v4 offset:3072
    ds_read_b128 v[48:51], v4 offset:4096
    ds_read_b128 v[52:55], v4 offset:5120
    ds_read_b128 v[56:59], v4 offset:6144
    ds_read_b128 v[60:63], v4 offset:7168
    s_branch L_g_jn_119
L_g_nw1_117:
    ds_read_b128 v[32:35], v4 offset:0
    ds_read_b128 v[36:39], v4 offset:1024
    ds_read_b128 v[40:43], v4 offset:2048
    ds_read_b128 v[44:47], v4 offset:3072
    ds_read_b128 v[48:51], v4 offset:4096
    ds_read_b128 v[52:55], v4 offset:5120
    ds_read_b128 v[56:59], v4 offset:6144
    ds_read_b128 v[60:63], v4 offset:7168
    s_barrier
L_g_jn_119:
    s_bitcmp1_b32 s67, 0
    s_cbranch_scc1 L_g_mm2_118
    s_setprio 1
    s_waitcnt lgkmcnt(6)
    v_mfma_f32_32x32x16_bf16 v[16:31], a[0:3], v[32:35], 0
    ds_read_b128 v[32:35], v4 offset:8192
    v_mfma_f32_32x32x16_bf16 v[16:31], a[4:7], v[36:39], v[16:31]
    ds_read_b128 v[36:39], v4 offset:9216
    s_waitcnt lgkmcnt(6)
    v_mfma_f32_32x32x16_bf16 v[16:31], a[8:11], v[40:43], v[16:31]
    ds_read_b128 v[40:43], v4 offset:10240
    v_mfma_f32_32x32x16_bf16 v[16:31], a[12:15], v[44:47], v[16:31]
    ds_read_b128 v[44:47], v4 offset:11264
    s_waitcnt lgkmcnt(6)
    v_mfma_f32_32x32x16_bf16 v[16:31], a[16:19], v[48:51], v[16:31]
    ds_read_b128 v[48:51], v4 offset:12288
    v_mfma_f32_32x32x16_bf16 v[16:31], a[20:23], v[52:55], v[16:31]
    ds_read_b128 v[52:55], v4 offset:13312
    s_waitcnt lgkmcnt(6)
    v_mfma_f32_32x32x16_bf16 v[16:31], a[24:27], v[56:59], v[16:31]
    ds_read_b128 v[56:59], v4 offset:14336
    v_mfma_f32_32x32x16_bf16 v[16:31], a[28:31], v[60:63], v[16:31]
    ds_read_b128 v[60:63], v4 offset:15360
    s_waitcnt lgkmcnt(6)
    v_mfma_f32_32x32x16_bf16 v[16:31], a[32:35], v[32:35], v[16:31]
    ds_read_b128 v[32:35], v4 offset:16384
    v_mfma_f32_32x32x16_bf16 v[16:31], a[36:39], v[36:39], v[16:31]
    ds_read_b128 v[36:39], v4 offset:17408
    s_waitcnt lgkmcnt(6)
    v_mfma_f32_32x32x16_bf16 v[16:31], a[40:43], v[40:43], v[16:31]
    ds_read_b128 v[40:43], v4 offset:18432
    v_mfma_f32_32x32x16_bf16 v[16:31], a[44:47], v[44:47], v[16:31]
    ds_read_b128 v[44:47], v4 offset:19456
    s_waitcnt lgkmcnt(6)
    v_mfma_f32_32x32x16_bf16 v[16:31], a[48:51], v[48:51], v[16:31]
    ds_read_b128 v[48:51], v4 offset:20480
    v_mfma_f32_32x32x16_bf16 v[16:31], a[52:55], v[52:55], v[16:31]
    ds_read_b128 v[52:55], v4 offset:21504
    s_waitcnt lgkmcnt(6)
    v_mfma_f32_32x32x16_bf16 v[16:31], a[56:59], v[56:59], v[16:31]
    ds_read_b128 v[56:59], v4 offset:22528
    v_mfma_f32_32x32x16_bf16 v[16:31], a[60:63], v[60:63], v[16:31]
    ds_read_b128 v[60:63], v4 offset:23552
    s_waitcnt lgkmcnt(6)
    v_mfma_f32_32x32x16_bf16 v[16:31], a[64:67], v[32:35], v[16:31]
    ds_read_b128 v[32:35], v4 offset:24576
    v_mfma_f32_32x32x16_bf16 v[16:31], a[68:71], v[36:39], v[16:31]
    ds_read_b128 v[36:39], v4 offset:25600
    s_waitcnt lgkmcnt(6)
    v_mfma_f32_32x32x16_bf16 v[16:31], a[72:75], v[40:43], v[16:31]
    ds_read_b128 v[40:43], v4 offset:26624
    v_mfma_f32_32x32x16_bf16 v[16:31], a[76:79], v[44:47], v[16:31]
    ds_read_b128 v[44:47], v4 offset:27648
    s_waitcnt lgkmcnt(6)
    v_mfma_f32_32x32x16_bf16 v[16:31], a[80:83], v[48:51], v[16:31]
    ds_read_b128 v[48:51], v4 offset:28672
    v_mfma_f32_32x32x16_bf16 v[16:31], a[84:87], v[52:55], v[16:31]
    ds_read_b128 v[52:55], v4 offset:29696
    s_waitcnt lgkmcnt(6)
    v_mfma_f32_32x32x16_bf16 v[16:31], a[88:91], v[56:59], v[16:31]
    ds_read_b128 v[56:59], v4 offset:30720
    v_mfma_f32_32x32x16_bf16 v[16:31], a[92:95], v[60:63], v[16:31]
    ds_read_b128 v[60:63], v4 offset:31744
    s_waitcnt lgkmcnt(6)
    v_mfma_f32_32x32x16_bf16 v[16:31], a[96:99], v[32:35], v[16:31]
    v_mfma_f32_32x32x16_bf16 v[16:31], a[100:103], v[36:39], v[16:31]
    s_waitcnt lgkmcnt(4)
    v_mfma_f32_32x32x16_bf16 v[16:31], a[104:107], v[40:43], v[16:31]
    v_mfma_f32_32x32x16_bf16 v[16:31], a[108:111], v[44:47], v[16:31]
    s_waitcnt lgkmcnt(2)
    v_mfma_f32_32x32x16_bf16 v[16:31], a[112:115], v[48:51], v[16:31]
    v_mfma_f32_32x32x16_bf16 v[16:31], a[116:119], v[52:55], v[16:31]
    s_waitcnt lgkmcnt(0)
    v_mfma_f32_32x32x16_bf16 v[16:31], a[120:123], v[56:59], v[16:31]
    v_mfma_f32_32x32x16_bf16 v[16:31], a[124:127], v[60:63], v[16:31]
    v_xor_b32 v4, 0x10000, v4
    s_setprio 0
    s_waitcnt vmcnt(0)
    s_branch L_g_mm2_118_d
L_g_mm2_118:
    s_setprio 1
    s_waitcnt lgkmcnt(6)
    v_mfma_f32_32x32x16_bf16 v[16:31], a[0:3], v[32:35], 0
    ds_read_b128 v[32:35], v4 offset:8192
    v_add_f32 v100, 1.0, v100
    v_add_f32 v101, 1.0, v101
    v_add_f32 v102, 1.0, v102
    v_add_f32 v103, 1.0, v103
    v_mfma_f32_32x32x16_bf16 v[16:31], a[4:7], v[36:39], v[16:31]
    ds_read_b128 v[36:39], v4 offset:9216
    v_rcp_f32 v96, v96
    v_rcp_f32 v97, v97
    s_waitcnt lgkmcnt(6)
    v_mfma_f32_32x32x16_bf16 v[16:31], a[8:11], v[40:43], v[16:31]
    ds_read_b128 v[40:43], v4 offset:10240
    v_rcp_f32 v98, v98
    v_rcp_f32 v99, v99
    v_mfma_f32_32x32x16_bf16 v[16:31], a[12:15], v[44:47], v[16:31]
    ds_read_b128 v[44:47], v4 offset:11264
    v_rcp_f32 v100, v100
    v_rcp_f32 v101, v101
    s_waitcnt lgkmcnt(6)
    v_mfma_f32_32x32x16_bf16 v[16:31], a[16:19], v[48:51], v[16:31]
    ds_read_b128 v[48:51], v4 offset:12288
    v_rcp_f32 v102, v102
    v_rcp_f32 v103, v103
    v_mfma_f32_32x32x16_bf16 v[16:31], a[20:23], v[52:55], v[16:31]
    ds_read_b128 v[52:55], v4 offset:13312
    v_mul_f32 v80, v80, v96
    v_mul_f32 v81, v81, v97
    v_mul_f32 v82, v82, v98
    v_mul_f32 v83, v83, v99
    s_waitcnt lgkmcnt(6)
    v_mfma_f32_32x32x16_bf16 v[16:31], a[24:27], v[56:59], v[16:31]
    ds_read_b128 v[56:59], v4 offset:14336
    v_mul_f32 v84, v84, v100
    v_mul_f32 v85, v85, v101
    v_mul_f32 v86, v86, v102
    v_mul_f32 v87, v87, v103
    v_mfma_f32_32x32x16_bf16 v[16:31], a[28:31], v[60:63], v[16:31]
    ds_read_b128 v[60:63], v4 offset:15360
    v_cvt_pk_bf16_f32 v104, v80, v81
    v_cvt_pk_bf16_f32 v105, v82, v83
    v_cvt_pk_bf16_f32 v106, v84, v85
    v_cvt_pk_bf16_f32 v107, v86, v87
    s_waitcnt lgkmcnt(6)
    v_mfma_f32_32x32x16_bf16 v[16:31], a[32:35], v[32:35], v[16:31]
    ds_read_b128 v[32:35], v4 offset:16384
    buffer_store_dwordx4 v[104:107], v8, s[12:15], s63 offen sc1
    v_mul_f32 v96, v88, v88
    v_mul_f32 v97, v89, v89
    v_mul_f32 v98, v90, v90
    v_mfma_f32_32x32x16_bf16 v[16:31], a[36:39], v[36:39], v[16:31]
    ds_read_b128 v[36:39], v4 offset:17408
    v_mul_f32 v99, v91, v91
    v_mul_f32 v100, v92, v92
    v_mul_f32 v101, v93, v93
    v_mul_f32 v102, v94, v94
    s_waitcnt lgkmcnt(6)
    v_mfma_f32_32x32x16_bf16 v[16:31], a[40:43], v[40:43], v[16:31]
    ds_read_b128 v[40:43], v4 offset:18432
    v_mul_f32 v103, v95, v95
    v_fma_f32 v96, v96, s56, v112
    v_fma_f32 v97, v97, s56, v112
    v_fma_f32 v98, v98, s56, v112
    v_mfma_f32_32x32x16_bf16 v[16:31], a[44:47], v[44:47], v[16:31]
    ds_read_b128 v[44:47], v4 offset:19456
    v_fma_f32 v99, v99, s56, v112
    v_fma_f32 v100, v100, s56, v112
    v_fma_f32 v101, v101, s56, v112
    v_fma_f32 v102, v102, s56, v112
    s_waitcnt lgkmcnt(6)
    v_mfma_f32_32x32x16_bf16 v[16:31], a[48:51], v[48:51], v[16:31]
    ds_read_b128 v[48:51], v4 offset:20480
    v_fma_f32 v103, v103, s56, v112
    v_mul_f32 v96, v96, v88
    v_mul_f32 v97, v97, v89
    v_mul_f32 v98, v98, v90
    v_mfma_f32_32x32x16_bf16 v[16:31], a[52:55], v[52:55], v[16:31]
    ds_read_b128 v[52:55], v4 offset:21504
    v_mul_f32 v99, v99, v91
    v_mul_f32 v100, v100, v92
    v_mul_f32 v101, v101, v93
    v_mul_f32 v102, v102, v94
    s_waitcnt lgkmcnt(6)
    v_mfma_f32_32x32x16_bf16 v[16:31], a[56:59], v[56:59], v[16:31]
    ds_read_b128 v[56:59], v4 offset:22528
    v_mul_f32 v103, v103, v95
    v_exp_f32 v96, v96
    v_exp_f32 v97, v97
    v_mfma_f32_32x32x16_bf16 v[16:31], a[60:63], v[60:63], v[16:31]
    ds_read_b128 v[60:63], v4 offset:23552
    v_exp_f32 v98, v98
    v_exp_f32 v99, v99
    s_waitcnt lgkmcnt(6)
    v_mfma_f32_32x32x16_bf16 v[16:31], a[64:67], v[32:35], v[16:31]
    ds_read_b128 v[32:35], v4 offset:24576
    v_exp_f32 v100, v100
    v_exp_f32 v101, v101
    v_mfma_f32_32x32x16_bf16 v[16:31], a[68:71], v[36:39], v[16:31]
    ds_read_b128 v[36:39], v4 offset:25600
    v_exp_f32 v102, v102
    v_exp_f32 v103, v103
    s_waitcnt lgkmcnt(6)
    v_mfma_f32_32x32x16_bf16 v[16:31], a[72:75], v[40:43], v[16:31]
    ds_read_b128 v[40:43], v4 offset:26624
    v_add_f32 v96, 1.0, v96
    v_add_f32 v97, 1.0, v97
    v_add_f32 v98, 1.0, v98
    v_add_f32 v99, 1.0, v99
    v_mfma_f32_32x32x16_bf16 v[16:31], a[76:79], v[44:47], v[16:31]
    ds_read_b128 v[44:47], v4 offset:27648
    v_add_f32 v100, 1.0, v100
    v_add_f32 v101, 1.0, v101
    v_add_f32 v102, 1.0, v102
    v_add_f32 v103, 1.0, v103
    s_waitcnt lgkmcnt(6)
    v_mfma_f32_32x32x16_bf16 v[16:31], a[80:83], v[48:51], v[16:31]
    ds_read_b128 v[48:51], v4 offset:28672
    v_rcp_f32 v96, v96
    v_rcp_f32 v97, v97
    v_mfma_f32_32x32x16_bf16 v[16:31], a[84:87], v[52:55], v[16:31]
    ds_read_b128 v[52:55], v4 offset:29696
    v_rcp_f32 v98, v98
    v_rcp_f32 v99, v99
    s_waitcnt lgkmcnt(6)
    v_mfma_f32_32x32x16_bf16 v[16:31], a[88:91], v[56:59], v[16:31]
    ds_read_b128 v[56:59], v4 offset:30720
    v_rcp_f32 v100, v100
    v_rcp_f32 v101, v101
    v_mfma_f32_32x32x16_bf16 v[16:31], a[92:95], v[60:63], v[16:31]
    ds_read_b128 v[60:63], v4 offset:31744
    v_rcp_f32 v102, v102
    v_rcp_f32 v103, v103
    s_waitcnt lgkmcnt(6)
    v_mfma_f32_32x32x16_bf16 v[16:31], a[96:99], v[32:35], v[16:31]
    v_mul_f32 v88, v88, v96
    v_mul_f32 v89, v89, v97
    v_mul_f32 v90, v90, v98
    v_mul_f32 v91, v91, v99
    v_mfma_f32_32x32x16_bf16 v[16:31], a[100:103], v[36:39], v[16:31]
    v_mul_f32 v92, v92, v100
    v_mul_f32 v93, v93, v101
    v_mul_f32 v94, v94, v102
    v_mul_f32 v95, v95, v103
    s_waitcnt lgkmcnt(4)
    v_mfma_f32_32x32x16_bf16 v[16:31], a[104:107], v[40:43], v[16:31]
    v_cvt_pk_bf16_f32 v108, v88, v89
    v_cvt_pk_bf16_f32 v109, v90, v91
    v_cvt_pk_bf16_f32 v110, v92, v93
    v_cvt_pk_bf16_f32 v111, v94, v95
    v_mfma_f32_32x32x16_bf16 v[16:31], a[108:111], v[44:47], v[16:31]
    buffer_store_dwordx4 v[108:111], v9, s[12:15], s63 offen sc1
    s_add_u32 s63, s63, 229376
    s_waitcnt lgkmcnt(2)
    v_mfma_f32_32x32x16_bf16 v[16:31], a[112:115], v[48:51], v[16:31]
    v_mfma_f32_32x32x16_bf16 v[16:31], a[116:119], v[52:55], v[16:31]
    s_waitcnt lgkmcnt(0)
    v_mfma_f32_32x32x16_bf16 v[16:31], a[120:123], v[56:59], v[16:31]
    v_mfma_f32_32x32x16_bf16 v[16:31], a[124:127], v[60:63], v[16:31]
    v_xor_b32 v4, 0x10000, v4
    s_setprio 0
    s_waitcnt vmcnt(2)
L_g_mm2_118_d:
    s_lshl_b32 s67, s67, 1
    s_or_b32 s67, s67, 1
    s_add_u32 s60, s60, 1
    s_cmp_gt_u32 s66, s60
    s_cbranch_scc1 L_g_loop1_98
    s_barrier
    ds_read_b32 v14, v15
    s_waitcnt lgkmcnt(0)
    v_readfirstlane_b32 s66, v14
    s_barrier
    s_mov_b32 s69, 0
    s_cmp_gt_u32 s62, s60
    s_cbranch_scc1 L_g_nd_125
    s_cmp_ge_u32 s62, s66
    s_cbranch_scc1 L_g_nd_125
    s_add_u32 s47, s61, 4096
    s_add_u32 m0, s64, 0
    s_nop 0
    buffer_load_dwordx4 v3, s[12:15], s61 offen offset:0 sc1 lds
    buffer_load_dwordx4 v3, s[12:15], s61 offen offset:1024 sc1 lds
    buffer_load_dwordx4 v3, s[12:15], s61 offen offset:2048 sc1 lds
    buffer_load_dwordx4 v3, s[12:15], s61 offen offset:3072 sc1 lds
    s_add_u32 m0, s64, 4096
    s_nop 0
    buffer_load_dwordx4 v3, s[12:15], s47 offen offset:0 sc1 lds
    buffer_load_dwordx4 v3, s[12:15], s47 offen offset:1024 sc1 lds
    buffer_load_dwordx4 v3, s[12:15], s47 offen offset:2048 sc1 lds
    buffer_load_dwordx4 v3, s[12:15], s47 offen offset:3072 sc1 lds
    s_add_u32 s61, s61, 65536
    s_add_u32 s62, s62, 1
    s_xor_b32 s64, s64, 0x10000
    s_mov_b32 s69, 1
L_g_nd_125:
    s_sub_u32 s59, s60, 1
    ds_read_b128 v[80:83], v5 offset:0
    ds_read_b128 v[84:87], v5 offset:1024
    ds_read_b128 v[88:91], v5 offset:2048
    ds_read_b128 v[92:95], v5 offset:3072
    s_nop 7
    s_waitcnt lgkmcnt(3)
    v_add_f32 v80, v80, v16
    v_add_f32 v81, v81, v17
    v_add_f32 v82, v82, v18
    v_add_f32 v83, v83, v19
    s_waitcnt lgkmcnt(2)
    v_add_f32 v84, v84, v20
    v_add_f32 v85, v85, v21
    v_add_f32 v86, v86, v22
    v_add_f32 v87, v87, v23
    s_waitcnt lgkmcnt(1)
    v_add_f32 v88, v88, v24
    v_add_f32 v89, v89, v25
    v_add_f32 v90, v90, v26
    v_add_f32 v91, v91, v27
    s_waitcnt lgkmcnt(0)
    v_add_f32 v92, v92, v28
    v_add_f32 v93, v93, v29
    v_add_f32 v94, v94, v30
    v_add_f32 v95, v95, v31
    v_mul_f32 v96, v80, v80
    v_mul_f32 v97, v81, v81
    v_mul_f32 v98, v82, v82
    v_mul_f32 v99, v83, v83
    v_mul_f32 v100, v84, v84
    v_mul_f32 v101, v85, v85
    v_mul_f32 v102, v86, v86
    v_mul_f32 v103, v87, v87
    v_fma_f32 v96, v96, s56, v112
    v_fma_f32 v97, v97, s56, v112
    v_fma_f32 v98, v98, s56, v112
    v_fma_f32 v99, v99, s56, v112
    v_fma_f32 v100, v100, s56, v112
    v_fma_f32 v101, v101, s56, v112
    v_fma_f32 v102, v102, s56, v112
    v_fma_f32 v103, v103, s56, v112
    v_mul_f32 v96, v96, v80
    v_mul_f32 v97, v97, v81
    v_mul_f32 v98, v98, v82
    v_mul_f32 v99, v99, v83
    v_mul_f32 v100, v100, v84
    v_mul_f32 v101, v101, v85
    v_mul_f32 v102, v102, v86
    v_mul_f32 v103, v103, v87
    v_exp_f32 v96, v96
    v_exp_f32 v97, v97
    v_exp_f32 v98, v98
    v_exp_f32 v99, v99
    v_exp_f32 v100, v100
    v_exp_f32 v101, v101
    v_exp_f32 v102, v102
    v_exp_f32 v103, v103
    v_add_f32 v96, 1.0, v96
    v_add_f32 v97, 1.0, v97
    v_add_f32 v98, 1.0, v98
    v_add_f32 v99, 1.0, v99
    v_add_f32 v100, 1.0, v100
    v_add_f32 v101, 1.0, v101
    v_add_f32 v102, 1.0, v102
    v_add_f32 v103, 1.0, v103
    v_rcp_f32 v96, v96
    v_rcp_f32 v97, v97
    v_rcp_f32 v98, v98
    v_rcp_f32 v99, v99
    v_rcp_f32 v100, v100
    v_rcp_f32 v101, v101
    v_rcp_f32 v102, v102
    v_rcp_f32 v103, v103
    v_mul_f32 v80, v80, v96
    v_mul_f32 v81, v81, v97
    v_mul_f32 v82, v82, v98
    v_mul_f32 v83, v83, v99
    v_mul_f32 v84, v84, v100
    v_mul_f32 v85, v85, v101
    v_mul_f32 v86, v86, v102
    v_mul_f32 v87, v87, v103
    v_cvt_pk_bf16_f32 v104, v80, v81
    v_cvt_pk_bf16_f32 v105, v82, v83
    v_cvt_pk_bf16_f32 v106, v84, v85
    v_cvt_pk_bf16_f32 v107, v86, v87
    buffer_store_dwordx4 v[104:107], v8, s[12:15], s63 offen sc1
    v_mul_f32 v96, v88, v88
    v_mul_f32 v97, v89, v89
    v_mul_f32 v98, v90, v90
    v_mul_f32 v99, v91, v91
    v_mul_f32 v100, v92, v92
    v_mul_f32 v101, v93, v93
    v_mul_f32 v102, v94, v94
    v_mul_f32 v103, v95, v95
    v_fma_f32 v96, v96, s56, v112
    v_fma_f32 v97, v97, s56, v112
    v_fma_f32 v98, v98, s56, v112
    v_fma_f32 v99, v99, s56, v112
    v_fma_f32 v100, v100, s56, v112
    v_fma_f32 v101, v101, s56, v112
    v_fma_f32 v102, v102, s56, v112
    v_fma_f32 v103, v103, s56, v112
    v_mul_f32 v96, v96, v88
    v_mul_f32 v97, v97, v89
    v_mul_f32 v98, v98, v90
    v_mul_f32 v99, v99, v91
    v_mul_f32 v100, v100, v92
    v_mul_f32 v101, v101, v93
    v_mul_f32 v102, v102, v94
    v_mul_f32 v103, v103, v95
    v_exp_f32 v96, v96
    v_exp_f32 v97, v97
    v_exp_f32 v98, v98
    v_exp_f32 v99, v99
    v_exp_f32 v100, v100
    v_exp_f32 v101, v101
    v_exp_f32 v102, v102
    v_exp_f32 v103, v103
    v_add_f32 v96, 1.0, v96
    v_add_f32 v97, 1.0, v97
    v_add_f32 v98, 1.0, v98
    v_add_f32 v99, 1.0, v99
    v_add_f32 v100, 1.0, v100
    v_add_f32 v101, 1.0, v101
    v_add_f32 v102, 1.0, v102
    v_add_f32 v103, 1.0, v103
    v_rcp_f32 v96, v96
    v_rcp_f32 v97, v97
    v_rcp_f32 v98, v98
    v_rcp_f32 v99, v99
    v_rcp_f32 v100, v100
    v_rcp_f32 v101, v101
    v_rcp_f32 v102, v102
    v_rcp_f32 v103, v103
    v_mul_f32 v88, v88, v96
    v_mul_f32 v89, v89, v97
    v_mul_f32 v90, v90, v98
    v_mul_f32 v91, v91, v99
    v_mul_f32 v92, v92, v100
    v_mul_f32 v93, v93, v101
    v_mul_f32 v94, v94, v102
    v_mul_f32 v95, v95, v103
    v_cvt_pk_bf16_f32 v108, v88, v89
    v_cvt_pk_bf16_f32 v109, v90, v91
    v_cvt_pk_bf16_f32 v110, v92, v93
    v_cvt_pk_bf16_f32 v111, v94, v95
    buffer_store_dwordx4 v[108:111], v9, s[12:15], s63 offen sc1
    s_add_u32 s63, s63, 229376
    s_mov_b32 s67, 0
    s_mov_b32 s71, 1
    s_cmp_gt_u32 s66, s60
    s_cbranch_scc1 L_g_g1r_96
    v_mov_b32 v10, 1
    s_mov_b64 exec, 1
    s_waitcnt vmcnt(0)
    ds_add_rtn_u32 v10, v15, v10 offset:4
    s_waitcnt lgkmcnt(0)
    v_readfirstlane_b32 s46, v10
    s_mov_b64 exec, -1
    s_mov_b32 s71, 0
    s_sub_u32 s59, s60, 1
    s_cmp_lg_u32 s46, s68
    s_cbranch_scc1 L_g_df_126
    v_mov_b32 v10, s59
    v_add_u32 v10, 1, v10
    v_mov_b32 v11, 0
    s_mov_b64 exec, 1
    buffer_store_dword v10, v11, s[12:15], s52 offen sc1
    s_mov_b64 exec, -1
L_sf_127:
L_g_df_126:
    s_add_u32 s68, s68, 4
    s_cmp_gt_u32 s66, s60
    s_cbranch_scc1 L_g_g1r_96
L_g_tail_99:
    s_cmp_lt_u32 s60, s75
    s_cbranch_scc1 L_g_restart_94
    s_waitcnt vmcnt(0)
    s_barrier
    s_branch L_w_f1_13_d
L_w_f2_12:
    s_load_dwordx2 s[4:5], s[0:1], 80
    s_load_dwordx2 s[6:7], s[0:1], 72
    s_and_b32 s50, s44, 3
    s_lshr_b32 s51, s44, 2
    s_waitcnt lgkmcnt(0)
    s_mov_b32 s24, s4
    s_and_b32 s25, s5, 0xffff
    s_mov_b32 s26, 0x700000
    s_mov_b32 s27, 0x00020000
    v_lshrrev_b32 v3, 4, v1
    v_and_b32 v4, 15, v1
    v_lshlrev_b32 v5, 2, v3
    v_xor_b32 v4, v4, v5
    v_mul_u32_u24 v3, 2048, v3
    v_lshl_add_u32 v3, v4, 4, v3
    s_mul_i32 s46, s51, 448
    s_mul_i32 s47, s50, 56
    s_add_u32 s46, s46, s47
    s_mul_i32 s47, s42, 896
    s_add_u32 s46, s46, s47
    s_mul_i32 s46, s46, 2048
    s_lshl_b32 s47, s43, 8
    s_add_u32 s46, s46, s47
    s_lshl_b32 s45, s51, 16
    s_mul_i32 s47, s50, 14336
    s_add_u32 s45, s45, s47
    v_bfe_u32 v4, v1, 2, 2
    v_bfe_u32 v5, v1, 4, 1
    v_lshlrev_b32 v5, 1, v5
    v_bfe_u32 v6, v1, 1, 1
    v_add_u32 v5, v5, v6
    s_lshl_b32 s47, s50, 2
    v_add_u32 v5, s47, v5
    v_lshlrev_b32 v6, 2, v4
    v_xor_b32 v5, v5, v6
    v_lshlrev_b32 v5, 4, v5
    v_lshl_add_u32 v5, v4, 8, v5
    v_bfe_u32 v6, v1, 0, 1
    v_lshl_add_u32 v5, v6, 3, v5
    v_lshrrev_b32 v6, 5, v1
    v_mul_u32_u24 v6, 1024, v6
    v_add_u32 v5, v5, v6
    s_lshl_b32 s47, s51, 16
    v_add_u32 v5, s47, v5
    v_bfe_u32 v4, v1, 2, 2
    v_xor_b32 v5, s50, v4
    v_lshlrev_b32 v5, 6, v5
    v_lshl_add_u32 v5, v4, 8, v5
    v_and_b32 v6, 3, v1
    v_lshl_add_u32 v5, v6, 3, v5
    v_lshrrev_b32 v6, 4, v1
    v_lshl_add_u32 v5, v6, 10, v5
    v_lshrrev_b32 v6, 5, v1
    v_lshl_add_u32 v5, v6, 11, v5
    s_lshl_b32 s47, s51, 16
    v_add_u32 v5, s47, v5
    s_add_u32 m0, s45, 0
    s_add_u32 s47, s46, 0x0
    buffer_load_dwordx4 v3, s[24:27], s47 offen lds
    s_add_u32 m0, s45, 1024
    s_add_u32 s47, s46, 0x2000
    buffer_load_dwordx4 v3, s[24:27], s47 offen lds
    s_add_u32 m0, s45, 2048
    s_add_u32 s47, s46, 0x4000
    buffer_load_dwordx4 v3, s[24:27], s47 offen lds
    s_add_u32 m0, s45, 3072
    s_add_u32 s47, s46, 0x6000
    buffer_load_dwordx4 v3, s[24:27], s47 offen lds
    s_add_u32 m0, s45, 4096
    s_add_u32 s47, s46, 0x8000
    buffer_load_dwordx4 v3, s[24:27], s47 offen lds
    s_add_u32 m0, s45, 5120
    s_add_u32 s47, s46, 0xa000
    buffer_load_dwordx4 v3, s[24:27], s47 offen lds
    s_add_u32 m0, s45, 6144
    s_add_u32 s47, s46, 0xc000
    buffer_load_dwordx4 v3, s[24:27], s47 offen lds
    s_add_u32 m0, s45, 7168
    s_add_u32 s47, s46, 0xe000
    buffer_load_dwordx4 v3, s[24:27], s47 offen lds
    s_add_u32 m0, s45, 8192
    s_add_u32 s47, s46, 0x10000
    buffer_load_dwordx4 v3, s[24:27], s47 offen lds
    s_add_u32 m0, s45, 9216
    s_add_u32 s47, s46, 0x12000
    buffer_load_dwordx4 v3, s[24:27], s47 offen lds
    s_add_u32 m0, s45, 10240
    s_add_u32 s47, s46, 0x14000
    buffer_load_dwordx4 v3, s[24:27], s47 offen lds
    s_add_u32 m0, s45, 11264
    s_add_u32 s47, s46, 0x16000
    buffer_load_dwordx4 v3, s[24:27], s47 offen lds
    s_add_u32 m0, s45, 12288
    s_add_u32 s47, s46, 0x18000
    buffer_load_dwordx4 v3, s[24:27], s47 offen lds
    s_add_u32 m0, s45, 13312
    s_add_u32 s47, s46, 0x1a000
    buffer_load_dwordx4 v3, s[24:27], s47 offen lds
    s_waitcnt vmcnt(0)
    s_barrier
    ds_read_b64_tr_b16 a[0:1], v5 offset:0
    ds_read_b64_tr_b16 a[2:3], v5 offset:2048
    ds_read_b64_tr_b16 a[4:5], v5 offset:32
    ds_read_b64_tr_b16 a[6:7], v5 offset:2080
    ds_read_b64_tr_b16 a[8:9], v5 offset:8192
    ds_read_b64_tr_b16 a[10:11], v5 offset:10240
    ds_read_b64_tr_b16 a[12:13], v5 offset:8224
    ds_read_b64_tr_b16 a[14:15], v5 offset:10272
    s_waitcnt lgkmcnt(0)
    ds_read_b64_tr_b16 a[16:17], v5 offset:16384
    ds_read_b64_tr_b16 a[18:19], v5 offset:18432
    ds_read_b64_tr_b16 a[20:21], v5 offset:16416
    ds_read_b64_tr_b16 a[22:23], v5 offset:18464
    ds_read_b64_tr_b16 a[24:25], v5 offset:24576
    ds_read_b64_tr_b16 a[26:27], v5 offset:26624
    ds_read_b64_tr_b16 a[28:29], v5 offset:24608
    ds_read_b64_tr_b16 a[30:31], v5 offset:26656
    s_waitcnt lgkmcnt(0)
    ds_read_b64_tr_b16 a[32:33], v5 offset:32768
    ds_read_b64_tr_b16 a[34:35], v5 offset:34816
    ds_read_b64_tr_b16 a[36:37], v5 offset:32800
    ds_read_b64_tr_b16 a[38:39], v5 offset:34848
    ds_read_b64_tr_b16 a[40:41], v5 offset:40960
    ds_read_b64_tr_b16 a[42:43], v5 offset:43008
    ds_read_b64_tr_b16 a[44:45], v5 offset:40992
    ds_read_b64_tr_b16 a[46:47], v5 offset:43040
    s_waitcnt lgkmcnt(0)
    ds_read_b64_tr_b16 a[48:49], v5 offset:49152
    ds_read_b64_tr_b16 a[50:51], v5 offset:51200
    ds_read_b64_tr_b16 a[52:53], v5 offset:49184
    ds_read_b64_tr_b16 a[54:55], v5 offset:51232
    s_waitcnt lgkmcnt(0)
    s_barrier
    s_add_u32 m0, s45, 0
    s_add_u32 s47, s46, 0x70000
    buffer_load_dwordx4 v3, s[24:27], s47 offen lds
    s_add_u32 m0, s45, 1024
    s_add_u32 s47, s46, 0x72000
    buffer_load_dwordx4 v3, s[24:27], s47 offen lds
    s_add_u32 m0, s45, 2048
    s_add_u32 s47, s46, 0x74000
    buffer_load_dwordx4 v3, s[24:27], s47 offen lds
    s_add_u32 m0, s45, 3072
    s_add_u32 s47, s46, 0x76000
    buffer_load_dwordx4 v3, s[24:27], s47 offen lds
    s_add_u32 m0, s45, 4096
    s_add_u32 s47, s46, 0x78000
    buffer_load_dwordx4 v3, s[24:27], s47 offen lds
    s_add_u32 m0, s45, 5120
    s_add_u32 s47, s46, 0x7a000
    buffer_load_dwordx4 v3, s[24:27], s47 offen lds
    s_add_u32 m0, s45, 6144
    s_add_u32 s47, s46, 0x7c000
    buffer_load_dwordx4 v3, s[24:27], s47 offen lds
    s_add_u32 m0, s45, 7168
    s_add_u32 s47, s46, 0x7e000
    buffer_load_dwordx4 v3, s[24:27], s47 offen lds
    s_add_u32 m0, s45, 8192
    s_add_u32 s47, s46, 0x80000
    buffer_load_dwordx4 v3, s[24:27], s47 offen lds
    s_add_u32 m0, s45, 9216
    s_add_u32 s47, s46, 0x82000
    buffer_load_dwordx4 v3, s[24:27], s47 offen lds
    s_add_u32 m0, s45, 10240
    s_add_u32 s47, s46, 0x84000
    buffer_load_dwordx4 v3, s[24:27], s47 offen lds
    s_add_u32 m0, s45, 11264
    s_add_u32 s47, s46, 0x86000
    buffer_load_dwordx4 v3, s[24:27], s47 offen lds
    s_add_u32 m0, s45, 12288
    s_add_u32 s47, s46, 0x88000
    buffer_load_dwordx4 v3, s[24:27], s47 offen lds
    s_add_u32 m0, s45, 13312
    s_add_u32 s47, s46, 0x8a000
    buffer_load_dwordx4 v3, s[24:27], s47 offen lds
    s_waitcnt vmcnt(0)
    s_barrier
    ds_read_b64_tr_b16 a[56:57], v5 offset:0
    ds_read_b64_tr_b16 a[58:59], v5 offset:2048
    ds_read_b64_tr_b16 a[60:61], v5 offset:32
    ds_read_b64_tr_b16 a[62:63], v5 offset:2080
    ds_read_b64_tr_b16 a[64:65], v5 offset:8192
    ds_read_b64_tr_b16 a[66:67], v5 offset:10240
    ds_read_b64_tr_b16 a[68:69], v5 offset:8224
    ds_read_b64_tr_b16 a[70:71], v5 offset:10272
    s_waitcnt lgkmcnt(0)
    ds_read_b64_tr_b16 a[72:73], v5 offset:16384
    ds_read_b64_tr_b16 a[74:75], v5 offset:18432
    ds_read_b64_tr_b16 a[76:77], v5 offset:16416
    ds_read_b64_tr_b16 a[78:79], v5 offset:18464
    ds_read_b64_tr_b16 a[80:81], v5 offset:24576
    ds_read_b64_tr_b16 a[82:83], v5 offset:26624
    ds_read_b64_tr_b16 a[84:85], v5 offset:24608
    ds_read_b64_tr_b16 a[86:87], v5 offset:26656
    s_waitcnt lgkmcnt(0)
    ds_read_b64_tr_b16 a[88:89], v5 offset:32768
    ds_read_b64_tr_b16 a[90:91], v5 offset:34816
    ds_read_b64_tr_b16 a[92:93], v5 offset:32800
    ds_read_b64_tr_b16 a[94:95], v5 offset:34848
    ds_read_b64_tr_b16 a[96:97], v5 offset:40960
    ds_read_b64_tr_b16 a[98:99], v5 offset:43008
    ds_read_b64_tr_b16 a[100:101], v5 offset:40992
    ds_read_b64_tr_b16 a[102:103], v5 offset:43040
    s_waitcnt lgkmcnt(0)
    ds_read_b64_tr_b16 a[104:105], v5 offset:49152
    ds_read_b64_tr_b16 a[106:107], v5 offset:51200
    ds_read_b64_tr_b16 a[108:109], v5 offset:49184
    ds_read_b64_tr_b16 a[110:111], v5 offset:51232
    s_waitcnt lgkmcnt(0)
    s_barrier
    v_lshlrev_b32 v2, 4, v1
    s_mul_i32 s64, s44, 7168
    s_add_u32 s46, s64, 0x6000000
    s_mul_i32 s47, s42, 57344
    s_add_u32 s46, s46, s47
    v_add_u32 v3, s46, v2
    s_mul_i32 s46, s51, 28672
    v_add_u32 v4, s46, v2
    v_and_b32 v6, 15, v1
    v_lshlrev_b32 v6, 4, v6
    v_lshrrev_b32 v7, 4, v1
    v_lshl_add_u32 v6, v7, 9, v6
    v_add_u32 v4, s46, v6
    s_lshl_b32 s46, s50, 12
    s_add_u32 s46, s46, 131072
    v_add_u32 v5, s46, v2
    v_min_u32 v7, 6, v1
    v_lshlrev_b32 v7, 7, v7
    s_mul_i32 s46, s42, 896
    s_add_u32 s46, s46, 0x106400
    v_add_u32 v7, s46, v7
    s_lshl_b32 s46, s42, 16
    s_lshl_b32 s47, s43, 11
    s_add_u32 s46, s46, s47
    s_lshl_b32 s47, s50, 9
    s_add_u32 s46, s46, s47
    s_add_u32 s46, s46, 0xb000000
    v_and_b32 v8, 31, v1
    v_lshlrev_b32 v8, 4, v8
    v_lshrrev_b32 v9, 5, v1
    v_lshl_add_u32 v8, v9, 14, v8
    v_add_u32 v8, s46, v8
    v_add_u32 v9, 0x8000, v8
    s_lshl_b32 s52, s43, 9
    s_lshl_b32 s47, s42, 7
    s_add_u32 s52, s52, s47
    s_add_u32 s52, s52, 0x108400
    s_add_u32 s52, s52, s76
    s_mov_b32 s60, s74
    s_mul_i32 s61, s74, 229376
    s_mov_b32 s62, s74
    s_mul_i32 s63, s74, 262144
    s_mov_b32 s67, 0
    s_mov_b32 s68, 3
    s_mov_b32 s71, 0
    v_mov_b32 v15, 147456
    v_mov_b32 v14, 0
    ds_write_b32 v15, v14 offset:4
    ds_write_b32 v15, v14 offset:12
    ds_write_b32 v15, v14 offset:16
    v_mov_b32 v114, 1
    s_mov_b32 s72, 0
L_g_restart_128:
    s_cmp_lg_u32 s44, 0
    s_cbranch_scc1 L_g_nsp_129
    s_mov_b32 s70, 0
L_g_sp_135:
    s_add_u32 s54, s60, 0
    s_add_u32 s55, s54, 0
    s_cmp_ge_u32 s55, 60
    s_cselect_b32 s46, 65536, 0
    s_cmp_ge_u32 s55, 62
    s_cselect_b32 s46, 131072, s46
    buffer_load_dword v11, v7, s[12:15], s46 offen sc1
    s_add_u32 s55, s54, 1
    s_cmp_ge_u32 s55, 60
    s_cselect_b32 s46, 65536, 0
    s_cmp_ge_u32 s55, 62
    s_cselect_b32 s46, 131072, s46
    buffer_load_dword v12, v7, s[12:15], s46 offen sc1
    s_add_u32 s55, s54, 2
    s_cmp_ge_u32 s55, 60
    s_cselect_b32 s46, 65536, 0
    s_cmp_ge_u32 s55, 62
    s_cselect_b32 s46, 131072, s46
    buffer_load_dword v13, v7, s[12:15], s46 offen sc1
    s_waitcnt vmcnt(0)
    v_cmp_ge_u32 vcc, s60, v11
    s_add_u32 s70, s70, 1
    s_cbranch_vccz L_g_sp_135_ok
    s_sleep 3
    s_cmp_lt_u32 s70, 524288
    s_cbranch_scc1 L_g_sp_135
    s_branch L_c_done_1
L_g_sp_135_ok:
    s_mov_b32 s46, s54
    v_cmp_ge_u32 vcc, s46, v11
    s_nop 0
    s_cbranch_vccnz L_g_le_136
    s_add_u32 s46, s46, 1
    v_cmp_ge_u32 vcc, s46, v12
    s_nop 0
    s_cbranch_vccnz L_g_le_136
    s_add_u32 s46, s46, 1
    v_cmp_ge_u32 vcc, s46, v13
    s_nop 0
    s_cbranch_vccnz L_g_le_136
    s_add_u32 s46, s46, 1
L_g_le_136:
    s_min_u32 s46, s46, s75
    v_mov_b32 v11, s46
    ds_write_b32 v15, v11
L_g_nsp_129:
    s_waitcnt lgkmcnt(0)
    s_barrier
    ds_read_b32 v14, v15
    s_waitcnt lgkmcnt(0)
    v_readfirstlane_b32 s66, v14
    s_nop 3
L_g_restart_128_go:
    s_mov_b32 s69, 0
    s_cmp_gt_u32 s62, s60
    s_cbranch_scc1 L_g_nd_137
    s_cmp_ge_u32 s62, s66
    s_cbranch_scc1 L_g_nd_137
    s_add_u32 s47, s61, 4096
    s_add_u32 m0, s64, 0
    s_nop 0
    buffer_load_dwordx4 v3, s[12:15], s61 offen offset:0 sc1 lds
    buffer_load_dwordx4 v3, s[12:15], s61 offen offset:1024 sc1 lds
    buffer_load_dwordx4 v3, s[12:15], s61 offen offset:2048 sc1 lds
    buffer_load_dwordx4 v3, s[12:15], s61 offen offset:3072 sc1 lds
    s_add_u32 m0, s64, 4096
    s_nop 0
    buffer_load_dwordx4 v3, s[12:15], s47 offen offset:0 sc1 lds
    buffer_load_dwordx4 v3, s[12:15], s47 offen offset:1024 sc1 lds
    buffer_load_dwordx4 v3, s[12:15], s47 offen offset:2048 sc1 lds
    s_add_u32 s61, s61, 229376
    s_add_u32 s62, s62, 1
    s_xor_b32 s64, s64, 0x10000
    s_mov_b32 s69, 1
L_g_nd_137:
    s_cmp_eq_u32 s51, 1
    s_cbranch_scc1 L_g_g1r_130
    s_add_u32 s59, s60, 1
    s_mov_b32 s69, 0
    s_cmp_gt_u32 s62, s59
    s_cbranch_scc1 L_g_nd_138
    s_cmp_ge_u32 s62, s66
    s_cbranch_scc1 L_g_nd_138
    s_add_u32 s47, s61, 4096
    s_add_u32 m0, s64, 0
    s_nop 0
    buffer_load_dwordx4 v3, s[12:15], s61 offen offset:0 sc1 lds
    buffer_load_dwordx4 v3, s[12:15], s61 offen offset:1024 sc1 lds
    buffer_load_dwordx4 v3, s[12:15], s61 offen offset:2048 sc1 lds
    buffer_load_dwordx4 v3, s[12:15], s61 offen offset:3072 sc1 lds
    s_add_u32 m0, s64, 4096
    s_nop 0
    buffer_load_dwordx4 v3, s[12:15], s47 offen offset:0 sc1 lds
    buffer_load_dwordx4 v3, s[12:15], s47 offen offset:1024 sc1 lds
    buffer_load_dwordx4 v3, s[12:15], s47 offen offset:2048 sc1 lds
    s_add_u32 s61, s61, 229376
    s_add_u32 s62, s62, 1
    s_xor_b32 s64, s64, 0x10000
    s_mov_b32 s69, 1
L_g_nd_138:
    s_cmp_eq_u32 s69, 1
    s_cbranch_scc1 L_g_w0_139
    s_waitcnt vmcnt(0)
L_g_w0_139:
    s_waitcnt vmcnt(7)
    s_mov_b32 s65, 1
.p2align 6
L_g_loop0_131:
    s_barrier
    s_cmp_eq_u32 s65, 0
    s_cbranch_scc1 L_g_pr_140
    ds_read_b128 v[32:35], v4 offset:0
    ds_read_b128 v[36:39], v4 offset:256
    ds_read_b128 v[40:43], v4 offset:2048
    ds_read_b128 v[44:47], v4 offset:2304
    ds_read_b128 v[48:51], v4 offset:4096
    ds_read_b128 v[52:55], v4 offset:4352
    ds_read_b128 v[56:59], v4 offset:6144
    ds_read_b128 v[60:63], v4 offset:6400
    ds_read_b128 v[72:75], v4 offset:8192
    ds_read_b128 v[76:79], v4 offset:8448
    ds_read_b128 v[120:123], v4 offset:10240
    ds_read_b128 v[124:127], v4 offset:10496
L_g_pr_140:
    ds_read_b32 v14, v15
    s_cmp_lg_u32 s44, 0
    s_cbranch_scc1 L_g_nl_141
    s_add_u32 s54, s60, 1
    s_add_u32 s55, s54, 0
    s_cmp_ge_u32 s55, 60
    s_cselect_b32 s46, 65536, 0
    s_cmp_ge_u32 s55, 62
    s_cselect_b32 s46, 131072, s46
    buffer_load_dword v11, v7, s[12:15], s46 offen sc1
    s_add_u32 s55, s54, 1
    s_cmp_ge_u32 s55, 60
    s_cselect_b32 s46, 65536, 0
    s_cmp_ge_u32 s55, 62
    s_cselect_b32 s46, 131072, s46
    buffer_load_dword v12, v7, s[12:15], s46 offen sc1
    s_add_u32 s55, s54, 2
    s_cmp_ge_u32 s55, 60
    s_cselect_b32 s46, 65536, 0
    s_cmp_ge_u32 s55, 62
    s_cselect_b32 s46, 131072, s46
    buffer_load_dword v13, v7, s[12:15], s46 offen sc1
L_g_nl_141:
    s_setprio 2
    s_waitcnt lgkmcnt(8)
    v_mfma_f32_16x16x32_bf16 v[16:19], v[32:35], a[0:3], 0
    v_mfma_f32_16x16x32_bf16 v[20:23], v[32:35], a[4:7], 0
    ds_read_b128 v[32:35], v4 offset:12288
    v_mfma_f32_16x16x32_bf16 v[28:31], v[36:39], a[4:7], 0
    v_mfma_f32_16x16x32_bf16 v[24:27], v[36:39], a[0:3], 0
    ds_read_b128 v[36:39], v4 offset:12544
    v_mfma_f32_16x16x32_bf16 v[16:19], v[40:43], a[8:11], v[16:19]
    v_mfma_f32_16x16x32_bf16 v[20:23], v[40:43], a[12:15], v[20:23]
    ds_read_b128 v[40:43], v4 offset:14336
    v_mfma_f32_16x16x32_bf16 v[28:31], v[44:47], a[12:15], v[28:31]
    v_mfma_f32_16x16x32_bf16 v[24:27], v[44:47], a[8:11], v[24:27]
    ds_read_b128 v[44:47], v4 offset:14592
    s_waitcnt lgkmcnt(8)
    v_mfma_f32_16x16x32_bf16 v[16:19], v[48:51], a[16:19], v[16:19]
    v_mfma_f32_16x16x32_bf16 v[20:23], v[48:51], a[20:23], v[20:23]
    ds_read_b128 v[48:51], v4 offset:16384
    v_mfma_f32_16x16x32_bf16 v[28:31], v[52:55], a[20:23], v[28:31]
    v_mfma_f32_16x16x32_bf16 v[24:27], v[52:55], a[16:19], v[24:27]
    ds_read_b128 v[52:55], v4 offset:16640
    v_mfma_f32_16x16x32_bf16 v[16:19], v[56:59], a[24:27], v[16:19]
    v_mfma_f32_16x16x32_bf16 v[20:23], v[56:59], a[28:31], v[20:23]
    ds_read_b128 v[56:59], v4 offset:18432
    v_mfma_f32_16x16x32_bf16 v[28:31], v[60:63], a[28:31], v[28:31]
    v_mfma_f32_16x16x32_bf16 v[24:27], v[60:63], a[24:27], v[24:27]
    ds_read_b128 v[60:63], v4 offset:18688
    s_waitcnt lgkmcnt(8)
    v_mfma_f32_16x16x32_bf16 v[16:19], v[72:75], a[32:35], v[16:19]
    v_mfma_f32_16x16x32_bf16 v[20:23], v[72:75], a[36:39], v[20:23]
    ds_read_b128 v[72:75], v4 offset:20480
    v_mfma_f32_16x16x32_bf16 v[28:31], v[76:79], a[36:39], v[28:31]
    v_mfma_f32_16x16x32_bf16 v[24:27], v[76:79], a[32:35], v[24:27]
    ds_read_b128 v[76:79], v4 offset:20736
    v_mfma_f32_16x16x32_bf16 v[16:19], v[120:123], a[40:43], v[16:19]
    v_mfma_f32_16x16x32_bf16 v[20:23], v[120:123], a[44:47], v[20:23]
    ds_read_b128 v[120:123], v4 offset:22528
    v_mfma_f32_16x16x32_bf16 v[28:31], v[124:127], a[44:47], v[28:31]
    v_mfma_f32_16x16x32_bf16 v[24:27], v[124:127], a[40:43], v[24:27]
    ds_read_b128 v[124:127], v4 offset:22784
    s_waitcnt lgkmcnt(8)
    v_mfma_f32_16x16x32_bf16 v[16:19], v[32:35], a[48:51], v[16:19]
    v_mfma_f32_16x16x32_bf16 v[20:23], v[32:35], a[52:55], v[20:23]
    ds_read_b128 v[32:35], v4 offset:24576
    v_mfma_f32_16x16x32_bf16 v[28:31], v[36:39], a[52:55], v[28:31]
    v_mfma_f32_16x16x32_bf16 v[24:27], v[36:39], a[48:51], v[24:27]
    ds_read_b128 v[36:39], v4 offset:24832
    v_mfma_f32_16x16x32_bf16 v[16:19], v[40:43], a[56:59], v[16:19]
    v_mfma_f32_16x16x32_bf16 v[20:23], v[40:43], a[60:63], v[20:23]
    ds_read_b128 v[40:43], v4 offset:26624
    v_mfma_f32_16x16x32_bf16 v[28:31], v[44:47], a[60:63], v[28:31]
    v_mfma_f32_16x16x32_bf16 v[24:27], v[44:47], a[56:59], v[24:27]
    ds_read_b128 v[44:47], v4 offset:26880
    s_waitcnt lgkmcnt(8)
    v_mfma_f32_16x16x32_bf16 v[16:19], v[48:51], a[64:67], v[16:19]
    v_mfma_f32_16x16x32_bf16 v[20:23], v[48:51], a[68:71], v[20:23]
    v_mfma_f32_16x16x32_bf16 v[28:31], v[52:55], a[68:71], v[28:31]
    v_mfma_f32_16x16x32_bf16 v[24:27], v[52:55], a[64:67], v[24:27]
    v_mfma_f32_16x16x32_bf16 v[16:19], v[56:59], a[72:75], v[16:19]
    v_mfma_f32_16x16x32_bf16 v[20:23], v[56:59], a[76:79], v[20:23]
    v_mfma_f32_16x16x32_bf16 v[28:31], v[60:63], a[76:79], v[28:31]
    v_mfma_f32_16x16x32_bf16 v[24:27], v[60:63], a[72:75], v[24:27]
    s_waitcnt lgkmcnt(4)
    v_mfma_f32_16x16x32_bf16 v[16:19], v[72:75], a[80:83], v[16:19]
    v_mfma_f32_16x16x32_bf16 v[20:23], v[72:75], a[84:87], v[20:23]
    v_mfma_f32_16x16x32_bf16 v[28:31], v[76:79], a[84:87], v[28:31]
    v_mfma_f32_16x16x32_bf16 v[24:27], v[76:79], a[80:83], v[24:27]
    v_mfma_f32_16x16x32_bf16 v[16:19], v[120:123], a[88:91], v[16:19]
    v_mfma_f32_16x16x32_bf16 v[20:23], v[120:123], a[92:95], v[20:23]
    v_mfma_f32_16x16x32_bf16 v[28:31], v[124:127], a[92:95], v[28:31]
    v_mfma_f32_16x16x32_bf16 v[24:27], v[124:127], a[88:91], v[24:27]
    s_waitcnt lgkmcnt(0)
    v_mfma_f32_16x16x32_bf16 v[16:19], v[32:35], a[96:99], v[16:19]
    v_mfma_f32_16x16x32_bf16 v[20:23], v[32:35], a[100:103], v[20:23]
    v_mfma_f32_16x16x32_bf16 v[28:31], v[36:39], a[100:103], v[28:31]
    v_mfma_f32_16x16x32_bf16 v[24:27], v[36:39], a[96:99], v[24:27]
    v_mfma_f32_16x16x32_bf16 v[16:19], v[40:43], a[104:107], v[16:19]
    v_mfma_f32_16x16x32_bf16 v[20:23], v[40:43], a[108:111], v[20:23]
    v_mfma_f32_16x16x32_bf16 v[28:31], v[44:47], a[108:111], v[28:31]
    v_mfma_f32_16x16x32_bf16 v[24:27], v[44:47], a[104:107], v[24:27]
    v_xor_b32 v4, 0x10000, v4
    s_setprio 0
    s_waitcnt vmcnt(0)
    v_readfirstlane_b32 s66, v14
    s_barrier
    s_nop 6
    ds_write_b128 v5, v[16:19] offset:0
    ds_write_b128 v5, v[20:23] offset:1024
    ds_write_b128 v5, v[24:27] offset:2048
    ds_write_b128 v5, v[28:31] offset:3072
    s_cmp_lg_u32 s44, 0
    s_cbranch_scc1 L_g_ne_142
    s_mov_b32 s46, s54
    v_cmp_ge_u32 vcc, s46, v11
    s_nop 0
    s_cbranch_vccnz L_g_le_145
    s_add_u32 s46, s46, 1
    v_cmp_ge_u32 vcc, s46, v12
    s_nop 0
    s_cbranch_vccnz L_g_le_145
    s_add_u32 s46, s46, 1
    v_cmp_ge_u32 vcc, s46, v13
    s_nop 0
    s_cbranch_vccnz L_g_le_145
    s_add_u32 s46, s46, 1
L_g_le_145:
    s_min_u32 s46, s46, s75
    v_mov_b32 v11, s46
    ds_write_b32 v15, v11
L_g_ne_142:
    s_add_u32 s60, s60, 1
    s_mov_b32 s69, 0
    s_cmp_gt_u32 s62, s60
    s_cbranch_scc1 L_g_nd_146
    s_cmp_ge_u32 s62, s66
    s_cbranch_scc1 L_g_nd_146
    s_add_u32 s47, s61, 4096
    s_add_u32 m0, s64, 0
    s_nop 0
    buffer_load_dwordx4 v3, s[12:15], s61 offen offset:0 sc1 lds
    buffer_load_dwordx4 v3, s[12:15], s61 offen offset:1024 sc1 lds
    buffer_load_dwordx4 v3, s[12:15], s61 offen offset:2048 sc1 lds
    buffer_load_dwordx4 v3, s[12:15], s61 offen offset:3072 sc1 lds
    s_add_u32 m0, s64, 4096
    s_nop 0
    buffer_load_dwordx4 v3, s[12:15], s47 offen offset:0 sc1 lds
    buffer_load_dwordx4 v3, s[12:15], s47 offen offset:1024 sc1 lds
    buffer_load_dwordx4 v3, s[12:15], s47 offen offset:2048 sc1 lds
    s_add_u32 s61, s61, 229376
    s_add_u32 s62, s62, 1
    s_xor_b32 s64, s64, 0x10000
    s_mov_b32 s69, 1
L_g_nd_146:
    s_mov_b32 s65, s69
    s_add_u32 s59, s60, 1
    s_mov_b32 s69, 0
    s_cmp_gt_u32 s62, s59
    s_cbranch_scc1 L_g_nd_147
    s_cmp_ge_u32 s62, s66
    s_cbranch_scc1 L_g_nd_147
    s_add_u32 s47, s61, 4096
    s_add_u32 m0, s64, 0
    s_nop 0
    buffer_load_dwordx4 v3, s[12:15], s61 offen offset:0 sc1 lds
    buffer_load_dwordx4 v3, s[12:15], s61 offen offset:1024 sc1 lds
    buffer_load_dwordx4 v3, s[12:15], s61 offen offset:2048 sc1 lds
    buffer_load_dwordx4 v3, s[12:15], s61 offen offset:3072 sc1 lds
    s_add_u32 m0, s64, 4096
    s_nop 0
    buffer_load_dwordx4 v3, s[12:15], s47 offen offset:0 sc1 lds
    buffer_load_dwordx4 v3, s[12:15], s47 offen offset:1024 sc1 lds
    buffer_load_dwordx4 v3, s[12:15], s47 offen offset:2048 sc1 lds
    s_add_u32 s61, s61, 229376
    s_add_u32 s62, s62, 1
    s_xor_b32 s64, s64, 0x10000
    s_mov_b32 s69, 1
L_g_nd_147:
    s_cmp_le_u32 s66, s60
    s_cbranch_scc1 L_g_ex0_144
    s_cmp_eq_u32 s65, 0
    s_cbranch_scc1 L_g_nw_143
    s_waitcnt vmcnt(0) lgkmcnt(0)
    s_branch L_g_loop0_131
L_g_nw_143:
    ds_read_b128 v[32:35], v4 offset:0
    ds_read_b128 v[36:39], v4 offset:256
    ds_read_b128 v[40:43], v4 offset:2048
    ds_read_b128 v[44:47], v4 offset:2304
    ds_read_b128 v[48:51], v4 offset:4096
    ds_read_b128 v[52:55], v4 offset:4352
    ds_read_b128 v[56:59], v4 offset:6144
    ds_read_b128 v[60:63], v4 offset:6400
    ds_read_b128 v[72:75], v4 offset:8192
    ds_read_b128 v[76:79], v4 offset:8448
    ds_read_b128 v[120:123], v4 offset:10240
    ds_read_b128 v[124:127], v4 offset:10496
    s_waitcnt lgkmcnt(12)
    s_branch L_g_loop0_131
L_g_ex0_144:
    s_cmp_lg_u32 s44, 0
    s_cbranch_scc1 L_g_ex0_144_n
    s_sleep 6
    s_add_u32 s54, s60, 0
    s_add_u32 s55, s54, 0
    s_cmp_ge_u32 s55, 60
    s_cselect_b32 s46, 65536, 0
    s_cmp_ge_u32 s55, 62
    s_cselect_b32 s46, 131072, s46
    buffer_load_dword v11, v7, s[12:15], s46 offen sc1
    s_add_u32 s55, s54, 1
    s_cmp_ge_u32 s55, 60
    s_cselect_b32 s46, 65536, 0
    s_cmp_ge_u32 s55, 62
    s_cselect_b32 s46, 131072, s46
    buffer_load_dword v12, v7, s[12:15], s46 offen sc1
    s_add_u32 s55, s54, 2
    s_cmp_ge_u32 s55, 60
    s_cselect_b32 s46, 65536, 0
    s_cmp_ge_u32 s55, 62
    s_cselect_b32 s46, 131072, s46
    buffer_load_dword v13, v7, s[12:15], s46 offen sc1
    s_waitcnt vmcnt(0)
    s_mov_b32 s46, s54
    v_cmp_ge_u32 vcc, s46, v11
    s_nop 0
    s_cbranch_vccnz L_g_le_148
    s_add_u32 s46, s46, 1
    v_cmp_ge_u32 vcc, s46, v12
    s_nop 0
    s_cbranch_vccnz L_g_le_148
    s_add_u32 s46, s46, 1
    v_cmp_ge_u32 vcc, s46, v13
    s_nop 0
    s_cbranch_vccnz L_g_le_148
    s_add_u32 s46, s46, 1
L_g_le_148:
    s_min_u32 s46, s46, s75
    v_mov_b32 v11, s46
    ds_write_b32 v15, v11
L_g_ex0_144_n:
    s_waitcnt lgkmcnt(0)
    s_barrier
    ds_read_b32 v14, v15
    s_waitcnt lgkmcnt(0)
    v_readfirstlane_b32 s66, v14
    s_barrier
    s_cmp_gt_u32 s66, s60
    s_cbranch_scc1 L_g_restart_128_go
    s_branch L_g_tail_133
L_g_g1r_130:
    s_mov_b32 s65, 1
    s_branch L_g_loop1_132_e
.p2align 6
L_g_loop1_132:
    s_mov_b32 s65, 0
L_g_loop1_132_e:
    s_barrier
    ds_read_b32 v14, v15
    s_bitcmp1_b32 s67, 1
    s_cbranch_scc0 L_g_nfl_149
    s_sub_u32 s59, s60, 2
    s_cmp_lg_u32 s44, 4
    s_cbranch_scc1 L_sf_154
    v_mov_b32 v10, s59
    v_add_u32 v10, 1, v10
    v_mov_b32 v11, 0
    s_mov_b64 exec, 1
    buffer_store_dword v10, v11, s[12:15], s52 offen sc1
    s_mov_b64 exec, -1
L_sf_154:
L_g_nfl_149:
    s_cmp_eq_u32 s71, 0
    s_cbranch_scc1 L_g_nfl_149_d
    v_mov_b32 v10, 1
    s_mov_b64 exec, 1
    s_waitcnt vmcnt(0)
    ds_add_rtn_u32 v10, v15, v10 offset:4
    s_waitcnt lgkmcnt(0)
    v_readfirstlane_b32 s46, v10
    s_mov_b64 exec, -1
    s_mov_b32 s71, 0
    s_sub_u32 s59, s60, 1
    s_cmp_lg_u32 s46, s68
    s_cbranch_scc1 L_g_df_155
    v_mov_b32 v10, s59
    v_add_u32 v10, 1, v10
    v_mov_b32 v11, 0
    s_mov_b64 exec, 1
    buffer_store_dword v10, v11, s[12:15], s52 offen sc1
    s_mov_b64 exec, -1
L_sf_156:
L_g_df_155:
    s_add_u32 s68, s68, 4
    s_mov_b32 s65, 2
L_g_nfl_149_d:
    s_waitcnt lgkmcnt(0)
    v_readfirstlane_b32 s66, v14
    s_nop 3
    s_mov_b32 s69, 0
    s_cmp_gt_u32 s62, s60
    s_cbranch_scc1 L_g_nd_157
    s_cmp_ge_u32 s62, s66
    s_cbranch_scc1 L_g_nd_157
    s_add_u32 s47, s61, 4096
    s_add_u32 m0, s64, 0
    s_nop 0
    buffer_load_dwordx4 v3, s[12:15], s61 offen offset:0 sc1 lds
    buffer_load_dwordx4 v3, s[12:15], s61 offen offset:1024 sc1 lds
    buffer_load_dwordx4 v3, s[12:15], s61 offen offset:2048 sc1 lds
    buffer_load_dwordx4 v3, s[12:15], s61 offen offset:3072 sc1 lds
    s_add_u32 m0, s64, 4096
    s_nop 0
    buffer_load_dwordx4 v3, s[12:15], s47 offen offset:0 sc1 lds
    buffer_load_dwordx4 v3, s[12:15], s47 offen offset:1024 sc1 lds
    buffer_load_dwordx4 v3, s[12:15], s47 offen offset:2048 sc1 lds
    s_add_u32 s61, s61, 229376
    s_add_u32 s62, s62, 1
    s_xor_b32 s64, s64, 0x10000
    s_mov_b32 s69, 1
L_g_nd_157:
    s_or_b32 s65, s65, s69
    s_add_u32 s59, s60, 1
    s_mov_b32 s69, 0
    s_cmp_gt_u32 s62, s59
    s_cbranch_scc1 L_g_nd_158
    s_cmp_ge_u32 s62, s66
    s_cbranch_scc1 L_g_nd_158
    s_add_u32 s47, s61, 4096
    s_add_u32 m0, s64, 0
    s_nop 0
    buffer_load_dwordx4 v3, s[12:15], s61 offen offset:0 sc1 lds
    buffer_load_dwordx4 v3, s[12:15], s61 offen offset:1024 sc1 lds
    buffer_load_dwordx4 v3, s[12:15], s61 offen offset:2048 sc1 lds
    buffer_load_dwordx4 v3, s[12:15], s61 offen offset:3072 sc1 lds
    s_add_u32 m0, s64, 4096
    s_nop 0
    buffer_load_dwordx4 v3, s[12:15], s47 offen offset:0 sc1 lds
    buffer_load_dwordx4 v3, s[12:15], s47 offen offset:1024 sc1 lds
    buffer_load_dwordx4 v3, s[12:15], s47 offen offset:2048 sc1 lds
    s_add_u32 s61, s61, 229376
    s_add_u32 s62, s62, 1
    s_xor_b32 s64, s64, 0x10000
    s_mov_b32 s69, 1
L_g_nd_158:
    s_bitcmp1_b32 s67, 0
    s_cbranch_scc0 L_g_nep_150
    ds_read_b128 v[80:83], v5 offset:0
    ds_read_b128 v[84:87], v5 offset:1024
    ds_read_b128 v[88:91], v5 offset:2048
    ds_read_b128 v[92:95], v5 offset:3072
    s_nop 7
    s_waitcnt lgkmcnt(3)
    v_add_f32 v80, v80, v16
    v_add_f32 v81, v81, v17
    v_add_f32 v82, v82, v18
    v_add_f32 v83, v83, v19
    s_waitcnt lgkmcnt(2)
    v_add_f32 v84, v84, v20
    v_add_f32 v85, v85, v21
    v_add_f32 v86, v86, v22
    v_add_f32 v87, v87, v23
    s_waitcnt lgkmcnt(1)
    v_add_f32 v88, v88, v24
    v_add_f32 v89, v89, v25
    v_add_f32 v90, v90, v26
    v_add_f32 v91, v91, v27
    s_waitcnt lgkmcnt(0)
    v_add_f32 v92, v92, v28
    v_add_f32 v93, v93, v29
    v_add_f32 v94, v94, v30
    v_add_f32 v95, v95, v31
    v_cvt_pk_bf16_f32 v104, v80, v81
    v_cvt_pk_bf16_f32 v105, v82, v83
    v_cvt_pk_bf16_f32 v106, v84, v85
    v_cvt_pk_bf16_f32 v107, v86, v87
    s_nop 1
    v_permlane16_swap_b32 v104, v106
    v_permlane16_swap_b32 v105, v107
    buffer_store_dwordx4 v[104:107], v8, s[12:15], s63 offen sc1
    v_cvt_pk_bf16_f32 v108, v88, v89
    v_cvt_pk_bf16_f32 v109, v90, v91
    v_cvt_pk_bf16_f32 v110, v92, v93
    v_cvt_pk_bf16_f32 v111, v94, v95
    s_nop 1
    v_permlane16_swap_b32 v108, v110
    v_permlane16_swap_b32 v109, v111
    buffer_store_dwordx4 v[108:111], v9, s[12:15], s63 offen sc1
    s_add_u32 s63, s63, 262144
L_g_nep_150:
    s_cmp_eq_u32 s65, 0
    s_cbranch_scc1 L_g_nw1_151
    s_cmp_eq_u32 s65, 2
    s_cbranch_scc1 L_g_nw1_151_w
    s_waitcnt vmcnt(0)
L_g_nw1_151_w:
    s_barrier
    ds_read_b128 v[32:35], v4 offset:0
    ds_read_b128 v[36:39], v4 offset:256
    ds_read_b128 v[40:43], v4 offset:2048
    ds_read_b128 v[44:47], v4 offset:2304
    ds_read_b128 v[48:51], v4 offset:4096
    ds_read_b128 v[52:55], v4 offset:4352
    ds_read_b128 v[56:59], v4 offset:6144
    ds_read_b128 v[60:63], v4 offset:6400
    ds_read_b128 v[72:75], v4 offset:8192
    ds_read_b128 v[76:79], v4 offset:8448
    ds_read_b128 v[120:123], v4 offset:10240
    ds_read_b128 v[124:127], v4 offset:10496
    s_branch L_g_jn_153
L_g_nw1_151:
    ds_read_b128 v[32:35], v4 offset:0
    ds_read_b128 v[36:39], v4 offset:256
    ds_read_b128 v[40:43], v4 offset:2048
    ds_read_b128 v[44:47], v4 offset:2304
    ds_read_b128 v[48:51], v4 offset:4096
    ds_read_b128 v[52:55], v4 offset:4352
    ds_read_b128 v[56:59], v4 offset:6144
    ds_read_b128 v[60:63], v4 offset:6400
    ds_read_b128 v[72:75], v4 offset:8192
    ds_read_b128 v[76:79], v4 offset:8448
    ds_read_b128 v[120:123], v4 offset:10240
    ds_read_b128 v[124:127], v4 offset:10496
    s_barrier
L_g_jn_153:
    s_setprio 1
    s_waitcnt lgkmcnt(8)
    v_mfma_f32_16x16x32_bf16 v[16:19], v[32:35], a[0:3], 0
    v_mfma_f32_16x16x32_bf16 v[20:23], v[32:35], a[4:7], 0
    ds_read_b128 v[32:35], v4 offset:12288
    v_mfma_f32_16x16x32_bf16 v[28:31], v[36:39], a[4:7], 0
    v_mfma_f32_16x16x32_bf16 v[24:27], v[36:39], a[0:3], 0
    ds_read_b128 v[36:39], v4 offset:12544
    v_mfma_f32_16x16x32_bf16 v[16:19], v[40:43], a[8:11], v[16:19]
    v_mfma_f32_16x16x32_bf16 v[20:23], v[40:43], a[12:15], v[20:23]
    ds_read_b128 v[40:43], v4 offset:14336
    v_mfma_f32_16x16x32_bf16 v[28:31], v[44:47], a[12:15], v[28:31]
    v_mfma_f32_16x16x32_bf16 v[24:27], v[44:47], a[8:11], v[24:27]
    ds_read_b128 v[44:47], v4 offset:14592
    s_waitcnt lgkmcnt(8)
    v_mfma_f32_16x16x32_bf16 v[16:19], v[48:51], a[16:19], v[16:19]
    v_mfma_f32_16x16x32_bf16 v[20:23], v[48:51], a[20:23], v[20:23]
    ds_read_b128 v[48:51], v4 offset:16384
    v_mfma_f32_16x16x32_bf16 v[28:31], v[52:55], a[20:23], v[28:31]
    v_mfma_f32_16x16x32_bf16 v[24:27], v[52:55], a[16:19], v[24:27]
    ds_read_b128 v[52:55], v4 offset:16640
    v_mfma_f32_16x16x32_bf16 v[16:19], v[56:59], a[24:27], v[16:19]
    v_mfma_f32_16x16x32_bf16 v[20:23], v[56:59], a[28:31], v[20:23]
    ds_read_b128 v[56:59], v4 offset:18432
    v_mfma_f32_16x16x32_bf16 v[28:31], v[60:63], a[28:31], v[28:31]
    v_mfma_f32_16x16x32_bf16 v[24:27], v[60:63], a[24:27], v[24:27]
    ds_read_b128 v[60:63], v4 offset:18688
    s_waitcnt lgkmcnt(8)
    v_mfma_f32_16x16x32_bf16 v[16:19], v[72:75], a[32:35], v[16:19]
    v_mfma_f32_16x16x32_bf16 v[20:23], v[72:75], a[36:39], v[20:23]
    ds_read_b128 v[72:75], v4 offset:20480
    v_mfma_f32_16x16x32_bf16 v[28:31], v[76:79], a[36:39], v[28:31]
    v_mfma_f32_16x16x32_bf16 v[24:27], v[76:79], a[32:35], v[24:27]
    ds_read_b128 v[76:79], v4 offset:20736
    v_mfma_f32_16x16x32_bf16 v[16:19], v[120:123], a[40:43], v[16:19]
    v_mfma_f32_16x16x32_bf16 v[20:23], v[120:123], a[44:47], v[20:23]
    ds_read_b128 v[120:123], v4 offset:22528
    v_mfma_f32_16x16x32_bf16 v[28:31], v[124:127], a[44:47], v[28:31]
    v_mfma_f32_16x16x32_bf16 v[24:27], v[124:127], a[40:43], v[24:27]
    ds_read_b128 v[124:127], v4 offset:22784
    s_waitcnt lgkmcnt(8)
    v_mfma_f32_16x16x32_bf16 v[16:19], v[32:35], a[48:51], v[16:19]
    v_mfma_f32_16x16x32_bf16 v[20:23], v[32:35], a[52:55], v[20:23]
    ds_read_b128 v[32:35], v4 offset:24576
    v_mfma_f32_16x16x32_bf16 v[28:31], v[36:39], a[52:55], v[28:31]
    v_mfma_f32_16x16x32_bf16 v[24:27], v[36:39], a[48:51], v[24:27]
    ds_read_b128 v[36:39], v4 offset:24832
    v_mfma_f32_16x16x32_bf16 v[16:19], v[40:43], a[56:59], v[16:19]
    v_mfma_f32_16x16x32_bf16 v[20:23], v[40:43], a[60:63], v[20:23]
    ds_read_b128 v[40:43], v4 offset:26624
    v_mfma_f32_16x16x32_bf16 v[28:31], v[44:47], a[60:63], v[28:31]
    v_mfma_f32_16x16x32_bf16 v[24:27], v[44:47], a[56:59], v[24:27]
    ds_read_b128 v[44:47], v4 offset:26880
    s_waitcnt lgkmcnt(8)
    v_mfma_f32_16x16x32_bf16 v[16:19], v[48:51], a[64:67], v[16:19]
    v_mfma_f32_16x16x32_bf16 v[20:23], v[48:51], a[68:71], v[20:23]
    v_mfma_f32_16x16x32_bf16 v[28:31], v[52:55], a[68:71], v[28:31]
    v_mfma_f32_16x16x32_bf16 v[24:27], v[52:55], a[64:67], v[24:27]
    v_mfma_f32_16x16x32_bf16 v[16:19], v[56:59], a[72:75], v[16:19]
    v_mfma_f32_16x16x32_bf16 v[20:23], v[56:59], a[76:79], v[20:23]
    v_mfma_f32_16x16x32_bf16 v[28:31], v[60:63], a[76:79], v[28:31]
    v_mfma_f32_16x16x32_bf16 v[24:27], v[60:63], a[72:75], v[24:27]
    s_waitcnt lgkmcnt(4)
    v_mfma_f32_16x16x32_bf16 v[16:19], v[72:75], a[80:83], v[16:19]
    v_mfma_f32_16x16x32_bf16 v[20:23], v[72:75], a[84:87], v[20:23]
    v_mfma_f32_16x16x32_bf16 v[28:31], v[76:79], a[84:87], v[28:31]
    v_mfma_f32_16x16x32_bf16 v[24:27], v[76:79], a[80:83], v[24:27]
    v_mfma_f32_16x16x32_bf16 v[16:19], v[120:123], a[88:91], v[16:19]
    v_mfma_f32_16x16x32_bf16 v[20:23], v[120:123], a[92:95], v[20:23]
    v_mfma_f32_16x16x32_bf16 v[28:31], v[124:127], a[92:95], v[28:31]
    v_mfma_f32_16x16x32_bf16 v[24:27], v[124:127], a[88:91], v[24:27]
    s_waitcnt lgkmcnt(0)
    v_mfma_f32_16x16x32_bf16 v[16:19], v[32:35], a[96:99], v[16:19]
    v_mfma_f32_16x16x32_bf16 v[20:23], v[32:35], a[100:103], v[20:23]
    v_mfma_f32_16x16x32_bf16 v[28:31], v[36:39], a[100:103], v[28:31]
    v_mfma_f32_16x16x32_bf16 v[24:27], v[36:39], a[96:99], v[24:27]
    v_mfma_f32_16x16x32_bf16 v[16:19], v[40:43], a[104:107], v[16:19]
    v_mfma_f32_16x16x32_bf16 v[20:23], v[40:43], a[108:111], v[20:23]
    v_mfma_f32_16x16x32_bf16 v[28:31], v[44:47], a[108:111], v[28:31]
    v_mfma_f32_16x16x32_bf16 v[24:27], v[44:47], a[104:107], v[24:27]
    v_xor_b32 v4, 0x10000, v4
    s_setprio 0
    s_waitcnt vmcnt(0)
    s_lshl_b32 s67, s67, 1
    s_or_b32 s67, s67, 1
    s_add_u32 s60, s60, 1
    s_cmp_gt_u32 s66, s60
    s_cbranch_scc1 L_g_loop1_132
    s_barrier
    ds_read_b32 v14, v15
    s_waitcnt lgkmcnt(0)
    v_readfirstlane_b32 s66, v14
    s_barrier
    s_mov_b32 s69, 0
    s_cmp_gt_u32 s62, s60
    s_cbranch_scc1 L_g_nd_159
    s_cmp_ge_u32 s62, s66
    s_cbranch_scc1 L_g_nd_159
    s_add_u32 s47, s61, 4096
    s_add_u32 m0, s64, 0
    s_nop 0
    buffer_load_dwordx4 v3, s[12:15], s61 offen offset:0 sc1 lds
    buffer_load_dwordx4 v3, s[12:15], s61 offen offset:1024 sc1 lds
    buffer_load_dwordx4 v3, s[12:15], s61 offen offset:2048 sc1 lds
    buffer_load_dwordx4 v3, s[12:15], s61 offen offset:3072 sc1 lds
    s_add_u32 m0, s64, 4096
    s_nop 0
    buffer_load_dwordx4 v3, s[12:15], s47 offen offset:0 sc1 lds
    buffer_load_dwordx4 v3, s[12:15], s47 offen offset:1024 sc1 lds
    buffer_load_dwordx4 v3, s[12:15], s47 offen offset:2048 sc1 lds
    s_add_u32 s61, s61, 229376
    s_add_u32 s62, s62, 1
    s_xor_b32 s64, s64, 0x10000
    s_mov_b32 s69, 1
L_g_nd_159:
    s_sub_u32 s59, s60, 1
    ds_read_b128 v[80:83], v5 offset:0
    ds_read_b128 v[84:87], v5 offset:1024
    ds_read_b128 v[88:91], v5 offset:2048
    ds_read_b128 v[92:95], v5 offset:3072
    s_nop 7
    s_waitcnt lgkmcnt(3)
    v_add_f32 v80, v80, v16
    v_add_f32 v81, v81, v17
    v_add_f32 v82, v82, v18
    v_add_f32 v83, v83, v19
    s_waitcnt lgkmcnt(2)
    v_add_f32 v84, v84, v20
    v_add_f32 v85, v85, v21
    v_add_f32 v86, v86, v22
    v_add_f32 v87, v87, v23
    s_waitcnt lgkmcnt(1)
    v_add_f32 v88, v88, v24
    v_add_f32 v89, v89, v25
    v_add_f32 v90, v90, v26
    v_add_f32 v91, v91, v27
    s_waitcnt lgkmcnt(0)
    v_add_f32 v92, v92, v28
    v_add_f32 v93, v93, v29
    v_add_f32 v94, v94, v30
    v_add_f32 v95, v95, v31
    v_cvt_pk_bf16_f32 v104, v80, v81
    v_cvt_pk_bf16_f32 v105, v82, v83
    v_cvt_pk_bf16_f32 v106, v84, v85
    v_cvt_pk_bf16_f32 v107, v86, v87
    s_nop 1
    v_permlane16_swap_b32 v104, v106
    v_permlane16_swap_b32 v105, v107
    buffer_store_dwordx4 v[104:107], v8, s[12:15], s63 offen sc1
    v_cvt_pk_bf16_f32 v108, v88, v89
    v_cvt_pk_bf16_f32 v109, v90, v91
    v_cvt_pk_bf16_f32 v110, v92, v93
    v_cvt_pk_bf16_f32 v111, v94, v95
    s_nop 1
    v_permlane16_swap_b32 v108, v110
    v_permlane16_swap_b32 v109, v111
    buffer_store_dwordx4 v[108:111], v9, s[12:15], s63 offen sc1
    s_add_u32 s63, s63, 262144
    s_mov_b32 s67, 0
    s_mov_b32 s71, 1
    s_cmp_gt_u32 s66, s60
    s_cbranch_scc1 L_g_g1r_130
    v_mov_b32 v10, 1
    s_mov_b64 exec, 1
    s_waitcnt vmcnt(0)
    ds_add_rtn_u32 v10, v15, v10 offset:4
    s_waitcnt lgkmcnt(0)
    v_readfirstlane_b32 s46, v10
    s_mov_b64 exec, -1
    s_mov_b32 s71, 0
    s_sub_u32 s59, s60, 1
    s_cmp_lg_u32 s46, s68
    s_cbranch_scc1 L_g_df_160
    v_mov_b32 v10, s59
    v_add_u32 v10, 1, v10
    v_mov_b32 v11, 0
    s_mov_b64 exec, 1
    buffer_store_dword v10, v11, s[12:15], s52 offen sc1
    s_mov_b64 exec, -1
L_sf_161:
L_g_df_160:
    s_add_u32 s68, s68, 4
    s_cmp_gt_u32 s66, s60
    s_cbranch_scc1 L_g_g1r_130
L_g_tail_133:
    s_cmp_lt_u32 s60, s75
    s_cbranch_scc1 L_g_restart_128
    s_waitcnt vmcnt(0)
    s_barrier
    s_branch L_c_done_1
L_w_wo_11:
    s_load_dwordx2 s[4:5], s[0:1], 40
    s_load_dwordx2 s[6:7], s[0:1], 72
    s_and_b32 s50, s44, 3
    s_lshr_b32 s51, s44, 2
    s_waitcnt lgkmcnt(0)
    s_mov_b32 s24, s4
    s_and_b32 s25, s5, 0xffff
    s_mov_b32 s26, 0x800000
    s_mov_b32 s27, 0x00020000
    v_lshrrev_b32 v3, 4, v1
    v_and_b32 v4, 15, v1
    v_lshlrev_b32 v5, 2, v3
    v_xor_b32 v4, v4, v5
    v_mul_u32_u24 v3, 2048, v3
    v_lshl_add_u32 v3, v4, 4, v3
    s_mul_i32 s46, s51, 512
    s_mul_i32 s47, s50, 64
    s_add_u32 s46, s46, s47
    s_mul_i32 s47, s42, 1024
    s_add_u32 s46, s46, s47
    s_mul_i32 s46, s46, 2048
    s_lshl_b32 s47, s43, 8
    s_add_u32 s46, s46, s47
    s_lshl_b32 s45, s51, 16
    s_mul_i32 s47, s50, 16384
    s_add_u32 s45, s45, s47
    v_bfe_u32 v4, v1, 2, 2
    v_bfe_u32 v5, v1, 4, 1
    v_lshlrev_b32 v5, 1, v5
    v_bfe_u32 v6, v1, 1, 1
    v_add_u32 v5, v5, v6
    s_lshl_b32 s47, s50, 2
    v_add_u32 v5, s47, v5
    v_lshlrev_b32 v6, 2, v4
    v_xor_b32 v5, v5, v6
    v_lshlrev_b32 v5, 4, v5
    v_lshl_add_u32 v5, v4, 8, v5
    v_bfe_u32 v6, v1, 0, 1
    v_lshl_add_u32 v5, v6, 3, v5
    v_lshrrev_b32 v6, 5, v1
    v_mul_u32_u24 v6, 1024, v6
    v_add_u32 v5, v5, v6
    s_lshl_b32 s47, s51, 16
    v_add_u32 v5, s47, v5
    v_bfe_u32 v4, v1, 2, 2
    v_xor_b32 v5, s50, v4
    v_lshlrev_b32 v5, 6, v5
    v_lshl_add_u32 v5, v4, 8, v5
    v_and_b32 v6, 3, v1
    v_lshl_add_u32 v5, v6, 3, v5
    v_lshrrev_b32 v6, 4, v1
    v_lshl_add_u32 v5, v6, 10, v5
    v_lshrrev_b32 v6, 5, v1
    s_lshl_b32 s47, s51, 16
    v_add_u32 v5, s47, v5
    s_add_u32 m0, s45, 0
    s_add_u32 s47, s46, 0x0
    buffer_load_dwordx4 v3, s[24:27], s47 offen lds
    s_add_u32 m0, s45, 1024
    s_add_u32 s47, s46, 0x2000
    buffer_load_dwordx4 v3, s[24:27], s47 offen lds
    s_add_u32 m0, s45, 2048
    s_add_u32 s47, s46, 0x4000
    buffer_load_dwordx4 v3, s[24:27], s47 offen lds
    s_add_u32 m0, s45, 3072
    s_add_u32 s47, s46, 0x6000
    buffer_load_dwordx4 v3, s[24:27], s47 offen lds
    s_add_u32 m0, s45, 4096
    s_add_u32 s47, s46, 0x8000
    buffer_load_dwordx4 v3, s[24:27], s47 offen lds
    s_add_u32 m0, s45, 5120
    s_add_u32 s47, s46, 0xa000
    buffer_load_dwordx4 v3, s[24:27], s47 offen lds
    s_add_u32 m0, s45, 6144
    s_add_u32 s47, s46, 0xc000
    buffer_load_dwordx4 v3, s[24:27], s47 offen lds
    s_add_u32 m0, s45, 7168
    s_add_u32 s47, s46, 0xe000
    buffer_load_dwordx4 v3, s[24:27], s47 offen lds
    s_add_u32 m0, s45, 8192
    s_add_u32 s47, s46, 0x10000
    buffer_load_dwordx4 v3, s[24:27], s47 offen lds
    s_add_u32 m0, s45, 9216
    s_add_u32 s47, s46, 0x12000
    buffer_load_dwordx4 v3, s[24:27], s47 offen lds
    s_add_u32 m0, s45, 10240
    s_add_u32 s47, s46, 0x14000
    buffer_load_dwordx4 v3, s[24:27], s47 offen lds
    s_add_u32 m0, s45, 11264
    s_add_u32 s47, s46, 0x16000
    buffer_load_dwordx4 v3, s[24:27], s47 offen lds
    s_add_u32 m0, s45, 12288
    s_add_u32 s47, s46, 0x18000
    buffer_load_dwordx4 v3, s[24:27], s47 offen lds
    s_add_u32 m0, s45, 13312
    s_add_u32 s47, s46, 0x1a000
    buffer_load_dwordx4 v3, s[24:27], s47 offen lds
    s_add_u32 m0, s45, 14336
    s_add_u32 s47, s46, 0x1c000
    buffer_load_dwordx4 v3, s[24:27], s47 offen lds
    s_add_u32 m0, s45, 15360
    s_add_u32 s47, s46, 0x1e000
    buffer_load_dwordx4 v3, s[24:27], s47 offen lds
    s_waitcnt vmcnt(0)
    s_barrier
    ds_read_b64_tr_b16 a[0:1], v5 offset:0
    ds_read_b64_tr_b16 a[2:3], v5 offset:4096
    ds_read_b64_tr_b16 a[4:5], v5 offset:32
    ds_read_b64_tr_b16 a[6:7], v5 offset:4128
    ds_read_b64_tr_b16 a[8:9], v5 offset:8192
    ds_read_b64_tr_b16 a[10:11], v5 offset:12288
    ds_read_b64_tr_b16 a[12:13], v5 offset:8224
    ds_read_b64_tr_b16 a[14:15], v5 offset:12320
    s_waitcnt lgkmcnt(0)
    ds_read_b64_tr_b16 a[16:17], v5 offset:16384
    ds_read_b64_tr_b16 a[18:19], v5 offset:20480
    ds_read_b64_tr_b16 a[20:21], v5 offset:16416
    ds_read_b64_tr_b16 a[22:23], v5 offset:20512
    ds_read_b64_tr_b16 a[24:25], v5 offset:24576
    ds_read_b64_tr_b16 a[26:27], v5 offset:28672
    ds_read_b64_tr_b16 a[28:29], v5 offset:24608
    ds_read_b64_tr_b16 a[30:31], v5 offset:28704
    s_waitcnt lgkmcnt(0)
    ds_read_b64_tr_b16 a[32:33], v5 offset:32768
    ds_read_b64_tr_b16 a[34:35], v5 offset:36864
    ds_read_b64_tr_b16 a[36:37], v5 offset:32800
    ds_read_b64_tr_b16 a[38:39], v5 offset:36896
    ds_read_b64_tr_b16 a[40:41], v5 offset:40960
    ds_read_b64_tr_b16 a[42:43], v5 offset:45056
    ds_read_b64_tr_b16 a[44:45], v5 offset:40992
    ds_read_b64_tr_b16 a[46:47], v5 offset:45088
    s_waitcnt lgkmcnt(0)
    ds_read_b64_tr_b16 a[48:49], v5 offset:49152
    ds_read_b64_tr_b16 a[50:51], v5 offset:53248
    ds_read_b64_tr_b16 a[52:53], v5 offset:49184
    ds_read_b64_tr_b16 a[54:55], v5 offset:53280
    ds_read_b64_tr_b16 a[56:57], v5 offset:57344
    ds_read_b64_tr_b16 a[58:59], v5 offset:61440
    ds_read_b64_tr_b16 a[60:61], v5 offset:57376
    ds_read_b64_tr_b16 a[62:63], v5 offset:61472
    s_waitcnt lgkmcnt(0)
    s_waitcnt lgkmcnt(0)
    s_barrier
    s_add_u32 m0, s45, 0
    s_add_u32 s47, s46, 0x80000
    buffer_load_dwordx4 v3, s[24:27], s47 offen lds
    s_add_u32 m0, s45, 1024
    s_add_u32 s47, s46, 0x82000
    buffer_load_dwordx4 v3, s[24:27], s47 offen lds
    s_add_u32 m0, s45, 2048
    s_add_u32 s47, s46, 0x84000
    buffer_load_dwordx4 v3, s[24:27], s47 offen lds
    s_add_u32 m0, s45, 3072
    s_add_u32 s47, s46, 0x86000
    buffer_load_dwordx4 v3, s[24:27], s47 offen lds
    s_add_u32 m0, s45, 4096
    s_add_u32 s47, s46, 0x88000
    buffer_load_dwordx4 v3, s[24:27], s47 offen lds
    s_add_u32 m0, s45, 5120
    s_add_u32 s47, s46, 0x8a000
    buffer_load_dwordx4 v3, s[24:27], s47 offen lds
    s_add_u32 m0, s45, 6144
    s_add_u32 s47, s46, 0x8c000
    buffer_load_dwordx4 v3, s[24:27], s47 offen lds
    s_add_u32 m0, s45, 7168
    s_add_u32 s47, s46, 0x8e000
    buffer_load_dwordx4 v3, s[24:27], s47 offen lds
    s_add_u32 m0, s45, 8192
    s_add_u32 s47, s46, 0x90000
    buffer_load_dwordx4 v3, s[24:27], s47 offen lds
    s_add_u32 m0, s45, 9216
    s_add_u32 s47, s46, 0x92000
    buffer_load_dwordx4 v3, s[24:27], s47 offen lds
    s_add_u32 m0, s45, 10240
    s_add_u32 s47, s46, 0x94000
    buffer_load_dwordx4 v3, s[24:27], s47 offen lds
    s_add_u32 m0, s45, 11264
    s_add_u32 s47, s46, 0x96000
    buffer_load_dwordx4 v3, s[24:27], s47 offen lds
    s_add_u32 m0, s45, 12288
    s_add_u32 s47, s46, 0x98000
    buffer_load_dwordx4 v3, s[24:27], s47 offen lds
    s_add_u32 m0, s45, 13312
    s_add_u32 s47, s46, 0x9a000
    buffer_load_dwordx4 v3, s[24:27], s47 offen lds
    s_add_u32 m0, s45, 14336
    s_add_u32 s47, s46, 0x9c000
    buffer_load_dwordx4 v3, s[24:27], s47 offen lds
    s_add_u32 m0, s45, 15360
    s_add_u32 s47, s46, 0x9e000
    buffer_load_dwordx4 v3, s[24:27], s47 offen lds
    s_waitcnt vmcnt(0)
    s_barrier
    ds_read_b64_tr_b16 a[64:65], v5 offset:0
    ds_read_b64_tr_b16 a[66:67], v5 offset:4096
    ds_read_b64_tr_b16 a[68:69], v5 offset:32
    ds_read_b64_tr_b16 a[70:71], v5 offset:4128
    ds_read_b64_tr_b16 a[72:73], v5 offset:8192
    ds_read_b64_tr_b16 a[74:75], v5 offset:12288
    ds_read_b64_tr_b16 a[76:77], v5 offset:8224
    ds_read_b64_tr_b16 a[78:79], v5 offset:12320
    s_waitcnt lgkmcnt(0)
    ds_read_b64_tr_b16 a[80:81], v5 offset:16384
    ds_read_b64_tr_b16 a[82:83], v5 offset:20480
    ds_read_b64_tr_b16 a[84:85], v5 offset:16416
    ds_read_b64_tr_b16 a[86:87], v5 offset:20512
    ds_read_b64_tr_b16 a[88:89], v5 offset:24576
    ds_read_b64_tr_b16 a[90:91], v5 offset:28672
    ds_read_b64_tr_b16 a[92:93], v5 offset:24608
    ds_read_b64_tr_b16 a[94:95], v5 offset:28704
    s_waitcnt lgkmcnt(0)
    ds_read_b64_tr_b16 a[96:97], v5 offset:32768
    ds_read_b64_tr_b16 a[98:99], v5 offset:36864
    ds_read_b64_tr_b16 a[100:101], v5 offset:32800
    ds_read_b64_tr_b16 a[102:103], v5 offset:36896
    ds_read_b64_tr_b16 a[104:105], v5 offset:40960
    ds_read_b64_tr_b16 a[106:107], v5 offset:45056
    ds_read_b64_tr_b16 a[108:109], v5 offset:40992
    ds_read_b64_tr_b16 a[110:111], v5 offset:45088
    s_waitcnt lgkmcnt(0)
    ds_read_b64_tr_b16 a[112:113], v5 offset:49152
    ds_read_b64_tr_b16 a[114:115], v5 offset:53248
    ds_read_b64_tr_b16 a[116:117], v5 offset:49184
    ds_read_b64_tr_b16 a[118:119], v5 offset:53280
    ds_read_b64_tr_b16 a[120:121], v5 offset:57344
    ds_read_b64_tr_b16 a[122:123], v5 offset:61440
    ds_read_b64_tr_b16 a[124:125], v5 offset:57376
    ds_read_b64_tr_b16 a[126:127], v5 offset:61472
    s_waitcnt lgkmcnt(0)
    s_waitcnt lgkmcnt(0)
    s_barrier
    v_lshlrev_b32 v2, 4, v1
    s_mul_i32 s64, s44, 8192
    s_add_u32 s46, s64, 0x5000000
    s_mul_i32 s47, s42, 65536
    s_add_u32 s46, s46, s47
    v_add_u32 v3, s46, v2
    s_mul_i32 s46, s51, 32768
    v_add_u32 v4, s46, v2
    v_and_b32 v6, 15, v1
    v_lshlrev_b32 v6, 4, v6
    v_lshrrev_b32 v7, 4, v1
    v_lshl_add_u32 v6, v7, 9, v6
    v_add_u32 v4, s46, v6
    s_lshl_b32 s46, s50, 12
    s_add_u32 s46, s46, 131072
    v_add_u32 v5, s46, v2
    v_and_b32 v7, 7, v1
    v_lshlrev_b32 v7, 9, v7
    s_lshl_b32 s46, s42, 12
    s_add_u32 s46, s46, 0x102000
    v_add_u32 v7, s46, v7
    s_lshl_b32 s46, s42, 16
    s_lshl_b32 s47, s43, 11
    s_add_u32 s46, s46, s47
    s_lshl_b32 s47, s50, 9
    s_add_u32 s46, s46, s47
    s_add_u32 s46, s46, 0x9000000
    v_and_b32 v8, 31, v1
    v_lshlrev_b32 v8, 4, v8
    v_lshrrev_b32 v9, 5, v1
    v_lshl_add_u32 v8, v9, 14, v8
    v_add_u32 v8, s46, v8
    v_add_u32 v9, 0x8000, v8
    s_lshl_b32 s52, s43, 9
    s_lshl_b32 s47, s42, 7
    s_add_u32 s52, s52, s47
    s_add_u32 s52, s52, 0x107400
    s_add_u32 s52, s52, s76
    s_mov_b32 s60, s74
    s_mul_i32 s61, s74, 262144
    s_mov_b32 s62, s74
    s_mul_i32 s63, s74, 262144
    s_mov_b32 s67, 0
    s_mov_b32 s68, 3
    s_mov_b32 s71, 0
    v_mov_b32 v15, 147456
    v_mov_b32 v14, 0
    ds_write_b32 v15, v14 offset:4
    ds_write_b32 v15, v14 offset:12
    ds_write_b32 v15, v14 offset:16
    v_mov_b32 v114, 1
    s_mov_b32 s72, 0
L_g_restart_162:
    s_cmp_lg_u32 s44, 0
    s_cbranch_scc1 L_g_nsp_163
    s_mov_b32 s70, 0
L_g_sp_169:
    s_add_u32 s54, s60, 0
    s_add_u32 s55, s54, 0
    s_and_b32 s46, s55, 3
    s_lshl_b32 s46, s46, 7
    buffer_load_dword v11, v7, s[12:15], s46 offen sc1
    s_add_u32 s55, s54, 1
    s_and_b32 s46, s55, 3
    s_lshl_b32 s46, s46, 7
    buffer_load_dword v12, v7, s[12:15], s46 offen sc1
    s_add_u32 s55, s54, 2
    s_and_b32 s46, s55, 3
    s_lshl_b32 s46, s46, 7
    buffer_load_dword v13, v7, s[12:15], s46 offen sc1
    s_waitcnt vmcnt(0)
    v_cmp_ge_u32 vcc, s60, v11
    s_add_u32 s70, s70, 1
    s_cbranch_vccz L_g_sp_169_ok
    s_sleep 3
    s_cmp_lt_u32 s70, 524288
    s_cbranch_scc1 L_g_sp_169
    s_branch L_c_done_1
L_g_sp_169_ok:
    s_mov_b32 s46, s54
    v_cmp_ge_u32 vcc, s46, v11
    s_nop 0
    s_cbranch_vccnz L_g_le_170
    s_add_u32 s46, s46, 1
    v_cmp_ge_u32 vcc, s46, v12
    s_nop 0
    s_cbranch_vccnz L_g_le_170
    s_add_u32 s46, s46, 1
    v_cmp_ge_u32 vcc, s46, v13
    s_nop 0
    s_cbranch_vccnz L_g_le_170
    s_add_u32 s46, s46, 1
L_g_le_170:
    s_min_u32 s46, s46, s75
    v_mov_b32 v11, s46
    ds_write_b32 v15, v11
L_g_nsp_163:
    s_waitcnt lgkmcnt(0)
    s_barrier
    ds_read_b32 v14, v15
    s_waitcnt lgkmcnt(0)
    v_readfirstlane_b32 s66, v14
    s_nop 3
L_g_restart_162_go:
    s_mov_b32 s69, 0
    s_cmp_gt_u32 s62, s60
    s_cbranch_scc1 L_g_nd_171
    s_cmp_ge_u32 s62, s66
    s_cbranch_scc1 L_g_nd_171
    s_add_u32 s47, s61, 4096
    s_add_u32 m0, s64, 0
    s_nop 0
    buffer_load_dwordx4 v3, s[12:15], s61 offen offset:0 sc1 lds
    buffer_load_dwordx4 v3, s[12:15], s61 offen offset:1024 sc1 lds
    buffer_load_dwordx4 v3, s[12:15], s61 offen offset:2048 sc1 lds
    buffer_load_dwordx4 v3, s[12:15], s61 offen offset:3072 sc1 lds
    s_add_u32 m0, s64, 4096
    s_nop 0
    buffer_load_dwordx4 v3, s[12:15], s47 offen offset:0 sc1 lds
    buffer_load_dwordx4 v3, s[12:15], s47 offen offset:1024 sc1 lds
    buffer_load_dwordx4 v3, s[12:15], s47 offen offset:2048 sc1 lds
    buffer_load_dwordx4 v3, s[12:15], s47 offen offset:3072 sc1 lds
    s_add_u32 s61, s61, 262144
    s_add_u32 s62, s62, 1
    s_xor_b32 s64, s64, 0x10000
    s_mov_b32 s69, 1
L_g_nd_171:
    s_cmp_eq_u32 s51, 1
    s_cbranch_scc1 L_g_g1r_164
    s_add_u32 s59, s60, 1
    s_mov_b32 s69, 0
    s_cmp_gt_u32 s62, s59
    s_cbranch_scc1 L_g_nd_172
    s_cmp_ge_u32 s62, s66
    s_cbranch_scc1 L_g_nd_172
    s_add_u32 s47, s61, 4096
    s_add_u32 m0, s64, 0
    s_nop 0
    buffer_load_dwordx4 v3, s[12:15], s61 offen offset:0 sc1 lds
    buffer_load_dwordx4 v3, s[12:15], s61 offen offset:1024 sc1 lds
    buffer_load_dwordx4 v3, s[12:15], s61 offen offset:2048 sc1 lds
    buffer_load_dwordx4 v3, s[12:15], s61 offen offset:3072 sc1 lds
    s_add_u32 m0, s64, 4096
    s_nop 0
    buffer_load_dwordx4 v3, s[12:15], s47 offen offset:0 sc1 lds
    buffer_load_dwordx4 v3, s[12:15], s47 offen offset:1024 sc1 lds
    buffer_load_dwordx4 v3, s[12:15], s47 offen offset:2048 sc1 lds
    buffer_load_dwordx4 v3, s[12:15], s47 offen offset:3072 sc1 lds
    s_add_u32 s61, s61, 262144
    s_add_u32 s62, s62, 1
    s_xor_b32 s64, s64, 0x10000
    s_mov_b32 s69, 1
L_g_nd_172:
    s_cmp_eq_u32 s69, 1
    s_cbranch_scc1 L_g_w0_173
    s_waitcnt vmcnt(0)
L_g_w0_173:
    s_waitcnt vmcnt(8)
    s_mov_b32 s65, 1
.p2align 6
L_g_loop0_165:
    s_barrier
    s_cmp_eq_u32 s65, 0
    s_cbranch_scc1 L_g_pr_174
    ds_read_b128 v[32:35], v4 offset:0
    ds_read_b128 v[36:39], v4 offset:256
    ds_read_b128 v[40:43], v4 offset:2048
    ds_read_b128 v[44:47], v4 offset:2304
    ds_read_b128 v[48:51], v4 offset:4096
    ds_read_b128 v[52:55], v4 offset:4352
    ds_read_b128 v[56:59], v4 offset:6144
    ds_read_b128 v[60:63], v4 offset:6400
    ds_read_b128 v[72:75], v4 offset:8192
    ds_read_b128 v[76:79], v4 offset:8448
    ds_read_b128 v[120:123], v4 offset:10240
    ds_read_b128 v[124:127], v4 offset:10496
L_g_pr_174:
    ds_read_b32 v14, v15
    s_cmp_lg_u32 s44, 0
    s_cbranch_scc1 L_g_nl_175
    s_add_u32 s54, s60, 1
    s_add_u32 s55, s54, 0
    s_and_b32 s46, s55, 3
    s_lshl_b32 s46, s46, 7
    buffer_load_dword v11, v7, s[12:15], s46 offen sc1
    s_add_u32 s55, s54, 1
    s_and_b32 s46, s55, 3
    s_lshl_b32 s46, s46, 7
    buffer_load_dword v12, v7, s[12:15], s46 offen sc1
    s_add_u32 s55, s54, 2
    s_and_b32 s46, s55, 3
    s_lshl_b32 s46, s46, 7
    buffer_load_dword v13, v7, s[12:15], s46 offen sc1
L_g_nl_175:
    s_setprio 2
    s_waitcnt lgkmcnt(8)
    v_mfma_f32_16x16x32_bf16 v[16:19], v[32:35], a[0:3], 0
    v_mfma_f32_16x16x32_bf16 v[20:23], v[32:35], a[4:7], 0
    ds_read_b128 v[32:35], v4 offset:12288
    v_mfma_f32_16x16x32_bf16 v[28:31], v[36:39], a[4:7], 0
    v_mfma_f32_16x16x32_bf16 v[24:27], v[36:39], a[0:3], 0
    ds_read_b128 v[36:39], v4 offset:12544
    v_mfma_f32_16x16x32_bf16 v[16:19], v[40:43], a[8:11], v[16:19]
    v_mfma_f32_16x16x32_bf16 v[20:23], v[40:43], a[12:15], v[20:23]
    ds_read_b128 v[40:43], v4 offset:14336
    v_mfma_f32_16x16x32_bf16 v[28:31], v[44:47], a[12:15], v[28:31]
    v_mfma_f32_16x16x32_bf16 v[24:27], v[44:47], a[8:11], v[24:27]
    ds_read_b128 v[44:47], v4 offset:14592
    s_waitcnt lgkmcnt(8)
    v_mfma_f32_16x16x32_bf16 v[16:19], v[48:51], a[16:19], v[16:19]
    v_mfma_f32_16x16x32_bf16 v[20:23], v[48:51], a[20:23], v[20:23]
    ds_read_b128 v[48:51], v4 offset:16384
    v_mfma_f32_16x16x32_bf16 v[28:31], v[52:55], a[20:23], v[28:31]
    v_mfma_f32_16x16x32_bf16 v[24:27], v[52:55], a[16:19], v[24:27]
    ds_read_b128 v[52:55], v4 offset:16640
    v_mfma_f32_16x16x32_bf16 v[16:19], v[56:59], a[24:27], v[16:19]
    v_mfma_f32_16x16x32_bf16 v[20:23], v[56:59], a[28:31], v[20:23]
    ds_read_b128 v[56:59], v4 offset:18432
    v_mfma_f32_16x16x32_bf16 v[28:31], v[60:63], a[28:31], v[28:31]
    v_mfma_f32_16x16x32_bf16 v[24:27], v[60:63], a[24:27], v[24:27]
    ds_read_b128 v[60:63], v4 offset:18688
    s_waitcnt lgkmcnt(8)
    v_mfma_f32_16x16x32_bf16 v[16:19], v[72:75], a[32:35], v[16:19]
    v_mfma_f32_16x16x32_bf16 v[20:23], v[72:75], a[36:39], v[20:23]
    ds_read_b128 v[72:75], v4 offset:20480
    v_mfma_f32_16x16x32_bf16 v[28:31], v[76:79], a[36:39], v[28:31]
    v_mfma_f32_16x16x32_bf16 v[24:27], v[76:79], a[32:35], v[24:27]
    ds_read_b128 v[76:79], v4 offset:20736
    v_mfma_f32_16x16x32_bf16 v[16:19], v[120:123], a[40:43], v[16:19]
    v_mfma_f32_16x16x32_bf16 v[20:23], v[120:123], a[44:47], v[20:23]
    ds_read_b128 v[120:123], v4 offset:22528
    v_mfma_f32_16x16x32_bf16 v[28:31], v[124:127], a[44:47], v[28:31]
    v_mfma_f32_16x16x32_bf16 v[24:27], v[124:127], a[40:43], v[24:27]
    ds_read_b128 v[124:127], v4 offset:22784
    s_waitcnt lgkmcnt(8)
    v_mfma_f32_16x16x32_bf16 v[16:19], v[32:35], a[48:51], v[16:19]
    v_mfma_f32_16x16x32_bf16 v[20:23], v[32:35], a[52:55], v[20:23]
    ds_read_b128 v[32:35], v4 offset:24576
    v_mfma_f32_16x16x32_bf16 v[28:31], v[36:39], a[52:55], v[28:31]
    v_mfma_f32_16x16x32_bf16 v[24:27], v[36:39], a[48:51], v[24:27]
    ds_read_b128 v[36:39], v4 offset:24832
    v_mfma_f32_16x16x32_bf16 v[16:19], v[40:43], a[56:59], v[16:19]
    v_mfma_f32_16x16x32_bf16 v[20:23], v[40:43], a[60:63], v[20:23]
    ds_read_b128 v[40:43], v4 offset:26624
    v_mfma_f32_16x16x32_bf16 v[28:31], v[44:47], a[60:63], v[28:31]
    v_mfma_f32_16x16x32_bf16 v[24:27], v[44:47], a[56:59], v[24:27]
    ds_read_b128 v[44:47], v4 offset:26880
    s_waitcnt lgkmcnt(8)
    v_mfma_f32_16x16x32_bf16 v[16:19], v[48:51], a[64:67], v[16:19]
    v_mfma_f32_16x16x32_bf16 v[20:23], v[48:51], a[68:71], v[20:23]
    ds_read_b128 v[48:51], v4 offset:28672
    v_mfma_f32_16x16x32_bf16 v[28:31], v[52:55], a[68:71], v[28:31]
    v_mfma_f32_16x16x32_bf16 v[24:27], v[52:55], a[64:67], v[24:27]
    ds_read_b128 v[52:55], v4 offset:28928
    v_mfma_f32_16x16x32_bf16 v[16:19], v[56:59], a[72:75], v[16:19]
    v_mfma_f32_16x16x32_bf16 v[20:23], v[56:59], a[76:79], v[20:23]
    ds_read_b128 v[56:59], v4 offset:30720
    v_mfma_f32_16x16x32_bf16 v[28:31], v[60:63], a[76:79], v[28:31]
    v_mfma_f32_16x16x32_bf16 v[24:27], v[60:63], a[72:75], v[24:27]
    ds_read_b128 v[60:63], v4 offset:30976
    s_waitcnt lgkmcnt(8)
    v_mfma_f32_16x16x32_bf16 v[16:19], v[72:75], a[80:83], v[16:19]
    v_mfma_f32_16x16x32_bf16 v[20:23], v[72:75], a[84:87], v[20:23]
    v_mfma_f32_16x16x32_bf16 v[28:31], v[76:79], a[84:87], v[28:31]
    v_mfma_f32_16x16x32_bf16 v[24:27], v[76:79], a[80:83], v[24:27]
    v_mfma_f32_16x16x32_bf16 v[16:19], v[120:123], a[88:91], v[16:19]
    v_mfma_f32_16x16x32_bf16 v[20:23], v[120:123], a[92:95], v[20:23]
    v_mfma_f32_16x16x32_bf16 v[28:31], v[124:127], a[92:95], v[28:31]
    v_mfma_f32_16x16x32_bf16 v[24:27], v[124:127], a[88:91], v[24:27]
    s_waitcnt lgkmcnt(4)
    v_mfma_f32_16x16x32_bf16 v[16:19], v[32:35], a[96:99], v[16:19]
    v_mfma_f32_16x16x32_bf16 v[20:23], v[32:35], a[100:103], v[20:23]
    v_mfma_f32_16x16x32_bf16 v[28:31], v[36:39], a[100:103], v[28:31]
    v_mfma_f32_16x16x32_bf16 v[24:27], v[36:39], a[96:99], v[24:27]
    v_mfma_f32_16x16x32_bf16 v[16:19], v[40:43], a[104:107], v[16:19]
    v_mfma_f32_16x16x32_bf16 v[20:23], v[40:43], a[108:111], v[20:23]
    v_mfma_f32_16x16x32_bf16 v[28:31], v[44:47], a[108:111], v[28:31]
    v_mfma_f32_16x16x32_bf16 v[24:27], v[44:47], a[104:107], v[24:27]
    s_waitcnt lgkmcnt(0)
    v_mfma_f32_16x16x32_bf16 v[16:19], v[48:51], a[112:115], v[16:19]
    v_mfma_f32_16x16x32_bf16 v[20:23], v[48:51], a[116:119], v[20:23]
    v_mfma_f32_16x16x32_bf16 v[28:31], v[52:55], a[116:119], v[28:31]
    v_mfma_f32_16x16x32_bf16 v[24:27], v[52:55], a[112:115], v[24:27]
    v_mfma_f32_16x16x32_bf16 v[16:19], v[56:59], a[120:123], v[16:19]
    v_mfma_f32_16x16x32_bf16 v[20:23], v[56:59], a[124:127], v[20:23]
    v_mfma_f32_16x16x32_bf16 v[28:31], v[60:63], a[124:127], v[28:31]
    v_mfma_f32_16x16x32_bf16 v[24:27], v[60:63], a[120:123], v[24:27]
    v_xor_b32 v4, 0x10000, v4
    s_setprio 0
    s_waitcnt vmcnt(0)
    v_readfirstlane_b32 s66, v14
    s_barrier
    s_nop 6
    ds_write_b128 v5, v[16:19] offset:0
    ds_write_b128 v5, v[20:23] offset:1024
    ds_write_b128 v5, v[24:27] offset:2048
    ds_write_b128 v5, v[28:31] offset:3072
    s_cmp_lg_u32 s44, 0
    s_cbranch_scc1 L_g_ne_176
    s_mov_b32 s46, s54
    v_cmp_ge_u32 vcc, s46, v11
    s_nop 0
    s_cbranch_vccnz L_g_le_179
    s_add_u32 s46, s46, 1
    v_cmp_ge_u32 vcc, s46, v12
    s_nop 0
    s_cbranch_vccnz L_g_le_179
    s_add_u32 s46, s46, 1
    v_cmp_ge_u32 vcc, s46, v13
    s_nop 0
    s_cbranch_vccnz L_g_le_179
    s_add_u32 s46, s46, 1
L_g_le_179:
    s_min_u32 s46, s46, s75
    v_mov_b32 v11, s46
    ds_write_b32 v15, v11
L_g_ne_176:
    s_add_u32 s60, s60, 1
    s_mov_b32 s69, 0
    s_cmp_gt_u32 s62, s60
    s_cbranch_scc1 L_g_nd_180
    s_cmp_ge_u32 s62, s66
    s_cbranch_scc1 L_g_nd_180
    s_add_u32 s47, s61, 4096
    s_add_u32 m0, s64, 0
    s_nop 0
    buffer_load_dwordx4 v3, s[12:15], s61 offen offset:0 sc1 lds
    buffer_load_dwordx4 v3, s[12:15], s61 offen offset:1024 sc1 lds
    buffer_load_dwordx4 v3, s[12:15], s61 offen offset:2048 sc1 lds
    buffer_load_dwordx4 v3, s[12:15], s61 offen offset:3072 sc1 lds
    s_add_u32 m0, s64, 4096
    s_nop 0
    buffer_load_dwordx4 v3, s[12:15], s47 offen offset:0 sc1 lds
    buffer_load_dwordx4 v3, s[12:15], s47 offen offset:1024 sc1 lds
    buffer_load_dwordx4 v3, s[12:15], s47 offen offset:2048 sc1 lds
    buffer_load_dwordx4 v3, s[12:15], s47 offen offset:3072 sc1 lds
    s_add_u32 s61, s61, 262144
    s_add_u32 s62, s62, 1
    s_xor_b32 s64, s64, 0x10000
    s_mov_b32 s69, 1
L_g_nd_180:
    s_mov_b32 s65, s69
    s_add_u32 s59, s60, 1
    s_mov_b32 s69, 0
    s_cmp_gt_u32 s62, s59
    s_cbranch_scc1 L_g_nd_181
    s_cmp_ge_u32 s62, s66
    s_cbranch_scc1 L_g_nd_181
    s_add_u32 s47, s61, 4096
    s_add_u32 m0, s64, 0
    s_nop 0
    buffer_load_dwordx4 v3, s[12:15], s61 offen offset:0 sc1 lds
    buffer_load_dwordx4 v3, s[12:15], s61 offen offset:1024 sc1 lds
    buffer_load_dwordx4 v3, s[12:15], s61 offen offset:2048 sc1 lds
    buffer_load_dwordx4 v3, s[12:15], s61 offen offset:3072 sc1 lds
    s_add_u32 m0, s64, 4096
    s_nop 0
    buffer_load_dwordx4 v3, s[12:15], s47 offen offset:0 sc1 lds
    buffer_load_dwordx4 v3, s[12:15], s47 offen offset:1024 sc1 lds
    buffer_load_dwordx4 v3, s[12:15], s47 offen offset:2048 sc1 lds
    buffer_load_dwordx4 v3, s[12:15], s47 offen offset:3072 sc1 lds
    s_add_u32 s61, s61, 262144
    s_add_u32 s62, s62, 1
    s_xor_b32 s64, s64, 0x10000
    s_mov_b32 s69, 1
L_g_nd_181:
    s_cmp_le_u32 s66, s60
    s_cbranch_scc1 L_g_ex0_178
    s_cmp_eq_u32 s65, 0
    s_cbranch_scc1 L_g_nw_177
    s_waitcnt vmcnt(0) lgkmcnt(0)
    s_branch L_g_loop0_165
L_g_nw_177:
    ds_read_b128 v[32:35], v4 offset:0
    ds_read_b128 v[36:39], v4 offset:256
    ds_read_b128 v[40:43], v4 offset:2048
    ds_read_b128 v[44:47], v4 offset:2304
    ds_read_b128 v[48:51], v4 offset:4096
    ds_read_b128 v[52:55], v4 offset:4352
    ds_read_b128 v[56:59], v4 offset:6144
    ds_read_b128 v[60:63], v4 offset:6400
    ds_read_b128 v[72:75], v4 offset:8192
    ds_read_b128 v[76:79], v4 offset:8448
    ds_read_b128 v[120:123], v4 offset:10240
    ds_read_b128 v[124:127], v4 offset:10496
    s_waitcnt lgkmcnt(12)
    s_branch L_g_loop0_165
L_g_ex0_178:
    s_cmp_lg_u32 s44, 0
    s_cbranch_scc1 L_g_ex0_178_n
    s_sleep 6
    s_add_u32 s54, s60, 0
    s_add_u32 s55, s54, 0
    s_and_b32 s46, s55, 3
    s_lshl_b32 s46, s46, 7
    buffer_load_dword v11, v7, s[12:15], s46 offen sc1
    s_add_u32 s55, s54, 1
    s_and_b32 s46, s55, 3
    s_lshl_b32 s46, s46, 7
    buffer_load_dword v12, v7, s[12:15], s46 offen sc1
    s_add_u32 s55, s54, 2
    s_and_b32 s46, s55, 3
    s_lshl_b32 s46, s46, 7
    buffer_load_dword v13, v7, s[12:15], s46 offen sc1
    s_waitcnt vmcnt(0)
    s_mov_b32 s46, s54
    v_cmp_ge_u32 vcc, s46, v11
    s_nop 0
    s_cbranch_vccnz L_g_le_182
    s_add_u32 s46, s46, 1
    v_cmp_ge_u32 vcc, s46, v12
    s_nop 0
    s_cbranch_vccnz L_g_le_182
    s_add_u32 s46, s46, 1
    v_cmp_ge_u32 vcc, s46, v13
    s_nop 0
    s_cbranch_vccnz L_g_le_182
    s_add_u32 s46, s46, 1
L_g_le_182:
    s_min_u32 s46, s46, s75
    v_mov_b32 v11, s46
    ds_write_b32 v15, v11
L_g_ex0_178_n:
    s_waitcnt lgkmcnt(0)
    s_barrier
    ds_read_b32 v14, v15
    s_waitcnt lgkmcnt(0)
    v_readfirstlane_b32 s66, v14
    s_barrier
    s_cmp_gt_u32 s66, s60
    s_cbranch_scc1 L_g_restart_162_go
    s_branch L_g_tail_167
L_g_g1r_164:
    s_mov_b32 s65, 1
    s_branch L_g_loop1_166_e
.p2align 6
L_g_loop1_166:
    s_mov_b32 s65, 0
L_g_loop1_166_e:
    s_barrier
    ds_read_b32 v14, v15
    s_bitcmp1_b32 s67, 1
    s_cbranch_scc0 L_g_nfl_183
    s_sub_u32 s59, s60, 2
    s_cmp_lg_u32 s44, 4
    s_cbranch_scc1 L_sf_188
    v_mov_b32 v10, s59
    v_add_u32 v10, 1, v10
    v_mov_b32 v11, 0
    s_mov_b64 exec, 1
    buffer_store_dword v10, v11, s[12:15], s52 offen sc1
    s_mov_b64 exec, -1
L_sf_188:
L_g_nfl_183:
    s_cmp_eq_u32 s71, 0
    s_cbranch_scc1 L_g_nfl_183_d
    v_mov_b32 v10, 1
    s_mov_b64 exec, 1
    s_waitcnt vmcnt(0)
    ds_add_rtn_u32 v10, v15, v10 offset:4
    s_waitcnt lgkmcnt(0)
    v_readfirstlane_b32 s46, v10
    s_mov_b64 exec, -1
    s_mov_b32 s71, 0
    s_sub_u32 s59, s60, 1
    s_cmp_lg_u32 s46, s68
    s_cbranch_scc1 L_g_df_189
    v_mov_b32 v10, s59
    v_add_u32 v10, 1, v10
    v_mov_b32 v11, 0
    s_mov_b64 exec, 1
    buffer_store_dword v10, v11, s[12:15], s52 offen sc1
    s_mov_b64 exec, -1
L_sf_190:
L_g_df_189:
    s_add_u32 s68, s68, 4
    s_mov_b32 s65, 2
L_g_nfl_183_d:
    s_waitcnt lgkmcnt(0)
    v_readfirstlane_b32 s66, v14
    s_nop 3
    s_mov_b32 s69, 0
    s_cmp_gt_u32 s62, s60
    s_cbranch_scc1 L_g_nd_191
    s_cmp_ge_u32 s62, s66
    s_cbranch_scc1 L_g_nd_191
    s_add_u32 s47, s61, 4096
    s_add_u32 m0, s64, 0
    s_nop 0
    buffer_load_dwordx4 v3, s[12:15], s61 offen offset:0 sc1 lds
    buffer_load_dwordx4 v3, s[12:15], s61 offen offset:1024 sc1 lds
    buffer_load_dwordx4 v3, s[12:15], s61 offen offset:2048 sc1 lds
    buffer_load_dwordx4 v3, s[12:15], s61 offen offset:3072 sc1 lds
    s_add_u32 m0, s64, 4096
    s_nop 0
    buffer_load_dwordx4 v3, s[12:15], s47 offen offset:0 sc1 lds
    buffer_load_dwordx4 v3, s[12:15], s47 offen offset:1024 sc1 lds
    buffer_load_dwordx4 v3, s[12:15], s47 offen offset:2048 sc1 lds
    buffer_load_dwordx4 v3, s[12:15], s47 offen offset:3072 sc1 lds
    s_add_u32 s61, s61, 262144
    s_add_u32 s62, s62, 1
    s_xor_b32 s64, s64, 0x10000
    s_mov_b32 s69, 1
L_g_nd_191:
    s_or_b32 s65, s65, s69
    s_add_u32 s59, s60, 1
    s_mov_b32 s69, 0
    s_cmp_gt_u32 s62, s59
    s_cbranch_scc1 L_g_nd_192
    s_cmp_ge_u32 s62, s66
    s_cbranch_scc1 L_g_nd_192
    s_add_u32 s47, s61, 4096
    s_add_u32 m0, s64, 0
    s_nop 0
    buffer_load_dwordx4 v3, s[12:15], s61 offen offset:0 sc1 lds
    buffer_load_dwordx4 v3, s[12:15], s61 offen offset:1024 sc1 lds
    buffer_load_dwordx4 v3, s[12:15], s61 offen offset:2048 sc1 lds
    buffer_load_dwordx4 v3, s[12:15], s61 offen offset:3072 sc1 lds
    s_add_u32 m0, s64, 4096
    s_nop 0
    buffer_load_dwordx4 v3, s[12:15], s47 offen offset:0 sc1 lds
    buffer_load_dwordx4 v3, s[12:15], s47 offen offset:1024 sc1 lds
    buffer_load_dwordx4 v3, s[12:15], s47 offen offset:2048 sc1 lds
    buffer_load_dwordx4 v3, s[12:15], s47 offen offset:3072 sc1 lds
    s_add_u32 s61, s61, 262144
    s_add_u32 s62, s62, 1
    s_xor_b32 s64, s64, 0x10000
    s_mov_b32 s69, 1
L_g_nd_192:
    s_bitcmp1_b32 s67, 0
    s_cbranch_scc0 L_g_nep_184
    ds_read_b128 v[80:83], v5 offset:0
    ds_read_b128 v[84:87], v5 offset:1024
    ds_read_b128 v[88:91], v5 offset:2048
    ds_read_b128 v[92:95], v5 offset:3072
    s_nop 7
    s_waitcnt lgkmcnt(3)
    v_add_f32 v80, v80, v16
    v_add_f32 v81, v81, v17
    v_add_f32 v82, v82, v18
    v_add_f32 v83, v83, v19
    s_waitcnt lgkmcnt(2)
    v_add_f32 v84, v84, v20
    v_add_f32 v85, v85, v21
    v_add_f32 v86, v86, v22
    v_add_f32 v87, v87, v23
    s_waitcnt lgkmcnt(1)
    v_add_f32 v88, v88, v24
    v_add_f32 v89, v89, v25
    v_add_f32 v90, v90, v26
    v_add_f32 v91, v91, v27
    s_waitcnt lgkmcnt(0)
    v_add_f32 v92, v92, v28
    v_add_f32 v93, v93, v29
    v_add_f32 v94, v94, v30
    v_add_f32 v95, v95, v31
    v_cvt_pk_bf16_f32 v104, v80, v81
    v_cvt_pk_bf16_f32 v105, v82, v83
    v_cvt_pk_bf16_f32 v106, v84, v85
    v_cvt_pk_bf16_f32 v107, v86, v87
    s_nop 1
    v_permlane16_swap_b32 v104, v106
    v_permlane16_swap_b32 v105, v107
    buffer_store_dwordx4 v[104:107], v8, s[12:15], s63 offen sc1
    v_cvt_pk_bf16_f32 v108, v88, v89
    v_cvt_pk_bf16_f32 v109, v90, v91
    v_cvt_pk_bf16_f32 v110, v92, v93
    v_cvt_pk_bf16_f32 v111, v94, v95
    s_nop 1
    v_permlane16_swap_b32 v108, v110
    v_permlane16_swap_b32 v109, v111
    buffer_store_dwordx4 v[108:111], v9, s[12:15], s63 offen sc1
    s_add_u32 s63, s63, 262144
L_g_nep_184:
    s_cmp_eq_u32 s65, 0
    s_cbranch_scc1 L_g_nw1_185
    s_cmp_eq_u32 s65, 2
    s_cbranch_scc1 L_g_nw1_185_w
    s_waitcnt vmcnt(0)
L_g_nw1_185_w:
    s_barrier
    ds_read_b128 v[32:35], v4 offset:0
    ds_read_b128 v[36:39], v4 offset:256
    ds_read_b128 v[40:43], v4 offset:2048
    ds_read_b128 v[44:47], v4 offset:2304
    ds_read_b128 v[48:51], v4 offset:4096
    ds_read_b128 v[52:55], v4 offset:4352
    ds_read_b128 v[56:59], v4 offset:6144
    ds_read_b128 v[60:63], v4 offset:6400
    ds_read_b128 v[72:75], v4 offset:8192
    ds_read_b128 v[76:79], v4 offset:8448
    ds_read_b128 v[120:123], v4 offset:10240
    ds_read_b128 v[124:127], v4 offset:10496
    s_branch L_g_jn_187
L_g_nw1_185:
    ds_read_b128 v[32:35], v4 offset:0
    ds_read_b128 v[36:39], v4 offset:256
    ds_read_b128 v[40:43], v4 offset:2048
    ds_read_b128 v[44:47], v4 offset:2304
    ds_read_b128 v[48:51], v4 offset:4096
    ds_read_b128 v[52:55], v4 offset:4352
    ds_read_b128 v[56:59], v4 offset:6144
    ds_read_b128 v[60:63], v4 offset:6400
    ds_read_b128 v[72:75], v4 offset:8192
    ds_read_b128 v[76:79], v4 offset:8448
    ds_read_b128 v[120:123], v4 offset:10240
    ds_read_b128 v[124:127], v4 offset:10496
    s_barrier
L_g_jn_187:
    s_setprio 1
    s_waitcnt lgkmcnt(8)
    v_mfma_f32_16x16x32_bf16 v[16:19], v[32:35], a[0:3], 0
    v_mfma_f32_16x16x32_bf16 v[20:23], v[32:35], a[4:7], 0
    ds_read_b128 v[32:35], v4 offset:12288
    v_mfma_f32_16x16x32_bf16 v[28:31], v[36:39], a[4:7], 0
    v_mfma_f32_16x16x32_bf16 v[24:27], v[36:39], a[0:3], 0
    ds_read_b128 v[36:39], v4 offset:12544
    v_mfma_f32_16x16x32_bf16 v[16:19], v[40:43], a[8:11], v[16:19]
    v_mfma_f32_16x16x32_bf16 v[20:23], v[40:43], a[12:15], v[20:23]
    ds_read_b128 v[40:43], v4 offset:14336
    v_mfma_f32_16x16x32_bf16 v[28:31], v[44:47], a[12:15], v[28:31]
    v_mfma_f32_16x16x32_bf16 v[24:27], v[44:47], a[8:11], v[24:27]
    ds_read_b128 v[44:47], v4 offset:14592
    s_waitcnt lgkmcnt(8)
    v_mfma_f32_16x16x32_bf16 v[16:19], v[48:51], a[16:19], v[16:19]
    v_mfma_f32_16x16x32_bf16 v[20:23], v[48:51], a[20:23], v[20:23]
    ds_read_b128 v[48:51], v4 offset:16384
    v_mfma_f32_16x16x32_bf16 v[28:31], v[52:55], a[20:23], v[28:31]
    v_mfma_f32_16x16x32_bf16 v[24:27], v[52:55], a[16:19], v[24:27]
    ds_read_b128 v[52:55], v4 offset:16640
    v_mfma_f32_16x16x32_bf16 v[16:19], v[56:59], a[24:27], v[16:19]
    v_mfma_f32_16x16x32_bf16 v[20:23], v[56:59], a[28:31], v[20:23]
    ds_read_b128 v[56:59], v4 offset:18432
    v_mfma_f32_16x16x32_bf16 v[28:31], v[60:63], a[28:31], v[28:31]
    v_mfma_f32_16x16x32_bf16 v[24:27], v[60:63], a[24:27], v[24:27]
    ds_read_b128 v[60:63], v4 offset:18688
    s_waitcnt lgkmcnt(8)
    v_mfma_f32_16x16x32_bf16 v[16:19], v[72:75], a[32:35], v[16:19]
    v_mfma_f32_16x16x32_bf16 v[20:23], v[72:75], a[36:39], v[20:23]
    ds_read_b128 v[72:75], v4 offset:20480
    v_mfma_f32_16x16x32_bf16 v[28:31], v[76:79], a[36:39], v[28:31]
    v_mfma_f32_16x16x32_bf16 v[24:27], v[76:79], a[32:35], v[24:27]
    ds_read_b128 v[76:79], v4 offset:20736
    v_mfma_f32_16x16x32_bf16 v[16:19], v[120:123], a[40:43], v[16:19]
    v_mfma_f32_16x16x32_bf16 v[20:23], v[120:123], a[44:47], v[20:23]
    ds_read_b128 v[120:123], v4 offset:22528
    v_mfma_f32_16x16x32_bf16 v[28:31], v[124:127], a[44:47], v[28:31]
    v_mfma_f32_16x16x32_bf16 v[24:27], v[124:127], a[40:43], v[24:27]
    ds_read_b128 v[124:127], v4 offset:22784
    s_waitcnt lgkmcnt(8)
    v_mfma_f32_16x16x32_bf16 v[16:19], v[32:35], a[48:51], v[16:19]
    v_mfma_f32_16x16x32_bf16 v[20:23], v[32:35], a[52:55], v[20:23]
    ds_read_b128 v[32:35], v4 offset:24576
    v_mfma_f32_16x16x32_bf16 v[28:31], v[36:39], a[52:55], v[28:31]
    v_mfma_f32_16x16x32_bf16 v[24:27], v[36:39], a[48:51], v[24:27]
    ds_read_b128 v[36:39], v4 offset:24832
    v_mfma_f32_16x16x32_bf16 v[16:19], v[40:43], a[56:59], v[16:19]
    v_mfma_f32_16x16x32_bf16 v[20:23], v[40:43], a[60:63], v[20:23]
    ds_read_b128 v[40:43], v4 offset:26624
    v_mfma_f32_16x16x32_bf16 v[28:31], v[44:47], a[60:63], v[28:31]
    v_mfma_f32_16x16x32_bf16 v[24:27], v[44:47], a[56:59], v[24:27]
    ds_read_b128 v[44:47], v4 offset:26880
    s_waitcnt lgkmcnt(8)
    v_mfma_f32_16x16x32_bf16 v[16:19], v[48:51], a[64:67], v[16:19]
    v_mfma_f32_16x16x32_bf16 v[20:23], v[48:51], a[68:71], v[20:23]
    ds_read_b128 v[48:51], v4 offset:28672
    v_mfma_f32_16x16x32_bf16 v[28:31], v[52:55], a[68:71], v[28:31]
    v_mfma_f32_16x16x32_bf16 v[24:27], v[52:55], a[64:67], v[24:27]
    ds_read_b128 v[52:55], v4 offset:28928
    v_mfma_f32_16x16x32_bf16 v[16:19], v[56:59], a[72:75], v[16:19]
    v_mfma_f32_16x16x32_bf16 v[20:23], v[56:59], a[76:79], v[20:23]
    ds_read_b128 v[56:59], v4 offset:30720
    v_mfma_f32_16x16x32_bf16 v[28:31], v[60:63], a[76:79], v[28:31]
    v_mfma_f32_16x16x32_bf16 v[24:27], v[60:63], a[72:75], v[24:27]
    ds_read_b128 v[60:63], v4 offset:30976
    s_waitcnt lgkmcnt(8)
    v_mfma_f32_16x16x32_bf16 v[16:19], v[72:75], a[80:83], v[16:19]
    v_mfma_f32_16x16x32_bf16 v[20:23], v[72:75], a[84:87], v[20:23]
    v_mfma_f32_16x16x32_bf16 v[28:31], v[76:79], a[84:87], v[28:31]
    v_mfma_f32_16x16x32_bf16 v[24:27], v[76:79], a[80:83], v[24:27]
    v_mfma_f32_16x16x32_bf16 v[16:19], v[120:123], a[88:91], v[16:19]
    v_mfma_f32_16x16x32_bf16 v[20:23], v[120:123], a[92:95], v[20:23]
    v_mfma_f32_16x16x32_bf16 v[28:31], v[124:127], a[92:95], v[28:31]
    v_mfma_f32_16x16x32_bf16 v[24:27], v[124:127], a[88:91], v[24:27]
    s_waitcnt lgkmcnt(4)
    v_mfma_f32_16x16x32_bf16 v[16:19], v[32:35], a[96:99], v[16:19]
    v_mfma_f32_16x16x32_bf16 v[20:23], v[32:35], a[100:103], v[20:23]
    v_mfma_f32_16x16x32_bf16 v[28:31], v[36:39], a[100:103], v[28:31]
    v_mfma_f32_16x16x32_bf16 v[24:27], v[36:39], a[96:99], v[24:27]
    v_mfma_f32_16x16x32_bf16 v[16:19], v[40:43], a[104:107], v[16:19]
    v_mfma_f32_16x16x32_bf16 v[20:23], v[40:43], a[108:111], v[20:23]
    v_mfma_f32_16x16x32_bf16 v[28:31], v[44:47], a[108:111], v[28:31]
    v_mfma_f32_16x16x32_bf16 v[24:27], v[44:47], a[104:107], v[24:27]
    s_waitcnt lgkmcnt(0)
    v_mfma_f32_16x16x32_bf16 v[16:19], v[48:51], a[112:115], v[16:19]
    v_mfma_f32_16x16x32_bf16 v[20:23], v[48:51], a[116:119], v[20:23]
    v_mfma_f32_16x16x32_bf16 v[28:31], v[52:55], a[116:119], v[28:31]
    v_mfma_f32_16x16x32_bf16 v[24:27], v[52:55], a[112:115], v[24:27]
    v_mfma_f32_16x16x32_bf16 v[16:19], v[56:59], a[120:123], v[16:19]
    v_mfma_f32_16x16x32_bf16 v[20:23], v[56:59], a[124:127], v[20:23]
    v_mfma_f32_16x16x32_bf16 v[28:31], v[60:63], a[124:127], v[28:31]
    v_mfma_f32_16x16x32_bf16 v[24:27], v[60:63], a[120:123], v[24:27]
    v_xor_b32 v4, 0x10000, v4
    s_setprio 0
    s_waitcnt vmcnt(0)
    s_lshl_b32 s67, s67, 1
    s_or_b32 s67, s67, 1
    s_add_u32 s60, s60, 1
    s_cmp_gt_u32 s66, s60
    s_cbranch_scc1 L_g_loop1_166
    s_barrier
    ds_read_b32 v14, v15
    s_waitcnt lgkmcnt(0)
    v_readfirstlane_b32 s66, v14
    s_barrier
    s_mov_b32 s69, 0
    s_cmp_gt_u32 s62, s60
    s_cbranch_scc1 L_g_nd_193
    s_cmp_ge_u32 s62, s66
    s_cbranch_scc1 L_g_nd_193
    s_add_u32 s47, s61, 4096
    s_add_u32 m0, s64, 0
    s_nop 0
    buffer_load_dwordx4 v3, s[12:15], s61 offen offset:0 sc1 lds
    buffer_load_dwordx4 v3, s[12:15], s61 offen offset:1024 sc1 lds
    buffer_load_dwordx4 v3, s[12:15], s61 offen offset:2048 sc1 lds
    buffer_load_dwordx4 v3, s[12:15], s61 offen offset:3072 sc1 lds
    s_add_u32 m0, s64, 4096
    s_nop 0
    buffer_load_dwordx4 v3, s[12:15], s47 offen offset:0 sc1 lds
    buffer_load_dwordx4 v3, s[12:15], s47 offen offset:1024 sc1 lds
    buffer_load_dwordx4 v3, s[12:15], s47 offen offset:2048 sc1 lds
    buffer_load_dwordx4 v3, s[12:15], s47 offen offset:3072 sc1 lds
    s_add_u32 s61, s61, 262144
    s_add_u32 s62, s62, 1
    s_xor_b32 s64, s64, 0x10000
    s_mov_b32 s69, 1
L_g_nd_193:
    s_sub_u32 s59, s60, 1
    ds_read_b128 v[80:83], v5 offset:0
    ds_read_b128 v[84:87], v5 offset:1024
    ds_read_b128 v[88:91], v5 offset:2048
    ds_read_b128 v[92:95], v5 offset:3072
    s_nop 7
    s_waitcnt lgkmcnt(3)
    v_add_f32 v80, v80, v16
    v_add_f32 v81, v81, v17
    v_add_f32 v82, v82, v18
    v_add_f32 v83, v83, v19
    s_waitcnt lgkmcnt(2)
    v_add_f32 v84, v84, v20
    v_add_f32 v85, v85, v21
    v_add_f32 v86, v86, v22
    v_add_f32 v87, v87, v23
    s_waitcnt lgkmcnt(1)
    v_add_f32 v88, v88, v24
    v_add_f32 v89, v89, v25
    v_add_f32 v90, v90, v26
    v_add_f32 v91, v91, v27
    s_waitcnt lgkmcnt(0)
    v_add_f32 v92, v92, v28
    v_add_f32 v93, v93, v29
    v_add_f32 v94, v94, v30
    v_add_f32 v95, v95, v31
    v_cvt_pk_bf16_f32 v104, v80, v81
    v_cvt_pk_bf16_f32 v105, v82, v83
    v_cvt_pk_bf16_f32 v106, v84, v85
    v_cvt_pk_bf16_f32 v107, v86, v87
    s_nop 1
    v_permlane16_swap_b32 v104, v106
    v_permlane16_swap_b32 v105, v107
    buffer_store_dwordx4 v[104:107], v8, s[12:15], s63 offen sc1
    v_cvt_pk_bf16_f32 v108, v88, v89
    v_cvt_pk_bf16_f32 v109, v90, v91
    v_cvt_pk_bf16_f32 v110, v92, v93
    v_cvt_pk_bf16_f32 v111, v94, v95
    s_nop 1
    v_permlane16_swap_b32 v108, v110
    v_permlane16_swap_b32 v109, v111
    buffer_store_dwordx4 v[108:111], v9, s[12:15], s63 offen sc1
    s_add_u32 s63, s63, 262144
    s_mov_b32 s67, 0
    s_mov_b32 s71, 1
    s_cmp_gt_u32 s66, s60
    s_cbranch_scc1 L_g_g1r_164
    v_mov_b32 v10, 1
    s_mov_b64 exec, 1
    s_waitcnt vmcnt(0)
    ds_add_rtn_u32 v10, v15, v10 offset:4
    s_waitcnt lgkmcnt(0)
    v_readfirstlane_b32 s46, v10
    s_mov_b64 exec, -1
    s_mov_b32 s71, 0
    s_sub_u32 s59, s60, 1
    s_cmp_lg_u32 s46, s68
    s_cbranch_scc1 L_g_df_194
    v_mov_b32 v10, s59
    v_add_u32 v10, 1, v10
    v_mov_b32 v11, 0
    s_mov_b64 exec, 1
    buffer_store_dword v10, v11, s[12:15], s52 offen sc1
    s_mov_b64 exec, -1
L_sf_195:
L_g_df_194:
    s_add_u32 s68, s68, 4
    s_cmp_gt_u32 s66, s60
    s_cbranch_scc1 L_g_g1r_164
L_g_tail_167:
    s_cmp_lt_u32 s60, s75
    s_cbranch_scc1 L_g_restart_162
    s_waitcnt vmcnt(0)
    s_barrier
    s_branch L_c_done_1
L_c_chain_8:
    v_mov_b32 v4, 0
    v_mov_b32 v5, 0
    v_mov_b32 v6, 0
    v_mov_b32 v7, 0
    v_mov_b32 v8, 0
    v_mov_b32 v9, 0
    v_mov_b32 v10, 0
    v_mov_b32 v11, 0
    v_mov_b32 v12, 0
    v_mov_b32 v13, 0
    v_mov_b32 v14, 0
    v_mov_b32 v15, 0
    v_mov_b32 v32, -1
    v_mov_b32 v33, -1
    v_mov_b32 v34, -1
    v_mov_b32 v35, -1
    v_lshlrev_b32 v2, 4, v1
    s_lshl_b32 s45, s40, 16
    s_lshl_b32 s46, s41, 12
    s_add_u32 s45, s45, s46
    s_and_b32 s46, s44, 3
    s_lshl_b32 s46, s46, 10
    s_add_u32 s45, s45, s46
    s_lshr_b32 s46, s44, 2
    s_lshl_b32 s46, s46, 19
    s_add_u32 s45, s45, s46
    s_add_u32 s45, s45, 0x7000000
    buffer_store_dwordx4 v[32:35], v2, s[12:15], s45 offen sc1
    s_lshl_b32 s45, s40, 15
    s_lshl_b32 s46, s41, 11
    s_add_u32 s45, s45, s46
    s_lshl_b32 s46, s44, 8
    s_add_u32 s45, s45, s46
    s_add_u32 s45, s45, 0x7100000
    s_mov_b64 exec, 0xffff
    buffer_store_dwordx4 v[32:35], v2, s[12:15], s45 offen sc1
    s_lshl_b32 s45, s40, 16
    s_lshl_b32 s46, s41, 8
    s_add_u32 s45, s45, s46
    s_and_b32 s46, s44, 3
    s_lshl_b32 s46, s46, 14
    s_add_u32 s45, s45, s46
    s_add_u32 s45, s45, 0x7180000
    buffer_store_dwordx4 v[32:35], v2, s[12:15], s45 offen sc1
    s_mov_b64 exec, -1
    v_lshlrev_b32 v2, 4, v1
    v_and_b32 v3, 8, v1
    v_cmp_eq_u32 vcc, 0, v3
    v_mov_b32 v3, 0xeeeeeeee
    v_mov_b32 v4, 0x44444444
    v_cndmask_b32 v3, v3, v4, vcc
    v_and_b32 v100, 15, v1
    v_lshrrev_b32 v101, 4, v1
    v_and_b32 v102, 1, v101
    v_lshrrev_b32 v103, 1, v101
    v_lshlrev_b32 v104, 2, v102
    v_lshl_add_u32 v104, v103, 1, v104
    v_and_b32 v105, 1, v1
    v_add_u32 v104, v104, v105
    v_and_b32 v106, 7, v1
    v_bfe_u32 v107, v1, 3, 1
    s_lshr_b32 s42, s41, 2
    s_and_b32 s43, s41, 3
    s_lshl_b32 s49, s40, 2
    s_add_u32 s49, s49, s42
    s_lshl_b32 s45, s44, 14
    v_lshlrev_b32 v22, 3, v101
    v_bfe_u32 v23, v1, 2, 2
    v_add_u32 v22, v22, v23
    v_and_b32 v23, 3, v1
    v_lshlrev_b32 v24, 3, v23
    v_lshl_add_u32 v20, v22, 6, v24
    v_lshl_add_u32 v21, v22, 7, v24
    v_lshrrev_b32 v22, 2, v1
    v_lshlrev_b32 v23, 4, v23
    v_lshl_add_u32 v24, v22, 13, v23
    v_lshrrev_b32 v22, 3, v1
    v_lshlrev_b32 v23, 4, v106
    v_lshl_add_u32 v25, v22, 11, v23
    s_cmp_ge_u32 s44, 4
    s_cbranch_scc1 L_v_init_196
    s_lshr_b32 s50, s44, 1
    s_and_b32 s51, s44, 1
    s_load_dwordx4 s[4:7], s[0:1], 16
    s_lshl_b32 s46, s49, 8
    s_lshl_b32 s48, s43, 6
    s_add_u32 s46, s46, s48
    s_lshl_b32 s48, s44, 21
    s_add_u32 s46, s46, s48
    s_lshl_b32 s52, s51, 5
    s_xor_b32 s53, s50, 1
    s_lshl_b32 s53, s53, 16
    s_add_u32 s52, s52, s53
    v_add_u32 v20, s52, v20
    s_waitcnt lgkmcnt(0)
    s_mov_b32 s24, s6
    s_and_b32 s25, s7, 0xffff
    s_mov_b32 s26, 0x800000
    s_mov_b32 s27, 0x00020000
    s_mov_b32 s28, s4
    s_and_b32 s29, s5, 0xffff
    s_mov_b32 s30, 0x800000
    s_mov_b32 s31, 0x00020000
    s_lshl_b32 s52, s51, 9
    s_lshl_b32 s53, s50, 7
    s_add_u32 s52, s52, s53
    s_add_u32 s52, s52, 61440
    v_lshlrev_b32 v5, 1, v106
    v_lshl_add_u32 v5, v107, 8, v5
    v_lshl_add_u32 v5, v102, 6, v5
    v_lshl_add_u32 v5, v103, 5, v5
    v_add_u32 v5, s52, v5
    s_lshl_b32 s67, s49, 12
    s_lshl_b32 s53, s43, 10
    s_add_u32 s67, s67, s53
    s_add_u32 s67, s67, 0x1000000
    s_lshl_b32 s52, s40, 16
    s_lshl_b32 s53, s44, 12
    s_add_u32 s53, s52, s53
    s_add_u32 s53, s53, 0x7080000
    v_add_u32 v7, s53, v2
    s_lshl_b32 s53, s44, 10
    s_add_u32 s53, s52, s53
    s_add_u32 s53, s53, 0x7180000
    v_lshlrev_b32 v28, 7, v103
    v_lshl_add_u32 v28, v106, 4, v28
    v_lshl_add_u32 v28, v102, 3, v28
    v_lshl_add_u32 v28, v107, 2, v28
    v_add_u32 v28, s53, v28
    s_lshl_b32 s52, s44, 10
    s_add_u32 s52, s52, 16384
    v_lshlrev_b32 v8, 8, v101
    v_lshl_add_u32 v8, v106, 4, v8
    v_lshl_add_u32 v8, v107, 3, v8
    v_add_u32 v8, s52, v8
    s_lshl_b32 s52, s44, 8
    s_add_u32 s52, s52, 20480
    v_lshlrev_b32 v9, 4, v106
    v_lshl_add_u32 v9, v101, 2, v9
    v_lshl_add_u32 v9, v107, 1, v9
    v_add_u32 v9, s52, v9
    s_mov_b32 s66, 0x3e0293ee
    s_add_u32 m0, s45, 0
    s_add_u32 s48, s46, 0x0
    buffer_load_dwordx4 v24, s[24:27], s48 offen lds
    s_add_u32 m0, s45, 1024
    s_add_u32 s48, s46, 0x20000
    buffer_load_dwordx4 v24, s[24:27], s48 offen lds
    s_add_u32 m0, s45, 2048
    s_add_u32 s48, s46, 0x40000
    buffer_load_dwordx4 v24, s[24:27], s48 offen lds
    s_add_u32 m0, s45, 3072
    s_add_u32 s48, s46, 0x60000
    buffer_load_dwordx4 v24, s[24:27], s48 offen lds
    s_add_u32 m0, s45, 4096
    s_add_u32 s48, s46, 0x80000
    buffer_load_dwordx4 v24, s[24:27], s48 offen lds
    s_add_u32 m0, s45, 5120
    s_add_u32 s48, s46, 0xa0000
    buffer_load_dwordx4 v24, s[24:27], s48 offen lds
    s_add_u32 m0, s45, 6144
    s_add_u32 s48, s46, 0xc0000
    buffer_load_dwordx4 v24, s[24:27], s48 offen lds
    s_add_u32 m0, s45, 7168
    s_add_u32 s48, s46, 0xe0000
    buffer_load_dwordx4 v24, s[24:27], s48 offen lds
    s_add_u32 m0, s45, 8192
    s_add_u32 s48, s46, 0x100000
    buffer_load_dwordx4 v24, s[24:27], s48 offen lds
    s_add_u32 m0, s45, 9216
    s_add_u32 s48, s46, 0x120000
    buffer_load_dwordx4 v24, s[24:27], s48 offen lds
    s_add_u32 m0, s45, 10240
    s_add_u32 s48, s46, 0x140000
    buffer_load_dwordx4 v24, s[24:27], s48 offen lds
    s_add_u32 m0, s45, 11264
    s_add_u32 s48, s46, 0x160000
    buffer_load_dwordx4 v24, s[24:27], s48 offen lds
    s_add_u32 m0, s45, 12288
    s_add_u32 s48, s46, 0x180000
    buffer_load_dwordx4 v24, s[24:27], s48 offen lds
    s_add_u32 m0, s45, 13312
    s_add_u32 s48, s46, 0x1a0000
    buffer_load_dwordx4 v24, s[24:27], s48 offen lds
    s_add_u32 m0, s45, 14336
    s_add_u32 s48, s46, 0x1c0000
    buffer_load_dwordx4 v24, s[24:27], s48 offen lds
    s_add_u32 m0, s45, 15360
    s_add_u32 s48, s46, 0x1e0000
    buffer_load_dwordx4 v24, s[24:27], s48 offen lds
    s_add_u32 s45, s45, 0x10000
    s_add_u32 m0, s45, 0
    s_add_u32 s48, s46, 0x0
    buffer_load_dwordx4 v24, s[28:31], s48 offen lds
    s_add_u32 m0, s45, 1024
    s_add_u32 s48, s46, 0x20000
    buffer_load_dwordx4 v24, s[28:31], s48 offen lds
    s_add_u32 m0, s45, 2048
    s_add_u32 s48, s46, 0x40000
    buffer_load_dwordx4 v24, s[28:31], s48 offen lds
    s_add_u32 m0, s45, 3072
    s_add_u32 s48, s46, 0x60000
    buffer_load_dwordx4 v24, s[28:31], s48 offen lds
    s_add_u32 m0, s45, 4096
    s_add_u32 s48, s46, 0x80000
    buffer_load_dwordx4 v24, s[28:31], s48 offen lds
    s_add_u32 m0, s45, 5120
    s_add_u32 s48, s46, 0xa0000
    buffer_load_dwordx4 v24, s[28:31], s48 offen lds
    s_add_u32 m0, s45, 6144
    s_add_u32 s48, s46, 0xc0000
    buffer_load_dwordx4 v24, s[28:31], s48 offen lds
    s_add_u32 m0, s45, 7168
    s_add_u32 s48, s46, 0xe0000
    buffer_load_dwordx4 v24, s[28:31], s48 offen lds
    s_add_u32 m0, s45, 8192
    s_add_u32 s48, s46, 0x100000
    buffer_load_dwordx4 v24, s[28:31], s48 offen lds
    s_add_u32 m0, s45, 9216
    s_add_u32 s48, s46, 0x120000
    buffer_load_dwordx4 v24, s[28:31], s48 offen lds
    s_add_u32 m0, s45, 10240
    s_add_u32 s48, s46, 0x140000
    buffer_load_dwordx4 v24, s[28:31], s48 offen lds
    s_add_u32 m0, s45, 11264
    s_add_u32 s48, s46, 0x160000
    buffer_load_dwordx4 v24, s[28:31], s48 offen lds
    s_add_u32 m0, s45, 12288
    s_add_u32 s48, s46, 0x180000
    buffer_load_dwordx4 v24, s[28:31], s48 offen lds
    s_add_u32 m0, s45, 13312
    s_add_u32 s48, s46, 0x1a0000
    buffer_load_dwordx4 v24, s[28:31], s48 offen lds
    s_add_u32 m0, s45, 14336
    s_add_u32 s48, s46, 0x1c0000
    buffer_load_dwordx4 v24, s[28:31], s48 offen lds
    s_add_u32 m0, s45, 15360
    s_add_u32 s48, s46, 0x1e0000
    buffer_load_dwordx4 v24, s[28:31], s48 offen lds
    s_add_u32 s45, s45, 0x10000
    s_waitcnt vmcnt(0)
    s_barrier
    s_cmp_lg_u32 s44, 0
    s_cbranch_scc1 L_zwok_199
    v_and_b32 v16, 7, v1
    v_lshlrev_b32 v16, 5, v16
    s_mov_b32 s70, 0
L_zw_198:
    buffer_load_dword v17, v16, s[16:19], 0 offen sc1
    s_waitcnt vmcnt(0)
    v_add_u32_dpp v17, v17, v17 row_ror:1 row_mask:0xf bank_mask:0xf
    s_nop 1
    v_add_u32_dpp v17, v17, v17 row_ror:2 row_mask:0xf bank_mask:0xf
    s_nop 1
    v_add_u32_dpp v17, v17, v17 row_ror:4 row_mask:0xf bank_mask:0xf
    v_cmp_ne_u32 vcc, 0x100, v17
    s_add_u32 s70, s70, 1
    s_cbranch_vccz L_zwok_199
    s_sleep 4
    s_cmp_lt_u32 s70, 524288
    s_cbranch_scc1 L_zw_198
    s_branch L_c_done_1
L_zwok_199:
    s_cmp_lg_u32 s44, 0
    s_cbranch_scc1 L_c_nr_200
    s_or_b32 s47, s39, 0x100
    v_mov_b32 v16, s47
    s_lshl_b32 s52, s40, 6
    s_lshl_b32 s53, s41, 2
    s_add_u32 s52, s52, s53
    s_add_u32 s52, s52, 0x101000
    v_mov_b32 v17, 0
    s_mov_b64 exec, 1
    buffer_store_dword v16, v17, s[12:15], s52 offen sc1
    s_mov_b64 exec, -1
L_c_nr_200:
    ds_read_b64_tr_b16 a[0:1], v20 offset:0
    ds_read_b64_tr_b16 a[2:3], v20 offset:256
    ds_read_b64_tr_b16 a[4:5], v20 offset:2048
    ds_read_b64_tr_b16 a[6:7], v20 offset:2304
    ds_read_b64_tr_b16 a[8:9], v20 offset:4096
    ds_read_b64_tr_b16 a[10:11], v20 offset:4352
    ds_read_b64_tr_b16 a[12:13], v20 offset:6144
    ds_read_b64_tr_b16 a[14:15], v20 offset:6400
    s_waitcnt lgkmcnt(0)
    ds_read_b64_tr_b16 a[16:17], v20 offset:8192
    ds_read_b64_tr_b16 a[18:19], v20 offset:8448
    ds_read_b64_tr_b16 a[20:21], v20 offset:10240
    ds_read_b64_tr_b16 a[22:23], v20 offset:10496
    ds_read_b64_tr_b16 a[24:25], v20 offset:12288
    ds_read_b64_tr_b16 a[26:27], v20 offset:12544
    ds_read_b64_tr_b16 a[28:29], v20 offset:14336
    ds_read_b64_tr_b16 a[30:31], v20 offset:14592
    s_waitcnt lgkmcnt(0)
    ds_read_b64_tr_b16 a[32:33], v20 offset:16384
    ds_read_b64_tr_b16 a[34:35], v20 offset:16640
    ds_read_b64_tr_b16 a[36:37], v20 offset:18432
    ds_read_b64_tr_b16 a[38:39], v20 offset:18688
    ds_read_b64_tr_b16 a[40:41], v20 offset:20480
    ds_read_b64_tr_b16 a[42:43], v20 offset:20736
    ds_read_b64_tr_b16 a[44:45], v20 offset:22528
    ds_read_b64_tr_b16 a[46:47], v20 offset:22784
    s_waitcnt lgkmcnt(0)
    ds_read_b64_tr_b16 a[48:49], v20 offset:24576
    ds_read_b64_tr_b16 a[50:51], v20 offset:24832
    ds_read_b64_tr_b16 a[52:53], v20 offset:26624
    ds_read_b64_tr_b16 a[54:55], v20 offset:26880
    ds_read_b64_tr_b16 a[56:57], v20 offset:28672
    ds_read_b64_tr_b16 a[58:59], v20 offset:28928
    ds_read_b64_tr_b16 a[60:61], v20 offset:30720
    ds_read_b64_tr_b16 a[62:63], v20 offset:30976
    s_waitcnt lgkmcnt(0)
    ds_read_b64_tr_b16 a[64:65], v20 offset:32768
    ds_read_b64_tr_b16 a[66:67], v20 offset:33024
    ds_read_b64_tr_b16 a[68:69], v20 offset:34816
    ds_read_b64_tr_b16 a[70:71], v20 offset:35072
    ds_read_b64_tr_b16 a[72:73], v20 offset:36864
    ds_read_b64_tr_b16 a[74:75], v20 offset:37120
    ds_read_b64_tr_b16 a[76:77], v20 offset:38912
    ds_read_b64_tr_b16 a[78:79], v20 offset:39168
    s_waitcnt lgkmcnt(0)
    ds_read_b64_tr_b16 a[80:81], v20 offset:40960
    ds_read_b64_tr_b16 a[82:83], v20 offset:41216
    ds_read_b64_tr_b16 a[84:85], v20 offset:43008
    ds_read_b64_tr_b16 a[86:87], v20 offset:43264
    ds_read_b64_tr_b16 a[88:89], v20 offset:45056
    ds_read_b64_tr_b16 a[90:91], v20 offset:45312
    ds_read_b64_tr_b16 a[92:93], v20 offset:47104
    ds_read_b64_tr_b16 a[94:95], v20 offset:47360
    s_waitcnt lgkmcnt(0)
    ds_read_b64_tr_b16 a[96:97], v20 offset:49152
    ds_read_b64_tr_b16 a[98:99], v20 offset:49408
    ds_read_b64_tr_b16 a[100:101], v20 offset:51200
    ds_read_b64_tr_b16 a[102:103], v20 offset:51456
    ds_read_b64_tr_b16 a[104:105], v20 offset:53248
    ds_read_b64_tr_b16 a[106:107], v20 offset:53504
    ds_read_b64_tr_b16 a[108:109], v20 offset:55296
    ds_read_b64_tr_b16 a[110:111], v20 offset:55552
    s_waitcnt lgkmcnt(0)
    ds_read_b64_tr_b16 a[112:113], v20 offset:57344
    ds_read_b64_tr_b16 a[114:115], v20 offset:57600
    ds_read_b64_tr_b16 a[116:117], v20 offset:59392
    ds_read_b64_tr_b16 a[118:119], v20 offset:59648
    ds_read_b64_tr_b16 a[120:121], v20 offset:61440
    ds_read_b64_tr_b16 a[122:123], v20 offset:61696
    ds_read_b64_tr_b16 a[124:125], v20 offset:63488
    ds_read_b64_tr_b16 a[126:127], v20 offset:63744
    s_waitcnt lgkmcnt(0)
    s_mov_b32 s63, 0
    s_barrier
    s_lshl_b32 s52, s40, 2
    s_add_u32 s52, s52, s44
    s_mul_i32 s52, s52, 24576
    s_lshl_b32 s53, s41, 9
    s_add_u32 s52, s52, s53
    s_add_u32 s52, s52, 0x2004000
    v_and_b32 v14, 3, v1
    v_lshlrev_b32 v14, 7, v14
    v_add_u32 v14, s52, v14
    s_lshl_b32 s52, s40, 16
    s_lshl_b32 s53, s41, 10
    s_add_u32 s53, s53, s52
    s_lshl_b32 s54, s44, 7
    s_add_u32 s53, s53, s54
    s_add_u32 s53, s53, 0x7080000
    v_lshlrev_b32 v4, 4, v106
    v_lshl_add_u32 v10, v102, 7, v4
    v_lshl_add_u32 v4, v101, 8, v4
    v_add_u32 v4, s53, v4
    s_lshl_b32 s53, s41, 8
    s_add_u32 s53, s53, s52
    s_add_u32 s53, s53, 0x7180000
    v_add_u32 v10, s53, v10
    s_cmp_ge_u32 s44, 2
    s_cselect_b64 vcc, -1, 0
    v_cndmask_b32 v4, v4, v10, vcc
    s_mul_i32 s52, s49, 24576
    s_lshl_b32 s53, s44, 12
    s_add_u32 s52, s52, s53
    s_lshl_b32 s53, s43, 10
    s_add_u32 s52, s52, s53
    s_add_u32 s52, s52, 0x2002000
    v_add_u32 v6, s52, v2
    v_lshrrev_b32 v10, 3, v1
    v_lshlrev_b32 v10, 8, v10
    v_lshl_add_u32 v10, v106, 4, v10
    v_add_u32 v10, 61568, v10
    v_add_u32 v11, 27648, v2
    v_cmp_gt_u32 s[52:53], 32, v1
    s_nop 1
    v_cndmask_b32 v10, v11, v10, s[52:53]
    v_cndmask_b32 v6, v6, v10, vcc
    v_mov_b32 v24, -1
    v_mov_b32 v25, -1
    v_mov_b32 v26, -1
    v_mov_b32 v27, -1
    v_mov_b32 v29, 26644
    v_mov_b32 v30, 0
    ds_write_b32 v29, v30
    v_mov_b32 v30, 1
    s_lshl_b32 s58, s40, 11
    s_lshl_b32 s53, s44, 7
    s_add_u32 s58, s58, s53
    s_add_u32 s58, s58, 0x10a600
    s_mov_b32 s69, 0
    v_mov_b32 v0, 0
    s_cmp_ge_u32 s44, 2
    s_cselect_b32 s50, 0, 0x00ff00ff
    s_mov_b32 s51, 0x00ff00ff
    s_setprio 1
    s_branch L_c_join_197
L_v_init_196:
    s_sub_u32 s54, s44, 4
    s_lshr_b32 s51, s54, 1
    s_and_b32 s50, s54, 1
    s_load_dwordx4 s[4:7], s[0:1], 32
    s_load_dwordx2 s[8:9], s[0:1], 8
    s_waitcnt lgkmcnt(0)
    s_mov_b32 s24, s4
    s_and_b32 s25, s5, 0xffff
    s_mov_b32 s26, 0x800000
    s_mov_b32 s27, 0x00020000
    s_mov_b32 s28, s6
    s_and_b32 s29, s7, 0xffff
    s_mov_b32 s30, 0x800000
    s_mov_b32 s31, 0x00020000
    s_mov_b32 s32, s8
    s_and_b32 s33, s9, 0xffff
    s_mov_b32 s34, 0x4000
    s_mov_b32 s35, 0x00020000
    s_lshl_b32 s45, s54, 12
    s_add_u32 s45, s45, 0x20000
    v_add_u32 v20, s45, v20
    v_add_u32 v21, s45, v21
    v_add_u32 v22, s45, v2
    s_lshl_b32 s46, s49, 8
    s_lshl_b32 s48, s43, 6
    s_add_u32 s46, s46, s48
    s_lshl_b32 s48, s54, 21
    s_add_u32 s46, s46, s48
    s_add_u32 s48, s46, 0x0
    buffer_load_dwordx4 a[0:3], v24, s[24:27], s48 offen
    s_add_u32 s48, s46, 0x20000
    buffer_load_dwordx4 a[32:35], v24, s[24:27], s48 offen
    s_add_u32 s48, s46, 0x40000
    buffer_load_dwordx4 a[4:7], v24, s[24:27], s48 offen
    s_add_u32 s48, s46, 0x60000
    buffer_load_dwordx4 a[36:39], v24, s[24:27], s48 offen
    s_add_u32 s48, s46, 0x80000
    buffer_load_dwordx4 a[8:11], v24, s[24:27], s48 offen
    s_add_u32 s48, s46, 0xa0000
    buffer_load_dwordx4 a[40:43], v24, s[24:27], s48 offen
    s_add_u32 s48, s46, 0xc0000
    buffer_load_dwordx4 a[12:15], v24, s[24:27], s48 offen
    s_add_u32 s48, s46, 0xe0000
    buffer_load_dwordx4 a[44:47], v24, s[24:27], s48 offen
    s_add_u32 s48, s46, 0x100000
    buffer_load_dwordx4 a[16:19], v24, s[24:27], s48 offen
    s_add_u32 s48, s46, 0x120000
    buffer_load_dwordx4 a[48:51], v24, s[24:27], s48 offen
    s_add_u32 s48, s46, 0x140000
    buffer_load_dwordx4 a[20:23], v24, s[24:27], s48 offen
    s_add_u32 s48, s46, 0x160000
    buffer_load_dwordx4 a[52:55], v24, s[24:27], s48 offen
    s_add_u32 s48, s46, 0x180000
    buffer_load_dwordx4 a[24:27], v24, s[24:27], s48 offen
    s_add_u32 s48, s46, 0x1a0000
    buffer_load_dwordx4 a[56:59], v24, s[24:27], s48 offen
    s_add_u32 s48, s46, 0x1c0000
    buffer_load_dwordx4 a[28:31], v24, s[24:27], s48 offen
    s_add_u32 s48, s46, 0x1e0000
    buffer_load_dwordx4 a[60:63], v24, s[24:27], s48 offen
    s_lshl_b32 s52, s40, 15
    s_lshl_b32 s53, s42, 11
    s_add_u32 s52, s52, s53
    s_lshl_b32 s53, s43, 9
    s_add_u32 s52, s52, s53
    s_lshl_b32 s53, s51, 8
    s_add_u32 s52, s52, s53
    s_add_u32 s52, s52, 0x7100000
    v_bfe_u32 v4, v1, 1, 1
    v_lshlrev_b32 v4, 7, v4
    v_lshl_add_u32 v4, v104, 4, v4
    v_and_b32 v5, 12, v100
    v_add_u32 v4, v4, v5
    v_add_u32 v4, s52, v4
    v_mov_b32 v26, -1
    s_lshl_b32 s52, s51, 5
    s_add_u32 s52, s52, 28160
    v_and_b32 v5, 14, v100
    v_lshlrev_b32 v5, 1, v5
    v_lshl_add_u32 v5, v104, 6, v5
    v_add_u32 v5, s52, v5
    s_lshl_b32 s52, s41, 14
    s_lshl_b32 s53, s54, 11
    s_add_u32 s52, s52, s53
    s_add_u32 s52, s52, 0x7800000
    v_lshlrev_b32 v6, 3, v101
    v_lshl_add_u32 v6, v106, 5, v6
    v_and_b32 v7, 3, v1
    v_lshlrev_b32 v7, 3, v7
    v_bfe_u32 v30, v1, 2, 3
    v_lshl_add_u32 v7, v30, 5, v7
    v_lshl_add_u32 v7, v103, 2, v7
    v_add_u32 v7, s52, v7
    s_lshl_b32 s53, s40, 8
    s_add_u32 s52, s52, s53
    v_add_u32 v6, s52, v6
    v_lshlrev_b32 v30, 4, v100
    v_lshl_add_u32 v30, v101, 18, v30
    v_add_u32 v30, s52, v30
    v_mov_b32 v32, -1
    v_mov_b32 v33, -1
    v_mov_b32 v34, -1
    v_mov_b32 v35, -1
    buffer_store_dwordx4 v[32:35], v30, s[12:15], 0 offen sc1
    s_mov_b32 s53, 8192
    buffer_store_dwordx4 v[32:35], v30, s[12:15], s53 offen sc1
    s_lshl_b32 s55, s40, 16
    s_add_u32 s55, s55, 0x7000000
    s_lshl_b32 s52, s41, 10
    s_lshl_b32 s53, s54, 8
    s_add_u32 s52, s52, s53
    s_add_u32 s52, s52, s55
    v_lshlrev_b32 v8, 2, v1
    v_add_u32 v8, s52, v8
    s_lshl_b32 s53, s54, 12
    v_add_u32 v10, s53, v2
    v_add_u32 v9, s55, v10
    s_lshl_b32 s52, s40, 15
    s_lshl_b32 s53, s54, 11
    s_add_u32 s52, s52, s53
    s_add_u32 s52, s52, 0x7100000
    v_add_u32 v11, s52, v2
    s_lshl_b32 s52, s54, 9
    s_add_u32 s52, s52, 53248
    v_lshlrev_b32 v12, 4, v100
    v_lshl_add_u32 v12, v102, 3, v12
    v_lshl_add_u32 v12, v103, 8, v12
    v_add_u32 v12, s52, v12
    s_lshl_b32 s52, s51, 3
    s_add_u32 s52, s52, 49152
    v_add_u32 v13, s52, v2
    s_lshl_b32 s52, s54, 10
    s_add_u32 s52, s52, 49152
    v_add_u32 v14, s52, v2
    s_lshl_b32 s52, s40, 2
    s_add_u32 s52, s52, s54
    s_mul_i32 s52, s52, 24576
    s_add_u32 s52, s52, 0x2004000
    v_add_u32 v15, s52, v2
    s_lshl_b32 s52, s54, 10
    v_add_u32 v27, s52, v2
    v_lshlrev_b32 v30, 11, v106
    v_lshl_add_u32 v30, v101, 5, v30
    v_lshl_add_u32 v30, v107, 2, v30
    s_lshl_b32 s52, s54, 9
    buffer_load_dword v112, v30, s[32:35], s52 offen offset:0
    buffer_load_dword v113, v30, s[32:35], s52 offen offset:8
    buffer_load_dword v114, v30, s[32:35], s52 offen offset:16
    buffer_load_dword v115, v30, s[32:35], s52 offen offset:24
    buffer_load_dword v116, v30, s[32:35], s52 offen offset:128
    buffer_load_dword v117, v30, s[32:35], s52 offen offset:136
    buffer_load_dword v118, v30, s[32:35], s52 offen offset:144
    buffer_load_dword v119, v30, s[32:35], s52 offen offset:152
    buffer_load_dword v120, v30, s[32:35], s52 offen offset:256
    buffer_load_dword v121, v30, s[32:35], s52 offen offset:264
    buffer_load_dword v122, v30, s[32:35], s52 offen offset:272
    buffer_load_dword v123, v30, s[32:35], s52 offen offset:280
    buffer_load_dword v124, v30, s[32:35], s52 offen offset:384
    buffer_load_dword v125, v30, s[32:35], s52 offen offset:392
    buffer_load_dword v126, v30, s[32:35], s52 offen offset:400
    buffer_load_dword v127, v30, s[32:35], s52 offen offset:408
    s_lshl_b32 s46, s40, 2
    s_add_u32 s46, s46, s54
    s_lshl_b32 s46, s46, 18
    s_lshl_b32 s48, s41, 7
    s_add_u32 s46, s46, s48
    s_add_u32 s48, s46, 0x0
    buffer_load_dwordx4 a[64:67], v25, s[28:31], s48 offen
    s_add_u32 s48, s46, 0x4000
    buffer_load_dwordx4 a[80:83], v25, s[28:31], s48 offen
    s_add_u32 s48, s46, 0x8000
    buffer_load_dwordx4 a[96:99], v25, s[28:31], s48 offen
    s_add_u32 s48, s46, 0xc000
    buffer_load_dwordx4 a[112:115], v25, s[28:31], s48 offen
    s_add_u32 s48, s46, 0x10000
    buffer_load_dwordx4 a[68:71], v25, s[28:31], s48 offen
    s_add_u32 s48, s46, 0x14000
    buffer_load_dwordx4 a[84:87], v25, s[28:31], s48 offen
    s_add_u32 s48, s46, 0x18000
    buffer_load_dwordx4 a[100:103], v25, s[28:31], s48 offen
    s_add_u32 s48, s46, 0x1c000
    buffer_load_dwordx4 a[116:119], v25, s[28:31], s48 offen
    s_add_u32 s48, s46, 0x20000
    buffer_load_dwordx4 a[72:75], v25, s[28:31], s48 offen
    s_add_u32 s48, s46, 0x24000
    buffer_load_dwordx4 a[88:91], v25, s[28:31], s48 offen
    s_add_u32 s48, s46, 0x28000
    buffer_load_dwordx4 a[104:107], v25, s[28:31], s48 offen
    s_add_u32 s48, s46, 0x2c000
    buffer_load_dwordx4 a[120:123], v25, s[28:31], s48 offen
    s_add_u32 s48, s46, 0x30000
    buffer_load_dwordx4 a[76:79], v25, s[28:31], s48 offen
    s_add_u32 s48, s46, 0x34000
    buffer_load_dwordx4 a[92:95], v25, s[28:31], s48 offen
    s_add_u32 s48, s46, 0x38000
    buffer_load_dwordx4 a[108:111], v25, s[28:31], s48 offen
    s_add_u32 s48, s46, 0x3c000
    buffer_load_dwordx4 a[124:127], v25, s[28:31], s48 offen
    s_waitcnt vmcnt(16)
    ds_write_b128 v22, a[0:3] offset:0
    ds_write_b128 v22, a[32:35] offset:1024
    ds_write_b128 v22, a[4:7] offset:2048
    ds_write_b128 v22, a[36:39] offset:3072
    s_waitcnt lgkmcnt(0)
    ds_read_b64_tr_b16 a[0:1], v20 offset:0
    ds_read_b64_tr_b16 a[2:3], v20 offset:256
    ds_read_b64_tr_b16 a[32:33], v20 offset:32
    ds_read_b64_tr_b16 a[34:35], v20 offset:288
    ds_read_b64_tr_b16 a[4:5], v20 offset:2048
    ds_read_b64_tr_b16 a[6:7], v20 offset:2304
    ds_read_b64_tr_b16 a[36:37], v20 offset:2080
    ds_read_b64_tr_b16 a[38:39], v20 offset:2336
    s_waitcnt lgkmcnt(0)
    ds_write_b128 v22, a[8:11] offset:0
    ds_write_b128 v22, a[40:43] offset:1024
    ds_write_b128 v22, a[12:15] offset:2048
    ds_write_b128 v22, a[44:47] offset:3072
    s_waitcnt lgkmcnt(0)
    ds_read_b64_tr_b16 a[8:9], v20 offset:0
    ds_read_b64_tr_b16 a[10:11], v20 offset:256
    ds_read_b64_tr_b16 a[40:41], v20 offset:32
    ds_read_b64_tr_b16 a[42:43], v20 offset:288
    ds_read_b64_tr_b16 a[12:13], v20 offset:2048
    ds_read_b64_tr_b16 a[14:15], v20 offset:2304
    ds_read_b64_tr_b16 a[44:45], v20 offset:2080
    ds_read_b64_tr_b16 a[46:47], v20 offset:2336
    s_waitcnt lgkmcnt(0)
    ds_write_b128 v22, a[16:19] offset:0
    ds_write_b128 v22, a[48:51] offset:1024
    ds_write_b128 v22, a[20:23] offset:2048
    ds_write_b128 v22, a[52:55] offset:3072
    s_waitcnt lgkmcnt(0)
    ds_read_b64_tr_b16 a[16:17], v20 offset:0
    ds_read_b64_tr_b16 a[18:19], v20 offset:256
    ds_read_b64_tr_b16 a[48:49], v20 offset:32
    ds_read_b64_tr_b16 a[50:51], v20 offset:288
    ds_read_b64_tr_b16 a[20:21], v20 offset:2048
    ds_read_b64_tr_b16 a[22:23], v20 offset:2304
    ds_read_b64_tr_b16 a[52:53], v20 offset:2080
    ds_read_b64_tr_b16 a[54:55], v20 offset:2336
    s_waitcnt lgkmcnt(0)
    ds_write_b128 v22, a[24:27] offset:0
    ds_write_b128 v22, a[56:59] offset:1024
    ds_write_b128 v22, a[28:31] offset:2048
    ds_write_b128 v22, a[60:63] offset:3072
    s_waitcnt lgkmcnt(0)
    ds_read_b64_tr_b16 a[24:25], v20 offset:0
    ds_read_b64_tr_b16 a[26:27], v20 offset:256
    ds_read_b64_tr_b16 a[56:57], v20 offset:32
    ds_read_b64_tr_b16 a[58:59], v20 offset:288
    ds_read_b64_tr_b16 a[28:29], v20 offset:2048
    ds_read_b64_tr_b16 a[30:31], v20 offset:2304
    ds_read_b64_tr_b16 a[60:61], v20 offset:2080
    ds_read_b64_tr_b16 a[62:63], v20 offset:2336
    s_waitcnt lgkmcnt(0)
    s_barrier
    s_waitcnt vmcnt(0)
    ds_write_b128 v22, a[64:67] offset:0
    ds_write_b128 v22, a[80:83] offset:1024
    ds_write_b128 v22, a[96:99] offset:2048
    ds_write_b128 v22, a[112:115] offset:3072
    s_waitcnt lgkmcnt(0)
    ds_read_b64_tr_b16 a[64:65], v21 offset:0
    ds_read_b64_tr_b16 a[66:67], v21 offset:512
    ds_read_b64_tr_b16 a[80:81], v21 offset:32
    ds_read_b64_tr_b16 a[82:83], v21 offset:544
    ds_read_b64_tr_b16 a[96:97], v21 offset:64
    ds_read_b64_tr_b16 a[98:99], v21 offset:576
    ds_read_b64_tr_b16 a[112:113], v21 offset:96
    ds_read_b64_tr_b16 a[114:115], v21 offset:608
    s_waitcnt lgkmcnt(0)
    ds_write_b128 v22, a[68:71] offset:0
    ds_write_b128 v22, a[84:87] offset:1024
    ds_write_b128 v22, a[100:103] offset:2048
    ds_write_b128 v22, a[116:119] offset:3072
    s_waitcnt lgkmcnt(0)
    ds_read_b64_tr_b16 a[68:69], v21 offset:0
    ds_read_b64_tr_b16 a[70:71], v21 offset:512
    ds_read_b64_tr_b16 a[84:85], v21 offset:32
    ds_read_b64_tr_b16 a[86:87], v21 offset:544
    ds_read_b64_tr_b16 a[100:101], v21 offset:64
    ds_read_b64_tr_b16 a[102:103], v21 offset:576
    ds_read_b64_tr_b16 a[116:117], v21 offset:96
    ds_read_b64_tr_b16 a[118:119], v21 offset:608
    s_waitcnt lgkmcnt(0)
    ds_write_b128 v22, a[72:75] offset:0
    ds_write_b128 v22, a[88:91] offset:1024
    ds_write_b128 v22, a[104:107] offset:2048
    ds_write_b128 v22, a[120:123] offset:3072
    s_waitcnt lgkmcnt(0)
    ds_read_b64_tr_b16 a[72:73], v21 offset:0
    ds_read_b64_tr_b16 a[74:75], v21 offset:512
    ds_read_b64_tr_b16 a[88:89], v21 offset:32
    ds_read_b64_tr_b16 a[90:91], v21 offset:544
    ds_read_b64_tr_b16 a[104:105], v21 offset:64
    ds_read_b64_tr_b16 a[106:107], v21 offset:576
    ds_read_b64_tr_b16 a[120:121], v21 offset:96
    ds_read_b64_tr_b16 a[122:123], v21 offset:608
    s_waitcnt lgkmcnt(0)
    ds_write_b128 v22, a[76:79] offset:0
    ds_write_b128 v22, a[92:95] offset:1024
    ds_write_b128 v22, a[108:111] offset:2048
    ds_write_b128 v22, a[124:127] offset:3072
    s_waitcnt lgkmcnt(0)
    ds_read_b64_tr_b16 a[76:77], v21 offset:0
    ds_read_b64_tr_b16 a[78:79], v21 offset:512
    ds_read_b64_tr_b16 a[92:93], v21 offset:32
    ds_read_b64_tr_b16 a[94:95], v21 offset:544
    ds_read_b64_tr_b16 a[108:109], v21 offset:64
    ds_read_b64_tr_b16 a[110:111], v21 offset:576
    ds_read_b64_tr_b16 a[124:125], v21 offset:96
    ds_read_b64_tr_b16 a[126:127], v21 offset:608
    s_waitcnt lgkmcnt(0)
    s_mov_b32 s65, 0
    s_waitcnt vmcnt(0)
    s_barrier
    s_lshl_b32 s57, s40, 11
    s_lshl_b32 s53, s54, 7
    s_add_u32 s57, s57, s53
    s_add_u32 s57, s57, 0x10a600
    s_mov_b32 s69, 0
    s_mov_b32 s68, 0
    s_cmp_gt_u32 s69, s68
    s_cbranch_scc1 L_kv_ok_202
    s_mov_b32 s70, 0
L_kv_lp_201:
    v_and_b32 v22, 1, v1
    v_lshlrev_b32 v22, 9, v22
    buffer_load_dword v23, v22, s[12:15], s57 offen sc1
    s_waitcnt vmcnt(0)
    v_readlane_b32 s69, v23, 0
    v_readlane_b32 s45, v23, 1
    s_add_u32 s70, s70, 1
    s_nop 2
    s_min_u32 s69, s69, s45
    s_cmp_gt_u32 s69, s68
    s_cbranch_scc1 L_kv_ok_202
    s_sleep 4
    s_cmp_lt_u32 s70, 524288
    s_cbranch_scc1 L_kv_lp_201
    s_branch L_c_done_1
L_kv_ok_202:
    v_subrev_u32 v28, 8192, v15
    v_lshlrev_b32 v31, 4, v100
    v_lshl_add_u32 v31, v103, 8, v31
    v_add_u32 v31, 20480, v31
    s_lshl_b32 s52, s54, 11
    s_add_u32 s52, s52, 53248
    v_add_u32 v25, s52, v2
    v_mov_b32 v29, 26640
    v_mov_b32 v30, 0
    ds_write_b32 v29, v30
    v_mov_b32 v30, 1
    s_mov_b32 s58, 0
    s_mov_b32 s64, 0
    s_add_u32 s46, s65, 4096
    buffer_load_dwordx4 v[32:35], v15, s[12:15], s65 offen offset:0 sc1
    buffer_load_dwordx4 v[48:51], v15, s[12:15], s46 offen offset:0 sc1
    buffer_load_dwordx4 v[36:39], v15, s[12:15], s65 offen offset:1024 sc1
    buffer_load_dwordx4 v[52:55], v15, s[12:15], s46 offen offset:1024 sc1
    buffer_load_dwordx4 v[40:43], v15, s[12:15], s65 offen offset:2048 sc1
    buffer_load_dwordx4 v[56:59], v15, s[12:15], s46 offen offset:2048 sc1
    buffer_load_dwordx4 v[44:47], v15, s[12:15], s65 offen offset:3072 sc1
    buffer_load_dwordx4 v[60:63], v15, s[12:15], s46 offen offset:3072 sc1
    s_add_u32 s65, s65, 786432
    s_mov_b32 s45, 0x20000
    buffer_load_dwordx4 v[96:99], v2, s[12:15], s45 offen sc1
    s_waitcnt vmcnt(0)
    v_mfma_f32_16x16x32_bf16 v[64:67], v[32:35], a[64:67], 0
    v_mfma_f32_16x16x32_bf16 v[68:71], v[48:51], a[64:67], 0
    v_mfma_f32_16x16x32_bf16 v[64:67], v[36:39], a[68:71], v[64:67]
    v_mfma_f32_16x16x32_bf16 v[68:71], v[52:55], a[68:71], v[68:71]
    v_mfma_f32_16x16x32_bf16 v[64:67], v[40:43], a[72:75], v[64:67]
    v_mfma_f32_16x16x32_bf16 v[68:71], v[56:59], a[72:75], v[68:71]
    v_mfma_f32_16x16x32_bf16 v[64:67], v[44:47], a[76:79], v[64:67]
    v_mfma_f32_16x16x32_bf16 v[68:71], v[60:63], a[76:79], v[68:71]
    v_mfma_f32_16x16x32_bf16 v[72:75], v[32:35], a[80:83], 0
    v_mfma_f32_16x16x32_bf16 v[76:79], v[48:51], a[80:83], 0
    v_mfma_f32_16x16x32_bf16 v[72:75], v[36:39], a[84:87], v[72:75]
    v_mfma_f32_16x16x32_bf16 v[76:79], v[52:55], a[84:87], v[76:79]
    v_mfma_f32_16x16x32_bf16 v[72:75], v[40:43], a[88:91], v[72:75]
    v_mfma_f32_16x16x32_bf16 v[76:79], v[56:59], a[88:91], v[76:79]
    v_mfma_f32_16x16x32_bf16 v[72:75], v[44:47], a[92:95], v[72:75]
    v_mfma_f32_16x16x32_bf16 v[76:79], v[60:63], a[92:95], v[76:79]
    v_cvt_pk_bf16_f32 v64, v64, v65
    v_cvt_pk_bf16_f32 v65, v66, v67
    v_cvt_pk_bf16_f32 v66, v68, v69
    v_cvt_pk_bf16_f32 v67, v70, v71
    ds_write_b128 v10, v[64:67] offset:32768
    v_mfma_f32_16x16x32_bf16 v[80:83], v[32:35], a[96:99], 0
    v_mfma_f32_16x16x32_bf16 v[84:87], v[48:51], a[96:99], 0
    v_mfma_f32_16x16x32_bf16 v[80:83], v[36:39], a[100:103], v[80:83]
    v_mfma_f32_16x16x32_bf16 v[84:87], v[52:55], a[100:103], v[84:87]
    v_mfma_f32_16x16x32_bf16 v[80:83], v[40:43], a[104:107], v[80:83]
    v_mfma_f32_16x16x32_bf16 v[84:87], v[56:59], a[104:107], v[84:87]
    v_mfma_f32_16x16x32_bf16 v[80:83], v[44:47], a[108:111], v[80:83]
    v_mfma_f32_16x16x32_bf16 v[84:87], v[60:63], a[108:111], v[84:87]
    v_cvt_pk_bf16_f32 v72, v72, v73
    v_cvt_pk_bf16_f32 v73, v74, v75
    v_cvt_pk_bf16_f32 v74, v76, v77
    v_cvt_pk_bf16_f32 v75, v78, v79
    ds_write_b128 v10, v[72:75] offset:33792
    v_mfma_f32_16x16x32_bf16 v[88:91], v[32:35], a[112:115], 0
    v_mfma_f32_16x16x32_bf16 v[92:95], v[48:51], a[112:115], 0
    v_mfma_f32_16x16x32_bf16 v[88:91], v[36:39], a[116:119], v[88:91]
    v_mfma_f32_16x16x32_bf16 v[92:95], v[52:55], a[116:119], v[92:95]
    v_mfma_f32_16x16x32_bf16 v[88:91], v[40:43], a[120:123], v[88:91]
    v_mfma_f32_16x16x32_bf16 v[92:95], v[56:59], a[120:123], v[92:95]
    v_mfma_f32_16x16x32_bf16 v[88:91], v[44:47], a[124:127], v[88:91]
    v_mfma_f32_16x16x32_bf16 v[92:95], v[60:63], a[124:127], v[92:95]
    v_cvt_pk_bf16_f32 v80, v80, v81
    v_cvt_pk_bf16_f32 v81, v82, v83
    v_cvt_pk_bf16_f32 v82, v84, v85
    v_cvt_pk_bf16_f32 v83, v86, v87
    ds_write_b128 v10, v[80:83] offset:34816
    s_nop 2
    v_cvt_pk_bf16_f32 v88, v88, v89
    v_cvt_pk_bf16_f32 v89, v90, v91
    v_cvt_pk_bf16_f32 v90, v92, v93
    v_cvt_pk_bf16_f32 v91, v94, v95
    ds_write_b128 v10, v[88:91] offset:35840
    v_add3_u32 v96, v96, v97, v98
    v_add_u32 v96, v96, v99
    s_nop 1
    v_add_u32_dpp v96, v96, v96 quad_perm:[1,0,3,2] row_mask:0xf bank_mask:0xf
    s_nop 1
    v_add_u32_dpp v96, v96, v96 quad_perm:[2,3,0,1] row_mask:0xf bank_mask:0xf
    s_nop 1
    v_add_u32_dpp v96, v96, v96 row_half_mirror row_mask:0xf bank_mask:0xf
    v_cmp_lt_u32 s[66:67], 64, v96
    s_nop 3
    s_bitcmp1_b32 s66, 0
    s_cselect_b32 s63, 8192, 0
    s_mov_b32 s68, 1
    s_cmp_gt_u32 s69, s68
    s_cbranch_scc1 L_kv_ok_204
    s_mov_b32 s70, 0
L_kv_lp_203:
    v_and_b32 v22, 1, v1
    v_lshlrev_b32 v22, 9, v22
    buffer_load_dword v23, v22, s[12:15], s57 offen sc1
    s_waitcnt vmcnt(0)
    v_readlane_b32 s69, v23, 0
    v_readlane_b32 s45, v23, 1
    s_add_u32 s70, s70, 1
    s_nop 2
    s_min_u32 s69, s69, s45
    s_cmp_gt_u32 s69, s68
    s_cbranch_scc1 L_kv_ok_204
    s_sleep 4
    s_cmp_lt_u32 s70, 524288
    s_cbranch_scc1 L_kv_lp_203
    s_branch L_c_done_1
L_kv_ok_204:
    s_waitcnt lgkmcnt(0)
    v_min_u32 v64, -2, v112
    v_min_u32 v65, -2, v113
    v_min_u32 v66, -2, v114
    v_min_u32 v67, -2, v115
    v_min_u32 v68, -2, v116
    v_min_u32 v69, -2, v117
    v_min_u32 v70, -2, v118
    v_min_u32 v71, -2, v119
    v_min_u32 v72, -2, v120
    v_min_u32 v73, -2, v121
    v_min_u32 v74, -2, v122
    v_min_u32 v75, -2, v123
    v_min_u32 v76, -2, v124
    v_min_u32 v77, -2, v125
    v_min_u32 v78, -2, v126
    v_min_u32 v79, -2, v127
    v_mov_b32 v16, 0
    v_mov_b32 v17, 0
    v_mov_b32 v18, 0
    v_mov_b32 v19, 0
    v_mov_b32 v20, 0
    v_mov_b32 v21, 0
    v_mov_b32 v22, 0
    v_mov_b32 v23, 0
L_c_join_197:
    s_mov_b32 s60, 0
    s_mov_b32 s61, 0
    s_mov_b32 s62, 0
    s_cmp_lg_u32 s44, 0
    s_cbranch_scc1 L_c_nh_205
    v_lshlrev_b32 v17, 3, v1
    s_lshl_b32 s46, s40, 3
    v_mov_b32 v21, s46
    s_mov_b32 s45, 0x101000
    s_mov_b32 s70, 0
L_c_rp_206:
    buffer_load_dwordx2 v[18:19], v17, s[12:15], s45 offen sc1
    buffer_load_dwordx2 v[22:23], v21, s[12:15], s45 offen offset:512 sc1
    s_waitcnt vmcnt(0)
    v_min3_u32 v20, v18, v19, v22
    v_min_u32 v20, v20, v23
    v_cmp_eq_u32 vcc, 0, v20
    s_cbranch_vccnz L_rt_207
    v_cmp_eq_u32 s[52:53], v18, v16
    v_cmp_eq_u32 vcc, v19, v16
    v_cmp_eq_u32 s[54:55], v22, v16
    v_cmp_eq_u32 s[56:57], v23, v16
    s_lshl_b32 s46, s40, 3
    s_nop 3
    s_and_b64 s[52:53], s[52:53], vcc
    s_lshr_b64 s[52:53], s[52:53], s46
    s_and_b32 s52, s52, 0xff
    s_cmp_eq_u32 s52, 0xff
    s_cselect_b32 s52, 1, 0
    v_mov_b32 v16, s52
    v_mov_b32 v17, 26624
    ds_write_b32 v17, v16
L_c_nh_205:
    s_waitcnt lgkmcnt(0)
    s_barrier
    v_mov_b32 v17, 26624
    ds_read_b32 v16, v17
    s_waitcnt lgkmcnt(0)
    v_readfirstlane_b32 s52, v16
    s_nop 3
    s_cmp_ge_u32 s44, 4
    s_cbranch_scc1 L_vf_210
    s_mov_b32 s57, s58
    s_mov_b32 s58, 0
    s_cmp_ge_u32 s44, 2
    s_cbranch_scc1 L_sf_208
    buffer_load_dwordx4 v[32:35], v6, s[12:15], 0 offen sc1
L_sf_208:
    s_cmp_eq_u32 s52, 0
    s_cbranch_scc1 L_ss_209
.p2align 6
L_s_loop_212:
    v_mov_b32 v16, 0
    v_mov_b32 v17, 0
    v_mov_b32 v18, 0
    v_mov_b32 v19, 0
    s_add_u32 s58, s58, 4
    s_mov_b32 s70, 1
    s_waitcnt vmcnt(0)
    s_barrier
    ds_read_b128 v[64:67], v2 offset:0
    ds_read_b128 v[68:71], v2 offset:1024
    ds_read_b128 v[72:75], v2 offset:2048
    ds_read_b128 v[76:79], v2 offset:3072
    ds_read_b128 v[80:83], v2 offset:4096
    ds_read_b128 v[84:87], v2 offset:5120
    ds_read_b128 v[88:91], v2 offset:6144
    ds_read_b128 v[92:95], v2 offset:7168
    ds_read_b128 v[96:99], v2 offset:8192
    ds_read_b128 v[100:103], v2 offset:9216
    ds_read_b128 v[104:107], v2 offset:10240
    ds_read_b128 v[108:111], v2 offset:11264
    s_waitcnt lgkmcnt(11)
    v_smfmac_f32_16x16x64_bf16 v[16:19], v[64:67], a[0:7], v3
    ds_read_b128 v[112:115], v2 offset:12288
    s_waitcnt lgkmcnt(11)
    v_smfmac_f32_16x16x64_bf16 v[16:19], v[68:71], a[8:15], v3
    ds_read_b128 v[116:119], v2 offset:13312
    s_waitcnt lgkmcnt(11)
    v_smfmac_f32_16x16x64_bf16 v[16:19], v[72:75], a[16:23], v3
    ds_read_b128 v[120:123], v2 offset:14336
    s_waitcnt lgkmcnt(11)
    v_smfmac_f32_16x16x64_bf16 v[16:19], v[76:79], a[24:31], v3
    ds_read_b128 v[124:127], v2 offset:15360
    s_waitcnt lgkmcnt(11)
    v_smfmac_f32_16x16x64_bf16 v[16:19], v[80:83], a[32:39], v3
    s_waitcnt lgkmcnt(10)
    v_smfmac_f32_16x16x64_bf16 v[16:19], v[84:87], a[40:47], v3
    s_waitcnt lgkmcnt(9)
    v_smfmac_f32_16x16x64_bf16 v[16:19], v[88:91], a[48:55], v3
    s_waitcnt lgkmcnt(8)
    v_smfmac_f32_16x16x64_bf16 v[16:19], v[92:95], a[56:63], v3
    s_waitcnt lgkmcnt(7)
    v_smfmac_f32_16x16x64_bf16 v[16:19], v[96:99], a[64:71], v3
    s_waitcnt lgkmcnt(6)
    v_smfmac_f32_16x16x64_bf16 v[16:19], v[100:103], a[72:79], v3
    s_waitcnt lgkmcnt(5)
    v_smfmac_f32_16x16x64_bf16 v[16:19], v[104:107], a[80:87], v3
    s_waitcnt lgkmcnt(4)
    v_smfmac_f32_16x16x64_bf16 v[16:19], v[108:111], a[88:95], v3
    s_waitcnt lgkmcnt(3)
    v_smfmac_f32_16x16x64_bf16 v[16:19], v[112:115], a[96:103], v3
    s_waitcnt lgkmcnt(2)
    v_smfmac_f32_16x16x64_bf16 v[16:19], v[116:119], a[104:111], v3
    s_waitcnt lgkmcnt(1)
    v_smfmac_f32_16x16x64_bf16 v[16:19], v[120:123], a[112:119], v3
    s_waitcnt lgkmcnt(0)
    v_smfmac_f32_16x16x64_bf16 v[16:19], v[124:127], a[120:127], v3
    s_nop 7
    v_permlane32_swap_b32 v16, v18
    v_permlane32_swap_b32 v17, v19
    v_add_f32 v16, v16, v18
    v_add_f32 v17, v17, v19
    v_cvt_pk_bf16_f32 v16, v16, v17
    ds_write_b16 v5, v16
    ds_write_b16_d16_hi v5, v16 offset:16
    s_mov_b64 exec, 1
    ds_add_u32 v29, v30
    s_mov_b64 exec, -1
L_s_xl_214:
    ds_read_b32 v10, v29
    ds_read_b128 v[64:67], v2 offset:61440
    s_cmp_eq_u32 s60, 63
    s_cbranch_scc1 L_s_last_213
    s_cmp_ge_u32 s44, 2
    s_cbranch_scc1 L_s_w2_215
    s_waitcnt lgkmcnt(0)
    v_mfma_f32_16x16x32_bf16 v[16:19], v[32:35], v[64:67], 0
L_s_w2_215_b:
    v_cmp_ne_u32 vcc, s58, v10
    s_nop 0
    s_cbranch_vccnz L_rt_217
    s_mov_b64 exec, s[50:51]
    s_nop 3
    v_min_u32 v16, -2, v16
    v_min_u32 v17, -2, v17
    v_min_u32 v18, -2, v18
    v_min_u32 v19, -2, v19
    buffer_store_dwordx4 v[16:19], v4, s[12:15], s61 offen
    s_mov_b64 exec, -1
L_s_w3_216_b:
    s_sleep 5
    s_mov_b32 s70, 1
L_s_xp_218:
    buffer_load_dwordx4 v[64:67], v7, s[12:15], s61 offen offset:0 sc1
    buffer_load_dword v80, v28, s[12:15], s61 offen offset:0 sc1
    buffer_load_dwordx4 v[68:71], v7, s[12:15], s61 offen offset:1024 sc1
    buffer_load_dword v81, v28, s[12:15], s61 offen offset:256 sc1
    buffer_load_dwordx4 v[72:75], v7, s[12:15], s61 offen offset:2048 sc1
    buffer_load_dword v82, v28, s[12:15], s61 offen offset:512 sc1
    buffer_load_dwordx4 v[76:79], v7, s[12:15], s61 offen offset:3072 sc1
    buffer_load_dword v83, v28, s[12:15], s61 offen offset:768 sc1
    s_waitcnt vmcnt(4)
    v_add_f32 v16, v64, v68
    v_add_f32 v17, v65, v69
    v_add_f32 v18, v66, v70
    v_add_f32 v19, v67, v71
    v_add_f32 v20, v80, v81
    s_waitcnt vmcnt(2)
    v_add_f32 v16, v16, v72
    v_add_f32 v17, v17, v73
    v_add_f32 v18, v18, v74
    v_add_f32 v19, v19, v75
    v_add_f32 v20, v20, v82
    s_waitcnt vmcnt(0)
    v_add_f32 v16, v16, v76
    v_add_f32 v17, v17, v77
    v_add_f32 v18, v18, v78
    v_add_f32 v19, v19, v79
    v_add_f32 v20, v20, v83
    v_cmp_u_f32 s[46:47], v16, v17
    v_cmp_u_f32 s[48:49], v18, v19
    v_cmp_u_f32 vcc, v20, v20
    v_max3_f32 v10, v16, v17, v18
    s_or_b64 s[46:47], s[46:47], s[48:49]
    v_max3_f32 v10, v10, v19, v20
    s_or_b64 vcc, vcc, s[46:47]
    s_cbranch_scc1 L_s_xf_219
L_s_xok_220:
    v_max_f32_dpp v11, v10, v10 row_ror:8 row_mask:0xf bank_mask:0xf
    v_max_f32_dpp v10, v10, v10 row_ror:8 row_mask:0xf bank_mask:0xf
    s_nop 1
    v_permlane16_swap_b32 v10, v11
    v_max_f32 v12, v10, v11
    v_max_f32 v10, v10, v11
    s_nop 1
    v_permlane32_swap_b32 v10, v12
    v_max_f32 v10, v10, v12
    v_mul_f32 v10, s66, v10
    v_fma_f32 v16, v16, s66, -v10
    v_fma_f32 v17, v17, s66, -v10
    v_fma_f32 v18, v18, s66, -v10
    v_fma_f32 v19, v19, s66, -v10
    v_fma_f32 v20, v20, s66, -v10
    v_exp_f32 v16, v16
    v_exp_f32 v17, v17
    v_exp_f32 v18, v18
    v_exp_f32 v19, v19
    v_exp_f32 v20, v20
    v_add_f32 v10, v16, v17
    v_add_f32 v11, v18, v19
    v_add_f32 v10, v10, v20
    v_add_f32 v10, v10, v11
    s_nop 1
    v_add_f32_dpp v11, v10, v10 row_ror:8 row_mask:0xf bank_mask:0xf
    v_add_f32_dpp v10, v10, v10 row_ror:8 row_mask:0xf bank_mask:0xf
    s_nop 1
    v_permlane16_swap_b32 v10, v11
    v_add_f32 v12, v10, v11
    v_add_f32 v10, v10, v11
    s_nop 1
    v_permlane32_swap_b32 v10, v12
    v_add_f32 v10, v10, v12
    v_rcp_f32 v10, v10
    s_nop 0
    v_mul_f32 v16, v16, v10
    v_mul_f32 v17, v17, v10
    v_mul_f32 v18, v18, v10
    v_mul_f32 v19, v19, v10
    v_mul_f32 v20, v20, v10
    v_cvt_pk_bf16_f32 v16, v16, v17
    v_cvt_pk_bf16_f32 v17, v18, v19
    v_cvt_pk_bf16_f32 v18, v20, v20
    ds_write_b64 v8, v[16:17]
    ds_write_b16 v9, v18
    s_add_u32 s63, s63, 786432
    s_cmp_ge_u32 s44, 2
    s_cbranch_scc1 L_s_nk_221
    buffer_load_dwordx4 v[32:35], v6, s[12:15], s63 offen sc1
L_s_nk_221:
    s_add_u32 s45, s63, 786432
    s_mov_b64 exec, 0xf
    buffer_load_dword v15, v14, s[12:15], s45 offen sc1
    s_mov_b64 exec, -1
    s_waitcnt lgkmcnt(0)
    s_barrier
    s_cmp_eq_u32 s44, 3
    s_cbranch_scc1 L_s_nr_222
    s_xor_b32 s45, s61, 0x8000
    s_mov_b64 exec, s[50:51]
    buffer_store_dwordx4 v[24:27], v4, s[12:15], s45 offen
    s_mov_b64 exec, -1
L_s_nr_222:
    s_cmp_lg_u32 s44, 3
    s_cbranch_scc1 L_s_np_223
    ds_read_b128 v[20:23], v6
    s_lshl_b32 s45, s60, 17
    s_add_u32 s45, s45, s67
    s_waitcnt lgkmcnt(0)
    v_min_u32 v20, -2, v20
    v_min_u32 v21, -2, v21
    v_min_u32 v22, -2, v22
    v_min_u32 v23, -2, v23
    buffer_store_dwordx4 v[20:23], v2, s[12:15], s45 offen sc1
L_s_np_223:
    s_add_u32 s68, s60, 3
    s_min_u32 s68, s68, 63
    v_readlane_b32 s45, v0, 0
    v_readlane_b32 s46, v0, 1
    s_nop 0
    s_min_u32 s45, s45, s46
    s_max_u32 s69, s69, s45
    s_cmp_gt_u32 s69, s68
    s_cbranch_scc1 L_kv_ok_226
    s_mov_b32 s70, 0
L_kv_lp_225:
    v_and_b32 v22, 1, v1
    v_lshlrev_b32 v22, 9, v22
    buffer_load_dword v23, v22, s[12:15], s57 offen sc1
    s_waitcnt vmcnt(0)
    v_readlane_b32 s69, v23, 0
    v_readlane_b32 s45, v23, 1
    s_add_u32 s70, s70, 1
    s_nop 2
    s_min_u32 s69, s69, s45
    s_cmp_gt_u32 s69, s68
    s_cbranch_scc1 L_kv_ok_226
    s_sleep 4
    s_cmp_lt_u32 s70, 524288
    s_cbranch_scc1 L_kv_lp_225
    s_branch L_c_done_1
L_kv_ok_226:
    s_add_u32 s45, s60, 7
    s_min_u32 s45, s45, 63
    s_cmp_gt_u32 s69, s45
    s_cbranch_scc1 L_s_na_224
    v_and_b32 v22, 1, v1
    v_lshlrev_b32 v22, 9, v22
    buffer_load_dword v0, v22, s[12:15], s57 offen sc1
L_s_na_224:
    s_add_u32 s60, s60, 1
    s_add_u32 s61, s61, 0x4000
    s_and_b32 s61, s61, 0xffff
    s_branch L_s_loop_212
L_s_last_213:
    s_waitcnt lgkmcnt(0)
    s_barrier
    s_cmp_lg_u32 s44, 3
    s_cbranch_scc1 L_s_np_227
    ds_read_b128 v[20:23], v6
    s_lshl_b32 s45, s60, 17
    s_add_u32 s45, s45, s67
    s_waitcnt lgkmcnt(0)
    v_min_u32 v20, -2, v20
    v_min_u32 v21, -2, v21
    v_min_u32 v22, -2, v22
    v_min_u32 v23, -2, v23
    buffer_store_dwordx4 v[20:23], v2, s[12:15], s45 offen sc1
L_s_np_227:
    s_branch L_replica
L_rt_207:
    s_add_u32 s70, s70, 1
    s_cmp_lt_u32 s70, 524288
    s_cbranch_scc1 L_c_rp_206
    s_branch L_c_done_1
L_rt_217:
    s_add_u32 s70, s70, 1
    s_cmp_lt_u32 s70, 524288
    s_cbranch_scc1 L_s_xl_214
    s_branch L_c_done_1
L_s_w2_215:
    s_cmp_eq_u32 s44, 3
    s_cbranch_scc1 L_s_w3_216
    s_waitcnt lgkmcnt(0)
    v_mfma_f32_16x16x32_bf16 v[16:19], v[64:67], v[64:67], 0
    s_branch L_s_w2_215_b
L_s_w3_216:
    s_sleep 3
    s_branch L_s_w3_216_b
L_s_xf_219:
    v_max3_u32 v11, v64, v65, v66
    v_max3_u32 v11, v11, v67, v68
    v_max3_u32 v11, v11, v69, v70
    v_max3_u32 v11, v11, v71, v72
    v_max3_u32 v11, v11, v73, v74
    v_max3_u32 v11, v11, v75, v76
    v_max3_u32 v11, v11, v77, v78
    v_max3_u32 v11, v11, v79, v80
    v_max3_u32 v11, v11, v81, v82
    v_max_u32 v11, v11, v83
    v_cmp_eq_u32 vcc, -1, v11
    s_add_u32 s70, s70, 1
    s_cbranch_vccz L_s_xok_220
    s_cmp_lt_u32 s70, 524288
    s_cbranch_scc1 L_s_xp_218
    s_branch L_c_done_1
L_ss_209:
.p2align 6
L_s_loop_228:
    v_mov_b32 v16, 0
    v_mov_b32 v17, 0
    v_mov_b32 v18, 0
    v_mov_b32 v19, 0
    s_add_u32 s58, s58, 4
    s_mov_b32 s70, 1
    s_waitcnt vmcnt(0)
    s_barrier
    ds_read_b128 v[64:67], v2 offset:0
    ds_read_b128 v[68:71], v2 offset:1024
    ds_read_b128 v[72:75], v2 offset:2048
    ds_read_b128 v[76:79], v2 offset:3072
    ds_read_b128 v[80:83], v2 offset:4096
    ds_read_b128 v[84:87], v2 offset:5120
    ds_read_b128 v[88:91], v2 offset:6144
    ds_read_b128 v[92:95], v2 offset:7168
    ds_read_b128 v[96:99], v2 offset:8192
    ds_read_b128 v[100:103], v2 offset:9216
    ds_read_b128 v[104:107], v2 offset:10240
    ds_read_b128 v[108:111], v2 offset:11264
    s_waitcnt lgkmcnt(11)
    v_smfmac_f32_16x16x64_bf16 v[16:19], v[64:67], a[0:7], v3
    ds_read_b128 v[112:115], v2 offset:12288
    s_waitcnt lgkmcnt(11)
    v_smfmac_f32_16x16x64_bf16 v[16:19], v[68:71], a[8:15], v3
    ds_read_b128 v[116:119], v2 offset:13312
    s_waitcnt lgkmcnt(11)
    v_smfmac_f32_16x16x64_bf16 v[16:19], v[72:75], a[16:23], v3
    ds_read_b128 v[120:123], v2 offset:14336
    s_waitcnt lgkmcnt(11)
    v_smfmac_f32_16x16x64_bf16 v[16:19], v[76:79], a[24:31], v3
    ds_read_b128 v[124:127], v2 offset:15360
    s_waitcnt lgkmcnt(11)
    v_smfmac_f32_16x16x64_bf16 v[16:19], v[80:83], a[32:39], v3
    s_waitcnt lgkmcnt(10)
    v_smfmac_f32_16x16x64_bf16 v[16:19], v[84:87], a[40:47], v3
    s_waitcnt lgkmcnt(9)
    v_smfmac_f32_16x16x64_bf16 v[16:19], v[88:91], a[48:55], v3
    s_waitcnt lgkmcnt(8)
    v_smfmac_f32_16x16x64_bf16 v[16:19], v[92:95], a[56:63], v3
    s_waitcnt lgkmcnt(7)
    v_smfmac_f32_16x16x64_bf16 v[16:19], v[96:99], a[64:71], v3
    s_waitcnt lgkmcnt(6)
    v_smfmac_f32_16x16x64_bf16 v[16:19], v[100:103], a[72:79], v3
    s_waitcnt lgkmcnt(5)
    v_smfmac_f32_16x16x64_bf16 v[16:19], v[104:107], a[80:87], v3
    s_waitcnt lgkmcnt(4)
    v_smfmac_f32_16x16x64_bf16 v[16:19], v[108:111], a[88:95], v3
    s_waitcnt lgkmcnt(3)
    v_smfmac_f32_16x16x64_bf16 v[16:19], v[112:115], a[96:103], v3
    s_waitcnt lgkmcnt(2)
    v_smfmac_f32_16x16x64_bf16 v[16:19], v[116:119], a[104:111], v3
    s_waitcnt lgkmcnt(1)
    v_smfmac_f32_16x16x64_bf16 v[16:19], v[120:123], a[112:119], v3
    s_waitcnt lgkmcnt(0)
    v_smfmac_f32_16x16x64_bf16 v[16:19], v[124:127], a[120:127], v3
    s_nop 7
    v_permlane32_swap_b32 v16, v18
    v_permlane32_swap_b32 v17, v19
    v_add_f32 v16, v16, v18
    v_add_f32 v17, v17, v19
    v_cvt_pk_bf16_f32 v16, v16, v17
    ds_write_b16 v5, v16
    ds_write_b16_d16_hi v5, v16 offset:16
    s_mov_b64 exec, 1
    ds_add_u32 v29, v30
    s_mov_b64 exec, -1
L_s_xl_230:
    ds_read_b32 v10, v29
    ds_read_b128 v[64:67], v2 offset:61440
    s_cmp_eq_u32 s60, 63
    s_cbranch_scc1 L_s_last_229
    s_cmp_ge_u32 s44, 2
    s_cbranch_scc1 L_s_w2_231
    s_waitcnt lgkmcnt(0)
    v_mfma_f32_16x16x32_bf16 v[16:19], v[32:35], v[64:67], 0
L_s_w2_231_b:
    v_cmp_ne_u32 vcc, s58, v10
    s_nop 0
    s_cbranch_vccnz L_rt_233
    s_mov_b64 exec, s[50:51]
    s_nop 3
    v_min_u32 v16, -2, v16
    v_min_u32 v17, -2, v17
    v_min_u32 v18, -2, v18
    v_min_u32 v19, -2, v19
    buffer_store_dwordx4 v[16:19], v4, s[12:15], s61 offen sc1
    s_mov_b64 exec, -1
L_s_w3_232_b:
    s_sleep 5
    s_mov_b32 s70, 1
L_s_xp_234:
    buffer_load_dwordx4 v[64:67], v7, s[12:15], s61 offen offset:0 sc1
    buffer_load_dword v80, v28, s[12:15], s61 offen offset:0 sc1
    buffer_load_dwordx4 v[68:71], v7, s[12:15], s61 offen offset:1024 sc1
    buffer_load_dword v81, v28, s[12:15], s61 offen offset:256 sc1
    buffer_load_dwordx4 v[72:75], v7, s[12:15], s61 offen offset:2048 sc1
    buffer_load_dword v82, v28, s[12:15], s61 offen offset:512 sc1
    buffer_load_dwordx4 v[76:79], v7, s[12:15], s61 offen offset:3072 sc1
    buffer_load_dword v83, v28, s[12:15], s61 offen offset:768 sc1
    s_waitcnt vmcnt(4)
    v_add_f32 v16, v64, v68
    v_add_f32 v17, v65, v69
    v_add_f32 v18, v66, v70
    v_add_f32 v19, v67, v71
    v_add_f32 v20, v80, v81
    s_waitcnt vmcnt(2)
    v_add_f32 v16, v16, v72
    v_add_f32 v17, v17, v73
    v_add_f32 v18, v18, v74
    v_add_f32 v19, v19, v75
    v_add_f32 v20, v20, v82
    s_waitcnt vmcnt(0)
    v_add_f32 v16, v16, v76
    v_add_f32 v17, v17, v77
    v_add_f32 v18, v18, v78
    v_add_f32 v19, v19, v79
    v_add_f32 v20, v20, v83
    v_cmp_u_f32 s[46:47], v16, v17
    v_cmp_u_f32 s[48:49], v18, v19
    v_cmp_u_f32 vcc, v20, v20
    v_max3_f32 v10, v16, v17, v18
    s_or_b64 s[46:47], s[46:47], s[48:49]
    v_max3_f32 v10, v10, v19, v20
    s_or_b64 vcc, vcc, s[46:47]
    s_cbranch_scc1 L_s_xf_235
L_s_xok_236:
    v_max_f32_dpp v11, v10, v10 row_ror:8 row_mask:0xf bank_mask:0xf
    v_max_f32_dpp v10, v10, v10 row_ror:8 row_mask:0xf bank_mask:0xf
    s_nop 1
    v_permlane16_swap_b32 v10, v11
    v_max_f32 v12, v10, v11
    v_max_f32 v10, v10, v11
    s_nop 1
    v_permlane32_swap_b32 v10, v12
    v_max_f32 v10, v10, v12
    v_mul_f32 v10, s66, v10
    v_fma_f32 v16, v16, s66, -v10
    v_fma_f32 v17, v17, s66, -v10
    v_fma_f32 v18, v18, s66, -v10
    v_fma_f32 v19, v19, s66, -v10
    v_fma_f32 v20, v20, s66, -v10
    v_exp_f32 v16, v16
    v_exp_f32 v17, v17
    v_exp_f32 v18, v18
    v_exp_f32 v19, v19
    v_exp_f32 v20, v20
    v_add_f32 v10, v16, v17
    v_add_f32 v11, v18, v19
    v_add_f32 v10, v10, v20
    v_add_f32 v10, v10, v11
    s_nop 1
    v_add_f32_dpp v11, v10, v10 row_ror:8 row_mask:0xf bank_mask:0xf
    v_add_f32_dpp v10, v10, v10 row_ror:8 row_mask:0xf bank_mask:0xf
    s_nop 1
    v_permlane16_swap_b32 v10, v11
    v_add_f32 v12, v10, v11
    v_add_f32 v10, v10, v11
    s_nop 1
    v_permlane32_swap_b32 v10, v12
    v_add_f32 v10, v10, v12
    v_rcp_f32 v10, v10
    s_nop 0
    v_mul_f32 v16, v16, v10
    v_mul_f32 v17, v17, v10
    v_mul_f32 v18, v18, v10
    v_mul_f32 v19, v19, v10
    v_mul_f32 v20, v20, v10
    v_cvt_pk_bf16_f32 v16, v16, v17
    v_cvt_pk_bf16_f32 v17, v18, v19
    v_cvt_pk_bf16_f32 v18, v20, v20
    ds_write_b64 v8, v[16:17]
    ds_write_b16 v9, v18
    s_add_u32 s63, s63, 786432
    s_cmp_ge_u32 s44, 2
    s_cbranch_scc1 L_s_nk_237
    buffer_load_dwordx4 v[32:35], v6, s[12:15], s63 offen sc1
L_s_nk_237:
    s_add_u32 s45, s63, 786432
    s_mov_b64 exec, 0xf
    buffer_load_dword v15, v14, s[12:15], s45 offen sc1
    s_mov_b64 exec, -1
    s_waitcnt lgkmcnt(0)
    s_barrier
    s_cmp_eq_u32 s44, 3
    s_cbranch_scc1 L_s_nr_238
    s_xor_b32 s45, s61, 0x8000
    s_mov_b64 exec, s[50:51]
    buffer_store_dwordx4 v[24:27], v4, s[12:15], s45 offen sc1
    s_mov_b64 exec, -1
L_s_nr_238:
    s_cmp_lg_u32 s44, 3
    s_cbranch_scc1 L_s_np_239
    ds_read_b128 v[20:23], v6
    s_lshl_b32 s45, s60, 17
    s_add_u32 s45, s45, s67
    s_waitcnt lgkmcnt(0)
    v_min_u32 v20, -2, v20
    v_min_u32 v21, -2, v21
    v_min_u32 v22, -2, v22
    v_min_u32 v23, -2, v23
    buffer_store_dwordx4 v[20:23], v2, s[12:15], s45 offen sc1
L_s_np_239:
    s_add_u32 s68, s60, 3
    s_min_u32 s68, s68, 63
    v_readlane_b32 s45, v0, 0
    v_readlane_b32 s46, v0, 1
    s_nop 0
    s_min_u32 s45, s45, s46
    s_max_u32 s69, s69, s45
    s_cmp_gt_u32 s69, s68
    s_cbranch_scc1 L_kv_ok_242
    s_mov_b32 s70, 0
L_kv_lp_241:
    v_and_b32 v22, 1, v1
    v_lshlrev_b32 v22, 9, v22
    buffer_load_dword v23, v22, s[12:15], s57 offen sc1
    s_waitcnt vmcnt(0)
    v_readlane_b32 s69, v23, 0
    v_readlane_b32 s45, v23, 1
    s_add_u32 s70, s70, 1
    s_nop 2
    s_min_u32 s69, s69, s45
    s_cmp_gt_u32 s69, s68
    s_cbranch_scc1 L_kv_ok_242
    s_sleep 4
    s_cmp_lt_u32 s70, 524288
    s_cbranch_scc1 L_kv_lp_241
    s_branch L_c_done_1
L_kv_ok_242:
    s_add_u32 s45, s60, 7
    s_min_u32 s45, s45, 63
    s_cmp_gt_u32 s69, s45
    s_cbranch_scc1 L_s_na_240
    v_and_b32 v22, 1, v1
    v_lshlrev_b32 v22, 9, v22
    buffer_load_dword v0, v22, s[12:15], s57 offen sc1
L_s_na_240:
    s_add_u32 s60, s60, 1
    s_add_u32 s61, s61, 0x4000
    s_and_b32 s61, s61, 0xffff
    s_branch L_s_loop_228
L_s_last_229:
    s_waitcnt lgkmcnt(0)
    s_barrier
    s_cmp_lg_u32 s44, 3
    s_cbranch_scc1 L_s_np_243
    ds_read_b128 v[20:23], v6
    s_lshl_b32 s45, s60, 17
    s_add_u32 s45, s45, s67
    s_waitcnt lgkmcnt(0)
    v_min_u32 v20, -2, v20
    v_min_u32 v21, -2, v21
    v_min_u32 v22, -2, v22
    v_min_u32 v23, -2, v23
    buffer_store_dwordx4 v[20:23], v2, s[12:15], s45 offen sc1
L_s_np_243:
    s_branch L_replica
L_rt_233:
    s_add_u32 s70, s70, 1
    s_cmp_lt_u32 s70, 524288
    s_cbranch_scc1 L_s_xl_230
    s_branch L_c_done_1
L_s_w2_231:
    s_cmp_eq_u32 s44, 3
    s_cbranch_scc1 L_s_w3_232
    s_waitcnt lgkmcnt(0)
    v_mfma_f32_16x16x32_bf16 v[16:19], v[64:67], v[64:67], 0
    s_branch L_s_w2_231_b
L_s_w3_232:
    s_sleep 3
    s_branch L_s_w3_232_b
L_s_xf_235:
    v_max3_u32 v11, v64, v65, v66
    v_max3_u32 v11, v11, v67, v68
    v_max3_u32 v11, v11, v69, v70
    v_max3_u32 v11, v11, v71, v72
    v_max3_u32 v11, v11, v73, v74
    v_max3_u32 v11, v11, v75, v76
    v_max3_u32 v11, v11, v77, v78
    v_max3_u32 v11, v11, v79, v80
    v_max3_u32 v11, v11, v81, v82
    v_max_u32 v11, v11, v83
    v_cmp_eq_u32 vcc, -1, v11
    s_add_u32 s70, s70, 1
    s_cbranch_vccz L_s_xok_236
    s_cmp_lt_u32 s70, 524288
    s_cbranch_scc1 L_s_xp_234
    s_branch L_c_done_1
L_vf_210:
    s_cmp_eq_u32 s52, 0
    s_cbranch_scc1 L_vs_211
    s_mov_b32 s70, 1
    v_mov_b32 v16, 0
    v_mov_b32 v17, 0
    s_branch L_v_l1m_246
.p2align 6
L_v_loop_244:
    s_mov_b32 s70, 1
    buffer_load_dwordx4 v[64:67], v9, s[12:15], s61 offen offset:0 sc1
    buffer_load_dwordx4 v[68:71], v9, s[12:15], s61 offen offset:1024 sc1
    buffer_load_dwordx4 v[72:75], v9, s[12:15], s61 offen offset:2048 sc1
    buffer_load_dwordx4 v[76:79], v9, s[12:15], s61 offen offset:3072 sc1
    v_mov_b32 v16, 0
    v_mov_b32 v17, 0
    v_mov_b32 v18, 0
    v_mov_b32 v19, 0
    v_mov_b32 v20, 0
    v_mov_b32 v21, 0
    v_mov_b32 v22, 0
    v_mov_b32 v23, 0
L_v_l1m_246:
    s_waitcnt vmcnt(3)
    ds_write_b128 v10, v[64:67] offset:0
    v_max3_u32 v24, v64, v65, v66
    v_max_u32 v24, v24, v67
    v_cmp_eq_u32 s[48:49], -1, v24
    s_waitcnt vmcnt(2)
    ds_write_b128 v10, v[68:71] offset:1024
    v_max3_u32 v24, v68, v69, v70
    v_max_u32 v24, v24, v71
    v_cmp_eq_u32 s[50:51], -1, v24
    s_waitcnt vmcnt(1)
    ds_write_b128 v10, v[72:75] offset:2048
    v_max3_u32 v24, v72, v73, v74
    v_max_u32 v24, v24, v75
    v_cmp_eq_u32 s[52:53], -1, v24
    s_waitcnt vmcnt(0)
    ds_write_b128 v10, v[76:79] offset:3072
    v_max3_u32 v24, v76, v77, v78
    v_max_u32 v24, v24, v79
    v_cmp_eq_u32 s[54:55], -1, v24
    s_or_b64 s[46:47], s[48:49], s[50:51]
    s_or_b64 vcc, s[52:53], s[54:55]
    s_or_b64 vcc, vcc, s[46:47]
    s_cbranch_scc1 L_v_l1_245
L_v_l1ok_247:
    s_waitcnt lgkmcnt(0)
    s_barrier
    v_smfmac_f32_16x16x64_bf16 v[16:19], v[64:67], a[0:7], v3
    v_smfmac_f32_16x16x64_bf16 v[20:23], v[64:67], a[32:39], v3
    v_smfmac_f32_16x16x64_bf16 v[16:19], v[68:71], a[8:15], v3
    v_smfmac_f32_16x16x64_bf16 v[20:23], v[68:71], a[40:47], v3
    v_smfmac_f32_16x16x64_bf16 v[16:19], v[72:75], a[16:23], v3
    v_smfmac_f32_16x16x64_bf16 v[20:23], v[72:75], a[48:55], v3
    v_smfmac_f32_16x16x64_bf16 v[16:19], v[76:79], a[24:31], v3
    v_smfmac_f32_16x16x64_bf16 v[20:23], v[76:79], a[56:63], v3
    s_add_u32 s46, s65, 4096
    buffer_load_dwordx4 v[32:35], v15, s[12:15], s65 offen offset:0 sc1
    buffer_load_dwordx4 v[48:51], v15, s[12:15], s46 offen offset:0 sc1
    buffer_load_dwordx4 v[36:39], v15, s[12:15], s65 offen offset:1024 sc1
    buffer_load_dwordx4 v[52:55], v15, s[12:15], s46 offen offset:1024 sc1
    buffer_load_dwordx4 v[40:43], v15, s[12:15], s65 offen offset:2048 sc1
    buffer_load_dwordx4 v[56:59], v15, s[12:15], s46 offen offset:2048 sc1
    buffer_load_dwordx4 v[44:47], v15, s[12:15], s65 offen offset:3072 sc1
    buffer_load_dwordx4 v[60:63], v15, s[12:15], s46 offen offset:3072 sc1
    s_add_u32 s65, s65, 786432
    v_permlane32_swap_b32 v16, v18
    v_permlane32_swap_b32 v17, v19
    v_permlane32_swap_b32 v20, v22
    v_permlane32_swap_b32 v21, v23
    v_add_f32 v16, v16, v18
    v_add_f32 v17, v17, v19
    v_add_f32 v18, v20, v22
    v_add_f32 v19, v21, v23
    ds_write_b128 v14, v[16:19]
    s_mov_b64 exec, 1
    ds_add_u32 v29, v30
    s_mov_b64 exec, -1
    s_add_u32 s58, s58, 4
    s_bitcmp1_b32 s44, 0
    s_cbranch_scc1 L_v_k1_249
    s_mov_b32 s70, 0
L_v_rl_250:
    ds_read_b32 v24, v29
    ds_read_b64 v[16:17], v13 offset:0
    ds_read_b64 v[18:19], v13 offset:1024
    ds_read_b64 v[20:21], v13 offset:2048
    ds_read_b64 v[22:23], v13 offset:3072
    s_waitcnt lgkmcnt(2)
    v_cmp_ne_u32 vcc, s58, v24
    v_add_f32 v16, v16, v18
    v_add_f32 v17, v17, v19
    s_waitcnt lgkmcnt(0)
    s_cbranch_vccnz L_rt_251
    v_add_f32 v20, v20, v22
    v_add_f32 v21, v21, v23
    v_add_f32 v16, v16, v20
    v_add_f32 v17, v17, v21
    s_mov_b32 vcc_lo, 0x55555555
    s_mov_b32 vcc_hi, 0x55555555
    v_cndmask_b32_dpp v18, v17, v16, vcc quad_perm:[1,0,3,2] row_mask:0xf bank_mask:0xf
    s_not_b64 vcc, vcc
    v_cndmask_b32_dpp v19, v16, v17, vcc quad_perm:[1,0,3,2] row_mask:0xf bank_mask:0xf
    v_cvt_pk_bf16_f32 v18, v18, v19
    v_min_u32 v18, -2, v18
    buffer_store_dword v18, v4, s[12:15], s62 offen
    ds_write_b32 v5, v18
L_v_k1_249:
    s_cmp_eq_u32 s60, 63
    s_cbranch_scc1 L_v_last_248
    ds_read_b128 v[80:83], v27 offset:32768
    ds_read_b128 v[84:87], v27 offset:36864
    ds_read_b128 v[88:91], v27 offset:40960
    ds_read_b128 v[92:95], v27 offset:45056
    v_mov_b32 v96, 0
    v_mov_b32 v97, 0
    v_mov_b32 v98, 0
    v_mov_b32 v99, 0
    v_mov_b32 v100, 0
    v_mov_b32 v101, 0
    v_mov_b32 v102, 0
    v_mov_b32 v103, 0
    v_mov_b32 v104, 0
    v_mov_b32 v105, 0
    v_mov_b32 v106, 0
    v_mov_b32 v107, 0
    v_mov_b32 v108, 0
    v_mov_b32 v109, 0
    v_mov_b32 v110, 0
    v_mov_b32 v111, 0
    s_bitcmp1_b32 s44, 0
    s_cbranch_scc0 L_v_sv_252
    s_sleep 3
L_v_sv_252:
    s_sleep 4
    s_mov_b32 s70, 1
L_v_vp_253:
    buffer_load_dwordx4 v[64:67], v11, s[12:15], s62 offen offset:0 sc1
    buffer_load_dwordx4 v[68:71], v11, s[12:15], s62 offen offset:1024 sc1
    s_waitcnt vmcnt(0)
    v_max3_u32 v20, v64, v65, v66
    v_max3_u32 v20, v20, v67, v68
    v_max3_u32 v20, v20, v69, v70
    v_max_u32 v20, v20, v71
    v_cmp_eq_u32 vcc, -1, v20
    s_cbranch_vccnz L_rt_254
    v_smfmac_f32_16x16x64_bf16 v[96:99], v[64:67], a[64:71], v3
    v_smfmac_f32_16x16x64_bf16 v[96:99], v[68:71], a[72:79], v3
    v_smfmac_f32_16x16x64_bf16 v[100:103], v[64:67], a[80:87], v3
    v_smfmac_f32_16x16x64_bf16 v[100:103], v[68:71], a[88:95], v3
    v_smfmac_f32_16x16x64_bf16 v[104:107], v[64:67], a[96:103], v3
    v_smfmac_f32_16x16x64_bf16 v[104:107], v[68:71], a[104:111], v3
    v_smfmac_f32_16x16x64_bf16 v[108:111], v[64:67], a[112:119], v3
    v_smfmac_f32_16x16x64_bf16 v[108:111], v[68:71], a[120:127], v3
    s_nop 1
    v_cvt_pk_bf16_f32 v96, v96, v97
    v_cvt_pk_bf16_f32 v97, v98, v99
    ds_write_b64 v12, v[96:97] offset:0
    v_cvt_pk_bf16_f32 v100, v100, v101
    v_cvt_pk_bf16_f32 v101, v102, v103
    ds_write_b64 v12, v[100:101] offset:2048
    v_cvt_pk_bf16_f32 v104, v104, v105
    v_cvt_pk_bf16_f32 v105, v106, v107
    ds_write_b64 v12, v[104:105] offset:4096
    v_cvt_pk_bf16_f32 v108, v108, v109
    v_cvt_pk_bf16_f32 v109, v110, v111
    ds_write_b64 v12, v[108:109] offset:6144
    s_waitcnt lgkmcnt(0)
    s_barrier
    ds_read_b128 v[96:99], v2 offset:16384
    ds_read_b128 v[100:103], v2 offset:17408
    ds_read_b128 v[104:107], v2 offset:18432
    ds_read_b128 v[108:111], v2 offset:19456
    ds_read_b128 v[112:115], v31 offset:0
    ds_read_b128 v[116:119], v25 offset:0
    ds_read_b128 v[120:123], v31 offset:512
    ds_read_b128 v[124:127], v25 offset:1024
    s_waitcnt lgkmcnt(7)
    v_mfma_f32_16x16x32_bf16 v[16:19], v[80:83], v[96:99], 0
    s_waitcnt lgkmcnt(6)
    v_mfma_f32_16x16x32_bf16 v[16:19], v[84:87], v[100:103], v[16:19]
    s_waitcnt lgkmcnt(5)
    v_mfma_f32_16x16x32_bf16 v[16:19], v[88:91], v[104:107], v[16:19]
    s_waitcnt lgkmcnt(4)
    v_mfma_f32_16x16x32_bf16 v[16:19], v[92:95], v[108:111], v[16:19]
    s_waitcnt lgkmcnt(2)
    v_mfma_f32_16x16x32_bf16 v[16:19], v[116:119], v[112:115], v[16:19]
    s_waitcnt lgkmcnt(0)
    v_mfma_f32_16x16x32_bf16 v[16:19], v[124:127], v[120:123], v[16:19]
    s_mov_b32 exec_lo, 0x00ff00ff
    s_mov_b32 exec_hi, 0x00ff00ff
    s_nop 5
    v_cvt_pk_bf16_f32 v16, v16, v17
    v_cvt_pk_bf16_f32 v17, v18, v19
    v_min_u32 v16, -2, v16
    v_min_u32 v17, -2, v17
    buffer_store_dwordx2 v[16:17], v6, s[12:15], s63 offen sc1
    s_mov_b64 exec, -1
    s_add_u32 s61, s61, 0x4000
    s_and_b32 s61, s61, 0xffff
    s_mov_b32 s70, 1
    s_waitcnt vmcnt(1)
    v_mfma_f32_16x16x32_bf16 v[64:67], v[32:35], a[64:67], 0
    v_mfma_f32_16x16x32_bf16 v[68:71], v[48:51], a[64:67], 0
    v_mfma_f32_16x16x32_bf16 v[64:67], v[36:39], a[68:71], v[64:67]
    v_mfma_f32_16x16x32_bf16 v[68:71], v[52:55], a[68:71], v[68:71]
    v_mfma_f32_16x16x32_bf16 v[64:67], v[40:43], a[72:75], v[64:67]
    v_mfma_f32_16x16x32_bf16 v[68:71], v[56:59], a[72:75], v[68:71]
    v_mfma_f32_16x16x32_bf16 v[64:67], v[44:47], a[76:79], v[64:67]
    v_mfma_f32_16x16x32_bf16 v[68:71], v[60:63], a[76:79], v[68:71]
    s_sleep 6
    buffer_load_dword v96, v7, s[12:15], s63 offen offset:0 sc1
    buffer_load_dword v97, v7, s[12:15], s63 offen offset:256 sc1
    buffer_load_dword v98, v7, s[12:15], s63 offen offset:512 sc1
    buffer_load_dword v99, v7, s[12:15], s63 offen offset:768 sc1
    buffer_load_dword v100, v7, s[12:15], s63 offen offset:1024 sc1
    buffer_load_dword v101, v7, s[12:15], s63 offen offset:1280 sc1
    buffer_load_dword v102, v7, s[12:15], s63 offen offset:1536 sc1
    buffer_load_dword v103, v7, s[12:15], s63 offen offset:1792 sc1
    v_mfma_f32_16x16x32_bf16 v[72:75], v[32:35], a[80:83], 0
    v_mfma_f32_16x16x32_bf16 v[76:79], v[48:51], a[80:83], 0
    v_mfma_f32_16x16x32_bf16 v[72:75], v[36:39], a[84:87], v[72:75]
    v_mfma_f32_16x16x32_bf16 v[76:79], v[52:55], a[84:87], v[76:79]
    v_mfma_f32_16x16x32_bf16 v[72:75], v[40:43], a[88:91], v[72:75]
    v_mfma_f32_16x16x32_bf16 v[76:79], v[56:59], a[88:91], v[76:79]
    v_mfma_f32_16x16x32_bf16 v[72:75], v[44:47], a[92:95], v[72:75]
    v_mfma_f32_16x16x32_bf16 v[76:79], v[60:63], a[92:95], v[76:79]
    v_cvt_pk_bf16_f32 v64, v64, v65
    v_cvt_pk_bf16_f32 v65, v66, v67
    v_cvt_pk_bf16_f32 v66, v68, v69
    v_cvt_pk_bf16_f32 v67, v70, v71
    ds_write_b128 v10, v[64:67] offset:32768
    v_mfma_f32_16x16x32_bf16 v[80:83], v[32:35], a[96:99], 0
    v_mfma_f32_16x16x32_bf16 v[84:87], v[48:51], a[96:99], 0
    v_mfma_f32_16x16x32_bf16 v[80:83], v[36:39], a[100:103], v[80:83]
    v_mfma_f32_16x16x32_bf16 v[84:87], v[52:55], a[100:103], v[84:87]
    v_mfma_f32_16x16x32_bf16 v[80:83], v[40:43], a[104:107], v[80:83]
    v_mfma_f32_16x16x32_bf16 v[84:87], v[56:59], a[104:107], v[84:87]
    v_mfma_f32_16x16x32_bf16 v[80:83], v[44:47], a[108:111], v[80:83]
    v_mfma_f32_16x16x32_bf16 v[84:87], v[60:63], a[108:111], v[84:87]
    v_cvt_pk_bf16_f32 v72, v72, v73
    v_cvt_pk_bf16_f32 v73, v74, v75
    v_cvt_pk_bf16_f32 v74, v76, v77
    v_cvt_pk_bf16_f32 v75, v78, v79
    ds_write_b128 v10, v[72:75] offset:33792
L_v_gp_255:
    s_waitcnt vmcnt(7)
    v_lshlrev_b32 v20, 16, v96
    v_and_b32 v21, 0xffff0000, v96
    s_waitcnt vmcnt(6)
    v_lshlrev_b32 v22, 16, v97
    v_and_b32 v23, 0xffff0000, v97
    v_add_f32 v20, v20, v22
    v_add_f32 v21, v21, v23
    s_waitcnt vmcnt(5)
    v_lshlrev_b32 v22, 16, v98
    v_and_b32 v23, 0xffff0000, v98
    v_add_f32 v20, v20, v22
    v_add_f32 v21, v21, v23
    s_waitcnt vmcnt(4)
    v_lshlrev_b32 v22, 16, v99
    v_and_b32 v23, 0xffff0000, v99
    v_add_f32 v20, v20, v22
    v_add_f32 v21, v21, v23
    s_waitcnt vmcnt(3)
    v_lshlrev_b32 v22, 16, v100
    v_and_b32 v23, 0xffff0000, v100
    v_add_f32 v20, v20, v22
    v_add_f32 v21, v21, v23
    s_waitcnt vmcnt(2)
    v_lshlrev_b32 v22, 16, v101
    v_and_b32 v23, 0xffff0000, v101
    v_add_f32 v20, v20, v22
    v_add_f32 v21, v21, v23
    s_waitcnt vmcnt(1)
    v_lshlrev_b32 v22, 16, v102
    v_and_b32 v23, 0xffff0000, v102
    v_add_f32 v20, v20, v22
    v_add_f32 v21, v21, v23
    s_waitcnt vmcnt(0)
    v_lshlrev_b32 v22, 16, v103
    v_and_b32 v23, 0xffff0000, v103
    v_add_f32 v20, v20, v22
    v_add_f32 v21, v21, v23
    v_cmp_u_f32 vcc, v20, v21
    v_cvt_pk_bf16_f32 v20, v20, v21
    s_cbranch_vccnz L_v_gf_257
L_v_gok_256:
    buffer_store_dword v20, v8, s[12:15], s61 offen
    s_xor_b32 s45, s61, 0x8000
    buffer_store_dword v26, v8, s[12:15], s45 offen
    s_bitcmp1_b32 s44, 0
    s_cbranch_scc1 L_v_nr_258
    s_xor_b32 s45, s62, 0x4000
    buffer_store_dword v26, v4, s[12:15], s45 offen
L_v_nr_258:
    s_add_u32 s60, s60, 1
    s_add_u32 s62, s62, 0x2000
    s_and_b32 s62, s62, 0x7fff
    s_and_b32 s45, s60, 0x38
    s_bitcmp1_b64 s[66:67], s45
    s_cselect_b32 s45, 8192, 0
    s_lshl_b32 s63, s60, 18
    s_add_u32 s63, s63, s45
    v_mfma_f32_16x16x32_bf16 v[88:91], v[32:35], a[112:115], 0
    v_mfma_f32_16x16x32_bf16 v[92:95], v[48:51], a[112:115], 0
    v_mfma_f32_16x16x32_bf16 v[88:91], v[36:39], a[116:119], v[88:91]
    v_mfma_f32_16x16x32_bf16 v[92:95], v[52:55], a[116:119], v[92:95]
    v_mfma_f32_16x16x32_bf16 v[88:91], v[40:43], a[120:123], v[88:91]
    v_mfma_f32_16x16x32_bf16 v[92:95], v[56:59], a[120:123], v[92:95]
    v_mfma_f32_16x16x32_bf16 v[88:91], v[44:47], a[124:127], v[88:91]
    v_mfma_f32_16x16x32_bf16 v[92:95], v[60:63], a[124:127], v[92:95]
    v_cvt_pk_bf16_f32 v80, v80, v81
    v_cvt_pk_bf16_f32 v81, v82, v83
    v_cvt_pk_bf16_f32 v82, v84, v85
    v_cvt_pk_bf16_f32 v83, v86, v87
    ds_write_b128 v10, v[80:83] offset:34816
    s_nop 2
    v_cvt_pk_bf16_f32 v88, v88, v89
    v_cvt_pk_bf16_f32 v89, v90, v91
    v_cvt_pk_bf16_f32 v90, v92, v93
    v_cvt_pk_bf16_f32 v91, v94, v95
    ds_write_b128 v10, v[88:91] offset:35840
    s_sleep 3
    s_branch L_v_loop_244
L_v_last_248:
    s_waitcnt lgkmcnt(0)
    s_barrier
    s_branch L_replica
L_v_l1_245:
    s_mov_b64 exec, s[48:49]
    s_cbranch_execz L_v_ls_259
    buffer_load_dwordx4 v[64:67], v9, s[12:15], s61 offen offset:0 sc1
L_v_ls_259:
    s_mov_b64 exec, s[50:51]
    s_cbranch_execz L_v_ls_260
    buffer_load_dwordx4 v[68:71], v9, s[12:15], s61 offen offset:1024 sc1
L_v_ls_260:
    s_mov_b64 exec, s[52:53]
    s_cbranch_execz L_v_ls_261
    buffer_load_dwordx4 v[72:75], v9, s[12:15], s61 offen offset:2048 sc1
L_v_ls_261:
    s_mov_b64 exec, s[54:55]
    s_cbranch_execz L_v_ls_262
    buffer_load_dwordx4 v[76:79], v9, s[12:15], s61 offen offset:3072 sc1
L_v_ls_262:
    s_mov_b64 exec, -1
    s_add_u32 s70, s70, 1
    s_cmp_ge_u32 s70, 524288
    s_cbranch_scc1 L_c_done_1
    s_waitcnt vmcnt(0)
    s_cmp_eq_u64 s[48:49], 0
    s_cbranch_scc1 L_v_lc_263
    ds_write_b128 v10, v[64:67] offset:0
    v_max3_u32 v24, v64, v65, v66
    v_max_u32 v24, v24, v67
    v_cmp_eq_u32 s[48:49], -1, v24
L_v_lc_263:
    s_cmp_eq_u64 s[50:51], 0
    s_cbranch_scc1 L_v_lc_264
    ds_write_b128 v10, v[68:71] offset:1024
    v_max3_u32 v24, v68, v69, v70
    v_max_u32 v24, v24, v71
    v_cmp_eq_u32 s[50:51], -1, v24
L_v_lc_264:
    s_cmp_eq_u64 s[52:53], 0
    s_cbranch_scc1 L_v_lc_265
    ds_write_b128 v10, v[72:75] offset:2048
    v_max3_u32 v24, v72, v73, v74
    v_max_u32 v24, v24, v75
    v_cmp_eq_u32 s[52:53], -1, v24
L_v_lc_265:
    s_cmp_eq_u64 s[54:55], 0
    s_cbranch_scc1 L_v_lc_266
    ds_write_b128 v10, v[76:79] offset:3072
    v_max3_u32 v24, v76, v77, v78
    v_max_u32 v24, v24, v79
    v_cmp_eq_u32 s[54:55], -1, v24
L_v_lc_266:
    s_or_b64 s[46:47], s[48:49], s[50:51]
    s_or_b64 vcc, s[52:53], s[54:55]
    s_or_b64 vcc, vcc, s[46:47]
    s_cbranch_scc1 L_v_l1_245
    s_branch L_v_l1ok_247
L_rt_251:
    s_add_u32 s70, s70, 1
    s_cmp_lt_u32 s70, 524288
    s_cbranch_scc1 L_v_rl_250
    s_branch L_c_done_1
L_rt_254:
    s_add_u32 s70, s70, 1
    s_cmp_lt_u32 s70, 524288
    s_cbranch_scc1 L_v_vp_253
    s_branch L_c_done_1
L_v_gf_257:
    v_max3_u32 v24, v96, v97, v98
    v_max3_u32 v24, v24, v99, v100
    v_max3_u32 v24, v24, v101, v102
    v_max_u32 v24, v24, v103
    v_cmp_eq_u32 vcc, -1, v24
    v_min_u32 v20, -2, v20
    s_add_u32 s70, s70, 1
    s_cbranch_vccz L_v_gok_256
    buffer_load_dword v96, v7, s[12:15], s63 offen offset:0 sc1
    buffer_load_dword v97, v7, s[12:15], s63 offen offset:256 sc1
    buffer_load_dword v98, v7, s[12:15], s63 offen offset:512 sc1
    buffer_load_dword v99, v7, s[12:15], s63 offen offset:768 sc1
    buffer_load_dword v100, v7, s[12:15], s63 offen offset:1024 sc1
    buffer_load_dword v101, v7, s[12:15], s63 offen offset:1280 sc1
    buffer_load_dword v102, v7, s[12:15], s63 offen offset:1536 sc1
    buffer_load_dword v103, v7, s[12:15], s63 offen offset:1792 sc1
    s_cmp_lt_u32 s70, 524288
    s_cbranch_scc1 L_v_gp_255
    s_branch L_c_done_1
L_vs_211:
    s_mov_b32 s70, 1
    v_mov_b32 v16, 0
    v_mov_b32 v17, 0
    s_branch L_v_l1m_269
.p2align 6
L_v_loop_267:
    s_mov_b32 s70, 1
    buffer_load_dwordx4 v[64:67], v9, s[12:15], s61 offen offset:0 sc1
    buffer_load_dwordx4 v[68:71], v9, s[12:15], s61 offen offset:1024 sc1
    buffer_load_dwordx4 v[72:75], v9, s[12:15], s61 offen offset:2048 sc1
    buffer_load_dwordx4 v[76:79], v9, s[12:15], s61 offen offset:3072 sc1
    v_mov_b32 v16, 0
    v_mov_b32 v17, 0
    v_mov_b32 v18, 0
    v_mov_b32 v19, 0
    v_mov_b32 v20, 0
    v_mov_b32 v21, 0
    v_mov_b32 v22, 0
    v_mov_b32 v23, 0
L_v_l1m_269:
    s_waitcnt vmcnt(3)
    ds_write_b128 v10, v[64:67] offset:0
    v_max3_u32 v24, v64, v65, v66
    v_max_u32 v24, v24, v67
    v_cmp_eq_u32 s[48:49], -1, v24
    s_waitcnt vmcnt(2)
    ds_write_b128 v10, v[68:71] offset:1024
    v_max3_u32 v24, v68, v69, v70
    v_max_u32 v24, v24, v71
    v_cmp_eq_u32 s[50:51], -1, v24
    s_waitcnt vmcnt(1)
    ds_write_b128 v10, v[72:75] offset:2048
    v_max3_u32 v24, v72, v73, v74
    v_max_u32 v24, v24, v75
    v_cmp_eq_u32 s[52:53], -1, v24
    s_waitcnt vmcnt(0)
    ds_write_b128 v10, v[76:79] offset:3072
    v_max3_u32 v24, v76, v77, v78
    v_max_u32 v24, v24, v79
    v_cmp_eq_u32 s[54:55], -1, v24
    s_or_b64 s[46:47], s[48:49], s[50:51]
    s_or_b64 vcc, s[52:53], s[54:55]
    s_or_b64 vcc, vcc, s[46:47]
    s_cbranch_scc1 L_v_l1_268
L_v_l1ok_270:
    s_waitcnt lgkmcnt(0)
    s_barrier
    v_smfmac_f32_16x16x64_bf16 v[16:19], v[64:67], a[0:7], v3
    v_smfmac_f32_16x16x64_bf16 v[20:23], v[64:67], a[32:39], v3
    v_smfmac_f32_16x16x64_bf16 v[16:19], v[68:71], a[8:15], v3
    v_smfmac_f32_16x16x64_bf16 v[20:23], v[68:71], a[40:47], v3
    v_smfmac_f32_16x16x64_bf16 v[16:19], v[72:75], a[16:23], v3
    v_smfmac_f32_16x16x64_bf16 v[20:23], v[72:75], a[48:55], v3
    v_smfmac_f32_16x16x64_bf16 v[16:19], v[76:79], a[24:31], v3
    v_smfmac_f32_16x16x64_bf16 v[20:23], v[76:79], a[56:63], v3
    s_add_u32 s46, s65, 4096
    buffer_load_dwordx4 v[32:35], v15, s[12:15], s65 offen offset:0 sc1
    buffer_load_dwordx4 v[48:51], v15, s[12:15], s46 offen offset:0 sc1
    buffer_load_dwordx4 v[36:39], v15, s[12:15], s65 offen offset:1024 sc1
    buffer_load_dwordx4 v[52:55], v15, s[12:15], s46 offen offset:1024 sc1
    buffer_load_dwordx4 v[40:43], v15, s[12:15], s65 offen offset:2048 sc1
    buffer_load_dwordx4 v[56:59], v15, s[12:15], s46 offen offset:2048 sc1
    buffer_load_dwordx4 v[44:47], v15, s[12:15], s65 offen offset:3072 sc1
    buffer_load_dwordx4 v[60:63], v15, s[12:15], s46 offen offset:3072 sc1
    s_add_u32 s65, s65, 786432
    v_permlane32_swap_b32 v16, v18
    v_permlane32_swap_b32 v17, v19
    v_permlane32_swap_b32 v20, v22
    v_permlane32_swap_b32 v21, v23
    v_add_f32 v16, v16, v18
    v_add_f32 v17, v17, v19
    v_add_f32 v18, v20, v22
    v_add_f32 v19, v21, v23
    ds_write_b128 v14, v[16:19]
    s_mov_b64 exec, 1
    ds_add_u32 v29, v30
    s_mov_b64 exec, -1
    s_add_u32 s58, s58, 4
    s_bitcmp1_b32 s44, 0
    s_cbranch_scc1 L_v_k1_272
    s_mov_b32 s70, 0
L_v_rl_273:
    ds_read_b32 v24, v29
    ds_read_b64 v[16:17], v13 offset:0
    ds_read_b64 v[18:19], v13 offset:1024
    ds_read_b64 v[20:21], v13 offset:2048
    ds_read_b64 v[22:23], v13 offset:3072
    s_waitcnt lgkmcnt(2)
    v_cmp_ne_u32 vcc, s58, v24
    v_add_f32 v16, v16, v18
    v_add_f32 v17, v17, v19
    s_waitcnt lgkmcnt(0)
    s_cbranch_vccnz L_rt_274
    v_add_f32 v20, v20, v22
    v_add_f32 v21, v21, v23
    v_add_f32 v16, v16, v20
    v_add_f32 v17, v17, v21
    s_mov_b32 vcc_lo, 0x55555555
    s_mov_b32 vcc_hi, 0x55555555
    v_cndmask_b32_dpp v18, v17, v16, vcc quad_perm:[1,0,3,2] row_mask:0xf bank_mask:0xf
    s_not_b64 vcc, vcc
    v_cndmask_b32_dpp v19, v16, v17, vcc quad_perm:[1,0,3,2] row_mask:0xf bank_mask:0xf
    v_cvt_pk_bf16_f32 v18, v18, v19
    v_min_u32 v18, -2, v18
    buffer_store_dword v18, v4, s[12:15], s62 offen sc1
    ds_write_b32 v5, v18
L_v_k1_272:
    s_cmp_eq_u32 s60, 63
    s_cbranch_scc1 L_v_last_271
    ds_read_b128 v[80:83], v27 offset:32768
    ds_read_b128 v[84:87], v27 offset:36864
    ds_read_b128 v[88:91], v27 offset:40960
    ds_read_b128 v[92:95], v27 offset:45056
    v_mov_b32 v96, 0
    v_mov_b32 v97, 0
    v_mov_b32 v98, 0
    v_mov_b32 v99, 0
    v_mov_b32 v100, 0
    v_mov_b32 v101, 0
    v_mov_b32 v102, 0
    v_mov_b32 v103, 0
    v_mov_b32 v104, 0
    v_mov_b32 v105, 0
    v_mov_b32 v106, 0
    v_mov_b32 v107, 0
    v_mov_b32 v108, 0
    v_mov_b32 v109, 0
    v_mov_b32 v110, 0
    v_mov_b32 v111, 0
    s_bitcmp1_b32 s44, 0
    s_cbranch_scc0 L_v_sv_275
    s_sleep 3
L_v_sv_275:
    s_sleep 4
    s_mov_b32 s70, 1
L_v_vp_276:
    buffer_load_dwordx4 v[64:67], v11, s[12:15], s62 offen offset:0 sc1
    buffer_load_dwordx4 v[68:71], v11, s[12:15], s62 offen offset:1024 sc1
    s_waitcnt vmcnt(0)
    v_max3_u32 v20, v64, v65, v66
    v_max3_u32 v20, v20, v67, v68
    v_max3_u32 v20, v20, v69, v70
    v_max_u32 v20, v20, v71
    v_cmp_eq_u32 vcc, -1, v20
    s_cbranch_vccnz L_rt_277
    v_smfmac_f32_16x16x64_bf16 v[96:99], v[64:67], a[64:71], v3
    v_smfmac_f32_16x16x64_bf16 v[96:99], v[68:71], a[72:79], v3
    v_smfmac_f32_16x16x64_bf16 v[100:103], v[64:67], a[80:87], v3
    v_smfmac_f32_16x16x64_bf16 v[100:103], v[68:71], a[88:95], v3
    v_smfmac_f32_16x16x64_bf16 v[104:107], v[64:67], a[96:103], v3
    v_smfmac_f32_16x16x64_bf16 v[104:107], v[68:71], a[104:111], v3
    v_smfmac_f32_16x16x64_bf16 v[108:111], v[64:67], a[112:119], v3
    v_smfmac_f32_16x16x64_bf16 v[108:111], v[68:71], a[120:127], v3
    s_nop 1
    v_cvt_pk_bf16_f32 v96, v96, v97
    v_cvt_pk_bf16_f32 v97, v98, v99
    ds_write_b64 v12, v[96:97] offset:0
    v_cvt_pk_bf16_f32 v100, v100, v101
    v_cvt_pk_bf16_f32 v101, v102, v103
    ds_write_b64 v12, v[100:101] offset:2048
    v_cvt_pk_bf16_f32 v104, v104, v105
    v_cvt_pk_bf16_f32 v105, v106, v107
    ds_write_b64 v12, v[104:105] offset:4096
    v_cvt_pk_bf16_f32 v108, v108, v109
    v_cvt_pk_bf16_f32 v109, v110, v111
    ds_write_b64 v12, v[108:109] offset:6144
    s_waitcnt lgkmcnt(0)
    s_barrier
    ds_read_b128 v[96:99], v2 offset:16384
    ds_read_b128 v[100:103], v2 offset:17408
    ds_read_b128 v[104:107], v2 offset:18432
    ds_read_b128 v[108:111], v2 offset:19456
    ds_read_b128 v[112:115], v31 offset:0
    ds_read_b128 v[116:119], v25 offset:0
    ds_read_b128 v[120:123], v31 offset:512
    ds_read_b128 v[124:127], v25 offset:1024
    s_waitcnt lgkmcnt(7)
    v_mfma_f32_16x16x32_bf16 v[16:19], v[80:83], v[96:99], 0
    s_waitcnt lgkmcnt(6)
    v_mfma_f32_16x16x32_bf16 v[16:19], v[84:87], v[100:103], v[16:19]
    s_waitcnt lgkmcnt(5)
    v_mfma_f32_16x16x32_bf16 v[16:19], v[88:91], v[104:107], v[16:19]
    s_waitcnt lgkmcnt(4)
    v_mfma_f32_16x16x32_bf16 v[16:19], v[92:95], v[108:111], v[16:19]
    s_waitcnt lgkmcnt(2)
    v_mfma_f32_16x16x32_bf16 v[16:19], v[116:119], v[112:115], v[16:19]
    s_waitcnt lgkmcnt(0)
    v_mfma_f32_16x16x32_bf16 v[16:19], v[124:127], v[120:123], v[16:19]
    s_mov_b32 exec_lo, 0x00ff00ff
    s_mov_b32 exec_hi, 0x00ff00ff
    s_nop 5
    v_cvt_pk_bf16_f32 v16, v16, v17
    v_cvt_pk_bf16_f32 v17, v18, v19
    v_min_u32 v16, -2, v16
    v_min_u32 v17, -2, v17
    buffer_store_dwordx2 v[16:17], v6, s[12:15], s63 offen sc1
    s_mov_b64 exec, -1
    s_add_u32 s61, s61, 0x4000
    s_and_b32 s61, s61, 0xffff
    s_mov_b32 s70, 1
    s_waitcnt vmcnt(1)
    v_mfma_f32_16x16x32_bf16 v[64:67], v[32:35], a[64:67], 0
    v_mfma_f32_16x16x32_bf16 v[68:71], v[48:51], a[64:67], 0
    v_mfma_f32_16x16x32_bf16 v[64:67], v[36:39], a[68:71], v[64:67]
    v_mfma_f32_16x16x32_bf16 v[68:71], v[52:55], a[68:71], v[68:71]
    v_mfma_f32_16x16x32_bf16 v[64:67], v[40:43], a[72:75], v[64:67]
    v_mfma_f32_16x16x32_bf16 v[68:71], v[56:59], a[72:75], v[68:71]
    v_mfma_f32_16x16x32_bf16 v[64:67], v[44:47], a[76:79], v[64:67]
    v_mfma_f32_16x16x32_bf16 v[68:71], v[60:63], a[76:79], v[68:71]
    s_sleep 6
    buffer_load_dword v96, v7, s[12:15], s63 offen offset:0 sc1
    buffer_load_dword v97, v7, s[12:15], s63 offen offset:256 sc1
    buffer_load_dword v98, v7, s[12:15], s63 offen offset:512 sc1
    buffer_load_dword v99, v7, s[12:15], s63 offen offset:768 sc1
    buffer_load_dword v100, v7, s[12:15], s63 offen offset:1024 sc1
    buffer_load_dword v101, v7, s[12:15], s63 offen offset:1280 sc1
    buffer_load_dword v102, v7, s[12:15], s63 offen offset:1536 sc1
    buffer_load_dword v103, v7, s[12:15], s63 offen offset:1792 sc1
    v_mfma_f32_16x16x32_bf16 v[72:75], v[32:35], a[80:83], 0
    v_mfma_f32_16x16x32_bf16 v[76:79], v[48:51], a[80:83], 0
    v_mfma_f32_16x16x32_bf16 v[72:75], v[36:39], a[84:87], v[72:75]
    v_mfma_f32_16x16x32_bf16 v[76:79], v[52:55], a[84:87], v[76:79]
    v_mfma_f32_16x16x32_bf16 v[72:75], v[40:43], a[88:91], v[72:75]
    v_mfma_f32_16x16x32_bf16 v[76:79], v[56:59], a[88:91], v[76:79]
    v_mfma_f32_16x16x32_bf16 v[72:75], v[44:47], a[92:95], v[72:75]
    v_mfma_f32_16x16x32_bf16 v[76:79], v[60:63], a[92:95], v[76:79]
    v_cvt_pk_bf16_f32 v64, v64, v65
    v_cvt_pk_bf16_f32 v65, v66, v67
    v_cvt_pk_bf16_f32 v66, v68, v69
    v_cvt_pk_bf16_f32 v67, v70, v71
    ds_write_b128 v10, v[64:67] offset:32768
    v_mfma_f32_16x16x32_bf16 v[80:83], v[32:35], a[96:99], 0
    v_mfma_f32_16x16x32_bf16 v[84:87], v[48:51], a[96:99], 0
    v_mfma_f32_16x16x32_bf16 v[80:83], v[36:39], a[100:103], v[80:83]
    v_mfma_f32_16x16x32_bf16 v[84:87], v[52:55], a[100:103], v[84:87]
    v_mfma_f32_16x16x32_bf16 v[80:83], v[40:43], a[104:107], v[80:83]
    v_mfma_f32_16x16x32_bf16 v[84:87], v[56:59], a[104:107], v[84:87]
    v_mfma_f32_16x16x32_bf16 v[80:83], v[44:47], a[108:111], v[80:83]
    v_mfma_f32_16x16x32_bf16 v[84:87], v[60:63], a[108:111], v[84:87]
    v_cvt_pk_bf16_f32 v72, v72, v73
    v_cvt_pk_bf16_f32 v73, v74, v75
    v_cvt_pk_bf16_f32 v74, v76, v77
    v_cvt_pk_bf16_f32 v75, v78, v79
    ds_write_b128 v10, v[72:75] offset:33792
L_v_gp_278:
    s_waitcnt vmcnt(7)
    v_lshlrev_b32 v20, 16, v96
    v_and_b32 v21, 0xffff0000, v96
    s_waitcnt vmcnt(6)
    v_lshlrev_b32 v22, 16, v97
    v_and_b32 v23, 0xffff0000, v97
    v_add_f32 v20, v20, v22
    v_add_f32 v21, v21, v23
    s_waitcnt vmcnt(5)
    v_lshlrev_b32 v22, 16, v98
    v_and_b32 v23, 0xffff0000, v98
    v_add_f32 v20, v20, v22
    v_add_f32 v21, v21, v23
    s_waitcnt vmcnt(4)
    v_lshlrev_b32 v22, 16, v99
    v_and_b32 v23, 0xffff0000, v99
    v_add_f32 v20, v20, v22
    v_add_f32 v21, v21, v23
    s_waitcnt vmcnt(3)
    v_lshlrev_b32 v22, 16, v100
    v_and_b32 v23, 0xffff0000, v100
    v_add_f32 v20, v20, v22
    v_add_f32 v21, v21, v23
    s_waitcnt vmcnt(2)
    v_lshlrev_b32 v22, 16, v101
    v_and_b32 v23, 0xffff0000, v101
    v_add_f32 v20, v20, v22
    v_add_f32 v21, v21, v23
    s_waitcnt vmcnt(1)
    v_lshlrev_b32 v22, 16, v102
    v_and_b32 v23, 0xffff0000, v102
    v_add_f32 v20, v20, v22
    v_add_f32 v21, v21, v23
    s_waitcnt vmcnt(0)
    v_lshlrev_b32 v22, 16, v103
    v_and_b32 v23, 0xffff0000, v103
    v_add_f32 v20, v20, v22
    v_add_f32 v21, v21, v23
    v_cmp_u_f32 vcc, v20, v21
    v_cvt_pk_bf16_f32 v20, v20, v21
    s_cbranch_vccnz L_v_gf_280
L_v_gok_279:
    buffer_store_dword v20, v8, s[12:15], s61 offen sc1
    s_xor_b32 s45, s61, 0x8000
    buffer_store_dword v26, v8, s[12:15], s45 offen sc1
    s_bitcmp1_b32 s44, 0
    s_cbranch_scc1 L_v_nr_281
    s_xor_b32 s45, s62, 0x4000
    buffer_store_dword v26, v4, s[12:15], s45 offen sc1
L_v_nr_281:
    s_add_u32 s60, s60, 1
    s_add_u32 s62, s62, 0x2000
    s_and_b32 s62, s62, 0x7fff
    s_and_b32 s45, s60, 0x38
    s_bitcmp1_b64 s[66:67], s45
    s_cselect_b32 s45, 8192, 0
    s_lshl_b32 s63, s60, 18
    s_add_u32 s63, s63, s45
    v_mfma_f32_16x16x32_bf16 v[88:91], v[32:35], a[112:115], 0
    v_mfma_f32_16x16x32_bf16 v[92:95], v[48:51], a[112:115], 0
    v_mfma_f32_16x16x32_bf16 v[88:91], v[36:39], a[116:119], v[88:91]
    v_mfma_f32_16x16x32_bf16 v[92:95], v[52:55], a[116:119], v[92:95]
    v_mfma_f32_16x16x32_bf16 v[88:91], v[40:43], a[120:123], v[88:91]
    v_mfma_f32_16x16x32_bf16 v[92:95], v[56:59], a[120:123], v[92:95]
    v_mfma_f32_16x16x32_bf16 v[88:91], v[44:47], a[124:127], v[88:91]
    v_mfma_f32_16x16x32_bf16 v[92:95], v[60:63], a[124:127], v[92:95]
    v_cvt_pk_bf16_f32 v80, v80, v81
    v_cvt_pk_bf16_f32 v81, v82, v83
    v_cvt_pk_bf16_f32 v82, v84, v85
    v_cvt_pk_bf16_f32 v83, v86, v87
    ds_write_b128 v10, v[80:83] offset:34816
    s_nop 2
    v_cvt_pk_bf16_f32 v88, v88, v89
    v_cvt_pk_bf16_f32 v89, v90, v91
    v_cvt_pk_bf16_f32 v90, v92, v93
    v_cvt_pk_bf16_f32 v91, v94, v95
    ds_write_b128 v10, v[88:91] offset:35840
    s_sleep 3
    s_branch L_v_loop_267
L_v_last_271:
    s_waitcnt lgkmcnt(0)
    s_barrier
    s_branch L_replica
L_v_l1_268:
    s_mov_b64 exec, s[48:49]
    s_cbranch_execz L_v_ls_282
    buffer_load_dwordx4 v[64:67], v9, s[12:15], s61 offen offset:0 sc1
L_v_ls_282:
    s_mov_b64 exec, s[50:51]
    s_cbranch_execz L_v_ls_283
    buffer_load_dwordx4 v[68:71], v9, s[12:15], s61 offen offset:1024 sc1
L_v_ls_283:
    s_mov_b64 exec, s[52:53]
    s_cbranch_execz L_v_ls_284
    buffer_load_dwordx4 v[72:75], v9, s[12:15], s61 offen offset:2048 sc1
L_v_ls_284:
    s_mov_b64 exec, s[54:55]
    s_cbranch_execz L_v_ls_285
    buffer_load_dwordx4 v[76:79], v9, s[12:15], s61 offen offset:3072 sc1
L_v_ls_285:
    s_mov_b64 exec, -1
    s_add_u32 s70, s70, 1
    s_cmp_ge_u32 s70, 524288
    s_cbranch_scc1 L_c_done_1
    s_waitcnt vmcnt(0)
    s_cmp_eq_u64 s[48:49], 0
    s_cbranch_scc1 L_v_lc_286
    ds_write_b128 v10, v[64:67] offset:0
    v_max3_u32 v24, v64, v65, v66
    v_max_u32 v24, v24, v67
    v_cmp_eq_u32 s[48:49], -1, v24
L_v_lc_286:
    s_cmp_eq_u64 s[50:51], 0
    s_cbranch_scc1 L_v_lc_287
    ds_write_b128 v10, v[68:71] offset:1024
    v_max3_u32 v24, v68, v69, v70
    v_max_u32 v24, v24, v71
    v_cmp_eq_u32 s[50:51], -1, v24
L_v_lc_287:
    s_cmp_eq_u64 s[52:53], 0
    s_cbranch_scc1 L_v_lc_288
    ds_write_b128 v10, v[72:75] offset:2048
    v_max3_u32 v24, v72, v73, v74
    v_max_u32 v24, v24, v75
    v_cmp_eq_u32 s[52:53], -1, v24
L_v_lc_288:
    s_cmp_eq_u64 s[54:55], 0
    s_cbranch_scc1 L_v_lc_289
    ds_write_b128 v10, v[76:79] offset:3072
    v_max3_u32 v24, v76, v77, v78
    v_max_u32 v24, v24, v79
    v_cmp_eq_u32 s[54:55], -1, v24
L_v_lc_289:
    s_or_b64 s[46:47], s[48:49], s[50:51]
    s_or_b64 vcc, s[52:53], s[54:55]
    s_or_b64 vcc, vcc, s[46:47]
    s_cbranch_scc1 L_v_l1_268
    s_branch L_v_l1ok_270
L_rt_274:
    s_add_u32 s70, s70, 1
    s_cmp_lt_u32 s70, 524288
    s_cbranch_scc1 L_v_rl_273
    s_branch L_c_done_1
L_rt_277:
    s_add_u32 s70, s70, 1
    s_cmp_lt_u32 s70, 524288
    s_cbranch_scc1 L_v_vp_276
    s_branch L_c_done_1
L_v_gf_280:
    v_max3_u32 v24, v96, v97, v98
    v_max3_u32 v24, v24, v99, v100
    v_max3_u32 v24, v24, v101, v102
    v_max_u32 v24, v24, v103
    v_cmp_eq_u32 vcc, -1, v24
    v_min_u32 v20, -2, v20
    s_add_u32 s70, s70, 1
    s_cbranch_vccz L_v_gok_279
    buffer_load_dword v96, v7, s[12:15], s63 offen offset:0 sc1
    buffer_load_dword v97, v7, s[12:15], s63 offen offset:256 sc1
    buffer_load_dword v98, v7, s[12:15], s63 offen offset:512 sc1
    buffer_load_dword v99, v7, s[12:15], s63 offen offset:768 sc1
    buffer_load_dword v100, v7, s[12:15], s63 offen offset:1024 sc1
    buffer_load_dword v101, v7, s[12:15], s63 offen offset:1280 sc1
    buffer_load_dword v102, v7, s[12:15], s63 offen offset:1536 sc1
    buffer_load_dword v103, v7, s[12:15], s63 offen offset:1792 sc1
    s_cmp_lt_u32 s70, 524288
    s_cbranch_scc1 L_v_gp_278
    s_branch L_c_done_1
L_c_done_1:
    s_endpgm
.section .rodata,"a"
.p2align 6
.amdhsa_kernel k3_chain_kernel
  .amdhsa_next_free_vgpr 256
  .amdhsa_next_free_sgpr 102
  .amdhsa_accum_offset 128
  .amdhsa_group_segment_fixed_size 0
  .amdhsa_kernarg_size 136
  .amdhsa_user_sgpr_count 2
  .amdhsa_user_sgpr_kernarg_segment_ptr 1
  .amdhsa_system_sgpr_workgroup_id_x 1
.end_amdhsa_kernel
```

```asm
; @launch kernel=k3_chain_kernel grid=(256,1,1) block=(512,1,1) lds=147712
.amdgcn_target "amdgcn-amd-amdhsa--gfx950"
.text
.globl k3_chain_kernel
.p2align 8
.type k3_chain_kernel,@function
k3_chain_kernel:
    s_cmp_ge_u32 s2, 256
    s_cbranch_scc1 L_c_done_1
    s_load_dwordx4 s[20:23], s[0:1], 120
    v_and_b32 v1, 63, v0
    v_lshrrev_b32 v2, 6, v0
    s_nop 0
    v_readfirstlane_b32 s44, v2
    s_waitcnt lgkmcnt(0)
    s_mov_b32 s12, s22
    s_and_b32 s13, s23, 0xffff
    s_mov_b32 s14, 0x10000000
    s_mov_b32 s15, 0x00020000
    s_mov_b32 s16, s20
    s_and_b32 s17, s21, 0xffff
    s_mov_b32 s18, 0x100
    s_mov_b32 s19, 0x00020000
    s_getpc_b64 s[24:25]
L_c_here_2:
    v_lshlrev_b32 v3, 7, v0
    v_mov_b32 v5, s25
    v_add_co_u32 v4, vcc, s24, v3
    s_nop 1
    v_addc_co_u32 v5, vcc, 0, v5, vcc
    v_cmp_gt_u32 vcc, L_c_done_1 - L_c_here_2, v3
    s_and_saveexec_b64 s[26:27], vcc
    s_cbranch_execz L_c_ct_3
    global_load_dword v109, v[4:5], off
L_c_ct_3:
    s_mov_b64 exec, s[26:27]
    s_load_dwordx4 s[8:11], s[0:1], 96
    v_lshrrev_b32 v5, 3, v0
    v_mul_u32_u24 v6, 24576, v5
    v_and_b32 v7, 7, v0
    v_lshl_add_u32 v6, v7, 4, v6
    v_add_u32 v7, 12288, v6
    v_lshlrev_b32 v5, 2, v5
    s_lshr_b32 s50, s2, 5
    s_and_b32 s51, s2, 31
    s_mul_i32 s52, s50, 1572864
    s_lshl_b32 s53, s51, 7
    s_add_u32 s52, s52, s53
    s_lshl_b32 s53, s50, 8
    s_waitcnt lgkmcnt(0)
    s_mov_b32 s28, s10
    s_and_b32 s29, s11, 0xffff
    s_mov_b32 s30, 0xc00000
    s_mov_b32 s31, 0x00020000
    s_mov_b32 s32, s8
    s_and_b32 s33, s9, 0xffff
    s_mov_b32 s34, 0x800
    s_mov_b32 s35, 0x00020000
    buffer_load_dword v8, v5, s[32:35], s53 offen
    buffer_load_dwordx4 v[12:15], v6, s[28:31], s52 offen
    buffer_load_dwordx4 v[16:19], v7, s[28:31], s52 offen
    s_getreg_b32 s39, hwreg(HW_REG_XCC_ID)
    s_and_b32 s39, s39, 7
    s_cmp_lg_u32 s44, 1
    s_cbranch_scc1 L_nz_7
    v_mov_b32 v32, 0
    v_mov_b32 v33, 0
    v_mov_b32 v34, 0
    v_mov_b32 v35, 0
    v_lshlrev_b32 v4, 4, v1
    s_lshl_b32 s45, s2, 10
    s_add_u32 s45, s45, 0x100000
    buffer_store_dwordx4 v[32:35], v4, s[12:15], s45 offen sc1
L_nz_7:
    s_waitcnt vmcnt(0)
    v_lshlrev_b32 v9, 16, v8
    v_and_b32 v10, 0xffff0000, v8
    v_mul_f32 v20, 0xbfb8aa3b, v9
    v_mul_f32 v21, 0xbfb8aa3b, v10
    v_exp_f32 v20, v20
    v_exp_f32 v21, v21
    s_nop 0
    v_add_f32 v20, 1.0, v20
    v_add_f32 v21, 1.0, v21
    v_rcp_f32 v20, v20
    v_rcp_f32 v21, v21
    s_nop 0
    v_mul_f32 v9, v9, v20
    v_mul_f32 v10, v10, v21
    v_cvt_pk_bf16_f32 v9, 0, v9
    v_cvt_pk_bf16_f32 v10, 0, v10
    v_lshlrev_b32 v28, 16, v12
    v_and_b32 v29, 0xffff0000, v12
    v_lshlrev_b32 v30, 16, v16
    v_and_b32 v31, 0xffff0000, v16
    v_mul_f32 v20, v28, v9
    v_mul_f32 v21, v29, v9
    v_fmac_f32 v20, v30, v10
    v_fmac_f32 v21, v31, v10
    v_lshlrev_b32 v28, 16, v13
    v_and_b32 v29, 0xffff0000, v13
    v_lshlrev_b32 v30, 16, v17
    v_and_b32 v31, 0xffff0000, v17
    v_mul_f32 v22, v28, v9
    v_mul_f32 v23, v29, v9
    v_fmac_f32 v22, v30, v10
    v_fmac_f32 v23, v31, v10
    v_lshlrev_b32 v28, 16, v14
    v_and_b32 v29, 0xffff0000, v14
    v_lshlrev_b32 v30, 16, v18
    v_and_b32 v31, 0xffff0000, v18
    v_mul_f32 v24, v28, v9
    v_mul_f32 v25, v29, v9
    v_fmac_f32 v24, v30, v10
    v_fmac_f32 v25, v31, v10
    v_lshlrev_b32 v28, 16, v15
    v_and_b32 v29, 0xffff0000, v15
    v_lshlrev_b32 v30, 16, v19
    v_and_b32 v31, 0xffff0000, v19
    v_mul_f32 v26, v28, v9
    v_mul_f32 v27, v29, v9
    v_fmac_f32 v26, v30, v10
    v_fmac_f32 v27, v31, v10
    s_nop 1
    v_add_f32_dpp v20, v20, v20 row_ror:8 row_mask:0xf bank_mask:0xf
    v_add_f32_dpp v21, v21, v21 row_ror:8 row_mask:0xf bank_mask:0xf
    v_add_f32_dpp v22, v22, v22 row_ror:8 row_mask:0xf bank_mask:0xf
    v_add_f32_dpp v23, v23, v23 row_ror:8 row_mask:0xf bank_mask:0xf
    v_add_f32_dpp v24, v24, v24 row_ror:8 row_mask:0xf bank_mask:0xf
    v_add_f32_dpp v25, v25, v25 row_ror:8 row_mask:0xf bank_mask:0xf
    v_add_f32_dpp v26, v26, v26 row_ror:8 row_mask:0xf bank_mask:0xf
    v_add_f32_dpp v27, v27, v27 row_ror:8 row_mask:0xf bank_mask:0xf
    s_nop 1
    v_permlane16_swap_b32 v20, v24
    v_permlane16_swap_b32 v21, v25
    v_permlane16_swap_b32 v22, v26
    v_permlane16_swap_b32 v23, v27
    v_add_f32 v20, v20, v24
    v_add_f32 v21, v21, v25
    v_add_f32 v22, v22, v26
    v_add_f32 v23, v23, v27
    s_nop 1
    v_permlane32_swap_b32 v20, v22
    v_permlane32_swap_b32 v21, v23
    v_add_f32 v20, v20, v22
    v_add_f32 v21, v21, v23
    v_and_b32 v22, 7, v1
    v_lshlrev_b32 v22, 5, v22
    v_bfe_u32 v23, v1, 4, 1
    v_lshl_add_u32 v22, v23, 4, v22
    v_lshrrev_b32 v23, 5, v1
    v_lshl_add_u32 v22, v23, 3, v22
    s_lshl_b32 s52, s44, 8
    s_add_u32 s52, s52, 139776
    v_add_u32 v22, s52, v22
    ds_write_b64 v22, v[20:21]
    s_waitcnt lgkmcnt(0)
    s_barrier
    s_cmp_lg_u32 s44, 1
    s_cbranch_scc1 L_m1_8
    v_lshlrev_b32 v22, 2, v1
    v_add_u32 v23, 139776, v22
    ds_read_b32 v24, v23 offset:0
    ds_read_b32 v25, v23 offset:256
    ds_read_b32 v26, v23 offset:512
    ds_read_b32 v27, v23 offset:768
    ds_read_b32 v28, v23 offset:1024
    ds_read_b32 v29, v23 offset:1280
    ds_read_b32 v30, v23 offset:1536
    ds_read_b32 v31, v23 offset:1792
    s_waitcnt lgkmcnt(0)
    v_add_f32 v24, v24, v28
    v_add_f32 v25, v25, v29
    v_add_f32 v26, v26, v30
    v_add_f32 v27, v27, v31
    v_add_f32 v24, v24, v26
    v_add_f32 v25, v25, v27
    v_add_f32 v24, v24, v25
    s_lshl_b32 s52, s2, 8
    s_add_u32 s52, s52, 0x10000
    buffer_store_dword v24, v22, s[12:15], s52 offen sc1
L_m1_8:
    s_cmp_lg_u32 s44, 1
    s_cbranch_scc1 L_tk_4
    v_mov_b32 v3, 1
    s_mov_b32 s40, s39
    s_lshl_b32 s45, s40, 5
    v_mov_b32 v4, 0
    s_waitcnt vmcnt(0)
    s_mov_b64 exec, 1
    buffer_atomic_add v3, v4, s[16:19], s45 offen sc0
    s_waitcnt vmcnt(0)
    v_readfirstlane_b32 s41, v3
    s_nop 3
    s_cmp_lt_u32 s41, 32
    s_cbranch_scc1 L_got_5
    v_mov_b32 v3, 1
    buffer_atomic_add v3, v4, s[16:19], 0 offen offset:16 sc0
    s_waitcnt vmcnt(0)
    v_readfirstlane_b32 s46, v3
    s_mov_b64 exec, -1
    v_and_b32 v4, 7, v1
    v_lshlrev_b32 v4, 5, v4
    s_mov_b32 s70, 0
L_sp_6:
    s_sleep 8
    buffer_load_dword v3, v4, s[16:19], 0 offen sc1
    s_waitcnt vmcnt(0)
    s_mov_b32 s48, 0
    v_readlane_b32 s50, v3, 0
    v_readlane_b32 s51, v3, 1
    v_readlane_b32 s52, v3, 2
    v_readlane_b32 s53, v3, 3
    v_readlane_b32 s54, v3, 4
    v_readlane_b32 s55, v3, 5
    v_readlane_b32 s56, v3, 6
    v_readlane_b32 s57, v3, 7
    s_nop 3
    s_add_u32 s48, s48, s50
    s_add_u32 s48, s48, s51
    s_add_u32 s48, s48, s52
    s_add_u32 s48, s48, s53
    s_add_u32 s48, s48, s54
    s_add_u32 s48, s48, s55
    s_add_u32 s48, s48, s56
    s_add_u32 s48, s48, s57
    s_add_u32 s70, s70, 1
    s_cmp_ge_u32 s70, 524288
    s_cbranch_scc1 L_c_done_1
    s_cmp_lt_u32 s48, 256
    s_cbranch_scc1 L_sp_6
    s_min_u32 s48, s50, 32
    s_mov_b32 s40, 0
    s_add_u32 s41, s48, s46
    s_cmp_lt_u32 s41, 32
    s_cbranch_scc1 L_got_5
    s_sub_u32 s46, s41, 32
    s_min_u32 s48, s51, 32
    s_mov_b32 s40, 1
    s_add_u32 s41, s48, s46
    s_cmp_lt_u32 s41, 32
    s_cbranch_scc1 L_got_5
    s_sub_u32 s46, s41, 32
    s_min_u32 s48, s52, 32
    s_mov_b32 s40, 2
    s_add_u32 s41, s48, s46
    s_cmp_lt_u32 s41, 32
    s_cbranch_scc1 L_got_5
    s_sub_u32 s46, s41, 32
    s_min_u32 s48, s53, 32
    s_mov_b32 s40, 3
    s_add_u32 s41, s48, s46
    s_cmp_lt_u32 s41, 32
    s_cbranch_scc1 L_got_5
    s_sub_u32 s46, s41, 32
    s_min_u32 s48, s54, 32
    s_mov_b32 s40, 4
    s_add_u32 s41, s48, s46
    s_cmp_lt_u32 s41, 32
    s_cbranch_scc1 L_got_5
    s_sub_u32 s46, s41, 32
    s_min_u32 s48, s55, 32
    s_mov_b32 s40, 5
    s_add_u32 s41, s48, s46
    s_cmp_lt_u32 s41, 32
    s_cbranch_scc1 L_got_5
    s_sub_u32 s46, s41, 32
    s_min_u32 s48, s56, 32
    s_mov_b32 s40, 6
    s_add_u32 s41, s48, s46
    s_cmp_lt_u32 s41, 32
    s_cbranch_scc1 L_got_5
    s_sub_u32 s46, s41, 32
    s_min_u32 s48, s57, 32
    s_mov_b32 s40, 7
    s_add_u32 s41, s48, s46
    s_cmp_lt_u32 s41, 32
    s_cbranch_scc1 L_got_5
    s_sub_u32 s46, s41, 32
    s_branch L_c_done_1
L_got_5:
    s_mov_b64 exec, -1
    s_lshl_b32 s45, s40, 8
    s_or_b32 s45, s45, s41
    v_mov_b32 v3, s45
    v_mov_b32 v4, 147464
    ds_write_b32 v4, v3
    s_waitcnt lgkmcnt(0)
L_tk_4:
    s_barrier
    v_mov_b32 v4, 147464
    ds_read_b32 v3, v4
    s_waitcnt lgkmcnt(0)
    v_readfirstlane_b32 s45, v3
    s_nop 3
    s_lshr_b32 s40, s45, 8
    s_and_b32 s41, s45, 0xff
    s_lshr_b32 s45, s40, 2
    s_xor_b32 s45, s45, 1
    s_lshl_b32 s45, s45, 4
    s_and_b32 s40, s40, 3
    s_lshl_b32 s40, s40, 1
    s_lshr_b32 s46, s41, 4
    s_add_u32 s40, s40, s46
    s_and_b32 s41, s41, 15
    s_add_u32 s41, s41, s45
    s_cmp_lt_u32 s41, 16
    s_cbranch_scc1 L_c_chain_9
    s_sub_u32 s48, s41, 16
    s_cmp_lt_u32 s48, 12
    s_cbranch_scc1 L_w_g_10
    s_and_b32 s42, s48, 3
    s_mov_b32 s43, s40
    s_load_dwordx2 s[4:5], s[0:1], 0
    v_lshlrev_b32 v2, 4, v1
    v_lshlrev_b32 v3, 5, v1
    s_lshl_b32 s55, s43, 2
    s_add_u32 s55, s55, s42
    s_waitcnt lgkmcnt(0)
    s_mov_b32 s24, s4
    s_and_b32 s25, s5, 0xffff
    s_mov_b32 s26, 0x400000
    s_mov_b32 s27, 0x00020000
    s_lshl_b32 s46, s42, 3
    s_add_u32 s46, s46, s44
    s_lshl_b32 s46, s46, 11
    v_add_u32 v7, s46, v2
    s_lshl_b32 s63, s43, 16
    buffer_load_dwordx4 a[0:3], v7, s[24:27], s63 offen
    buffer_load_dwordx4 a[4:7], v7, s[24:27], s63 offen offset:1024
    s_cmp_lg_u32 s44, 0
    s_cbranch_scc1 L_zwok_19
    v_and_b32 v8, 7, v1
    v_lshlrev_b32 v8, 5, v8
    s_mov_b32 s70, 0
L_zw_18:
    buffer_load_dword v9, v8, s[16:19], 0 offen sc1
    s_waitcnt vmcnt(0)
    v_add_u32_dpp v9, v9, v9 row_ror:1 row_mask:0xf bank_mask:0xf
    s_nop 1
    v_add_u32_dpp v9, v9, v9 row_ror:2 row_mask:0xf bank_mask:0xf
    s_nop 1
    v_add_u32_dpp v9, v9, v9 row_ror:4 row_mask:0xf bank_mask:0xf
    v_cmp_ne_u32 vcc, 0x100, v9
    s_add_u32 s70, s70, 1
    s_cbranch_vccz L_zwok_19
    s_sleep 4
    s_cmp_lt_u32 s70, 524288
    s_cbranch_scc1 L_zw_18
    s_branch L_c_done_1
L_zwok_19:
    s_barrier
    v_lshlrev_b32 v4, 4, v0
    s_mov_b32 s46, 0x10000
    buffer_load_dwordx4 v[32:35], v4, s[12:15], s46 offen sc1
    s_mov_b32 s46, 0x12000
    buffer_load_dwordx4 v[36:39], v4, s[12:15], s46 offen sc1
    s_mov_b32 s46, 0x14000
    buffer_load_dwordx4 v[40:43], v4, s[12:15], s46 offen sc1
    s_mov_b32 s46, 0x16000
    buffer_load_dwordx4 v[44:47], v4, s[12:15], s46 offen sc1
    s_mov_b32 s46, 0x18000
    buffer_load_dwordx4 v[48:51], v4, s[12:15], s46 offen sc1
    s_mov_b32 s46, 0x1a000
    buffer_load_dwordx4 v[52:55], v4, s[12:15], s46 offen sc1
    s_mov_b32 s46, 0x1c000
    buffer_load_dwordx4 v[56:59], v4, s[12:15], s46 offen sc1
    s_mov_b32 s46, 0x1e000
    buffer_load_dwordx4 v[60:63], v4, s[12:15], s46 offen sc1
    s_cmp_lg_u32 s44, 0
    s_cbranch_scc1 L_l_nx_20
    s_cmp_ge_u32 s42, 2
    s_cbranch_scc1 L_l_nx_20
    s_or_b32 s47, s39, 0x100
    v_mov_b32 v8, s47
    v_mov_b32 v9, 0
    s_lshl_b32 s46, s40, 3
    s_lshl_b32 s47, s42, 2
    s_add_u32 s46, s46, s47
    s_add_u32 s46, s46, 0x101200
    s_mov_b64 exec, 1
    buffer_store_dword v8, v9, s[12:15], s46 offen sc1
    s_mov_b64 exec, -1
L_l_nx_20:
    s_mul_i32 s46, s44, 2064
    s_add_u32 s46, s46, 32768
    v_add_u32 v10, s46, v2
    v_and_b32 v11, 7, v1
    v_lshrrev_b32 v12, 3, v1
    v_mul_u32_u24 v13, 2064, v11
    v_lshl_add_u32 v13, v12, 4, v13
    s_lshl_b32 s46, s44, 8
    s_add_u32 s46, s46, 32768
    v_add_u32 v13, s46, v13
    v_lshlrev_b32 v11, 4, v11
    v_lshl_add_u32 v11, v12, 9, v11
    s_lshl_b32 s46, s44, 13
    s_lshl_b32 s47, s42, 7
    s_add_u32 s46, s46, s47
    s_add_u32 s46, s46, 0x400000
    v_add_u32 v11, s46, v11
    v_add_u32 v12, 4096, v11
    s_lshl_b32 s52, s43, 9
    s_lshl_b32 s47, s42, 7
    s_add_u32 s52, s52, s47
    s_add_u32 s52, s52, 0x109400
    s_mov_b32 s60, s43
    s_waitcnt vmcnt(0)
    v_add_f32 v32, v32, v48
    v_add_f32 v33, v33, v49
    v_add_f32 v34, v34, v50
    v_add_f32 v35, v35, v51
    v_add_f32 v36, v36, v52
    v_add_f32 v37, v37, v53
    v_add_f32 v38, v38, v54
    v_add_f32 v39, v39, v55
    v_add_f32 v40, v40, v56
    v_add_f32 v41, v41, v57
    v_add_f32 v42, v42, v58
    v_add_f32 v43, v43, v59
    v_add_f32 v44, v44, v60
    v_add_f32 v45, v45, v61
    v_add_f32 v46, v46, v62
    v_add_f32 v47, v47, v63
    v_add_f32 v32, v32, v40
    v_add_f32 v33, v33, v41
    v_add_f32 v34, v34, v42
    v_add_f32 v35, v35, v43
    v_add_f32 v36, v36, v44
    v_add_f32 v37, v37, v45
    v_add_f32 v38, v38, v46
    v_add_f32 v39, v39, v47
    v_add_f32 v32, v32, v36
    v_add_f32 v33, v33, v37
    v_add_f32 v34, v34, v38
    v_add_f32 v35, v35, v39
    v_cvt_pk_bf16_f32 v32, 0, v32
    v_cvt_pk_bf16_f32 v33, 0, v33
    v_cvt_pk_bf16_f32 v34, 0, v34
    v_cvt_pk_bf16_f32 v35, 0, v35
    ds_write_b128 v4, v[32:35]
    s_waitcnt lgkmcnt(0)
    s_barrier
    ds_read_b128 v[48:51], v3 offset:0
    ds_read_b128 v[52:55], v3 offset:16
    ds_read_b128 v[56:59], v3 offset:2048
    ds_read_b128 v[60:63], v3 offset:2064
    ds_read_b128 v[32:35], v3 offset:4096
    ds_read_b128 v[36:39], v3 offset:4112
    ds_read_b128 v[40:43], v3 offset:6144
    ds_read_b128 v[44:47], v3 offset:6160
    s_waitcnt lgkmcnt(0)
    v_add_f32 v32, 1.0, v32
    v_add_f32 v33, 1.0, v33
    v_add_f32 v34, 1.0, v34
    v_add_f32 v35, 1.0, v35
    v_add_f32 v36, 1.0, v36
    v_add_f32 v37, 1.0, v37
    v_add_f32 v38, 1.0, v38
    v_add_f32 v39, 1.0, v39
    v_add_f32 v40, 1.0, v40
    v_add_f32 v41, 1.0, v41
    v_add_f32 v42, 1.0, v42
    v_add_f32 v43, 1.0, v43
    v_add_f32 v44, 1.0, v44
    v_add_f32 v45, 1.0, v45
    v_add_f32 v46, 1.0, v46
    v_add_f32 v47, 1.0, v47
    v_cvt_pk_bf16_f32 v32, 0, v32
    v_cvt_pk_bf16_f32 v33, 0, v33
    v_cvt_pk_bf16_f32 v34, 0, v34
    v_cvt_pk_bf16_f32 v35, 0, v35
    v_cvt_pk_bf16_f32 v36, 0, v36
    v_cvt_pk_bf16_f32 v37, 0, v37
    v_cvt_pk_bf16_f32 v38, 0, v38
    v_cvt_pk_bf16_f32 v39, 0, v39
    v_cvt_pk_bf16_f32 v40, 0, v40
    v_cvt_pk_bf16_f32 v41, 0, v41
    v_cvt_pk_bf16_f32 v42, 0, v42
    v_cvt_pk_bf16_f32 v43, 0, v43
    v_cvt_pk_bf16_f32 v44, 0, v44
    v_cvt_pk_bf16_f32 v45, 0, v45
    v_cvt_pk_bf16_f32 v46, 0, v46
    v_cvt_pk_bf16_f32 v47, 0, v47
L_l_sub_21:
    s_lshl_b32 s63, s60, 16
    v_accvgpr_read_b32 v96, a0
    v_accvgpr_read_b32 v97, a1
    v_accvgpr_read_b32 v98, a2
    v_accvgpr_read_b32 v99, a3
    v_accvgpr_read_b32 v100, a4
    v_accvgpr_read_b32 v101, a5
    v_accvgpr_read_b32 v102, a6
    v_accvgpr_read_b32 v103, a7
    v_lshlrev_b32 v64, 16, v96
    v_and_b32 v65, 0xffff0000, v96
    v_lshlrev_b32 v66, 16, v97
    v_and_b32 v67, 0xffff0000, v97
    v_lshlrev_b32 v68, 16, v98
    v_and_b32 v69, 0xffff0000, v98
    v_lshlrev_b32 v70, 16, v99
    v_and_b32 v71, 0xffff0000, v99
    v_lshlrev_b32 v72, 16, v100
    v_and_b32 v73, 0xffff0000, v100
    v_lshlrev_b32 v74, 16, v101
    v_and_b32 v75, 0xffff0000, v101
    v_lshlrev_b32 v76, 16, v102
    v_and_b32 v77, 0xffff0000, v102
    v_lshlrev_b32 v78, 16, v103
    v_and_b32 v79, 0xffff0000, v103
    v_pk_add_f32 v[80:81], v[64:65], v[72:73]
    v_pk_add_f32 v[82:83], v[66:67], v[74:75]
    v_pk_add_f32 v[84:85], v[68:69], v[76:77]
    v_pk_add_f32 v[86:87], v[70:71], v[78:79]
    v_pk_add_f32 v[80:81], v[80:81], v[84:85]
    v_pk_add_f32 v[82:83], v[82:83], v[86:87]
    v_pk_add_f32 v[80:81], v[80:81], v[82:83]
    v_add_f32 v14, v80, v81
    s_nop 1
    v_add_f32_dpp v14, v14, v14 row_shr:1 row_mask:0xf bank_mask:0xf bound_ctrl:0
    s_nop 1
    v_add_f32_dpp v14, v14, v14 row_shr:2 row_mask:0xf bank_mask:0xf bound_ctrl:0
    s_nop 1
    v_add_f32_dpp v14, v14, v14 row_shr:4 row_mask:0xf bank_mask:0xf bound_ctrl:0
    s_nop 1
    v_add_f32_dpp v14, v14, v14 row_shr:8 row_mask:0xf bank_mask:0xf bound_ctrl:0
    s_nop 1
    v_add_f32_dpp v14, v14, v14 row_bcast:15 row_mask:0xa bank_mask:0xf
    s_nop 1
    v_add_f32_dpp v14, v14, v14 row_bcast:31 row_mask:0xc bank_mask:0xf
    s_nop 1
    v_readlane_b32 s46, v14, 63
    s_nop 1
    v_mov_b32 v15, s46
    v_mul_f32 v15, 0x3a800000, v15
    v_pk_add_f32 v[80:81], v[64:65], v[14:15] op_sel:[0,1] op_sel_hi:[1,1] neg_lo:[0,1] neg_hi:[0,1]
    v_pk_add_f32 v[82:83], v[66:67], v[14:15] op_sel:[0,1] op_sel_hi:[1,1] neg_lo:[0,1] neg_hi:[0,1]
    v_pk_add_f32 v[84:85], v[68:69], v[14:15] op_sel:[0,1] op_sel_hi:[1,1] neg_lo:[0,1] neg_hi:[0,1]
    v_pk_add_f32 v[86:87], v[70:71], v[14:15] op_sel:[0,1] op_sel_hi:[1,1] neg_lo:[0,1] neg_hi:[0,1]
    v_pk_add_f32 v[88:89], v[72:73], v[14:15] op_sel:[0,1] op_sel_hi:[1,1] neg_lo:[0,1] neg_hi:[0,1]
    v_pk_add_f32 v[90:91], v[74:75], v[14:15] op_sel:[0,1] op_sel_hi:[1,1] neg_lo:[0,1] neg_hi:[0,1]
    v_pk_add_f32 v[92:93], v[76:77], v[14:15] op_sel:[0,1] op_sel_hi:[1,1] neg_lo:[0,1] neg_hi:[0,1]
    v_pk_add_f32 v[94:95], v[78:79], v[14:15] op_sel:[0,1] op_sel_hi:[1,1] neg_lo:[0,1] neg_hi:[0,1]
    v_pk_mul_f32 v[104:105], v[80:81], v[80:81]
    v_pk_mul_f32 v[106:107], v[82:83], v[82:83]
    v_pk_fma_f32 v[104:105], v[84:85], v[84:85], v[104:105]
    v_pk_fma_f32 v[106:107], v[86:87], v[86:87], v[106:107]
    v_pk_fma_f32 v[104:105], v[88:89], v[88:89], v[104:105]
    v_pk_fma_f32 v[106:107], v[90:91], v[90:91], v[106:107]
    v_pk_fma_f32 v[104:105], v[92:93], v[92:93], v[104:105]
    v_pk_fma_f32 v[106:107], v[94:95], v[94:95], v[106:107]
    v_pk_add_f32 v[104:105], v[104:105], v[106:107]
    v_add_f32 v14, v104, v105
    v_cvt_pk_bf16_f32 v15, 0, v15
    s_nop 1
    v_add_f32_dpp v14, v14, v14 row_shr:1 row_mask:0xf bank_mask:0xf bound_ctrl:0
    s_nop 1
    v_add_f32_dpp v14, v14, v14 row_shr:2 row_mask:0xf bank_mask:0xf bound_ctrl:0
    s_nop 1
    v_add_f32_dpp v14, v14, v14 row_shr:4 row_mask:0xf bank_mask:0xf bound_ctrl:0
    s_nop 1
    v_add_f32_dpp v14, v14, v14 row_shr:8 row_mask:0xf bank_mask:0xf bound_ctrl:0
    s_nop 1
    v_add_f32_dpp v14, v14, v14 row_bcast:15 row_mask:0xa bank_mask:0xf
    s_nop 1
    v_add_f32_dpp v14, v14, v14 row_bcast:31 row_mask:0xc bank_mask:0xf
    s_nop 1
    v_readlane_b32 s47, v14, 63
    v_pk_add_f32 v[64:65], v[64:65], v[14:15] op_sel:[0,1] op_sel_hi:[1,1] neg_lo:[0,1] neg_hi:[0,1]
    v_pk_add_f32 v[66:67], v[66:67], v[14:15] op_sel:[0,1] op_sel_hi:[1,1] neg_lo:[0,1] neg_hi:[0,1]
    v_pk_add_f32 v[68:69], v[68:69], v[14:15] op_sel:[0,1] op_sel_hi:[1,1] neg_lo:[0,1] neg_hi:[0,1]
    v_pk_add_f32 v[70:71], v[70:71], v[14:15] op_sel:[0,1] op_sel_hi:[1,1] neg_lo:[0,1] neg_hi:[0,1]
    v_pk_add_f32 v[72:73], v[72:73], v[14:15] op_sel:[0,1] op_sel_hi:[1,1] neg_lo:[0,1] neg_hi:[0,1]
    v_pk_add_f32 v[74:75], v[74:75], v[14:15] op_sel:[0,1] op_sel_hi:[1,1] neg_lo:[0,1] neg_hi:[0,1]
    v_pk_add_f32 v[76:77], v[76:77], v[14:15] op_sel:[0,1] op_sel_hi:[1,1] neg_lo:[0,1] neg_hi:[0,1]
    v_pk_add_f32 v[78:79], v[78:79], v[14:15] op_sel:[0,1] op_sel_hi:[1,1] neg_lo:[0,1] neg_hi:[0,1]
    v_mov_b32 v14, s47
    v_mul_f32 v14, 0x3a800000, v14
    v_cvt_pk_bf16_f32 v14, 0, v14
    v_add_f32 v14, 0x3727c5ac, v14
    v_cvt_pk_bf16_f32 v14, 0, v14
    v_sqrt_f32 v14, v14
    s_nop 0
    v_cvt_pk_bf16_f32 v14, 0, v14
    v_rcp_f32 v14, v14
    v_cvt_pk_bf16_f32 v64, 0, v64
    v_cvt_pk_bf16_f32 v65, 0, v65
    v_cvt_pk_bf16_f32 v66, 0, v66
    v_cvt_pk_bf16_f32 v67, 0, v67
    v_cvt_pk_bf16_f32 v68, 0, v68
    v_cvt_pk_bf16_f32 v69, 0, v69
    v_cvt_pk_bf16_f32 v70, 0, v70
    v_cvt_pk_bf16_f32 v71, 0, v71
    v_cvt_pk_bf16_f32 v72, 0, v72
    v_cvt_pk_bf16_f32 v73, 0, v73
    v_cvt_pk_bf16_f32 v74, 0, v74
    v_cvt_pk_bf16_f32 v75, 0, v75
    v_cvt_pk_bf16_f32 v76, 0, v76
    v_cvt_pk_bf16_f32 v77, 0, v77
    v_cvt_pk_bf16_f32 v78, 0, v78
    v_cvt_pk_bf16_f32 v79, 0, v79
    v_pk_mul_f32 v[64:65], v[64:65], v[14:15] op_sel_hi:[1,0]
    v_pk_mul_f32 v[66:67], v[66:67], v[14:15] op_sel_hi:[1,0]
    v_pk_mul_f32 v[68:69], v[68:69], v[14:15] op_sel_hi:[1,0]
    v_pk_mul_f32 v[70:71], v[70:71], v[14:15] op_sel_hi:[1,0]
    v_pk_mul_f32 v[72:73], v[72:73], v[14:15] op_sel_hi:[1,0]
    v_pk_mul_f32 v[74:75], v[74:75], v[14:15] op_sel_hi:[1,0]
    v_pk_mul_f32 v[76:77], v[76:77], v[14:15] op_sel_hi:[1,0]
    v_pk_mul_f32 v[78:79], v[78:79], v[14:15] op_sel_hi:[1,0]
    v_cvt_pk_bf16_f32 v64, 0, v64
    v_cvt_pk_bf16_f32 v65, 0, v65
    v_cvt_pk_bf16_f32 v66, 0, v66
    v_cvt_pk_bf16_f32 v67, 0, v67
    v_cvt_pk_bf16_f32 v68, 0, v68
    v_cvt_pk_bf16_f32 v69, 0, v69
    v_cvt_pk_bf16_f32 v70, 0, v70
    v_cvt_pk_bf16_f32 v71, 0, v71
    v_cvt_pk_bf16_f32 v72, 0, v72
    v_cvt_pk_bf16_f32 v73, 0, v73
    v_cvt_pk_bf16_f32 v74, 0, v74
    v_cvt_pk_bf16_f32 v75, 0, v75
    v_cvt_pk_bf16_f32 v76, 0, v76
    v_cvt_pk_bf16_f32 v77, 0, v77
    v_cvt_pk_bf16_f32 v78, 0, v78
    v_cvt_pk_bf16_f32 v79, 0, v79
    v_pk_mul_f32 v[64:65], v[64:65], v[32:33]
    v_pk_mul_f32 v[66:67], v[66:67], v[34:35]
    v_pk_mul_f32 v[68:69], v[68:69], v[36:37]
    v_pk_mul_f32 v[70:71], v[70:71], v[38:39]
    v_pk_mul_f32 v[72:73], v[72:73], v[40:41]
    v_pk_mul_f32 v[74:75], v[74:75], v[42:43]
    v_pk_mul_f32 v[76:77], v[76:77], v[44:45]
    v_pk_mul_f32 v[78:79], v[78:79], v[46:47]
    v_cvt_pk_bf16_f32 v64, 0, v64
    v_cvt_pk_bf16_f32 v65, 0, v65
    v_cvt_pk_bf16_f32 v66, 0, v66
    v_cvt_pk_bf16_f32 v67, 0, v67
    v_cvt_pk_bf16_f32 v68, 0, v68
    v_cvt_pk_bf16_f32 v69, 0, v69
    v_cvt_pk_bf16_f32 v70, 0, v70
    v_cvt_pk_bf16_f32 v71, 0, v71
    v_cvt_pk_bf16_f32 v72, 0, v72
    v_cvt_pk_bf16_f32 v73, 0, v73
    v_cvt_pk_bf16_f32 v74, 0, v74
    v_cvt_pk_bf16_f32 v75, 0, v75
    v_cvt_pk_bf16_f32 v76, 0, v76
    v_cvt_pk_bf16_f32 v77, 0, v77
    v_cvt_pk_bf16_f32 v78, 0, v78
    v_cvt_pk_bf16_f32 v79, 0, v79
    v_pk_add_f32 v[64:65], v[64:65], v[48:49]
    v_pk_add_f32 v[66:67], v[66:67], v[50:51]
    v_pk_add_f32 v[68:69], v[68:69], v[52:53]
    v_pk_add_f32 v[70:71], v[70:71], v[54:55]
    v_pk_add_f32 v[72:73], v[72:73], v[56:57]
    v_pk_add_f32 v[74:75], v[74:75], v[58:59]
    v_pk_add_f32 v[76:77], v[76:77], v[60:61]
    v_pk_add_f32 v[78:79], v[78:79], v[62:63]
    v_cvt_pk_bf16_f32 v104, v64, v65
    v_cvt_pk_bf16_f32 v105, v66, v67
    v_cvt_pk_bf16_f32 v106, v68, v69
    v_cvt_pk_bf16_f32 v107, v70, v71
    v_cvt_pk_bf16_f32 v108, v72, v73
    v_cvt_pk_bf16_f32 v109, v74, v75
    v_cvt_pk_bf16_f32 v110, v76, v77
    v_cvt_pk_bf16_f32 v111, v78, v79
    ds_write_b128 v10, v[104:107]
    ds_write_b128 v10, v[108:111] offset:1024
    s_waitcnt lgkmcnt(0)
    s_barrier
    ds_read_b128 v[104:107], v13
    ds_read_b128 v[108:111], v13 offset:128
    s_waitcnt lgkmcnt(1)
    buffer_store_dwordx4 v[104:107], v11, s[12:15], s63 offen sc1
    s_waitcnt lgkmcnt(0)
    buffer_store_dwordx4 v[108:111], v12, s[12:15], s63 offen sc1
    s_waitcnt vmcnt(0)
    s_barrier
    s_cmp_lg_u32 s44, 0
    s_cbranch_scc1 L_sf_23
    v_mov_b32 v14, s60
    v_add_u32 v14, 1, v14
    v_mov_b32 v15, 0
    s_mov_b64 exec, 1
    buffer_store_dword v14, v15, s[12:15], s52 offen sc1
    s_mov_b64 exec, -1
L_sf_23:
    s_cmp_ge_u32 s60, 8
    s_cbranch_scc1 L_l_end_22
    s_add_u32 s63, s63, 524288
    buffer_load_dwordx4 a[8:11], v7, s[24:27], s63 offen
    buffer_load_dwordx4 a[12:15], v7, s[24:27], s63 offen offset:1024
    s_add_u32 s63, s63, 524288
    buffer_load_dwordx4 a[16:19], v7, s[24:27], s63 offen
    buffer_load_dwordx4 a[20:23], v7, s[24:27], s63 offen offset:1024
    s_add_u32 s63, s63, 524288
    buffer_load_dwordx4 a[24:27], v7, s[24:27], s63 offen
    buffer_load_dwordx4 a[28:31], v7, s[24:27], s63 offen offset:1024
    s_add_u32 s63, s63, 524288
    buffer_load_dwordx4 a[32:35], v7, s[24:27], s63 offen
    buffer_load_dwordx4 a[36:39], v7, s[24:27], s63 offen offset:1024
    s_add_u32 s63, s63, 524288
    buffer_load_dwordx4 a[40:43], v7, s[24:27], s63 offen
    buffer_load_dwordx4 a[44:47], v7, s[24:27], s63 offen offset:1024
    s_add_u32 s63, s63, 524288
    buffer_load_dwordx4 a[48:51], v7, s[24:27], s63 offen
    buffer_load_dwordx4 a[52:55], v7, s[24:27], s63 offen offset:1024
    s_add_u32 s63, s63, 524288
    buffer_load_dwordx4 a[56:59], v7, s[24:27], s63 offen
    buffer_load_dwordx4 a[60:63], v7, s[24:27], s63 offen offset:1024
    s_waitcnt vmcnt(0)
L_l_end_22:
    v_accvgpr_mov_b32 a0, a8
    v_accvgpr_mov_b32 a1, a9
    v_accvgpr_mov_b32 a2, a10
    v_accvgpr_mov_b32 a3, a11
    v_accvgpr_mov_b32 a4, a12
    v_accvgpr_mov_b32 a5, a13
    v_accvgpr_mov_b32 a6, a14
    v_accvgpr_mov_b32 a7, a15
    v_accvgpr_mov_b32 a8, a16
    v_accvgpr_mov_b32 a9, a17
    v_accvgpr_mov_b32 a10, a18
    v_accvgpr_mov_b32 a11, a19
    v_accvgpr_mov_b32 a12, a20
    v_accvgpr_mov_b32 a13, a21
    v_accvgpr_mov_b32 a14, a22
    v_accvgpr_mov_b32 a15, a23
    v_accvgpr_mov_b32 a16, a24
    v_accvgpr_mov_b32 a17, a25
    v_accvgpr_mov_b32 a18, a26
    v_accvgpr_mov_b32 a19, a27
    v_accvgpr_mov_b32 a20, a28
    v_accvgpr_mov_b32 a21, a29
    v_accvgpr_mov_b32 a22, a30
    v_accvgpr_mov_b32 a23, a31
    v_accvgpr_mov_b32 a24, a32
    v_accvgpr_mov_b32 a25, a33
    v_accvgpr_mov_b32 a26, a34
    v_accvgpr_mov_b32 a27, a35
    v_accvgpr_mov_b32 a28, a36
    v_accvgpr_mov_b32 a29, a37
    v_accvgpr_mov_b32 a30, a38
    v_accvgpr_mov_b32 a31, a39
    v_accvgpr_mov_b32 a32, a40
    v_accvgpr_mov_b32 a33, a41
    v_accvgpr_mov_b32 a34, a42
    v_accvgpr_mov_b32 a35, a43
    v_accvgpr_mov_b32 a36, a44
    v_accvgpr_mov_b32 a37, a45
    v_accvgpr_mov_b32 a38, a46
    v_accvgpr_mov_b32 a39, a47
    v_accvgpr_mov_b32 a40, a48
    v_accvgpr_mov_b32 a41, a49
    v_accvgpr_mov_b32 a42, a50
    v_accvgpr_mov_b32 a43, a51
    v_accvgpr_mov_b32 a44, a52
    v_accvgpr_mov_b32 a45, a53
    v_accvgpr_mov_b32 a46, a54
    v_accvgpr_mov_b32 a47, a55
    v_accvgpr_mov_b32 a48, a56
    v_accvgpr_mov_b32 a49, a57
    v_accvgpr_mov_b32 a50, a58
    v_accvgpr_mov_b32 a51, a59
    v_accvgpr_mov_b32 a52, a60
    v_accvgpr_mov_b32 a53, a61
    v_accvgpr_mov_b32 a54, a62
    v_accvgpr_mov_b32 a55, a63
    s_add_u32 s60, s60, 8
    s_cmp_lt_u32 s60, 64
    s_cbranch_scc1 L_l_sub_21
    s_cmp_lt_u32 s48, 14
    s_cbranch_scc1 L_w_h_17_s
    s_and_b32 s55, s48, 1
    s_lshl_b32 s55, s55, 3
    s_add_u32 s55, s55, s40
    s_load_dwordx4 s[8:11], s[0:1], 96
    v_lshrrev_b32 v5, 3, v0
    s_mov_b32 s46, 196608
    v_mul_lo_u32 v4, v5, s46
    v_and_b32 v6, 7, v0
    v_lshl_add_u32 v4, v6, 4, v4
    v_lshlrev_b32 v5, 5, v5
    s_waitcnt lgkmcnt(0)
    s_mov_b32 s28, s10
    s_and_b32 s29, s11, 0xffff
    s_mov_b32 s30, 0xc00000
    s_mov_b32 s31, 0x00020000
    s_mov_b32 s32, s8
    s_and_b32 s33, s9, 0xffff
    s_mov_b32 s34, 0x800
    s_mov_b32 s35, 0x00020000
    buffer_load_dwordx4 v[8:11], v5, s[32:35], 0 offen
    buffer_load_dwordx4 v[12:15], v5, s[32:35], 0 offen offset:16
    s_waitcnt vmcnt(0)
    v_lshlrev_b32 v16, 16, v8
    v_and_b32 v17, 0xffff0000, v8
    v_lshlrev_b32 v18, 16, v9
    v_and_b32 v19, 0xffff0000, v9
    v_lshlrev_b32 v20, 16, v10
    v_and_b32 v21, 0xffff0000, v10
    v_lshlrev_b32 v22, 16, v11
    v_and_b32 v23, 0xffff0000, v11
    v_lshlrev_b32 v24, 16, v12
    v_and_b32 v25, 0xffff0000, v12
    v_lshlrev_b32 v26, 16, v13
    v_and_b32 v27, 0xffff0000, v13
    v_lshlrev_b32 v28, 16, v14
    v_and_b32 v29, 0xffff0000, v14
    v_lshlrev_b32 v30, 16, v15
    v_and_b32 v31, 0xffff0000, v15
    v_mul_f32 v112, 0xbfb8aa3b, v16
    v_mul_f32 v113, 0xbfb8aa3b, v17
    v_mul_f32 v114, 0xbfb8aa3b, v18
    v_mul_f32 v115, 0xbfb8aa3b, v19
    v_mul_f32 v116, 0xbfb8aa3b, v20
    v_mul_f32 v117, 0xbfb8aa3b, v21
    v_mul_f32 v118, 0xbfb8aa3b, v22
    v_mul_f32 v119, 0xbfb8aa3b, v23
    v_mul_f32 v120, 0xbfb8aa3b, v24
    v_mul_f32 v121, 0xbfb8aa3b, v25
    v_mul_f32 v122, 0xbfb8aa3b, v26
    v_mul_f32 v123, 0xbfb8aa3b, v27
    v_mul_f32 v124, 0xbfb8aa3b, v28
    v_mul_f32 v125, 0xbfb8aa3b, v29
    v_mul_f32 v126, 0xbfb8aa3b, v30
    v_mul_f32 v127, 0xbfb8aa3b, v31
    v_exp_f32 v112, v112
    v_exp_f32 v113, v113
    v_exp_f32 v114, v114
    v_exp_f32 v115, v115
    v_exp_f32 v116, v116
    v_exp_f32 v117, v117
    v_exp_f32 v118, v118
    v_exp_f32 v119, v119
    v_exp_f32 v120, v120
    v_exp_f32 v121, v121
    v_exp_f32 v122, v122
    v_exp_f32 v123, v123
    v_exp_f32 v124, v124
    v_exp_f32 v125, v125
    v_exp_f32 v126, v126
    v_exp_f32 v127, v127
    v_add_f32 v112, 1.0, v112
    v_add_f32 v113, 1.0, v113
    v_add_f32 v114, 1.0, v114
    v_add_f32 v115, 1.0, v115
    v_add_f32 v116, 1.0, v116
    v_add_f32 v117, 1.0, v117
    v_add_f32 v118, 1.0, v118
    v_add_f32 v119, 1.0, v119
    v_add_f32 v120, 1.0, v120
    v_add_f32 v121, 1.0, v121
    v_add_f32 v122, 1.0, v122
    v_add_f32 v123, 1.0, v123
    v_add_f32 v124, 1.0, v124
    v_add_f32 v125, 1.0, v125
    v_add_f32 v126, 1.0, v126
    v_add_f32 v127, 1.0, v127
    v_rcp_f32 v112, v112
    v_rcp_f32 v113, v113
    v_rcp_f32 v114, v114
    v_rcp_f32 v115, v115
    v_rcp_f32 v116, v116
    v_rcp_f32 v117, v117
    v_rcp_f32 v118, v118
    v_rcp_f32 v119, v119
    v_rcp_f32 v120, v120
    v_rcp_f32 v121, v121
    v_rcp_f32 v122, v122
    v_rcp_f32 v123, v123
    v_rcp_f32 v124, v124
    v_rcp_f32 v125, v125
    v_rcp_f32 v126, v126
    v_rcp_f32 v127, v127
    v_mul_f32 v16, v16, v112
    v_mul_f32 v17, v17, v113
    v_mul_f32 v18, v18, v114
    v_mul_f32 v19, v19, v115
    v_mul_f32 v20, v20, v116
    v_mul_f32 v21, v21, v117
    v_mul_f32 v22, v22, v118
    v_mul_f32 v23, v23, v119
    v_mul_f32 v24, v24, v120
    v_mul_f32 v25, v25, v121
    v_mul_f32 v26, v26, v122
    v_mul_f32 v27, v27, v123
    v_mul_f32 v28, v28, v124
    v_mul_f32 v29, v29, v125
    v_mul_f32 v30, v30, v126
    v_mul_f32 v31, v31, v127
    v_cvt_pk_bf16_f32 v16, 0, v16
    v_cvt_pk_bf16_f32 v17, 0, v17
    v_cvt_pk_bf16_f32 v18, 0, v18
    v_cvt_pk_bf16_f32 v19, 0, v19
    v_cvt_pk_bf16_f32 v20, 0, v20
    v_cvt_pk_bf16_f32 v21, 0, v21
    v_cvt_pk_bf16_f32 v22, 0, v22
    v_cvt_pk_bf16_f32 v23, 0, v23
    v_cvt_pk_bf16_f32 v24, 0, v24
    v_cvt_pk_bf16_f32 v25, 0, v25
    v_cvt_pk_bf16_f32 v26, 0, v26
    v_cvt_pk_bf16_f32 v27, 0, v27
    v_cvt_pk_bf16_f32 v28, 0, v28
    v_cvt_pk_bf16_f32 v29, 0, v29
    v_cvt_pk_bf16_f32 v30, 0, v30
    v_cvt_pk_bf16_f32 v31, 0, v31
    s_lshl_b32 s53, s55, 9
    s_add_u32 s53, s53, 4096
L_m_loop_24:
    s_add_u32 s46, s53, 0
    buffer_load_dwordx4 v[32:35], v4, s[28:31], s46 offen
    s_add_u32 s46, s53, 12288
    buffer_load_dwordx4 v[36:39], v4, s[28:31], s46 offen
    s_add_u32 s46, s53, 24576
    buffer_load_dwordx4 v[40:43], v4, s[28:31], s46 offen
    s_add_u32 s46, s53, 36864
    buffer_load_dwordx4 v[44:47], v4, s[28:31], s46 offen
    s_add_u32 s46, s53, 49152
    buffer_load_dwordx4 v[48:51], v4, s[28:31], s46 offen
    s_add_u32 s46, s53, 61440
    buffer_load_dwordx4 v[52:55], v4, s[28:31], s46 offen
    s_add_u32 s46, s53, 73728
    buffer_load_dwordx4 v[56:59], v4, s[28:31], s46 offen
    s_add_u32 s46, s53, 86016
    buffer_load_dwordx4 v[60:63], v4, s[28:31], s46 offen
    s_add_u32 s46, s53, 98304
    buffer_load_dwordx4 v[64:67], v4, s[28:31], s46 offen
    s_add_u32 s46, s53, 110592
    buffer_load_dwordx4 v[68:71], v4, s[28:31], s46 offen
    s_add_u32 s46, s53, 122880
    buffer_load_dwordx4 v[72:75], v4, s[28:31], s46 offen
    s_add_u32 s46, s53, 135168
    buffer_load_dwordx4 v[76:79], v4, s[28:31], s46 offen
    s_add_u32 s46, s53, 147456
    buffer_load_dwordx4 v[80:83], v4, s[28:31], s46 offen
    s_add_u32 s46, s53, 159744
    buffer_load_dwordx4 v[84:87], v4, s[28:31], s46 offen
    s_add_u32 s46, s53, 172032
    buffer_load_dwordx4 v[88:91], v4, s[28:31], s46 offen
    s_add_u32 s46, s53, 184320
    buffer_load_dwordx4 v[92:95], v4, s[28:31], s46 offen
    s_waitcnt vmcnt(15)
    v_lshlrev_b32 v104, 16, v32
    v_and_b32 v105, 0xffff0000, v32
    v_mul_f32 v96, v104, v16
    v_mul_f32 v97, v105, v16
    v_lshlrev_b32 v104, 16, v33
    v_and_b32 v105, 0xffff0000, v33
    v_mul_f32 v98, v104, v16
    v_mul_f32 v99, v105, v16
    v_lshlrev_b32 v104, 16, v34
    v_and_b32 v105, 0xffff0000, v34
    v_mul_f32 v100, v104, v16
    v_mul_f32 v101, v105, v16
    v_lshlrev_b32 v104, 16, v35
    v_and_b32 v105, 0xffff0000, v35
    v_mul_f32 v102, v104, v16
    v_mul_f32 v103, v105, v16
    s_waitcnt vmcnt(14)
    v_lshlrev_b32 v104, 16, v36
    v_and_b32 v105, 0xffff0000, v36
    v_fmac_f32 v96, v104, v17
    v_fmac_f32 v97, v105, v17
    v_lshlrev_b32 v104, 16, v37
    v_and_b32 v105, 0xffff0000, v37
    v_fmac_f32 v98, v104, v17
    v_fmac_f32 v99, v105, v17
    v_lshlrev_b32 v104, 16, v38
    v_and_b32 v105, 0xffff0000, v38
    v_fmac_f32 v100, v104, v17
    v_fmac_f32 v101, v105, v17
    v_lshlrev_b32 v104, 16, v39
    v_and_b32 v105, 0xffff0000, v39
    v_fmac_f32 v102, v104, v17
    v_fmac_f32 v103, v105, v17
    s_waitcnt vmcnt(13)
    v_lshlrev_b32 v104, 16, v40
    v_and_b32 v105, 0xffff0000, v40
    v_fmac_f32 v96, v104, v18
    v_fmac_f32 v97, v105, v18
    v_lshlrev_b32 v104, 16, v41
    v_and_b32 v105, 0xffff0000, v41
    v_fmac_f32 v98, v104, v18
    v_fmac_f32 v99, v105, v18
    v_lshlrev_b32 v104, 16, v42
    v_and_b32 v105, 0xffff0000, v42
    v_fmac_f32 v100, v104, v18
    v_fmac_f32 v101, v105, v18
    v_lshlrev_b32 v104, 16, v43
    v_and_b32 v105, 0xffff0000, v43
    v_fmac_f32 v102, v104, v18
    v_fmac_f32 v103, v105, v18
    s_waitcnt vmcnt(12)
    v_lshlrev_b32 v104, 16, v44
    v_and_b32 v105, 0xffff0000, v44
    v_fmac_f32 v96, v104, v19
    v_fmac_f32 v97, v105, v19
    v_lshlrev_b32 v104, 16, v45
    v_and_b32 v105, 0xffff0000, v45
    v_fmac_f32 v98, v104, v19
    v_fmac_f32 v99, v105, v19
    v_lshlrev_b32 v104, 16, v46
    v_and_b32 v105, 0xffff0000, v46
    v_fmac_f32 v100, v104, v19
    v_fmac_f32 v101, v105, v19
    v_lshlrev_b32 v104, 16, v47
    v_and_b32 v105, 0xffff0000, v47
    v_fmac_f32 v102, v104, v19
    v_fmac_f32 v103, v105, v19
    s_waitcnt vmcnt(11)
    v_lshlrev_b32 v104, 16, v48
    v_and_b32 v105, 0xffff0000, v48
    v_fmac_f32 v96, v104, v20
    v_fmac_f32 v97, v105, v20
    v_lshlrev_b32 v104, 16, v49
    v_and_b32 v105, 0xffff0000, v49
    v_fmac_f32 v98, v104, v20
    v_fmac_f32 v99, v105, v20
    v_lshlrev_b32 v104, 16, v50
    v_and_b32 v105, 0xffff0000, v50
    v_fmac_f32 v100, v104, v20
    v_fmac_f32 v101, v105, v20
    v_lshlrev_b32 v104, 16, v51
    v_and_b32 v105, 0xffff0000, v51
    v_fmac_f32 v102, v104, v20
    v_fmac_f32 v103, v105, v20
    s_waitcnt vmcnt(10)
    v_lshlrev_b32 v104, 16, v52
    v_and_b32 v105, 0xffff0000, v52
    v_fmac_f32 v96, v104, v21
    v_fmac_f32 v97, v105, v21
    v_lshlrev_b32 v104, 16, v53
    v_and_b32 v105, 0xffff0000, v53
    v_fmac_f32 v98, v104, v21
    v_fmac_f32 v99, v105, v21
    v_lshlrev_b32 v104, 16, v54
    v_and_b32 v105, 0xffff0000, v54
    v_fmac_f32 v100, v104, v21
    v_fmac_f32 v101, v105, v21
    v_lshlrev_b32 v104, 16, v55
    v_and_b32 v105, 0xffff0000, v55
    v_fmac_f32 v102, v104, v21
    v_fmac_f32 v103, v105, v21
    s_waitcnt vmcnt(9)
    v_lshlrev_b32 v104, 16, v56
    v_and_b32 v105, 0xffff0000, v56
    v_fmac_f32 v96, v104, v22
    v_fmac_f32 v97, v105, v22
    v_lshlrev_b32 v104, 16, v57
    v_and_b32 v105, 0xffff0000, v57
    v_fmac_f32 v98, v104, v22
    v_fmac_f32 v99, v105, v22
    v_lshlrev_b32 v104, 16, v58
    v_and_b32 v105, 0xffff0000, v58
    v_fmac_f32 v100, v104, v22
    v_fmac_f32 v101, v105, v22
    v_lshlrev_b32 v104, 16, v59
    v_and_b32 v105, 0xffff0000, v59
    v_fmac_f32 v102, v104, v22
    v_fmac_f32 v103, v105, v22
    s_waitcnt vmcnt(8)
    v_lshlrev_b32 v104, 16, v60
    v_and_b32 v105, 0xffff0000, v60
    v_fmac_f32 v96, v104, v23
    v_fmac_f32 v97, v105, v23
    v_lshlrev_b32 v104, 16, v61
    v_and_b32 v105, 0xffff0000, v61
    v_fmac_f32 v98, v104, v23
    v_fmac_f32 v99, v105, v23
    v_lshlrev_b32 v104, 16, v62
    v_and_b32 v105, 0xffff0000, v62
    v_fmac_f32 v100, v104, v23
    v_fmac_f32 v101, v105, v23
    v_lshlrev_b32 v104, 16, v63
    v_and_b32 v105, 0xffff0000, v63
    v_fmac_f32 v102, v104, v23
    v_fmac_f32 v103, v105, v23
    s_waitcnt vmcnt(7)
    v_lshlrev_b32 v104, 16, v64
    v_and_b32 v105, 0xffff0000, v64
    v_fmac_f32 v96, v104, v24
    v_fmac_f32 v97, v105, v24
    v_lshlrev_b32 v104, 16, v65
    v_and_b32 v105, 0xffff0000, v65
    v_fmac_f32 v98, v104, v24
    v_fmac_f32 v99, v105, v24
    v_lshlrev_b32 v104, 16, v66
    v_and_b32 v105, 0xffff0000, v66
    v_fmac_f32 v100, v104, v24
    v_fmac_f32 v101, v105, v24
    v_lshlrev_b32 v104, 16, v67
    v_and_b32 v105, 0xffff0000, v67
    v_fmac_f32 v102, v104, v24
    v_fmac_f32 v103, v105, v24
    s_waitcnt vmcnt(6)
    v_lshlrev_b32 v104, 16, v68
    v_and_b32 v105, 0xffff0000, v68
    v_fmac_f32 v96, v104, v25
    v_fmac_f32 v97, v105, v25
    v_lshlrev_b32 v104, 16, v69
    v_and_b32 v105, 0xffff0000, v69
    v_fmac_f32 v98, v104, v25
    v_fmac_f32 v99, v105, v25
    v_lshlrev_b32 v104, 16, v70
    v_and_b32 v105, 0xffff0000, v70
    v_fmac_f32 v100, v104, v25
    v_fmac_f32 v101, v105, v25
    v_lshlrev_b32 v104, 16, v71
    v_and_b32 v105, 0xffff0000, v71
    v_fmac_f32 v102, v104, v25
    v_fmac_f32 v103, v105, v25
    s_waitcnt vmcnt(5)
    v_lshlrev_b32 v104, 16, v72
    v_and_b32 v105, 0xffff0000, v72
    v_fmac_f32 v96, v104, v26
    v_fmac_f32 v97, v105, v26
    v_lshlrev_b32 v104, 16, v73
    v_and_b32 v105, 0xffff0000, v73
    v_fmac_f32 v98, v104, v26
    v_fmac_f32 v99, v105, v26
    v_lshlrev_b32 v104, 16, v74
    v_and_b32 v105, 0xffff0000, v74
    v_fmac_f32 v100, v104, v26
    v_fmac_f32 v101, v105, v26
    v_lshlrev_b32 v104, 16, v75
    v_and_b32 v105, 0xffff0000, v75
    v_fmac_f32 v102, v104, v26
    v_fmac_f32 v103, v105, v26
    s_waitcnt vmcnt(4)
    v_lshlrev_b32 v104, 16, v76
    v_and_b32 v105, 0xffff0000, v76
    v_fmac_f32 v96, v104, v27
    v_fmac_f32 v97, v105, v27
    v_lshlrev_b32 v104, 16, v77
    v_and_b32 v105, 0xffff0000, v77
    v_fmac_f32 v98, v104, v27
    v_fmac_f32 v99, v105, v27
    v_lshlrev_b32 v104, 16, v78
    v_and_b32 v105, 0xffff0000, v78
    v_fmac_f32 v100, v104, v27
    v_fmac_f32 v101, v105, v27
    v_lshlrev_b32 v104, 16, v79
    v_and_b32 v105, 0xffff0000, v79
    v_fmac_f32 v102, v104, v27
    v_fmac_f32 v103, v105, v27
    s_waitcnt vmcnt(3)
    v_lshlrev_b32 v104, 16, v80
    v_and_b32 v105, 0xffff0000, v80
    v_fmac_f32 v96, v104, v28
    v_fmac_f32 v97, v105, v28
    v_lshlrev_b32 v104, 16, v81
    v_and_b32 v105, 0xffff0000, v81
    v_fmac_f32 v98, v104, v28
    v_fmac_f32 v99, v105, v28
    v_lshlrev_b32 v104, 16, v82
    v_and_b32 v105, 0xffff0000, v82
    v_fmac_f32 v100, v104, v28
    v_fmac_f32 v101, v105, v28
    v_lshlrev_b32 v104, 16, v83
    v_and_b32 v105, 0xffff0000, v83
    v_fmac_f32 v102, v104, v28
    v_fmac_f32 v103, v105, v28
    s_waitcnt vmcnt(2)
    v_lshlrev_b32 v104, 16, v84
    v_and_b32 v105, 0xffff0000, v84
    v_fmac_f32 v96, v104, v29
    v_fmac_f32 v97, v105, v29
    v_lshlrev_b32 v104, 16, v85
    v_and_b32 v105, 0xffff0000, v85
    v_fmac_f32 v98, v104, v29
    v_fmac_f32 v99, v105, v29
    v_lshlrev_b32 v104, 16, v86
    v_and_b32 v105, 0xffff0000, v86
    v_fmac_f32 v100, v104, v29
    v_fmac_f32 v101, v105, v29
    v_lshlrev_b32 v104, 16, v87
    v_and_b32 v105, 0xffff0000, v87
    v_fmac_f32 v102, v104, v29
    v_fmac_f32 v103, v105, v29
    s_waitcnt vmcnt(1)
    v_lshlrev_b32 v104, 16, v88
    v_and_b32 v105, 0xffff0000, v88
    v_fmac_f32 v96, v104, v30
    v_fmac_f32 v97, v105, v30
    v_lshlrev_b32 v104, 16, v89
    v_and_b32 v105, 0xffff0000, v89
    v_fmac_f32 v98, v104, v30
    v_fmac_f32 v99, v105, v30
    v_lshlrev_b32 v104, 16, v90
    v_and_b32 v105, 0xffff0000, v90
    v_fmac_f32 v100, v104, v30
    v_fmac_f32 v101, v105, v30
    v_lshlrev_b32 v104, 16, v91
    v_and_b32 v105, 0xffff0000, v91
    v_fmac_f32 v102, v104, v30
    v_fmac_f32 v103, v105, v30
    s_waitcnt vmcnt(0)
    v_lshlrev_b32 v104, 16, v92
    v_and_b32 v105, 0xffff0000, v92
    v_fmac_f32 v96, v104, v31
    v_fmac_f32 v97, v105, v31
    v_lshlrev_b32 v104, 16, v93
    v_and_b32 v105, 0xffff0000, v93
    v_fmac_f32 v98, v104, v31
    v_fmac_f32 v99, v105, v31
    v_lshlrev_b32 v104, 16, v94
    v_and_b32 v105, 0xffff0000, v94
    v_fmac_f32 v100, v104, v31
    v_fmac_f32 v101, v105, v31
    v_lshlrev_b32 v104, 16, v95
    v_and_b32 v105, 0xffff0000, v95
    v_fmac_f32 v102, v104, v31
    v_fmac_f32 v103, v105, v31
    v_lshlrev_b32 v104, 5, v0
    ds_write_b128 v104, v[96:99]
    ds_write_b128 v104, v[100:103] offset:16
    v_lshlrev_b32 v105, 2, v1
    s_lshl_b32 s46, s44, 11
    v_add_u32 v104, s46, v105
    s_waitcnt lgkmcnt(0)
    ds_read_b32 v96, v104 offset:0
    ds_read_b32 v97, v104 offset:256
    ds_read_b32 v98, v104 offset:512
    ds_read_b32 v99, v104 offset:768
    ds_read_b32 v100, v104 offset:1024
    ds_read_b32 v101, v104 offset:1280
    ds_read_b32 v102, v104 offset:1536
    ds_read_b32 v103, v104 offset:1792
    s_waitcnt lgkmcnt(0)
    v_add_f32 v96, v96, v100
    v_add_f32 v97, v97, v101
    v_add_f32 v98, v98, v102
    v_add_f32 v99, v99, v103
    v_add_f32 v96, v96, v98
    v_add_f32 v97, v97, v99
    v_add_f32 v96, v96, v97
    v_lshlrev_b32 v104, 2, v0
    ds_write_b32 v104, v96 offset:16384
    s_waitcnt lgkmcnt(0)
    s_barrier
    s_cmp_lg_u32 s44, 0
    s_cbranch_scc1 L_m_sk_25
    ds_read_b32 v96, v105 offset:16384
    ds_read_b32 v97, v105 offset:16640
    ds_read_b32 v98, v105 offset:16896
    ds_read_b32 v99, v105 offset:17152
    ds_read_b32 v100, v105 offset:17408
    ds_read_b32 v101, v105 offset:17664
    ds_read_b32 v102, v105 offset:17920
    ds_read_b32 v103, v105 offset:18176
    s_waitcnt lgkmcnt(0)
    v_add_f32 v96, v96, v100
    v_add_f32 v97, v97, v101
    v_add_f32 v98, v98, v102
    v_add_f32 v99, v99, v103
    v_add_f32 v96, v96, v98
    v_add_f32 v97, v97, v99
    v_add_f32 v96, v96, v97
    v_cvt_pk_bf16_f32 v96, 0, v96
    s_lshl_b32 s46, s53, 1
    buffer_store_dword v96, v105, s[12:15], s46 offen sc1
L_m_sk_25:
    s_barrier
    s_add_u32 s53, s53, 128
    s_and_b32 s46, s53, 511
    s_cmp_lg_u32 s46, 0
    s_cbranch_scc1 L_m_loop_24
    s_lshl_b32 s54, s55, 7
    s_add_u32 s54, s54, 0x10e400
    s_mov_b32 s60, 0
    s_waitcnt vmcnt(0)
    s_cmp_lg_u32 s44, 0
    s_cbranch_scc1 L_sf_26
    v_mov_b32 v8, s60
    v_add_u32 v8, 1, v8
    v_mov_b32 v9, 0
    s_mov_b64 exec, 1
    buffer_store_dword v8, v9, s[12:15], s54 offen sc1
    s_mov_b64 exec, -1
L_sf_26:
    s_barrier
L_w_h_17_s:
    s_mov_b32 s77, s48
    s_cmp_eq_u32 s48, 14
    s_cselect_b32 s53, 2, 1
    s_sub_u32 s48, s48, 12
    s_min_u32 s48, s48, 2
    s_mov_b32 s79, 0
L_w_h_17_n:
    s_cmp_eq_u32 s53, 1
    s_cselect_b32 s74, 46, 54
    s_mov_b32 s75, 64
    s_mov_b32 s76, 65536
    s_branch L_w_g_10_e
L_w_h_17:
    s_mov_b32 s48, s77
    s_cmp_lt_u32 s48, 14
    s_cbranch_scc1 L_w_att_15
    s_and_b32 s42, s40, 3
    s_lshr_b32 s43, s40, 2
    s_cmp_eq_u32 s48, 14
    s_cbranch_scc1 L_w_c_16
    s_mov_b32 s75, 58
    s_mov_b32 s76, 0
    s_mov_b32 s78, 2
L_w_h_17_f:
    s_load_dwordx2 s[4:5], s[0:1], 112
    s_load_dwordx2 s[6:7], s[0:1], 88
    v_lshlrev_b32 v2, 4, v1
    v_lshlrev_b32 v3, 5, v1
    s_waitcnt lgkmcnt(0)
    s_mov_b32 s24, s4
    s_and_b32 s25, s5, 0xffff
    s_mov_b32 s26, 0x400000
    s_mov_b32 s27, 0x00020000
    s_mov_b32 s28, s6
    s_and_b32 s29, s7, 0xffff
    s_mov_b32 s30, 0x800
    s_mov_b32 s31, 0x00020000
    s_cmp_lg_u32 s44, 0
    s_cbranch_scc1 L_mw_27
    v_and_b32 v8, 15, v1
    v_lshlrev_b32 v8, 7, v8
    s_mov_b32 s46, 0x10e400
    s_mov_b32 s47, 0
    s_mov_b32 s70, 0
L_spin_28:
    buffer_load_dword v9, v8, s[12:15], s46 offen sc1
    s_waitcnt vmcnt(0)
    v_cmp_ge_u32 vcc, s47, v9
    s_add_u32 s70, s70, 1
    s_cbranch_vccz L_spok_29
    s_sleep 2
    s_cmp_lt_u32 s70, 524288
    s_cbranch_scc1 L_spin_28
    s_branch L_c_done_1
L_spok_29:
L_mw_27:
    s_barrier
    s_mov_b32 s46, 20480
    buffer_load_dwordx4 v[16:19], v3, s[12:15], s46 offen offset:0 sc1
    buffer_load_dwordx4 v[20:23], v3, s[12:15], s46 offen offset:16 sc1
    buffer_load_dwordx4 v[24:27], v3, s[12:15], s46 offen offset:2048 sc1
    buffer_load_dwordx4 v[28:31], v3, s[12:15], s46 offen offset:2064 sc1
    buffer_load_dwordx4 v[48:51], v2, s[28:31], 0 offen
    buffer_load_dwordx4 v[52:55], v2, s[28:31], 0 offen offset:1024
    s_waitcnt vmcnt(0)
    v_lshlrev_b32 v32, 16, v48
    v_and_b32 v33, 0xffff0000, v48
    v_lshlrev_b32 v34, 16, v49
    v_and_b32 v35, 0xffff0000, v49
    v_lshlrev_b32 v36, 16, v50
    v_and_b32 v37, 0xffff0000, v50
    v_lshlrev_b32 v38, 16, v51
    v_and_b32 v39, 0xffff0000, v51
    v_lshlrev_b32 v40, 16, v52
    v_and_b32 v41, 0xffff0000, v52
    v_lshlrev_b32 v42, 16, v53
    v_and_b32 v43, 0xffff0000, v53
    v_lshlrev_b32 v44, 16, v54
    v_and_b32 v45, 0xffff0000, v54
    v_lshlrev_b32 v46, 16, v55
    v_and_b32 v47, 0xffff0000, v55
    s_lshl_b32 s46, s42, 14
    s_lshl_b32 s47, s44, 11
    s_add_u32 s46, s46, s47
    s_add_u32 s46, s46, 0xb000000
    v_add_u32 v4, s46, v2
    v_and_b32 v5, 31, v1
    v_lshlrev_b32 v5, 7, v5
    v_add_u32 v5, 0x108400, v5
    v_lshlrev_b32 v6, 2, v1
    s_lshl_b32 s46, s44, 9
    v_add_u32 v6, s46, v6
    s_lshl_b32 s46, s44, 12
    v_add_u32 v7, s46, v3
    s_lshl_b32 s46, s42, 3
    s_add_u32 s46, s46, s44
    s_lshl_b32 s46, s46, 11
    v_add_u32 v8, s46, v2
    v_add_u32 v9, 0x800000, v8
    s_mov_b32 s60, s43
L_r_loop_30:
    s_lshl_b32 s61, s60, 18
    s_lshl_b32 s63, s60, 16
    s_cmp_lg_u32 s44, 0
    s_cbranch_scc1 L_r_nsp_31
    s_mov_b32 s70, 0
L_spin_32:
    buffer_load_dword v14, v5, s[12:15], s76 offen sc1
    s_waitcnt vmcnt(0)
    v_cmp_ge_u32 vcc, s60, v14
    s_add_u32 s70, s70, 1
    s_cbranch_vccz L_spok_33
    s_sleep 3
    s_cmp_lt_u32 s70, 524288
    s_cbranch_scc1 L_spin_32
    s_branch L_c_done_1
L_spok_33:
L_r_nsp_31:
    s_barrier
    buffer_load_dwordx4 v[96:99], v4, s[12:15], s61 offen offset:0 sc1
    buffer_load_dwordx4 v[100:103], v4, s[12:15], s61 offen offset:1024 sc1
    s_add_u32 s61, s61, 65536
    buffer_load_dwordx4 v[104:107], v4, s[12:15], s61 offen offset:0 sc1
    buffer_load_dwordx4 v[108:111], v4, s[12:15], s61 offen offset:1024 sc1
    s_add_u32 s61, s61, 65536
    buffer_load_dwordx4 v[112:115], v4, s[12:15], s61 offen offset:0 sc1
    buffer_load_dwordx4 v[116:119], v4, s[12:15], s61 offen offset:1024 sc1
    s_add_u32 s61, s61, 65536
    buffer_load_dwordx4 v[120:123], v4, s[12:15], s61 offen offset:0 sc1
    buffer_load_dwordx4 v[124:127], v4, s[12:15], s61 offen offset:1024 sc1
    buffer_load_dwordx4 a[0:3], v9, s[12:15], s63 offen sc1
    buffer_load_dwordx4 a[4:7], v9, s[12:15], s63 offen offset:1024 sc1
    s_waitcnt vmcnt(8)
    v_lshlrev_b32 v64, 16, v96
    v_and_b32 v65, 0xffff0000, v96
    v_lshlrev_b32 v66, 16, v97
    v_and_b32 v67, 0xffff0000, v97
    v_lshlrev_b32 v68, 16, v98
    v_and_b32 v69, 0xffff0000, v98
    v_lshlrev_b32 v70, 16, v99
    v_and_b32 v71, 0xffff0000, v99
    v_lshlrev_b32 v72, 16, v100
    v_and_b32 v73, 0xffff0000, v100
    v_lshlrev_b32 v74, 16, v101
    v_and_b32 v75, 0xffff0000, v101
    v_lshlrev_b32 v76, 16, v102
    v_and_b32 v77, 0xffff0000, v102
    v_lshlrev_b32 v78, 16, v103
    v_and_b32 v79, 0xffff0000, v103
    s_waitcnt vmcnt(6)
    v_lshlrev_b32 v80, 16, v104
    v_and_b32 v81, 0xffff0000, v104
    v_lshlrev_b32 v82, 16, v105
    v_and_b32 v83, 0xffff0000, v105
    v_lshlrev_b32 v84, 16, v106
    v_and_b32 v85, 0xffff0000, v106
    v_lshlrev_b32 v86, 16, v107
    v_and_b32 v87, 0xffff0000, v107
    v_lshlrev_b32 v88, 16, v108
    v_and_b32 v89, 0xffff0000, v108
    v_lshlrev_b32 v90, 16, v109
    v_and_b32 v91, 0xffff0000, v109
    v_lshlrev_b32 v92, 16, v110
    v_and_b32 v93, 0xffff0000, v110
    v_lshlrev_b32 v94, 16, v111
    v_and_b32 v95, 0xffff0000, v111
    v_pk_add_f32 v[64:65], v[64:65], v[80:81]
    v_pk_add_f32 v[66:67], v[66:67], v[82:83]
    v_pk_add_f32 v[68:69], v[68:69], v[84:85]
    v_pk_add_f32 v[70:71], v[70:71], v[86:87]
    v_pk_add_f32 v[72:73], v[72:73], v[88:89]
    v_pk_add_f32 v[74:75], v[74:75], v[90:91]
    v_pk_add_f32 v[76:77], v[76:77], v[92:93]
    v_pk_add_f32 v[78:79], v[78:79], v[94:95]
    s_waitcnt vmcnt(4)
    v_lshlrev_b32 v80, 16, v112
    v_and_b32 v81, 0xffff0000, v112
    v_lshlrev_b32 v82, 16, v113
    v_and_b32 v83, 0xffff0000, v113
    v_lshlrev_b32 v84, 16, v114
    v_and_b32 v85, 0xffff0000, v114
    v_lshlrev_b32 v86, 16, v115
    v_and_b32 v87, 0xffff0000, v115
    v_lshlrev_b32 v88, 16, v116
    v_and_b32 v89, 0xffff0000, v116
    v_lshlrev_b32 v90, 16, v117
    v_and_b32 v91, 0xffff0000, v117
    v_lshlrev_b32 v92, 16, v118
    v_and_b32 v93, 0xffff0000, v118
    v_lshlrev_b32 v94, 16, v119
    v_and_b32 v95, 0xffff0000, v119
    v_pk_add_f32 v[64:65], v[64:65], v[80:81]
    v_pk_add_f32 v[66:67], v[66:67], v[82:83]
    v_pk_add_f32 v[68:69], v[68:69], v[84:85]
    v_pk_add_f32 v[70:71], v[70:71], v[86:87]
    v_pk_add_f32 v[72:73], v[72:73], v[88:89]
    v_pk_add_f32 v[74:75], v[74:75], v[90:91]
    v_pk_add_f32 v[76:77], v[76:77], v[92:93]
    v_pk_add_f32 v[78:79], v[78:79], v[94:95]
    s_waitcnt vmcnt(2)
    v_lshlrev_b32 v80, 16, v120
    v_and_b32 v81, 0xffff0000, v120
    v_lshlrev_b32 v82, 16, v121
    v_and_b32 v83, 0xffff0000, v121
    v_lshlrev_b32 v84, 16, v122
    v_and_b32 v85, 0xffff0000, v122
    v_lshlrev_b32 v86, 16, v123
    v_and_b32 v87, 0xffff0000, v123
    v_lshlrev_b32 v88, 16, v124
    v_and_b32 v89, 0xffff0000, v124
    v_lshlrev_b32 v90, 16, v125
    v_and_b32 v91, 0xffff0000, v125
    v_lshlrev_b32 v92, 16, v126
    v_and_b32 v93, 0xffff0000, v126
    v_lshlrev_b32 v94, 16, v127
    v_and_b32 v95, 0xffff0000, v127
    v_pk_add_f32 v[64:65], v[64:65], v[80:81]
    v_pk_add_f32 v[66:67], v[66:67], v[82:83]
    v_pk_add_f32 v[68:69], v[68:69], v[84:85]
    v_pk_add_f32 v[70:71], v[70:71], v[86:87]
    v_pk_add_f32 v[72:73], v[72:73], v[88:89]
    v_pk_add_f32 v[74:75], v[74:75], v[90:91]
    v_pk_add_f32 v[76:77], v[76:77], v[92:93]
    v_pk_add_f32 v[78:79], v[78:79], v[94:95]
    ds_write_b32 v6, v64 offset:0
    ds_write_b32 v6, v65 offset:4096
    ds_write_b32 v6, v66 offset:8192
    ds_write_b32 v6, v67 offset:12288
    ds_write_b32 v6, v68 offset:16384
    ds_write_b32 v6, v69 offset:20480
    ds_write_b32 v6, v70 offset:24576
    ds_write_b32 v6, v71 offset:28672
    ds_write_b32 v6, v72 offset:256
    ds_write_b32 v6, v73 offset:4352
    ds_write_b32 v6, v74 offset:8448
    ds_write_b32 v6, v75 offset:12544
    ds_write_b32 v6, v76 offset:16640
    ds_write_b32 v6, v77 offset:20736
    ds_write_b32 v6, v78 offset:24832
    ds_write_b32 v6, v79 offset:28928
    s_waitcnt lgkmcnt(0)
    s_barrier
    ds_read_b128 v[64:67], v7
    ds_read_b128 v[68:71], v7 offset:16
    ds_read_b128 v[72:75], v7 offset:2048
    ds_read_b128 v[76:79], v7 offset:2064
    s_waitcnt vmcnt(0)
    v_accvgpr_read_b32 v96, a0
    v_accvgpr_read_b32 v97, a1
    v_accvgpr_read_b32 v98, a2
    v_accvgpr_read_b32 v99, a3
    v_accvgpr_read_b32 v100, a4
    v_accvgpr_read_b32 v101, a5
    v_accvgpr_read_b32 v102, a6
    v_accvgpr_read_b32 v103, a7
    v_lshlrev_b32 v80, 16, v96
    v_and_b32 v81, 0xffff0000, v96
    v_lshlrev_b32 v82, 16, v97
    v_and_b32 v83, 0xffff0000, v97
    v_lshlrev_b32 v84, 16, v98
    v_and_b32 v85, 0xffff0000, v98
    v_lshlrev_b32 v86, 16, v99
    v_and_b32 v87, 0xffff0000, v99
    v_lshlrev_b32 v88, 16, v100
    v_and_b32 v89, 0xffff0000, v100
    v_lshlrev_b32 v90, 16, v101
    v_and_b32 v91, 0xffff0000, v101
    v_lshlrev_b32 v92, 16, v102
    v_and_b32 v93, 0xffff0000, v102
    v_lshlrev_b32 v94, 16, v103
    v_and_b32 v95, 0xffff0000, v103
    s_waitcnt lgkmcnt(0)
    v_cvt_pk_bf16_f32 v64, 0, v64
    v_cvt_pk_bf16_f32 v65, 0, v65
    v_cvt_pk_bf16_f32 v66, 0, v66
    v_cvt_pk_bf16_f32 v67, 0, v67
    v_cvt_pk_bf16_f32 v68, 0, v68
    v_cvt_pk_bf16_f32 v69, 0, v69
    v_cvt_pk_bf16_f32 v70, 0, v70
    v_cvt_pk_bf16_f32 v71, 0, v71
    v_cvt_pk_bf16_f32 v72, 0, v72
    v_cvt_pk_bf16_f32 v73, 0, v73
    v_cvt_pk_bf16_f32 v74, 0, v74
    v_cvt_pk_bf16_f32 v75, 0, v75
    v_cvt_pk_bf16_f32 v76, 0, v76
    v_cvt_pk_bf16_f32 v77, 0, v77
    v_cvt_pk_bf16_f32 v78, 0, v78
    v_cvt_pk_bf16_f32 v79, 0, v79
    v_pk_add_f32 v[64:65], v[64:65], v[32:33]
    v_pk_add_f32 v[66:67], v[66:67], v[34:35]
    v_pk_add_f32 v[68:69], v[68:69], v[36:37]
    v_pk_add_f32 v[70:71], v[70:71], v[38:39]
    v_pk_add_f32 v[72:73], v[72:73], v[40:41]
    v_pk_add_f32 v[74:75], v[74:75], v[42:43]
    v_pk_add_f32 v[76:77], v[76:77], v[44:45]
    v_pk_add_f32 v[78:79], v[78:79], v[46:47]
    v_cvt_pk_bf16_f32 v64, 0, v64
    v_cvt_pk_bf16_f32 v65, 0, v65
    v_cvt_pk_bf16_f32 v66, 0, v66
    v_cvt_pk_bf16_f32 v67, 0, v67
    v_cvt_pk_bf16_f32 v68, 0, v68
    v_cvt_pk_bf16_f32 v69, 0, v69
    v_cvt_pk_bf16_f32 v70, 0, v70
    v_cvt_pk_bf16_f32 v71, 0, v71
    v_cvt_pk_bf16_f32 v72, 0, v72
    v_cvt_pk_bf16_f32 v73, 0, v73
    v_cvt_pk_bf16_f32 v74, 0, v74
    v_cvt_pk_bf16_f32 v75, 0, v75
    v_cvt_pk_bf16_f32 v76, 0, v76
    v_cvt_pk_bf16_f32 v77, 0, v77
    v_cvt_pk_bf16_f32 v78, 0, v78
    v_cvt_pk_bf16_f32 v79, 0, v79
    v_pk_mul_f32 v[64:65], v[64:65], v[16:17]
    v_pk_mul_f32 v[66:67], v[66:67], v[18:19]
    v_pk_mul_f32 v[68:69], v[68:69], v[20:21]
    v_pk_mul_f32 v[70:71], v[70:71], v[22:23]
    v_pk_mul_f32 v[72:73], v[72:73], v[24:25]
    v_pk_mul_f32 v[74:75], v[74:75], v[26:27]
    v_pk_mul_f32 v[76:77], v[76:77], v[28:29]
    v_pk_mul_f32 v[78:79], v[78:79], v[30:31]
    v_cvt_pk_bf16_f32 v64, 0, v64
    v_cvt_pk_bf16_f32 v65, 0, v65
    v_cvt_pk_bf16_f32 v66, 0, v66
    v_cvt_pk_bf16_f32 v67, 0, v67
    v_cvt_pk_bf16_f32 v68, 0, v68
    v_cvt_pk_bf16_f32 v69, 0, v69
    v_cvt_pk_bf16_f32 v70, 0, v70
    v_cvt_pk_bf16_f32 v71, 0, v71
    v_cvt_pk_bf16_f32 v72, 0, v72
    v_cvt_pk_bf16_f32 v73, 0, v73
    v_cvt_pk_bf16_f32 v74, 0, v74
    v_cvt_pk_bf16_f32 v75, 0, v75
    v_cvt_pk_bf16_f32 v76, 0, v76
    v_cvt_pk_bf16_f32 v77, 0, v77
    v_cvt_pk_bf16_f32 v78, 0, v78
    v_cvt_pk_bf16_f32 v79, 0, v79
    v_pk_add_f32 v[64:65], v[64:65], v[80:81]
    v_pk_add_f32 v[66:67], v[66:67], v[82:83]
    v_pk_add_f32 v[68:69], v[68:69], v[84:85]
    v_pk_add_f32 v[70:71], v[70:71], v[86:87]
    v_pk_add_f32 v[72:73], v[72:73], v[88:89]
    v_pk_add_f32 v[74:75], v[74:75], v[90:91]
    v_pk_add_f32 v[76:77], v[76:77], v[92:93]
    v_pk_add_f32 v[78:79], v[78:79], v[94:95]
    v_cvt_pk_bf16_f32 v96, v64, v65
    v_cvt_pk_bf16_f32 v97, v66, v67
    v_cvt_pk_bf16_f32 v98, v68, v69
    v_cvt_pk_bf16_f32 v99, v70, v71
    v_cvt_pk_bf16_f32 v100, v72, v73
    v_cvt_pk_bf16_f32 v101, v74, v75
    v_cvt_pk_bf16_f32 v102, v76, v77
    v_cvt_pk_bf16_f32 v103, v78, v79
    buffer_store_dwordx4 v[96:99], v8, s[24:27], s63 offen
    buffer_store_dwordx4 v[100:103], v8, s[24:27], s63 offen offset:1024
    s_add_u32 s60, s60, s78
    s_cmp_lt_u32 s60, s75
    s_cbranch_scc1 L_r_loop_30
    s_branch L_c_done_1
L_w_c_16:
    s_load_dwordx2 s[4:5], s[0:1], 0
    s_load_dwordx2 s[6:7], s[0:1], 88
    v_lshlrev_b32 v2, 4, v1
    v_lshlrev_b32 v3, 5, v1
    s_waitcnt lgkmcnt(0)
    s_mov_b32 s24, s4
    s_and_b32 s25, s5, 0xffff
    s_mov_b32 s26, 0x400000
    s_mov_b32 s27, 0x00020000
    s_mov_b32 s28, s6
    s_and_b32 s29, s7, 0xffff
    s_mov_b32 s30, 0x800
    s_mov_b32 s31, 0x00020000
    s_cmp_lg_u32 s44, 0
    s_cbranch_scc1 L_mw_34
    v_and_b32 v8, 15, v1
    v_lshlrev_b32 v8, 7, v8
    s_mov_b32 s46, 0x10e400
    s_mov_b32 s47, 0
    s_mov_b32 s70, 0
L_spin_35:
    buffer_load_dword v9, v8, s[12:15], s46 offen sc1
    s_waitcnt vmcnt(0)
    v_cmp_ge_u32 vcc, s47, v9
    s_add_u32 s70, s70, 1
    s_cbranch_vccz L_spok_36
    s_sleep 2
    s_cmp_lt_u32 s70, 524288
    s_cbranch_scc1 L_spin_35
    s_branch L_c_done_1
L_spok_36:
L_mw_34:
    s_barrier
    s_mov_b32 s46, 8192
    buffer_load_dwordx4 v[16:19], v3, s[12:15], s46 offen offset:0 sc1
    buffer_load_dwordx4 v[20:23], v3, s[12:15], s46 offen offset:16 sc1
    buffer_load_dwordx4 v[24:27], v3, s[12:15], s46 offen offset:2048 sc1
    buffer_load_dwordx4 v[28:31], v3, s[12:15], s46 offen offset:2064 sc1
    s_mov_b32 s46, 16384
    buffer_load_dwordx4 v[32:35], v3, s[12:15], s46 offen offset:0 sc1
    buffer_load_dwordx4 v[36:39], v3, s[12:15], s46 offen offset:16 sc1
    buffer_load_dwordx4 v[40:43], v3, s[12:15], s46 offen offset:2048 sc1
    buffer_load_dwordx4 v[44:47], v3, s[12:15], s46 offen offset:2064 sc1
    s_mov_b32 s46, 12288
    buffer_load_dwordx4 v[48:51], v3, s[12:15], s46 offen offset:0 sc1
    buffer_load_dwordx4 v[52:55], v3, s[12:15], s46 offen offset:16 sc1
    buffer_load_dwordx4 v[56:59], v3, s[12:15], s46 offen offset:2048 sc1
    buffer_load_dwordx4 v[60:63], v3, s[12:15], s46 offen offset:2064 sc1
    s_waitcnt vmcnt(0)
    v_add_f32 v32, 1.0, v32
    v_add_f32 v33, 1.0, v33
    v_add_f32 v34, 1.0, v34
    v_add_f32 v35, 1.0, v35
    v_add_f32 v36, 1.0, v36
    v_add_f32 v37, 1.0, v37
    v_add_f32 v38, 1.0, v38
    v_add_f32 v39, 1.0, v39
    v_add_f32 v40, 1.0, v40
    v_add_f32 v41, 1.0, v41
    v_add_f32 v42, 1.0, v42
    v_add_f32 v43, 1.0, v43
    v_add_f32 v44, 1.0, v44
    v_add_f32 v45, 1.0, v45
    v_add_f32 v46, 1.0, v46
    v_add_f32 v47, 1.0, v47
    v_cvt_pk_bf16_f32 v32, 0, v32
    v_cvt_pk_bf16_f32 v33, 0, v33
    v_cvt_pk_bf16_f32 v34, 0, v34
    v_cvt_pk_bf16_f32 v35, 0, v35
    v_cvt_pk_bf16_f32 v36, 0, v36
    v_cvt_pk_bf16_f32 v37, 0, v37
    v_cvt_pk_bf16_f32 v38, 0, v38
    v_cvt_pk_bf16_f32 v39, 0, v39
    v_cvt_pk_bf16_f32 v40, 0, v40
    v_cvt_pk_bf16_f32 v41, 0, v41
    v_cvt_pk_bf16_f32 v42, 0, v42
    v_cvt_pk_bf16_f32 v43, 0, v43
    v_cvt_pk_bf16_f32 v44, 0, v44
    v_cvt_pk_bf16_f32 v45, 0, v45
    v_cvt_pk_bf16_f32 v46, 0, v46
    v_cvt_pk_bf16_f32 v47, 0, v47
    s_lshl_b32 s46, s42, 14
    s_lshl_b32 s47, s44, 11
    s_add_u32 s46, s46, s47
    s_add_u32 s46, s46, 0x9000000
    v_add_u32 v4, s46, v2
    v_and_b32 v5, 31, v1
    v_lshlrev_b32 v5, 7, v5
    v_add_u32 v5, 0x107400, v5
    v_lshlrev_b32 v6, 2, v1
    s_lshl_b32 s46, s44, 9
    v_add_u32 v6, s46, v6
    s_lshl_b32 s46, s44, 12
    v_add_u32 v7, s46, v3
    s_lshl_b32 s46, s42, 3
    s_add_u32 s46, s46, s44
    s_lshl_b32 s46, s46, 11
    v_add_u32 v8, s46, v2
    v_add_u32 v9, 0x800000, v8
    s_mul_i32 s46, s44, 2064
    s_add_u32 s46, s46, 32768
    v_add_u32 v10, s46, v2
    v_and_b32 v11, 7, v1
    v_lshrrev_b32 v12, 3, v1
    v_mul_u32_u24 v13, 2064, v11
    v_lshl_add_u32 v13, v12, 4, v13
    s_lshl_b32 s46, s44, 8
    s_add_u32 s46, s46, 32768
    v_add_u32 v13, s46, v13
    v_lshlrev_b32 v11, 4, v11
    v_lshl_add_u32 v11, v12, 9, v11
    s_lshl_b32 s46, s44, 13
    s_lshl_b32 s47, s42, 7
    s_add_u32 s46, s46, s47
    s_add_u32 s46, s46, 0xc00000
    v_add_u32 v11, s46, v11
    v_add_u32 v12, 4096, v11
    s_lshl_b32 s52, s43, 9
    s_lshl_b32 s47, s42, 7
    s_add_u32 s52, s52, s47
    s_add_u32 s52, s52, 0x10ec00
    s_mov_b32 s60, s43
L_r_loop_37:
    s_lshl_b32 s61, s60, 18
    s_lshl_b32 s63, s60, 16
    buffer_load_dwordx4 a[0:3], v8, s[24:27], s63 offen
    buffer_load_dwordx4 a[4:7], v8, s[24:27], s63 offen offset:1024
    s_cmp_lg_u32 s44, 0
    s_cbranch_scc1 L_r_nsp_38
    s_mov_b32 s70, 0
L_spin_39:
    buffer_load_dword v14, v5, s[12:15], 0 offen sc1
    s_waitcnt vmcnt(0)
    v_cmp_ge_u32 vcc, s60, v14
    s_add_u32 s70, s70, 1
    s_cbranch_vccz L_spok_40
    s_sleep 3
    s_cmp_lt_u32 s70, 524288
    s_cbranch_scc1 L_spin_39
    s_branch L_c_done_1
L_spok_40:
L_r_nsp_38:
    s_barrier
    buffer_load_dwordx4 v[96:99], v4, s[12:15], s61 offen offset:0 sc1
    buffer_load_dwordx4 v[100:103], v4, s[12:15], s61 offen offset:1024 sc1
    s_add_u32 s61, s61, 65536
    buffer_load_dwordx4 v[104:107], v4, s[12:15], s61 offen offset:0 sc1
    buffer_load_dwordx4 v[108:111], v4, s[12:15], s61 offen offset:1024 sc1
    s_add_u32 s61, s61, 65536
    buffer_load_dwordx4 v[112:115], v4, s[12:15], s61 offen offset:0 sc1
    buffer_load_dwordx4 v[116:119], v4, s[12:15], s61 offen offset:1024 sc1
    s_add_u32 s61, s61, 65536
    buffer_load_dwordx4 v[120:123], v4, s[12:15], s61 offen offset:0 sc1
    buffer_load_dwordx4 v[124:127], v4, s[12:15], s61 offen offset:1024 sc1
    s_waitcnt vmcnt(6)
    v_lshlrev_b32 v64, 16, v96
    v_and_b32 v65, 0xffff0000, v96
    v_lshlrev_b32 v66, 16, v97
    v_and_b32 v67, 0xffff0000, v97
    v_lshlrev_b32 v68, 16, v98
    v_and_b32 v69, 0xffff0000, v98
    v_lshlrev_b32 v70, 16, v99
    v_and_b32 v71, 0xffff0000, v99
    v_lshlrev_b32 v72, 16, v100
    v_and_b32 v73, 0xffff0000, v100
    v_lshlrev_b32 v74, 16, v101
    v_and_b32 v75, 0xffff0000, v101
    v_lshlrev_b32 v76, 16, v102
    v_and_b32 v77, 0xffff0000, v102
    v_lshlrev_b32 v78, 16, v103
    v_and_b32 v79, 0xffff0000, v103
    s_waitcnt vmcnt(4)
    v_lshlrev_b32 v80, 16, v104
    v_and_b32 v81, 0xffff0000, v104
    v_lshlrev_b32 v82, 16, v105
    v_and_b32 v83, 0xffff0000, v105
    v_lshlrev_b32 v84, 16, v106
    v_and_b32 v85, 0xffff0000, v106
    v_lshlrev_b32 v86, 16, v107
    v_and_b32 v87, 0xffff0000, v107
    v_lshlrev_b32 v88, 16, v108
    v_and_b32 v89, 0xffff0000, v108
    v_lshlrev_b32 v90, 16, v109
    v_and_b32 v91, 0xffff0000, v109
    v_lshlrev_b32 v92, 16, v110
    v_and_b32 v93, 0xffff0000, v110
    v_lshlrev_b32 v94, 16, v111
    v_and_b32 v95, 0xffff0000, v111
    v_pk_add_f32 v[64:65], v[64:65], v[80:81]
    v_pk_add_f32 v[66:67], v[66:67], v[82:83]
    v_pk_add_f32 v[68:69], v[68:69], v[84:85]
    v_pk_add_f32 v[70:71], v[70:71], v[86:87]
    v_pk_add_f32 v[72:73], v[72:73], v[88:89]
    v_pk_add_f32 v[74:75], v[74:75], v[90:91]
    v_pk_add_f32 v[76:77], v[76:77], v[92:93]
    v_pk_add_f32 v[78:79], v[78:79], v[94:95]
    s_waitcnt vmcnt(2)
    v_lshlrev_b32 v80, 16, v112
    v_and_b32 v81, 0xffff0000, v112
    v_lshlrev_b32 v82, 16, v113
    v_and_b32 v83, 0xffff0000, v113
    v_lshlrev_b32 v84, 16, v114
    v_and_b32 v85, 0xffff0000, v114
    v_lshlrev_b32 v86, 16, v115
    v_and_b32 v87, 0xffff0000, v115
    v_lshlrev_b32 v88, 16, v116
    v_and_b32 v89, 0xffff0000, v116
    v_lshlrev_b32 v90, 16, v117
    v_and_b32 v91, 0xffff0000, v117
    v_lshlrev_b32 v92, 16, v118
    v_and_b32 v93, 0xffff0000, v118
    v_lshlrev_b32 v94, 16, v119
    v_and_b32 v95, 0xffff0000, v119
    v_pk_add_f32 v[64:65], v[64:65], v[80:81]
    v_pk_add_f32 v[66:67], v[66:67], v[82:83]
    v_pk_add_f32 v[68:69], v[68:69], v[84:85]
    v_pk_add_f32 v[70:71], v[70:71], v[86:87]
    v_pk_add_f32 v[72:73], v[72:73], v[88:89]
    v_pk_add_f32 v[74:75], v[74:75], v[90:91]
    v_pk_add_f32 v[76:77], v[76:77], v[92:93]
    v_pk_add_f32 v[78:79], v[78:79], v[94:95]
    s_waitcnt vmcnt(0)
    v_lshlrev_b32 v80, 16, v120
    v_and_b32 v81, 0xffff0000, v120
    v_lshlrev_b32 v82, 16, v121
    v_and_b32 v83, 0xffff0000, v121
    v_lshlrev_b32 v84, 16, v122
    v_and_b32 v85, 0xffff0000, v122
    v_lshlrev_b32 v86, 16, v123
    v_and_b32 v87, 0xffff0000, v123
    v_lshlrev_b32 v88, 16, v124
    v_and_b32 v89, 0xffff0000, v124
    v_lshlrev_b32 v90, 16, v125
    v_and_b32 v91, 0xffff0000, v125
    v_lshlrev_b32 v92, 16, v126
    v_and_b32 v93, 0xffff0000, v126
    v_lshlrev_b32 v94, 16, v127
    v_and_b32 v95, 0xffff0000, v127
    v_pk_add_f32 v[64:65], v[64:65], v[80:81]
    v_pk_add_f32 v[66:67], v[66:67], v[82:83]
    v_pk_add_f32 v[68:69], v[68:69], v[84:85]
    v_pk_add_f32 v[70:71], v[70:71], v[86:87]
    v_pk_add_f32 v[72:73], v[72:73], v[88:89]
    v_pk_add_f32 v[74:75], v[74:75], v[90:91]
    v_pk_add_f32 v[76:77], v[76:77], v[92:93]
    v_pk_add_f32 v[78:79], v[78:79], v[94:95]
    ds_write_b32 v6, v64 offset:0
    ds_write_b32 v6, v65 offset:4096
    ds_write_b32 v6, v66 offset:8192
    ds_write_b32 v6, v67 offset:12288
    ds_write_b32 v6, v68 offset:16384
    ds_write_b32 v6, v69 offset:20480
    ds_write_b32 v6, v70 offset:24576
    ds_write_b32 v6, v71 offset:28672
    ds_write_b32 v6, v72 offset:256
    ds_write_b32 v6, v73 offset:4352
    ds_write_b32 v6, v74 offset:8448
    ds_write_b32 v6, v75 offset:12544
    ds_write_b32 v6, v76 offset:16640
    ds_write_b32 v6, v77 offset:20736
    ds_write_b32 v6, v78 offset:24832
    ds_write_b32 v6, v79 offset:28928
    s_waitcnt lgkmcnt(0)
    s_barrier
    ds_read_b128 v[64:67], v7
    ds_read_b128 v[68:71], v7 offset:16
    ds_read_b128 v[72:75], v7 offset:2048
    ds_read_b128 v[76:79], v7 offset:2064
    s_waitcnt vmcnt(0)
    v_accvgpr_read_b32 v96, a0
    v_accvgpr_read_b32 v97, a1
    v_accvgpr_read_b32 v98, a2
    v_accvgpr_read_b32 v99, a3
    v_accvgpr_read_b32 v100, a4
    v_accvgpr_read_b32 v101, a5
    v_accvgpr_read_b32 v102, a6
    v_accvgpr_read_b32 v103, a7
    v_lshlrev_b32 v80, 16, v96
    v_and_b32 v81, 0xffff0000, v96
    v_lshlrev_b32 v82, 16, v97
    v_and_b32 v83, 0xffff0000, v97
    v_lshlrev_b32 v84, 16, v98
    v_and_b32 v85, 0xffff0000, v98
    v_lshlrev_b32 v86, 16, v99
    v_and_b32 v87, 0xffff0000, v99
    v_lshlrev_b32 v88, 16, v100
    v_and_b32 v89, 0xffff0000, v100
    v_lshlrev_b32 v90, 16, v101
    v_and_b32 v91, 0xffff0000, v101
    v_lshlrev_b32 v92, 16, v102
    v_and_b32 v93, 0xffff0000, v102
    v_lshlrev_b32 v94, 16, v103
    v_and_b32 v95, 0xffff0000, v103
    s_waitcnt lgkmcnt(0)
    v_cvt_pk_bf16_f32 v64, 0, v64
    v_cvt_pk_bf16_f32 v65, 0, v65
    v_cvt_pk_bf16_f32 v66, 0, v66
    v_cvt_pk_bf16_f32 v67, 0, v67
    v_cvt_pk_bf16_f32 v68, 0, v68
    v_cvt_pk_bf16_f32 v69, 0, v69
    v_cvt_pk_bf16_f32 v70, 0, v70
    v_cvt_pk_bf16_f32 v71, 0, v71
    v_cvt_pk_bf16_f32 v72, 0, v72
    v_cvt_pk_bf16_f32 v73, 0, v73
    v_cvt_pk_bf16_f32 v74, 0, v74
    v_cvt_pk_bf16_f32 v75, 0, v75
    v_cvt_pk_bf16_f32 v76, 0, v76
    v_cvt_pk_bf16_f32 v77, 0, v77
    v_cvt_pk_bf16_f32 v78, 0, v78
    v_cvt_pk_bf16_f32 v79, 0, v79
    v_pk_mul_f32 v[64:65], v[64:65], v[16:17]
    v_pk_mul_f32 v[66:67], v[66:67], v[18:19]
    v_pk_mul_f32 v[68:69], v[68:69], v[20:21]
    v_pk_mul_f32 v[70:71], v[70:71], v[22:23]
    v_pk_mul_f32 v[72:73], v[72:73], v[24:25]
    v_pk_mul_f32 v[74:75], v[74:75], v[26:27]
    v_pk_mul_f32 v[76:77], v[76:77], v[28:29]
    v_pk_mul_f32 v[78:79], v[78:79], v[30:31]
    v_cvt_pk_bf16_f32 v64, 0, v64
    v_cvt_pk_bf16_f32 v65, 0, v65
    v_cvt_pk_bf16_f32 v66, 0, v66
    v_cvt_pk_bf16_f32 v67, 0, v67
    v_cvt_pk_bf16_f32 v68, 0, v68
    v_cvt_pk_bf16_f32 v69, 0, v69
    v_cvt_pk_bf16_f32 v70, 0, v70
    v_cvt_pk_bf16_f32 v71, 0, v71
    v_cvt_pk_bf16_f32 v72, 0, v72
    v_cvt_pk_bf16_f32 v73, 0, v73
    v_cvt_pk_bf16_f32 v74, 0, v74
    v_cvt_pk_bf16_f32 v75, 0, v75
    v_cvt_pk_bf16_f32 v76, 0, v76
    v_cvt_pk_bf16_f32 v77, 0, v77
    v_cvt_pk_bf16_f32 v78, 0, v78
    v_cvt_pk_bf16_f32 v79, 0, v79
    v_pk_add_f32 v[64:65], v[64:65], v[80:81]
    v_pk_add_f32 v[66:67], v[66:67], v[82:83]
    v_pk_add_f32 v[68:69], v[68:69], v[84:85]
    v_pk_add_f32 v[70:71], v[70:71], v[86:87]
    v_pk_add_f32 v[72:73], v[72:73], v[88:89]
    v_pk_add_f32 v[74:75], v[74:75], v[90:91]
    v_pk_add_f32 v[76:77], v[76:77], v[92:93]
    v_pk_add_f32 v[78:79], v[78:79], v[94:95]
    v_cvt_pk_bf16_f32 v96, v64, v65
    v_cvt_pk_bf16_f32 v97, v66, v67
    v_cvt_pk_bf16_f32 v98, v68, v69
    v_cvt_pk_bf16_f32 v99, v70, v71
    v_cvt_pk_bf16_f32 v100, v72, v73
    v_cvt_pk_bf16_f32 v101, v74, v75
    v_cvt_pk_bf16_f32 v102, v76, v77
    v_cvt_pk_bf16_f32 v103, v78, v79
    buffer_store_dwordx4 v[96:99], v9, s[12:15], s63 offen sc1
    buffer_store_dwordx4 v[100:103], v9, s[12:15], s63 offen offset:1024 sc1
    v_lshlrev_b32 v64, 16, v96
    v_and_b32 v65, 0xffff0000, v96
    v_lshlrev_b32 v66, 16, v97
    v_and_b32 v67, 0xffff0000, v97
    v_lshlrev_b32 v68, 16, v98
    v_and_b32 v69, 0xffff0000, v98
    v_lshlrev_b32 v70, 16, v99
    v_and_b32 v71, 0xffff0000, v99
    v_lshlrev_b32 v72, 16, v100
    v_and_b32 v73, 0xffff0000, v100
    v_lshlrev_b32 v74, 16, v101
    v_and_b32 v75, 0xffff0000, v101
    v_lshlrev_b32 v76, 16, v102
    v_and_b32 v77, 0xffff0000, v102
    v_lshlrev_b32 v78, 16, v103
    v_and_b32 v79, 0xffff0000, v103
    v_pk_add_f32 v[80:81], v[64:65], v[72:73]
    v_pk_add_f32 v[82:83], v[66:67], v[74:75]
    v_pk_add_f32 v[84:85], v[68:69], v[76:77]
    v_pk_add_f32 v[86:87], v[70:71], v[78:79]
    v_pk_add_f32 v[80:81], v[80:81], v[84:85]
    v_pk_add_f32 v[82:83], v[82:83], v[86:87]
    v_pk_add_f32 v[80:81], v[80:81], v[82:83]
    v_add_f32 v14, v80, v81
    s_nop 1
    v_add_f32_dpp v14, v14, v14 row_shr:1 row_mask:0xf bank_mask:0xf bound_ctrl:0
    s_nop 1
    v_add_f32_dpp v14, v14, v14 row_shr:2 row_mask:0xf bank_mask:0xf bound_ctrl:0
    s_nop 1
    v_add_f32_dpp v14, v14, v14 row_shr:4 row_mask:0xf bank_mask:0xf bound_ctrl:0
    s_nop 1
    v_add_f32_dpp v14, v14, v14 row_shr:8 row_mask:0xf bank_mask:0xf bound_ctrl:0
    s_nop 1
    v_add_f32_dpp v14, v14, v14 row_bcast:15 row_mask:0xa bank_mask:0xf
    s_nop 1
    v_add_f32_dpp v14, v14, v14 row_bcast:31 row_mask:0xc bank_mask:0xf
    s_nop 1
    v_readlane_b32 s46, v14, 63
    s_nop 1
    v_mov_b32 v15, s46
    v_mul_f32 v15, 0x3a800000, v15
    v_pk_add_f32 v[80:81], v[64:65], v[14:15] op_sel:[0,1] op_sel_hi:[1,1] neg_lo:[0,1] neg_hi:[0,1]
    v_pk_add_f32 v[82:83], v[66:67], v[14:15] op_sel:[0,1] op_sel_hi:[1,1] neg_lo:[0,1] neg_hi:[0,1]
    v_pk_add_f32 v[84:85], v[68:69], v[14:15] op_sel:[0,1] op_sel_hi:[1,1] neg_lo:[0,1] neg_hi:[0,1]
    v_pk_add_f32 v[86:87], v[70:71], v[14:15] op_sel:[0,1] op_sel_hi:[1,1] neg_lo:[0,1] neg_hi:[0,1]
    v_pk_add_f32 v[88:89], v[72:73], v[14:15] op_sel:[0,1] op_sel_hi:[1,1] neg_lo:[0,1] neg_hi:[0,1]
    v_pk_add_f32 v[90:91], v[74:75], v[14:15] op_sel:[0,1] op_sel_hi:[1,1] neg_lo:[0,1] neg_hi:[0,1]
    v_pk_add_f32 v[92:93], v[76:77], v[14:15] op_sel:[0,1] op_sel_hi:[1,1] neg_lo:[0,1] neg_hi:[0,1]
    v_pk_add_f32 v[94:95], v[78:79], v[14:15] op_sel:[0,1] op_sel_hi:[1,1] neg_lo:[0,1] neg_hi:[0,1]
    v_pk_mul_f32 v[104:105], v[80:81], v[80:81]
    v_pk_mul_f32 v[106:107], v[82:83], v[82:83]
    v_pk_fma_f32 v[104:105], v[84:85], v[84:85], v[104:105]
    v_pk_fma_f32 v[106:107], v[86:87], v[86:87], v[106:107]
    v_pk_fma_f32 v[104:105], v[88:89], v[88:89], v[104:105]
    v_pk_fma_f32 v[106:107], v[90:91], v[90:91], v[106:107]
    v_pk_fma_f32 v[104:105], v[92:93], v[92:93], v[104:105]
    v_pk_fma_f32 v[106:107], v[94:95], v[94:95], v[106:107]
    v_pk_add_f32 v[104:105], v[104:105], v[106:107]
    v_add_f32 v14, v104, v105
    v_cvt_pk_bf16_f32 v15, 0, v15
    s_nop 1
    v_add_f32_dpp v14, v14, v14 row_shr:1 row_mask:0xf bank_mask:0xf bound_ctrl:0
    s_nop 1
    v_add_f32_dpp v14, v14, v14 row_shr:2 row_mask:0xf bank_mask:0xf bound_ctrl:0
    s_nop 1
    v_add_f32_dpp v14, v14, v14 row_shr:4 row_mask:0xf bank_mask:0xf bound_ctrl:0
    s_nop 1
    v_add_f32_dpp v14, v14, v14 row_shr:8 row_mask:0xf bank_mask:0xf bound_ctrl:0
    s_nop 1
    v_add_f32_dpp v14, v14, v14 row_bcast:15 row_mask:0xa bank_mask:0xf
    s_nop 1
    v_add_f32_dpp v14, v14, v14 row_bcast:31 row_mask:0xc bank_mask:0xf
    s_nop 1
    v_readlane_b32 s47, v14, 63
    v_pk_add_f32 v[64:65], v[64:65], v[14:15] op_sel:[0,1] op_sel_hi:[1,1] neg_lo:[0,1] neg_hi:[0,1]
    v_pk_add_f32 v[66:67], v[66:67], v[14:15] op_sel:[0,1] op_sel_hi:[1,1] neg_lo:[0,1] neg_hi:[0,1]
    v_pk_add_f32 v[68:69], v[68:69], v[14:15] op_sel:[0,1] op_sel_hi:[1,1] neg_lo:[0,1] neg_hi:[0,1]
    v_pk_add_f32 v[70:71], v[70:71], v[14:15] op_sel:[0,1] op_sel_hi:[1,1] neg_lo:[0,1] neg_hi:[0,1]
    v_pk_add_f32 v[72:73], v[72:73], v[14:15] op_sel:[0,1] op_sel_hi:[1,1] neg_lo:[0,1] neg_hi:[0,1]
    v_pk_add_f32 v[74:75], v[74:75], v[14:15] op_sel:[0,1] op_sel_hi:[1,1] neg_lo:[0,1] neg_hi:[0,1]
    v_pk_add_f32 v[76:77], v[76:77], v[14:15] op_sel:[0,1] op_sel_hi:[1,1] neg_lo:[0,1] neg_hi:[0,1]
    v_pk_add_f32 v[78:79], v[78:79], v[14:15] op_sel:[0,1] op_sel_hi:[1,1] neg_lo:[0,1] neg_hi:[0,1]
    v_mov_b32 v14, s47
    v_mul_f32 v14, 0x3a800000, v14
    v_cvt_pk_bf16_f32 v14, 0, v14
    v_add_f32 v14, 0x3727c5ac, v14
    v_cvt_pk_bf16_f32 v14, 0, v14
    v_sqrt_f32 v14, v14
    s_nop 0
    v_cvt_pk_bf16_f32 v14, 0, v14
    v_rcp_f32 v14, v14
    v_cvt_pk_bf16_f32 v64, 0, v64
    v_cvt_pk_bf16_f32 v65, 0, v65
    v_cvt_pk_bf16_f32 v66, 0, v66
    v_cvt_pk_bf16_f32 v67, 0, v67
    v_cvt_pk_bf16_f32 v68, 0, v68
    v_cvt_pk_bf16_f32 v69, 0, v69
    v_cvt_pk_bf16_f32 v70, 0, v70
    v_cvt_pk_bf16_f32 v71, 0, v71
    v_cvt_pk_bf16_f32 v72, 0, v72
    v_cvt_pk_bf16_f32 v73, 0, v73
    v_cvt_pk_bf16_f32 v74, 0, v74
    v_cvt_pk_bf16_f32 v75, 0, v75
    v_cvt_pk_bf16_f32 v76, 0, v76
    v_cvt_pk_bf16_f32 v77, 0, v77
    v_cvt_pk_bf16_f32 v78, 0, v78
    v_cvt_pk_bf16_f32 v79, 0, v79
    v_pk_mul_f32 v[64:65], v[64:65], v[14:15] op_sel_hi:[1,0]
    v_pk_mul_f32 v[66:67], v[66:67], v[14:15] op_sel_hi:[1,0]
    v_pk_mul_f32 v[68:69], v[68:69], v[14:15] op_sel_hi:[1,0]
    v_pk_mul_f32 v[70:71], v[70:71], v[14:15] op_sel_hi:[1,0]
    v_pk_mul_f32 v[72:73], v[72:73], v[14:15] op_sel_hi:[1,0]
    v_pk_mul_f32 v[74:75], v[74:75], v[14:15] op_sel_hi:[1,0]
    v_pk_mul_f32 v[76:77], v[76:77], v[14:15] op_sel_hi:[1,0]
    v_pk_mul_f32 v[78:79], v[78:79], v[14:15] op_sel_hi:[1,0]
    v_cvt_pk_bf16_f32 v64, 0, v64
    v_cvt_pk_bf16_f32 v65, 0, v65
    v_cvt_pk_bf16_f32 v66, 0, v66
    v_cvt_pk_bf16_f32 v67, 0, v67
    v_cvt_pk_bf16_f32 v68, 0, v68
    v_cvt_pk_bf16_f32 v69, 0, v69
    v_cvt_pk_bf16_f32 v70, 0, v70
    v_cvt_pk_bf16_f32 v71, 0, v71
    v_cvt_pk_bf16_f32 v72, 0, v72
    v_cvt_pk_bf16_f32 v73, 0, v73
    v_cvt_pk_bf16_f32 v74, 0, v74
    v_cvt_pk_bf16_f32 v75, 0, v75
    v_cvt_pk_bf16_f32 v76, 0, v76
    v_cvt_pk_bf16_f32 v77, 0, v77
    v_cvt_pk_bf16_f32 v78, 0, v78
    v_cvt_pk_bf16_f32 v79, 0, v79
    v_pk_mul_f32 v[64:65], v[64:65], v[32:33]
    v_pk_mul_f32 v[66:67], v[66:67], v[34:35]
    v_pk_mul_f32 v[68:69], v[68:69], v[36:37]
    v_pk_mul_f32 v[70:71], v[70:71], v[38:39]
    v_pk_mul_f32 v[72:73], v[72:73], v[40:41]
    v_pk_mul_f32 v[74:75], v[74:75], v[42:43]
    v_pk_mul_f32 v[76:77], v[76:77], v[44:45]
    v_pk_mul_f32 v[78:79], v[78:79], v[46:47]
    v_cvt_pk_bf16_f32 v64, 0, v64
    v_cvt_pk_bf16_f32 v65, 0, v65
    v_cvt_pk_bf16_f32 v66, 0, v66
    v_cvt_pk_bf16_f32 v67, 0, v67
    v_cvt_pk_bf16_f32 v68, 0, v68
    v_cvt_pk_bf16_f32 v69, 0, v69
    v_cvt_pk_bf16_f32 v70, 0, v70
    v_cvt_pk_bf16_f32 v71, 0, v71
    v_cvt_pk_bf16_f32 v72, 0, v72
    v_cvt_pk_bf16_f32 v73, 0, v73
    v_cvt_pk_bf16_f32 v74, 0, v74
    v_cvt_pk_bf16_f32 v75, 0, v75
    v_cvt_pk_bf16_f32 v76, 0, v76
    v_cvt_pk_bf16_f32 v77, 0, v77
    v_cvt_pk_bf16_f32 v78, 0, v78
    v_cvt_pk_bf16_f32 v79, 0, v79
    v_pk_add_f32 v[64:65], v[64:65], v[48:49]
    v_pk_add_f32 v[66:67], v[66:67], v[50:51]
    v_pk_add_f32 v[68:69], v[68:69], v[52:53]
    v_pk_add_f32 v[70:71], v[70:71], v[54:55]
    v_pk_add_f32 v[72:73], v[72:73], v[56:57]
    v_pk_add_f32 v[74:75], v[74:75], v[58:59]
    v_pk_add_f32 v[76:77], v[76:77], v[60:61]
    v_pk_add_f32 v[78:79], v[78:79], v[62:63]
    v_cvt_pk_bf16_f32 v104, v64, v65
    v_cvt_pk_bf16_f32 v105, v66, v67
    v_cvt_pk_bf16_f32 v106, v68, v69
    v_cvt_pk_bf16_f32 v107, v70, v71
    v_cvt_pk_bf16_f32 v108, v72, v73
    v_cvt_pk_bf16_f32 v109, v74, v75
    v_cvt_pk_bf16_f32 v110, v76, v77
    v_cvt_pk_bf16_f32 v111, v78, v79
    ds_write_b128 v10, v[104:107]
    ds_write_b128 v10, v[108:111] offset:1024
    s_waitcnt lgkmcnt(0)
    s_barrier
    ds_read_b128 v[104:107], v13
    ds_read_b128 v[108:111], v13 offset:128
    s_waitcnt lgkmcnt(1)
    buffer_store_dwordx4 v[104:107], v11, s[12:15], s63 offen sc1
    s_waitcnt lgkmcnt(0)
    buffer_store_dwordx4 v[108:111], v12, s[12:15], s63 offen sc1
    s_waitcnt vmcnt(0)
    s_barrier
    s_cmp_lg_u32 s44, 0
    s_cbranch_scc1 L_sf_41
    v_mov_b32 v14, s60
    v_add_u32 v14, 1, v14
    v_mov_b32 v15, 0
    s_mov_b64 exec, 1
    buffer_store_dword v14, v15, s[12:15], s52 offen sc1
    s_mov_b64 exec, -1
L_sf_41:
    s_add_u32 s60, s60, 3
    s_cmp_lt_u32 s60, 64
    s_cbranch_scc1 L_r_loop_37
    s_branch L_c_done_1
L_w_att_15:
    s_lshl_b32 s42, s40, 2
    s_and_b32 s46, s44, 3
    s_add_u32 s42, s42, s46
    s_and_b32 s43, s48, 1
    s_lshl_b32 s43, s43, 1
    s_lshr_b32 s46, s44, 2
    s_add_u32 s43, s43, s46
    s_mul_i32 s46, s42, 24576
    s_add_u32 s46, s46, 0x2000000
    v_lshlrev_b32 v2, 4, v1
    v_add_u32 v3, s46, v2
    v_add_u32 v5, 4096, v3
    v_lshrrev_b32 v4, 4, v1
    v_and_b32 v9, 15, v1
    s_lshl_b32 s46, s42, 12
    s_add_u32 s46, s46, 0x1000000
    v_and_b32 v6, 7, v1
    v_lshlrev_b32 v6, 4, v6
    v_lshl_add_u32 v6, v4, 7, v6
    v_add_u32 v6, s46, v6
    v_and_b32 v7, 31, v1
    v_lshlrev_b32 v7, 4, v7
    v_lshrrev_b32 v10, 5, v1
    v_lshl_add_u32 v7, v10, 10, v7
    v_add_u32 v7, s46, v7
    s_mul_i32 s50, s44, 13056
    v_mul_u32_u24 v8, 272, v9
    v_lshl_add_u32 v8, v4, 4, v8
    v_add_u32 v8, s50, v8
    v_bfe_u32 v11, v1, 2, 3
    v_mul_u32_u24 v11, 272, v11
    v_lshl_add_u32 v11, v10, 6, v11
    v_and_b32 v12, 3, v1
    v_lshl_add_u32 v11, v12, 4, v11
    v_add_u32 v11, s50, v11
    v_mul_u32_u24 v14, 272, v4
    v_lshl_add_u32 v14, v9, 4, v14
    v_add_u32 v14, s50, v14
    v_mov_b32 v16, 0
    v_mov_b32 v17, 0
    v_mov_b32 v18, 0
    v_mov_b32 v19, 0
    ds_write_b128 v14, v[16:19] offset:10880
    ds_write_b128 v14, v[16:19] offset:11968
    v_lshlrev_b32 v12, 2, v4
    v_bfe_u32 v13, v1, 2, 2
    v_add_u32 v12, v12, v13
    v_mul_u32_u24 v12, 272, v12
    v_and_b32 v13, 3, v1
    v_lshl_add_u32 v12, v13, 3, v12
    v_add_u32 v12, s50, v12
    v_lshlrev_b32 v13, 10, v13
    s_lshl_b32 s46, s42, 12
    s_add_u32 s46, s46, 0x1000000
    v_add_u32 v13, s46, v13
    v_lshlrev_b32 v10, 9, v4
    v_lshl_add_u32 v10, v9, 4, v10
    s_lshl_b32 s46, s42, 13
    s_add_u32 s46, s46, 0x5000000
    v_add_u32 v10, s46, v10
    s_lshl_b32 s52, s42, 9
    s_lshl_b32 s47, s43, 7
    s_add_u32 s52, s52, s47
    s_add_u32 s52, s52, 0x102000
    v_min_u32 v42, 2, v1
    v_lshlrev_b32 v42, 9, v42
    s_lshl_b32 s46, s40, 11
    s_and_b32 s47, s42, 3
    s_lshl_b32 s47, s47, 7
    s_add_u32 s46, s46, s47
    s_add_u32 s46, s46, 0x10a400
    v_add_u32 v48, s46, v42
    s_mul_i32 s46, s42, 24576
    s_add_u32 s46, s46, 0x2000000
    v_lshlrev_b32 v49, 7, v1
    v_add_u32 v49, s46, v49
    v_cmp_le_u32 s[56:57], 32, v1
    v_lshlrev_b32 v14, 2, v4
    s_mov_b32 s54, 0x3e0293ee
    s_mov_b32 s60, s43
    v_add_u32 v15, 0, v14
    v_cmp_gt_u32 s[84:85], v15, v9
    v_add_u32 v15, 1, v14
    v_cmp_gt_u32 s[86:87], v15, v9
    v_add_u32 v15, 2, v14
    v_cmp_gt_u32 s[88:89], v15, v9
    v_add_u32 v15, 3, v14
    v_cmp_gt_u32 s[90:91], v15, v9
L_a_loop_42:
    s_mul_i32 s45, s60, 786432
    s_add_u32 s48, s45, 8192
    s_add_u32 s49, s45, 16384
    s_lshl_b32 s61, s60, 17
    s_lshl_b32 s63, s60, 18
    s_mov_b32 s70, 0
L_spin_43:
    buffer_load_dword v40, v48, s[12:15], 0 offen sc1
    s_waitcnt vmcnt(0)
    v_cmp_ge_u32 vcc, s60, v40
    s_add_u32 s70, s70, 1
    s_cbranch_vccz L_spok_44
    s_sleep 3
    s_cmp_lt_u32 s70, 524288
    s_cbranch_scc1 L_spin_43
    s_branch L_c_done_1
L_spok_44:
    buffer_load_dwordx4 a[0:3], v3, s[12:15], s45 offen offset:0 sc1
    buffer_load_dwordx4 a[4:7], v3, s[12:15], s45 offen offset:1024 sc1
    buffer_load_dwordx4 a[8:11], v3, s[12:15], s45 offen offset:2048 sc1
    buffer_load_dwordx4 a[12:15], v3, s[12:15], s45 offen offset:3072 sc1
    buffer_load_dwordx4 a[16:19], v5, s[12:15], s45 offen offset:0 sc1
    buffer_load_dwordx4 a[20:23], v5, s[12:15], s45 offen offset:1024 sc1
    buffer_load_dwordx4 a[24:27], v5, s[12:15], s45 offen offset:2048 sc1
    buffer_load_dwordx4 a[28:31], v5, s[12:15], s45 offen offset:3072 sc1
    buffer_load_dwordx4 a[32:35], v3, s[12:15], s48 offen offset:0 sc1
    buffer_load_dwordx4 a[36:39], v3, s[12:15], s48 offen offset:1024 sc1
    buffer_load_dwordx4 a[40:43], v3, s[12:15], s48 offen offset:2048 sc1
    buffer_load_dwordx4 a[44:47], v3, s[12:15], s48 offen offset:3072 sc1
    buffer_load_dwordx4 a[48:51], v5, s[12:15], s48 offen offset:0 sc1
    buffer_load_dwordx4 a[52:55], v5, s[12:15], s48 offen offset:1024 sc1
    buffer_load_dwordx4 a[56:59], v5, s[12:15], s48 offen offset:2048 sc1
    buffer_load_dwordx4 a[60:63], v5, s[12:15], s48 offen offset:3072 sc1
    buffer_load_dwordx4 v[16:19], v3, s[12:15], s49 offen offset:0 sc1
    buffer_load_dwordx4 v[20:23], v3, s[12:15], s49 offen offset:1024 sc1
    buffer_load_dwordx4 v[24:27], v3, s[12:15], s49 offen offset:2048 sc1
    buffer_load_dwordx4 v[28:31], v3, s[12:15], s49 offen offset:3072 sc1
    buffer_load_dwordx4 v[32:35], v5, s[12:15], s49 offen offset:0 sc1
    buffer_load_dwordx4 v[36:39], v5, s[12:15], s49 offen offset:1024 sc1
    buffer_load_dwordx4 v[40:43], v5, s[12:15], s49 offen offset:2048 sc1
    buffer_load_dwordx4 v[44:47], v5, s[12:15], s49 offen offset:3072 sc1
    s_waitcnt vmcnt(0)
    ds_write_b128 v8, v[16:19] offset:0
    ds_write_b128 v8, v[20:23] offset:64
    ds_write_b128 v8, v[24:27] offset:128
    ds_write_b128 v8, v[28:31] offset:192
    ds_write_b128 v8, v[32:35] offset:4352
    ds_write_b128 v8, v[36:39] offset:4416
    ds_write_b128 v8, v[40:43] offset:4480
    ds_write_b128 v8, v[44:47] offset:4544
    v_mfma_f32_16x16x32_bf16 v[56:59], a[32:35], a[0:3], 0
    v_mfma_f32_16x16x32_bf16 v[60:63], a[32:35], a[16:19], 0
    v_mfma_f32_16x16x32_bf16 v[68:71], a[48:51], a[16:19], 0
    v_mfma_f32_16x16x32_bf16 v[56:59], a[36:39], a[4:7], v[56:59]
    v_mfma_f32_16x16x32_bf16 v[60:63], a[36:39], a[20:23], v[60:63]
    v_mfma_f32_16x16x32_bf16 v[68:71], a[52:55], a[20:23], v[68:71]
    v_mfma_f32_16x16x32_bf16 v[56:59], a[40:43], a[8:11], v[56:59]
    v_mfma_f32_16x16x32_bf16 v[60:63], a[40:43], a[24:27], v[60:63]
    v_mfma_f32_16x16x32_bf16 v[68:71], a[56:59], a[24:27], v[68:71]
    v_mfma_f32_16x16x32_bf16 v[56:59], a[44:47], a[12:15], v[56:59]
    v_mfma_f32_16x16x32_bf16 v[60:63], a[44:47], a[28:31], v[60:63]
    v_mfma_f32_16x16x32_bf16 v[68:71], a[60:63], a[28:31], v[68:71]
    s_waitcnt lgkmcnt(0)
    ds_read_b64_tr_b16 a[80:81], v12 offset:0
    ds_read_b64_tr_b16 a[82:83], v12 offset:4352
    ds_read_b64_tr_b16 a[86:87], v12 offset:32
    ds_read_b64_tr_b16 a[88:89], v12 offset:4384
    ds_read_b64_tr_b16 a[92:93], v12 offset:64
    ds_read_b64_tr_b16 a[94:95], v12 offset:4416
    ds_read_b64_tr_b16 a[98:99], v12 offset:96
    ds_read_b64_tr_b16 a[100:101], v12 offset:4448
    s_waitcnt lgkmcnt(0)
    ds_read_b64_tr_b16 a[104:105], v12 offset:128
    ds_read_b64_tr_b16 a[106:107], v12 offset:4480
    ds_read_b64_tr_b16 a[110:111], v12 offset:160
    ds_read_b64_tr_b16 a[112:113], v12 offset:4512
    ds_read_b64_tr_b16 a[116:117], v12 offset:192
    ds_read_b64_tr_b16 a[118:119], v12 offset:4544
    ds_read_b64_tr_b16 a[122:123], v12 offset:224
    ds_read_b64_tr_b16 a[124:125], v12 offset:4576
    v_mov_b32 v15, 0xff800000
    v_cndmask_b32 v56, v56, v15, s[84:85]
    v_cndmask_b32 v68, v68, v15, s[84:85]
    v_cndmask_b32 v57, v57, v15, s[86:87]
    v_cndmask_b32 v69, v69, v15, s[86:87]
    v_cndmask_b32 v58, v58, v15, s[88:89]
    v_cndmask_b32 v70, v70, v15, s[88:89]
    v_cndmask_b32 v59, v59, v15, s[90:91]
    v_cndmask_b32 v71, v71, v15, s[90:91]
    s_mov_b32 s70, 0
L_a_cp_45:
    buffer_load_dword v40, v13, s[12:15], s61 offen sc1
    s_waitcnt vmcnt(0)
    v_cmp_eq_u32 vcc, -1, v40
    s_add_u32 s70, s70, 1
    s_cbranch_vccz L_a_fl_46
L_a_cp_45_s:
    s_sleep 4
    s_cmp_lt_u32 s70, 524288
    s_cbranch_scc1 L_a_cp_45
    s_branch L_c_done_1
L_a_fl_46:
    buffer_load_dwordx4 v[24:27], v6, s[12:15], s61 offen offset:0 sc1
    buffer_load_dwordx4 v[28:31], v6, s[12:15], s61 offen offset:1024 sc1
    buffer_load_dwordx4 v[32:35], v6, s[12:15], s61 offen offset:2048 sc1
    buffer_load_dwordx4 v[36:39], v6, s[12:15], s61 offen offset:3072 sc1
    buffer_load_dwordx4 v[16:19], v7, s[12:15], s61 offen offset:512 sc1
    buffer_load_dwordx4 v[20:23], v7, s[12:15], s61 offen offset:2560 sc1
    s_waitcnt vmcnt(0)
    v_max_u32 v40, v16, v17
    v_max3_u32 v40, v40, v18, v19
    v_max3_u32 v40, v40, v20, v21
    v_max3_u32 v40, v40, v22, v23
    v_max3_u32 v40, v40, v24, v25
    v_max3_u32 v40, v40, v26, v27
    v_max3_u32 v40, v40, v28, v29
    v_max3_u32 v40, v40, v30, v31
    v_max3_u32 v40, v40, v32, v33
    v_max3_u32 v40, v40, v34, v35
    v_max3_u32 v40, v40, v36, v37
    v_max3_u32 v40, v40, v38, v39
    v_cmp_eq_u32 vcc, -1, v40
    s_nop 0
    s_cbranch_vccnz L_a_cp_45_s
    v_mfma_f32_16x16x32_bf16 v[72:75], v[24:27], a[0:3], 0
    v_mfma_f32_16x16x32_bf16 v[76:79], v[24:27], a[16:19], 0
    v_mfma_f32_16x16x32_bf16 v[72:75], v[28:31], a[4:7], v[72:75]
    v_mfma_f32_16x16x32_bf16 v[76:79], v[28:31], a[20:23], v[76:79]
    v_mfma_f32_16x16x32_bf16 v[72:75], v[32:35], a[8:11], v[72:75]
    v_mfma_f32_16x16x32_bf16 v[76:79], v[32:35], a[24:27], v[76:79]
    v_mfma_f32_16x16x32_bf16 v[72:75], v[36:39], a[12:15], v[72:75]
    v_mfma_f32_16x16x32_bf16 v[76:79], v[36:39], a[28:31], v[76:79]
    ds_write_b128 v11, v[16:19] offset:8704
    ds_write_b128 v11, v[20:23] offset:8832
    s_waitcnt lgkmcnt(0)
    ds_read_b64_tr_b16 a[84:85], v12 offset:8704
    ds_read_b64_tr_b16 a[90:91], v12 offset:8736
    ds_read_b64_tr_b16 a[96:97], v12 offset:8768
    ds_read_b64_tr_b16 a[102:103], v12 offset:8800
    ds_read_b64_tr_b16 a[108:109], v12 offset:8832
    ds_read_b64_tr_b16 a[114:115], v12 offset:8864
    ds_read_b64_tr_b16 a[120:121], v12 offset:8896
    ds_read_b64_tr_b16 a[126:127], v12 offset:8928
    v_cndmask_b32 v72, v72, v15, s[56:57]
    v_cndmask_b32 v73, v73, v15, s[56:57]
    v_cndmask_b32 v74, v74, v15, s[56:57]
    v_cndmask_b32 v75, v75, v15, s[56:57]
    v_cndmask_b32 v76, v76, v15, s[56:57]
    v_cndmask_b32 v77, v77, v15, s[56:57]
    v_cndmask_b32 v78, v78, v15, s[56:57]
    v_cndmask_b32 v79, v79, v15, s[56:57]
    v_max_f32 v40, v56, v57
    v_max3_f32 v40, v40, v58, v59
    v_max3_f32 v40, v40, v72, v73
    v_max3_f32 v40, v40, v74, v75
    v_mov_b32 v41, v40
    s_nop 1
    v_permlane16_swap_b32 v40, v41
    v_max_f32 v40, v40, v41
    v_mov_b32 v41, v40
    s_nop 1
    v_permlane32_swap_b32 v40, v41
    v_max_f32 v40, v40, v41
    v_mul_f32 v40, s54, v40
    v_fma_f32 v56, v56, s54, -v40
    v_fma_f32 v57, v57, s54, -v40
    v_fma_f32 v58, v58, s54, -v40
    v_fma_f32 v59, v59, s54, -v40
    v_fma_f32 v72, v72, s54, -v40
    v_fma_f32 v73, v73, s54, -v40
    v_fma_f32 v74, v74, s54, -v40
    v_fma_f32 v75, v75, s54, -v40
    v_exp_f32 v56, v56
    v_exp_f32 v57, v57
    v_exp_f32 v58, v58
    v_exp_f32 v59, v59
    v_exp_f32 v72, v72
    v_exp_f32 v73, v73
    v_exp_f32 v74, v74
    v_exp_f32 v75, v75
    v_add_f32 v40, v56, v57
    v_add_f32 v40, v40, v58
    v_add_f32 v40, v40, v59
    v_add_f32 v40, v40, v72
    v_add_f32 v40, v40, v73
    v_add_f32 v40, v40, v74
    v_add_f32 v40, v40, v75
    v_mov_b32 v41, v40
    s_nop 1
    v_permlane16_swap_b32 v40, v41
    v_add_f32 v40, v40, v41
    v_mov_b32 v41, v40
    s_nop 1
    v_permlane32_swap_b32 v40, v41
    v_add_f32 v40, v40, v41
    v_rcp_f32 v40, v40
    s_nop 0
    v_mul_f32 v56, v56, v40
    v_mul_f32 v57, v57, v40
    v_mul_f32 v58, v58, v40
    v_mul_f32 v59, v59, v40
    v_mul_f32 v72, v72, v40
    v_mul_f32 v73, v73, v40
    v_mul_f32 v74, v74, v40
    v_mul_f32 v75, v75, v40
    v_cvt_pk_bf16_f32 v24, v56, v57
    v_cvt_pk_bf16_f32 v25, v58, v59
    v_cvt_pk_bf16_f32 v28, v72, v73
    v_cvt_pk_bf16_f32 v29, v74, v75
    v_max_f32 v40, v60, v61
    v_max3_f32 v40, v40, v62, v63
    v_max3_f32 v40, v40, v68, v69
    v_max3_f32 v40, v40, v70, v71
    v_max3_f32 v40, v40, v76, v77
    v_max3_f32 v40, v40, v78, v79
    v_mov_b32 v41, v40
    s_nop 1
    v_permlane16_swap_b32 v40, v41
    v_max_f32 v40, v40, v41
    v_mov_b32 v41, v40
    s_nop 1
    v_permlane32_swap_b32 v40, v41
    v_max_f32 v40, v40, v41
    v_mul_f32 v40, s54, v40
    v_fma_f32 v60, v60, s54, -v40
    v_fma_f32 v61, v61, s54, -v40
    v_fma_f32 v62, v62, s54, -v40
    v_fma_f32 v63, v63, s54, -v40
    v_fma_f32 v68, v68, s54, -v40
    v_fma_f32 v69, v69, s54, -v40
    v_fma_f32 v70, v70, s54, -v40
    v_fma_f32 v71, v71, s54, -v40
    v_fma_f32 v76, v76, s54, -v40
    v_fma_f32 v77, v77, s54, -v40
    v_fma_f32 v78, v78, s54, -v40
    v_fma_f32 v79, v79, s54, -v40
    v_exp_f32 v60, v60
    v_exp_f32 v61, v61
    v_exp_f32 v62, v62
    v_exp_f32 v63, v63
    v_exp_f32 v68, v68
    v_exp_f32 v69, v69
    v_exp_f32 v70, v70
    v_exp_f32 v71, v71
    v_exp_f32 v76, v76
    v_exp_f32 v77, v77
    v_exp_f32 v78, v78
    v_exp_f32 v79, v79
    v_add_f32 v40, v60, v61
    v_add_f32 v40, v40, v62
    v_add_f32 v40, v40, v63
    v_add_f32 v40, v40, v68
    v_add_f32 v40, v40, v69
    v_add_f32 v40, v40, v70
    v_add_f32 v40, v40, v71
    v_add_f32 v40, v40, v76
    v_add_f32 v40, v40, v77
    v_add_f32 v40, v40, v78
    v_add_f32 v40, v40, v79
    v_mov_b32 v41, v40
    s_nop 1
    v_permlane16_swap_b32 v40, v41
    v_add_f32 v40, v40, v41
    v_mov_b32 v41, v40
    s_nop 1
    v_permlane32_swap_b32 v40, v41
    v_add_f32 v40, v40, v41
    v_rcp_f32 v40, v40
    s_nop 0
    v_mul_f32 v60, v60, v40
    v_mul_f32 v61, v61, v40
    v_mul_f32 v62, v62, v40
    v_mul_f32 v63, v63, v40
    v_mul_f32 v68, v68, v40
    v_mul_f32 v69, v69, v40
    v_mul_f32 v70, v70, v40
    v_mul_f32 v71, v71, v40
    v_mul_f32 v76, v76, v40
    v_mul_f32 v77, v77, v40
    v_mul_f32 v78, v78, v40
    v_mul_f32 v79, v79, v40
    v_cvt_pk_bf16_f32 v30, v60, v61
    v_cvt_pk_bf16_f32 v31, v62, v63
    v_cvt_pk_bf16_f32 v32, v68, v69
    v_cvt_pk_bf16_f32 v33, v70, v71
    v_cvt_pk_bf16_f32 v34, v76, v77
    v_cvt_pk_bf16_f32 v35, v78, v79
    s_waitcnt lgkmcnt(0)
    s_nop 0
    v_mfma_f32_16x16x16_bf16 v[64:67], a[80:81], v[24:25], 0
    v_mfma_f32_16x16x16_bf16 v[68:71], a[86:87], v[24:25], 0
    v_mfma_f32_16x16x16_bf16 v[72:75], a[92:93], v[24:25], 0
    v_mfma_f32_16x16x16_bf16 v[76:79], a[98:99], v[24:25], 0
    v_mfma_f32_16x16x16_bf16 v[80:83], a[104:105], v[24:25], 0
    v_mfma_f32_16x16x16_bf16 v[84:87], a[110:111], v[24:25], 0
    v_mfma_f32_16x16x16_bf16 v[88:91], a[116:117], v[24:25], 0
    v_mfma_f32_16x16x16_bf16 v[92:95], a[122:123], v[24:25], 0
    v_mfma_f32_16x16x16_bf16 v[64:67], a[84:85], v[28:29], v[64:67]
    v_mfma_f32_16x16x16_bf16 v[68:71], a[90:91], v[28:29], v[68:71]
    v_mfma_f32_16x16x16_bf16 v[72:75], a[96:97], v[28:29], v[72:75]
    v_mfma_f32_16x16x16_bf16 v[76:79], a[102:103], v[28:29], v[76:79]
    v_mfma_f32_16x16x16_bf16 v[80:83], a[108:109], v[28:29], v[80:83]
    v_mfma_f32_16x16x16_bf16 v[84:87], a[114:115], v[28:29], v[84:87]
    v_mfma_f32_16x16x16_bf16 v[88:91], a[120:121], v[28:29], v[88:91]
    v_mfma_f32_16x16x16_bf16 v[92:95], a[126:127], v[28:29], v[92:95]
    v_mfma_f32_16x16x16_bf16 v[96:99], a[80:81], v[30:31], 0
    v_mfma_f32_16x16x16_bf16 v[100:103], a[86:87], v[30:31], 0
    v_mfma_f32_16x16x16_bf16 v[104:107], a[92:93], v[30:31], 0
    v_mfma_f32_16x16x16_bf16 v[108:111], a[98:99], v[30:31], 0
    v_mfma_f32_16x16x16_bf16 v[112:115], a[104:105], v[30:31], 0
    v_mfma_f32_16x16x16_bf16 v[116:119], a[110:111], v[30:31], 0
    v_mfma_f32_16x16x16_bf16 v[120:123], a[116:117], v[30:31], 0
    v_mfma_f32_16x16x16_bf16 v[124:127], a[122:123], v[30:31], 0
    v_mfma_f32_16x16x16_bf16 v[96:99], a[82:83], v[32:33], v[96:99]
    v_mfma_f32_16x16x16_bf16 v[100:103], a[88:89], v[32:33], v[100:103]
    v_mfma_f32_16x16x16_bf16 v[104:107], a[94:95], v[32:33], v[104:107]
    v_mfma_f32_16x16x16_bf16 v[108:111], a[100:101], v[32:33], v[108:111]
    v_mfma_f32_16x16x16_bf16 v[112:115], a[106:107], v[32:33], v[112:115]
    v_mfma_f32_16x16x16_bf16 v[116:119], a[112:113], v[32:33], v[116:119]
    v_mfma_f32_16x16x16_bf16 v[120:123], a[118:119], v[32:33], v[120:123]
    v_mfma_f32_16x16x16_bf16 v[124:127], a[124:125], v[32:33], v[124:127]
    v_mfma_f32_16x16x16_bf16 v[96:99], a[84:85], v[34:35], v[96:99]
    v_mfma_f32_16x16x16_bf16 v[100:103], a[90:91], v[34:35], v[100:103]
    v_mfma_f32_16x16x16_bf16 v[104:107], a[96:97], v[34:35], v[104:107]
    v_mfma_f32_16x16x16_bf16 v[108:111], a[102:103], v[34:35], v[108:111]
    v_mfma_f32_16x16x16_bf16 v[112:115], a[108:109], v[34:35], v[112:115]
    v_mfma_f32_16x16x16_bf16 v[116:119], a[114:115], v[34:35], v[116:119]
    v_mfma_f32_16x16x16_bf16 v[120:123], a[120:121], v[34:35], v[120:123]
    v_mfma_f32_16x16x16_bf16 v[124:127], a[126:127], v[34:35], v[124:127]
    s_add_u32 s46, s63, 4096
    v_cvt_pk_bf16_f32 v64, v64, v65
    v_cvt_pk_bf16_f32 v65, v66, v67
    v_cvt_pk_bf16_f32 v66, v68, v69
    v_cvt_pk_bf16_f32 v67, v70, v71
    buffer_store_dwordx4 v[64:67], v10, s[12:15], s63 offen offset:0 sc1
    v_cvt_pk_bf16_f32 v72, v72, v73
    v_cvt_pk_bf16_f32 v73, v74, v75
    v_cvt_pk_bf16_f32 v74, v76, v77
    v_cvt_pk_bf16_f32 v75, v78, v79
    buffer_store_dwordx4 v[72:75], v10, s[12:15], s63 offen offset:2048 sc1
    v_cvt_pk_bf16_f32 v80, v80, v81
    v_cvt_pk_bf16_f32 v81, v82, v83
    v_cvt_pk_bf16_f32 v82, v84, v85
    v_cvt_pk_bf16_f32 v83, v86, v87
    buffer_store_dwordx4 v[80:83], v10, s[12:15], s46 offen offset:0 sc1
    v_cvt_pk_bf16_f32 v88, v88, v89
    v_cvt_pk_bf16_f32 v89, v90, v91
    v_cvt_pk_bf16_f32 v90, v92, v93
    v_cvt_pk_bf16_f32 v91, v94, v95
    buffer_store_dwordx4 v[88:91], v10, s[12:15], s46 offen offset:2048 sc1
    v_cvt_pk_bf16_f32 v96, v96, v97
    v_cvt_pk_bf16_f32 v97, v98, v99
    v_cvt_pk_bf16_f32 v98, v100, v101
    v_cvt_pk_bf16_f32 v99, v102, v103
    buffer_store_dwordx4 v[96:99], v10, s[12:15], s63 offen offset:256 sc1
    v_cvt_pk_bf16_f32 v104, v104, v105
    v_cvt_pk_bf16_f32 v105, v106, v107
    v_cvt_pk_bf16_f32 v106, v108, v109
    v_cvt_pk_bf16_f32 v107, v110, v111
    buffer_store_dwordx4 v[104:107], v10, s[12:15], s63 offen offset:2304 sc1
    v_cvt_pk_bf16_f32 v112, v112, v113
    v_cvt_pk_bf16_f32 v113, v114, v115
    v_cvt_pk_bf16_f32 v114, v116, v117
    v_cvt_pk_bf16_f32 v115, v118, v119
    buffer_store_dwordx4 v[112:115], v10, s[12:15], s46 offen offset:256 sc1
    v_cvt_pk_bf16_f32 v120, v120, v121
    v_cvt_pk_bf16_f32 v121, v122, v123
    v_cvt_pk_bf16_f32 v122, v124, v125
    v_cvt_pk_bf16_f32 v123, v126, v127
    buffer_store_dwordx4 v[120:123], v10, s[12:15], s46 offen offset:2304 sc1
    s_waitcnt vmcnt(0)
    v_mov_b32 v16, s60
    v_add_u32 v16, 1, v16
    v_mov_b32 v17, 0
    s_mov_b64 exec, 1
    buffer_store_dword v16, v17, s[12:15], s52 offen sc1
    s_mov_b64 exec, -1
L_sf_48:
    s_add_u32 s60, s60, 4
    s_cmp_lt_u32 s60, 64
    s_cbranch_scc1 L_a_loop_42
    s_branch L_c_done_1
L_w_g_10:
    s_lshr_b32 s53, s48, 2
    s_cmp_lt_u32 s53, 2
    s_cselect_b32 s46, 1, 0
    s_xor_b32 s53, s53, s46
    s_mov_b32 s74, 0
    s_mov_b32 s76, 0
    s_cmp_eq_u32 s53, 1
    s_cselect_b32 s75, 46, 64
    s_cmp_eq_u32 s53, 2
    s_cselect_b32 s75, 54, s75
L_w_g_10_e:
    s_lshl_b32 s46, s53, 3
    s_add_u32 s46, s46, 16
    s_load_dwordx2 s[4:5], s[0:1], s46
    s_lshl_b32 s49, s40, 2
    s_and_b32 s46, s48, 3
    s_add_u32 s49, s49, s46
    s_load_dwordx2 s[6:7], s[0:1], 72
    s_and_b32 s50, s44, 3
    s_lshr_b32 s51, s44, 2
    s_waitcnt lgkmcnt(0)
    s_mov_b32 s24, s4
    s_and_b32 s25, s5, 0xffff
    s_mov_b32 s26, 0x800000
    s_mov_b32 s27, 0x00020000
    s_cmp_lg_u32 s53, 0
    s_cbranch_scc1 L_g_nq_49
    s_load_dwordx4 s[8:11], s[0:1], 24
    v_and_b32 v10, 255, v0
    v_lshlrev_b32 v10, 13, v10
    s_and_b32 s46, s48, 3
    s_lshl_b32 s46, s46, 21
    s_lshl_b32 s47, s40, 10
    s_add_u32 s46, s46, s47
    s_add_u32 s46, s46, 384
    s_waitcnt lgkmcnt(0)
    s_cmp_eq_u32 s51, 1
    s_cselect_b32 s8, s10, s8
    s_cselect_b32 s9, s11, s9
    s_mov_b32 s28, s8
    s_and_b32 s29, s9, 0xffff
    s_mov_b32 s30, 0x800000
    s_mov_b32 s31, 0x00020000
    buffer_load_dword v11, v10, s[28:31], s46 offen
    s_cmp_eq_u32 s51, 1
    s_cbranch_scc1 L_g_nq_49
    buffer_load_dword v12, v10, s[24:27], s46 offen
L_g_nq_49:
    v_lshrrev_b32 v3, 4, v1
    v_and_b32 v4, 15, v1
    v_lshlrev_b32 v5, 2, v3
    v_xor_b32 v4, v4, v5
    v_mul_u32_u24 v3, 8192, v3
    v_lshl_add_u32 v3, v4, 4, v3
    s_mul_i32 s46, s51, 512
    s_mul_i32 s47, s50, 64
    s_add_u32 s46, s46, s47
    s_mul_i32 s46, s46, 8192
    s_lshl_b32 s47, s49, 8
    s_add_u32 s46, s46, s47
    s_lshl_b32 s45, s51, 16
    s_mul_i32 s47, s50, 16384
    s_add_u32 s45, s45, s47
    v_bfe_u32 v4, v1, 2, 2
    v_bfe_u32 v5, v1, 4, 1
    v_lshlrev_b32 v5, 1, v5
    v_bfe_u32 v6, v1, 0, 1
    v_add_u32 v5, v5, v6
    s_lshl_b32 s47, s50, 2
    v_add_u32 v5, s47, v5
    v_lshlrev_b32 v6, 2, v4
    v_xor_b32 v5, v5, v6
    v_lshlrev_b32 v5, 4, v5
    v_lshl_add_u32 v5, v4, 8, v5
    v_bfe_u32 v6, v1, 1, 1
    v_lshl_add_u32 v5, v6, 3, v5
    v_lshrrev_b32 v6, 5, v1
    v_mul_u32_u24 v6, 2048, v6
    v_add_u32 v5, v5, v6
    s_lshl_b32 s47, s51, 16
    v_add_u32 v5, s47, v5
    v_bfe_u32 v4, v1, 2, 2
    v_xor_b32 v5, s50, v4
    v_lshlrev_b32 v5, 6, v5
    v_lshl_add_u32 v5, v4, 8, v5
    v_and_b32 v6, 3, v1
    v_lshl_add_u32 v5, v6, 4, v5
    v_lshrrev_b32 v6, 4, v1
    v_lshl_add_u32 v5, v6, 11, v5
    v_lshrrev_b32 v6, 5, v1
    s_lshl_b32 s47, s51, 16
    v_add_u32 v5, s47, v5
    s_add_u32 m0, s45, 0
    s_add_u32 s47, s46, 0x0
    buffer_load_dwordx4 v3, s[24:27], s47 offen lds
    s_add_u32 m0, s45, 1024
    s_add_u32 s47, s46, 0x8000
    buffer_load_dwordx4 v3, s[24:27], s47 offen lds
    s_add_u32 m0, s45, 2048
    s_add_u32 s47, s46, 0x10000
    buffer_load_dwordx4 v3, s[24:27], s47 offen lds
    s_add_u32 m0, s45, 3072
    s_add_u32 s47, s46, 0x18000
    buffer_load_dwordx4 v3, s[24:27], s47 offen lds
    s_add_u32 m0, s45, 4096
    s_add_u32 s47, s46, 0x20000
    buffer_load_dwordx4 v3, s[24:27], s47 offen lds
    s_add_u32 m0, s45, 5120
    s_add_u32 s47, s46, 0x28000
    buffer_load_dwordx4 v3, s[24:27], s47 offen lds
    s_add_u32 m0, s45, 6144
    s_add_u32 s47, s46, 0x30000
    buffer_load_dwordx4 v3, s[24:27], s47 offen lds
    s_add_u32 m0, s45, 7168
    s_add_u32 s47, s46, 0x38000
    buffer_load_dwordx4 v3, s[24:27], s47 offen lds
    s_add_u32 m0, s45, 8192
    s_add_u32 s47, s46, 0x40000
    buffer_load_dwordx4 v3, s[24:27], s47 offen lds
    s_add_u32 m0, s45, 9216
    s_add_u32 s47, s46, 0x48000
    buffer_load_dwordx4 v3, s[24:27], s47 offen lds
    s_add_u32 m0, s45, 10240
    s_add_u32 s47, s46, 0x50000
    buffer_load_dwordx4 v3, s[24:27], s47 offen lds
    s_add_u32 m0, s45, 11264
    s_add_u32 s47, s46, 0x58000
    buffer_load_dwordx4 v3, s[24:27], s47 offen lds
    s_add_u32 m0, s45, 12288
    s_add_u32 s47, s46, 0x60000
    buffer_load_dwordx4 v3, s[24:27], s47 offen lds
    s_add_u32 m0, s45, 13312
    s_add_u32 s47, s46, 0x68000
    buffer_load_dwordx4 v3, s[24:27], s47 offen lds
    s_add_u32 m0, s45, 14336
    s_add_u32 s47, s46, 0x70000
    buffer_load_dwordx4 v3, s[24:27], s47 offen lds
    s_add_u32 m0, s45, 15360
    s_add_u32 s47, s46, 0x78000
    buffer_load_dwordx4 v3, s[24:27], s47 offen lds
    s_waitcnt vmcnt(0)
    s_barrier
    ds_read_b64_tr_b16 a[0:1], v5 offset:0
    ds_read_b64_tr_b16 a[2:3], v5 offset:1024
    ds_read_b64_tr_b16 a[4:5], v5 offset:8
    ds_read_b64_tr_b16 a[6:7], v5 offset:1032
    ds_read_b64_tr_b16 a[8:9], v5 offset:8192
    ds_read_b64_tr_b16 a[10:11], v5 offset:9216
    ds_read_b64_tr_b16 a[12:13], v5 offset:8200
    ds_read_b64_tr_b16 a[14:15], v5 offset:9224
    s_waitcnt lgkmcnt(0)
    ds_read_b64_tr_b16 a[16:17], v5 offset:16384
    ds_read_b64_tr_b16 a[18:19], v5 offset:17408
    ds_read_b64_tr_b16 a[20:21], v5 offset:16392
    ds_read_b64_tr_b16 a[22:23], v5 offset:17416
    ds_read_b64_tr_b16 a[24:25], v5 offset:24576
    ds_read_b64_tr_b16 a[26:27], v5 offset:25600
    ds_read_b64_tr_b16 a[28:29], v5 offset:24584
    ds_read_b64_tr_b16 a[30:31], v5 offset:25608
    s_waitcnt lgkmcnt(0)
    ds_read_b64_tr_b16 a[32:33], v5 offset:32768
    ds_read_b64_tr_b16 a[34:35], v5 offset:33792
    ds_read_b64_tr_b16 a[36:37], v5 offset:32776
    ds_read_b64_tr_b16 a[38:39], v5 offset:33800
    ds_read_b64_tr_b16 a[40:41], v5 offset:40960
    ds_read_b64_tr_b16 a[42:43], v5 offset:41984
    ds_read_b64_tr_b16 a[44:45], v5 offset:40968
    ds_read_b64_tr_b16 a[46:47], v5 offset:41992
    s_waitcnt lgkmcnt(0)
    ds_read_b64_tr_b16 a[48:49], v5 offset:49152
    ds_read_b64_tr_b16 a[50:51], v5 offset:50176
    ds_read_b64_tr_b16 a[52:53], v5 offset:49160
    ds_read_b64_tr_b16 a[54:55], v5 offset:50184
    ds_read_b64_tr_b16 a[56:57], v5 offset:57344
    ds_read_b64_tr_b16 a[58:59], v5 offset:58368
    ds_read_b64_tr_b16 a[60:61], v5 offset:57352
    ds_read_b64_tr_b16 a[62:63], v5 offset:58376
    s_waitcnt lgkmcnt(0)
    s_waitcnt lgkmcnt(0)
    s_barrier
    s_add_u32 m0, s45, 0
    s_add_u32 s47, s46, 0x200000
    buffer_load_dwordx4 v3, s[24:27], s47 offen lds
    s_add_u32 m0, s45, 1024
    s_add_u32 s47, s46, 0x208000
    buffer_load_dwordx4 v3, s[24:27], s47 offen lds
    s_add_u32 m0, s45, 2048
    s_add_u32 s47, s46, 0x210000
    buffer_load_dwordx4 v3, s[24:27], s47 offen lds
    s_add_u32 m0, s45, 3072
    s_add_u32 s47, s46, 0x218000
    buffer_load_dwordx4 v3, s[24:27], s47 offen lds
    s_add_u32 m0, s45, 4096
    s_add_u32 s47, s46, 0x220000
    buffer_load_dwordx4 v3, s[24:27], s47 offen lds
    s_add_u32 m0, s45, 5120
    s_add_u32 s47, s46, 0x228000
    buffer_load_dwordx4 v3, s[24:27], s47 offen lds
    s_add_u32 m0, s45, 6144
    s_add_u32 s47, s46, 0x230000
    buffer_load_dwordx4 v3, s[24:27], s47 offen lds
    s_add_u32 m0, s45, 7168
    s_add_u32 s47, s46, 0x238000
    buffer_load_dwordx4 v3, s[24:27], s47 offen lds
    s_add_u32 m0, s45, 8192
    s_add_u32 s47, s46, 0x240000
    buffer_load_dwordx4 v3, s[24:27], s47 offen lds
    s_add_u32 m0, s45, 9216
    s_add_u32 s47, s46, 0x248000
    buffer_load_dwordx4 v3, s[24:27], s47 offen lds
    s_add_u32 m0, s45, 10240
    s_add_u32 s47, s46, 0x250000
    buffer_load_dwordx4 v3, s[24:27], s47 offen lds
    s_add_u32 m0, s45, 11264
    s_add_u32 s47, s46, 0x258000
    buffer_load_dwordx4 v3, s[24:27], s47 offen lds
    s_add_u32 m0, s45, 12288
    s_add_u32 s47, s46, 0x260000
    buffer_load_dwordx4 v3, s[24:27], s47 offen lds
    s_add_u32 m0, s45, 13312
    s_add_u32 s47, s46, 0x268000
    buffer_load_dwordx4 v3, s[24:27], s47 offen lds
    s_add_u32 m0, s45, 14336
    s_add_u32 s47, s46, 0x270000
    buffer_load_dwordx4 v3, s[24:27], s47 offen lds
    s_add_u32 m0, s45, 15360
    s_add_u32 s47, s46, 0x278000
    buffer_load_dwordx4 v3, s[24:27], s47 offen lds
    s_waitcnt vmcnt(0)
    s_barrier
    ds_read_b64_tr_b16 a[64:65], v5 offset:0
    ds_read_b64_tr_b16 a[66:67], v5 offset:1024
    ds_read_b64_tr_b16 a[68:69], v5 offset:8
    ds_read_b64_tr_b16 a[70:71], v5 offset:1032
    ds_read_b64_tr_b16 a[72:73], v5 offset:8192
    ds_read_b64_tr_b16 a[74:75], v5 offset:9216
    ds_read_b64_tr_b16 a[76:77], v5 offset:8200
    ds_read_b64_tr_b16 a[78:79], v5 offset:9224
    s_waitcnt lgkmcnt(0)
    ds_read_b64_tr_b16 a[80:81], v5 offset:16384
    ds_read_b64_tr_b16 a[82:83], v5 offset:17408
    ds_read_b64_tr_b16 a[84:85], v5 offset:16392
    ds_read_b64_tr_b16 a[86:87], v5 offset:17416
    ds_read_b64_tr_b16 a[88:89], v5 offset:24576
    ds_read_b64_tr_b16 a[90:91], v5 offset:25600
    ds_read_b64_tr_b16 a[92:93], v5 offset:24584
    ds_read_b64_tr_b16 a[94:95], v5 offset:25608
    s_waitcnt lgkmcnt(0)
    ds_read_b64_tr_b16 a[96:97], v5 offset:32768
    ds_read_b64_tr_b16 a[98:99], v5 offset:33792
    ds_read_b64_tr_b16 a[100:101], v5 offset:32776
    ds_read_b64_tr_b16 a[102:103], v5 offset:33800
    ds_read_b64_tr_b16 a[104:105], v5 offset:40960
    ds_read_b64_tr_b16 a[106:107], v5 offset:41984
    ds_read_b64_tr_b16 a[108:109], v5 offset:40968
    ds_read_b64_tr_b16 a[110:111], v5 offset:41992
    s_waitcnt lgkmcnt(0)
    ds_read_b64_tr_b16 a[112:113], v5 offset:49152
    ds_read_b64_tr_b16 a[114:115], v5 offset:50176
    ds_read_b64_tr_b16 a[116:117], v5 offset:49160
    ds_read_b64_tr_b16 a[118:119], v5 offset:50184
    ds_read_b64_tr_b16 a[120:121], v5 offset:57344
    ds_read_b64_tr_b16 a[122:123], v5 offset:58368
    ds_read_b64_tr_b16 a[124:125], v5 offset:57352
    ds_read_b64_tr_b16 a[126:127], v5 offset:58376
    s_waitcnt lgkmcnt(0)
    s_waitcnt lgkmcnt(0)
    s_barrier
    v_lshlrev_b32 v2, 4, v1
    s_mul_i32 s64, s44, 8192
    s_add_u32 s46, s64, 0x400000
    v_add_u32 v3, s46, v2
    s_mul_i32 s46, s51, 32768
    v_add_u32 v4, s46, v2
    v_and_b32 v6, 15, v1
    v_lshlrev_b32 v6, 4, v6
    v_lshrrev_b32 v7, 4, v1
    v_lshl_add_u32 v6, v7, 9, v6
    v_add_u32 v4, s46, v6
    s_lshl_b32 s46, s50, 12
    s_add_u32 s46, s46, 131072
    v_add_u32 v5, s46, v2
    v_and_b32 v7, 3, v1
    v_lshlrev_b32 v7, 7, v7
    v_add_u32 v7, 0x109400, v7
    s_mul_i32 s46, s49, 24576
    s_lshl_b32 s47, s53, 13
    s_add_u32 s46, s46, s47
    s_lshl_b32 s47, s50, 10
    s_add_u32 s46, s46, s47
    s_add_u32 s46, s46, 0x2000000
    v_and_b32 v8, 15, v1
    v_lshlrev_b32 v8, 4, v8
    v_bfe_u32 v9, v1, 4, 1
    v_lshl_add_u32 v8, v9, 12, v8
    v_lshrrev_b32 v9, 5, v1
    v_lshl_add_u32 v8, v9, 8, v8
    v_add_u32 v8, s46, v2
    v_add_u32 v9, 4096, v8
    s_lshl_b32 s52, s40, 2
    s_add_u32 s52, s52, s53
    s_lshl_b32 s52, s52, 2
    s_and_b32 s47, s48, 3
    s_add_u32 s52, s52, s47
    s_lshl_b32 s52, s52, 7
    s_add_u32 s52, s52, 0x10a400
    s_add_u32 s52, s52, s76
    v_mov_b32 v116, -1
    v_mov_b32 v117, -1
    v_mov_b32 v118, -1
    v_mov_b32 v119, -1
    s_lshl_b32 s46, s49, 12
    s_lshl_b32 s47, s50, 10
    s_add_u32 s46, s46, s47
    s_add_u32 s46, s46, 0x1000000
    v_add_u32 v64, s46, v2
    s_and_b32 s46, s48, 3
    s_lshl_b32 s46, s46, 16
    s_lshl_b32 s47, s50, 14
    s_add_u32 s46, s46, s47
    s_lshl_b32 s47, s40, 8
    s_add_u32 s46, s46, s47
    s_add_u32 s46, s46, 0x7800000
    v_and_b32 v65, 15, v1
    v_lshlrev_b32 v65, 4, v65
    v_lshrrev_b32 v66, 4, v1
    v_lshl_add_u32 v65, v66, 11, v65
    v_add_u32 v65, s46, v65
    s_cmp_eq_u32 s53, 2
    s_cselect_b64 vcc, -1, 0
    v_cndmask_b32 v64, v64, v65, vcc
    v_add_u32 v65, 8192, v64
    s_lshl_b32 s73, s53, 17
    s_mul_i32 s58, s74, s73
    s_lshl_b32 s46, s53, 3
    s_sub_u32 s46, 80, s46
    s_load_dwordx2 s[8:9], s[0:1], s46
    v_lshlrev_b32 v66, 7, v1
    s_mul_i32 s57, s49, 229376
    s_waitcnt lgkmcnt(0)
    s_mov_b32 s32, s8
    s_and_b32 s33, s9, 0xffff
    s_mov_b32 s34, 0x700000
    s_mov_b32 s35, 0x00020000
    s_mov_b32 s60, s74
    s_mul_i32 s61, s74, 65536
    s_mov_b32 s62, s74
    s_mul_i32 s63, s74, 786432
    s_mov_b32 s67, 0
    s_mov_b32 s68, 3
    s_mov_b32 s71, 0
    v_mov_b32 v15, 147456
    v_mov_b32 v14, 0
    ds_write_b32 v15, v14 offset:4
    ds_write_b32 v15, v14 offset:12
    ds_write_b32 v15, v14 offset:16
    v_mov_b32 v114, 1
    s_mov_b32 s72, 0
    s_cmp_lg_u32 s44, 0
    s_cbranch_scc1 L_zwok_59
    v_and_b32 v10, 7, v1
    v_lshlrev_b32 v10, 5, v10
    s_mov_b32 s70, 0
L_zw_58:
    buffer_load_dword v11, v10, s[16:19], 0 offen sc1
    s_waitcnt vmcnt(0)
    v_add_u32_dpp v11, v11, v11 row_ror:1 row_mask:0xf bank_mask:0xf
    s_nop 1
    v_add_u32_dpp v11, v11, v11 row_ror:2 row_mask:0xf bank_mask:0xf
    s_nop 1
    v_add_u32_dpp v11, v11, v11 row_ror:4 row_mask:0xf bank_mask:0xf
    v_cmp_ne_u32 vcc, 0x100, v11
    s_add_u32 s70, s70, 1
    s_cbranch_vccz L_zwok_59
    s_sleep 4
    s_cmp_lt_u32 s70, 524288
    s_cbranch_scc1 L_zw_58
    s_branch L_c_done_1
L_zwok_59:
L_g_restart_50:
    s_cmp_lg_u32 s44, 0
    s_cbranch_scc1 L_g_nsp_51
    s_mov_b32 s70, 0
L_g_sp_57:
    s_add_u32 s54, s60, 0
    s_add_u32 s55, s54, 0
    s_and_b32 s46, s55, 7
    s_lshl_b32 s46, s46, 9
    buffer_load_dword v11, v7, s[12:15], s46 offen sc1
    s_add_u32 s55, s54, 1
    s_and_b32 s46, s55, 7
    s_lshl_b32 s46, s46, 9
    buffer_load_dword v12, v7, s[12:15], s46 offen sc1
    s_add_u32 s55, s54, 2
    s_and_b32 s46, s55, 7
    s_lshl_b32 s46, s46, 9
    buffer_load_dword v13, v7, s[12:15], s46 offen sc1
    s_waitcnt vmcnt(0)
    v_cmp_ge_u32 vcc, s60, v11
    s_add_u32 s70, s70, 1
    s_cbranch_vccz L_g_sp_57_ok
    s_sleep 3
    s_cmp_lt_u32 s70, 524288
    s_cbranch_scc1 L_g_sp_57
    s_branch L_c_done_1
L_g_sp_57_ok:
    s_mov_b32 s46, s54
    v_cmp_ge_u32 vcc, s46, v11
    s_nop 0
    s_cbranch_vccnz L_g_le_60
    s_add_u32 s46, s46, 1
    v_cmp_ge_u32 vcc, s46, v12
    s_nop 0
    s_cbranch_vccnz L_g_le_60
    s_add_u32 s46, s46, 1
    v_cmp_ge_u32 vcc, s46, v13
    s_nop 0
    s_cbranch_vccnz L_g_le_60
    s_add_u32 s46, s46, 1
L_g_le_60:
    s_min_u32 s46, s46, s75
    v_mov_b32 v11, s46
    ds_write_b32 v15, v11
L_g_nsp_51:
    s_waitcnt lgkmcnt(0)
    s_barrier
    ds_read_b32 v14, v15
    s_waitcnt lgkmcnt(0)
    v_readfirstlane_b32 s66, v14
    s_nop 3
L_g_restart_50_go:
    s_mov_b32 s69, 0
    s_cmp_gt_u32 s62, s60
    s_cbranch_scc1 L_g_nd_61
    s_cmp_ge_u32 s62, s66
    s_cbranch_scc1 L_g_nd_61
    s_add_u32 s47, s61, 4096
    s_add_u32 m0, s64, 0
    s_nop 0
    buffer_load_dwordx4 v3, s[12:15], s61 offen offset:0 sc1 lds
    buffer_load_dwordx4 v3, s[12:15], s61 offen offset:1024 sc1 lds
    buffer_load_dwordx4 v3, s[12:15], s61 offen offset:2048 sc1 lds
    buffer_load_dwordx4 v3, s[12:15], s61 offen offset:3072 sc1 lds
    s_add_u32 m0, s64, 4096
    s_nop 0
    buffer_load_dwordx4 v3, s[12:15], s47 offen offset:0 sc1 lds
    buffer_load_dwordx4 v3, s[12:15], s47 offen offset:1024 sc1 lds
    buffer_load_dwordx4 v3, s[12:15], s47 offen offset:2048 sc1 lds
    buffer_load_dwordx4 v3, s[12:15], s47 offen offset:3072 sc1 lds
    s_add_u32 s61, s61, 65536
    s_add_u32 s62, s62, 1
    s_xor_b32 s64, s64, 0x10000
    s_mov_b32 s69, 1
L_g_nd_61:
    s_cmp_eq_u32 s51, 1
    s_cbranch_scc1 L_g_g1r_52
    s_add_u32 s59, s60, 1
    s_mov_b32 s69, 0
    s_cmp_gt_u32 s62, s59
    s_cbranch_scc1 L_g_nd_62
    s_cmp_ge_u32 s62, s66
    s_cbranch_scc1 L_g_nd_62
    s_add_u32 s47, s61, 4096
    s_add_u32 m0, s64, 0
    s_nop 0
    buffer_load_dwordx4 v3, s[12:15], s61 offen offset:0 sc1 lds
    buffer_load_dwordx4 v3, s[12:15], s61 offen offset:1024 sc1 lds
    buffer_load_dwordx4 v3, s[12:15], s61 offen offset:2048 sc1 lds
    buffer_load_dwordx4 v3, s[12:15], s61 offen offset:3072 sc1 lds
    s_add_u32 m0, s64, 4096
    s_nop 0
    buffer_load_dwordx4 v3, s[12:15], s47 offen offset:0 sc1 lds
    buffer_load_dwordx4 v3, s[12:15], s47 offen offset:1024 sc1 lds
    buffer_load_dwordx4 v3, s[12:15], s47 offen offset:2048 sc1 lds
    buffer_load_dwordx4 v3, s[12:15], s47 offen offset:3072 sc1 lds
    s_add_u32 s61, s61, 65536
    s_add_u32 s62, s62, 1
    s_xor_b32 s64, s64, 0x10000
    s_mov_b32 s69, 1
L_g_nd_62:
    s_cmp_eq_u32 s69, 1
    s_cbranch_scc1 L_g_w0_63
    s_waitcnt vmcnt(0)
L_g_w0_63:
    s_waitcnt vmcnt(8)
    s_mov_b32 s65, 1
.p2align 6
L_g_loop0_53:
    s_barrier
    s_cmp_eq_u32 s65, 0
    s_cbranch_scc1 L_g_pr_64
    ds_read_b128 v[32:35], v4 offset:0
    ds_read_b128 v[36:39], v4 offset:256
    ds_read_b128 v[40:43], v4 offset:2048
    ds_read_b128 v[44:47], v4 offset:2304
    ds_read_b128 v[48:51], v4 offset:4096
    ds_read_b128 v[52:55], v4 offset:4352
    ds_read_b128 v[56:59], v4 offset:6144
    ds_read_b128 v[60:63], v4 offset:6400
    ds_read_b128 v[72:75], v4 offset:8192
    ds_read_b128 v[76:79], v4 offset:8448
    ds_read_b128 v[120:123], v4 offset:10240
    ds_read_b128 v[124:127], v4 offset:10496
L_g_pr_64:
    ds_read_b32 v14, v15
    s_cmp_lg_u32 s44, 0
    s_cbranch_scc1 L_g_nl_65
    s_add_u32 s54, s60, 1
    s_add_u32 s55, s54, 0
    s_and_b32 s46, s55, 7
    s_lshl_b32 s46, s46, 9
    buffer_load_dword v11, v7, s[12:15], s46 offen sc1
    s_add_u32 s55, s54, 1
    s_and_b32 s46, s55, 7
    s_lshl_b32 s46, s46, 9
    buffer_load_dword v12, v7, s[12:15], s46 offen sc1
    s_add_u32 s55, s54, 2
    s_and_b32 s46, s55, 7
    s_lshl_b32 s46, s46, 9
    buffer_load_dword v13, v7, s[12:15], s46 offen sc1
L_g_nl_65:
    s_setprio 2
    s_waitcnt lgkmcnt(8)
    v_mfma_f32_16x16x32_bf16 v[16:19], a[0:3], v[32:35], 0
    v_mfma_f32_16x16x32_bf16 v[20:23], a[4:7], v[32:35], 0
    ds_read_b128 v[32:35], v4 offset:12288
    v_mfma_f32_16x16x32_bf16 v[28:31], a[4:7], v[36:39], 0
    v_mfma_f32_16x16x32_bf16 v[24:27], a[0:3], v[36:39], 0
    ds_read_b128 v[36:39], v4 offset:12544
    v_mfma_f32_16x16x32_bf16 v[16:19], a[8:11], v[40:43], v[16:19]
    v_mfma_f32_16x16x32_bf16 v[20:23], a[12:15], v[40:43], v[20:23]
    ds_read_b128 v[40:43], v4 offset:14336
    v_mfma_f32_16x16x32_bf16 v[28:31], a[12:15], v[44:47], v[28:31]
    v_mfma_f32_16x16x32_bf16 v[24:27], a[8:11], v[44:47], v[24:27]
    ds_read_b128 v[44:47], v4 offset:14592
    s_waitcnt lgkmcnt(8)
    v_mfma_f32_16x16x32_bf16 v[16:19], a[16:19], v[48:51], v[16:19]
    v_mfma_f32_16x16x32_bf16 v[20:23], a[20:23], v[48:51], v[20:23]
    ds_read_b128 v[48:51], v4 offset:16384
    v_mfma_f32_16x16x32_bf16 v[28:31], a[20:23], v[52:55], v[28:31]
    v_mfma_f32_16x16x32_bf16 v[24:27], a[16:19], v[52:55], v[24:27]
    ds_read_b128 v[52:55], v4 offset:16640
    v_mfma_f32_16x16x32_bf16 v[16:19], a[24:27], v[56:59], v[16:19]
    v_mfma_f32_16x16x32_bf16 v[20:23], a[28:31], v[56:59], v[20:23]
    ds_read_b128 v[56:59], v4 offset:18432
    v_mfma_f32_16x16x32_bf16 v[28:31], a[28:31], v[60:63], v[28:31]
    v_mfma_f32_16x16x32_bf16 v[24:27], a[24:27], v[60:63], v[24:27]
    ds_read_b128 v[60:63], v4 offset:18688
    s_waitcnt lgkmcnt(8)
    v_mfma_f32_16x16x32_bf16 v[16:19], a[32:35], v[72:75], v[16:19]
    v_mfma_f32_16x16x32_bf16 v[20:23], a[36:39], v[72:75], v[20:23]
    ds_read_b128 v[72:75], v4 offset:20480
    v_mfma_f32_16x16x32_bf16 v[28:31], a[36:39], v[76:79], v[28:31]
    v_mfma_f32_16x16x32_bf16 v[24:27], a[32:35], v[76:79], v[24:27]
    ds_read_b128 v[76:79], v4 offset:20736
    v_mfma_f32_16x16x32_bf16 v[16:19], a[40:43], v[120:123], v[16:19]
    v_mfma_f32_16x16x32_bf16 v[20:23], a[44:47], v[120:123], v[20:23]
    ds_read_b128 v[120:123], v4 offset:22528
    v_mfma_f32_16x16x32_bf16 v[28:31], a[44:47], v[124:127], v[28:31]
    v_mfma_f32_16x16x32_bf16 v[24:27], a[40:43], v[124:127], v[24:27]
    ds_read_b128 v[124:127], v4 offset:22784
    s_waitcnt lgkmcnt(8)
    v_mfma_f32_16x16x32_bf16 v[16:19], a[48:51], v[32:35], v[16:19]
    v_mfma_f32_16x16x32_bf16 v[20:23], a[52:55], v[32:35], v[20:23]
    ds_read_b128 v[32:35], v4 offset:24576
    v_mfma_f32_16x16x32_bf16 v[28:31], a[52:55], v[36:39], v[28:31]
    v_mfma_f32_16x16x32_bf16 v[24:27], a[48:51], v[36:39], v[24:27]
    ds_read_b128 v[36:39], v4 offset:24832
    v_mfma_f32_16x16x32_bf16 v[16:19], a[56:59], v[40:43], v[16:19]
    v_mfma_f32_16x16x32_bf16 v[20:23], a[60:63], v[40:43], v[20:23]
    ds_read_b128 v[40:43], v4 offset:26624
    v_mfma_f32_16x16x32_bf16 v[28:31], a[60:63], v[44:47], v[28:31]
    v_mfma_f32_16x16x32_bf16 v[24:27], a[56:59], v[44:47], v[24:27]
    ds_read_b128 v[44:47], v4 offset:26880
    s_waitcnt lgkmcnt(8)
    v_mfma_f32_16x16x32_bf16 v[16:19], a[64:67], v[48:51], v[16:19]
    v_mfma_f32_16x16x32_bf16 v[20:23], a[68:71], v[48:51], v[20:23]
    ds_read_b128 v[48:51], v4 offset:28672
    v_mfma_f32_16x16x32_bf16 v[28:31], a[68:71], v[52:55], v[28:31]
    v_mfma_f32_16x16x32_bf16 v[24:27], a[64:67], v[52:55], v[24:27]
    ds_read_b128 v[52:55], v4 offset:28928
    v_mfma_f32_16x16x32_bf16 v[16:19], a[72:75], v[56:59], v[16:19]
    v_mfma_f32_16x16x32_bf16 v[20:23], a[76:79], v[56:59], v[20:23]
    ds_read_b128 v[56:59], v4 offset:30720
    v_mfma_f32_16x16x32_bf16 v[28:31], a[76:79], v[60:63], v[28:31]
    v_mfma_f32_16x16x32_bf16 v[24:27], a[72:75], v[60:63], v[24:27]
    ds_read_b128 v[60:63], v4 offset:30976
    s_waitcnt lgkmcnt(8)
    v_mfma_f32_16x16x32_bf16 v[16:19], a[80:83], v[72:75], v[16:19]
    v_mfma_f32_16x16x32_bf16 v[20:23], a[84:87], v[72:75], v[20:23]
    v_mfma_f32_16x16x32_bf16 v[28:31], a[84:87], v[76:79], v[28:31]
    v_mfma_f32_16x16x32_bf16 v[24:27], a[80:83], v[76:79], v[24:27]
    v_mfma_f32_16x16x32_bf16 v[16:19], a[88:91], v[120:123], v[16:19]
    v_mfma_f32_16x16x32_bf16 v[20:23], a[92:95], v[120:123], v[20:23]
    v_mfma_f32_16x16x32_bf16 v[28:31], a[92:95], v[124:127], v[28:31]
    v_mfma_f32_16x16x32_bf16 v[24:27], a[88:91], v[124:127], v[24:27]
    s_waitcnt lgkmcnt(4)
    v_mfma_f32_16x16x32_bf16 v[16:19], a[96:99], v[32:35], v[16:19]
    v_mfma_f32_16x16x32_bf16 v[20:23], a[100:103], v[32:35], v[20:23]
    v_mfma_f32_16x16x32_bf16 v[28:31], a[100:103], v[36:39], v[28:31]
    v_mfma_f32_16x16x32_bf16 v[24:27], a[96:99], v[36:39], v[24:27]
    v_mfma_f32_16x16x32_bf16 v[16:19], a[104:107], v[40:43], v[16:19]
    v_mfma_f32_16x16x32_bf16 v[20:23], a[108:111], v[40:43], v[20:23]
    v_mfma_f32_16x16x32_bf16 v[28:31], a[108:111], v[44:47], v[28:31]
    v_mfma_f32_16x16x32_bf16 v[24:27], a[104:107], v[44:47], v[24:27]
    s_waitcnt lgkmcnt(0)
    v_mfma_f32_16x16x32_bf16 v[16:19], a[112:115], v[48:51], v[16:19]
    v_mfma_f32_16x16x32_bf16 v[20:23], a[116:119], v[48:51], v[20:23]
    v_mfma_f32_16x16x32_bf16 v[28:31], a[116:119], v[52:55], v[28:31]
    v_mfma_f32_16x16x32_bf16 v[24:27], a[112:115], v[52:55], v[24:27]
    v_mfma_f32_16x16x32_bf16 v[16:19], a[120:123], v[56:59], v[16:19]
    v_mfma_f32_16x16x32_bf16 v[20:23], a[124:127], v[56:59], v[20:23]
    v_mfma_f32_16x16x32_bf16 v[28:31], a[124:127], v[60:63], v[28:31]
    v_mfma_f32_16x16x32_bf16 v[24:27], a[120:123], v[60:63], v[24:27]
    v_xor_b32 v4, 0x10000, v4
    s_setprio 0
    s_waitcnt vmcnt(0)
    v_readfirstlane_b32 s66, v14
    s_barrier
    s_nop 6
    ds_write_b128 v5, v[16:19] offset:0
    ds_write_b128 v5, v[20:23] offset:1024
    ds_write_b128 v5, v[24:27] offset:2048
    ds_write_b128 v5, v[28:31] offset:3072
    s_cmp_lg_u32 s44, 0
    s_cbranch_scc1 L_g_ne_66
    s_mov_b32 s46, s54
    v_cmp_ge_u32 vcc, s46, v11
    s_nop 0
    s_cbranch_vccnz L_g_le_69
    s_add_u32 s46, s46, 1
    v_cmp_ge_u32 vcc, s46, v12
    s_nop 0
    s_cbranch_vccnz L_g_le_69
    s_add_u32 s46, s46, 1
    v_cmp_ge_u32 vcc, s46, v13
    s_nop 0
    s_cbranch_vccnz L_g_le_69
    s_add_u32 s46, s46, 1
L_g_le_69:
    s_min_u32 s46, s46, s75
    v_mov_b32 v11, s46
    ds_write_b32 v15, v11
L_g_ne_66:
    s_add_u32 s60, s60, 1
    s_mov_b32 s69, 0
    s_cmp_gt_u32 s62, s60
    s_cbranch_scc1 L_g_nd_70
    s_cmp_ge_u32 s62, s66
    s_cbranch_scc1 L_g_nd_70
    s_add_u32 s47, s61, 4096
    s_add_u32 m0, s64, 0
    s_nop 0
    buffer_load_dwordx4 v3, s[12:15], s61 offen offset:0 sc1 lds
    buffer_load_dwordx4 v3, s[12:15], s61 offen offset:1024 sc1 lds
    buffer_load_dwordx4 v3, s[12:15], s61 offen offset:2048 sc1 lds
    buffer_load_dwordx4 v3, s[12:15], s61 offen offset:3072 sc1 lds
    s_add_u32 m0, s64, 4096
    s_nop 0
    buffer_load_dwordx4 v3, s[12:15], s47 offen offset:0 sc1 lds
    buffer_load_dwordx4 v3, s[12:15], s47 offen offset:1024 sc1 lds
    buffer_load_dwordx4 v3, s[12:15], s47 offen offset:2048 sc1 lds
    buffer_load_dwordx4 v3, s[12:15], s47 offen offset:3072 sc1 lds
    s_add_u32 s61, s61, 65536
    s_add_u32 s62, s62, 1
    s_xor_b32 s64, s64, 0x10000
    s_mov_b32 s69, 1
L_g_nd_70:
    s_mov_b32 s65, s69
    s_add_u32 s59, s60, 1
    s_mov_b32 s69, 0
    s_cmp_gt_u32 s62, s59
    s_cbranch_scc1 L_g_nd_71
    s_cmp_ge_u32 s62, s66
    s_cbranch_scc1 L_g_nd_71
    s_add_u32 s47, s61, 4096
    s_add_u32 m0, s64, 0
    s_nop 0
    buffer_load_dwordx4 v3, s[12:15], s61 offen offset:0 sc1 lds
    buffer_load_dwordx4 v3, s[12:15], s61 offen offset:1024 sc1 lds
    buffer_load_dwordx4 v3, s[12:15], s61 offen offset:2048 sc1 lds
    buffer_load_dwordx4 v3, s[12:15], s61 offen offset:3072 sc1 lds
    s_add_u32 m0, s64, 4096
    s_nop 0
    buffer_load_dwordx4 v3, s[12:15], s47 offen offset:0 sc1 lds
    buffer_load_dwordx4 v3, s[12:15], s47 offen offset:1024 sc1 lds
    buffer_load_dwordx4 v3, s[12:15], s47 offen offset:2048 sc1 lds
    buffer_load_dwordx4 v3, s[12:15], s47 offen offset:3072 sc1 lds
    s_add_u32 s61, s61, 65536
    s_add_u32 s62, s62, 1
    s_xor_b32 s64, s64, 0x10000
    s_mov_b32 s69, 1
L_g_nd_71:
    s_cmp_le_u32 s66, s60
    s_cbranch_scc1 L_g_ex0_68
    s_cmp_eq_u32 s65, 0
    s_cbranch_scc1 L_g_nw_67
    s_waitcnt vmcnt(0) lgkmcnt(0)
    s_branch L_g_loop0_53
L_g_nw_67:
    ds_read_b128 v[32:35], v4 offset:0
    ds_read_b128 v[36:39], v4 offset:256
    ds_read_b128 v[40:43], v4 offset:2048
    ds_read_b128 v[44:47], v4 offset:2304
    ds_read_b128 v[48:51], v4 offset:4096
    ds_read_b128 v[52:55], v4 offset:4352
    ds_read_b128 v[56:59], v4 offset:6144
    ds_read_b128 v[60:63], v4 offset:6400
    ds_read_b128 v[72:75], v4 offset:8192
    ds_read_b128 v[76:79], v4 offset:8448
    ds_read_b128 v[120:123], v4 offset:10240
    ds_read_b128 v[124:127], v4 offset:10496
    s_waitcnt lgkmcnt(12)
    s_branch L_g_loop0_53
L_g_ex0_68:
    s_cmp_lg_u32 s44, 0
    s_cbranch_scc1 L_g_ex0_68_n
    s_sleep 6
    s_add_u32 s54, s60, 0
    s_add_u32 s55, s54, 0
    s_and_b32 s46, s55, 7
    s_lshl_b32 s46, s46, 9
    buffer_load_dword v11, v7, s[12:15], s46 offen sc1
    s_add_u32 s55, s54, 1
    s_and_b32 s46, s55, 7
    s_lshl_b32 s46, s46, 9
    buffer_load_dword v12, v7, s[12:15], s46 offen sc1
    s_add_u32 s55, s54, 2
    s_and_b32 s46, s55, 7
    s_lshl_b32 s46, s46, 9
    buffer_load_dword v13, v7, s[12:15], s46 offen sc1
    s_waitcnt vmcnt(0)
    s_mov_b32 s46, s54
    v_cmp_ge_u32 vcc, s46, v11
    s_nop 0
    s_cbranch_vccnz L_g_le_72
    s_add_u32 s46, s46, 1
    v_cmp_ge_u32 vcc, s46, v12
    s_nop 0
    s_cbranch_vccnz L_g_le_72
    s_add_u32 s46, s46, 1
    v_cmp_ge_u32 vcc, s46, v13
    s_nop 0
    s_cbranch_vccnz L_g_le_72
    s_add_u32 s46, s46, 1
L_g_le_72:
    s_min_u32 s46, s46, s75
    v_mov_b32 v11, s46
    ds_write_b32 v15, v11
L_g_ex0_68_n:
    s_waitcnt lgkmcnt(0)
    s_barrier
    ds_read_b32 v14, v15
    s_waitcnt lgkmcnt(0)
    v_readfirstlane_b32 s66, v14
    s_barrier
    s_cmp_gt_u32 s66, s60
    s_cbranch_scc1 L_g_restart_50_go
    s_branch L_g_tail_55
L_g_g1r_52:
    s_mov_b32 s65, 1
    s_branch L_g_loop1_54_e
.p2align 6
L_g_loop1_54:
    s_mov_b32 s65, 0
L_g_loop1_54_e:
    s_barrier
    ds_read_b32 v14, v15
    s_bitcmp1_b32 s67, 1
    s_cbranch_scc0 L_g_nfl_73
    s_sub_u32 s59, s60, 2
    s_cmp_lg_u32 s44, 4
    s_cbranch_scc1 L_sf_78
    v_mov_b32 v10, s59
    v_add_u32 v10, 1, v10
    v_mov_b32 v11, 0
    s_mov_b64 exec, 1
    buffer_store_dword v10, v11, s[12:15], s52 offen sc1
    s_mov_b64 exec, -1
L_sf_78:
L_g_nfl_73:
    s_cmp_eq_u32 s71, 0
    s_cbranch_scc1 L_g_nfl_73_d
    v_mov_b32 v10, 1
    s_mov_b64 exec, 1
    s_waitcnt vmcnt(0)
    ds_add_rtn_u32 v10, v15, v10 offset:4
    s_waitcnt lgkmcnt(0)
    v_readfirstlane_b32 s46, v10
    s_mov_b64 exec, -1
    s_mov_b32 s71, 0
    s_sub_u32 s59, s60, 1
    s_cmp_lg_u32 s46, s68
    s_cbranch_scc1 L_g_df_79
    v_mov_b32 v10, s59
    v_add_u32 v10, 1, v10
    v_mov_b32 v11, 0
    s_mov_b64 exec, 1
    buffer_store_dword v10, v11, s[12:15], s52 offen sc1
    s_mov_b64 exec, -1
L_sf_80:
L_g_df_79:
    s_add_u32 s68, s68, 4
    s_mov_b32 s65, 2
L_g_nfl_73_d:
    s_waitcnt lgkmcnt(0)
    v_readfirstlane_b32 s66, v14
    s_nop 3
    s_mov_b32 s69, 0
    s_cmp_gt_u32 s62, s60
    s_cbranch_scc1 L_g_nd_81
    s_cmp_ge_u32 s62, s66
    s_cbranch_scc1 L_g_nd_81
    s_add_u32 s47, s61, 4096
    s_add_u32 m0, s64, 0
    s_nop 0
    buffer_load_dwordx4 v3, s[12:15], s61 offen offset:0 sc1 lds
    buffer_load_dwordx4 v3, s[12:15], s61 offen offset:1024 sc1 lds
    buffer_load_dwordx4 v3, s[12:15], s61 offen offset:2048 sc1 lds
    buffer_load_dwordx4 v3, s[12:15], s61 offen offset:3072 sc1 lds
    s_add_u32 m0, s64, 4096
    s_nop 0
    buffer_load_dwordx4 v3, s[12:15], s47 offen offset:0 sc1 lds
    buffer_load_dwordx4 v3, s[12:15], s47 offen offset:1024 sc1 lds
    buffer_load_dwordx4 v3, s[12:15], s47 offen offset:2048 sc1 lds
    buffer_load_dwordx4 v3, s[12:15], s47 offen offset:3072 sc1 lds
    s_add_u32 s61, s61, 65536
    s_add_u32 s62, s62, 1
    s_xor_b32 s64, s64, 0x10000
    s_mov_b32 s69, 1
L_g_nd_81:
    s_or_b32 s65, s65, s69
    s_add_u32 s59, s60, 1
    s_mov_b32 s69, 0
    s_cmp_gt_u32 s62, s59
    s_cbranch_scc1 L_g_nd_82
    s_cmp_ge_u32 s62, s66
    s_cbranch_scc1 L_g_nd_82
    s_add_u32 s47, s61, 4096
    s_add_u32 m0, s64, 0
    s_nop 0
    buffer_load_dwordx4 v3, s[12:15], s61 offen offset:0 sc1 lds
    buffer_load_dwordx4 v3, s[12:15], s61 offen offset:1024 sc1 lds
    buffer_load_dwordx4 v3, s[12:15], s61 offen offset:2048 sc1 lds
    buffer_load_dwordx4 v3, s[12:15], s61 offen offset:3072 sc1 lds
    s_add_u32 m0, s64, 4096
    s_nop 0
    buffer_load_dwordx4 v3, s[12:15], s47 offen offset:0 sc1 lds
    buffer_load_dwordx4 v3, s[12:15], s47 offen offset:1024 sc1 lds
    buffer_load_dwordx4 v3, s[12:15], s47 offen offset:2048 sc1 lds
    buffer_load_dwordx4 v3, s[12:15], s47 offen offset:3072 sc1 lds
    s_add_u32 s61, s61, 65536
    s_add_u32 s62, s62, 1
    s_xor_b32 s64, s64, 0x10000
    s_mov_b32 s69, 1
L_g_nd_82:
    s_bitcmp1_b32 s67, 0
    s_cbranch_scc0 L_g_nep_74
    ds_read_b128 v[80:83], v5 offset:0
    ds_read_b128 v[84:87], v5 offset:1024
    ds_read_b128 v[88:91], v5 offset:2048
    ds_read_b128 v[92:95], v5 offset:3072
    s_nop 7
    s_waitcnt lgkmcnt(3)
    v_add_f32 v80, v80, v16
    v_add_f32 v81, v81, v17
    v_add_f32 v82, v82, v18
    v_add_f32 v83, v83, v19
    s_waitcnt lgkmcnt(2)
    v_add_f32 v84, v84, v20
    v_add_f32 v85, v85, v21
    v_add_f32 v86, v86, v22
    v_add_f32 v87, v87, v23
    s_waitcnt lgkmcnt(1)
    v_add_f32 v88, v88, v24
    v_add_f32 v89, v89, v25
    v_add_f32 v90, v90, v26
    v_add_f32 v91, v91, v27
    s_waitcnt lgkmcnt(0)
    v_add_f32 v92, v92, v28
    v_add_f32 v93, v93, v29
    v_add_f32 v94, v94, v30
    v_add_f32 v95, v95, v31
    v_cvt_pk_bf16_f32 v104, v80, v81
    v_cvt_pk_bf16_f32 v105, v82, v83
    v_cvt_pk_bf16_f32 v106, v84, v85
    v_cvt_pk_bf16_f32 v107, v86, v87
    buffer_store_dwordx4 v[104:107], v8, s[12:15], s63 offen sc1
    v_cvt_pk_bf16_f32 v108, v88, v89
    v_cvt_pk_bf16_f32 v109, v90, v91
    v_cvt_pk_bf16_f32 v110, v92, v93
    v_cvt_pk_bf16_f32 v111, v94, v95
    buffer_store_dwordx4 v[108:111], v9, s[12:15], s63 offen sc1
    s_add_u32 s63, s63, 786432
    s_cmp_eq_u32 s53, 0
    s_cbranch_scc1 L_g_pf_83
    buffer_store_dwordx4 v[116:119], v64, s[12:15], s58 offen sc1
    s_cmp_eq_u32 s53, 1
    s_cbranch_scc1 L_g_pf_83
    buffer_store_dwordx4 v[116:119], v65, s[12:15], s58 offen sc1
L_g_pf_83:
    s_add_u32 s58, s58, s73
    s_cmp_gt_u32 s60, 2
    s_cbranch_scc1 L_g_nep_74
    v_mov_b32 v10, 1
    s_mov_b64 exec, 1
    s_waitcnt vmcnt(0)
    ds_add_rtn_u32 v10, v15, v10 offset:4
    s_waitcnt lgkmcnt(0)
    v_readfirstlane_b32 s46, v10
    s_mov_b64 exec, -1
    s_mov_b32 s71, 0
    s_sub_u32 s59, s60, 1
    s_cmp_lg_u32 s46, s68
    s_cbranch_scc1 L_g_df_84
    v_mov_b32 v10, s59
    v_add_u32 v10, 1, v10
    v_mov_b32 v11, 0
    s_mov_b64 exec, 1
    buffer_store_dword v10, v11, s[12:15], s52 offen sc1
    s_mov_b64 exec, -1
L_sf_85:
L_g_df_84:
    s_add_u32 s68, s68, 4
L_g_nep_74:
    s_cmp_eq_u32 s65, 0
    s_cbranch_scc1 L_g_nw1_75
    s_cmp_eq_u32 s65, 2
    s_cbranch_scc1 L_g_nw1_75_w
    s_waitcnt vmcnt(0)
L_g_nw1_75_w:
    s_barrier
    ds_read_b128 v[32:35], v4 offset:0
    ds_read_b128 v[36:39], v4 offset:256
    ds_read_b128 v[40:43], v4 offset:2048
    ds_read_b128 v[44:47], v4 offset:2304
    ds_read_b128 v[48:51], v4 offset:4096
    ds_read_b128 v[52:55], v4 offset:4352
    ds_read_b128 v[56:59], v4 offset:6144
    ds_read_b128 v[60:63], v4 offset:6400
    ds_read_b128 v[72:75], v4 offset:8192
    ds_read_b128 v[76:79], v4 offset:8448
    ds_read_b128 v[120:123], v4 offset:10240
    ds_read_b128 v[124:127], v4 offset:10496
    s_branch L_g_jn_77
L_g_nw1_75:
    ds_read_b128 v[32:35], v4 offset:0
    ds_read_b128 v[36:39], v4 offset:256
    ds_read_b128 v[40:43], v4 offset:2048
    ds_read_b128 v[44:47], v4 offset:2304
    ds_read_b128 v[48:51], v4 offset:4096
    ds_read_b128 v[52:55], v4 offset:4352
    ds_read_b128 v[56:59], v4 offset:6144
    ds_read_b128 v[60:63], v4 offset:6400
    ds_read_b128 v[72:75], v4 offset:8192
    ds_read_b128 v[76:79], v4 offset:8448
    ds_read_b128 v[120:123], v4 offset:10240
    ds_read_b128 v[124:127], v4 offset:10496
    s_barrier
L_g_jn_77:
    s_setprio 1
    s_waitcnt lgkmcnt(8)
    v_mfma_f32_16x16x32_bf16 v[16:19], a[0:3], v[32:35], 0
    v_mfma_f32_16x16x32_bf16 v[20:23], a[4:7], v[32:35], 0
    ds_read_b128 v[32:35], v4 offset:12288
    v_mfma_f32_16x16x32_bf16 v[28:31], a[4:7], v[36:39], 0
    v_mfma_f32_16x16x32_bf16 v[24:27], a[0:3], v[36:39], 0
    ds_read_b128 v[36:39], v4 offset:12544
    v_mfma_f32_16x16x32_bf16 v[16:19], a[8:11], v[40:43], v[16:19]
    v_mfma_f32_16x16x32_bf16 v[20:23], a[12:15], v[40:43], v[20:23]
    ds_read_b128 v[40:43], v4 offset:14336
    v_mfma_f32_16x16x32_bf16 v[28:31], a[12:15], v[44:47], v[28:31]
    v_mfma_f32_16x16x32_bf16 v[24:27], a[8:11], v[44:47], v[24:27]
    ds_read_b128 v[44:47], v4 offset:14592
    s_waitcnt lgkmcnt(8)
    v_mfma_f32_16x16x32_bf16 v[16:19], a[16:19], v[48:51], v[16:19]
    v_mfma_f32_16x16x32_bf16 v[20:23], a[20:23], v[48:51], v[20:23]
    ds_read_b128 v[48:51], v4 offset:16384
    v_mfma_f32_16x16x32_bf16 v[28:31], a[20:23], v[52:55], v[28:31]
    v_mfma_f32_16x16x32_bf16 v[24:27], a[16:19], v[52:55], v[24:27]
    ds_read_b128 v[52:55], v4 offset:16640
    v_mfma_f32_16x16x32_bf16 v[16:19], a[24:27], v[56:59], v[16:19]
    v_mfma_f32_16x16x32_bf16 v[20:23], a[28:31], v[56:59], v[20:23]
    ds_read_b128 v[56:59], v4 offset:18432
    v_mfma_f32_16x16x32_bf16 v[28:31], a[28:31], v[60:63], v[28:31]
    v_mfma_f32_16x16x32_bf16 v[24:27], a[24:27], v[60:63], v[24:27]
    ds_read_b128 v[60:63], v4 offset:18688
    s_waitcnt lgkmcnt(8)
    v_mfma_f32_16x16x32_bf16 v[16:19], a[32:35], v[72:75], v[16:19]
    v_mfma_f32_16x16x32_bf16 v[20:23], a[36:39], v[72:75], v[20:23]
    ds_read_b128 v[72:75], v4 offset:20480
    v_mfma_f32_16x16x32_bf16 v[28:31], a[36:39], v[76:79], v[28:31]
    v_mfma_f32_16x16x32_bf16 v[24:27], a[32:35], v[76:79], v[24:27]
    ds_read_b128 v[76:79], v4 offset:20736
    v_mfma_f32_16x16x32_bf16 v[16:19], a[40:43], v[120:123], v[16:19]
    v_mfma_f32_16x16x32_bf16 v[20:23], a[44:47], v[120:123], v[20:23]
    ds_read_b128 v[120:123], v4 offset:22528
    v_mfma_f32_16x16x32_bf16 v[28:31], a[44:47], v[124:127], v[28:31]
    v_mfma_f32_16x16x32_bf16 v[24:27], a[40:43], v[124:127], v[24:27]
    ds_read_b128 v[124:127], v4 offset:22784
    s_waitcnt lgkmcnt(8)
    v_mfma_f32_16x16x32_bf16 v[16:19], a[48:51], v[32:35], v[16:19]
    v_mfma_f32_16x16x32_bf16 v[20:23], a[52:55], v[32:35], v[20:23]
    ds_read_b128 v[32:35], v4 offset:24576
    v_mfma_f32_16x16x32_bf16 v[28:31], a[52:55], v[36:39], v[28:31]
    v_mfma_f32_16x16x32_bf16 v[24:27], a[48:51], v[36:39], v[24:27]
    ds_read_b128 v[36:39], v4 offset:24832
    v_mfma_f32_16x16x32_bf16 v[16:19], a[56:59], v[40:43], v[16:19]
    v_mfma_f32_16x16x32_bf16 v[20:23], a[60:63], v[40:43], v[20:23]
    ds_read_b128 v[40:43], v4 offset:26624
    v_mfma_f32_16x16x32_bf16 v[28:31], a[60:63], v[44:47], v[28:31]
    v_mfma_f32_16x16x32_bf16 v[24:27], a[56:59], v[44:47], v[24:27]
    ds_read_b128 v[44:47], v4 offset:26880
    s_waitcnt lgkmcnt(8)
    v_mfma_f32_16x16x32_bf16 v[16:19], a[64:67], v[48:51], v[16:19]
    v_mfma_f32_16x16x32_bf16 v[20:23], a[68:71], v[48:51], v[20:23]
    ds_read_b128 v[48:51], v4 offset:28672
    v_mfma_f32_16x16x32_bf16 v[28:31], a[68:71], v[52:55], v[28:31]
    v_mfma_f32_16x16x32_bf16 v[24:27], a[64:67], v[52:55], v[24:27]
    ds_read_b128 v[52:55], v4 offset:28928
    v_mfma_f32_16x16x32_bf16 v[16:19], a[72:75], v[56:59], v[16:19]
    v_mfma_f32_16x16x32_bf16 v[20:23], a[76:79], v[56:59], v[20:23]
    ds_read_b128 v[56:59], v4 offset:30720
    v_mfma_f32_16x16x32_bf16 v[28:31], a[76:79], v[60:63], v[28:31]
    v_mfma_f32_16x16x32_bf16 v[24:27], a[72:75], v[60:63], v[24:27]
    ds_read_b128 v[60:63], v4 offset:30976
    s_waitcnt lgkmcnt(8)
    v_mfma_f32_16x16x32_bf16 v[16:19], a[80:83], v[72:75], v[16:19]
    v_mfma_f32_16x16x32_bf16 v[20:23], a[84:87], v[72:75], v[20:23]
    v_mfma_f32_16x16x32_bf16 v[28:31], a[84:87], v[76:79], v[28:31]
    v_mfma_f32_16x16x32_bf16 v[24:27], a[80:83], v[76:79], v[24:27]
    v_mfma_f32_16x16x32_bf16 v[16:19], a[88:91], v[120:123], v[16:19]
    v_mfma_f32_16x16x32_bf16 v[20:23], a[92:95], v[120:123], v[20:23]
    v_mfma_f32_16x16x32_bf16 v[28:31], a[92:95], v[124:127], v[28:31]
    v_mfma_f32_16x16x32_bf16 v[24:27], a[88:91], v[124:127], v[24:27]
    s_waitcnt lgkmcnt(4)
    v_mfma_f32_16x16x32_bf16 v[16:19], a[96:99], v[32:35], v[16:19]
    v_mfma_f32_16x16x32_bf16 v[20:23], a[100:103], v[32:35], v[20:23]
    v_mfma_f32_16x16x32_bf16 v[28:31], a[100:103], v[36:39], v[28:31]
    v_mfma_f32_16x16x32_bf16 v[24:27], a[96:99], v[36:39], v[24:27]
    v_mfma_f32_16x16x32_bf16 v[16:19], a[104:107], v[40:43], v[16:19]
    v_mfma_f32_16x16x32_bf16 v[20:23], a[108:111], v[40:43], v[20:23]
    v_mfma_f32_16x16x32_bf16 v[28:31], a[108:111], v[44:47], v[28:31]
    v_mfma_f32_16x16x32_bf16 v[24:27], a[104:107], v[44:47], v[24:27]
    s_waitcnt lgkmcnt(0)
    v_mfma_f32_16x16x32_bf16 v[16:19], a[112:115], v[48:51], v[16:19]
    v_mfma_f32_16x16x32_bf16 v[20:23], a[116:119], v[48:51], v[20:23]
    v_mfma_f32_16x16x32_bf16 v[28:31], a[116:119], v[52:55], v[28:31]
    v_mfma_f32_16x16x32_bf16 v[24:27], a[112:115], v[52:55], v[24:27]
    v_mfma_f32_16x16x32_bf16 v[16:19], a[120:123], v[56:59], v[16:19]
    v_mfma_f32_16x16x32_bf16 v[20:23], a[124:127], v[56:59], v[20:23]
    v_mfma_f32_16x16x32_bf16 v[28:31], a[124:127], v[60:63], v[28:31]
    v_mfma_f32_16x16x32_bf16 v[24:27], a[120:123], v[60:63], v[24:27]
    v_xor_b32 v4, 0x10000, v4
    s_setprio 0
    s_waitcnt vmcnt(0)
    s_lshl_b32 s67, s67, 1
    s_or_b32 s67, s67, 1
    s_add_u32 s60, s60, 1
    s_cmp_gt_u32 s66, s60
    s_cbranch_scc1 L_g_loop1_54
    s_barrier
    ds_read_b32 v14, v15
    s_waitcnt lgkmcnt(0)
    v_readfirstlane_b32 s66, v14
    s_barrier
    s_mov_b32 s69, 0
    s_cmp_gt_u32 s62, s60
    s_cbranch_scc1 L_g_nd_86
    s_cmp_ge_u32 s62, s66
    s_cbranch_scc1 L_g_nd_86
    s_add_u32 s47, s61, 4096
    s_add_u32 m0, s64, 0
    s_nop 0
    buffer_load_dwordx4 v3, s[12:15], s61 offen offset:0 sc1 lds
    buffer_load_dwordx4 v3, s[12:15], s61 offen offset:1024 sc1 lds
    buffer_load_dwordx4 v3, s[12:15], s61 offen offset:2048 sc1 lds
    buffer_load_dwordx4 v3, s[12:15], s61 offen offset:3072 sc1 lds
    s_add_u32 m0, s64, 4096
    s_nop 0
    buffer_load_dwordx4 v3, s[12:15], s47 offen offset:0 sc1 lds
    buffer_load_dwordx4 v3, s[12:15], s47 offen offset:1024 sc1 lds
    buffer_load_dwordx4 v3, s[12:15], s47 offen offset:2048 sc1 lds
    buffer_load_dwordx4 v3, s[12:15], s47 offen offset:3072 sc1 lds
    s_add_u32 s61, s61, 65536
    s_add_u32 s62, s62, 1
    s_xor_b32 s64, s64, 0x10000
    s_mov_b32 s69, 1
L_g_nd_86:
    s_sub_u32 s59, s60, 1
    ds_read_b128 v[80:83], v5 offset:0
    ds_read_b128 v[84:87], v5 offset:1024
    ds_read_b128 v[88:91], v5 offset:2048
    ds_read_b128 v[92:95], v5 offset:3072
    s_nop 7
    s_waitcnt lgkmcnt(3)
    v_add_f32 v80, v80, v16
    v_add_f32 v81, v81, v17
    v_add_f32 v82, v82, v18
    v_add_f32 v83, v83, v19
    s_waitcnt lgkmcnt(2)
    v_add_f32 v84, v84, v20
    v_add_f32 v85, v85, v21
    v_add_f32 v86, v86, v22
    v_add_f32 v87, v87, v23
    s_waitcnt lgkmcnt(1)
    v_add_f32 v88, v88, v24
    v_add_f32 v89, v89, v25
    v_add_f32 v90, v90, v26
    v_add_f32 v91, v91, v27
    s_waitcnt lgkmcnt(0)
    v_add_f32 v92, v92, v28
    v_add_f32 v93, v93, v29
    v_add_f32 v94, v94, v30
    v_add_f32 v95, v95, v31
    v_cvt_pk_bf16_f32 v104, v80, v81
    v_cvt_pk_bf16_f32 v105, v82, v83
    v_cvt_pk_bf16_f32 v106, v84, v85
    v_cvt_pk_bf16_f32 v107, v86, v87
    buffer_store_dwordx4 v[104:107], v8, s[12:15], s63 offen sc1
    v_cvt_pk_bf16_f32 v108, v88, v89
    v_cvt_pk_bf16_f32 v109, v90, v91
    v_cvt_pk_bf16_f32 v110, v92, v93
    v_cvt_pk_bf16_f32 v111, v94, v95
    buffer_store_dwordx4 v[108:111], v9, s[12:15], s63 offen sc1
    s_add_u32 s63, s63, 786432
    s_cmp_eq_u32 s53, 0
    s_cbranch_scc1 L_g_pf_87
    buffer_store_dwordx4 v[116:119], v64, s[12:15], s58 offen sc1
    s_cmp_eq_u32 s53, 1
    s_cbranch_scc1 L_g_pf_87
    buffer_store_dwordx4 v[116:119], v65, s[12:15], s58 offen sc1
L_g_pf_87:
    s_add_u32 s58, s58, s73
    s_mov_b32 s67, 0
    s_mov_b32 s71, 1
    s_cmp_gt_u32 s66, s60
    s_cbranch_scc1 L_g_g1r_52
    v_mov_b32 v10, 1
    s_mov_b64 exec, 1
    s_waitcnt vmcnt(0)
    ds_add_rtn_u32 v10, v15, v10 offset:4
    s_waitcnt lgkmcnt(0)
    v_readfirstlane_b32 s46, v10
    s_mov_b64 exec, -1
    s_mov_b32 s71, 0
    s_sub_u32 s59, s60, 1
    s_cmp_lg_u32 s46, s68
    s_cbranch_scc1 L_g_df_88
    v_mov_b32 v10, s59
    v_add_u32 v10, 1, v10
    v_mov_b32 v11, 0
    s_mov_b64 exec, 1
    buffer_store_dword v10, v11, s[12:15], s52 offen sc1
    s_mov_b64 exec, -1
L_sf_89:
L_g_df_88:
    s_add_u32 s68, s68, 4
    s_cmp_gt_u32 s66, s60
    s_cbranch_scc1 L_g_g1r_52
L_g_tail_55:
    s_cmp_lt_u32 s60, s75
    s_cbranch_scc1 L_g_restart_50
    s_waitcnt vmcnt(0)
    s_barrier
    s_branch L_w_p2_11
L_w_p2_11:
    s_cmp_eq_u32 s53, 0
    s_cbranch_scc1 L_w_p2_11_m
    s_cmp_lg_u32 s44, 0
    s_cbranch_scc1 L_w_p2_11_h
    s_sub_u32 s52, s52, s76
    v_mov_b32 v10, 1
    v_mov_b32 v11, 131072
    s_mov_b64 exec, 1
    buffer_atomic_add v10, v11, s[12:15], s52 offen sc0
    s_waitcnt vmcnt(0)
    v_readfirstlane_b32 s46, v10
    s_mov_b64 exec, -1
    s_mov_b32 s47, 63
    s_nop 1
    s_cmp_eq_u32 s46, 0
    s_cbranch_scc1 L_w_p2_11_h
    v_mov_b32 v10, s47
    v_add_u32 v10, 1, v10
    v_mov_b32 v11, 0
    s_mov_b64 exec, 1
    buffer_store_dword v10, v11, s[12:15], s52 offen sc1
    s_mov_b64 exec, -1
L_sf_90:
L_w_p2_11_h:
    s_cmp_eq_u32 s76, 0
    s_cbranch_scc1 L_w_p2_11_m
    s_cmp_eq_u32 s79, 1
    s_cbranch_scc1 L_w_h_17
    s_mov_b32 s79, 1
    s_cmp_lt_u32 s77, 14
    s_cselect_b32 s53, 2, s53
    s_cselect_b32 s48, s48, 3
    s_branch L_w_h_17_n
L_w_p2_11_m:
    s_cmp_lt_u32 s48, 8
    s_cselect_b32 s75, 58, 58
    s_cmp_lt_u32 s48, 4
    s_cselect_b32 s75, 64, s75
L_w_p2_11_r:
    s_lshr_b32 s42, s40, 1
    s_and_b32 s43, s40, 1
    s_lshl_b32 s43, s43, 2
    s_and_b32 s46, s48, 3
    s_add_u32 s43, s43, s46
    s_cmp_lt_u32 s48, 4
    s_cbranch_scc1 L_w_wo_12
    s_cmp_lt_u32 s48, 8
    s_cbranch_scc1 L_w_f2_13
    s_cmp_lg_u32 s43, 7
    s_cbranch_scc1 L_w_f1_14
    s_mov_b32 s43, 2
    s_cmp_eq_u32 s76, 0
    s_cbranch_scc1 L_w_c_16
    s_mov_b32 s43, 7
    s_mov_b32 s78, 1
L_w_f1_14_t:
    s_cmp_lt_u32 s41, 8
    s_cselect_b32 s74, 58, 61
    s_cselect_b32 s75, 61, 64
    s_add_u32 s43, s43, s74
    s_cmp_lt_u32 s43, s75
    s_cbranch_scc1 L_w_h_17_f
    s_branch L_c_done_1
L_w_f1_14_d:
    s_cmp_eq_u32 s76, 0
    s_cbranch_scc1 L_c_done_1
    s_and_b32 s42, s49, 3
    s_lshr_b32 s43, s49, 2
    s_mov_b32 s78, 64
    s_branch L_w_f1_14_t
L_replica:
    s_setprio 0
    s_barrier
    s_and_b32 s48, s41, 7
    s_add_u32 s48, s48, 4
    s_cmp_lt_u32 s41, 8
    s_cselect_b32 s74, 58, 61
    s_cselect_b32 s75, 61, 64
    s_cselect_b32 s76, 1, 2
    s_cselect_b32 s46, 58, 61
    s_cselect_b32 s47, 61, 64
    s_mul_i32 s76, s76, 65536
    s_cmp_lt_u32 s48, 8
    s_cselect_b32 s74, s46, s74
    s_cselect_b32 s75, s47, s75
    s_branch L_w_p2_11_r
L_w_f1_14:
    s_load_dwordx2 s[4:5], s[0:1], 64
    s_load_dwordx2 s[6:7], s[0:1], 72
    s_and_b32 s50, s44, 3
    s_lshr_b32 s51, s44, 2
    s_waitcnt lgkmcnt(0)
    s_mov_b32 s24, s4
    s_and_b32 s25, s5, 0xffff
    s_mov_b32 s26, 0x700000
    s_mov_b32 s27, 0x00020000
    s_mul_i32 s49, s42, 7
    s_add_u32 s49, s49, s43
    v_lshrrev_b32 v3, 4, v1
    v_and_b32 v4, 15, v1
    v_lshlrev_b32 v5, 2, v3
    v_xor_b32 v4, v4, v5
    v_mul_u32_u24 v3, 7168, v3
    v_lshl_add_u32 v3, v4, 4, v3
    s_mul_i32 s46, s51, 512
    s_mul_i32 s47, s50, 64
    s_add_u32 s46, s46, s47
    s_mul_i32 s46, s46, 7168
    s_lshl_b32 s47, s49, 8
    s_add_u32 s46, s46, s47
    s_lshl_b32 s45, s51, 16
    s_mul_i32 s47, s50, 16384
    s_add_u32 s45, s45, s47
    v_bfe_u32 v4, v1, 2, 2
    v_bfe_u32 v5, v1, 4, 1
    v_lshlrev_b32 v5, 1, v5
    v_bfe_u32 v6, v1, 1, 1
    v_add_u32 v5, v5, v6
    s_lshl_b32 s47, s50, 2
    v_add_u32 v5, s47, v5
    v_lshlrev_b32 v6, 2, v4
    v_xor_b32 v5, v5, v6
    v_lshlrev_b32 v5, 4, v5
    v_lshl_add_u32 v5, v4, 8, v5
    v_bfe_u32 v6, v1, 0, 1
    v_lshl_add_u32 v5, v6, 3, v5
    v_lshrrev_b32 v6, 5, v1
    v_mul_u32_u24 v6, 2048, v6
    v_add_u32 v5, v5, v6
    s_lshl_b32 s47, s51, 16
    v_add_u32 v5, s47, v5
    s_add_u32 m0, s45, 0
    s_add_u32 s47, s46, 0x0
    buffer_load_dwordx4 v3, s[24:27], s47 offen lds
    s_add_u32 m0, s45, 1024
    s_add_u32 s47, s46, 0x7000
    buffer_load_dwordx4 v3, s[24:27], s47 offen lds
    s_add_u32 m0, s45, 2048
    s_add_u32 s47, s46, 0xe000
    buffer_load_dwordx4 v3, s[24:27], s47 offen lds
    s_add_u32 m0, s45, 3072
    s_add_u32 s47, s46, 0x15000
    buffer_load_dwordx4 v3, s[24:27], s47 offen lds
    s_add_u32 m0, s45, 4096
    s_add_u32 s47, s46, 0x1c000
    buffer_load_dwordx4 v3, s[24:27], s47 offen lds
    s_add_u32 m0, s45, 5120
    s_add_u32 s47, s46, 0x23000
    buffer_load_dwordx4 v3, s[24:27], s47 offen lds
    s_add_u32 m0, s45, 6144
    s_add_u32 s47, s46, 0x2a000
    buffer_load_dwordx4 v3, s[24:27], s47 offen lds
    s_add_u32 m0, s45, 7168
    s_add_u32 s47, s46, 0x31000
    buffer_load_dwordx4 v3, s[24:27], s47 offen lds
    s_add_u32 m0, s45, 8192
    s_add_u32 s47, s46, 0x38000
    buffer_load_dwordx4 v3, s[24:27], s47 offen lds
    s_add_u32 m0, s45, 9216
    s_add_u32 s47, s46, 0x3f000
    buffer_load_dwordx4 v3, s[24:27], s47 offen lds
    s_add_u32 m0, s45, 10240
    s_add_u32 s47, s46, 0x46000
    buffer_load_dwordx4 v3, s[24:27], s47 offen lds
    s_add_u32 m0, s45, 11264
    s_add_u32 s47, s46, 0x4d000
    buffer_load_dwordx4 v3, s[24:27], s47 offen lds
    s_add_u32 m0, s45, 12288
    s_add_u32 s47, s46, 0x54000
    buffer_load_dwordx4 v3, s[24:27], s47 offen lds
    s_add_u32 m0, s45, 13312
    s_add_u32 s47, s46, 0x5b000
    buffer_load_dwordx4 v3, s[24:27], s47 offen lds
    s_add_u32 m0, s45, 14336
    s_add_u32 s47, s46, 0x62000
    buffer_load_dwordx4 v3, s[24:27], s47 offen lds
    s_add_u32 m0, s45, 15360
    s_add_u32 s47, s46, 0x69000
    buffer_load_dwordx4 v3, s[24:27], s47 offen lds
    s_waitcnt vmcnt(0)
    s_barrier
    ds_read_b64_tr_b16 a[0:1], v5 offset:0
    ds_read_b64_tr_b16 a[2:3], v5 offset:1024
    ds_read_b64_tr_b16 a[4:5], v5 offset:4096
    ds_read_b64_tr_b16 a[6:7], v5 offset:5120
    ds_read_b64_tr_b16 a[8:9], v5 offset:8192
    ds_read_b64_tr_b16 a[10:11], v5 offset:9216
    ds_read_b64_tr_b16 a[12:13], v5 offset:12288
    ds_read_b64_tr_b16 a[14:15], v5 offset:13312
    s_waitcnt lgkmcnt(0)
    ds_read_b64_tr_b16 a[16:17], v5 offset:16384
    ds_read_b64_tr_b16 a[18:19], v5 offset:17408
    ds_read_b64_tr_b16 a[20:21], v5 offset:20480
    ds_read_b64_tr_b16 a[22:23], v5 offset:21504
    ds_read_b64_tr_b16 a[24:25], v5 offset:24576
    ds_read_b64_tr_b16 a[26:27], v5 offset:25600
    ds_read_b64_tr_b16 a[28:29], v5 offset:28672
    ds_read_b64_tr_b16 a[30:31], v5 offset:29696
    s_waitcnt lgkmcnt(0)
    ds_read_b64_tr_b16 a[32:33], v5 offset:32768
    ds_read_b64_tr_b16 a[34:35], v5 offset:33792
    ds_read_b64_tr_b16 a[36:37], v5 offset:36864
    ds_read_b64_tr_b16 a[38:39], v5 offset:37888
    ds_read_b64_tr_b16 a[40:41], v5 offset:40960
    ds_read_b64_tr_b16 a[42:43], v5 offset:41984
    ds_read_b64_tr_b16 a[44:45], v5 offset:45056
    ds_read_b64_tr_b16 a[46:47], v5 offset:46080
    s_waitcnt lgkmcnt(0)
    ds_read_b64_tr_b16 a[48:49], v5 offset:49152
    ds_read_b64_tr_b16 a[50:51], v5 offset:50176
    ds_read_b64_tr_b16 a[52:53], v5 offset:53248
    ds_read_b64_tr_b16 a[54:55], v5 offset:54272
    ds_read_b64_tr_b16 a[56:57], v5 offset:57344
    ds_read_b64_tr_b16 a[58:59], v5 offset:58368
    ds_read_b64_tr_b16 a[60:61], v5 offset:61440
    ds_read_b64_tr_b16 a[62:63], v5 offset:62464
    s_waitcnt lgkmcnt(0)
    s_waitcnt lgkmcnt(0)
    s_barrier
    s_add_u32 m0, s45, 0
    s_add_u32 s47, s46, 0x1c0000
    buffer_load_dwordx4 v3, s[24:27], s47 offen lds
    s_add_u32 m0, s45, 1024
    s_add_u32 s47, s46, 0x1c7000
    buffer_load_dwordx4 v3, s[24:27], s47 offen lds
    s_add_u32 m0, s45, 2048
    s_add_u32 s47, s46, 0x1ce000
    buffer_load_dwordx4 v3, s[24:27], s47 offen lds
    s_add_u32 m0, s45, 3072
    s_add_u32 s47, s46, 0x1d5000
    buffer_load_dwordx4 v3, s[24:27], s47 offen lds
    s_add_u32 m0, s45, 4096
    s_add_u32 s47, s46, 0x1dc000
    buffer_load_dwordx4 v3, s[24:27], s47 offen lds
    s_add_u32 m0, s45, 5120
    s_add_u32 s47, s46, 0x1e3000
    buffer_load_dwordx4 v3, s[24:27], s47 offen lds
    s_add_u32 m0, s45, 6144
    s_add_u32 s47, s46, 0x1ea000
    buffer_load_dwordx4 v3, s[24:27], s47 offen lds
    s_add_u32 m0, s45, 7168
    s_add_u32 s47, s46, 0x1f1000
    buffer_load_dwordx4 v3, s[24:27], s47 offen lds
    s_add_u32 m0, s45, 8192
    s_add_u32 s47, s46, 0x1f8000
    buffer_load_dwordx4 v3, s[24:27], s47 offen lds
    s_add_u32 m0, s45, 9216
    s_add_u32 s47, s46, 0x1ff000
    buffer_load_dwordx4 v3, s[24:27], s47 offen lds
    s_add_u32 m0, s45, 10240
    s_add_u32 s47, s46, 0x206000
    buffer_load_dwordx4 v3, s[24:27], s47 offen lds
    s_add_u32 m0, s45, 11264
    s_add_u32 s47, s46, 0x20d000
    buffer_load_dwordx4 v3, s[24:27], s47 offen lds
    s_add_u32 m0, s45, 12288
    s_add_u32 s47, s46, 0x214000
    buffer_load_dwordx4 v3, s[24:27], s47 offen lds
    s_add_u32 m0, s45, 13312
    s_add_u32 s47, s46, 0x21b000
    buffer_load_dwordx4 v3, s[24:27], s47 offen lds
    s_add_u32 m0, s45, 14336
    s_add_u32 s47, s46, 0x222000
    buffer_load_dwordx4 v3, s[24:27], s47 offen lds
    s_add_u32 m0, s45, 15360
    s_add_u32 s47, s46, 0x229000
    buffer_load_dwordx4 v3, s[24:27], s47 offen lds
    s_waitcnt vmcnt(0)
    s_barrier
    ds_read_b64_tr_b16 a[64:65], v5 offset:0
    ds_read_b64_tr_b16 a[66:67], v5 offset:1024
    ds_read_b64_tr_b16 a[68:69], v5 offset:4096
    ds_read_b64_tr_b16 a[70:71], v5 offset:5120
    ds_read_b64_tr_b16 a[72:73], v5 offset:8192
    ds_read_b64_tr_b16 a[74:75], v5 offset:9216
    ds_read_b64_tr_b16 a[76:77], v5 offset:12288
    ds_read_b64_tr_b16 a[78:79], v5 offset:13312
    s_waitcnt lgkmcnt(0)
    ds_read_b64_tr_b16 a[80:81], v5 offset:16384
    ds_read_b64_tr_b16 a[82:83], v5 offset:17408
    ds_read_b64_tr_b16 a[84:85], v5 offset:20480
    ds_read_b64_tr_b16 a[86:87], v5 offset:21504
    ds_read_b64_tr_b16 a[88:89], v5 offset:24576
    ds_read_b64_tr_b16 a[90:91], v5 offset:25600
    ds_read_b64_tr_b16 a[92:93], v5 offset:28672
    ds_read_b64_tr_b16 a[94:95], v5 offset:29696
    s_waitcnt lgkmcnt(0)
    ds_read_b64_tr_b16 a[96:97], v5 offset:32768
    ds_read_b64_tr_b16 a[98:99], v5 offset:33792
    ds_read_b64_tr_b16 a[100:101], v5 offset:36864
    ds_read_b64_tr_b16 a[102:103], v5 offset:37888
    ds_read_b64_tr_b16 a[104:105], v5 offset:40960
    ds_read_b64_tr_b16 a[106:107], v5 offset:41984
    ds_read_b64_tr_b16 a[108:109], v5 offset:45056
    ds_read_b64_tr_b16 a[110:111], v5 offset:46080
    s_waitcnt lgkmcnt(0)
    ds_read_b64_tr_b16 a[112:113], v5 offset:49152
    ds_read_b64_tr_b16 a[114:115], v5 offset:50176
    ds_read_b64_tr_b16 a[116:117], v5 offset:53248
    ds_read_b64_tr_b16 a[118:119], v5 offset:54272
    ds_read_b64_tr_b16 a[120:121], v5 offset:57344
    ds_read_b64_tr_b16 a[122:123], v5 offset:58368
    ds_read_b64_tr_b16 a[124:125], v5 offset:61440
    ds_read_b64_tr_b16 a[126:127], v5 offset:62464
    s_waitcnt lgkmcnt(0)
    s_waitcnt lgkmcnt(0)
    s_barrier
    v_lshlrev_b32 v2, 4, v1
    s_mul_i32 s64, s44, 8192
    s_add_u32 s46, s64, 0xc00000
    v_add_u32 v3, s46, v2
    s_mul_i32 s46, s51, 32768
    v_add_u32 v4, s46, v2
    v_and_b32 v6, 15, v1
    v_lshlrev_b32 v6, 4, v6
    v_lshrrev_b32 v7, 4, v1
    v_lshl_add_u32 v6, v7, 9, v6
    s_lshl_b32 s46, s50, 12
    s_add_u32 s46, s46, 131072
    v_add_u32 v5, s46, v2
    v_and_b32 v7, 3, v1
    v_lshlrev_b32 v7, 7, v7
    v_add_u32 v7, 0x10ec00, v7
    s_lshl_b32 s46, s49, 13
    s_lshl_b32 s47, s50, 11
    s_add_u32 s46, s46, s47
    s_add_u32 s46, s46, 0x6000000
    v_add_u32 v8, s46, v2
    s_lshl_b32 s52, s49, 7
    s_add_u32 s52, s52, 0x106400
    s_add_u32 s52, s52, s76
    s_mov_b32 s28, s6
    s_and_b32 s29, s7, 0xffff
    s_mov_b32 s30, 0x1c00
    s_mov_b32 s31, 0x00020000
    s_lshl_b32 s46, s49, 8
    s_lshl_b32 s47, s50, 6
    s_add_u32 s46, s46, s47
    v_lshrrev_b32 v9, 5, v1
    v_lshlrev_b32 v9, 3, v9
    buffer_load_dwordx2 v[32:33], v9, s[28:31], s46 offen offset:0
    buffer_load_dwordx2 v[34:35], v9, s[28:31], s46 offen offset:16
    buffer_load_dwordx2 v[36:37], v9, s[28:31], s46 offen offset:32
    buffer_load_dwordx2 v[38:39], v9, s[28:31], s46 offen offset:48
    v_add_u32 v9, 1024, v8
    s_mov_b32 s56, 0xbdd2d3e8
    s_mov_b32 s57, 0xbdd2d3e8
    v_mov_b32 v112, 0xc0135761
    v_mov_b32 v113, 0xc0135761
    s_waitcnt vmcnt(0)
    v_lshlrev_b32 v64, 16, v32
    v_and_b32 v65, 0xffff0000, v32
    v_lshlrev_b32 v66, 16, v33
    v_and_b32 v67, 0xffff0000, v33
    v_lshlrev_b32 v68, 16, v34
    v_and_b32 v69, 0xffff0000, v34
    v_lshlrev_b32 v70, 16, v35
    v_and_b32 v71, 0xffff0000, v35
    v_lshlrev_b32 v72, 16, v36
    v_and_b32 v73, 0xffff0000, v36
    v_lshlrev_b32 v74, 16, v37
    v_and_b32 v75, 0xffff0000, v37
    v_lshlrev_b32 v76, 16, v38
    v_and_b32 v77, 0xffff0000, v38
    v_lshlrev_b32 v78, 16, v39
    v_and_b32 v79, 0xffff0000, v39
    s_mov_b32 s60, s74
    s_mul_i32 s61, s74, 65536
    s_mov_b32 s62, s74
    s_mul_i32 s63, s74, 229376
    s_mov_b32 s67, 0
    s_mov_b32 s68, 3
    s_mov_b32 s71, 0
    v_mov_b32 v15, 147456
    v_mov_b32 v14, 0
    ds_write_b32 v15, v14 offset:4
    ds_write_b32 v15, v14 offset:12
    ds_write_b32 v15, v14 offset:16
    v_mov_b32 v114, 1
    s_mov_b32 s72, 0
L_g_restart_91:
    s_cmp_lg_u32 s44, 0
    s_cbranch_scc1 L_g_nsp_92
    s_mov_b32 s70, 0
L_g_sp_98:
    s_add_u32 s54, s60, 0
    s_add_u32 s55, s54, 0
    s_mul_i32 s46, s55, 171
    s_lshr_b32 s46, s46, 9
    s_mul_i32 s46, s46, 3
    s_sub_u32 s46, s55, s46
    s_lshl_b32 s46, s46, 9
    buffer_load_dword v11, v7, s[12:15], s46 offen sc1
    s_add_u32 s55, s54, 1
    s_mul_i32 s46, s55, 171
    s_lshr_b32 s46, s46, 9
    s_mul_i32 s46, s46, 3
    s_sub_u32 s46, s55, s46
    s_lshl_b32 s46, s46, 9
    buffer_load_dword v12, v7, s[12:15], s46 offen sc1
    s_add_u32 s55, s54, 2
    s_mul_i32 s46, s55, 171
    s_lshr_b32 s46, s46, 9
    s_mul_i32 s46, s46, 3
    s_sub_u32 s46, s55, s46
    s_lshl_b32 s46, s46, 9
    buffer_load_dword v13, v7, s[12:15], s46 offen sc1
    s_waitcnt vmcnt(0)
    v_cmp_ge_u32 vcc, s60, v11
    s_add_u32 s70, s70, 1
    s_cbranch_vccz L_g_sp_98_ok
    s_sleep 3
    s_cmp_lt_u32 s70, 524288
    s_cbranch_scc1 L_g_sp_98
    s_branch L_c_done_1
L_g_sp_98_ok:
    s_mov_b32 s46, s54
    v_cmp_ge_u32 vcc, s46, v11
    s_nop 0
    s_cbranch_vccnz L_g_le_99
    s_add_u32 s46, s46, 1
    v_cmp_ge_u32 vcc, s46, v12
    s_nop 0
    s_cbranch_vccnz L_g_le_99
    s_add_u32 s46, s46, 1
    v_cmp_ge_u32 vcc, s46, v13
    s_nop 0
    s_cbranch_vccnz L_g_le_99
    s_add_u32 s46, s46, 1
L_g_le_99:
    s_min_u32 s46, s46, s75
    v_mov_b32 v11, s46
    ds_write_b32 v15, v11
L_g_nsp_92:
    s_waitcnt lgkmcnt(0)
    s_barrier
    ds_read_b32 v14, v15
    s_waitcnt lgkmcnt(0)
    v_readfirstlane_b32 s66, v14
    s_nop 3
L_g_restart_91_go:
    s_mov_b32 s69, 0
    s_cmp_gt_u32 s62, s60
    s_cbranch_scc1 L_g_nd_100
    s_cmp_ge_u32 s62, s66
    s_cbranch_scc1 L_g_nd_100
    s_add_u32 s47, s61, 4096
    s_add_u32 m0, s64, 0
    s_nop 0
    buffer_load_dwordx4 v3, s[12:15], s61 offen offset:0 sc1 lds
    buffer_load_dwordx4 v3, s[12:15], s61 offen offset:1024 sc1 lds
    buffer_load_dwordx4 v3, s[12:15], s61 offen offset:2048 sc1 lds
    buffer_load_dwordx4 v3, s[12:15], s61 offen offset:3072 sc1 lds
    s_add_u32 m0, s64, 4096
    s_nop 0
    buffer_load_dwordx4 v3, s[12:15], s47 offen offset:0 sc1 lds
    buffer_load_dwordx4 v3, s[12:15], s47 offen offset:1024 sc1 lds
    buffer_load_dwordx4 v3, s[12:15], s47 offen offset:2048 sc1 lds
    buffer_load_dwordx4 v3, s[12:15], s47 offen offset:3072 sc1 lds
    s_add_u32 s61, s61, 65536
    s_add_u32 s62, s62, 1
    s_xor_b32 s64, s64, 0x10000
    s_mov_b32 s69, 1
L_g_nd_100:
    s_cmp_eq_u32 s51, 1
    s_cbranch_scc1 L_g_g1r_93
    s_add_u32 s59, s60, 1
    s_mov_b32 s69, 0
    s_cmp_gt_u32 s62, s59
    s_cbranch_scc1 L_g_nd_101
    s_cmp_ge_u32 s62, s66
    s_cbranch_scc1 L_g_nd_101
    s_add_u32 s47, s61, 4096
    s_add_u32 m0, s64, 0
    s_nop 0
    buffer_load_dwordx4 v3, s[12:15], s61 offen offset:0 sc1 lds
    buffer_load_dwordx4 v3, s[12:15], s61 offen offset:1024 sc1 lds
    buffer_load_dwordx4 v3, s[12:15], s61 offen offset:2048 sc1 lds
    buffer_load_dwordx4 v3, s[12:15], s61 offen offset:3072 sc1 lds
    s_add_u32 m0, s64, 4096
    s_nop 0
    buffer_load_dwordx4 v3, s[12:15], s47 offen offset:0 sc1 lds
    buffer_load_dwordx4 v3, s[12:15], s47 offen offset:1024 sc1 lds
    buffer_load_dwordx4 v3, s[12:15], s47 offen offset:2048 sc1 lds
    buffer_load_dwordx4 v3, s[12:15], s47 offen offset:3072 sc1 lds
    s_add_u32 s61, s61, 65536
    s_add_u32 s62, s62, 1
    s_xor_b32 s64, s64, 0x10000
    s_mov_b32 s69, 1
L_g_nd_101:
    s_cmp_eq_u32 s69, 1
    s_cbranch_scc1 L_g_w0_102
    s_waitcnt vmcnt(0)
L_g_w0_102:
    s_waitcnt vmcnt(8)
    s_mov_b32 s65, 1
.p2align 6
L_g_loop0_94:
    s_barrier
    s_cmp_eq_u32 s65, 0
    s_cbranch_scc1 L_g_pr_103
    ds_read_b128 v[32:35], v4 offset:0
    ds_read_b128 v[36:39], v4 offset:1024
    ds_read_b128 v[40:43], v4 offset:2048
    ds_read_b128 v[44:47], v4 offset:3072
    ds_read_b128 v[48:51], v4 offset:4096
    ds_read_b128 v[52:55], v4 offset:5120
    ds_read_b128 v[56:59], v4 offset:6144
    ds_read_b128 v[60:63], v4 offset:7168
L_g_pr_103:
    ds_read_b32 v14, v15
    s_cmp_lg_u32 s44, 0
    s_cbranch_scc1 L_g_nl_104
    s_add_u32 s54, s60, 1
    s_add_u32 s55, s54, 0
    s_mul_i32 s46, s55, 171
    s_lshr_b32 s46, s46, 9
    s_mul_i32 s46, s46, 3
    s_sub_u32 s46, s55, s46
    s_lshl_b32 s46, s46, 9
    buffer_load_dword v11, v7, s[12:15], s46 offen sc1
    s_add_u32 s55, s54, 1
    s_mul_i32 s46, s55, 171
    s_lshr_b32 s46, s46, 9
    s_mul_i32 s46, s46, 3
    s_sub_u32 s46, s55, s46
    s_lshl_b32 s46, s46, 9
    buffer_load_dword v12, v7, s[12:15], s46 offen sc1
    s_add_u32 s55, s54, 2
    s_mul_i32 s46, s55, 171
    s_lshr_b32 s46, s46, 9
    s_mul_i32 s46, s46, 3
    s_sub_u32 s46, s55, s46
    s_lshl_b32 s46, s46, 9
    buffer_load_dword v13, v7, s[12:15], s46 offen sc1
L_g_nl_104:
    s_setprio 2
    s_waitcnt lgkmcnt(6)
    v_mfma_f32_32x32x16_bf16 v[16:31], a[0:3], v[32:35], v[64:79]
    ds_read_b128 v[32:35], v4 offset:8192
    v_mfma_f32_32x32x16_bf16 v[16:31], a[4:7], v[36:39], v[16:31]
    ds_read_b128 v[36:39], v4 offset:9216
    s_waitcnt lgkmcnt(6)
    v_mfma_f32_32x32x16_bf16 v[16:31], a[8:11], v[40:43], v[16:31]
    ds_read_b128 v[40:43], v4 offset:10240
    v_mfma_f32_32x32x16_bf16 v[16:31], a[12:15], v[44:47], v[16:31]
    ds_read_b128 v[44:47], v4 offset:11264
    s_waitcnt lgkmcnt(6)
    v_mfma_f32_32x32x16_bf16 v[16:31], a[16:19], v[48:51], v[16:31]
    ds_read_b128 v[48:51], v4 offset:12288
    v_mfma_f32_32x32x16_bf16 v[16:31], a[20:23], v[52:55], v[16:31]
    ds_read_b128 v[52:55], v4 offset:13312
    s_waitcnt lgkmcnt(6)
    v_mfma_f32_32x32x16_bf16 v[16:31], a[24:27], v[56:59], v[16:31]
    ds_read_b128 v[56:59], v4 offset:14336
    v_mfma_f32_32x32x16_bf16 v[16:31], a[28:31], v[60:63], v[16:31]
    ds_read_b128 v[60:63], v4 offset:15360
    s_waitcnt lgkmcnt(6)
    v_mfma_f32_32x32x16_bf16 v[16:31], a[32:35], v[32:35], v[16:31]
    ds_read_b128 v[32:35], v4 offset:16384
    v_mfma_f32_32x32x16_bf16 v[16:31], a[36:39], v[36:39], v[16:31]
    ds_read_b128 v[36:39], v4 offset:17408
    s_waitcnt lgkmcnt(6)
    v_mfma_f32_32x32x16_bf16 v[16:31], a[40:43], v[40:43], v[16:31]
    ds_read_b128 v[40:43], v4 offset:18432
    v_mfma_f32_32x32x16_bf16 v[16:31], a[44:47], v[44:47], v[16:31]
    ds_read_b128 v[44:47], v4 offset:19456
    s_waitcnt lgkmcnt(6)
    v_mfma_f32_32x32x16_bf16 v[16:31], a[48:51], v[48:51], v[16:31]
    ds_read_b128 v[48:51], v4 offset:20480
    v_mfma_f32_32x32x16_bf16 v[16:31], a[52:55], v[52:55], v[16:31]
    ds_read_b128 v[52:55], v4 offset:21504
    s_waitcnt lgkmcnt(6)
    v_mfma_f32_32x32x16_bf16 v[16:31], a[56:59], v[56:59], v[16:31]
    ds_read_b128 v[56:59], v4 offset:22528
    v_mfma_f32_32x32x16_bf16 v[16:31], a[60:63], v[60:63], v[16:31]
    ds_read_b128 v[60:63], v4 offset:23552
    s_waitcnt lgkmcnt(6)
    v_mfma_f32_32x32x16_bf16 v[16:31], a[64:67], v[32:35], v[16:31]
    ds_read_b128 v[32:35], v4 offset:24576
    v_mfma_f32_32x32x16_bf16 v[16:31], a[68:71], v[36:39], v[16:31]
    ds_read_b128 v[36:39], v4 offset:25600
    s_waitcnt lgkmcnt(6)
    v_mfma_f32_32x32x16_bf16 v[16:31], a[72:75], v[40:43], v[16:31]
    ds_read_b128 v[40:43], v4 offset:26624
    v_mfma_f32_32x32x16_bf16 v[16:31], a[76:79], v[44:47], v[16:31]
    ds_read_b128 v[44:47], v4 offset:27648
    s_waitcnt lgkmcnt(6)
    v_mfma_f32_32x32x16_bf16 v[16:31], a[80:83], v[48:51], v[16:31]
    ds_read_b128 v[48:51], v4 offset:28672
    v_mfma_f32_32x32x16_bf16 v[16:31], a[84:87], v[52:55], v[16:31]
    ds_read_b128 v[52:55], v4 offset:29696
    s_waitcnt lgkmcnt(6)
    v_mfma_f32_32x32x16_bf16 v[16:31], a[88:91], v[56:59], v[16:31]
    ds_read_b128 v[56:59], v4 offset:30720
    v_mfma_f32_32x32x16_bf16 v[16:31], a[92:95], v[60:63], v[16:31]
    ds_read_b128 v[60:63], v4 offset:31744
    s_waitcnt lgkmcnt(6)
    v_mfma_f32_32x32x16_bf16 v[16:31], a[96:99], v[32:35], v[16:31]
    v_mfma_f32_32x32x16_bf16 v[16:31], a[100:103], v[36:39], v[16:31]
    s_waitcnt lgkmcnt(4)
    v_mfma_f32_32x32x16_bf16 v[16:31], a[104:107], v[40:43], v[16:31]
    v_mfma_f32_32x32x16_bf16 v[16:31], a[108:111], v[44:47], v[16:31]
    s_waitcnt lgkmcnt(2)
    v_mfma_f32_32x32x16_bf16 v[16:31], a[112:115], v[48:51], v[16:31]
    v_mfma_f32_32x32x16_bf16 v[16:31], a[116:119], v[52:55], v[16:31]
    s_waitcnt lgkmcnt(0)
    v_mfma_f32_32x32x16_bf16 v[16:31], a[120:123], v[56:59], v[16:31]
    v_mfma_f32_32x32x16_bf16 v[16:31], a[124:127], v[60:63], v[16:31]
    v_xor_b32 v4, 0x10000, v4
    s_setprio 0
    s_waitcnt vmcnt(0)
    v_readfirstlane_b32 s66, v14
    s_barrier
    s_nop 6
    ds_write_b128 v5, v[16:19] offset:0
    ds_write_b128 v5, v[20:23] offset:1024
    ds_write_b128 v5, v[24:27] offset:2048
    ds_write_b128 v5, v[28:31] offset:3072
    s_cmp_lg_u32 s44, 0
    s_cbranch_scc1 L_g_ne_105
    s_mov_b32 s46, s54
    v_cmp_ge_u32 vcc, s46, v11
    s_nop 0
    s_cbranch_vccnz L_g_le_108
    s_add_u32 s46, s46, 1
    v_cmp_ge_u32 vcc, s46, v12
    s_nop 0
    s_cbranch_vccnz L_g_le_108
    s_add_u32 s46, s46, 1
    v_cmp_ge_u32 vcc, s46, v13
    s_nop 0
    s_cbranch_vccnz L_g_le_108
    s_add_u32 s46, s46, 1
L_g_le_108:
    s_min_u32 s46, s46, s75
    v_mov_b32 v11, s46
    ds_write_b32 v15, v11
L_g_ne_105:
    s_add_u32 s60, s60, 1
    s_mov_b32 s69, 0
    s_cmp_gt_u32 s62, s60
    s_cbranch_scc1 L_g_nd_109
    s_cmp_ge_u32 s62, s66
    s_cbranch_scc1 L_g_nd_109
    s_add_u32 s47, s61, 4096
    s_add_u32 m0, s64, 0
    s_nop 0
    buffer_load_dwordx4 v3, s[12:15], s61 offen offset:0 sc1 lds
    buffer_load_dwordx4 v3, s[12:15], s61 offen offset:1024 sc1 lds
    buffer_load_dwordx4 v3, s[12:15], s61 offen offset:2048 sc1 lds
    buffer_load_dwordx4 v3, s[12:15], s61 offen offset:3072 sc1 lds
    s_add_u32 m0, s64, 4096
    s_nop 0
    buffer_load_dwordx4 v3, s[12:15], s47 offen offset:0 sc1 lds
    buffer_load_dwordx4 v3, s[12:15], s47 offen offset:1024 sc1 lds
    buffer_load_dwordx4 v3, s[12:15], s47 offen offset:2048 sc1 lds
    buffer_load_dwordx4 v3, s[12:15], s47 offen offset:3072 sc1 lds
    s_add_u32 s61, s61, 65536
    s_add_u32 s62, s62, 1
    s_xor_b32 s64, s64, 0x10000
    s_mov_b32 s69, 1
L_g_nd_109:
    s_mov_b32 s65, s69
    s_add_u32 s59, s60, 1
    s_mov_b32 s69, 0
    s_cmp_gt_u32 s62, s59
    s_cbranch_scc1 L_g_nd_110
    s_cmp_ge_u32 s62, s66
    s_cbranch_scc1 L_g_nd_110
    s_add_u32 s47, s61, 4096
    s_add_u32 m0, s64, 0
    s_nop 0
    buffer_load_dwordx4 v3, s[12:15], s61 offen offset:0 sc1 lds
    buffer_load_dwordx4 v3, s[12:15], s61 offen offset:1024 sc1 lds
    buffer_load_dwordx4 v3, s[12:15], s61 offen offset:2048 sc1 lds
    buffer_load_dwordx4 v3, s[12:15], s61 offen offset:3072 sc1 lds
    s_add_u32 m0, s64, 4096
    s_nop 0
    buffer_load_dwordx4 v3, s[12:15], s47 offen offset:0 sc1 lds
    buffer_load_dwordx4 v3, s[12:15], s47 offen offset:1024 sc1 lds
    buffer_load_dwordx4 v3, s[12:15], s47 offen offset:2048 sc1 lds
    buffer_load_dwordx4 v3, s[12:15], s47 offen offset:3072 sc1 lds
    s_add_u32 s61, s61, 65536
    s_add_u32 s62, s62, 1
    s_xor_b32 s64, s64, 0x10000
    s_mov_b32 s69, 1
L_g_nd_110:
    s_cmp_le_u32 s66, s60
    s_cbranch_scc1 L_g_ex0_107
    s_cmp_eq_u32 s65, 0
    s_cbranch_scc1 L_g_nw_106
    s_waitcnt vmcnt(0) lgkmcnt(0)
    s_branch L_g_loop0_94
L_g_nw_106:
    ds_read_b128 v[32:35], v4 offset:0
    ds_read_b128 v[36:39], v4 offset:1024
    ds_read_b128 v[40:43], v4 offset:2048
    ds_read_b128 v[44:47], v4 offset:3072
    ds_read_b128 v[48:51], v4 offset:4096
    ds_read_b128 v[52:55], v4 offset:5120
    ds_read_b128 v[56:59], v4 offset:6144
    ds_read_b128 v[60:63], v4 offset:7168
    s_waitcnt lgkmcnt(8)
    s_branch L_g_loop0_94
L_g_ex0_107:
    s_cmp_lg_u32 s44, 0
    s_cbranch_scc1 L_g_ex0_107_n
    s_sleep 6
    s_add_u32 s54, s60, 0
    s_add_u32 s55, s54, 0
    s_mul_i32 s46, s55, 171
    s_lshr_b32 s46, s46, 9
    s_mul_i32 s46, s46, 3
    s_sub_u32 s46, s55, s46
    s_lshl_b32 s46, s46, 9
    buffer_load_dword v11, v7, s[12:15], s46 offen sc1
    s_add_u32 s55, s54, 1
    s_mul_i32 s46, s55, 171
    s_lshr_b32 s46, s46, 9
    s_mul_i32 s46, s46, 3
    s_sub_u32 s46, s55, s46
    s_lshl_b32 s46, s46, 9
    buffer_load_dword v12, v7, s[12:15], s46 offen sc1
    s_add_u32 s55, s54, 2
    s_mul_i32 s46, s55, 171
    s_lshr_b32 s46, s46, 9
    s_mul_i32 s46, s46, 3
    s_sub_u32 s46, s55, s46
    s_lshl_b32 s46, s46, 9
    buffer_load_dword v13, v7, s[12:15], s46 offen sc1
    s_waitcnt vmcnt(0)
    s_mov_b32 s46, s54
    v_cmp_ge_u32 vcc, s46, v11
    s_nop 0
    s_cbranch_vccnz L_g_le_111
    s_add_u32 s46, s46, 1
    v_cmp_ge_u32 vcc, s46, v12
    s_nop 0
    s_cbranch_vccnz L_g_le_111
    s_add_u32 s46, s46, 1
    v_cmp_ge_u32 vcc, s46, v13
    s_nop 0
    s_cbranch_vccnz L_g_le_111
    s_add_u32 s46, s46, 1
L_g_le_111:
    s_min_u32 s46, s46, s75
    v_mov_b32 v11, s46
    ds_write_b32 v15, v11
L_g_ex0_107_n:
    s_waitcnt lgkmcnt(0)
    s_barrier
    ds_read_b32 v14, v15
    s_waitcnt lgkmcnt(0)
    v_readfirstlane_b32 s66, v14
    s_barrier
    s_cmp_gt_u32 s66, s60
    s_cbranch_scc1 L_g_restart_91_go
    s_branch L_g_tail_96
L_g_g1r_93:
    s_mov_b32 s65, 1
    s_branch L_g_loop1_95_e
.p2align 6
L_g_loop1_95:
    s_mov_b32 s65, 0
L_g_loop1_95_e:
    s_barrier
    ds_read_b32 v14, v15
    s_bitcmp1_b32 s67, 2
    s_cbranch_scc0 L_g_nfl_112
    s_sub_u32 s59, s60, 3
    s_cmp_lg_u32 s44, 4
    s_cbranch_scc1 L_sf_117
    v_mov_b32 v10, s59
    v_add_u32 v10, 1, v10
    v_mov_b32 v11, 0
    s_mov_b64 exec, 1
    buffer_store_dword v10, v11, s[12:15], s52 offen sc1
    s_mov_b64 exec, -1
L_sf_117:
L_g_nfl_112:
    s_cmp_eq_u32 s71, 0
    s_cbranch_scc1 L_g_nfl_112_d
    v_mov_b32 v10, 1
    s_mov_b64 exec, 1
    s_waitcnt vmcnt(0)
    ds_add_rtn_u32 v10, v15, v10 offset:4
    s_waitcnt lgkmcnt(0)
    v_readfirstlane_b32 s46, v10
    s_mov_b64 exec, -1
    s_mov_b32 s71, 0
    s_sub_u32 s59, s60, 1
    s_cmp_lg_u32 s46, s68
    s_cbranch_scc1 L_g_df_118
    v_mov_b32 v10, s59
    v_add_u32 v10, 1, v10
    v_mov_b32 v11, 0
    s_mov_b64 exec, 1
    buffer_store_dword v10, v11, s[12:15], s52 offen sc1
    s_mov_b64 exec, -1
L_sf_119:
L_g_df_118:
    s_add_u32 s68, s68, 4
    s_mov_b32 s65, 2
L_g_nfl_112_d:
    s_waitcnt lgkmcnt(0)
    v_readfirstlane_b32 s66, v14
    s_nop 3
    s_mov_b32 s69, 0
    s_cmp_gt_u32 s62, s60
    s_cbranch_scc1 L_g_nd_120
    s_cmp_ge_u32 s62, s66
    s_cbranch_scc1 L_g_nd_120
    s_add_u32 s47, s61, 4096
    s_add_u32 m0, s64, 0
    s_nop 0
    buffer_load_dwordx4 v3, s[12:15], s61 offen offset:0 sc1 lds
    buffer_load_dwordx4 v3, s[12:15], s61 offen offset:1024 sc1 lds
    buffer_load_dwordx4 v3, s[12:15], s61 offen offset:2048 sc1 lds
    buffer_load_dwordx4 v3, s[12:15], s61 offen offset:3072 sc1 lds
    s_add_u32 m0, s64, 4096
    s_nop 0
    buffer_load_dwordx4 v3, s[12:15], s47 offen offset:0 sc1 lds
    buffer_load_dwordx4 v3, s[12:15], s47 offen offset:1024 sc1 lds
    buffer_load_dwordx4 v3, s[12:15], s47 offen offset:2048 sc1 lds
    buffer_load_dwordx4 v3, s[12:15], s47 offen offset:3072 sc1 lds
    s_add_u32 s61, s61, 65536
    s_add_u32 s62, s62, 1
    s_xor_b32 s64, s64, 0x10000
    s_mov_b32 s69, 1
L_g_nd_120:
    s_or_b32 s65, s65, s69
    s_add_u32 s59, s60, 1
    s_mov_b32 s69, 0
    s_cmp_gt_u32 s62, s59
    s_cbranch_scc1 L_g_nd_121
    s_cmp_ge_u32 s62, s66
    s_cbranch_scc1 L_g_nd_121
    s_add_u32 s47, s61, 4096
    s_add_u32 m0, s64, 0
    s_nop 0
    buffer_load_dwordx4 v3, s[12:15], s61 offen offset:0 sc1 lds
    buffer_load_dwordx4 v3, s[12:15], s61 offen offset:1024 sc1 lds
    buffer_load_dwordx4 v3, s[12:15], s61 offen offset:2048 sc1 lds
    buffer_load_dwordx4 v3, s[12:15], s61 offen offset:3072 sc1 lds
    s_add_u32 m0, s64, 4096
    s_nop 0
    buffer_load_dwordx4 v3, s[12:15], s47 offen offset:0 sc1 lds
    buffer_load_dwordx4 v3, s[12:15], s47 offen offset:1024 sc1 lds
    buffer_load_dwordx4 v3, s[12:15], s47 offen offset:2048 sc1 lds
    buffer_load_dwordx4 v3, s[12:15], s47 offen offset:3072 sc1 lds
    s_add_u32 s61, s61, 65536
    s_add_u32 s62, s62, 1
    s_xor_b32 s64, s64, 0x10000
    s_mov_b32 s69, 1
L_g_nd_121:
    s_bitcmp1_b32 s67, 0
    s_cbranch_scc0 L_g_nep_113
    ds_read_b128 v[80:83], v5 offset:0
    ds_read_b128 v[84:87], v5 offset:1024
    ds_read_b128 v[88:91], v5 offset:2048
    ds_read_b128 v[92:95], v5 offset:3072
    s_nop 7
    s_waitcnt lgkmcnt(3)
    v_add_f32 v80, v80, v16
    v_add_f32 v81, v81, v17
    v_add_f32 v82, v82, v18
    v_add_f32 v83, v83, v19
    s_waitcnt lgkmcnt(2)
    v_add_f32 v84, v84, v20
    v_add_f32 v85, v85, v21
    v_add_f32 v86, v86, v22
    v_add_f32 v87, v87, v23
    s_waitcnt lgkmcnt(1)
    v_add_f32 v88, v88, v24
    v_add_f32 v89, v89, v25
    v_add_f32 v90, v90, v26
    v_add_f32 v91, v91, v27
    s_waitcnt lgkmcnt(0)
    v_add_f32 v92, v92, v28
    v_add_f32 v93, v93, v29
    v_add_f32 v94, v94, v30
    v_add_f32 v95, v95, v31
L_g_nep_113:
    v_mul_f32 v96, v80, v80
    v_mul_f32 v97, v81, v81
    v_mul_f32 v98, v82, v82
    v_mul_f32 v99, v83, v83
    v_mul_f32 v100, v84, v84
    v_mul_f32 v101, v85, v85
    v_mul_f32 v102, v86, v86
    v_mul_f32 v103, v87, v87
    v_fma_f32 v96, v96, s56, v112
    v_fma_f32 v97, v97, s56, v112
    v_fma_f32 v98, v98, s56, v112
    v_fma_f32 v99, v99, s56, v112
    v_fma_f32 v100, v100, s56, v112
    v_fma_f32 v101, v101, s56, v112
    v_fma_f32 v102, v102, s56, v112
    v_fma_f32 v103, v103, s56, v112
    v_mul_f32 v96, v96, v80
    v_mul_f32 v97, v97, v81
    v_mul_f32 v98, v98, v82
    v_mul_f32 v99, v99, v83
    v_mul_f32 v100, v100, v84
    v_mul_f32 v101, v101, v85
    v_mul_f32 v102, v102, v86
    v_mul_f32 v103, v103, v87
    v_exp_f32 v96, v96
    v_exp_f32 v97, v97
    v_exp_f32 v98, v98
    v_exp_f32 v99, v99
    v_exp_f32 v100, v100
    v_exp_f32 v101, v101
    v_exp_f32 v102, v102
    v_exp_f32 v103, v103
    v_add_f32 v96, 1.0, v96
    v_add_f32 v97, 1.0, v97
    v_add_f32 v98, 1.0, v98
    v_add_f32 v99, 1.0, v99
    s_cmp_eq_u32 s65, 0
    s_cbranch_scc1 L_g_nw1_114
    s_cmp_eq_u32 s65, 2
    s_cbranch_scc1 L_g_nw1_114_w
    s_waitcnt vmcnt(0)
L_g_nw1_114_w:
    s_barrier
    ds_read_b128 v[32:35], v4 offset:0
    ds_read_b128 v[36:39], v4 offset:1024
    ds_read_b128 v[40:43], v4 offset:2048
    ds_read_b128 v[44:47], v4 offset:3072
    ds_read_b128 v[48:51], v4 offset:4096
    ds_read_b128 v[52:55], v4 offset:5120
    ds_read_b128 v[56:59], v4 offset:6144
    ds_read_b128 v[60:63], v4 offset:7168
    s_branch L_g_jn_116
L_g_nw1_114:
    ds_read_b128 v[32:35], v4 offset:0
    ds_read_b128 v[36:39], v4 offset:1024
    ds_read_b128 v[40:43], v4 offset:2048
    ds_read_b128 v[44:47], v4 offset:3072
    ds_read_b128 v[48:51], v4 offset:4096
    ds_read_b128 v[52:55], v4 offset:5120
    ds_read_b128 v[56:59], v4 offset:6144
    ds_read_b128 v[60:63], v4 offset:7168
    s_barrier
L_g_jn_116:
    s_bitcmp1_b32 s67, 0
    s_cbranch_scc1 L_g_mm2_115
    s_setprio 1
    s_waitcnt lgkmcnt(6)
    v_mfma_f32_32x32x16_bf16 v[16:31], a[0:3], v[32:35], 0
    ds_read_b128 v[32:35], v4 offset:8192
    v_mfma_f32_32x32x16_bf16 v[16:31], a[4:7], v[36:39], v[16:31]
    ds_read_b128 v[36:39], v4 offset:9216
    s_waitcnt lgkmcnt(6)
    v_mfma_f32_32x32x16_bf16 v[16:31], a[8:11], v[40:43], v[16:31]
    ds_read_b128 v[40:43], v4 offset:10240
    v_mfma_f32_32x32x16_bf16 v[16:31], a[12:15], v[44:47], v[16:31]
    ds_read_b128 v[44:47], v4 offset:11264
    s_waitcnt lgkmcnt(6)
    v_mfma_f32_32x32x16_bf16 v[16:31], a[16:19], v[48:51], v[16:31]
    ds_read_b128 v[48:51], v4 offset:12288
    v_mfma_f32_32x32x16_bf16 v[16:31], a[20:23], v[52:55], v[16:31]
    ds_read_b128 v[52:55], v4 offset:13312
    s_waitcnt lgkmcnt(6)
    v_mfma_f32_32x32x16_bf16 v[16:31], a[24:27], v[56:59], v[16:31]
    ds_read_b128 v[56:59], v4 offset:14336
    v_mfma_f32_32x32x16_bf16 v[16:31], a[28:31], v[60:63], v[16:31]
    ds_read_b128 v[60:63], v4 offset:15360
    s_waitcnt lgkmcnt(6)
    v_mfma_f32_32x32x16_bf16 v[16:31], a[32:35], v[32:35], v[16:31]
    ds_read_b128 v[32:35], v4 offset:16384
    v_mfma_f32_32x32x16_bf16 v[16:31], a[36:39], v[36:39], v[16:31]
    ds_read_b128 v[36:39], v4 offset:17408
    s_waitcnt lgkmcnt(6)
    v_mfma_f32_32x32x16_bf16 v[16:31], a[40:43], v[40:43], v[16:31]
    ds_read_b128 v[40:43], v4 offset:18432
    v_mfma_f32_32x32x16_bf16 v[16:31], a[44:47], v[44:47], v[16:31]
    ds_read_b128 v[44:47], v4 offset:19456
    s_waitcnt lgkmcnt(6)
    v_mfma_f32_32x32x16_bf16 v[16:31], a[48:51], v[48:51], v[16:31]
    ds_read_b128 v[48:51], v4 offset:20480
    v_mfma_f32_32x32x16_bf16 v[16:31], a[52:55], v[52:55], v[16:31]
    ds_read_b128 v[52:55], v4 offset:21504
    s_waitcnt lgkmcnt(6)
    v_mfma_f32_32x32x16_bf16 v[16:31], a[56:59], v[56:59], v[16:31]
    ds_read_b128 v[56:59], v4 offset:22528
    v_mfma_f32_32x32x16_bf16 v[16:31], a[60:63], v[60:63], v[16:31]
    ds_read_b128 v[60:63], v4 offset:23552
    s_waitcnt lgkmcnt(6)
    v_mfma_f32_32x32x16_bf16 v[16:31], a[64:67], v[32:35], v[16:31]
    ds_read_b128 v[32:35], v4 offset:24576
    v_mfma_f32_32x32x16_bf16 v[16:31], a[68:71], v[36:39], v[16:31]
    ds_read_b128 v[36:39], v4 offset:25600
    s_waitcnt lgkmcnt(6)
    v_mfma_f32_32x32x16_bf16 v[16:31], a[72:75], v[40:43], v[16:31]
    ds_read_b128 v[40:43], v4 offset:26624
    v_mfma_f32_32x32x16_bf16 v[16:31], a[76:79], v[44:47], v[16:31]
    ds_read_b128 v[44:47], v4 offset:27648
    s_waitcnt lgkmcnt(6)
    v_mfma_f32_32x32x16_bf16 v[16:31], a[80:83], v[48:51], v[16:31]
    ds_read_b128 v[48:51], v4 offset:28672
    v_mfma_f32_32x32x16_bf16 v[16:31], a[84:87], v[52:55], v[16:31]
    ds_read_b128 v[52:55], v4 offset:29696
    s_waitcnt lgkmcnt(6)
    v_mfma_f32_32x32x16_bf16 v[16:31], a[88:91], v[56:59], v[16:31]
    ds_read_b128 v[56:59], v4 offset:30720
    v_mfma_f32_32x32x16_bf16 v[16:31], a[92:95], v[60:63], v[16:31]
    ds_read_b128 v[60:63], v4 offset:31744
    s_waitcnt lgkmcnt(6)
    v_mfma_f32_32x32x16_bf16 v[16:31], a[96:99], v[32:35], v[16:31]
    v_mfma_f32_32x32x16_bf16 v[16:31], a[100:103], v[36:39], v[16:31]
    s_waitcnt lgkmcnt(4)
    v_mfma_f32_32x32x16_bf16 v[16:31], a[104:107], v[40:43], v[16:31]
    v_mfma_f32_32x32x16_bf16 v[16:31], a[108:111], v[44:47], v[16:31]
    s_waitcnt lgkmcnt(2)
    v_mfma_f32_32x32x16_bf16 v[16:31], a[112:115], v[48:51], v[16:31]
    v_mfma_f32_32x32x16_bf16 v[16:31], a[116:119], v[52:55], v[16:31]
    s_waitcnt lgkmcnt(0)
    v_mfma_f32_32x32x16_bf16 v[16:31], a[120:123], v[56:59], v[16:31]
    v_mfma_f32_32x32x16_bf16 v[16:31], a[124:127], v[60:63], v[16:31]
    v_xor_b32 v4, 0x10000, v4
    s_setprio 0
    s_waitcnt vmcnt(0)
    s_branch L_g_mm2_115_d
L_g_mm2_115:
    s_setprio 1
    s_waitcnt lgkmcnt(6)
    v_mfma_f32_32x32x16_bf16 v[16:31], a[0:3], v[32:35], 0
    ds_read_b128 v[32:35], v4 offset:8192
    v_add_f32 v100, 1.0, v100
    v_add_f32 v101, 1.0, v101
    v_add_f32 v102, 1.0, v102
    v_add_f32 v103, 1.0, v103
    v_mfma_f32_32x32x16_bf16 v[16:31], a[4:7], v[36:39], v[16:31]
    ds_read_b128 v[36:39], v4 offset:9216
    v_rcp_f32 v96, v96
    v_rcp_f32 v97, v97
    s_waitcnt lgkmcnt(6)
    v_mfma_f32_32x32x16_bf16 v[16:31], a[8:11], v[40:43], v[16:31]
    ds_read_b128 v[40:43], v4 offset:10240
    v_rcp_f32 v98, v98
    v_rcp_f32 v99, v99
    v_mfma_f32_32x32x16_bf16 v[16:31], a[12:15], v[44:47], v[16:31]
    ds_read_b128 v[44:47], v4 offset:11264
    v_rcp_f32 v100, v100
    v_rcp_f32 v101, v101
    s_waitcnt lgkmcnt(6)
    v_mfma_f32_32x32x16_bf16 v[16:31], a[16:19], v[48:51], v[16:31]
    ds_read_b128 v[48:51], v4 offset:12288
    v_rcp_f32 v102, v102
    v_rcp_f32 v103, v103
    v_mfma_f32_32x32x16_bf16 v[16:31], a[20:23], v[52:55], v[16:31]
    ds_read_b128 v[52:55], v4 offset:13312
    v_mul_f32 v80, v80, v96
    v_mul_f32 v81, v81, v97
    v_mul_f32 v82, v82, v98
    v_mul_f32 v83, v83, v99
    s_waitcnt lgkmcnt(6)
    v_mfma_f32_32x32x16_bf16 v[16:31], a[24:27], v[56:59], v[16:31]
    ds_read_b128 v[56:59], v4 offset:14336
    v_mul_f32 v84, v84, v100
    v_mul_f32 v85, v85, v101
    v_mul_f32 v86, v86, v102
    v_mul_f32 v87, v87, v103
    v_mfma_f32_32x32x16_bf16 v[16:31], a[28:31], v[60:63], v[16:31]
    ds_read_b128 v[60:63], v4 offset:15360
    v_cvt_pk_bf16_f32 v104, v80, v81
    v_cvt_pk_bf16_f32 v105, v82, v83
    v_cvt_pk_bf16_f32 v106, v84, v85
    v_cvt_pk_bf16_f32 v107, v86, v87
    s_waitcnt lgkmcnt(6)
    v_mfma_f32_32x32x16_bf16 v[16:31], a[32:35], v[32:35], v[16:31]
    ds_read_b128 v[32:35], v4 offset:16384
    buffer_store_dwordx4 v[104:107], v8, s[12:15], s63 offen sc1
    v_mul_f32 v96, v88, v88
    v_mul_f32 v97, v89, v89
    v_mul_f32 v98, v90, v90
    v_mfma_f32_32x32x16_bf16 v[16:31], a[36:39], v[36:39], v[16:31]
    ds_read_b128 v[36:39], v4 offset:17408
    v_mul_f32 v99, v91, v91
    v_mul_f32 v100, v92, v92
    v_mul_f32 v101, v93, v93
    v_mul_f32 v102, v94, v94
    s_waitcnt lgkmcnt(6)
    v_mfma_f32_32x32x16_bf16 v[16:31], a[40:43], v[40:43], v[16:31]
    ds_read_b128 v[40:43], v4 offset:18432
    v_mul_f32 v103, v95, v95
    v_fma_f32 v96, v96, s56, v112
    v_fma_f32 v97, v97, s56, v112
    v_fma_f32 v98, v98, s56, v112
    v_mfma_f32_32x32x16_bf16 v[16:31], a[44:47], v[44:47], v[16:31]
    ds_read_b128 v[44:47], v4 offset:19456
    v_fma_f32 v99, v99, s56, v112
    v_fma_f32 v100, v100, s56, v112
    v_fma_f32 v101, v101, s56, v112
    v_fma_f32 v102, v102, s56, v112
    s_waitcnt lgkmcnt(6)
    v_mfma_f32_32x32x16_bf16 v[16:31], a[48:51], v[48:51], v[16:31]
    ds_read_b128 v[48:51], v4 offset:20480
    v_fma_f32 v103, v103, s56, v112
    v_mul_f32 v96, v96, v88
    v_mul_f32 v97, v97, v89
    v_mul_f32 v98, v98, v90
    v_mfma_f32_32x32x16_bf16 v[16:31], a[52:55], v[52:55], v[16:31]
    ds_read_b128 v[52:55], v4 offset:21504
    v_mul_f32 v99, v99, v91
    v_mul_f32 v100, v100, v92
    v_mul_f32 v101, v101, v93
    v_mul_f32 v102, v102, v94
    s_waitcnt lgkmcnt(6)
    v_mfma_f32_32x32x16_bf16 v[16:31], a[56:59], v[56:59], v[16:31]
    ds_read_b128 v[56:59], v4 offset:22528
    v_mul_f32 v103, v103, v95
    v_exp_f32 v96, v96
    v_exp_f32 v97, v97
    v_mfma_f32_32x32x16_bf16 v[16:31], a[60:63], v[60:63], v[16:31]
    ds_read_b128 v[60:63], v4 offset:23552
    v_exp_f32 v98, v98
    v_exp_f32 v99, v99
    s_waitcnt lgkmcnt(6)
    v_mfma_f32_32x32x16_bf16 v[16:31], a[64:67], v[32:35], v[16:31]
    ds_read_b128 v[32:35], v4 offset:24576
    v_exp_f32 v100, v100
    v_exp_f32 v101, v101
    v_mfma_f32_32x32x16_bf16 v[16:31], a[68:71], v[36:39], v[16:31]
    ds_read_b128 v[36:39], v4 offset:25600
    v_exp_f32 v102, v102
    v_exp_f32 v103, v103
    s_waitcnt lgkmcnt(6)
    v_mfma_f32_32x32x16_bf16 v[16:31], a[72:75], v[40:43], v[16:31]
    ds_read_b128 v[40:43], v4 offset:26624
    v_add_f32 v96, 1.0, v96
    v_add_f32 v97, 1.0, v97
    v_add_f32 v98, 1.0, v98
    v_add_f32 v99, 1.0, v99
    v_mfma_f32_32x32x16_bf16 v[16:31], a[76:79], v[44:47], v[16:31]
    ds_read_b128 v[44:47], v4 offset:27648
    v_add_f32 v100, 1.0, v100
    v_add_f32 v101, 1.0, v101
    v_add_f32 v102, 1.0, v102
    v_add_f32 v103, 1.0, v103
    s_waitcnt lgkmcnt(6)
    v_mfma_f32_32x32x16_bf16 v[16:31], a[80:83], v[48:51], v[16:31]
    ds_read_b128 v[48:51], v4 offset:28672
    v_rcp_f32 v96, v96
    v_rcp_f32 v97, v97
    v_mfma_f32_32x32x16_bf16 v[16:31], a[84:87], v[52:55], v[16:31]
    ds_read_b128 v[52:55], v4 offset:29696
    v_rcp_f32 v98, v98
    v_rcp_f32 v99, v99
    s_waitcnt lgkmcnt(6)
    v_mfma_f32_32x32x16_bf16 v[16:31], a[88:91], v[56:59], v[16:31]
    ds_read_b128 v[56:59], v4 offset:30720
    v_rcp_f32 v100, v100
    v_rcp_f32 v101, v101
    v_mfma_f32_32x32x16_bf16 v[16:31], a[92:95], v[60:63], v[16:31]
    ds_read_b128 v[60:63], v4 offset:31744
    v_rcp_f32 v102, v102
    v_rcp_f32 v103, v103
    s_waitcnt lgkmcnt(6)
    v_mfma_f32_32x32x16_bf16 v[16:31], a[96:99], v[32:35], v[16:31]
    v_mul_f32 v88, v88, v96
    v_mul_f32 v89, v89, v97
    v_mul_f32 v90, v90, v98
    v_mul_f32 v91, v91, v99
    v_mfma_f32_32x32x16_bf16 v[16:31], a[100:103], v[36:39], v[16:31]
    v_mul_f32 v92, v92, v100
    v_mul_f32 v93, v93, v101
    v_mul_f32 v94, v94, v102
    v_mul_f32 v95, v95, v103
    s_waitcnt lgkmcnt(4)
    v_mfma_f32_32x32x16_bf16 v[16:31], a[104:107], v[40:43], v[16:31]
    v_cvt_pk_bf16_f32 v108, v88, v89
    v_cvt_pk_bf16_f32 v109, v90, v91
    v_cvt_pk_bf16_f32 v110, v92, v93
    v_cvt_pk_bf16_f32 v111, v94, v95
    v_mfma_f32_32x32x16_bf16 v[16:31], a[108:111], v[44:47], v[16:31]
    buffer_store_dwordx4 v[108:111], v9, s[12:15], s63 offen sc1
    s_add_u32 s63, s63, 229376
    s_waitcnt lgkmcnt(2)
    v_mfma_f32_32x32x16_bf16 v[16:31], a[112:115], v[48:51], v[16:31]
    v_mfma_f32_32x32x16_bf16 v[16:31], a[116:119], v[52:55], v[16:31]
    s_waitcnt lgkmcnt(0)
    v_mfma_f32_32x32x16_bf16 v[16:31], a[120:123], v[56:59], v[16:31]
    v_mfma_f32_32x32x16_bf16 v[16:31], a[124:127], v[60:63], v[16:31]
    v_xor_b32 v4, 0x10000, v4
    s_setprio 0
    s_waitcnt vmcnt(2)
L_g_mm2_115_d:
    s_lshl_b32 s67, s67, 1
    s_or_b32 s67, s67, 1
    s_add_u32 s60, s60, 1
    s_cmp_gt_u32 s66, s60
    s_cbranch_scc1 L_g_loop1_95
    s_barrier
    ds_read_b32 v14, v15
    s_waitcnt lgkmcnt(0)
    v_readfirstlane_b32 s66, v14
    s_barrier
    s_mov_b32 s69, 0
    s_cmp_gt_u32 s62, s60
    s_cbranch_scc1 L_g_nd_122
    s_cmp_ge_u32 s62, s66
    s_cbranch_scc1 L_g_nd_122
    s_add_u32 s47, s61, 4096
    s_add_u32 m0, s64, 0
    s_nop 0
    buffer_load_dwordx4 v3, s[12:15], s61 offen offset:0 sc1 lds
    buffer_load_dwordx4 v3, s[12:15], s61 offen offset:1024 sc1 lds
    buffer_load_dwordx4 v3, s[12:15], s61 offen offset:2048 sc1 lds
    buffer_load_dwordx4 v3, s[12:15], s61 offen offset:3072 sc1 lds
    s_add_u32 m0, s64, 4096
    s_nop 0
    buffer_load_dwordx4 v3, s[12:15], s47 offen offset:0 sc1 lds
    buffer_load_dwordx4 v3, s[12:15], s47 offen offset:1024 sc1 lds
    buffer_load_dwordx4 v3, s[12:15], s47 offen offset:2048 sc1 lds
    buffer_load_dwordx4 v3, s[12:15], s47 offen offset:3072 sc1 lds
    s_add_u32 s61, s61, 65536
    s_add_u32 s62, s62, 1
    s_xor_b32 s64, s64, 0x10000
    s_mov_b32 s69, 1
L_g_nd_122:
    s_sub_u32 s59, s60, 1
    ds_read_b128 v[80:83], v5 offset:0
    ds_read_b128 v[84:87], v5 offset:1024
    ds_read_b128 v[88:91], v5 offset:2048
    ds_read_b128 v[92:95], v5 offset:3072
    s_nop 7
    s_waitcnt lgkmcnt(3)
    v_add_f32 v80, v80, v16
    v_add_f32 v81, v81, v17
    v_add_f32 v82, v82, v18
    v_add_f32 v83, v83, v19
    s_waitcnt lgkmcnt(2)
    v_add_f32 v84, v84, v20
    v_add_f32 v85, v85, v21
    v_add_f32 v86, v86, v22
    v_add_f32 v87, v87, v23
    s_waitcnt lgkmcnt(1)
    v_add_f32 v88, v88, v24
    v_add_f32 v89, v89, v25
    v_add_f32 v90, v90, v26
    v_add_f32 v91, v91, v27
    s_waitcnt lgkmcnt(0)
    v_add_f32 v92, v92, v28
    v_add_f32 v93, v93, v29
    v_add_f32 v94, v94, v30
    v_add_f32 v95, v95, v31
    v_mul_f32 v96, v80, v80
    v_mul_f32 v97, v81, v81
    v_mul_f32 v98, v82, v82
    v_mul_f32 v99, v83, v83
    v_mul_f32 v100, v84, v84
    v_mul_f32 v101, v85, v85
    v_mul_f32 v102, v86, v86
    v_mul_f32 v103, v87, v87
    v_fma_f32 v96, v96, s56, v112
    v_fma_f32 v97, v97, s56, v112
    v_fma_f32 v98, v98, s56, v112
    v_fma_f32 v99, v99, s56, v112
    v_fma_f32 v100, v100, s56, v112
    v_fma_f32 v101, v101, s56, v112
    v_fma_f32 v102, v102, s56, v112
    v_fma_f32 v103, v103, s56, v112
    v_mul_f32 v96, v96, v80
    v_mul_f32 v97, v97, v81
    v_mul_f32 v98, v98, v82
    v_mul_f32 v99, v99, v83
    v_mul_f32 v100, v100, v84
    v_mul_f32 v101, v101, v85
    v_mul_f32 v102, v102, v86
    v_mul_f32 v103, v103, v87
    v_exp_f32 v96, v96
    v_exp_f32 v97, v97
    v_exp_f32 v98, v98
    v_exp_f32 v99, v99
    v_exp_f32 v100, v100
    v_exp_f32 v101, v101
    v_exp_f32 v102, v102
    v_exp_f32 v103, v103
    v_add_f32 v96, 1.0, v96
    v_add_f32 v97, 1.0, v97
    v_add_f32 v98, 1.0, v98
    v_add_f32 v99, 1.0, v99
    v_add_f32 v100, 1.0, v100
    v_add_f32 v101, 1.0, v101
    v_add_f32 v102, 1.0, v102
    v_add_f32 v103, 1.0, v103
    v_rcp_f32 v96, v96
    v_rcp_f32 v97, v97
    v_rcp_f32 v98, v98
    v_rcp_f32 v99, v99
    v_rcp_f32 v100, v100
    v_rcp_f32 v101, v101
    v_rcp_f32 v102, v102
    v_rcp_f32 v103, v103
    v_mul_f32 v80, v80, v96
    v_mul_f32 v81, v81, v97
    v_mul_f32 v82, v82, v98
    v_mul_f32 v83, v83, v99
    v_mul_f32 v84, v84, v100
    v_mul_f32 v85, v85, v101
    v_mul_f32 v86, v86, v102
    v_mul_f32 v87, v87, v103
    v_cvt_pk_bf16_f32 v104, v80, v81
    v_cvt_pk_bf16_f32 v105, v82, v83
    v_cvt_pk_bf16_f32 v106, v84, v85
    v_cvt_pk_bf16_f32 v107, v86, v87
    buffer_store_dwordx4 v[104:107], v8, s[12:15], s63 offen sc1
    v_mul_f32 v96, v88, v88
    v_mul_f32 v97, v89, v89
    v_mul_f32 v98, v90, v90
    v_mul_f32 v99, v91, v91
    v_mul_f32 v100, v92, v92
    v_mul_f32 v101, v93, v93
    v_mul_f32 v102, v94, v94
    v_mul_f32 v103, v95, v95
    v_fma_f32 v96, v96, s56, v112
    v_fma_f32 v97, v97, s56, v112
    v_fma_f32 v98, v98, s56, v112
    v_fma_f32 v99, v99, s56, v112
    v_fma_f32 v100, v100, s56, v112
    v_fma_f32 v101, v101, s56, v112
    v_fma_f32 v102, v102, s56, v112
    v_fma_f32 v103, v103, s56, v112
    v_mul_f32 v96, v96, v88
    v_mul_f32 v97, v97, v89
    v_mul_f32 v98, v98, v90
    v_mul_f32 v99, v99, v91
    v_mul_f32 v100, v100, v92
    v_mul_f32 v101, v101, v93
    v_mul_f32 v102, v102, v94
    v_mul_f32 v103, v103, v95
    v_exp_f32 v96, v96
    v_exp_f32 v97, v97
    v_exp_f32 v98, v98
    v_exp_f32 v99, v99
    v_exp_f32 v100, v100
    v_exp_f32 v101, v101
    v_exp_f32 v102, v102
    v_exp_f32 v103, v103
    v_add_f32 v96, 1.0, v96
    v_add_f32 v97, 1.0, v97
    v_add_f32 v98, 1.0, v98
    v_add_f32 v99, 1.0, v99
    v_add_f32 v100, 1.0, v100
    v_add_f32 v101, 1.0, v101
    v_add_f32 v102, 1.0, v102
    v_add_f32 v103, 1.0, v103
    v_rcp_f32 v96, v96
    v_rcp_f32 v97, v97
    v_rcp_f32 v98, v98
    v_rcp_f32 v99, v99
    v_rcp_f32 v100, v100
    v_rcp_f32 v101, v101
    v_rcp_f32 v102, v102
    v_rcp_f32 v103, v103
    v_mul_f32 v88, v88, v96
    v_mul_f32 v89, v89, v97
    v_mul_f32 v90, v90, v98
    v_mul_f32 v91, v91, v99
    v_mul_f32 v92, v92, v100
    v_mul_f32 v93, v93, v101
    v_mul_f32 v94, v94, v102
    v_mul_f32 v95, v95, v103
    v_cvt_pk_bf16_f32 v108, v88, v89
    v_cvt_pk_bf16_f32 v109, v90, v91
    v_cvt_pk_bf16_f32 v110, v92, v93
    v_cvt_pk_bf16_f32 v111, v94, v95
    buffer_store_dwordx4 v[108:111], v9, s[12:15], s63 offen sc1
    s_add_u32 s63, s63, 229376
    s_mov_b32 s67, 0
    s_mov_b32 s71, 1
    s_cmp_gt_u32 s66, s60
    s_cbranch_scc1 L_g_g1r_93
    v_mov_b32 v10, 1
    s_mov_b64 exec, 1
    s_waitcnt vmcnt(0)
    ds_add_rtn_u32 v10, v15, v10 offset:4
    s_waitcnt lgkmcnt(0)
    v_readfirstlane_b32 s46, v10
    s_mov_b64 exec, -1
    s_mov_b32 s71, 0
    s_sub_u32 s59, s60, 1
    s_cmp_lg_u32 s46, s68
    s_cbranch_scc1 L_g_df_123
    v_mov_b32 v10, s59
    v_add_u32 v10, 1, v10
    v_mov_b32 v11, 0
    s_mov_b64 exec, 1
    buffer_store_dword v10, v11, s[12:15], s52 offen sc1
    s_mov_b64 exec, -1
L_sf_124:
L_g_df_123:
    s_add_u32 s68, s68, 4
    s_cmp_gt_u32 s66, s60
    s_cbranch_scc1 L_g_g1r_93
L_g_tail_96:
    s_cmp_lt_u32 s60, s75
    s_cbranch_scc1 L_g_restart_91
    s_waitcnt vmcnt(0)
    s_barrier
    s_branch L_w_f1_14_d
L_w_f2_13:
    s_load_dwordx2 s[4:5], s[0:1], 80
    s_load_dwordx2 s[6:7], s[0:1], 72
    s_and_b32 s50, s44, 3
    s_lshr_b32 s51, s44, 2
    s_waitcnt lgkmcnt(0)
    s_mov_b32 s24, s4
    s_and_b32 s25, s5, 0xffff
    s_mov_b32 s26, 0x700000
    s_mov_b32 s27, 0x00020000
    v_lshrrev_b32 v3, 4, v1
    v_and_b32 v4, 15, v1
    v_lshlrev_b32 v5, 2, v3
    v_xor_b32 v4, v4, v5
    v_mul_u32_u24 v3, 2048, v3
    v_lshl_add_u32 v3, v4, 4, v3
    s_mul_i32 s46, s51, 448
    s_mul_i32 s47, s50, 56
    s_add_u32 s46, s46, s47
    s_mul_i32 s47, s42, 896
    s_add_u32 s46, s46, s47
    s_mul_i32 s46, s46, 2048
    s_lshl_b32 s47, s43, 8
    s_add_u32 s46, s46, s47
    s_lshl_b32 s45, s51, 16
    s_mul_i32 s47, s50, 14336
    s_add_u32 s45, s45, s47
    v_bfe_u32 v4, v1, 2, 2
    v_bfe_u32 v5, v1, 4, 1
    v_lshlrev_b32 v5, 1, v5
    v_bfe_u32 v6, v1, 1, 1
    v_add_u32 v5, v5, v6
    s_lshl_b32 s47, s50, 2
    v_add_u32 v5, s47, v5
    v_lshlrev_b32 v6, 2, v4
    v_xor_b32 v5, v5, v6
    v_lshlrev_b32 v5, 4, v5
    v_lshl_add_u32 v5, v4, 8, v5
    v_bfe_u32 v6, v1, 0, 1
    v_lshl_add_u32 v5, v6, 3, v5
    v_lshrrev_b32 v6, 5, v1
    v_mul_u32_u24 v6, 1024, v6
    v_add_u32 v5, v5, v6
    s_lshl_b32 s47, s51, 16
    v_add_u32 v5, s47, v5
    v_bfe_u32 v4, v1, 2, 2
    v_xor_b32 v5, s50, v4
    v_lshlrev_b32 v5, 6, v5
    v_lshl_add_u32 v5, v4, 8, v5
    v_and_b32 v6, 3, v1
    v_lshl_add_u32 v5, v6, 3, v5
    v_lshrrev_b32 v6, 4, v1
    v_lshl_add_u32 v5, v6, 10, v5
    v_lshrrev_b32 v6, 5, v1
    v_lshl_add_u32 v5, v6, 11, v5
    s_lshl_b32 s47, s51, 16
    v_add_u32 v5, s47, v5
    s_add_u32 m0, s45, 0
    s_add_u32 s47, s46, 0x0
    buffer_load_dwordx4 v3, s[24:27], s47 offen lds
    s_add_u32 m0, s45, 1024
    s_add_u32 s47, s46, 0x2000
    buffer_load_dwordx4 v3, s[24:27], s47 offen lds
    s_add_u32 m0, s45, 2048
    s_add_u32 s47, s46, 0x4000
    buffer_load_dwordx4 v3, s[24:27], s47 offen lds
    s_add_u32 m0, s45, 3072
    s_add_u32 s47, s46, 0x6000
    buffer_load_dwordx4 v3, s[24:27], s47 offen lds
    s_add_u32 m0, s45, 4096
    s_add_u32 s47, s46, 0x8000
    buffer_load_dwordx4 v3, s[24:27], s47 offen lds
    s_add_u32 m0, s45, 5120
    s_add_u32 s47, s46, 0xa000
    buffer_load_dwordx4 v3, s[24:27], s47 offen lds
    s_add_u32 m0, s45, 6144
    s_add_u32 s47, s46, 0xc000
    buffer_load_dwordx4 v3, s[24:27], s47 offen lds
    s_add_u32 m0, s45, 7168
    s_add_u32 s47, s46, 0xe000
    buffer_load_dwordx4 v3, s[24:27], s47 offen lds
    s_add_u32 m0, s45, 8192
    s_add_u32 s47, s46, 0x10000
    buffer_load_dwordx4 v3, s[24:27], s47 offen lds
    s_add_u32 m0, s45, 9216
    s_add_u32 s47, s46, 0x12000
    buffer_load_dwordx4 v3, s[24:27], s47 offen lds
    s_add_u32 m0, s45, 10240
    s_add_u32 s47, s46, 0x14000
    buffer_load_dwordx4 v3, s[24:27], s47 offen lds
    s_add_u32 m0, s45, 11264
    s_add_u32 s47, s46, 0x16000
    buffer_load_dwordx4 v3, s[24:27], s47 offen lds
    s_add_u32 m0, s45, 12288
    s_add_u32 s47, s46, 0x18000
    buffer_load_dwordx4 v3, s[24:27], s47 offen lds
    s_add_u32 m0, s45, 13312
    s_add_u32 s47, s46, 0x1a000
    buffer_load_dwordx4 v3, s[24:27], s47 offen lds
    s_waitcnt vmcnt(0)
    s_barrier
    ds_read_b64_tr_b16 a[0:1], v5 offset:0
    ds_read_b64_tr_b16 a[2:3], v5 offset:2048
    ds_read_b64_tr_b16 a[4:5], v5 offset:32
    ds_read_b64_tr_b16 a[6:7], v5 offset:2080
    ds_read_b64_tr_b16 a[8:9], v5 offset:8192
    ds_read_b64_tr_b16 a[10:11], v5 offset:10240
    ds_read_b64_tr_b16 a[12:13], v5 offset:8224
    ds_read_b64_tr_b16 a[14:15], v5 offset:10272
    s_waitcnt lgkmcnt(0)
    ds_read_b64_tr_b16 a[16:17], v5 offset:16384
    ds_read_b64_tr_b16 a[18:19], v5 offset:18432
    ds_read_b64_tr_b16 a[20:21], v5 offset:16416
    ds_read_b64_tr_b16 a[22:23], v5 offset:18464
    ds_read_b64_tr_b16 a[24:25], v5 offset:24576
    ds_read_b64_tr_b16 a[26:27], v5 offset:26624
    ds_read_b64_tr_b16 a[28:29], v5 offset:24608
    ds_read_b64_tr_b16 a[30:31], v5 offset:26656
    s_waitcnt lgkmcnt(0)
    ds_read_b64_tr_b16 a[32:33], v5 offset:32768
    ds_read_b64_tr_b16 a[34:35], v5 offset:34816
    ds_read_b64_tr_b16 a[36:37], v5 offset:32800
    ds_read_b64_tr_b16 a[38:39], v5 offset:34848
    ds_read_b64_tr_b16 a[40:41], v5 offset:40960
    ds_read_b64_tr_b16 a[42:43], v5 offset:43008
    ds_read_b64_tr_b16 a[44:45], v5 offset:40992
    ds_read_b64_tr_b16 a[46:47], v5 offset:43040
    s_waitcnt lgkmcnt(0)
    ds_read_b64_tr_b16 a[48:49], v5 offset:49152
    ds_read_b64_tr_b16 a[50:51], v5 offset:51200
    ds_read_b64_tr_b16 a[52:53], v5 offset:49184
    ds_read_b64_tr_b16 a[54:55], v5 offset:51232
    s_waitcnt lgkmcnt(0)
    s_barrier
    s_add_u32 m0, s45, 0
    s_add_u32 s47, s46, 0x70000
    buffer_load_dwordx4 v3, s[24:27], s47 offen lds
    s_add_u32 m0, s45, 1024
    s_add_u32 s47, s46, 0x72000
    buffer_load_dwordx4 v3, s[24:27], s47 offen lds
    s_add_u32 m0, s45, 2048
    s_add_u32 s47, s46, 0x74000
    buffer_load_dwordx4 v3, s[24:27], s47 offen lds
    s_add_u32 m0, s45, 3072
    s_add_u32 s47, s46, 0x76000
    buffer_load_dwordx4 v3, s[24:27], s47 offen lds
    s_add_u32 m0, s45, 4096
    s_add_u32 s47, s46, 0x78000
    buffer_load_dwordx4 v3, s[24:27], s47 offen lds
    s_add_u32 m0, s45, 5120
    s_add_u32 s47, s46, 0x7a000
    buffer_load_dwordx4 v3, s[24:27], s47 offen lds
    s_add_u32 m0, s45, 6144
    s_add_u32 s47, s46, 0x7c000
    buffer_load_dwordx4 v3, s[24:27], s47 offen lds
    s_add_u32 m0, s45, 7168
    s_add_u32 s47, s46, 0x7e000
    buffer_load_dwordx4 v3, s[24:27], s47 offen lds
    s_add_u32 m0, s45, 8192
    s_add_u32 s47, s46, 0x80000
    buffer_load_dwordx4 v3, s[24:27], s47 offen lds
    s_add_u32 m0, s45, 9216
    s_add_u32 s47, s46, 0x82000
    buffer_load_dwordx4 v3, s[24:27], s47 offen lds
    s_add_u32 m0, s45, 10240
    s_add_u32 s47, s46, 0x84000
    buffer_load_dwordx4 v3, s[24:27], s47 offen lds
    s_add_u32 m0, s45, 11264
    s_add_u32 s47, s46, 0x86000
    buffer_load_dwordx4 v3, s[24:27], s47 offen lds
    s_add_u32 m0, s45, 12288
    s_add_u32 s47, s46, 0x88000
    buffer_load_dwordx4 v3, s[24:27], s47 offen lds
    s_add_u32 m0, s45, 13312
    s_add_u32 s47, s46, 0x8a000
    buffer_load_dwordx4 v3, s[24:27], s47 offen lds
    s_waitcnt vmcnt(0)
    s_barrier
    ds_read_b64_tr_b16 a[56:57], v5 offset:0
    ds_read_b64_tr_b16 a[58:59], v5 offset:2048
    ds_read_b64_tr_b16 a[60:61], v5 offset:32
    ds_read_b64_tr_b16 a[62:63], v5 offset:2080
    ds_read_b64_tr_b16 a[64:65], v5 offset:8192
    ds_read_b64_tr_b16 a[66:67], v5 offset:10240
    ds_read_b64_tr_b16 a[68:69], v5 offset:8224
    ds_read_b64_tr_b16 a[70:71], v5 offset:10272
    s_waitcnt lgkmcnt(0)
    ds_read_b64_tr_b16 a[72:73], v5 offset:16384
    ds_read_b64_tr_b16 a[74:75], v5 offset:18432
    ds_read_b64_tr_b16 a[76:77], v5 offset:16416
    ds_read_b64_tr_b16 a[78:79], v5 offset:18464
    ds_read_b64_tr_b16 a[80:81], v5 offset:24576
    ds_read_b64_tr_b16 a[82:83], v5 offset:26624
    ds_read_b64_tr_b16 a[84:85], v5 offset:24608
    ds_read_b64_tr_b16 a[86:87], v5 offset:26656
    s_waitcnt lgkmcnt(0)
    ds_read_b64_tr_b16 a[88:89], v5 offset:32768
    ds_read_b64_tr_b16 a[90:91], v5 offset:34816
    ds_read_b64_tr_b16 a[92:93], v5 offset:32800
    ds_read_b64_tr_b16 a[94:95], v5 offset:34848
    ds_read_b64_tr_b16 a[96:97], v5 offset:40960
    ds_read_b64_tr_b16 a[98:99], v5 offset:43008
    ds_read_b64_tr_b16 a[100:101], v5 offset:40992
    ds_read_b64_tr_b16 a[102:103], v5 offset:43040
    s_waitcnt lgkmcnt(0)
    ds_read_b64_tr_b16 a[104:105], v5 offset:49152
    ds_read_b64_tr_b16 a[106:107], v5 offset:51200
    ds_read_b64_tr_b16 a[108:109], v5 offset:49184
    ds_read_b64_tr_b16 a[110:111], v5 offset:51232
    s_waitcnt lgkmcnt(0)
    s_barrier
    v_lshlrev_b32 v2, 4, v1
    s_mul_i32 s64, s44, 7168
    s_add_u32 s46, s64, 0x6000000
    s_mul_i32 s47, s42, 57344
    s_add_u32 s46, s46, s47
    v_add_u32 v3, s46, v2
    s_mul_i32 s46, s51, 28672
    v_add_u32 v4, s46, v2
    v_and_b32 v6, 15, v1
    v_lshlrev_b32 v6, 4, v6
    v_lshrrev_b32 v7, 4, v1
    v_lshl_add_u32 v6, v7, 9, v6
    v_add_u32 v4, s46, v6
    s_lshl_b32 s46, s50, 12
    s_add_u32 s46, s46, 131072
    v_add_u32 v5, s46, v2
    v_min_u32 v7, 6, v1
    v_lshlrev_b32 v7, 7, v7
    s_mul_i32 s46, s42, 896
    s_add_u32 s46, s46, 0x106400
    v_add_u32 v7, s46, v7
    s_lshl_b32 s46, s42, 16
    s_lshl_b32 s47, s43, 11
    s_add_u32 s46, s46, s47
    s_lshl_b32 s47, s50, 9
    s_add_u32 s46, s46, s47
    s_add_u32 s46, s46, 0xb000000
    v_and_b32 v8, 31, v1
    v_lshlrev_b32 v8, 4, v8
    v_lshrrev_b32 v9, 5, v1
    v_lshl_add_u32 v8, v9, 14, v8
    v_add_u32 v8, s46, v8
    v_add_u32 v9, 0x8000, v8
    s_lshl_b32 s52, s43, 9
    s_lshl_b32 s47, s42, 7
    s_add_u32 s52, s52, s47
    s_add_u32 s52, s52, 0x108400
    s_add_u32 s52, s52, s76
    s_mov_b32 s60, s74
    s_mul_i32 s61, s74, 229376
    s_mov_b32 s62, s74
    s_mul_i32 s63, s74, 262144
    s_mov_b32 s67, 0
    s_mov_b32 s68, 3
    s_mov_b32 s71, 0
    v_mov_b32 v15, 147456
    v_mov_b32 v14, 0
    ds_write_b32 v15, v14 offset:4
    ds_write_b32 v15, v14 offset:12
    ds_write_b32 v15, v14 offset:16
    v_mov_b32 v114, 1
    s_mov_b32 s72, 0
L_g_restart_125:
    s_cmp_lg_u32 s44, 0
    s_cbranch_scc1 L_g_nsp_126
    s_mov_b32 s70, 0
L_g_sp_132:
    s_add_u32 s54, s60, 0
    s_add_u32 s55, s54, 0
    s_cmp_ge_u32 s55, 58
    s_cselect_b32 s46, 65536, 0
    s_cmp_ge_u32 s55, 61
    s_cselect_b32 s46, 131072, s46
    buffer_load_dword v11, v7, s[12:15], s46 offen sc1
    s_add_u32 s55, s54, 1
    s_cmp_ge_u32 s55, 58
    s_cselect_b32 s46, 65536, 0
    s_cmp_ge_u32 s55, 61
    s_cselect_b32 s46, 131072, s46
    buffer_load_dword v12, v7, s[12:15], s46 offen sc1
    s_add_u32 s55, s54, 2
    s_cmp_ge_u32 s55, 58
    s_cselect_b32 s46, 65536, 0
    s_cmp_ge_u32 s55, 61
    s_cselect_b32 s46, 131072, s46
    buffer_load_dword v13, v7, s[12:15], s46 offen sc1
    s_waitcnt vmcnt(0)
    v_cmp_ge_u32 vcc, s60, v11
    s_add_u32 s70, s70, 1
    s_cbranch_vccz L_g_sp_132_ok
    s_sleep 3
    s_cmp_lt_u32 s70, 524288
    s_cbranch_scc1 L_g_sp_132
    s_branch L_c_done_1
L_g_sp_132_ok:
    s_mov_b32 s46, s54
    v_cmp_ge_u32 vcc, s46, v11
    s_nop 0
    s_cbranch_vccnz L_g_le_133
    s_add_u32 s46, s46, 1
    v_cmp_ge_u32 vcc, s46, v12
    s_nop 0
    s_cbranch_vccnz L_g_le_133
    s_add_u32 s46, s46, 1
    v_cmp_ge_u32 vcc, s46, v13
    s_nop 0
    s_cbranch_vccnz L_g_le_133
    s_add_u32 s46, s46, 1
L_g_le_133:
    s_min_u32 s46, s46, s75
    v_mov_b32 v11, s46
    ds_write_b32 v15, v11
L_g_nsp_126:
    s_waitcnt lgkmcnt(0)
    s_barrier
    ds_read_b32 v14, v15
    s_waitcnt lgkmcnt(0)
    v_readfirstlane_b32 s66, v14
    s_nop 3
L_g_restart_125_go:
    s_mov_b32 s69, 0
    s_cmp_gt_u32 s62, s60
    s_cbranch_scc1 L_g_nd_134
    s_cmp_ge_u32 s62, s66
    s_cbranch_scc1 L_g_nd_134
    s_add_u32 s47, s61, 4096
    s_add_u32 m0, s64, 0
    s_nop 0
    buffer_load_dwordx4 v3, s[12:15], s61 offen offset:0 sc1 lds
    buffer_load_dwordx4 v3, s[12:15], s61 offen offset:1024 sc1 lds
    buffer_load_dwordx4 v3, s[12:15], s61 offen offset:2048 sc1 lds
    buffer_load_dwordx4 v3, s[12:15], s61 offen offset:3072 sc1 lds
    s_add_u32 m0, s64, 4096
    s_nop 0
    buffer_load_dwordx4 v3, s[12:15], s47 offen offset:0 sc1 lds
    buffer_load_dwordx4 v3, s[12:15], s47 offen offset:1024 sc1 lds
    buffer_load_dwordx4 v3, s[12:15], s47 offen offset:2048 sc1 lds
    s_add_u32 s61, s61, 229376
    s_add_u32 s62, s62, 1
    s_xor_b32 s64, s64, 0x10000
    s_mov_b32 s69, 1
L_g_nd_134:
    s_cmp_eq_u32 s51, 1
    s_cbranch_scc1 L_g_g1r_127
    s_add_u32 s59, s60, 1
    s_mov_b32 s69, 0
    s_cmp_gt_u32 s62, s59
    s_cbranch_scc1 L_g_nd_135
    s_cmp_ge_u32 s62, s66
    s_cbranch_scc1 L_g_nd_135
    s_add_u32 s47, s61, 4096
    s_add_u32 m0, s64, 0
    s_nop 0
    buffer_load_dwordx4 v3, s[12:15], s61 offen offset:0 sc1 lds
    buffer_load_dwordx4 v3, s[12:15], s61 offen offset:1024 sc1 lds
    buffer_load_dwordx4 v3, s[12:15], s61 offen offset:2048 sc1 lds
    buffer_load_dwordx4 v3, s[12:15], s61 offen offset:3072 sc1 lds
    s_add_u32 m0, s64, 4096
    s_nop 0
    buffer_load_dwordx4 v3, s[12:15], s47 offen offset:0 sc1 lds
    buffer_load_dwordx4 v3, s[12:15], s47 offen offset:1024 sc1 lds
    buffer_load_dwordx4 v3, s[12:15], s47 offen offset:2048 sc1 lds
    s_add_u32 s61, s61, 229376
    s_add_u32 s62, s62, 1
    s_xor_b32 s64, s64, 0x10000
    s_mov_b32 s69, 1
L_g_nd_135:
    s_cmp_eq_u32 s69, 1
    s_cbranch_scc1 L_g_w0_136
    s_waitcnt vmcnt(0)
L_g_w0_136:
    s_waitcnt vmcnt(7)
    s_mov_b32 s65, 1
.p2align 6
L_g_loop0_128:
    s_barrier
    s_cmp_eq_u32 s65, 0
    s_cbranch_scc1 L_g_pr_137
    ds_read_b128 v[32:35], v4 offset:0
    ds_read_b128 v[36:39], v4 offset:256
    ds_read_b128 v[40:43], v4 offset:2048
    ds_read_b128 v[44:47], v4 offset:2304
    ds_read_b128 v[48:51], v4 offset:4096
    ds_read_b128 v[52:55], v4 offset:4352
    ds_read_b128 v[56:59], v4 offset:6144
    ds_read_b128 v[60:63], v4 offset:6400
    ds_read_b128 v[72:75], v4 offset:8192
    ds_read_b128 v[76:79], v4 offset:8448
    ds_read_b128 v[120:123], v4 offset:10240
    ds_read_b128 v[124:127], v4 offset:10496
L_g_pr_137:
    ds_read_b32 v14, v15
    s_cmp_lg_u32 s44, 0
    s_cbranch_scc1 L_g_nl_138
    s_add_u32 s54, s60, 1
    s_add_u32 s55, s54, 0
    s_cmp_ge_u32 s55, 58
    s_cselect_b32 s46, 65536, 0
    s_cmp_ge_u32 s55, 61
    s_cselect_b32 s46, 131072, s46
    buffer_load_dword v11, v7, s[12:15], s46 offen sc1
    s_add_u32 s55, s54, 1
    s_cmp_ge_u32 s55, 58
    s_cselect_b32 s46, 65536, 0
    s_cmp_ge_u32 s55, 61
    s_cselect_b32 s46, 131072, s46
    buffer_load_dword v12, v7, s[12:15], s46 offen sc1
    s_add_u32 s55, s54, 2
    s_cmp_ge_u32 s55, 58
    s_cselect_b32 s46, 65536, 0
    s_cmp_ge_u32 s55, 61
    s_cselect_b32 s46, 131072, s46
    buffer_load_dword v13, v7, s[12:15], s46 offen sc1
L_g_nl_138:
    s_setprio 2
    s_waitcnt lgkmcnt(8)
    v_mfma_f32_16x16x32_bf16 v[16:19], v[32:35], a[0:3], 0
    v_mfma_f32_16x16x32_bf16 v[20:23], v[32:35], a[4:7], 0
    ds_read_b128 v[32:35], v4 offset:12288
    v_mfma_f32_16x16x32_bf16 v[28:31], v[36:39], a[4:7], 0
    v_mfma_f32_16x16x32_bf16 v[24:27], v[36:39], a[0:3], 0
    ds_read_b128 v[36:39], v4 offset:12544
    v_mfma_f32_16x16x32_bf16 v[16:19], v[40:43], a[8:11], v[16:19]
    v_mfma_f32_16x16x32_bf16 v[20:23], v[40:43], a[12:15], v[20:23]
    ds_read_b128 v[40:43], v4 offset:14336
    v_mfma_f32_16x16x32_bf16 v[28:31], v[44:47], a[12:15], v[28:31]
    v_mfma_f32_16x16x32_bf16 v[24:27], v[44:47], a[8:11], v[24:27]
    ds_read_b128 v[44:47], v4 offset:14592
    s_waitcnt lgkmcnt(8)
    v_mfma_f32_16x16x32_bf16 v[16:19], v[48:51], a[16:19], v[16:19]
    v_mfma_f32_16x16x32_bf16 v[20:23], v[48:51], a[20:23], v[20:23]
    ds_read_b128 v[48:51], v4 offset:16384
    v_mfma_f32_16x16x32_bf16 v[28:31], v[52:55], a[20:23], v[28:31]
    v_mfma_f32_16x16x32_bf16 v[24:27], v[52:55], a[16:19], v[24:27]
    ds_read_b128 v[52:55], v4 offset:16640
    v_mfma_f32_16x16x32_bf16 v[16:19], v[56:59], a[24:27], v[16:19]
    v_mfma_f32_16x16x32_bf16 v[20:23], v[56:59], a[28:31], v[20:23]
    ds_read_b128 v[56:59], v4 offset:18432
    v_mfma_f32_16x16x32_bf16 v[28:31], v[60:63], a[28:31], v[28:31]
    v_mfma_f32_16x16x32_bf16 v[24:27], v[60:63], a[24:27], v[24:27]
    ds_read_b128 v[60:63], v4 offset:18688
    s_waitcnt lgkmcnt(8)
    v_mfma_f32_16x16x32_bf16 v[16:19], v[72:75], a[32:35], v[16:19]
    v_mfma_f32_16x16x32_bf16 v[20:23], v[72:75], a[36:39], v[20:23]
    ds_read_b128 v[72:75], v4 offset:20480
    v_mfma_f32_16x16x32_bf16 v[28:31], v[76:79], a[36:39], v[28:31]
    v_mfma_f32_16x16x32_bf16 v[24:27], v[76:79], a[32:35], v[24:27]
    ds_read_b128 v[76:79], v4 offset:20736
    v_mfma_f32_16x16x32_bf16 v[16:19], v[120:123], a[40:43], v[16:19]
    v_mfma_f32_16x16x32_bf16 v[20:23], v[120:123], a[44:47], v[20:23]
    ds_read_b128 v[120:123], v4 offset:22528
    v_mfma_f32_16x16x32_bf16 v[28:31], v[124:127], a[44:47], v[28:31]
    v_mfma_f32_16x16x32_bf16 v[24:27], v[124:127], a[40:43], v[24:27]
    ds_read_b128 v[124:127], v4 offset:22784
    s_waitcnt lgkmcnt(8)
    v_mfma_f32_16x16x32_bf16 v[16:19], v[32:35], a[48:51], v[16:19]
    v_mfma_f32_16x16x32_bf16 v[20:23], v[32:35], a[52:55], v[20:23]
    ds_read_b128 v[32:35], v4 offset:24576
    v_mfma_f32_16x16x32_bf16 v[28:31], v[36:39], a[52:55], v[28:31]
    v_mfma_f32_16x16x32_bf16 v[24:27], v[36:39], a[48:51], v[24:27]
    ds_read_b128 v[36:39], v4 offset:24832
    v_mfma_f32_16x16x32_bf16 v[16:19], v[40:43], a[56:59], v[16:19]
    v_mfma_f32_16x16x32_bf16 v[20:23], v[40:43], a[60:63], v[20:23]
    ds_read_b128 v[40:43], v4 offset:26624
    v_mfma_f32_16x16x32_bf16 v[28:31], v[44:47], a[60:63], v[28:31]
    v_mfma_f32_16x16x32_bf16 v[24:27], v[44:47], a[56:59], v[24:27]
    ds_read_b128 v[44:47], v4 offset:26880
    s_waitcnt lgkmcnt(8)
    v_mfma_f32_16x16x32_bf16 v[16:19], v[48:51], a[64:67], v[16:19]
    v_mfma_f32_16x16x32_bf16 v[20:23], v[48:51], a[68:71], v[20:23]
    v_mfma_f32_16x16x32_bf16 v[28:31], v[52:55], a[68:71], v[28:31]
    v_mfma_f32_16x16x32_bf16 v[24:27], v[52:55], a[64:67], v[24:27]
    v_mfma_f32_16x16x32_bf16 v[16:19], v[56:59], a[72:75], v[16:19]
    v_mfma_f32_16x16x32_bf16 v[20:23], v[56:59], a[76:79], v[20:23]
    v_mfma_f32_16x16x32_bf16 v[28:31], v[60:63], a[76:79], v[28:31]
    v_mfma_f32_16x16x32_bf16 v[24:27], v[60:63], a[72:75], v[24:27]
    s_waitcnt lgkmcnt(4)
    v_mfma_f32_16x16x32_bf16 v[16:19], v[72:75], a[80:83], v[16:19]
    v_mfma_f32_16x16x32_bf16 v[20:23], v[72:75], a[84:87], v[20:23]
    v_mfma_f32_16x16x32_bf16 v[28:31], v[76:79], a[84:87], v[28:31]
    v_mfma_f32_16x16x32_bf16 v[24:27], v[76:79], a[80:83], v[24:27]
    v_mfma_f32_16x16x32_bf16 v[16:19], v[120:123], a[88:91], v[16:19]
    v_mfma_f32_16x16x32_bf16 v[20:23], v[120:123], a[92:95], v[20:23]
    v_mfma_f32_16x16x32_bf16 v[28:31], v[124:127], a[92:95], v[28:31]
    v_mfma_f32_16x16x32_bf16 v[24:27], v[124:127], a[88:91], v[24:27]
    s_waitcnt lgkmcnt(0)
    v_mfma_f32_16x16x32_bf16 v[16:19], v[32:35], a[96:99], v[16:19]
    v_mfma_f32_16x16x32_bf16 v[20:23], v[32:35], a[100:103], v[20:23]
    v_mfma_f32_16x16x32_bf16 v[28:31], v[36:39], a[100:103], v[28:31]
    v_mfma_f32_16x16x32_bf16 v[24:27], v[36:39], a[96:99], v[24:27]
    v_mfma_f32_16x16x32_bf16 v[16:19], v[40:43], a[104:107], v[16:19]
    v_mfma_f32_16x16x32_bf16 v[20:23], v[40:43], a[108:111], v[20:23]
    v_mfma_f32_16x16x32_bf16 v[28:31], v[44:47], a[108:111], v[28:31]
    v_mfma_f32_16x16x32_bf16 v[24:27], v[44:47], a[104:107], v[24:27]
    v_xor_b32 v4, 0x10000, v4
    s_setprio 0
    s_waitcnt vmcnt(0)
    v_readfirstlane_b32 s66, v14
    s_barrier
    s_nop 6
    ds_write_b128 v5, v[16:19] offset:0
    ds_write_b128 v5, v[20:23] offset:1024
    ds_write_b128 v5, v[24:27] offset:2048
    ds_write_b128 v5, v[28:31] offset:3072
    s_cmp_lg_u32 s44, 0
    s_cbranch_scc1 L_g_ne_139
    s_mov_b32 s46, s54
    v_cmp_ge_u32 vcc, s46, v11
    s_nop 0
    s_cbranch_vccnz L_g_le_142
    s_add_u32 s46, s46, 1
    v_cmp_ge_u32 vcc, s46, v12
    s_nop 0
    s_cbranch_vccnz L_g_le_142
    s_add_u32 s46, s46, 1
    v_cmp_ge_u32 vcc, s46, v13
    s_nop 0
    s_cbranch_vccnz L_g_le_142
    s_add_u32 s46, s46, 1
L_g_le_142:
    s_min_u32 s46, s46, s75
    v_mov_b32 v11, s46
    ds_write_b32 v15, v11
L_g_ne_139:
    s_add_u32 s60, s60, 1
    s_mov_b32 s69, 0
    s_cmp_gt_u32 s62, s60
    s_cbranch_scc1 L_g_nd_143
    s_cmp_ge_u32 s62, s66
    s_cbranch_scc1 L_g_nd_143
    s_add_u32 s47, s61, 4096
    s_add_u32 m0, s64, 0
    s_nop 0
    buffer_load_dwordx4 v3, s[12:15], s61 offen offset:0 sc1 lds
    buffer_load_dwordx4 v3, s[12:15], s61 offen offset:1024 sc1 lds
    buffer_load_dwordx4 v3, s[12:15], s61 offen offset:2048 sc1 lds
    buffer_load_dwordx4 v3, s[12:15], s61 offen offset:3072 sc1 lds
    s_add_u32 m0, s64, 4096
    s_nop 0
    buffer_load_dwordx4 v3, s[12:15], s47 offen offset:0 sc1 lds
    buffer_load_dwordx4 v3, s[12:15], s47 offen offset:1024 sc1 lds
    buffer_load_dwordx4 v3, s[12:15], s47 offen offset:2048 sc1 lds
    s_add_u32 s61, s61, 229376
    s_add_u32 s62, s62, 1
    s_xor_b32 s64, s64, 0x10000
    s_mov_b32 s69, 1
L_g_nd_143:
    s_mov_b32 s65, s69
    s_add_u32 s59, s60, 1
    s_mov_b32 s69, 0
    s_cmp_gt_u32 s62, s59
    s_cbranch_scc1 L_g_nd_144
    s_cmp_ge_u32 s62, s66
    s_cbranch_scc1 L_g_nd_144
    s_add_u32 s47, s61, 4096
    s_add_u32 m0, s64, 0
    s_nop 0
    buffer_load_dwordx4 v3, s[12:15], s61 offen offset:0 sc1 lds
    buffer_load_dwordx4 v3, s[12:15], s61 offen offset:1024 sc1 lds
    buffer_load_dwordx4 v3, s[12:15], s61 offen offset:2048 sc1 lds
    buffer_load_dwordx4 v3, s[12:15], s61 offen offset:3072 sc1 lds
    s_add_u32 m0, s64, 4096
    s_nop 0
    buffer_load_dwordx4 v3, s[12:15], s47 offen offset:0 sc1 lds
    buffer_load_dwordx4 v3, s[12:15], s47 offen offset:1024 sc1 lds
    buffer_load_dwordx4 v3, s[12:15], s47 offen offset:2048 sc1 lds
    s_add_u32 s61, s61, 229376
    s_add_u32 s62, s62, 1
    s_xor_b32 s64, s64, 0x10000
    s_mov_b32 s69, 1
L_g_nd_144:
    s_cmp_le_u32 s66, s60
    s_cbranch_scc1 L_g_ex0_141
    s_cmp_eq_u32 s65, 0
    s_cbranch_scc1 L_g_nw_140
    s_waitcnt vmcnt(0) lgkmcnt(0)
    s_branch L_g_loop0_128
L_g_nw_140:
    ds_read_b128 v[32:35], v4 offset:0
    ds_read_b128 v[36:39], v4 offset:256
    ds_read_b128 v[40:43], v4 offset:2048
    ds_read_b128 v[44:47], v4 offset:2304
    ds_read_b128 v[48:51], v4 offset:4096
    ds_read_b128 v[52:55], v4 offset:4352
    ds_read_b128 v[56:59], v4 offset:6144
    ds_read_b128 v[60:63], v4 offset:6400
    ds_read_b128 v[72:75], v4 offset:8192
    ds_read_b128 v[76:79], v4 offset:8448
    ds_read_b128 v[120:123], v4 offset:10240
    ds_read_b128 v[124:127], v4 offset:10496
    s_waitcnt lgkmcnt(12)
    s_branch L_g_loop0_128
L_g_ex0_141:
    s_cmp_lg_u32 s44, 0
    s_cbranch_scc1 L_g_ex0_141_n
    s_sleep 6
    s_add_u32 s54, s60, 0
    s_add_u32 s55, s54, 0
    s_cmp_ge_u32 s55, 58
    s_cselect_b32 s46, 65536, 0
    s_cmp_ge_u32 s55, 61
    s_cselect_b32 s46, 131072, s46
    buffer_load_dword v11, v7, s[12:15], s46 offen sc1
    s_add_u32 s55, s54, 1
    s_cmp_ge_u32 s55, 58
    s_cselect_b32 s46, 65536, 0
    s_cmp_ge_u32 s55, 61
    s_cselect_b32 s46, 131072, s46
    buffer_load_dword v12, v7, s[12:15], s46 offen sc1
    s_add_u32 s55, s54, 2
    s_cmp_ge_u32 s55, 58
    s_cselect_b32 s46, 65536, 0
    s_cmp_ge_u32 s55, 61
    s_cselect_b32 s46, 131072, s46
    buffer_load_dword v13, v7, s[12:15], s46 offen sc1
    s_waitcnt vmcnt(0)
    s_mov_b32 s46, s54
    v_cmp_ge_u32 vcc, s46, v11
    s_nop 0
    s_cbranch_vccnz L_g_le_145
    s_add_u32 s46, s46, 1
    v_cmp_ge_u32 vcc, s46, v12
    s_nop 0
    s_cbranch_vccnz L_g_le_145
    s_add_u32 s46, s46, 1
    v_cmp_ge_u32 vcc, s46, v13
    s_nop 0
    s_cbranch_vccnz L_g_le_145
    s_add_u32 s46, s46, 1
L_g_le_145:
    s_min_u32 s46, s46, s75
    v_mov_b32 v11, s46
    ds_write_b32 v15, v11
L_g_ex0_141_n:
    s_waitcnt lgkmcnt(0)
    s_barrier
    ds_read_b32 v14, v15
    s_waitcnt lgkmcnt(0)
    v_readfirstlane_b32 s66, v14
    s_barrier
    s_cmp_gt_u32 s66, s60
    s_cbranch_scc1 L_g_restart_125_go
    s_branch L_g_tail_130
L_g_g1r_127:
    s_mov_b32 s65, 1
    s_branch L_g_loop1_129_e
.p2align 6
L_g_loop1_129:
    s_mov_b32 s65, 0
L_g_loop1_129_e:
    s_barrier
    ds_read_b32 v14, v15
    s_bitcmp1_b32 s67, 1
    s_cbranch_scc0 L_g_nfl_146
    s_sub_u32 s59, s60, 2
    s_cmp_lg_u32 s44, 4
    s_cbranch_scc1 L_sf_151
    v_mov_b32 v10, s59
    v_add_u32 v10, 1, v10
    v_mov_b32 v11, 0
    s_mov_b64 exec, 1
    buffer_store_dword v10, v11, s[12:15], s52 offen sc1
    s_mov_b64 exec, -1
L_sf_151:
L_g_nfl_146:
    s_cmp_eq_u32 s71, 0
    s_cbranch_scc1 L_g_nfl_146_d
    v_mov_b32 v10, 1
    s_mov_b64 exec, 1
    s_waitcnt vmcnt(0)
    ds_add_rtn_u32 v10, v15, v10 offset:4
    s_waitcnt lgkmcnt(0)
    v_readfirstlane_b32 s46, v10
    s_mov_b64 exec, -1
    s_mov_b32 s71, 0
    s_sub_u32 s59, s60, 1
    s_cmp_lg_u32 s46, s68
    s_cbranch_scc1 L_g_df_152
    v_mov_b32 v10, s59
    v_add_u32 v10, 1, v10
    v_mov_b32 v11, 0
    s_mov_b64 exec, 1
    buffer_store_dword v10, v11, s[12:15], s52 offen sc1
    s_mov_b64 exec, -1
L_sf_153:
L_g_df_152:
    s_add_u32 s68, s68, 4
    s_mov_b32 s65, 2
L_g_nfl_146_d:
    s_waitcnt lgkmcnt(0)
    v_readfirstlane_b32 s66, v14
    s_nop 3
    s_mov_b32 s69, 0
    s_cmp_gt_u32 s62, s60
    s_cbranch_scc1 L_g_nd_154
    s_cmp_ge_u32 s62, s66
    s_cbranch_scc1 L_g_nd_154
    s_add_u32 s47, s61, 4096
    s_add_u32 m0, s64, 0
    s_nop 0
    buffer_load_dwordx4 v3, s[12:15], s61 offen offset:0 sc1 lds
    buffer_load_dwordx4 v3, s[12:15], s61 offen offset:1024 sc1 lds
    buffer_load_dwordx4 v3, s[12:15], s61 offen offset:2048 sc1 lds
    buffer_load_dwordx4 v3, s[12:15], s61 offen offset:3072 sc1 lds
    s_add_u32 m0, s64, 4096
    s_nop 0
    buffer_load_dwordx4 v3, s[12:15], s47 offen offset:0 sc1 lds
    buffer_load_dwordx4 v3, s[12:15], s47 offen offset:1024 sc1 lds
    buffer_load_dwordx4 v3, s[12:15], s47 offen offset:2048 sc1 lds
    s_add_u32 s61, s61, 229376
    s_add_u32 s62, s62, 1
    s_xor_b32 s64, s64, 0x10000
    s_mov_b32 s69, 1
L_g_nd_154:
    s_or_b32 s65, s65, s69
    s_add_u32 s59, s60, 1
    s_mov_b32 s69, 0
    s_cmp_gt_u32 s62, s59
    s_cbranch_scc1 L_g_nd_155
    s_cmp_ge_u32 s62, s66
    s_cbranch_scc1 L_g_nd_155
    s_add_u32 s47, s61, 4096
    s_add_u32 m0, s64, 0
    s_nop 0
    buffer_load_dwordx4 v3, s[12:15], s61 offen offset:0 sc1 lds
    buffer_load_dwordx4 v3, s[12:15], s61 offen offset:1024 sc1 lds
    buffer_load_dwordx4 v3, s[12:15], s61 offen offset:2048 sc1 lds
    buffer_load_dwordx4 v3, s[12:15], s61 offen offset:3072 sc1 lds
    s_add_u32 m0, s64, 4096
    s_nop 0
    buffer_load_dwordx4 v3, s[12:15], s47 offen offset:0 sc1 lds
    buffer_load_dwordx4 v3, s[12:15], s47 offen offset:1024 sc1 lds
    buffer_load_dwordx4 v3, s[12:15], s47 offen offset:2048 sc1 lds
    s_add_u32 s61, s61, 229376
    s_add_u32 s62, s62, 1
    s_xor_b32 s64, s64, 0x10000
    s_mov_b32 s69, 1
L_g_nd_155:
    s_bitcmp1_b32 s67, 0
    s_cbranch_scc0 L_g_nep_147
    ds_read_b128 v[80:83], v5 offset:0
    ds_read_b128 v[84:87], v5 offset:1024
    ds_read_b128 v[88:91], v5 offset:2048
    ds_read_b128 v[92:95], v5 offset:3072
    s_nop 7
    s_waitcnt lgkmcnt(3)
    v_add_f32 v80, v80, v16
    v_add_f32 v81, v81, v17
    v_add_f32 v82, v82, v18
    v_add_f32 v83, v83, v19
    s_waitcnt lgkmcnt(2)
    v_add_f32 v84, v84, v20
    v_add_f32 v85, v85, v21
    v_add_f32 v86, v86, v22
    v_add_f32 v87, v87, v23
    s_waitcnt lgkmcnt(1)
    v_add_f32 v88, v88, v24
    v_add_f32 v89, v89, v25
    v_add_f32 v90, v90, v26
    v_add_f32 v91, v91, v27
    s_waitcnt lgkmcnt(0)
    v_add_f32 v92, v92, v28
    v_add_f32 v93, v93, v29
    v_add_f32 v94, v94, v30
    v_add_f32 v95, v95, v31
    v_cvt_pk_bf16_f32 v104, v80, v81
    v_cvt_pk_bf16_f32 v105, v82, v83
    v_cvt_pk_bf16_f32 v106, v84, v85
    v_cvt_pk_bf16_f32 v107, v86, v87
    s_nop 1
    v_permlane16_swap_b32 v104, v106
    v_permlane16_swap_b32 v105, v107
    buffer_store_dwordx4 v[104:107], v8, s[12:15], s63 offen sc1
    v_cvt_pk_bf16_f32 v108, v88, v89
    v_cvt_pk_bf16_f32 v109, v90, v91
    v_cvt_pk_bf16_f32 v110, v92, v93
    v_cvt_pk_bf16_f32 v111, v94, v95
    s_nop 1
    v_permlane16_swap_b32 v108, v110
    v_permlane16_swap_b32 v109, v111
    buffer_store_dwordx4 v[108:111], v9, s[12:15], s63 offen sc1
    s_add_u32 s63, s63, 262144
L_g_nep_147:
    s_cmp_eq_u32 s65, 0
    s_cbranch_scc1 L_g_nw1_148
    s_cmp_eq_u32 s65, 2
    s_cbranch_scc1 L_g_nw1_148_w
    s_waitcnt vmcnt(0)
L_g_nw1_148_w:
    s_barrier
    ds_read_b128 v[32:35], v4 offset:0
    ds_read_b128 v[36:39], v4 offset:256
    ds_read_b128 v[40:43], v4 offset:2048
    ds_read_b128 v[44:47], v4 offset:2304
    ds_read_b128 v[48:51], v4 offset:4096
    ds_read_b128 v[52:55], v4 offset:4352
    ds_read_b128 v[56:59], v4 offset:6144
    ds_read_b128 v[60:63], v4 offset:6400
    ds_read_b128 v[72:75], v4 offset:8192
    ds_read_b128 v[76:79], v4 offset:8448
    ds_read_b128 v[120:123], v4 offset:10240
    ds_read_b128 v[124:127], v4 offset:10496
    s_branch L_g_jn_150
L_g_nw1_148:
    ds_read_b128 v[32:35], v4 offset:0
    ds_read_b128 v[36:39], v4 offset:256
    ds_read_b128 v[40:43], v4 offset:2048
    ds_read_b128 v[44:47], v4 offset:2304
    ds_read_b128 v[48:51], v4 offset:4096
    ds_read_b128 v[52:55], v4 offset:4352
    ds_read_b128 v[56:59], v4 offset:6144
    ds_read_b128 v[60:63], v4 offset:6400
    ds_read_b128 v[72:75], v4 offset:8192
    ds_read_b128 v[76:79], v4 offset:8448
    ds_read_b128 v[120:123], v4 offset:10240
    ds_read_b128 v[124:127], v4 offset:10496
    s_barrier
L_g_jn_150:
    s_setprio 1
    s_waitcnt lgkmcnt(8)
    v_mfma_f32_16x16x32_bf16 v[16:19], v[32:35], a[0:3], 0
    v_mfma_f32_16x16x32_bf16 v[20:23], v[32:35], a[4:7], 0
    ds_read_b128 v[32:35], v4 offset:12288
    v_mfma_f32_16x16x32_bf16 v[28:31], v[36:39], a[4:7], 0
    v_mfma_f32_16x16x32_bf16 v[24:27], v[36:39], a[0:3], 0
    ds_read_b128 v[36:39], v4 offset:12544
    v_mfma_f32_16x16x32_bf16 v[16:19], v[40:43], a[8:11], v[16:19]
    v_mfma_f32_16x16x32_bf16 v[20:23], v[40:43], a[12:15], v[20:23]
    ds_read_b128 v[40:43], v4 offset:14336
    v_mfma_f32_16x16x32_bf16 v[28:31], v[44:47], a[12:15], v[28:31]
    v_mfma_f32_16x16x32_bf16 v[24:27], v[44:47], a[8:11], v[24:27]
    ds_read_b128 v[44:47], v4 offset:14592
    s_waitcnt lgkmcnt(8)
    v_mfma_f32_16x16x32_bf16 v[16:19], v[48:51], a[16:19], v[16:19]
    v_mfma_f32_16x16x32_bf16 v[20:23], v[48:51], a[20:23], v[20:23]
    ds_read_b128 v[48:51], v4 offset:16384
    v_mfma_f32_16x16x32_bf16 v[28:31], v[52:55], a[20:23], v[28:31]
    v_mfma_f32_16x16x32_bf16 v[24:27], v[52:55], a[16:19], v[24:27]
    ds_read_b128 v[52:55], v4 offset:16640
    v_mfma_f32_16x16x32_bf16 v[16:19], v[56:59], a[24:27], v[16:19]
    v_mfma_f32_16x16x32_bf16 v[20:23], v[56:59], a[28:31], v[20:23]
    ds_read_b128 v[56:59], v4 offset:18432
    v_mfma_f32_16x16x32_bf16 v[28:31], v[60:63], a[28:31], v[28:31]
    v_mfma_f32_16x16x32_bf16 v[24:27], v[60:63], a[24:27], v[24:27]
    ds_read_b128 v[60:63], v4 offset:18688
    s_waitcnt lgkmcnt(8)
    v_mfma_f32_16x16x32_bf16 v[16:19], v[72:75], a[32:35], v[16:19]
    v_mfma_f32_16x16x32_bf16 v[20:23], v[72:75], a[36:39], v[20:23]
    ds_read_b128 v[72:75], v4 offset:20480
    v_mfma_f32_16x16x32_bf16 v[28:31], v[76:79], a[36:39], v[28:31]
    v_mfma_f32_16x16x32_bf16 v[24:27], v[76:79], a[32:35], v[24:27]
    ds_read_b128 v[76:79], v4 offset:20736
    v_mfma_f32_16x16x32_bf16 v[16:19], v[120:123], a[40:43], v[16:19]
    v_mfma_f32_16x16x32_bf16 v[20:23], v[120:123], a[44:47], v[20:23]
    ds_read_b128 v[120:123], v4 offset:22528
    v_mfma_f32_16x16x32_bf16 v[28:31], v[124:127], a[44:47], v[28:31]
    v_mfma_f32_16x16x32_bf16 v[24:27], v[124:127], a[40:43], v[24:27]
    ds_read_b128 v[124:127], v4 offset:22784
    s_waitcnt lgkmcnt(8)
    v_mfma_f32_16x16x32_bf16 v[16:19], v[32:35], a[48:51], v[16:19]
    v_mfma_f32_16x16x32_bf16 v[20:23], v[32:35], a[52:55], v[20:23]
    ds_read_b128 v[32:35], v4 offset:24576
    v_mfma_f32_16x16x32_bf16 v[28:31], v[36:39], a[52:55], v[28:31]
    v_mfma_f32_16x16x32_bf16 v[24:27], v[36:39], a[48:51], v[24:27]
    ds_read_b128 v[36:39], v4 offset:24832
    v_mfma_f32_16x16x32_bf16 v[16:19], v[40:43], a[56:59], v[16:19]
    v_mfma_f32_16x16x32_bf16 v[20:23], v[40:43], a[60:63], v[20:23]
    ds_read_b128 v[40:43], v4 offset:26624
    v_mfma_f32_16x16x32_bf16 v[28:31], v[44:47], a[60:63], v[28:31]
    v_mfma_f32_16x16x32_bf16 v[24:27], v[44:47], a[56:59], v[24:27]
    ds_read_b128 v[44:47], v4 offset:26880
    s_waitcnt lgkmcnt(8)
    v_mfma_f32_16x16x32_bf16 v[16:19], v[48:51], a[64:67], v[16:19]
    v_mfma_f32_16x16x32_bf16 v[20:23], v[48:51], a[68:71], v[20:23]
    v_mfma_f32_16x16x32_bf16 v[28:31], v[52:55], a[68:71], v[28:31]
    v_mfma_f32_16x16x32_bf16 v[24:27], v[52:55], a[64:67], v[24:27]
    v_mfma_f32_16x16x32_bf16 v[16:19], v[56:59], a[72:75], v[16:19]
    v_mfma_f32_16x16x32_bf16 v[20:23], v[56:59], a[76:79], v[20:23]
    v_mfma_f32_16x16x32_bf16 v[28:31], v[60:63], a[76:79], v[28:31]
    v_mfma_f32_16x16x32_bf16 v[24:27], v[60:63], a[72:75], v[24:27]
    s_waitcnt lgkmcnt(4)
    v_mfma_f32_16x16x32_bf16 v[16:19], v[72:75], a[80:83], v[16:19]
    v_mfma_f32_16x16x32_bf16 v[20:23], v[72:75], a[84:87], v[20:23]
    v_mfma_f32_16x16x32_bf16 v[28:31], v[76:79], a[84:87], v[28:31]
    v_mfma_f32_16x16x32_bf16 v[24:27], v[76:79], a[80:83], v[24:27]
    v_mfma_f32_16x16x32_bf16 v[16:19], v[120:123], a[88:91], v[16:19]
    v_mfma_f32_16x16x32_bf16 v[20:23], v[120:123], a[92:95], v[20:23]
    v_mfma_f32_16x16x32_bf16 v[28:31], v[124:127], a[92:95], v[28:31]
    v_mfma_f32_16x16x32_bf16 v[24:27], v[124:127], a[88:91], v[24:27]
    s_waitcnt lgkmcnt(0)
    v_mfma_f32_16x16x32_bf16 v[16:19], v[32:35], a[96:99], v[16:19]
    v_mfma_f32_16x16x32_bf16 v[20:23], v[32:35], a[100:103], v[20:23]
    v_mfma_f32_16x16x32_bf16 v[28:31], v[36:39], a[100:103], v[28:31]
    v_mfma_f32_16x16x32_bf16 v[24:27], v[36:39], a[96:99], v[24:27]
    v_mfma_f32_16x16x32_bf16 v[16:19], v[40:43], a[104:107], v[16:19]
    v_mfma_f32_16x16x32_bf16 v[20:23], v[40:43], a[108:111], v[20:23]
    v_mfma_f32_16x16x32_bf16 v[28:31], v[44:47], a[108:111], v[28:31]
    v_mfma_f32_16x16x32_bf16 v[24:27], v[44:47], a[104:107], v[24:27]
    v_xor_b32 v4, 0x10000, v4
    s_setprio 0
    s_waitcnt vmcnt(0)
    s_lshl_b32 s67, s67, 1
    s_or_b32 s67, s67, 1
    s_add_u32 s60, s60, 1
    s_cmp_gt_u32 s66, s60
    s_cbranch_scc1 L_g_loop1_129
    s_barrier
    ds_read_b32 v14, v15
    s_waitcnt lgkmcnt(0)
    v_readfirstlane_b32 s66, v14
    s_barrier
    s_mov_b32 s69, 0
    s_cmp_gt_u32 s62, s60
    s_cbranch_scc1 L_g_nd_156
    s_cmp_ge_u32 s62, s66
    s_cbranch_scc1 L_g_nd_156
    s_add_u32 s47, s61, 4096
    s_add_u32 m0, s64, 0
    s_nop 0
    buffer_load_dwordx4 v3, s[12:15], s61 offen offset:0 sc1 lds
    buffer_load_dwordx4 v3, s[12:15], s61 offen offset:1024 sc1 lds
    buffer_load_dwordx4 v3, s[12:15], s61 offen offset:2048 sc1 lds
    buffer_load_dwordx4 v3, s[12:15], s61 offen offset:3072 sc1 lds
    s_add_u32 m0, s64, 4096
    s_nop 0
    buffer_load_dwordx4 v3, s[12:15], s47 offen offset:0 sc1 lds
    buffer_load_dwordx4 v3, s[12:15], s47 offen offset:1024 sc1 lds
    buffer_load_dwordx4 v3, s[12:15], s47 offen offset:2048 sc1 lds
    s_add_u32 s61, s61, 229376
    s_add_u32 s62, s62, 1
    s_xor_b32 s64, s64, 0x10000
    s_mov_b32 s69, 1
L_g_nd_156:
    s_sub_u32 s59, s60, 1
    ds_read_b128 v[80:83], v5 offset:0
    ds_read_b128 v[84:87], v5 offset:1024
    ds_read_b128 v[88:91], v5 offset:2048
    ds_read_b128 v[92:95], v5 offset:3072
    s_nop 7
    s_waitcnt lgkmcnt(3)
    v_add_f32 v80, v80, v16
    v_add_f32 v81, v81, v17
    v_add_f32 v82, v82, v18
    v_add_f32 v83, v83, v19
    s_waitcnt lgkmcnt(2)
    v_add_f32 v84, v84, v20
    v_add_f32 v85, v85, v21
    v_add_f32 v86, v86, v22
    v_add_f32 v87, v87, v23
    s_waitcnt lgkmcnt(1)
    v_add_f32 v88, v88, v24
    v_add_f32 v89, v89, v25
    v_add_f32 v90, v90, v26
    v_add_f32 v91, v91, v27
    s_waitcnt lgkmcnt(0)
    v_add_f32 v92, v92, v28
    v_add_f32 v93, v93, v29
    v_add_f32 v94, v94, v30
    v_add_f32 v95, v95, v31
    v_cvt_pk_bf16_f32 v104, v80, v81
    v_cvt_pk_bf16_f32 v105, v82, v83
    v_cvt_pk_bf16_f32 v106, v84, v85
    v_cvt_pk_bf16_f32 v107, v86, v87
    s_nop 1
    v_permlane16_swap_b32 v104, v106
    v_permlane16_swap_b32 v105, v107
    buffer_store_dwordx4 v[104:107], v8, s[12:15], s63 offen sc1
    v_cvt_pk_bf16_f32 v108, v88, v89
    v_cvt_pk_bf16_f32 v109, v90, v91
    v_cvt_pk_bf16_f32 v110, v92, v93
    v_cvt_pk_bf16_f32 v111, v94, v95
    s_nop 1
    v_permlane16_swap_b32 v108, v110
    v_permlane16_swap_b32 v109, v111
    buffer_store_dwordx4 v[108:111], v9, s[12:15], s63 offen sc1
    s_add_u32 s63, s63, 262144
    s_mov_b32 s67, 0
    s_mov_b32 s71, 1
    s_cmp_gt_u32 s66, s60
    s_cbranch_scc1 L_g_g1r_127
    v_mov_b32 v10, 1
    s_mov_b64 exec, 1
    s_waitcnt vmcnt(0)
    ds_add_rtn_u32 v10, v15, v10 offset:4
    s_waitcnt lgkmcnt(0)
    v_readfirstlane_b32 s46, v10
    s_mov_b64 exec, -1
    s_mov_b32 s71, 0
    s_sub_u32 s59, s60, 1
    s_cmp_lg_u32 s46, s68
    s_cbranch_scc1 L_g_df_157
    v_mov_b32 v10, s59
    v_add_u32 v10, 1, v10
    v_mov_b32 v11, 0
    s_mov_b64 exec, 1
    buffer_store_dword v10, v11, s[12:15], s52 offen sc1
    s_mov_b64 exec, -1
L_sf_158:
L_g_df_157:
    s_add_u32 s68, s68, 4
    s_cmp_gt_u32 s66, s60
    s_cbranch_scc1 L_g_g1r_127
L_g_tail_130:
    s_cmp_lt_u32 s60, s75
    s_cbranch_scc1 L_g_restart_125
    s_waitcnt vmcnt(0)
    s_barrier
    s_branch L_c_done_1
L_w_wo_12:
    s_load_dwordx2 s[4:5], s[0:1], 40
    s_load_dwordx2 s[6:7], s[0:1], 72
    s_and_b32 s50, s44, 3
    s_lshr_b32 s51, s44, 2
    s_waitcnt lgkmcnt(0)
    s_mov_b32 s24, s4
    s_and_b32 s25, s5, 0xffff
    s_mov_b32 s26, 0x800000
    s_mov_b32 s27, 0x00020000
    v_lshrrev_b32 v3, 4, v1
    v_and_b32 v4, 15, v1
    v_lshlrev_b32 v5, 2, v3
    v_xor_b32 v4, v4, v5
    v_mul_u32_u24 v3, 2048, v3
    v_lshl_add_u32 v3, v4, 4, v3
    s_mul_i32 s46, s51, 512
    s_mul_i32 s47, s50, 64
    s_add_u32 s46, s46, s47
    s_mul_i32 s47, s42, 1024
    s_add_u32 s46, s46, s47
    s_mul_i32 s46, s46, 2048
    s_lshl_b32 s47, s43, 8
    s_add_u32 s46, s46, s47
    s_lshl_b32 s45, s51, 16
    s_mul_i32 s47, s50, 16384
    s_add_u32 s45, s45, s47
    v_bfe_u32 v4, v1, 2, 2
    v_bfe_u32 v5, v1, 4, 1
    v_lshlrev_b32 v5, 1, v5
    v_bfe_u32 v6, v1, 1, 1
    v_add_u32 v5, v5, v6
    s_lshl_b32 s47, s50, 2
    v_add_u32 v5, s47, v5
    v_lshlrev_b32 v6, 2, v4
    v_xor_b32 v5, v5, v6
    v_lshlrev_b32 v5, 4, v5
    v_lshl_add_u32 v5, v4, 8, v5
    v_bfe_u32 v6, v1, 0, 1
    v_lshl_add_u32 v5, v6, 3, v5
    v_lshrrev_b32 v6, 5, v1
    v_mul_u32_u24 v6, 1024, v6
    v_add_u32 v5, v5, v6
    s_lshl_b32 s47, s51, 16
    v_add_u32 v5, s47, v5
    v_bfe_u32 v4, v1, 2, 2
    v_xor_b32 v5, s50, v4
    v_lshlrev_b32 v5, 6, v5
    v_lshl_add_u32 v5, v4, 8, v5
    v_and_b32 v6, 3, v1
    v_lshl_add_u32 v5, v6, 3, v5
    v_lshrrev_b32 v6, 4, v1
    v_lshl_add_u32 v5, v6, 10, v5
    v_lshrrev_b32 v6, 5, v1
    s_lshl_b32 s47, s51, 16
    v_add_u32 v5, s47, v5
    s_add_u32 m0, s45, 0
    s_add_u32 s47, s46, 0x0
    buffer_load_dwordx4 v3, s[24:27], s47 offen lds
    s_add_u32 m0, s45, 1024
    s_add_u32 s47, s46, 0x2000
    buffer_load_dwordx4 v3, s[24:27], s47 offen lds
    s_add_u32 m0, s45, 2048
    s_add_u32 s47, s46, 0x4000
    buffer_load_dwordx4 v3, s[24:27], s47 offen lds
    s_add_u32 m0, s45, 3072
    s_add_u32 s47, s46, 0x6000
    buffer_load_dwordx4 v3, s[24:27], s47 offen lds
    s_add_u32 m0, s45, 4096
    s_add_u32 s47, s46, 0x8000
    buffer_load_dwordx4 v3, s[24:27], s47 offen lds
    s_add_u32 m0, s45, 5120
    s_add_u32 s47, s46, 0xa000
    buffer_load_dwordx4 v3, s[24:27], s47 offen lds
    s_add_u32 m0, s45, 6144
    s_add_u32 s47, s46, 0xc000
    buffer_load_dwordx4 v3, s[24:27], s47 offen lds
    s_add_u32 m0, s45, 7168
    s_add_u32 s47, s46, 0xe000
    buffer_load_dwordx4 v3, s[24:27], s47 offen lds
    s_add_u32 m0, s45, 8192
    s_add_u32 s47, s46, 0x10000
    buffer_load_dwordx4 v3, s[24:27], s47 offen lds
    s_add_u32 m0, s45, 9216
    s_add_u32 s47, s46, 0x12000
    buffer_load_dwordx4 v3, s[24:27], s47 offen lds
    s_add_u32 m0, s45, 10240
    s_add_u32 s47, s46, 0x14000
    buffer_load_dwordx4 v3, s[24:27], s47 offen lds
    s_add_u32 m0, s45, 11264
    s_add_u32 s47, s46, 0x16000
    buffer_load_dwordx4 v3, s[24:27], s47 offen lds
    s_add_u32 m0, s45, 12288
    s_add_u32 s47, s46, 0x18000
    buffer_load_dwordx4 v3, s[24:27], s47 offen lds
    s_add_u32 m0, s45, 13312
    s_add_u32 s47, s46, 0x1a000
    buffer_load_dwordx4 v3, s[24:27], s47 offen lds
    s_add_u32 m0, s45, 14336
    s_add_u32 s47, s46, 0x1c000
    buffer_load_dwordx4 v3, s[24:27], s47 offen lds
    s_add_u32 m0, s45, 15360
    s_add_u32 s47, s46, 0x1e000
    buffer_load_dwordx4 v3, s[24:27], s47 offen lds
    s_waitcnt vmcnt(0)
    s_barrier
    ds_read_b64_tr_b16 a[0:1], v5 offset:0
    ds_read_b64_tr_b16 a[2:3], v5 offset:4096
    ds_read_b64_tr_b16 a[4:5], v5 offset:32
    ds_read_b64_tr_b16 a[6:7], v5 offset:4128
    ds_read_b64_tr_b16 a[8:9], v5 offset:8192
    ds_read_b64_tr_b16 a[10:11], v5 offset:12288
    ds_read_b64_tr_b16 a[12:13], v5 offset:8224
    ds_read_b64_tr_b16 a[14:15], v5 offset:12320
    s_waitcnt lgkmcnt(0)
    ds_read_b64_tr_b16 a[16:17], v5 offset:16384
    ds_read_b64_tr_b16 a[18:19], v5 offset:20480
    ds_read_b64_tr_b16 a[20:21], v5 offset:16416
    ds_read_b64_tr_b16 a[22:23], v5 offset:20512
    ds_read_b64_tr_b16 a[24:25], v5 offset:24576
    ds_read_b64_tr_b16 a[26:27], v5 offset:28672
    ds_read_b64_tr_b16 a[28:29], v5 offset:24608
    ds_read_b64_tr_b16 a[30:31], v5 offset:28704
    s_waitcnt lgkmcnt(0)
    ds_read_b64_tr_b16 a[32:33], v5 offset:32768
    ds_read_b64_tr_b16 a[34:35], v5 offset:36864
    ds_read_b64_tr_b16 a[36:37], v5 offset:32800
    ds_read_b64_tr_b16 a[38:39], v5 offset:36896
    ds_read_b64_tr_b16 a[40:41], v5 offset:40960
    ds_read_b64_tr_b16 a[42:43], v5 offset:45056
    ds_read_b64_tr_b16 a[44:45], v5 offset:40992
    ds_read_b64_tr_b16 a[46:47], v5 offset:45088
    s_waitcnt lgkmcnt(0)
    ds_read_b64_tr_b16 a[48:49], v5 offset:49152
    ds_read_b64_tr_b16 a[50:51], v5 offset:53248
    ds_read_b64_tr_b16 a[52:53], v5 offset:49184
    ds_read_b64_tr_b16 a[54:55], v5 offset:53280
    ds_read_b64_tr_b16 a[56:57], v5 offset:57344
    ds_read_b64_tr_b16 a[58:59], v5 offset:61440
    ds_read_b64_tr_b16 a[60:61], v5 offset:57376
    ds_read_b64_tr_b16 a[62:63], v5 offset:61472
    s_waitcnt lgkmcnt(0)
    s_waitcnt lgkmcnt(0)
    s_barrier
    s_add_u32 m0, s45, 0
    s_add_u32 s47, s46, 0x80000
    buffer_load_dwordx4 v3, s[24:27], s47 offen lds
    s_add_u32 m0, s45, 1024
    s_add_u32 s47, s46, 0x82000
    buffer_load_dwordx4 v3, s[24:27], s47 offen lds
    s_add_u32 m0, s45, 2048
    s_add_u32 s47, s46, 0x84000
    buffer_load_dwordx4 v3, s[24:27], s47 offen lds
    s_add_u32 m0, s45, 3072
    s_add_u32 s47, s46, 0x86000
    buffer_load_dwordx4 v3, s[24:27], s47 offen lds
    s_add_u32 m0, s45, 4096
    s_add_u32 s47, s46, 0x88000
    buffer_load_dwordx4 v3, s[24:27], s47 offen lds
    s_add_u32 m0, s45, 5120
    s_add_u32 s47, s46, 0x8a000
    buffer_load_dwordx4 v3, s[24:27], s47 offen lds
    s_add_u32 m0, s45, 6144
    s_add_u32 s47, s46, 0x8c000
    buffer_load_dwordx4 v3, s[24:27], s47 offen lds
    s_add_u32 m0, s45, 7168
    s_add_u32 s47, s46, 0x8e000
    buffer_load_dwordx4 v3, s[24:27], s47 offen lds
    s_add_u32 m0, s45, 8192
    s_add_u32 s47, s46, 0x90000
    buffer_load_dwordx4 v3, s[24:27], s47 offen lds
    s_add_u32 m0, s45, 9216
    s_add_u32 s47, s46, 0x92000
    buffer_load_dwordx4 v3, s[24:27], s47 offen lds
    s_add_u32 m0, s45, 10240
    s_add_u32 s47, s46, 0x94000
    buffer_load_dwordx4 v3, s[24:27], s47 offen lds
    s_add_u32 m0, s45, 11264
    s_add_u32 s47, s46, 0x96000
    buffer_load_dwordx4 v3, s[24:27], s47 offen lds
    s_add_u32 m0, s45, 12288
    s_add_u32 s47, s46, 0x98000
    buffer_load_dwordx4 v3, s[24:27], s47 offen lds
    s_add_u32 m0, s45, 13312
    s_add_u32 s47, s46, 0x9a000
    buffer_load_dwordx4 v3, s[24:27], s47 offen lds
    s_add_u32 m0, s45, 14336
    s_add_u32 s47, s46, 0x9c000
    buffer_load_dwordx4 v3, s[24:27], s47 offen lds
    s_add_u32 m0, s45, 15360
    s_add_u32 s47, s46, 0x9e000
    buffer_load_dwordx4 v3, s[24:27], s47 offen lds
    s_waitcnt vmcnt(0)
    s_barrier
    ds_read_b64_tr_b16 a[64:65], v5 offset:0
    ds_read_b64_tr_b16 a[66:67], v5 offset:4096
    ds_read_b64_tr_b16 a[68:69], v5 offset:32
    ds_read_b64_tr_b16 a[70:71], v5 offset:4128
    ds_read_b64_tr_b16 a[72:73], v5 offset:8192
    ds_read_b64_tr_b16 a[74:75], v5 offset:12288
    ds_read_b64_tr_b16 a[76:77], v5 offset:8224
    ds_read_b64_tr_b16 a[78:79], v5 offset:12320
    s_waitcnt lgkmcnt(0)
    ds_read_b64_tr_b16 a[80:81], v5 offset:16384
    ds_read_b64_tr_b16 a[82:83], v5 offset:20480
    ds_read_b64_tr_b16 a[84:85], v5 offset:16416
    ds_read_b64_tr_b16 a[86:87], v5 offset:20512
    ds_read_b64_tr_b16 a[88:89], v5 offset:24576
    ds_read_b64_tr_b16 a[90:91], v5 offset:28672
    ds_read_b64_tr_b16 a[92:93], v5 offset:24608
    ds_read_b64_tr_b16 a[94:95], v5 offset:28704
    s_waitcnt lgkmcnt(0)
    ds_read_b64_tr_b16 a[96:97], v5 offset:32768
    ds_read_b64_tr_b16 a[98:99], v5 offset:36864
    ds_read_b64_tr_b16 a[100:101], v5 offset:32800
    ds_read_b64_tr_b16 a[102:103], v5 offset:36896
    ds_read_b64_tr_b16 a[104:105], v5 offset:40960
    ds_read_b64_tr_b16 a[106:107], v5 offset:45056
    ds_read_b64_tr_b16 a[108:109], v5 offset:40992
    ds_read_b64_tr_b16 a[110:111], v5 offset:45088
    s_waitcnt lgkmcnt(0)
    ds_read_b64_tr_b16 a[112:113], v5 offset:49152
    ds_read_b64_tr_b16 a[114:115], v5 offset:53248
    ds_read_b64_tr_b16 a[116:117], v5 offset:49184
    ds_read_b64_tr_b16 a[118:119], v5 offset:53280
    ds_read_b64_tr_b16 a[120:121], v5 offset:57344
    ds_read_b64_tr_b16 a[122:123], v5 offset:61440
    ds_read_b64_tr_b16 a[124:125], v5 offset:57376
    ds_read_b64_tr_b16 a[126:127], v5 offset:61472
    s_waitcnt lgkmcnt(0)
    s_waitcnt lgkmcnt(0)
    s_barrier
    v_lshlrev_b32 v2, 4, v1
    s_mul_i32 s64, s44, 8192
    s_add_u32 s46, s64, 0x5000000
    s_mul_i32 s47, s42, 65536
    s_add_u32 s46, s46, s47
    v_add_u32 v3, s46, v2
    s_mul_i32 s46, s51, 32768
    v_add_u32 v4, s46, v2
    v_and_b32 v6, 15, v1
    v_lshlrev_b32 v6, 4, v6
    v_lshrrev_b32 v7, 4, v1
    v_lshl_add_u32 v6, v7, 9, v6
    v_add_u32 v4, s46, v6
    s_lshl_b32 s46, s50, 12
    s_add_u32 s46, s46, 131072
    v_add_u32 v5, s46, v2
    v_and_b32 v7, 7, v1
    v_lshlrev_b32 v7, 9, v7
    s_lshl_b32 s46, s42, 12
    s_add_u32 s46, s46, 0x102000
    v_add_u32 v7, s46, v7
    s_lshl_b32 s46, s42, 16
    s_lshl_b32 s47, s43, 11
    s_add_u32 s46, s46, s47
    s_lshl_b32 s47, s50, 9
    s_add_u32 s46, s46, s47
    s_add_u32 s46, s46, 0x9000000
    v_and_b32 v8, 31, v1
    v_lshlrev_b32 v8, 4, v8
    v_lshrrev_b32 v9, 5, v1
    v_lshl_add_u32 v8, v9, 14, v8
    v_add_u32 v8, s46, v8
    v_add_u32 v9, 0x8000, v8
    s_lshl_b32 s52, s43, 9
    s_lshl_b32 s47, s42, 7
    s_add_u32 s52, s52, s47
    s_add_u32 s52, s52, 0x107400
    s_add_u32 s52, s52, s76
    s_mov_b32 s60, s74
    s_mul_i32 s61, s74, 262144
    s_mov_b32 s62, s74
    s_mul_i32 s63, s74, 262144
    s_mov_b32 s67, 0
    s_mov_b32 s68, 3
    s_mov_b32 s71, 0
    v_mov_b32 v15, 147456
    v_mov_b32 v14, 0
    ds_write_b32 v15, v14 offset:4
    ds_write_b32 v15, v14 offset:12
    ds_write_b32 v15, v14 offset:16
    v_mov_b32 v114, 1
    s_mov_b32 s72, 0
L_g_restart_159:
    s_cmp_lg_u32 s44, 0
    s_cbranch_scc1 L_g_nsp_160
    s_mov_b32 s70, 0
L_g_sp_166:
    s_add_u32 s54, s60, 0
    s_add_u32 s55, s54, 0
    s_and_b32 s46, s55, 3
    s_lshl_b32 s46, s46, 7
    buffer_load_dword v11, v7, s[12:15], s46 offen sc1
    s_add_u32 s55, s54, 1
    s_and_b32 s46, s55, 3
    s_lshl_b32 s46, s46, 7
    buffer_load_dword v12, v7, s[12:15], s46 offen sc1
    s_add_u32 s55, s54, 2
    s_and_b32 s46, s55, 3
    s_lshl_b32 s46, s46, 7
    buffer_load_dword v13, v7, s[12:15], s46 offen sc1
    s_waitcnt vmcnt(0)
    v_cmp_ge_u32 vcc, s60, v11
    s_add_u32 s70, s70, 1
    s_cbranch_vccz L_g_sp_166_ok
    s_sleep 3
    s_cmp_lt_u32 s70, 524288
    s_cbranch_scc1 L_g_sp_166
    s_branch L_c_done_1
L_g_sp_166_ok:
    s_mov_b32 s46, s54
    v_cmp_ge_u32 vcc, s46, v11
    s_nop 0
    s_cbranch_vccnz L_g_le_167
    s_add_u32 s46, s46, 1
    v_cmp_ge_u32 vcc, s46, v12
    s_nop 0
    s_cbranch_vccnz L_g_le_167
    s_add_u32 s46, s46, 1
    v_cmp_ge_u32 vcc, s46, v13
    s_nop 0
    s_cbranch_vccnz L_g_le_167
    s_add_u32 s46, s46, 1
L_g_le_167:
    s_min_u32 s46, s46, s75
    v_mov_b32 v11, s46
    ds_write_b32 v15, v11
L_g_nsp_160:
    s_waitcnt lgkmcnt(0)
    s_barrier
    ds_read_b32 v14, v15
    s_waitcnt lgkmcnt(0)
    v_readfirstlane_b32 s66, v14
    s_nop 3
L_g_restart_159_go:
    s_mov_b32 s69, 0
    s_cmp_gt_u32 s62, s60
    s_cbranch_scc1 L_g_nd_168
    s_cmp_ge_u32 s62, s66
    s_cbranch_scc1 L_g_nd_168
    s_add_u32 s47, s61, 4096
    s_add_u32 m0, s64, 0
    s_nop 0
    buffer_load_dwordx4 v3, s[12:15], s61 offen offset:0 sc1 lds
    buffer_load_dwordx4 v3, s[12:15], s61 offen offset:1024 sc1 lds
    buffer_load_dwordx4 v3, s[12:15], s61 offen offset:2048 sc1 lds
    buffer_load_dwordx4 v3, s[12:15], s61 offen offset:3072 sc1 lds
    s_add_u32 m0, s64, 4096
    s_nop 0
    buffer_load_dwordx4 v3, s[12:15], s47 offen offset:0 sc1 lds
    buffer_load_dwordx4 v3, s[12:15], s47 offen offset:1024 sc1 lds
    buffer_load_dwordx4 v3, s[12:15], s47 offen offset:2048 sc1 lds
    buffer_load_dwordx4 v3, s[12:15], s47 offen offset:3072 sc1 lds
    s_add_u32 s61, s61, 262144
    s_add_u32 s62, s62, 1
    s_xor_b32 s64, s64, 0x10000
    s_mov_b32 s69, 1
L_g_nd_168:
    s_cmp_eq_u32 s51, 1
    s_cbranch_scc1 L_g_g1r_161
    s_add_u32 s59, s60, 1
    s_mov_b32 s69, 0
    s_cmp_gt_u32 s62, s59
    s_cbranch_scc1 L_g_nd_169
    s_cmp_ge_u32 s62, s66
    s_cbranch_scc1 L_g_nd_169
    s_add_u32 s47, s61, 4096
    s_add_u32 m0, s64, 0
    s_nop 0
    buffer_load_dwordx4 v3, s[12:15], s61 offen offset:0 sc1 lds
    buffer_load_dwordx4 v3, s[12:15], s61 offen offset:1024 sc1 lds
    buffer_load_dwordx4 v3, s[12:15], s61 offen offset:2048 sc1 lds
    buffer_load_dwordx4 v3, s[12:15], s61 offen offset:3072 sc1 lds
    s_add_u32 m0, s64, 4096
    s_nop 0
    buffer_load_dwordx4 v3, s[12:15], s47 offen offset:0 sc1 lds
    buffer_load_dwordx4 v3, s[12:15], s47 offen offset:1024 sc1 lds
    buffer_load_dwordx4 v3, s[12:15], s47 offen offset:2048 sc1 lds
    buffer_load_dwordx4 v3, s[12:15], s47 offen offset:3072 sc1 lds
    s_add_u32 s61, s61, 262144
    s_add_u32 s62, s62, 1
    s_xor_b32 s64, s64, 0x10000
    s_mov_b32 s69, 1
L_g_nd_169:
    s_cmp_eq_u32 s69, 1
    s_cbranch_scc1 L_g_w0_170
    s_waitcnt vmcnt(0)
L_g_w0_170:
    s_waitcnt vmcnt(8)
    s_mov_b32 s65, 1
.p2align 6
L_g_loop0_162:
    s_barrier
    s_cmp_eq_u32 s65, 0
    s_cbranch_scc1 L_g_pr_171
    ds_read_b128 v[32:35], v4 offset:0
    ds_read_b128 v[36:39], v4 offset:256
    ds_read_b128 v[40:43], v4 offset:2048
    ds_read_b128 v[44:47], v4 offset:2304
    ds_read_b128 v[48:51], v4 offset:4096
    ds_read_b128 v[52:55], v4 offset:4352
    ds_read_b128 v[56:59], v4 offset:6144
    ds_read_b128 v[60:63], v4 offset:6400
    ds_read_b128 v[72:75], v4 offset:8192
    ds_read_b128 v[76:79], v4 offset:8448
    ds_read_b128 v[120:123], v4 offset:10240
    ds_read_b128 v[124:127], v4 offset:10496
L_g_pr_171:
    ds_read_b32 v14, v15
    s_cmp_lg_u32 s44, 0
    s_cbranch_scc1 L_g_nl_172
    s_add_u32 s54, s60, 1
    s_add_u32 s55, s54, 0
    s_and_b32 s46, s55, 3
    s_lshl_b32 s46, s46, 7
    buffer_load_dword v11, v7, s[12:15], s46 offen sc1
    s_add_u32 s55, s54, 1
    s_and_b32 s46, s55, 3
    s_lshl_b32 s46, s46, 7
    buffer_load_dword v12, v7, s[12:15], s46 offen sc1
    s_add_u32 s55, s54, 2
    s_and_b32 s46, s55, 3
    s_lshl_b32 s46, s46, 7
    buffer_load_dword v13, v7, s[12:15], s46 offen sc1
L_g_nl_172:
    s_setprio 2
    s_waitcnt lgkmcnt(8)
    v_mfma_f32_16x16x32_bf16 v[16:19], v[32:35], a[0:3], 0
    v_mfma_f32_16x16x32_bf16 v[20:23], v[32:35], a[4:7], 0
    ds_read_b128 v[32:35], v4 offset:12288
    v_mfma_f32_16x16x32_bf16 v[28:31], v[36:39], a[4:7], 0
    v_mfma_f32_16x16x32_bf16 v[24:27], v[36:39], a[0:3], 0
    ds_read_b128 v[36:39], v4 offset:12544
    v_mfma_f32_16x16x32_bf16 v[16:19], v[40:43], a[8:11], v[16:19]
    v_mfma_f32_16x16x32_bf16 v[20:23], v[40:43], a[12:15], v[20:23]
    ds_read_b128 v[40:43], v4 offset:14336
    v_mfma_f32_16x16x32_bf16 v[28:31], v[44:47], a[12:15], v[28:31]
    v_mfma_f32_16x16x32_bf16 v[24:27], v[44:47], a[8:11], v[24:27]
    ds_read_b128 v[44:47], v4 offset:14592
    s_waitcnt lgkmcnt(8)
    v_mfma_f32_16x16x32_bf16 v[16:19], v[48:51], a[16:19], v[16:19]
    v_mfma_f32_16x16x32_bf16 v[20:23], v[48:51], a[20:23], v[20:23]
    ds_read_b128 v[48:51], v4 offset:16384
    v_mfma_f32_16x16x32_bf16 v[28:31], v[52:55], a[20:23], v[28:31]
    v_mfma_f32_16x16x32_bf16 v[24:27], v[52:55], a[16:19], v[24:27]
    ds_read_b128 v[52:55], v4 offset:16640
    v_mfma_f32_16x16x32_bf16 v[16:19], v[56:59], a[24:27], v[16:19]
    v_mfma_f32_16x16x32_bf16 v[20:23], v[56:59], a[28:31], v[20:23]
    ds_read_b128 v[56:59], v4 offset:18432
    v_mfma_f32_16x16x32_bf16 v[28:31], v[60:63], a[28:31], v[28:31]
    v_mfma_f32_16x16x32_bf16 v[24:27], v[60:63], a[24:27], v[24:27]
    ds_read_b128 v[60:63], v4 offset:18688
    s_waitcnt lgkmcnt(8)
    v_mfma_f32_16x16x32_bf16 v[16:19], v[72:75], a[32:35], v[16:19]
    v_mfma_f32_16x16x32_bf16 v[20:23], v[72:75], a[36:39], v[20:23]
    ds_read_b128 v[72:75], v4 offset:20480
    v_mfma_f32_16x16x32_bf16 v[28:31], v[76:79], a[36:39], v[28:31]
    v_mfma_f32_16x16x32_bf16 v[24:27], v[76:79], a[32:35], v[24:27]
    ds_read_b128 v[76:79], v4 offset:20736
    v_mfma_f32_16x16x32_bf16 v[16:19], v[120:123], a[40:43], v[16:19]
    v_mfma_f32_16x16x32_bf16 v[20:23], v[120:123], a[44:47], v[20:23]
    ds_read_b128 v[120:123], v4 offset:22528
    v_mfma_f32_16x16x32_bf16 v[28:31], v[124:127], a[44:47], v[28:31]
    v_mfma_f32_16x16x32_bf16 v[24:27], v[124:127], a[40:43], v[24:27]
    ds_read_b128 v[124:127], v4 offset:22784
    s_waitcnt lgkmcnt(8)
    v_mfma_f32_16x16x32_bf16 v[16:19], v[32:35], a[48:51], v[16:19]
    v_mfma_f32_16x16x32_bf16 v[20:23], v[32:35], a[52:55], v[20:23]
    ds_read_b128 v[32:35], v4 offset:24576
    v_mfma_f32_16x16x32_bf16 v[28:31], v[36:39], a[52:55], v[28:31]
    v_mfma_f32_16x16x32_bf16 v[24:27], v[36:39], a[48:51], v[24:27]
    ds_read_b128 v[36:39], v4 offset:24832
    v_mfma_f32_16x16x32_bf16 v[16:19], v[40:43], a[56:59], v[16:19]
    v_mfma_f32_16x16x32_bf16 v[20:23], v[40:43], a[60:63], v[20:23]
    ds_read_b128 v[40:43], v4 offset:26624
    v_mfma_f32_16x16x32_bf16 v[28:31], v[44:47], a[60:63], v[28:31]
    v_mfma_f32_16x16x32_bf16 v[24:27], v[44:47], a[56:59], v[24:27]
    ds_read_b128 v[44:47], v4 offset:26880
    s_waitcnt lgkmcnt(8)
    v_mfma_f32_16x16x32_bf16 v[16:19], v[48:51], a[64:67], v[16:19]
    v_mfma_f32_16x16x32_bf16 v[20:23], v[48:51], a[68:71], v[20:23]
    ds_read_b128 v[48:51], v4 offset:28672
    v_mfma_f32_16x16x32_bf16 v[28:31], v[52:55], a[68:71], v[28:31]
    v_mfma_f32_16x16x32_bf16 v[24:27], v[52:55], a[64:67], v[24:27]
    ds_read_b128 v[52:55], v4 offset:28928
    v_mfma_f32_16x16x32_bf16 v[16:19], v[56:59], a[72:75], v[16:19]
    v_mfma_f32_16x16x32_bf16 v[20:23], v[56:59], a[76:79], v[20:23]
    ds_read_b128 v[56:59], v4 offset:30720
    v_mfma_f32_16x16x32_bf16 v[28:31], v[60:63], a[76:79], v[28:31]
    v_mfma_f32_16x16x32_bf16 v[24:27], v[60:63], a[72:75], v[24:27]
    ds_read_b128 v[60:63], v4 offset:30976
    s_waitcnt lgkmcnt(8)
    v_mfma_f32_16x16x32_bf16 v[16:19], v[72:75], a[80:83], v[16:19]
    v_mfma_f32_16x16x32_bf16 v[20:23], v[72:75], a[84:87], v[20:23]
    v_mfma_f32_16x16x32_bf16 v[28:31], v[76:79], a[84:87], v[28:31]
    v_mfma_f32_16x16x32_bf16 v[24:27], v[76:79], a[80:83], v[24:27]
    v_mfma_f32_16x16x32_bf16 v[16:19], v[120:123], a[88:91], v[16:19]
    v_mfma_f32_16x16x32_bf16 v[20:23], v[120:123], a[92:95], v[20:23]
    v_mfma_f32_16x16x32_bf16 v[28:31], v[124:127], a[92:95], v[28:31]
    v_mfma_f32_16x16x32_bf16 v[24:27], v[124:127], a[88:91], v[24:27]
    s_waitcnt lgkmcnt(4)
    v_mfma_f32_16x16x32_bf16 v[16:19], v[32:35], a[96:99], v[16:19]
    v_mfma_f32_16x16x32_bf16 v[20:23], v[32:35], a[100:103], v[20:23]
    v_mfma_f32_16x16x32_bf16 v[28:31], v[36:39], a[100:103], v[28:31]
    v_mfma_f32_16x16x32_bf16 v[24:27], v[36:39], a[96:99], v[24:27]
    v_mfma_f32_16x16x32_bf16 v[16:19], v[40:43], a[104:107], v[16:19]
    v_mfma_f32_16x16x32_bf16 v[20:23], v[40:43], a[108:111], v[20:23]
    v_mfma_f32_16x16x32_bf16 v[28:31], v[44:47], a[108:111], v[28:31]
    v_mfma_f32_16x16x32_bf16 v[24:27], v[44:47], a[104:107], v[24:27]
    s_waitcnt lgkmcnt(0)
    v_mfma_f32_16x16x32_bf16 v[16:19], v[48:51], a[112:115], v[16:19]
    v_mfma_f32_16x16x32_bf16 v[20:23], v[48:51], a[116:119], v[20:23]
    v_mfma_f32_16x16x32_bf16 v[28:31], v[52:55], a[116:119], v[28:31]
    v_mfma_f32_16x16x32_bf16 v[24:27], v[52:55], a[112:115], v[24:27]
    v_mfma_f32_16x16x32_bf16 v[16:19], v[56:59], a[120:123], v[16:19]
    v_mfma_f32_16x16x32_bf16 v[20:23], v[56:59], a[124:127], v[20:23]
    v_mfma_f32_16x16x32_bf16 v[28:31], v[60:63], a[124:127], v[28:31]
    v_mfma_f32_16x16x32_bf16 v[24:27], v[60:63], a[120:123], v[24:27]
    v_xor_b32 v4, 0x10000, v4
    s_setprio 0
    s_waitcnt vmcnt(0)
    v_readfirstlane_b32 s66, v14
    s_barrier
    s_nop 6
    ds_write_b128 v5, v[16:19] offset:0
    ds_write_b128 v5, v[20:23] offset:1024
    ds_write_b128 v5, v[24:27] offset:2048
    ds_write_b128 v5, v[28:31] offset:3072
    s_cmp_lg_u32 s44, 0
    s_cbranch_scc1 L_g_ne_173
    s_mov_b32 s46, s54
    v_cmp_ge_u32 vcc, s46, v11
    s_nop 0
    s_cbranch_vccnz L_g_le_176
    s_add_u32 s46, s46, 1
    v_cmp_ge_u32 vcc, s46, v12
    s_nop 0
    s_cbranch_vccnz L_g_le_176
    s_add_u32 s46, s46, 1
    v_cmp_ge_u32 vcc, s46, v13
    s_nop 0
    s_cbranch_vccnz L_g_le_176
    s_add_u32 s46, s46, 1
L_g_le_176:
    s_min_u32 s46, s46, s75
    v_mov_b32 v11, s46
    ds_write_b32 v15, v11
L_g_ne_173:
    s_add_u32 s60, s60, 1
    s_mov_b32 s69, 0
    s_cmp_gt_u32 s62, s60
    s_cbranch_scc1 L_g_nd_177
    s_cmp_ge_u32 s62, s66
    s_cbranch_scc1 L_g_nd_177
    s_add_u32 s47, s61, 4096
    s_add_u32 m0, s64, 0
    s_nop 0
    buffer_load_dwordx4 v3, s[12:15], s61 offen offset:0 sc1 lds
    buffer_load_dwordx4 v3, s[12:15], s61 offen offset:1024 sc1 lds
    buffer_load_dwordx4 v3, s[12:15], s61 offen offset:2048 sc1 lds
    buffer_load_dwordx4 v3, s[12:15], s61 offen offset:3072 sc1 lds
    s_add_u32 m0, s64, 4096
    s_nop 0
    buffer_load_dwordx4 v3, s[12:15], s47 offen offset:0 sc1 lds
    buffer_load_dwordx4 v3, s[12:15], s47 offen offset:1024 sc1 lds
    buffer_load_dwordx4 v3, s[12:15], s47 offen offset:2048 sc1 lds
    buffer_load_dwordx4 v3, s[12:15], s47 offen offset:3072 sc1 lds
    s_add_u32 s61, s61, 262144
    s_add_u32 s62, s62, 1
    s_xor_b32 s64, s64, 0x10000
    s_mov_b32 s69, 1
L_g_nd_177:
    s_mov_b32 s65, s69
    s_add_u32 s59, s60, 1
    s_mov_b32 s69, 0
    s_cmp_gt_u32 s62, s59
    s_cbranch_scc1 L_g_nd_178
    s_cmp_ge_u32 s62, s66
    s_cbranch_scc1 L_g_nd_178
    s_add_u32 s47, s61, 4096
    s_add_u32 m0, s64, 0
    s_nop 0
    buffer_load_dwordx4 v3, s[12:15], s61 offen offset:0 sc1 lds
    buffer_load_dwordx4 v3, s[12:15], s61 offen offset:1024 sc1 lds
    buffer_load_dwordx4 v3, s[12:15], s61 offen offset:2048 sc1 lds
    buffer_load_dwordx4 v3, s[12:15], s61 offen offset:3072 sc1 lds
    s_add_u32 m0, s64, 4096
    s_nop 0
    buffer_load_dwordx4 v3, s[12:15], s47 offen offset:0 sc1 lds
    buffer_load_dwordx4 v3, s[12:15], s47 offen offset:1024 sc1 lds
    buffer_load_dwordx4 v3, s[12:15], s47 offen offset:2048 sc1 lds
    buffer_load_dwordx4 v3, s[12:15], s47 offen offset:3072 sc1 lds
    s_add_u32 s61, s61, 262144
    s_add_u32 s62, s62, 1
    s_xor_b32 s64, s64, 0x10000
    s_mov_b32 s69, 1
L_g_nd_178:
    s_cmp_le_u32 s66, s60
    s_cbranch_scc1 L_g_ex0_175
    s_cmp_eq_u32 s65, 0
    s_cbranch_scc1 L_g_nw_174
    s_waitcnt vmcnt(0) lgkmcnt(0)
    s_branch L_g_loop0_162
L_g_nw_174:
    ds_read_b128 v[32:35], v4 offset:0
    ds_read_b128 v[36:39], v4 offset:256
    ds_read_b128 v[40:43], v4 offset:2048
    ds_read_b128 v[44:47], v4 offset:2304
    ds_read_b128 v[48:51], v4 offset:4096
    ds_read_b128 v[52:55], v4 offset:4352
    ds_read_b128 v[56:59], v4 offset:6144
    ds_read_b128 v[60:63], v4 offset:6400
    ds_read_b128 v[72:75], v4 offset:8192
    ds_read_b128 v[76:79], v4 offset:8448
    ds_read_b128 v[120:123], v4 offset:10240
    ds_read_b128 v[124:127], v4 offset:10496
    s_waitcnt lgkmcnt(12)
    s_branch L_g_loop0_162
L_g_ex0_175:
    s_cmp_lg_u32 s44, 0
    s_cbranch_scc1 L_g_ex0_175_n
    s_sleep 6
    s_add_u32 s54, s60, 0
    s_add_u32 s55, s54, 0
    s_and_b32 s46, s55, 3
    s_lshl_b32 s46, s46, 7
    buffer_load_dword v11, v7, s[12:15], s46 offen sc1
    s_add_u32 s55, s54, 1
    s_and_b32 s46, s55, 3
    s_lshl_b32 s46, s46, 7
    buffer_load_dword v12, v7, s[12:15], s46 offen sc1
    s_add_u32 s55, s54, 2
    s_and_b32 s46, s55, 3
    s_lshl_b32 s46, s46, 7
    buffer_load_dword v13, v7, s[12:15], s46 offen sc1
    s_waitcnt vmcnt(0)
    s_mov_b32 s46, s54
    v_cmp_ge_u32 vcc, s46, v11
    s_nop 0
    s_cbranch_vccnz L_g_le_179
    s_add_u32 s46, s46, 1
    v_cmp_ge_u32 vcc, s46, v12
    s_nop 0
    s_cbranch_vccnz L_g_le_179
    s_add_u32 s46, s46, 1
    v_cmp_ge_u32 vcc, s46, v13
    s_nop 0
    s_cbranch_vccnz L_g_le_179
    s_add_u32 s46, s46, 1
L_g_le_179:
    s_min_u32 s46, s46, s75
    v_mov_b32 v11, s46
    ds_write_b32 v15, v11
L_g_ex0_175_n:
    s_waitcnt lgkmcnt(0)
    s_barrier
    ds_read_b32 v14, v15
    s_waitcnt lgkmcnt(0)
    v_readfirstlane_b32 s66, v14
    s_barrier
    s_cmp_gt_u32 s66, s60
    s_cbranch_scc1 L_g_restart_159_go
    s_branch L_g_tail_164
L_g_g1r_161:
    s_mov_b32 s65, 1
    s_branch L_g_loop1_163_e
.p2align 6
L_g_loop1_163:
    s_mov_b32 s65, 0
L_g_loop1_163_e:
    s_barrier
    ds_read_b32 v14, v15
    s_bitcmp1_b32 s67, 1
    s_cbranch_scc0 L_g_nfl_180
    s_sub_u32 s59, s60, 2
    s_cmp_lg_u32 s44, 4
    s_cbranch_scc1 L_sf_185
    v_mov_b32 v10, s59
    v_add_u32 v10, 1, v10
    v_mov_b32 v11, 0
    s_mov_b64 exec, 1
    buffer_store_dword v10, v11, s[12:15], s52 offen sc1
    s_mov_b64 exec, -1
L_sf_185:
L_g_nfl_180:
    s_cmp_eq_u32 s71, 0
    s_cbranch_scc1 L_g_nfl_180_d
    v_mov_b32 v10, 1
    s_mov_b64 exec, 1
    s_waitcnt vmcnt(0)
    ds_add_rtn_u32 v10, v15, v10 offset:4
    s_waitcnt lgkmcnt(0)
    v_readfirstlane_b32 s46, v10
    s_mov_b64 exec, -1
    s_mov_b32 s71, 0
    s_sub_u32 s59, s60, 1
    s_cmp_lg_u32 s46, s68
    s_cbranch_scc1 L_g_df_186
    v_mov_b32 v10, s59
    v_add_u32 v10, 1, v10
    v_mov_b32 v11, 0
    s_mov_b64 exec, 1
    buffer_store_dword v10, v11, s[12:15], s52 offen sc1
    s_mov_b64 exec, -1
L_sf_187:
L_g_df_186:
    s_add_u32 s68, s68, 4
    s_mov_b32 s65, 2
L_g_nfl_180_d:
    s_waitcnt lgkmcnt(0)
    v_readfirstlane_b32 s66, v14
    s_nop 3
    s_mov_b32 s69, 0
    s_cmp_gt_u32 s62, s60
    s_cbranch_scc1 L_g_nd_188
    s_cmp_ge_u32 s62, s66
    s_cbranch_scc1 L_g_nd_188
    s_add_u32 s47, s61, 4096
    s_add_u32 m0, s64, 0
    s_nop 0
    buffer_load_dwordx4 v3, s[12:15], s61 offen offset:0 sc1 lds
    buffer_load_dwordx4 v3, s[12:15], s61 offen offset:1024 sc1 lds
    buffer_load_dwordx4 v3, s[12:15], s61 offen offset:2048 sc1 lds
    buffer_load_dwordx4 v3, s[12:15], s61 offen offset:3072 sc1 lds
    s_add_u32 m0, s64, 4096
    s_nop 0
    buffer_load_dwordx4 v3, s[12:15], s47 offen offset:0 sc1 lds
    buffer_load_dwordx4 v3, s[12:15], s47 offen offset:1024 sc1 lds
    buffer_load_dwordx4 v3, s[12:15], s47 offen offset:2048 sc1 lds
    buffer_load_dwordx4 v3, s[12:15], s47 offen offset:3072 sc1 lds
    s_add_u32 s61, s61, 262144
    s_add_u32 s62, s62, 1
    s_xor_b32 s64, s64, 0x10000
    s_mov_b32 s69, 1
L_g_nd_188:
    s_or_b32 s65, s65, s69
    s_add_u32 s59, s60, 1
    s_mov_b32 s69, 0
    s_cmp_gt_u32 s62, s59
    s_cbranch_scc1 L_g_nd_189
    s_cmp_ge_u32 s62, s66
    s_cbranch_scc1 L_g_nd_189
    s_add_u32 s47, s61, 4096
    s_add_u32 m0, s64, 0
    s_nop 0
    buffer_load_dwordx4 v3, s[12:15], s61 offen offset:0 sc1 lds
    buffer_load_dwordx4 v3, s[12:15], s61 offen offset:1024 sc1 lds
    buffer_load_dwordx4 v3, s[12:15], s61 offen offset:2048 sc1 lds
    buffer_load_dwordx4 v3, s[12:15], s61 offen offset:3072 sc1 lds
    s_add_u32 m0, s64, 4096
    s_nop 0
    buffer_load_dwordx4 v3, s[12:15], s47 offen offset:0 sc1 lds
    buffer_load_dwordx4 v3, s[12:15], s47 offen offset:1024 sc1 lds
    buffer_load_dwordx4 v3, s[12:15], s47 offen offset:2048 sc1 lds
    buffer_load_dwordx4 v3, s[12:15], s47 offen offset:3072 sc1 lds
    s_add_u32 s61, s61, 262144
    s_add_u32 s62, s62, 1
    s_xor_b32 s64, s64, 0x10000
    s_mov_b32 s69, 1
L_g_nd_189:
    s_bitcmp1_b32 s67, 0
    s_cbranch_scc0 L_g_nep_181
    ds_read_b128 v[80:83], v5 offset:0
    ds_read_b128 v[84:87], v5 offset:1024
    ds_read_b128 v[88:91], v5 offset:2048
    ds_read_b128 v[92:95], v5 offset:3072
    s_nop 7
    s_waitcnt lgkmcnt(3)
    v_add_f32 v80, v80, v16
    v_add_f32 v81, v81, v17
    v_add_f32 v82, v82, v18
    v_add_f32 v83, v83, v19
    s_waitcnt lgkmcnt(2)
    v_add_f32 v84, v84, v20
    v_add_f32 v85, v85, v21
    v_add_f32 v86, v86, v22
    v_add_f32 v87, v87, v23
    s_waitcnt lgkmcnt(1)
    v_add_f32 v88, v88, v24
    v_add_f32 v89, v89, v25
    v_add_f32 v90, v90, v26
    v_add_f32 v91, v91, v27
    s_waitcnt lgkmcnt(0)
    v_add_f32 v92, v92, v28
    v_add_f32 v93, v93, v29
    v_add_f32 v94, v94, v30
    v_add_f32 v95, v95, v31
    v_cvt_pk_bf16_f32 v104, v80, v81
    v_cvt_pk_bf16_f32 v105, v82, v83
    v_cvt_pk_bf16_f32 v106, v84, v85
    v_cvt_pk_bf16_f32 v107, v86, v87
    s_nop 1
    v_permlane16_swap_b32 v104, v106
    v_permlane16_swap_b32 v105, v107
    buffer_store_dwordx4 v[104:107], v8, s[12:15], s63 offen sc1
    v_cvt_pk_bf16_f32 v108, v88, v89
    v_cvt_pk_bf16_f32 v109, v90, v91
    v_cvt_pk_bf16_f32 v110, v92, v93
    v_cvt_pk_bf16_f32 v111, v94, v95
    s_nop 1
    v_permlane16_swap_b32 v108, v110
    v_permlane16_swap_b32 v109, v111
    buffer_store_dwordx4 v[108:111], v9, s[12:15], s63 offen sc1
    s_add_u32 s63, s63, 262144
L_g_nep_181:
    s_cmp_eq_u32 s65, 0
    s_cbranch_scc1 L_g_nw1_182
    s_cmp_eq_u32 s65, 2
    s_cbranch_scc1 L_g_nw1_182_w
    s_waitcnt vmcnt(0)
L_g_nw1_182_w:
    s_barrier
    ds_read_b128 v[32:35], v4 offset:0
    ds_read_b128 v[36:39], v4 offset:256
    ds_read_b128 v[40:43], v4 offset:2048
    ds_read_b128 v[44:47], v4 offset:2304
    ds_read_b128 v[48:51], v4 offset:4096
    ds_read_b128 v[52:55], v4 offset:4352
    ds_read_b128 v[56:59], v4 offset:6144
    ds_read_b128 v[60:63], v4 offset:6400
    ds_read_b128 v[72:75], v4 offset:8192
    ds_read_b128 v[76:79], v4 offset:8448
    ds_read_b128 v[120:123], v4 offset:10240
    ds_read_b128 v[124:127], v4 offset:10496
    s_branch L_g_jn_184
L_g_nw1_182:
    ds_read_b128 v[32:35], v4 offset:0
    ds_read_b128 v[36:39], v4 offset:256
    ds_read_b128 v[40:43], v4 offset:2048
    ds_read_b128 v[44:47], v4 offset:2304
    ds_read_b128 v[48:51], v4 offset:4096
    ds_read_b128 v[52:55], v4 offset:4352
    ds_read_b128 v[56:59], v4 offset:6144
    ds_read_b128 v[60:63], v4 offset:6400
    ds_read_b128 v[72:75], v4 offset:8192
    ds_read_b128 v[76:79], v4 offset:8448
    ds_read_b128 v[120:123], v4 offset:10240
    ds_read_b128 v[124:127], v4 offset:10496
    s_barrier
L_g_jn_184:
    s_setprio 1
    s_waitcnt lgkmcnt(8)
    v_mfma_f32_16x16x32_bf16 v[16:19], v[32:35], a[0:3], 0
    v_mfma_f32_16x16x32_bf16 v[20:23], v[32:35], a[4:7], 0
    ds_read_b128 v[32:35], v4 offset:12288
    v_mfma_f32_16x16x32_bf16 v[28:31], v[36:39], a[4:7], 0
    v_mfma_f32_16x16x32_bf16 v[24:27], v[36:39], a[0:3], 0
    ds_read_b128 v[36:39], v4 offset:12544
    v_mfma_f32_16x16x32_bf16 v[16:19], v[40:43], a[8:11], v[16:19]
    v_mfma_f32_16x16x32_bf16 v[20:23], v[40:43], a[12:15], v[20:23]
    ds_read_b128 v[40:43], v4 offset:14336
    v_mfma_f32_16x16x32_bf16 v[28:31], v[44:47], a[12:15], v[28:31]
    v_mfma_f32_16x16x32_bf16 v[24:27], v[44:47], a[8:11], v[24:27]
    ds_read_b128 v[44:47], v4 offset:14592
    s_waitcnt lgkmcnt(8)
    v_mfma_f32_16x16x32_bf16 v[16:19], v[48:51], a[16:19], v[16:19]
    v_mfma_f32_16x16x32_bf16 v[20:23], v[48:51], a[20:23], v[20:23]
    ds_read_b128 v[48:51], v4 offset:16384
    v_mfma_f32_16x16x32_bf16 v[28:31], v[52:55], a[20:23], v[28:31]
    v_mfma_f32_16x16x32_bf16 v[24:27], v[52:55], a[16:19], v[24:27]
    ds_read_b128 v[52:55], v4 offset:16640
    v_mfma_f32_16x16x32_bf16 v[16:19], v[56:59], a[24:27], v[16:19]
    v_mfma_f32_16x16x32_bf16 v[20:23], v[56:59], a[28:31], v[20:23]
    ds_read_b128 v[56:59], v4 offset:18432
    v_mfma_f32_16x16x32_bf16 v[28:31], v[60:63], a[28:31], v[28:31]
    v_mfma_f32_16x16x32_bf16 v[24:27], v[60:63], a[24:27], v[24:27]
    ds_read_b128 v[60:63], v4 offset:18688
    s_waitcnt lgkmcnt(8)
    v_mfma_f32_16x16x32_bf16 v[16:19], v[72:75], a[32:35], v[16:19]
    v_mfma_f32_16x16x32_bf16 v[20:23], v[72:75], a[36:39], v[20:23]
    ds_read_b128 v[72:75], v4 offset:20480
    v_mfma_f32_16x16x32_bf16 v[28:31], v[76:79], a[36:39], v[28:31]
    v_mfma_f32_16x16x32_bf16 v[24:27], v[76:79], a[32:35], v[24:27]
    ds_read_b128 v[76:79], v4 offset:20736
    v_mfma_f32_16x16x32_bf16 v[16:19], v[120:123], a[40:43], v[16:19]
    v_mfma_f32_16x16x32_bf16 v[20:23], v[120:123], a[44:47], v[20:23]
    ds_read_b128 v[120:123], v4 offset:22528
    v_mfma_f32_16x16x32_bf16 v[28:31], v[124:127], a[44:47], v[28:31]
    v_mfma_f32_16x16x32_bf16 v[24:27], v[124:127], a[40:43], v[24:27]
    ds_read_b128 v[124:127], v4 offset:22784
    s_waitcnt lgkmcnt(8)
    v_mfma_f32_16x16x32_bf16 v[16:19], v[32:35], a[48:51], v[16:19]
    v_mfma_f32_16x16x32_bf16 v[20:23], v[32:35], a[52:55], v[20:23]
    ds_read_b128 v[32:35], v4 offset:24576
    v_mfma_f32_16x16x32_bf16 v[28:31], v[36:39], a[52:55], v[28:31]
    v_mfma_f32_16x16x32_bf16 v[24:27], v[36:39], a[48:51], v[24:27]
    ds_read_b128 v[36:39], v4 offset:24832
    v_mfma_f32_16x16x32_bf16 v[16:19], v[40:43], a[56:59], v[16:19]
    v_mfma_f32_16x16x32_bf16 v[20:23], v[40:43], a[60:63], v[20:23]
    ds_read_b128 v[40:43], v4 offset:26624
    v_mfma_f32_16x16x32_bf16 v[28:31], v[44:47], a[60:63], v[28:31]
    v_mfma_f32_16x16x32_bf16 v[24:27], v[44:47], a[56:59], v[24:27]
    ds_read_b128 v[44:47], v4 offset:26880
    s_waitcnt lgkmcnt(8)
    v_mfma_f32_16x16x32_bf16 v[16:19], v[48:51], a[64:67], v[16:19]
    v_mfma_f32_16x16x32_bf16 v[20:23], v[48:51], a[68:71], v[20:23]
    ds_read_b128 v[48:51], v4 offset:28672
    v_mfma_f32_16x16x32_bf16 v[28:31], v[52:55], a[68:71], v[28:31]
    v_mfma_f32_16x16x32_bf16 v[24:27], v[52:55], a[64:67], v[24:27]
    ds_read_b128 v[52:55], v4 offset:28928
    v_mfma_f32_16x16x32_bf16 v[16:19], v[56:59], a[72:75], v[16:19]
    v_mfma_f32_16x16x32_bf16 v[20:23], v[56:59], a[76:79], v[20:23]
    ds_read_b128 v[56:59], v4 offset:30720
    v_mfma_f32_16x16x32_bf16 v[28:31], v[60:63], a[76:79], v[28:31]
    v_mfma_f32_16x16x32_bf16 v[24:27], v[60:63], a[72:75], v[24:27]
    ds_read_b128 v[60:63], v4 offset:30976
    s_waitcnt lgkmcnt(8)
    v_mfma_f32_16x16x32_bf16 v[16:19], v[72:75], a[80:83], v[16:19]
    v_mfma_f32_16x16x32_bf16 v[20:23], v[72:75], a[84:87], v[20:23]
    v_mfma_f32_16x16x32_bf16 v[28:31], v[76:79], a[84:87], v[28:31]
    v_mfma_f32_16x16x32_bf16 v[24:27], v[76:79], a[80:83], v[24:27]
    v_mfma_f32_16x16x32_bf16 v[16:19], v[120:123], a[88:91], v[16:19]
    v_mfma_f32_16x16x32_bf16 v[20:23], v[120:123], a[92:95], v[20:23]
    v_mfma_f32_16x16x32_bf16 v[28:31], v[124:127], a[92:95], v[28:31]
    v_mfma_f32_16x16x32_bf16 v[24:27], v[124:127], a[88:91], v[24:27]
    s_waitcnt lgkmcnt(4)
    v_mfma_f32_16x16x32_bf16 v[16:19], v[32:35], a[96:99], v[16:19]
    v_mfma_f32_16x16x32_bf16 v[20:23], v[32:35], a[100:103], v[20:23]
    v_mfma_f32_16x16x32_bf16 v[28:31], v[36:39], a[100:103], v[28:31]
    v_mfma_f32_16x16x32_bf16 v[24:27], v[36:39], a[96:99], v[24:27]
    v_mfma_f32_16x16x32_bf16 v[16:19], v[40:43], a[104:107], v[16:19]
    v_mfma_f32_16x16x32_bf16 v[20:23], v[40:43], a[108:111], v[20:23]
    v_mfma_f32_16x16x32_bf16 v[28:31], v[44:47], a[108:111], v[28:31]
    v_mfma_f32_16x16x32_bf16 v[24:27], v[44:47], a[104:107], v[24:27]
    s_waitcnt lgkmcnt(0)
    v_mfma_f32_16x16x32_bf16 v[16:19], v[48:51], a[112:115], v[16:19]
    v_mfma_f32_16x16x32_bf16 v[20:23], v[48:51], a[116:119], v[20:23]
    v_mfma_f32_16x16x32_bf16 v[28:31], v[52:55], a[116:119], v[28:31]
    v_mfma_f32_16x16x32_bf16 v[24:27], v[52:55], a[112:115], v[24:27]
    v_mfma_f32_16x16x32_bf16 v[16:19], v[56:59], a[120:123], v[16:19]
    v_mfma_f32_16x16x32_bf16 v[20:23], v[56:59], a[124:127], v[20:23]
    v_mfma_f32_16x16x32_bf16 v[28:31], v[60:63], a[124:127], v[28:31]
    v_mfma_f32_16x16x32_bf16 v[24:27], v[60:63], a[120:123], v[24:27]
    v_xor_b32 v4, 0x10000, v4
    s_setprio 0
    s_waitcnt vmcnt(0)
    s_lshl_b32 s67, s67, 1
    s_or_b32 s67, s67, 1
    s_add_u32 s60, s60, 1
    s_cmp_gt_u32 s66, s60
    s_cbranch_scc1 L_g_loop1_163
    s_barrier
    ds_read_b32 v14, v15
    s_waitcnt lgkmcnt(0)
    v_readfirstlane_b32 s66, v14
    s_barrier
    s_mov_b32 s69, 0
    s_cmp_gt_u32 s62, s60
    s_cbranch_scc1 L_g_nd_190
    s_cmp_ge_u32 s62, s66
    s_cbranch_scc1 L_g_nd_190
    s_add_u32 s47, s61, 4096
    s_add_u32 m0, s64, 0
    s_nop 0
    buffer_load_dwordx4 v3, s[12:15], s61 offen offset:0 sc1 lds
    buffer_load_dwordx4 v3, s[12:15], s61 offen offset:1024 sc1 lds
    buffer_load_dwordx4 v3, s[12:15], s61 offen offset:2048 sc1 lds
    buffer_load_dwordx4 v3, s[12:15], s61 offen offset:3072 sc1 lds
    s_add_u32 m0, s64, 4096
    s_nop 0
    buffer_load_dwordx4 v3, s[12:15], s47 offen offset:0 sc1 lds
    buffer_load_dwordx4 v3, s[12:15], s47 offen offset:1024 sc1 lds
    buffer_load_dwordx4 v3, s[12:15], s47 offen offset:2048 sc1 lds
    buffer_load_dwordx4 v3, s[12:15], s47 offen offset:3072 sc1 lds
    s_add_u32 s61, s61, 262144
    s_add_u32 s62, s62, 1
    s_xor_b32 s64, s64, 0x10000
    s_mov_b32 s69, 1
L_g_nd_190:
    s_sub_u32 s59, s60, 1
    ds_read_b128 v[80:83], v5 offset:0
    ds_read_b128 v[84:87], v5 offset:1024
    ds_read_b128 v[88:91], v5 offset:2048
    ds_read_b128 v[92:95], v5 offset:3072
    s_nop 7
    s_waitcnt lgkmcnt(3)
    v_add_f32 v80, v80, v16
    v_add_f32 v81, v81, v17
    v_add_f32 v82, v82, v18
    v_add_f32 v83, v83, v19
    s_waitcnt lgkmcnt(2)
    v_add_f32 v84, v84, v20
    v_add_f32 v85, v85, v21
    v_add_f32 v86, v86, v22
    v_add_f32 v87, v87, v23
    s_waitcnt lgkmcnt(1)
    v_add_f32 v88, v88, v24
    v_add_f32 v89, v89, v25
    v_add_f32 v90, v90, v26
    v_add_f32 v91, v91, v27
    s_waitcnt lgkmcnt(0)
    v_add_f32 v92, v92, v28
    v_add_f32 v93, v93, v29
    v_add_f32 v94, v94, v30
    v_add_f32 v95, v95, v31
    v_cvt_pk_bf16_f32 v104, v80, v81
    v_cvt_pk_bf16_f32 v105, v82, v83
    v_cvt_pk_bf16_f32 v106, v84, v85
    v_cvt_pk_bf16_f32 v107, v86, v87
    s_nop 1
    v_permlane16_swap_b32 v104, v106
    v_permlane16_swap_b32 v105, v107
    buffer_store_dwordx4 v[104:107], v8, s[12:15], s63 offen sc1
    v_cvt_pk_bf16_f32 v108, v88, v89
    v_cvt_pk_bf16_f32 v109, v90, v91
    v_cvt_pk_bf16_f32 v110, v92, v93
    v_cvt_pk_bf16_f32 v111, v94, v95
    s_nop 1
    v_permlane16_swap_b32 v108, v110
    v_permlane16_swap_b32 v109, v111
    buffer_store_dwordx4 v[108:111], v9, s[12:15], s63 offen sc1
    s_add_u32 s63, s63, 262144
    s_mov_b32 s67, 0
    s_mov_b32 s71, 1
    s_cmp_gt_u32 s66, s60
    s_cbranch_scc1 L_g_g1r_161
    v_mov_b32 v10, 1
    s_mov_b64 exec, 1
    s_waitcnt vmcnt(0)
    ds_add_rtn_u32 v10, v15, v10 offset:4
    s_waitcnt lgkmcnt(0)
    v_readfirstlane_b32 s46, v10
    s_mov_b64 exec, -1
    s_mov_b32 s71, 0
    s_sub_u32 s59, s60, 1
    s_cmp_lg_u32 s46, s68
    s_cbranch_scc1 L_g_df_191
    v_mov_b32 v10, s59
    v_add_u32 v10, 1, v10
    v_mov_b32 v11, 0
    s_mov_b64 exec, 1
    buffer_store_dword v10, v11, s[12:15], s52 offen sc1
    s_mov_b64 exec, -1
L_sf_192:
L_g_df_191:
    s_add_u32 s68, s68, 4
    s_cmp_gt_u32 s66, s60
    s_cbranch_scc1 L_g_g1r_161
L_g_tail_164:
    s_cmp_lt_u32 s60, s75
    s_cbranch_scc1 L_g_restart_159
    s_waitcnt vmcnt(0)
    s_barrier
    s_branch L_c_done_1
L_c_chain_9:
    v_mov_b32 v4, 0
    v_mov_b32 v5, 0
    v_mov_b32 v6, 0
    v_mov_b32 v7, 0
    v_mov_b32 v8, 0
    v_mov_b32 v9, 0
    v_mov_b32 v10, 0
    v_mov_b32 v11, 0
    v_mov_b32 v12, 0
    v_mov_b32 v13, 0
    v_mov_b32 v14, 0
    v_mov_b32 v15, 0
    v_mov_b32 v32, -1
    v_mov_b32 v33, -1
    v_mov_b32 v34, -1
    v_mov_b32 v35, -1
    v_lshlrev_b32 v2, 4, v1
    s_lshl_b32 s45, s40, 16
    s_lshl_b32 s46, s41, 12
    s_add_u32 s45, s45, s46
    s_and_b32 s46, s44, 3
    s_lshl_b32 s46, s46, 10
    s_add_u32 s45, s45, s46
    s_lshr_b32 s46, s44, 2
    s_lshl_b32 s46, s46, 19
    s_add_u32 s45, s45, s46
    s_add_u32 s45, s45, 0x7000000
    buffer_store_dwordx4 v[32:35], v2, s[12:15], s45 offen sc1
    s_lshl_b32 s45, s40, 15
    s_lshl_b32 s46, s41, 11
    s_add_u32 s45, s45, s46
    s_lshl_b32 s46, s44, 8
    s_add_u32 s45, s45, s46
    s_add_u32 s45, s45, 0x7100000
    s_mov_b64 exec, 0xffff
    buffer_store_dwordx4 v[32:35], v2, s[12:15], s45 offen sc1
    s_lshl_b32 s45, s40, 16
    s_lshl_b32 s46, s41, 8
    s_add_u32 s45, s45, s46
    s_and_b32 s46, s44, 3
    s_lshl_b32 s46, s46, 14
    s_add_u32 s45, s45, s46
    s_add_u32 s45, s45, 0x7180000
    buffer_store_dwordx4 v[32:35], v2, s[12:15], s45 offen sc1
    s_mov_b64 exec, -1
    v_lshlrev_b32 v2, 4, v1
    v_and_b32 v3, 8, v1
    v_cmp_eq_u32 vcc, 0, v3
    v_mov_b32 v3, 0xeeeeeeee
    v_mov_b32 v4, 0x44444444
    v_cndmask_b32 v3, v3, v4, vcc
    v_and_b32 v100, 15, v1
    v_lshrrev_b32 v101, 4, v1
    v_and_b32 v102, 1, v101
    v_lshrrev_b32 v103, 1, v101
    v_lshlrev_b32 v104, 2, v102
    v_lshl_add_u32 v104, v103, 1, v104
    v_and_b32 v105, 1, v1
    v_add_u32 v104, v104, v105
    v_and_b32 v106, 7, v1
    v_bfe_u32 v107, v1, 3, 1
    s_lshr_b32 s42, s41, 2
    s_and_b32 s43, s41, 3
    s_lshl_b32 s49, s40, 2
    s_add_u32 s49, s49, s42
    s_lshl_b32 s45, s44, 14
    v_lshlrev_b32 v22, 3, v101
    v_bfe_u32 v23, v1, 2, 2
    v_add_u32 v22, v22, v23
    v_and_b32 v23, 3, v1
    v_lshlrev_b32 v24, 3, v23
    v_lshl_add_u32 v20, v22, 6, v24
    v_lshl_add_u32 v21, v22, 7, v24
    v_lshrrev_b32 v22, 2, v1
    v_lshlrev_b32 v23, 4, v23
    v_lshl_add_u32 v24, v22, 13, v23
    v_lshrrev_b32 v22, 3, v1
    v_lshlrev_b32 v23, 4, v106
    v_lshl_add_u32 v25, v22, 11, v23
    s_cmp_ge_u32 s44, 4
    s_cbranch_scc1 L_v_init_193
    s_lshr_b32 s50, s44, 1
    s_and_b32 s51, s44, 1
    s_load_dwordx4 s[4:7], s[0:1], 16
    s_lshl_b32 s46, s49, 8
    s_lshl_b32 s48, s43, 6
    s_add_u32 s46, s46, s48
    s_lshl_b32 s48, s44, 21
    s_add_u32 s46, s46, s48
    s_lshl_b32 s52, s51, 5
    s_xor_b32 s53, s50, 1
    s_lshl_b32 s53, s53, 16
    s_add_u32 s52, s52, s53
    v_add_u32 v20, s52, v20
    s_waitcnt lgkmcnt(0)
    s_mov_b32 s24, s6
    s_and_b32 s25, s7, 0xffff
    s_mov_b32 s26, 0x800000
    s_mov_b32 s27, 0x00020000
    s_mov_b32 s28, s4
    s_and_b32 s29, s5, 0xffff
    s_mov_b32 s30, 0x800000
    s_mov_b32 s31, 0x00020000
    s_lshl_b32 s52, s51, 9
    s_lshl_b32 s53, s50, 7
    s_add_u32 s52, s52, s53
    s_add_u32 s52, s52, 61440
    v_lshlrev_b32 v5, 1, v106
    v_lshl_add_u32 v5, v107, 8, v5
    v_lshl_add_u32 v5, v102, 6, v5
    v_lshl_add_u32 v5, v103, 5, v5
    v_add_u32 v5, s52, v5
    s_lshl_b32 s67, s49, 12
    s_lshl_b32 s53, s43, 10
    s_add_u32 s67, s67, s53
    s_add_u32 s67, s67, 0x1000000
    s_lshl_b32 s52, s40, 16
    s_lshl_b32 s53, s44, 12
    s_add_u32 s53, s52, s53
    s_add_u32 s53, s53, 0x7080000
    v_add_u32 v7, s53, v2
    s_lshl_b32 s53, s44, 10
    s_add_u32 s53, s52, s53
    s_add_u32 s53, s53, 0x7180000
    v_lshlrev_b32 v28, 7, v103
    v_lshl_add_u32 v28, v106, 4, v28
    v_lshl_add_u32 v28, v102, 3, v28
    v_lshl_add_u32 v28, v107, 2, v28
    v_add_u32 v28, s53, v28
    s_lshl_b32 s52, s44, 10
    s_add_u32 s52, s52, 16384
    v_lshlrev_b32 v8, 8, v101
    v_lshl_add_u32 v8, v106, 4, v8
    v_lshl_add_u32 v8, v107, 3, v8
    v_add_u32 v8, s52, v8
    s_lshl_b32 s52, s44, 8
    s_add_u32 s52, s52, 20480
    v_lshlrev_b32 v9, 4, v106
    v_lshl_add_u32 v9, v101, 2, v9
    v_lshl_add_u32 v9, v107, 1, v9
    v_add_u32 v9, s52, v9
    s_mov_b32 s66, 0x3e0293ee
    s_add_u32 m0, s45, 0
    s_add_u32 s48, s46, 0x0
    buffer_load_dwordx4 v24, s[24:27], s48 offen lds
    s_add_u32 m0, s45, 1024
    s_add_u32 s48, s46, 0x20000
    buffer_load_dwordx4 v24, s[24:27], s48 offen lds
    s_add_u32 m0, s45, 2048
    s_add_u32 s48, s46, 0x40000
    buffer_load_dwordx4 v24, s[24:27], s48 offen lds
    s_add_u32 m0, s45, 3072
    s_add_u32 s48, s46, 0x60000
    buffer_load_dwordx4 v24, s[24:27], s48 offen lds
    s_add_u32 m0, s45, 4096
    s_add_u32 s48, s46, 0x80000
    buffer_load_dwordx4 v24, s[24:27], s48 offen lds
    s_add_u32 m0, s45, 5120
    s_add_u32 s48, s46, 0xa0000
    buffer_load_dwordx4 v24, s[24:27], s48 offen lds
    s_add_u32 m0, s45, 6144
    s_add_u32 s48, s46, 0xc0000
    buffer_load_dwordx4 v24, s[24:27], s48 offen lds
    s_add_u32 m0, s45, 7168
    s_add_u32 s48, s46, 0xe0000
    buffer_load_dwordx4 v24, s[24:27], s48 offen lds
    s_add_u32 m0, s45, 8192
    s_add_u32 s48, s46, 0x100000
    buffer_load_dwordx4 v24, s[24:27], s48 offen lds
    s_add_u32 m0, s45, 9216
    s_add_u32 s48, s46, 0x120000
    buffer_load_dwordx4 v24, s[24:27], s48 offen lds
    s_add_u32 m0, s45, 10240
    s_add_u32 s48, s46, 0x140000
    buffer_load_dwordx4 v24, s[24:27], s48 offen lds
    s_add_u32 m0, s45, 11264
    s_add_u32 s48, s46, 0x160000
    buffer_load_dwordx4 v24, s[24:27], s48 offen lds
    s_add_u32 m0, s45, 12288
    s_add_u32 s48, s46, 0x180000
    buffer_load_dwordx4 v24, s[24:27], s48 offen lds
    s_add_u32 m0, s45, 13312
    s_add_u32 s48, s46, 0x1a0000
    buffer_load_dwordx4 v24, s[24:27], s48 offen lds
    s_add_u32 m0, s45, 14336
    s_add_u32 s48, s46, 0x1c0000
    buffer_load_dwordx4 v24, s[24:27], s48 offen lds
    s_add_u32 m0, s45, 15360
    s_add_u32 s48, s46, 0x1e0000
    buffer_load_dwordx4 v24, s[24:27], s48 offen lds
    s_add_u32 s45, s45, 0x10000
    s_add_u32 m0, s45, 0
    s_add_u32 s48, s46, 0x0
    buffer_load_dwordx4 v24, s[28:31], s48 offen lds
    s_add_u32 m0, s45, 1024
    s_add_u32 s48, s46, 0x20000
    buffer_load_dwordx4 v24, s[28:31], s48 offen lds
    s_add_u32 m0, s45, 2048
    s_add_u32 s48, s46, 0x40000
    buffer_load_dwordx4 v24, s[28:31], s48 offen lds
    s_add_u32 m0, s45, 3072
    s_add_u32 s48, s46, 0x60000
    buffer_load_dwordx4 v24, s[28:31], s48 offen lds
    s_add_u32 m0, s45, 4096
    s_add_u32 s48, s46, 0x80000
    buffer_load_dwordx4 v24, s[28:31], s48 offen lds
    s_add_u32 m0, s45, 5120
    s_add_u32 s48, s46, 0xa0000
    buffer_load_dwordx4 v24, s[28:31], s48 offen lds
    s_add_u32 m0, s45, 6144
    s_add_u32 s48, s46, 0xc0000
    buffer_load_dwordx4 v24, s[28:31], s48 offen lds
    s_add_u32 m0, s45, 7168
    s_add_u32 s48, s46, 0xe0000
    buffer_load_dwordx4 v24, s[28:31], s48 offen lds
    s_add_u32 m0, s45, 8192
    s_add_u32 s48, s46, 0x100000
    buffer_load_dwordx4 v24, s[28:31], s48 offen lds
    s_add_u32 m0, s45, 9216
    s_add_u32 s48, s46, 0x120000
    buffer_load_dwordx4 v24, s[28:31], s48 offen lds
    s_add_u32 m0, s45, 10240
    s_add_u32 s48, s46, 0x140000
    buffer_load_dwordx4 v24, s[28:31], s48 offen lds
    s_add_u32 m0, s45, 11264
    s_add_u32 s48, s46, 0x160000
    buffer_load_dwordx4 v24, s[28:31], s48 offen lds
    s_add_u32 m0, s45, 12288
    s_add_u32 s48, s46, 0x180000
    buffer_load_dwordx4 v24, s[28:31], s48 offen lds
    s_add_u32 m0, s45, 13312
    s_add_u32 s48, s46, 0x1a0000
    buffer_load_dwordx4 v24, s[28:31], s48 offen lds
    s_add_u32 m0, s45, 14336
    s_add_u32 s48, s46, 0x1c0000
    buffer_load_dwordx4 v24, s[28:31], s48 offen lds
    s_add_u32 m0, s45, 15360
    s_add_u32 s48, s46, 0x1e0000
    buffer_load_dwordx4 v24, s[28:31], s48 offen lds
    s_add_u32 s45, s45, 0x10000
    s_waitcnt vmcnt(0)
    s_barrier
    s_cmp_lg_u32 s44, 0
    s_cbranch_scc1 L_zwok_196
    v_and_b32 v16, 7, v1
    v_lshlrev_b32 v16, 5, v16
    s_mov_b32 s70, 0
L_zw_195:
    buffer_load_dword v17, v16, s[16:19], 0 offen sc1
    s_waitcnt vmcnt(0)
    v_add_u32_dpp v17, v17, v17 row_ror:1 row_mask:0xf bank_mask:0xf
    s_nop 1
    v_add_u32_dpp v17, v17, v17 row_ror:2 row_mask:0xf bank_mask:0xf
    s_nop 1
    v_add_u32_dpp v17, v17, v17 row_ror:4 row_mask:0xf bank_mask:0xf
    v_cmp_ne_u32 vcc, 0x100, v17
    s_add_u32 s70, s70, 1
    s_cbranch_vccz L_zwok_196
    s_sleep 4
    s_cmp_lt_u32 s70, 524288
    s_cbranch_scc1 L_zw_195
    s_branch L_c_done_1
L_zwok_196:
    s_cmp_lg_u32 s44, 0
    s_cbranch_scc1 L_c_nr_197
    s_or_b32 s47, s39, 0x100
    v_mov_b32 v16, s47
    s_lshl_b32 s52, s40, 6
    s_lshl_b32 s53, s41, 2
    s_add_u32 s52, s52, s53
    s_add_u32 s52, s52, 0x101000
    v_mov_b32 v17, 0
    s_mov_b64 exec, 1
    buffer_store_dword v16, v17, s[12:15], s52 offen sc1
    s_mov_b64 exec, -1
L_c_nr_197:
    ds_read_b64_tr_b16 a[0:1], v20 offset:0
    ds_read_b64_tr_b16 a[2:3], v20 offset:256
    ds_read_b64_tr_b16 a[4:5], v20 offset:2048
    ds_read_b64_tr_b16 a[6:7], v20 offset:2304
    ds_read_b64_tr_b16 a[8:9], v20 offset:4096
    ds_read_b64_tr_b16 a[10:11], v20 offset:4352
    ds_read_b64_tr_b16 a[12:13], v20 offset:6144
    ds_read_b64_tr_b16 a[14:15], v20 offset:6400
    s_waitcnt lgkmcnt(0)
    ds_read_b64_tr_b16 a[16:17], v20 offset:8192
    ds_read_b64_tr_b16 a[18:19], v20 offset:8448
    ds_read_b64_tr_b16 a[20:21], v20 offset:10240
    ds_read_b64_tr_b16 a[22:23], v20 offset:10496
    ds_read_b64_tr_b16 a[24:25], v20 offset:12288
    ds_read_b64_tr_b16 a[26:27], v20 offset:12544
    ds_read_b64_tr_b16 a[28:29], v20 offset:14336
    ds_read_b64_tr_b16 a[30:31], v20 offset:14592
    s_waitcnt lgkmcnt(0)
    ds_read_b64_tr_b16 a[32:33], v20 offset:16384
    ds_read_b64_tr_b16 a[34:35], v20 offset:16640
    ds_read_b64_tr_b16 a[36:37], v20 offset:18432
    ds_read_b64_tr_b16 a[38:39], v20 offset:18688
    ds_read_b64_tr_b16 a[40:41], v20 offset:20480
    ds_read_b64_tr_b16 a[42:43], v20 offset:20736
    ds_read_b64_tr_b16 a[44:45], v20 offset:22528
    ds_read_b64_tr_b16 a[46:47], v20 offset:22784
    s_waitcnt lgkmcnt(0)
    ds_read_b64_tr_b16 a[48:49], v20 offset:24576
    ds_read_b64_tr_b16 a[50:51], v20 offset:24832
    ds_read_b64_tr_b16 a[52:53], v20 offset:26624
    ds_read_b64_tr_b16 a[54:55], v20 offset:26880
    ds_read_b64_tr_b16 a[56:57], v20 offset:28672
    ds_read_b64_tr_b16 a[58:59], v20 offset:28928
    ds_read_b64_tr_b16 a[60:61], v20 offset:30720
    ds_read_b64_tr_b16 a[62:63], v20 offset:30976
    s_waitcnt lgkmcnt(0)
    ds_read_b64_tr_b16 a[64:65], v20 offset:32768
    ds_read_b64_tr_b16 a[66:67], v20 offset:33024
    ds_read_b64_tr_b16 a[68:69], v20 offset:34816
    ds_read_b64_tr_b16 a[70:71], v20 offset:35072
    ds_read_b64_tr_b16 a[72:73], v20 offset:36864
    ds_read_b64_tr_b16 a[74:75], v20 offset:37120
    ds_read_b64_tr_b16 a[76:77], v20 offset:38912
    ds_read_b64_tr_b16 a[78:79], v20 offset:39168
    s_waitcnt lgkmcnt(0)
    ds_read_b64_tr_b16 a[80:81], v20 offset:40960
    ds_read_b64_tr_b16 a[82:83], v20 offset:41216
    ds_read_b64_tr_b16 a[84:85], v20 offset:43008
    ds_read_b64_tr_b16 a[86:87], v20 offset:43264
    ds_read_b64_tr_b16 a[88:89], v20 offset:45056
    ds_read_b64_tr_b16 a[90:91], v20 offset:45312
    ds_read_b64_tr_b16 a[92:93], v20 offset:47104
    ds_read_b64_tr_b16 a[94:95], v20 offset:47360
    s_waitcnt lgkmcnt(0)
    ds_read_b64_tr_b16 a[96:97], v20 offset:49152
    ds_read_b64_tr_b16 a[98:99], v20 offset:49408
    ds_read_b64_tr_b16 a[100:101], v20 offset:51200
    ds_read_b64_tr_b16 a[102:103], v20 offset:51456
    ds_read_b64_tr_b16 a[104:105], v20 offset:53248
    ds_read_b64_tr_b16 a[106:107], v20 offset:53504
    ds_read_b64_tr_b16 a[108:109], v20 offset:55296
    ds_read_b64_tr_b16 a[110:111], v20 offset:55552
    s_waitcnt lgkmcnt(0)
    ds_read_b64_tr_b16 a[112:113], v20 offset:57344
    ds_read_b64_tr_b16 a[114:115], v20 offset:57600
    ds_read_b64_tr_b16 a[116:117], v20 offset:59392
    ds_read_b64_tr_b16 a[118:119], v20 offset:59648
    ds_read_b64_tr_b16 a[120:121], v20 offset:61440
    ds_read_b64_tr_b16 a[122:123], v20 offset:61696
    ds_read_b64_tr_b16 a[124:125], v20 offset:63488
    ds_read_b64_tr_b16 a[126:127], v20 offset:63744
    s_waitcnt lgkmcnt(0)
    s_mov_b32 s63, 0
    s_barrier
    s_lshl_b32 s52, s40, 2
    s_add_u32 s52, s52, s44
    s_mul_i32 s52, s52, 24576
    s_lshl_b32 s53, s41, 9
    s_add_u32 s52, s52, s53
    s_add_u32 s52, s52, 0x2004000
    v_and_b32 v14, 3, v1
    v_lshlrev_b32 v14, 7, v14
    v_add_u32 v14, s52, v14
    s_lshl_b32 s52, s40, 16
    s_lshl_b32 s53, s41, 10
    s_add_u32 s53, s53, s52
    s_lshl_b32 s54, s44, 7
    s_add_u32 s53, s53, s54
    s_add_u32 s53, s53, 0x7080000
    v_lshlrev_b32 v4, 4, v106
    v_lshl_add_u32 v10, v102, 7, v4
    v_lshl_add_u32 v4, v101, 8, v4
    v_add_u32 v4, s53, v4
    s_lshl_b32 s53, s41, 8
    s_add_u32 s53, s53, s52
    s_add_u32 s53, s53, 0x7180000
    v_add_u32 v10, s53, v10
    s_cmp_ge_u32 s44, 2
    s_cselect_b64 vcc, -1, 0
    v_cndmask_b32 v4, v4, v10, vcc
    s_mul_i32 s52, s49, 24576
    s_lshl_b32 s53, s44, 12
    s_add_u32 s52, s52, s53
    s_lshl_b32 s53, s43, 10
    s_add_u32 s52, s52, s53
    s_add_u32 s52, s52, 0x2002000
    v_add_u32 v6, s52, v2
    v_lshrrev_b32 v10, 3, v1
    v_lshlrev_b32 v10, 8, v10
    v_lshl_add_u32 v10, v106, 4, v10
    v_add_u32 v10, 61568, v10
    v_add_u32 v11, 27648, v2
    v_cmp_gt_u32 s[52:53], 32, v1
    s_nop 1
    v_cndmask_b32 v10, v11, v10, s[52:53]
    v_cndmask_b32 v6, v6, v10, vcc
    v_mov_b32 v24, -1
    v_mov_b32 v25, -1
    v_mov_b32 v26, -1
    v_mov_b32 v27, -1
    v_mov_b32 v29, 26644
    v_mov_b32 v30, 0
    ds_write_b32 v29, v30
    v_mov_b32 v30, 1
    s_lshl_b32 s58, s40, 11
    s_lshl_b32 s53, s44, 7
    s_add_u32 s58, s58, s53
    s_add_u32 s58, s58, 0x10a600
    s_mov_b32 s69, 0
    v_mov_b32 v0, 0
    s_xor_b32 s59, s44, 2
    s_or_b32 s59, s59, s41
    s_cselect_b32 s59, 0, 3
    s_mov_b32 s64, 0
    s_cmp_ge_u32 s44, 2
    s_cselect_b32 s50, 0, 0x00ff00ff
    s_mov_b32 s51, 0x00ff00ff
    s_setprio 1
    s_branch L_c_join_194
L_v_init_193:
    s_sub_u32 s54, s44, 4
    s_lshr_b32 s51, s54, 1
    s_and_b32 s50, s54, 1
    s_load_dwordx4 s[4:7], s[0:1], 32
    s_load_dwordx2 s[8:9], s[0:1], 8
    s_waitcnt lgkmcnt(0)
    s_mov_b32 s24, s4
    s_and_b32 s25, s5, 0xffff
    s_mov_b32 s26, 0x800000
    s_mov_b32 s27, 0x00020000
    s_mov_b32 s28, s6
    s_and_b32 s29, s7, 0xffff
    s_mov_b32 s30, 0x800000
    s_mov_b32 s31, 0x00020000
    s_mov_b32 s32, s8
    s_and_b32 s33, s9, 0xffff
    s_mov_b32 s34, 0x4000
    s_mov_b32 s35, 0x00020000
    s_lshl_b32 s45, s54, 12
    s_add_u32 s45, s45, 0x20000
    v_add_u32 v20, s45, v20
    v_add_u32 v21, s45, v21
    v_add_u32 v22, s45, v2
    s_lshl_b32 s46, s49, 8
    s_lshl_b32 s48, s43, 6
    s_add_u32 s46, s46, s48
    s_lshl_b32 s48, s54, 21
    s_add_u32 s46, s46, s48
    s_add_u32 s48, s46, 0x0
    buffer_load_dwordx4 a[0:3], v24, s[24:27], s48 offen
    s_add_u32 s48, s46, 0x20000
    buffer_load_dwordx4 a[32:35], v24, s[24:27], s48 offen
    s_add_u32 s48, s46, 0x40000
    buffer_load_dwordx4 a[4:7], v24, s[24:27], s48 offen
    s_add_u32 s48, s46, 0x60000
    buffer_load_dwordx4 a[36:39], v24, s[24:27], s48 offen
    s_add_u32 s48, s46, 0x80000
    buffer_load_dwordx4 a[8:11], v24, s[24:27], s48 offen
    s_add_u32 s48, s46, 0xa0000
    buffer_load_dwordx4 a[40:43], v24, s[24:27], s48 offen
    s_add_u32 s48, s46, 0xc0000
    buffer_load_dwordx4 a[12:15], v24, s[24:27], s48 offen
    s_add_u32 s48, s46, 0xe0000
    buffer_load_dwordx4 a[44:47], v24, s[24:27], s48 offen
    s_add_u32 s48, s46, 0x100000
    buffer_load_dwordx4 a[16:19], v24, s[24:27], s48 offen
    s_add_u32 s48, s46, 0x120000
    buffer_load_dwordx4 a[48:51], v24, s[24:27], s48 offen
    s_add_u32 s48, s46, 0x140000
    buffer_load_dwordx4 a[20:23], v24, s[24:27], s48 offen
    s_add_u32 s48, s46, 0x160000
    buffer_load_dwordx4 a[52:55], v24, s[24:27], s48 offen
    s_add_u32 s48, s46, 0x180000
    buffer_load_dwordx4 a[24:27], v24, s[24:27], s48 offen
    s_add_u32 s48, s46, 0x1a0000
    buffer_load_dwordx4 a[56:59], v24, s[24:27], s48 offen
    s_add_u32 s48, s46, 0x1c0000
    buffer_load_dwordx4 a[28:31], v24, s[24:27], s48 offen
    s_add_u32 s48, s46, 0x1e0000
    buffer_load_dwordx4 a[60:63], v24, s[24:27], s48 offen
    s_lshl_b32 s52, s40, 15
    s_lshl_b32 s53, s42, 11
    s_add_u32 s52, s52, s53
    s_lshl_b32 s53, s43, 9
    s_add_u32 s52, s52, s53
    s_lshl_b32 s53, s51, 8
    s_add_u32 s52, s52, s53
    s_add_u32 s52, s52, 0x7100000
    v_bfe_u32 v4, v1, 1, 1
    v_lshlrev_b32 v4, 7, v4
    v_lshl_add_u32 v4, v104, 4, v4
    v_and_b32 v5, 12, v100
    v_add_u32 v4, v4, v5
    v_add_u32 v4, s52, v4
    v_mov_b32 v26, -1
    s_lshl_b32 s52, s51, 5
    s_add_u32 s52, s52, 28160
    v_and_b32 v5, 14, v100
    v_lshlrev_b32 v5, 1, v5
    v_lshl_add_u32 v5, v104, 6, v5
    v_add_u32 v5, s52, v5
    s_lshl_b32 s52, s41, 14
    s_lshl_b32 s53, s54, 11
    s_add_u32 s52, s52, s53
    s_add_u32 s52, s52, 0x7800000
    v_lshlrev_b32 v6, 3, v101
    v_lshl_add_u32 v6, v106, 5, v6
    v_and_b32 v7, 3, v1
    v_lshlrev_b32 v7, 3, v7
    v_bfe_u32 v30, v1, 2, 3
    v_lshl_add_u32 v7, v30, 5, v7
    v_lshl_add_u32 v7, v103, 2, v7
    v_add_u32 v7, s52, v7
    s_lshl_b32 s53, s40, 8
    s_add_u32 s52, s52, s53
    v_add_u32 v6, s52, v6
    v_lshlrev_b32 v30, 4, v100
    v_lshl_add_u32 v30, v101, 18, v30
    v_add_u32 v30, s52, v30
    v_mov_b32 v32, -1
    v_mov_b32 v33, -1
    v_mov_b32 v34, -1
    v_mov_b32 v35, -1
    buffer_store_dwordx4 v[32:35], v30, s[12:15], 0 offen sc1
    s_mov_b32 s53, 8192
    buffer_store_dwordx4 v[32:35], v30, s[12:15], s53 offen sc1
    s_lshl_b32 s55, s40, 16
    s_add_u32 s55, s55, 0x7000000
    s_lshl_b32 s52, s41, 10
    s_lshl_b32 s53, s54, 8
    s_add_u32 s52, s52, s53
    s_add_u32 s52, s52, s55
    v_lshlrev_b32 v8, 2, v1
    v_add_u32 v8, s52, v8
    s_lshl_b32 s53, s54, 12
    v_add_u32 v10, s53, v2
    v_add_u32 v9, s55, v10
    s_lshl_b32 s52, s40, 15
    s_lshl_b32 s53, s54, 11
    s_add_u32 s52, s52, s53
    s_add_u32 s52, s52, 0x7100000
    v_add_u32 v11, s52, v2
    s_lshl_b32 s52, s54, 9
    s_add_u32 s52, s52, 53248
    v_lshlrev_b32 v12, 4, v100
    v_lshl_add_u32 v12, v102, 3, v12
    v_lshl_add_u32 v12, v103, 8, v12
    v_add_u32 v12, s52, v12
    s_lshl_b32 s52, s51, 3
    s_add_u32 s52, s52, 49152
    v_add_u32 v13, s52, v2
    s_lshl_b32 s52, s54, 10
    s_add_u32 s52, s52, 49152
    v_add_u32 v14, s52, v2
    s_lshl_b32 s52, s40, 2
    s_add_u32 s52, s52, s54
    s_mul_i32 s52, s52, 24576
    s_add_u32 s52, s52, 0x2004000
    v_add_u32 v15, s52, v2
    s_lshl_b32 s52, s54, 10
    v_add_u32 v27, s52, v2
    v_lshlrev_b32 v30, 11, v106
    v_lshl_add_u32 v30, v101, 5, v30
    v_lshl_add_u32 v30, v107, 2, v30
    s_lshl_b32 s52, s54, 9
    buffer_load_dword v112, v30, s[32:35], s52 offen offset:0
    buffer_load_dword v113, v30, s[32:35], s52 offen offset:8
    buffer_load_dword v114, v30, s[32:35], s52 offen offset:16
    buffer_load_dword v115, v30, s[32:35], s52 offen offset:24
    buffer_load_dword v116, v30, s[32:35], s52 offen offset:128
    buffer_load_dword v117, v30, s[32:35], s52 offen offset:136
    buffer_load_dword v118, v30, s[32:35], s52 offen offset:144
    buffer_load_dword v119, v30, s[32:35], s52 offen offset:152
    buffer_load_dword v120, v30, s[32:35], s52 offen offset:256
    buffer_load_dword v121, v30, s[32:35], s52 offen offset:264
    buffer_load_dword v122, v30, s[32:35], s52 offen offset:272
    buffer_load_dword v123, v30, s[32:35], s52 offen offset:280
    buffer_load_dword v124, v30, s[32:35], s52 offen offset:384
    buffer_load_dword v125, v30, s[32:35], s52 offen offset:392
    buffer_load_dword v126, v30, s[32:35], s52 offen offset:400
    buffer_load_dword v127, v30, s[32:35], s52 offen offset:408
    s_lshl_b32 s46, s40, 2
    s_add_u32 s46, s46, s54
    s_lshl_b32 s46, s46, 18
    s_lshl_b32 s48, s41, 7
    s_add_u32 s46, s46, s48
    s_add_u32 s48, s46, 0x0
    buffer_load_dwordx4 a[64:67], v25, s[28:31], s48 offen
    s_add_u32 s48, s46, 0x4000
    buffer_load_dwordx4 a[80:83], v25, s[28:31], s48 offen
    s_add_u32 s48, s46, 0x8000
    buffer_load_dwordx4 a[96:99], v25, s[28:31], s48 offen
    s_add_u32 s48, s46, 0xc000
    buffer_load_dwordx4 a[112:115], v25, s[28:31], s48 offen
    s_add_u32 s48, s46, 0x10000
    buffer_load_dwordx4 a[68:71], v25, s[28:31], s48 offen
    s_add_u32 s48, s46, 0x14000
    buffer_load_dwordx4 a[84:87], v25, s[28:31], s48 offen
    s_add_u32 s48, s46, 0x18000
    buffer_load_dwordx4 a[100:103], v25, s[28:31], s48 offen
    s_add_u32 s48, s46, 0x1c000
    buffer_load_dwordx4 a[116:119], v25, s[28:31], s48 offen
    s_add_u32 s48, s46, 0x20000
    buffer_load_dwordx4 a[72:75], v25, s[28:31], s48 offen
    s_add_u32 s48, s46, 0x24000
    buffer_load_dwordx4 a[88:91], v25, s[28:31], s48 offen
    s_add_u32 s48, s46, 0x28000
    buffer_load_dwordx4 a[104:107], v25, s[28:31], s48 offen
    s_add_u32 s48, s46, 0x2c000
    buffer_load_dwordx4 a[120:123], v25, s[28:31], s48 offen
    s_add_u32 s48, s46, 0x30000
    buffer_load_dwordx4 a[76:79], v25, s[28:31], s48 offen
    s_add_u32 s48, s46, 0x34000
    buffer_load_dwordx4 a[92:95], v25, s[28:31], s48 offen
    s_add_u32 s48, s46, 0x38000
    buffer_load_dwordx4 a[108:111], v25, s[28:31], s48 offen
    s_add_u32 s48, s46, 0x3c000
    buffer_load_dwordx4 a[124:127], v25, s[28:31], s48 offen
    s_waitcnt vmcnt(16)
    ds_write_b128 v22, a[0:3] offset:0
    ds_write_b128 v22, a[32:35] offset:1024
    ds_write_b128 v22, a[4:7] offset:2048
    ds_write_b128 v22, a[36:39] offset:3072
    s_waitcnt lgkmcnt(0)
    ds_read_b64_tr_b16 a[0:1], v20 offset:0
    ds_read_b64_tr_b16 a[2:3], v20 offset:256
    ds_read_b64_tr_b16 a[32:33], v20 offset:32
    ds_read_b64_tr_b16 a[34:35], v20 offset:288
    ds_read_b64_tr_b16 a[4:5], v20 offset:2048
    ds_read_b64_tr_b16 a[6:7], v20 offset:2304
    ds_read_b64_tr_b16 a[36:37], v20 offset:2080
    ds_read_b64_tr_b16 a[38:39], v20 offset:2336
    s_waitcnt lgkmcnt(0)
    ds_write_b128 v22, a[8:11] offset:0
    ds_write_b128 v22, a[40:43] offset:1024
    ds_write_b128 v22, a[12:15] offset:2048
    ds_write_b128 v22, a[44:47] offset:3072
    s_waitcnt lgkmcnt(0)
    ds_read_b64_tr_b16 a[8:9], v20 offset:0
    ds_read_b64_tr_b16 a[10:11], v20 offset:256
    ds_read_b64_tr_b16 a[40:41], v20 offset:32
    ds_read_b64_tr_b16 a[42:43], v20 offset:288
    ds_read_b64_tr_b16 a[12:13], v20 offset:2048
    ds_read_b64_tr_b16 a[14:15], v20 offset:2304
    ds_read_b64_tr_b16 a[44:45], v20 offset:2080
    ds_read_b64_tr_b16 a[46:47], v20 offset:2336
    s_waitcnt lgkmcnt(0)
    ds_write_b128 v22, a[16:19] offset:0
    ds_write_b128 v22, a[48:51] offset:1024
    ds_write_b128 v22, a[20:23] offset:2048
    ds_write_b128 v22, a[52:55] offset:3072
    s_waitcnt lgkmcnt(0)
    ds_read_b64_tr_b16 a[16:17], v20 offset:0
    ds_read_b64_tr_b16 a[18:19], v20 offset:256
    ds_read_b64_tr_b16 a[48:49], v20 offset:32
    ds_read_b64_tr_b16 a[50:51], v20 offset:288
    ds_read_b64_tr_b16 a[20:21], v20 offset:2048
    ds_read_b64_tr_b16 a[22:23], v20 offset:2304
    ds_read_b64_tr_b16 a[52:53], v20 offset:2080
    ds_read_b64_tr_b16 a[54:55], v20 offset:2336
    s_waitcnt lgkmcnt(0)
    ds_write_b128 v22, a[24:27] offset:0
    ds_write_b128 v22, a[56:59] offset:1024
    ds_write_b128 v22, a[28:31] offset:2048
    ds_write_b128 v22, a[60:63] offset:3072
    s_waitcnt lgkmcnt(0)
    ds_read_b64_tr_b16 a[24:25], v20 offset:0
    ds_read_b64_tr_b16 a[26:27], v20 offset:256
    ds_read_b64_tr_b16 a[56:57], v20 offset:32
    ds_read_b64_tr_b16 a[58:59], v20 offset:288
    ds_read_b64_tr_b16 a[28:29], v20 offset:2048
    ds_read_b64_tr_b16 a[30:31], v20 offset:2304
    ds_read_b64_tr_b16 a[60:61], v20 offset:2080
    ds_read_b64_tr_b16 a[62:63], v20 offset:2336
    s_waitcnt lgkmcnt(0)
    s_barrier
    s_waitcnt vmcnt(0)
    ds_write_b128 v22, a[64:67] offset:0
    ds_write_b128 v22, a[80:83] offset:1024
    ds_write_b128 v22, a[96:99] offset:2048
    ds_write_b128 v22, a[112:115] offset:3072
    s_waitcnt lgkmcnt(0)
    ds_read_b64_tr_b16 a[64:65], v21 offset:0
    ds_read_b64_tr_b16 a[66:67], v21 offset:512
    ds_read_b64_tr_b16 a[80:81], v21 offset:32
    ds_read_b64_tr_b16 a[82:83], v21 offset:544
    ds_read_b64_tr_b16 a[96:97], v21 offset:64
    ds_read_b64_tr_b16 a[98:99], v21 offset:576
    ds_read_b64_tr_b16 a[112:113], v21 offset:96
    ds_read_b64_tr_b16 a[114:115], v21 offset:608
    s_waitcnt lgkmcnt(0)
    ds_write_b128 v22, a[68:71] offset:0
    ds_write_b128 v22, a[84:87] offset:1024
    ds_write_b128 v22, a[100:103] offset:2048
    ds_write_b128 v22, a[116:119] offset:3072
    s_waitcnt lgkmcnt(0)
    ds_read_b64_tr_b16 a[68:69], v21 offset:0
    ds_read_b64_tr_b16 a[70:71], v21 offset:512
    ds_read_b64_tr_b16 a[84:85], v21 offset:32
    ds_read_b64_tr_b16 a[86:87], v21 offset:544
    ds_read_b64_tr_b16 a[100:101], v21 offset:64
    ds_read_b64_tr_b16 a[102:103], v21 offset:576
    ds_read_b64_tr_b16 a[116:117], v21 offset:96
    ds_read_b64_tr_b16 a[118:119], v21 offset:608
    s_waitcnt lgkmcnt(0)
    ds_write_b128 v22, a[72:75] offset:0
    ds_write_b128 v22, a[88:91] offset:1024
    ds_write_b128 v22, a[104:107] offset:2048
    ds_write_b128 v22, a[120:123] offset:3072
    s_waitcnt lgkmcnt(0)
    ds_read_b64_tr_b16 a[72:73], v21 offset:0
    ds_read_b64_tr_b16 a[74:75], v21 offset:512
    ds_read_b64_tr_b16 a[88:89], v21 offset:32
    ds_read_b64_tr_b16 a[90:91], v21 offset:544
    ds_read_b64_tr_b16 a[104:105], v21 offset:64
    ds_read_b64_tr_b16 a[106:107], v21 offset:576
    ds_read_b64_tr_b16 a[120:121], v21 offset:96
    ds_read_b64_tr_b16 a[122:123], v21 offset:608
    s_waitcnt lgkmcnt(0)
    ds_write_b128 v22, a[76:79] offset:0
    ds_write_b128 v22, a[92:95] offset:1024
    ds_write_b128 v22, a[108:111] offset:2048
    ds_write_b128 v22, a[124:127] offset:3072
    s_waitcnt lgkmcnt(0)
    ds_read_b64_tr_b16 a[76:77], v21 offset:0
    ds_read_b64_tr_b16 a[78:79], v21 offset:512
    ds_read_b64_tr_b16 a[92:93], v21 offset:32
    ds_read_b64_tr_b16 a[94:95], v21 offset:544
    ds_read_b64_tr_b16 a[108:109], v21 offset:64
    ds_read_b64_tr_b16 a[110:111], v21 offset:576
    ds_read_b64_tr_b16 a[124:125], v21 offset:96
    ds_read_b64_tr_b16 a[126:127], v21 offset:608
    s_waitcnt lgkmcnt(0)
    s_mov_b32 s65, 0
    s_waitcnt vmcnt(0)
    s_barrier
    s_lshl_b32 s57, s40, 11
    s_lshl_b32 s53, s54, 7
    s_add_u32 s57, s57, s53
    s_add_u32 s57, s57, 0x10a600
    s_mov_b32 s69, 0
    s_mov_b32 s68, 0
    s_cmp_gt_u32 s69, s68
    s_cbranch_scc1 L_kv_ok_199
    s_mov_b32 s70, 0
L_kv_lp_198:
    v_and_b32 v22, 1, v1
    v_lshlrev_b32 v22, 9, v22
    buffer_load_dword v23, v22, s[12:15], s57 offen sc1
    s_waitcnt vmcnt(0)
    v_readlane_b32 s69, v23, 0
    v_readlane_b32 s45, v23, 1
    s_add_u32 s70, s70, 1
    s_nop 2
    s_min_u32 s69, s69, s45
    s_cmp_gt_u32 s69, s68
    s_cbranch_scc1 L_kv_ok_199
    s_sleep 4
    s_cmp_lt_u32 s70, 524288
    s_cbranch_scc1 L_kv_lp_198
    s_branch L_c_done_1
L_kv_ok_199:
    v_subrev_u32 v28, 8192, v15
    v_lshlrev_b32 v31, 4, v100
    v_lshl_add_u32 v31, v103, 8, v31
    v_add_u32 v31, 20480, v31
    s_lshl_b32 s52, s54, 11
    s_add_u32 s52, s52, 53248
    v_add_u32 v25, s52, v2
    v_mov_b32 v29, 26640
    v_mov_b32 v30, 0
    ds_write_b32 v29, v30
    v_mov_b32 v30, 1
    s_mov_b32 s58, 0
    s_mov_b32 s64, 0
    s_add_u32 s46, s65, 4096
    buffer_load_dwordx4 v[32:35], v15, s[12:15], s65 offen offset:0 sc1
    buffer_load_dwordx4 v[48:51], v15, s[12:15], s46 offen offset:0 sc1
    buffer_load_dwordx4 v[36:39], v15, s[12:15], s65 offen offset:1024 sc1
    buffer_load_dwordx4 v[52:55], v15, s[12:15], s46 offen offset:1024 sc1
    buffer_load_dwordx4 v[40:43], v15, s[12:15], s65 offen offset:2048 sc1
    buffer_load_dwordx4 v[56:59], v15, s[12:15], s46 offen offset:2048 sc1
    buffer_load_dwordx4 v[44:47], v15, s[12:15], s65 offen offset:3072 sc1
    buffer_load_dwordx4 v[60:63], v15, s[12:15], s46 offen offset:3072 sc1
    s_add_u32 s65, s65, 786432
    s_waitcnt vmcnt(0)
    v_mfma_f32_16x16x32_bf16 v[64:67], v[32:35], a[64:67], 0
    v_mfma_f32_16x16x32_bf16 v[68:71], v[48:51], a[64:67], 0
    v_mfma_f32_16x16x32_bf16 v[64:67], v[36:39], a[68:71], v[64:67]
    v_mfma_f32_16x16x32_bf16 v[68:71], v[52:55], a[68:71], v[68:71]
    v_mfma_f32_16x16x32_bf16 v[64:67], v[40:43], a[72:75], v[64:67]
    v_mfma_f32_16x16x32_bf16 v[68:71], v[56:59], a[72:75], v[68:71]
    v_mfma_f32_16x16x32_bf16 v[64:67], v[44:47], a[76:79], v[64:67]
    v_mfma_f32_16x16x32_bf16 v[68:71], v[60:63], a[76:79], v[68:71]
    v_mfma_f32_16x16x32_bf16 v[72:75], v[32:35], a[80:83], 0
    v_mfma_f32_16x16x32_bf16 v[76:79], v[48:51], a[80:83], 0
    v_mfma_f32_16x16x32_bf16 v[72:75], v[36:39], a[84:87], v[72:75]
    v_mfma_f32_16x16x32_bf16 v[76:79], v[52:55], a[84:87], v[76:79]
    v_mfma_f32_16x16x32_bf16 v[72:75], v[40:43], a[88:91], v[72:75]
    v_mfma_f32_16x16x32_bf16 v[76:79], v[56:59], a[88:91], v[76:79]
    v_mfma_f32_16x16x32_bf16 v[72:75], v[44:47], a[92:95], v[72:75]
    v_mfma_f32_16x16x32_bf16 v[76:79], v[60:63], a[92:95], v[76:79]
    v_cvt_pk_bf16_f32 v64, v64, v65
    v_cvt_pk_bf16_f32 v65, v66, v67
    v_cvt_pk_bf16_f32 v66, v68, v69
    v_cvt_pk_bf16_f32 v67, v70, v71
    ds_write_b128 v10, v[64:67] offset:32768
    v_mfma_f32_16x16x32_bf16 v[80:83], v[32:35], a[96:99], 0
    v_mfma_f32_16x16x32_bf16 v[84:87], v[48:51], a[96:99], 0
    v_mfma_f32_16x16x32_bf16 v[80:83], v[36:39], a[100:103], v[80:83]
    v_mfma_f32_16x16x32_bf16 v[84:87], v[52:55], a[100:103], v[84:87]
    v_mfma_f32_16x16x32_bf16 v[80:83], v[40:43], a[104:107], v[80:83]
    v_mfma_f32_16x16x32_bf16 v[84:87], v[56:59], a[104:107], v[84:87]
    v_mfma_f32_16x16x32_bf16 v[80:83], v[44:47], a[108:111], v[80:83]
    v_mfma_f32_16x16x32_bf16 v[84:87], v[60:63], a[108:111], v[84:87]
    v_cvt_pk_bf16_f32 v72, v72, v73
    v_cvt_pk_bf16_f32 v73, v74, v75
    v_cvt_pk_bf16_f32 v74, v76, v77
    v_cvt_pk_bf16_f32 v75, v78, v79
    ds_write_b128 v10, v[72:75] offset:33792
    v_mfma_f32_16x16x32_bf16 v[88:91], v[32:35], a[112:115], 0
    v_mfma_f32_16x16x32_bf16 v[92:95], v[48:51], a[112:115], 0
    v_mfma_f32_16x16x32_bf16 v[88:91], v[36:39], a[116:119], v[88:91]
    v_mfma_f32_16x16x32_bf16 v[92:95], v[52:55], a[116:119], v[92:95]
    v_mfma_f32_16x16x32_bf16 v[88:91], v[40:43], a[120:123], v[88:91]
    v_mfma_f32_16x16x32_bf16 v[92:95], v[56:59], a[120:123], v[92:95]
    v_mfma_f32_16x16x32_bf16 v[88:91], v[44:47], a[124:127], v[88:91]
    v_mfma_f32_16x16x32_bf16 v[92:95], v[60:63], a[124:127], v[92:95]
    v_cvt_pk_bf16_f32 v80, v80, v81
    v_cvt_pk_bf16_f32 v81, v82, v83
    v_cvt_pk_bf16_f32 v82, v84, v85
    v_cvt_pk_bf16_f32 v83, v86, v87
    ds_write_b128 v10, v[80:83] offset:34816
    s_nop 2
    v_cvt_pk_bf16_f32 v88, v88, v89
    v_cvt_pk_bf16_f32 v89, v90, v91
    v_cvt_pk_bf16_f32 v90, v92, v93
    v_cvt_pk_bf16_f32 v91, v94, v95
    ds_write_b128 v10, v[88:91] offset:35840
    s_mov_b64 s[66:67], 0
    s_mov_b32 s63, 0
    s_mov_b32 s68, 1
    s_cmp_gt_u32 s69, s68
    s_cbranch_scc1 L_kv_ok_201
    s_mov_b32 s70, 0
L_kv_lp_200:
    v_and_b32 v22, 1, v1
    v_lshlrev_b32 v22, 9, v22
    buffer_load_dword v23, v22, s[12:15], s57 offen sc1
    s_waitcnt vmcnt(0)
    v_readlane_b32 s69, v23, 0
    v_readlane_b32 s45, v23, 1
    s_add_u32 s70, s70, 1
    s_nop 2
    s_min_u32 s69, s69, s45
    s_cmp_gt_u32 s69, s68
    s_cbranch_scc1 L_kv_ok_201
    s_sleep 4
    s_cmp_lt_u32 s70, 524288
    s_cbranch_scc1 L_kv_lp_200
    s_branch L_c_done_1
L_kv_ok_201:
    s_waitcnt lgkmcnt(0)
    v_min_u32 v64, -2, v112
    v_min_u32 v65, -2, v113
    v_min_u32 v66, -2, v114
    v_min_u32 v67, -2, v115
    v_min_u32 v68, -2, v116
    v_min_u32 v69, -2, v117
    v_min_u32 v70, -2, v118
    v_min_u32 v71, -2, v119
    v_min_u32 v72, -2, v120
    v_min_u32 v73, -2, v121
    v_min_u32 v74, -2, v122
    v_min_u32 v75, -2, v123
    v_min_u32 v76, -2, v124
    v_min_u32 v77, -2, v125
    v_min_u32 v78, -2, v126
    v_min_u32 v79, -2, v127
    v_mov_b32 v16, 0
    v_mov_b32 v17, 0
    v_mov_b32 v18, 0
    v_mov_b32 v19, 0
    v_mov_b32 v20, 0
    v_mov_b32 v21, 0
    v_mov_b32 v22, 0
    v_mov_b32 v23, 0
L_c_join_194:
    s_mov_b32 s60, 0
    s_mov_b32 s61, 0
    s_mov_b32 s62, 0
    s_cmp_lg_u32 s44, 0
    s_cbranch_scc1 L_c_nh_202
    v_lshlrev_b32 v17, 3, v1
    s_lshl_b32 s46, s40, 3
    v_mov_b32 v21, s46
    s_mov_b32 s45, 0x101000
    s_mov_b32 s70, 0
L_c_rp_203:
    buffer_load_dwordx2 v[18:19], v17, s[12:15], s45 offen sc1
    buffer_load_dwordx2 v[22:23], v21, s[12:15], s45 offen offset:512 sc1
    s_waitcnt vmcnt(0)
    v_min3_u32 v20, v18, v19, v22
    v_min_u32 v20, v20, v23
    v_cmp_eq_u32 vcc, 0, v20
    s_cbranch_vccnz L_rt_204
    v_cmp_eq_u32 s[52:53], v18, v16
    v_cmp_eq_u32 vcc, v19, v16
    v_cmp_eq_u32 s[54:55], v22, v16
    v_cmp_eq_u32 s[56:57], v23, v16
    s_lshl_b32 s46, s40, 3
    s_nop 3
    s_and_b64 s[52:53], s[52:53], vcc
    s_lshr_b64 s[52:53], s[52:53], s46
    s_and_b32 s52, s52, 0xff
    s_cmp_eq_u32 s52, 0xff
    s_cselect_b32 s52, 1, 0
    v_mov_b32 v16, s52
    v_mov_b32 v17, 26624
    ds_write_b32 v17, v16
L_c_nh_202:
    s_waitcnt lgkmcnt(0)
    s_barrier
    v_mov_b32 v17, 26624
    ds_read_b32 v16, v17
    s_waitcnt lgkmcnt(0)
    v_readfirstlane_b32 s52, v16
    s_nop 3
    s_cmp_ge_u32 s44, 4
    s_cbranch_scc1 L_vf_207
    s_mov_b32 s57, s58
    s_mov_b32 s58, 0
    s_cmp_ge_u32 s44, 2
    s_cbranch_scc1 L_sf_205
    buffer_load_dwordx4 v[32:35], v6, s[12:15], 0 offen sc1
L_sf_205:
    s_cmp_eq_u32 s52, 0
    s_cbranch_scc1 L_ss_206
.p2align 6
L_s_loop_209:
    v_mov_b32 v16, 0
    v_mov_b32 v17, 0
    v_mov_b32 v18, 0
    v_mov_b32 v19, 0
    s_add_u32 s58, s58, 4
    s_mov_b32 s70, 1
    s_waitcnt vmcnt(0)
    s_barrier
    ds_read_b128 v[64:67], v2 offset:0
    ds_read_b128 v[68:71], v2 offset:1024
    ds_read_b128 v[72:75], v2 offset:2048
    ds_read_b128 v[76:79], v2 offset:3072
    ds_read_b128 v[80:83], v2 offset:4096
    ds_read_b128 v[84:87], v2 offset:5120
    ds_read_b128 v[88:91], v2 offset:6144
    ds_read_b128 v[92:95], v2 offset:7168
    ds_read_b128 v[96:99], v2 offset:8192
    ds_read_b128 v[100:103], v2 offset:9216
    ds_read_b128 v[104:107], v2 offset:10240
    ds_read_b128 v[108:111], v2 offset:11264
    s_waitcnt lgkmcnt(11)
    v_smfmac_f32_16x16x64_bf16 v[16:19], v[64:67], a[0:7], v3
    ds_read_b128 v[112:115], v2 offset:12288
    s_waitcnt lgkmcnt(11)
    v_smfmac_f32_16x16x64_bf16 v[16:19], v[68:71], a[8:15], v3
    ds_read_b128 v[116:119], v2 offset:13312
    s_waitcnt lgkmcnt(11)
    v_smfmac_f32_16x16x64_bf16 v[16:19], v[72:75], a[16:23], v3
    ds_read_b128 v[120:123], v2 offset:14336
    s_waitcnt lgkmcnt(11)
    v_smfmac_f32_16x16x64_bf16 v[16:19], v[76:79], a[24:31], v3
    ds_read_b128 v[124:127], v2 offset:15360
    s_waitcnt lgkmcnt(11)
    v_smfmac_f32_16x16x64_bf16 v[16:19], v[80:83], a[32:39], v3
    s_waitcnt lgkmcnt(10)
    v_smfmac_f32_16x16x64_bf16 v[16:19], v[84:87], a[40:47], v3
    s_waitcnt lgkmcnt(9)
    v_smfmac_f32_16x16x64_bf16 v[16:19], v[88:91], a[48:55], v3
    s_waitcnt lgkmcnt(8)
    v_smfmac_f32_16x16x64_bf16 v[16:19], v[92:95], a[56:63], v3
    s_waitcnt lgkmcnt(7)
    v_smfmac_f32_16x16x64_bf16 v[16:19], v[96:99], a[64:71], v3
    s_waitcnt lgkmcnt(6)
    v_smfmac_f32_16x16x64_bf16 v[16:19], v[100:103], a[72:79], v3
    s_waitcnt lgkmcnt(5)
    v_smfmac_f32_16x16x64_bf16 v[16:19], v[104:107], a[80:87], v3
    s_waitcnt lgkmcnt(4)
    v_smfmac_f32_16x16x64_bf16 v[16:19], v[108:111], a[88:95], v3
    s_waitcnt lgkmcnt(3)
    v_smfmac_f32_16x16x64_bf16 v[16:19], v[112:115], a[96:103], v3
    s_waitcnt lgkmcnt(2)
    v_smfmac_f32_16x16x64_bf16 v[16:19], v[116:119], a[104:111], v3
    s_waitcnt lgkmcnt(1)
    v_smfmac_f32_16x16x64_bf16 v[16:19], v[120:123], a[112:119], v3
    s_waitcnt lgkmcnt(0)
    v_smfmac_f32_16x16x64_bf16 v[16:19], v[124:127], a[120:127], v3
    s_nop 7
    v_permlane32_swap_b32 v16, v18
    v_permlane32_swap_b32 v17, v19
    v_add_f32 v16, v16, v18
    v_add_f32 v17, v17, v19
    v_cvt_pk_bf16_f32 v16, v16, v17
    ds_write_b16 v5, v16
    ds_write_b16_d16_hi v5, v16 offset:16
    s_mov_b64 exec, 1
    ds_add_u32 v29, v30
    s_mov_b64 exec, -1
L_s_xl_211:
    ds_read_b32 v10, v29
    ds_read_b128 v[64:67], v2 offset:61440
    s_cmp_eq_u32 s60, 63
    s_cbranch_scc1 L_s_last_210
    s_cmp_ge_u32 s44, 2
    s_cbranch_scc1 L_s_w2_212
    s_waitcnt lgkmcnt(0)
    v_mfma_f32_16x16x32_bf16 v[16:19], v[32:35], v[64:67], 0
L_s_w2_212_b:
    v_cmp_ne_u32 vcc, s58, v10
    s_nop 0
    s_cbranch_vccnz L_rt_214
    s_mov_b64 exec, s[50:51]
    s_nop 3
    v_min_u32 v16, -2, v16
    v_min_u32 v17, -2, v17
    v_min_u32 v18, -2, v18
    v_min_u32 v19, -2, v19
    buffer_store_dwordx4 v[16:19], v4, s[12:15], s61 offen
    s_mov_b64 exec, -1
L_s_w3_213_b:
    s_sleep 5
    s_mov_b32 s70, 1
L_s_xp_215:
    buffer_load_dwordx4 v[64:67], v7, s[12:15], s61 offen offset:0 sc1
    buffer_load_dword v80, v28, s[12:15], s61 offen offset:0 sc1
    buffer_load_dwordx4 v[68:71], v7, s[12:15], s61 offen offset:1024 sc1
    buffer_load_dword v81, v28, s[12:15], s61 offen offset:256 sc1
    buffer_load_dwordx4 v[72:75], v7, s[12:15], s61 offen offset:2048 sc1
    buffer_load_dword v82, v28, s[12:15], s61 offen offset:512 sc1
    buffer_load_dwordx4 v[76:79], v7, s[12:15], s61 offen offset:3072 sc1
    buffer_load_dword v83, v28, s[12:15], s61 offen offset:768 sc1
    s_waitcnt vmcnt(4)
    v_add_f32 v16, v64, v68
    v_add_f32 v17, v65, v69
    v_add_f32 v18, v66, v70
    v_add_f32 v19, v67, v71
    v_add_f32 v20, v80, v81
    s_waitcnt vmcnt(2)
    v_add_f32 v16, v16, v72
    v_add_f32 v17, v17, v73
    v_add_f32 v18, v18, v74
    v_add_f32 v19, v19, v75
    v_add_f32 v20, v20, v82
    s_waitcnt vmcnt(0)
    v_add_f32 v16, v16, v76
    v_add_f32 v17, v17, v77
    v_add_f32 v18, v18, v78
    v_add_f32 v19, v19, v79
    v_add_f32 v20, v20, v83
    v_cmp_u_f32 s[46:47], v16, v17
    v_cmp_u_f32 s[48:49], v18, v19
    v_cmp_u_f32 vcc, v20, v20
    v_max3_f32 v10, v16, v17, v18
    s_or_b64 s[46:47], s[46:47], s[48:49]
    v_max3_f32 v10, v10, v19, v20
    s_or_b64 vcc, vcc, s[46:47]
    s_cbranch_scc1 L_s_xf_216
L_s_xok_217:
    v_max_f32_dpp v11, v10, v10 row_ror:8 row_mask:0xf bank_mask:0xf
    v_max_f32_dpp v10, v10, v10 row_ror:8 row_mask:0xf bank_mask:0xf
    s_nop 1
    v_permlane16_swap_b32 v10, v11
    v_max_f32 v12, v10, v11
    v_max_f32 v10, v10, v11
    s_nop 1
    v_permlane32_swap_b32 v10, v12
    v_max_f32 v10, v10, v12
    v_mul_f32 v10, s66, v10
    v_fma_f32 v16, v16, s66, -v10
    v_fma_f32 v17, v17, s66, -v10
    v_fma_f32 v18, v18, s66, -v10
    v_fma_f32 v19, v19, s66, -v10
    v_fma_f32 v20, v20, s66, -v10
    v_exp_f32 v16, v16
    v_exp_f32 v17, v17
    v_exp_f32 v18, v18
    v_exp_f32 v19, v19
    v_exp_f32 v20, v20
    v_add_f32 v10, v16, v17
    v_add_f32 v11, v18, v19
    v_add_f32 v10, v10, v20
    v_add_f32 v10, v10, v11
    s_nop 1
    v_add_f32_dpp v11, v10, v10 row_ror:8 row_mask:0xf bank_mask:0xf
    v_add_f32_dpp v10, v10, v10 row_ror:8 row_mask:0xf bank_mask:0xf
    s_nop 1
    v_permlane16_swap_b32 v10, v11
    v_add_f32 v12, v10, v11
    v_add_f32 v10, v10, v11
    s_nop 1
    v_permlane32_swap_b32 v10, v12
    v_add_f32 v10, v10, v12
    v_rcp_f32 v10, v10
    s_nop 0
    v_mul_f32 v16, v16, v10
    v_mul_f32 v17, v17, v10
    v_mul_f32 v18, v18, v10
    v_mul_f32 v19, v19, v10
    v_mul_f32 v20, v20, v10
    v_cvt_pk_bf16_f32 v16, v16, v17
    v_cvt_pk_bf16_f32 v17, v18, v19
    v_cvt_pk_bf16_f32 v18, v20, v20
    ds_write_b64 v8, v[16:17]
    ds_write_b16 v9, v18
    s_add_u32 s63, s63, 786432
    s_cmp_ge_u32 s44, 2
    s_cbranch_scc1 L_s_nk_218
    buffer_load_dwordx4 v[32:35], v6, s[12:15], s63 offen sc1
L_s_nk_218:
    s_add_u32 s45, s63, 786432
    s_mov_b64 exec, 0xf
    buffer_load_dword v15, v14, s[12:15], s45 offen sc1
    s_mov_b64 exec, -1
    s_waitcnt lgkmcnt(0)
    s_barrier
    s_cmp_eq_u32 s44, 3
    s_cbranch_scc1 L_s_nr_219
    s_xor_b32 s45, s61, 0x8000
    s_mov_b64 exec, s[50:51]
    buffer_store_dwordx4 v[24:27], v4, s[12:15], s45 offen
    s_mov_b64 exec, -1
L_s_nr_219:
    s_cmp_lg_u32 s44, 3
    s_cbranch_scc1 L_s_np_220
    ds_read_b128 v[20:23], v6
    s_lshl_b32 s45, s60, 17
    s_add_u32 s45, s45, s67
    s_waitcnt lgkmcnt(0)
    v_min_u32 v20, -2, v20
    v_min_u32 v21, -2, v21
    v_min_u32 v22, -2, v22
    v_min_u32 v23, -2, v23
    buffer_store_dwordx4 v[20:23], v2, s[12:15], s45 offen sc1
L_s_np_220:
    s_add_u32 s68, s60, 3
    s_min_u32 s68, s68, 63
    v_readlane_b32 s45, v0, 0
    v_readlane_b32 s46, v0, 1
    s_nop 0
    s_min_u32 s45, s45, s46
    s_max_u32 s69, s69, s45
    s_cmp_gt_u32 s69, s68
    s_cbranch_scc1 L_kv_ok_223
    s_mov_b32 s70, 0
L_kv_lp_222:
    v_and_b32 v22, 1, v1
    v_lshlrev_b32 v22, 9, v22
    buffer_load_dword v23, v22, s[12:15], s57 offen sc1
    s_waitcnt vmcnt(0)
    v_readlane_b32 s69, v23, 0
    v_readlane_b32 s45, v23, 1
    s_add_u32 s70, s70, 1
    s_nop 2
    s_min_u32 s69, s69, s45
    s_cmp_gt_u32 s69, s68
    s_cbranch_scc1 L_kv_ok_223
    s_sleep 4
    s_cmp_lt_u32 s70, 524288
    s_cbranch_scc1 L_kv_lp_222
    s_branch L_c_done_1
L_kv_ok_223:
    s_add_u32 s45, s60, 7
    s_min_u32 s45, s45, 63
    s_cmp_gt_u32 s69, s45
    s_cbranch_scc1 L_s_na_221
    v_and_b32 v22, 1, v1
    v_lshlrev_b32 v22, 9, v22
    buffer_load_dword v0, v22, s[12:15], s57 offen sc1
L_s_na_221:
    s_cmp_lt_u32 s60, s59
    s_cbranch_scc1 L_s_pr_224
L_s_pr_224_b:
    s_add_u32 s60, s60, 1
    s_add_u32 s61, s61, 0x4000
    s_and_b32 s61, s61, 0xffff
    s_branch L_s_loop_209
L_s_last_210:
    s_waitcnt lgkmcnt(0)
    s_barrier
    s_cmp_lg_u32 s44, 3
    s_cbranch_scc1 L_s_np_225
    ds_read_b128 v[20:23], v6
    s_lshl_b32 s45, s60, 17
    s_add_u32 s45, s45, s67
    s_waitcnt lgkmcnt(0)
    v_min_u32 v20, -2, v20
    v_min_u32 v21, -2, v21
    v_min_u32 v22, -2, v22
    v_min_u32 v23, -2, v23
    buffer_store_dwordx4 v[20:23], v2, s[12:15], s45 offen sc1
L_s_np_225:
    s_branch L_replica
L_rt_204:
    s_add_u32 s70, s70, 1
    s_cmp_lt_u32 s70, 524288
    s_cbranch_scc1 L_c_rp_203
    s_branch L_c_done_1
L_rt_214:
    s_add_u32 s70, s70, 1
    s_cmp_lt_u32 s70, 524288
    s_cbranch_scc1 L_s_xl_211
    s_branch L_c_done_1
L_s_w2_212:
    s_cmp_eq_u32 s44, 3
    s_cbranch_scc1 L_s_w3_213
    s_waitcnt lgkmcnt(0)
    v_mfma_f32_16x16x32_bf16 v[16:19], v[64:67], v[64:67], 0
    s_branch L_s_w2_212_b
L_s_w3_213:
    s_sleep 3
    s_branch L_s_w3_213_b
L_s_xf_216:
    v_max3_u32 v11, v64, v65, v66
    v_max3_u32 v11, v11, v67, v68
    v_max3_u32 v11, v11, v69, v70
    v_max3_u32 v11, v11, v71, v72
    v_max3_u32 v11, v11, v73, v74
    v_max3_u32 v11, v11, v75, v76
    v_max3_u32 v11, v11, v77, v78
    v_max3_u32 v11, v11, v79, v80
    v_max3_u32 v11, v11, v81, v82
    v_max_u32 v11, v11, v83
    v_cmp_eq_u32 vcc, -1, v11
    s_add_u32 s70, s70, 1
    s_cbranch_vccz L_s_xok_217
    s_cmp_lt_u32 s70, 524288
    s_cbranch_scc1 L_s_xp_215
    s_branch L_c_done_1
L_s_pr_224:
    s_lshl_b32 s45, s40, 21
    s_lshl_b32 s46, s60, 14
    s_add_u32 s45, s45, s46
    s_add_u32 s45, s45, 0x79c0000
    v_and_b32 v10, 15, v1
    v_lshlrev_b32 v10, 4, v10
    v_bfe_u32 v11, v1, 4, 1
    v_lshl_add_u32 v10, v11, 13, v10
    buffer_store_dwordx4 v[24:27], v10, s[12:15], s45 offen sc1
    s_add_u32 s46, s45, 0x1000
    s_load_dword s47, s[22:23], s46
    s_add_u32 s46, s45, 0x2000
    s_add_u32 s48, s45, 0x2080
    s_add_u32 s49, s45, 0x80
    s_waitcnt vmcnt(0) lgkmcnt(0)
    s_memtime s[72:73]
    s_waitcnt lgkmcnt(0)
    s_load_dword s47, s[22:23], s45
    s_waitcnt lgkmcnt(0)
    s_memtime s[74:75]
    s_waitcnt lgkmcnt(0)
    s_load_dword s47, s[22:23], s46
    s_waitcnt lgkmcnt(0)
    s_memtime s[76:77]
    s_waitcnt lgkmcnt(0)
    s_sub_u32 s76, s76, s74
    s_sub_u32 s74, s74, s72
    s_cmp_gt_u32 s74, s76
    s_addc_u32 s64, s64, 0
    s_cmp_lg_u32 s60, 2
    s_cbranch_scc1 L_s_pr_224_b
    s_cmp_ge_u32 s64, 2
    s_cselect_b32 s45, 3, 2
    v_mov_b32 v10, s45
    v_mov_b32 v11, 0
    s_lshl_b32 s45, s40, 7
    s_add_u32 s45, s45, 0x101800
    s_mov_b64 exec, 1
    buffer_store_dword v10, v11, s[12:15], s45 offen sc1
    s_mov_b64 exec, -1
    s_branch L_s_pr_224_b
L_ss_206:
.p2align 6
L_s_loop_226:
    v_mov_b32 v16, 0
    v_mov_b32 v17, 0
    v_mov_b32 v18, 0
    v_mov_b32 v19, 0
    s_add_u32 s58, s58, 4
    s_mov_b32 s70, 1
    s_waitcnt vmcnt(0)
    s_barrier
    ds_read_b128 v[64:67], v2 offset:0
    ds_read_b128 v[68:71], v2 offset:1024
    ds_read_b128 v[72:75], v2 offset:2048
    ds_read_b128 v[76:79], v2 offset:3072
    ds_read_b128 v[80:83], v2 offset:4096
    ds_read_b128 v[84:87], v2 offset:5120
    ds_read_b128 v[88:91], v2 offset:6144
    ds_read_b128 v[92:95], v2 offset:7168
    ds_read_b128 v[96:99], v2 offset:8192
    ds_read_b128 v[100:103], v2 offset:9216
    ds_read_b128 v[104:107], v2 offset:10240
    ds_read_b128 v[108:111], v2 offset:11264
    s_waitcnt lgkmcnt(11)
    v_smfmac_f32_16x16x64_bf16 v[16:19], v[64:67], a[0:7], v3
    ds_read_b128 v[112:115], v2 offset:12288
    s_waitcnt lgkmcnt(11)
    v_smfmac_f32_16x16x64_bf16 v[16:19], v[68:71], a[8:15], v3
    ds_read_b128 v[116:119], v2 offset:13312
    s_waitcnt lgkmcnt(11)
    v_smfmac_f32_16x16x64_bf16 v[16:19], v[72:75], a[16:23], v3
    ds_read_b128 v[120:123], v2 offset:14336
    s_waitcnt lgkmcnt(11)
    v_smfmac_f32_16x16x64_bf16 v[16:19], v[76:79], a[24:31], v3
    ds_read_b128 v[124:127], v2 offset:15360
    s_waitcnt lgkmcnt(11)
    v_smfmac_f32_16x16x64_bf16 v[16:19], v[80:83], a[32:39], v3
    s_waitcnt lgkmcnt(10)
    v_smfmac_f32_16x16x64_bf16 v[16:19], v[84:87], a[40:47], v3
    s_waitcnt lgkmcnt(9)
    v_smfmac_f32_16x16x64_bf16 v[16:19], v[88:91], a[48:55], v3
    s_waitcnt lgkmcnt(8)
    v_smfmac_f32_16x16x64_bf16 v[16:19], v[92:95], a[56:63], v3
    s_waitcnt lgkmcnt(7)
    v_smfmac_f32_16x16x64_bf16 v[16:19], v[96:99], a[64:71], v3
    s_waitcnt lgkmcnt(6)
    v_smfmac_f32_16x16x64_bf16 v[16:19], v[100:103], a[72:79], v3
    s_waitcnt lgkmcnt(5)
    v_smfmac_f32_16x16x64_bf16 v[16:19], v[104:107], a[80:87], v3
    s_waitcnt lgkmcnt(4)
    v_smfmac_f32_16x16x64_bf16 v[16:19], v[108:111], a[88:95], v3
    s_waitcnt lgkmcnt(3)
    v_smfmac_f32_16x16x64_bf16 v[16:19], v[112:115], a[96:103], v3
    s_waitcnt lgkmcnt(2)
    v_smfmac_f32_16x16x64_bf16 v[16:19], v[116:119], a[104:111], v3
    s_waitcnt lgkmcnt(1)
    v_smfmac_f32_16x16x64_bf16 v[16:19], v[120:123], a[112:119], v3
    s_waitcnt lgkmcnt(0)
    v_smfmac_f32_16x16x64_bf16 v[16:19], v[124:127], a[120:127], v3
    s_nop 7
    v_permlane32_swap_b32 v16, v18
    v_permlane32_swap_b32 v17, v19
    v_add_f32 v16, v16, v18
    v_add_f32 v17, v17, v19
    v_cvt_pk_bf16_f32 v16, v16, v17
    ds_write_b16 v5, v16
    ds_write_b16_d16_hi v5, v16 offset:16
    s_mov_b64 exec, 1
    ds_add_u32 v29, v30
    s_mov_b64 exec, -1
L_s_xl_228:
    ds_read_b32 v10, v29
    ds_read_b128 v[64:67], v2 offset:61440
    s_cmp_eq_u32 s60, 63
    s_cbranch_scc1 L_s_last_227
    s_cmp_ge_u32 s44, 2
    s_cbranch_scc1 L_s_w2_229
    s_waitcnt lgkmcnt(0)
    v_mfma_f32_16x16x32_bf16 v[16:19], v[32:35], v[64:67], 0
L_s_w2_229_b:
    v_cmp_ne_u32 vcc, s58, v10
    s_nop 0
    s_cbranch_vccnz L_rt_231
    s_mov_b64 exec, s[50:51]
    s_nop 3
    v_min_u32 v16, -2, v16
    v_min_u32 v17, -2, v17
    v_min_u32 v18, -2, v18
    v_min_u32 v19, -2, v19
    buffer_store_dwordx4 v[16:19], v4, s[12:15], s61 offen sc1
    s_mov_b64 exec, -1
L_s_w3_230_b:
    s_sleep 5
    s_mov_b32 s70, 1
L_s_xp_232:
    buffer_load_dwordx4 v[64:67], v7, s[12:15], s61 offen offset:0 sc1
    buffer_load_dword v80, v28, s[12:15], s61 offen offset:0 sc1
    buffer_load_dwordx4 v[68:71], v7, s[12:15], s61 offen offset:1024 sc1
    buffer_load_dword v81, v28, s[12:15], s61 offen offset:256 sc1
    buffer_load_dwordx4 v[72:75], v7, s[12:15], s61 offen offset:2048 sc1
    buffer_load_dword v82, v28, s[12:15], s61 offen offset:512 sc1
    buffer_load_dwordx4 v[76:79], v7, s[12:15], s61 offen offset:3072 sc1
    buffer_load_dword v83, v28, s[12:15], s61 offen offset:768 sc1
    s_waitcnt vmcnt(4)
    v_add_f32 v16, v64, v68
    v_add_f32 v17, v65, v69
    v_add_f32 v18, v66, v70
    v_add_f32 v19, v67, v71
    v_add_f32 v20, v80, v81
    s_waitcnt vmcnt(2)
    v_add_f32 v16, v16, v72
    v_add_f32 v17, v17, v73
    v_add_f32 v18, v18, v74
    v_add_f32 v19, v19, v75
    v_add_f32 v20, v20, v82
    s_waitcnt vmcnt(0)
    v_add_f32 v16, v16, v76
    v_add_f32 v17, v17, v77
    v_add_f32 v18, v18, v78
    v_add_f32 v19, v19, v79
    v_add_f32 v20, v20, v83
    v_cmp_u_f32 s[46:47], v16, v17
    v_cmp_u_f32 s[48:49], v18, v19
    v_cmp_u_f32 vcc, v20, v20
    v_max3_f32 v10, v16, v17, v18
    s_or_b64 s[46:47], s[46:47], s[48:49]
    v_max3_f32 v10, v10, v19, v20
    s_or_b64 vcc, vcc, s[46:47]
    s_cbranch_scc1 L_s_xf_233
L_s_xok_234:
    v_max_f32_dpp v11, v10, v10 row_ror:8 row_mask:0xf bank_mask:0xf
    v_max_f32_dpp v10, v10, v10 row_ror:8 row_mask:0xf bank_mask:0xf
    s_nop 1
    v_permlane16_swap_b32 v10, v11
    v_max_f32 v12, v10, v11
    v_max_f32 v10, v10, v11
    s_nop 1
    v_permlane32_swap_b32 v10, v12
    v_max_f32 v10, v10, v12
    v_mul_f32 v10, s66, v10
    v_fma_f32 v16, v16, s66, -v10
    v_fma_f32 v17, v17, s66, -v10
    v_fma_f32 v18, v18, s66, -v10
    v_fma_f32 v19, v19, s66, -v10
    v_fma_f32 v20, v20, s66, -v10
    v_exp_f32 v16, v16
    v_exp_f32 v17, v17
    v_exp_f32 v18, v18
    v_exp_f32 v19, v19
    v_exp_f32 v20, v20
    v_add_f32 v10, v16, v17
    v_add_f32 v11, v18, v19
    v_add_f32 v10, v10, v20
    v_add_f32 v10, v10, v11
    s_nop 1
    v_add_f32_dpp v11, v10, v10 row_ror:8 row_mask:0xf bank_mask:0xf
    v_add_f32_dpp v10, v10, v10 row_ror:8 row_mask:0xf bank_mask:0xf
    s_nop 1
    v_permlane16_swap_b32 v10, v11
    v_add_f32 v12, v10, v11
    v_add_f32 v10, v10, v11
    s_nop 1
    v_permlane32_swap_b32 v10, v12
    v_add_f32 v10, v10, v12
    v_rcp_f32 v10, v10
    s_nop 0
    v_mul_f32 v16, v16, v10
    v_mul_f32 v17, v17, v10
    v_mul_f32 v18, v18, v10
    v_mul_f32 v19, v19, v10
    v_mul_f32 v20, v20, v10
    v_cvt_pk_bf16_f32 v16, v16, v17
    v_cvt_pk_bf16_f32 v17, v18, v19
    v_cvt_pk_bf16_f32 v18, v20, v20
    ds_write_b64 v8, v[16:17]
    ds_write_b16 v9, v18
    s_add_u32 s63, s63, 786432
    s_cmp_ge_u32 s44, 2
    s_cbranch_scc1 L_s_nk_235
    buffer_load_dwordx4 v[32:35], v6, s[12:15], s63 offen sc1
L_s_nk_235:
    s_add_u32 s45, s63, 786432
    s_mov_b64 exec, 0xf
    buffer_load_dword v15, v14, s[12:15], s45 offen sc1
    s_mov_b64 exec, -1
    s_waitcnt lgkmcnt(0)
    s_barrier
    s_cmp_eq_u32 s44, 3
    s_cbranch_scc1 L_s_nr_236
    s_xor_b32 s45, s61, 0x8000
    s_mov_b64 exec, s[50:51]
    buffer_store_dwordx4 v[24:27], v4, s[12:15], s45 offen sc1
    s_mov_b64 exec, -1
L_s_nr_236:
    s_cmp_lg_u32 s44, 3
    s_cbranch_scc1 L_s_np_237
    ds_read_b128 v[20:23], v6
    s_lshl_b32 s45, s60, 17
    s_add_u32 s45, s45, s67
    s_waitcnt lgkmcnt(0)
    v_min_u32 v20, -2, v20
    v_min_u32 v21, -2, v21
    v_min_u32 v22, -2, v22
    v_min_u32 v23, -2, v23
    buffer_store_dwordx4 v[20:23], v2, s[12:15], s45 offen sc1
L_s_np_237:
    s_add_u32 s68, s60, 3
    s_min_u32 s68, s68, 63
    v_readlane_b32 s45, v0, 0
    v_readlane_b32 s46, v0, 1
    s_nop 0
    s_min_u32 s45, s45, s46
    s_max_u32 s69, s69, s45
    s_cmp_gt_u32 s69, s68
    s_cbranch_scc1 L_kv_ok_240
    s_mov_b32 s70, 0
L_kv_lp_239:
    v_and_b32 v22, 1, v1
    v_lshlrev_b32 v22, 9, v22
    buffer_load_dword v23, v22, s[12:15], s57 offen sc1
    s_waitcnt vmcnt(0)
    v_readlane_b32 s69, v23, 0
    v_readlane_b32 s45, v23, 1
    s_add_u32 s70, s70, 1
    s_nop 2
    s_min_u32 s69, s69, s45
    s_cmp_gt_u32 s69, s68
    s_cbranch_scc1 L_kv_ok_240
    s_sleep 4
    s_cmp_lt_u32 s70, 524288
    s_cbranch_scc1 L_kv_lp_239
    s_branch L_c_done_1
L_kv_ok_240:
    s_add_u32 s45, s60, 7
    s_min_u32 s45, s45, 63
    s_cmp_gt_u32 s69, s45
    s_cbranch_scc1 L_s_na_238
    v_and_b32 v22, 1, v1
    v_lshlrev_b32 v22, 9, v22
    buffer_load_dword v0, v22, s[12:15], s57 offen sc1
L_s_na_238:
    s_cmp_lt_u32 s60, s59
    s_cbranch_scc1 L_s_pr_241
L_s_pr_241_b:
    s_add_u32 s60, s60, 1
    s_add_u32 s61, s61, 0x4000
    s_and_b32 s61, s61, 0xffff
    s_branch L_s_loop_226
L_s_last_227:
    s_waitcnt lgkmcnt(0)
    s_barrier
    s_cmp_lg_u32 s44, 3
    s_cbranch_scc1 L_s_np_242
    ds_read_b128 v[20:23], v6
    s_lshl_b32 s45, s60, 17
    s_add_u32 s45, s45, s67
    s_waitcnt lgkmcnt(0)
    v_min_u32 v20, -2, v20
    v_min_u32 v21, -2, v21
    v_min_u32 v22, -2, v22
    v_min_u32 v23, -2, v23
    buffer_store_dwordx4 v[20:23], v2, s[12:15], s45 offen sc1
L_s_np_242:
    s_branch L_replica
L_rt_231:
    s_add_u32 s70, s70, 1
    s_cmp_lt_u32 s70, 524288
    s_cbranch_scc1 L_s_xl_228
    s_branch L_c_done_1
L_s_w2_229:
    s_cmp_eq_u32 s44, 3
    s_cbranch_scc1 L_s_w3_230
    s_waitcnt lgkmcnt(0)
    v_mfma_f32_16x16x32_bf16 v[16:19], v[64:67], v[64:67], 0
    s_branch L_s_w2_229_b
L_s_w3_230:
    s_sleep 3
    s_branch L_s_w3_230_b
L_s_xf_233:
    v_max3_u32 v11, v64, v65, v66
    v_max3_u32 v11, v11, v67, v68
    v_max3_u32 v11, v11, v69, v70
    v_max3_u32 v11, v11, v71, v72
    v_max3_u32 v11, v11, v73, v74
    v_max3_u32 v11, v11, v75, v76
    v_max3_u32 v11, v11, v77, v78
    v_max3_u32 v11, v11, v79, v80
    v_max3_u32 v11, v11, v81, v82
    v_max_u32 v11, v11, v83
    v_cmp_eq_u32 vcc, -1, v11
    s_add_u32 s70, s70, 1
    s_cbranch_vccz L_s_xok_234
    s_cmp_lt_u32 s70, 524288
    s_cbranch_scc1 L_s_xp_232
    s_branch L_c_done_1
L_s_pr_241:
    s_lshl_b32 s45, s40, 21
    s_lshl_b32 s46, s60, 14
    s_add_u32 s45, s45, s46
    s_add_u32 s45, s45, 0x79c0000
    v_and_b32 v10, 15, v1
    v_lshlrev_b32 v10, 4, v10
    v_bfe_u32 v11, v1, 4, 1
    v_lshl_add_u32 v10, v11, 13, v10
    buffer_store_dwordx4 v[24:27], v10, s[12:15], s45 offen sc1
    s_add_u32 s46, s45, 0x1000
    s_load_dword s47, s[22:23], s46
    s_add_u32 s46, s45, 0x2000
    s_add_u32 s48, s45, 0x2080
    s_add_u32 s49, s45, 0x80
    s_waitcnt vmcnt(0) lgkmcnt(0)
    s_memtime s[72:73]
    s_waitcnt lgkmcnt(0)
    s_load_dword s47, s[22:23], s45
    s_waitcnt lgkmcnt(0)
    s_memtime s[74:75]
    s_waitcnt lgkmcnt(0)
    s_load_dword s47, s[22:23], s46
    s_waitcnt lgkmcnt(0)
    s_memtime s[76:77]
    s_waitcnt lgkmcnt(0)
    s_sub_u32 s76, s76, s74
    s_sub_u32 s74, s74, s72
    s_cmp_gt_u32 s74, s76
    s_addc_u32 s64, s64, 0
    s_cmp_lg_u32 s60, 2
    s_cbranch_scc1 L_s_pr_241_b
    s_cmp_ge_u32 s64, 2
    s_cselect_b32 s45, 3, 2
    v_mov_b32 v10, s45
    v_mov_b32 v11, 0
    s_lshl_b32 s45, s40, 7
    s_add_u32 s45, s45, 0x101800
    s_mov_b64 exec, 1
    buffer_store_dword v10, v11, s[12:15], s45 offen sc1
    s_mov_b64 exec, -1
    s_branch L_s_pr_241_b
L_vf_207:
    s_cmp_eq_u32 s52, 0
    s_cbranch_scc1 L_vs_208
    s_mov_b32 s70, 1
    v_mov_b32 v16, 0
    v_mov_b32 v17, 0
    s_branch L_v_l1m_245
.p2align 6
L_v_loop_243:
    s_mov_b32 s70, 1
    buffer_load_dwordx4 v[64:67], v9, s[12:15], s61 offen offset:0 sc1
    buffer_load_dwordx4 v[68:71], v9, s[12:15], s61 offen offset:1024 sc1
    buffer_load_dwordx4 v[72:75], v9, s[12:15], s61 offen offset:2048 sc1
    buffer_load_dwordx4 v[76:79], v9, s[12:15], s61 offen offset:3072 sc1
    v_mov_b32 v16, 0
    v_mov_b32 v17, 0
    v_mov_b32 v18, 0
    v_mov_b32 v19, 0
    v_mov_b32 v20, 0
    v_mov_b32 v21, 0
    v_mov_b32 v22, 0
    v_mov_b32 v23, 0
L_v_l1m_245:
    s_waitcnt vmcnt(3)
    ds_write_b128 v10, v[64:67] offset:0
    v_max3_u32 v24, v64, v65, v66
    v_max_u32 v24, v24, v67
    v_cmp_eq_u32 s[48:49], -1, v24
    s_waitcnt vmcnt(2)
    ds_write_b128 v10, v[68:71] offset:1024
    v_max3_u32 v24, v68, v69, v70
    v_max_u32 v24, v24, v71
    v_cmp_eq_u32 s[50:51], -1, v24
    s_waitcnt vmcnt(1)
    ds_write_b128 v10, v[72:75] offset:2048
    v_max3_u32 v24, v72, v73, v74
    v_max_u32 v24, v24, v75
    v_cmp_eq_u32 s[52:53], -1, v24
    s_waitcnt vmcnt(0)
    ds_write_b128 v10, v[76:79] offset:3072
    v_max3_u32 v24, v76, v77, v78
    v_max_u32 v24, v24, v79
    v_cmp_eq_u32 s[54:55], -1, v24
    s_or_b64 s[46:47], s[48:49], s[50:51]
    s_or_b64 vcc, s[52:53], s[54:55]
    s_or_b64 vcc, vcc, s[46:47]
    s_cbranch_scc1 L_v_l1_244
L_v_l1ok_246:
    s_waitcnt lgkmcnt(0)
    s_barrier
    v_smfmac_f32_16x16x64_bf16 v[16:19], v[64:67], a[0:7], v3
    v_smfmac_f32_16x16x64_bf16 v[20:23], v[64:67], a[32:39], v3
    v_smfmac_f32_16x16x64_bf16 v[16:19], v[68:71], a[8:15], v3
    v_smfmac_f32_16x16x64_bf16 v[20:23], v[68:71], a[40:47], v3
    v_smfmac_f32_16x16x64_bf16 v[16:19], v[72:75], a[16:23], v3
    v_smfmac_f32_16x16x64_bf16 v[20:23], v[72:75], a[48:55], v3
    v_smfmac_f32_16x16x64_bf16 v[16:19], v[76:79], a[24:31], v3
    v_smfmac_f32_16x16x64_bf16 v[20:23], v[76:79], a[56:63], v3
    s_add_u32 s46, s65, 4096
    buffer_load_dwordx4 v[32:35], v15, s[12:15], s65 offen offset:0 sc1
    buffer_load_dwordx4 v[48:51], v15, s[12:15], s46 offen offset:0 sc1
    buffer_load_dwordx4 v[36:39], v15, s[12:15], s65 offen offset:1024 sc1
    buffer_load_dwordx4 v[52:55], v15, s[12:15], s46 offen offset:1024 sc1
    buffer_load_dwordx4 v[40:43], v15, s[12:15], s65 offen offset:2048 sc1
    buffer_load_dwordx4 v[56:59], v15, s[12:15], s46 offen offset:2048 sc1
    buffer_load_dwordx4 v[44:47], v15, s[12:15], s65 offen offset:3072 sc1
    buffer_load_dwordx4 v[60:63], v15, s[12:15], s46 offen offset:3072 sc1
    s_add_u32 s65, s65, 786432
    v_permlane32_swap_b32 v16, v18
    v_permlane32_swap_b32 v17, v19
    v_permlane32_swap_b32 v20, v22
    v_permlane32_swap_b32 v21, v23
    v_add_f32 v16, v16, v18
    v_add_f32 v17, v17, v19
    v_add_f32 v18, v20, v22
    v_add_f32 v19, v21, v23
    ds_write_b128 v14, v[16:19]
    s_mov_b64 exec, 1
    ds_add_u32 v29, v30
    s_mov_b64 exec, -1
    s_add_u32 s58, s58, 4
    s_bitcmp1_b32 s44, 0
    s_cbranch_scc1 L_v_k1_248
    s_mov_b32 s70, 0
L_v_rl_249:
    ds_read_b32 v24, v29
    ds_read_b64 v[16:17], v13 offset:0
    ds_read_b64 v[18:19], v13 offset:1024
    ds_read_b64 v[20:21], v13 offset:2048
    ds_read_b64 v[22:23], v13 offset:3072
    s_waitcnt lgkmcnt(2)
    v_cmp_ne_u32 vcc, s58, v24
    v_add_f32 v16, v16, v18
    v_add_f32 v17, v17, v19
    s_waitcnt lgkmcnt(0)
    s_cbranch_vccnz L_rt_250
    v_add_f32 v20, v20, v22
    v_add_f32 v21, v21, v23
    v_add_f32 v16, v16, v20
    v_add_f32 v17, v17, v21
    s_mov_b32 vcc_lo, 0x55555555
    s_mov_b32 vcc_hi, 0x55555555
    v_cndmask_b32_dpp v18, v17, v16, vcc quad_perm:[1,0,3,2] row_mask:0xf bank_mask:0xf
    s_not_b64 vcc, vcc
    v_cndmask_b32_dpp v19, v16, v17, vcc quad_perm:[1,0,3,2] row_mask:0xf bank_mask:0xf
    v_cvt_pk_bf16_f32 v18, v18, v19
    v_min_u32 v18, -2, v18
    buffer_store_dword v18, v4, s[12:15], s62 offen
    ds_write_b32 v5, v18
L_v_k1_248:
    s_cmp_eq_u32 s60, 63
    s_cbranch_scc1 L_v_last_247
    ds_read_b128 v[80:83], v27 offset:32768
    ds_read_b128 v[84:87], v27 offset:36864
    ds_read_b128 v[88:91], v27 offset:40960
    ds_read_b128 v[92:95], v27 offset:45056
    v_mov_b32 v96, 0
    v_mov_b32 v97, 0
    v_mov_b32 v98, 0
    v_mov_b32 v99, 0
    v_mov_b32 v100, 0
    v_mov_b32 v101, 0
    v_mov_b32 v102, 0
    v_mov_b32 v103, 0
    v_mov_b32 v104, 0
    v_mov_b32 v105, 0
    v_mov_b32 v106, 0
    v_mov_b32 v107, 0
    v_mov_b32 v108, 0
    v_mov_b32 v109, 0
    v_mov_b32 v110, 0
    v_mov_b32 v111, 0
    s_bitcmp1_b32 s44, 0
    s_cbranch_scc0 L_v_sv_251
    s_sleep 3
L_v_sv_251:
    s_sleep 4
    s_mov_b32 s70, 1
L_v_vp_252:
    buffer_load_dwordx4 v[64:67], v11, s[12:15], s62 offen offset:0 sc1
    buffer_load_dwordx4 v[68:71], v11, s[12:15], s62 offen offset:1024 sc1
    s_waitcnt vmcnt(0)
    v_max3_u32 v20, v64, v65, v66
    v_max3_u32 v20, v20, v67, v68
    v_max3_u32 v20, v20, v69, v70
    v_max_u32 v20, v20, v71
    v_cmp_eq_u32 vcc, -1, v20
    s_cbranch_vccnz L_rt_253
    v_smfmac_f32_16x16x64_bf16 v[96:99], v[64:67], a[64:71], v3
    v_smfmac_f32_16x16x64_bf16 v[96:99], v[68:71], a[72:79], v3
    v_smfmac_f32_16x16x64_bf16 v[100:103], v[64:67], a[80:87], v3
    v_smfmac_f32_16x16x64_bf16 v[100:103], v[68:71], a[88:95], v3
    v_smfmac_f32_16x16x64_bf16 v[104:107], v[64:67], a[96:103], v3
    v_smfmac_f32_16x16x64_bf16 v[104:107], v[68:71], a[104:111], v3
    v_smfmac_f32_16x16x64_bf16 v[108:111], v[64:67], a[112:119], v3
    v_smfmac_f32_16x16x64_bf16 v[108:111], v[68:71], a[120:127], v3
    s_nop 1
    v_cvt_pk_bf16_f32 v96, v96, v97
    v_cvt_pk_bf16_f32 v97, v98, v99
    ds_write_b64 v12, v[96:97] offset:0
    v_cvt_pk_bf16_f32 v100, v100, v101
    v_cvt_pk_bf16_f32 v101, v102, v103
    ds_write_b64 v12, v[100:101] offset:2048
    v_cvt_pk_bf16_f32 v104, v104, v105
    v_cvt_pk_bf16_f32 v105, v106, v107
    ds_write_b64 v12, v[104:105] offset:4096
    v_cvt_pk_bf16_f32 v108, v108, v109
    v_cvt_pk_bf16_f32 v109, v110, v111
    ds_write_b64 v12, v[108:109] offset:6144
    s_waitcnt lgkmcnt(0)
    s_barrier
    ds_read_b128 v[96:99], v2 offset:16384
    ds_read_b128 v[100:103], v2 offset:17408
    ds_read_b128 v[104:107], v2 offset:18432
    ds_read_b128 v[108:111], v2 offset:19456
    ds_read_b128 v[112:115], v31 offset:0
    ds_read_b128 v[116:119], v25 offset:0
    ds_read_b128 v[120:123], v31 offset:512
    ds_read_b128 v[124:127], v25 offset:1024
    s_waitcnt lgkmcnt(7)
    v_mfma_f32_16x16x32_bf16 v[16:19], v[80:83], v[96:99], 0
    s_waitcnt lgkmcnt(6)
    v_mfma_f32_16x16x32_bf16 v[16:19], v[84:87], v[100:103], v[16:19]
    s_waitcnt lgkmcnt(5)
    v_mfma_f32_16x16x32_bf16 v[16:19], v[88:91], v[104:107], v[16:19]
    s_waitcnt lgkmcnt(4)
    v_mfma_f32_16x16x32_bf16 v[16:19], v[92:95], v[108:111], v[16:19]
    s_waitcnt lgkmcnt(2)
    v_mfma_f32_16x16x32_bf16 v[16:19], v[116:119], v[112:115], v[16:19]
    s_waitcnt lgkmcnt(0)
    v_mfma_f32_16x16x32_bf16 v[16:19], v[124:127], v[120:123], v[16:19]
    s_mov_b32 exec_lo, 0x00ff00ff
    s_mov_b32 exec_hi, 0x00ff00ff
    s_nop 5
    v_cvt_pk_bf16_f32 v16, v16, v17
    v_cvt_pk_bf16_f32 v17, v18, v19
    v_min_u32 v16, -2, v16
    v_min_u32 v17, -2, v17
    buffer_store_dwordx2 v[16:17], v6, s[12:15], s63 offen sc1
    s_mov_b64 exec, -1
    s_add_u32 s61, s61, 0x4000
    s_and_b32 s61, s61, 0xffff
    s_mov_b32 s70, 1
    s_waitcnt vmcnt(1)
    v_mfma_f32_16x16x32_bf16 v[64:67], v[32:35], a[64:67], 0
    v_mfma_f32_16x16x32_bf16 v[68:71], v[48:51], a[64:67], 0
    v_mfma_f32_16x16x32_bf16 v[64:67], v[36:39], a[68:71], v[64:67]
    v_mfma_f32_16x16x32_bf16 v[68:71], v[52:55], a[68:71], v[68:71]
    v_mfma_f32_16x16x32_bf16 v[64:67], v[40:43], a[72:75], v[64:67]
    v_mfma_f32_16x16x32_bf16 v[68:71], v[56:59], a[72:75], v[68:71]
    v_mfma_f32_16x16x32_bf16 v[64:67], v[44:47], a[76:79], v[64:67]
    v_mfma_f32_16x16x32_bf16 v[68:71], v[60:63], a[76:79], v[68:71]
    s_sleep 6
    buffer_load_dword v96, v7, s[12:15], s63 offen offset:0 sc1
    buffer_load_dword v97, v7, s[12:15], s63 offen offset:256 sc1
    buffer_load_dword v98, v7, s[12:15], s63 offen offset:512 sc1
    buffer_load_dword v99, v7, s[12:15], s63 offen offset:768 sc1
    buffer_load_dword v100, v7, s[12:15], s63 offen offset:1024 sc1
    buffer_load_dword v101, v7, s[12:15], s63 offen offset:1280 sc1
    buffer_load_dword v102, v7, s[12:15], s63 offen offset:1536 sc1
    buffer_load_dword v103, v7, s[12:15], s63 offen offset:1792 sc1
    v_mfma_f32_16x16x32_bf16 v[72:75], v[32:35], a[80:83], 0
    v_mfma_f32_16x16x32_bf16 v[76:79], v[48:51], a[80:83], 0
    v_mfma_f32_16x16x32_bf16 v[72:75], v[36:39], a[84:87], v[72:75]
    v_mfma_f32_16x16x32_bf16 v[76:79], v[52:55], a[84:87], v[76:79]
    v_mfma_f32_16x16x32_bf16 v[72:75], v[40:43], a[88:91], v[72:75]
    v_mfma_f32_16x16x32_bf16 v[76:79], v[56:59], a[88:91], v[76:79]
    v_mfma_f32_16x16x32_bf16 v[72:75], v[44:47], a[92:95], v[72:75]
    v_mfma_f32_16x16x32_bf16 v[76:79], v[60:63], a[92:95], v[76:79]
    v_cvt_pk_bf16_f32 v64, v64, v65
    v_cvt_pk_bf16_f32 v65, v66, v67
    v_cvt_pk_bf16_f32 v66, v68, v69
    v_cvt_pk_bf16_f32 v67, v70, v71
    ds_write_b128 v10, v[64:67] offset:32768
    v_mfma_f32_16x16x32_bf16 v[80:83], v[32:35], a[96:99], 0
    v_mfma_f32_16x16x32_bf16 v[84:87], v[48:51], a[96:99], 0
    v_mfma_f32_16x16x32_bf16 v[80:83], v[36:39], a[100:103], v[80:83]
    v_mfma_f32_16x16x32_bf16 v[84:87], v[52:55], a[100:103], v[84:87]
    v_mfma_f32_16x16x32_bf16 v[80:83], v[40:43], a[104:107], v[80:83]
    v_mfma_f32_16x16x32_bf16 v[84:87], v[56:59], a[104:107], v[84:87]
    v_mfma_f32_16x16x32_bf16 v[80:83], v[44:47], a[108:111], v[80:83]
    v_mfma_f32_16x16x32_bf16 v[84:87], v[60:63], a[108:111], v[84:87]
    v_cvt_pk_bf16_f32 v72, v72, v73
    v_cvt_pk_bf16_f32 v73, v74, v75
    v_cvt_pk_bf16_f32 v74, v76, v77
    v_cvt_pk_bf16_f32 v75, v78, v79
    ds_write_b128 v10, v[72:75] offset:33792
L_v_gp_254:
    s_waitcnt vmcnt(7)
    v_lshlrev_b32 v20, 16, v96
    v_and_b32 v21, 0xffff0000, v96
    s_waitcnt vmcnt(6)
    v_lshlrev_b32 v22, 16, v97
    v_and_b32 v23, 0xffff0000, v97
    v_add_f32 v20, v20, v22
    v_add_f32 v21, v21, v23
    s_waitcnt vmcnt(5)
    v_lshlrev_b32 v22, 16, v98
    v_and_b32 v23, 0xffff0000, v98
    v_add_f32 v20, v20, v22
    v_add_f32 v21, v21, v23
    s_waitcnt vmcnt(4)
    v_lshlrev_b32 v22, 16, v99
    v_and_b32 v23, 0xffff0000, v99
    v_add_f32 v20, v20, v22
    v_add_f32 v21, v21, v23
    s_waitcnt vmcnt(3)
    v_lshlrev_b32 v22, 16, v100
    v_and_b32 v23, 0xffff0000, v100
    v_add_f32 v20, v20, v22
    v_add_f32 v21, v21, v23
    s_waitcnt vmcnt(2)
    v_lshlrev_b32 v22, 16, v101
    v_and_b32 v23, 0xffff0000, v101
    v_add_f32 v20, v20, v22
    v_add_f32 v21, v21, v23
    s_waitcnt vmcnt(1)
    v_lshlrev_b32 v22, 16, v102
    v_and_b32 v23, 0xffff0000, v102
    v_add_f32 v20, v20, v22
    v_add_f32 v21, v21, v23
    s_waitcnt vmcnt(0)
    v_lshlrev_b32 v22, 16, v103
    v_and_b32 v23, 0xffff0000, v103
    v_add_f32 v20, v20, v22
    v_add_f32 v21, v21, v23
    v_cmp_u_f32 vcc, v20, v21
    v_cvt_pk_bf16_f32 v20, v20, v21
    s_cbranch_vccnz L_v_gf_256
L_v_gok_255:
    buffer_store_dword v20, v8, s[12:15], s61 offen
    s_xor_b32 s45, s61, 0x8000
    buffer_store_dword v26, v8, s[12:15], s45 offen
    s_bitcmp1_b32 s44, 0
    s_cbranch_scc1 L_v_nr_257
    s_xor_b32 s45, s62, 0x4000
    buffer_store_dword v26, v4, s[12:15], s45 offen
L_v_nr_257:
    s_add_u32 s60, s60, 1
    s_add_u32 s62, s62, 0x2000
    s_and_b32 s62, s62, 0x7fff
    s_cmp_eq_u32 s60, 5
    s_cbranch_scc1 L_v_vt_258
L_v_vt_258_b:
    s_and_b32 s45, s60, 0x38
    s_bitcmp1_b64 s[66:67], s45
    s_cselect_b32 s45, 8192, 0
    s_lshl_b32 s63, s60, 18
    s_add_u32 s63, s63, s45
    v_mfma_f32_16x16x32_bf16 v[88:91], v[32:35], a[112:115], 0
    v_mfma_f32_16x16x32_bf16 v[92:95], v[48:51], a[112:115], 0
    v_mfma_f32_16x16x32_bf16 v[88:91], v[36:39], a[116:119], v[88:91]
    v_mfma_f32_16x16x32_bf16 v[92:95], v[52:55], a[116:119], v[92:95]
    v_mfma_f32_16x16x32_bf16 v[88:91], v[40:43], a[120:123], v[88:91]
    v_mfma_f32_16x16x32_bf16 v[92:95], v[56:59], a[120:123], v[92:95]
    v_mfma_f32_16x16x32_bf16 v[88:91], v[44:47], a[124:127], v[88:91]
    v_mfma_f32_16x16x32_bf16 v[92:95], v[60:63], a[124:127], v[92:95]
    v_cvt_pk_bf16_f32 v80, v80, v81
    v_cvt_pk_bf16_f32 v81, v82, v83
    v_cvt_pk_bf16_f32 v82, v84, v85
    v_cvt_pk_bf16_f32 v83, v86, v87
    ds_write_b128 v10, v[80:83] offset:34816
    s_nop 2
    v_cvt_pk_bf16_f32 v88, v88, v89
    v_cvt_pk_bf16_f32 v89, v90, v91
    v_cvt_pk_bf16_f32 v90, v92, v93
    v_cvt_pk_bf16_f32 v91, v94, v95
    ds_write_b128 v10, v[88:91] offset:35840
    s_sleep 3
    s_branch L_v_loop_243
L_v_last_247:
    s_waitcnt lgkmcnt(0)
    s_barrier
    s_branch L_replica
L_v_l1_244:
    s_mov_b64 exec, s[48:49]
    s_cbranch_execz L_v_ls_259
    buffer_load_dwordx4 v[64:67], v9, s[12:15], s61 offen offset:0 sc1
L_v_ls_259:
    s_mov_b64 exec, s[50:51]
    s_cbranch_execz L_v_ls_260
    buffer_load_dwordx4 v[68:71], v9, s[12:15], s61 offen offset:1024 sc1
L_v_ls_260:
    s_mov_b64 exec, s[52:53]
    s_cbranch_execz L_v_ls_261
    buffer_load_dwordx4 v[72:75], v9, s[12:15], s61 offen offset:2048 sc1
L_v_ls_261:
    s_mov_b64 exec, s[54:55]
    s_cbranch_execz L_v_ls_262
    buffer_load_dwordx4 v[76:79], v9, s[12:15], s61 offen offset:3072 sc1
L_v_ls_262:
    s_mov_b64 exec, -1
    s_add_u32 s70, s70, 1
    s_cmp_ge_u32 s70, 524288
    s_cbranch_scc1 L_c_done_1
    s_waitcnt vmcnt(0)
    s_cmp_eq_u64 s[48:49], 0
    s_cbranch_scc1 L_v_lc_263
    ds_write_b128 v10, v[64:67] offset:0
    v_max3_u32 v24, v64, v65, v66
    v_max_u32 v24, v24, v67
    v_cmp_eq_u32 s[48:49], -1, v24
L_v_lc_263:
    s_cmp_eq_u64 s[50:51], 0
    s_cbranch_scc1 L_v_lc_264
    ds_write_b128 v10, v[68:71] offset:1024
    v_max3_u32 v24, v68, v69, v70
    v_max_u32 v24, v24, v71
    v_cmp_eq_u32 s[50:51], -1, v24
L_v_lc_264:
    s_cmp_eq_u64 s[52:53], 0
    s_cbranch_scc1 L_v_lc_265
    ds_write_b128 v10, v[72:75] offset:2048
    v_max3_u32 v24, v72, v73, v74
    v_max_u32 v24, v24, v75
    v_cmp_eq_u32 s[52:53], -1, v24
L_v_lc_265:
    s_cmp_eq_u64 s[54:55], 0
    s_cbranch_scc1 L_v_lc_266
    ds_write_b128 v10, v[76:79] offset:3072
    v_max3_u32 v24, v76, v77, v78
    v_max_u32 v24, v24, v79
    v_cmp_eq_u32 s[54:55], -1, v24
L_v_lc_266:
    s_or_b64 s[46:47], s[48:49], s[50:51]
    s_or_b64 vcc, s[52:53], s[54:55]
    s_or_b64 vcc, vcc, s[46:47]
    s_cbranch_scc1 L_v_l1_244
    s_branch L_v_l1ok_246
L_rt_250:
    s_add_u32 s70, s70, 1
    s_cmp_lt_u32 s70, 524288
    s_cbranch_scc1 L_v_rl_249
    s_branch L_c_done_1
L_rt_253:
    s_add_u32 s70, s70, 1
    s_cmp_lt_u32 s70, 524288
    s_cbranch_scc1 L_v_vp_252
    s_branch L_c_done_1
L_v_gf_256:
    v_max3_u32 v24, v96, v97, v98
    v_max3_u32 v24, v24, v99, v100
    v_max3_u32 v24, v24, v101, v102
    v_max_u32 v24, v24, v103
    v_cmp_eq_u32 vcc, -1, v24
    v_min_u32 v20, -2, v20
    s_add_u32 s70, s70, 1
    s_cbranch_vccz L_v_gok_255
    buffer_load_dword v96, v7, s[12:15], s63 offen offset:0 sc1
    buffer_load_dword v97, v7, s[12:15], s63 offen offset:256 sc1
    buffer_load_dword v98, v7, s[12:15], s63 offen offset:512 sc1
    buffer_load_dword v99, v7, s[12:15], s63 offen offset:768 sc1
    buffer_load_dword v100, v7, s[12:15], s63 offen offset:1024 sc1
    buffer_load_dword v101, v7, s[12:15], s63 offen offset:1280 sc1
    buffer_load_dword v102, v7, s[12:15], s63 offen offset:1536 sc1
    buffer_load_dword v103, v7, s[12:15], s63 offen offset:1792 sc1
    s_cmp_lt_u32 s70, 524288
    s_cbranch_scc1 L_v_gp_254
    s_branch L_c_done_1
L_v_vt_258:
    v_lshrrev_b32 v22, 3, v1
    v_lshlrev_b32 v22, 7, v22
    s_mov_b32 s45, 0x101800
    s_mov_b32 s46, 0
    s_mov_b32 s70, 0
L_spin_267:
    buffer_load_dword v23, v22, s[12:15], s45 offen sc1
    s_waitcnt vmcnt(0)
    v_cmp_ge_u32 vcc, s46, v23
    s_add_u32 s70, s70, 1
    s_cbranch_vccz L_spok_268
    s_sleep 3
    s_cmp_lt_u32 s70, 524288
    s_cbranch_scc1 L_spin_267
    s_branch L_c_done_1
L_spok_268:
    v_cmp_eq_u32 s[66:67], 3, v23
    s_nop 3
    s_branch L_v_vt_258_b
L_vs_208:
    s_mov_b32 s70, 1
    v_mov_b32 v16, 0
    v_mov_b32 v17, 0
    s_branch L_v_l1m_271
.p2align 6
L_v_loop_269:
    s_mov_b32 s70, 1
    buffer_load_dwordx4 v[64:67], v9, s[12:15], s61 offen offset:0 sc1
    buffer_load_dwordx4 v[68:71], v9, s[12:15], s61 offen offset:1024 sc1
    buffer_load_dwordx4 v[72:75], v9, s[12:15], s61 offen offset:2048 sc1
    buffer_load_dwordx4 v[76:79], v9, s[12:15], s61 offen offset:3072 sc1
    v_mov_b32 v16, 0
    v_mov_b32 v17, 0
    v_mov_b32 v18, 0
    v_mov_b32 v19, 0
    v_mov_b32 v20, 0
    v_mov_b32 v21, 0
    v_mov_b32 v22, 0
    v_mov_b32 v23, 0
L_v_l1m_271:
    s_waitcnt vmcnt(3)
    ds_write_b128 v10, v[64:67] offset:0
    v_max3_u32 v24, v64, v65, v66
    v_max_u32 v24, v24, v67
    v_cmp_eq_u32 s[48:49], -1, v24
    s_waitcnt vmcnt(2)
    ds_write_b128 v10, v[68:71] offset:1024
    v_max3_u32 v24, v68, v69, v70
    v_max_u32 v24, v24, v71
    v_cmp_eq_u32 s[50:51], -1, v24
    s_waitcnt vmcnt(1)
    ds_write_b128 v10, v[72:75] offset:2048
    v_max3_u32 v24, v72, v73, v74
    v_max_u32 v24, v24, v75
    v_cmp_eq_u32 s[52:53], -1, v24
    s_waitcnt vmcnt(0)
    ds_write_b128 v10, v[76:79] offset:3072
    v_max3_u32 v24, v76, v77, v78
    v_max_u32 v24, v24, v79
    v_cmp_eq_u32 s[54:55], -1, v24
    s_or_b64 s[46:47], s[48:49], s[50:51]
    s_or_b64 vcc, s[52:53], s[54:55]
    s_or_b64 vcc, vcc, s[46:47]
    s_cbranch_scc1 L_v_l1_270
L_v_l1ok_272:
    s_waitcnt lgkmcnt(0)
    s_barrier
    v_smfmac_f32_16x16x64_bf16 v[16:19], v[64:67], a[0:7], v3
    v_smfmac_f32_16x16x64_bf16 v[20:23], v[64:67], a[32:39], v3
    v_smfmac_f32_16x16x64_bf16 v[16:19], v[68:71], a[8:15], v3
    v_smfmac_f32_16x16x64_bf16 v[20:23], v[68:71], a[40:47], v3
    v_smfmac_f32_16x16x64_bf16 v[16:19], v[72:75], a[16:23], v3
    v_smfmac_f32_16x16x64_bf16 v[20:23], v[72:75], a[48:55], v3
    v_smfmac_f32_16x16x64_bf16 v[16:19], v[76:79], a[24:31], v3
    v_smfmac_f32_16x16x64_bf16 v[20:23], v[76:79], a[56:63], v3
    s_add_u32 s46, s65, 4096
    buffer_load_dwordx4 v[32:35], v15, s[12:15], s65 offen offset:0 sc1
    buffer_load_dwordx4 v[48:51], v15, s[12:15], s46 offen offset:0 sc1
    buffer_load_dwordx4 v[36:39], v15, s[12:15], s65 offen offset:1024 sc1
    buffer_load_dwordx4 v[52:55], v15, s[12:15], s46 offen offset:1024 sc1
    buffer_load_dwordx4 v[40:43], v15, s[12:15], s65 offen offset:2048 sc1
    buffer_load_dwordx4 v[56:59], v15, s[12:15], s46 offen offset:2048 sc1
    buffer_load_dwordx4 v[44:47], v15, s[12:15], s65 offen offset:3072 sc1
    buffer_load_dwordx4 v[60:63], v15, s[12:15], s46 offen offset:3072 sc1
    s_add_u32 s65, s65, 786432
    v_permlane32_swap_b32 v16, v18
    v_permlane32_swap_b32 v17, v19
    v_permlane32_swap_b32 v20, v22
    v_permlane32_swap_b32 v21, v23
    v_add_f32 v16, v16, v18
    v_add_f32 v17, v17, v19
    v_add_f32 v18, v20, v22
    v_add_f32 v19, v21, v23
    ds_write_b128 v14, v[16:19]
    s_mov_b64 exec, 1
    ds_add_u32 v29, v30
    s_mov_b64 exec, -1
    s_add_u32 s58, s58, 4
    s_bitcmp1_b32 s44, 0
    s_cbranch_scc1 L_v_k1_274
    s_mov_b32 s70, 0
L_v_rl_275:
    ds_read_b32 v24, v29
    ds_read_b64 v[16:17], v13 offset:0
    ds_read_b64 v[18:19], v13 offset:1024
    ds_read_b64 v[20:21], v13 offset:2048
    ds_read_b64 v[22:23], v13 offset:3072
    s_waitcnt lgkmcnt(2)
    v_cmp_ne_u32 vcc, s58, v24
    v_add_f32 v16, v16, v18
    v_add_f32 v17, v17, v19
    s_waitcnt lgkmcnt(0)
    s_cbranch_vccnz L_rt_276
    v_add_f32 v20, v20, v22
    v_add_f32 v21, v21, v23
    v_add_f32 v16, v16, v20
    v_add_f32 v17, v17, v21
    s_mov_b32 vcc_lo, 0x55555555
    s_mov_b32 vcc_hi, 0x55555555
    v_cndmask_b32_dpp v18, v17, v16, vcc quad_perm:[1,0,3,2] row_mask:0xf bank_mask:0xf
    s_not_b64 vcc, vcc
    v_cndmask_b32_dpp v19, v16, v17, vcc quad_perm:[1,0,3,2] row_mask:0xf bank_mask:0xf
    v_cvt_pk_bf16_f32 v18, v18, v19
    v_min_u32 v18, -2, v18
    buffer_store_dword v18, v4, s[12:15], s62 offen sc1
    ds_write_b32 v5, v18
L_v_k1_274:
    s_cmp_eq_u32 s60, 63
    s_cbranch_scc1 L_v_last_273
    ds_read_b128 v[80:83], v27 offset:32768
    ds_read_b128 v[84:87], v27 offset:36864
    ds_read_b128 v[88:91], v27 offset:40960
    ds_read_b128 v[92:95], v27 offset:45056
    v_mov_b32 v96, 0
    v_mov_b32 v97, 0
    v_mov_b32 v98, 0
    v_mov_b32 v99, 0
    v_mov_b32 v100, 0
    v_mov_b32 v101, 0
    v_mov_b32 v102, 0
    v_mov_b32 v103, 0
    v_mov_b32 v104, 0
    v_mov_b32 v105, 0
    v_mov_b32 v106, 0
    v_mov_b32 v107, 0
    v_mov_b32 v108, 0
    v_mov_b32 v109, 0
    v_mov_b32 v110, 0
    v_mov_b32 v111, 0
    s_bitcmp1_b32 s44, 0
    s_cbranch_scc0 L_v_sv_277
    s_sleep 3
L_v_sv_277:
    s_sleep 4
    s_mov_b32 s70, 1
L_v_vp_278:
    buffer_load_dwordx4 v[64:67], v11, s[12:15], s62 offen offset:0 sc1
    buffer_load_dwordx4 v[68:71], v11, s[12:15], s62 offen offset:1024 sc1
    s_waitcnt vmcnt(0)
    v_max3_u32 v20, v64, v65, v66
    v_max3_u32 v20, v20, v67, v68
    v_max3_u32 v20, v20, v69, v70
    v_max_u32 v20, v20, v71
    v_cmp_eq_u32 vcc, -1, v20
    s_cbranch_vccnz L_rt_279
    v_smfmac_f32_16x16x64_bf16 v[96:99], v[64:67], a[64:71], v3
    v_smfmac_f32_16x16x64_bf16 v[96:99], v[68:71], a[72:79], v3
    v_smfmac_f32_16x16x64_bf16 v[100:103], v[64:67], a[80:87], v3
    v_smfmac_f32_16x16x64_bf16 v[100:103], v[68:71], a[88:95], v3
    v_smfmac_f32_16x16x64_bf16 v[104:107], v[64:67], a[96:103], v3
    v_smfmac_f32_16x16x64_bf16 v[104:107], v[68:71], a[104:111], v3
    v_smfmac_f32_16x16x64_bf16 v[108:111], v[64:67], a[112:119], v3
    v_smfmac_f32_16x16x64_bf16 v[108:111], v[68:71], a[120:127], v3
    s_nop 1
    v_cvt_pk_bf16_f32 v96, v96, v97
    v_cvt_pk_bf16_f32 v97, v98, v99
    ds_write_b64 v12, v[96:97] offset:0
    v_cvt_pk_bf16_f32 v100, v100, v101
    v_cvt_pk_bf16_f32 v101, v102, v103
    ds_write_b64 v12, v[100:101] offset:2048
    v_cvt_pk_bf16_f32 v104, v104, v105
    v_cvt_pk_bf16_f32 v105, v106, v107
    ds_write_b64 v12, v[104:105] offset:4096
    v_cvt_pk_bf16_f32 v108, v108, v109
    v_cvt_pk_bf16_f32 v109, v110, v111
    ds_write_b64 v12, v[108:109] offset:6144
    s_waitcnt lgkmcnt(0)
    s_barrier
    ds_read_b128 v[96:99], v2 offset:16384
    ds_read_b128 v[100:103], v2 offset:17408
    ds_read_b128 v[104:107], v2 offset:18432
    ds_read_b128 v[108:111], v2 offset:19456
    ds_read_b128 v[112:115], v31 offset:0
    ds_read_b128 v[116:119], v25 offset:0
    ds_read_b128 v[120:123], v31 offset:512
    ds_read_b128 v[124:127], v25 offset:1024
    s_waitcnt lgkmcnt(7)
    v_mfma_f32_16x16x32_bf16 v[16:19], v[80:83], v[96:99], 0
    s_waitcnt lgkmcnt(6)
    v_mfma_f32_16x16x32_bf16 v[16:19], v[84:87], v[100:103], v[16:19]
    s_waitcnt lgkmcnt(5)
    v_mfma_f32_16x16x32_bf16 v[16:19], v[88:91], v[104:107], v[16:19]
    s_waitcnt lgkmcnt(4)
    v_mfma_f32_16x16x32_bf16 v[16:19], v[92:95], v[108:111], v[16:19]
    s_waitcnt lgkmcnt(2)
    v_mfma_f32_16x16x32_bf16 v[16:19], v[116:119], v[112:115], v[16:19]
    s_waitcnt lgkmcnt(0)
    v_mfma_f32_16x16x32_bf16 v[16:19], v[124:127], v[120:123], v[16:19]
    s_mov_b32 exec_lo, 0x00ff00ff
    s_mov_b32 exec_hi, 0x00ff00ff
    s_nop 5
    v_cvt_pk_bf16_f32 v16, v16, v17
    v_cvt_pk_bf16_f32 v17, v18, v19
    v_min_u32 v16, -2, v16
    v_min_u32 v17, -2, v17
    buffer_store_dwordx2 v[16:17], v6, s[12:15], s63 offen sc1
    s_mov_b64 exec, -1
    s_add_u32 s61, s61, 0x4000
    s_and_b32 s61, s61, 0xffff
    s_mov_b32 s70, 1
    s_waitcnt vmcnt(1)
    v_mfma_f32_16x16x32_bf16 v[64:67], v[32:35], a[64:67], 0
    v_mfma_f32_16x16x32_bf16 v[68:71], v[48:51], a[64:67], 0
    v_mfma_f32_16x16x32_bf16 v[64:67], v[36:39], a[68:71], v[64:67]
    v_mfma_f32_16x16x32_bf16 v[68:71], v[52:55], a[68:71], v[68:71]
    v_mfma_f32_16x16x32_bf16 v[64:67], v[40:43], a[72:75], v[64:67]
    v_mfma_f32_16x16x32_bf16 v[68:71], v[56:59], a[72:75], v[68:71]
    v_mfma_f32_16x16x32_bf16 v[64:67], v[44:47], a[76:79], v[64:67]
    v_mfma_f32_16x16x32_bf16 v[68:71], v[60:63], a[76:79], v[68:71]
    s_sleep 6
    buffer_load_dword v96, v7, s[12:15], s63 offen offset:0 sc1
    buffer_load_dword v97, v7, s[12:15], s63 offen offset:256 sc1
    buffer_load_dword v98, v7, s[12:15], s63 offen offset:512 sc1
    buffer_load_dword v99, v7, s[12:15], s63 offen offset:768 sc1
    buffer_load_dword v100, v7, s[12:15], s63 offen offset:1024 sc1
    buffer_load_dword v101, v7, s[12:15], s63 offen offset:1280 sc1
    buffer_load_dword v102, v7, s[12:15], s63 offen offset:1536 sc1
    buffer_load_dword v103, v7, s[12:15], s63 offen offset:1792 sc1
    v_mfma_f32_16x16x32_bf16 v[72:75], v[32:35], a[80:83], 0
    v_mfma_f32_16x16x32_bf16 v[76:79], v[48:51], a[80:83], 0
    v_mfma_f32_16x16x32_bf16 v[72:75], v[36:39], a[84:87], v[72:75]
    v_mfma_f32_16x16x32_bf16 v[76:79], v[52:55], a[84:87], v[76:79]
    v_mfma_f32_16x16x32_bf16 v[72:75], v[40:43], a[88:91], v[72:75]
    v_mfma_f32_16x16x32_bf16 v[76:79], v[56:59], a[88:91], v[76:79]
    v_mfma_f32_16x16x32_bf16 v[72:75], v[44:47], a[92:95], v[72:75]
    v_mfma_f32_16x16x32_bf16 v[76:79], v[60:63], a[92:95], v[76:79]
    v_cvt_pk_bf16_f32 v64, v64, v65
    v_cvt_pk_bf16_f32 v65, v66, v67
    v_cvt_pk_bf16_f32 v66, v68, v69
    v_cvt_pk_bf16_f32 v67, v70, v71
    ds_write_b128 v10, v[64:67] offset:32768
    v_mfma_f32_16x16x32_bf16 v[80:83], v[32:35], a[96:99], 0
    v_mfma_f32_16x16x32_bf16 v[84:87], v[48:51], a[96:99], 0
    v_mfma_f32_16x16x32_bf16 v[80:83], v[36:39], a[100:103], v[80:83]
    v_mfma_f32_16x16x32_bf16 v[84:87], v[52:55], a[100:103], v[84:87]
    v_mfma_f32_16x16x32_bf16 v[80:83], v[40:43], a[104:107], v[80:83]
    v_mfma_f32_16x16x32_bf16 v[84:87], v[56:59], a[104:107], v[84:87]
    v_mfma_f32_16x16x32_bf16 v[80:83], v[44:47], a[108:111], v[80:83]
    v_mfma_f32_16x16x32_bf16 v[84:87], v[60:63], a[108:111], v[84:87]
    v_cvt_pk_bf16_f32 v72, v72, v73
    v_cvt_pk_bf16_f32 v73, v74, v75
    v_cvt_pk_bf16_f32 v74, v76, v77
    v_cvt_pk_bf16_f32 v75, v78, v79
    ds_write_b128 v10, v[72:75] offset:33792
L_v_gp_280:
    s_waitcnt vmcnt(7)
    v_lshlrev_b32 v20, 16, v96
    v_and_b32 v21, 0xffff0000, v96
    s_waitcnt vmcnt(6)
    v_lshlrev_b32 v22, 16, v97
    v_and_b32 v23, 0xffff0000, v97
    v_add_f32 v20, v20, v22
    v_add_f32 v21, v21, v23
    s_waitcnt vmcnt(5)
    v_lshlrev_b32 v22, 16, v98
    v_and_b32 v23, 0xffff0000, v98
    v_add_f32 v20, v20, v22
    v_add_f32 v21, v21, v23
    s_waitcnt vmcnt(4)
    v_lshlrev_b32 v22, 16, v99
    v_and_b32 v23, 0xffff0000, v99
    v_add_f32 v20, v20, v22
    v_add_f32 v21, v21, v23
    s_waitcnt vmcnt(3)
    v_lshlrev_b32 v22, 16, v100
    v_and_b32 v23, 0xffff0000, v100
    v_add_f32 v20, v20, v22
    v_add_f32 v21, v21, v23
    s_waitcnt vmcnt(2)
    v_lshlrev_b32 v22, 16, v101
    v_and_b32 v23, 0xffff0000, v101
    v_add_f32 v20, v20, v22
    v_add_f32 v21, v21, v23
    s_waitcnt vmcnt(1)
    v_lshlrev_b32 v22, 16, v102
    v_and_b32 v23, 0xffff0000, v102
    v_add_f32 v20, v20, v22
    v_add_f32 v21, v21, v23
    s_waitcnt vmcnt(0)
    v_lshlrev_b32 v22, 16, v103
    v_and_b32 v23, 0xffff0000, v103
    v_add_f32 v20, v20, v22
    v_add_f32 v21, v21, v23
    v_cmp_u_f32 vcc, v20, v21
    v_cvt_pk_bf16_f32 v20, v20, v21
    s_cbranch_vccnz L_v_gf_282
L_v_gok_281:
    buffer_store_dword v20, v8, s[12:15], s61 offen sc1
    s_xor_b32 s45, s61, 0x8000
    buffer_store_dword v26, v8, s[12:15], s45 offen sc1
    s_bitcmp1_b32 s44, 0
    s_cbranch_scc1 L_v_nr_283
    s_xor_b32 s45, s62, 0x4000
    buffer_store_dword v26, v4, s[12:15], s45 offen sc1
L_v_nr_283:
    s_add_u32 s60, s60, 1
    s_add_u32 s62, s62, 0x2000
    s_and_b32 s62, s62, 0x7fff
    s_cmp_eq_u32 s60, 5
    s_cbranch_scc1 L_v_vt_284
L_v_vt_284_b:
    s_and_b32 s45, s60, 0x38
    s_bitcmp1_b64 s[66:67], s45
    s_cselect_b32 s45, 8192, 0
    s_lshl_b32 s63, s60, 18
    s_add_u32 s63, s63, s45
    v_mfma_f32_16x16x32_bf16 v[88:91], v[32:35], a[112:115], 0
    v_mfma_f32_16x16x32_bf16 v[92:95], v[48:51], a[112:115], 0
    v_mfma_f32_16x16x32_bf16 v[88:91], v[36:39], a[116:119], v[88:91]
    v_mfma_f32_16x16x32_bf16 v[92:95], v[52:55], a[116:119], v[92:95]
    v_mfma_f32_16x16x32_bf16 v[88:91], v[40:43], a[120:123], v[88:91]
    v_mfma_f32_16x16x32_bf16 v[92:95], v[56:59], a[120:123], v[92:95]
    v_mfma_f32_16x16x32_bf16 v[88:91], v[44:47], a[124:127], v[88:91]
    v_mfma_f32_16x16x32_bf16 v[92:95], v[60:63], a[124:127], v[92:95]
    v_cvt_pk_bf16_f32 v80, v80, v81
    v_cvt_pk_bf16_f32 v81, v82, v83
    v_cvt_pk_bf16_f32 v82, v84, v85
    v_cvt_pk_bf16_f32 v83, v86, v87
    ds_write_b128 v10, v[80:83] offset:34816
    s_nop 2
    v_cvt_pk_bf16_f32 v88, v88, v89
    v_cvt_pk_bf16_f32 v89, v90, v91
    v_cvt_pk_bf16_f32 v90, v92, v93
    v_cvt_pk_bf16_f32 v91, v94, v95
    ds_write_b128 v10, v[88:91] offset:35840
    s_sleep 3
    s_branch L_v_loop_269
L_v_last_273:
    s_waitcnt lgkmcnt(0)
    s_barrier
    s_branch L_replica
L_v_l1_270:
    s_mov_b64 exec, s[48:49]
    s_cbranch_execz L_v_ls_285
    buffer_load_dwordx4 v[64:67], v9, s[12:15], s61 offen offset:0 sc1
L_v_ls_285:
    s_mov_b64 exec, s[50:51]
    s_cbranch_execz L_v_ls_286
    buffer_load_dwordx4 v[68:71], v9, s[12:15], s61 offen offset:1024 sc1
L_v_ls_286:
    s_mov_b64 exec, s[52:53]
    s_cbranch_execz L_v_ls_287
    buffer_load_dwordx4 v[72:75], v9, s[12:15], s61 offen offset:2048 sc1
L_v_ls_287:
    s_mov_b64 exec, s[54:55]
    s_cbranch_execz L_v_ls_288
    buffer_load_dwordx4 v[76:79], v9, s[12:15], s61 offen offset:3072 sc1
L_v_ls_288:
    s_mov_b64 exec, -1
    s_add_u32 s70, s70, 1
    s_cmp_ge_u32 s70, 524288
    s_cbranch_scc1 L_c_done_1
    s_waitcnt vmcnt(0)
    s_cmp_eq_u64 s[48:49], 0
    s_cbranch_scc1 L_v_lc_289
    ds_write_b128 v10, v[64:67] offset:0
    v_max3_u32 v24, v64, v65, v66
    v_max_u32 v24, v24, v67
    v_cmp_eq_u32 s[48:49], -1, v24
L_v_lc_289:
    s_cmp_eq_u64 s[50:51], 0
    s_cbranch_scc1 L_v_lc_290
    ds_write_b128 v10, v[68:71] offset:1024
    v_max3_u32 v24, v68, v69, v70
    v_max_u32 v24, v24, v71
    v_cmp_eq_u32 s[50:51], -1, v24
L_v_lc_290:
    s_cmp_eq_u64 s[52:53], 0
    s_cbranch_scc1 L_v_lc_291
    ds_write_b128 v10, v[72:75] offset:2048
    v_max3_u32 v24, v72, v73, v74
    v_max_u32 v24, v24, v75
    v_cmp_eq_u32 s[52:53], -1, v24
L_v_lc_291:
    s_cmp_eq_u64 s[54:55], 0
    s_cbranch_scc1 L_v_lc_292
    ds_write_b128 v10, v[76:79] offset:3072
    v_max3_u32 v24, v76, v77, v78
    v_max_u32 v24, v24, v79
    v_cmp_eq_u32 s[54:55], -1, v24
L_v_lc_292:
    s_or_b64 s[46:47], s[48:49], s[50:51]
    s_or_b64 vcc, s[52:53], s[54:55]
    s_or_b64 vcc, vcc, s[46:47]
    s_cbranch_scc1 L_v_l1_270
    s_branch L_v_l1ok_272
L_rt_276:
    s_add_u32 s70, s70, 1
    s_cmp_lt_u32 s70, 524288
    s_cbranch_scc1 L_v_rl_275
    s_branch L_c_done_1
L_rt_279:
    s_add_u32 s70, s70, 1
    s_cmp_lt_u32 s70, 524288
    s_cbranch_scc1 L_v_vp_278
    s_branch L_c_done_1
L_v_gf_282:
    v_max3_u32 v24, v96, v97, v98
    v_max3_u32 v24, v24, v99, v100
    v_max3_u32 v24, v24, v101, v102
    v_max_u32 v24, v24, v103
    v_cmp_eq_u32 vcc, -1, v24
    v_min_u32 v20, -2, v20
    s_add_u32 s70, s70, 1
    s_cbranch_vccz L_v_gok_281
    buffer_load_dword v96, v7, s[12:15], s63 offen offset:0 sc1
    buffer_load_dword v97, v7, s[12:15], s63 offen offset:256 sc1
    buffer_load_dword v98, v7, s[12:15], s63 offen offset:512 sc1
    buffer_load_dword v99, v7, s[12:15], s63 offen offset:768 sc1
    buffer_load_dword v100, v7, s[12:15], s63 offen offset:1024 sc1
    buffer_load_dword v101, v7, s[12:15], s63 offen offset:1280 sc1
    buffer_load_dword v102, v7, s[12:15], s63 offen offset:1536 sc1
    buffer_load_dword v103, v7, s[12:15], s63 offen offset:1792 sc1
    s_cmp_lt_u32 s70, 524288
    s_cbranch_scc1 L_v_gp_280
    s_branch L_c_done_1
L_v_vt_284:
    v_lshrrev_b32 v22, 3, v1
    v_lshlrev_b32 v22, 7, v22
    s_mov_b32 s45, 0x101800
    s_mov_b32 s46, 0
    s_mov_b32 s70, 0
L_spin_293:
    buffer_load_dword v23, v22, s[12:15], s45 offen sc1
    s_waitcnt vmcnt(0)
    v_cmp_ge_u32 vcc, s46, v23
    s_add_u32 s70, s70, 1
    s_cbranch_vccz L_spok_294
    s_sleep 3
    s_cmp_lt_u32 s70, 524288
    s_cbranch_scc1 L_spin_293
    s_branch L_c_done_1
L_spok_294:
    v_cmp_eq_u32 s[66:67], 3, v23
    s_nop 3
    s_branch L_v_vt_284_b
L_c_done_1:
    s_endpgm
.section .rodata,"a"
.p2align 6
.amdhsa_kernel k3_chain_kernel
  .amdhsa_next_free_vgpr 256
  .amdhsa_next_free_sgpr 102
  .amdhsa_accum_offset 128
  .amdhsa_group_segment_fixed_size 0
  .amdhsa_kernarg_size 136
  .amdhsa_user_sgpr_count 2
  .amdhsa_user_sgpr_kernarg_segment_ptr 1
  .amdhsa_system_sgpr_workgroup_id_x 1
.end_amdhsa_kernel
```

```asm
; @launch kernel=k3_chain_kernel grid=(256,1,1) block=(512,1,1) lds=147712
.amdgcn_target "amdgcn-amd-amdhsa--gfx950"
.text
.globl k3_chain_kernel
.p2align 8
.type k3_chain_kernel,@function
k3_chain_kernel:
    s_cmp_ge_u32 s2, 256
    s_cbranch_scc1 L_c_done_1
    s_load_dwordx4 s[20:23], s[0:1], 120
    v_and_b32 v1, 63, v0
    v_lshrrev_b32 v2, 6, v0
    s_nop 0
    v_readfirstlane_b32 s44, v2
    s_waitcnt lgkmcnt(0)
    s_mov_b32 s12, s22
    s_and_b32 s13, s23, 0xffff
    s_mov_b32 s14, 0x10000000
    s_mov_b32 s15, 0x00020000
    s_mov_b32 s16, s20
    s_and_b32 s17, s21, 0xffff
    s_mov_b32 s18, 0x100
    s_mov_b32 s19, 0x00020000
    s_getpc_b64 s[24:25]
L_c_here_2:
    v_lshlrev_b32 v3, 7, v0
    v_mov_b32 v5, s25
    v_add_co_u32 v4, vcc, s24, v3
    s_nop 1
    v_addc_co_u32 v5, vcc, 0, v5, vcc
    v_cmp_gt_u32 vcc, L_c_done_1 - L_c_here_2, v3
    s_and_saveexec_b64 s[26:27], vcc
    s_cbranch_execz L_c_ct_3
    global_load_dword v109, v[4:5], off
L_c_ct_3:
    s_mov_b64 exec, s[26:27]
    s_load_dwordx4 s[8:11], s[0:1], 96
    v_lshrrev_b32 v5, 3, v0
    v_mul_u32_u24 v6, 24576, v5
    v_and_b32 v7, 7, v0
    v_lshl_add_u32 v6, v7, 4, v6
    v_add_u32 v7, 12288, v6
    v_lshlrev_b32 v5, 2, v5
    s_lshr_b32 s50, s2, 5
    s_and_b32 s51, s2, 31
    s_mul_i32 s52, s50, 1572864
    s_lshl_b32 s53, s51, 7
    s_add_u32 s52, s52, s53
    s_lshl_b32 s53, s50, 8
    s_waitcnt lgkmcnt(0)
    s_mov_b32 s28, s10
    s_and_b32 s29, s11, 0xffff
    s_mov_b32 s30, 0xc00000
    s_mov_b32 s31, 0x00020000
    s_mov_b32 s32, s8
    s_and_b32 s33, s9, 0xffff
    s_mov_b32 s34, 0x800
    s_mov_b32 s35, 0x00020000
    buffer_load_dword v8, v5, s[32:35], s53 offen
    buffer_load_dwordx4 v[12:15], v6, s[28:31], s52 offen
    buffer_load_dwordx4 v[16:19], v7, s[28:31], s52 offen
    s_getreg_b32 s39, hwreg(HW_REG_XCC_ID)
    s_and_b32 s39, s39, 7
    s_cmp_lg_u32 s44, 1
    s_cbranch_scc1 L_nz_7
    v_mov_b32 v32, 0
    v_mov_b32 v33, 0
    v_mov_b32 v34, 0
    v_mov_b32 v35, 0
    v_lshlrev_b32 v4, 4, v1
    s_lshl_b32 s45, s2, 10
    s_add_u32 s45, s45, 0x100000
    buffer_store_dwordx4 v[32:35], v4, s[12:15], s45 offen sc1
L_nz_7:
    s_waitcnt vmcnt(0)
    v_lshlrev_b32 v9, 16, v8
    v_and_b32 v10, 0xffff0000, v8
    v_mul_f32 v20, 0xbfb8aa3b, v9
    v_mul_f32 v21, 0xbfb8aa3b, v10
    v_exp_f32 v20, v20
    v_exp_f32 v21, v21
    s_nop 0
    v_add_f32 v20, 1.0, v20
    v_add_f32 v21, 1.0, v21
    v_rcp_f32 v20, v20
    v_rcp_f32 v21, v21
    s_nop 0
    v_mul_f32 v9, v9, v20
    v_mul_f32 v10, v10, v21
    v_cvt_pk_bf16_f32 v9, 0, v9
    v_cvt_pk_bf16_f32 v10, 0, v10
    v_lshlrev_b32 v28, 16, v12
    v_and_b32 v29, 0xffff0000, v12
    v_lshlrev_b32 v30, 16, v16
    v_and_b32 v31, 0xffff0000, v16
    v_mul_f32 v20, v28, v9
    v_mul_f32 v21, v29, v9
    v_fmac_f32 v20, v30, v10
    v_fmac_f32 v21, v31, v10
    v_lshlrev_b32 v28, 16, v13
    v_and_b32 v29, 0xffff0000, v13
    v_lshlrev_b32 v30, 16, v17
    v_and_b32 v31, 0xffff0000, v17
    v_mul_f32 v22, v28, v9
    v_mul_f32 v23, v29, v9
    v_fmac_f32 v22, v30, v10
    v_fmac_f32 v23, v31, v10
    v_lshlrev_b32 v28, 16, v14
    v_and_b32 v29, 0xffff0000, v14
    v_lshlrev_b32 v30, 16, v18
    v_and_b32 v31, 0xffff0000, v18
    v_mul_f32 v24, v28, v9
    v_mul_f32 v25, v29, v9
    v_fmac_f32 v24, v30, v10
    v_fmac_f32 v25, v31, v10
    v_lshlrev_b32 v28, 16, v15
    v_and_b32 v29, 0xffff0000, v15
    v_lshlrev_b32 v30, 16, v19
    v_and_b32 v31, 0xffff0000, v19
    v_mul_f32 v26, v28, v9
    v_mul_f32 v27, v29, v9
    v_fmac_f32 v26, v30, v10
    v_fmac_f32 v27, v31, v10
    s_nop 1
    v_add_f32_dpp v20, v20, v20 row_ror:8 row_mask:0xf bank_mask:0xf
    v_add_f32_dpp v21, v21, v21 row_ror:8 row_mask:0xf bank_mask:0xf
    v_add_f32_dpp v22, v22, v22 row_ror:8 row_mask:0xf bank_mask:0xf
    v_add_f32_dpp v23, v23, v23 row_ror:8 row_mask:0xf bank_mask:0xf
    v_add_f32_dpp v24, v24, v24 row_ror:8 row_mask:0xf bank_mask:0xf
    v_add_f32_dpp v25, v25, v25 row_ror:8 row_mask:0xf bank_mask:0xf
    v_add_f32_dpp v26, v26, v26 row_ror:8 row_mask:0xf bank_mask:0xf
    v_add_f32_dpp v27, v27, v27 row_ror:8 row_mask:0xf bank_mask:0xf
    s_nop 1
    v_permlane16_swap_b32 v20, v24
    v_permlane16_swap_b32 v21, v25
    v_permlane16_swap_b32 v22, v26
    v_permlane16_swap_b32 v23, v27
    v_add_f32 v20, v20, v24
    v_add_f32 v21, v21, v25
    v_add_f32 v22, v22, v26
    v_add_f32 v23, v23, v27
    s_nop 1
    v_permlane32_swap_b32 v20, v22
    v_permlane32_swap_b32 v21, v23
    v_add_f32 v20, v20, v22
    v_add_f32 v21, v21, v23
    v_and_b32 v22, 7, v1
    v_lshlrev_b32 v22, 5, v22
    v_bfe_u32 v23, v1, 4, 1
    v_lshl_add_u32 v22, v23, 4, v22
    v_lshrrev_b32 v23, 5, v1
    v_lshl_add_u32 v22, v23, 3, v22
    s_lshl_b32 s52, s44, 8
    s_add_u32 s52, s52, 139776
    v_add_u32 v22, s52, v22
    ds_write_b64 v22, v[20:21]
    s_waitcnt lgkmcnt(0)
    s_barrier
    s_cmp_lg_u32 s44, 1
    s_cbranch_scc1 L_m1_8
    v_lshlrev_b32 v22, 2, v1
    v_add_u32 v23, 139776, v22
    ds_read_b32 v24, v23 offset:0
    ds_read_b32 v25, v23 offset:256
    ds_read_b32 v26, v23 offset:512
    ds_read_b32 v27, v23 offset:768
    ds_read_b32 v28, v23 offset:1024
    ds_read_b32 v29, v23 offset:1280
    ds_read_b32 v30, v23 offset:1536
    ds_read_b32 v31, v23 offset:1792
    s_waitcnt lgkmcnt(0)
    v_add_f32 v24, v24, v28
    v_add_f32 v25, v25, v29
    v_add_f32 v26, v26, v30
    v_add_f32 v27, v27, v31
    v_add_f32 v24, v24, v26
    v_add_f32 v25, v25, v27
    v_add_f32 v24, v24, v25
    s_lshl_b32 s52, s2, 8
    s_add_u32 s52, s52, 0x10000
    buffer_store_dword v24, v22, s[12:15], s52 offen sc1
L_m1_8:
    s_cmp_lg_u32 s44, 1
    s_cbranch_scc1 L_tk_4
    v_mov_b32 v3, 1
    s_mov_b32 s40, s39
    s_lshl_b32 s45, s40, 5
    v_mov_b32 v4, 0
    s_waitcnt vmcnt(0)
    s_mov_b64 exec, 1
    buffer_atomic_add v3, v4, s[16:19], s45 offen sc0
    s_waitcnt vmcnt(0)
    v_readfirstlane_b32 s41, v3
    s_nop 3
    s_cmp_lt_u32 s41, 32
    s_cbranch_scc1 L_got_5
    v_mov_b32 v3, 1
    buffer_atomic_add v3, v4, s[16:19], 0 offen offset:16 sc0
    s_waitcnt vmcnt(0)
    v_readfirstlane_b32 s46, v3
    s_mov_b64 exec, -1
    v_and_b32 v4, 7, v1
    v_lshlrev_b32 v4, 5, v4
    s_mov_b32 s70, 0
L_sp_6:
    s_sleep 8
    buffer_load_dword v3, v4, s[16:19], 0 offen sc1
    s_waitcnt vmcnt(0)
    s_mov_b32 s48, 0
    v_readlane_b32 s50, v3, 0
    v_readlane_b32 s51, v3, 1
    v_readlane_b32 s52, v3, 2
    v_readlane_b32 s53, v3, 3
    v_readlane_b32 s54, v3, 4
    v_readlane_b32 s55, v3, 5
    v_readlane_b32 s56, v3, 6
    v_readlane_b32 s57, v3, 7
    s_nop 3
    s_add_u32 s48, s48, s50
    s_add_u32 s48, s48, s51
    s_add_u32 s48, s48, s52
    s_add_u32 s48, s48, s53
    s_add_u32 s48, s48, s54
    s_add_u32 s48, s48, s55
    s_add_u32 s48, s48, s56
    s_add_u32 s48, s48, s57
    s_add_u32 s70, s70, 1
    s_cmp_ge_u32 s70, 524288
    s_cbranch_scc1 L_c_done_1
    s_cmp_lt_u32 s48, 256
    s_cbranch_scc1 L_sp_6
    s_min_u32 s48, s50, 32
    s_mov_b32 s40, 0
    s_add_u32 s41, s48, s46
    s_cmp_lt_u32 s41, 32
    s_cbranch_scc1 L_got_5
    s_sub_u32 s46, s41, 32
    s_min_u32 s48, s51, 32
    s_mov_b32 s40, 1
    s_add_u32 s41, s48, s46
    s_cmp_lt_u32 s41, 32
    s_cbranch_scc1 L_got_5
    s_sub_u32 s46, s41, 32
    s_min_u32 s48, s52, 32
    s_mov_b32 s40, 2
    s_add_u32 s41, s48, s46
    s_cmp_lt_u32 s41, 32
    s_cbranch_scc1 L_got_5
    s_sub_u32 s46, s41, 32
    s_min_u32 s48, s53, 32
    s_mov_b32 s40, 3
    s_add_u32 s41, s48, s46
    s_cmp_lt_u32 s41, 32
    s_cbranch_scc1 L_got_5
    s_sub_u32 s46, s41, 32
    s_min_u32 s48, s54, 32
    s_mov_b32 s40, 4
    s_add_u32 s41, s48, s46
    s_cmp_lt_u32 s41, 32
    s_cbranch_scc1 L_got_5
    s_sub_u32 s46, s41, 32
    s_min_u32 s48, s55, 32
    s_mov_b32 s40, 5
    s_add_u32 s41, s48, s46
    s_cmp_lt_u32 s41, 32
    s_cbranch_scc1 L_got_5
    s_sub_u32 s46, s41, 32
    s_min_u32 s48, s56, 32
    s_mov_b32 s40, 6
    s_add_u32 s41, s48, s46
    s_cmp_lt_u32 s41, 32
    s_cbranch_scc1 L_got_5
    s_sub_u32 s46, s41, 32
    s_min_u32 s48, s57, 32
    s_mov_b32 s40, 7
    s_add_u32 s41, s48, s46
    s_cmp_lt_u32 s41, 32
    s_cbranch_scc1 L_got_5
    s_sub_u32 s46, s41, 32
    s_branch L_c_done_1
L_got_5:
    s_mov_b64 exec, -1
    s_lshl_b32 s45, s40, 8
    s_or_b32 s45, s45, s41
    v_mov_b32 v3, s45
    v_mov_b32 v4, 147464
    ds_write_b32 v4, v3
    s_waitcnt lgkmcnt(0)
L_tk_4:
    s_barrier
    v_mov_b32 v4, 147464
    ds_read_b32 v3, v4
    s_waitcnt lgkmcnt(0)
    v_readfirstlane_b32 s45, v3
    s_nop 3
    s_lshr_b32 s40, s45, 8
    s_and_b32 s41, s45, 0xff
    s_lshr_b32 s45, s40, 2
    s_xor_b32 s45, s45, 1
    s_lshl_b32 s45, s45, 4
    s_and_b32 s40, s40, 3
    s_lshl_b32 s40, s40, 1
    s_lshr_b32 s46, s41, 4
    s_add_u32 s40, s40, s46
    s_and_b32 s41, s41, 15
    s_add_u32 s41, s41, s45
    s_cmp_lt_u32 s41, 16
    s_cbranch_scc1 L_c_chain_9
    s_sub_u32 s48, s41, 16
    s_cmp_lt_u32 s48, 12
    s_cbranch_scc1 L_w_g_10
    s_and_b32 s42, s48, 3
    s_mov_b32 s43, s40
    s_load_dwordx2 s[4:5], s[0:1], 0
    v_lshlrev_b32 v2, 4, v1
    v_lshlrev_b32 v3, 5, v1
    s_lshl_b32 s55, s43, 2
    s_add_u32 s55, s55, s42
    s_waitcnt lgkmcnt(0)
    s_mov_b32 s24, s4
    s_and_b32 s25, s5, 0xffff
    s_mov_b32 s26, 0x400000
    s_mov_b32 s27, 0x00020000
    s_lshl_b32 s46, s42, 3
    s_add_u32 s46, s46, s44
    s_lshl_b32 s46, s46, 11
    v_add_u32 v7, s46, v2
    s_lshl_b32 s63, s43, 16
    buffer_load_dwordx4 a[0:3], v7, s[24:27], s63 offen
    buffer_load_dwordx4 a[4:7], v7, s[24:27], s63 offen offset:1024
    s_cmp_lg_u32 s44, 0
    s_cbranch_scc1 L_zwok_19
    v_and_b32 v8, 7, v1
    v_lshlrev_b32 v8, 5, v8
    s_mov_b32 s70, 0
L_zw_18:
    buffer_load_dword v9, v8, s[16:19], 0 offen sc1
    s_waitcnt vmcnt(0)
    v_add_u32_dpp v9, v9, v9 row_ror:1 row_mask:0xf bank_mask:0xf
    s_nop 1
    v_add_u32_dpp v9, v9, v9 row_ror:2 row_mask:0xf bank_mask:0xf
    s_nop 1
    v_add_u32_dpp v9, v9, v9 row_ror:4 row_mask:0xf bank_mask:0xf
    v_cmp_ne_u32 vcc, 0x100, v9
    s_add_u32 s70, s70, 1
    s_cbranch_vccz L_zwok_19
    s_sleep 4
    s_cmp_lt_u32 s70, 524288
    s_cbranch_scc1 L_zw_18
    s_branch L_c_done_1
L_zwok_19:
    s_barrier
    v_lshlrev_b32 v4, 4, v0
    s_mov_b32 s46, 0x10000
    buffer_load_dwordx4 v[32:35], v4, s[12:15], s46 offen sc1
    s_mov_b32 s46, 0x12000
    buffer_load_dwordx4 v[36:39], v4, s[12:15], s46 offen sc1
    s_mov_b32 s46, 0x14000
    buffer_load_dwordx4 v[40:43], v4, s[12:15], s46 offen sc1
    s_mov_b32 s46, 0x16000
    buffer_load_dwordx4 v[44:47], v4, s[12:15], s46 offen sc1
    s_mov_b32 s46, 0x18000
    buffer_load_dwordx4 v[48:51], v4, s[12:15], s46 offen sc1
    s_mov_b32 s46, 0x1a000
    buffer_load_dwordx4 v[52:55], v4, s[12:15], s46 offen sc1
    s_mov_b32 s46, 0x1c000
    buffer_load_dwordx4 v[56:59], v4, s[12:15], s46 offen sc1
    s_mov_b32 s46, 0x1e000
    buffer_load_dwordx4 v[60:63], v4, s[12:15], s46 offen sc1
    s_cmp_lg_u32 s44, 0
    s_cbranch_scc1 L_l_nx_20
    s_cmp_ge_u32 s42, 2
    s_cbranch_scc1 L_l_nx_20
    s_or_b32 s47, s39, 0x100
    v_mov_b32 v8, s47
    v_mov_b32 v9, 0
    s_lshl_b32 s46, s40, 3
    s_lshl_b32 s47, s42, 2
    s_add_u32 s46, s46, s47
    s_add_u32 s46, s46, 0x101200
    s_mov_b64 exec, 1
    buffer_store_dword v8, v9, s[12:15], s46 offen sc1
    s_mov_b64 exec, -1
L_l_nx_20:
    s_mul_i32 s46, s44, 2064
    s_add_u32 s46, s46, 32768
    v_add_u32 v10, s46, v2
    v_and_b32 v11, 7, v1
    v_lshrrev_b32 v12, 3, v1
    v_mul_u32_u24 v13, 2064, v11
    v_lshl_add_u32 v13, v12, 4, v13
    s_lshl_b32 s46, s44, 8
    s_add_u32 s46, s46, 32768
    v_add_u32 v13, s46, v13
    v_lshlrev_b32 v11, 4, v11
    v_lshl_add_u32 v11, v12, 9, v11
    s_lshl_b32 s46, s44, 13
    s_lshl_b32 s47, s42, 7
    s_add_u32 s46, s46, s47
    s_add_u32 s46, s46, 0x400000
    v_add_u32 v11, s46, v11
    v_add_u32 v12, 4096, v11
    s_lshl_b32 s52, s43, 9
    s_lshl_b32 s47, s42, 7
    s_add_u32 s52, s52, s47
    s_add_u32 s52, s52, 0x109400
    s_mov_b32 s60, s43
    s_waitcnt vmcnt(0)
    v_add_f32 v32, v32, v48
    v_add_f32 v33, v33, v49
    v_add_f32 v34, v34, v50
    v_add_f32 v35, v35, v51
    v_add_f32 v36, v36, v52
    v_add_f32 v37, v37, v53
    v_add_f32 v38, v38, v54
    v_add_f32 v39, v39, v55
    v_add_f32 v40, v40, v56
    v_add_f32 v41, v41, v57
    v_add_f32 v42, v42, v58
    v_add_f32 v43, v43, v59
    v_add_f32 v44, v44, v60
    v_add_f32 v45, v45, v61
    v_add_f32 v46, v46, v62
    v_add_f32 v47, v47, v63
    v_add_f32 v32, v32, v40
    v_add_f32 v33, v33, v41
    v_add_f32 v34, v34, v42
    v_add_f32 v35, v35, v43
    v_add_f32 v36, v36, v44
    v_add_f32 v37, v37, v45
    v_add_f32 v38, v38, v46
    v_add_f32 v39, v39, v47
    v_add_f32 v32, v32, v36
    v_add_f32 v33, v33, v37
    v_add_f32 v34, v34, v38
    v_add_f32 v35, v35, v39
    v_cvt_pk_bf16_f32 v32, 0, v32
    v_cvt_pk_bf16_f32 v33, 0, v33
    v_cvt_pk_bf16_f32 v34, 0, v34
    v_cvt_pk_bf16_f32 v35, 0, v35
    ds_write_b128 v4, v[32:35]
    s_waitcnt lgkmcnt(0)
    s_barrier
    ds_read_b128 v[48:51], v3 offset:0
    ds_read_b128 v[52:55], v3 offset:16
    ds_read_b128 v[56:59], v3 offset:2048
    ds_read_b128 v[60:63], v3 offset:2064
    ds_read_b128 v[32:35], v3 offset:4096
    ds_read_b128 v[36:39], v3 offset:4112
    ds_read_b128 v[40:43], v3 offset:6144
    ds_read_b128 v[44:47], v3 offset:6160
    s_waitcnt lgkmcnt(0)
    v_add_f32 v32, 1.0, v32
    v_add_f32 v33, 1.0, v33
    v_add_f32 v34, 1.0, v34
    v_add_f32 v35, 1.0, v35
    v_add_f32 v36, 1.0, v36
    v_add_f32 v37, 1.0, v37
    v_add_f32 v38, 1.0, v38
    v_add_f32 v39, 1.0, v39
    v_add_f32 v40, 1.0, v40
    v_add_f32 v41, 1.0, v41
    v_add_f32 v42, 1.0, v42
    v_add_f32 v43, 1.0, v43
    v_add_f32 v44, 1.0, v44
    v_add_f32 v45, 1.0, v45
    v_add_f32 v46, 1.0, v46
    v_add_f32 v47, 1.0, v47
    v_cvt_pk_bf16_f32 v32, 0, v32
    v_cvt_pk_bf16_f32 v33, 0, v33
    v_cvt_pk_bf16_f32 v34, 0, v34
    v_cvt_pk_bf16_f32 v35, 0, v35
    v_cvt_pk_bf16_f32 v36, 0, v36
    v_cvt_pk_bf16_f32 v37, 0, v37
    v_cvt_pk_bf16_f32 v38, 0, v38
    v_cvt_pk_bf16_f32 v39, 0, v39
    v_cvt_pk_bf16_f32 v40, 0, v40
    v_cvt_pk_bf16_f32 v41, 0, v41
    v_cvt_pk_bf16_f32 v42, 0, v42
    v_cvt_pk_bf16_f32 v43, 0, v43
    v_cvt_pk_bf16_f32 v44, 0, v44
    v_cvt_pk_bf16_f32 v45, 0, v45
    v_cvt_pk_bf16_f32 v46, 0, v46
    v_cvt_pk_bf16_f32 v47, 0, v47
L_l_sub_21:
    s_lshl_b32 s63, s60, 16
    v_accvgpr_read_b32 v96, a0
    v_accvgpr_read_b32 v97, a1
    v_accvgpr_read_b32 v98, a2
    v_accvgpr_read_b32 v99, a3
    v_accvgpr_read_b32 v100, a4
    v_accvgpr_read_b32 v101, a5
    v_accvgpr_read_b32 v102, a6
    v_accvgpr_read_b32 v103, a7
    v_lshlrev_b32 v64, 16, v96
    v_and_b32 v65, 0xffff0000, v96
    v_lshlrev_b32 v66, 16, v97
    v_and_b32 v67, 0xffff0000, v97
    v_lshlrev_b32 v68, 16, v98
    v_and_b32 v69, 0xffff0000, v98
    v_lshlrev_b32 v70, 16, v99
    v_and_b32 v71, 0xffff0000, v99
    v_lshlrev_b32 v72, 16, v100
    v_and_b32 v73, 0xffff0000, v100
    v_lshlrev_b32 v74, 16, v101
    v_and_b32 v75, 0xffff0000, v101
    v_lshlrev_b32 v76, 16, v102
    v_and_b32 v77, 0xffff0000, v102
    v_lshlrev_b32 v78, 16, v103
    v_and_b32 v79, 0xffff0000, v103
    v_pk_add_f32 v[80:81], v[64:65], v[72:73]
    v_pk_add_f32 v[82:83], v[66:67], v[74:75]
    v_pk_add_f32 v[84:85], v[68:69], v[76:77]
    v_pk_add_f32 v[86:87], v[70:71], v[78:79]
    v_pk_add_f32 v[80:81], v[80:81], v[84:85]
    v_pk_add_f32 v[82:83], v[82:83], v[86:87]
    v_pk_add_f32 v[80:81], v[80:81], v[82:83]
    v_add_f32 v14, v80, v81
    s_nop 1
    v_add_f32_dpp v14, v14, v14 row_shr:1 row_mask:0xf bank_mask:0xf bound_ctrl:0
    s_nop 1
    v_add_f32_dpp v14, v14, v14 row_shr:2 row_mask:0xf bank_mask:0xf bound_ctrl:0
    s_nop 1
    v_add_f32_dpp v14, v14, v14 row_shr:4 row_mask:0xf bank_mask:0xf bound_ctrl:0
    s_nop 1
    v_add_f32_dpp v14, v14, v14 row_shr:8 row_mask:0xf bank_mask:0xf bound_ctrl:0
    s_nop 1
    v_add_f32_dpp v14, v14, v14 row_bcast:15 row_mask:0xa bank_mask:0xf
    s_nop 1
    v_add_f32_dpp v14, v14, v14 row_bcast:31 row_mask:0xc bank_mask:0xf
    s_nop 1
    v_readlane_b32 s46, v14, 63
    s_nop 1
    v_mov_b32 v15, s46
    v_mul_f32 v15, 0x3a800000, v15
    v_pk_add_f32 v[80:81], v[64:65], v[14:15] op_sel:[0,1] op_sel_hi:[1,1] neg_lo:[0,1] neg_hi:[0,1]
    v_pk_add_f32 v[82:83], v[66:67], v[14:15] op_sel:[0,1] op_sel_hi:[1,1] neg_lo:[0,1] neg_hi:[0,1]
    v_pk_add_f32 v[84:85], v[68:69], v[14:15] op_sel:[0,1] op_sel_hi:[1,1] neg_lo:[0,1] neg_hi:[0,1]
    v_pk_add_f32 v[86:87], v[70:71], v[14:15] op_sel:[0,1] op_sel_hi:[1,1] neg_lo:[0,1] neg_hi:[0,1]
    v_pk_add_f32 v[88:89], v[72:73], v[14:15] op_sel:[0,1] op_sel_hi:[1,1] neg_lo:[0,1] neg_hi:[0,1]
    v_pk_add_f32 v[90:91], v[74:75], v[14:15] op_sel:[0,1] op_sel_hi:[1,1] neg_lo:[0,1] neg_hi:[0,1]
    v_pk_add_f32 v[92:93], v[76:77], v[14:15] op_sel:[0,1] op_sel_hi:[1,1] neg_lo:[0,1] neg_hi:[0,1]
    v_pk_add_f32 v[94:95], v[78:79], v[14:15] op_sel:[0,1] op_sel_hi:[1,1] neg_lo:[0,1] neg_hi:[0,1]
    v_pk_mul_f32 v[104:105], v[80:81], v[80:81]
    v_pk_mul_f32 v[106:107], v[82:83], v[82:83]
    v_pk_fma_f32 v[104:105], v[84:85], v[84:85], v[104:105]
    v_pk_fma_f32 v[106:107], v[86:87], v[86:87], v[106:107]
    v_pk_fma_f32 v[104:105], v[88:89], v[88:89], v[104:105]
    v_pk_fma_f32 v[106:107], v[90:91], v[90:91], v[106:107]
    v_pk_fma_f32 v[104:105], v[92:93], v[92:93], v[104:105]
    v_pk_fma_f32 v[106:107], v[94:95], v[94:95], v[106:107]
    v_pk_add_f32 v[104:105], v[104:105], v[106:107]
    v_add_f32 v14, v104, v105
    v_cvt_pk_bf16_f32 v15, 0, v15
    s_nop 1
    v_add_f32_dpp v14, v14, v14 row_shr:1 row_mask:0xf bank_mask:0xf bound_ctrl:0
    s_nop 1
    v_add_f32_dpp v14, v14, v14 row_shr:2 row_mask:0xf bank_mask:0xf bound_ctrl:0
    s_nop 1
    v_add_f32_dpp v14, v14, v14 row_shr:4 row_mask:0xf bank_mask:0xf bound_ctrl:0
    s_nop 1
    v_add_f32_dpp v14, v14, v14 row_shr:8 row_mask:0xf bank_mask:0xf bound_ctrl:0
    s_nop 1
    v_add_f32_dpp v14, v14, v14 row_bcast:15 row_mask:0xa bank_mask:0xf
    s_nop 1
    v_add_f32_dpp v14, v14, v14 row_bcast:31 row_mask:0xc bank_mask:0xf
    s_nop 1
    v_readlane_b32 s47, v14, 63
    v_pk_add_f32 v[64:65], v[64:65], v[14:15] op_sel:[0,1] op_sel_hi:[1,1] neg_lo:[0,1] neg_hi:[0,1]
    v_pk_add_f32 v[66:67], v[66:67], v[14:15] op_sel:[0,1] op_sel_hi:[1,1] neg_lo:[0,1] neg_hi:[0,1]
    v_pk_add_f32 v[68:69], v[68:69], v[14:15] op_sel:[0,1] op_sel_hi:[1,1] neg_lo:[0,1] neg_hi:[0,1]
    v_pk_add_f32 v[70:71], v[70:71], v[14:15] op_sel:[0,1] op_sel_hi:[1,1] neg_lo:[0,1] neg_hi:[0,1]
    v_pk_add_f32 v[72:73], v[72:73], v[14:15] op_sel:[0,1] op_sel_hi:[1,1] neg_lo:[0,1] neg_hi:[0,1]
    v_pk_add_f32 v[74:75], v[74:75], v[14:15] op_sel:[0,1] op_sel_hi:[1,1] neg_lo:[0,1] neg_hi:[0,1]
    v_pk_add_f32 v[76:77], v[76:77], v[14:15] op_sel:[0,1] op_sel_hi:[1,1] neg_lo:[0,1] neg_hi:[0,1]
    v_pk_add_f32 v[78:79], v[78:79], v[14:15] op_sel:[0,1] op_sel_hi:[1,1] neg_lo:[0,1] neg_hi:[0,1]
    v_mov_b32 v14, s47
    v_mul_f32 v14, 0x3a800000, v14
    v_cvt_pk_bf16_f32 v14, 0, v14
    v_add_f32 v14, 0x3727c5ac, v14
    v_cvt_pk_bf16_f32 v14, 0, v14
    v_sqrt_f32 v14, v14
    s_nop 0
    v_cvt_pk_bf16_f32 v14, 0, v14
    v_rcp_f32 v14, v14
    v_cvt_pk_bf16_f32 v64, 0, v64
    v_cvt_pk_bf16_f32 v65, 0, v65
    v_cvt_pk_bf16_f32 v66, 0, v66
    v_cvt_pk_bf16_f32 v67, 0, v67
    v_cvt_pk_bf16_f32 v68, 0, v68
    v_cvt_pk_bf16_f32 v69, 0, v69
    v_cvt_pk_bf16_f32 v70, 0, v70
    v_cvt_pk_bf16_f32 v71, 0, v71
    v_cvt_pk_bf16_f32 v72, 0, v72
    v_cvt_pk_bf16_f32 v73, 0, v73
    v_cvt_pk_bf16_f32 v74, 0, v74
    v_cvt_pk_bf16_f32 v75, 0, v75
    v_cvt_pk_bf16_f32 v76, 0, v76
    v_cvt_pk_bf16_f32 v77, 0, v77
    v_cvt_pk_bf16_f32 v78, 0, v78
    v_cvt_pk_bf16_f32 v79, 0, v79
    v_pk_mul_f32 v[64:65], v[64:65], v[14:15] op_sel_hi:[1,0]
    v_pk_mul_f32 v[66:67], v[66:67], v[14:15] op_sel_hi:[1,0]
    v_pk_mul_f32 v[68:69], v[68:69], v[14:15] op_sel_hi:[1,0]
    v_pk_mul_f32 v[70:71], v[70:71], v[14:15] op_sel_hi:[1,0]
    v_pk_mul_f32 v[72:73], v[72:73], v[14:15] op_sel_hi:[1,0]
    v_pk_mul_f32 v[74:75], v[74:75], v[14:15] op_sel_hi:[1,0]
    v_pk_mul_f32 v[76:77], v[76:77], v[14:15] op_sel_hi:[1,0]
    v_pk_mul_f32 v[78:79], v[78:79], v[14:15] op_sel_hi:[1,0]
    v_cvt_pk_bf16_f32 v64, 0, v64
    v_cvt_pk_bf16_f32 v65, 0, v65
    v_cvt_pk_bf16_f32 v66, 0, v66
    v_cvt_pk_bf16_f32 v67, 0, v67
    v_cvt_pk_bf16_f32 v68, 0, v68
    v_cvt_pk_bf16_f32 v69, 0, v69
    v_cvt_pk_bf16_f32 v70, 0, v70
    v_cvt_pk_bf16_f32 v71, 0, v71
    v_cvt_pk_bf16_f32 v72, 0, v72
    v_cvt_pk_bf16_f32 v73, 0, v73
    v_cvt_pk_bf16_f32 v74, 0, v74
    v_cvt_pk_bf16_f32 v75, 0, v75
    v_cvt_pk_bf16_f32 v76, 0, v76
    v_cvt_pk_bf16_f32 v77, 0, v77
    v_cvt_pk_bf16_f32 v78, 0, v78
    v_cvt_pk_bf16_f32 v79, 0, v79
    v_pk_mul_f32 v[64:65], v[64:65], v[32:33]
    v_pk_mul_f32 v[66:67], v[66:67], v[34:35]
    v_pk_mul_f32 v[68:69], v[68:69], v[36:37]
    v_pk_mul_f32 v[70:71], v[70:71], v[38:39]
    v_pk_mul_f32 v[72:73], v[72:73], v[40:41]
    v_pk_mul_f32 v[74:75], v[74:75], v[42:43]
    v_pk_mul_f32 v[76:77], v[76:77], v[44:45]
    v_pk_mul_f32 v[78:79], v[78:79], v[46:47]
    v_cvt_pk_bf16_f32 v64, 0, v64
    v_cvt_pk_bf16_f32 v65, 0, v65
    v_cvt_pk_bf16_f32 v66, 0, v66
    v_cvt_pk_bf16_f32 v67, 0, v67
    v_cvt_pk_bf16_f32 v68, 0, v68
    v_cvt_pk_bf16_f32 v69, 0, v69
    v_cvt_pk_bf16_f32 v70, 0, v70
    v_cvt_pk_bf16_f32 v71, 0, v71
    v_cvt_pk_bf16_f32 v72, 0, v72
    v_cvt_pk_bf16_f32 v73, 0, v73
    v_cvt_pk_bf16_f32 v74, 0, v74
    v_cvt_pk_bf16_f32 v75, 0, v75
    v_cvt_pk_bf16_f32 v76, 0, v76
    v_cvt_pk_bf16_f32 v77, 0, v77
    v_cvt_pk_bf16_f32 v78, 0, v78
    v_cvt_pk_bf16_f32 v79, 0, v79
    v_pk_add_f32 v[64:65], v[64:65], v[48:49]
    v_pk_add_f32 v[66:67], v[66:67], v[50:51]
    v_pk_add_f32 v[68:69], v[68:69], v[52:53]
    v_pk_add_f32 v[70:71], v[70:71], v[54:55]
    v_pk_add_f32 v[72:73], v[72:73], v[56:57]
    v_pk_add_f32 v[74:75], v[74:75], v[58:59]
    v_pk_add_f32 v[76:77], v[76:77], v[60:61]
    v_pk_add_f32 v[78:79], v[78:79], v[62:63]
    v_cvt_pk_bf16_f32 v104, v64, v65
    v_cvt_pk_bf16_f32 v105, v66, v67
    v_cvt_pk_bf16_f32 v106, v68, v69
    v_cvt_pk_bf16_f32 v107, v70, v71
    v_cvt_pk_bf16_f32 v108, v72, v73
    v_cvt_pk_bf16_f32 v109, v74, v75
    v_cvt_pk_bf16_f32 v110, v76, v77
    v_cvt_pk_bf16_f32 v111, v78, v79
    ds_write_b128 v10, v[104:107]
    ds_write_b128 v10, v[108:111] offset:1024
    s_waitcnt lgkmcnt(0)
    s_barrier
    ds_read_b128 v[104:107], v13
    ds_read_b128 v[108:111], v13 offset:128
    s_waitcnt lgkmcnt(1)
    buffer_store_dwordx4 v[104:107], v11, s[12:15], s63 offen sc1
    s_waitcnt lgkmcnt(0)
    buffer_store_dwordx4 v[108:111], v12, s[12:15], s63 offen sc1
    s_waitcnt vmcnt(0)
    s_barrier
    s_cmp_lg_u32 s44, 0
    s_cbranch_scc1 L_sf_23
    v_mov_b32 v14, s60
    v_add_u32 v14, 1, v14
    v_mov_b32 v15, 0
    s_mov_b64 exec, 1
    buffer_store_dword v14, v15, s[12:15], s52 offen sc1
    s_mov_b64 exec, -1
L_sf_23:
    s_cmp_ge_u32 s60, 8
    s_cbranch_scc1 L_l_end_22
    s_add_u32 s63, s63, 524288
    buffer_load_dwordx4 a[8:11], v7, s[24:27], s63 offen
    buffer_load_dwordx4 a[12:15], v7, s[24:27], s63 offen offset:1024
    s_add_u32 s63, s63, 524288
    buffer_load_dwordx4 a[16:19], v7, s[24:27], s63 offen
    buffer_load_dwordx4 a[20:23], v7, s[24:27], s63 offen offset:1024
    s_add_u32 s63, s63, 524288
    buffer_load_dwordx4 a[24:27], v7, s[24:27], s63 offen
    buffer_load_dwordx4 a[28:31], v7, s[24:27], s63 offen offset:1024
    s_add_u32 s63, s63, 524288
    buffer_load_dwordx4 a[32:35], v7, s[24:27], s63 offen
    buffer_load_dwordx4 a[36:39], v7, s[24:27], s63 offen offset:1024
    s_add_u32 s63, s63, 524288
    buffer_load_dwordx4 a[40:43], v7, s[24:27], s63 offen
    buffer_load_dwordx4 a[44:47], v7, s[24:27], s63 offen offset:1024
    s_add_u32 s63, s63, 524288
    buffer_load_dwordx4 a[48:51], v7, s[24:27], s63 offen
    buffer_load_dwordx4 a[52:55], v7, s[24:27], s63 offen offset:1024
    s_add_u32 s63, s63, 524288
    buffer_load_dwordx4 a[56:59], v7, s[24:27], s63 offen
    buffer_load_dwordx4 a[60:63], v7, s[24:27], s63 offen offset:1024
    s_waitcnt vmcnt(0)
L_l_end_22:
    v_accvgpr_mov_b32 a0, a8
    v_accvgpr_mov_b32 a1, a9
    v_accvgpr_mov_b32 a2, a10
    v_accvgpr_mov_b32 a3, a11
    v_accvgpr_mov_b32 a4, a12
    v_accvgpr_mov_b32 a5, a13
    v_accvgpr_mov_b32 a6, a14
    v_accvgpr_mov_b32 a7, a15
    v_accvgpr_mov_b32 a8, a16
    v_accvgpr_mov_b32 a9, a17
    v_accvgpr_mov_b32 a10, a18
    v_accvgpr_mov_b32 a11, a19
    v_accvgpr_mov_b32 a12, a20
    v_accvgpr_mov_b32 a13, a21
    v_accvgpr_mov_b32 a14, a22
    v_accvgpr_mov_b32 a15, a23
    v_accvgpr_mov_b32 a16, a24
    v_accvgpr_mov_b32 a17, a25
    v_accvgpr_mov_b32 a18, a26
    v_accvgpr_mov_b32 a19, a27
    v_accvgpr_mov_b32 a20, a28
    v_accvgpr_mov_b32 a21, a29
    v_accvgpr_mov_b32 a22, a30
    v_accvgpr_mov_b32 a23, a31
    v_accvgpr_mov_b32 a24, a32
    v_accvgpr_mov_b32 a25, a33
    v_accvgpr_mov_b32 a26, a34
    v_accvgpr_mov_b32 a27, a35
    v_accvgpr_mov_b32 a28, a36
    v_accvgpr_mov_b32 a29, a37
    v_accvgpr_mov_b32 a30, a38
    v_accvgpr_mov_b32 a31, a39
    v_accvgpr_mov_b32 a32, a40
    v_accvgpr_mov_b32 a33, a41
    v_accvgpr_mov_b32 a34, a42
    v_accvgpr_mov_b32 a35, a43
    v_accvgpr_mov_b32 a36, a44
    v_accvgpr_mov_b32 a37, a45
    v_accvgpr_mov_b32 a38, a46
    v_accvgpr_mov_b32 a39, a47
    v_accvgpr_mov_b32 a40, a48
    v_accvgpr_mov_b32 a41, a49
    v_accvgpr_mov_b32 a42, a50
    v_accvgpr_mov_b32 a43, a51
    v_accvgpr_mov_b32 a44, a52
    v_accvgpr_mov_b32 a45, a53
    v_accvgpr_mov_b32 a46, a54
    v_accvgpr_mov_b32 a47, a55
    v_accvgpr_mov_b32 a48, a56
    v_accvgpr_mov_b32 a49, a57
    v_accvgpr_mov_b32 a50, a58
    v_accvgpr_mov_b32 a51, a59
    v_accvgpr_mov_b32 a52, a60
    v_accvgpr_mov_b32 a53, a61
    v_accvgpr_mov_b32 a54, a62
    v_accvgpr_mov_b32 a55, a63
    s_add_u32 s60, s60, 8
    s_cmp_lt_u32 s60, 64
    s_cbranch_scc1 L_l_sub_21
    s_cmp_lt_u32 s48, 14
    s_cbranch_scc1 L_w_h_17_s
    s_and_b32 s55, s48, 1
    s_lshl_b32 s55, s55, 3
    s_add_u32 s55, s55, s40
    s_load_dwordx4 s[8:11], s[0:1], 96
    v_lshrrev_b32 v5, 3, v0
    s_mov_b32 s46, 196608
    v_mul_lo_u32 v4, v5, s46
    v_and_b32 v6, 7, v0
    v_lshl_add_u32 v4, v6, 4, v4
    v_lshlrev_b32 v5, 5, v5
    s_waitcnt lgkmcnt(0)
    s_mov_b32 s28, s10
    s_and_b32 s29, s11, 0xffff
    s_mov_b32 s30, 0xc00000
    s_mov_b32 s31, 0x00020000
    s_mov_b32 s32, s8
    s_and_b32 s33, s9, 0xffff
    s_mov_b32 s34, 0x800
    s_mov_b32 s35, 0x00020000
    buffer_load_dwordx4 v[8:11], v5, s[32:35], 0 offen
    buffer_load_dwordx4 v[12:15], v5, s[32:35], 0 offen offset:16
    s_waitcnt vmcnt(0)
    v_lshlrev_b32 v16, 16, v8
    v_and_b32 v17, 0xffff0000, v8
    v_lshlrev_b32 v18, 16, v9
    v_and_b32 v19, 0xffff0000, v9
    v_lshlrev_b32 v20, 16, v10
    v_and_b32 v21, 0xffff0000, v10
    v_lshlrev_b32 v22, 16, v11
    v_and_b32 v23, 0xffff0000, v11
    v_lshlrev_b32 v24, 16, v12
    v_and_b32 v25, 0xffff0000, v12
    v_lshlrev_b32 v26, 16, v13
    v_and_b32 v27, 0xffff0000, v13
    v_lshlrev_b32 v28, 16, v14
    v_and_b32 v29, 0xffff0000, v14
    v_lshlrev_b32 v30, 16, v15
    v_and_b32 v31, 0xffff0000, v15
    v_mul_f32 v112, 0xbfb8aa3b, v16
    v_mul_f32 v113, 0xbfb8aa3b, v17
    v_mul_f32 v114, 0xbfb8aa3b, v18
    v_mul_f32 v115, 0xbfb8aa3b, v19
    v_mul_f32 v116, 0xbfb8aa3b, v20
    v_mul_f32 v117, 0xbfb8aa3b, v21
    v_mul_f32 v118, 0xbfb8aa3b, v22
    v_mul_f32 v119, 0xbfb8aa3b, v23
    v_mul_f32 v120, 0xbfb8aa3b, v24
    v_mul_f32 v121, 0xbfb8aa3b, v25
    v_mul_f32 v122, 0xbfb8aa3b, v26
    v_mul_f32 v123, 0xbfb8aa3b, v27
    v_mul_f32 v124, 0xbfb8aa3b, v28
    v_mul_f32 v125, 0xbfb8aa3b, v29
    v_mul_f32 v126, 0xbfb8aa3b, v30
    v_mul_f32 v127, 0xbfb8aa3b, v31
    v_exp_f32 v112, v112
    v_exp_f32 v113, v113
    v_exp_f32 v114, v114
    v_exp_f32 v115, v115
    v_exp_f32 v116, v116
    v_exp_f32 v117, v117
    v_exp_f32 v118, v118
    v_exp_f32 v119, v119
    v_exp_f32 v120, v120
    v_exp_f32 v121, v121
    v_exp_f32 v122, v122
    v_exp_f32 v123, v123
    v_exp_f32 v124, v124
    v_exp_f32 v125, v125
    v_exp_f32 v126, v126
    v_exp_f32 v127, v127
    v_add_f32 v112, 1.0, v112
    v_add_f32 v113, 1.0, v113
    v_add_f32 v114, 1.0, v114
    v_add_f32 v115, 1.0, v115
    v_add_f32 v116, 1.0, v116
    v_add_f32 v117, 1.0, v117
    v_add_f32 v118, 1.0, v118
    v_add_f32 v119, 1.0, v119
    v_add_f32 v120, 1.0, v120
    v_add_f32 v121, 1.0, v121
    v_add_f32 v122, 1.0, v122
    v_add_f32 v123, 1.0, v123
    v_add_f32 v124, 1.0, v124
    v_add_f32 v125, 1.0, v125
    v_add_f32 v126, 1.0, v126
    v_add_f32 v127, 1.0, v127
    v_rcp_f32 v112, v112
    v_rcp_f32 v113, v113
    v_rcp_f32 v114, v114
    v_rcp_f32 v115, v115
    v_rcp_f32 v116, v116
    v_rcp_f32 v117, v117
    v_rcp_f32 v118, v118
    v_rcp_f32 v119, v119
    v_rcp_f32 v120, v120
    v_rcp_f32 v121, v121
    v_rcp_f32 v122, v122
    v_rcp_f32 v123, v123
    v_rcp_f32 v124, v124
    v_rcp_f32 v125, v125
    v_rcp_f32 v126, v126
    v_rcp_f32 v127, v127
    v_mul_f32 v16, v16, v112
    v_mul_f32 v17, v17, v113
    v_mul_f32 v18, v18, v114
    v_mul_f32 v19, v19, v115
    v_mul_f32 v20, v20, v116
    v_mul_f32 v21, v21, v117
    v_mul_f32 v22, v22, v118
    v_mul_f32 v23, v23, v119
    v_mul_f32 v24, v24, v120
    v_mul_f32 v25, v25, v121
    v_mul_f32 v26, v26, v122
    v_mul_f32 v27, v27, v123
    v_mul_f32 v28, v28, v124
    v_mul_f32 v29, v29, v125
    v_mul_f32 v30, v30, v126
    v_mul_f32 v31, v31, v127
    v_cvt_pk_bf16_f32 v16, 0, v16
    v_cvt_pk_bf16_f32 v17, 0, v17
    v_cvt_pk_bf16_f32 v18, 0, v18
    v_cvt_pk_bf16_f32 v19, 0, v19
    v_cvt_pk_bf16_f32 v20, 0, v20
    v_cvt_pk_bf16_f32 v21, 0, v21
    v_cvt_pk_bf16_f32 v22, 0, v22
    v_cvt_pk_bf16_f32 v23, 0, v23
    v_cvt_pk_bf16_f32 v24, 0, v24
    v_cvt_pk_bf16_f32 v25, 0, v25
    v_cvt_pk_bf16_f32 v26, 0, v26
    v_cvt_pk_bf16_f32 v27, 0, v27
    v_cvt_pk_bf16_f32 v28, 0, v28
    v_cvt_pk_bf16_f32 v29, 0, v29
    v_cvt_pk_bf16_f32 v30, 0, v30
    v_cvt_pk_bf16_f32 v31, 0, v31
    s_lshl_b32 s53, s55, 9
    s_add_u32 s53, s53, 4096
L_m_loop_24:
    s_add_u32 s46, s53, 0
    buffer_load_dwordx4 v[32:35], v4, s[28:31], s46 offen
    s_add_u32 s46, s53, 12288
    buffer_load_dwordx4 v[36:39], v4, s[28:31], s46 offen
    s_add_u32 s46, s53, 24576
    buffer_load_dwordx4 v[40:43], v4, s[28:31], s46 offen
    s_add_u32 s46, s53, 36864
    buffer_load_dwordx4 v[44:47], v4, s[28:31], s46 offen
    s_add_u32 s46, s53, 49152
    buffer_load_dwordx4 v[48:51], v4, s[28:31], s46 offen
    s_add_u32 s46, s53, 61440
    buffer_load_dwordx4 v[52:55], v4, s[28:31], s46 offen
    s_add_u32 s46, s53, 73728
    buffer_load_dwordx4 v[56:59], v4, s[28:31], s46 offen
    s_add_u32 s46, s53, 86016
    buffer_load_dwordx4 v[60:63], v4, s[28:31], s46 offen
    s_add_u32 s46, s53, 98304
    buffer_load_dwordx4 v[64:67], v4, s[28:31], s46 offen
    s_add_u32 s46, s53, 110592
    buffer_load_dwordx4 v[68:71], v4, s[28:31], s46 offen
    s_add_u32 s46, s53, 122880
    buffer_load_dwordx4 v[72:75], v4, s[28:31], s46 offen
    s_add_u32 s46, s53, 135168
    buffer_load_dwordx4 v[76:79], v4, s[28:31], s46 offen
    s_add_u32 s46, s53, 147456
    buffer_load_dwordx4 v[80:83], v4, s[28:31], s46 offen
    s_add_u32 s46, s53, 159744
    buffer_load_dwordx4 v[84:87], v4, s[28:31], s46 offen
    s_add_u32 s46, s53, 172032
    buffer_load_dwordx4 v[88:91], v4, s[28:31], s46 offen
    s_add_u32 s46, s53, 184320
    buffer_load_dwordx4 v[92:95], v4, s[28:31], s46 offen
    s_waitcnt vmcnt(15)
    v_lshlrev_b32 v104, 16, v32
    v_and_b32 v105, 0xffff0000, v32
    v_mul_f32 v96, v104, v16
    v_mul_f32 v97, v105, v16
    v_lshlrev_b32 v104, 16, v33
    v_and_b32 v105, 0xffff0000, v33
    v_mul_f32 v98, v104, v16
    v_mul_f32 v99, v105, v16
    v_lshlrev_b32 v104, 16, v34
    v_and_b32 v105, 0xffff0000, v34
    v_mul_f32 v100, v104, v16
    v_mul_f32 v101, v105, v16
    v_lshlrev_b32 v104, 16, v35
    v_and_b32 v105, 0xffff0000, v35
    v_mul_f32 v102, v104, v16
    v_mul_f32 v103, v105, v16
    s_waitcnt vmcnt(14)
    v_lshlrev_b32 v104, 16, v36
    v_and_b32 v105, 0xffff0000, v36
    v_fmac_f32 v96, v104, v17
    v_fmac_f32 v97, v105, v17
    v_lshlrev_b32 v104, 16, v37
    v_and_b32 v105, 0xffff0000, v37
    v_fmac_f32 v98, v104, v17
    v_fmac_f32 v99, v105, v17
    v_lshlrev_b32 v104, 16, v38
    v_and_b32 v105, 0xffff0000, v38
    v_fmac_f32 v100, v104, v17
    v_fmac_f32 v101, v105, v17
    v_lshlrev_b32 v104, 16, v39
    v_and_b32 v105, 0xffff0000, v39
    v_fmac_f32 v102, v104, v17
    v_fmac_f32 v103, v105, v17
    s_waitcnt vmcnt(13)
    v_lshlrev_b32 v104, 16, v40
    v_and_b32 v105, 0xffff0000, v40
    v_fmac_f32 v96, v104, v18
    v_fmac_f32 v97, v105, v18
    v_lshlrev_b32 v104, 16, v41
    v_and_b32 v105, 0xffff0000, v41
    v_fmac_f32 v98, v104, v18
    v_fmac_f32 v99, v105, v18
    v_lshlrev_b32 v104, 16, v42
    v_and_b32 v105, 0xffff0000, v42
    v_fmac_f32 v100, v104, v18
    v_fmac_f32 v101, v105, v18
    v_lshlrev_b32 v104, 16, v43
    v_and_b32 v105, 0xffff0000, v43
    v_fmac_f32 v102, v104, v18
    v_fmac_f32 v103, v105, v18
    s_waitcnt vmcnt(12)
    v_lshlrev_b32 v104, 16, v44
    v_and_b32 v105, 0xffff0000, v44
    v_fmac_f32 v96, v104, v19
    v_fmac_f32 v97, v105, v19
    v_lshlrev_b32 v104, 16, v45
    v_and_b32 v105, 0xffff0000, v45
    v_fmac_f32 v98, v104, v19
    v_fmac_f32 v99, v105, v19
    v_lshlrev_b32 v104, 16, v46
    v_and_b32 v105, 0xffff0000, v46
    v_fmac_f32 v100, v104, v19
    v_fmac_f32 v101, v105, v19
    v_lshlrev_b32 v104, 16, v47
    v_and_b32 v105, 0xffff0000, v47
    v_fmac_f32 v102, v104, v19
    v_fmac_f32 v103, v105, v19
    s_waitcnt vmcnt(11)
    v_lshlrev_b32 v104, 16, v48
    v_and_b32 v105, 0xffff0000, v48
    v_fmac_f32 v96, v104, v20
    v_fmac_f32 v97, v105, v20
    v_lshlrev_b32 v104, 16, v49
    v_and_b32 v105, 0xffff0000, v49
    v_fmac_f32 v98, v104, v20
    v_fmac_f32 v99, v105, v20
    v_lshlrev_b32 v104, 16, v50
    v_and_b32 v105, 0xffff0000, v50
    v_fmac_f32 v100, v104, v20
    v_fmac_f32 v101, v105, v20
    v_lshlrev_b32 v104, 16, v51
    v_and_b32 v105, 0xffff0000, v51
    v_fmac_f32 v102, v104, v20
    v_fmac_f32 v103, v105, v20
    s_waitcnt vmcnt(10)
    v_lshlrev_b32 v104, 16, v52
    v_and_b32 v105, 0xffff0000, v52
    v_fmac_f32 v96, v104, v21
    v_fmac_f32 v97, v105, v21
    v_lshlrev_b32 v104, 16, v53
    v_and_b32 v105, 0xffff0000, v53
    v_fmac_f32 v98, v104, v21
    v_fmac_f32 v99, v105, v21
    v_lshlrev_b32 v104, 16, v54
    v_and_b32 v105, 0xffff0000, v54
    v_fmac_f32 v100, v104, v21
    v_fmac_f32 v101, v105, v21
    v_lshlrev_b32 v104, 16, v55
    v_and_b32 v105, 0xffff0000, v55
    v_fmac_f32 v102, v104, v21
    v_fmac_f32 v103, v105, v21
    s_waitcnt vmcnt(9)
    v_lshlrev_b32 v104, 16, v56
    v_and_b32 v105, 0xffff0000, v56
    v_fmac_f32 v96, v104, v22
    v_fmac_f32 v97, v105, v22
    v_lshlrev_b32 v104, 16, v57
    v_and_b32 v105, 0xffff0000, v57
    v_fmac_f32 v98, v104, v22
    v_fmac_f32 v99, v105, v22
    v_lshlrev_b32 v104, 16, v58
    v_and_b32 v105, 0xffff0000, v58
    v_fmac_f32 v100, v104, v22
    v_fmac_f32 v101, v105, v22
    v_lshlrev_b32 v104, 16, v59
    v_and_b32 v105, 0xffff0000, v59
    v_fmac_f32 v102, v104, v22
    v_fmac_f32 v103, v105, v22
    s_waitcnt vmcnt(8)
    v_lshlrev_b32 v104, 16, v60
    v_and_b32 v105, 0xffff0000, v60
    v_fmac_f32 v96, v104, v23
    v_fmac_f32 v97, v105, v23
    v_lshlrev_b32 v104, 16, v61
    v_and_b32 v105, 0xffff0000, v61
    v_fmac_f32 v98, v104, v23
    v_fmac_f32 v99, v105, v23
    v_lshlrev_b32 v104, 16, v62
    v_and_b32 v105, 0xffff0000, v62
    v_fmac_f32 v100, v104, v23
    v_fmac_f32 v101, v105, v23
    v_lshlrev_b32 v104, 16, v63
    v_and_b32 v105, 0xffff0000, v63
    v_fmac_f32 v102, v104, v23
    v_fmac_f32 v103, v105, v23
    s_waitcnt vmcnt(7)
    v_lshlrev_b32 v104, 16, v64
    v_and_b32 v105, 0xffff0000, v64
    v_fmac_f32 v96, v104, v24
    v_fmac_f32 v97, v105, v24
    v_lshlrev_b32 v104, 16, v65
    v_and_b32 v105, 0xffff0000, v65
    v_fmac_f32 v98, v104, v24
    v_fmac_f32 v99, v105, v24
    v_lshlrev_b32 v104, 16, v66
    v_and_b32 v105, 0xffff0000, v66
    v_fmac_f32 v100, v104, v24
    v_fmac_f32 v101, v105, v24
    v_lshlrev_b32 v104, 16, v67
    v_and_b32 v105, 0xffff0000, v67
    v_fmac_f32 v102, v104, v24
    v_fmac_f32 v103, v105, v24
    s_waitcnt vmcnt(6)
    v_lshlrev_b32 v104, 16, v68
    v_and_b32 v105, 0xffff0000, v68
    v_fmac_f32 v96, v104, v25
    v_fmac_f32 v97, v105, v25
    v_lshlrev_b32 v104, 16, v69
    v_and_b32 v105, 0xffff0000, v69
    v_fmac_f32 v98, v104, v25
    v_fmac_f32 v99, v105, v25
    v_lshlrev_b32 v104, 16, v70
    v_and_b32 v105, 0xffff0000, v70
    v_fmac_f32 v100, v104, v25
    v_fmac_f32 v101, v105, v25
    v_lshlrev_b32 v104, 16, v71
    v_and_b32 v105, 0xffff0000, v71
    v_fmac_f32 v102, v104, v25
    v_fmac_f32 v103, v105, v25
    s_waitcnt vmcnt(5)
    v_lshlrev_b32 v104, 16, v72
    v_and_b32 v105, 0xffff0000, v72
    v_fmac_f32 v96, v104, v26
    v_fmac_f32 v97, v105, v26
    v_lshlrev_b32 v104, 16, v73
    v_and_b32 v105, 0xffff0000, v73
    v_fmac_f32 v98, v104, v26
    v_fmac_f32 v99, v105, v26
    v_lshlrev_b32 v104, 16, v74
    v_and_b32 v105, 0xffff0000, v74
    v_fmac_f32 v100, v104, v26
    v_fmac_f32 v101, v105, v26
    v_lshlrev_b32 v104, 16, v75
    v_and_b32 v105, 0xffff0000, v75
    v_fmac_f32 v102, v104, v26
    v_fmac_f32 v103, v105, v26
    s_waitcnt vmcnt(4)
    v_lshlrev_b32 v104, 16, v76
    v_and_b32 v105, 0xffff0000, v76
    v_fmac_f32 v96, v104, v27
    v_fmac_f32 v97, v105, v27
    v_lshlrev_b32 v104, 16, v77
    v_and_b32 v105, 0xffff0000, v77
    v_fmac_f32 v98, v104, v27
    v_fmac_f32 v99, v105, v27
    v_lshlrev_b32 v104, 16, v78
    v_and_b32 v105, 0xffff0000, v78
    v_fmac_f32 v100, v104, v27
    v_fmac_f32 v101, v105, v27
    v_lshlrev_b32 v104, 16, v79
    v_and_b32 v105, 0xffff0000, v79
    v_fmac_f32 v102, v104, v27
    v_fmac_f32 v103, v105, v27
    s_waitcnt vmcnt(3)
    v_lshlrev_b32 v104, 16, v80
    v_and_b32 v105, 0xffff0000, v80
    v_fmac_f32 v96, v104, v28
    v_fmac_f32 v97, v105, v28
    v_lshlrev_b32 v104, 16, v81
    v_and_b32 v105, 0xffff0000, v81
    v_fmac_f32 v98, v104, v28
    v_fmac_f32 v99, v105, v28
    v_lshlrev_b32 v104, 16, v82
    v_and_b32 v105, 0xffff0000, v82
    v_fmac_f32 v100, v104, v28
    v_fmac_f32 v101, v105, v28
    v_lshlrev_b32 v104, 16, v83
    v_and_b32 v105, 0xffff0000, v83
    v_fmac_f32 v102, v104, v28
    v_fmac_f32 v103, v105, v28
    s_waitcnt vmcnt(2)
    v_lshlrev_b32 v104, 16, v84
    v_and_b32 v105, 0xffff0000, v84
    v_fmac_f32 v96, v104, v29
    v_fmac_f32 v97, v105, v29
    v_lshlrev_b32 v104, 16, v85
    v_and_b32 v105, 0xffff0000, v85
    v_fmac_f32 v98, v104, v29
    v_fmac_f32 v99, v105, v29
    v_lshlrev_b32 v104, 16, v86
    v_and_b32 v105, 0xffff0000, v86
    v_fmac_f32 v100, v104, v29
    v_fmac_f32 v101, v105, v29
    v_lshlrev_b32 v104, 16, v87
    v_and_b32 v105, 0xffff0000, v87
    v_fmac_f32 v102, v104, v29
    v_fmac_f32 v103, v105, v29
    s_waitcnt vmcnt(1)
    v_lshlrev_b32 v104, 16, v88
    v_and_b32 v105, 0xffff0000, v88
    v_fmac_f32 v96, v104, v30
    v_fmac_f32 v97, v105, v30
    v_lshlrev_b32 v104, 16, v89
    v_and_b32 v105, 0xffff0000, v89
    v_fmac_f32 v98, v104, v30
    v_fmac_f32 v99, v105, v30
    v_lshlrev_b32 v104, 16, v90
    v_and_b32 v105, 0xffff0000, v90
    v_fmac_f32 v100, v104, v30
    v_fmac_f32 v101, v105, v30
    v_lshlrev_b32 v104, 16, v91
    v_and_b32 v105, 0xffff0000, v91
    v_fmac_f32 v102, v104, v30
    v_fmac_f32 v103, v105, v30
    s_waitcnt vmcnt(0)
    v_lshlrev_b32 v104, 16, v92
    v_and_b32 v105, 0xffff0000, v92
    v_fmac_f32 v96, v104, v31
    v_fmac_f32 v97, v105, v31
    v_lshlrev_b32 v104, 16, v93
    v_and_b32 v105, 0xffff0000, v93
    v_fmac_f32 v98, v104, v31
    v_fmac_f32 v99, v105, v31
    v_lshlrev_b32 v104, 16, v94
    v_and_b32 v105, 0xffff0000, v94
    v_fmac_f32 v100, v104, v31
    v_fmac_f32 v101, v105, v31
    v_lshlrev_b32 v104, 16, v95
    v_and_b32 v105, 0xffff0000, v95
    v_fmac_f32 v102, v104, v31
    v_fmac_f32 v103, v105, v31
    v_lshlrev_b32 v104, 5, v0
    ds_write_b128 v104, v[96:99]
    ds_write_b128 v104, v[100:103] offset:16
    v_lshlrev_b32 v105, 2, v1
    s_lshl_b32 s46, s44, 11
    v_add_u32 v104, s46, v105
    s_waitcnt lgkmcnt(0)
    ds_read_b32 v96, v104 offset:0
    ds_read_b32 v97, v104 offset:256
    ds_read_b32 v98, v104 offset:512
    ds_read_b32 v99, v104 offset:768
    ds_read_b32 v100, v104 offset:1024
    ds_read_b32 v101, v104 offset:1280
    ds_read_b32 v102, v104 offset:1536
    ds_read_b32 v103, v104 offset:1792
    s_waitcnt lgkmcnt(0)
    v_add_f32 v96, v96, v100
    v_add_f32 v97, v97, v101
    v_add_f32 v98, v98, v102
    v_add_f32 v99, v99, v103
    v_add_f32 v96, v96, v98
    v_add_f32 v97, v97, v99
    v_add_f32 v96, v96, v97
    v_lshlrev_b32 v104, 2, v0
    ds_write_b32 v104, v96 offset:16384
    s_waitcnt lgkmcnt(0)
    s_barrier
    s_cmp_lg_u32 s44, 0
    s_cbranch_scc1 L_m_sk_25
    ds_read_b32 v96, v105 offset:16384
    ds_read_b32 v97, v105 offset:16640
    ds_read_b32 v98, v105 offset:16896
    ds_read_b32 v99, v105 offset:17152
    ds_read_b32 v100, v105 offset:17408
    ds_read_b32 v101, v105 offset:17664
    ds_read_b32 v102, v105 offset:17920
    ds_read_b32 v103, v105 offset:18176
    s_waitcnt lgkmcnt(0)
    v_add_f32 v96, v96, v100
    v_add_f32 v97, v97, v101
    v_add_f32 v98, v98, v102
    v_add_f32 v99, v99, v103
    v_add_f32 v96, v96, v98
    v_add_f32 v97, v97, v99
    v_add_f32 v96, v96, v97
    v_cvt_pk_bf16_f32 v96, 0, v96
    s_lshl_b32 s46, s53, 1
    buffer_store_dword v96, v105, s[12:15], s46 offen sc1
L_m_sk_25:
    s_barrier
    s_add_u32 s53, s53, 128
    s_and_b32 s46, s53, 511
    s_cmp_lg_u32 s46, 0
    s_cbranch_scc1 L_m_loop_24
    s_lshl_b32 s54, s55, 7
    s_add_u32 s54, s54, 0x10e400
    s_mov_b32 s60, 0
    s_waitcnt vmcnt(0)
    s_cmp_lg_u32 s44, 0
    s_cbranch_scc1 L_sf_26
    v_mov_b32 v8, s60
    v_add_u32 v8, 1, v8
    v_mov_b32 v9, 0
    s_mov_b64 exec, 1
    buffer_store_dword v8, v9, s[12:15], s54 offen sc1
    s_mov_b64 exec, -1
L_sf_26:
    s_barrier
L_w_h_17_s:
    s_mov_b32 s77, s48
    s_cmp_eq_u32 s48, 14
    s_cselect_b32 s53, 2, 1
    s_sub_u32 s48, s48, 12
    s_min_u32 s48, s48, 2
    s_mov_b32 s79, 0
L_w_h_17_n:
    s_cmp_eq_u32 s53, 1
    s_cselect_b32 s74, 46, 54
    s_cselect_b32 s75, 64, 64
    s_mov_b32 s76, 65536
    s_branch L_w_g_10_e
L_w_h_17:
    s_mov_b32 s48, s77
    s_cmp_lt_u32 s48, 14
    s_cbranch_scc1 L_w_att_15
    s_and_b32 s42, s40, 3
    s_lshr_b32 s43, s40, 2
    s_cmp_eq_u32 s48, 14
    s_cbranch_scc1 L_w_c_16
    s_mov_b32 s75, 58
    s_mov_b32 s76, 0
    s_mov_b32 s78, 2
L_w_h_17_f:
    s_load_dwordx2 s[4:5], s[0:1], 112
    s_load_dwordx2 s[6:7], s[0:1], 88
    v_lshlrev_b32 v2, 4, v1
    v_lshlrev_b32 v3, 5, v1
    s_waitcnt lgkmcnt(0)
    s_mov_b32 s24, s4
    s_and_b32 s25, s5, 0xffff
    s_mov_b32 s26, 0x400000
    s_mov_b32 s27, 0x00020000
    s_mov_b32 s28, s6
    s_and_b32 s29, s7, 0xffff
    s_mov_b32 s30, 0x800
    s_mov_b32 s31, 0x00020000
    s_cmp_lg_u32 s44, 0
    s_cbranch_scc1 L_mw_27
    v_and_b32 v8, 15, v1
    v_lshlrev_b32 v8, 7, v8
    s_mov_b32 s46, 0x10e400
    s_mov_b32 s47, 0
    s_mov_b32 s70, 0
L_spin_28:
    buffer_load_dword v9, v8, s[12:15], s46 offen sc1
    s_waitcnt vmcnt(0)
    v_cmp_ge_u32 vcc, s47, v9
    s_add_u32 s70, s70, 1
    s_cbranch_vccz L_spok_29
    s_sleep 2
    s_cmp_lt_u32 s70, 524288
    s_cbranch_scc1 L_spin_28
    s_branch L_c_done_1
L_spok_29:
L_mw_27:
    s_barrier
    s_mov_b32 s46, 20480
    buffer_load_dwordx4 v[16:19], v3, s[12:15], s46 offen offset:0 sc1
    buffer_load_dwordx4 v[20:23], v3, s[12:15], s46 offen offset:16 sc1
    buffer_load_dwordx4 v[24:27], v3, s[12:15], s46 offen offset:2048 sc1
    buffer_load_dwordx4 v[28:31], v3, s[12:15], s46 offen offset:2064 sc1
    buffer_load_dwordx4 v[48:51], v2, s[28:31], 0 offen
    buffer_load_dwordx4 v[52:55], v2, s[28:31], 0 offen offset:1024
    s_waitcnt vmcnt(0)
    v_lshlrev_b32 v32, 16, v48
    v_and_b32 v33, 0xffff0000, v48
    v_lshlrev_b32 v34, 16, v49
    v_and_b32 v35, 0xffff0000, v49
    v_lshlrev_b32 v36, 16, v50
    v_and_b32 v37, 0xffff0000, v50
    v_lshlrev_b32 v38, 16, v51
    v_and_b32 v39, 0xffff0000, v51
    v_lshlrev_b32 v40, 16, v52
    v_and_b32 v41, 0xffff0000, v52
    v_lshlrev_b32 v42, 16, v53
    v_and_b32 v43, 0xffff0000, v53
    v_lshlrev_b32 v44, 16, v54
    v_and_b32 v45, 0xffff0000, v54
    v_lshlrev_b32 v46, 16, v55
    v_and_b32 v47, 0xffff0000, v55
    s_lshl_b32 s46, s42, 14
    s_lshl_b32 s47, s44, 11
    s_add_u32 s46, s46, s47
    s_add_u32 s46, s46, 0xb000000
    v_add_u32 v4, s46, v2
    v_and_b32 v5, 31, v1
    v_lshlrev_b32 v5, 7, v5
    v_add_u32 v5, 0x108400, v5
    v_lshlrev_b32 v6, 2, v1
    s_lshl_b32 s46, s44, 9
    v_add_u32 v6, s46, v6
    s_lshl_b32 s46, s44, 12
    v_add_u32 v7, s46, v3
    s_lshl_b32 s46, s42, 3
    s_add_u32 s46, s46, s44
    s_lshl_b32 s46, s46, 11
    v_add_u32 v8, s46, v2
    v_add_u32 v9, 0x800000, v8
    s_mov_b32 s60, s43
L_r_loop_30:
    s_lshl_b32 s61, s60, 18
    s_lshl_b32 s63, s60, 16
    s_cmp_lg_u32 s44, 0
    s_cbranch_scc1 L_r_nsp_31
    s_mov_b32 s70, 0
L_spin_32:
    buffer_load_dword v14, v5, s[12:15], s76 offen sc1
    s_waitcnt vmcnt(0)
    v_cmp_ge_u32 vcc, s60, v14
    s_add_u32 s70, s70, 1
    s_cbranch_vccz L_spok_33
    s_sleep 3
    s_cmp_lt_u32 s70, 524288
    s_cbranch_scc1 L_spin_32
    s_branch L_c_done_1
L_spok_33:
L_r_nsp_31:
    s_barrier
    buffer_load_dwordx4 v[96:99], v4, s[12:15], s61 offen offset:0 sc1
    buffer_load_dwordx4 v[100:103], v4, s[12:15], s61 offen offset:1024 sc1
    s_add_u32 s61, s61, 65536
    buffer_load_dwordx4 v[104:107], v4, s[12:15], s61 offen offset:0 sc1
    buffer_load_dwordx4 v[108:111], v4, s[12:15], s61 offen offset:1024 sc1
    s_add_u32 s61, s61, 65536
    buffer_load_dwordx4 v[112:115], v4, s[12:15], s61 offen offset:0 sc1
    buffer_load_dwordx4 v[116:119], v4, s[12:15], s61 offen offset:1024 sc1
    s_add_u32 s61, s61, 65536
    buffer_load_dwordx4 v[120:123], v4, s[12:15], s61 offen offset:0 sc1
    buffer_load_dwordx4 v[124:127], v4, s[12:15], s61 offen offset:1024 sc1
    buffer_load_dwordx4 a[0:3], v9, s[12:15], s63 offen sc1
    buffer_load_dwordx4 a[4:7], v9, s[12:15], s63 offen offset:1024 sc1
    s_waitcnt vmcnt(8)
    v_lshlrev_b32 v64, 16, v96
    v_and_b32 v65, 0xffff0000, v96
    v_lshlrev_b32 v66, 16, v97
    v_and_b32 v67, 0xffff0000, v97
    v_lshlrev_b32 v68, 16, v98
    v_and_b32 v69, 0xffff0000, v98
    v_lshlrev_b32 v70, 16, v99
    v_and_b32 v71, 0xffff0000, v99
    v_lshlrev_b32 v72, 16, v100
    v_and_b32 v73, 0xffff0000, v100
    v_lshlrev_b32 v74, 16, v101
    v_and_b32 v75, 0xffff0000, v101
    v_lshlrev_b32 v76, 16, v102
    v_and_b32 v77, 0xffff0000, v102
    v_lshlrev_b32 v78, 16, v103
    v_and_b32 v79, 0xffff0000, v103
    s_waitcnt vmcnt(6)
    v_lshlrev_b32 v80, 16, v104
    v_and_b32 v81, 0xffff0000, v104
    v_lshlrev_b32 v82, 16, v105
    v_and_b32 v83, 0xffff0000, v105
    v_lshlrev_b32 v84, 16, v106
    v_and_b32 v85, 0xffff0000, v106
    v_lshlrev_b32 v86, 16, v107
    v_and_b32 v87, 0xffff0000, v107
    v_lshlrev_b32 v88, 16, v108
    v_and_b32 v89, 0xffff0000, v108
    v_lshlrev_b32 v90, 16, v109
    v_and_b32 v91, 0xffff0000, v109
    v_lshlrev_b32 v92, 16, v110
    v_and_b32 v93, 0xffff0000, v110
    v_lshlrev_b32 v94, 16, v111
    v_and_b32 v95, 0xffff0000, v111
    v_pk_add_f32 v[64:65], v[64:65], v[80:81]
    v_pk_add_f32 v[66:67], v[66:67], v[82:83]
    v_pk_add_f32 v[68:69], v[68:69], v[84:85]
    v_pk_add_f32 v[70:71], v[70:71], v[86:87]
    v_pk_add_f32 v[72:73], v[72:73], v[88:89]
    v_pk_add_f32 v[74:75], v[74:75], v[90:91]
    v_pk_add_f32 v[76:77], v[76:77], v[92:93]
    v_pk_add_f32 v[78:79], v[78:79], v[94:95]
    s_waitcnt vmcnt(4)
    v_lshlrev_b32 v80, 16, v112
    v_and_b32 v81, 0xffff0000, v112
    v_lshlrev_b32 v82, 16, v113
    v_and_b32 v83, 0xffff0000, v113
    v_lshlrev_b32 v84, 16, v114
    v_and_b32 v85, 0xffff0000, v114
    v_lshlrev_b32 v86, 16, v115
    v_and_b32 v87, 0xffff0000, v115
    v_lshlrev_b32 v88, 16, v116
    v_and_b32 v89, 0xffff0000, v116
    v_lshlrev_b32 v90, 16, v117
    v_and_b32 v91, 0xffff0000, v117
    v_lshlrev_b32 v92, 16, v118
    v_and_b32 v93, 0xffff0000, v118
    v_lshlrev_b32 v94, 16, v119
    v_and_b32 v95, 0xffff0000, v119
    v_pk_add_f32 v[64:65], v[64:65], v[80:81]
    v_pk_add_f32 v[66:67], v[66:67], v[82:83]
    v_pk_add_f32 v[68:69], v[68:69], v[84:85]
    v_pk_add_f32 v[70:71], v[70:71], v[86:87]
    v_pk_add_f32 v[72:73], v[72:73], v[88:89]
    v_pk_add_f32 v[74:75], v[74:75], v[90:91]
    v_pk_add_f32 v[76:77], v[76:77], v[92:93]
    v_pk_add_f32 v[78:79], v[78:79], v[94:95]
    s_waitcnt vmcnt(2)
    v_lshlrev_b32 v80, 16, v120
    v_and_b32 v81, 0xffff0000, v120
    v_lshlrev_b32 v82, 16, v121
    v_and_b32 v83, 0xffff0000, v121
    v_lshlrev_b32 v84, 16, v122
    v_and_b32 v85, 0xffff0000, v122
    v_lshlrev_b32 v86, 16, v123
    v_and_b32 v87, 0xffff0000, v123
    v_lshlrev_b32 v88, 16, v124
    v_and_b32 v89, 0xffff0000, v124
    v_lshlrev_b32 v90, 16, v125
    v_and_b32 v91, 0xffff0000, v125
    v_lshlrev_b32 v92, 16, v126
    v_and_b32 v93, 0xffff0000, v126
    v_lshlrev_b32 v94, 16, v127
    v_and_b32 v95, 0xffff0000, v127
    v_pk_add_f32 v[64:65], v[64:65], v[80:81]
    v_pk_add_f32 v[66:67], v[66:67], v[82:83]
    v_pk_add_f32 v[68:69], v[68:69], v[84:85]
    v_pk_add_f32 v[70:71], v[70:71], v[86:87]
    v_pk_add_f32 v[72:73], v[72:73], v[88:89]
    v_pk_add_f32 v[74:75], v[74:75], v[90:91]
    v_pk_add_f32 v[76:77], v[76:77], v[92:93]
    v_pk_add_f32 v[78:79], v[78:79], v[94:95]
    ds_write_b32 v6, v64 offset:0
    ds_write_b32 v6, v65 offset:4096
    ds_write_b32 v6, v66 offset:8192
    ds_write_b32 v6, v67 offset:12288
    ds_write_b32 v6, v68 offset:16384
    ds_write_b32 v6, v69 offset:20480
    ds_write_b32 v6, v70 offset:24576
    ds_write_b32 v6, v71 offset:28672
    ds_write_b32 v6, v72 offset:256
    ds_write_b32 v6, v73 offset:4352
    ds_write_b32 v6, v74 offset:8448
    ds_write_b32 v6, v75 offset:12544
    ds_write_b32 v6, v76 offset:16640
    ds_write_b32 v6, v77 offset:20736
    ds_write_b32 v6, v78 offset:24832
    ds_write_b32 v6, v79 offset:28928
    s_waitcnt lgkmcnt(0)
    s_barrier
    ds_read_b128 v[64:67], v7
    ds_read_b128 v[68:71], v7 offset:16
    ds_read_b128 v[72:75], v7 offset:2048
    ds_read_b128 v[76:79], v7 offset:2064
    s_waitcnt vmcnt(0)
    v_accvgpr_read_b32 v96, a0
    v_accvgpr_read_b32 v97, a1
    v_accvgpr_read_b32 v98, a2
    v_accvgpr_read_b32 v99, a3
    v_accvgpr_read_b32 v100, a4
    v_accvgpr_read_b32 v101, a5
    v_accvgpr_read_b32 v102, a6
    v_accvgpr_read_b32 v103, a7
    v_lshlrev_b32 v80, 16, v96
    v_and_b32 v81, 0xffff0000, v96
    v_lshlrev_b32 v82, 16, v97
    v_and_b32 v83, 0xffff0000, v97
    v_lshlrev_b32 v84, 16, v98
    v_and_b32 v85, 0xffff0000, v98
    v_lshlrev_b32 v86, 16, v99
    v_and_b32 v87, 0xffff0000, v99
    v_lshlrev_b32 v88, 16, v100
    v_and_b32 v89, 0xffff0000, v100
    v_lshlrev_b32 v90, 16, v101
    v_and_b32 v91, 0xffff0000, v101
    v_lshlrev_b32 v92, 16, v102
    v_and_b32 v93, 0xffff0000, v102
    v_lshlrev_b32 v94, 16, v103
    v_and_b32 v95, 0xffff0000, v103
    s_waitcnt lgkmcnt(0)
    v_cvt_pk_bf16_f32 v64, 0, v64
    v_cvt_pk_bf16_f32 v65, 0, v65
    v_cvt_pk_bf16_f32 v66, 0, v66
    v_cvt_pk_bf16_f32 v67, 0, v67
    v_cvt_pk_bf16_f32 v68, 0, v68
    v_cvt_pk_bf16_f32 v69, 0, v69
    v_cvt_pk_bf16_f32 v70, 0, v70
    v_cvt_pk_bf16_f32 v71, 0, v71
    v_cvt_pk_bf16_f32 v72, 0, v72
    v_cvt_pk_bf16_f32 v73, 0, v73
    v_cvt_pk_bf16_f32 v74, 0, v74
    v_cvt_pk_bf16_f32 v75, 0, v75
    v_cvt_pk_bf16_f32 v76, 0, v76
    v_cvt_pk_bf16_f32 v77, 0, v77
    v_cvt_pk_bf16_f32 v78, 0, v78
    v_cvt_pk_bf16_f32 v79, 0, v79
    v_pk_add_f32 v[64:65], v[64:65], v[32:33]
    v_pk_add_f32 v[66:67], v[66:67], v[34:35]
    v_pk_add_f32 v[68:69], v[68:69], v[36:37]
    v_pk_add_f32 v[70:71], v[70:71], v[38:39]
    v_pk_add_f32 v[72:73], v[72:73], v[40:41]
    v_pk_add_f32 v[74:75], v[74:75], v[42:43]
    v_pk_add_f32 v[76:77], v[76:77], v[44:45]
    v_pk_add_f32 v[78:79], v[78:79], v[46:47]
    v_cvt_pk_bf16_f32 v64, 0, v64
    v_cvt_pk_bf16_f32 v65, 0, v65
    v_cvt_pk_bf16_f32 v66, 0, v66
    v_cvt_pk_bf16_f32 v67, 0, v67
    v_cvt_pk_bf16_f32 v68, 0, v68
    v_cvt_pk_bf16_f32 v69, 0, v69
    v_cvt_pk_bf16_f32 v70, 0, v70
    v_cvt_pk_bf16_f32 v71, 0, v71
    v_cvt_pk_bf16_f32 v72, 0, v72
    v_cvt_pk_bf16_f32 v73, 0, v73
    v_cvt_pk_bf16_f32 v74, 0, v74
    v_cvt_pk_bf16_f32 v75, 0, v75
    v_cvt_pk_bf16_f32 v76, 0, v76
    v_cvt_pk_bf16_f32 v77, 0, v77
    v_cvt_pk_bf16_f32 v78, 0, v78
    v_cvt_pk_bf16_f32 v79, 0, v79
    v_pk_mul_f32 v[64:65], v[64:65], v[16:17]
    v_pk_mul_f32 v[66:67], v[66:67], v[18:19]
    v_pk_mul_f32 v[68:69], v[68:69], v[20:21]
    v_pk_mul_f32 v[70:71], v[70:71], v[22:23]
    v_pk_mul_f32 v[72:73], v[72:73], v[24:25]
    v_pk_mul_f32 v[74:75], v[74:75], v[26:27]
    v_pk_mul_f32 v[76:77], v[76:77], v[28:29]
    v_pk_mul_f32 v[78:79], v[78:79], v[30:31]
    v_cvt_pk_bf16_f32 v64, 0, v64
    v_cvt_pk_bf16_f32 v65, 0, v65
    v_cvt_pk_bf16_f32 v66, 0, v66
    v_cvt_pk_bf16_f32 v67, 0, v67
    v_cvt_pk_bf16_f32 v68, 0, v68
    v_cvt_pk_bf16_f32 v69, 0, v69
    v_cvt_pk_bf16_f32 v70, 0, v70
    v_cvt_pk_bf16_f32 v71, 0, v71
    v_cvt_pk_bf16_f32 v72, 0, v72
    v_cvt_pk_bf16_f32 v73, 0, v73
    v_cvt_pk_bf16_f32 v74, 0, v74
    v_cvt_pk_bf16_f32 v75, 0, v75
    v_cvt_pk_bf16_f32 v76, 0, v76
    v_cvt_pk_bf16_f32 v77, 0, v77
    v_cvt_pk_bf16_f32 v78, 0, v78
    v_cvt_pk_bf16_f32 v79, 0, v79
    v_pk_add_f32 v[64:65], v[64:65], v[80:81]
    v_pk_add_f32 v[66:67], v[66:67], v[82:83]
    v_pk_add_f32 v[68:69], v[68:69], v[84:85]
    v_pk_add_f32 v[70:71], v[70:71], v[86:87]
    v_pk_add_f32 v[72:73], v[72:73], v[88:89]
    v_pk_add_f32 v[74:75], v[74:75], v[90:91]
    v_pk_add_f32 v[76:77], v[76:77], v[92:93]
    v_pk_add_f32 v[78:79], v[78:79], v[94:95]
    v_cvt_pk_bf16_f32 v96, v64, v65
    v_cvt_pk_bf16_f32 v97, v66, v67
    v_cvt_pk_bf16_f32 v98, v68, v69
    v_cvt_pk_bf16_f32 v99, v70, v71
    v_cvt_pk_bf16_f32 v100, v72, v73
    v_cvt_pk_bf16_f32 v101, v74, v75
    v_cvt_pk_bf16_f32 v102, v76, v77
    v_cvt_pk_bf16_f32 v103, v78, v79
    buffer_store_dwordx4 v[96:99], v8, s[24:27], s63 offen
    buffer_store_dwordx4 v[100:103], v8, s[24:27], s63 offen offset:1024
    s_add_u32 s60, s60, s78
    s_cmp_lt_u32 s60, s75
    s_cbranch_scc1 L_r_loop_30
    s_branch L_c_done_1
L_w_c_16:
    s_load_dwordx2 s[4:5], s[0:1], 0
    s_load_dwordx2 s[6:7], s[0:1], 88
    v_lshlrev_b32 v2, 4, v1
    v_lshlrev_b32 v3, 5, v1
    s_waitcnt lgkmcnt(0)
    s_mov_b32 s24, s4
    s_and_b32 s25, s5, 0xffff
    s_mov_b32 s26, 0x400000
    s_mov_b32 s27, 0x00020000
    s_mov_b32 s28, s6
    s_and_b32 s29, s7, 0xffff
    s_mov_b32 s30, 0x800
    s_mov_b32 s31, 0x00020000
    s_cmp_lg_u32 s44, 0
    s_cbranch_scc1 L_mw_34
    v_and_b32 v8, 15, v1
    v_lshlrev_b32 v8, 7, v8
    s_mov_b32 s46, 0x10e400
    s_mov_b32 s47, 0
    s_mov_b32 s70, 0
L_spin_35:
    buffer_load_dword v9, v8, s[12:15], s46 offen sc1
    s_waitcnt vmcnt(0)
    v_cmp_ge_u32 vcc, s47, v9
    s_add_u32 s70, s70, 1
    s_cbranch_vccz L_spok_36
    s_sleep 2
    s_cmp_lt_u32 s70, 524288
    s_cbranch_scc1 L_spin_35
    s_branch L_c_done_1
L_spok_36:
L_mw_34:
    s_barrier
    s_mov_b32 s46, 8192
    buffer_load_dwordx4 v[16:19], v3, s[12:15], s46 offen offset:0 sc1
    buffer_load_dwordx4 v[20:23], v3, s[12:15], s46 offen offset:16 sc1
    buffer_load_dwordx4 v[24:27], v3, s[12:15], s46 offen offset:2048 sc1
    buffer_load_dwordx4 v[28:31], v3, s[12:15], s46 offen offset:2064 sc1
    s_mov_b32 s46, 16384
    buffer_load_dwordx4 v[32:35], v3, s[12:15], s46 offen offset:0 sc1
    buffer_load_dwordx4 v[36:39], v3, s[12:15], s46 offen offset:16 sc1
    buffer_load_dwordx4 v[40:43], v3, s[12:15], s46 offen offset:2048 sc1
    buffer_load_dwordx4 v[44:47], v3, s[12:15], s46 offen offset:2064 sc1
    s_mov_b32 s46, 12288
    buffer_load_dwordx4 v[48:51], v3, s[12:15], s46 offen offset:0 sc1
    buffer_load_dwordx4 v[52:55], v3, s[12:15], s46 offen offset:16 sc1
    buffer_load_dwordx4 v[56:59], v3, s[12:15], s46 offen offset:2048 sc1
    buffer_load_dwordx4 v[60:63], v3, s[12:15], s46 offen offset:2064 sc1
    s_waitcnt vmcnt(0)
    v_add_f32 v32, 1.0, v32
    v_add_f32 v33, 1.0, v33
    v_add_f32 v34, 1.0, v34
    v_add_f32 v35, 1.0, v35
    v_add_f32 v36, 1.0, v36
    v_add_f32 v37, 1.0, v37
    v_add_f32 v38, 1.0, v38
    v_add_f32 v39, 1.0, v39
    v_add_f32 v40, 1.0, v40
    v_add_f32 v41, 1.0, v41
    v_add_f32 v42, 1.0, v42
    v_add_f32 v43, 1.0, v43
    v_add_f32 v44, 1.0, v44
    v_add_f32 v45, 1.0, v45
    v_add_f32 v46, 1.0, v46
    v_add_f32 v47, 1.0, v47
    v_cvt_pk_bf16_f32 v32, 0, v32
    v_cvt_pk_bf16_f32 v33, 0, v33
    v_cvt_pk_bf16_f32 v34, 0, v34
    v_cvt_pk_bf16_f32 v35, 0, v35
    v_cvt_pk_bf16_f32 v36, 0, v36
    v_cvt_pk_bf16_f32 v37, 0, v37
    v_cvt_pk_bf16_f32 v38, 0, v38
    v_cvt_pk_bf16_f32 v39, 0, v39
    v_cvt_pk_bf16_f32 v40, 0, v40
    v_cvt_pk_bf16_f32 v41, 0, v41
    v_cvt_pk_bf16_f32 v42, 0, v42
    v_cvt_pk_bf16_f32 v43, 0, v43
    v_cvt_pk_bf16_f32 v44, 0, v44
    v_cvt_pk_bf16_f32 v45, 0, v45
    v_cvt_pk_bf16_f32 v46, 0, v46
    v_cvt_pk_bf16_f32 v47, 0, v47
    s_lshl_b32 s46, s42, 14
    s_lshl_b32 s47, s44, 11
    s_add_u32 s46, s46, s47
    s_add_u32 s46, s46, 0x9000000
    v_add_u32 v4, s46, v2
    v_and_b32 v5, 31, v1
    v_lshlrev_b32 v5, 7, v5
    v_add_u32 v5, 0x107400, v5
    v_lshlrev_b32 v6, 2, v1
    s_lshl_b32 s46, s44, 9
    v_add_u32 v6, s46, v6
    s_lshl_b32 s46, s44, 12
    v_add_u32 v7, s46, v3
    s_lshl_b32 s46, s42, 3
    s_add_u32 s46, s46, s44
    s_lshl_b32 s46, s46, 11
    v_add_u32 v8, s46, v2
    v_add_u32 v9, 0x800000, v8
    s_mul_i32 s46, s44, 2064
    s_add_u32 s46, s46, 32768
    v_add_u32 v10, s46, v2
    v_and_b32 v11, 7, v1
    v_lshrrev_b32 v12, 3, v1
    v_mul_u32_u24 v13, 2064, v11
    v_lshl_add_u32 v13, v12, 4, v13
    s_lshl_b32 s46, s44, 8
    s_add_u32 s46, s46, 32768
    v_add_u32 v13, s46, v13
    v_lshlrev_b32 v11, 4, v11
    v_lshl_add_u32 v11, v12, 9, v11
    s_lshl_b32 s46, s44, 13
    s_lshl_b32 s47, s42, 7
    s_add_u32 s46, s46, s47
    s_add_u32 s46, s46, 0xc00000
    v_add_u32 v11, s46, v11
    v_add_u32 v12, 4096, v11
    s_lshl_b32 s52, s43, 9
    s_lshl_b32 s47, s42, 7
    s_add_u32 s52, s52, s47
    s_add_u32 s52, s52, 0x10ec00
    s_mov_b32 s60, s43
L_r_loop_37:
    s_lshl_b32 s61, s60, 18
    s_lshl_b32 s63, s60, 16
    buffer_load_dwordx4 a[0:3], v8, s[24:27], s63 offen
    buffer_load_dwordx4 a[4:7], v8, s[24:27], s63 offen offset:1024
    s_cmp_lg_u32 s44, 0
    s_cbranch_scc1 L_r_nsp_38
    s_mov_b32 s70, 0
L_spin_39:
    buffer_load_dword v14, v5, s[12:15], 0 offen sc1
    s_waitcnt vmcnt(0)
    v_cmp_ge_u32 vcc, s60, v14
    s_add_u32 s70, s70, 1
    s_cbranch_vccz L_spok_40
    s_sleep 3
    s_cmp_lt_u32 s70, 524288
    s_cbranch_scc1 L_spin_39
    s_branch L_c_done_1
L_spok_40:
L_r_nsp_38:
    s_barrier
    buffer_load_dwordx4 v[96:99], v4, s[12:15], s61 offen offset:0 sc1
    buffer_load_dwordx4 v[100:103], v4, s[12:15], s61 offen offset:1024 sc1
    s_add_u32 s61, s61, 65536
    buffer_load_dwordx4 v[104:107], v4, s[12:15], s61 offen offset:0 sc1
    buffer_load_dwordx4 v[108:111], v4, s[12:15], s61 offen offset:1024 sc1
    s_add_u32 s61, s61, 65536
    buffer_load_dwordx4 v[112:115], v4, s[12:15], s61 offen offset:0 sc1
    buffer_load_dwordx4 v[116:119], v4, s[12:15], s61 offen offset:1024 sc1
    s_add_u32 s61, s61, 65536
    buffer_load_dwordx4 v[120:123], v4, s[12:15], s61 offen offset:0 sc1
    buffer_load_dwordx4 v[124:127], v4, s[12:15], s61 offen offset:1024 sc1
    s_waitcnt vmcnt(6)
    v_lshlrev_b32 v64, 16, v96
    v_and_b32 v65, 0xffff0000, v96
    v_lshlrev_b32 v66, 16, v97
    v_and_b32 v67, 0xffff0000, v97
    v_lshlrev_b32 v68, 16, v98
    v_and_b32 v69, 0xffff0000, v98
    v_lshlrev_b32 v70, 16, v99
    v_and_b32 v71, 0xffff0000, v99
    v_lshlrev_b32 v72, 16, v100
    v_and_b32 v73, 0xffff0000, v100
    v_lshlrev_b32 v74, 16, v101
    v_and_b32 v75, 0xffff0000, v101
    v_lshlrev_b32 v76, 16, v102
    v_and_b32 v77, 0xffff0000, v102
    v_lshlrev_b32 v78, 16, v103
    v_and_b32 v79, 0xffff0000, v103
    s_waitcnt vmcnt(4)
    v_lshlrev_b32 v80, 16, v104
    v_and_b32 v81, 0xffff0000, v104
    v_lshlrev_b32 v82, 16, v105
    v_and_b32 v83, 0xffff0000, v105
    v_lshlrev_b32 v84, 16, v106
    v_and_b32 v85, 0xffff0000, v106
    v_lshlrev_b32 v86, 16, v107
    v_and_b32 v87, 0xffff0000, v107
    v_lshlrev_b32 v88, 16, v108
    v_and_b32 v89, 0xffff0000, v108
    v_lshlrev_b32 v90, 16, v109
    v_and_b32 v91, 0xffff0000, v109
    v_lshlrev_b32 v92, 16, v110
    v_and_b32 v93, 0xffff0000, v110
    v_lshlrev_b32 v94, 16, v111
    v_and_b32 v95, 0xffff0000, v111
    v_pk_add_f32 v[64:65], v[64:65], v[80:81]
    v_pk_add_f32 v[66:67], v[66:67], v[82:83]
    v_pk_add_f32 v[68:69], v[68:69], v[84:85]
    v_pk_add_f32 v[70:71], v[70:71], v[86:87]
    v_pk_add_f32 v[72:73], v[72:73], v[88:89]
    v_pk_add_f32 v[74:75], v[74:75], v[90:91]
    v_pk_add_f32 v[76:77], v[76:77], v[92:93]
    v_pk_add_f32 v[78:79], v[78:79], v[94:95]
    s_waitcnt vmcnt(2)
    v_lshlrev_b32 v80, 16, v112
    v_and_b32 v81, 0xffff0000, v112
    v_lshlrev_b32 v82, 16, v113
    v_and_b32 v83, 0xffff0000, v113
    v_lshlrev_b32 v84, 16, v114
    v_and_b32 v85, 0xffff0000, v114
    v_lshlrev_b32 v86, 16, v115
    v_and_b32 v87, 0xffff0000, v115
    v_lshlrev_b32 v88, 16, v116
    v_and_b32 v89, 0xffff0000, v116
    v_lshlrev_b32 v90, 16, v117
    v_and_b32 v91, 0xffff0000, v117
    v_lshlrev_b32 v92, 16, v118
    v_and_b32 v93, 0xffff0000, v118
    v_lshlrev_b32 v94, 16, v119
    v_and_b32 v95, 0xffff0000, v119
    v_pk_add_f32 v[64:65], v[64:65], v[80:81]
    v_pk_add_f32 v[66:67], v[66:67], v[82:83]
    v_pk_add_f32 v[68:69], v[68:69], v[84:85]
    v_pk_add_f32 v[70:71], v[70:71], v[86:87]
    v_pk_add_f32 v[72:73], v[72:73], v[88:89]
    v_pk_add_f32 v[74:75], v[74:75], v[90:91]
    v_pk_add_f32 v[76:77], v[76:77], v[92:93]
    v_pk_add_f32 v[78:79], v[78:79], v[94:95]
    s_waitcnt vmcnt(0)
    v_lshlrev_b32 v80, 16, v120
    v_and_b32 v81, 0xffff0000, v120
    v_lshlrev_b32 v82, 16, v121
    v_and_b32 v83, 0xffff0000, v121
    v_lshlrev_b32 v84, 16, v122
    v_and_b32 v85, 0xffff0000, v122
    v_lshlrev_b32 v86, 16, v123
    v_and_b32 v87, 0xffff0000, v123
    v_lshlrev_b32 v88, 16, v124
    v_and_b32 v89, 0xffff0000, v124
    v_lshlrev_b32 v90, 16, v125
    v_and_b32 v91, 0xffff0000, v125
    v_lshlrev_b32 v92, 16, v126
    v_and_b32 v93, 0xffff0000, v126
    v_lshlrev_b32 v94, 16, v127
    v_and_b32 v95, 0xffff0000, v127
    v_pk_add_f32 v[64:65], v[64:65], v[80:81]
    v_pk_add_f32 v[66:67], v[66:67], v[82:83]
    v_pk_add_f32 v[68:69], v[68:69], v[84:85]
    v_pk_add_f32 v[70:71], v[70:71], v[86:87]
    v_pk_add_f32 v[72:73], v[72:73], v[88:89]
    v_pk_add_f32 v[74:75], v[74:75], v[90:91]
    v_pk_add_f32 v[76:77], v[76:77], v[92:93]
    v_pk_add_f32 v[78:79], v[78:79], v[94:95]
    ds_write_b32 v6, v64 offset:0
    ds_write_b32 v6, v65 offset:4096
    ds_write_b32 v6, v66 offset:8192
    ds_write_b32 v6, v67 offset:12288
    ds_write_b32 v6, v68 offset:16384
    ds_write_b32 v6, v69 offset:20480
    ds_write_b32 v6, v70 offset:24576
    ds_write_b32 v6, v71 offset:28672
    ds_write_b32 v6, v72 offset:256
    ds_write_b32 v6, v73 offset:4352
    ds_write_b32 v6, v74 offset:8448
    ds_write_b32 v6, v75 offset:12544
    ds_write_b32 v6, v76 offset:16640
    ds_write_b32 v6, v77 offset:20736
    ds_write_b32 v6, v78 offset:24832
    ds_write_b32 v6, v79 offset:28928
    s_waitcnt lgkmcnt(0)
    s_barrier
    ds_read_b128 v[64:67], v7
    ds_read_b128 v[68:71], v7 offset:16
    ds_read_b128 v[72:75], v7 offset:2048
    ds_read_b128 v[76:79], v7 offset:2064
    s_waitcnt vmcnt(0)
    v_accvgpr_read_b32 v96, a0
    v_accvgpr_read_b32 v97, a1
    v_accvgpr_read_b32 v98, a2
    v_accvgpr_read_b32 v99, a3
    v_accvgpr_read_b32 v100, a4
    v_accvgpr_read_b32 v101, a5
    v_accvgpr_read_b32 v102, a6
    v_accvgpr_read_b32 v103, a7
    v_lshlrev_b32 v80, 16, v96
    v_and_b32 v81, 0xffff0000, v96
    v_lshlrev_b32 v82, 16, v97
    v_and_b32 v83, 0xffff0000, v97
    v_lshlrev_b32 v84, 16, v98
    v_and_b32 v85, 0xffff0000, v98
    v_lshlrev_b32 v86, 16, v99
    v_and_b32 v87, 0xffff0000, v99
    v_lshlrev_b32 v88, 16, v100
    v_and_b32 v89, 0xffff0000, v100
    v_lshlrev_b32 v90, 16, v101
    v_and_b32 v91, 0xffff0000, v101
    v_lshlrev_b32 v92, 16, v102
    v_and_b32 v93, 0xffff0000, v102
    v_lshlrev_b32 v94, 16, v103
    v_and_b32 v95, 0xffff0000, v103
    s_waitcnt lgkmcnt(0)
    v_cvt_pk_bf16_f32 v64, 0, v64
    v_cvt_pk_bf16_f32 v65, 0, v65
    v_cvt_pk_bf16_f32 v66, 0, v66
    v_cvt_pk_bf16_f32 v67, 0, v67
    v_cvt_pk_bf16_f32 v68, 0, v68
    v_cvt_pk_bf16_f32 v69, 0, v69
    v_cvt_pk_bf16_f32 v70, 0, v70
    v_cvt_pk_bf16_f32 v71, 0, v71
    v_cvt_pk_bf16_f32 v72, 0, v72
    v_cvt_pk_bf16_f32 v73, 0, v73
    v_cvt_pk_bf16_f32 v74, 0, v74
    v_cvt_pk_bf16_f32 v75, 0, v75
    v_cvt_pk_bf16_f32 v76, 0, v76
    v_cvt_pk_bf16_f32 v77, 0, v77
    v_cvt_pk_bf16_f32 v78, 0, v78
    v_cvt_pk_bf16_f32 v79, 0, v79
    v_pk_mul_f32 v[64:65], v[64:65], v[16:17]
    v_pk_mul_f32 v[66:67], v[66:67], v[18:19]
    v_pk_mul_f32 v[68:69], v[68:69], v[20:21]
    v_pk_mul_f32 v[70:71], v[70:71], v[22:23]
    v_pk_mul_f32 v[72:73], v[72:73], v[24:25]
    v_pk_mul_f32 v[74:75], v[74:75], v[26:27]
    v_pk_mul_f32 v[76:77], v[76:77], v[28:29]
    v_pk_mul_f32 v[78:79], v[78:79], v[30:31]
    v_cvt_pk_bf16_f32 v64, 0, v64
    v_cvt_pk_bf16_f32 v65, 0, v65
    v_cvt_pk_bf16_f32 v66, 0, v66
    v_cvt_pk_bf16_f32 v67, 0, v67
    v_cvt_pk_bf16_f32 v68, 0, v68
    v_cvt_pk_bf16_f32 v69, 0, v69
    v_cvt_pk_bf16_f32 v70, 0, v70
    v_cvt_pk_bf16_f32 v71, 0, v71
    v_cvt_pk_bf16_f32 v72, 0, v72
    v_cvt_pk_bf16_f32 v73, 0, v73
    v_cvt_pk_bf16_f32 v74, 0, v74
    v_cvt_pk_bf16_f32 v75, 0, v75
    v_cvt_pk_bf16_f32 v76, 0, v76
    v_cvt_pk_bf16_f32 v77, 0, v77
    v_cvt_pk_bf16_f32 v78, 0, v78
    v_cvt_pk_bf16_f32 v79, 0, v79
    v_pk_add_f32 v[64:65], v[64:65], v[80:81]
    v_pk_add_f32 v[66:67], v[66:67], v[82:83]
    v_pk_add_f32 v[68:69], v[68:69], v[84:85]
    v_pk_add_f32 v[70:71], v[70:71], v[86:87]
    v_pk_add_f32 v[72:73], v[72:73], v[88:89]
    v_pk_add_f32 v[74:75], v[74:75], v[90:91]
    v_pk_add_f32 v[76:77], v[76:77], v[92:93]
    v_pk_add_f32 v[78:79], v[78:79], v[94:95]
    v_cvt_pk_bf16_f32 v96, v64, v65
    v_cvt_pk_bf16_f32 v97, v66, v67
    v_cvt_pk_bf16_f32 v98, v68, v69
    v_cvt_pk_bf16_f32 v99, v70, v71
    v_cvt_pk_bf16_f32 v100, v72, v73
    v_cvt_pk_bf16_f32 v101, v74, v75
    v_cvt_pk_bf16_f32 v102, v76, v77
    v_cvt_pk_bf16_f32 v103, v78, v79
    buffer_store_dwordx4 v[96:99], v9, s[12:15], s63 offen sc1
    buffer_store_dwordx4 v[100:103], v9, s[12:15], s63 offen offset:1024 sc1
    v_lshlrev_b32 v64, 16, v96
    v_and_b32 v65, 0xffff0000, v96
    v_lshlrev_b32 v66, 16, v97
    v_and_b32 v67, 0xffff0000, v97
    v_lshlrev_b32 v68, 16, v98
    v_and_b32 v69, 0xffff0000, v98
    v_lshlrev_b32 v70, 16, v99
    v_and_b32 v71, 0xffff0000, v99
    v_lshlrev_b32 v72, 16, v100
    v_and_b32 v73, 0xffff0000, v100
    v_lshlrev_b32 v74, 16, v101
    v_and_b32 v75, 0xffff0000, v101
    v_lshlrev_b32 v76, 16, v102
    v_and_b32 v77, 0xffff0000, v102
    v_lshlrev_b32 v78, 16, v103
    v_and_b32 v79, 0xffff0000, v103
    v_pk_add_f32 v[80:81], v[64:65], v[72:73]
    v_pk_add_f32 v[82:83], v[66:67], v[74:75]
    v_pk_add_f32 v[84:85], v[68:69], v[76:77]
    v_pk_add_f32 v[86:87], v[70:71], v[78:79]
    v_pk_add_f32 v[80:81], v[80:81], v[84:85]
    v_pk_add_f32 v[82:83], v[82:83], v[86:87]
    v_pk_add_f32 v[80:81], v[80:81], v[82:83]
    v_add_f32 v14, v80, v81
    s_nop 1
    v_add_f32_dpp v14, v14, v14 row_shr:1 row_mask:0xf bank_mask:0xf bound_ctrl:0
    s_nop 1
    v_add_f32_dpp v14, v14, v14 row_shr:2 row_mask:0xf bank_mask:0xf bound_ctrl:0
    s_nop 1
    v_add_f32_dpp v14, v14, v14 row_shr:4 row_mask:0xf bank_mask:0xf bound_ctrl:0
    s_nop 1
    v_add_f32_dpp v14, v14, v14 row_shr:8 row_mask:0xf bank_mask:0xf bound_ctrl:0
    s_nop 1
    v_add_f32_dpp v14, v14, v14 row_bcast:15 row_mask:0xa bank_mask:0xf
    s_nop 1
    v_add_f32_dpp v14, v14, v14 row_bcast:31 row_mask:0xc bank_mask:0xf
    s_nop 1
    v_readlane_b32 s46, v14, 63
    s_nop 1
    v_mov_b32 v15, s46
    v_mul_f32 v15, 0x3a800000, v15
    v_pk_add_f32 v[80:81], v[64:65], v[14:15] op_sel:[0,1] op_sel_hi:[1,1] neg_lo:[0,1] neg_hi:[0,1]
    v_pk_add_f32 v[82:83], v[66:67], v[14:15] op_sel:[0,1] op_sel_hi:[1,1] neg_lo:[0,1] neg_hi:[0,1]
    v_pk_add_f32 v[84:85], v[68:69], v[14:15] op_sel:[0,1] op_sel_hi:[1,1] neg_lo:[0,1] neg_hi:[0,1]
    v_pk_add_f32 v[86:87], v[70:71], v[14:15] op_sel:[0,1] op_sel_hi:[1,1] neg_lo:[0,1] neg_hi:[0,1]
    v_pk_add_f32 v[88:89], v[72:73], v[14:15] op_sel:[0,1] op_sel_hi:[1,1] neg_lo:[0,1] neg_hi:[0,1]
    v_pk_add_f32 v[90:91], v[74:75], v[14:15] op_sel:[0,1] op_sel_hi:[1,1] neg_lo:[0,1] neg_hi:[0,1]
    v_pk_add_f32 v[92:93], v[76:77], v[14:15] op_sel:[0,1] op_sel_hi:[1,1] neg_lo:[0,1] neg_hi:[0,1]
    v_pk_add_f32 v[94:95], v[78:79], v[14:15] op_sel:[0,1] op_sel_hi:[1,1] neg_lo:[0,1] neg_hi:[0,1]
    v_pk_mul_f32 v[104:105], v[80:81], v[80:81]
    v_pk_mul_f32 v[106:107], v[82:83], v[82:83]
    v_pk_fma_f32 v[104:105], v[84:85], v[84:85], v[104:105]
    v_pk_fma_f32 v[106:107], v[86:87], v[86:87], v[106:107]
    v_pk_fma_f32 v[104:105], v[88:89], v[88:89], v[104:105]
    v_pk_fma_f32 v[106:107], v[90:91], v[90:91], v[106:107]
    v_pk_fma_f32 v[104:105], v[92:93], v[92:93], v[104:105]
    v_pk_fma_f32 v[106:107], v[94:95], v[94:95], v[106:107]
    v_pk_add_f32 v[104:105], v[104:105], v[106:107]
    v_add_f32 v14, v104, v105
    v_cvt_pk_bf16_f32 v15, 0, v15
    s_nop 1
    v_add_f32_dpp v14, v14, v14 row_shr:1 row_mask:0xf bank_mask:0xf bound_ctrl:0
    s_nop 1
    v_add_f32_dpp v14, v14, v14 row_shr:2 row_mask:0xf bank_mask:0xf bound_ctrl:0
    s_nop 1
    v_add_f32_dpp v14, v14, v14 row_shr:4 row_mask:0xf bank_mask:0xf bound_ctrl:0
    s_nop 1
    v_add_f32_dpp v14, v14, v14 row_shr:8 row_mask:0xf bank_mask:0xf bound_ctrl:0
    s_nop 1
    v_add_f32_dpp v14, v14, v14 row_bcast:15 row_mask:0xa bank_mask:0xf
    s_nop 1
    v_add_f32_dpp v14, v14, v14 row_bcast:31 row_mask:0xc bank_mask:0xf
    s_nop 1
    v_readlane_b32 s47, v14, 63
    v_pk_add_f32 v[64:65], v[64:65], v[14:15] op_sel:[0,1] op_sel_hi:[1,1] neg_lo:[0,1] neg_hi:[0,1]
    v_pk_add_f32 v[66:67], v[66:67], v[14:15] op_sel:[0,1] op_sel_hi:[1,1] neg_lo:[0,1] neg_hi:[0,1]
    v_pk_add_f32 v[68:69], v[68:69], v[14:15] op_sel:[0,1] op_sel_hi:[1,1] neg_lo:[0,1] neg_hi:[0,1]
    v_pk_add_f32 v[70:71], v[70:71], v[14:15] op_sel:[0,1] op_sel_hi:[1,1] neg_lo:[0,1] neg_hi:[0,1]
    v_pk_add_f32 v[72:73], v[72:73], v[14:15] op_sel:[0,1] op_sel_hi:[1,1] neg_lo:[0,1] neg_hi:[0,1]
    v_pk_add_f32 v[74:75], v[74:75], v[14:15] op_sel:[0,1] op_sel_hi:[1,1] neg_lo:[0,1] neg_hi:[0,1]
    v_pk_add_f32 v[76:77], v[76:77], v[14:15] op_sel:[0,1] op_sel_hi:[1,1] neg_lo:[0,1] neg_hi:[0,1]
    v_pk_add_f32 v[78:79], v[78:79], v[14:15] op_sel:[0,1] op_sel_hi:[1,1] neg_lo:[0,1] neg_hi:[0,1]
    v_mov_b32 v14, s47
    v_mul_f32 v14, 0x3a800000, v14
    v_cvt_pk_bf16_f32 v14, 0, v14
    v_add_f32 v14, 0x3727c5ac, v14
    v_cvt_pk_bf16_f32 v14, 0, v14
    v_sqrt_f32 v14, v14
    s_nop 0
    v_cvt_pk_bf16_f32 v14, 0, v14
    v_rcp_f32 v14, v14
    v_cvt_pk_bf16_f32 v64, 0, v64
    v_cvt_pk_bf16_f32 v65, 0, v65
    v_cvt_pk_bf16_f32 v66, 0, v66
    v_cvt_pk_bf16_f32 v67, 0, v67
    v_cvt_pk_bf16_f32 v68, 0, v68
    v_cvt_pk_bf16_f32 v69, 0, v69
    v_cvt_pk_bf16_f32 v70, 0, v70
    v_cvt_pk_bf16_f32 v71, 0, v71
    v_cvt_pk_bf16_f32 v72, 0, v72
    v_cvt_pk_bf16_f32 v73, 0, v73
    v_cvt_pk_bf16_f32 v74, 0, v74
    v_cvt_pk_bf16_f32 v75, 0, v75
    v_cvt_pk_bf16_f32 v76, 0, v76
    v_cvt_pk_bf16_f32 v77, 0, v77
    v_cvt_pk_bf16_f32 v78, 0, v78
    v_cvt_pk_bf16_f32 v79, 0, v79
    v_pk_mul_f32 v[64:65], v[64:65], v[14:15] op_sel_hi:[1,0]
    v_pk_mul_f32 v[66:67], v[66:67], v[14:15] op_sel_hi:[1,0]
    v_pk_mul_f32 v[68:69], v[68:69], v[14:15] op_sel_hi:[1,0]
    v_pk_mul_f32 v[70:71], v[70:71], v[14:15] op_sel_hi:[1,0]
    v_pk_mul_f32 v[72:73], v[72:73], v[14:15] op_sel_hi:[1,0]
    v_pk_mul_f32 v[74:75], v[74:75], v[14:15] op_sel_hi:[1,0]
    v_pk_mul_f32 v[76:77], v[76:77], v[14:15] op_sel_hi:[1,0]
    v_pk_mul_f32 v[78:79], v[78:79], v[14:15] op_sel_hi:[1,0]
    v_cvt_pk_bf16_f32 v64, 0, v64
    v_cvt_pk_bf16_f32 v65, 0, v65
    v_cvt_pk_bf16_f32 v66, 0, v66
    v_cvt_pk_bf16_f32 v67, 0, v67
    v_cvt_pk_bf16_f32 v68, 0, v68
    v_cvt_pk_bf16_f32 v69, 0, v69
    v_cvt_pk_bf16_f32 v70, 0, v70
    v_cvt_pk_bf16_f32 v71, 0, v71
    v_cvt_pk_bf16_f32 v72, 0, v72
    v_cvt_pk_bf16_f32 v73, 0, v73
    v_cvt_pk_bf16_f32 v74, 0, v74
    v_cvt_pk_bf16_f32 v75, 0, v75
    v_cvt_pk_bf16_f32 v76, 0, v76
    v_cvt_pk_bf16_f32 v77, 0, v77
    v_cvt_pk_bf16_f32 v78, 0, v78
    v_cvt_pk_bf16_f32 v79, 0, v79
    v_pk_mul_f32 v[64:65], v[64:65], v[32:33]
    v_pk_mul_f32 v[66:67], v[66:67], v[34:35]
    v_pk_mul_f32 v[68:69], v[68:69], v[36:37]
    v_pk_mul_f32 v[70:71], v[70:71], v[38:39]
    v_pk_mul_f32 v[72:73], v[72:73], v[40:41]
    v_pk_mul_f32 v[74:75], v[74:75], v[42:43]
    v_pk_mul_f32 v[76:77], v[76:77], v[44:45]
    v_pk_mul_f32 v[78:79], v[78:79], v[46:47]
    v_cvt_pk_bf16_f32 v64, 0, v64
    v_cvt_pk_bf16_f32 v65, 0, v65
    v_cvt_pk_bf16_f32 v66, 0, v66
    v_cvt_pk_bf16_f32 v67, 0, v67
    v_cvt_pk_bf16_f32 v68, 0, v68
    v_cvt_pk_bf16_f32 v69, 0, v69
    v_cvt_pk_bf16_f32 v70, 0, v70
    v_cvt_pk_bf16_f32 v71, 0, v71
    v_cvt_pk_bf16_f32 v72, 0, v72
    v_cvt_pk_bf16_f32 v73, 0, v73
    v_cvt_pk_bf16_f32 v74, 0, v74
    v_cvt_pk_bf16_f32 v75, 0, v75
    v_cvt_pk_bf16_f32 v76, 0, v76
    v_cvt_pk_bf16_f32 v77, 0, v77
    v_cvt_pk_bf16_f32 v78, 0, v78
    v_cvt_pk_bf16_f32 v79, 0, v79
    v_pk_add_f32 v[64:65], v[64:65], v[48:49]
    v_pk_add_f32 v[66:67], v[66:67], v[50:51]
    v_pk_add_f32 v[68:69], v[68:69], v[52:53]
    v_pk_add_f32 v[70:71], v[70:71], v[54:55]
    v_pk_add_f32 v[72:73], v[72:73], v[56:57]
    v_pk_add_f32 v[74:75], v[74:75], v[58:59]
    v_pk_add_f32 v[76:77], v[76:77], v[60:61]
    v_pk_add_f32 v[78:79], v[78:79], v[62:63]
    v_cvt_pk_bf16_f32 v104, v64, v65
    v_cvt_pk_bf16_f32 v105, v66, v67
    v_cvt_pk_bf16_f32 v106, v68, v69
    v_cvt_pk_bf16_f32 v107, v70, v71
    v_cvt_pk_bf16_f32 v108, v72, v73
    v_cvt_pk_bf16_f32 v109, v74, v75
    v_cvt_pk_bf16_f32 v110, v76, v77
    v_cvt_pk_bf16_f32 v111, v78, v79
    ds_write_b128 v10, v[104:107]
    ds_write_b128 v10, v[108:111] offset:1024
    s_waitcnt lgkmcnt(0)
    s_barrier
    ds_read_b128 v[104:107], v13
    ds_read_b128 v[108:111], v13 offset:128
    s_waitcnt lgkmcnt(1)
    buffer_store_dwordx4 v[104:107], v11, s[12:15], s63 offen sc1
    s_waitcnt lgkmcnt(0)
    buffer_store_dwordx4 v[108:111], v12, s[12:15], s63 offen sc1
    s_waitcnt vmcnt(0)
    s_barrier
    s_cmp_lg_u32 s44, 0
    s_cbranch_scc1 L_sf_41
    v_mov_b32 v14, s60
    v_add_u32 v14, 1, v14
    v_mov_b32 v15, 0
    s_mov_b64 exec, 1
    buffer_store_dword v14, v15, s[12:15], s52 offen sc1
    s_mov_b64 exec, -1
L_sf_41:
    s_add_u32 s60, s60, 3
    s_cmp_lt_u32 s60, 64
    s_cbranch_scc1 L_r_loop_37
    s_branch L_c_done_1
L_w_att_15:
    s_lshl_b32 s42, s40, 2
    s_and_b32 s46, s44, 3
    s_add_u32 s42, s42, s46
    s_and_b32 s43, s48, 1
    s_lshl_b32 s43, s43, 1
    s_lshr_b32 s46, s44, 2
    s_add_u32 s43, s43, s46
    s_mul_i32 s46, s42, 24576
    s_add_u32 s46, s46, 0x2000000
    v_lshlrev_b32 v2, 4, v1
    v_add_u32 v3, s46, v2
    v_add_u32 v5, 4096, v3
    v_lshrrev_b32 v4, 4, v1
    v_and_b32 v9, 15, v1
    s_lshl_b32 s46, s42, 12
    s_add_u32 s46, s46, 0x1000000
    v_and_b32 v6, 7, v1
    v_lshlrev_b32 v6, 4, v6
    v_lshl_add_u32 v6, v4, 7, v6
    v_add_u32 v6, s46, v6
    v_and_b32 v7, 31, v1
    v_lshlrev_b32 v7, 4, v7
    v_lshrrev_b32 v10, 5, v1
    v_lshl_add_u32 v7, v10, 10, v7
    v_add_u32 v7, s46, v7
    s_mul_i32 s50, s44, 13056
    v_mul_u32_u24 v8, 272, v9
    v_lshl_add_u32 v8, v4, 4, v8
    v_add_u32 v8, s50, v8
    v_bfe_u32 v11, v1, 2, 3
    v_mul_u32_u24 v11, 272, v11
    v_lshl_add_u32 v11, v10, 6, v11
    v_and_b32 v12, 3, v1
    v_lshl_add_u32 v11, v12, 4, v11
    v_add_u32 v11, s50, v11
    v_mul_u32_u24 v14, 272, v4
    v_lshl_add_u32 v14, v9, 4, v14
    v_add_u32 v14, s50, v14
    v_mov_b32 v16, 0
    v_mov_b32 v17, 0
    v_mov_b32 v18, 0
    v_mov_b32 v19, 0
    ds_write_b128 v14, v[16:19] offset:10880
    ds_write_b128 v14, v[16:19] offset:11968
    v_lshlrev_b32 v12, 2, v4
    v_bfe_u32 v13, v1, 2, 2
    v_add_u32 v12, v12, v13
    v_mul_u32_u24 v12, 272, v12
    v_and_b32 v13, 3, v1
    v_lshl_add_u32 v12, v13, 3, v12
    v_add_u32 v12, s50, v12
    v_lshlrev_b32 v13, 10, v13
    s_lshl_b32 s46, s42, 12
    s_add_u32 s46, s46, 0x1000000
    v_add_u32 v13, s46, v13
    v_lshlrev_b32 v10, 9, v4
    v_lshl_add_u32 v10, v9, 4, v10
    s_lshl_b32 s46, s42, 13
    s_add_u32 s46, s46, 0x5000000
    v_add_u32 v10, s46, v10
    s_lshl_b32 s52, s42, 9
    s_lshl_b32 s47, s43, 7
    s_add_u32 s52, s52, s47
    s_add_u32 s52, s52, 0x102000
    v_min_u32 v42, 2, v1
    v_lshlrev_b32 v42, 9, v42
    s_lshl_b32 s46, s40, 11
    s_and_b32 s47, s42, 3
    s_lshl_b32 s47, s47, 7
    s_add_u32 s46, s46, s47
    s_add_u32 s46, s46, 0x10a400
    v_add_u32 v48, s46, v42
    s_mul_i32 s46, s42, 24576
    s_add_u32 s46, s46, 0x2000000
    v_lshlrev_b32 v49, 7, v1
    v_add_u32 v49, s46, v49
    v_cmp_le_u32 s[56:57], 32, v1
    v_lshlrev_b32 v14, 2, v4
    s_mov_b32 s54, 0x3e0293ee
    s_mov_b32 s60, s43
    v_add_u32 v15, 0, v14
    v_cmp_gt_u32 s[84:85], v15, v9
    v_add_u32 v15, 1, v14
    v_cmp_gt_u32 s[86:87], v15, v9
    v_add_u32 v15, 2, v14
    v_cmp_gt_u32 s[88:89], v15, v9
    v_add_u32 v15, 3, v14
    v_cmp_gt_u32 s[90:91], v15, v9
L_a_loop_42:
    s_mul_i32 s45, s60, 786432
    s_add_u32 s48, s45, 8192
    s_add_u32 s49, s45, 16384
    s_lshl_b32 s61, s60, 17
    s_lshl_b32 s63, s60, 18
    s_mov_b32 s70, 0
L_spin_43:
    buffer_load_dword v40, v48, s[12:15], 0 offen sc1
    s_waitcnt vmcnt(0)
    v_cmp_ge_u32 vcc, s60, v40
    s_add_u32 s70, s70, 1
    s_cbranch_vccz L_spok_44
    s_sleep 3
    s_cmp_lt_u32 s70, 524288
    s_cbranch_scc1 L_spin_43
    s_branch L_c_done_1
L_spok_44:
    buffer_load_dwordx4 a[0:3], v3, s[12:15], s45 offen offset:0 sc1
    buffer_load_dwordx4 a[4:7], v3, s[12:15], s45 offen offset:1024 sc1
    buffer_load_dwordx4 a[8:11], v3, s[12:15], s45 offen offset:2048 sc1
    buffer_load_dwordx4 a[12:15], v3, s[12:15], s45 offen offset:3072 sc1
    buffer_load_dwordx4 a[16:19], v5, s[12:15], s45 offen offset:0 sc1
    buffer_load_dwordx4 a[20:23], v5, s[12:15], s45 offen offset:1024 sc1
    buffer_load_dwordx4 a[24:27], v5, s[12:15], s45 offen offset:2048 sc1
    buffer_load_dwordx4 a[28:31], v5, s[12:15], s45 offen offset:3072 sc1
    buffer_load_dwordx4 a[32:35], v3, s[12:15], s48 offen offset:0 sc1
    buffer_load_dwordx4 a[36:39], v3, s[12:15], s48 offen offset:1024 sc1
    buffer_load_dwordx4 a[40:43], v3, s[12:15], s48 offen offset:2048 sc1
    buffer_load_dwordx4 a[44:47], v3, s[12:15], s48 offen offset:3072 sc1
    buffer_load_dwordx4 a[48:51], v5, s[12:15], s48 offen offset:0 sc1
    buffer_load_dwordx4 a[52:55], v5, s[12:15], s48 offen offset:1024 sc1
    buffer_load_dwordx4 a[56:59], v5, s[12:15], s48 offen offset:2048 sc1
    buffer_load_dwordx4 a[60:63], v5, s[12:15], s48 offen offset:3072 sc1
    buffer_load_dwordx4 v[16:19], v3, s[12:15], s49 offen offset:0 sc1
    buffer_load_dwordx4 v[20:23], v3, s[12:15], s49 offen offset:1024 sc1
    buffer_load_dwordx4 v[24:27], v3, s[12:15], s49 offen offset:2048 sc1
    buffer_load_dwordx4 v[28:31], v3, s[12:15], s49 offen offset:3072 sc1
    buffer_load_dwordx4 v[32:35], v5, s[12:15], s49 offen offset:0 sc1
    buffer_load_dwordx4 v[36:39], v5, s[12:15], s49 offen offset:1024 sc1
    buffer_load_dwordx4 v[40:43], v5, s[12:15], s49 offen offset:2048 sc1
    buffer_load_dwordx4 v[44:47], v5, s[12:15], s49 offen offset:3072 sc1
    s_waitcnt vmcnt(0)
    ds_write_b128 v8, v[16:19] offset:0
    ds_write_b128 v8, v[20:23] offset:64
    ds_write_b128 v8, v[24:27] offset:128
    ds_write_b128 v8, v[28:31] offset:192
    ds_write_b128 v8, v[32:35] offset:4352
    ds_write_b128 v8, v[36:39] offset:4416
    ds_write_b128 v8, v[40:43] offset:4480
    ds_write_b128 v8, v[44:47] offset:4544
    v_mfma_f32_16x16x32_bf16 v[56:59], a[32:35], a[0:3], 0
    v_mfma_f32_16x16x32_bf16 v[60:63], a[32:35], a[16:19], 0
    v_mfma_f32_16x16x32_bf16 v[68:71], a[48:51], a[16:19], 0
    v_mfma_f32_16x16x32_bf16 v[56:59], a[36:39], a[4:7], v[56:59]
    v_mfma_f32_16x16x32_bf16 v[60:63], a[36:39], a[20:23], v[60:63]
    v_mfma_f32_16x16x32_bf16 v[68:71], a[52:55], a[20:23], v[68:71]
    v_mfma_f32_16x16x32_bf16 v[56:59], a[40:43], a[8:11], v[56:59]
    v_mfma_f32_16x16x32_bf16 v[60:63], a[40:43], a[24:27], v[60:63]
    v_mfma_f32_16x16x32_bf16 v[68:71], a[56:59], a[24:27], v[68:71]
    v_mfma_f32_16x16x32_bf16 v[56:59], a[44:47], a[12:15], v[56:59]
    v_mfma_f32_16x16x32_bf16 v[60:63], a[44:47], a[28:31], v[60:63]
    v_mfma_f32_16x16x32_bf16 v[68:71], a[60:63], a[28:31], v[68:71]
    s_waitcnt lgkmcnt(0)
    ds_read_b64_tr_b16 a[80:81], v12 offset:0
    ds_read_b64_tr_b16 a[82:83], v12 offset:4352
    ds_read_b64_tr_b16 a[86:87], v12 offset:32
    ds_read_b64_tr_b16 a[88:89], v12 offset:4384
    ds_read_b64_tr_b16 a[92:93], v12 offset:64
    ds_read_b64_tr_b16 a[94:95], v12 offset:4416
    ds_read_b64_tr_b16 a[98:99], v12 offset:96
    ds_read_b64_tr_b16 a[100:101], v12 offset:4448
    s_waitcnt lgkmcnt(0)
    ds_read_b64_tr_b16 a[104:105], v12 offset:128
    ds_read_b64_tr_b16 a[106:107], v12 offset:4480
    ds_read_b64_tr_b16 a[110:111], v12 offset:160
    ds_read_b64_tr_b16 a[112:113], v12 offset:4512
    ds_read_b64_tr_b16 a[116:117], v12 offset:192
    ds_read_b64_tr_b16 a[118:119], v12 offset:4544
    ds_read_b64_tr_b16 a[122:123], v12 offset:224
    ds_read_b64_tr_b16 a[124:125], v12 offset:4576
    v_mov_b32 v15, 0xff800000
    v_cndmask_b32 v56, v56, v15, s[84:85]
    v_cndmask_b32 v68, v68, v15, s[84:85]
    v_cndmask_b32 v57, v57, v15, s[86:87]
    v_cndmask_b32 v69, v69, v15, s[86:87]
    v_cndmask_b32 v58, v58, v15, s[88:89]
    v_cndmask_b32 v70, v70, v15, s[88:89]
    v_cndmask_b32 v59, v59, v15, s[90:91]
    v_cndmask_b32 v71, v71, v15, s[90:91]
    s_mov_b32 s70, 0
L_a_cp_45:
    buffer_load_dword v40, v13, s[12:15], s61 offen sc1
    s_waitcnt vmcnt(0)
    v_cmp_eq_u32 vcc, -1, v40
    s_add_u32 s70, s70, 1
    s_cbranch_vccz L_a_fl_46
L_a_cp_45_s:
    s_sleep 4
    s_cmp_lt_u32 s70, 524288
    s_cbranch_scc1 L_a_cp_45
    s_branch L_c_done_1
L_a_fl_46:
    buffer_load_dwordx4 v[24:27], v6, s[12:15], s61 offen offset:0 sc1
    buffer_load_dwordx4 v[28:31], v6, s[12:15], s61 offen offset:1024 sc1
    buffer_load_dwordx4 v[32:35], v6, s[12:15], s61 offen offset:2048 sc1
    buffer_load_dwordx4 v[36:39], v6, s[12:15], s61 offen offset:3072 sc1
    buffer_load_dwordx4 v[16:19], v7, s[12:15], s61 offen offset:512 sc1
    buffer_load_dwordx4 v[20:23], v7, s[12:15], s61 offen offset:2560 sc1
    s_waitcnt vmcnt(0)
    v_max_u32 v40, v16, v17
    v_max3_u32 v40, v40, v18, v19
    v_max3_u32 v40, v40, v20, v21
    v_max3_u32 v40, v40, v22, v23
    v_max3_u32 v40, v40, v24, v25
    v_max3_u32 v40, v40, v26, v27
    v_max3_u32 v40, v40, v28, v29
    v_max3_u32 v40, v40, v30, v31
    v_max3_u32 v40, v40, v32, v33
    v_max3_u32 v40, v40, v34, v35
    v_max3_u32 v40, v40, v36, v37
    v_max3_u32 v40, v40, v38, v39
    v_cmp_eq_u32 vcc, -1, v40
    s_nop 0
    s_cbranch_vccnz L_a_cp_45_s
    v_mfma_f32_16x16x32_bf16 v[72:75], v[24:27], a[0:3], 0
    v_mfma_f32_16x16x32_bf16 v[76:79], v[24:27], a[16:19], 0
    v_mfma_f32_16x16x32_bf16 v[72:75], v[28:31], a[4:7], v[72:75]
    v_mfma_f32_16x16x32_bf16 v[76:79], v[28:31], a[20:23], v[76:79]
    v_mfma_f32_16x16x32_bf16 v[72:75], v[32:35], a[8:11], v[72:75]
    v_mfma_f32_16x16x32_bf16 v[76:79], v[32:35], a[24:27], v[76:79]
    v_mfma_f32_16x16x32_bf16 v[72:75], v[36:39], a[12:15], v[72:75]
    v_mfma_f32_16x16x32_bf16 v[76:79], v[36:39], a[28:31], v[76:79]
    ds_write_b128 v11, v[16:19] offset:8704
    ds_write_b128 v11, v[20:23] offset:8832
    s_waitcnt lgkmcnt(0)
    ds_read_b64_tr_b16 a[84:85], v12 offset:8704
    ds_read_b64_tr_b16 a[90:91], v12 offset:8736
    ds_read_b64_tr_b16 a[96:97], v12 offset:8768
    ds_read_b64_tr_b16 a[102:103], v12 offset:8800
    ds_read_b64_tr_b16 a[108:109], v12 offset:8832
    ds_read_b64_tr_b16 a[114:115], v12 offset:8864
    ds_read_b64_tr_b16 a[120:121], v12 offset:8896
    ds_read_b64_tr_b16 a[126:127], v12 offset:8928
    v_cndmask_b32 v72, v72, v15, s[56:57]
    v_cndmask_b32 v73, v73, v15, s[56:57]
    v_cndmask_b32 v74, v74, v15, s[56:57]
    v_cndmask_b32 v75, v75, v15, s[56:57]
    v_cndmask_b32 v76, v76, v15, s[56:57]
    v_cndmask_b32 v77, v77, v15, s[56:57]
    v_cndmask_b32 v78, v78, v15, s[56:57]
    v_cndmask_b32 v79, v79, v15, s[56:57]
    v_max_f32 v40, v56, v57
    v_max3_f32 v40, v40, v58, v59
    v_max3_f32 v40, v40, v72, v73
    v_max3_f32 v40, v40, v74, v75
    v_mov_b32 v41, v40
    s_nop 1
    v_permlane16_swap_b32 v40, v41
    v_max_f32 v40, v40, v41
    v_mov_b32 v41, v40
    s_nop 1
    v_permlane32_swap_b32 v40, v41
    v_max_f32 v40, v40, v41
    v_mul_f32 v40, s54, v40
    v_fma_f32 v56, v56, s54, -v40
    v_fma_f32 v57, v57, s54, -v40
    v_fma_f32 v58, v58, s54, -v40
    v_fma_f32 v59, v59, s54, -v40
    v_fma_f32 v72, v72, s54, -v40
    v_fma_f32 v73, v73, s54, -v40
    v_fma_f32 v74, v74, s54, -v40
    v_fma_f32 v75, v75, s54, -v40
    v_exp_f32 v56, v56
    v_exp_f32 v57, v57
    v_exp_f32 v58, v58
    v_exp_f32 v59, v59
    v_exp_f32 v72, v72
    v_exp_f32 v73, v73
    v_exp_f32 v74, v74
    v_exp_f32 v75, v75
    v_add_f32 v40, v56, v57
    v_add_f32 v40, v40, v58
    v_add_f32 v40, v40, v59
    v_add_f32 v40, v40, v72
    v_add_f32 v40, v40, v73
    v_add_f32 v40, v40, v74
    v_add_f32 v40, v40, v75
    v_mov_b32 v41, v40
    s_nop 1
    v_permlane16_swap_b32 v40, v41
    v_add_f32 v40, v40, v41
    v_mov_b32 v41, v40
    s_nop 1
    v_permlane32_swap_b32 v40, v41
    v_add_f32 v40, v40, v41
    v_rcp_f32 v40, v40
    s_nop 0
    v_mul_f32 v56, v56, v40
    v_mul_f32 v57, v57, v40
    v_mul_f32 v58, v58, v40
    v_mul_f32 v59, v59, v40
    v_mul_f32 v72, v72, v40
    v_mul_f32 v73, v73, v40
    v_mul_f32 v74, v74, v40
    v_mul_f32 v75, v75, v40
    v_cvt_pk_bf16_f32 v24, v56, v57
    v_cvt_pk_bf16_f32 v25, v58, v59
    v_cvt_pk_bf16_f32 v28, v72, v73
    v_cvt_pk_bf16_f32 v29, v74, v75
    v_max_f32 v40, v60, v61
    v_max3_f32 v40, v40, v62, v63
    v_max3_f32 v40, v40, v68, v69
    v_max3_f32 v40, v40, v70, v71
    v_max3_f32 v40, v40, v76, v77
    v_max3_f32 v40, v40, v78, v79
    v_mov_b32 v41, v40
    s_nop 1
    v_permlane16_swap_b32 v40, v41
    v_max_f32 v40, v40, v41
    v_mov_b32 v41, v40
    s_nop 1
    v_permlane32_swap_b32 v40, v41
    v_max_f32 v40, v40, v41
    v_mul_f32 v40, s54, v40
    v_fma_f32 v60, v60, s54, -v40
    v_fma_f32 v61, v61, s54, -v40
    v_fma_f32 v62, v62, s54, -v40
    v_fma_f32 v63, v63, s54, -v40
    v_fma_f32 v68, v68, s54, -v40
    v_fma_f32 v69, v69, s54, -v40
    v_fma_f32 v70, v70, s54, -v40
    v_fma_f32 v71, v71, s54, -v40
    v_fma_f32 v76, v76, s54, -v40
    v_fma_f32 v77, v77, s54, -v40
    v_fma_f32 v78, v78, s54, -v40
    v_fma_f32 v79, v79, s54, -v40
    v_exp_f32 v60, v60
    v_exp_f32 v61, v61
    v_exp_f32 v62, v62
    v_exp_f32 v63, v63
    v_exp_f32 v68, v68
    v_exp_f32 v69, v69
    v_exp_f32 v70, v70
    v_exp_f32 v71, v71
    v_exp_f32 v76, v76
    v_exp_f32 v77, v77
    v_exp_f32 v78, v78
    v_exp_f32 v79, v79
    v_add_f32 v40, v60, v61
    v_add_f32 v40, v40, v62
    v_add_f32 v40, v40, v63
    v_add_f32 v40, v40, v68
    v_add_f32 v40, v40, v69
    v_add_f32 v40, v40, v70
    v_add_f32 v40, v40, v71
    v_add_f32 v40, v40, v76
    v_add_f32 v40, v40, v77
    v_add_f32 v40, v40, v78
    v_add_f32 v40, v40, v79
    v_mov_b32 v41, v40
    s_nop 1
    v_permlane16_swap_b32 v40, v41
    v_add_f32 v40, v40, v41
    v_mov_b32 v41, v40
    s_nop 1
    v_permlane32_swap_b32 v40, v41
    v_add_f32 v40, v40, v41
    v_rcp_f32 v40, v40
    s_nop 0
    v_mul_f32 v60, v60, v40
    v_mul_f32 v61, v61, v40
    v_mul_f32 v62, v62, v40
    v_mul_f32 v63, v63, v40
    v_mul_f32 v68, v68, v40
    v_mul_f32 v69, v69, v40
    v_mul_f32 v70, v70, v40
    v_mul_f32 v71, v71, v40
    v_mul_f32 v76, v76, v40
    v_mul_f32 v77, v77, v40
    v_mul_f32 v78, v78, v40
    v_mul_f32 v79, v79, v40
    v_cvt_pk_bf16_f32 v30, v60, v61
    v_cvt_pk_bf16_f32 v31, v62, v63
    v_cvt_pk_bf16_f32 v32, v68, v69
    v_cvt_pk_bf16_f32 v33, v70, v71
    v_cvt_pk_bf16_f32 v34, v76, v77
    v_cvt_pk_bf16_f32 v35, v78, v79
    s_waitcnt lgkmcnt(0)
    s_nop 0
    v_mfma_f32_16x16x16_bf16 v[64:67], a[80:81], v[24:25], 0
    v_mfma_f32_16x16x16_bf16 v[68:71], a[86:87], v[24:25], 0
    v_mfma_f32_16x16x16_bf16 v[72:75], a[92:93], v[24:25], 0
    v_mfma_f32_16x16x16_bf16 v[76:79], a[98:99], v[24:25], 0
    v_mfma_f32_16x16x16_bf16 v[80:83], a[104:105], v[24:25], 0
    v_mfma_f32_16x16x16_bf16 v[84:87], a[110:111], v[24:25], 0
    v_mfma_f32_16x16x16_bf16 v[88:91], a[116:117], v[24:25], 0
    v_mfma_f32_16x16x16_bf16 v[92:95], a[122:123], v[24:25], 0
    v_mfma_f32_16x16x16_bf16 v[64:67], a[84:85], v[28:29], v[64:67]
    v_mfma_f32_16x16x16_bf16 v[68:71], a[90:91], v[28:29], v[68:71]
    v_mfma_f32_16x16x16_bf16 v[72:75], a[96:97], v[28:29], v[72:75]
    v_mfma_f32_16x16x16_bf16 v[76:79], a[102:103], v[28:29], v[76:79]
    v_mfma_f32_16x16x16_bf16 v[80:83], a[108:109], v[28:29], v[80:83]
    v_mfma_f32_16x16x16_bf16 v[84:87], a[114:115], v[28:29], v[84:87]
    v_mfma_f32_16x16x16_bf16 v[88:91], a[120:121], v[28:29], v[88:91]
    v_mfma_f32_16x16x16_bf16 v[92:95], a[126:127], v[28:29], v[92:95]
    v_mfma_f32_16x16x16_bf16 v[96:99], a[80:81], v[30:31], 0
    v_mfma_f32_16x16x16_bf16 v[100:103], a[86:87], v[30:31], 0
    v_mfma_f32_16x16x16_bf16 v[104:107], a[92:93], v[30:31], 0
    v_mfma_f32_16x16x16_bf16 v[108:111], a[98:99], v[30:31], 0
    v_mfma_f32_16x16x16_bf16 v[112:115], a[104:105], v[30:31], 0
    v_mfma_f32_16x16x16_bf16 v[116:119], a[110:111], v[30:31], 0
    v_mfma_f32_16x16x16_bf16 v[120:123], a[116:117], v[30:31], 0
    v_mfma_f32_16x16x16_bf16 v[124:127], a[122:123], v[30:31], 0
    v_mfma_f32_16x16x16_bf16 v[96:99], a[82:83], v[32:33], v[96:99]
    v_mfma_f32_16x16x16_bf16 v[100:103], a[88:89], v[32:33], v[100:103]
    v_mfma_f32_16x16x16_bf16 v[104:107], a[94:95], v[32:33], v[104:107]
    v_mfma_f32_16x16x16_bf16 v[108:111], a[100:101], v[32:33], v[108:111]
    v_mfma_f32_16x16x16_bf16 v[112:115], a[106:107], v[32:33], v[112:115]
    v_mfma_f32_16x16x16_bf16 v[116:119], a[112:113], v[32:33], v[116:119]
    v_mfma_f32_16x16x16_bf16 v[120:123], a[118:119], v[32:33], v[120:123]
    v_mfma_f32_16x16x16_bf16 v[124:127], a[124:125], v[32:33], v[124:127]
    v_mfma_f32_16x16x16_bf16 v[96:99], a[84:85], v[34:35], v[96:99]
    v_mfma_f32_16x16x16_bf16 v[100:103], a[90:91], v[34:35], v[100:103]
    v_mfma_f32_16x16x16_bf16 v[104:107], a[96:97], v[34:35], v[104:107]
    v_mfma_f32_16x16x16_bf16 v[108:111], a[102:103], v[34:35], v[108:111]
    v_mfma_f32_16x16x16_bf16 v[112:115], a[108:109], v[34:35], v[112:115]
    v_mfma_f32_16x16x16_bf16 v[116:119], a[114:115], v[34:35], v[116:119]
    v_mfma_f32_16x16x16_bf16 v[120:123], a[120:121], v[34:35], v[120:123]
    v_mfma_f32_16x16x16_bf16 v[124:127], a[126:127], v[34:35], v[124:127]
    s_add_u32 s46, s63, 4096
    v_cvt_pk_bf16_f32 v64, v64, v65
    v_cvt_pk_bf16_f32 v65, v66, v67
    v_cvt_pk_bf16_f32 v66, v68, v69
    v_cvt_pk_bf16_f32 v67, v70, v71
    buffer_store_dwordx4 v[64:67], v10, s[12:15], s63 offen offset:0 sc1
    v_cvt_pk_bf16_f32 v72, v72, v73
    v_cvt_pk_bf16_f32 v73, v74, v75
    v_cvt_pk_bf16_f32 v74, v76, v77
    v_cvt_pk_bf16_f32 v75, v78, v79
    buffer_store_dwordx4 v[72:75], v10, s[12:15], s63 offen offset:2048 sc1
    v_cvt_pk_bf16_f32 v80, v80, v81
    v_cvt_pk_bf16_f32 v81, v82, v83
    v_cvt_pk_bf16_f32 v82, v84, v85
    v_cvt_pk_bf16_f32 v83, v86, v87
    buffer_store_dwordx4 v[80:83], v10, s[12:15], s46 offen offset:0 sc1
    v_cvt_pk_bf16_f32 v88, v88, v89
    v_cvt_pk_bf16_f32 v89, v90, v91
    v_cvt_pk_bf16_f32 v90, v92, v93
    v_cvt_pk_bf16_f32 v91, v94, v95
    buffer_store_dwordx4 v[88:91], v10, s[12:15], s46 offen offset:2048 sc1
    v_cvt_pk_bf16_f32 v96, v96, v97
    v_cvt_pk_bf16_f32 v97, v98, v99
    v_cvt_pk_bf16_f32 v98, v100, v101
    v_cvt_pk_bf16_f32 v99, v102, v103
    buffer_store_dwordx4 v[96:99], v10, s[12:15], s63 offen offset:256 sc1
    v_cvt_pk_bf16_f32 v104, v104, v105
    v_cvt_pk_bf16_f32 v105, v106, v107
    v_cvt_pk_bf16_f32 v106, v108, v109
    v_cvt_pk_bf16_f32 v107, v110, v111
    buffer_store_dwordx4 v[104:107], v10, s[12:15], s63 offen offset:2304 sc1
    v_cvt_pk_bf16_f32 v112, v112, v113
    v_cvt_pk_bf16_f32 v113, v114, v115
    v_cvt_pk_bf16_f32 v114, v116, v117
    v_cvt_pk_bf16_f32 v115, v118, v119
    buffer_store_dwordx4 v[112:115], v10, s[12:15], s46 offen offset:256 sc1
    v_cvt_pk_bf16_f32 v120, v120, v121
    v_cvt_pk_bf16_f32 v121, v122, v123
    v_cvt_pk_bf16_f32 v122, v124, v125
    v_cvt_pk_bf16_f32 v123, v126, v127
    buffer_store_dwordx4 v[120:123], v10, s[12:15], s46 offen offset:2304 sc1
    s_waitcnt vmcnt(0)
    v_mov_b32 v16, s60
    v_add_u32 v16, 1, v16
    v_mov_b32 v17, 0
    s_mov_b64 exec, 1
    buffer_store_dword v16, v17, s[12:15], s52 offen sc1
    s_mov_b64 exec, -1
L_sf_48:
    s_add_u32 s60, s60, 4
    s_cmp_lt_u32 s60, 64
    s_cbranch_scc1 L_a_loop_42
    s_branch L_c_done_1
L_w_g_10:
    s_lshr_b32 s53, s48, 2
    s_cmp_lt_u32 s53, 2
    s_cselect_b32 s46, 1, 0
    s_xor_b32 s53, s53, s46
    s_mov_b32 s74, 0
    s_mov_b32 s76, 0
    s_cmp_eq_u32 s53, 1
    s_cselect_b32 s75, 46, 64
    s_cmp_eq_u32 s53, 2
    s_cselect_b32 s75, 54, s75
L_w_g_10_e:
    s_lshl_b32 s46, s53, 3
    s_add_u32 s46, s46, 16
    s_load_dwordx2 s[4:5], s[0:1], s46
    s_lshl_b32 s49, s40, 2
    s_and_b32 s46, s48, 3
    s_add_u32 s49, s49, s46
    s_load_dwordx2 s[6:7], s[0:1], 72
    s_and_b32 s50, s44, 3
    s_lshr_b32 s51, s44, 2
    s_waitcnt lgkmcnt(0)
    s_mov_b32 s24, s4
    s_and_b32 s25, s5, 0xffff
    s_mov_b32 s26, 0x800000
    s_mov_b32 s27, 0x00020000
    s_cmp_lg_u32 s53, 0
    s_cbranch_scc1 L_g_nq_49
    s_load_dwordx4 s[8:11], s[0:1], 24
    v_and_b32 v10, 255, v0
    v_lshlrev_b32 v10, 13, v10
    s_and_b32 s46, s48, 3
    s_lshl_b32 s46, s46, 21
    s_lshl_b32 s47, s40, 10
    s_add_u32 s46, s46, s47
    s_add_u32 s46, s46, 384
    s_waitcnt lgkmcnt(0)
    s_cmp_eq_u32 s51, 1
    s_cselect_b32 s8, s10, s8
    s_cselect_b32 s9, s11, s9
    s_mov_b32 s28, s8
    s_and_b32 s29, s9, 0xffff
    s_mov_b32 s30, 0x800000
    s_mov_b32 s31, 0x00020000
    buffer_load_dword v11, v10, s[28:31], s46 offen
    s_cmp_eq_u32 s51, 1
    s_cbranch_scc1 L_g_nq_49
    buffer_load_dword v12, v10, s[24:27], s46 offen
L_g_nq_49:
    v_lshrrev_b32 v3, 4, v1
    v_and_b32 v4, 15, v1
    v_lshlrev_b32 v5, 2, v3
    v_xor_b32 v4, v4, v5
    v_mul_u32_u24 v3, 8192, v3
    v_lshl_add_u32 v3, v4, 4, v3
    s_mul_i32 s46, s51, 512
    s_mul_i32 s47, s50, 64
    s_add_u32 s46, s46, s47
    s_mul_i32 s46, s46, 8192
    s_lshl_b32 s47, s49, 8
    s_add_u32 s46, s46, s47
    s_lshl_b32 s45, s51, 16
    s_mul_i32 s47, s50, 16384
    s_add_u32 s45, s45, s47
    v_bfe_u32 v4, v1, 2, 2
    v_bfe_u32 v5, v1, 4, 1
    v_lshlrev_b32 v5, 1, v5
    v_bfe_u32 v6, v1, 0, 1
    v_add_u32 v5, v5, v6
    s_lshl_b32 s47, s50, 2
    v_add_u32 v5, s47, v5
    v_lshlrev_b32 v6, 2, v4
    v_xor_b32 v5, v5, v6
    v_lshlrev_b32 v5, 4, v5
    v_lshl_add_u32 v5, v4, 8, v5
    v_bfe_u32 v6, v1, 1, 1
    v_lshl_add_u32 v5, v6, 3, v5
    v_lshrrev_b32 v6, 5, v1
    v_mul_u32_u24 v6, 2048, v6
    v_add_u32 v5, v5, v6
    s_lshl_b32 s47, s51, 16
    v_add_u32 v5, s47, v5
    v_bfe_u32 v4, v1, 2, 2
    v_xor_b32 v5, s50, v4
    v_lshlrev_b32 v5, 6, v5
    v_lshl_add_u32 v5, v4, 8, v5
    v_and_b32 v6, 3, v1
    v_lshl_add_u32 v5, v6, 4, v5
    v_lshrrev_b32 v6, 4, v1
    v_lshl_add_u32 v5, v6, 11, v5
    v_lshrrev_b32 v6, 5, v1
    s_lshl_b32 s47, s51, 16
    v_add_u32 v5, s47, v5
    s_add_u32 m0, s45, 0
    s_add_u32 s47, s46, 0x0
    buffer_load_dwordx4 v3, s[24:27], s47 offen lds
    s_add_u32 m0, s45, 1024
    s_add_u32 s47, s46, 0x8000
    buffer_load_dwordx4 v3, s[24:27], s47 offen lds
    s_add_u32 m0, s45, 2048
    s_add_u32 s47, s46, 0x10000
    buffer_load_dwordx4 v3, s[24:27], s47 offen lds
    s_add_u32 m0, s45, 3072
    s_add_u32 s47, s46, 0x18000
    buffer_load_dwordx4 v3, s[24:27], s47 offen lds
    s_add_u32 m0, s45, 4096
    s_add_u32 s47, s46, 0x20000
    buffer_load_dwordx4 v3, s[24:27], s47 offen lds
    s_add_u32 m0, s45, 5120
    s_add_u32 s47, s46, 0x28000
    buffer_load_dwordx4 v3, s[24:27], s47 offen lds
    s_add_u32 m0, s45, 6144
    s_add_u32 s47, s46, 0x30000
    buffer_load_dwordx4 v3, s[24:27], s47 offen lds
    s_add_u32 m0, s45, 7168
    s_add_u32 s47, s46, 0x38000
    buffer_load_dwordx4 v3, s[24:27], s47 offen lds
    s_add_u32 m0, s45, 8192
    s_add_u32 s47, s46, 0x40000
    buffer_load_dwordx4 v3, s[24:27], s47 offen lds
    s_add_u32 m0, s45, 9216
    s_add_u32 s47, s46, 0x48000
    buffer_load_dwordx4 v3, s[24:27], s47 offen lds
    s_add_u32 m0, s45, 10240
    s_add_u32 s47, s46, 0x50000
    buffer_load_dwordx4 v3, s[24:27], s47 offen lds
    s_add_u32 m0, s45, 11264
    s_add_u32 s47, s46, 0x58000
    buffer_load_dwordx4 v3, s[24:27], s47 offen lds
    s_add_u32 m0, s45, 12288
    s_add_u32 s47, s46, 0x60000
    buffer_load_dwordx4 v3, s[24:27], s47 offen lds
    s_add_u32 m0, s45, 13312
    s_add_u32 s47, s46, 0x68000
    buffer_load_dwordx4 v3, s[24:27], s47 offen lds
    s_add_u32 m0, s45, 14336
    s_add_u32 s47, s46, 0x70000
    buffer_load_dwordx4 v3, s[24:27], s47 offen lds
    s_add_u32 m0, s45, 15360
    s_add_u32 s47, s46, 0x78000
    buffer_load_dwordx4 v3, s[24:27], s47 offen lds
    s_waitcnt vmcnt(0)
    s_barrier
    ds_read_b64_tr_b16 a[0:1], v5 offset:0
    ds_read_b64_tr_b16 a[2:3], v5 offset:1024
    ds_read_b64_tr_b16 a[4:5], v5 offset:8
    ds_read_b64_tr_b16 a[6:7], v5 offset:1032
    ds_read_b64_tr_b16 a[8:9], v5 offset:8192
    ds_read_b64_tr_b16 a[10:11], v5 offset:9216
    ds_read_b64_tr_b16 a[12:13], v5 offset:8200
    ds_read_b64_tr_b16 a[14:15], v5 offset:9224
    s_waitcnt lgkmcnt(0)
    ds_read_b64_tr_b16 a[16:17], v5 offset:16384
    ds_read_b64_tr_b16 a[18:19], v5 offset:17408
    ds_read_b64_tr_b16 a[20:21], v5 offset:16392
    ds_read_b64_tr_b16 a[22:23], v5 offset:17416
    ds_read_b64_tr_b16 a[24:25], v5 offset:24576
    ds_read_b64_tr_b16 a[26:27], v5 offset:25600
    ds_read_b64_tr_b16 a[28:29], v5 offset:24584
    ds_read_b64_tr_b16 a[30:31], v5 offset:25608
    s_waitcnt lgkmcnt(0)
    ds_read_b64_tr_b16 a[32:33], v5 offset:32768
    ds_read_b64_tr_b16 a[34:35], v5 offset:33792
    ds_read_b64_tr_b16 a[36:37], v5 offset:32776
    ds_read_b64_tr_b16 a[38:39], v5 offset:33800
    ds_read_b64_tr_b16 a[40:41], v5 offset:40960
    ds_read_b64_tr_b16 a[42:43], v5 offset:41984
    ds_read_b64_tr_b16 a[44:45], v5 offset:40968
    ds_read_b64_tr_b16 a[46:47], v5 offset:41992
    s_waitcnt lgkmcnt(0)
    ds_read_b64_tr_b16 a[48:49], v5 offset:49152
    ds_read_b64_tr_b16 a[50:51], v5 offset:50176
    ds_read_b64_tr_b16 a[52:53], v5 offset:49160
    ds_read_b64_tr_b16 a[54:55], v5 offset:50184
    ds_read_b64_tr_b16 a[56:57], v5 offset:57344
    ds_read_b64_tr_b16 a[58:59], v5 offset:58368
    ds_read_b64_tr_b16 a[60:61], v5 offset:57352
    ds_read_b64_tr_b16 a[62:63], v5 offset:58376
    s_waitcnt lgkmcnt(0)
    s_waitcnt lgkmcnt(0)
    s_barrier
    s_add_u32 m0, s45, 0
    s_add_u32 s47, s46, 0x200000
    buffer_load_dwordx4 v3, s[24:27], s47 offen lds
    s_add_u32 m0, s45, 1024
    s_add_u32 s47, s46, 0x208000
    buffer_load_dwordx4 v3, s[24:27], s47 offen lds
    s_add_u32 m0, s45, 2048
    s_add_u32 s47, s46, 0x210000
    buffer_load_dwordx4 v3, s[24:27], s47 offen lds
    s_add_u32 m0, s45, 3072
    s_add_u32 s47, s46, 0x218000
    buffer_load_dwordx4 v3, s[24:27], s47 offen lds
    s_add_u32 m0, s45, 4096
    s_add_u32 s47, s46, 0x220000
    buffer_load_dwordx4 v3, s[24:27], s47 offen lds
    s_add_u32 m0, s45, 5120
    s_add_u32 s47, s46, 0x228000
    buffer_load_dwordx4 v3, s[24:27], s47 offen lds
    s_add_u32 m0, s45, 6144
    s_add_u32 s47, s46, 0x230000
    buffer_load_dwordx4 v3, s[24:27], s47 offen lds
    s_add_u32 m0, s45, 7168
    s_add_u32 s47, s46, 0x238000
    buffer_load_dwordx4 v3, s[24:27], s47 offen lds
    s_add_u32 m0, s45, 8192
    s_add_u32 s47, s46, 0x240000
    buffer_load_dwordx4 v3, s[24:27], s47 offen lds
    s_add_u32 m0, s45, 9216
    s_add_u32 s47, s46, 0x248000
    buffer_load_dwordx4 v3, s[24:27], s47 offen lds
    s_add_u32 m0, s45, 10240
    s_add_u32 s47, s46, 0x250000
    buffer_load_dwordx4 v3, s[24:27], s47 offen lds
    s_add_u32 m0, s45, 11264
    s_add_u32 s47, s46, 0x258000
    buffer_load_dwordx4 v3, s[24:27], s47 offen lds
    s_add_u32 m0, s45, 12288
    s_add_u32 s47, s46, 0x260000
    buffer_load_dwordx4 v3, s[24:27], s47 offen lds
    s_add_u32 m0, s45, 13312
    s_add_u32 s47, s46, 0x268000
    buffer_load_dwordx4 v3, s[24:27], s47 offen lds
    s_add_u32 m0, s45, 14336
    s_add_u32 s47, s46, 0x270000
    buffer_load_dwordx4 v3, s[24:27], s47 offen lds
    s_add_u32 m0, s45, 15360
    s_add_u32 s47, s46, 0x278000
    buffer_load_dwordx4 v3, s[24:27], s47 offen lds
    s_waitcnt vmcnt(0)
    s_barrier
    ds_read_b64_tr_b16 a[64:65], v5 offset:0
    ds_read_b64_tr_b16 a[66:67], v5 offset:1024
    ds_read_b64_tr_b16 a[68:69], v5 offset:8
    ds_read_b64_tr_b16 a[70:71], v5 offset:1032
    ds_read_b64_tr_b16 a[72:73], v5 offset:8192
    ds_read_b64_tr_b16 a[74:75], v5 offset:9216
    ds_read_b64_tr_b16 a[76:77], v5 offset:8200
    ds_read_b64_tr_b16 a[78:79], v5 offset:9224
    s_waitcnt lgkmcnt(0)
    ds_read_b64_tr_b16 a[80:81], v5 offset:16384
    ds_read_b64_tr_b16 a[82:83], v5 offset:17408
    ds_read_b64_tr_b16 a[84:85], v5 offset:16392
    ds_read_b64_tr_b16 a[86:87], v5 offset:17416
    ds_read_b64_tr_b16 a[88:89], v5 offset:24576
    ds_read_b64_tr_b16 a[90:91], v5 offset:25600
    ds_read_b64_tr_b16 a[92:93], v5 offset:24584
    ds_read_b64_tr_b16 a[94:95], v5 offset:25608
    s_waitcnt lgkmcnt(0)
    ds_read_b64_tr_b16 a[96:97], v5 offset:32768
    ds_read_b64_tr_b16 a[98:99], v5 offset:33792
    ds_read_b64_tr_b16 a[100:101], v5 offset:32776
    ds_read_b64_tr_b16 a[102:103], v5 offset:33800
    ds_read_b64_tr_b16 a[104:105], v5 offset:40960
    ds_read_b64_tr_b16 a[106:107], v5 offset:41984
    ds_read_b64_tr_b16 a[108:109], v5 offset:40968
    ds_read_b64_tr_b16 a[110:111], v5 offset:41992
    s_waitcnt lgkmcnt(0)
    ds_read_b64_tr_b16 a[112:113], v5 offset:49152
    ds_read_b64_tr_b16 a[114:115], v5 offset:50176
    ds_read_b64_tr_b16 a[116:117], v5 offset:49160
    ds_read_b64_tr_b16 a[118:119], v5 offset:50184
    ds_read_b64_tr_b16 a[120:121], v5 offset:57344
    ds_read_b64_tr_b16 a[122:123], v5 offset:58368
    ds_read_b64_tr_b16 a[124:125], v5 offset:57352
    ds_read_b64_tr_b16 a[126:127], v5 offset:58376
    s_waitcnt lgkmcnt(0)
    s_waitcnt lgkmcnt(0)
    s_barrier
    v_lshlrev_b32 v2, 4, v1
    s_mul_i32 s64, s44, 8192
    s_add_u32 s46, s64, 0x400000
    v_add_u32 v3, s46, v2
    s_mul_i32 s46, s51, 32768
    v_add_u32 v4, s46, v2
    v_and_b32 v6, 15, v1
    v_lshlrev_b32 v6, 4, v6
    v_lshrrev_b32 v7, 4, v1
    v_lshl_add_u32 v6, v7, 9, v6
    v_add_u32 v4, s46, v6
    s_lshl_b32 s46, s50, 12
    s_add_u32 s46, s46, 131072
    v_add_u32 v5, s46, v2
    v_and_b32 v7, 3, v1
    v_lshlrev_b32 v7, 7, v7
    v_add_u32 v7, 0x109400, v7
    s_mul_i32 s46, s49, 24576
    s_lshl_b32 s47, s53, 13
    s_add_u32 s46, s46, s47
    s_lshl_b32 s47, s50, 10
    s_add_u32 s46, s46, s47
    s_add_u32 s46, s46, 0x2000000
    v_and_b32 v8, 15, v1
    v_lshlrev_b32 v8, 4, v8
    v_bfe_u32 v9, v1, 4, 1
    v_lshl_add_u32 v8, v9, 12, v8
    v_lshrrev_b32 v9, 5, v1
    v_lshl_add_u32 v8, v9, 8, v8
    v_add_u32 v8, s46, v2
    v_add_u32 v9, 4096, v8
    s_lshl_b32 s52, s40, 2
    s_add_u32 s52, s52, s53
    s_lshl_b32 s52, s52, 2
    s_and_b32 s47, s48, 3
    s_add_u32 s52, s52, s47
    s_lshl_b32 s52, s52, 7
    s_add_u32 s52, s52, 0x10a400
    s_add_u32 s52, s52, s76
    v_mov_b32 v116, -1
    v_mov_b32 v117, -1
    v_mov_b32 v118, -1
    v_mov_b32 v119, -1
    s_lshl_b32 s46, s49, 12
    s_lshl_b32 s47, s50, 10
    s_add_u32 s46, s46, s47
    s_add_u32 s46, s46, 0x1000000
    v_add_u32 v64, s46, v2
    s_and_b32 s46, s48, 3
    s_lshl_b32 s46, s46, 16
    s_lshl_b32 s47, s50, 14
    s_add_u32 s46, s46, s47
    s_lshl_b32 s47, s40, 8
    s_add_u32 s46, s46, s47
    s_add_u32 s46, s46, 0x7800000
    v_and_b32 v65, 15, v1
    v_lshlrev_b32 v65, 4, v65
    v_lshrrev_b32 v66, 4, v1
    v_lshl_add_u32 v65, v66, 11, v65
    v_add_u32 v65, s46, v65
    v_add_u32 v68, 8192, v65
    s_lshl_b32 s58, s74, 17
    s_lshl_b32 s46, s53, 3
    s_sub_u32 s46, 80, s46
    s_load_dwordx2 s[8:9], s[0:1], s46
    v_lshlrev_b32 v66, 7, v1
    s_mul_i32 s57, s49, 229376
    s_waitcnt lgkmcnt(0)
    s_mov_b32 s32, s8
    s_and_b32 s33, s9, 0xffff
    s_mov_b32 s34, 0x700000
    s_mov_b32 s35, 0x00020000
    s_mov_b32 s60, s74
    s_mul_i32 s61, s74, 65536
    s_mov_b32 s62, s74
    s_mul_i32 s63, s74, 786432
    s_mov_b32 s67, 0
    s_mov_b32 s68, 3
    s_mov_b32 s71, 0
    v_mov_b32 v15, 147456
    v_mov_b32 v14, 0
    ds_write_b32 v15, v14 offset:4
    ds_write_b32 v15, v14 offset:12
    ds_write_b32 v15, v14 offset:16
    v_mov_b32 v114, 1
    v_mov_b32 v115, 0
    v_lshrrev_b32 v113, 4, v1
    s_mov_b32 s72, 0
    s_cmp_lg_u32 s44, 0
    s_cbranch_scc1 L_zwok_59
    v_and_b32 v10, 7, v1
    v_lshlrev_b32 v10, 5, v10
    s_mov_b32 s70, 0
L_zw_58:
    buffer_load_dword v11, v10, s[16:19], 0 offen sc1
    s_waitcnt vmcnt(0)
    v_add_u32_dpp v11, v11, v11 row_ror:1 row_mask:0xf bank_mask:0xf
    s_nop 1
    v_add_u32_dpp v11, v11, v11 row_ror:2 row_mask:0xf bank_mask:0xf
    s_nop 1
    v_add_u32_dpp v11, v11, v11 row_ror:4 row_mask:0xf bank_mask:0xf
    v_cmp_ne_u32 vcc, 0x100, v11
    s_add_u32 s70, s70, 1
    s_cbranch_vccz L_zwok_59
    s_sleep 4
    s_cmp_lt_u32 s70, 524288
    s_cbranch_scc1 L_zw_58
    s_branch L_c_done_1
L_zwok_59:
L_g_restart_50:
    s_cmp_lg_u32 s44, 0
    s_cbranch_scc1 L_g_nsp_51
    s_mov_b32 s70, 0
L_g_sp_57:
    s_add_u32 s54, s60, 0
    v_add_u32 v12, s54, v113
    v_and_b32 v13, 7, v12
    v_lshl_add_u32 v13, v13, 9, v7
    buffer_load_dword v11, v13, s[12:15], 0 offen sc1
    s_waitcnt vmcnt(0)
    v_cmp_ge_u32 vcc, v12, v11
    s_add_u32 s70, s70, 1
    s_and_b32 s46, vcc_lo, 0xffff
    s_cbranch_scc0 L_g_sp_57_ok
    s_sleep 3
    s_cmp_lt_u32 s70, 524288
    s_cbranch_scc1 L_g_sp_57
    s_branch L_c_done_1
L_g_sp_57_ok:
    v_cmp_ge_u32 vcc, v12, v11
    s_nop 0
    s_ff1_i32_b64 s46, vcc
    s_lshr_b32 s46, s46, 4
    s_min_u32 s46, s46, 4
    s_add_u32 s46, s46, s54
    s_min_u32 s46, s46, s75
    v_mov_b32 v11, s46
    ds_write_b32 v15, v11
L_g_nsp_51:
    s_waitcnt lgkmcnt(0)
    s_barrier
    ds_read_b32 v14, v15
    s_waitcnt lgkmcnt(0)
    v_readfirstlane_b32 s66, v14
    s_nop 3
L_g_restart_50_go:
    s_mov_b32 s69, 0
    s_cmp_gt_u32 s62, s60
    s_cbranch_scc1 L_g_nd_60
    s_cmp_ge_u32 s62, s66
    s_cbranch_scc1 L_g_nd_60
    s_add_u32 s47, s61, 4096
    s_add_u32 m0, s64, 0
    s_nop 0
    buffer_load_dwordx4 v3, s[12:15], s61 offen offset:0 sc1 lds
    buffer_load_dwordx4 v3, s[12:15], s61 offen offset:1024 sc1 lds
    buffer_load_dwordx4 v3, s[12:15], s61 offen offset:2048 sc1 lds
    buffer_load_dwordx4 v3, s[12:15], s61 offen offset:3072 sc1 lds
    s_add_u32 m0, s64, 4096
    s_nop 0
    buffer_load_dwordx4 v3, s[12:15], s47 offen offset:0 sc1 lds
    buffer_load_dwordx4 v3, s[12:15], s47 offen offset:1024 sc1 lds
    buffer_load_dwordx4 v3, s[12:15], s47 offen offset:2048 sc1 lds
    buffer_load_dwordx4 v3, s[12:15], s47 offen offset:3072 sc1 lds
    s_add_u32 s61, s61, 65536
    s_add_u32 s62, s62, 1
    s_xor_b32 s64, s64, 0x10000
    s_mov_b32 s69, 1
L_g_nd_60:
    s_cmp_eq_u32 s51, 1
    s_cbranch_scc1 L_g_g1r_52
    s_add_u32 s59, s60, 1
    s_mov_b32 s69, 0
    s_cmp_gt_u32 s62, s59
    s_cbranch_scc1 L_g_nd_61
    s_cmp_ge_u32 s62, s66
    s_cbranch_scc1 L_g_nd_61
    s_add_u32 s47, s61, 4096
    s_add_u32 m0, s64, 0
    s_nop 0
    buffer_load_dwordx4 v3, s[12:15], s61 offen offset:0 sc1 lds
    buffer_load_dwordx4 v3, s[12:15], s61 offen offset:1024 sc1 lds
    buffer_load_dwordx4 v3, s[12:15], s61 offen offset:2048 sc1 lds
    buffer_load_dwordx4 v3, s[12:15], s61 offen offset:3072 sc1 lds
    s_add_u32 m0, s64, 4096
    s_nop 0
    buffer_load_dwordx4 v3, s[12:15], s47 offen offset:0 sc1 lds
    buffer_load_dwordx4 v3, s[12:15], s47 offen offset:1024 sc1 lds
    buffer_load_dwordx4 v3, s[12:15], s47 offen offset:2048 sc1 lds
    buffer_load_dwordx4 v3, s[12:15], s47 offen offset:3072 sc1 lds
    s_add_u32 s61, s61, 65536
    s_add_u32 s62, s62, 1
    s_xor_b32 s64, s64, 0x10000
    s_mov_b32 s69, 1
L_g_nd_61:
    s_cmp_eq_u32 s69, 1
    s_cbranch_scc1 L_g_w0_62
    s_waitcnt vmcnt(0)
L_g_w0_62:
    s_waitcnt vmcnt(8)
    s_cmp_lg_u32 s44, 0
    s_cbranch_scc1 L_g_nl_63
    s_add_u32 s54, s60, 1
    v_add_u32 v12, s54, v113
    v_and_b32 v13, 7, v12
    v_lshl_add_u32 v13, v13, 9, v7
    buffer_load_dword v11, v13, s[12:15], 0 offen sc1
L_g_nl_63:
L_g_loop0_53_l:
    s_barrier
    ds_read_b128 v[32:35], v4 offset:0
    ds_read_b128 v[36:39], v4 offset:256
    ds_read_b128 v[40:43], v4 offset:2048
    ds_read_b128 v[44:47], v4 offset:2304
    ds_read_b128 v[48:51], v4 offset:4096
    ds_read_b128 v[52:55], v4 offset:4352
    ds_read_b128 v[56:59], v4 offset:6144
    ds_read_b128 v[60:63], v4 offset:6400
    s_branch L_g_loop0_53_m
.p2align 6
L_g_loop0_53:
    s_barrier
L_g_loop0_53_m:
    s_setprio 2
    s_waitcnt lgkmcnt(6)
    v_mfma_f32_16x16x32_bf16 v[16:19], a[0:3], v[32:35], 0
    ds_read_b32 v14, v15
    v_mfma_f32_16x16x32_bf16 v[20:23], a[4:7], v[32:35], 0
    ds_read_b128 v[32:35], v4 offset:8192
    v_mfma_f32_16x16x32_bf16 v[28:31], a[4:7], v[36:39], 0
    v_mfma_f32_16x16x32_bf16 v[24:27], a[0:3], v[36:39], 0
    ds_read_b128 v[36:39], v4 offset:8448
    s_waitcnt lgkmcnt(6)
    v_mfma_f32_16x16x32_bf16 v[16:19], a[8:11], v[40:43], v[16:19]
    v_mfma_f32_16x16x32_bf16 v[20:23], a[12:15], v[40:43], v[20:23]
    ds_read_b128 v[40:43], v4 offset:10240
    v_mfma_f32_16x16x32_bf16 v[28:31], a[12:15], v[44:47], v[28:31]
    v_mfma_f32_16x16x32_bf16 v[24:27], a[8:11], v[44:47], v[24:27]
    ds_read_b128 v[44:47], v4 offset:10496
    s_waitcnt lgkmcnt(6)
    v_mfma_f32_16x16x32_bf16 v[16:19], a[16:19], v[48:51], v[16:19]
    v_mfma_f32_16x16x32_bf16 v[20:23], a[20:23], v[48:51], v[20:23]
    ds_read_b128 v[48:51], v4 offset:12288
    v_mfma_f32_16x16x32_bf16 v[28:31], a[20:23], v[52:55], v[28:31]
    v_mfma_f32_16x16x32_bf16 v[24:27], a[16:19], v[52:55], v[24:27]
    ds_read_b128 v[52:55], v4 offset:12544
    s_waitcnt lgkmcnt(6)
    v_mfma_f32_16x16x32_bf16 v[16:19], a[24:27], v[56:59], v[16:19]
    v_mfma_f32_16x16x32_bf16 v[20:23], a[28:31], v[56:59], v[20:23]
    ds_read_b128 v[56:59], v4 offset:14336
    v_mfma_f32_16x16x32_bf16 v[28:31], a[28:31], v[60:63], v[28:31]
    v_mfma_f32_16x16x32_bf16 v[24:27], a[24:27], v[60:63], v[24:27]
    ds_read_b128 v[60:63], v4 offset:14592
    s_waitcnt lgkmcnt(6)
    v_mfma_f32_16x16x32_bf16 v[16:19], a[32:35], v[32:35], v[16:19]
    v_mfma_f32_16x16x32_bf16 v[20:23], a[36:39], v[32:35], v[20:23]
    ds_read_b128 v[32:35], v4 offset:16384
    v_mfma_f32_16x16x32_bf16 v[28:31], a[36:39], v[36:39], v[28:31]
    v_mfma_f32_16x16x32_bf16 v[24:27], a[32:35], v[36:39], v[24:27]
    ds_read_b128 v[36:39], v4 offset:16640
    s_waitcnt lgkmcnt(6)
    v_mfma_f32_16x16x32_bf16 v[16:19], a[40:43], v[40:43], v[16:19]
    v_mfma_f32_16x16x32_bf16 v[20:23], a[44:47], v[40:43], v[20:23]
    ds_read_b128 v[40:43], v4 offset:18432
    v_mfma_f32_16x16x32_bf16 v[28:31], a[44:47], v[44:47], v[28:31]
    v_mfma_f32_16x16x32_bf16 v[24:27], a[40:43], v[44:47], v[24:27]
    ds_read_b128 v[44:47], v4 offset:18688
    s_waitcnt lgkmcnt(6)
    v_mfma_f32_16x16x32_bf16 v[16:19], a[48:51], v[48:51], v[16:19]
    v_mfma_f32_16x16x32_bf16 v[20:23], a[52:55], v[48:51], v[20:23]
    ds_read_b128 v[48:51], v4 offset:20480
    v_mfma_f32_16x16x32_bf16 v[28:31], a[52:55], v[52:55], v[28:31]
    v_mfma_f32_16x16x32_bf16 v[24:27], a[48:51], v[52:55], v[24:27]
    ds_read_b128 v[52:55], v4 offset:20736
    s_waitcnt lgkmcnt(6)
    v_mfma_f32_16x16x32_bf16 v[16:19], a[56:59], v[56:59], v[16:19]
    v_mfma_f32_16x16x32_bf16 v[20:23], a[60:63], v[56:59], v[20:23]
    ds_read_b128 v[56:59], v4 offset:22528
    v_mfma_f32_16x16x32_bf16 v[28:31], a[60:63], v[60:63], v[28:31]
    v_mfma_f32_16x16x32_bf16 v[24:27], a[56:59], v[60:63], v[24:27]
    ds_read_b128 v[60:63], v4 offset:22784
    s_waitcnt lgkmcnt(6)
    v_mfma_f32_16x16x32_bf16 v[16:19], a[64:67], v[32:35], v[16:19]
    v_mfma_f32_16x16x32_bf16 v[20:23], a[68:71], v[32:35], v[20:23]
    ds_read_b128 v[32:35], v4 offset:24576
    v_mfma_f32_16x16x32_bf16 v[28:31], a[68:71], v[36:39], v[28:31]
    v_mfma_f32_16x16x32_bf16 v[24:27], a[64:67], v[36:39], v[24:27]
    ds_read_b128 v[36:39], v4 offset:24832
    s_waitcnt lgkmcnt(6)
    v_mfma_f32_16x16x32_bf16 v[16:19], a[72:75], v[40:43], v[16:19]
    v_mfma_f32_16x16x32_bf16 v[20:23], a[76:79], v[40:43], v[20:23]
    ds_read_b128 v[40:43], v4 offset:26624
    v_mfma_f32_16x16x32_bf16 v[28:31], a[76:79], v[44:47], v[28:31]
    v_mfma_f32_16x16x32_bf16 v[24:27], a[72:75], v[44:47], v[24:27]
    ds_read_b128 v[44:47], v4 offset:26880
    s_waitcnt lgkmcnt(6)
    v_mfma_f32_16x16x32_bf16 v[16:19], a[80:83], v[48:51], v[16:19]
    v_mfma_f32_16x16x32_bf16 v[20:23], a[84:87], v[48:51], v[20:23]
    ds_read_b128 v[48:51], v4 offset:28672
    v_mfma_f32_16x16x32_bf16 v[28:31], a[84:87], v[52:55], v[28:31]
    v_mfma_f32_16x16x32_bf16 v[24:27], a[80:83], v[52:55], v[24:27]
    ds_read_b128 v[52:55], v4 offset:28928
    s_waitcnt lgkmcnt(6)
    v_mfma_f32_16x16x32_bf16 v[16:19], a[88:91], v[56:59], v[16:19]
    v_mfma_f32_16x16x32_bf16 v[20:23], a[92:95], v[56:59], v[20:23]
    ds_read_b128 v[56:59], v4 offset:30720
    v_mfma_f32_16x16x32_bf16 v[28:31], a[92:95], v[60:63], v[28:31]
    v_mfma_f32_16x16x32_bf16 v[24:27], a[88:91], v[60:63], v[24:27]
    ds_read_b128 v[60:63], v4 offset:30976
    s_waitcnt lgkmcnt(6)
    v_mfma_f32_16x16x32_bf16 v[16:19], a[96:99], v[32:35], v[16:19]
    v_mfma_f32_16x16x32_bf16 v[20:23], a[100:103], v[32:35], v[20:23]
    v_mfma_f32_16x16x32_bf16 v[28:31], a[100:103], v[36:39], v[28:31]
    v_mfma_f32_16x16x32_bf16 v[24:27], a[96:99], v[36:39], v[24:27]
    s_waitcnt lgkmcnt(4)
    v_mfma_f32_16x16x32_bf16 v[16:19], a[104:107], v[40:43], v[16:19]
    v_mfma_f32_16x16x32_bf16 v[20:23], a[108:111], v[40:43], v[20:23]
    v_mfma_f32_16x16x32_bf16 v[28:31], a[108:111], v[44:47], v[28:31]
    v_mfma_f32_16x16x32_bf16 v[24:27], a[104:107], v[44:47], v[24:27]
    s_waitcnt lgkmcnt(2)
    v_mfma_f32_16x16x32_bf16 v[16:19], a[112:115], v[48:51], v[16:19]
    v_mfma_f32_16x16x32_bf16 v[20:23], a[116:119], v[48:51], v[20:23]
    v_mfma_f32_16x16x32_bf16 v[28:31], a[116:119], v[52:55], v[28:31]
    v_mfma_f32_16x16x32_bf16 v[24:27], a[112:115], v[52:55], v[24:27]
    s_waitcnt lgkmcnt(0)
    v_mfma_f32_16x16x32_bf16 v[16:19], a[120:123], v[56:59], v[16:19]
    v_mfma_f32_16x16x32_bf16 v[20:23], a[124:127], v[56:59], v[20:23]
    v_mfma_f32_16x16x32_bf16 v[28:31], a[124:127], v[60:63], v[28:31]
    v_mfma_f32_16x16x32_bf16 v[24:27], a[120:123], v[60:63], v[24:27]
    v_xor_b32 v4, 0x10000, v4
    s_setprio 0
    s_waitcnt vmcnt(0)
    v_readfirstlane_b32 s66, v14
    s_barrier
    s_nop 6
    ds_write_b128 v5, v[16:19] offset:0
    ds_write_b128 v5, v[20:23] offset:1024
    ds_write_b128 v5, v[24:27] offset:2048
    ds_write_b128 v5, v[28:31] offset:3072
    s_cmp_lg_u32 s44, 0
    s_cbranch_scc1 L_g_ne_64
    v_cmp_ge_u32 vcc, v12, v11
    s_nop 0
    s_ff1_i32_b64 s46, vcc
    s_lshr_b32 s46, s46, 4
    s_min_u32 s46, s46, 4
    s_add_u32 s46, s46, s54
    s_min_u32 s46, s46, s75
    v_mov_b32 v11, s46
    ds_write_b32 v15, v11
L_g_ne_64:
    s_add_u32 s60, s60, 1
    s_mov_b32 s65, 0
    s_cmp_le_u32 s62, s60
    s_cbranch_scc1 L_g_dp_67_l
L_g_dp_67_a:
    s_cmp_ge_u32 s62, s66
    s_cbranch_scc1 L_g_dp_67_d
    s_add_u32 s47, s61, 4096
    s_mov_b32 m0, s64
    s_add_u32 s62, s62, 1
    buffer_load_dwordx4 v3, s[12:15], s61 offen offset:0 sc1 lds
    buffer_load_dwordx4 v3, s[12:15], s61 offen offset:1024 sc1 lds
    buffer_load_dwordx4 v3, s[12:15], s61 offen offset:2048 sc1 lds
    buffer_load_dwordx4 v3, s[12:15], s61 offen offset:3072 sc1 lds
    s_add_u32 m0, s64, 4096
    s_add_u32 s61, s61, 65536
    buffer_load_dwordx4 v3, s[12:15], s47 offen offset:0 sc1 lds
    buffer_load_dwordx4 v3, s[12:15], s47 offen offset:1024 sc1 lds
    buffer_load_dwordx4 v3, s[12:15], s47 offen offset:2048 sc1 lds
    buffer_load_dwordx4 v3, s[12:15], s47 offen offset:3072 sc1 lds
    s_xor_b32 s64, s64, 0x10000
L_g_dp_67_d:
    s_cmp_le_u32 s66, s60
    s_cbranch_scc1 L_g_ex0_66
    s_cmp_lg_u32 s65, 0
    s_cbranch_scc1 L_g_nw_65
    ds_read_b128 v[32:35], v4 offset:0
    ds_read_b128 v[36:39], v4 offset:256
    ds_read_b128 v[40:43], v4 offset:2048
    ds_read_b128 v[44:47], v4 offset:2304
    ds_read_b128 v[48:51], v4 offset:4096
    ds_read_b128 v[52:55], v4 offset:4352
    ds_read_b128 v[56:59], v4 offset:6144
    ds_read_b128 v[60:63], v4 offset:6400
    s_cmp_lg_u32 s44, 0
    s_cbranch_scc1 L_g_nl_68
    s_add_u32 s54, s60, 1
    v_add_u32 v12, s54, v113
    v_and_b32 v13, 7, v12
    v_lshl_add_u32 v13, v13, 9, v7
    buffer_load_dword v11, v13, s[12:15], 0 offen sc1
L_g_nl_68:
    s_waitcnt lgkmcnt(8)
    s_branch L_g_loop0_53
L_g_ex0_66:
    s_cmp_lg_u32 s44, 0
    s_cbranch_scc1 L_g_ex0_66_n
    s_sleep 6
    s_add_u32 s54, s60, 0
    v_add_u32 v12, s54, v113
    v_and_b32 v13, 7, v12
    v_lshl_add_u32 v13, v13, 9, v7
    buffer_load_dword v11, v13, s[12:15], 0 offen sc1
    s_waitcnt vmcnt(0)
    v_cmp_ge_u32 vcc, v12, v11
    s_nop 0
    s_ff1_i32_b64 s46, vcc
    s_lshr_b32 s46, s46, 4
    s_min_u32 s46, s46, 4
    s_add_u32 s46, s46, s54
    s_min_u32 s46, s46, s75
    v_mov_b32 v11, s46
    ds_write_b32 v15, v11
L_g_ex0_66_n:
    s_waitcnt lgkmcnt(0)
    s_barrier
    ds_read_b32 v14, v15
    s_waitcnt lgkmcnt(0)
    v_readfirstlane_b32 s66, v14
    s_barrier
    s_cmp_gt_u32 s66, s60
    s_cbranch_scc1 L_g_restart_50_go
    s_branch L_g_tail_55
L_g_g1r_52:
    s_mov_b32 s65, 1
    s_branch L_g_loop1_54_e
.p2align 6
L_g_loop1_54:
    s_mov_b32 s65, 0
L_g_loop1_54_e:
    s_barrier
    ds_read_b32 v14, v15
    s_bitcmp1_b32 s67, 1
    s_cbranch_scc0 L_g_nfl_69
    s_cmp_lg_u32 s44, 4
    s_cbranch_scc1 L_g_nfl_69_d
    s_sub_u32 s59, s60, 1
    v_mov_b32 v10, s59
    buffer_store_dword v10, v115, s[12:15], s52 offen sc1
L_g_nfl_69_d:
    s_waitcnt lgkmcnt(0)
    v_readfirstlane_b32 s66, v14
    ds_read_b128 v[80:83], v5 offset:0
    ds_read_b128 v[84:87], v5 offset:1024
    ds_read_b128 v[88:91], v5 offset:2048
    ds_read_b128 v[92:95], v5 offset:3072
    s_cmp_le_u32 s62, s60
    s_cbranch_scc1 L_g_dp_74_l
L_g_dp_74_a:
    s_cmp_ge_u32 s62, s66
    s_cbranch_scc1 L_g_dp_74_d
    s_add_u32 s47, s61, 4096
    s_mov_b32 m0, s64
    s_add_u32 s62, s62, 1
    buffer_load_dwordx4 v3, s[12:15], s61 offen offset:0 sc1 lds
    buffer_load_dwordx4 v3, s[12:15], s61 offen offset:1024 sc1 lds
    buffer_load_dwordx4 v3, s[12:15], s61 offen offset:2048 sc1 lds
    buffer_load_dwordx4 v3, s[12:15], s61 offen offset:3072 sc1 lds
    s_add_u32 m0, s64, 4096
    s_add_u32 s61, s61, 65536
    buffer_load_dwordx4 v3, s[12:15], s47 offen offset:0 sc1 lds
    buffer_load_dwordx4 v3, s[12:15], s47 offen offset:1024 sc1 lds
    buffer_load_dwordx4 v3, s[12:15], s47 offen offset:2048 sc1 lds
    buffer_load_dwordx4 v3, s[12:15], s47 offen offset:3072 sc1 lds
    s_xor_b32 s64, s64, 0x10000
L_g_dp_74_d:
    s_bitcmp1_b32 s67, 0
    s_cbranch_scc0 L_g_nep_70
    s_waitcnt lgkmcnt(0)
    v_add_f32 v80, v80, v16
    v_add_f32 v81, v81, v17
    v_add_f32 v82, v82, v18
    v_add_f32 v83, v83, v19
    v_add_f32 v84, v84, v20
    v_add_f32 v85, v85, v21
    v_add_f32 v86, v86, v22
    v_add_f32 v87, v87, v23
    v_add_f32 v88, v88, v24
    v_add_f32 v89, v89, v25
    v_add_f32 v90, v90, v26
    v_add_f32 v91, v91, v27
    v_add_f32 v92, v92, v28
    v_add_f32 v93, v93, v29
    v_add_f32 v94, v94, v30
    v_add_f32 v95, v95, v31
    v_cvt_pk_bf16_f32 v104, v80, v81
    v_cvt_pk_bf16_f32 v105, v82, v83
    v_cvt_pk_bf16_f32 v106, v84, v85
    v_cvt_pk_bf16_f32 v107, v86, v87
    buffer_store_dwordx4 v[104:107], v8, s[12:15], s63 offen sc1
    v_cvt_pk_bf16_f32 v108, v88, v89
    v_cvt_pk_bf16_f32 v109, v90, v91
    v_cvt_pk_bf16_f32 v110, v92, v93
    v_cvt_pk_bf16_f32 v111, v94, v95
    buffer_store_dwordx4 v[108:111], v9, s[12:15], s63 offen sc1
    s_add_u32 s63, s63, 786432
    s_cmp_lg_u32 s53, 2
    s_cbranch_scc1 L_g_pf_75
    s_lshl_b32 s73, s58, 1
    buffer_store_dwordx4 v[116:119], v64, s[12:15], s58 offen sc1
    buffer_store_dwordx4 v[116:119], v65, s[12:15], s73 offen sc1
    buffer_store_dwordx4 v[116:119], v68, s[12:15], s73 offen sc1
    s_add_u32 s58, s58, 131072
L_g_pf_75:
    s_cmp_le_u32 s60, 2
    s_cbranch_scc1 L_g_nep_70_e
L_g_nep_70:
    s_cmp_lg_u32 s65, 0
    s_cbranch_scc1 L_g_nw1_71
    ds_read_b128 v[32:35], v4 offset:0
    ds_read_b128 v[36:39], v4 offset:256
    ds_read_b128 v[40:43], v4 offset:2048
    ds_read_b128 v[44:47], v4 offset:2304
    ds_read_b128 v[48:51], v4 offset:4096
    ds_read_b128 v[52:55], v4 offset:4352
    ds_read_b128 v[56:59], v4 offset:6144
    ds_read_b128 v[60:63], v4 offset:6400
    s_barrier
L_g_jn_73:
    s_setprio 1
    s_waitcnt lgkmcnt(6)
    v_mfma_f32_16x16x32_bf16 v[16:19], a[0:3], v[32:35], 0
    v_mfma_f32_16x16x32_bf16 v[20:23], a[4:7], v[32:35], 0
    ds_read_b128 v[32:35], v4 offset:8192
    v_mfma_f32_16x16x32_bf16 v[28:31], a[4:7], v[36:39], 0
    v_mfma_f32_16x16x32_bf16 v[24:27], a[0:3], v[36:39], 0
    ds_read_b128 v[36:39], v4 offset:8448
    s_waitcnt lgkmcnt(6)
    v_mfma_f32_16x16x32_bf16 v[16:19], a[8:11], v[40:43], v[16:19]
    v_mfma_f32_16x16x32_bf16 v[20:23], a[12:15], v[40:43], v[20:23]
    ds_read_b128 v[40:43], v4 offset:10240
    v_mfma_f32_16x16x32_bf16 v[28:31], a[12:15], v[44:47], v[28:31]
    v_mfma_f32_16x16x32_bf16 v[24:27], a[8:11], v[44:47], v[24:27]
    ds_read_b128 v[44:47], v4 offset:10496
    s_waitcnt lgkmcnt(6)
    v_mfma_f32_16x16x32_bf16 v[16:19], a[16:19], v[48:51], v[16:19]
    v_mfma_f32_16x16x32_bf16 v[20:23], a[20:23], v[48:51], v[20:23]
    ds_read_b128 v[48:51], v4 offset:12288
    v_mfma_f32_16x16x32_bf16 v[28:31], a[20:23], v[52:55], v[28:31]
    v_mfma_f32_16x16x32_bf16 v[24:27], a[16:19], v[52:55], v[24:27]
    ds_read_b128 v[52:55], v4 offset:12544
    s_waitcnt lgkmcnt(6)
    v_mfma_f32_16x16x32_bf16 v[16:19], a[24:27], v[56:59], v[16:19]
    v_mfma_f32_16x16x32_bf16 v[20:23], a[28:31], v[56:59], v[20:23]
    ds_read_b128 v[56:59], v4 offset:14336
    v_mfma_f32_16x16x32_bf16 v[28:31], a[28:31], v[60:63], v[28:31]
    v_mfma_f32_16x16x32_bf16 v[24:27], a[24:27], v[60:63], v[24:27]
    ds_read_b128 v[60:63], v4 offset:14592
    s_waitcnt lgkmcnt(6)
    v_mfma_f32_16x16x32_bf16 v[16:19], a[32:35], v[32:35], v[16:19]
    v_mfma_f32_16x16x32_bf16 v[20:23], a[36:39], v[32:35], v[20:23]
    ds_read_b128 v[32:35], v4 offset:16384
    v_mfma_f32_16x16x32_bf16 v[28:31], a[36:39], v[36:39], v[28:31]
    v_mfma_f32_16x16x32_bf16 v[24:27], a[32:35], v[36:39], v[24:27]
    ds_read_b128 v[36:39], v4 offset:16640
    s_waitcnt lgkmcnt(6)
    v_mfma_f32_16x16x32_bf16 v[16:19], a[40:43], v[40:43], v[16:19]
    v_mfma_f32_16x16x32_bf16 v[20:23], a[44:47], v[40:43], v[20:23]
    ds_read_b128 v[40:43], v4 offset:18432
    v_mfma_f32_16x16x32_bf16 v[28:31], a[44:47], v[44:47], v[28:31]
    v_mfma_f32_16x16x32_bf16 v[24:27], a[40:43], v[44:47], v[24:27]
    ds_read_b128 v[44:47], v4 offset:18688
    s_waitcnt lgkmcnt(6)
    v_mfma_f32_16x16x32_bf16 v[16:19], a[48:51], v[48:51], v[16:19]
    v_mfma_f32_16x16x32_bf16 v[20:23], a[52:55], v[48:51], v[20:23]
    ds_read_b128 v[48:51], v4 offset:20480
    v_mfma_f32_16x16x32_bf16 v[28:31], a[52:55], v[52:55], v[28:31]
    v_mfma_f32_16x16x32_bf16 v[24:27], a[48:51], v[52:55], v[24:27]
    ds_read_b128 v[52:55], v4 offset:20736
    s_waitcnt lgkmcnt(6)
    v_mfma_f32_16x16x32_bf16 v[16:19], a[56:59], v[56:59], v[16:19]
    v_mfma_f32_16x16x32_bf16 v[20:23], a[60:63], v[56:59], v[20:23]
    ds_read_b128 v[56:59], v4 offset:22528
    v_mfma_f32_16x16x32_bf16 v[28:31], a[60:63], v[60:63], v[28:31]
    v_mfma_f32_16x16x32_bf16 v[24:27], a[56:59], v[60:63], v[24:27]
    ds_read_b128 v[60:63], v4 offset:22784
    s_waitcnt lgkmcnt(6)
    v_mfma_f32_16x16x32_bf16 v[16:19], a[64:67], v[32:35], v[16:19]
    v_mfma_f32_16x16x32_bf16 v[20:23], a[68:71], v[32:35], v[20:23]
    ds_read_b128 v[32:35], v4 offset:24576
    v_mfma_f32_16x16x32_bf16 v[28:31], a[68:71], v[36:39], v[28:31]
    v_mfma_f32_16x16x32_bf16 v[24:27], a[64:67], v[36:39], v[24:27]
    ds_read_b128 v[36:39], v4 offset:24832
    s_waitcnt lgkmcnt(6)
    v_mfma_f32_16x16x32_bf16 v[16:19], a[72:75], v[40:43], v[16:19]
    v_mfma_f32_16x16x32_bf16 v[20:23], a[76:79], v[40:43], v[20:23]
    ds_read_b128 v[40:43], v4 offset:26624
    v_mfma_f32_16x16x32_bf16 v[28:31], a[76:79], v[44:47], v[28:31]
    v_mfma_f32_16x16x32_bf16 v[24:27], a[72:75], v[44:47], v[24:27]
    ds_read_b128 v[44:47], v4 offset:26880
    s_waitcnt lgkmcnt(6)
    v_mfma_f32_16x16x32_bf16 v[16:19], a[80:83], v[48:51], v[16:19]
    v_mfma_f32_16x16x32_bf16 v[20:23], a[84:87], v[48:51], v[20:23]
    ds_read_b128 v[48:51], v4 offset:28672
    v_mfma_f32_16x16x32_bf16 v[28:31], a[84:87], v[52:55], v[28:31]
    v_mfma_f32_16x16x32_bf16 v[24:27], a[80:83], v[52:55], v[24:27]
    ds_read_b128 v[52:55], v4 offset:28928
    s_waitcnt lgkmcnt(6)
    v_mfma_f32_16x16x32_bf16 v[16:19], a[88:91], v[56:59], v[16:19]
    v_mfma_f32_16x16x32_bf16 v[20:23], a[92:95], v[56:59], v[20:23]
    ds_read_b128 v[56:59], v4 offset:30720
    v_mfma_f32_16x16x32_bf16 v[28:31], a[92:95], v[60:63], v[28:31]
    v_mfma_f32_16x16x32_bf16 v[24:27], a[88:91], v[60:63], v[24:27]
    ds_read_b128 v[60:63], v4 offset:30976
    s_waitcnt lgkmcnt(6)
    v_mfma_f32_16x16x32_bf16 v[16:19], a[96:99], v[32:35], v[16:19]
    v_mfma_f32_16x16x32_bf16 v[20:23], a[100:103], v[32:35], v[20:23]
    v_mfma_f32_16x16x32_bf16 v[28:31], a[100:103], v[36:39], v[28:31]
    v_mfma_f32_16x16x32_bf16 v[24:27], a[96:99], v[36:39], v[24:27]
    s_waitcnt lgkmcnt(4)
    v_mfma_f32_16x16x32_bf16 v[16:19], a[104:107], v[40:43], v[16:19]
    v_mfma_f32_16x16x32_bf16 v[20:23], a[108:111], v[40:43], v[20:23]
    v_mfma_f32_16x16x32_bf16 v[28:31], a[108:111], v[44:47], v[28:31]
    v_mfma_f32_16x16x32_bf16 v[24:27], a[104:107], v[44:47], v[24:27]
    s_waitcnt lgkmcnt(2)
    v_mfma_f32_16x16x32_bf16 v[16:19], a[112:115], v[48:51], v[16:19]
    v_mfma_f32_16x16x32_bf16 v[20:23], a[116:119], v[48:51], v[20:23]
    v_mfma_f32_16x16x32_bf16 v[28:31], a[116:119], v[52:55], v[28:31]
    v_mfma_f32_16x16x32_bf16 v[24:27], a[112:115], v[52:55], v[24:27]
    s_waitcnt lgkmcnt(0)
    v_mfma_f32_16x16x32_bf16 v[16:19], a[120:123], v[56:59], v[16:19]
    v_mfma_f32_16x16x32_bf16 v[20:23], a[124:127], v[56:59], v[20:23]
    v_mfma_f32_16x16x32_bf16 v[28:31], a[124:127], v[60:63], v[28:31]
    v_mfma_f32_16x16x32_bf16 v[24:27], a[120:123], v[60:63], v[24:27]
    v_xor_b32 v4, 0x10000, v4
    s_setprio 0
    s_waitcnt vmcnt(0)
    s_lshl_b32 s67, s67, 1
    s_or_b32 s67, s67, 1
    s_add_u32 s60, s60, 1
    s_cmp_gt_u32 s66, s60
    s_cbranch_scc1 L_g_loop1_54
    s_barrier
    ds_read_b32 v14, v15
    s_waitcnt lgkmcnt(0)
    v_readfirstlane_b32 s66, v14
    s_barrier
    s_mov_b32 s69, 0
    s_cmp_gt_u32 s62, s60
    s_cbranch_scc1 L_g_nd_76
    s_cmp_ge_u32 s62, s66
    s_cbranch_scc1 L_g_nd_76
    s_add_u32 s47, s61, 4096
    s_add_u32 m0, s64, 0
    s_nop 0
    buffer_load_dwordx4 v3, s[12:15], s61 offen offset:0 sc1 lds
    buffer_load_dwordx4 v3, s[12:15], s61 offen offset:1024 sc1 lds
    buffer_load_dwordx4 v3, s[12:15], s61 offen offset:2048 sc1 lds
    buffer_load_dwordx4 v3, s[12:15], s61 offen offset:3072 sc1 lds
    s_add_u32 m0, s64, 4096
    s_nop 0
    buffer_load_dwordx4 v3, s[12:15], s47 offen offset:0 sc1 lds
    buffer_load_dwordx4 v3, s[12:15], s47 offen offset:1024 sc1 lds
    buffer_load_dwordx4 v3, s[12:15], s47 offen offset:2048 sc1 lds
    buffer_load_dwordx4 v3, s[12:15], s47 offen offset:3072 sc1 lds
    s_add_u32 s61, s61, 65536
    s_add_u32 s62, s62, 1
    s_xor_b32 s64, s64, 0x10000
    s_mov_b32 s69, 1
L_g_nd_76:
    s_sub_u32 s59, s60, 1
    ds_read_b128 v[80:83], v5 offset:0
    ds_read_b128 v[84:87], v5 offset:1024
    ds_read_b128 v[88:91], v5 offset:2048
    ds_read_b128 v[92:95], v5 offset:3072
    s_nop 7
    s_waitcnt lgkmcnt(3)
    v_add_f32 v80, v80, v16
    v_add_f32 v81, v81, v17
    v_add_f32 v82, v82, v18
    v_add_f32 v83, v83, v19
    s_waitcnt lgkmcnt(2)
    v_add_f32 v84, v84, v20
    v_add_f32 v85, v85, v21
    v_add_f32 v86, v86, v22
    v_add_f32 v87, v87, v23
    s_waitcnt lgkmcnt(1)
    v_add_f32 v88, v88, v24
    v_add_f32 v89, v89, v25
    v_add_f32 v90, v90, v26
    v_add_f32 v91, v91, v27
    s_waitcnt lgkmcnt(0)
    v_add_f32 v92, v92, v28
    v_add_f32 v93, v93, v29
    v_add_f32 v94, v94, v30
    v_add_f32 v95, v95, v31
    v_cvt_pk_bf16_f32 v104, v80, v81
    v_cvt_pk_bf16_f32 v105, v82, v83
    v_cvt_pk_bf16_f32 v106, v84, v85
    v_cvt_pk_bf16_f32 v107, v86, v87
    buffer_store_dwordx4 v[104:107], v8, s[12:15], s63 offen sc1
    v_cvt_pk_bf16_f32 v108, v88, v89
    v_cvt_pk_bf16_f32 v109, v90, v91
    v_cvt_pk_bf16_f32 v110, v92, v93
    v_cvt_pk_bf16_f32 v111, v94, v95
    buffer_store_dwordx4 v[108:111], v9, s[12:15], s63 offen sc1
    s_add_u32 s63, s63, 786432
    s_cmp_lg_u32 s53, 2
    s_cbranch_scc1 L_g_pf_77
    s_lshl_b32 s73, s58, 1
    buffer_store_dwordx4 v[116:119], v64, s[12:15], s58 offen sc1
    buffer_store_dwordx4 v[116:119], v65, s[12:15], s73 offen sc1
    buffer_store_dwordx4 v[116:119], v68, s[12:15], s73 offen sc1
    s_add_u32 s58, s58, 131072
L_g_pf_77:
    s_mov_b32 s67, 0
    s_mov_b32 s71, 1
    s_cmp_gt_u32 s66, s60
    s_cbranch_scc1 L_g_g1r_52
    v_mov_b32 v10, 1
    s_mov_b64 exec, 1
    s_waitcnt vmcnt(0)
    ds_add_rtn_u32 v10, v15, v10 offset:4
    s_waitcnt lgkmcnt(0)
    v_readfirstlane_b32 s46, v10
    s_mov_b64 exec, -1
    s_mov_b32 s71, 0
    s_sub_u32 s59, s60, 1
    s_cmp_lg_u32 s46, s68
    s_cbranch_scc1 L_g_df_78
    v_mov_b32 v10, s59
    v_add_u32 v10, 1, v10
    v_mov_b32 v11, 0
    s_mov_b64 exec, 1
    buffer_store_dword v10, v11, s[12:15], s52 offen sc1
    s_mov_b64 exec, -1
L_sf_79:
L_g_df_78:
    s_add_u32 s68, s68, 4
    s_cmp_gt_u32 s66, s60
    s_cbranch_scc1 L_g_g1r_52
L_g_tail_55:
    s_cmp_lt_u32 s60, s75
    s_cbranch_scc1 L_g_restart_50
    s_waitcnt vmcnt(0)
    s_barrier
    s_branch L_w_p2_11
L_g_dp_67_l:
    s_cmp_ge_u32 s62, s66
    s_cbranch_scc1 L_g_dp_67_d
    s_mov_b32 s65, 1
    s_add_u32 s47, s61, 4096
    s_mov_b32 m0, s64
    s_add_u32 s62, s62, 1
    buffer_load_dwordx4 v3, s[12:15], s61 offen offset:0 sc1 lds
    buffer_load_dwordx4 v3, s[12:15], s61 offen offset:1024 sc1 lds
    buffer_load_dwordx4 v3, s[12:15], s61 offen offset:2048 sc1 lds
    buffer_load_dwordx4 v3, s[12:15], s61 offen offset:3072 sc1 lds
    s_add_u32 m0, s64, 4096
    s_add_u32 s61, s61, 65536
    buffer_load_dwordx4 v3, s[12:15], s47 offen offset:0 sc1 lds
    buffer_load_dwordx4 v3, s[12:15], s47 offen offset:1024 sc1 lds
    buffer_load_dwordx4 v3, s[12:15], s47 offen offset:2048 sc1 lds
    buffer_load_dwordx4 v3, s[12:15], s47 offen offset:3072 sc1 lds
    s_xor_b32 s64, s64, 0x10000
    s_branch L_g_dp_67_a
L_g_nw_65:
    s_waitcnt vmcnt(0) lgkmcnt(0)
    s_cmp_lg_u32 s44, 0
    s_cbranch_scc1 L_g_nl_80
    s_add_u32 s54, s60, 1
    v_add_u32 v12, s54, v113
    v_and_b32 v13, 7, v12
    v_lshl_add_u32 v13, v13, 9, v7
    buffer_load_dword v11, v13, s[12:15], 0 offen sc1
L_g_nl_80:
    s_branch L_g_loop0_53_l
L_g_nfl_69:
    s_cmp_eq_u32 s71, 0
    s_cbranch_scc1 L_g_nfl_69_d
    v_mov_b32 v10, 1
    s_mov_b64 exec, 1
    s_waitcnt vmcnt(0)
    ds_add_rtn_u32 v10, v15, v10 offset:4
    s_waitcnt lgkmcnt(0)
    v_readfirstlane_b32 s46, v10
    s_mov_b64 exec, -1
    s_mov_b32 s71, 0
    s_sub_u32 s59, s60, 1
    s_cmp_lg_u32 s46, s68
    s_cbranch_scc1 L_g_df_81
    v_mov_b32 v10, s59
    v_add_u32 v10, 1, v10
    v_mov_b32 v11, 0
    s_mov_b64 exec, 1
    buffer_store_dword v10, v11, s[12:15], s52 offen sc1
    s_mov_b64 exec, -1
L_sf_82:
L_g_df_81:
    s_add_u32 s68, s68, 4
    s_mov_b32 s65, 2
    s_branch L_g_nfl_69_d
L_g_dp_74_l:
    s_cmp_ge_u32 s62, s66
    s_cbranch_scc1 L_g_dp_74_d
    s_or_b32 s65, s65, 1
    s_add_u32 s47, s61, 4096
    s_mov_b32 m0, s64
    s_add_u32 s62, s62, 1
    buffer_load_dwordx4 v3, s[12:15], s61 offen offset:0 sc1 lds
    buffer_load_dwordx4 v3, s[12:15], s61 offen offset:1024 sc1 lds
    buffer_load_dwordx4 v3, s[12:15], s61 offen offset:2048 sc1 lds
    buffer_load_dwordx4 v3, s[12:15], s61 offen offset:3072 sc1 lds
    s_add_u32 m0, s64, 4096
    s_add_u32 s61, s61, 65536
    buffer_load_dwordx4 v3, s[12:15], s47 offen offset:0 sc1 lds
    buffer_load_dwordx4 v3, s[12:15], s47 offen offset:1024 sc1 lds
    buffer_load_dwordx4 v3, s[12:15], s47 offen offset:2048 sc1 lds
    buffer_load_dwordx4 v3, s[12:15], s47 offen offset:3072 sc1 lds
    s_xor_b32 s64, s64, 0x10000
    s_branch L_g_dp_74_a
L_g_nep_70_e:
    v_mov_b32 v10, 1
    s_mov_b64 exec, 1
    s_waitcnt vmcnt(0)
    ds_add_rtn_u32 v10, v15, v10 offset:4
    s_waitcnt lgkmcnt(0)
    v_readfirstlane_b32 s46, v10
    s_mov_b64 exec, -1
    s_mov_b32 s71, 0
    s_sub_u32 s59, s60, 1
    s_cmp_lg_u32 s46, s68
    s_cbranch_scc1 L_g_df_83
    v_mov_b32 v10, s59
    v_add_u32 v10, 1, v10
    v_mov_b32 v11, 0
    s_mov_b64 exec, 1
    buffer_store_dword v10, v11, s[12:15], s52 offen sc1
    s_mov_b64 exec, -1
L_sf_84:
L_g_df_83:
    s_add_u32 s68, s68, 4
    s_branch L_g_nep_70
L_g_nw1_71:
    s_cmp_eq_u32 s65, 2
    s_cbranch_scc1 L_g_nw1_71_w
    s_waitcnt vmcnt(0)
L_g_nw1_71_w:
    s_barrier
    ds_read_b128 v[32:35], v4 offset:0
    ds_read_b128 v[36:39], v4 offset:256
    ds_read_b128 v[40:43], v4 offset:2048
    ds_read_b128 v[44:47], v4 offset:2304
    ds_read_b128 v[48:51], v4 offset:4096
    ds_read_b128 v[52:55], v4 offset:4352
    ds_read_b128 v[56:59], v4 offset:6144
    ds_read_b128 v[60:63], v4 offset:6400
    s_branch L_g_jn_73
L_w_p2_11:
    s_cmp_lg_u32 s44, 0
    s_cbranch_scc1 L_w_p2_11_h
    s_mov_b32 s47, 63
    s_cmp_eq_u32 s53, 0
    s_cbranch_scc1 L_w_p2_11_q
    s_sub_u32 s52, s52, s76
    v_mov_b32 v10, 1
    v_mov_b32 v11, 131072
    s_mov_b64 exec, 1
    buffer_atomic_add v10, v11, s[12:15], s52 offen sc0
    s_waitcnt vmcnt(0)
    v_readfirstlane_b32 s46, v10
    s_mov_b64 exec, -1
    s_mov_b32 s47, 63
    s_nop 1
    s_cmp_eq_u32 s46, 0
    s_cbranch_scc1 L_w_p2_11_h
L_w_p2_11_q:
    v_mov_b32 v10, s47
    v_add_u32 v10, 1, v10
    v_mov_b32 v11, 0
    s_mov_b64 exec, 1
    buffer_store_dword v10, v11, s[12:15], s52 offen sc1
    s_mov_b64 exec, -1
L_sf_85:
L_w_p2_11_h:
    s_cmp_eq_u32 s76, 0
    s_cbranch_scc1 L_w_p2_11_m
    s_cmp_eq_u32 s79, 1
    s_cbranch_scc1 L_w_h_17
    s_mov_b32 s79, 1
    s_cmp_lt_u32 s77, 14
    s_cselect_b32 s53, 2, s53
    s_cselect_b32 s48, s48, 3
    s_branch L_w_h_17_n
L_w_p2_11_m:
    s_cmp_lt_u32 s48, 8
    s_cselect_b32 s75, 58, 58
    s_cmp_lt_u32 s48, 4
    s_cselect_b32 s75, 64, s75
L_w_p2_11_r:
    s_lshr_b32 s42, s40, 1
    s_and_b32 s43, s40, 1
    s_lshl_b32 s43, s43, 2
    s_and_b32 s46, s48, 3
    s_add_u32 s43, s43, s46
    s_cmp_lt_u32 s48, 4
    s_cbranch_scc1 L_w_wo_12
    s_cmp_lt_u32 s48, 8
    s_cbranch_scc1 L_w_f2_13
    s_cmp_lg_u32 s43, 7
    s_cbranch_scc1 L_w_f1_14
    s_mov_b32 s43, 2
    s_cmp_eq_u32 s76, 0
    s_cbranch_scc1 L_w_c_16
    s_mov_b32 s43, 7
    s_mov_b32 s78, 1
L_w_f1_14_t:
    s_cmp_lt_u32 s41, 8
    s_cselect_b32 s74, 58, 61
    s_cselect_b32 s75, 61, 64
    s_add_u32 s43, s43, s74
    s_cmp_lt_u32 s43, s75
    s_cbranch_scc1 L_w_h_17_f
    s_branch L_c_done_1
L_w_f1_14_d:
    s_cmp_eq_u32 s76, 0
    s_cbranch_scc1 L_c_done_1
    s_and_b32 s42, s49, 3
    s_lshr_b32 s43, s49, 2
    s_mov_b32 s78, 64
    s_branch L_w_f1_14_t
L_replica:
    s_setprio 0
    s_barrier
    s_and_b32 s48, s41, 7
    s_add_u32 s48, s48, 4
    s_cmp_lt_u32 s41, 8
    s_cselect_b32 s74, 58, 61
    s_cselect_b32 s75, 61, 64
    s_cselect_b32 s76, 1, 2
    s_cselect_b32 s46, 58, 61
    s_cselect_b32 s47, 61, 64
    s_mul_i32 s76, s76, 65536
    s_cmp_lt_u32 s48, 8
    s_cselect_b32 s74, s46, s74
    s_cselect_b32 s75, s47, s75
    s_branch L_w_p2_11_r
L_w_f1_14:
    s_load_dwordx2 s[4:5], s[0:1], 64
    s_load_dwordx2 s[6:7], s[0:1], 72
    s_and_b32 s50, s44, 3
    s_lshr_b32 s51, s44, 2
    s_waitcnt lgkmcnt(0)
    s_mov_b32 s24, s4
    s_and_b32 s25, s5, 0xffff
    s_mov_b32 s26, 0x700000
    s_mov_b32 s27, 0x00020000
    s_mul_i32 s49, s42, 7
    s_add_u32 s49, s49, s43
    v_lshrrev_b32 v3, 4, v1
    v_and_b32 v4, 15, v1
    v_lshlrev_b32 v5, 2, v3
    v_xor_b32 v4, v4, v5
    v_mul_u32_u24 v3, 7168, v3
    v_lshl_add_u32 v3, v4, 4, v3
    s_mul_i32 s46, s51, 512
    s_mul_i32 s47, s50, 64
    s_add_u32 s46, s46, s47
    s_mul_i32 s46, s46, 7168
    s_lshl_b32 s47, s49, 8
    s_add_u32 s46, s46, s47
    s_lshl_b32 s45, s51, 16
    s_mul_i32 s47, s50, 16384
    s_add_u32 s45, s45, s47
    v_bfe_u32 v4, v1, 2, 2
    v_bfe_u32 v5, v1, 4, 1
    v_lshlrev_b32 v5, 1, v5
    v_bfe_u32 v6, v1, 1, 1
    v_add_u32 v5, v5, v6
    s_lshl_b32 s47, s50, 2
    v_add_u32 v5, s47, v5
    v_lshlrev_b32 v6, 2, v4
    v_xor_b32 v5, v5, v6
    v_lshlrev_b32 v5, 4, v5
    v_lshl_add_u32 v5, v4, 8, v5
    v_bfe_u32 v6, v1, 0, 1
    v_lshl_add_u32 v5, v6, 3, v5
    v_lshrrev_b32 v6, 5, v1
    v_mul_u32_u24 v6, 2048, v6
    v_add_u32 v5, v5, v6
    s_lshl_b32 s47, s51, 16
    v_add_u32 v5, s47, v5
    s_add_u32 m0, s45, 0
    s_add_u32 s47, s46, 0x0
    buffer_load_dwordx4 v3, s[24:27], s47 offen lds
    s_add_u32 m0, s45, 1024
    s_add_u32 s47, s46, 0x7000
    buffer_load_dwordx4 v3, s[24:27], s47 offen lds
    s_add_u32 m0, s45, 2048
    s_add_u32 s47, s46, 0xe000
    buffer_load_dwordx4 v3, s[24:27], s47 offen lds
    s_add_u32 m0, s45, 3072
    s_add_u32 s47, s46, 0x15000
    buffer_load_dwordx4 v3, s[24:27], s47 offen lds
    s_add_u32 m0, s45, 4096
    s_add_u32 s47, s46, 0x1c000
    buffer_load_dwordx4 v3, s[24:27], s47 offen lds
    s_add_u32 m0, s45, 5120
    s_add_u32 s47, s46, 0x23000
    buffer_load_dwordx4 v3, s[24:27], s47 offen lds
    s_add_u32 m0, s45, 6144
    s_add_u32 s47, s46, 0x2a000
    buffer_load_dwordx4 v3, s[24:27], s47 offen lds
    s_add_u32 m0, s45, 7168
    s_add_u32 s47, s46, 0x31000
    buffer_load_dwordx4 v3, s[24:27], s47 offen lds
    s_add_u32 m0, s45, 8192
    s_add_u32 s47, s46, 0x38000
    buffer_load_dwordx4 v3, s[24:27], s47 offen lds
    s_add_u32 m0, s45, 9216
    s_add_u32 s47, s46, 0x3f000
    buffer_load_dwordx4 v3, s[24:27], s47 offen lds
    s_add_u32 m0, s45, 10240
    s_add_u32 s47, s46, 0x46000
    buffer_load_dwordx4 v3, s[24:27], s47 offen lds
    s_add_u32 m0, s45, 11264
    s_add_u32 s47, s46, 0x4d000
    buffer_load_dwordx4 v3, s[24:27], s47 offen lds
    s_add_u32 m0, s45, 12288
    s_add_u32 s47, s46, 0x54000
    buffer_load_dwordx4 v3, s[24:27], s47 offen lds
    s_add_u32 m0, s45, 13312
    s_add_u32 s47, s46, 0x5b000
    buffer_load_dwordx4 v3, s[24:27], s47 offen lds
    s_add_u32 m0, s45, 14336
    s_add_u32 s47, s46, 0x62000
    buffer_load_dwordx4 v3, s[24:27], s47 offen lds
    s_add_u32 m0, s45, 15360
    s_add_u32 s47, s46, 0x69000
    buffer_load_dwordx4 v3, s[24:27], s47 offen lds
    s_waitcnt vmcnt(0)
    s_barrier
    ds_read_b64_tr_b16 a[0:1], v5 offset:0
    ds_read_b64_tr_b16 a[2:3], v5 offset:1024
    ds_read_b64_tr_b16 a[4:5], v5 offset:4096
    ds_read_b64_tr_b16 a[6:7], v5 offset:5120
    ds_read_b64_tr_b16 a[8:9], v5 offset:8192
    ds_read_b64_tr_b16 a[10:11], v5 offset:9216
    ds_read_b64_tr_b16 a[12:13], v5 offset:12288
    ds_read_b64_tr_b16 a[14:15], v5 offset:13312
    s_waitcnt lgkmcnt(0)
    ds_read_b64_tr_b16 a[16:17], v5 offset:16384
    ds_read_b64_tr_b16 a[18:19], v5 offset:17408
    ds_read_b64_tr_b16 a[20:21], v5 offset:20480
    ds_read_b64_tr_b16 a[22:23], v5 offset:21504
    ds_read_b64_tr_b16 a[24:25], v5 offset:24576
    ds_read_b64_tr_b16 a[26:27], v5 offset:25600
    ds_read_b64_tr_b16 a[28:29], v5 offset:28672
    ds_read_b64_tr_b16 a[30:31], v5 offset:29696
    s_waitcnt lgkmcnt(0)
    ds_read_b64_tr_b16 a[32:33], v5 offset:32768
    ds_read_b64_tr_b16 a[34:35], v5 offset:33792
    ds_read_b64_tr_b16 a[36:37], v5 offset:36864
    ds_read_b64_tr_b16 a[38:39], v5 offset:37888
    ds_read_b64_tr_b16 a[40:41], v5 offset:40960
    ds_read_b64_tr_b16 a[42:43], v5 offset:41984
    ds_read_b64_tr_b16 a[44:45], v5 offset:45056
    ds_read_b64_tr_b16 a[46:47], v5 offset:46080
    s_waitcnt lgkmcnt(0)
    ds_read_b64_tr_b16 a[48:49], v5 offset:49152
    ds_read_b64_tr_b16 a[50:51], v5 offset:50176
    ds_read_b64_tr_b16 a[52:53], v5 offset:53248
    ds_read_b64_tr_b16 a[54:55], v5 offset:54272
    ds_read_b64_tr_b16 a[56:57], v5 offset:57344
    ds_read_b64_tr_b16 a[58:59], v5 offset:58368
    ds_read_b64_tr_b16 a[60:61], v5 offset:61440
    ds_read_b64_tr_b16 a[62:63], v5 offset:62464
    s_waitcnt lgkmcnt(0)
    s_waitcnt lgkmcnt(0)
    s_barrier
    s_add_u32 m0, s45, 0
    s_add_u32 s47, s46, 0x1c0000
    buffer_load_dwordx4 v3, s[24:27], s47 offen lds
    s_add_u32 m0, s45, 1024
    s_add_u32 s47, s46, 0x1c7000
    buffer_load_dwordx4 v3, s[24:27], s47 offen lds
    s_add_u32 m0, s45, 2048
    s_add_u32 s47, s46, 0x1ce000
    buffer_load_dwordx4 v3, s[24:27], s47 offen lds
    s_add_u32 m0, s45, 3072
    s_add_u32 s47, s46, 0x1d5000
    buffer_load_dwordx4 v3, s[24:27], s47 offen lds
    s_add_u32 m0, s45, 4096
    s_add_u32 s47, s46, 0x1dc000
    buffer_load_dwordx4 v3, s[24:27], s47 offen lds
    s_add_u32 m0, s45, 5120
    s_add_u32 s47, s46, 0x1e3000
    buffer_load_dwordx4 v3, s[24:27], s47 offen lds
    s_add_u32 m0, s45, 6144
    s_add_u32 s47, s46, 0x1ea000
    buffer_load_dwordx4 v3, s[24:27], s47 offen lds
    s_add_u32 m0, s45, 7168
    s_add_u32 s47, s46, 0x1f1000
    buffer_load_dwordx4 v3, s[24:27], s47 offen lds
    s_add_u32 m0, s45, 8192
    s_add_u32 s47, s46, 0x1f8000
    buffer_load_dwordx4 v3, s[24:27], s47 offen lds
    s_add_u32 m0, s45, 9216
    s_add_u32 s47, s46, 0x1ff000
    buffer_load_dwordx4 v3, s[24:27], s47 offen lds
    s_add_u32 m0, s45, 10240
    s_add_u32 s47, s46, 0x206000
    buffer_load_dwordx4 v3, s[24:27], s47 offen lds
    s_add_u32 m0, s45, 11264
    s_add_u32 s47, s46, 0x20d000
    buffer_load_dwordx4 v3, s[24:27], s47 offen lds
    s_add_u32 m0, s45, 12288
    s_add_u32 s47, s46, 0x214000
    buffer_load_dwordx4 v3, s[24:27], s47 offen lds
    s_add_u32 m0, s45, 13312
    s_add_u32 s47, s46, 0x21b000
    buffer_load_dwordx4 v3, s[24:27], s47 offen lds
    s_add_u32 m0, s45, 14336
    s_add_u32 s47, s46, 0x222000
    buffer_load_dwordx4 v3, s[24:27], s47 offen lds
    s_add_u32 m0, s45, 15360
    s_add_u32 s47, s46, 0x229000
    buffer_load_dwordx4 v3, s[24:27], s47 offen lds
    s_waitcnt vmcnt(0)
    s_barrier
    ds_read_b64_tr_b16 a[64:65], v5 offset:0
    ds_read_b64_tr_b16 a[66:67], v5 offset:1024
    ds_read_b64_tr_b16 a[68:69], v5 offset:4096
    ds_read_b64_tr_b16 a[70:71], v5 offset:5120
    ds_read_b64_tr_b16 a[72:73], v5 offset:8192
    ds_read_b64_tr_b16 a[74:75], v5 offset:9216
    ds_read_b64_tr_b16 a[76:77], v5 offset:12288
    ds_read_b64_tr_b16 a[78:79], v5 offset:13312
    s_waitcnt lgkmcnt(0)
    ds_read_b64_tr_b16 a[80:81], v5 offset:16384
    ds_read_b64_tr_b16 a[82:83], v5 offset:17408
    ds_read_b64_tr_b16 a[84:85], v5 offset:20480
    ds_read_b64_tr_b16 a[86:87], v5 offset:21504
    ds_read_b64_tr_b16 a[88:89], v5 offset:24576
    ds_read_b64_tr_b16 a[90:91], v5 offset:25600
    ds_read_b64_tr_b16 a[92:93], v5 offset:28672
    ds_read_b64_tr_b16 a[94:95], v5 offset:29696
    s_waitcnt lgkmcnt(0)
    ds_read_b64_tr_b16 a[96:97], v5 offset:32768
    ds_read_b64_tr_b16 a[98:99], v5 offset:33792
    ds_read_b64_tr_b16 a[100:101], v5 offset:36864
    ds_read_b64_tr_b16 a[102:103], v5 offset:37888
    ds_read_b64_tr_b16 a[104:105], v5 offset:40960
    ds_read_b64_tr_b16 a[106:107], v5 offset:41984
    ds_read_b64_tr_b16 a[108:109], v5 offset:45056
    ds_read_b64_tr_b16 a[110:111], v5 offset:46080
    s_waitcnt lgkmcnt(0)
    ds_read_b64_tr_b16 a[112:113], v5 offset:49152
    ds_read_b64_tr_b16 a[114:115], v5 offset:50176
    ds_read_b64_tr_b16 a[116:117], v5 offset:53248
    ds_read_b64_tr_b16 a[118:119], v5 offset:54272
    ds_read_b64_tr_b16 a[120:121], v5 offset:57344
    ds_read_b64_tr_b16 a[122:123], v5 offset:58368
    ds_read_b64_tr_b16 a[124:125], v5 offset:61440
    ds_read_b64_tr_b16 a[126:127], v5 offset:62464
    s_waitcnt lgkmcnt(0)
    s_waitcnt lgkmcnt(0)
    s_barrier
    v_lshlrev_b32 v2, 4, v1
    s_mul_i32 s64, s44, 8192
    s_add_u32 s46, s64, 0xc00000
    v_add_u32 v3, s46, v2
    s_mul_i32 s46, s51, 32768
    v_add_u32 v4, s46, v2
    v_and_b32 v6, 15, v1
    v_lshlrev_b32 v6, 4, v6
    v_lshrrev_b32 v7, 4, v1
    v_lshl_add_u32 v6, v7, 9, v6
    s_lshl_b32 s46, s50, 12
    s_add_u32 s46, s46, 131072
    v_add_u32 v5, s46, v2
    v_and_b32 v7, 3, v1
    v_lshlrev_b32 v7, 7, v7
    v_add_u32 v7, 0x10ec00, v7
    s_lshl_b32 s46, s49, 13
    s_lshl_b32 s47, s50, 11
    s_add_u32 s46, s46, s47
    s_add_u32 s46, s46, 0x6000000
    v_add_u32 v8, s46, v2
    s_lshl_b32 s52, s49, 7
    s_add_u32 s52, s52, 0x106400
    s_add_u32 s52, s52, s76
    s_mov_b32 s28, s6
    s_and_b32 s29, s7, 0xffff
    s_mov_b32 s30, 0x1c00
    s_mov_b32 s31, 0x00020000
    s_lshl_b32 s46, s49, 8
    s_lshl_b32 s47, s50, 6
    s_add_u32 s46, s46, s47
    v_lshrrev_b32 v9, 5, v1
    v_lshlrev_b32 v9, 3, v9
    buffer_load_dwordx2 v[32:33], v9, s[28:31], s46 offen offset:0
    buffer_load_dwordx2 v[34:35], v9, s[28:31], s46 offen offset:16
    buffer_load_dwordx2 v[36:37], v9, s[28:31], s46 offen offset:32
    buffer_load_dwordx2 v[38:39], v9, s[28:31], s46 offen offset:48
    v_add_u32 v9, 1024, v8
    s_mov_b32 s56, 0xbdd2d3e8
    s_mov_b32 s57, 0xbdd2d3e8
    v_mov_b32 v112, 0xc0135761
    s_waitcnt vmcnt(0)
    v_lshlrev_b32 v64, 16, v32
    v_and_b32 v65, 0xffff0000, v32
    v_lshlrev_b32 v66, 16, v33
    v_and_b32 v67, 0xffff0000, v33
    v_lshlrev_b32 v68, 16, v34
    v_and_b32 v69, 0xffff0000, v34
    v_lshlrev_b32 v70, 16, v35
    v_and_b32 v71, 0xffff0000, v35
    v_lshlrev_b32 v72, 16, v36
    v_and_b32 v73, 0xffff0000, v36
    v_lshlrev_b32 v74, 16, v37
    v_and_b32 v75, 0xffff0000, v37
    v_lshlrev_b32 v76, 16, v38
    v_and_b32 v77, 0xffff0000, v38
    v_lshlrev_b32 v78, 16, v39
    v_and_b32 v79, 0xffff0000, v39
    s_mul_i32 s46, s43, 8192
    s_add_u32 s46, s46, 0xc00000
    s_mul_i32 s47, s42, 0
    s_add_u32 s46, s46, s47
    v_min_u32 v116, 63, v1
    v_lshlrev_b32 v116, 7, v116
    v_add_u32 v116, s46, v116
    s_mov_b32 s60, s74
    s_mul_i32 s61, s74, 65536
    s_mov_b32 s62, s74
    s_mul_i32 s63, s74, 229376
    s_mov_b32 s67, 0
    s_mov_b32 s68, 3
    s_mov_b32 s71, 0
    v_mov_b32 v15, 147456
    v_mov_b32 v14, 0
    ds_write_b32 v15, v14 offset:4
    ds_write_b32 v15, v14 offset:12
    ds_write_b32 v15, v14 offset:16
    v_mov_b32 v114, 1
    v_mov_b32 v115, 0
    v_lshrrev_b32 v113, 4, v1
    s_mov_b32 s72, 0
L_g_restart_86:
    s_cmp_lg_u32 s44, 0
    s_cbranch_scc1 L_g_nsp_87
    s_mov_b32 s70, 0
L_g_sp_93:
    s_add_u32 s54, s60, 0
    v_add_u32 v12, s54, v113
    v_mul_u32_u24 v13, 171, v12
    v_lshrrev_b32 v13, 9, v13
    v_mad_i32_i24 v13, v13, -3, v12
    v_lshl_add_u32 v13, v13, 9, v7
    buffer_load_dword v11, v13, s[12:15], 0 offen sc1
    s_waitcnt vmcnt(0)
    v_cmp_ge_u32 vcc, v12, v11
    s_add_u32 s70, s70, 1
    s_and_b32 s46, vcc_lo, 0xffff
    s_cbranch_scc0 L_g_sp_93_ok
    s_sleep 3
    s_cmp_lt_u32 s70, 524288
    s_cbranch_scc1 L_g_sp_93
    s_branch L_c_done_1
L_g_sp_93_ok:
    v_cmp_ge_u32 vcc, v12, v11
    s_nop 0
    s_ff1_i32_b64 s46, vcc
    s_lshr_b32 s46, s46, 4
    s_min_u32 s46, s46, 4
    s_add_u32 s46, s46, s54
    s_min_u32 s46, s46, s75
    v_mov_b32 v11, s46
    ds_write_b32 v15, v11
L_g_nsp_87:
    s_waitcnt lgkmcnt(0)
    s_barrier
    ds_read_b32 v14, v15
    s_waitcnt lgkmcnt(0)
    v_readfirstlane_b32 s66, v14
    s_nop 3
L_g_restart_86_go:
    s_mov_b32 s69, 0
    s_cmp_gt_u32 s62, s60
    s_cbranch_scc1 L_g_nd_94
    s_cmp_ge_u32 s62, s66
    s_cbranch_scc1 L_g_nd_94
    s_add_u32 s47, s61, 4096
    s_add_u32 m0, s64, 0
    s_nop 0
    buffer_load_dwordx4 v3, s[12:15], s61 offen offset:0 sc1 lds
    buffer_load_dwordx4 v3, s[12:15], s61 offen offset:1024 sc1 lds
    buffer_load_dwordx4 v3, s[12:15], s61 offen offset:2048 sc1 lds
    buffer_load_dwordx4 v3, s[12:15], s61 offen offset:3072 sc1 lds
    s_add_u32 m0, s64, 4096
    s_nop 0
    buffer_load_dwordx4 v3, s[12:15], s47 offen offset:0 sc1 lds
    buffer_load_dwordx4 v3, s[12:15], s47 offen offset:1024 sc1 lds
    buffer_load_dwordx4 v3, s[12:15], s47 offen offset:2048 sc1 lds
    buffer_load_dwordx4 v3, s[12:15], s47 offen offset:3072 sc1 lds
    s_add_u32 s61, s61, 65536
    s_add_u32 s62, s62, 1
    s_xor_b32 s64, s64, 0x10000
    s_mov_b32 s69, 1
L_g_nd_94:
    s_cmp_eq_u32 s51, 1
    s_cbranch_scc1 L_g_g1r_88
    s_add_u32 s59, s60, 1
    s_mov_b32 s69, 0
    s_cmp_gt_u32 s62, s59
    s_cbranch_scc1 L_g_nd_95
    s_cmp_ge_u32 s62, s66
    s_cbranch_scc1 L_g_nd_95
    s_add_u32 s47, s61, 4096
    s_add_u32 m0, s64, 0
    s_nop 0
    buffer_load_dwordx4 v3, s[12:15], s61 offen offset:0 sc1 lds
    buffer_load_dwordx4 v3, s[12:15], s61 offen offset:1024 sc1 lds
    buffer_load_dwordx4 v3, s[12:15], s61 offen offset:2048 sc1 lds
    buffer_load_dwordx4 v3, s[12:15], s61 offen offset:3072 sc1 lds
    s_add_u32 m0, s64, 4096
    s_nop 0
    buffer_load_dwordx4 v3, s[12:15], s47 offen offset:0 sc1 lds
    buffer_load_dwordx4 v3, s[12:15], s47 offen offset:1024 sc1 lds
    buffer_load_dwordx4 v3, s[12:15], s47 offen offset:2048 sc1 lds
    buffer_load_dwordx4 v3, s[12:15], s47 offen offset:3072 sc1 lds
    s_add_u32 s61, s61, 65536
    s_add_u32 s62, s62, 1
    s_xor_b32 s64, s64, 0x10000
    s_mov_b32 s69, 1
L_g_nd_95:
    s_cmp_eq_u32 s69, 1
    s_cbranch_scc1 L_g_w0_96
    s_waitcnt vmcnt(0)
L_g_w0_96:
    s_waitcnt vmcnt(8)
    s_cmp_lg_u32 s44, 0
    s_cbranch_scc1 L_g_nl_97
    s_add_u32 s54, s60, 1
    v_add_u32 v12, s54, v113
    v_mul_u32_u24 v13, 171, v12
    v_lshrrev_b32 v13, 9, v13
    v_mad_i32_i24 v13, v13, -3, v12
    v_lshl_add_u32 v13, v13, 9, v7
    buffer_load_dword v11, v13, s[12:15], 0 offen sc1
L_g_nl_97:
L_g_loop0_89_l:
    s_barrier
    ds_read_b128 v[32:35], v4 offset:0
    ds_read_b128 v[36:39], v4 offset:1024
    ds_read_b128 v[40:43], v4 offset:2048
    ds_read_b128 v[44:47], v4 offset:3072
    ds_read_b128 v[48:51], v4 offset:4096
    ds_read_b128 v[52:55], v4 offset:5120
    ds_read_b128 v[56:59], v4 offset:6144
    ds_read_b128 v[60:63], v4 offset:7168
    s_branch L_g_loop0_89_m
.p2align 6
L_g_loop0_89:
    s_barrier
L_g_loop0_89_m:
    s_setprio 2
    s_waitcnt lgkmcnt(6)
    v_mfma_f32_32x32x16_bf16 v[16:31], a[0:3], v[32:35], v[64:79]
    ds_read_b128 v[32:35], v4 offset:8192
    ds_read_b32 v14, v15
    v_mfma_f32_32x32x16_bf16 v[16:31], a[4:7], v[36:39], v[16:31]
    ds_read_b128 v[36:39], v4 offset:9216
    s_waitcnt lgkmcnt(6)
    v_mfma_f32_32x32x16_bf16 v[16:31], a[8:11], v[40:43], v[16:31]
    ds_read_b128 v[40:43], v4 offset:10240
    v_mfma_f32_32x32x16_bf16 v[16:31], a[12:15], v[44:47], v[16:31]
    ds_read_b128 v[44:47], v4 offset:11264
    s_waitcnt lgkmcnt(6)
    v_mfma_f32_32x32x16_bf16 v[16:31], a[16:19], v[48:51], v[16:31]
    ds_read_b128 v[48:51], v4 offset:12288
    v_mfma_f32_32x32x16_bf16 v[16:31], a[20:23], v[52:55], v[16:31]
    ds_read_b128 v[52:55], v4 offset:13312
    s_waitcnt lgkmcnt(6)
    v_mfma_f32_32x32x16_bf16 v[16:31], a[24:27], v[56:59], v[16:31]
    ds_read_b128 v[56:59], v4 offset:14336
    v_mfma_f32_32x32x16_bf16 v[16:31], a[28:31], v[60:63], v[16:31]
    ds_read_b128 v[60:63], v4 offset:15360
    s_waitcnt lgkmcnt(6)
    v_mfma_f32_32x32x16_bf16 v[16:31], a[32:35], v[32:35], v[16:31]
    ds_read_b128 v[32:35], v4 offset:16384
    v_mfma_f32_32x32x16_bf16 v[16:31], a[36:39], v[36:39], v[16:31]
    ds_read_b128 v[36:39], v4 offset:17408
    s_waitcnt lgkmcnt(6)
    v_mfma_f32_32x32x16_bf16 v[16:31], a[40:43], v[40:43], v[16:31]
    ds_read_b128 v[40:43], v4 offset:18432
    v_mfma_f32_32x32x16_bf16 v[16:31], a[44:47], v[44:47], v[16:31]
    ds_read_b128 v[44:47], v4 offset:19456
    s_waitcnt lgkmcnt(6)
    v_mfma_f32_32x32x16_bf16 v[16:31], a[48:51], v[48:51], v[16:31]
    ds_read_b128 v[48:51], v4 offset:20480
    v_mfma_f32_32x32x16_bf16 v[16:31], a[52:55], v[52:55], v[16:31]
    ds_read_b128 v[52:55], v4 offset:21504
    s_waitcnt lgkmcnt(6)
    v_mfma_f32_32x32x16_bf16 v[16:31], a[56:59], v[56:59], v[16:31]
    ds_read_b128 v[56:59], v4 offset:22528
    v_mfma_f32_32x32x16_bf16 v[16:31], a[60:63], v[60:63], v[16:31]
    ds_read_b128 v[60:63], v4 offset:23552
    s_waitcnt lgkmcnt(6)
    v_mfma_f32_32x32x16_bf16 v[16:31], a[64:67], v[32:35], v[16:31]
    ds_read_b128 v[32:35], v4 offset:24576
    v_mfma_f32_32x32x16_bf16 v[16:31], a[68:71], v[36:39], v[16:31]
    ds_read_b128 v[36:39], v4 offset:25600
    s_waitcnt lgkmcnt(6)
    v_mfma_f32_32x32x16_bf16 v[16:31], a[72:75], v[40:43], v[16:31]
    ds_read_b128 v[40:43], v4 offset:26624
    v_mfma_f32_32x32x16_bf16 v[16:31], a[76:79], v[44:47], v[16:31]
    ds_read_b128 v[44:47], v4 offset:27648
    s_waitcnt lgkmcnt(6)
    v_mfma_f32_32x32x16_bf16 v[16:31], a[80:83], v[48:51], v[16:31]
    ds_read_b128 v[48:51], v4 offset:28672
    v_mfma_f32_32x32x16_bf16 v[16:31], a[84:87], v[52:55], v[16:31]
    ds_read_b128 v[52:55], v4 offset:29696
    s_waitcnt lgkmcnt(6)
    v_mfma_f32_32x32x16_bf16 v[16:31], a[88:91], v[56:59], v[16:31]
    ds_read_b128 v[56:59], v4 offset:30720
    v_mfma_f32_32x32x16_bf16 v[16:31], a[92:95], v[60:63], v[16:31]
    ds_read_b128 v[60:63], v4 offset:31744
    s_waitcnt lgkmcnt(6)
    v_mfma_f32_32x32x16_bf16 v[16:31], a[96:99], v[32:35], v[16:31]
    v_mfma_f32_32x32x16_bf16 v[16:31], a[100:103], v[36:39], v[16:31]
    s_waitcnt lgkmcnt(4)
    v_mfma_f32_32x32x16_bf16 v[16:31], a[104:107], v[40:43], v[16:31]
    v_mfma_f32_32x32x16_bf16 v[16:31], a[108:111], v[44:47], v[16:31]
    s_waitcnt lgkmcnt(2)
    v_mfma_f32_32x32x16_bf16 v[16:31], a[112:115], v[48:51], v[16:31]
    v_mfma_f32_32x32x16_bf16 v[16:31], a[116:119], v[52:55], v[16:31]
    s_waitcnt lgkmcnt(0)
    v_mfma_f32_32x32x16_bf16 v[16:31], a[120:123], v[56:59], v[16:31]
    v_mfma_f32_32x32x16_bf16 v[16:31], a[124:127], v[60:63], v[16:31]
    v_xor_b32 v4, 0x10000, v4
    s_setprio 0
    s_waitcnt vmcnt(0)
    v_readfirstlane_b32 s66, v14
    s_barrier
    s_nop 6
    ds_write_b128 v5, v[16:19] offset:0
    ds_write_b128 v5, v[20:23] offset:1024
    ds_write_b128 v5, v[24:27] offset:2048
    ds_write_b128 v5, v[28:31] offset:3072
    s_cmp_lg_u32 s44, 0
    s_cbranch_scc1 L_g_ne_98
    v_cmp_ge_u32 vcc, v12, v11
    s_nop 0
    s_ff1_i32_b64 s46, vcc
    s_lshr_b32 s46, s46, 4
    s_min_u32 s46, s46, 4
    s_add_u32 s46, s46, s54
    s_min_u32 s46, s46, s75
    v_mov_b32 v11, s46
    ds_write_b32 v15, v11
L_g_ne_98:
    s_add_u32 s60, s60, 1
    s_mov_b32 s65, 0
    s_cmp_le_u32 s62, s60
    s_cbranch_scc1 L_g_dp_101_l
L_g_dp_101_a:
    s_cmp_ge_u32 s62, s66
    s_cbranch_scc1 L_g_dp_101_d
    s_add_u32 s47, s61, 4096
    s_mov_b32 m0, s64
    s_add_u32 s62, s62, 1
    buffer_load_dwordx4 v3, s[12:15], s61 offen offset:0 sc1 lds
    buffer_load_dwordx4 v3, s[12:15], s61 offen offset:1024 sc1 lds
    buffer_load_dwordx4 v3, s[12:15], s61 offen offset:2048 sc1 lds
    buffer_load_dwordx4 v3, s[12:15], s61 offen offset:3072 sc1 lds
    s_add_u32 m0, s64, 4096
    s_add_u32 s61, s61, 65536
    buffer_load_dwordx4 v3, s[12:15], s47 offen offset:0 sc1 lds
    buffer_load_dwordx4 v3, s[12:15], s47 offen offset:1024 sc1 lds
    buffer_load_dwordx4 v3, s[12:15], s47 offen offset:2048 sc1 lds
    buffer_load_dwordx4 v3, s[12:15], s47 offen offset:3072 sc1 lds
    s_xor_b32 s64, s64, 0x10000
L_g_dp_101_d:
    s_cmp_le_u32 s66, s60
    s_cbranch_scc1 L_g_ex0_100
    s_cmp_lg_u32 s65, 0
    s_cbranch_scc1 L_g_nw_99
    ds_read_b128 v[32:35], v4 offset:0
    ds_read_b128 v[36:39], v4 offset:1024
    ds_read_b128 v[40:43], v4 offset:2048
    ds_read_b128 v[44:47], v4 offset:3072
    ds_read_b128 v[48:51], v4 offset:4096
    ds_read_b128 v[52:55], v4 offset:5120
    ds_read_b128 v[56:59], v4 offset:6144
    ds_read_b128 v[60:63], v4 offset:7168
    s_cmp_lg_u32 s44, 0
    s_cbranch_scc1 L_g_nl_102
    s_add_u32 s54, s60, 1
    v_add_u32 v12, s54, v113
    v_mul_u32_u24 v13, 171, v12
    v_lshrrev_b32 v13, 9, v13
    v_mad_i32_i24 v13, v13, -3, v12
    v_lshl_add_u32 v13, v13, 9, v7
    buffer_load_dword v11, v13, s[12:15], 0 offen sc1
L_g_nl_102:
    s_waitcnt lgkmcnt(8)
    s_branch L_g_loop0_89
L_g_ex0_100:
    s_cmp_lg_u32 s44, 0
    s_cbranch_scc1 L_g_ex0_100_n
    s_sleep 6
    s_add_u32 s54, s60, 0
    v_add_u32 v12, s54, v113
    v_mul_u32_u24 v13, 171, v12
    v_lshrrev_b32 v13, 9, v13
    v_mad_i32_i24 v13, v13, -3, v12
    v_lshl_add_u32 v13, v13, 9, v7
    buffer_load_dword v11, v13, s[12:15], 0 offen sc1
    s_waitcnt vmcnt(0)
    v_cmp_ge_u32 vcc, v12, v11
    s_nop 0
    s_ff1_i32_b64 s46, vcc
    s_lshr_b32 s46, s46, 4
    s_min_u32 s46, s46, 4
    s_add_u32 s46, s46, s54
    s_min_u32 s46, s46, s75
    v_mov_b32 v11, s46
    ds_write_b32 v15, v11
L_g_ex0_100_n:
    s_waitcnt lgkmcnt(0)
    s_barrier
    ds_read_b32 v14, v15
    s_waitcnt lgkmcnt(0)
    v_readfirstlane_b32 s66, v14
    s_barrier
    s_cmp_gt_u32 s66, s60
    s_cbranch_scc1 L_g_restart_86_go
    s_branch L_g_tail_91
L_g_g1r_88:
    s_mov_b32 s65, 1
    s_branch L_g_loop1_90_e
.p2align 6
L_g_loop1_90:
    s_mov_b32 s65, 0
L_g_loop1_90_e:
    s_barrier
    ds_read_b32 v14, v15
    s_bitcmp1_b32 s67, 2
    s_cbranch_scc0 L_g_nfl_103
    s_cmp_lg_u32 s44, 4
    s_cbranch_scc1 L_g_nfl_103_d
    s_sub_u32 s59, s60, 2
    v_mov_b32 v10, s59
    buffer_store_dword v10, v115, s[12:15], s52 offen sc1
L_g_nfl_103_d:
    s_waitcnt lgkmcnt(0)
    v_readfirstlane_b32 s66, v14
    ds_read_b128 v[80:83], v5 offset:0
    ds_read_b128 v[84:87], v5 offset:1024
    ds_read_b128 v[88:91], v5 offset:2048
    ds_read_b128 v[92:95], v5 offset:3072
    s_cmp_le_u32 s62, s60
    s_cbranch_scc1 L_g_dp_108_l
L_g_dp_108_a:
    s_cmp_ge_u32 s62, s66
    s_cbranch_scc1 L_g_dp_108_d
    s_add_u32 s47, s61, 4096
    s_mov_b32 m0, s64
    s_add_u32 s62, s62, 1
    buffer_load_dwordx4 v3, s[12:15], s61 offen offset:0 sc1 lds
    buffer_load_dwordx4 v3, s[12:15], s61 offen offset:1024 sc1 lds
    buffer_load_dwordx4 v3, s[12:15], s61 offen offset:2048 sc1 lds
    buffer_load_dwordx4 v3, s[12:15], s61 offen offset:3072 sc1 lds
    s_add_u32 m0, s64, 4096
    s_add_u32 s61, s61, 65536
    buffer_load_dwordx4 v3, s[12:15], s47 offen offset:0 sc1 lds
    buffer_load_dwordx4 v3, s[12:15], s47 offen offset:1024 sc1 lds
    buffer_load_dwordx4 v3, s[12:15], s47 offen offset:2048 sc1 lds
    buffer_load_dwordx4 v3, s[12:15], s47 offen offset:3072 sc1 lds
    s_xor_b32 s64, s64, 0x10000
L_g_dp_108_d:
    s_bitcmp1_b32 s67, 0
    s_cbranch_scc0 L_g_nep_104
    s_waitcnt lgkmcnt(0)
    v_add_f32 v80, v80, v16
    v_add_f32 v81, v81, v17
    v_add_f32 v82, v82, v18
    v_add_f32 v83, v83, v19
    v_add_f32 v84, v84, v20
    v_add_f32 v85, v85, v21
    v_add_f32 v86, v86, v22
    v_add_f32 v87, v87, v23
    v_add_f32 v88, v88, v24
    v_add_f32 v89, v89, v25
    v_add_f32 v90, v90, v26
    v_add_f32 v91, v91, v27
    v_add_f32 v92, v92, v28
    v_add_f32 v93, v93, v29
    v_add_f32 v94, v94, v30
    v_add_f32 v95, v95, v31
L_g_nep_104:
    v_mul_f32 v96, v80, v80
    v_mul_f32 v97, v81, v81
    v_mul_f32 v98, v82, v82
    v_mul_f32 v99, v83, v83
    v_mul_f32 v100, v84, v84
    v_mul_f32 v101, v85, v85
    v_mul_f32 v102, v86, v86
    v_mul_f32 v103, v87, v87
    v_fma_f32 v96, v96, s56, v112
    v_fma_f32 v97, v97, s56, v112
    v_fma_f32 v98, v98, s56, v112
    v_fma_f32 v99, v99, s56, v112
    v_fma_f32 v100, v100, s56, v112
    v_fma_f32 v101, v101, s56, v112
    v_fma_f32 v102, v102, s56, v112
    v_fma_f32 v103, v103, s56, v112
    v_mul_f32 v96, v96, v80
    v_mul_f32 v97, v97, v81
    v_mul_f32 v98, v98, v82
    v_mul_f32 v99, v99, v83
    v_mul_f32 v100, v100, v84
    v_mul_f32 v101, v101, v85
    v_mul_f32 v102, v102, v86
    v_mul_f32 v103, v103, v87
    v_exp_f32 v96, v96
    v_exp_f32 v97, v97
    v_exp_f32 v98, v98
    v_exp_f32 v99, v99
    v_exp_f32 v100, v100
    v_exp_f32 v101, v101
    v_exp_f32 v102, v102
    v_exp_f32 v103, v103
    v_add_f32 v96, 1.0, v96
    v_add_f32 v97, 1.0, v97
    v_add_f32 v98, 1.0, v98
    v_add_f32 v99, 1.0, v99
    s_cmp_lg_u32 s65, 0
    s_cbranch_scc1 L_g_nw1_105
    ds_read_b128 v[32:35], v4 offset:0
    ds_read_b128 v[36:39], v4 offset:1024
    ds_read_b128 v[40:43], v4 offset:2048
    ds_read_b128 v[44:47], v4 offset:3072
    ds_read_b128 v[48:51], v4 offset:4096
    ds_read_b128 v[52:55], v4 offset:5120
    ds_read_b128 v[56:59], v4 offset:6144
    ds_read_b128 v[60:63], v4 offset:7168
    s_barrier
L_g_jn_107:
    s_bitcmp1_b32 s67, 0
    s_cbranch_scc0 L_g_mm2_106
    s_setprio 1
    s_waitcnt lgkmcnt(6)
    v_mfma_f32_32x32x16_bf16 v[16:31], a[0:3], v[32:35], 0
    ds_read_b128 v[32:35], v4 offset:8192
    v_add_f32 v100, 1.0, v100
    v_add_f32 v101, 1.0, v101
    v_add_f32 v102, 1.0, v102
    v_add_f32 v103, 1.0, v103
    v_mfma_f32_32x32x16_bf16 v[16:31], a[4:7], v[36:39], v[16:31]
    ds_read_b128 v[36:39], v4 offset:9216
    v_rcp_f32 v96, v96
    v_rcp_f32 v97, v97
    s_waitcnt lgkmcnt(6)
    v_mfma_f32_32x32x16_bf16 v[16:31], a[8:11], v[40:43], v[16:31]
    ds_read_b128 v[40:43], v4 offset:10240
    v_rcp_f32 v98, v98
    v_rcp_f32 v99, v99
    v_mfma_f32_32x32x16_bf16 v[16:31], a[12:15], v[44:47], v[16:31]
    ds_read_b128 v[44:47], v4 offset:11264
    v_rcp_f32 v100, v100
    v_rcp_f32 v101, v101
    s_waitcnt lgkmcnt(6)
    v_mfma_f32_32x32x16_bf16 v[16:31], a[16:19], v[48:51], v[16:31]
    ds_read_b128 v[48:51], v4 offset:12288
    v_rcp_f32 v102, v102
    v_rcp_f32 v103, v103
    v_mfma_f32_32x32x16_bf16 v[16:31], a[20:23], v[52:55], v[16:31]
    ds_read_b128 v[52:55], v4 offset:13312
    v_mul_f32 v80, v80, v96
    v_mul_f32 v81, v81, v97
    v_mul_f32 v82, v82, v98
    v_mul_f32 v83, v83, v99
    s_waitcnt lgkmcnt(6)
    v_mfma_f32_32x32x16_bf16 v[16:31], a[24:27], v[56:59], v[16:31]
    ds_read_b128 v[56:59], v4 offset:14336
    v_mul_f32 v84, v84, v100
    v_mul_f32 v85, v85, v101
    v_mul_f32 v86, v86, v102
    v_mul_f32 v87, v87, v103
    v_mfma_f32_32x32x16_bf16 v[16:31], a[28:31], v[60:63], v[16:31]
    ds_read_b128 v[60:63], v4 offset:15360
    v_cvt_pk_bf16_f32 v104, v80, v81
    v_cvt_pk_bf16_f32 v105, v82, v83
    v_cvt_pk_bf16_f32 v106, v84, v85
    v_cvt_pk_bf16_f32 v107, v86, v87
    s_waitcnt lgkmcnt(6)
    v_mfma_f32_32x32x16_bf16 v[16:31], a[32:35], v[32:35], v[16:31]
    ds_read_b128 v[32:35], v4 offset:16384
    buffer_store_dwordx4 v[104:107], v8, s[12:15], s63 offen sc1
    v_mul_f32 v96, v88, v88
    v_mul_f32 v97, v89, v89
    v_mul_f32 v98, v90, v90
    v_mfma_f32_32x32x16_bf16 v[16:31], a[36:39], v[36:39], v[16:31]
    ds_read_b128 v[36:39], v4 offset:17408
    v_mul_f32 v99, v91, v91
    v_mul_f32 v100, v92, v92
    v_mul_f32 v101, v93, v93
    v_mul_f32 v102, v94, v94
    s_waitcnt lgkmcnt(6)
    v_mfma_f32_32x32x16_bf16 v[16:31], a[40:43], v[40:43], v[16:31]
    ds_read_b128 v[40:43], v4 offset:18432
    v_mul_f32 v103, v95, v95
    v_fma_f32 v96, v96, s56, v112
    v_fma_f32 v97, v97, s56, v112
    v_fma_f32 v98, v98, s56, v112
    v_mfma_f32_32x32x16_bf16 v[16:31], a[44:47], v[44:47], v[16:31]
    ds_read_b128 v[44:47], v4 offset:19456
    v_fma_f32 v99, v99, s56, v112
    v_fma_f32 v100, v100, s56, v112
    v_fma_f32 v101, v101, s56, v112
    v_fma_f32 v102, v102, s56, v112
    s_waitcnt lgkmcnt(6)
    v_mfma_f32_32x32x16_bf16 v[16:31], a[48:51], v[48:51], v[16:31]
    ds_read_b128 v[48:51], v4 offset:20480
    v_fma_f32 v103, v103, s56, v112
    v_mul_f32 v96, v96, v88
    v_mul_f32 v97, v97, v89
    v_mul_f32 v98, v98, v90
    v_mfma_f32_32x32x16_bf16 v[16:31], a[52:55], v[52:55], v[16:31]
    ds_read_b128 v[52:55], v4 offset:21504
    v_mul_f32 v99, v99, v91
    v_mul_f32 v100, v100, v92
    v_mul_f32 v101, v101, v93
    v_mul_f32 v102, v102, v94
    s_waitcnt lgkmcnt(6)
    v_mfma_f32_32x32x16_bf16 v[16:31], a[56:59], v[56:59], v[16:31]
    ds_read_b128 v[56:59], v4 offset:22528
    v_mul_f32 v103, v103, v95
    v_exp_f32 v96, v96
    v_exp_f32 v97, v97
    v_mfma_f32_32x32x16_bf16 v[16:31], a[60:63], v[60:63], v[16:31]
    ds_read_b128 v[60:63], v4 offset:23552
    v_exp_f32 v98, v98
    v_exp_f32 v99, v99
    s_waitcnt lgkmcnt(6)
    v_mfma_f32_32x32x16_bf16 v[16:31], a[64:67], v[32:35], v[16:31]
    ds_read_b128 v[32:35], v4 offset:24576
    v_exp_f32 v100, v100
    v_exp_f32 v101, v101
    v_mfma_f32_32x32x16_bf16 v[16:31], a[68:71], v[36:39], v[16:31]
    ds_read_b128 v[36:39], v4 offset:25600
    v_exp_f32 v102, v102
    v_exp_f32 v103, v103
    s_waitcnt lgkmcnt(6)
    v_mfma_f32_32x32x16_bf16 v[16:31], a[72:75], v[40:43], v[16:31]
    ds_read_b128 v[40:43], v4 offset:26624
    v_add_f32 v96, 1.0, v96
    v_add_f32 v97, 1.0, v97
    v_add_f32 v98, 1.0, v98
    v_add_f32 v99, 1.0, v99
    v_mfma_f32_32x32x16_bf16 v[16:31], a[76:79], v[44:47], v[16:31]
    ds_read_b128 v[44:47], v4 offset:27648
    v_add_f32 v100, 1.0, v100
    v_add_f32 v101, 1.0, v101
    v_add_f32 v102, 1.0, v102
    v_add_f32 v103, 1.0, v103
    s_waitcnt lgkmcnt(6)
    v_mfma_f32_32x32x16_bf16 v[16:31], a[80:83], v[48:51], v[16:31]
    ds_read_b128 v[48:51], v4 offset:28672
    v_rcp_f32 v96, v96
    v_rcp_f32 v97, v97
    v_mfma_f32_32x32x16_bf16 v[16:31], a[84:87], v[52:55], v[16:31]
    ds_read_b128 v[52:55], v4 offset:29696
    v_rcp_f32 v98, v98
    v_rcp_f32 v99, v99
    s_waitcnt lgkmcnt(6)
    v_mfma_f32_32x32x16_bf16 v[16:31], a[88:91], v[56:59], v[16:31]
    ds_read_b128 v[56:59], v4 offset:30720
    v_rcp_f32 v100, v100
    v_rcp_f32 v101, v101
    v_mfma_f32_32x32x16_bf16 v[16:31], a[92:95], v[60:63], v[16:31]
    ds_read_b128 v[60:63], v4 offset:31744
    v_rcp_f32 v102, v102
    v_rcp_f32 v103, v103
    s_waitcnt lgkmcnt(6)
    v_mfma_f32_32x32x16_bf16 v[16:31], a[96:99], v[32:35], v[16:31]
    v_mul_f32 v88, v88, v96
    v_mul_f32 v89, v89, v97
    v_mul_f32 v90, v90, v98
    v_mul_f32 v91, v91, v99
    v_mfma_f32_32x32x16_bf16 v[16:31], a[100:103], v[36:39], v[16:31]
    v_mul_f32 v92, v92, v100
    v_mul_f32 v93, v93, v101
    v_mul_f32 v94, v94, v102
    v_mul_f32 v95, v95, v103
    s_waitcnt lgkmcnt(4)
    v_mfma_f32_32x32x16_bf16 v[16:31], a[104:107], v[40:43], v[16:31]
    v_cvt_pk_bf16_f32 v108, v88, v89
    v_cvt_pk_bf16_f32 v109, v90, v91
    v_cvt_pk_bf16_f32 v110, v92, v93
    v_cvt_pk_bf16_f32 v111, v94, v95
    v_mfma_f32_32x32x16_bf16 v[16:31], a[108:111], v[44:47], v[16:31]
    buffer_store_dwordx4 v[108:111], v9, s[12:15], s63 offen sc1
    s_add_u32 s63, s63, 229376
    s_waitcnt lgkmcnt(2)
    v_mfma_f32_32x32x16_bf16 v[16:31], a[112:115], v[48:51], v[16:31]
    v_mfma_f32_32x32x16_bf16 v[16:31], a[116:119], v[52:55], v[16:31]
    s_waitcnt lgkmcnt(0)
    v_mfma_f32_32x32x16_bf16 v[16:31], a[120:123], v[56:59], v[16:31]
    v_mfma_f32_32x32x16_bf16 v[16:31], a[124:127], v[60:63], v[16:31]
    v_xor_b32 v4, 0x10000, v4
    s_setprio 0
    s_waitcnt vmcnt(2)
L_g_mm2_106_d:
    s_lshl_b32 s67, s67, 1
    s_or_b32 s67, s67, 1
    s_add_u32 s60, s60, 1
    s_cmp_gt_u32 s66, s60
    s_cbranch_scc1 L_g_loop1_90
    s_barrier
    ds_read_b32 v14, v15
    s_waitcnt lgkmcnt(0)
    v_readfirstlane_b32 s66, v14
    s_barrier
    s_mov_b32 s69, 0
    s_cmp_gt_u32 s62, s60
    s_cbranch_scc1 L_g_nd_109
    s_cmp_ge_u32 s62, s66
    s_cbranch_scc1 L_g_nd_109
    s_add_u32 s47, s61, 4096
    s_add_u32 m0, s64, 0
    s_nop 0
    buffer_load_dwordx4 v3, s[12:15], s61 offen offset:0 sc1 lds
    buffer_load_dwordx4 v3, s[12:15], s61 offen offset:1024 sc1 lds
    buffer_load_dwordx4 v3, s[12:15], s61 offen offset:2048 sc1 lds
    buffer_load_dwordx4 v3, s[12:15], s61 offen offset:3072 sc1 lds
    s_add_u32 m0, s64, 4096
    s_nop 0
    buffer_load_dwordx4 v3, s[12:15], s47 offen offset:0 sc1 lds
    buffer_load_dwordx4 v3, s[12:15], s47 offen offset:1024 sc1 lds
    buffer_load_dwordx4 v3, s[12:15], s47 offen offset:2048 sc1 lds
    buffer_load_dwordx4 v3, s[12:15], s47 offen offset:3072 sc1 lds
    s_add_u32 s61, s61, 65536
    s_add_u32 s62, s62, 1
    s_xor_b32 s64, s64, 0x10000
    s_mov_b32 s69, 1
L_g_nd_109:
    s_sub_u32 s59, s60, 1
    ds_read_b128 v[80:83], v5 offset:0
    ds_read_b128 v[84:87], v5 offset:1024
    ds_read_b128 v[88:91], v5 offset:2048
    ds_read_b128 v[92:95], v5 offset:3072
    s_nop 7
    s_waitcnt lgkmcnt(3)
    v_add_f32 v80, v80, v16
    v_add_f32 v81, v81, v17
    v_add_f32 v82, v82, v18
    v_add_f32 v83, v83, v19
    s_waitcnt lgkmcnt(2)
    v_add_f32 v84, v84, v20
    v_add_f32 v85, v85, v21
    v_add_f32 v86, v86, v22
    v_add_f32 v87, v87, v23
    s_waitcnt lgkmcnt(1)
    v_add_f32 v88, v88, v24
    v_add_f32 v89, v89, v25
    v_add_f32 v90, v90, v26
    v_add_f32 v91, v91, v27
    s_waitcnt lgkmcnt(0)
    v_add_f32 v92, v92, v28
    v_add_f32 v93, v93, v29
    v_add_f32 v94, v94, v30
    v_add_f32 v95, v95, v31
    v_mul_f32 v96, v80, v80
    v_mul_f32 v97, v81, v81
    v_mul_f32 v98, v82, v82
    v_mul_f32 v99, v83, v83
    v_mul_f32 v100, v84, v84
    v_mul_f32 v101, v85, v85
    v_mul_f32 v102, v86, v86
    v_mul_f32 v103, v87, v87
    v_fma_f32 v96, v96, s56, v112
    v_fma_f32 v97, v97, s56, v112
    v_fma_f32 v98, v98, s56, v112
    v_fma_f32 v99, v99, s56, v112
    v_fma_f32 v100, v100, s56, v112
    v_fma_f32 v101, v101, s56, v112
    v_fma_f32 v102, v102, s56, v112
    v_fma_f32 v103, v103, s56, v112
    v_mul_f32 v96, v96, v80
    v_mul_f32 v97, v97, v81
    v_mul_f32 v98, v98, v82
    v_mul_f32 v99, v99, v83
    v_mul_f32 v100, v100, v84
    v_mul_f32 v101, v101, v85
    v_mul_f32 v102, v102, v86
    v_mul_f32 v103, v103, v87
    v_exp_f32 v96, v96
    v_exp_f32 v97, v97
    v_exp_f32 v98, v98
    v_exp_f32 v99, v99
    v_exp_f32 v100, v100
    v_exp_f32 v101, v101
    v_exp_f32 v102, v102
    v_exp_f32 v103, v103
    v_add_f32 v96, 1.0, v96
    v_add_f32 v97, 1.0, v97
    v_add_f32 v98, 1.0, v98
    v_add_f32 v99, 1.0, v99
    v_add_f32 v100, 1.0, v100
    v_add_f32 v101, 1.0, v101
    v_add_f32 v102, 1.0, v102
    v_add_f32 v103, 1.0, v103
    v_rcp_f32 v96, v96
    v_rcp_f32 v97, v97
    v_rcp_f32 v98, v98
    v_rcp_f32 v99, v99
    v_rcp_f32 v100, v100
    v_rcp_f32 v101, v101
    v_rcp_f32 v102, v102
    v_rcp_f32 v103, v103
    v_mul_f32 v80, v80, v96
    v_mul_f32 v81, v81, v97
    v_mul_f32 v82, v82, v98
    v_mul_f32 v83, v83, v99
    v_mul_f32 v84, v84, v100
    v_mul_f32 v85, v85, v101
    v_mul_f32 v86, v86, v102
    v_mul_f32 v87, v87, v103
    v_cvt_pk_bf16_f32 v104, v80, v81
    v_cvt_pk_bf16_f32 v105, v82, v83
    v_cvt_pk_bf16_f32 v106, v84, v85
    v_cvt_pk_bf16_f32 v107, v86, v87
    buffer_store_dwordx4 v[104:107], v8, s[12:15], s63 offen sc1
    v_mul_f32 v96, v88, v88
    v_mul_f32 v97, v89, v89
    v_mul_f32 v98, v90, v90
    v_mul_f32 v99, v91, v91
    v_mul_f32 v100, v92, v92
    v_mul_f32 v101, v93, v93
    v_mul_f32 v102, v94, v94
    v_mul_f32 v103, v95, v95
    v_fma_f32 v96, v96, s56, v112
    v_fma_f32 v97, v97, s56, v112
    v_fma_f32 v98, v98, s56, v112
    v_fma_f32 v99, v99, s56, v112
    v_fma_f32 v100, v100, s56, v112
    v_fma_f32 v101, v101, s56, v112
    v_fma_f32 v102, v102, s56, v112
    v_fma_f32 v103, v103, s56, v112
    v_mul_f32 v96, v96, v88
    v_mul_f32 v97, v97, v89
    v_mul_f32 v98, v98, v90
    v_mul_f32 v99, v99, v91
    v_mul_f32 v100, v100, v92
    v_mul_f32 v101, v101, v93
    v_mul_f32 v102, v102, v94
    v_mul_f32 v103, v103, v95
    v_exp_f32 v96, v96
    v_exp_f32 v97, v97
    v_exp_f32 v98, v98
    v_exp_f32 v99, v99
    v_exp_f32 v100, v100
    v_exp_f32 v101, v101
    v_exp_f32 v102, v102
    v_exp_f32 v103, v103
    v_add_f32 v96, 1.0, v96
    v_add_f32 v97, 1.0, v97
    v_add_f32 v98, 1.0, v98
    v_add_f32 v99, 1.0, v99
    v_add_f32 v100, 1.0, v100
    v_add_f32 v101, 1.0, v101
    v_add_f32 v102, 1.0, v102
    v_add_f32 v103, 1.0, v103
    v_rcp_f32 v96, v96
    v_rcp_f32 v97, v97
    v_rcp_f32 v98, v98
    v_rcp_f32 v99, v99
    v_rcp_f32 v100, v100
    v_rcp_f32 v101, v101
    v_rcp_f32 v102, v102
    v_rcp_f32 v103, v103
    v_mul_f32 v88, v88, v96
    v_mul_f32 v89, v89, v97
    v_mul_f32 v90, v90, v98
    v_mul_f32 v91, v91, v99
    v_mul_f32 v92, v92, v100
    v_mul_f32 v93, v93, v101
    v_mul_f32 v94, v94, v102
    v_mul_f32 v95, v95, v103
    v_cvt_pk_bf16_f32 v108, v88, v89
    v_cvt_pk_bf16_f32 v109, v90, v91
    v_cvt_pk_bf16_f32 v110, v92, v93
    v_cvt_pk_bf16_f32 v111, v94, v95
    buffer_store_dwordx4 v[108:111], v9, s[12:15], s63 offen sc1
    s_add_u32 s63, s63, 229376
    s_mov_b32 s67, 0
    s_mov_b32 s71, 1
    s_cmp_gt_u32 s66, s60
    s_cbranch_scc1 L_g_g1r_88
    v_mov_b32 v10, 1
    s_mov_b64 exec, 1
    s_waitcnt vmcnt(0)
    ds_add_rtn_u32 v10, v15, v10 offset:4
    s_waitcnt lgkmcnt(0)
    v_readfirstlane_b32 s46, v10
    s_mov_b64 exec, -1
    s_mov_b32 s71, 0
    s_sub_u32 s59, s60, 1
    s_cmp_lg_u32 s46, s68
    s_cbranch_scc1 L_g_df_110
    v_mov_b32 v10, s59
    v_add_u32 v10, 1, v10
    v_mov_b32 v11, 0
    s_mov_b64 exec, 1
    buffer_store_dword v10, v11, s[12:15], s52 offen sc1
    s_mov_b64 exec, -1
L_sf_111:
L_g_df_110:
    s_add_u32 s68, s68, 4
    s_cmp_gt_u32 s66, s60
    s_cbranch_scc1 L_g_g1r_88
L_g_tail_91:
    s_cmp_lt_u32 s60, s75
    s_cbranch_scc1 L_g_restart_86
    s_waitcnt vmcnt(0)
    s_barrier
    s_branch L_w_f1_14_d
L_g_dp_101_l:
    s_cmp_ge_u32 s62, s66
    s_cbranch_scc1 L_g_dp_101_d
    s_mov_b32 s65, 1
    s_add_u32 s47, s61, 4096
    s_mov_b32 m0, s64
    s_add_u32 s62, s62, 1
    buffer_load_dwordx4 v3, s[12:15], s61 offen offset:0 sc1 lds
    buffer_load_dwordx4 v3, s[12:15], s61 offen offset:1024 sc1 lds
    buffer_load_dwordx4 v3, s[12:15], s61 offen offset:2048 sc1 lds
    buffer_load_dwordx4 v3, s[12:15], s61 offen offset:3072 sc1 lds
    s_add_u32 m0, s64, 4096
    s_add_u32 s61, s61, 65536
    buffer_load_dwordx4 v3, s[12:15], s47 offen offset:0 sc1 lds
    buffer_load_dwordx4 v3, s[12:15], s47 offen offset:1024 sc1 lds
    buffer_load_dwordx4 v3, s[12:15], s47 offen offset:2048 sc1 lds
    buffer_load_dwordx4 v3, s[12:15], s47 offen offset:3072 sc1 lds
    s_xor_b32 s64, s64, 0x10000
    s_branch L_g_dp_101_a
L_g_nw_99:
    s_waitcnt vmcnt(0) lgkmcnt(0)
    s_cmp_lg_u32 s44, 0
    s_cbranch_scc1 L_g_nl_112
    s_add_u32 s54, s60, 1
    v_add_u32 v12, s54, v113
    v_mul_u32_u24 v13, 171, v12
    v_lshrrev_b32 v13, 9, v13
    v_mad_i32_i24 v13, v13, -3, v12
    v_lshl_add_u32 v13, v13, 9, v7
    buffer_load_dword v11, v13, s[12:15], 0 offen sc1
L_g_nl_112:
    s_branch L_g_loop0_89_l
L_g_nfl_103:
    s_cmp_eq_u32 s71, 0
    s_cbranch_scc1 L_g_nfl_103_d
    v_mov_b32 v10, 1
    s_mov_b64 exec, 1
    s_waitcnt vmcnt(0)
    ds_add_rtn_u32 v10, v15, v10 offset:4
    s_waitcnt lgkmcnt(0)
    v_readfirstlane_b32 s46, v10
    s_mov_b64 exec, -1
    s_mov_b32 s71, 0
    s_sub_u32 s59, s60, 1
    s_cmp_lg_u32 s46, s68
    s_cbranch_scc1 L_g_df_113
    v_mov_b32 v10, s59
    v_add_u32 v10, 1, v10
    v_mov_b32 v11, 0
    s_mov_b64 exec, 1
    buffer_store_dword v10, v11, s[12:15], s52 offen sc1
    s_mov_b64 exec, -1
L_sf_114:
L_g_df_113:
    s_add_u32 s68, s68, 4
    s_mov_b32 s65, 2
    s_branch L_g_nfl_103_d
L_g_dp_108_l:
    s_cmp_ge_u32 s62, s66
    s_cbranch_scc1 L_g_dp_108_d
    s_or_b32 s65, s65, 1
    s_add_u32 s47, s61, 4096
    s_mov_b32 m0, s64
    s_add_u32 s62, s62, 1
    buffer_load_dwordx4 v3, s[12:15], s61 offen offset:0 sc1 lds
    buffer_load_dwordx4 v3, s[12:15], s61 offen offset:1024 sc1 lds
    buffer_load_dwordx4 v3, s[12:15], s61 offen offset:2048 sc1 lds
    buffer_load_dwordx4 v3, s[12:15], s61 offen offset:3072 sc1 lds
    s_add_u32 m0, s64, 4096
    s_add_u32 s61, s61, 65536
    buffer_load_dwordx4 v3, s[12:15], s47 offen offset:0 sc1 lds
    buffer_load_dwordx4 v3, s[12:15], s47 offen offset:1024 sc1 lds
    buffer_load_dwordx4 v3, s[12:15], s47 offen offset:2048 sc1 lds
    buffer_load_dwordx4 v3, s[12:15], s47 offen offset:3072 sc1 lds
    s_xor_b32 s64, s64, 0x10000
    s_branch L_g_dp_108_a
L_g_nw1_105:
    s_cmp_eq_u32 s65, 2
    s_cbranch_scc1 L_g_nw1_105_w
    s_waitcnt vmcnt(0)
L_g_nw1_105_w:
    s_barrier
    ds_read_b128 v[32:35], v4 offset:0
    ds_read_b128 v[36:39], v4 offset:1024
    ds_read_b128 v[40:43], v4 offset:2048
    ds_read_b128 v[44:47], v4 offset:3072
    ds_read_b128 v[48:51], v4 offset:4096
    ds_read_b128 v[52:55], v4 offset:5120
    ds_read_b128 v[56:59], v4 offset:6144
    ds_read_b128 v[60:63], v4 offset:7168
    s_branch L_g_jn_107
L_g_mm2_106:
    s_setprio 1
    s_waitcnt lgkmcnt(6)
    v_mfma_f32_32x32x16_bf16 v[16:31], a[0:3], v[32:35], 0
    ds_read_b128 v[32:35], v4 offset:8192
    v_mfma_f32_32x32x16_bf16 v[16:31], a[4:7], v[36:39], v[16:31]
    ds_read_b128 v[36:39], v4 offset:9216
    s_waitcnt lgkmcnt(6)
    v_mfma_f32_32x32x16_bf16 v[16:31], a[8:11], v[40:43], v[16:31]
    ds_read_b128 v[40:43], v4 offset:10240
    v_mfma_f32_32x32x16_bf16 v[16:31], a[12:15], v[44:47], v[16:31]
    ds_read_b128 v[44:47], v4 offset:11264
    s_waitcnt lgkmcnt(6)
    v_mfma_f32_32x32x16_bf16 v[16:31], a[16:19], v[48:51], v[16:31]
    ds_read_b128 v[48:51], v4 offset:12288
    v_mfma_f32_32x32x16_bf16 v[16:31], a[20:23], v[52:55], v[16:31]
    ds_read_b128 v[52:55], v4 offset:13312
    s_waitcnt lgkmcnt(6)
    v_mfma_f32_32x32x16_bf16 v[16:31], a[24:27], v[56:59], v[16:31]
    ds_read_b128 v[56:59], v4 offset:14336
    v_mfma_f32_32x32x16_bf16 v[16:31], a[28:31], v[60:63], v[16:31]
    ds_read_b128 v[60:63], v4 offset:15360
    s_waitcnt lgkmcnt(6)
    v_mfma_f32_32x32x16_bf16 v[16:31], a[32:35], v[32:35], v[16:31]
    ds_read_b128 v[32:35], v4 offset:16384
    v_mfma_f32_32x32x16_bf16 v[16:31], a[36:39], v[36:39], v[16:31]
    ds_read_b128 v[36:39], v4 offset:17408
    s_waitcnt lgkmcnt(6)
    v_mfma_f32_32x32x16_bf16 v[16:31], a[40:43], v[40:43], v[16:31]
    ds_read_b128 v[40:43], v4 offset:18432
    v_mfma_f32_32x32x16_bf16 v[16:31], a[44:47], v[44:47], v[16:31]
    ds_read_b128 v[44:47], v4 offset:19456
    s_waitcnt lgkmcnt(6)
    v_mfma_f32_32x32x16_bf16 v[16:31], a[48:51], v[48:51], v[16:31]
    ds_read_b128 v[48:51], v4 offset:20480
    v_mfma_f32_32x32x16_bf16 v[16:31], a[52:55], v[52:55], v[16:31]
    ds_read_b128 v[52:55], v4 offset:21504
    s_waitcnt lgkmcnt(6)
    v_mfma_f32_32x32x16_bf16 v[16:31], a[56:59], v[56:59], v[16:31]
    ds_read_b128 v[56:59], v4 offset:22528
    v_mfma_f32_32x32x16_bf16 v[16:31], a[60:63], v[60:63], v[16:31]
    ds_read_b128 v[60:63], v4 offset:23552
    s_waitcnt lgkmcnt(6)
    v_mfma_f32_32x32x16_bf16 v[16:31], a[64:67], v[32:35], v[16:31]
    ds_read_b128 v[32:35], v4 offset:24576
    v_mfma_f32_32x32x16_bf16 v[16:31], a[68:71], v[36:39], v[16:31]
    ds_read_b128 v[36:39], v4 offset:25600
    s_waitcnt lgkmcnt(6)
    v_mfma_f32_32x32x16_bf16 v[16:31], a[72:75], v[40:43], v[16:31]
    ds_read_b128 v[40:43], v4 offset:26624
    v_mfma_f32_32x32x16_bf16 v[16:31], a[76:79], v[44:47], v[16:31]
    ds_read_b128 v[44:47], v4 offset:27648
    s_waitcnt lgkmcnt(6)
    v_mfma_f32_32x32x16_bf16 v[16:31], a[80:83], v[48:51], v[16:31]
    ds_read_b128 v[48:51], v4 offset:28672
    v_mfma_f32_32x32x16_bf16 v[16:31], a[84:87], v[52:55], v[16:31]
    ds_read_b128 v[52:55], v4 offset:29696
    s_waitcnt lgkmcnt(6)
    v_mfma_f32_32x32x16_bf16 v[16:31], a[88:91], v[56:59], v[16:31]
    ds_read_b128 v[56:59], v4 offset:30720
    v_mfma_f32_32x32x16_bf16 v[16:31], a[92:95], v[60:63], v[16:31]
    ds_read_b128 v[60:63], v4 offset:31744
    s_waitcnt lgkmcnt(6)
    v_mfma_f32_32x32x16_bf16 v[16:31], a[96:99], v[32:35], v[16:31]
    v_mfma_f32_32x32x16_bf16 v[16:31], a[100:103], v[36:39], v[16:31]
    s_waitcnt lgkmcnt(4)
    v_mfma_f32_32x32x16_bf16 v[16:31], a[104:107], v[40:43], v[16:31]
    v_mfma_f32_32x32x16_bf16 v[16:31], a[108:111], v[44:47], v[16:31]
    s_waitcnt lgkmcnt(2)
    v_mfma_f32_32x32x16_bf16 v[16:31], a[112:115], v[48:51], v[16:31]
    v_mfma_f32_32x32x16_bf16 v[16:31], a[116:119], v[52:55], v[16:31]
    s_waitcnt lgkmcnt(0)
    v_mfma_f32_32x32x16_bf16 v[16:31], a[120:123], v[56:59], v[16:31]
    v_mfma_f32_32x32x16_bf16 v[16:31], a[124:127], v[60:63], v[16:31]
    v_xor_b32 v4, 0x10000, v4
    s_setprio 0
    s_waitcnt vmcnt(0)
    s_branch L_g_mm2_106_d
L_w_f2_13:
    s_load_dwordx2 s[4:5], s[0:1], 80
    s_load_dwordx2 s[6:7], s[0:1], 72
    s_and_b32 s50, s44, 3
    s_lshr_b32 s51, s44, 2
    s_waitcnt lgkmcnt(0)
    s_mov_b32 s24, s4
    s_and_b32 s25, s5, 0xffff
    s_mov_b32 s26, 0x700000
    s_mov_b32 s27, 0x00020000
    v_lshrrev_b32 v3, 4, v1
    v_and_b32 v4, 15, v1
    v_lshlrev_b32 v5, 2, v3
    v_xor_b32 v4, v4, v5
    v_mul_u32_u24 v3, 2048, v3
    v_lshl_add_u32 v3, v4, 4, v3
    s_mul_i32 s46, s51, 448
    s_mul_i32 s47, s50, 56
    s_add_u32 s46, s46, s47
    s_mul_i32 s47, s42, 896
    s_add_u32 s46, s46, s47
    s_mul_i32 s46, s46, 2048
    s_lshl_b32 s47, s43, 8
    s_add_u32 s46, s46, s47
    s_lshl_b32 s45, s51, 16
    s_mul_i32 s47, s50, 14336
    s_add_u32 s45, s45, s47
    v_bfe_u32 v4, v1, 2, 2
    v_bfe_u32 v5, v1, 4, 1
    v_lshlrev_b32 v5, 1, v5
    v_bfe_u32 v6, v1, 1, 1
    v_add_u32 v5, v5, v6
    s_lshl_b32 s47, s50, 2
    v_add_u32 v5, s47, v5
    v_lshlrev_b32 v6, 2, v4
    v_xor_b32 v5, v5, v6
    v_lshlrev_b32 v5, 4, v5
    v_lshl_add_u32 v5, v4, 8, v5
    v_bfe_u32 v6, v1, 0, 1
    v_lshl_add_u32 v5, v6, 3, v5
    v_lshrrev_b32 v6, 5, v1
    v_mul_u32_u24 v6, 1024, v6
    v_add_u32 v5, v5, v6
    s_lshl_b32 s47, s51, 16
    v_add_u32 v5, s47, v5
    v_bfe_u32 v4, v1, 2, 2
    v_xor_b32 v5, s50, v4
    v_lshlrev_b32 v5, 6, v5
    v_lshl_add_u32 v5, v4, 8, v5
    v_and_b32 v6, 3, v1
    v_lshl_add_u32 v5, v6, 3, v5
    v_lshrrev_b32 v6, 4, v1
    v_lshl_add_u32 v5, v6, 10, v5
    v_lshrrev_b32 v6, 5, v1
    v_lshl_add_u32 v5, v6, 11, v5
    s_lshl_b32 s47, s51, 16
    v_add_u32 v5, s47, v5
    s_add_u32 m0, s45, 0
    s_add_u32 s47, s46, 0x0
    buffer_load_dwordx4 v3, s[24:27], s47 offen lds
    s_add_u32 m0, s45, 1024
    s_add_u32 s47, s46, 0x2000
    buffer_load_dwordx4 v3, s[24:27], s47 offen lds
    s_add_u32 m0, s45, 2048
    s_add_u32 s47, s46, 0x4000
    buffer_load_dwordx4 v3, s[24:27], s47 offen lds
    s_add_u32 m0, s45, 3072
    s_add_u32 s47, s46, 0x6000
    buffer_load_dwordx4 v3, s[24:27], s47 offen lds
    s_add_u32 m0, s45, 4096
    s_add_u32 s47, s46, 0x8000
    buffer_load_dwordx4 v3, s[24:27], s47 offen lds
    s_add_u32 m0, s45, 5120
    s_add_u32 s47, s46, 0xa000
    buffer_load_dwordx4 v3, s[24:27], s47 offen lds
    s_add_u32 m0, s45, 6144
    s_add_u32 s47, s46, 0xc000
    buffer_load_dwordx4 v3, s[24:27], s47 offen lds
    s_add_u32 m0, s45, 7168
    s_add_u32 s47, s46, 0xe000
    buffer_load_dwordx4 v3, s[24:27], s47 offen lds
    s_add_u32 m0, s45, 8192
    s_add_u32 s47, s46, 0x10000
    buffer_load_dwordx4 v3, s[24:27], s47 offen lds
    s_add_u32 m0, s45, 9216
    s_add_u32 s47, s46, 0x12000
    buffer_load_dwordx4 v3, s[24:27], s47 offen lds
    s_add_u32 m0, s45, 10240
    s_add_u32 s47, s46, 0x14000
    buffer_load_dwordx4 v3, s[24:27], s47 offen lds
    s_add_u32 m0, s45, 11264
    s_add_u32 s47, s46, 0x16000
    buffer_load_dwordx4 v3, s[24:27], s47 offen lds
    s_add_u32 m0, s45, 12288
    s_add_u32 s47, s46, 0x18000
    buffer_load_dwordx4 v3, s[24:27], s47 offen lds
    s_add_u32 m0, s45, 13312
    s_add_u32 s47, s46, 0x1a000
    buffer_load_dwordx4 v3, s[24:27], s47 offen lds
    s_waitcnt vmcnt(0)
    s_barrier
    ds_read_b64_tr_b16 a[0:1], v5 offset:0
    ds_read_b64_tr_b16 a[2:3], v5 offset:2048
    ds_read_b64_tr_b16 a[4:5], v5 offset:32
    ds_read_b64_tr_b16 a[6:7], v5 offset:2080
    ds_read_b64_tr_b16 a[8:9], v5 offset:8192
    ds_read_b64_tr_b16 a[10:11], v5 offset:10240
    ds_read_b64_tr_b16 a[12:13], v5 offset:8224
    ds_read_b64_tr_b16 a[14:15], v5 offset:10272
    s_waitcnt lgkmcnt(0)
    ds_read_b64_tr_b16 a[16:17], v5 offset:16384
    ds_read_b64_tr_b16 a[18:19], v5 offset:18432
    ds_read_b64_tr_b16 a[20:21], v5 offset:16416
    ds_read_b64_tr_b16 a[22:23], v5 offset:18464
    ds_read_b64_tr_b16 a[24:25], v5 offset:24576
    ds_read_b64_tr_b16 a[26:27], v5 offset:26624
    ds_read_b64_tr_b16 a[28:29], v5 offset:24608
    ds_read_b64_tr_b16 a[30:31], v5 offset:26656
    s_waitcnt lgkmcnt(0)
    ds_read_b64_tr_b16 a[32:33], v5 offset:32768
    ds_read_b64_tr_b16 a[34:35], v5 offset:34816
    ds_read_b64_tr_b16 a[36:37], v5 offset:32800
    ds_read_b64_tr_b16 a[38:39], v5 offset:34848
    ds_read_b64_tr_b16 a[40:41], v5 offset:40960
    ds_read_b64_tr_b16 a[42:43], v5 offset:43008
    ds_read_b64_tr_b16 a[44:45], v5 offset:40992
    ds_read_b64_tr_b16 a[46:47], v5 offset:43040
    s_waitcnt lgkmcnt(0)
    ds_read_b64_tr_b16 a[48:49], v5 offset:49152
    ds_read_b64_tr_b16 a[50:51], v5 offset:51200
    ds_read_b64_tr_b16 a[52:53], v5 offset:49184
    ds_read_b64_tr_b16 a[54:55], v5 offset:51232
    s_waitcnt lgkmcnt(0)
    s_barrier
    s_add_u32 m0, s45, 0
    s_add_u32 s47, s46, 0x70000
    buffer_load_dwordx4 v3, s[24:27], s47 offen lds
    s_add_u32 m0, s45, 1024
    s_add_u32 s47, s46, 0x72000
    buffer_load_dwordx4 v3, s[24:27], s47 offen lds
    s_add_u32 m0, s45, 2048
    s_add_u32 s47, s46, 0x74000
    buffer_load_dwordx4 v3, s[24:27], s47 offen lds
    s_add_u32 m0, s45, 3072
    s_add_u32 s47, s46, 0x76000
    buffer_load_dwordx4 v3, s[24:27], s47 offen lds
    s_add_u32 m0, s45, 4096
    s_add_u32 s47, s46, 0x78000
    buffer_load_dwordx4 v3, s[24:27], s47 offen lds
    s_add_u32 m0, s45, 5120
    s_add_u32 s47, s46, 0x7a000
    buffer_load_dwordx4 v3, s[24:27], s47 offen lds
    s_add_u32 m0, s45, 6144
    s_add_u32 s47, s46, 0x7c000
    buffer_load_dwordx4 v3, s[24:27], s47 offen lds
    s_add_u32 m0, s45, 7168
    s_add_u32 s47, s46, 0x7e000
    buffer_load_dwordx4 v3, s[24:27], s47 offen lds
    s_add_u32 m0, s45, 8192
    s_add_u32 s47, s46, 0x80000
    buffer_load_dwordx4 v3, s[24:27], s47 offen lds
    s_add_u32 m0, s45, 9216
    s_add_u32 s47, s46, 0x82000
    buffer_load_dwordx4 v3, s[24:27], s47 offen lds
    s_add_u32 m0, s45, 10240
    s_add_u32 s47, s46, 0x84000
    buffer_load_dwordx4 v3, s[24:27], s47 offen lds
    s_add_u32 m0, s45, 11264
    s_add_u32 s47, s46, 0x86000
    buffer_load_dwordx4 v3, s[24:27], s47 offen lds
    s_add_u32 m0, s45, 12288
    s_add_u32 s47, s46, 0x88000
    buffer_load_dwordx4 v3, s[24:27], s47 offen lds
    s_add_u32 m0, s45, 13312
    s_add_u32 s47, s46, 0x8a000
    buffer_load_dwordx4 v3, s[24:27], s47 offen lds
    s_waitcnt vmcnt(0)
    s_barrier
    ds_read_b64_tr_b16 a[56:57], v5 offset:0
    ds_read_b64_tr_b16 a[58:59], v5 offset:2048
    ds_read_b64_tr_b16 a[60:61], v5 offset:32
    ds_read_b64_tr_b16 a[62:63], v5 offset:2080
    ds_read_b64_tr_b16 a[64:65], v5 offset:8192
    ds_read_b64_tr_b16 a[66:67], v5 offset:10240
    ds_read_b64_tr_b16 a[68:69], v5 offset:8224
    ds_read_b64_tr_b16 a[70:71], v5 offset:10272
    s_waitcnt lgkmcnt(0)
    ds_read_b64_tr_b16 a[72:73], v5 offset:16384
    ds_read_b64_tr_b16 a[74:75], v5 offset:18432
    ds_read_b64_tr_b16 a[76:77], v5 offset:16416
    ds_read_b64_tr_b16 a[78:79], v5 offset:18464
    ds_read_b64_tr_b16 a[80:81], v5 offset:24576
    ds_read_b64_tr_b16 a[82:83], v5 offset:26624
    ds_read_b64_tr_b16 a[84:85], v5 offset:24608
    ds_read_b64_tr_b16 a[86:87], v5 offset:26656
    s_waitcnt lgkmcnt(0)
    ds_read_b64_tr_b16 a[88:89], v5 offset:32768
    ds_read_b64_tr_b16 a[90:91], v5 offset:34816
    ds_read_b64_tr_b16 a[92:93], v5 offset:32800
    ds_read_b64_tr_b16 a[94:95], v5 offset:34848
    ds_read_b64_tr_b16 a[96:97], v5 offset:40960
    ds_read_b64_tr_b16 a[98:99], v5 offset:43008
    ds_read_b64_tr_b16 a[100:101], v5 offset:40992
    ds_read_b64_tr_b16 a[102:103], v5 offset:43040
    s_waitcnt lgkmcnt(0)
    ds_read_b64_tr_b16 a[104:105], v5 offset:49152
    ds_read_b64_tr_b16 a[106:107], v5 offset:51200
    ds_read_b64_tr_b16 a[108:109], v5 offset:49184
    ds_read_b64_tr_b16 a[110:111], v5 offset:51232
    s_waitcnt lgkmcnt(0)
    s_barrier
    v_lshlrev_b32 v2, 4, v1
    s_mul_i32 s64, s44, 7168
    s_add_u32 s46, s64, 0x6000000
    s_mul_i32 s47, s42, 57344
    s_add_u32 s46, s46, s47
    v_add_u32 v3, s46, v2
    s_mul_i32 s46, s51, 28672
    v_add_u32 v4, s46, v2
    v_and_b32 v6, 15, v1
    v_lshlrev_b32 v6, 4, v6
    v_lshrrev_b32 v7, 4, v1
    v_lshl_add_u32 v6, v7, 9, v6
    v_add_u32 v4, s46, v6
    s_lshl_b32 s46, s50, 12
    s_add_u32 s46, s46, 131072
    v_add_u32 v5, s46, v2
    v_and_b32 v7, 15, v1
    v_min_u32 v7, 6, v7
    v_lshlrev_b32 v7, 7, v7
    s_mul_i32 s46, s42, 896
    s_add_u32 s46, s46, 0x106400
    v_add_u32 v7, s46, v7
    s_lshl_b32 s46, s42, 16
    s_lshl_b32 s47, s43, 11
    s_add_u32 s46, s46, s47
    s_lshl_b32 s47, s50, 9
    s_add_u32 s46, s46, s47
    s_add_u32 s46, s46, 0xb000000
    v_and_b32 v8, 31, v1
    v_lshlrev_b32 v8, 4, v8
    v_lshrrev_b32 v9, 5, v1
    v_lshl_add_u32 v8, v9, 14, v8
    v_add_u32 v8, s46, v8
    v_add_u32 v9, 0x8000, v8
    s_lshl_b32 s52, s43, 9
    s_lshl_b32 s47, s42, 7
    s_add_u32 s52, s52, s47
    s_add_u32 s52, s52, 0x108400
    s_add_u32 s52, s52, s76
    s_mul_i32 s46, s43, 7168
    s_add_u32 s46, s46, 0x6000000
    s_mul_i32 s47, s42, 57344
    s_add_u32 s46, s46, s47
    v_min_u32 v116, 55, v1
    v_lshlrev_b32 v116, 7, v116
    v_add_u32 v116, s46, v116
    s_mov_b32 s60, s74
    s_mul_i32 s61, s74, 229376
    s_mov_b32 s62, s74
    s_mul_i32 s63, s74, 262144
    s_mov_b32 s67, 0
    s_mov_b32 s68, 3
    s_mov_b32 s71, 0
    v_mov_b32 v15, 147456
    v_mov_b32 v14, 0
    ds_write_b32 v15, v14 offset:4
    ds_write_b32 v15, v14 offset:12
    ds_write_b32 v15, v14 offset:16
    v_mov_b32 v114, 1
    v_mov_b32 v115, 0
    v_lshrrev_b32 v113, 4, v1
    s_mov_b32 s72, 0
L_g_restart_115:
    s_cmp_lg_u32 s44, 0
    s_cbranch_scc1 L_g_nsp_116
    s_mov_b32 s70, 0
L_g_sp_122:
    s_add_u32 s54, s60, 0
    v_add_u32 v12, s54, v113
    v_subrev_u32 v13, 58, v12
    v_subrev_u32 v11, 61, v12
    v_ashrrev_i32 v13, 31, v13
    v_ashrrev_i32 v11, 31, v11
    v_add3_u32 v13, v13, v11, 2
    v_lshl_add_u32 v13, v13, 16, v7
    buffer_load_dword v11, v13, s[12:15], 0 offen sc1
    s_waitcnt vmcnt(0)
    v_cmp_ge_u32 vcc, v12, v11
    s_add_u32 s70, s70, 1
    s_and_b32 s46, vcc_lo, 0xffff
    s_cbranch_scc0 L_g_sp_122_ok
    s_sleep 3
    s_cmp_lt_u32 s70, 524288
    s_cbranch_scc1 L_g_sp_122
    s_branch L_c_done_1
L_g_sp_122_ok:
    v_cmp_ge_u32 vcc, v12, v11
    s_nop 0
    s_ff1_i32_b64 s46, vcc
    s_lshr_b32 s46, s46, 4
    s_min_u32 s46, s46, 4
    s_add_u32 s46, s46, s54
    s_min_u32 s46, s46, s75
    v_mov_b32 v11, s46
    ds_write_b32 v15, v11
L_g_nsp_116:
    s_waitcnt lgkmcnt(0)
    s_barrier
    ds_read_b32 v14, v15
    s_waitcnt lgkmcnt(0)
    v_readfirstlane_b32 s66, v14
    s_nop 3
L_g_restart_115_go:
    s_mov_b32 s69, 0
    s_cmp_gt_u32 s62, s60
    s_cbranch_scc1 L_g_nd_123
    s_cmp_ge_u32 s62, s66
    s_cbranch_scc1 L_g_nd_123
    s_add_u32 s47, s61, 4096
    s_add_u32 m0, s64, 0
    s_nop 0
    buffer_load_dwordx4 v3, s[12:15], s61 offen offset:0 sc1 lds
    buffer_load_dwordx4 v3, s[12:15], s61 offen offset:1024 sc1 lds
    buffer_load_dwordx4 v3, s[12:15], s61 offen offset:2048 sc1 lds
    buffer_load_dwordx4 v3, s[12:15], s61 offen offset:3072 sc1 lds
    s_add_u32 m0, s64, 4096
    s_nop 0
    buffer_load_dwordx4 v3, s[12:15], s47 offen offset:0 sc1 lds
    buffer_load_dwordx4 v3, s[12:15], s47 offen offset:1024 sc1 lds
    buffer_load_dwordx4 v3, s[12:15], s47 offen offset:2048 sc1 lds
    s_add_u32 s61, s61, 229376
    s_add_u32 s62, s62, 1
    s_xor_b32 s64, s64, 0x10000
    s_mov_b32 s69, 1
L_g_nd_123:
    s_cmp_eq_u32 s51, 1
    s_cbranch_scc1 L_g_g1r_117
    s_add_u32 s59, s60, 1
    s_mov_b32 s69, 0
    s_cmp_gt_u32 s62, s59
    s_cbranch_scc1 L_g_nd_124
    s_cmp_ge_u32 s62, s66
    s_cbranch_scc1 L_g_nd_124
    s_add_u32 s47, s61, 4096
    s_add_u32 m0, s64, 0
    s_nop 0
    buffer_load_dwordx4 v3, s[12:15], s61 offen offset:0 sc1 lds
    buffer_load_dwordx4 v3, s[12:15], s61 offen offset:1024 sc1 lds
    buffer_load_dwordx4 v3, s[12:15], s61 offen offset:2048 sc1 lds
    buffer_load_dwordx4 v3, s[12:15], s61 offen offset:3072 sc1 lds
    s_add_u32 m0, s64, 4096
    s_nop 0
    buffer_load_dwordx4 v3, s[12:15], s47 offen offset:0 sc1 lds
    buffer_load_dwordx4 v3, s[12:15], s47 offen offset:1024 sc1 lds
    buffer_load_dwordx4 v3, s[12:15], s47 offen offset:2048 sc1 lds
    s_add_u32 s61, s61, 229376
    s_add_u32 s62, s62, 1
    s_xor_b32 s64, s64, 0x10000
    s_mov_b32 s69, 1
L_g_nd_124:
    s_cmp_eq_u32 s69, 1
    s_cbranch_scc1 L_g_w0_125
    s_waitcnt vmcnt(0)
L_g_w0_125:
    s_waitcnt vmcnt(7)
    s_cmp_lg_u32 s44, 0
    s_cbranch_scc1 L_g_nl_126
    s_add_u32 s54, s60, 1
    v_add_u32 v12, s54, v113
    v_subrev_u32 v13, 58, v12
    v_subrev_u32 v11, 61, v12
    v_ashrrev_i32 v13, 31, v13
    v_ashrrev_i32 v11, 31, v11
    v_add3_u32 v13, v13, v11, 2
    v_lshl_add_u32 v13, v13, 16, v7
    buffer_load_dword v11, v13, s[12:15], 0 offen sc1
L_g_nl_126:
L_g_loop0_118_l:
    s_barrier
    ds_read_b128 v[32:35], v4 offset:0
    ds_read_b128 v[36:39], v4 offset:256
    ds_read_b128 v[40:43], v4 offset:2048
    ds_read_b128 v[44:47], v4 offset:2304
    ds_read_b128 v[48:51], v4 offset:4096
    ds_read_b128 v[52:55], v4 offset:4352
    ds_read_b128 v[56:59], v4 offset:6144
    ds_read_b128 v[60:63], v4 offset:6400
    s_branch L_g_loop0_118_m
.p2align 6
L_g_loop0_118:
    s_barrier
L_g_loop0_118_m:
    s_setprio 2
    s_waitcnt lgkmcnt(6)
    v_mfma_f32_16x16x32_bf16 v[16:19], v[32:35], a[0:3], 0
    ds_read_b32 v14, v15
    v_mfma_f32_16x16x32_bf16 v[20:23], v[32:35], a[4:7], 0
    ds_read_b128 v[32:35], v4 offset:8192
    v_mfma_f32_16x16x32_bf16 v[28:31], v[36:39], a[4:7], 0
    v_mfma_f32_16x16x32_bf16 v[24:27], v[36:39], a[0:3], 0
    ds_read_b128 v[36:39], v4 offset:8448
    s_waitcnt lgkmcnt(6)
    v_mfma_f32_16x16x32_bf16 v[16:19], v[40:43], a[8:11], v[16:19]
    v_mfma_f32_16x16x32_bf16 v[20:23], v[40:43], a[12:15], v[20:23]
    ds_read_b128 v[40:43], v4 offset:10240
    v_mfma_f32_16x16x32_bf16 v[28:31], v[44:47], a[12:15], v[28:31]
    v_mfma_f32_16x16x32_bf16 v[24:27], v[44:47], a[8:11], v[24:27]
    ds_read_b128 v[44:47], v4 offset:10496
    s_waitcnt lgkmcnt(6)
    v_mfma_f32_16x16x32_bf16 v[16:19], v[48:51], a[16:19], v[16:19]
    v_mfma_f32_16x16x32_bf16 v[20:23], v[48:51], a[20:23], v[20:23]
    ds_read_b128 v[48:51], v4 offset:12288
    v_mfma_f32_16x16x32_bf16 v[28:31], v[52:55], a[20:23], v[28:31]
    v_mfma_f32_16x16x32_bf16 v[24:27], v[52:55], a[16:19], v[24:27]
    ds_read_b128 v[52:55], v4 offset:12544
    s_waitcnt lgkmcnt(6)
    v_mfma_f32_16x16x32_bf16 v[16:19], v[56:59], a[24:27], v[16:19]
    v_mfma_f32_16x16x32_bf16 v[20:23], v[56:59], a[28:31], v[20:23]
    ds_read_b128 v[56:59], v4 offset:14336
    v_mfma_f32_16x16x32_bf16 v[28:31], v[60:63], a[28:31], v[28:31]
    v_mfma_f32_16x16x32_bf16 v[24:27], v[60:63], a[24:27], v[24:27]
    ds_read_b128 v[60:63], v4 offset:14592
    s_waitcnt lgkmcnt(6)
    v_mfma_f32_16x16x32_bf16 v[16:19], v[32:35], a[32:35], v[16:19]
    v_mfma_f32_16x16x32_bf16 v[20:23], v[32:35], a[36:39], v[20:23]
    ds_read_b128 v[32:35], v4 offset:16384
    v_mfma_f32_16x16x32_bf16 v[28:31], v[36:39], a[36:39], v[28:31]
    v_mfma_f32_16x16x32_bf16 v[24:27], v[36:39], a[32:35], v[24:27]
    ds_read_b128 v[36:39], v4 offset:16640
    s_waitcnt lgkmcnt(6)
    v_mfma_f32_16x16x32_bf16 v[16:19], v[40:43], a[40:43], v[16:19]
    v_mfma_f32_16x16x32_bf16 v[20:23], v[40:43], a[44:47], v[20:23]
    ds_read_b128 v[40:43], v4 offset:18432
    v_mfma_f32_16x16x32_bf16 v[28:31], v[44:47], a[44:47], v[28:31]
    v_mfma_f32_16x16x32_bf16 v[24:27], v[44:47], a[40:43], v[24:27]
    ds_read_b128 v[44:47], v4 offset:18688
    s_waitcnt lgkmcnt(6)
    v_mfma_f32_16x16x32_bf16 v[16:19], v[48:51], a[48:51], v[16:19]
    v_mfma_f32_16x16x32_bf16 v[20:23], v[48:51], a[52:55], v[20:23]
    ds_read_b128 v[48:51], v4 offset:20480
    v_mfma_f32_16x16x32_bf16 v[28:31], v[52:55], a[52:55], v[28:31]
    v_mfma_f32_16x16x32_bf16 v[24:27], v[52:55], a[48:51], v[24:27]
    ds_read_b128 v[52:55], v4 offset:20736
    s_waitcnt lgkmcnt(6)
    v_mfma_f32_16x16x32_bf16 v[16:19], v[56:59], a[56:59], v[16:19]
    v_mfma_f32_16x16x32_bf16 v[20:23], v[56:59], a[60:63], v[20:23]
    ds_read_b128 v[56:59], v4 offset:22528
    v_mfma_f32_16x16x32_bf16 v[28:31], v[60:63], a[60:63], v[28:31]
    v_mfma_f32_16x16x32_bf16 v[24:27], v[60:63], a[56:59], v[24:27]
    ds_read_b128 v[60:63], v4 offset:22784
    s_waitcnt lgkmcnt(6)
    v_mfma_f32_16x16x32_bf16 v[16:19], v[32:35], a[64:67], v[16:19]
    v_mfma_f32_16x16x32_bf16 v[20:23], v[32:35], a[68:71], v[20:23]
    ds_read_b128 v[32:35], v4 offset:24576
    v_mfma_f32_16x16x32_bf16 v[28:31], v[36:39], a[68:71], v[28:31]
    v_mfma_f32_16x16x32_bf16 v[24:27], v[36:39], a[64:67], v[24:27]
    ds_read_b128 v[36:39], v4 offset:24832
    s_waitcnt lgkmcnt(6)
    v_mfma_f32_16x16x32_bf16 v[16:19], v[40:43], a[72:75], v[16:19]
    v_mfma_f32_16x16x32_bf16 v[20:23], v[40:43], a[76:79], v[20:23]
    ds_read_b128 v[40:43], v4 offset:26624
    v_mfma_f32_16x16x32_bf16 v[28:31], v[44:47], a[76:79], v[28:31]
    v_mfma_f32_16x16x32_bf16 v[24:27], v[44:47], a[72:75], v[24:27]
    ds_read_b128 v[44:47], v4 offset:26880
    s_waitcnt lgkmcnt(6)
    v_mfma_f32_16x16x32_bf16 v[16:19], v[48:51], a[80:83], v[16:19]
    v_mfma_f32_16x16x32_bf16 v[20:23], v[48:51], a[84:87], v[20:23]
    v_mfma_f32_16x16x32_bf16 v[28:31], v[52:55], a[84:87], v[28:31]
    v_mfma_f32_16x16x32_bf16 v[24:27], v[52:55], a[80:83], v[24:27]
    s_waitcnt lgkmcnt(4)
    v_mfma_f32_16x16x32_bf16 v[16:19], v[56:59], a[88:91], v[16:19]
    v_mfma_f32_16x16x32_bf16 v[20:23], v[56:59], a[92:95], v[20:23]
    v_mfma_f32_16x16x32_bf16 v[28:31], v[60:63], a[92:95], v[28:31]
    v_mfma_f32_16x16x32_bf16 v[24:27], v[60:63], a[88:91], v[24:27]
    s_waitcnt lgkmcnt(2)
    v_mfma_f32_16x16x32_bf16 v[16:19], v[32:35], a[96:99], v[16:19]
    v_mfma_f32_16x16x32_bf16 v[20:23], v[32:35], a[100:103], v[20:23]
    v_mfma_f32_16x16x32_bf16 v[28:31], v[36:39], a[100:103], v[28:31]
    v_mfma_f32_16x16x32_bf16 v[24:27], v[36:39], a[96:99], v[24:27]
    s_waitcnt lgkmcnt(0)
    v_mfma_f32_16x16x32_bf16 v[16:19], v[40:43], a[104:107], v[16:19]
    v_mfma_f32_16x16x32_bf16 v[20:23], v[40:43], a[108:111], v[20:23]
    v_mfma_f32_16x16x32_bf16 v[28:31], v[44:47], a[108:111], v[28:31]
    v_mfma_f32_16x16x32_bf16 v[24:27], v[44:47], a[104:107], v[24:27]
    v_xor_b32 v4, 0x10000, v4
    s_setprio 0
    s_waitcnt vmcnt(0)
    v_readfirstlane_b32 s66, v14
    s_barrier
    s_nop 6
    ds_write_b128 v5, v[16:19] offset:0
    ds_write_b128 v5, v[20:23] offset:1024
    ds_write_b128 v5, v[24:27] offset:2048
    ds_write_b128 v5, v[28:31] offset:3072
    s_cmp_lg_u32 s44, 0
    s_cbranch_scc1 L_g_ne_127
    v_cmp_ge_u32 vcc, v12, v11
    s_nop 0
    s_ff1_i32_b64 s46, vcc
    s_lshr_b32 s46, s46, 4
    s_min_u32 s46, s46, 4
    s_add_u32 s46, s46, s54
    s_min_u32 s46, s46, s75
    v_mov_b32 v11, s46
    ds_write_b32 v15, v11
L_g_ne_127:
    s_add_u32 s60, s60, 1
    s_mov_b32 s65, 0
    s_cmp_le_u32 s62, s60
    s_cbranch_scc1 L_g_dp_130_l
L_g_dp_130_a:
    s_cmp_ge_u32 s62, s66
    s_cbranch_scc1 L_g_dp_130_d
    s_add_u32 s47, s61, 4096
    s_mov_b32 m0, s64
    s_add_u32 s62, s62, 1
    buffer_load_dwordx4 v3, s[12:15], s61 offen offset:0 sc1 lds
    buffer_load_dwordx4 v3, s[12:15], s61 offen offset:1024 sc1 lds
    buffer_load_dwordx4 v3, s[12:15], s61 offen offset:2048 sc1 lds
    buffer_load_dwordx4 v3, s[12:15], s61 offen offset:3072 sc1 lds
    s_add_u32 m0, s64, 4096
    s_add_u32 s61, s61, 229376
    buffer_load_dwordx4 v3, s[12:15], s47 offen offset:0 sc1 lds
    buffer_load_dwordx4 v3, s[12:15], s47 offen offset:1024 sc1 lds
    buffer_load_dwordx4 v3, s[12:15], s47 offen offset:2048 sc1 lds
    s_xor_b32 s64, s64, 0x10000
L_g_dp_130_d:
    s_cmp_le_u32 s66, s60
    s_cbranch_scc1 L_g_ex0_129
    s_cmp_lg_u32 s65, 0
    s_cbranch_scc1 L_g_nw_128
    ds_read_b128 v[32:35], v4 offset:0
    ds_read_b128 v[36:39], v4 offset:256
    ds_read_b128 v[40:43], v4 offset:2048
    ds_read_b128 v[44:47], v4 offset:2304
    ds_read_b128 v[48:51], v4 offset:4096
    ds_read_b128 v[52:55], v4 offset:4352
    ds_read_b128 v[56:59], v4 offset:6144
    ds_read_b128 v[60:63], v4 offset:6400
    s_cmp_lg_u32 s44, 0
    s_cbranch_scc1 L_g_nl_131
    s_add_u32 s54, s60, 1
    v_add_u32 v12, s54, v113
    v_subrev_u32 v13, 58, v12
    v_subrev_u32 v11, 61, v12
    v_ashrrev_i32 v13, 31, v13
    v_ashrrev_i32 v11, 31, v11
    v_add3_u32 v13, v13, v11, 2
    v_lshl_add_u32 v13, v13, 16, v7
    buffer_load_dword v11, v13, s[12:15], 0 offen sc1
L_g_nl_131:
    s_waitcnt lgkmcnt(8)
    s_branch L_g_loop0_118
L_g_ex0_129:
    s_cmp_lg_u32 s44, 0
    s_cbranch_scc1 L_g_ex0_129_n
    s_sleep 6
    s_add_u32 s54, s60, 0
    v_add_u32 v12, s54, v113
    v_subrev_u32 v13, 58, v12
    v_subrev_u32 v11, 61, v12
    v_ashrrev_i32 v13, 31, v13
    v_ashrrev_i32 v11, 31, v11
    v_add3_u32 v13, v13, v11, 2
    v_lshl_add_u32 v13, v13, 16, v7
    buffer_load_dword v11, v13, s[12:15], 0 offen sc1
    s_waitcnt vmcnt(0)
    v_cmp_ge_u32 vcc, v12, v11
    s_nop 0
    s_ff1_i32_b64 s46, vcc
    s_lshr_b32 s46, s46, 4
    s_min_u32 s46, s46, 4
    s_add_u32 s46, s46, s54
    s_min_u32 s46, s46, s75
    v_mov_b32 v11, s46
    ds_write_b32 v15, v11
L_g_ex0_129_n:
    s_waitcnt lgkmcnt(0)
    s_barrier
    ds_read_b32 v14, v15
    s_waitcnt lgkmcnt(0)
    v_readfirstlane_b32 s66, v14
    s_barrier
    s_cmp_gt_u32 s66, s60
    s_cbranch_scc1 L_g_restart_115_go
    s_branch L_g_tail_120
L_g_g1r_117:
    s_mov_b32 s65, 1
    s_branch L_g_loop1_119_e
.p2align 6
L_g_loop1_119:
    s_mov_b32 s65, 0
L_g_loop1_119_e:
    s_barrier
    ds_read_b32 v14, v15
    s_bitcmp1_b32 s67, 1
    s_cbranch_scc0 L_g_nfl_132
    s_cmp_lg_u32 s44, 4
    s_cbranch_scc1 L_g_nfl_132_d
    s_sub_u32 s59, s60, 1
    v_mov_b32 v10, s59
    buffer_store_dword v10, v115, s[12:15], s52 offen sc1
L_g_nfl_132_d:
    s_waitcnt lgkmcnt(0)
    v_readfirstlane_b32 s66, v14
    ds_read_b128 v[80:83], v5 offset:0
    ds_read_b128 v[84:87], v5 offset:1024
    ds_read_b128 v[88:91], v5 offset:2048
    ds_read_b128 v[92:95], v5 offset:3072
    s_cmp_le_u32 s62, s60
    s_cbranch_scc1 L_g_dp_137_l
L_g_dp_137_a:
    s_cmp_ge_u32 s62, s66
    s_cbranch_scc1 L_g_dp_137_d
    s_add_u32 s47, s61, 4096
    s_mov_b32 m0, s64
    s_add_u32 s62, s62, 1
    buffer_load_dwordx4 v3, s[12:15], s61 offen offset:0 sc1 lds
    buffer_load_dwordx4 v3, s[12:15], s61 offen offset:1024 sc1 lds
    buffer_load_dwordx4 v3, s[12:15], s61 offen offset:2048 sc1 lds
    buffer_load_dwordx4 v3, s[12:15], s61 offen offset:3072 sc1 lds
    s_add_u32 m0, s64, 4096
    s_add_u32 s61, s61, 229376
    buffer_load_dwordx4 v3, s[12:15], s47 offen offset:0 sc1 lds
    buffer_load_dwordx4 v3, s[12:15], s47 offen offset:1024 sc1 lds
    buffer_load_dwordx4 v3, s[12:15], s47 offen offset:2048 sc1 lds
    s_xor_b32 s64, s64, 0x10000
L_g_dp_137_d:
    s_bitcmp1_b32 s67, 0
    s_cbranch_scc0 L_g_nep_133
    s_waitcnt lgkmcnt(0)
    v_add_f32 v80, v80, v16
    v_add_f32 v81, v81, v17
    v_add_f32 v82, v82, v18
    v_add_f32 v83, v83, v19
    v_add_f32 v84, v84, v20
    v_add_f32 v85, v85, v21
    v_add_f32 v86, v86, v22
    v_add_f32 v87, v87, v23
    v_add_f32 v88, v88, v24
    v_add_f32 v89, v89, v25
    v_add_f32 v90, v90, v26
    v_add_f32 v91, v91, v27
    v_add_f32 v92, v92, v28
    v_add_f32 v93, v93, v29
    v_add_f32 v94, v94, v30
    v_add_f32 v95, v95, v31
    v_cvt_pk_bf16_f32 v104, v80, v81
    v_cvt_pk_bf16_f32 v105, v82, v83
    v_cvt_pk_bf16_f32 v106, v84, v85
    v_cvt_pk_bf16_f32 v107, v86, v87
    s_nop 1
    v_permlane16_swap_b32 v104, v106
    v_permlane16_swap_b32 v105, v107
    buffer_store_dwordx4 v[104:107], v8, s[12:15], s63 offen sc1
    v_cvt_pk_bf16_f32 v108, v88, v89
    v_cvt_pk_bf16_f32 v109, v90, v91
    v_cvt_pk_bf16_f32 v110, v92, v93
    v_cvt_pk_bf16_f32 v111, v94, v95
    s_nop 1
    v_permlane16_swap_b32 v108, v110
    v_permlane16_swap_b32 v109, v111
    buffer_store_dwordx4 v[108:111], v9, s[12:15], s63 offen sc1
    s_add_u32 s63, s63, 262144
L_g_nep_133:
    s_cmp_lg_u32 s65, 0
    s_cbranch_scc1 L_g_nw1_134
    ds_read_b128 v[32:35], v4 offset:0
    ds_read_b128 v[36:39], v4 offset:256
    ds_read_b128 v[40:43], v4 offset:2048
    ds_read_b128 v[44:47], v4 offset:2304
    ds_read_b128 v[48:51], v4 offset:4096
    ds_read_b128 v[52:55], v4 offset:4352
    ds_read_b128 v[56:59], v4 offset:6144
    ds_read_b128 v[60:63], v4 offset:6400
    s_barrier
L_g_jn_136:
    s_setprio 1
    s_waitcnt lgkmcnt(6)
    v_mfma_f32_16x16x32_bf16 v[16:19], v[32:35], a[0:3], 0
    v_mfma_f32_16x16x32_bf16 v[20:23], v[32:35], a[4:7], 0
    ds_read_b128 v[32:35], v4 offset:8192
    v_mfma_f32_16x16x32_bf16 v[28:31], v[36:39], a[4:7], 0
    v_mfma_f32_16x16x32_bf16 v[24:27], v[36:39], a[0:3], 0
    ds_read_b128 v[36:39], v4 offset:8448
    s_waitcnt lgkmcnt(6)
    v_mfma_f32_16x16x32_bf16 v[16:19], v[40:43], a[8:11], v[16:19]
    v_mfma_f32_16x16x32_bf16 v[20:23], v[40:43], a[12:15], v[20:23]
    ds_read_b128 v[40:43], v4 offset:10240
    v_mfma_f32_16x16x32_bf16 v[28:31], v[44:47], a[12:15], v[28:31]
    v_mfma_f32_16x16x32_bf16 v[24:27], v[44:47], a[8:11], v[24:27]
    ds_read_b128 v[44:47], v4 offset:10496
    s_waitcnt lgkmcnt(6)
    v_mfma_f32_16x16x32_bf16 v[16:19], v[48:51], a[16:19], v[16:19]
    v_mfma_f32_16x16x32_bf16 v[20:23], v[48:51], a[20:23], v[20:23]
    ds_read_b128 v[48:51], v4 offset:12288
    v_mfma_f32_16x16x32_bf16 v[28:31], v[52:55], a[20:23], v[28:31]
    v_mfma_f32_16x16x32_bf16 v[24:27], v[52:55], a[16:19], v[24:27]
    ds_read_b128 v[52:55], v4 offset:12544
    s_waitcnt lgkmcnt(6)
    v_mfma_f32_16x16x32_bf16 v[16:19], v[56:59], a[24:27], v[16:19]
    v_mfma_f32_16x16x32_bf16 v[20:23], v[56:59], a[28:31], v[20:23]
    ds_read_b128 v[56:59], v4 offset:14336
    v_mfma_f32_16x16x32_bf16 v[28:31], v[60:63], a[28:31], v[28:31]
    v_mfma_f32_16x16x32_bf16 v[24:27], v[60:63], a[24:27], v[24:27]
    ds_read_b128 v[60:63], v4 offset:14592
    s_waitcnt lgkmcnt(6)
    v_mfma_f32_16x16x32_bf16 v[16:19], v[32:35], a[32:35], v[16:19]
    v_mfma_f32_16x16x32_bf16 v[20:23], v[32:35], a[36:39], v[20:23]
    ds_read_b128 v[32:35], v4 offset:16384
    v_mfma_f32_16x16x32_bf16 v[28:31], v[36:39], a[36:39], v[28:31]
    v_mfma_f32_16x16x32_bf16 v[24:27], v[36:39], a[32:35], v[24:27]
    ds_read_b128 v[36:39], v4 offset:16640
    s_waitcnt lgkmcnt(6)
    v_mfma_f32_16x16x32_bf16 v[16:19], v[40:43], a[40:43], v[16:19]
    v_mfma_f32_16x16x32_bf16 v[20:23], v[40:43], a[44:47], v[20:23]
    ds_read_b128 v[40:43], v4 offset:18432
    v_mfma_f32_16x16x32_bf16 v[28:31], v[44:47], a[44:47], v[28:31]
    v_mfma_f32_16x16x32_bf16 v[24:27], v[44:47], a[40:43], v[24:27]
    ds_read_b128 v[44:47], v4 offset:18688
    s_waitcnt lgkmcnt(6)
    v_mfma_f32_16x16x32_bf16 v[16:19], v[48:51], a[48:51], v[16:19]
    v_mfma_f32_16x16x32_bf16 v[20:23], v[48:51], a[52:55], v[20:23]
    ds_read_b128 v[48:51], v4 offset:20480
    v_mfma_f32_16x16x32_bf16 v[28:31], v[52:55], a[52:55], v[28:31]
    v_mfma_f32_16x16x32_bf16 v[24:27], v[52:55], a[48:51], v[24:27]
    ds_read_b128 v[52:55], v4 offset:20736
    s_waitcnt lgkmcnt(6)
    v_mfma_f32_16x16x32_bf16 v[16:19], v[56:59], a[56:59], v[16:19]
    v_mfma_f32_16x16x32_bf16 v[20:23], v[56:59], a[60:63], v[20:23]
    ds_read_b128 v[56:59], v4 offset:22528
    v_mfma_f32_16x16x32_bf16 v[28:31], v[60:63], a[60:63], v[28:31]
    v_mfma_f32_16x16x32_bf16 v[24:27], v[60:63], a[56:59], v[24:27]
    ds_read_b128 v[60:63], v4 offset:22784
    s_waitcnt lgkmcnt(6)
    v_mfma_f32_16x16x32_bf16 v[16:19], v[32:35], a[64:67], v[16:19]
    v_mfma_f32_16x16x32_bf16 v[20:23], v[32:35], a[68:71], v[20:23]
    ds_read_b128 v[32:35], v4 offset:24576
    v_mfma_f32_16x16x32_bf16 v[28:31], v[36:39], a[68:71], v[28:31]
    v_mfma_f32_16x16x32_bf16 v[24:27], v[36:39], a[64:67], v[24:27]
    ds_read_b128 v[36:39], v4 offset:24832
    s_waitcnt lgkmcnt(6)
    v_mfma_f32_16x16x32_bf16 v[16:19], v[40:43], a[72:75], v[16:19]
    v_mfma_f32_16x16x32_bf16 v[20:23], v[40:43], a[76:79], v[20:23]
    ds_read_b128 v[40:43], v4 offset:26624
    v_mfma_f32_16x16x32_bf16 v[28:31], v[44:47], a[76:79], v[28:31]
    v_mfma_f32_16x16x32_bf16 v[24:27], v[44:47], a[72:75], v[24:27]
    ds_read_b128 v[44:47], v4 offset:26880
    s_waitcnt lgkmcnt(6)
    v_mfma_f32_16x16x32_bf16 v[16:19], v[48:51], a[80:83], v[16:19]
    v_mfma_f32_16x16x32_bf16 v[20:23], v[48:51], a[84:87], v[20:23]
    v_mfma_f32_16x16x32_bf16 v[28:31], v[52:55], a[84:87], v[28:31]
    v_mfma_f32_16x16x32_bf16 v[24:27], v[52:55], a[80:83], v[24:27]
    s_waitcnt lgkmcnt(4)
    v_mfma_f32_16x16x32_bf16 v[16:19], v[56:59], a[88:91], v[16:19]
    v_mfma_f32_16x16x32_bf16 v[20:23], v[56:59], a[92:95], v[20:23]
    v_mfma_f32_16x16x32_bf16 v[28:31], v[60:63], a[92:95], v[28:31]
    v_mfma_f32_16x16x32_bf16 v[24:27], v[60:63], a[88:91], v[24:27]
    s_waitcnt lgkmcnt(2)
    v_mfma_f32_16x16x32_bf16 v[16:19], v[32:35], a[96:99], v[16:19]
    v_mfma_f32_16x16x32_bf16 v[20:23], v[32:35], a[100:103], v[20:23]
    v_mfma_f32_16x16x32_bf16 v[28:31], v[36:39], a[100:103], v[28:31]
    v_mfma_f32_16x16x32_bf16 v[24:27], v[36:39], a[96:99], v[24:27]
    s_waitcnt lgkmcnt(0)
    v_mfma_f32_16x16x32_bf16 v[16:19], v[40:43], a[104:107], v[16:19]
    v_mfma_f32_16x16x32_bf16 v[20:23], v[40:43], a[108:111], v[20:23]
    v_mfma_f32_16x16x32_bf16 v[28:31], v[44:47], a[108:111], v[28:31]
    v_mfma_f32_16x16x32_bf16 v[24:27], v[44:47], a[104:107], v[24:27]
    v_xor_b32 v4, 0x10000, v4
    s_setprio 0
    s_waitcnt vmcnt(0)
    s_lshl_b32 s67, s67, 1
    s_or_b32 s67, s67, 1
    s_add_u32 s60, s60, 1
    s_cmp_gt_u32 s66, s60
    s_cbranch_scc1 L_g_loop1_119
    s_barrier
    ds_read_b32 v14, v15
    s_waitcnt lgkmcnt(0)
    v_readfirstlane_b32 s66, v14
    s_barrier
    s_mov_b32 s69, 0
    s_cmp_gt_u32 s62, s60
    s_cbranch_scc1 L_g_nd_138
    s_cmp_ge_u32 s62, s66
    s_cbranch_scc1 L_g_nd_138
    s_add_u32 s47, s61, 4096
    s_add_u32 m0, s64, 0
    s_nop 0
    buffer_load_dwordx4 v3, s[12:15], s61 offen offset:0 sc1 lds
    buffer_load_dwordx4 v3, s[12:15], s61 offen offset:1024 sc1 lds
    buffer_load_dwordx4 v3, s[12:15], s61 offen offset:2048 sc1 lds
    buffer_load_dwordx4 v3, s[12:15], s61 offen offset:3072 sc1 lds
    s_add_u32 m0, s64, 4096
    s_nop 0
    buffer_load_dwordx4 v3, s[12:15], s47 offen offset:0 sc1 lds
    buffer_load_dwordx4 v3, s[12:15], s47 offen offset:1024 sc1 lds
    buffer_load_dwordx4 v3, s[12:15], s47 offen offset:2048 sc1 lds
    s_add_u32 s61, s61, 229376
    s_add_u32 s62, s62, 1
    s_xor_b32 s64, s64, 0x10000
    s_mov_b32 s69, 1
L_g_nd_138:
    s_sub_u32 s59, s60, 1
    ds_read_b128 v[80:83], v5 offset:0
    ds_read_b128 v[84:87], v5 offset:1024
    ds_read_b128 v[88:91], v5 offset:2048
    ds_read_b128 v[92:95], v5 offset:3072
    s_nop 7
    s_waitcnt lgkmcnt(3)
    v_add_f32 v80, v80, v16
    v_add_f32 v81, v81, v17
    v_add_f32 v82, v82, v18
    v_add_f32 v83, v83, v19
    s_waitcnt lgkmcnt(2)
    v_add_f32 v84, v84, v20
    v_add_f32 v85, v85, v21
    v_add_f32 v86, v86, v22
    v_add_f32 v87, v87, v23
    s_waitcnt lgkmcnt(1)
    v_add_f32 v88, v88, v24
    v_add_f32 v89, v89, v25
    v_add_f32 v90, v90, v26
    v_add_f32 v91, v91, v27
    s_waitcnt lgkmcnt(0)
    v_add_f32 v92, v92, v28
    v_add_f32 v93, v93, v29
    v_add_f32 v94, v94, v30
    v_add_f32 v95, v95, v31
    v_cvt_pk_bf16_f32 v104, v80, v81
    v_cvt_pk_bf16_f32 v105, v82, v83
    v_cvt_pk_bf16_f32 v106, v84, v85
    v_cvt_pk_bf16_f32 v107, v86, v87
    s_nop 1
    v_permlane16_swap_b32 v104, v106
    v_permlane16_swap_b32 v105, v107
    buffer_store_dwordx4 v[104:107], v8, s[12:15], s63 offen sc1
    v_cvt_pk_bf16_f32 v108, v88, v89
    v_cvt_pk_bf16_f32 v109, v90, v91
    v_cvt_pk_bf16_f32 v110, v92, v93
    v_cvt_pk_bf16_f32 v111, v94, v95
    s_nop 1
    v_permlane16_swap_b32 v108, v110
    v_permlane16_swap_b32 v109, v111
    buffer_store_dwordx4 v[108:111], v9, s[12:15], s63 offen sc1
    s_add_u32 s63, s63, 262144
    s_mov_b32 s67, 0
    s_mov_b32 s71, 1
    s_cmp_gt_u32 s66, s60
    s_cbranch_scc1 L_g_g1r_117
    v_mov_b32 v10, 1
    s_mov_b64 exec, 1
    s_waitcnt vmcnt(0)
    ds_add_rtn_u32 v10, v15, v10 offset:4
    s_waitcnt lgkmcnt(0)
    v_readfirstlane_b32 s46, v10
    s_mov_b64 exec, -1
    s_mov_b32 s71, 0
    s_sub_u32 s59, s60, 1
    s_cmp_lg_u32 s46, s68
    s_cbranch_scc1 L_g_df_139
    v_mov_b32 v10, s59
    v_add_u32 v10, 1, v10
    v_mov_b32 v11, 0
    s_mov_b64 exec, 1
    buffer_store_dword v10, v11, s[12:15], s52 offen sc1
    s_mov_b64 exec, -1
L_sf_140:
L_g_df_139:
    s_add_u32 s68, s68, 4
    s_cmp_gt_u32 s66, s60
    s_cbranch_scc1 L_g_g1r_117
L_g_tail_120:
    s_cmp_lt_u32 s60, s75
    s_cbranch_scc1 L_g_restart_115
    s_waitcnt vmcnt(0)
    s_barrier
    s_branch L_c_done_1
L_g_dp_130_l:
    s_cmp_ge_u32 s62, s66
    s_cbranch_scc1 L_g_dp_130_d
    s_mov_b32 s65, 1
    s_add_u32 s47, s61, 4096
    s_mov_b32 m0, s64
    s_add_u32 s62, s62, 1
    buffer_load_dwordx4 v3, s[12:15], s61 offen offset:0 sc1 lds
    buffer_load_dwordx4 v3, s[12:15], s61 offen offset:1024 sc1 lds
    buffer_load_dwordx4 v3, s[12:15], s61 offen offset:2048 sc1 lds
    buffer_load_dwordx4 v3, s[12:15], s61 offen offset:3072 sc1 lds
    s_add_u32 m0, s64, 4096
    s_add_u32 s61, s61, 229376
    buffer_load_dwordx4 v3, s[12:15], s47 offen offset:0 sc1 lds
    buffer_load_dwordx4 v3, s[12:15], s47 offen offset:1024 sc1 lds
    buffer_load_dwordx4 v3, s[12:15], s47 offen offset:2048 sc1 lds
    s_xor_b32 s64, s64, 0x10000
    s_branch L_g_dp_130_a
L_g_nw_128:
    s_waitcnt vmcnt(0) lgkmcnt(0)
    s_cmp_lg_u32 s44, 0
    s_cbranch_scc1 L_g_nl_141
    s_add_u32 s54, s60, 1
    v_add_u32 v12, s54, v113
    v_subrev_u32 v13, 58, v12
    v_subrev_u32 v11, 61, v12
    v_ashrrev_i32 v13, 31, v13
    v_ashrrev_i32 v11, 31, v11
    v_add3_u32 v13, v13, v11, 2
    v_lshl_add_u32 v13, v13, 16, v7
    buffer_load_dword v11, v13, s[12:15], 0 offen sc1
L_g_nl_141:
    s_branch L_g_loop0_118_l
L_g_nfl_132:
    s_cmp_eq_u32 s71, 0
    s_cbranch_scc1 L_g_nfl_132_d
    v_mov_b32 v10, 1
    s_mov_b64 exec, 1
    s_waitcnt vmcnt(0)
    ds_add_rtn_u32 v10, v15, v10 offset:4
    s_waitcnt lgkmcnt(0)
    v_readfirstlane_b32 s46, v10
    s_mov_b64 exec, -1
    s_mov_b32 s71, 0
    s_sub_u32 s59, s60, 1
    s_cmp_lg_u32 s46, s68
    s_cbranch_scc1 L_g_df_142
    v_mov_b32 v10, s59
    v_add_u32 v10, 1, v10
    v_mov_b32 v11, 0
    s_mov_b64 exec, 1
    buffer_store_dword v10, v11, s[12:15], s52 offen sc1
    s_mov_b64 exec, -1
L_sf_143:
L_g_df_142:
    s_add_u32 s68, s68, 4
    s_mov_b32 s65, 2
    s_branch L_g_nfl_132_d
L_g_dp_137_l:
    s_cmp_ge_u32 s62, s66
    s_cbranch_scc1 L_g_dp_137_d
    s_or_b32 s65, s65, 1
    s_add_u32 s47, s61, 4096
    s_mov_b32 m0, s64
    s_add_u32 s62, s62, 1
    buffer_load_dwordx4 v3, s[12:15], s61 offen offset:0 sc1 lds
    buffer_load_dwordx4 v3, s[12:15], s61 offen offset:1024 sc1 lds
    buffer_load_dwordx4 v3, s[12:15], s61 offen offset:2048 sc1 lds
    buffer_load_dwordx4 v3, s[12:15], s61 offen offset:3072 sc1 lds
    s_add_u32 m0, s64, 4096
    s_add_u32 s61, s61, 229376
    buffer_load_dwordx4 v3, s[12:15], s47 offen offset:0 sc1 lds
    buffer_load_dwordx4 v3, s[12:15], s47 offen offset:1024 sc1 lds
    buffer_load_dwordx4 v3, s[12:15], s47 offen offset:2048 sc1 lds
    s_xor_b32 s64, s64, 0x10000
    s_branch L_g_dp_137_a
L_g_nw1_134:
    s_cmp_eq_u32 s65, 2
    s_cbranch_scc1 L_g_nw1_134_w
    s_waitcnt vmcnt(0)
L_g_nw1_134_w:
    s_barrier
    ds_read_b128 v[32:35], v4 offset:0
    ds_read_b128 v[36:39], v4 offset:256
    ds_read_b128 v[40:43], v4 offset:2048
    ds_read_b128 v[44:47], v4 offset:2304
    ds_read_b128 v[48:51], v4 offset:4096
    ds_read_b128 v[52:55], v4 offset:4352
    ds_read_b128 v[56:59], v4 offset:6144
    ds_read_b128 v[60:63], v4 offset:6400
    s_branch L_g_jn_136
L_w_wo_12:
    s_load_dwordx2 s[4:5], s[0:1], 40
    s_load_dwordx2 s[6:7], s[0:1], 72
    s_and_b32 s50, s44, 3
    s_lshr_b32 s51, s44, 2
    s_waitcnt lgkmcnt(0)
    s_mov_b32 s24, s4
    s_and_b32 s25, s5, 0xffff
    s_mov_b32 s26, 0x800000
    s_mov_b32 s27, 0x00020000
    v_lshrrev_b32 v3, 4, v1
    v_and_b32 v4, 15, v1
    v_lshlrev_b32 v5, 2, v3
    v_xor_b32 v4, v4, v5
    v_mul_u32_u24 v3, 2048, v3
    v_lshl_add_u32 v3, v4, 4, v3
    s_mul_i32 s46, s51, 512
    s_mul_i32 s47, s50, 64
    s_add_u32 s46, s46, s47
    s_mul_i32 s47, s42, 1024
    s_add_u32 s46, s46, s47
    s_mul_i32 s46, s46, 2048
    s_lshl_b32 s47, s43, 8
    s_add_u32 s46, s46, s47
    s_lshl_b32 s45, s51, 16
    s_mul_i32 s47, s50, 16384
    s_add_u32 s45, s45, s47
    v_bfe_u32 v4, v1, 2, 2
    v_bfe_u32 v5, v1, 4, 1
    v_lshlrev_b32 v5, 1, v5
    v_bfe_u32 v6, v1, 1, 1
    v_add_u32 v5, v5, v6
    s_lshl_b32 s47, s50, 2
    v_add_u32 v5, s47, v5
    v_lshlrev_b32 v6, 2, v4
    v_xor_b32 v5, v5, v6
    v_lshlrev_b32 v5, 4, v5
    v_lshl_add_u32 v5, v4, 8, v5
    v_bfe_u32 v6, v1, 0, 1
    v_lshl_add_u32 v5, v6, 3, v5
    v_lshrrev_b32 v6, 5, v1
    v_mul_u32_u24 v6, 1024, v6
    v_add_u32 v5, v5, v6
    s_lshl_b32 s47, s51, 16
    v_add_u32 v5, s47, v5
    v_bfe_u32 v4, v1, 2, 2
    v_xor_b32 v5, s50, v4
    v_lshlrev_b32 v5, 6, v5
    v_lshl_add_u32 v5, v4, 8, v5
    v_and_b32 v6, 3, v1
    v_lshl_add_u32 v5, v6, 3, v5
    v_lshrrev_b32 v6, 4, v1
    v_lshl_add_u32 v5, v6, 10, v5
    v_lshrrev_b32 v6, 5, v1
    s_lshl_b32 s47, s51, 16
    v_add_u32 v5, s47, v5
    s_add_u32 m0, s45, 0
    s_add_u32 s47, s46, 0x0
    buffer_load_dwordx4 v3, s[24:27], s47 offen lds
    s_add_u32 m0, s45, 1024
    s_add_u32 s47, s46, 0x2000
    buffer_load_dwordx4 v3, s[24:27], s47 offen lds
    s_add_u32 m0, s45, 2048
    s_add_u32 s47, s46, 0x4000
    buffer_load_dwordx4 v3, s[24:27], s47 offen lds
    s_add_u32 m0, s45, 3072
    s_add_u32 s47, s46, 0x6000
    buffer_load_dwordx4 v3, s[24:27], s47 offen lds
    s_add_u32 m0, s45, 4096
    s_add_u32 s47, s46, 0x8000
    buffer_load_dwordx4 v3, s[24:27], s47 offen lds
    s_add_u32 m0, s45, 5120
    s_add_u32 s47, s46, 0xa000
    buffer_load_dwordx4 v3, s[24:27], s47 offen lds
    s_add_u32 m0, s45, 6144
    s_add_u32 s47, s46, 0xc000
    buffer_load_dwordx4 v3, s[24:27], s47 offen lds
    s_add_u32 m0, s45, 7168
    s_add_u32 s47, s46, 0xe000
    buffer_load_dwordx4 v3, s[24:27], s47 offen lds
    s_add_u32 m0, s45, 8192
    s_add_u32 s47, s46, 0x10000
    buffer_load_dwordx4 v3, s[24:27], s47 offen lds
    s_add_u32 m0, s45, 9216
    s_add_u32 s47, s46, 0x12000
    buffer_load_dwordx4 v3, s[24:27], s47 offen lds
    s_add_u32 m0, s45, 10240
    s_add_u32 s47, s46, 0x14000
    buffer_load_dwordx4 v3, s[24:27], s47 offen lds
    s_add_u32 m0, s45, 11264
    s_add_u32 s47, s46, 0x16000
    buffer_load_dwordx4 v3, s[24:27], s47 offen lds
    s_add_u32 m0, s45, 12288
    s_add_u32 s47, s46, 0x18000
    buffer_load_dwordx4 v3, s[24:27], s47 offen lds
    s_add_u32 m0, s45, 13312
    s_add_u32 s47, s46, 0x1a000
    buffer_load_dwordx4 v3, s[24:27], s47 offen lds
    s_add_u32 m0, s45, 14336
    s_add_u32 s47, s46, 0x1c000
    buffer_load_dwordx4 v3, s[24:27], s47 offen lds
    s_add_u32 m0, s45, 15360
    s_add_u32 s47, s46, 0x1e000
    buffer_load_dwordx4 v3, s[24:27], s47 offen lds
    s_waitcnt vmcnt(0)
    s_barrier
    ds_read_b64_tr_b16 a[0:1], v5 offset:0
    ds_read_b64_tr_b16 a[2:3], v5 offset:4096
    ds_read_b64_tr_b16 a[4:5], v5 offset:32
    ds_read_b64_tr_b16 a[6:7], v5 offset:4128
    ds_read_b64_tr_b16 a[8:9], v5 offset:8192
    ds_read_b64_tr_b16 a[10:11], v5 offset:12288
    ds_read_b64_tr_b16 a[12:13], v5 offset:8224
    ds_read_b64_tr_b16 a[14:15], v5 offset:12320
    s_waitcnt lgkmcnt(0)
    ds_read_b64_tr_b16 a[16:17], v5 offset:16384
    ds_read_b64_tr_b16 a[18:19], v5 offset:20480
    ds_read_b64_tr_b16 a[20:21], v5 offset:16416
    ds_read_b64_tr_b16 a[22:23], v5 offset:20512
    ds_read_b64_tr_b16 a[24:25], v5 offset:24576
    ds_read_b64_tr_b16 a[26:27], v5 offset:28672
    ds_read_b64_tr_b16 a[28:29], v5 offset:24608
    ds_read_b64_tr_b16 a[30:31], v5 offset:28704
    s_waitcnt lgkmcnt(0)
    ds_read_b64_tr_b16 a[32:33], v5 offset:32768
    ds_read_b64_tr_b16 a[34:35], v5 offset:36864
    ds_read_b64_tr_b16 a[36:37], v5 offset:32800
    ds_read_b64_tr_b16 a[38:39], v5 offset:36896
    ds_read_b64_tr_b16 a[40:41], v5 offset:40960
    ds_read_b64_tr_b16 a[42:43], v5 offset:45056
    ds_read_b64_tr_b16 a[44:45], v5 offset:40992
    ds_read_b64_tr_b16 a[46:47], v5 offset:45088
    s_waitcnt lgkmcnt(0)
    ds_read_b64_tr_b16 a[48:49], v5 offset:49152
    ds_read_b64_tr_b16 a[50:51], v5 offset:53248
    ds_read_b64_tr_b16 a[52:53], v5 offset:49184
    ds_read_b64_tr_b16 a[54:55], v5 offset:53280
    ds_read_b64_tr_b16 a[56:57], v5 offset:57344
    ds_read_b64_tr_b16 a[58:59], v5 offset:61440
    ds_read_b64_tr_b16 a[60:61], v5 offset:57376
    ds_read_b64_tr_b16 a[62:63], v5 offset:61472
    s_waitcnt lgkmcnt(0)
    s_waitcnt lgkmcnt(0)
    s_barrier
    s_add_u32 m0, s45, 0
    s_add_u32 s47, s46, 0x80000
    buffer_load_dwordx4 v3, s[24:27], s47 offen lds
    s_add_u32 m0, s45, 1024
    s_add_u32 s47, s46, 0x82000
    buffer_load_dwordx4 v3, s[24:27], s47 offen lds
    s_add_u32 m0, s45, 2048
    s_add_u32 s47, s46, 0x84000
    buffer_load_dwordx4 v3, s[24:27], s47 offen lds
    s_add_u32 m0, s45, 3072
    s_add_u32 s47, s46, 0x86000
    buffer_load_dwordx4 v3, s[24:27], s47 offen lds
    s_add_u32 m0, s45, 4096
    s_add_u32 s47, s46, 0x88000
    buffer_load_dwordx4 v3, s[24:27], s47 offen lds
    s_add_u32 m0, s45, 5120
    s_add_u32 s47, s46, 0x8a000
    buffer_load_dwordx4 v3, s[24:27], s47 offen lds
    s_add_u32 m0, s45, 6144
    s_add_u32 s47, s46, 0x8c000
    buffer_load_dwordx4 v3, s[24:27], s47 offen lds
    s_add_u32 m0, s45, 7168
    s_add_u32 s47, s46, 0x8e000
    buffer_load_dwordx4 v3, s[24:27], s47 offen lds
    s_add_u32 m0, s45, 8192
    s_add_u32 s47, s46, 0x90000
    buffer_load_dwordx4 v3, s[24:27], s47 offen lds
    s_add_u32 m0, s45, 9216
    s_add_u32 s47, s46, 0x92000
    buffer_load_dwordx4 v3, s[24:27], s47 offen lds
    s_add_u32 m0, s45, 10240
    s_add_u32 s47, s46, 0x94000
    buffer_load_dwordx4 v3, s[24:27], s47 offen lds
    s_add_u32 m0, s45, 11264
    s_add_u32 s47, s46, 0x96000
    buffer_load_dwordx4 v3, s[24:27], s47 offen lds
    s_add_u32 m0, s45, 12288
    s_add_u32 s47, s46, 0x98000
    buffer_load_dwordx4 v3, s[24:27], s47 offen lds
    s_add_u32 m0, s45, 13312
    s_add_u32 s47, s46, 0x9a000
    buffer_load_dwordx4 v3, s[24:27], s47 offen lds
    s_add_u32 m0, s45, 14336
    s_add_u32 s47, s46, 0x9c000
    buffer_load_dwordx4 v3, s[24:27], s47 offen lds
    s_add_u32 m0, s45, 15360
    s_add_u32 s47, s46, 0x9e000
    buffer_load_dwordx4 v3, s[24:27], s47 offen lds
    s_waitcnt vmcnt(0)
    s_barrier
    ds_read_b64_tr_b16 a[64:65], v5 offset:0
    ds_read_b64_tr_b16 a[66:67], v5 offset:4096
    ds_read_b64_tr_b16 a[68:69], v5 offset:32
    ds_read_b64_tr_b16 a[70:71], v5 offset:4128
    ds_read_b64_tr_b16 a[72:73], v5 offset:8192
    ds_read_b64_tr_b16 a[74:75], v5 offset:12288
    ds_read_b64_tr_b16 a[76:77], v5 offset:8224
    ds_read_b64_tr_b16 a[78:79], v5 offset:12320
    s_waitcnt lgkmcnt(0)
    ds_read_b64_tr_b16 a[80:81], v5 offset:16384
    ds_read_b64_tr_b16 a[82:83], v5 offset:20480
    ds_read_b64_tr_b16 a[84:85], v5 offset:16416
    ds_read_b64_tr_b16 a[86:87], v5 offset:20512
    ds_read_b64_tr_b16 a[88:89], v5 offset:24576
    ds_read_b64_tr_b16 a[90:91], v5 offset:28672
    ds_read_b64_tr_b16 a[92:93], v5 offset:24608
    ds_read_b64_tr_b16 a[94:95], v5 offset:28704
    s_waitcnt lgkmcnt(0)
    ds_read_b64_tr_b16 a[96:97], v5 offset:32768
    ds_read_b64_tr_b16 a[98:99], v5 offset:36864
    ds_read_b64_tr_b16 a[100:101], v5 offset:32800
    ds_read_b64_tr_b16 a[102:103], v5 offset:36896
    ds_read_b64_tr_b16 a[104:105], v5 offset:40960
    ds_read_b64_tr_b16 a[106:107], v5 offset:45056
    ds_read_b64_tr_b16 a[108:109], v5 offset:40992
    ds_read_b64_tr_b16 a[110:111], v5 offset:45088
    s_waitcnt lgkmcnt(0)
    ds_read_b64_tr_b16 a[112:113], v5 offset:49152
    ds_read_b64_tr_b16 a[114:115], v5 offset:53248
    ds_read_b64_tr_b16 a[116:117], v5 offset:49184
    ds_read_b64_tr_b16 a[118:119], v5 offset:53280
    ds_read_b64_tr_b16 a[120:121], v5 offset:57344
    ds_read_b64_tr_b16 a[122:123], v5 offset:61440
    ds_read_b64_tr_b16 a[124:125], v5 offset:57376
    ds_read_b64_tr_b16 a[126:127], v5 offset:61472
    s_waitcnt lgkmcnt(0)
    s_waitcnt lgkmcnt(0)
    s_barrier
    v_lshlrev_b32 v2, 4, v1
    s_mul_i32 s64, s44, 8192
    s_add_u32 s46, s64, 0x5000000
    s_mul_i32 s47, s42, 65536
    s_add_u32 s46, s46, s47
    v_add_u32 v3, s46, v2
    s_mul_i32 s46, s51, 32768
    v_add_u32 v4, s46, v2
    v_and_b32 v6, 15, v1
    v_lshlrev_b32 v6, 4, v6
    v_lshrrev_b32 v7, 4, v1
    v_lshl_add_u32 v6, v7, 9, v6
    v_add_u32 v4, s46, v6
    s_lshl_b32 s46, s50, 12
    s_add_u32 s46, s46, 131072
    v_add_u32 v5, s46, v2
    v_and_b32 v7, 7, v1
    v_lshlrev_b32 v7, 9, v7
    s_lshl_b32 s46, s42, 12
    s_add_u32 s46, s46, 0x102000
    v_add_u32 v7, s46, v7
    s_lshl_b32 s46, s42, 16
    s_lshl_b32 s47, s43, 11
    s_add_u32 s46, s46, s47
    s_lshl_b32 s47, s50, 9
    s_add_u32 s46, s46, s47
    s_add_u32 s46, s46, 0x9000000
    v_and_b32 v8, 31, v1
    v_lshlrev_b32 v8, 4, v8
    v_lshrrev_b32 v9, 5, v1
    v_lshl_add_u32 v8, v9, 14, v8
    v_add_u32 v8, s46, v8
    v_add_u32 v9, 0x8000, v8
    s_lshl_b32 s52, s43, 9
    s_lshl_b32 s47, s42, 7
    s_add_u32 s52, s52, s47
    s_add_u32 s52, s52, 0x107400
    s_add_u32 s52, s52, s76
    s_mul_i32 s46, s43, 8192
    s_add_u32 s46, s46, 0x5000000
    s_mul_i32 s47, s42, 65536
    s_add_u32 s46, s46, s47
    v_min_u32 v116, 63, v1
    v_lshlrev_b32 v116, 7, v116
    v_add_u32 v116, s46, v116
    s_mov_b32 s60, s74
    s_mul_i32 s61, s74, 262144
    s_mov_b32 s62, s74
    s_mul_i32 s63, s74, 262144
    s_mov_b32 s67, 0
    s_mov_b32 s68, 3
    s_mov_b32 s71, 0
    v_mov_b32 v15, 147456
    v_mov_b32 v14, 0
    ds_write_b32 v15, v14 offset:4
    ds_write_b32 v15, v14 offset:12
    ds_write_b32 v15, v14 offset:16
    v_mov_b32 v114, 1
    v_mov_b32 v115, 0
    v_lshrrev_b32 v113, 4, v1
    s_mov_b32 s72, 0
L_g_restart_144:
    s_cmp_lg_u32 s44, 0
    s_cbranch_scc1 L_g_nsp_145
    s_mov_b32 s70, 0
L_g_sp_151:
    s_add_u32 s54, s60, 0
    v_add_u32 v12, s54, v113
    v_and_b32 v13, 3, v12
    v_lshl_add_u32 v13, v13, 7, v7
    buffer_load_dword v11, v13, s[12:15], 0 offen sc1
    s_waitcnt vmcnt(0)
    v_cmp_ge_u32 vcc, v12, v11
    s_add_u32 s70, s70, 1
    s_and_b32 s46, vcc_lo, 0xffff
    s_cbranch_scc0 L_g_sp_151_ok
    s_sleep 3
    s_cmp_lt_u32 s70, 524288
    s_cbranch_scc1 L_g_sp_151
    s_branch L_c_done_1
L_g_sp_151_ok:
    v_cmp_ge_u32 vcc, v12, v11
    s_nop 0
    s_ff1_i32_b64 s46, vcc
    s_lshr_b32 s46, s46, 4
    s_min_u32 s46, s46, 4
    s_add_u32 s46, s46, s54
    s_min_u32 s46, s46, s75
    v_mov_b32 v11, s46
    ds_write_b32 v15, v11
L_g_nsp_145:
    s_waitcnt lgkmcnt(0)
    s_barrier
    ds_read_b32 v14, v15
    s_waitcnt lgkmcnt(0)
    v_readfirstlane_b32 s66, v14
    s_nop 3
L_g_restart_144_go:
    s_mov_b32 s69, 0
    s_cmp_gt_u32 s62, s60
    s_cbranch_scc1 L_g_nd_152
    s_cmp_ge_u32 s62, s66
    s_cbranch_scc1 L_g_nd_152
    s_add_u32 s47, s61, 4096
    s_add_u32 m0, s64, 0
    s_nop 0
    buffer_load_dwordx4 v3, s[12:15], s61 offen offset:0 sc1 lds
    buffer_load_dwordx4 v3, s[12:15], s61 offen offset:1024 sc1 lds
    buffer_load_dwordx4 v3, s[12:15], s61 offen offset:2048 sc1 lds
    buffer_load_dwordx4 v3, s[12:15], s61 offen offset:3072 sc1 lds
    s_add_u32 m0, s64, 4096
    s_nop 0
    buffer_load_dwordx4 v3, s[12:15], s47 offen offset:0 sc1 lds
    buffer_load_dwordx4 v3, s[12:15], s47 offen offset:1024 sc1 lds
    buffer_load_dwordx4 v3, s[12:15], s47 offen offset:2048 sc1 lds
    buffer_load_dwordx4 v3, s[12:15], s47 offen offset:3072 sc1 lds
    s_add_u32 s61, s61, 262144
    s_add_u32 s62, s62, 1
    s_xor_b32 s64, s64, 0x10000
    s_mov_b32 s69, 1
L_g_nd_152:
    s_cmp_eq_u32 s51, 1
    s_cbranch_scc1 L_g_g1r_146
    s_add_u32 s59, s60, 1
    s_mov_b32 s69, 0
    s_cmp_gt_u32 s62, s59
    s_cbranch_scc1 L_g_nd_153
    s_cmp_ge_u32 s62, s66
    s_cbranch_scc1 L_g_nd_153
    s_add_u32 s47, s61, 4096
    s_add_u32 m0, s64, 0
    s_nop 0
    buffer_load_dwordx4 v3, s[12:15], s61 offen offset:0 sc1 lds
    buffer_load_dwordx4 v3, s[12:15], s61 offen offset:1024 sc1 lds
    buffer_load_dwordx4 v3, s[12:15], s61 offen offset:2048 sc1 lds
    buffer_load_dwordx4 v3, s[12:15], s61 offen offset:3072 sc1 lds
    s_add_u32 m0, s64, 4096
    s_nop 0
    buffer_load_dwordx4 v3, s[12:15], s47 offen offset:0 sc1 lds
    buffer_load_dwordx4 v3, s[12:15], s47 offen offset:1024 sc1 lds
    buffer_load_dwordx4 v3, s[12:15], s47 offen offset:2048 sc1 lds
    buffer_load_dwordx4 v3, s[12:15], s47 offen offset:3072 sc1 lds
    s_add_u32 s61, s61, 262144
    s_add_u32 s62, s62, 1
    s_xor_b32 s64, s64, 0x10000
    s_mov_b32 s69, 1
L_g_nd_153:
    s_cmp_eq_u32 s69, 1
    s_cbranch_scc1 L_g_w0_154
    s_waitcnt vmcnt(0)
L_g_w0_154:
    s_waitcnt vmcnt(8)
    s_cmp_lg_u32 s44, 0
    s_cbranch_scc1 L_g_nl_155
    s_add_u32 s54, s60, 1
    v_add_u32 v12, s54, v113
    v_and_b32 v13, 3, v12
    v_lshl_add_u32 v13, v13, 7, v7
    buffer_load_dword v11, v13, s[12:15], 0 offen sc1
L_g_nl_155:
L_g_loop0_147_l:
    s_barrier
    ds_read_b128 v[32:35], v4 offset:0
    ds_read_b128 v[36:39], v4 offset:256
    ds_read_b128 v[40:43], v4 offset:2048
    ds_read_b128 v[44:47], v4 offset:2304
    ds_read_b128 v[48:51], v4 offset:4096
    ds_read_b128 v[52:55], v4 offset:4352
    ds_read_b128 v[56:59], v4 offset:6144
    ds_read_b128 v[60:63], v4 offset:6400
    s_branch L_g_loop0_147_m
.p2align 6
L_g_loop0_147:
    s_barrier
L_g_loop0_147_m:
    s_setprio 2
    s_waitcnt lgkmcnt(6)
    v_mfma_f32_16x16x32_bf16 v[16:19], v[32:35], a[0:3], 0
    ds_read_b32 v14, v15
    v_mfma_f32_16x16x32_bf16 v[20:23], v[32:35], a[4:7], 0
    ds_read_b128 v[32:35], v4 offset:8192
    v_mfma_f32_16x16x32_bf16 v[28:31], v[36:39], a[4:7], 0
    v_mfma_f32_16x16x32_bf16 v[24:27], v[36:39], a[0:3], 0
    ds_read_b128 v[36:39], v4 offset:8448
    s_waitcnt lgkmcnt(6)
    v_mfma_f32_16x16x32_bf16 v[16:19], v[40:43], a[8:11], v[16:19]
    v_mfma_f32_16x16x32_bf16 v[20:23], v[40:43], a[12:15], v[20:23]
    ds_read_b128 v[40:43], v4 offset:10240
    v_mfma_f32_16x16x32_bf16 v[28:31], v[44:47], a[12:15], v[28:31]
    v_mfma_f32_16x16x32_bf16 v[24:27], v[44:47], a[8:11], v[24:27]
    ds_read_b128 v[44:47], v4 offset:10496
    s_waitcnt lgkmcnt(6)
    v_mfma_f32_16x16x32_bf16 v[16:19], v[48:51], a[16:19], v[16:19]
    v_mfma_f32_16x16x32_bf16 v[20:23], v[48:51], a[20:23], v[20:23]
    ds_read_b128 v[48:51], v4 offset:12288
    v_mfma_f32_16x16x32_bf16 v[28:31], v[52:55], a[20:23], v[28:31]
    v_mfma_f32_16x16x32_bf16 v[24:27], v[52:55], a[16:19], v[24:27]
    ds_read_b128 v[52:55], v4 offset:12544
    s_waitcnt lgkmcnt(6)
    v_mfma_f32_16x16x32_bf16 v[16:19], v[56:59], a[24:27], v[16:19]
    v_mfma_f32_16x16x32_bf16 v[20:23], v[56:59], a[28:31], v[20:23]
    ds_read_b128 v[56:59], v4 offset:14336
    v_mfma_f32_16x16x32_bf16 v[28:31], v[60:63], a[28:31], v[28:31]
    v_mfma_f32_16x16x32_bf16 v[24:27], v[60:63], a[24:27], v[24:27]
    ds_read_b128 v[60:63], v4 offset:14592
    s_waitcnt lgkmcnt(6)
    v_mfma_f32_16x16x32_bf16 v[16:19], v[32:35], a[32:35], v[16:19]
    v_mfma_f32_16x16x32_bf16 v[20:23], v[32:35], a[36:39], v[20:23]
    ds_read_b128 v[32:35], v4 offset:16384
    v_mfma_f32_16x16x32_bf16 v[28:31], v[36:39], a[36:39], v[28:31]
    v_mfma_f32_16x16x32_bf16 v[24:27], v[36:39], a[32:35], v[24:27]
    ds_read_b128 v[36:39], v4 offset:16640
    s_waitcnt lgkmcnt(6)
    v_mfma_f32_16x16x32_bf16 v[16:19], v[40:43], a[40:43], v[16:19]
    v_mfma_f32_16x16x32_bf16 v[20:23], v[40:43], a[44:47], v[20:23]
    ds_read_b128 v[40:43], v4 offset:18432
    v_mfma_f32_16x16x32_bf16 v[28:31], v[44:47], a[44:47], v[28:31]
    v_mfma_f32_16x16x32_bf16 v[24:27], v[44:47], a[40:43], v[24:27]
    ds_read_b128 v[44:47], v4 offset:18688
    s_waitcnt lgkmcnt(6)
    v_mfma_f32_16x16x32_bf16 v[16:19], v[48:51], a[48:51], v[16:19]
    v_mfma_f32_16x16x32_bf16 v[20:23], v[48:51], a[52:55], v[20:23]
    ds_read_b128 v[48:51], v4 offset:20480
    v_mfma_f32_16x16x32_bf16 v[28:31], v[52:55], a[52:55], v[28:31]
    v_mfma_f32_16x16x32_bf16 v[24:27], v[52:55], a[48:51], v[24:27]
    ds_read_b128 v[52:55], v4 offset:20736
    s_waitcnt lgkmcnt(6)
    v_mfma_f32_16x16x32_bf16 v[16:19], v[56:59], a[56:59], v[16:19]
    v_mfma_f32_16x16x32_bf16 v[20:23], v[56:59], a[60:63], v[20:23]
    ds_read_b128 v[56:59], v4 offset:22528
    v_mfma_f32_16x16x32_bf16 v[28:31], v[60:63], a[60:63], v[28:31]
    v_mfma_f32_16x16x32_bf16 v[24:27], v[60:63], a[56:59], v[24:27]
    ds_read_b128 v[60:63], v4 offset:22784
    s_waitcnt lgkmcnt(6)
    v_mfma_f32_16x16x32_bf16 v[16:19], v[32:35], a[64:67], v[16:19]
    v_mfma_f32_16x16x32_bf16 v[20:23], v[32:35], a[68:71], v[20:23]
    ds_read_b128 v[32:35], v4 offset:24576
    v_mfma_f32_16x16x32_bf16 v[28:31], v[36:39], a[68:71], v[28:31]
    v_mfma_f32_16x16x32_bf16 v[24:27], v[36:39], a[64:67], v[24:27]
    ds_read_b128 v[36:39], v4 offset:24832
    s_waitcnt lgkmcnt(6)
    v_mfma_f32_16x16x32_bf16 v[16:19], v[40:43], a[72:75], v[16:19]
    v_mfma_f32_16x16x32_bf16 v[20:23], v[40:43], a[76:79], v[20:23]
    ds_read_b128 v[40:43], v4 offset:26624
    v_mfma_f32_16x16x32_bf16 v[28:31], v[44:47], a[76:79], v[28:31]
    v_mfma_f32_16x16x32_bf16 v[24:27], v[44:47], a[72:75], v[24:27]
    ds_read_b128 v[44:47], v4 offset:26880
    s_waitcnt lgkmcnt(6)
    v_mfma_f32_16x16x32_bf16 v[16:19], v[48:51], a[80:83], v[16:19]
    v_mfma_f32_16x16x32_bf16 v[20:23], v[48:51], a[84:87], v[20:23]
    ds_read_b128 v[48:51], v4 offset:28672
    v_mfma_f32_16x16x32_bf16 v[28:31], v[52:55], a[84:87], v[28:31]
    v_mfma_f32_16x16x32_bf16 v[24:27], v[52:55], a[80:83], v[24:27]
    ds_read_b128 v[52:55], v4 offset:28928
    s_waitcnt lgkmcnt(6)
    v_mfma_f32_16x16x32_bf16 v[16:19], v[56:59], a[88:91], v[16:19]
    v_mfma_f32_16x16x32_bf16 v[20:23], v[56:59], a[92:95], v[20:23]
    ds_read_b128 v[56:59], v4 offset:30720
    v_mfma_f32_16x16x32_bf16 v[28:31], v[60:63], a[92:95], v[28:31]
    v_mfma_f32_16x16x32_bf16 v[24:27], v[60:63], a[88:91], v[24:27]
    ds_read_b128 v[60:63], v4 offset:30976
    s_waitcnt lgkmcnt(6)
    v_mfma_f32_16x16x32_bf16 v[16:19], v[32:35], a[96:99], v[16:19]
    v_mfma_f32_16x16x32_bf16 v[20:23], v[32:35], a[100:103], v[20:23]
    v_mfma_f32_16x16x32_bf16 v[28:31], v[36:39], a[100:103], v[28:31]
    v_mfma_f32_16x16x32_bf16 v[24:27], v[36:39], a[96:99], v[24:27]
    s_waitcnt lgkmcnt(4)
    v_mfma_f32_16x16x32_bf16 v[16:19], v[40:43], a[104:107], v[16:19]
    v_mfma_f32_16x16x32_bf16 v[20:23], v[40:43], a[108:111], v[20:23]
    v_mfma_f32_16x16x32_bf16 v[28:31], v[44:47], a[108:111], v[28:31]
    v_mfma_f32_16x16x32_bf16 v[24:27], v[44:47], a[104:107], v[24:27]
    s_waitcnt lgkmcnt(2)
    v_mfma_f32_16x16x32_bf16 v[16:19], v[48:51], a[112:115], v[16:19]
    v_mfma_f32_16x16x32_bf16 v[20:23], v[48:51], a[116:119], v[20:23]
    v_mfma_f32_16x16x32_bf16 v[28:31], v[52:55], a[116:119], v[28:31]
    v_mfma_f32_16x16x32_bf16 v[24:27], v[52:55], a[112:115], v[24:27]
    s_waitcnt lgkmcnt(0)
    v_mfma_f32_16x16x32_bf16 v[16:19], v[56:59], a[120:123], v[16:19]
    v_mfma_f32_16x16x32_bf16 v[20:23], v[56:59], a[124:127], v[20:23]
    v_mfma_f32_16x16x32_bf16 v[28:31], v[60:63], a[124:127], v[28:31]
    v_mfma_f32_16x16x32_bf16 v[24:27], v[60:63], a[120:123], v[24:27]
    v_xor_b32 v4, 0x10000, v4
    s_setprio 0
    s_waitcnt vmcnt(0)
    v_readfirstlane_b32 s66, v14
    s_barrier
    s_nop 6
    ds_write_b128 v5, v[16:19] offset:0
    ds_write_b128 v5, v[20:23] offset:1024
    ds_write_b128 v5, v[24:27] offset:2048
    ds_write_b128 v5, v[28:31] offset:3072
    s_cmp_lg_u32 s44, 0
    s_cbranch_scc1 L_g_ne_156
    v_cmp_ge_u32 vcc, v12, v11
    s_nop 0
    s_ff1_i32_b64 s46, vcc
    s_lshr_b32 s46, s46, 4
    s_min_u32 s46, s46, 4
    s_add_u32 s46, s46, s54
    s_min_u32 s46, s46, s75
    v_mov_b32 v11, s46
    ds_write_b32 v15, v11
L_g_ne_156:
    s_add_u32 s60, s60, 1
    s_mov_b32 s65, 0
    s_cmp_le_u32 s62, s60
    s_cbranch_scc1 L_g_dp_159_l
L_g_dp_159_a:
    s_cmp_ge_u32 s62, s66
    s_cbranch_scc1 L_g_dp_159_d
    s_add_u32 s47, s61, 4096
    s_mov_b32 m0, s64
    s_add_u32 s62, s62, 1
    buffer_load_dwordx4 v3, s[12:15], s61 offen offset:0 sc1 lds
    buffer_load_dwordx4 v3, s[12:15], s61 offen offset:1024 sc1 lds
    buffer_load_dwordx4 v3, s[12:15], s61 offen offset:2048 sc1 lds
    buffer_load_dwordx4 v3, s[12:15], s61 offen offset:3072 sc1 lds
    s_add_u32 m0, s64, 4096
    s_add_u32 s61, s61, 262144
    buffer_load_dwordx4 v3, s[12:15], s47 offen offset:0 sc1 lds
    buffer_load_dwordx4 v3, s[12:15], s47 offen offset:1024 sc1 lds
    buffer_load_dwordx4 v3, s[12:15], s47 offen offset:2048 sc1 lds
    buffer_load_dwordx4 v3, s[12:15], s47 offen offset:3072 sc1 lds
    s_xor_b32 s64, s64, 0x10000
L_g_dp_159_d:
    s_cmp_le_u32 s66, s60
    s_cbranch_scc1 L_g_ex0_158
    s_cmp_lg_u32 s65, 0
    s_cbranch_scc1 L_g_nw_157
    ds_read_b128 v[32:35], v4 offset:0
    ds_read_b128 v[36:39], v4 offset:256
    ds_read_b128 v[40:43], v4 offset:2048
    ds_read_b128 v[44:47], v4 offset:2304
    ds_read_b128 v[48:51], v4 offset:4096
    ds_read_b128 v[52:55], v4 offset:4352
    ds_read_b128 v[56:59], v4 offset:6144
    ds_read_b128 v[60:63], v4 offset:6400
    s_cmp_lg_u32 s44, 0
    s_cbranch_scc1 L_g_nl_160
    s_add_u32 s54, s60, 1
    v_add_u32 v12, s54, v113
    v_and_b32 v13, 3, v12
    v_lshl_add_u32 v13, v13, 7, v7
    buffer_load_dword v11, v13, s[12:15], 0 offen sc1
L_g_nl_160:
    s_waitcnt lgkmcnt(8)
    s_branch L_g_loop0_147
L_g_ex0_158:
    s_cmp_lg_u32 s44, 0
    s_cbranch_scc1 L_g_ex0_158_n
    s_sleep 6
    s_add_u32 s54, s60, 0
    v_add_u32 v12, s54, v113
    v_and_b32 v13, 3, v12
    v_lshl_add_u32 v13, v13, 7, v7
    buffer_load_dword v11, v13, s[12:15], 0 offen sc1
    s_waitcnt vmcnt(0)
    v_cmp_ge_u32 vcc, v12, v11
    s_nop 0
    s_ff1_i32_b64 s46, vcc
    s_lshr_b32 s46, s46, 4
    s_min_u32 s46, s46, 4
    s_add_u32 s46, s46, s54
    s_min_u32 s46, s46, s75
    v_mov_b32 v11, s46
    ds_write_b32 v15, v11
L_g_ex0_158_n:
    s_waitcnt lgkmcnt(0)
    s_barrier
    ds_read_b32 v14, v15
    s_waitcnt lgkmcnt(0)
    v_readfirstlane_b32 s66, v14
    s_barrier
    s_cmp_gt_u32 s66, s60
    s_cbranch_scc1 L_g_restart_144_go
    s_branch L_g_tail_149
L_g_g1r_146:
    s_mov_b32 s65, 1
    s_branch L_g_loop1_148_e
.p2align 6
L_g_loop1_148:
    s_mov_b32 s65, 0
L_g_loop1_148_e:
    s_barrier
    ds_read_b32 v14, v15
    s_bitcmp1_b32 s67, 1
    s_cbranch_scc0 L_g_nfl_161
    s_cmp_lg_u32 s44, 4
    s_cbranch_scc1 L_g_nfl_161_d
    s_sub_u32 s59, s60, 1
    v_mov_b32 v10, s59
    buffer_store_dword v10, v115, s[12:15], s52 offen sc1
L_g_nfl_161_d:
    s_waitcnt lgkmcnt(0)
    v_readfirstlane_b32 s66, v14
    ds_read_b128 v[80:83], v5 offset:0
    ds_read_b128 v[84:87], v5 offset:1024
    ds_read_b128 v[88:91], v5 offset:2048
    ds_read_b128 v[92:95], v5 offset:3072
    s_cmp_le_u32 s62, s60
    s_cbranch_scc1 L_g_dp_166_l
L_g_dp_166_a:
    s_cmp_ge_u32 s62, s66
    s_cbranch_scc1 L_g_dp_166_d
    s_add_u32 s47, s61, 4096
    s_mov_b32 m0, s64
    s_add_u32 s62, s62, 1
    buffer_load_dwordx4 v3, s[12:15], s61 offen offset:0 sc1 lds
    buffer_load_dwordx4 v3, s[12:15], s61 offen offset:1024 sc1 lds
    buffer_load_dwordx4 v3, s[12:15], s61 offen offset:2048 sc1 lds
    buffer_load_dwordx4 v3, s[12:15], s61 offen offset:3072 sc1 lds
    s_add_u32 m0, s64, 4096
    s_add_u32 s61, s61, 262144
    buffer_load_dwordx4 v3, s[12:15], s47 offen offset:0 sc1 lds
    buffer_load_dwordx4 v3, s[12:15], s47 offen offset:1024 sc1 lds
    buffer_load_dwordx4 v3, s[12:15], s47 offen offset:2048 sc1 lds
    buffer_load_dwordx4 v3, s[12:15], s47 offen offset:3072 sc1 lds
    s_xor_b32 s64, s64, 0x10000
L_g_dp_166_d:
    s_bitcmp1_b32 s67, 0
    s_cbranch_scc0 L_g_nep_162
    s_waitcnt lgkmcnt(0)
    v_add_f32 v80, v80, v16
    v_add_f32 v81, v81, v17
    v_add_f32 v82, v82, v18
    v_add_f32 v83, v83, v19
    v_add_f32 v84, v84, v20
    v_add_f32 v85, v85, v21
    v_add_f32 v86, v86, v22
    v_add_f32 v87, v87, v23
    v_add_f32 v88, v88, v24
    v_add_f32 v89, v89, v25
    v_add_f32 v90, v90, v26
    v_add_f32 v91, v91, v27
    v_add_f32 v92, v92, v28
    v_add_f32 v93, v93, v29
    v_add_f32 v94, v94, v30
    v_add_f32 v95, v95, v31
    v_cvt_pk_bf16_f32 v104, v80, v81
    v_cvt_pk_bf16_f32 v105, v82, v83
    v_cvt_pk_bf16_f32 v106, v84, v85
    v_cvt_pk_bf16_f32 v107, v86, v87
    s_nop 1
    v_permlane16_swap_b32 v104, v106
    v_permlane16_swap_b32 v105, v107
    buffer_store_dwordx4 v[104:107], v8, s[12:15], s63 offen sc1
    v_cvt_pk_bf16_f32 v108, v88, v89
    v_cvt_pk_bf16_f32 v109, v90, v91
    v_cvt_pk_bf16_f32 v110, v92, v93
    v_cvt_pk_bf16_f32 v111, v94, v95
    s_nop 1
    v_permlane16_swap_b32 v108, v110
    v_permlane16_swap_b32 v109, v111
    buffer_store_dwordx4 v[108:111], v9, s[12:15], s63 offen sc1
    s_add_u32 s63, s63, 262144
L_g_nep_162:
    s_cmp_lg_u32 s65, 0
    s_cbranch_scc1 L_g_nw1_163
    ds_read_b128 v[32:35], v4 offset:0
    ds_read_b128 v[36:39], v4 offset:256
    ds_read_b128 v[40:43], v4 offset:2048
    ds_read_b128 v[44:47], v4 offset:2304
    ds_read_b128 v[48:51], v4 offset:4096
    ds_read_b128 v[52:55], v4 offset:4352
    ds_read_b128 v[56:59], v4 offset:6144
    ds_read_b128 v[60:63], v4 offset:6400
    s_barrier
L_g_jn_165:
    s_setprio 1
    s_waitcnt lgkmcnt(6)
    v_mfma_f32_16x16x32_bf16 v[16:19], v[32:35], a[0:3], 0
    v_mfma_f32_16x16x32_bf16 v[20:23], v[32:35], a[4:7], 0
    ds_read_b128 v[32:35], v4 offset:8192
    v_mfma_f32_16x16x32_bf16 v[28:31], v[36:39], a[4:7], 0
    v_mfma_f32_16x16x32_bf16 v[24:27], v[36:39], a[0:3], 0
    ds_read_b128 v[36:39], v4 offset:8448
    s_waitcnt lgkmcnt(6)
    v_mfma_f32_16x16x32_bf16 v[16:19], v[40:43], a[8:11], v[16:19]
    v_mfma_f32_16x16x32_bf16 v[20:23], v[40:43], a[12:15], v[20:23]
    ds_read_b128 v[40:43], v4 offset:10240
    v_mfma_f32_16x16x32_bf16 v[28:31], v[44:47], a[12:15], v[28:31]
    v_mfma_f32_16x16x32_bf16 v[24:27], v[44:47], a[8:11], v[24:27]
    ds_read_b128 v[44:47], v4 offset:10496
    s_waitcnt lgkmcnt(6)
    v_mfma_f32_16x16x32_bf16 v[16:19], v[48:51], a[16:19], v[16:19]
    v_mfma_f32_16x16x32_bf16 v[20:23], v[48:51], a[20:23], v[20:23]
    ds_read_b128 v[48:51], v4 offset:12288
    v_mfma_f32_16x16x32_bf16 v[28:31], v[52:55], a[20:23], v[28:31]
    v_mfma_f32_16x16x32_bf16 v[24:27], v[52:55], a[16:19], v[24:27]
    ds_read_b128 v[52:55], v4 offset:12544
    s_waitcnt lgkmcnt(6)
    v_mfma_f32_16x16x32_bf16 v[16:19], v[56:59], a[24:27], v[16:19]
    v_mfma_f32_16x16x32_bf16 v[20:23], v[56:59], a[28:31], v[20:23]
    ds_read_b128 v[56:59], v4 offset:14336
    v_mfma_f32_16x16x32_bf16 v[28:31], v[60:63], a[28:31], v[28:31]
    v_mfma_f32_16x16x32_bf16 v[24:27], v[60:63], a[24:27], v[24:27]
    ds_read_b128 v[60:63], v4 offset:14592
    s_waitcnt lgkmcnt(6)
    v_mfma_f32_16x16x32_bf16 v[16:19], v[32:35], a[32:35], v[16:19]
    v_mfma_f32_16x16x32_bf16 v[20:23], v[32:35], a[36:39], v[20:23]
    ds_read_b128 v[32:35], v4 offset:16384
    v_mfma_f32_16x16x32_bf16 v[28:31], v[36:39], a[36:39], v[28:31]
    v_mfma_f32_16x16x32_bf16 v[24:27], v[36:39], a[32:35], v[24:27]
    ds_read_b128 v[36:39], v4 offset:16640
    s_waitcnt lgkmcnt(6)
    v_mfma_f32_16x16x32_bf16 v[16:19], v[40:43], a[40:43], v[16:19]
    v_mfma_f32_16x16x32_bf16 v[20:23], v[40:43], a[44:47], v[20:23]
    ds_read_b128 v[40:43], v4 offset:18432
    v_mfma_f32_16x16x32_bf16 v[28:31], v[44:47], a[44:47], v[28:31]
    v_mfma_f32_16x16x32_bf16 v[24:27], v[44:47], a[40:43], v[24:27]
    ds_read_b128 v[44:47], v4 offset:18688
    s_waitcnt lgkmcnt(6)
    v_mfma_f32_16x16x32_bf16 v[16:19], v[48:51], a[48:51], v[16:19]
    v_mfma_f32_16x16x32_bf16 v[20:23], v[48:51], a[52:55], v[20:23]
    ds_read_b128 v[48:51], v4 offset:20480
    v_mfma_f32_16x16x32_bf16 v[28:31], v[52:55], a[52:55], v[28:31]
    v_mfma_f32_16x16x32_bf16 v[24:27], v[52:55], a[48:51], v[24:27]
    ds_read_b128 v[52:55], v4 offset:20736
    s_waitcnt lgkmcnt(6)
    v_mfma_f32_16x16x32_bf16 v[16:19], v[56:59], a[56:59], v[16:19]
    v_mfma_f32_16x16x32_bf16 v[20:23], v[56:59], a[60:63], v[20:23]
    ds_read_b128 v[56:59], v4 offset:22528
    v_mfma_f32_16x16x32_bf16 v[28:31], v[60:63], a[60:63], v[28:31]
    v_mfma_f32_16x16x32_bf16 v[24:27], v[60:63], a[56:59], v[24:27]
    ds_read_b128 v[60:63], v4 offset:22784
    s_waitcnt lgkmcnt(6)
    v_mfma_f32_16x16x32_bf16 v[16:19], v[32:35], a[64:67], v[16:19]
    v_mfma_f32_16x16x32_bf16 v[20:23], v[32:35], a[68:71], v[20:23]
    ds_read_b128 v[32:35], v4 offset:24576
    v_mfma_f32_16x16x32_bf16 v[28:31], v[36:39], a[68:71], v[28:31]
    v_mfma_f32_16x16x32_bf16 v[24:27], v[36:39], a[64:67], v[24:27]
    ds_read_b128 v[36:39], v4 offset:24832
    s_waitcnt lgkmcnt(6)
    v_mfma_f32_16x16x32_bf16 v[16:19], v[40:43], a[72:75], v[16:19]
    v_mfma_f32_16x16x32_bf16 v[20:23], v[40:43], a[76:79], v[20:23]
    ds_read_b128 v[40:43], v4 offset:26624
    v_mfma_f32_16x16x32_bf16 v[28:31], v[44:47], a[76:79], v[28:31]
    v_mfma_f32_16x16x32_bf16 v[24:27], v[44:47], a[72:75], v[24:27]
    ds_read_b128 v[44:47], v4 offset:26880
    s_waitcnt lgkmcnt(6)
    v_mfma_f32_16x16x32_bf16 v[16:19], v[48:51], a[80:83], v[16:19]
    v_mfma_f32_16x16x32_bf16 v[20:23], v[48:51], a[84:87], v[20:23]
    ds_read_b128 v[48:51], v4 offset:28672
    v_mfma_f32_16x16x32_bf16 v[28:31], v[52:55], a[84:87], v[28:31]
    v_mfma_f32_16x16x32_bf16 v[24:27], v[52:55], a[80:83], v[24:27]
    ds_read_b128 v[52:55], v4 offset:28928
    s_waitcnt lgkmcnt(6)
    v_mfma_f32_16x16x32_bf16 v[16:19], v[56:59], a[88:91], v[16:19]
    v_mfma_f32_16x16x32_bf16 v[20:23], v[56:59], a[92:95], v[20:23]
    ds_read_b128 v[56:59], v4 offset:30720
    v_mfma_f32_16x16x32_bf16 v[28:31], v[60:63], a[92:95], v[28:31]
    v_mfma_f32_16x16x32_bf16 v[24:27], v[60:63], a[88:91], v[24:27]
    ds_read_b128 v[60:63], v4 offset:30976
    s_waitcnt lgkmcnt(6)
    v_mfma_f32_16x16x32_bf16 v[16:19], v[32:35], a[96:99], v[16:19]
    v_mfma_f32_16x16x32_bf16 v[20:23], v[32:35], a[100:103], v[20:23]
    v_mfma_f32_16x16x32_bf16 v[28:31], v[36:39], a[100:103], v[28:31]
    v_mfma_f32_16x16x32_bf16 v[24:27], v[36:39], a[96:99], v[24:27]
    s_waitcnt lgkmcnt(4)
    v_mfma_f32_16x16x32_bf16 v[16:19], v[40:43], a[104:107], v[16:19]
    v_mfma_f32_16x16x32_bf16 v[20:23], v[40:43], a[108:111], v[20:23]
    v_mfma_f32_16x16x32_bf16 v[28:31], v[44:47], a[108:111], v[28:31]
    v_mfma_f32_16x16x32_bf16 v[24:27], v[44:47], a[104:107], v[24:27]
    s_waitcnt lgkmcnt(2)
    v_mfma_f32_16x16x32_bf16 v[16:19], v[48:51], a[112:115], v[16:19]
    v_mfma_f32_16x16x32_bf16 v[20:23], v[48:51], a[116:119], v[20:23]
    v_mfma_f32_16x16x32_bf16 v[28:31], v[52:55], a[116:119], v[28:31]
    v_mfma_f32_16x16x32_bf16 v[24:27], v[52:55], a[112:115], v[24:27]
    s_waitcnt lgkmcnt(0)
    v_mfma_f32_16x16x32_bf16 v[16:19], v[56:59], a[120:123], v[16:19]
    v_mfma_f32_16x16x32_bf16 v[20:23], v[56:59], a[124:127], v[20:23]
    v_mfma_f32_16x16x32_bf16 v[28:31], v[60:63], a[124:127], v[28:31]
    v_mfma_f32_16x16x32_bf16 v[24:27], v[60:63], a[120:123], v[24:27]
    v_xor_b32 v4, 0x10000, v4
    s_setprio 0
    s_waitcnt vmcnt(0)
    s_lshl_b32 s67, s67, 1
    s_or_b32 s67, s67, 1
    s_add_u32 s60, s60, 1
    s_cmp_gt_u32 s66, s60
    s_cbranch_scc1 L_g_loop1_148
    s_barrier
    ds_read_b32 v14, v15
    s_waitcnt lgkmcnt(0)
    v_readfirstlane_b32 s66, v14
    s_barrier
    s_mov_b32 s69, 0
    s_cmp_gt_u32 s62, s60
    s_cbranch_scc1 L_g_nd_167
    s_cmp_ge_u32 s62, s66
    s_cbranch_scc1 L_g_nd_167
    s_add_u32 s47, s61, 4096
    s_add_u32 m0, s64, 0
    s_nop 0
    buffer_load_dwordx4 v3, s[12:15], s61 offen offset:0 sc1 lds
    buffer_load_dwordx4 v3, s[12:15], s61 offen offset:1024 sc1 lds
    buffer_load_dwordx4 v3, s[12:15], s61 offen offset:2048 sc1 lds
    buffer_load_dwordx4 v3, s[12:15], s61 offen offset:3072 sc1 lds
    s_add_u32 m0, s64, 4096
    s_nop 0
    buffer_load_dwordx4 v3, s[12:15], s47 offen offset:0 sc1 lds
    buffer_load_dwordx4 v3, s[12:15], s47 offen offset:1024 sc1 lds
    buffer_load_dwordx4 v3, s[12:15], s47 offen offset:2048 sc1 lds
    buffer_load_dwordx4 v3, s[12:15], s47 offen offset:3072 sc1 lds
    s_add_u32 s61, s61, 262144
    s_add_u32 s62, s62, 1
    s_xor_b32 s64, s64, 0x10000
    s_mov_b32 s69, 1
L_g_nd_167:
    s_sub_u32 s59, s60, 1
    ds_read_b128 v[80:83], v5 offset:0
    ds_read_b128 v[84:87], v5 offset:1024
    ds_read_b128 v[88:91], v5 offset:2048
    ds_read_b128 v[92:95], v5 offset:3072
    s_nop 7
    s_waitcnt lgkmcnt(3)
    v_add_f32 v80, v80, v16
    v_add_f32 v81, v81, v17
    v_add_f32 v82, v82, v18
    v_add_f32 v83, v83, v19
    s_waitcnt lgkmcnt(2)
    v_add_f32 v84, v84, v20
    v_add_f32 v85, v85, v21
    v_add_f32 v86, v86, v22
    v_add_f32 v87, v87, v23
    s_waitcnt lgkmcnt(1)
    v_add_f32 v88, v88, v24
    v_add_f32 v89, v89, v25
    v_add_f32 v90, v90, v26
    v_add_f32 v91, v91, v27
    s_waitcnt lgkmcnt(0)
    v_add_f32 v92, v92, v28
    v_add_f32 v93, v93, v29
    v_add_f32 v94, v94, v30
    v_add_f32 v95, v95, v31
    v_cvt_pk_bf16_f32 v104, v80, v81
    v_cvt_pk_bf16_f32 v105, v82, v83
    v_cvt_pk_bf16_f32 v106, v84, v85
    v_cvt_pk_bf16_f32 v107, v86, v87
    s_nop 1
    v_permlane16_swap_b32 v104, v106
    v_permlane16_swap_b32 v105, v107
    buffer_store_dwordx4 v[104:107], v8, s[12:15], s63 offen sc1
    v_cvt_pk_bf16_f32 v108, v88, v89
    v_cvt_pk_bf16_f32 v109, v90, v91
    v_cvt_pk_bf16_f32 v110, v92, v93
    v_cvt_pk_bf16_f32 v111, v94, v95
    s_nop 1
    v_permlane16_swap_b32 v108, v110
    v_permlane16_swap_b32 v109, v111
    buffer_store_dwordx4 v[108:111], v9, s[12:15], s63 offen sc1
    s_add_u32 s63, s63, 262144
    s_mov_b32 s67, 0
    s_mov_b32 s71, 1
    s_cmp_gt_u32 s66, s60
    s_cbranch_scc1 L_g_g1r_146
    v_mov_b32 v10, 1
    s_mov_b64 exec, 1
    s_waitcnt vmcnt(0)
    ds_add_rtn_u32 v10, v15, v10 offset:4
    s_waitcnt lgkmcnt(0)
    v_readfirstlane_b32 s46, v10
    s_mov_b64 exec, -1
    s_mov_b32 s71, 0
    s_sub_u32 s59, s60, 1
    s_cmp_lg_u32 s46, s68
    s_cbranch_scc1 L_g_df_168
    v_mov_b32 v10, s59
    v_add_u32 v10, 1, v10
    v_mov_b32 v11, 0
    s_mov_b64 exec, 1
    buffer_store_dword v10, v11, s[12:15], s52 offen sc1
    s_mov_b64 exec, -1
L_sf_169:
L_g_df_168:
    s_add_u32 s68, s68, 4
    s_cmp_gt_u32 s66, s60
    s_cbranch_scc1 L_g_g1r_146
L_g_tail_149:
    s_cmp_lt_u32 s60, s75
    s_cbranch_scc1 L_g_restart_144
    s_waitcnt vmcnt(0)
    s_barrier
    s_branch L_c_done_1
L_g_dp_159_l:
    s_cmp_ge_u32 s62, s66
    s_cbranch_scc1 L_g_dp_159_d
    s_mov_b32 s65, 1
    s_add_u32 s47, s61, 4096
    s_mov_b32 m0, s64
    s_add_u32 s62, s62, 1
    buffer_load_dwordx4 v3, s[12:15], s61 offen offset:0 sc1 lds
    buffer_load_dwordx4 v3, s[12:15], s61 offen offset:1024 sc1 lds
    buffer_load_dwordx4 v3, s[12:15], s61 offen offset:2048 sc1 lds
    buffer_load_dwordx4 v3, s[12:15], s61 offen offset:3072 sc1 lds
    s_add_u32 m0, s64, 4096
    s_add_u32 s61, s61, 262144
    buffer_load_dwordx4 v3, s[12:15], s47 offen offset:0 sc1 lds
    buffer_load_dwordx4 v3, s[12:15], s47 offen offset:1024 sc1 lds
    buffer_load_dwordx4 v3, s[12:15], s47 offen offset:2048 sc1 lds
    buffer_load_dwordx4 v3, s[12:15], s47 offen offset:3072 sc1 lds
    s_xor_b32 s64, s64, 0x10000
    s_branch L_g_dp_159_a
L_g_nw_157:
    s_waitcnt vmcnt(0) lgkmcnt(0)
    s_cmp_lg_u32 s44, 0
    s_cbranch_scc1 L_g_nl_170
    s_add_u32 s54, s60, 1
    v_add_u32 v12, s54, v113
    v_and_b32 v13, 3, v12
    v_lshl_add_u32 v13, v13, 7, v7
    buffer_load_dword v11, v13, s[12:15], 0 offen sc1
L_g_nl_170:
    s_branch L_g_loop0_147_l
L_g_nfl_161:
    s_cmp_eq_u32 s71, 0
    s_cbranch_scc1 L_g_nfl_161_d
    v_mov_b32 v10, 1
    s_mov_b64 exec, 1
    s_waitcnt vmcnt(0)
    ds_add_rtn_u32 v10, v15, v10 offset:4
    s_waitcnt lgkmcnt(0)
    v_readfirstlane_b32 s46, v10
    s_mov_b64 exec, -1
    s_mov_b32 s71, 0
    s_sub_u32 s59, s60, 1
    s_cmp_lg_u32 s46, s68
    s_cbranch_scc1 L_g_df_171
    v_mov_b32 v10, s59
    v_add_u32 v10, 1, v10
    v_mov_b32 v11, 0
    s_mov_b64 exec, 1
    buffer_store_dword v10, v11, s[12:15], s52 offen sc1
    s_mov_b64 exec, -1
L_sf_172:
L_g_df_171:
    s_add_u32 s68, s68, 4
    s_mov_b32 s65, 2
    s_branch L_g_nfl_161_d
L_g_dp_166_l:
    s_cmp_ge_u32 s62, s66
    s_cbranch_scc1 L_g_dp_166_d
    s_or_b32 s65, s65, 1
    s_add_u32 s47, s61, 4096
    s_mov_b32 m0, s64
    s_add_u32 s62, s62, 1
    buffer_load_dwordx4 v3, s[12:15], s61 offen offset:0 sc1 lds
    buffer_load_dwordx4 v3, s[12:15], s61 offen offset:1024 sc1 lds
    buffer_load_dwordx4 v3, s[12:15], s61 offen offset:2048 sc1 lds
    buffer_load_dwordx4 v3, s[12:15], s61 offen offset:3072 sc1 lds
    s_add_u32 m0, s64, 4096
    s_add_u32 s61, s61, 262144
    buffer_load_dwordx4 v3, s[12:15], s47 offen offset:0 sc1 lds
    buffer_load_dwordx4 v3, s[12:15], s47 offen offset:1024 sc1 lds
    buffer_load_dwordx4 v3, s[12:15], s47 offen offset:2048 sc1 lds
    buffer_load_dwordx4 v3, s[12:15], s47 offen offset:3072 sc1 lds
    s_xor_b32 s64, s64, 0x10000
    s_branch L_g_dp_166_a
L_g_nw1_163:
    s_cmp_eq_u32 s65, 2
    s_cbranch_scc1 L_g_nw1_163_w
    s_waitcnt vmcnt(0)
L_g_nw1_163_w:
    s_barrier
    ds_read_b128 v[32:35], v4 offset:0
    ds_read_b128 v[36:39], v4 offset:256
    ds_read_b128 v[40:43], v4 offset:2048
    ds_read_b128 v[44:47], v4 offset:2304
    ds_read_b128 v[48:51], v4 offset:4096
    ds_read_b128 v[52:55], v4 offset:4352
    ds_read_b128 v[56:59], v4 offset:6144
    ds_read_b128 v[60:63], v4 offset:6400
    s_branch L_g_jn_165
L_c_chain_9:
    v_mov_b32 v4, 0
    v_mov_b32 v5, 0
    v_mov_b32 v6, 0
    v_mov_b32 v7, 0
    v_mov_b32 v8, 0
    v_mov_b32 v9, 0
    v_mov_b32 v10, 0
    v_mov_b32 v11, 0
    v_mov_b32 v12, 0
    v_mov_b32 v13, 0
    v_mov_b32 v14, 0
    v_mov_b32 v15, 0
    v_mov_b32 v32, -1
    v_mov_b32 v33, -1
    v_mov_b32 v34, -1
    v_mov_b32 v35, -1
    v_lshlrev_b32 v2, 4, v1
    s_lshl_b32 s45, s40, 16
    s_lshl_b32 s46, s41, 12
    s_add_u32 s45, s45, s46
    s_and_b32 s46, s44, 3
    s_lshl_b32 s46, s46, 10
    s_add_u32 s45, s45, s46
    s_lshr_b32 s46, s44, 2
    s_lshl_b32 s46, s46, 19
    s_add_u32 s45, s45, s46
    s_add_u32 s45, s45, 0x7000000
    buffer_store_dwordx4 v[32:35], v2, s[12:15], s45 offen sc1
    s_lshl_b32 s45, s40, 15
    s_lshl_b32 s46, s41, 11
    s_add_u32 s45, s45, s46
    s_lshl_b32 s46, s44, 8
    s_add_u32 s45, s45, s46
    s_add_u32 s45, s45, 0x7100000
    s_mov_b64 exec, 0xffff
    buffer_store_dwordx4 v[32:35], v2, s[12:15], s45 offen sc1
    s_lshl_b32 s45, s40, 16
    s_lshl_b32 s46, s41, 8
    s_add_u32 s45, s45, s46
    s_and_b32 s46, s44, 3
    s_lshl_b32 s46, s46, 14
    s_add_u32 s45, s45, s46
    s_add_u32 s45, s45, 0x7180000
    buffer_store_dwordx4 v[32:35], v2, s[12:15], s45 offen sc1
    s_mov_b64 exec, -1
    v_lshlrev_b32 v2, 4, v1
    v_and_b32 v3, 8, v1
    v_cmp_eq_u32 vcc, 0, v3
    v_mov_b32 v3, 0xeeeeeeee
    v_mov_b32 v4, 0x44444444
    v_cndmask_b32 v3, v3, v4, vcc
    v_and_b32 v100, 15, v1
    v_lshrrev_b32 v101, 4, v1
    v_and_b32 v102, 1, v101
    v_lshrrev_b32 v103, 1, v101
    v_lshlrev_b32 v104, 2, v102
    v_lshl_add_u32 v104, v103, 1, v104
    v_and_b32 v105, 1, v1
    v_add_u32 v104, v104, v105
    v_and_b32 v106, 7, v1
    v_bfe_u32 v107, v1, 3, 1
    s_lshr_b32 s42, s41, 2
    s_and_b32 s43, s41, 3
    s_lshl_b32 s49, s40, 2
    s_add_u32 s49, s49, s42
    s_lshl_b32 s45, s44, 14
    v_lshlrev_b32 v22, 3, v101
    v_bfe_u32 v23, v1, 2, 2
    v_add_u32 v22, v22, v23
    v_and_b32 v23, 3, v1
    v_lshlrev_b32 v24, 3, v23
    v_lshl_add_u32 v20, v22, 6, v24
    v_lshl_add_u32 v21, v22, 7, v24
    v_lshrrev_b32 v22, 2, v1
    v_lshlrev_b32 v23, 4, v23
    v_lshl_add_u32 v24, v22, 13, v23
    v_lshrrev_b32 v22, 3, v1
    v_lshlrev_b32 v23, 4, v106
    v_lshl_add_u32 v25, v22, 11, v23
    s_cmp_ge_u32 s44, 4
    s_cbranch_scc1 L_v_init_173
    s_lshr_b32 s50, s44, 1
    s_and_b32 s51, s44, 1
    s_load_dwordx4 s[4:7], s[0:1], 16
    s_lshl_b32 s46, s49, 8
    s_lshl_b32 s48, s43, 6
    s_add_u32 s46, s46, s48
    s_lshl_b32 s48, s44, 21
    s_add_u32 s46, s46, s48
    s_lshl_b32 s52, s51, 5
    s_xor_b32 s53, s50, 1
    s_lshl_b32 s53, s53, 16
    s_add_u32 s52, s52, s53
    v_add_u32 v20, s52, v20
    s_waitcnt lgkmcnt(0)
    s_mov_b32 s24, s6
    s_and_b32 s25, s7, 0xffff
    s_mov_b32 s26, 0x800000
    s_mov_b32 s27, 0x00020000
    s_mov_b32 s28, s4
    s_and_b32 s29, s5, 0xffff
    s_mov_b32 s30, 0x800000
    s_mov_b32 s31, 0x00020000
    s_lshl_b32 s52, s51, 9
    s_lshl_b32 s53, s50, 7
    s_add_u32 s52, s52, s53
    s_add_u32 s52, s52, 61440
    v_lshlrev_b32 v5, 1, v106
    v_lshl_add_u32 v5, v107, 8, v5
    v_lshl_add_u32 v5, v102, 6, v5
    v_lshl_add_u32 v5, v103, 5, v5
    v_add_u32 v5, s52, v5
    s_lshl_b32 s67, s49, 12
    s_lshl_b32 s53, s43, 10
    s_add_u32 s67, s67, s53
    s_add_u32 s67, s67, 0x1000000
    s_lshl_b32 s52, s40, 16
    s_lshl_b32 s53, s44, 12
    s_add_u32 s53, s52, s53
    s_add_u32 s53, s53, 0x7080000
    v_add_u32 v7, s53, v2
    s_lshl_b32 s53, s44, 10
    s_add_u32 s53, s52, s53
    s_add_u32 s53, s53, 0x7180000
    v_lshlrev_b32 v28, 7, v103
    v_lshl_add_u32 v28, v106, 4, v28
    v_lshl_add_u32 v28, v102, 3, v28
    v_lshl_add_u32 v28, v107, 2, v28
    v_add_u32 v28, s53, v28
    s_lshl_b32 s52, s44, 10
    s_add_u32 s52, s52, 16384
    v_lshlrev_b32 v8, 8, v101
    v_lshl_add_u32 v8, v106, 4, v8
    v_lshl_add_u32 v8, v107, 3, v8
    v_add_u32 v8, s52, v8
    s_lshl_b32 s52, s44, 8
    s_add_u32 s52, s52, 20480
    v_lshlrev_b32 v9, 4, v106
    v_lshl_add_u32 v9, v101, 2, v9
    v_lshl_add_u32 v9, v107, 1, v9
    v_add_u32 v9, s52, v9
    s_mov_b32 s66, 0x3e0293ee
    s_add_u32 m0, s45, 0
    s_add_u32 s48, s46, 0x0
    buffer_load_dwordx4 v24, s[24:27], s48 offen lds
    s_add_u32 m0, s45, 1024
    s_add_u32 s48, s46, 0x20000
    buffer_load_dwordx4 v24, s[24:27], s48 offen lds
    s_add_u32 m0, s45, 2048
    s_add_u32 s48, s46, 0x40000
    buffer_load_dwordx4 v24, s[24:27], s48 offen lds
    s_add_u32 m0, s45, 3072
    s_add_u32 s48, s46, 0x60000
    buffer_load_dwordx4 v24, s[24:27], s48 offen lds
    s_add_u32 m0, s45, 4096
    s_add_u32 s48, s46, 0x80000
    buffer_load_dwordx4 v24, s[24:27], s48 offen lds
    s_add_u32 m0, s45, 5120
    s_add_u32 s48, s46, 0xa0000
    buffer_load_dwordx4 v24, s[24:27], s48 offen lds
    s_add_u32 m0, s45, 6144
    s_add_u32 s48, s46, 0xc0000
    buffer_load_dwordx4 v24, s[24:27], s48 offen lds
    s_add_u32 m0, s45, 7168
    s_add_u32 s48, s46, 0xe0000
    buffer_load_dwordx4 v24, s[24:27], s48 offen lds
    s_add_u32 m0, s45, 8192
    s_add_u32 s48, s46, 0x100000
    buffer_load_dwordx4 v24, s[24:27], s48 offen lds
    s_add_u32 m0, s45, 9216
    s_add_u32 s48, s46, 0x120000
    buffer_load_dwordx4 v24, s[24:27], s48 offen lds
    s_add_u32 m0, s45, 10240
    s_add_u32 s48, s46, 0x140000
    buffer_load_dwordx4 v24, s[24:27], s48 offen lds
    s_add_u32 m0, s45, 11264
    s_add_u32 s48, s46, 0x160000
    buffer_load_dwordx4 v24, s[24:27], s48 offen lds
    s_add_u32 m0, s45, 12288
    s_add_u32 s48, s46, 0x180000
    buffer_load_dwordx4 v24, s[24:27], s48 offen lds
    s_add_u32 m0, s45, 13312
    s_add_u32 s48, s46, 0x1a0000
    buffer_load_dwordx4 v24, s[24:27], s48 offen lds
    s_add_u32 m0, s45, 14336
    s_add_u32 s48, s46, 0x1c0000
    buffer_load_dwordx4 v24, s[24:27], s48 offen lds
    s_add_u32 m0, s45, 15360
    s_add_u32 s48, s46, 0x1e0000
    buffer_load_dwordx4 v24, s[24:27], s48 offen lds
    s_add_u32 s45, s45, 0x10000
    s_add_u32 m0, s45, 0
    s_add_u32 s48, s46, 0x0
    buffer_load_dwordx4 v24, s[28:31], s48 offen lds
    s_add_u32 m0, s45, 1024
    s_add_u32 s48, s46, 0x20000
    buffer_load_dwordx4 v24, s[28:31], s48 offen lds
    s_add_u32 m0, s45, 2048
    s_add_u32 s48, s46, 0x40000
    buffer_load_dwordx4 v24, s[28:31], s48 offen lds
    s_add_u32 m0, s45, 3072
    s_add_u32 s48, s46, 0x60000
    buffer_load_dwordx4 v24, s[28:31], s48 offen lds
    s_add_u32 m0, s45, 4096
    s_add_u32 s48, s46, 0x80000
    buffer_load_dwordx4 v24, s[28:31], s48 offen lds
    s_add_u32 m0, s45, 5120
    s_add_u32 s48, s46, 0xa0000
    buffer_load_dwordx4 v24, s[28:31], s48 offen lds
    s_add_u32 m0, s45, 6144
    s_add_u32 s48, s46, 0xc0000
    buffer_load_dwordx4 v24, s[28:31], s48 offen lds
    s_add_u32 m0, s45, 7168
    s_add_u32 s48, s46, 0xe0000
    buffer_load_dwordx4 v24, s[28:31], s48 offen lds
    s_add_u32 m0, s45, 8192
    s_add_u32 s48, s46, 0x100000
    buffer_load_dwordx4 v24, s[28:31], s48 offen lds
    s_add_u32 m0, s45, 9216
    s_add_u32 s48, s46, 0x120000
    buffer_load_dwordx4 v24, s[28:31], s48 offen lds
    s_add_u32 m0, s45, 10240
    s_add_u32 s48, s46, 0x140000
    buffer_load_dwordx4 v24, s[28:31], s48 offen lds
    s_add_u32 m0, s45, 11264
    s_add_u32 s48, s46, 0x160000
    buffer_load_dwordx4 v24, s[28:31], s48 offen lds
    s_add_u32 m0, s45, 12288
    s_add_u32 s48, s46, 0x180000
    buffer_load_dwordx4 v24, s[28:31], s48 offen lds
    s_add_u32 m0, s45, 13312
    s_add_u32 s48, s46, 0x1a0000
    buffer_load_dwordx4 v24, s[28:31], s48 offen lds
    s_add_u32 m0, s45, 14336
    s_add_u32 s48, s46, 0x1c0000
    buffer_load_dwordx4 v24, s[28:31], s48 offen lds
    s_add_u32 m0, s45, 15360
    s_add_u32 s48, s46, 0x1e0000
    buffer_load_dwordx4 v24, s[28:31], s48 offen lds
    s_add_u32 s45, s45, 0x10000
    s_waitcnt vmcnt(0)
    s_barrier
    s_cmp_lg_u32 s44, 0
    s_cbranch_scc1 L_zwok_176
    v_and_b32 v16, 7, v1
    v_lshlrev_b32 v16, 5, v16
    s_mov_b32 s70, 0
L_zw_175:
    buffer_load_dword v17, v16, s[16:19], 0 offen sc1
    s_waitcnt vmcnt(0)
    v_add_u32_dpp v17, v17, v17 row_ror:1 row_mask:0xf bank_mask:0xf
    s_nop 1
    v_add_u32_dpp v17, v17, v17 row_ror:2 row_mask:0xf bank_mask:0xf
    s_nop 1
    v_add_u32_dpp v17, v17, v17 row_ror:4 row_mask:0xf bank_mask:0xf
    v_cmp_ne_u32 vcc, 0x100, v17
    s_add_u32 s70, s70, 1
    s_cbranch_vccz L_zwok_176
    s_sleep 4
    s_cmp_lt_u32 s70, 524288
    s_cbranch_scc1 L_zw_175
    s_branch L_c_done_1
L_zwok_176:
    s_cmp_lg_u32 s44, 0
    s_cbranch_scc1 L_c_nr_177
    s_or_b32 s47, s39, 0x100
    v_mov_b32 v16, s47
    s_lshl_b32 s52, s40, 6
    s_lshl_b32 s53, s41, 2
    s_add_u32 s52, s52, s53
    s_add_u32 s52, s52, 0x101000
    v_mov_b32 v17, 0
    s_mov_b64 exec, 1
    buffer_store_dword v16, v17, s[12:15], s52 offen sc1
    s_mov_b64 exec, -1
L_c_nr_177:
    ds_read_b64_tr_b16 a[0:1], v20 offset:0
    ds_read_b64_tr_b16 a[2:3], v20 offset:256
    ds_read_b64_tr_b16 a[4:5], v20 offset:2048
    ds_read_b64_tr_b16 a[6:7], v20 offset:2304
    ds_read_b64_tr_b16 a[8:9], v20 offset:4096
    ds_read_b64_tr_b16 a[10:11], v20 offset:4352
    ds_read_b64_tr_b16 a[12:13], v20 offset:6144
    ds_read_b64_tr_b16 a[14:15], v20 offset:6400
    s_waitcnt lgkmcnt(0)
    ds_read_b64_tr_b16 a[16:17], v20 offset:8192
    ds_read_b64_tr_b16 a[18:19], v20 offset:8448
    ds_read_b64_tr_b16 a[20:21], v20 offset:10240
    ds_read_b64_tr_b16 a[22:23], v20 offset:10496
    ds_read_b64_tr_b16 a[24:25], v20 offset:12288
    ds_read_b64_tr_b16 a[26:27], v20 offset:12544
    ds_read_b64_tr_b16 a[28:29], v20 offset:14336
    ds_read_b64_tr_b16 a[30:31], v20 offset:14592
    s_waitcnt lgkmcnt(0)
    ds_read_b64_tr_b16 a[32:33], v20 offset:16384
    ds_read_b64_tr_b16 a[34:35], v20 offset:16640
    ds_read_b64_tr_b16 a[36:37], v20 offset:18432
    ds_read_b64_tr_b16 a[38:39], v20 offset:18688
    ds_read_b64_tr_b16 a[40:41], v20 offset:20480
    ds_read_b64_tr_b16 a[42:43], v20 offset:20736
    ds_read_b64_tr_b16 a[44:45], v20 offset:22528
    ds_read_b64_tr_b16 a[46:47], v20 offset:22784
    s_waitcnt lgkmcnt(0)
    ds_read_b64_tr_b16 a[48:49], v20 offset:24576
    ds_read_b64_tr_b16 a[50:51], v20 offset:24832
    ds_read_b64_tr_b16 a[52:53], v20 offset:26624
    ds_read_b64_tr_b16 a[54:55], v20 offset:26880
    ds_read_b64_tr_b16 a[56:57], v20 offset:28672
    ds_read_b64_tr_b16 a[58:59], v20 offset:28928
    ds_read_b64_tr_b16 a[60:61], v20 offset:30720
    ds_read_b64_tr_b16 a[62:63], v20 offset:30976
    s_waitcnt lgkmcnt(0)
    ds_read_b64_tr_b16 a[64:65], v20 offset:32768
    ds_read_b64_tr_b16 a[66:67], v20 offset:33024
    ds_read_b64_tr_b16 a[68:69], v20 offset:34816
    ds_read_b64_tr_b16 a[70:71], v20 offset:35072
    ds_read_b64_tr_b16 a[72:73], v20 offset:36864
    ds_read_b64_tr_b16 a[74:75], v20 offset:37120
    ds_read_b64_tr_b16 a[76:77], v20 offset:38912
    ds_read_b64_tr_b16 a[78:79], v20 offset:39168
    s_waitcnt lgkmcnt(0)
    ds_read_b64_tr_b16 a[80:81], v20 offset:40960
    ds_read_b64_tr_b16 a[82:83], v20 offset:41216
    ds_read_b64_tr_b16 a[84:85], v20 offset:43008
    ds_read_b64_tr_b16 a[86:87], v20 offset:43264
    ds_read_b64_tr_b16 a[88:89], v20 offset:45056
    ds_read_b64_tr_b16 a[90:91], v20 offset:45312
    ds_read_b64_tr_b16 a[92:93], v20 offset:47104
    ds_read_b64_tr_b16 a[94:95], v20 offset:47360
    s_waitcnt lgkmcnt(0)
    ds_read_b64_tr_b16 a[96:97], v20 offset:49152
    ds_read_b64_tr_b16 a[98:99], v20 offset:49408
    ds_read_b64_tr_b16 a[100:101], v20 offset:51200
    ds_read_b64_tr_b16 a[102:103], v20 offset:51456
    ds_read_b64_tr_b16 a[104:105], v20 offset:53248
    ds_read_b64_tr_b16 a[106:107], v20 offset:53504
    ds_read_b64_tr_b16 a[108:109], v20 offset:55296
    ds_read_b64_tr_b16 a[110:111], v20 offset:55552
    s_waitcnt lgkmcnt(0)
    ds_read_b64_tr_b16 a[112:113], v20 offset:57344
    ds_read_b64_tr_b16 a[114:115], v20 offset:57600
    ds_read_b64_tr_b16 a[116:117], v20 offset:59392
    ds_read_b64_tr_b16 a[118:119], v20 offset:59648
    ds_read_b64_tr_b16 a[120:121], v20 offset:61440
    ds_read_b64_tr_b16 a[122:123], v20 offset:61696
    ds_read_b64_tr_b16 a[124:125], v20 offset:63488
    ds_read_b64_tr_b16 a[126:127], v20 offset:63744
    s_waitcnt lgkmcnt(0)
    s_mov_b32 s63, 0
    s_barrier
    s_lshl_b32 s52, s40, 2
    s_add_u32 s52, s52, s44
    s_mul_i32 s52, s52, 24576
    s_lshl_b32 s53, s41, 9
    s_add_u32 s52, s52, s53
    s_add_u32 s52, s52, 0x2004000
    v_and_b32 v14, 3, v1
    v_lshlrev_b32 v14, 7, v14
    v_add_u32 v14, s52, v14
    s_lshl_b32 s52, s40, 16
    s_lshl_b32 s53, s41, 10
    s_add_u32 s53, s53, s52
    s_lshl_b32 s54, s44, 7
    s_add_u32 s53, s53, s54
    s_add_u32 s53, s53, 0x7080000
    v_lshlrev_b32 v4, 4, v106
    v_lshl_add_u32 v10, v102, 7, v4
    v_lshl_add_u32 v4, v101, 8, v4
    v_add_u32 v4, s53, v4
    s_lshl_b32 s53, s41, 8
    s_add_u32 s53, s53, s52
    s_add_u32 s53, s53, 0x7180000
    v_add_u32 v10, s53, v10
    s_cmp_ge_u32 s44, 2
    s_cselect_b64 vcc, -1, 0
    v_cndmask_b32 v4, v4, v10, vcc
    s_mul_i32 s52, s49, 24576
    s_lshl_b32 s53, s44, 12
    s_add_u32 s52, s52, s53
    s_lshl_b32 s53, s43, 10
    s_add_u32 s52, s52, s53
    s_add_u32 s52, s52, 0x2002000
    v_add_u32 v6, s52, v2
    v_lshrrev_b32 v10, 3, v1
    v_lshlrev_b32 v10, 8, v10
    v_lshl_add_u32 v10, v106, 4, v10
    v_add_u32 v10, 61568, v10
    v_add_u32 v11, 27648, v2
    v_cmp_gt_u32 s[52:53], 32, v1
    s_nop 1
    v_cndmask_b32 v10, v11, v10, s[52:53]
    v_cndmask_b32 v6, v6, v10, vcc
    v_mov_b32 v24, -1
    v_mov_b32 v25, -1
    v_mov_b32 v26, -1
    v_mov_b32 v27, -1
    s_and_b32 s52, s40, 1
    s_lshl_b32 s52, s52, 14
    s_lshl_b32 s53, s41, 10
    s_add_u32 s52, s52, s53
    s_lshl_b32 s53, s50, 9
    s_add_u32 s52, s52, s53
    s_lshl_b32 s53, s51, 7
    s_add_u32 s52, s52, s53
    s_add_u32 s52, s52, 0x800000
    v_mov_b32 v46, s52
    v_add_u32 v44, 65536, v2
    s_lshl_b32 s52, s50, 10
    s_add_u32 s52, s52, 62464
    v_add_u32 v31, s52, v2
    s_lshl_b32 s53, s51, 9
    s_add_u32 s52, s52, s53
    v_lshlrev_b32 v45, 4, v100
    v_lshl_add_u32 v45, v103, 8, v45
    v_lshl_add_u32 v45, v102, 3, v45
    v_add_u32 v45, s52, v45
    s_mul_i32 s52, s49, 24576
    s_lshl_b32 s53, s50, 13
    s_add_u32 s52, s52, s53
    s_lshl_b32 s53, s43, 10
    s_add_u32 s52, s52, s53
    s_add_u32 s52, s52, 0x5000000
    v_add_u32 v13, s52, v2
    v_mov_b32 v29, 26644
    v_mov_b32 v30, 0
    ds_write_b32 v29, v30
    v_mov_b32 v30, 1
    s_lshl_b32 s58, s40, 11
    s_lshl_b32 s53, s44, 7
    s_add_u32 s58, s58, s53
    s_add_u32 s58, s58, 0x10a600
    s_mov_b32 s69, 0
    v_mov_b32 v0, 0
    s_xor_b32 s59, s44, 2
    s_or_b32 s59, s59, s41
    s_cselect_b32 s59, 0, 3
    s_mov_b32 s64, 0
    s_cmp_ge_u32 s44, 2
    s_cselect_b32 s50, 0, 0x00ff00ff
    s_mov_b32 s51, 0x00ff00ff
    s_setprio 1
    s_branch L_c_join_174
L_v_init_173:
    s_sub_u32 s54, s44, 4
    s_lshr_b32 s51, s54, 1
    s_and_b32 s50, s54, 1
    s_load_dwordx4 s[4:7], s[0:1], 32
    s_load_dwordx2 s[8:9], s[0:1], 8
    s_waitcnt lgkmcnt(0)
    s_mov_b32 s24, s4
    s_and_b32 s25, s5, 0xffff
    s_mov_b32 s26, 0x800000
    s_mov_b32 s27, 0x00020000
    s_mov_b32 s28, s6
    s_and_b32 s29, s7, 0xffff
    s_mov_b32 s30, 0x800000
    s_mov_b32 s31, 0x00020000
    s_mov_b32 s32, s8
    s_and_b32 s33, s9, 0xffff
    s_mov_b32 s34, 0x4000
    s_mov_b32 s35, 0x00020000
    s_lshl_b32 s45, s54, 12
    s_add_u32 s45, s45, 0x20000
    v_add_u32 v20, s45, v20
    v_add_u32 v21, s45, v21
    v_add_u32 v22, s45, v2
    s_lshl_b32 s46, s49, 8
    s_lshl_b32 s48, s43, 6
    s_add_u32 s46, s46, s48
    s_lshl_b32 s48, s54, 21
    s_add_u32 s46, s46, s48
    s_add_u32 s48, s46, 0x0
    buffer_load_dwordx4 a[0:3], v24, s[24:27], s48 offen
    s_add_u32 s48, s46, 0x20000
    buffer_load_dwordx4 a[32:35], v24, s[24:27], s48 offen
    s_add_u32 s48, s46, 0x40000
    buffer_load_dwordx4 a[4:7], v24, s[24:27], s48 offen
    s_add_u32 s48, s46, 0x60000
    buffer_load_dwordx4 a[36:39], v24, s[24:27], s48 offen
    s_add_u32 s48, s46, 0x80000
    buffer_load_dwordx4 a[8:11], v24, s[24:27], s48 offen
    s_add_u32 s48, s46, 0xa0000
    buffer_load_dwordx4 a[40:43], v24, s[24:27], s48 offen
    s_add_u32 s48, s46, 0xc0000
    buffer_load_dwordx4 a[12:15], v24, s[24:27], s48 offen
    s_add_u32 s48, s46, 0xe0000
    buffer_load_dwordx4 a[44:47], v24, s[24:27], s48 offen
    s_add_u32 s48, s46, 0x100000
    buffer_load_dwordx4 a[16:19], v24, s[24:27], s48 offen
    s_add_u32 s48, s46, 0x120000
    buffer_load_dwordx4 a[48:51], v24, s[24:27], s48 offen
    s_add_u32 s48, s46, 0x140000
    buffer_load_dwordx4 a[20:23], v24, s[24:27], s48 offen
    s_add_u32 s48, s46, 0x160000
    buffer_load_dwordx4 a[52:55], v24, s[24:27], s48 offen
    s_add_u32 s48, s46, 0x180000
    buffer_load_dwordx4 a[24:27], v24, s[24:27], s48 offen
    s_add_u32 s48, s46, 0x1a0000
    buffer_load_dwordx4 a[56:59], v24, s[24:27], s48 offen
    s_add_u32 s48, s46, 0x1c0000
    buffer_load_dwordx4 a[28:31], v24, s[24:27], s48 offen
    s_add_u32 s48, s46, 0x1e0000
    buffer_load_dwordx4 a[60:63], v24, s[24:27], s48 offen
    s_lshl_b32 s52, s40, 15
    s_lshl_b32 s53, s42, 11
    s_add_u32 s52, s52, s53
    s_lshl_b32 s53, s43, 9
    s_add_u32 s52, s52, s53
    s_lshl_b32 s53, s51, 8
    s_add_u32 s52, s52, s53
    s_add_u32 s52, s52, 0x7100000
    v_bfe_u32 v4, v1, 1, 1
    v_lshlrev_b32 v4, 7, v4
    v_lshl_add_u32 v4, v104, 4, v4
    v_and_b32 v5, 12, v100
    v_add_u32 v4, v4, v5
    v_add_u32 v4, s52, v4
    v_mov_b32 v26, -1
    s_lshl_b32 s52, s51, 5
    s_add_u32 s52, s52, 28160
    v_and_b32 v5, 14, v100
    v_lshlrev_b32 v5, 1, v5
    v_lshl_add_u32 v5, v104, 6, v5
    v_add_u32 v5, s52, v5
    s_lshl_b32 s52, s41, 14
    s_lshl_b32 s53, s54, 11
    s_add_u32 s52, s52, s53
    s_add_u32 s52, s52, 0x7800000
    v_lshlrev_b32 v6, 3, v101
    v_lshl_add_u32 v6, v106, 5, v6
    v_and_b32 v7, 3, v1
    v_lshlrev_b32 v7, 3, v7
    v_bfe_u32 v30, v1, 2, 3
    v_lshl_add_u32 v7, v30, 5, v7
    v_lshl_add_u32 v7, v103, 2, v7
    v_add_u32 v7, s52, v7
    s_lshl_b32 s53, s40, 8
    s_add_u32 s52, s52, s53
    v_add_u32 v6, s52, v6
    v_lshlrev_b32 v30, 4, v100
    v_lshl_add_u32 v30, v101, 18, v30
    v_add_u32 v30, s52, v30
    v_mov_b32 v32, -1
    v_mov_b32 v33, -1
    v_mov_b32 v34, -1
    v_mov_b32 v35, -1
    buffer_store_dwordx4 v[32:35], v30, s[12:15], 0 offen sc1
    s_mov_b32 s53, 8192
    buffer_store_dwordx4 v[32:35], v30, s[12:15], s53 offen sc1
    s_lshl_b32 s55, s40, 16
    s_add_u32 s55, s55, 0x7000000
    s_lshl_b32 s52, s41, 10
    s_lshl_b32 s53, s54, 8
    s_add_u32 s52, s52, s53
    s_add_u32 s52, s52, s55
    v_lshlrev_b32 v8, 2, v1
    v_add_u32 v8, s52, v8
    s_lshl_b32 s53, s54, 12
    v_add_u32 v10, s53, v2
    v_add_u32 v9, s55, v10
    s_lshl_b32 s52, s40, 15
    s_lshl_b32 s53, s54, 11
    s_add_u32 s52, s52, s53
    s_add_u32 s52, s52, 0x7100000
    v_add_u32 v11, s52, v2
    s_lshl_b32 s52, s54, 9
    s_add_u32 s52, s52, 53248
    v_lshlrev_b32 v12, 4, v100
    v_lshl_add_u32 v12, v102, 3, v12
    v_lshl_add_u32 v12, v103, 8, v12
    v_add_u32 v12, s52, v12
    s_lshl_b32 s52, s51, 3
    s_add_u32 s52, s52, 49152
    v_add_u32 v13, s52, v2
    s_lshl_b32 s52, s54, 10
    s_add_u32 s52, s52, 49152
    v_add_u32 v14, s52, v2
    s_lshl_b32 s52, s40, 2
    s_add_u32 s52, s52, s54
    s_mul_i32 s52, s52, 24576
    s_add_u32 s52, s52, 0x2004000
    v_add_u32 v15, s52, v2
    s_lshl_b32 s52, s54, 10
    v_add_u32 v27, s52, v2
    v_lshlrev_b32 v30, 11, v106
    v_lshl_add_u32 v30, v101, 5, v30
    v_lshl_add_u32 v30, v107, 2, v30
    s_lshl_b32 s52, s54, 9
    buffer_load_dword v112, v30, s[32:35], s52 offen offset:0
    buffer_load_dword v113, v30, s[32:35], s52 offen offset:8
    buffer_load_dword v114, v30, s[32:35], s52 offen offset:16
    buffer_load_dword v115, v30, s[32:35], s52 offen offset:24
    buffer_load_dword v116, v30, s[32:35], s52 offen offset:128
    buffer_load_dword v117, v30, s[32:35], s52 offen offset:136
    buffer_load_dword v118, v30, s[32:35], s52 offen offset:144
    buffer_load_dword v119, v30, s[32:35], s52 offen offset:152
    buffer_load_dword v120, v30, s[32:35], s52 offen offset:256
    buffer_load_dword v121, v30, s[32:35], s52 offen offset:264
    buffer_load_dword v122, v30, s[32:35], s52 offen offset:272
    buffer_load_dword v123, v30, s[32:35], s52 offen offset:280
    buffer_load_dword v124, v30, s[32:35], s52 offen offset:384
    buffer_load_dword v125, v30, s[32:35], s52 offen offset:392
    buffer_load_dword v126, v30, s[32:35], s52 offen offset:400
    buffer_load_dword v127, v30, s[32:35], s52 offen offset:408
    s_lshl_b32 s46, s40, 2
    s_add_u32 s46, s46, s54
    s_lshl_b32 s46, s46, 18
    s_lshl_b32 s48, s41, 7
    s_add_u32 s46, s46, s48
    s_add_u32 s48, s46, 0x0
    buffer_load_dwordx4 a[64:67], v25, s[28:31], s48 offen
    s_add_u32 s48, s46, 0x4000
    buffer_load_dwordx4 a[80:83], v25, s[28:31], s48 offen
    s_add_u32 s48, s46, 0x8000
    buffer_load_dwordx4 a[96:99], v25, s[28:31], s48 offen
    s_add_u32 s48, s46, 0xc000
    buffer_load_dwordx4 a[112:115], v25, s[28:31], s48 offen
    s_add_u32 s48, s46, 0x10000
    buffer_load_dwordx4 a[68:71], v25, s[28:31], s48 offen
    s_add_u32 s48, s46, 0x14000
    buffer_load_dwordx4 a[84:87], v25, s[28:31], s48 offen
    s_add_u32 s48, s46, 0x18000
    buffer_load_dwordx4 a[100:103], v25, s[28:31], s48 offen
    s_add_u32 s48, s46, 0x1c000
    buffer_load_dwordx4 a[116:119], v25, s[28:31], s48 offen
    s_add_u32 s48, s46, 0x20000
    buffer_load_dwordx4 a[72:75], v25, s[28:31], s48 offen
    s_add_u32 s48, s46, 0x24000
    buffer_load_dwordx4 a[88:91], v25, s[28:31], s48 offen
    s_add_u32 s48, s46, 0x28000
    buffer_load_dwordx4 a[104:107], v25, s[28:31], s48 offen
    s_add_u32 s48, s46, 0x2c000
    buffer_load_dwordx4 a[120:123], v25, s[28:31], s48 offen
    s_add_u32 s48, s46, 0x30000
    buffer_load_dwordx4 a[76:79], v25, s[28:31], s48 offen
    s_add_u32 s48, s46, 0x34000
    buffer_load_dwordx4 a[92:95], v25, s[28:31], s48 offen
    s_add_u32 s48, s46, 0x38000
    buffer_load_dwordx4 a[108:111], v25, s[28:31], s48 offen
    s_add_u32 s48, s46, 0x3c000
    buffer_load_dwordx4 a[124:127], v25, s[28:31], s48 offen
    s_waitcnt vmcnt(16)
    ds_write_b128 v22, a[0:3] offset:0
    ds_write_b128 v22, a[32:35] offset:1024
    ds_write_b128 v22, a[4:7] offset:2048
    ds_write_b128 v22, a[36:39] offset:3072
    s_waitcnt lgkmcnt(0)
    ds_read_b64_tr_b16 a[0:1], v20 offset:0
    ds_read_b64_tr_b16 a[2:3], v20 offset:256
    ds_read_b64_tr_b16 a[32:33], v20 offset:32
    ds_read_b64_tr_b16 a[34:35], v20 offset:288
    ds_read_b64_tr_b16 a[4:5], v20 offset:2048
    ds_read_b64_tr_b16 a[6:7], v20 offset:2304
    ds_read_b64_tr_b16 a[36:37], v20 offset:2080
    ds_read_b64_tr_b16 a[38:39], v20 offset:2336
    s_waitcnt lgkmcnt(0)
    ds_write_b128 v22, a[8:11] offset:0
    ds_write_b128 v22, a[40:43] offset:1024
    ds_write_b128 v22, a[12:15] offset:2048
    ds_write_b128 v22, a[44:47] offset:3072
    s_waitcnt lgkmcnt(0)
    ds_read_b64_tr_b16 a[8:9], v20 offset:0
    ds_read_b64_tr_b16 a[10:11], v20 offset:256
    ds_read_b64_tr_b16 a[40:41], v20 offset:32
    ds_read_b64_tr_b16 a[42:43], v20 offset:288
    ds_read_b64_tr_b16 a[12:13], v20 offset:2048
    ds_read_b64_tr_b16 a[14:15], v20 offset:2304
    ds_read_b64_tr_b16 a[44:45], v20 offset:2080
    ds_read_b64_tr_b16 a[46:47], v20 offset:2336
    s_waitcnt lgkmcnt(0)
    ds_write_b128 v22, a[16:19] offset:0
    ds_write_b128 v22, a[48:51] offset:1024
    ds_write_b128 v22, a[20:23] offset:2048
    ds_write_b128 v22, a[52:55] offset:3072
    s_waitcnt lgkmcnt(0)
    ds_read_b64_tr_b16 a[16:17], v20 offset:0
    ds_read_b64_tr_b16 a[18:19], v20 offset:256
    ds_read_b64_tr_b16 a[48:49], v20 offset:32
    ds_read_b64_tr_b16 a[50:51], v20 offset:288
    ds_read_b64_tr_b16 a[20:21], v20 offset:2048
    ds_read_b64_tr_b16 a[22:23], v20 offset:2304
    ds_read_b64_tr_b16 a[52:53], v20 offset:2080
    ds_read_b64_tr_b16 a[54:55], v20 offset:2336
    s_waitcnt lgkmcnt(0)
    ds_write_b128 v22, a[24:27] offset:0
    ds_write_b128 v22, a[56:59] offset:1024
    ds_write_b128 v22, a[28:31] offset:2048
    ds_write_b128 v22, a[60:63] offset:3072
    s_waitcnt lgkmcnt(0)
    ds_read_b64_tr_b16 a[24:25], v20 offset:0
    ds_read_b64_tr_b16 a[26:27], v20 offset:256
    ds_read_b64_tr_b16 a[56:57], v20 offset:32
    ds_read_b64_tr_b16 a[58:59], v20 offset:288
    ds_read_b64_tr_b16 a[28:29], v20 offset:2048
    ds_read_b64_tr_b16 a[30:31], v20 offset:2304
    ds_read_b64_tr_b16 a[60:61], v20 offset:2080
    ds_read_b64_tr_b16 a[62:63], v20 offset:2336
    s_waitcnt lgkmcnt(0)
    s_barrier
    s_waitcnt vmcnt(0)
    ds_write_b128 v22, a[64:67] offset:0
    ds_write_b128 v22, a[80:83] offset:1024
    ds_write_b128 v22, a[96:99] offset:2048
    ds_write_b128 v22, a[112:115] offset:3072
    s_waitcnt lgkmcnt(0)
    ds_read_b64_tr_b16 a[64:65], v21 offset:0
    ds_read_b64_tr_b16 a[66:67], v21 offset:512
    ds_read_b64_tr_b16 a[80:81], v21 offset:32
    ds_read_b64_tr_b16 a[82:83], v21 offset:544
    ds_read_b64_tr_b16 a[96:97], v21 offset:64
    ds_read_b64_tr_b16 a[98:99], v21 offset:576
    ds_read_b64_tr_b16 a[112:113], v21 offset:96
    ds_read_b64_tr_b16 a[114:115], v21 offset:608
    s_waitcnt lgkmcnt(0)
    ds_write_b128 v22, a[68:71] offset:0
    ds_write_b128 v22, a[84:87] offset:1024
    ds_write_b128 v22, a[100:103] offset:2048
    ds_write_b128 v22, a[116:119] offset:3072
    s_waitcnt lgkmcnt(0)
    ds_read_b64_tr_b16 a[68:69], v21 offset:0
    ds_read_b64_tr_b16 a[70:71], v21 offset:512
    ds_read_b64_tr_b16 a[84:85], v21 offset:32
    ds_read_b64_tr_b16 a[86:87], v21 offset:544
    ds_read_b64_tr_b16 a[100:101], v21 offset:64
    ds_read_b64_tr_b16 a[102:103], v21 offset:576
    ds_read_b64_tr_b16 a[116:117], v21 offset:96
    ds_read_b64_tr_b16 a[118:119], v21 offset:608
    s_waitcnt lgkmcnt(0)
    ds_write_b128 v22, a[72:75] offset:0
    ds_write_b128 v22, a[88:91] offset:1024
    ds_write_b128 v22, a[104:107] offset:2048
    ds_write_b128 v22, a[120:123] offset:3072
    s_waitcnt lgkmcnt(0)
    ds_read_b64_tr_b16 a[72:73], v21 offset:0
    ds_read_b64_tr_b16 a[74:75], v21 offset:512
    ds_read_b64_tr_b16 a[88:89], v21 offset:32
    ds_read_b64_tr_b16 a[90:91], v21 offset:544
    ds_read_b64_tr_b16 a[104:105], v21 offset:64
    ds_read_b64_tr_b16 a[106:107], v21 offset:576
    ds_read_b64_tr_b16 a[120:121], v21 offset:96
    ds_read_b64_tr_b16 a[122:123], v21 offset:608
    s_waitcnt lgkmcnt(0)
    ds_write_b128 v22, a[76:79] offset:0
    ds_write_b128 v22, a[92:95] offset:1024
    ds_write_b128 v22, a[108:111] offset:2048
    ds_write_b128 v22, a[124:127] offset:3072
    s_waitcnt lgkmcnt(0)
    ds_read_b64_tr_b16 a[76:77], v21 offset:0
    ds_read_b64_tr_b16 a[78:79], v21 offset:512
    ds_read_b64_tr_b16 a[92:93], v21 offset:32
    ds_read_b64_tr_b16 a[94:95], v21 offset:544
    ds_read_b64_tr_b16 a[108:109], v21 offset:64
    ds_read_b64_tr_b16 a[110:111], v21 offset:576
    ds_read_b64_tr_b16 a[124:125], v21 offset:96
    ds_read_b64_tr_b16 a[126:127], v21 offset:608
    s_waitcnt lgkmcnt(0)
    s_mov_b32 s65, 0
    s_waitcnt vmcnt(0)
    s_barrier
    s_lshl_b32 s57, s40, 11
    s_lshl_b32 s53, s54, 7
    s_add_u32 s57, s57, s53
    s_add_u32 s57, s57, 0x10a600
    s_mov_b32 s69, 0
    s_mov_b32 s68, 0
    s_cmp_gt_u32 s69, s68
    s_cbranch_scc1 L_kv_ok_179
    s_mov_b32 s70, 0
L_kv_lp_178:
    v_and_b32 v22, 1, v1
    v_lshlrev_b32 v22, 9, v22
    buffer_load_dword v23, v22, s[12:15], s57 offen sc1
    s_waitcnt vmcnt(0)
    v_readlane_b32 s69, v23, 0
    v_readlane_b32 s45, v23, 1
    s_add_u32 s70, s70, 1
    s_nop 2
    s_min_u32 s69, s69, s45
    s_cmp_gt_u32 s69, s68
    s_cbranch_scc1 L_kv_ok_179
    s_sleep 4
    s_cmp_lt_u32 s70, 524288
    s_cbranch_scc1 L_kv_lp_178
    s_branch L_c_done_1
L_kv_ok_179:
    v_lshlrev_b32 v28, 9, v101
    v_lshl_add_u32 v28, v100, 4, v28
    s_lshl_b32 s52, s54, 13
    s_add_u32 s52, s52, 0x800000
    v_add_u32 v28, s52, v28
    s_lshl_b32 s59, s54, 12
    s_add_u32 s59, s59, 65536
    v_lshlrev_b32 v31, 4, v100
    v_lshl_add_u32 v31, v103, 8, v31
    v_add_u32 v31, 20480, v31
    s_lshl_b32 s52, s54, 11
    s_add_u32 s52, s52, 53248
    v_add_u32 v25, s52, v2
    v_mov_b32 v29, 26640
    v_mov_b32 v30, 0
    ds_write_b32 v29, v30
    v_mov_b32 v30, 1
    s_mov_b32 s58, 0
    s_mov_b32 s64, 0
    s_add_u32 s46, s65, 4096
    buffer_load_dwordx4 v[32:35], v15, s[12:15], s65 offen offset:0 sc1
    buffer_load_dwordx4 v[48:51], v15, s[12:15], s46 offen offset:0 sc1
    buffer_load_dwordx4 v[36:39], v15, s[12:15], s65 offen offset:1024 sc1
    buffer_load_dwordx4 v[52:55], v15, s[12:15], s46 offen offset:1024 sc1
    buffer_load_dwordx4 v[40:43], v15, s[12:15], s65 offen offset:2048 sc1
    buffer_load_dwordx4 v[56:59], v15, s[12:15], s46 offen offset:2048 sc1
    buffer_load_dwordx4 v[44:47], v15, s[12:15], s65 offen offset:3072 sc1
    buffer_load_dwordx4 v[60:63], v15, s[12:15], s46 offen offset:3072 sc1
    s_add_u32 s65, s65, 786432
    s_waitcnt vmcnt(0)
    v_mfma_f32_16x16x32_bf16 v[64:67], v[32:35], a[64:67], 0
    v_mfma_f32_16x16x32_bf16 v[68:71], v[48:51], a[64:67], 0
    v_mfma_f32_16x16x32_bf16 v[64:67], v[36:39], a[68:71], v[64:67]
    v_mfma_f32_16x16x32_bf16 v[68:71], v[52:55], a[68:71], v[68:71]
    v_mfma_f32_16x16x32_bf16 v[64:67], v[40:43], a[72:75], v[64:67]
    v_mfma_f32_16x16x32_bf16 v[68:71], v[56:59], a[72:75], v[68:71]
    v_mfma_f32_16x16x32_bf16 v[64:67], v[44:47], a[76:79], v[64:67]
    v_mfma_f32_16x16x32_bf16 v[68:71], v[60:63], a[76:79], v[68:71]
    v_mfma_f32_16x16x32_bf16 v[72:75], v[32:35], a[80:83], 0
    v_mfma_f32_16x16x32_bf16 v[76:79], v[48:51], a[80:83], 0
    v_mfma_f32_16x16x32_bf16 v[72:75], v[36:39], a[84:87], v[72:75]
    v_mfma_f32_16x16x32_bf16 v[76:79], v[52:55], a[84:87], v[76:79]
    v_mfma_f32_16x16x32_bf16 v[72:75], v[40:43], a[88:91], v[72:75]
    v_mfma_f32_16x16x32_bf16 v[76:79], v[56:59], a[88:91], v[76:79]
    v_mfma_f32_16x16x32_bf16 v[72:75], v[44:47], a[92:95], v[72:75]
    v_mfma_f32_16x16x32_bf16 v[76:79], v[60:63], a[92:95], v[76:79]
    v_cvt_pk_bf16_f32 v64, v64, v65
    v_cvt_pk_bf16_f32 v65, v66, v67
    v_cvt_pk_bf16_f32 v66, v68, v69
    v_cvt_pk_bf16_f32 v67, v70, v71
    ds_write_b128 v10, v[64:67] offset:32768
    v_mfma_f32_16x16x32_bf16 v[80:83], v[32:35], a[96:99], 0
    v_mfma_f32_16x16x32_bf16 v[84:87], v[48:51], a[96:99], 0
    v_mfma_f32_16x16x32_bf16 v[80:83], v[36:39], a[100:103], v[80:83]
    v_mfma_f32_16x16x32_bf16 v[84:87], v[52:55], a[100:103], v[84:87]
    v_mfma_f32_16x16x32_bf16 v[80:83], v[40:43], a[104:107], v[80:83]
    v_mfma_f32_16x16x32_bf16 v[84:87], v[56:59], a[104:107], v[84:87]
    v_mfma_f32_16x16x32_bf16 v[80:83], v[44:47], a[108:111], v[80:83]
    v_mfma_f32_16x16x32_bf16 v[84:87], v[60:63], a[108:111], v[84:87]
    v_cvt_pk_bf16_f32 v72, v72, v73
    v_cvt_pk_bf16_f32 v73, v74, v75
    v_cvt_pk_bf16_f32 v74, v76, v77
    v_cvt_pk_bf16_f32 v75, v78, v79
    ds_write_b128 v10, v[72:75] offset:33792
    v_mfma_f32_16x16x32_bf16 v[88:91], v[32:35], a[112:115], 0
    v_mfma_f32_16x16x32_bf16 v[92:95], v[48:51], a[112:115], 0
    v_mfma_f32_16x16x32_bf16 v[88:91], v[36:39], a[116:119], v[88:91]
    v_mfma_f32_16x16x32_bf16 v[92:95], v[52:55], a[116:119], v[92:95]
    v_mfma_f32_16x16x32_bf16 v[88:91], v[40:43], a[120:123], v[88:91]
    v_mfma_f32_16x16x32_bf16 v[92:95], v[56:59], a[120:123], v[92:95]
    v_mfma_f32_16x16x32_bf16 v[88:91], v[44:47], a[124:127], v[88:91]
    v_mfma_f32_16x16x32_bf16 v[92:95], v[60:63], a[124:127], v[92:95]
    v_cvt_pk_bf16_f32 v80, v80, v81
    v_cvt_pk_bf16_f32 v81, v82, v83
    v_cvt_pk_bf16_f32 v82, v84, v85
    v_cvt_pk_bf16_f32 v83, v86, v87
    ds_write_b128 v10, v[80:83] offset:34816
    s_nop 2
    v_cvt_pk_bf16_f32 v88, v88, v89
    v_cvt_pk_bf16_f32 v89, v90, v91
    v_cvt_pk_bf16_f32 v90, v92, v93
    v_cvt_pk_bf16_f32 v91, v94, v95
    ds_write_b128 v10, v[88:91] offset:35840
    s_mov_b64 s[66:67], 0
    s_mov_b32 s63, 0
    s_mov_b32 s68, 1
    s_cmp_gt_u32 s69, s68
    s_cbranch_scc1 L_kv_ok_181
    s_mov_b32 s70, 0
L_kv_lp_180:
    v_and_b32 v22, 1, v1
    v_lshlrev_b32 v22, 9, v22
    buffer_load_dword v23, v22, s[12:15], s57 offen sc1
    s_waitcnt vmcnt(0)
    v_readlane_b32 s69, v23, 0
    v_readlane_b32 s45, v23, 1
    s_add_u32 s70, s70, 1
    s_nop 2
    s_min_u32 s69, s69, s45
    s_cmp_gt_u32 s69, s68
    s_cbranch_scc1 L_kv_ok_181
    s_sleep 4
    s_cmp_lt_u32 s70, 524288
    s_cbranch_scc1 L_kv_lp_180
    s_branch L_c_done_1
L_kv_ok_181:
    s_waitcnt lgkmcnt(0)
    v_min_u32 v64, -2, v112
    v_min_u32 v65, -2, v113
    v_min_u32 v66, -2, v114
    v_min_u32 v67, -2, v115
    v_min_u32 v68, -2, v116
    v_min_u32 v69, -2, v117
    v_min_u32 v70, -2, v118
    v_min_u32 v71, -2, v119
    v_min_u32 v72, -2, v120
    v_min_u32 v73, -2, v121
    v_min_u32 v74, -2, v122
    v_min_u32 v75, -2, v123
    v_min_u32 v76, -2, v124
    v_min_u32 v77, -2, v125
    v_min_u32 v78, -2, v126
    v_min_u32 v79, -2, v127
    v_mov_b32 v16, 0
    v_mov_b32 v17, 0
    v_mov_b32 v18, 0
    v_mov_b32 v19, 0
    v_mov_b32 v20, 0
    v_mov_b32 v21, 0
    v_mov_b32 v22, 0
    v_mov_b32 v23, 0
L_c_join_174:
    s_mov_b32 s60, 0
    s_mov_b32 s61, 0
    s_mov_b32 s62, 0
    s_cmp_lg_u32 s44, 0
    s_cbranch_scc1 L_c_nh_182
    v_lshlrev_b32 v17, 3, v1
    s_lshl_b32 s46, s40, 3
    v_mov_b32 v21, s46
    s_mov_b32 s45, 0x101000
    s_mov_b32 s70, 0
L_c_rp_183:
    buffer_load_dwordx2 v[18:19], v17, s[12:15], s45 offen sc1
    buffer_load_dwordx2 v[22:23], v21, s[12:15], s45 offen offset:512 sc1
    s_waitcnt vmcnt(0)
    v_min3_u32 v20, v18, v19, v22
    v_min_u32 v20, v20, v23
    v_cmp_eq_u32 vcc, 0, v20
    s_cbranch_vccnz L_rt_184
    v_cmp_eq_u32 s[52:53], v18, v16
    v_cmp_eq_u32 vcc, v19, v16
    v_cmp_eq_u32 s[54:55], v22, v16
    v_cmp_eq_u32 s[56:57], v23, v16
    s_lshl_b32 s46, s40, 3
    s_nop 3
    s_and_b64 s[52:53], s[52:53], vcc
    s_lshr_b64 s[52:53], s[52:53], s46
    s_and_b32 s52, s52, 0xff
    s_cmp_eq_u32 s52, 0xff
    s_cselect_b32 s52, 1, 0
    v_mov_b32 v16, s52
    v_mov_b32 v17, 26624
    ds_write_b32 v17, v16
L_c_nh_182:
    s_waitcnt lgkmcnt(0)
    s_barrier
    v_mov_b32 v17, 26624
    ds_read_b32 v16, v17
    s_waitcnt lgkmcnt(0)
    v_readfirstlane_b32 s52, v16
    s_nop 3
    s_cmp_ge_u32 s44, 4
    s_cbranch_scc1 L_vf_187
    s_mov_b32 s57, s58
    s_mov_b32 s58, 0
    s_cmp_ge_u32 s44, 2
    s_cbranch_scc1 L_sf_185
    buffer_load_dwordx4 v[32:35], v6, s[12:15], 0 offen sc1
L_sf_185:
    s_cmp_eq_u32 s52, 0
    s_cbranch_scc1 L_ss_186
.p2align 6
L_s_loop_189:
    v_mov_b32 v16, 0
    v_mov_b32 v17, 0
    v_mov_b32 v18, 0
    v_mov_b32 v19, 0
    s_add_u32 s58, s58, 4
    s_mov_b32 s70, 1
    s_waitcnt vmcnt(0)
    s_barrier
    ds_read_b128 v[64:67], v2 offset:0
    ds_read_b128 v[68:71], v2 offset:1024
    ds_read_b128 v[72:75], v2 offset:2048
    ds_read_b128 v[76:79], v2 offset:3072
    ds_read_b128 v[80:83], v2 offset:4096
    ds_read_b128 v[84:87], v2 offset:5120
    ds_read_b128 v[88:91], v2 offset:6144
    ds_read_b128 v[92:95], v2 offset:7168
    ds_read_b128 v[96:99], v2 offset:8192
    ds_read_b128 v[100:103], v2 offset:9216
    ds_read_b128 v[104:107], v2 offset:10240
    ds_read_b128 v[108:111], v2 offset:11264
    s_waitcnt lgkmcnt(11)
    v_smfmac_f32_16x16x64_bf16 v[16:19], v[64:67], a[0:7], v3
    ds_read_b128 v[112:115], v2 offset:12288
    s_waitcnt lgkmcnt(11)
    v_smfmac_f32_16x16x64_bf16 v[16:19], v[68:71], a[8:15], v3
    ds_read_b128 v[116:119], v2 offset:13312
    s_waitcnt lgkmcnt(11)
    v_smfmac_f32_16x16x64_bf16 v[16:19], v[72:75], a[16:23], v3
    ds_read_b128 v[120:123], v2 offset:14336
    s_waitcnt lgkmcnt(11)
    v_smfmac_f32_16x16x64_bf16 v[16:19], v[76:79], a[24:31], v3
    ds_read_b128 v[124:127], v2 offset:15360
    s_waitcnt lgkmcnt(11)
    v_smfmac_f32_16x16x64_bf16 v[16:19], v[80:83], a[32:39], v3
    s_waitcnt lgkmcnt(10)
    v_smfmac_f32_16x16x64_bf16 v[16:19], v[84:87], a[40:47], v3
    s_waitcnt lgkmcnt(9)
    v_smfmac_f32_16x16x64_bf16 v[16:19], v[88:91], a[48:55], v3
    s_waitcnt lgkmcnt(8)
    v_smfmac_f32_16x16x64_bf16 v[16:19], v[92:95], a[56:63], v3
    s_waitcnt lgkmcnt(7)
    v_smfmac_f32_16x16x64_bf16 v[16:19], v[96:99], a[64:71], v3
    s_waitcnt lgkmcnt(6)
    v_smfmac_f32_16x16x64_bf16 v[16:19], v[100:103], a[72:79], v3
    s_waitcnt lgkmcnt(5)
    v_smfmac_f32_16x16x64_bf16 v[16:19], v[104:107], a[80:87], v3
    s_waitcnt lgkmcnt(4)
    v_smfmac_f32_16x16x64_bf16 v[16:19], v[108:111], a[88:95], v3
    s_waitcnt lgkmcnt(3)
    v_smfmac_f32_16x16x64_bf16 v[16:19], v[112:115], a[96:103], v3
    s_waitcnt lgkmcnt(2)
    v_smfmac_f32_16x16x64_bf16 v[16:19], v[116:119], a[104:111], v3
    s_waitcnt lgkmcnt(1)
    v_smfmac_f32_16x16x64_bf16 v[16:19], v[120:123], a[112:119], v3
    s_waitcnt lgkmcnt(0)
    v_smfmac_f32_16x16x64_bf16 v[16:19], v[124:127], a[120:127], v3
    s_nop 7
    v_permlane32_swap_b32 v16, v18
    v_permlane32_swap_b32 v17, v19
    v_add_f32 v16, v16, v18
    v_add_f32 v17, v17, v19
    v_cvt_pk_bf16_f32 v16, v16, v17
    ds_write_b16 v5, v16
    ds_write_b16_d16_hi v5, v16 offset:16
    s_mov_b64 exec, 1
    ds_add_u32 v29, v30
    s_mov_b64 exec, -1
L_s_xl_191:
    ds_read_b32 v10, v29
    ds_read_b128 v[64:67], v2 offset:61440
    s_cmp_eq_u32 s60, 63
    s_cbranch_scc1 L_s_last_190
    s_cmp_ge_u32 s44, 2
    s_cbranch_scc1 L_s_w2_192
    s_waitcnt lgkmcnt(0)
    v_mfma_f32_16x16x32_bf16 v[16:19], v[32:35], v[64:67], 0
L_s_w2_192_b:
    v_cmp_ne_u32 vcc, s58, v10
    s_nop 0
    s_cbranch_vccnz L_rt_194
    s_mov_b64 exec, s[50:51]
    s_nop 3
    v_min_u32 v16, -2, v16
    v_min_u32 v17, -2, v17
    v_min_u32 v18, -2, v18
    v_min_u32 v19, -2, v19
    buffer_store_dwordx4 v[16:19], v4, s[12:15], s61 offen
    s_mov_b64 exec, -1
L_s_w3_193_b:
    s_sleep 5
    s_mov_b32 s70, 1
L_s_xp_195:
    buffer_load_dwordx4 v[64:67], v7, s[12:15], s61 offen offset:0 sc1
    buffer_load_dword v80, v28, s[12:15], s61 offen offset:0 sc1
    buffer_load_dwordx4 v[68:71], v7, s[12:15], s61 offen offset:1024 sc1
    buffer_load_dword v81, v28, s[12:15], s61 offen offset:256 sc1
    buffer_load_dwordx4 v[72:75], v7, s[12:15], s61 offen offset:2048 sc1
    buffer_load_dword v82, v28, s[12:15], s61 offen offset:512 sc1
    buffer_load_dwordx4 v[76:79], v7, s[12:15], s61 offen offset:3072 sc1
    buffer_load_dword v83, v28, s[12:15], s61 offen offset:768 sc1
    s_waitcnt vmcnt(4)
    v_add_f32 v16, v64, v68
    v_add_f32 v17, v65, v69
    v_add_f32 v18, v66, v70
    v_add_f32 v19, v67, v71
    v_add_f32 v20, v80, v81
    s_waitcnt vmcnt(2)
    v_add_f32 v16, v16, v72
    v_add_f32 v17, v17, v73
    v_add_f32 v18, v18, v74
    v_add_f32 v19, v19, v75
    v_add_f32 v20, v20, v82
    s_waitcnt vmcnt(0)
    v_add_f32 v16, v16, v76
    v_add_f32 v17, v17, v77
    v_add_f32 v18, v18, v78
    v_add_f32 v19, v19, v79
    v_add_f32 v20, v20, v83
    v_cmp_u_f32 s[46:47], v16, v17
    v_cmp_u_f32 s[48:49], v18, v19
    v_cmp_u_f32 vcc, v20, v20
    v_max3_f32 v10, v16, v17, v18
    s_or_b64 s[46:47], s[46:47], s[48:49]
    v_max3_f32 v10, v10, v19, v20
    s_or_b64 vcc, vcc, s[46:47]
    s_cbranch_scc1 L_s_xf_196
L_s_xok_197:
    v_max_f32_dpp v11, v10, v10 row_ror:8 row_mask:0xf bank_mask:0xf
    v_max_f32_dpp v10, v10, v10 row_ror:8 row_mask:0xf bank_mask:0xf
    s_nop 1
    v_permlane16_swap_b32 v10, v11
    v_max_f32 v12, v10, v11
    v_max_f32 v10, v10, v11
    s_nop 1
    v_permlane32_swap_b32 v10, v12
    v_max_f32 v10, v10, v12
    v_mul_f32 v10, s66, v10
    v_fma_f32 v16, v16, s66, -v10
    v_fma_f32 v17, v17, s66, -v10
    v_fma_f32 v18, v18, s66, -v10
    v_fma_f32 v19, v19, s66, -v10
    v_fma_f32 v20, v20, s66, -v10
    v_exp_f32 v16, v16
    v_exp_f32 v17, v17
    v_exp_f32 v18, v18
    v_exp_f32 v19, v19
    v_exp_f32 v20, v20
    v_add_f32 v10, v16, v17
    v_add_f32 v11, v18, v19
    v_add_f32 v10, v10, v20
    v_add_f32 v10, v10, v11
    s_nop 1
    v_add_f32_dpp v11, v10, v10 row_ror:8 row_mask:0xf bank_mask:0xf
    v_add_f32_dpp v10, v10, v10 row_ror:8 row_mask:0xf bank_mask:0xf
    s_nop 1
    v_permlane16_swap_b32 v10, v11
    v_add_f32 v12, v10, v11
    v_add_f32 v10, v10, v11
    s_nop 1
    v_permlane32_swap_b32 v10, v12
    v_add_f32 v10, v10, v12
    v_rcp_f32 v10, v10
    s_nop 0
    v_mul_f32 v16, v16, v10
    v_mul_f32 v17, v17, v10
    v_mul_f32 v18, v18, v10
    v_mul_f32 v19, v19, v10
    v_mul_f32 v20, v20, v10
    v_cvt_pk_bf16_f32 v16, v16, v17
    v_cvt_pk_bf16_f32 v17, v18, v19
    v_cvt_pk_bf16_f32 v18, v20, v20
    ds_write_b64 v8, v[16:17]
    ds_write_b16 v9, v18
    s_add_u32 s63, s63, 786432
    s_cmp_ge_u32 s44, 2
    s_cbranch_scc1 L_s_nk_198
    buffer_load_dwordx4 v[32:35], v6, s[12:15], s63 offen sc1
L_s_nk_198:
    s_add_u32 s45, s63, 786432
    s_mov_b64 exec, 0xf
    buffer_load_dword v15, v14, s[12:15], s45 offen sc1
    s_mov_b64 exec, -1
    s_waitcnt lgkmcnt(0)
    s_barrier
    s_cmp_eq_u32 s44, 3
    s_cbranch_scc1 L_s_nr_199
    s_xor_b32 s45, s61, 0x8000
    s_mov_b64 exec, s[50:51]
    buffer_store_dwordx4 v[24:27], v4, s[12:15], s45 offen
    s_mov_b64 exec, -1
L_s_nr_199:
    s_cmp_lg_u32 s44, 3
    s_cbranch_scc1 L_s_np_200
    ds_read_b128 v[20:23], v6
    s_lshl_b32 s45, s60, 17
    s_add_u32 s45, s45, s67
    s_waitcnt lgkmcnt(0)
    v_min_u32 v20, -2, v20
    v_min_u32 v21, -2, v21
    v_min_u32 v22, -2, v22
    v_min_u32 v23, -2, v23
    buffer_store_dwordx4 v[20:23], v2, s[12:15], s45 offen sc1
L_s_np_200:
    s_add_u32 s68, s60, 3
    s_min_u32 s68, s68, 63
    v_readlane_b32 s45, v0, 0
    v_readlane_b32 s46, v0, 1
    s_nop 0
    s_min_u32 s45, s45, s46
    s_max_u32 s69, s69, s45
    s_cmp_gt_u32 s69, s68
    s_cbranch_scc1 L_kv_ok_203
    s_mov_b32 s70, 0
L_kv_lp_202:
    v_and_b32 v22, 1, v1
    v_lshlrev_b32 v22, 9, v22
    buffer_load_dword v23, v22, s[12:15], s57 offen sc1
    s_waitcnt vmcnt(0)
    v_readlane_b32 s69, v23, 0
    v_readlane_b32 s45, v23, 1
    s_add_u32 s70, s70, 1
    s_nop 2
    s_min_u32 s69, s69, s45
    s_cmp_gt_u32 s69, s68
    s_cbranch_scc1 L_kv_ok_203
    s_sleep 4
    s_cmp_lt_u32 s70, 524288
    s_cbranch_scc1 L_kv_lp_202
    s_branch L_c_done_1
L_kv_ok_203:
    s_add_u32 s45, s60, 7
    s_min_u32 s45, s45, 63
    s_cmp_gt_u32 s69, s45
    s_cbranch_scc1 L_s_na_201
    v_and_b32 v22, 1, v1
    v_lshlrev_b32 v22, 9, v22
    buffer_load_dword v0, v22, s[12:15], s57 offen sc1
L_s_na_201:
    s_cmp_lt_u32 s60, s59
    s_cbranch_scc1 L_s_pr_204
L_s_pr_204_b:
    s_add_u32 s60, s60, 1
    s_add_u32 s61, s61, 0x4000
    s_and_b32 s61, s61, 0xffff
    s_branch L_s_loop_189
L_s_last_190:
    s_waitcnt lgkmcnt(0)
    s_barrier
    s_cmp_lg_u32 s44, 3
    s_cbranch_scc1 L_s_np_205
    ds_read_b128 v[20:23], v6
    s_lshl_b32 s45, s60, 17
    s_add_u32 s45, s45, s67
    s_waitcnt lgkmcnt(0)
    v_min_u32 v20, -2, v20
    v_min_u32 v21, -2, v21
    v_min_u32 v22, -2, v22
    v_min_u32 v23, -2, v23
    buffer_store_dwordx4 v[20:23], v2, s[12:15], s45 offen sc1
L_s_np_205:
    s_branch L_replica
L_rt_184:
    s_add_u32 s70, s70, 1
    s_cmp_lt_u32 s70, 524288
    s_cbranch_scc1 L_c_rp_183
    s_branch L_c_done_1
L_rt_194:
    s_add_u32 s70, s70, 1
    s_cmp_lt_u32 s70, 524288
    s_cbranch_scc1 L_s_xl_191
    s_branch L_c_done_1
L_s_w2_192:
    s_cmp_eq_u32 s44, 3
    s_cbranch_scc1 L_s_w3_193
    s_waitcnt lgkmcnt(0)
    v_mfma_f32_16x16x32_bf16 v[16:19], v[64:67], v[64:67], 0
    s_branch L_s_w2_192_b
L_s_w3_193:
    s_sleep 3
    s_branch L_s_w3_193_b
L_s_xf_196:
    v_max3_u32 v11, v64, v65, v66
    v_max3_u32 v11, v11, v67, v68
    v_max3_u32 v11, v11, v69, v70
    v_max3_u32 v11, v11, v71, v72
    v_max3_u32 v11, v11, v73, v74
    v_max3_u32 v11, v11, v75, v76
    v_max3_u32 v11, v11, v77, v78
    v_max3_u32 v11, v11, v79, v80
    v_max3_u32 v11, v11, v81, v82
    v_max_u32 v11, v11, v83
    v_cmp_eq_u32 vcc, -1, v11
    s_add_u32 s70, s70, 1
    s_cbranch_vccz L_s_xok_197
    s_cmp_lt_u32 s70, 524288
    s_cbranch_scc1 L_s_xp_195
    s_branch L_c_done_1
L_s_pr_204:
    s_lshl_b32 s45, s40, 21
    s_lshl_b32 s46, s60, 14
    s_add_u32 s45, s45, s46
    s_add_u32 s45, s45, 0x79c0000
    v_and_b32 v10, 15, v1
    v_lshlrev_b32 v10, 4, v10
    v_bfe_u32 v11, v1, 4, 1
    v_lshl_add_u32 v10, v11, 13, v10
    buffer_store_dwordx4 v[24:27], v10, s[12:15], s45 offen sc1
    s_add_u32 s46, s45, 0x1000
    s_load_dword s47, s[22:23], s46
    s_add_u32 s46, s45, 0x2000
    s_add_u32 s48, s45, 0x2080
    s_add_u32 s49, s45, 0x80
    s_waitcnt vmcnt(0) lgkmcnt(0)
    s_memtime s[72:73]
    s_waitcnt lgkmcnt(0)
    s_load_dword s47, s[22:23], s45
    s_waitcnt lgkmcnt(0)
    s_memtime s[74:75]
    s_waitcnt lgkmcnt(0)
    s_load_dword s47, s[22:23], s46
    s_waitcnt lgkmcnt(0)
    s_memtime s[76:77]
    s_waitcnt lgkmcnt(0)
    s_sub_u32 s76, s76, s74
    s_sub_u32 s74, s74, s72
    s_cmp_gt_u32 s74, s76
    s_addc_u32 s64, s64, 0
    s_cmp_lg_u32 s60, 2
    s_cbranch_scc1 L_s_pr_204_b
    s_cmp_ge_u32 s64, 2
    s_cselect_b32 s45, 3, 2
    v_mov_b32 v10, s45
    v_mov_b32 v11, 0
    s_lshl_b32 s45, s40, 7
    s_add_u32 s45, s45, 0x101800
    s_mov_b64 exec, 1
    buffer_store_dword v10, v11, s[12:15], s45 offen sc1
    s_mov_b64 exec, -1
    s_branch L_s_pr_204_b
L_ss_186:
.p2align 6
L_s_loop_206:
    v_mov_b32 v16, 0
    v_mov_b32 v17, 0
    v_mov_b32 v18, 0
    v_mov_b32 v19, 0
    s_add_u32 s58, s58, 4
    s_mov_b32 s70, 1
    s_waitcnt vmcnt(0)
    s_barrier
    ds_read_b128 v[64:67], v2 offset:0
    ds_read_b128 v[68:71], v2 offset:1024
    ds_read_b128 v[72:75], v2 offset:2048
    ds_read_b128 v[76:79], v2 offset:3072
    ds_read_b128 v[80:83], v2 offset:4096
    ds_read_b128 v[84:87], v2 offset:5120
    ds_read_b128 v[88:91], v2 offset:6144
    ds_read_b128 v[92:95], v2 offset:7168
    ds_read_b128 v[96:99], v2 offset:8192
    ds_read_b128 v[100:103], v2 offset:9216
    ds_read_b128 v[104:107], v2 offset:10240
    ds_read_b128 v[108:111], v2 offset:11264
    s_waitcnt lgkmcnt(11)
    v_smfmac_f32_16x16x64_bf16 v[16:19], v[64:67], a[0:7], v3
    ds_read_b128 v[112:115], v2 offset:12288
    s_waitcnt lgkmcnt(11)
    v_smfmac_f32_16x16x64_bf16 v[16:19], v[68:71], a[8:15], v3
    ds_read_b128 v[116:119], v2 offset:13312
    s_waitcnt lgkmcnt(11)
    v_smfmac_f32_16x16x64_bf16 v[16:19], v[72:75], a[16:23], v3
    ds_read_b128 v[120:123], v2 offset:14336
    s_waitcnt lgkmcnt(11)
    v_smfmac_f32_16x16x64_bf16 v[16:19], v[76:79], a[24:31], v3
    ds_read_b128 v[124:127], v2 offset:15360
    s_waitcnt lgkmcnt(11)
    v_smfmac_f32_16x16x64_bf16 v[16:19], v[80:83], a[32:39], v3
    s_waitcnt lgkmcnt(10)
    v_smfmac_f32_16x16x64_bf16 v[16:19], v[84:87], a[40:47], v3
    s_waitcnt lgkmcnt(9)
    v_smfmac_f32_16x16x64_bf16 v[16:19], v[88:91], a[48:55], v3
    s_waitcnt lgkmcnt(8)
    v_smfmac_f32_16x16x64_bf16 v[16:19], v[92:95], a[56:63], v3
    s_waitcnt lgkmcnt(7)
    v_smfmac_f32_16x16x64_bf16 v[16:19], v[96:99], a[64:71], v3
    s_waitcnt lgkmcnt(6)
    v_smfmac_f32_16x16x64_bf16 v[16:19], v[100:103], a[72:79], v3
    s_waitcnt lgkmcnt(5)
    v_smfmac_f32_16x16x64_bf16 v[16:19], v[104:107], a[80:87], v3
    s_waitcnt lgkmcnt(4)
    v_smfmac_f32_16x16x64_bf16 v[16:19], v[108:111], a[88:95], v3
    s_waitcnt lgkmcnt(3)
    v_smfmac_f32_16x16x64_bf16 v[16:19], v[112:115], a[96:103], v3
    s_waitcnt lgkmcnt(2)
    v_smfmac_f32_16x16x64_bf16 v[16:19], v[116:119], a[104:111], v3
    s_waitcnt lgkmcnt(1)
    v_smfmac_f32_16x16x64_bf16 v[16:19], v[120:123], a[112:119], v3
    s_waitcnt lgkmcnt(0)
    v_smfmac_f32_16x16x64_bf16 v[16:19], v[124:127], a[120:127], v3
    s_nop 7
    v_permlane32_swap_b32 v16, v18
    v_permlane32_swap_b32 v17, v19
    v_add_f32 v16, v16, v18
    v_add_f32 v17, v17, v19
    v_cvt_pk_bf16_f32 v16, v16, v17
    ds_write_b16 v5, v16
    ds_write_b16_d16_hi v5, v16 offset:16
    s_mov_b64 exec, 1
    ds_add_u32 v29, v30
    s_mov_b64 exec, -1
L_s_xl_208:
    ds_read_b32 v10, v29
    ds_read_b128 v[64:67], v2 offset:61440
    s_cmp_eq_u32 s60, 63
    s_cbranch_scc1 L_s_last_207
    s_cmp_ge_u32 s44, 2
    s_cbranch_scc1 L_s_w2_209
    s_waitcnt lgkmcnt(0)
    v_mfma_f32_16x16x32_bf16 v[16:19], v[32:35], v[64:67], 0
L_s_w2_209_b:
    v_cmp_ne_u32 vcc, s58, v10
    s_nop 0
    s_cbranch_vccnz L_rt_211
    s_mov_b64 exec, s[50:51]
    s_nop 3
    v_min_u32 v16, -2, v16
    v_min_u32 v17, -2, v17
    v_min_u32 v18, -2, v18
    v_min_u32 v19, -2, v19
    buffer_store_dwordx4 v[16:19], v4, s[12:15], s61 offen sc1
    s_mov_b64 exec, -1
L_s_w3_210_b:
    s_sleep 5
    s_mov_b32 s70, 1
L_s_xp_212:
    buffer_load_dwordx4 v[64:67], v7, s[12:15], s61 offen offset:0 sc1
    buffer_load_dword v80, v28, s[12:15], s61 offen offset:0 sc1
    buffer_load_dwordx4 v[68:71], v7, s[12:15], s61 offen offset:1024 sc1
    buffer_load_dword v81, v28, s[12:15], s61 offen offset:256 sc1
    buffer_load_dwordx4 v[72:75], v7, s[12:15], s61 offen offset:2048 sc1
    buffer_load_dword v82, v28, s[12:15], s61 offen offset:512 sc1
    buffer_load_dwordx4 v[76:79], v7, s[12:15], s61 offen offset:3072 sc1
    buffer_load_dword v83, v28, s[12:15], s61 offen offset:768 sc1
    s_waitcnt vmcnt(4)
    v_add_f32 v16, v64, v68
    v_add_f32 v17, v65, v69
    v_add_f32 v18, v66, v70
    v_add_f32 v19, v67, v71
    v_add_f32 v20, v80, v81
    s_waitcnt vmcnt(2)
    v_add_f32 v16, v16, v72
    v_add_f32 v17, v17, v73
    v_add_f32 v18, v18, v74
    v_add_f32 v19, v19, v75
    v_add_f32 v20, v20, v82
    s_waitcnt vmcnt(0)
    v_add_f32 v16, v16, v76
    v_add_f32 v17, v17, v77
    v_add_f32 v18, v18, v78
    v_add_f32 v19, v19, v79
    v_add_f32 v20, v20, v83
    v_cmp_u_f32 s[46:47], v16, v17
    v_cmp_u_f32 s[48:49], v18, v19
    v_cmp_u_f32 vcc, v20, v20
    v_max3_f32 v10, v16, v17, v18
    s_or_b64 s[46:47], s[46:47], s[48:49]
    v_max3_f32 v10, v10, v19, v20
    s_or_b64 vcc, vcc, s[46:47]
    s_cbranch_scc1 L_s_xf_213
L_s_xok_214:
    v_max_f32_dpp v11, v10, v10 row_ror:8 row_mask:0xf bank_mask:0xf
    v_max_f32_dpp v10, v10, v10 row_ror:8 row_mask:0xf bank_mask:0xf
    s_nop 1
    v_permlane16_swap_b32 v10, v11
    v_max_f32 v12, v10, v11
    v_max_f32 v10, v10, v11
    s_nop 1
    v_permlane32_swap_b32 v10, v12
    v_max_f32 v10, v10, v12
    v_mul_f32 v10, s66, v10
    v_fma_f32 v16, v16, s66, -v10
    v_fma_f32 v17, v17, s66, -v10
    v_fma_f32 v18, v18, s66, -v10
    v_fma_f32 v19, v19, s66, -v10
    v_fma_f32 v20, v20, s66, -v10
    v_exp_f32 v16, v16
    v_exp_f32 v17, v17
    v_exp_f32 v18, v18
    v_exp_f32 v19, v19
    v_exp_f32 v20, v20
    v_add_f32 v10, v16, v17
    v_add_f32 v11, v18, v19
    v_add_f32 v10, v10, v20
    v_add_f32 v10, v10, v11
    s_nop 1
    v_add_f32_dpp v11, v10, v10 row_ror:8 row_mask:0xf bank_mask:0xf
    v_add_f32_dpp v10, v10, v10 row_ror:8 row_mask:0xf bank_mask:0xf
    s_nop 1
    v_permlane16_swap_b32 v10, v11
    v_add_f32 v12, v10, v11
    v_add_f32 v10, v10, v11
    s_nop 1
    v_permlane32_swap_b32 v10, v12
    v_add_f32 v10, v10, v12
    v_rcp_f32 v10, v10
    s_nop 0
    v_mul_f32 v16, v16, v10
    v_mul_f32 v17, v17, v10
    v_mul_f32 v18, v18, v10
    v_mul_f32 v19, v19, v10
    v_mul_f32 v20, v20, v10
    v_cvt_pk_bf16_f32 v16, v16, v17
    v_cvt_pk_bf16_f32 v17, v18, v19
    v_cvt_pk_bf16_f32 v18, v20, v20
    ds_write_b64 v8, v[16:17]
    ds_write_b16 v9, v18
    s_add_u32 s63, s63, 786432
    s_cmp_ge_u32 s44, 2
    s_cbranch_scc1 L_s_nk_215
    buffer_load_dwordx4 v[32:35], v6, s[12:15], s63 offen sc1
L_s_nk_215:
    s_add_u32 s45, s63, 786432
    s_mov_b64 exec, 0xf
    buffer_load_dword v15, v14, s[12:15], s45 offen sc1
    s_mov_b64 exec, -1
    s_waitcnt lgkmcnt(0)
    s_barrier
    s_cmp_eq_u32 s44, 3
    s_cbranch_scc1 L_s_nr_216
    s_xor_b32 s45, s61, 0x8000
    s_mov_b64 exec, s[50:51]
    buffer_store_dwordx4 v[24:27], v4, s[12:15], s45 offen sc1
    s_mov_b64 exec, -1
L_s_nr_216:
    s_cmp_lg_u32 s44, 3
    s_cbranch_scc1 L_s_np_217
    ds_read_b128 v[20:23], v6
    s_lshl_b32 s45, s60, 17
    s_add_u32 s45, s45, s67
    s_waitcnt lgkmcnt(0)
    v_min_u32 v20, -2, v20
    v_min_u32 v21, -2, v21
    v_min_u32 v22, -2, v22
    v_min_u32 v23, -2, v23
    buffer_store_dwordx4 v[20:23], v2, s[12:15], s45 offen sc1
L_s_np_217:
    s_add_u32 s68, s60, 3
    s_min_u32 s68, s68, 63
    v_readlane_b32 s45, v0, 0
    v_readlane_b32 s46, v0, 1
    s_nop 0
    s_min_u32 s45, s45, s46
    s_max_u32 s69, s69, s45
    s_cmp_gt_u32 s69, s68
    s_cbranch_scc1 L_kv_ok_220
    s_mov_b32 s70, 0
L_kv_lp_219:
    v_and_b32 v22, 1, v1
    v_lshlrev_b32 v22, 9, v22
    buffer_load_dword v23, v22, s[12:15], s57 offen sc1
    s_waitcnt vmcnt(0)
    v_readlane_b32 s69, v23, 0
    v_readlane_b32 s45, v23, 1
    s_add_u32 s70, s70, 1
    s_nop 2
    s_min_u32 s69, s69, s45
    s_cmp_gt_u32 s69, s68
    s_cbranch_scc1 L_kv_ok_220
    s_sleep 4
    s_cmp_lt_u32 s70, 524288
    s_cbranch_scc1 L_kv_lp_219
    s_branch L_c_done_1
L_kv_ok_220:
    s_add_u32 s45, s60, 7
    s_min_u32 s45, s45, 63
    s_cmp_gt_u32 s69, s45
    s_cbranch_scc1 L_s_na_218
    v_and_b32 v22, 1, v1
    v_lshlrev_b32 v22, 9, v22
    buffer_load_dword v0, v22, s[12:15], s57 offen sc1
L_s_na_218:
    s_cmp_lt_u32 s60, s59
    s_cbranch_scc1 L_s_pr_221
L_s_pr_221_b:
    s_add_u32 s60, s60, 1
    s_add_u32 s61, s61, 0x4000
    s_and_b32 s61, s61, 0xffff
    s_branch L_s_loop_206
L_s_last_207:
    s_waitcnt lgkmcnt(0)
    s_barrier
    s_cmp_lg_u32 s44, 3
    s_cbranch_scc1 L_s_np_222
    ds_read_b128 v[20:23], v6
    s_lshl_b32 s45, s60, 17
    s_add_u32 s45, s45, s67
    s_waitcnt lgkmcnt(0)
    v_min_u32 v20, -2, v20
    v_min_u32 v21, -2, v21
    v_min_u32 v22, -2, v22
    v_min_u32 v23, -2, v23
    buffer_store_dwordx4 v[20:23], v2, s[12:15], s45 offen sc1
L_s_np_222:
    s_branch L_replica
L_rt_211:
    s_add_u32 s70, s70, 1
    s_cmp_lt_u32 s70, 524288
    s_cbranch_scc1 L_s_xl_208
    s_branch L_c_done_1
L_s_w2_209:
    s_cmp_eq_u32 s44, 3
    s_cbranch_scc1 L_s_w3_210
    s_waitcnt lgkmcnt(0)
    v_mfma_f32_16x16x32_bf16 v[16:19], v[64:67], v[64:67], 0
    s_branch L_s_w2_209_b
L_s_w3_210:
    s_sleep 3
    s_branch L_s_w3_210_b
L_s_xf_213:
    v_max3_u32 v11, v64, v65, v66
    v_max3_u32 v11, v11, v67, v68
    v_max3_u32 v11, v11, v69, v70
    v_max3_u32 v11, v11, v71, v72
    v_max3_u32 v11, v11, v73, v74
    v_max3_u32 v11, v11, v75, v76
    v_max3_u32 v11, v11, v77, v78
    v_max3_u32 v11, v11, v79, v80
    v_max3_u32 v11, v11, v81, v82
    v_max_u32 v11, v11, v83
    v_cmp_eq_u32 vcc, -1, v11
    s_add_u32 s70, s70, 1
    s_cbranch_vccz L_s_xok_214
    s_cmp_lt_u32 s70, 524288
    s_cbranch_scc1 L_s_xp_212
    s_branch L_c_done_1
L_s_pr_221:
    s_lshl_b32 s45, s40, 21
    s_lshl_b32 s46, s60, 14
    s_add_u32 s45, s45, s46
    s_add_u32 s45, s45, 0x79c0000
    v_and_b32 v10, 15, v1
    v_lshlrev_b32 v10, 4, v10
    v_bfe_u32 v11, v1, 4, 1
    v_lshl_add_u32 v10, v11, 13, v10
    buffer_store_dwordx4 v[24:27], v10, s[12:15], s45 offen sc1
    s_add_u32 s46, s45, 0x1000
    s_load_dword s47, s[22:23], s46
    s_add_u32 s46, s45, 0x2000
    s_add_u32 s48, s45, 0x2080
    s_add_u32 s49, s45, 0x80
    s_waitcnt vmcnt(0) lgkmcnt(0)
    s_memtime s[72:73]
    s_waitcnt lgkmcnt(0)
    s_load_dword s47, s[22:23], s45
    s_waitcnt lgkmcnt(0)
    s_memtime s[74:75]
    s_waitcnt lgkmcnt(0)
    s_load_dword s47, s[22:23], s46
    s_waitcnt lgkmcnt(0)
    s_memtime s[76:77]
    s_waitcnt lgkmcnt(0)
    s_sub_u32 s76, s76, s74
    s_sub_u32 s74, s74, s72
    s_cmp_gt_u32 s74, s76
    s_addc_u32 s64, s64, 0
    s_cmp_lg_u32 s60, 2
    s_cbranch_scc1 L_s_pr_221_b
    s_cmp_ge_u32 s64, 2
    s_cselect_b32 s45, 3, 2
    v_mov_b32 v10, s45
    v_mov_b32 v11, 0
    s_lshl_b32 s45, s40, 7
    s_add_u32 s45, s45, 0x101800
    s_mov_b64 exec, 1
    buffer_store_dword v10, v11, s[12:15], s45 offen sc1
    s_mov_b64 exec, -1
    s_branch L_s_pr_221_b
L_vf_187:
    s_cmp_eq_u32 s52, 0
    s_cbranch_scc1 L_vs_188
    s_mov_b32 s70, 1
    v_mov_b32 v16, 0
    v_mov_b32 v17, 0
    s_branch L_v_l1m_225
.p2align 6
L_v_loop_223:
    s_mov_b32 s70, 1
    buffer_load_dwordx4 v[64:67], v9, s[12:15], s61 offen offset:0 sc1
    buffer_load_dwordx4 v[68:71], v9, s[12:15], s61 offen offset:1024 sc1
    buffer_load_dwordx4 v[72:75], v9, s[12:15], s61 offen offset:2048 sc1
    buffer_load_dwordx4 v[76:79], v9, s[12:15], s61 offen offset:3072 sc1
    v_mov_b32 v16, 0
    v_mov_b32 v17, 0
    v_mov_b32 v18, 0
    v_mov_b32 v19, 0
    v_mov_b32 v20, 0
    v_mov_b32 v21, 0
    v_mov_b32 v22, 0
    v_mov_b32 v23, 0
L_v_l1m_225:
    s_waitcnt vmcnt(3)
    ds_write_b128 v10, v[64:67] offset:0
    v_max3_u32 v24, v64, v65, v66
    v_max_u32 v24, v24, v67
    v_cmp_eq_u32 s[48:49], -1, v24
    s_waitcnt vmcnt(2)
    ds_write_b128 v10, v[68:71] offset:1024
    v_max3_u32 v24, v68, v69, v70
    v_max_u32 v24, v24, v71
    v_cmp_eq_u32 s[50:51], -1, v24
    s_waitcnt vmcnt(1)
    ds_write_b128 v10, v[72:75] offset:2048
    v_max3_u32 v24, v72, v73, v74
    v_max_u32 v24, v24, v75
    v_cmp_eq_u32 s[52:53], -1, v24
    s_waitcnt vmcnt(0)
    ds_write_b128 v10, v[76:79] offset:3072
    v_max3_u32 v24, v76, v77, v78
    v_max_u32 v24, v24, v79
    v_cmp_eq_u32 s[54:55], -1, v24
    s_or_b64 s[46:47], s[48:49], s[50:51]
    s_or_b64 vcc, s[52:53], s[54:55]
    s_or_b64 vcc, vcc, s[46:47]
    s_cbranch_scc1 L_v_l1_224
L_v_l1ok_226:
    s_waitcnt lgkmcnt(0)
    s_barrier
    v_smfmac_f32_16x16x64_bf16 v[16:19], v[64:67], a[0:7], v3
    v_smfmac_f32_16x16x64_bf16 v[20:23], v[64:67], a[32:39], v3
    v_smfmac_f32_16x16x64_bf16 v[16:19], v[68:71], a[8:15], v3
    v_smfmac_f32_16x16x64_bf16 v[20:23], v[68:71], a[40:47], v3
    v_smfmac_f32_16x16x64_bf16 v[16:19], v[72:75], a[16:23], v3
    v_smfmac_f32_16x16x64_bf16 v[20:23], v[72:75], a[48:55], v3
    v_smfmac_f32_16x16x64_bf16 v[16:19], v[76:79], a[24:31], v3
    v_smfmac_f32_16x16x64_bf16 v[20:23], v[76:79], a[56:63], v3
    s_add_u32 s46, s65, 4096
    buffer_load_dwordx4 v[32:35], v15, s[12:15], s65 offen offset:0 sc1
    buffer_load_dwordx4 v[48:51], v15, s[12:15], s46 offen offset:0 sc1
    buffer_load_dwordx4 v[36:39], v15, s[12:15], s65 offen offset:1024 sc1
    buffer_load_dwordx4 v[52:55], v15, s[12:15], s46 offen offset:1024 sc1
    buffer_load_dwordx4 v[40:43], v15, s[12:15], s65 offen offset:2048 sc1
    buffer_load_dwordx4 v[56:59], v15, s[12:15], s46 offen offset:2048 sc1
    buffer_load_dwordx4 v[44:47], v15, s[12:15], s65 offen offset:3072 sc1
    buffer_load_dwordx4 v[60:63], v15, s[12:15], s46 offen offset:3072 sc1
    s_add_u32 s65, s65, 786432
    v_permlane32_swap_b32 v16, v18
    v_permlane32_swap_b32 v17, v19
    v_permlane32_swap_b32 v20, v22
    v_permlane32_swap_b32 v21, v23
    v_add_f32 v16, v16, v18
    v_add_f32 v17, v17, v19
    v_add_f32 v18, v20, v22
    v_add_f32 v19, v21, v23
    ds_write_b128 v14, v[16:19]
    s_mov_b64 exec, 1
    ds_add_u32 v29, v30
    s_mov_b64 exec, -1
    s_add_u32 s58, s58, 4
    s_bitcmp1_b32 s44, 0
    s_cbranch_scc1 L_v_k1_228_c
    s_mov_b32 s70, 0
L_v_rl_229:
    ds_read_b32 v24, v29
    ds_read_b64 v[16:17], v13 offset:0
    ds_read_b64 v[18:19], v13 offset:1024
    ds_read_b64 v[20:21], v13 offset:2048
    ds_read_b64 v[22:23], v13 offset:3072
    s_waitcnt lgkmcnt(2)
    v_cmp_ne_u32 vcc, s58, v24
    v_add_f32 v16, v16, v18
    v_add_f32 v17, v17, v19
    s_waitcnt lgkmcnt(0)
    s_cbranch_vccnz L_rt_230
    v_add_f32 v20, v20, v22
    v_add_f32 v21, v21, v23
    v_add_f32 v16, v16, v20
    v_add_f32 v17, v17, v21
    s_mov_b32 vcc_lo, 0x55555555
    s_mov_b32 vcc_hi, 0x55555555
    v_cndmask_b32_dpp v18, v17, v16, vcc quad_perm:[1,0,3,2] row_mask:0xf bank_mask:0xf
    s_not_b64 vcc, vcc
    v_cndmask_b32_dpp v19, v16, v17, vcc quad_perm:[1,0,3,2] row_mask:0xf bank_mask:0xf
    v_cvt_pk_bf16_f32 v18, v18, v19
    v_min_u32 v18, -2, v18
    buffer_store_dword v18, v4, s[12:15], s62 offen
    ds_write_b32 v5, v18
L_v_k1_228:
    s_cmp_eq_u32 s60, 63
    s_cbranch_scc1 L_v_last_227
    ds_read_b128 v[80:83], v27 offset:32768
    ds_read_b128 v[84:87], v27 offset:36864
    ds_read_b128 v[88:91], v27 offset:40960
    ds_read_b128 v[92:95], v27 offset:45056
    v_mov_b32 v96, 0
    v_mov_b32 v97, 0
    v_mov_b32 v98, 0
    v_mov_b32 v99, 0
    v_mov_b32 v100, 0
    v_mov_b32 v101, 0
    v_mov_b32 v102, 0
    v_mov_b32 v103, 0
    v_mov_b32 v104, 0
    v_mov_b32 v105, 0
    v_mov_b32 v106, 0
    v_mov_b32 v107, 0
    v_mov_b32 v108, 0
    v_mov_b32 v109, 0
    v_mov_b32 v110, 0
    v_mov_b32 v111, 0
    s_bitcmp1_b32 s44, 0
    s_cbranch_scc0 L_v_sv_231
    s_sleep 3
L_v_sv_231:
    s_sleep 4
    s_mov_b32 s70, 1
    buffer_load_dwordx4 v[64:67], v11, s[12:15], s62 offen offset:0 sc1
    buffer_load_dwordx4 v[68:71], v11, s[12:15], s62 offen offset:1024 sc1
L_v_vp_232_m:
    s_waitcnt vmcnt(0)
    v_max3_u32 v20, v64, v65, v66
    v_max3_u32 v20, v20, v67, v68
    v_max3_u32 v20, v20, v69, v70
    v_max_u32 v20, v20, v71
    v_cmp_eq_u32 vcc, -1, v20
    s_cbranch_vccnz L_rt_233
    v_smfmac_f32_16x16x64_bf16 v[96:99], v[64:67], a[64:71], v3
    v_smfmac_f32_16x16x64_bf16 v[96:99], v[68:71], a[72:79], v3
    v_smfmac_f32_16x16x64_bf16 v[100:103], v[64:67], a[80:87], v3
    v_smfmac_f32_16x16x64_bf16 v[100:103], v[68:71], a[88:95], v3
    v_smfmac_f32_16x16x64_bf16 v[104:107], v[64:67], a[96:103], v3
    v_smfmac_f32_16x16x64_bf16 v[104:107], v[68:71], a[104:111], v3
    v_smfmac_f32_16x16x64_bf16 v[108:111], v[64:67], a[112:119], v3
    v_smfmac_f32_16x16x64_bf16 v[108:111], v[68:71], a[120:127], v3
    s_nop 1
    v_cvt_pk_bf16_f32 v96, v96, v97
    v_cvt_pk_bf16_f32 v97, v98, v99
    ds_write_b64 v12, v[96:97] offset:0
    v_cvt_pk_bf16_f32 v100, v100, v101
    v_cvt_pk_bf16_f32 v101, v102, v103
    ds_write_b64 v12, v[100:101] offset:2048
    v_cvt_pk_bf16_f32 v104, v104, v105
    v_cvt_pk_bf16_f32 v105, v106, v107
    ds_write_b64 v12, v[104:105] offset:4096
    v_cvt_pk_bf16_f32 v108, v108, v109
    v_cvt_pk_bf16_f32 v109, v110, v111
    ds_write_b64 v12, v[108:109] offset:6144
    s_waitcnt lgkmcnt(0)
    s_barrier
    ds_read_b128 v[96:99], v2 offset:16384
    ds_read_b128 v[100:103], v2 offset:17408
    ds_read_b128 v[104:107], v2 offset:18432
    ds_read_b128 v[108:111], v2 offset:19456
    ds_read_b128 v[112:115], v31 offset:0
    ds_read_b128 v[116:119], v25 offset:0
    ds_read_b128 v[120:123], v31 offset:512
    ds_read_b128 v[124:127], v25 offset:1024
    s_waitcnt lgkmcnt(7)
    v_mfma_f32_16x16x32_bf16 v[16:19], v[80:83], v[96:99], 0
    s_waitcnt lgkmcnt(6)
    v_mfma_f32_16x16x32_bf16 v[16:19], v[84:87], v[100:103], v[16:19]
    s_waitcnt lgkmcnt(5)
    v_mfma_f32_16x16x32_bf16 v[16:19], v[88:91], v[104:107], v[16:19]
    s_waitcnt lgkmcnt(4)
    v_mfma_f32_16x16x32_bf16 v[16:19], v[92:95], v[108:111], v[16:19]
    s_waitcnt lgkmcnt(2)
    v_mfma_f32_16x16x32_bf16 v[16:19], v[116:119], v[112:115], v[16:19]
    s_waitcnt lgkmcnt(0)
    v_mfma_f32_16x16x32_bf16 v[16:19], v[124:127], v[120:123], v[16:19]
    s_mov_b32 exec_lo, 0x00ff00ff
    s_mov_b32 exec_hi, 0x00ff00ff
    s_nop 5
    v_cvt_pk_bf16_f32 v16, v16, v17
    v_cvt_pk_bf16_f32 v17, v18, v19
    v_min_u32 v16, -2, v16
    v_min_u32 v17, -2, v17
    buffer_store_dwordx2 v[16:17], v6, s[12:15], s63 offen sc1
    s_mov_b64 exec, -1
    s_add_u32 s61, s61, 0x4000
    s_and_b32 s61, s61, 0xffff
    s_mov_b32 s70, 1
    s_sleep 8
    buffer_load_dword v96, v7, s[12:15], s63 offen offset:0 sc1
    buffer_load_dword v97, v7, s[12:15], s63 offen offset:256 sc1
    buffer_load_dword v98, v7, s[12:15], s63 offen offset:512 sc1
    buffer_load_dword v99, v7, s[12:15], s63 offen offset:768 sc1
    buffer_load_dword v100, v7, s[12:15], s63 offen offset:1024 sc1
    buffer_load_dword v101, v7, s[12:15], s63 offen offset:1280 sc1
    buffer_load_dword v102, v7, s[12:15], s63 offen offset:1536 sc1
    buffer_load_dword v103, v7, s[12:15], s63 offen offset:1792 sc1
    v_mfma_f32_16x16x32_bf16 v[64:67], v[32:35], a[64:67], 0
    v_mfma_f32_16x16x32_bf16 v[68:71], v[48:51], a[64:67], 0
    v_mfma_f32_16x16x32_bf16 v[64:67], v[36:39], a[68:71], v[64:67]
    v_mfma_f32_16x16x32_bf16 v[68:71], v[52:55], a[68:71], v[68:71]
    v_mfma_f32_16x16x32_bf16 v[64:67], v[40:43], a[72:75], v[64:67]
    v_mfma_f32_16x16x32_bf16 v[68:71], v[56:59], a[72:75], v[68:71]
    v_mfma_f32_16x16x32_bf16 v[64:67], v[44:47], a[76:79], v[64:67]
    v_mfma_f32_16x16x32_bf16 v[68:71], v[60:63], a[76:79], v[68:71]
    v_mfma_f32_16x16x32_bf16 v[72:75], v[32:35], a[80:83], 0
    v_mfma_f32_16x16x32_bf16 v[76:79], v[48:51], a[80:83], 0
    v_mfma_f32_16x16x32_bf16 v[72:75], v[36:39], a[84:87], v[72:75]
    v_mfma_f32_16x16x32_bf16 v[76:79], v[52:55], a[84:87], v[76:79]
    v_mfma_f32_16x16x32_bf16 v[72:75], v[40:43], a[88:91], v[72:75]
    v_mfma_f32_16x16x32_bf16 v[76:79], v[56:59], a[88:91], v[76:79]
    v_mfma_f32_16x16x32_bf16 v[72:75], v[44:47], a[92:95], v[72:75]
    v_mfma_f32_16x16x32_bf16 v[76:79], v[60:63], a[92:95], v[76:79]
    v_cvt_pk_bf16_f32 v64, v64, v65
    v_cvt_pk_bf16_f32 v65, v66, v67
    v_cvt_pk_bf16_f32 v66, v68, v69
    v_cvt_pk_bf16_f32 v67, v70, v71
    ds_write_b128 v10, v[64:67] offset:32768
    v_mfma_f32_16x16x32_bf16 v[80:83], v[32:35], a[96:99], 0
    v_mfma_f32_16x16x32_bf16 v[84:87], v[48:51], a[96:99], 0
    v_mfma_f32_16x16x32_bf16 v[80:83], v[36:39], a[100:103], v[80:83]
    v_mfma_f32_16x16x32_bf16 v[84:87], v[52:55], a[100:103], v[84:87]
    v_mfma_f32_16x16x32_bf16 v[80:83], v[40:43], a[104:107], v[80:83]
    v_mfma_f32_16x16x32_bf16 v[84:87], v[56:59], a[104:107], v[84:87]
    v_mfma_f32_16x16x32_bf16 v[80:83], v[44:47], a[108:111], v[80:83]
    v_mfma_f32_16x16x32_bf16 v[84:87], v[60:63], a[108:111], v[84:87]
    v_cvt_pk_bf16_f32 v72, v72, v73
    v_cvt_pk_bf16_f32 v73, v74, v75
    v_cvt_pk_bf16_f32 v74, v76, v77
    v_cvt_pk_bf16_f32 v75, v78, v79
    ds_write_b128 v10, v[72:75] offset:33792
L_v_gp_234:
    s_waitcnt vmcnt(7)
    v_lshlrev_b32 v20, 16, v96
    v_and_b32 v21, 0xffff0000, v96
    s_waitcnt vmcnt(6)
    v_lshlrev_b32 v22, 16, v97
    v_and_b32 v23, 0xffff0000, v97
    v_add_f32 v20, v20, v22
    v_add_f32 v21, v21, v23
    s_waitcnt vmcnt(5)
    v_lshlrev_b32 v22, 16, v98
    v_and_b32 v23, 0xffff0000, v98
    v_add_f32 v20, v20, v22
    v_add_f32 v21, v21, v23
    s_waitcnt vmcnt(4)
    v_lshlrev_b32 v22, 16, v99
    v_and_b32 v23, 0xffff0000, v99
    v_add_f32 v20, v20, v22
    v_add_f32 v21, v21, v23
    s_waitcnt vmcnt(3)
    v_lshlrev_b32 v22, 16, v100
    v_and_b32 v23, 0xffff0000, v100
    v_add_f32 v20, v20, v22
    v_add_f32 v21, v21, v23
    s_waitcnt vmcnt(2)
    v_lshlrev_b32 v22, 16, v101
    v_and_b32 v23, 0xffff0000, v101
    v_add_f32 v20, v20, v22
    v_add_f32 v21, v21, v23
    s_waitcnt vmcnt(1)
    v_lshlrev_b32 v22, 16, v102
    v_and_b32 v23, 0xffff0000, v102
    v_add_f32 v20, v20, v22
    v_add_f32 v21, v21, v23
    s_waitcnt vmcnt(0)
    v_lshlrev_b32 v22, 16, v103
    v_and_b32 v23, 0xffff0000, v103
    v_add_f32 v20, v20, v22
    v_add_f32 v21, v21, v23
    v_cmp_u_f32 vcc, v20, v21
    v_cvt_pk_bf16_f32 v20, v20, v21
    s_cbranch_vccnz L_v_gf_236
L_v_gok_235:
    buffer_store_dword v20, v8, s[12:15], s61 offen
    s_xor_b32 s45, s61, 0x8000
    buffer_store_dword v26, v8, s[12:15], s45 offen
    s_bitcmp1_b32 s44, 0
    s_cbranch_scc1 L_v_nr_237
    s_xor_b32 s45, s62, 0x4000
    buffer_store_dword v26, v4, s[12:15], s45 offen
L_v_nr_237:
    s_add_u32 s60, s60, 1
    s_add_u32 s62, s62, 0x2000
    s_and_b32 s62, s62, 0x7fff
    s_cmp_eq_u32 s60, 5
    s_cbranch_scc1 L_v_vt_238
L_v_vt_238_b:
    s_and_b32 s45, s60, 0x38
    s_bitcmp1_b64 s[66:67], s45
    s_cselect_b32 s45, 8192, 0
    s_lshl_b32 s63, s60, 18
    s_add_u32 s63, s63, s45
    v_mfma_f32_16x16x32_bf16 v[88:91], v[32:35], a[112:115], 0
    v_mfma_f32_16x16x32_bf16 v[92:95], v[48:51], a[112:115], 0
    v_mfma_f32_16x16x32_bf16 v[88:91], v[36:39], a[116:119], v[88:91]
    v_mfma_f32_16x16x32_bf16 v[92:95], v[52:55], a[116:119], v[92:95]
    v_mfma_f32_16x16x32_bf16 v[88:91], v[40:43], a[120:123], v[88:91]
    v_mfma_f32_16x16x32_bf16 v[92:95], v[56:59], a[120:123], v[92:95]
    v_mfma_f32_16x16x32_bf16 v[88:91], v[44:47], a[124:127], v[88:91]
    v_mfma_f32_16x16x32_bf16 v[92:95], v[60:63], a[124:127], v[92:95]
    v_cvt_pk_bf16_f32 v80, v80, v81
    v_cvt_pk_bf16_f32 v81, v82, v83
    v_cvt_pk_bf16_f32 v82, v84, v85
    v_cvt_pk_bf16_f32 v83, v86, v87
    ds_write_b128 v10, v[80:83] offset:34816
    s_nop 2
    v_cvt_pk_bf16_f32 v88, v88, v89
    v_cvt_pk_bf16_f32 v89, v90, v91
    v_cvt_pk_bf16_f32 v90, v92, v93
    v_cvt_pk_bf16_f32 v91, v94, v95
    ds_write_b128 v10, v[88:91] offset:35840
    s_sleep 3
    s_branch L_v_loop_223
L_v_last_227:
    s_waitcnt lgkmcnt(0)
    s_barrier
    s_branch L_replica
L_v_l1_224:
    s_mov_b64 exec, s[48:49]
    s_cbranch_execz L_v_ls_239
    buffer_load_dwordx4 v[64:67], v9, s[12:15], s61 offen offset:0 sc1
L_v_ls_239:
    s_mov_b64 exec, s[50:51]
    s_cbranch_execz L_v_ls_240
    buffer_load_dwordx4 v[68:71], v9, s[12:15], s61 offen offset:1024 sc1
L_v_ls_240:
    s_mov_b64 exec, s[52:53]
    s_cbranch_execz L_v_ls_241
    buffer_load_dwordx4 v[72:75], v9, s[12:15], s61 offen offset:2048 sc1
L_v_ls_241:
    s_mov_b64 exec, s[54:55]
    s_cbranch_execz L_v_ls_242
    buffer_load_dwordx4 v[76:79], v9, s[12:15], s61 offen offset:3072 sc1
L_v_ls_242:
    s_mov_b64 exec, -1
    s_add_u32 s70, s70, 1
    s_cmp_ge_u32 s70, 524288
    s_cbranch_scc1 L_c_done_1
    s_waitcnt vmcnt(0)
    s_cmp_eq_u64 s[48:49], 0
    s_cbranch_scc1 L_v_lc_243
    ds_write_b128 v10, v[64:67] offset:0
    v_max3_u32 v24, v64, v65, v66
    v_max_u32 v24, v24, v67
    v_cmp_eq_u32 s[48:49], -1, v24
L_v_lc_243:
    s_cmp_eq_u64 s[50:51], 0
    s_cbranch_scc1 L_v_lc_244
    ds_write_b128 v10, v[68:71] offset:1024
    v_max3_u32 v24, v68, v69, v70
    v_max_u32 v24, v24, v71
    v_cmp_eq_u32 s[50:51], -1, v24
L_v_lc_244:
    s_cmp_eq_u64 s[52:53], 0
    s_cbranch_scc1 L_v_lc_245
    ds_write_b128 v10, v[72:75] offset:2048
    v_max3_u32 v24, v72, v73, v74
    v_max_u32 v24, v24, v75
    v_cmp_eq_u32 s[52:53], -1, v24
L_v_lc_245:
    s_cmp_eq_u64 s[54:55], 0
    s_cbranch_scc1 L_v_lc_246
    ds_write_b128 v10, v[76:79] offset:3072
    v_max3_u32 v24, v76, v77, v78
    v_max_u32 v24, v24, v79
    v_cmp_eq_u32 s[54:55], -1, v24
L_v_lc_246:
    s_or_b64 s[46:47], s[48:49], s[50:51]
    s_or_b64 vcc, s[52:53], s[54:55]
    s_or_b64 vcc, vcc, s[46:47]
    s_cbranch_scc1 L_v_l1_224
    s_branch L_v_l1ok_226
L_v_k1_228_c:
    s_waitcnt vmcnt(0)
    s_branch L_v_k1_228
L_rt_230:
    s_add_u32 s70, s70, 1
    s_cmp_lt_u32 s70, 524288
    s_cbranch_scc1 L_v_rl_229
    s_branch L_c_done_1
L_v_vp_232:
    buffer_load_dwordx4 v[64:67], v11, s[12:15], s62 offen offset:0 sc1
    buffer_load_dwordx4 v[68:71], v11, s[12:15], s62 offen offset:1024 sc1
    s_branch L_v_vp_232_m
L_rt_233:
    s_add_u32 s70, s70, 1
    s_cmp_lt_u32 s70, 524288
    s_cbranch_scc1 L_v_vp_232
    s_branch L_c_done_1
L_v_gf_236:
    v_max3_u32 v24, v96, v97, v98
    v_max3_u32 v24, v24, v99, v100
    v_max3_u32 v24, v24, v101, v102
    v_max_u32 v24, v24, v103
    v_cmp_eq_u32 vcc, -1, v24
    v_min_u32 v20, -2, v20
    s_add_u32 s70, s70, 1
    s_cbranch_vccz L_v_gok_235
    buffer_load_dword v96, v7, s[12:15], s63 offen offset:0 sc1
    buffer_load_dword v97, v7, s[12:15], s63 offen offset:256 sc1
    buffer_load_dword v98, v7, s[12:15], s63 offen offset:512 sc1
    buffer_load_dword v99, v7, s[12:15], s63 offen offset:768 sc1
    buffer_load_dword v100, v7, s[12:15], s63 offen offset:1024 sc1
    buffer_load_dword v101, v7, s[12:15], s63 offen offset:1280 sc1
    buffer_load_dword v102, v7, s[12:15], s63 offen offset:1536 sc1
    buffer_load_dword v103, v7, s[12:15], s63 offen offset:1792 sc1
    s_cmp_lt_u32 s70, 524288
    s_cbranch_scc1 L_v_gp_234
    s_branch L_c_done_1
L_v_vt_238:
    v_lshrrev_b32 v22, 3, v1
    v_lshlrev_b32 v22, 7, v22
    s_mov_b32 s45, 0x101800
    s_mov_b32 s46, 0
    s_mov_b32 s70, 0
L_spin_247:
    buffer_load_dword v23, v22, s[12:15], s45 offen sc1
    s_waitcnt vmcnt(0)
    v_cmp_ge_u32 vcc, s46, v23
    s_add_u32 s70, s70, 1
    s_cbranch_vccz L_spok_248
    s_sleep 3
    s_cmp_lt_u32 s70, 524288
    s_cbranch_scc1 L_spin_247
    s_branch L_c_done_1
L_spok_248:
    v_cmp_eq_u32 s[66:67], 3, v23
    s_nop 3
    s_branch L_v_vt_238_b
L_vs_188:
    s_mov_b32 s70, 1
    v_mov_b32 v16, 0
    v_mov_b32 v17, 0
    s_branch L_v_l1m_251
.p2align 6
L_v_loop_249:
    s_mov_b32 s70, 1
    buffer_load_dwordx4 v[64:67], v9, s[12:15], s61 offen offset:0 sc1
    buffer_load_dwordx4 v[68:71], v9, s[12:15], s61 offen offset:1024 sc1
    buffer_load_dwordx4 v[72:75], v9, s[12:15], s61 offen offset:2048 sc1
    buffer_load_dwordx4 v[76:79], v9, s[12:15], s61 offen offset:3072 sc1
    v_mov_b32 v16, 0
    v_mov_b32 v17, 0
    v_mov_b32 v18, 0
    v_mov_b32 v19, 0
    v_mov_b32 v20, 0
    v_mov_b32 v21, 0
    v_mov_b32 v22, 0
    v_mov_b32 v23, 0
L_v_l1m_251:
    s_waitcnt vmcnt(3)
    ds_write_b128 v10, v[64:67] offset:0
    v_max3_u32 v24, v64, v65, v66
    v_max_u32 v24, v24, v67
    v_cmp_eq_u32 s[48:49], -1, v24
    s_waitcnt vmcnt(2)
    ds_write_b128 v10, v[68:71] offset:1024
    v_max3_u32 v24, v68, v69, v70
    v_max_u32 v24, v24, v71
    v_cmp_eq_u32 s[50:51], -1, v24
    s_waitcnt vmcnt(1)
    ds_write_b128 v10, v[72:75] offset:2048
    v_max3_u32 v24, v72, v73, v74
    v_max_u32 v24, v24, v75
    v_cmp_eq_u32 s[52:53], -1, v24
    s_waitcnt vmcnt(0)
    ds_write_b128 v10, v[76:79] offset:3072
    v_max3_u32 v24, v76, v77, v78
    v_max_u32 v24, v24, v79
    v_cmp_eq_u32 s[54:55], -1, v24
    s_or_b64 s[46:47], s[48:49], s[50:51]
    s_or_b64 vcc, s[52:53], s[54:55]
    s_or_b64 vcc, vcc, s[46:47]
    s_cbranch_scc1 L_v_l1_250
L_v_l1ok_252:
    s_waitcnt lgkmcnt(0)
    s_barrier
    v_smfmac_f32_16x16x64_bf16 v[16:19], v[64:67], a[0:7], v3
    v_smfmac_f32_16x16x64_bf16 v[20:23], v[64:67], a[32:39], v3
    v_smfmac_f32_16x16x64_bf16 v[16:19], v[68:71], a[8:15], v3
    v_smfmac_f32_16x16x64_bf16 v[20:23], v[68:71], a[40:47], v3
    v_smfmac_f32_16x16x64_bf16 v[16:19], v[72:75], a[16:23], v3
    v_smfmac_f32_16x16x64_bf16 v[20:23], v[72:75], a[48:55], v3
    v_smfmac_f32_16x16x64_bf16 v[16:19], v[76:79], a[24:31], v3
    v_smfmac_f32_16x16x64_bf16 v[20:23], v[76:79], a[56:63], v3
    s_add_u32 s46, s65, 4096
    buffer_load_dwordx4 v[32:35], v15, s[12:15], s65 offen offset:0 sc1
    buffer_load_dwordx4 v[48:51], v15, s[12:15], s46 offen offset:0 sc1
    buffer_load_dwordx4 v[36:39], v15, s[12:15], s65 offen offset:1024 sc1
    buffer_load_dwordx4 v[52:55], v15, s[12:15], s46 offen offset:1024 sc1
    buffer_load_dwordx4 v[40:43], v15, s[12:15], s65 offen offset:2048 sc1
    buffer_load_dwordx4 v[56:59], v15, s[12:15], s46 offen offset:2048 sc1
    buffer_load_dwordx4 v[44:47], v15, s[12:15], s65 offen offset:3072 sc1
    buffer_load_dwordx4 v[60:63], v15, s[12:15], s46 offen offset:3072 sc1
    s_add_u32 s65, s65, 786432
    v_permlane32_swap_b32 v16, v18
    v_permlane32_swap_b32 v17, v19
    v_permlane32_swap_b32 v20, v22
    v_permlane32_swap_b32 v21, v23
    v_add_f32 v16, v16, v18
    v_add_f32 v17, v17, v19
    v_add_f32 v18, v20, v22
    v_add_f32 v19, v21, v23
    ds_write_b128 v14, v[16:19]
    s_mov_b64 exec, 1
    ds_add_u32 v29, v30
    s_mov_b64 exec, -1
    s_add_u32 s58, s58, 4
    s_bitcmp1_b32 s44, 0
    s_cbranch_scc1 L_v_k1_254_c
    s_mov_b32 s70, 0
L_v_rl_255:
    ds_read_b32 v24, v29
    ds_read_b64 v[16:17], v13 offset:0
    ds_read_b64 v[18:19], v13 offset:1024
    ds_read_b64 v[20:21], v13 offset:2048
    ds_read_b64 v[22:23], v13 offset:3072
    s_waitcnt lgkmcnt(2)
    v_cmp_ne_u32 vcc, s58, v24
    v_add_f32 v16, v16, v18
    v_add_f32 v17, v17, v19
    s_waitcnt lgkmcnt(0)
    s_cbranch_vccnz L_rt_256
    v_add_f32 v20, v20, v22
    v_add_f32 v21, v21, v23
    v_add_f32 v16, v16, v20
    v_add_f32 v17, v17, v21
    s_mov_b32 vcc_lo, 0x55555555
    s_mov_b32 vcc_hi, 0x55555555
    v_cndmask_b32_dpp v18, v17, v16, vcc quad_perm:[1,0,3,2] row_mask:0xf bank_mask:0xf
    s_not_b64 vcc, vcc
    v_cndmask_b32_dpp v19, v16, v17, vcc quad_perm:[1,0,3,2] row_mask:0xf bank_mask:0xf
    v_cvt_pk_bf16_f32 v18, v18, v19
    v_min_u32 v18, -2, v18
    buffer_store_dword v18, v4, s[12:15], s62 offen sc1
    ds_write_b32 v5, v18
L_v_k1_254:
    s_cmp_eq_u32 s60, 63
    s_cbranch_scc1 L_v_last_253
    ds_read_b128 v[80:83], v27 offset:32768
    ds_read_b128 v[84:87], v27 offset:36864
    ds_read_b128 v[88:91], v27 offset:40960
    ds_read_b128 v[92:95], v27 offset:45056
    v_mov_b32 v96, 0
    v_mov_b32 v97, 0
    v_mov_b32 v98, 0
    v_mov_b32 v99, 0
    v_mov_b32 v100, 0
    v_mov_b32 v101, 0
    v_mov_b32 v102, 0
    v_mov_b32 v103, 0
    v_mov_b32 v104, 0
    v_mov_b32 v105, 0
    v_mov_b32 v106, 0
    v_mov_b32 v107, 0
    v_mov_b32 v108, 0
    v_mov_b32 v109, 0
    v_mov_b32 v110, 0
    v_mov_b32 v111, 0
    s_bitcmp1_b32 s44, 0
    s_cbranch_scc0 L_v_sv_257
    s_sleep 3
L_v_sv_257:
    s_sleep 4
    s_mov_b32 s70, 1
    buffer_load_dwordx4 v[64:67], v11, s[12:15], s62 offen offset:0 sc1
    buffer_load_dwordx4 v[68:71], v11, s[12:15], s62 offen offset:1024 sc1
L_v_vp_258_m:
    s_waitcnt vmcnt(0)
    v_max3_u32 v20, v64, v65, v66
    v_max3_u32 v20, v20, v67, v68
    v_max3_u32 v20, v20, v69, v70
    v_max_u32 v20, v20, v71
    v_cmp_eq_u32 vcc, -1, v20
    s_cbranch_vccnz L_rt_259
    v_smfmac_f32_16x16x64_bf16 v[96:99], v[64:67], a[64:71], v3
    v_smfmac_f32_16x16x64_bf16 v[96:99], v[68:71], a[72:79], v3
    v_smfmac_f32_16x16x64_bf16 v[100:103], v[64:67], a[80:87], v3
    v_smfmac_f32_16x16x64_bf16 v[100:103], v[68:71], a[88:95], v3
    v_smfmac_f32_16x16x64_bf16 v[104:107], v[64:67], a[96:103], v3
    v_smfmac_f32_16x16x64_bf16 v[104:107], v[68:71], a[104:111], v3
    v_smfmac_f32_16x16x64_bf16 v[108:111], v[64:67], a[112:119], v3
    v_smfmac_f32_16x16x64_bf16 v[108:111], v[68:71], a[120:127], v3
    s_nop 1
    v_cvt_pk_bf16_f32 v96, v96, v97
    v_cvt_pk_bf16_f32 v97, v98, v99
    ds_write_b64 v12, v[96:97] offset:0
    v_cvt_pk_bf16_f32 v100, v100, v101
    v_cvt_pk_bf16_f32 v101, v102, v103
    ds_write_b64 v12, v[100:101] offset:2048
    v_cvt_pk_bf16_f32 v104, v104, v105
    v_cvt_pk_bf16_f32 v105, v106, v107
    ds_write_b64 v12, v[104:105] offset:4096
    v_cvt_pk_bf16_f32 v108, v108, v109
    v_cvt_pk_bf16_f32 v109, v110, v111
    ds_write_b64 v12, v[108:109] offset:6144
    s_waitcnt lgkmcnt(0)
    s_barrier
    ds_read_b128 v[96:99], v2 offset:16384
    ds_read_b128 v[100:103], v2 offset:17408
    ds_read_b128 v[104:107], v2 offset:18432
    ds_read_b128 v[108:111], v2 offset:19456
    ds_read_b128 v[112:115], v31 offset:0
    ds_read_b128 v[116:119], v25 offset:0
    ds_read_b128 v[120:123], v31 offset:512
    ds_read_b128 v[124:127], v25 offset:1024
    s_waitcnt lgkmcnt(7)
    v_mfma_f32_16x16x32_bf16 v[16:19], v[80:83], v[96:99], 0
    s_waitcnt lgkmcnt(6)
    v_mfma_f32_16x16x32_bf16 v[16:19], v[84:87], v[100:103], v[16:19]
    s_waitcnt lgkmcnt(5)
    v_mfma_f32_16x16x32_bf16 v[16:19], v[88:91], v[104:107], v[16:19]
    s_waitcnt lgkmcnt(4)
    v_mfma_f32_16x16x32_bf16 v[16:19], v[92:95], v[108:111], v[16:19]
    s_waitcnt lgkmcnt(2)
    v_mfma_f32_16x16x32_bf16 v[16:19], v[116:119], v[112:115], v[16:19]
    s_waitcnt lgkmcnt(0)
    v_mfma_f32_16x16x32_bf16 v[16:19], v[124:127], v[120:123], v[16:19]
    s_mov_b32 exec_lo, 0x00ff00ff
    s_mov_b32 exec_hi, 0x00ff00ff
    s_nop 5
    v_cvt_pk_bf16_f32 v16, v16, v17
    v_cvt_pk_bf16_f32 v17, v18, v19
    v_min_u32 v16, -2, v16
    v_min_u32 v17, -2, v17
    buffer_store_dwordx2 v[16:17], v6, s[12:15], s63 offen sc1
    s_mov_b64 exec, -1
    s_add_u32 s61, s61, 0x4000
    s_and_b32 s61, s61, 0xffff
    s_mov_b32 s70, 1
    s_sleep 8
    buffer_load_dword v96, v7, s[12:15], s63 offen offset:0 sc1
    buffer_load_dword v97, v7, s[12:15], s63 offen offset:256 sc1
    buffer_load_dword v98, v7, s[12:15], s63 offen offset:512 sc1
    buffer_load_dword v99, v7, s[12:15], s63 offen offset:768 sc1
    buffer_load_dword v100, v7, s[12:15], s63 offen offset:1024 sc1
    buffer_load_dword v101, v7, s[12:15], s63 offen offset:1280 sc1
    buffer_load_dword v102, v7, s[12:15], s63 offen offset:1536 sc1
    buffer_load_dword v103, v7, s[12:15], s63 offen offset:1792 sc1
    v_mfma_f32_16x16x32_bf16 v[64:67], v[32:35], a[64:67], 0
    v_mfma_f32_16x16x32_bf16 v[68:71], v[48:51], a[64:67], 0
    v_mfma_f32_16x16x32_bf16 v[64:67], v[36:39], a[68:71], v[64:67]
    v_mfma_f32_16x16x32_bf16 v[68:71], v[52:55], a[68:71], v[68:71]
    v_mfma_f32_16x16x32_bf16 v[64:67], v[40:43], a[72:75], v[64:67]
    v_mfma_f32_16x16x32_bf16 v[68:71], v[56:59], a[72:75], v[68:71]
    v_mfma_f32_16x16x32_bf16 v[64:67], v[44:47], a[76:79], v[64:67]
    v_mfma_f32_16x16x32_bf16 v[68:71], v[60:63], a[76:79], v[68:71]
    v_mfma_f32_16x16x32_bf16 v[72:75], v[32:35], a[80:83], 0
    v_mfma_f32_16x16x32_bf16 v[76:79], v[48:51], a[80:83], 0
    v_mfma_f32_16x16x32_bf16 v[72:75], v[36:39], a[84:87], v[72:75]
    v_mfma_f32_16x16x32_bf16 v[76:79], v[52:55], a[84:87], v[76:79]
    v_mfma_f32_16x16x32_bf16 v[72:75], v[40:43], a[88:91], v[72:75]
    v_mfma_f32_16x16x32_bf16 v[76:79], v[56:59], a[88:91], v[76:79]
    v_mfma_f32_16x16x32_bf16 v[72:75], v[44:47], a[92:95], v[72:75]
    v_mfma_f32_16x16x32_bf16 v[76:79], v[60:63], a[92:95], v[76:79]
    v_cvt_pk_bf16_f32 v64, v64, v65
    v_cvt_pk_bf16_f32 v65, v66, v67
    v_cvt_pk_bf16_f32 v66, v68, v69
    v_cvt_pk_bf16_f32 v67, v70, v71
    ds_write_b128 v10, v[64:67] offset:32768
    v_mfma_f32_16x16x32_bf16 v[80:83], v[32:35], a[96:99], 0
    v_mfma_f32_16x16x32_bf16 v[84:87], v[48:51], a[96:99], 0
    v_mfma_f32_16x16x32_bf16 v[80:83], v[36:39], a[100:103], v[80:83]
    v_mfma_f32_16x16x32_bf16 v[84:87], v[52:55], a[100:103], v[84:87]
    v_mfma_f32_16x16x32_bf16 v[80:83], v[40:43], a[104:107], v[80:83]
    v_mfma_f32_16x16x32_bf16 v[84:87], v[56:59], a[104:107], v[84:87]
    v_mfma_f32_16x16x32_bf16 v[80:83], v[44:47], a[108:111], v[80:83]
    v_mfma_f32_16x16x32_bf16 v[84:87], v[60:63], a[108:111], v[84:87]
    v_cvt_pk_bf16_f32 v72, v72, v73
    v_cvt_pk_bf16_f32 v73, v74, v75
    v_cvt_pk_bf16_f32 v74, v76, v77
    v_cvt_pk_bf16_f32 v75, v78, v79
    ds_write_b128 v10, v[72:75] offset:33792
L_v_gp_260:
    s_waitcnt vmcnt(7)
    v_lshlrev_b32 v20, 16, v96
    v_and_b32 v21, 0xffff0000, v96
    s_waitcnt vmcnt(6)
    v_lshlrev_b32 v22, 16, v97
    v_and_b32 v23, 0xffff0000, v97
    v_add_f32 v20, v20, v22
    v_add_f32 v21, v21, v23
    s_waitcnt vmcnt(5)
    v_lshlrev_b32 v22, 16, v98
    v_and_b32 v23, 0xffff0000, v98
    v_add_f32 v20, v20, v22
    v_add_f32 v21, v21, v23
    s_waitcnt vmcnt(4)
    v_lshlrev_b32 v22, 16, v99
    v_and_b32 v23, 0xffff0000, v99
    v_add_f32 v20, v20, v22
    v_add_f32 v21, v21, v23
    s_waitcnt vmcnt(3)
    v_lshlrev_b32 v22, 16, v100
    v_and_b32 v23, 0xffff0000, v100
    v_add_f32 v20, v20, v22
    v_add_f32 v21, v21, v23
    s_waitcnt vmcnt(2)
    v_lshlrev_b32 v22, 16, v101
    v_and_b32 v23, 0xffff0000, v101
    v_add_f32 v20, v20, v22
    v_add_f32 v21, v21, v23
    s_waitcnt vmcnt(1)
    v_lshlrev_b32 v22, 16, v102
    v_and_b32 v23, 0xffff0000, v102
    v_add_f32 v20, v20, v22
    v_add_f32 v21, v21, v23
    s_waitcnt vmcnt(0)
    v_lshlrev_b32 v22, 16, v103
    v_and_b32 v23, 0xffff0000, v103
    v_add_f32 v20, v20, v22
    v_add_f32 v21, v21, v23
    v_cmp_u_f32 vcc, v20, v21
    v_cvt_pk_bf16_f32 v20, v20, v21
    s_cbranch_vccnz L_v_gf_262
L_v_gok_261:
    buffer_store_dword v20, v8, s[12:15], s61 offen sc1
    s_xor_b32 s45, s61, 0x8000
    buffer_store_dword v26, v8, s[12:15], s45 offen sc1
    s_bitcmp1_b32 s44, 0
    s_cbranch_scc1 L_v_nr_263
    s_xor_b32 s45, s62, 0x4000
    buffer_store_dword v26, v4, s[12:15], s45 offen sc1
L_v_nr_263:
    s_add_u32 s60, s60, 1
    s_add_u32 s62, s62, 0x2000
    s_and_b32 s62, s62, 0x7fff
    s_cmp_eq_u32 s60, 5
    s_cbranch_scc1 L_v_vt_264
L_v_vt_264_b:
    s_and_b32 s45, s60, 0x38
    s_bitcmp1_b64 s[66:67], s45
    s_cselect_b32 s45, 8192, 0
    s_lshl_b32 s63, s60, 18
    s_add_u32 s63, s63, s45
    v_mfma_f32_16x16x32_bf16 v[88:91], v[32:35], a[112:115], 0
    v_mfma_f32_16x16x32_bf16 v[92:95], v[48:51], a[112:115], 0
    v_mfma_f32_16x16x32_bf16 v[88:91], v[36:39], a[116:119], v[88:91]
    v_mfma_f32_16x16x32_bf16 v[92:95], v[52:55], a[116:119], v[92:95]
    v_mfma_f32_16x16x32_bf16 v[88:91], v[40:43], a[120:123], v[88:91]
    v_mfma_f32_16x16x32_bf16 v[92:95], v[56:59], a[120:123], v[92:95]
    v_mfma_f32_16x16x32_bf16 v[88:91], v[44:47], a[124:127], v[88:91]
    v_mfma_f32_16x16x32_bf16 v[92:95], v[60:63], a[124:127], v[92:95]
    v_cvt_pk_bf16_f32 v80, v80, v81
    v_cvt_pk_bf16_f32 v81, v82, v83
    v_cvt_pk_bf16_f32 v82, v84, v85
    v_cvt_pk_bf16_f32 v83, v86, v87
    ds_write_b128 v10, v[80:83] offset:34816
    s_nop 2
    v_cvt_pk_bf16_f32 v88, v88, v89
    v_cvt_pk_bf16_f32 v89, v90, v91
    v_cvt_pk_bf16_f32 v90, v92, v93
    v_cvt_pk_bf16_f32 v91, v94, v95
    ds_write_b128 v10, v[88:91] offset:35840
    s_sleep 3
    s_branch L_v_loop_249
L_v_last_253:
    s_waitcnt lgkmcnt(0)
    s_barrier
    s_branch L_replica
L_v_l1_250:
    s_mov_b64 exec, s[48:49]
    s_cbranch_execz L_v_ls_265
    buffer_load_dwordx4 v[64:67], v9, s[12:15], s61 offen offset:0 sc1
L_v_ls_265:
    s_mov_b64 exec, s[50:51]
    s_cbranch_execz L_v_ls_266
    buffer_load_dwordx4 v[68:71], v9, s[12:15], s61 offen offset:1024 sc1
L_v_ls_266:
    s_mov_b64 exec, s[52:53]
    s_cbranch_execz L_v_ls_267
    buffer_load_dwordx4 v[72:75], v9, s[12:15], s61 offen offset:2048 sc1
L_v_ls_267:
    s_mov_b64 exec, s[54:55]
    s_cbranch_execz L_v_ls_268
    buffer_load_dwordx4 v[76:79], v9, s[12:15], s61 offen offset:3072 sc1
L_v_ls_268:
    s_mov_b64 exec, -1
    s_add_u32 s70, s70, 1
    s_cmp_ge_u32 s70, 524288
    s_cbranch_scc1 L_c_done_1
    s_waitcnt vmcnt(0)
    s_cmp_eq_u64 s[48:49], 0
    s_cbranch_scc1 L_v_lc_269
    ds_write_b128 v10, v[64:67] offset:0
    v_max3_u32 v24, v64, v65, v66
    v_max_u32 v24, v24, v67
    v_cmp_eq_u32 s[48:49], -1, v24
L_v_lc_269:
    s_cmp_eq_u64 s[50:51], 0
    s_cbranch_scc1 L_v_lc_270
    ds_write_b128 v10, v[68:71] offset:1024
    v_max3_u32 v24, v68, v69, v70
    v_max_u32 v24, v24, v71
    v_cmp_eq_u32 s[50:51], -1, v24
L_v_lc_270:
    s_cmp_eq_u64 s[52:53], 0
    s_cbranch_scc1 L_v_lc_271
    ds_write_b128 v10, v[72:75] offset:2048
    v_max3_u32 v24, v72, v73, v74
    v_max_u32 v24, v24, v75
    v_cmp_eq_u32 s[52:53], -1, v24
L_v_lc_271:
    s_cmp_eq_u64 s[54:55], 0
    s_cbranch_scc1 L_v_lc_272
    ds_write_b128 v10, v[76:79] offset:3072
    v_max3_u32 v24, v76, v77, v78
    v_max_u32 v24, v24, v79
    v_cmp_eq_u32 s[54:55], -1, v24
L_v_lc_272:
    s_or_b64 s[46:47], s[48:49], s[50:51]
    s_or_b64 vcc, s[52:53], s[54:55]
    s_or_b64 vcc, vcc, s[46:47]
    s_cbranch_scc1 L_v_l1_250
    s_branch L_v_l1ok_252
L_v_k1_254_c:
    s_waitcnt vmcnt(0)
    s_branch L_v_k1_254
L_rt_256:
    s_add_u32 s70, s70, 1
    s_cmp_lt_u32 s70, 524288
    s_cbranch_scc1 L_v_rl_255
    s_branch L_c_done_1
L_v_vp_258:
    buffer_load_dwordx4 v[64:67], v11, s[12:15], s62 offen offset:0 sc1
    buffer_load_dwordx4 v[68:71], v11, s[12:15], s62 offen offset:1024 sc1
    s_branch L_v_vp_258_m
L_rt_259:
    s_add_u32 s70, s70, 1
    s_cmp_lt_u32 s70, 524288
    s_cbranch_scc1 L_v_vp_258
    s_branch L_c_done_1
L_v_gf_262:
    v_max3_u32 v24, v96, v97, v98
    v_max3_u32 v24, v24, v99, v100
    v_max3_u32 v24, v24, v101, v102
    v_max_u32 v24, v24, v103
    v_cmp_eq_u32 vcc, -1, v24
    v_min_u32 v20, -2, v20
    s_add_u32 s70, s70, 1
    s_cbranch_vccz L_v_gok_261
    buffer_load_dword v96, v7, s[12:15], s63 offen offset:0 sc1
    buffer_load_dword v97, v7, s[12:15], s63 offen offset:256 sc1
    buffer_load_dword v98, v7, s[12:15], s63 offen offset:512 sc1
    buffer_load_dword v99, v7, s[12:15], s63 offen offset:768 sc1
    buffer_load_dword v100, v7, s[12:15], s63 offen offset:1024 sc1
    buffer_load_dword v101, v7, s[12:15], s63 offen offset:1280 sc1
    buffer_load_dword v102, v7, s[12:15], s63 offen offset:1536 sc1
    buffer_load_dword v103, v7, s[12:15], s63 offen offset:1792 sc1
    s_cmp_lt_u32 s70, 524288
    s_cbranch_scc1 L_v_gp_260
    s_branch L_c_done_1
L_v_vt_264:
    v_lshrrev_b32 v22, 3, v1
    v_lshlrev_b32 v22, 7, v22
    s_mov_b32 s45, 0x101800
    s_mov_b32 s46, 0
    s_mov_b32 s70, 0
L_spin_273:
    buffer_load_dword v23, v22, s[12:15], s45 offen sc1
    s_waitcnt vmcnt(0)
    v_cmp_ge_u32 vcc, s46, v23
    s_add_u32 s70, s70, 1
    s_cbranch_vccz L_spok_274
    s_sleep 3
    s_cmp_lt_u32 s70, 524288
    s_cbranch_scc1 L_spin_273
    s_branch L_c_done_1
L_spok_274:
    v_cmp_eq_u32 s[66:67], 3, v23
    s_nop 3
    s_branch L_v_vt_264_b
L_c_done_1:
    s_endpgm
.section .rodata,"a"
.p2align 6
.amdhsa_kernel k3_chain_kernel
  .amdhsa_next_free_vgpr 256
  .amdhsa_next_free_sgpr 102
  .amdhsa_accum_offset 128
  .amdhsa_group_segment_fixed_size 0
  .amdhsa_kernarg_size 136
  .amdhsa_user_sgpr_count 2
  .amdhsa_user_sgpr_kernarg_segment_ptr 1
  .amdhsa_system_sgpr_workgroup_id_x 1
.end_amdhsa_kernel
```

```asm
; @launch kernel=k3_chain_kernel grid=(256,1,1) block=(512,1,1) lds=147712
.amdgcn_target "amdgcn-amd-amdhsa--gfx950"
.text
.globl k3_chain_kernel
.p2align 8
.type k3_chain_kernel,@function
k3_chain_kernel:
    s_cmp_ge_u32 s2, 256
    s_cbranch_scc1 L_c_done_1
    s_load_dwordx4 s[20:23], s[0:1], 120
    v_and_b32 v1, 63, v0
    v_lshrrev_b32 v2, 6, v0
    s_nop 0
    v_readfirstlane_b32 s44, v2
    s_waitcnt lgkmcnt(0)
    s_mov_b32 s12, s22
    s_and_b32 s13, s23, 0xffff
    s_mov_b32 s14, 0x10000000
    s_mov_b32 s15, 0x00020000
    s_mov_b32 s16, s20
    s_and_b32 s17, s21, 0xffff
    s_mov_b32 s18, 0x100
    s_mov_b32 s19, 0x00020000
    s_getpc_b64 s[24:25]
L_c_here_2:
    v_lshlrev_b32 v3, 7, v0
    v_mov_b32 v5, s25
    v_add_co_u32 v4, vcc, s24, v3
    s_nop 1
    v_addc_co_u32 v5, vcc, 0, v5, vcc
    v_cmp_gt_u32 vcc, L_c_done_1 - L_c_here_2, v3
    s_and_saveexec_b64 s[26:27], vcc
    s_cbranch_execz L_c_ct_3
    global_load_dword v109, v[4:5], off
L_c_ct_3:
    s_mov_b64 exec, s[26:27]
    s_load_dwordx4 s[8:11], s[0:1], 96
    v_lshrrev_b32 v5, 3, v0
    v_mul_u32_u24 v6, 24576, v5
    v_and_b32 v7, 7, v0
    v_lshl_add_u32 v6, v7, 4, v6
    v_add_u32 v7, 12288, v6
    v_lshlrev_b32 v5, 2, v5
    s_lshr_b32 s50, s2, 5
    s_and_b32 s51, s2, 31
    s_mul_i32 s52, s50, 1572864
    s_lshl_b32 s53, s51, 7
    s_add_u32 s52, s52, s53
    s_lshl_b32 s53, s50, 8
    s_waitcnt lgkmcnt(0)
    s_mov_b32 s28, s10
    s_and_b32 s29, s11, 0xffff
    s_mov_b32 s30, 0xc00000
    s_mov_b32 s31, 0x00020000
    s_mov_b32 s32, s8
    s_and_b32 s33, s9, 0xffff
    s_mov_b32 s34, 0x800
    s_mov_b32 s35, 0x00020000
    buffer_load_dword v8, v5, s[32:35], s53 offen
    buffer_load_dwordx4 v[12:15], v6, s[28:31], s52 offen
    buffer_load_dwordx4 v[16:19], v7, s[28:31], s52 offen
    s_getreg_b32 s39, hwreg(HW_REG_XCC_ID)
    s_and_b32 s39, s39, 7
    s_cmp_lg_u32 s44, 1
    s_cbranch_scc1 L_nz_7
    v_mov_b32 v32, 0
    v_mov_b32 v33, 0
    v_mov_b32 v34, 0
    v_mov_b32 v35, 0
    v_lshlrev_b32 v4, 4, v1
    s_lshl_b32 s45, s2, 10
    s_add_u32 s45, s45, 0x100000
    buffer_store_dwordx4 v[32:35], v4, s[12:15], s45 offen sc1
L_nz_7:
    s_waitcnt vmcnt(0)
    v_lshlrev_b32 v9, 16, v8
    v_and_b32 v10, 0xffff0000, v8
    v_mul_f32 v20, 0xbfb8aa3b, v9
    v_mul_f32 v21, 0xbfb8aa3b, v10
    v_exp_f32 v20, v20
    v_exp_f32 v21, v21
    s_nop 0
    v_add_f32 v20, 1.0, v20
    v_add_f32 v21, 1.0, v21
    v_rcp_f32 v20, v20
    v_rcp_f32 v21, v21
    s_nop 0
    v_mul_f32 v9, v9, v20
    v_mul_f32 v10, v10, v21
    v_cvt_pk_bf16_f32 v9, 0, v9
    v_cvt_pk_bf16_f32 v10, 0, v10
    v_lshlrev_b32 v28, 16, v12
    v_and_b32 v29, 0xffff0000, v12
    v_lshlrev_b32 v30, 16, v16
    v_and_b32 v31, 0xffff0000, v16
    v_mul_f32 v20, v28, v9
    v_mul_f32 v21, v29, v9
    v_fmac_f32 v20, v30, v10
    v_fmac_f32 v21, v31, v10
    v_lshlrev_b32 v28, 16, v13
    v_and_b32 v29, 0xffff0000, v13
    v_lshlrev_b32 v30, 16, v17
    v_and_b32 v31, 0xffff0000, v17
    v_mul_f32 v22, v28, v9
    v_mul_f32 v23, v29, v9
    v_fmac_f32 v22, v30, v10
    v_fmac_f32 v23, v31, v10
    v_lshlrev_b32 v28, 16, v14
    v_and_b32 v29, 0xffff0000, v14
    v_lshlrev_b32 v30, 16, v18
    v_and_b32 v31, 0xffff0000, v18
    v_mul_f32 v24, v28, v9
    v_mul_f32 v25, v29, v9
    v_fmac_f32 v24, v30, v10
    v_fmac_f32 v25, v31, v10
    v_lshlrev_b32 v28, 16, v15
    v_and_b32 v29, 0xffff0000, v15
    v_lshlrev_b32 v30, 16, v19
    v_and_b32 v31, 0xffff0000, v19
    v_mul_f32 v26, v28, v9
    v_mul_f32 v27, v29, v9
    v_fmac_f32 v26, v30, v10
    v_fmac_f32 v27, v31, v10
    s_nop 1
    v_add_f32_dpp v20, v20, v20 row_ror:8 row_mask:0xf bank_mask:0xf
    v_add_f32_dpp v21, v21, v21 row_ror:8 row_mask:0xf bank_mask:0xf
    v_add_f32_dpp v22, v22, v22 row_ror:8 row_mask:0xf bank_mask:0xf
    v_add_f32_dpp v23, v23, v23 row_ror:8 row_mask:0xf bank_mask:0xf
    v_add_f32_dpp v24, v24, v24 row_ror:8 row_mask:0xf bank_mask:0xf
    v_add_f32_dpp v25, v25, v25 row_ror:8 row_mask:0xf bank_mask:0xf
    v_add_f32_dpp v26, v26, v26 row_ror:8 row_mask:0xf bank_mask:0xf
    v_add_f32_dpp v27, v27, v27 row_ror:8 row_mask:0xf bank_mask:0xf
    s_nop 1
    v_permlane16_swap_b32 v20, v24
    v_permlane16_swap_b32 v21, v25
    v_permlane16_swap_b32 v22, v26
    v_permlane16_swap_b32 v23, v27
    v_add_f32 v20, v20, v24
    v_add_f32 v21, v21, v25
    v_add_f32 v22, v22, v26
    v_add_f32 v23, v23, v27
    s_nop 1
    v_permlane32_swap_b32 v20, v22
    v_permlane32_swap_b32 v21, v23
    v_add_f32 v20, v20, v22
    v_add_f32 v21, v21, v23
    v_and_b32 v22, 7, v1
    v_lshlrev_b32 v22, 5, v22
    v_bfe_u32 v23, v1, 4, 1
    v_lshl_add_u32 v22, v23, 4, v22
    v_lshrrev_b32 v23, 5, v1
    v_lshl_add_u32 v22, v23, 3, v22
    s_lshl_b32 s52, s44, 8
    s_add_u32 s52, s52, 139776
    v_add_u32 v22, s52, v22
    ds_write_b64 v22, v[20:21]
    s_waitcnt lgkmcnt(0)
    s_barrier
    s_cmp_lg_u32 s44, 1
    s_cbranch_scc1 L_m1_8
    v_lshlrev_b32 v22, 2, v1
    v_add_u32 v23, 139776, v22
    ds_read_b32 v24, v23 offset:0
    ds_read_b32 v25, v23 offset:256
    ds_read_b32 v26, v23 offset:512
    ds_read_b32 v27, v23 offset:768
    ds_read_b32 v28, v23 offset:1024
    ds_read_b32 v29, v23 offset:1280
    ds_read_b32 v30, v23 offset:1536
    ds_read_b32 v31, v23 offset:1792
    s_waitcnt lgkmcnt(0)
    v_add_f32 v24, v24, v28
    v_add_f32 v25, v25, v29
    v_add_f32 v26, v26, v30
    v_add_f32 v27, v27, v31
    v_add_f32 v24, v24, v26
    v_add_f32 v25, v25, v27
    v_add_f32 v24, v24, v25
    s_lshl_b32 s52, s2, 8
    s_add_u32 s52, s52, 0x10000
    buffer_store_dword v24, v22, s[12:15], s52 offen sc1
L_m1_8:
    s_cmp_lg_u32 s44, 1
    s_cbranch_scc1 L_tk_4
    v_mov_b32 v3, 1
    s_mov_b32 s40, s39
    s_lshl_b32 s45, s40, 5
    v_mov_b32 v4, 0
    s_waitcnt vmcnt(0)
    s_mov_b64 exec, 1
    buffer_atomic_add v3, v4, s[16:19], s45 offen sc0
    s_waitcnt vmcnt(0)
    v_readfirstlane_b32 s41, v3
    s_nop 3
    s_cmp_lt_u32 s41, 32
    s_cbranch_scc1 L_got_5
    v_mov_b32 v3, 1
    buffer_atomic_add v3, v4, s[16:19], 0 offen offset:16 sc0
    s_waitcnt vmcnt(0)
    v_readfirstlane_b32 s46, v3
    s_mov_b64 exec, -1
    v_and_b32 v4, 7, v1
    v_lshlrev_b32 v4, 5, v4
    s_mov_b32 s70, 0
L_sp_6:
    s_sleep 8
    buffer_load_dword v3, v4, s[16:19], 0 offen sc1
    s_waitcnt vmcnt(0)
    s_mov_b32 s48, 0
    v_readlane_b32 s50, v3, 0
    v_readlane_b32 s51, v3, 1
    v_readlane_b32 s52, v3, 2
    v_readlane_b32 s53, v3, 3
    v_readlane_b32 s54, v3, 4
    v_readlane_b32 s55, v3, 5
    v_readlane_b32 s56, v3, 6
    v_readlane_b32 s57, v3, 7
    s_nop 3
    s_add_u32 s48, s48, s50
    s_add_u32 s48, s48, s51
    s_add_u32 s48, s48, s52
    s_add_u32 s48, s48, s53
    s_add_u32 s48, s48, s54
    s_add_u32 s48, s48, s55
    s_add_u32 s48, s48, s56
    s_add_u32 s48, s48, s57
    s_add_u32 s70, s70, 1
    s_cmp_ge_u32 s70, 524288
    s_cbranch_scc1 L_c_done_1
    s_cmp_lt_u32 s48, 256
    s_cbranch_scc1 L_sp_6
    s_min_u32 s48, s50, 32
    s_mov_b32 s40, 0
    s_add_u32 s41, s48, s46
    s_cmp_lt_u32 s41, 32
    s_cbranch_scc1 L_got_5
    s_sub_u32 s46, s41, 32
    s_min_u32 s48, s51, 32
    s_mov_b32 s40, 1
    s_add_u32 s41, s48, s46
    s_cmp_lt_u32 s41, 32
    s_cbranch_scc1 L_got_5
    s_sub_u32 s46, s41, 32
    s_min_u32 s48, s52, 32
    s_mov_b32 s40, 2
    s_add_u32 s41, s48, s46
    s_cmp_lt_u32 s41, 32
    s_cbranch_scc1 L_got_5
    s_sub_u32 s46, s41, 32
    s_min_u32 s48, s53, 32
    s_mov_b32 s40, 3
    s_add_u32 s41, s48, s46
    s_cmp_lt_u32 s41, 32
    s_cbranch_scc1 L_got_5
    s_sub_u32 s46, s41, 32
    s_min_u32 s48, s54, 32
    s_mov_b32 s40, 4
    s_add_u32 s41, s48, s46
    s_cmp_lt_u32 s41, 32
    s_cbranch_scc1 L_got_5
    s_sub_u32 s46, s41, 32
    s_min_u32 s48, s55, 32
    s_mov_b32 s40, 5
    s_add_u32 s41, s48, s46
    s_cmp_lt_u32 s41, 32
    s_cbranch_scc1 L_got_5
    s_sub_u32 s46, s41, 32
    s_min_u32 s48, s56, 32
    s_mov_b32 s40, 6
    s_add_u32 s41, s48, s46
    s_cmp_lt_u32 s41, 32
    s_cbranch_scc1 L_got_5
    s_sub_u32 s46, s41, 32
    s_min_u32 s48, s57, 32
    s_mov_b32 s40, 7
    s_add_u32 s41, s48, s46
    s_cmp_lt_u32 s41, 32
    s_cbranch_scc1 L_got_5
    s_sub_u32 s46, s41, 32
    s_branch L_c_done_1
L_got_5:
    s_mov_b64 exec, -1
    s_lshl_b32 s45, s40, 8
    s_or_b32 s45, s45, s41
    v_mov_b32 v3, s45
    v_mov_b32 v4, 147464
    ds_write_b32 v4, v3
    s_waitcnt lgkmcnt(0)
L_tk_4:
    s_barrier
    v_mov_b32 v4, 147464
    ds_read_b32 v3, v4
    s_waitcnt lgkmcnt(0)
    v_readfirstlane_b32 s45, v3
    s_nop 3
    s_lshr_b32 s40, s45, 8
    s_and_b32 s41, s45, 0xff
    s_lshr_b32 s45, s40, 2
    s_xor_b32 s45, s45, 1
    s_lshl_b32 s45, s45, 4
    s_and_b32 s40, s40, 3
    s_lshl_b32 s40, s40, 1
    s_lshr_b32 s46, s41, 4
    s_add_u32 s40, s40, s46
    s_and_b32 s41, s41, 15
    s_add_u32 s41, s41, s45
    s_cmp_lt_u32 s41, 16
    s_cbranch_scc1 L_c_chain_9
    s_sub_u32 s48, s41, 16
    s_cmp_lt_u32 s48, 12
    s_cbranch_scc1 L_w_g_10
    s_and_b32 s42, s48, 3
    s_mov_b32 s43, s40
    s_load_dwordx2 s[4:5], s[0:1], 0
    v_lshlrev_b32 v2, 4, v1
    v_lshlrev_b32 v3, 5, v1
    s_lshl_b32 s55, s43, 2
    s_add_u32 s55, s55, s42
    s_waitcnt lgkmcnt(0)
    s_mov_b32 s24, s4
    s_and_b32 s25, s5, 0xffff
    s_mov_b32 s26, 0x400000
    s_mov_b32 s27, 0x00020000
    s_lshl_b32 s46, s42, 3
    s_add_u32 s46, s46, s44
    s_lshl_b32 s46, s46, 11
    v_add_u32 v7, s46, v2
    s_lshl_b32 s63, s43, 16
    buffer_load_dwordx4 a[0:3], v7, s[24:27], s63 offen
    buffer_load_dwordx4 a[4:7], v7, s[24:27], s63 offen offset:1024
    s_cmp_lg_u32 s44, 0
    s_cbranch_scc1 L_zwok_19
    v_and_b32 v8, 7, v1
    v_lshlrev_b32 v8, 5, v8
    s_mov_b32 s70, 0
L_zw_18:
    buffer_load_dword v9, v8, s[16:19], 0 offen sc1
    s_waitcnt vmcnt(0)
    v_add_u32_dpp v9, v9, v9 row_ror:1 row_mask:0xf bank_mask:0xf
    s_nop 1
    v_add_u32_dpp v9, v9, v9 row_ror:2 row_mask:0xf bank_mask:0xf
    s_nop 1
    v_add_u32_dpp v9, v9, v9 row_ror:4 row_mask:0xf bank_mask:0xf
    v_cmp_ne_u32 vcc, 0x100, v9
    s_add_u32 s70, s70, 1
    s_cbranch_vccz L_zwok_19
    s_sleep 4
    s_cmp_lt_u32 s70, 524288
    s_cbranch_scc1 L_zw_18
    s_branch L_c_done_1
L_zwok_19:
    s_barrier
    v_lshlrev_b32 v4, 4, v0
    s_mov_b32 s46, 0x10000
    buffer_load_dwordx4 v[32:35], v4, s[12:15], s46 offen sc1
    s_mov_b32 s46, 0x12000
    buffer_load_dwordx4 v[36:39], v4, s[12:15], s46 offen sc1
    s_mov_b32 s46, 0x14000
    buffer_load_dwordx4 v[40:43], v4, s[12:15], s46 offen sc1
    s_mov_b32 s46, 0x16000
    buffer_load_dwordx4 v[44:47], v4, s[12:15], s46 offen sc1
    s_mov_b32 s46, 0x18000
    buffer_load_dwordx4 v[48:51], v4, s[12:15], s46 offen sc1
    s_mov_b32 s46, 0x1a000
    buffer_load_dwordx4 v[52:55], v4, s[12:15], s46 offen sc1
    s_mov_b32 s46, 0x1c000
    buffer_load_dwordx4 v[56:59], v4, s[12:15], s46 offen sc1
    s_mov_b32 s46, 0x1e000
    buffer_load_dwordx4 v[60:63], v4, s[12:15], s46 offen sc1
    s_cmp_lg_u32 s44, 0
    s_cbranch_scc1 L_l_nx_20
    s_cmp_ge_u32 s42, 2
    s_cbranch_scc1 L_l_nx_20
    s_or_b32 s47, s39, 0x100
    v_mov_b32 v8, s47
    v_mov_b32 v9, 0
    s_lshl_b32 s46, s40, 3
    s_lshl_b32 s47, s42, 2
    s_add_u32 s46, s46, s47
    s_add_u32 s46, s46, 0x101200
    s_mov_b64 exec, 1
    buffer_store_dword v8, v9, s[12:15], s46 offen sc1
    s_mov_b64 exec, -1
L_l_nx_20:
    s_mul_i32 s46, s44, 2064
    s_add_u32 s46, s46, 32768
    v_add_u32 v10, s46, v2
    v_and_b32 v11, 7, v1
    v_lshrrev_b32 v12, 3, v1
    v_mul_u32_u24 v13, 2064, v11
    v_lshl_add_u32 v13, v12, 4, v13
    s_lshl_b32 s46, s44, 8
    s_add_u32 s46, s46, 32768
    v_add_u32 v13, s46, v13
    v_lshlrev_b32 v11, 4, v11
    v_lshl_add_u32 v11, v12, 9, v11
    s_lshl_b32 s46, s44, 13
    s_lshl_b32 s47, s42, 7
    s_add_u32 s46, s46, s47
    s_add_u32 s46, s46, 0x400000
    v_add_u32 v11, s46, v11
    v_add_u32 v12, 4096, v11
    s_lshl_b32 s52, s43, 9
    s_lshl_b32 s47, s42, 7
    s_add_u32 s52, s52, s47
    s_add_u32 s52, s52, 0x109400
    s_mov_b32 s60, s43
    s_waitcnt vmcnt(0)
    v_add_f32 v32, v32, v48
    v_add_f32 v33, v33, v49
    v_add_f32 v34, v34, v50
    v_add_f32 v35, v35, v51
    v_add_f32 v36, v36, v52
    v_add_f32 v37, v37, v53
    v_add_f32 v38, v38, v54
    v_add_f32 v39, v39, v55
    v_add_f32 v40, v40, v56
    v_add_f32 v41, v41, v57
    v_add_f32 v42, v42, v58
    v_add_f32 v43, v43, v59
    v_add_f32 v44, v44, v60
    v_add_f32 v45, v45, v61
    v_add_f32 v46, v46, v62
    v_add_f32 v47, v47, v63
    v_add_f32 v32, v32, v40
    v_add_f32 v33, v33, v41
    v_add_f32 v34, v34, v42
    v_add_f32 v35, v35, v43
    v_add_f32 v36, v36, v44
    v_add_f32 v37, v37, v45
    v_add_f32 v38, v38, v46
    v_add_f32 v39, v39, v47
    v_add_f32 v32, v32, v36
    v_add_f32 v33, v33, v37
    v_add_f32 v34, v34, v38
    v_add_f32 v35, v35, v39
    v_cvt_pk_bf16_f32 v32, 0, v32
    v_cvt_pk_bf16_f32 v33, 0, v33
    v_cvt_pk_bf16_f32 v34, 0, v34
    v_cvt_pk_bf16_f32 v35, 0, v35
    ds_write_b128 v4, v[32:35]
    s_waitcnt lgkmcnt(0)
    s_barrier
    ds_read_b128 v[48:51], v3 offset:0
    ds_read_b128 v[52:55], v3 offset:16
    ds_read_b128 v[56:59], v3 offset:2048
    ds_read_b128 v[60:63], v3 offset:2064
    ds_read_b128 v[32:35], v3 offset:4096
    ds_read_b128 v[36:39], v3 offset:4112
    ds_read_b128 v[40:43], v3 offset:6144
    ds_read_b128 v[44:47], v3 offset:6160
    s_waitcnt lgkmcnt(0)
    v_add_f32 v32, 1.0, v32
    v_add_f32 v33, 1.0, v33
    v_add_f32 v34, 1.0, v34
    v_add_f32 v35, 1.0, v35
    v_add_f32 v36, 1.0, v36
    v_add_f32 v37, 1.0, v37
    v_add_f32 v38, 1.0, v38
    v_add_f32 v39, 1.0, v39
    v_add_f32 v40, 1.0, v40
    v_add_f32 v41, 1.0, v41
    v_add_f32 v42, 1.0, v42
    v_add_f32 v43, 1.0, v43
    v_add_f32 v44, 1.0, v44
    v_add_f32 v45, 1.0, v45
    v_add_f32 v46, 1.0, v46
    v_add_f32 v47, 1.0, v47
    v_cvt_pk_bf16_f32 v32, 0, v32
    v_cvt_pk_bf16_f32 v33, 0, v33
    v_cvt_pk_bf16_f32 v34, 0, v34
    v_cvt_pk_bf16_f32 v35, 0, v35
    v_cvt_pk_bf16_f32 v36, 0, v36
    v_cvt_pk_bf16_f32 v37, 0, v37
    v_cvt_pk_bf16_f32 v38, 0, v38
    v_cvt_pk_bf16_f32 v39, 0, v39
    v_cvt_pk_bf16_f32 v40, 0, v40
    v_cvt_pk_bf16_f32 v41, 0, v41
    v_cvt_pk_bf16_f32 v42, 0, v42
    v_cvt_pk_bf16_f32 v43, 0, v43
    v_cvt_pk_bf16_f32 v44, 0, v44
    v_cvt_pk_bf16_f32 v45, 0, v45
    v_cvt_pk_bf16_f32 v46, 0, v46
    v_cvt_pk_bf16_f32 v47, 0, v47
L_l_sub_21:
    s_lshl_b32 s63, s60, 16
    v_accvgpr_read_b32 v96, a0
    v_accvgpr_read_b32 v97, a1
    v_accvgpr_read_b32 v98, a2
    v_accvgpr_read_b32 v99, a3
    v_accvgpr_read_b32 v100, a4
    v_accvgpr_read_b32 v101, a5
    v_accvgpr_read_b32 v102, a6
    v_accvgpr_read_b32 v103, a7
    v_lshlrev_b32 v64, 16, v96
    v_and_b32 v65, 0xffff0000, v96
    v_lshlrev_b32 v66, 16, v97
    v_and_b32 v67, 0xffff0000, v97
    v_lshlrev_b32 v68, 16, v98
    v_and_b32 v69, 0xffff0000, v98
    v_lshlrev_b32 v70, 16, v99
    v_and_b32 v71, 0xffff0000, v99
    v_lshlrev_b32 v72, 16, v100
    v_and_b32 v73, 0xffff0000, v100
    v_lshlrev_b32 v74, 16, v101
    v_and_b32 v75, 0xffff0000, v101
    v_lshlrev_b32 v76, 16, v102
    v_and_b32 v77, 0xffff0000, v102
    v_lshlrev_b32 v78, 16, v103
    v_and_b32 v79, 0xffff0000, v103
    v_pk_add_f32 v[80:81], v[64:65], v[72:73]
    v_pk_add_f32 v[82:83], v[66:67], v[74:75]
    v_pk_add_f32 v[84:85], v[68:69], v[76:77]
    v_pk_add_f32 v[86:87], v[70:71], v[78:79]
    v_pk_add_f32 v[80:81], v[80:81], v[84:85]
    v_pk_add_f32 v[82:83], v[82:83], v[86:87]
    v_pk_add_f32 v[80:81], v[80:81], v[82:83]
    v_add_f32 v14, v80, v81
    s_nop 1
    v_add_f32_dpp v14, v14, v14 row_shr:1 row_mask:0xf bank_mask:0xf bound_ctrl:0
    s_nop 1
    v_add_f32_dpp v14, v14, v14 row_shr:2 row_mask:0xf bank_mask:0xf bound_ctrl:0
    s_nop 1
    v_add_f32_dpp v14, v14, v14 row_shr:4 row_mask:0xf bank_mask:0xf bound_ctrl:0
    s_nop 1
    v_add_f32_dpp v14, v14, v14 row_shr:8 row_mask:0xf bank_mask:0xf bound_ctrl:0
    s_nop 1
    v_add_f32_dpp v14, v14, v14 row_bcast:15 row_mask:0xa bank_mask:0xf
    s_nop 1
    v_add_f32_dpp v14, v14, v14 row_bcast:31 row_mask:0xc bank_mask:0xf
    s_nop 1
    v_readlane_b32 s46, v14, 63
    s_nop 1
    v_mov_b32 v15, s46
    v_mul_f32 v15, 0x3a800000, v15
    v_pk_add_f32 v[80:81], v[64:65], v[14:15] op_sel:[0,1] op_sel_hi:[1,1] neg_lo:[0,1] neg_hi:[0,1]
    v_pk_add_f32 v[82:83], v[66:67], v[14:15] op_sel:[0,1] op_sel_hi:[1,1] neg_lo:[0,1] neg_hi:[0,1]
    v_pk_add_f32 v[84:85], v[68:69], v[14:15] op_sel:[0,1] op_sel_hi:[1,1] neg_lo:[0,1] neg_hi:[0,1]
    v_pk_add_f32 v[86:87], v[70:71], v[14:15] op_sel:[0,1] op_sel_hi:[1,1] neg_lo:[0,1] neg_hi:[0,1]
    v_pk_add_f32 v[88:89], v[72:73], v[14:15] op_sel:[0,1] op_sel_hi:[1,1] neg_lo:[0,1] neg_hi:[0,1]
    v_pk_add_f32 v[90:91], v[74:75], v[14:15] op_sel:[0,1] op_sel_hi:[1,1] neg_lo:[0,1] neg_hi:[0,1]
    v_pk_add_f32 v[92:93], v[76:77], v[14:15] op_sel:[0,1] op_sel_hi:[1,1] neg_lo:[0,1] neg_hi:[0,1]
    v_pk_add_f32 v[94:95], v[78:79], v[14:15] op_sel:[0,1] op_sel_hi:[1,1] neg_lo:[0,1] neg_hi:[0,1]
    v_pk_mul_f32 v[104:105], v[80:81], v[80:81]
    v_pk_mul_f32 v[106:107], v[82:83], v[82:83]
    v_pk_fma_f32 v[104:105], v[84:85], v[84:85], v[104:105]
    v_pk_fma_f32 v[106:107], v[86:87], v[86:87], v[106:107]
    v_pk_fma_f32 v[104:105], v[88:89], v[88:89], v[104:105]
    v_pk_fma_f32 v[106:107], v[90:91], v[90:91], v[106:107]
    v_pk_fma_f32 v[104:105], v[92:93], v[92:93], v[104:105]
    v_pk_fma_f32 v[106:107], v[94:95], v[94:95], v[106:107]
    v_pk_add_f32 v[104:105], v[104:105], v[106:107]
    v_add_f32 v14, v104, v105
    v_cvt_pk_bf16_f32 v15, 0, v15
    s_nop 1
    v_add_f32_dpp v14, v14, v14 row_shr:1 row_mask:0xf bank_mask:0xf bound_ctrl:0
    s_nop 1
    v_add_f32_dpp v14, v14, v14 row_shr:2 row_mask:0xf bank_mask:0xf bound_ctrl:0
    s_nop 1
    v_add_f32_dpp v14, v14, v14 row_shr:4 row_mask:0xf bank_mask:0xf bound_ctrl:0
    s_nop 1
    v_add_f32_dpp v14, v14, v14 row_shr:8 row_mask:0xf bank_mask:0xf bound_ctrl:0
    s_nop 1
    v_add_f32_dpp v14, v14, v14 row_bcast:15 row_mask:0xa bank_mask:0xf
    s_nop 1
    v_add_f32_dpp v14, v14, v14 row_bcast:31 row_mask:0xc bank_mask:0xf
    s_nop 1
    v_readlane_b32 s47, v14, 63
    v_pk_add_f32 v[64:65], v[64:65], v[14:15] op_sel:[0,1] op_sel_hi:[1,1] neg_lo:[0,1] neg_hi:[0,1]
    v_pk_add_f32 v[66:67], v[66:67], v[14:15] op_sel:[0,1] op_sel_hi:[1,1] neg_lo:[0,1] neg_hi:[0,1]
    v_pk_add_f32 v[68:69], v[68:69], v[14:15] op_sel:[0,1] op_sel_hi:[1,1] neg_lo:[0,1] neg_hi:[0,1]
    v_pk_add_f32 v[70:71], v[70:71], v[14:15] op_sel:[0,1] op_sel_hi:[1,1] neg_lo:[0,1] neg_hi:[0,1]
    v_pk_add_f32 v[72:73], v[72:73], v[14:15] op_sel:[0,1] op_sel_hi:[1,1] neg_lo:[0,1] neg_hi:[0,1]
    v_pk_add_f32 v[74:75], v[74:75], v[14:15] op_sel:[0,1] op_sel_hi:[1,1] neg_lo:[0,1] neg_hi:[0,1]
    v_pk_add_f32 v[76:77], v[76:77], v[14:15] op_sel:[0,1] op_sel_hi:[1,1] neg_lo:[0,1] neg_hi:[0,1]
    v_pk_add_f32 v[78:79], v[78:79], v[14:15] op_sel:[0,1] op_sel_hi:[1,1] neg_lo:[0,1] neg_hi:[0,1]
    v_mov_b32 v14, s47
    v_mul_f32 v14, 0x3a800000, v14
    v_cvt_pk_bf16_f32 v14, 0, v14
    v_add_f32 v14, 0x3727c5ac, v14
    v_cvt_pk_bf16_f32 v14, 0, v14
    v_sqrt_f32 v14, v14
    s_nop 0
    v_cvt_pk_bf16_f32 v14, 0, v14
    v_rcp_f32 v14, v14
    v_cvt_pk_bf16_f32 v64, 0, v64
    v_cvt_pk_bf16_f32 v65, 0, v65
    v_cvt_pk_bf16_f32 v66, 0, v66
    v_cvt_pk_bf16_f32 v67, 0, v67
    v_cvt_pk_bf16_f32 v68, 0, v68
    v_cvt_pk_bf16_f32 v69, 0, v69
    v_cvt_pk_bf16_f32 v70, 0, v70
    v_cvt_pk_bf16_f32 v71, 0, v71
    v_cvt_pk_bf16_f32 v72, 0, v72
    v_cvt_pk_bf16_f32 v73, 0, v73
    v_cvt_pk_bf16_f32 v74, 0, v74
    v_cvt_pk_bf16_f32 v75, 0, v75
    v_cvt_pk_bf16_f32 v76, 0, v76
    v_cvt_pk_bf16_f32 v77, 0, v77
    v_cvt_pk_bf16_f32 v78, 0, v78
    v_cvt_pk_bf16_f32 v79, 0, v79
    v_pk_mul_f32 v[64:65], v[64:65], v[14:15] op_sel_hi:[1,0]
    v_pk_mul_f32 v[66:67], v[66:67], v[14:15] op_sel_hi:[1,0]
    v_pk_mul_f32 v[68:69], v[68:69], v[14:15] op_sel_hi:[1,0]
    v_pk_mul_f32 v[70:71], v[70:71], v[14:15] op_sel_hi:[1,0]
    v_pk_mul_f32 v[72:73], v[72:73], v[14:15] op_sel_hi:[1,0]
    v_pk_mul_f32 v[74:75], v[74:75], v[14:15] op_sel_hi:[1,0]
    v_pk_mul_f32 v[76:77], v[76:77], v[14:15] op_sel_hi:[1,0]
    v_pk_mul_f32 v[78:79], v[78:79], v[14:15] op_sel_hi:[1,0]
    v_cvt_pk_bf16_f32 v64, 0, v64
    v_cvt_pk_bf16_f32 v65, 0, v65
    v_cvt_pk_bf16_f32 v66, 0, v66
    v_cvt_pk_bf16_f32 v67, 0, v67
    v_cvt_pk_bf16_f32 v68, 0, v68
    v_cvt_pk_bf16_f32 v69, 0, v69
    v_cvt_pk_bf16_f32 v70, 0, v70
    v_cvt_pk_bf16_f32 v71, 0, v71
    v_cvt_pk_bf16_f32 v72, 0, v72
    v_cvt_pk_bf16_f32 v73, 0, v73
    v_cvt_pk_bf16_f32 v74, 0, v74
    v_cvt_pk_bf16_f32 v75, 0, v75
    v_cvt_pk_bf16_f32 v76, 0, v76
    v_cvt_pk_bf16_f32 v77, 0, v77
    v_cvt_pk_bf16_f32 v78, 0, v78
    v_cvt_pk_bf16_f32 v79, 0, v79
    v_pk_mul_f32 v[64:65], v[64:65], v[32:33]
    v_pk_mul_f32 v[66:67], v[66:67], v[34:35]
    v_pk_mul_f32 v[68:69], v[68:69], v[36:37]
    v_pk_mul_f32 v[70:71], v[70:71], v[38:39]
    v_pk_mul_f32 v[72:73], v[72:73], v[40:41]
    v_pk_mul_f32 v[74:75], v[74:75], v[42:43]
    v_pk_mul_f32 v[76:77], v[76:77], v[44:45]
    v_pk_mul_f32 v[78:79], v[78:79], v[46:47]
    v_cvt_pk_bf16_f32 v64, 0, v64
    v_cvt_pk_bf16_f32 v65, 0, v65
    v_cvt_pk_bf16_f32 v66, 0, v66
    v_cvt_pk_bf16_f32 v67, 0, v67
    v_cvt_pk_bf16_f32 v68, 0, v68
    v_cvt_pk_bf16_f32 v69, 0, v69
    v_cvt_pk_bf16_f32 v70, 0, v70
    v_cvt_pk_bf16_f32 v71, 0, v71
    v_cvt_pk_bf16_f32 v72, 0, v72
    v_cvt_pk_bf16_f32 v73, 0, v73
    v_cvt_pk_bf16_f32 v74, 0, v74
    v_cvt_pk_bf16_f32 v75, 0, v75
    v_cvt_pk_bf16_f32 v76, 0, v76
    v_cvt_pk_bf16_f32 v77, 0, v77
    v_cvt_pk_bf16_f32 v78, 0, v78
    v_cvt_pk_bf16_f32 v79, 0, v79
    v_pk_add_f32 v[64:65], v[64:65], v[48:49]
    v_pk_add_f32 v[66:67], v[66:67], v[50:51]
    v_pk_add_f32 v[68:69], v[68:69], v[52:53]
    v_pk_add_f32 v[70:71], v[70:71], v[54:55]
    v_pk_add_f32 v[72:73], v[72:73], v[56:57]
    v_pk_add_f32 v[74:75], v[74:75], v[58:59]
    v_pk_add_f32 v[76:77], v[76:77], v[60:61]
    v_pk_add_f32 v[78:79], v[78:79], v[62:63]
    v_cvt_pk_bf16_f32 v104, v64, v65
    v_cvt_pk_bf16_f32 v105, v66, v67
    v_cvt_pk_bf16_f32 v106, v68, v69
    v_cvt_pk_bf16_f32 v107, v70, v71
    v_cvt_pk_bf16_f32 v108, v72, v73
    v_cvt_pk_bf16_f32 v109, v74, v75
    v_cvt_pk_bf16_f32 v110, v76, v77
    v_cvt_pk_bf16_f32 v111, v78, v79
    ds_write_b128 v10, v[104:107]
    ds_write_b128 v10, v[108:111] offset:1024
    s_waitcnt lgkmcnt(0)
    s_barrier
    ds_read_b128 v[104:107], v13
    ds_read_b128 v[108:111], v13 offset:128
    s_waitcnt lgkmcnt(1)
    buffer_store_dwordx4 v[104:107], v11, s[12:15], s63 offen sc1
    s_waitcnt lgkmcnt(0)
    buffer_store_dwordx4 v[108:111], v12, s[12:15], s63 offen sc1
    s_waitcnt vmcnt(0)
    s_barrier
    s_cmp_lg_u32 s44, 0
    s_cbranch_scc1 L_sf_23
    v_mov_b32 v14, s60
    v_add_u32 v14, 1, v14
    v_mov_b32 v15, 0
    s_mov_b64 exec, 1
    buffer_store_dword v14, v15, s[12:15], s52 offen sc1
    s_mov_b64 exec, -1
L_sf_23:
    s_cmp_ge_u32 s60, 8
    s_cbranch_scc1 L_l_end_22
    s_add_u32 s63, s63, 524288
    buffer_load_dwordx4 a[8:11], v7, s[24:27], s63 offen
    buffer_load_dwordx4 a[12:15], v7, s[24:27], s63 offen offset:1024
    s_add_u32 s63, s63, 524288
    buffer_load_dwordx4 a[16:19], v7, s[24:27], s63 offen
    buffer_load_dwordx4 a[20:23], v7, s[24:27], s63 offen offset:1024
    s_add_u32 s63, s63, 524288
    buffer_load_dwordx4 a[24:27], v7, s[24:27], s63 offen
    buffer_load_dwordx4 a[28:31], v7, s[24:27], s63 offen offset:1024
    s_add_u32 s63, s63, 524288
    buffer_load_dwordx4 a[32:35], v7, s[24:27], s63 offen
    buffer_load_dwordx4 a[36:39], v7, s[24:27], s63 offen offset:1024
    s_add_u32 s63, s63, 524288
    buffer_load_dwordx4 a[40:43], v7, s[24:27], s63 offen
    buffer_load_dwordx4 a[44:47], v7, s[24:27], s63 offen offset:1024
    s_add_u32 s63, s63, 524288
    buffer_load_dwordx4 a[48:51], v7, s[24:27], s63 offen
    buffer_load_dwordx4 a[52:55], v7, s[24:27], s63 offen offset:1024
    s_add_u32 s63, s63, 524288
    buffer_load_dwordx4 a[56:59], v7, s[24:27], s63 offen
    buffer_load_dwordx4 a[60:63], v7, s[24:27], s63 offen offset:1024
    s_waitcnt vmcnt(0)
L_l_end_22:
    v_accvgpr_mov_b32 a0, a8
    v_accvgpr_mov_b32 a1, a9
    v_accvgpr_mov_b32 a2, a10
    v_accvgpr_mov_b32 a3, a11
    v_accvgpr_mov_b32 a4, a12
    v_accvgpr_mov_b32 a5, a13
    v_accvgpr_mov_b32 a6, a14
    v_accvgpr_mov_b32 a7, a15
    v_accvgpr_mov_b32 a8, a16
    v_accvgpr_mov_b32 a9, a17
    v_accvgpr_mov_b32 a10, a18
    v_accvgpr_mov_b32 a11, a19
    v_accvgpr_mov_b32 a12, a20
    v_accvgpr_mov_b32 a13, a21
    v_accvgpr_mov_b32 a14, a22
    v_accvgpr_mov_b32 a15, a23
    v_accvgpr_mov_b32 a16, a24
    v_accvgpr_mov_b32 a17, a25
    v_accvgpr_mov_b32 a18, a26
    v_accvgpr_mov_b32 a19, a27
    v_accvgpr_mov_b32 a20, a28
    v_accvgpr_mov_b32 a21, a29
    v_accvgpr_mov_b32 a22, a30
    v_accvgpr_mov_b32 a23, a31
    v_accvgpr_mov_b32 a24, a32
    v_accvgpr_mov_b32 a25, a33
    v_accvgpr_mov_b32 a26, a34
    v_accvgpr_mov_b32 a27, a35
    v_accvgpr_mov_b32 a28, a36
    v_accvgpr_mov_b32 a29, a37
    v_accvgpr_mov_b32 a30, a38
    v_accvgpr_mov_b32 a31, a39
    v_accvgpr_mov_b32 a32, a40
    v_accvgpr_mov_b32 a33, a41
    v_accvgpr_mov_b32 a34, a42
    v_accvgpr_mov_b32 a35, a43
    v_accvgpr_mov_b32 a36, a44
    v_accvgpr_mov_b32 a37, a45
    v_accvgpr_mov_b32 a38, a46
    v_accvgpr_mov_b32 a39, a47
    v_accvgpr_mov_b32 a40, a48
    v_accvgpr_mov_b32 a41, a49
    v_accvgpr_mov_b32 a42, a50
    v_accvgpr_mov_b32 a43, a51
    v_accvgpr_mov_b32 a44, a52
    v_accvgpr_mov_b32 a45, a53
    v_accvgpr_mov_b32 a46, a54
    v_accvgpr_mov_b32 a47, a55
    v_accvgpr_mov_b32 a48, a56
    v_accvgpr_mov_b32 a49, a57
    v_accvgpr_mov_b32 a50, a58
    v_accvgpr_mov_b32 a51, a59
    v_accvgpr_mov_b32 a52, a60
    v_accvgpr_mov_b32 a53, a61
    v_accvgpr_mov_b32 a54, a62
    v_accvgpr_mov_b32 a55, a63
    s_add_u32 s60, s60, 8
    s_cmp_lt_u32 s60, 64
    s_cbranch_scc1 L_l_sub_21
    s_cmp_lt_u32 s48, 14
    s_cbranch_scc1 L_w_h_17_s
    s_and_b32 s55, s48, 1
    s_lshl_b32 s55, s55, 3
    s_add_u32 s55, s55, s40
    s_load_dwordx4 s[8:11], s[0:1], 96
    v_lshrrev_b32 v5, 3, v0
    s_mov_b32 s46, 196608
    v_mul_lo_u32 v4, v5, s46
    v_and_b32 v6, 7, v0
    v_lshl_add_u32 v4, v6, 4, v4
    v_lshlrev_b32 v5, 5, v5
    s_waitcnt lgkmcnt(0)
    s_mov_b32 s28, s10
    s_and_b32 s29, s11, 0xffff
    s_mov_b32 s30, 0xc00000
    s_mov_b32 s31, 0x00020000
    s_mov_b32 s32, s8
    s_and_b32 s33, s9, 0xffff
    s_mov_b32 s34, 0x800
    s_mov_b32 s35, 0x00020000
    buffer_load_dwordx4 v[8:11], v5, s[32:35], 0 offen
    buffer_load_dwordx4 v[12:15], v5, s[32:35], 0 offen offset:16
    s_waitcnt vmcnt(0)
    v_lshlrev_b32 v16, 16, v8
    v_and_b32 v17, 0xffff0000, v8
    v_lshlrev_b32 v18, 16, v9
    v_and_b32 v19, 0xffff0000, v9
    v_lshlrev_b32 v20, 16, v10
    v_and_b32 v21, 0xffff0000, v10
    v_lshlrev_b32 v22, 16, v11
    v_and_b32 v23, 0xffff0000, v11
    v_lshlrev_b32 v24, 16, v12
    v_and_b32 v25, 0xffff0000, v12
    v_lshlrev_b32 v26, 16, v13
    v_and_b32 v27, 0xffff0000, v13
    v_lshlrev_b32 v28, 16, v14
    v_and_b32 v29, 0xffff0000, v14
    v_lshlrev_b32 v30, 16, v15
    v_and_b32 v31, 0xffff0000, v15
    v_mul_f32 v112, 0xbfb8aa3b, v16
    v_mul_f32 v113, 0xbfb8aa3b, v17
    v_mul_f32 v114, 0xbfb8aa3b, v18
    v_mul_f32 v115, 0xbfb8aa3b, v19
    v_mul_f32 v116, 0xbfb8aa3b, v20
    v_mul_f32 v117, 0xbfb8aa3b, v21
    v_mul_f32 v118, 0xbfb8aa3b, v22
    v_mul_f32 v119, 0xbfb8aa3b, v23
    v_mul_f32 v120, 0xbfb8aa3b, v24
    v_mul_f32 v121, 0xbfb8aa3b, v25
    v_mul_f32 v122, 0xbfb8aa3b, v26
    v_mul_f32 v123, 0xbfb8aa3b, v27
    v_mul_f32 v124, 0xbfb8aa3b, v28
    v_mul_f32 v125, 0xbfb8aa3b, v29
    v_mul_f32 v126, 0xbfb8aa3b, v30
    v_mul_f32 v127, 0xbfb8aa3b, v31
    v_exp_f32 v112, v112
    v_exp_f32 v113, v113
    v_exp_f32 v114, v114
    v_exp_f32 v115, v115
    v_exp_f32 v116, v116
    v_exp_f32 v117, v117
    v_exp_f32 v118, v118
    v_exp_f32 v119, v119
    v_exp_f32 v120, v120
    v_exp_f32 v121, v121
    v_exp_f32 v122, v122
    v_exp_f32 v123, v123
    v_exp_f32 v124, v124
    v_exp_f32 v125, v125
    v_exp_f32 v126, v126
    v_exp_f32 v127, v127
    v_add_f32 v112, 1.0, v112
    v_add_f32 v113, 1.0, v113
    v_add_f32 v114, 1.0, v114
    v_add_f32 v115, 1.0, v115
    v_add_f32 v116, 1.0, v116
    v_add_f32 v117, 1.0, v117
    v_add_f32 v118, 1.0, v118
    v_add_f32 v119, 1.0, v119
    v_add_f32 v120, 1.0, v120
    v_add_f32 v121, 1.0, v121
    v_add_f32 v122, 1.0, v122
    v_add_f32 v123, 1.0, v123
    v_add_f32 v124, 1.0, v124
    v_add_f32 v125, 1.0, v125
    v_add_f32 v126, 1.0, v126
    v_add_f32 v127, 1.0, v127
    v_rcp_f32 v112, v112
    v_rcp_f32 v113, v113
    v_rcp_f32 v114, v114
    v_rcp_f32 v115, v115
    v_rcp_f32 v116, v116
    v_rcp_f32 v117, v117
    v_rcp_f32 v118, v118
    v_rcp_f32 v119, v119
    v_rcp_f32 v120, v120
    v_rcp_f32 v121, v121
    v_rcp_f32 v122, v122
    v_rcp_f32 v123, v123
    v_rcp_f32 v124, v124
    v_rcp_f32 v125, v125
    v_rcp_f32 v126, v126
    v_rcp_f32 v127, v127
    v_mul_f32 v16, v16, v112
    v_mul_f32 v17, v17, v113
    v_mul_f32 v18, v18, v114
    v_mul_f32 v19, v19, v115
    v_mul_f32 v20, v20, v116
    v_mul_f32 v21, v21, v117
    v_mul_f32 v22, v22, v118
    v_mul_f32 v23, v23, v119
    v_mul_f32 v24, v24, v120
    v_mul_f32 v25, v25, v121
    v_mul_f32 v26, v26, v122
    v_mul_f32 v27, v27, v123
    v_mul_f32 v28, v28, v124
    v_mul_f32 v29, v29, v125
    v_mul_f32 v30, v30, v126
    v_mul_f32 v31, v31, v127
    v_cvt_pk_bf16_f32 v16, 0, v16
    v_cvt_pk_bf16_f32 v17, 0, v17
    v_cvt_pk_bf16_f32 v18, 0, v18
    v_cvt_pk_bf16_f32 v19, 0, v19
    v_cvt_pk_bf16_f32 v20, 0, v20
    v_cvt_pk_bf16_f32 v21, 0, v21
    v_cvt_pk_bf16_f32 v22, 0, v22
    v_cvt_pk_bf16_f32 v23, 0, v23
    v_cvt_pk_bf16_f32 v24, 0, v24
    v_cvt_pk_bf16_f32 v25, 0, v25
    v_cvt_pk_bf16_f32 v26, 0, v26
    v_cvt_pk_bf16_f32 v27, 0, v27
    v_cvt_pk_bf16_f32 v28, 0, v28
    v_cvt_pk_bf16_f32 v29, 0, v29
    v_cvt_pk_bf16_f32 v30, 0, v30
    v_cvt_pk_bf16_f32 v31, 0, v31
    s_lshl_b32 s53, s55, 9
    s_add_u32 s53, s53, 4096
L_m_loop_24:
    s_add_u32 s46, s53, 0
    buffer_load_dwordx4 v[32:35], v4, s[28:31], s46 offen
    s_add_u32 s46, s53, 12288
    buffer_load_dwordx4 v[36:39], v4, s[28:31], s46 offen
    s_add_u32 s46, s53, 24576
    buffer_load_dwordx4 v[40:43], v4, s[28:31], s46 offen
    s_add_u32 s46, s53, 36864
    buffer_load_dwordx4 v[44:47], v4, s[28:31], s46 offen
    s_add_u32 s46, s53, 49152
    buffer_load_dwordx4 v[48:51], v4, s[28:31], s46 offen
    s_add_u32 s46, s53, 61440
    buffer_load_dwordx4 v[52:55], v4, s[28:31], s46 offen
    s_add_u32 s46, s53, 73728
    buffer_load_dwordx4 v[56:59], v4, s[28:31], s46 offen
    s_add_u32 s46, s53, 86016
    buffer_load_dwordx4 v[60:63], v4, s[28:31], s46 offen
    s_add_u32 s46, s53, 98304
    buffer_load_dwordx4 v[64:67], v4, s[28:31], s46 offen
    s_add_u32 s46, s53, 110592
    buffer_load_dwordx4 v[68:71], v4, s[28:31], s46 offen
    s_add_u32 s46, s53, 122880
    buffer_load_dwordx4 v[72:75], v4, s[28:31], s46 offen
    s_add_u32 s46, s53, 135168
    buffer_load_dwordx4 v[76:79], v4, s[28:31], s46 offen
    s_add_u32 s46, s53, 147456
    buffer_load_dwordx4 v[80:83], v4, s[28:31], s46 offen
    s_add_u32 s46, s53, 159744
    buffer_load_dwordx4 v[84:87], v4, s[28:31], s46 offen
    s_add_u32 s46, s53, 172032
    buffer_load_dwordx4 v[88:91], v4, s[28:31], s46 offen
    s_add_u32 s46, s53, 184320
    buffer_load_dwordx4 v[92:95], v4, s[28:31], s46 offen
    s_waitcnt vmcnt(15)
    v_lshlrev_b32 v104, 16, v32
    v_and_b32 v105, 0xffff0000, v32
    v_mul_f32 v96, v104, v16
    v_mul_f32 v97, v105, v16
    v_lshlrev_b32 v104, 16, v33
    v_and_b32 v105, 0xffff0000, v33
    v_mul_f32 v98, v104, v16
    v_mul_f32 v99, v105, v16
    v_lshlrev_b32 v104, 16, v34
    v_and_b32 v105, 0xffff0000, v34
    v_mul_f32 v100, v104, v16
    v_mul_f32 v101, v105, v16
    v_lshlrev_b32 v104, 16, v35
    v_and_b32 v105, 0xffff0000, v35
    v_mul_f32 v102, v104, v16
    v_mul_f32 v103, v105, v16
    s_waitcnt vmcnt(14)
    v_lshlrev_b32 v104, 16, v36
    v_and_b32 v105, 0xffff0000, v36
    v_fmac_f32 v96, v104, v17
    v_fmac_f32 v97, v105, v17
    v_lshlrev_b32 v104, 16, v37
    v_and_b32 v105, 0xffff0000, v37
    v_fmac_f32 v98, v104, v17
    v_fmac_f32 v99, v105, v17
    v_lshlrev_b32 v104, 16, v38
    v_and_b32 v105, 0xffff0000, v38
    v_fmac_f32 v100, v104, v17
    v_fmac_f32 v101, v105, v17
    v_lshlrev_b32 v104, 16, v39
    v_and_b32 v105, 0xffff0000, v39
    v_fmac_f32 v102, v104, v17
    v_fmac_f32 v103, v105, v17
    s_waitcnt vmcnt(13)
    v_lshlrev_b32 v104, 16, v40
    v_and_b32 v105, 0xffff0000, v40
    v_fmac_f32 v96, v104, v18
    v_fmac_f32 v97, v105, v18
    v_lshlrev_b32 v104, 16, v41
    v_and_b32 v105, 0xffff0000, v41
    v_fmac_f32 v98, v104, v18
    v_fmac_f32 v99, v105, v18
    v_lshlrev_b32 v104, 16, v42
    v_and_b32 v105, 0xffff0000, v42
    v_fmac_f32 v100, v104, v18
    v_fmac_f32 v101, v105, v18
    v_lshlrev_b32 v104, 16, v43
    v_and_b32 v105, 0xffff0000, v43
    v_fmac_f32 v102, v104, v18
    v_fmac_f32 v103, v105, v18
    s_waitcnt vmcnt(12)
    v_lshlrev_b32 v104, 16, v44
    v_and_b32 v105, 0xffff0000, v44
    v_fmac_f32 v96, v104, v19
    v_fmac_f32 v97, v105, v19
    v_lshlrev_b32 v104, 16, v45
    v_and_b32 v105, 0xffff0000, v45
    v_fmac_f32 v98, v104, v19
    v_fmac_f32 v99, v105, v19
    v_lshlrev_b32 v104, 16, v46
    v_and_b32 v105, 0xffff0000, v46
    v_fmac_f32 v100, v104, v19
    v_fmac_f32 v101, v105, v19
    v_lshlrev_b32 v104, 16, v47
    v_and_b32 v105, 0xffff0000, v47
    v_fmac_f32 v102, v104, v19
    v_fmac_f32 v103, v105, v19
    s_waitcnt vmcnt(11)
    v_lshlrev_b32 v104, 16, v48
    v_and_b32 v105, 0xffff0000, v48
    v_fmac_f32 v96, v104, v20
    v_fmac_f32 v97, v105, v20
    v_lshlrev_b32 v104, 16, v49
    v_and_b32 v105, 0xffff0000, v49
    v_fmac_f32 v98, v104, v20
    v_fmac_f32 v99, v105, v20
    v_lshlrev_b32 v104, 16, v50
    v_and_b32 v105, 0xffff0000, v50
    v_fmac_f32 v100, v104, v20
    v_fmac_f32 v101, v105, v20
    v_lshlrev_b32 v104, 16, v51
    v_and_b32 v105, 0xffff0000, v51
    v_fmac_f32 v102, v104, v20
    v_fmac_f32 v103, v105, v20
    s_waitcnt vmcnt(10)
    v_lshlrev_b32 v104, 16, v52
    v_and_b32 v105, 0xffff0000, v52
    v_fmac_f32 v96, v104, v21
    v_fmac_f32 v97, v105, v21
    v_lshlrev_b32 v104, 16, v53
    v_and_b32 v105, 0xffff0000, v53
    v_fmac_f32 v98, v104, v21
    v_fmac_f32 v99, v105, v21
    v_lshlrev_b32 v104, 16, v54
    v_and_b32 v105, 0xffff0000, v54
    v_fmac_f32 v100, v104, v21
    v_fmac_f32 v101, v105, v21
    v_lshlrev_b32 v104, 16, v55
    v_and_b32 v105, 0xffff0000, v55
    v_fmac_f32 v102, v104, v21
    v_fmac_f32 v103, v105, v21
    s_waitcnt vmcnt(9)
    v_lshlrev_b32 v104, 16, v56
    v_and_b32 v105, 0xffff0000, v56
    v_fmac_f32 v96, v104, v22
    v_fmac_f32 v97, v105, v22
    v_lshlrev_b32 v104, 16, v57
    v_and_b32 v105, 0xffff0000, v57
    v_fmac_f32 v98, v104, v22
    v_fmac_f32 v99, v105, v22
    v_lshlrev_b32 v104, 16, v58
    v_and_b32 v105, 0xffff0000, v58
    v_fmac_f32 v100, v104, v22
    v_fmac_f32 v101, v105, v22
    v_lshlrev_b32 v104, 16, v59
    v_and_b32 v105, 0xffff0000, v59
    v_fmac_f32 v102, v104, v22
    v_fmac_f32 v103, v105, v22
    s_waitcnt vmcnt(8)
    v_lshlrev_b32 v104, 16, v60
    v_and_b32 v105, 0xffff0000, v60
    v_fmac_f32 v96, v104, v23
    v_fmac_f32 v97, v105, v23
    v_lshlrev_b32 v104, 16, v61
    v_and_b32 v105, 0xffff0000, v61
    v_fmac_f32 v98, v104, v23
    v_fmac_f32 v99, v105, v23
    v_lshlrev_b32 v104, 16, v62
    v_and_b32 v105, 0xffff0000, v62
    v_fmac_f32 v100, v104, v23
    v_fmac_f32 v101, v105, v23
    v_lshlrev_b32 v104, 16, v63
    v_and_b32 v105, 0xffff0000, v63
    v_fmac_f32 v102, v104, v23
    v_fmac_f32 v103, v105, v23
    s_waitcnt vmcnt(7)
    v_lshlrev_b32 v104, 16, v64
    v_and_b32 v105, 0xffff0000, v64
    v_fmac_f32 v96, v104, v24
    v_fmac_f32 v97, v105, v24
    v_lshlrev_b32 v104, 16, v65
    v_and_b32 v105, 0xffff0000, v65
    v_fmac_f32 v98, v104, v24
    v_fmac_f32 v99, v105, v24
    v_lshlrev_b32 v104, 16, v66
    v_and_b32 v105, 0xffff0000, v66
    v_fmac_f32 v100, v104, v24
    v_fmac_f32 v101, v105, v24
    v_lshlrev_b32 v104, 16, v67
    v_and_b32 v105, 0xffff0000, v67
    v_fmac_f32 v102, v104, v24
    v_fmac_f32 v103, v105, v24
    s_waitcnt vmcnt(6)
    v_lshlrev_b32 v104, 16, v68
    v_and_b32 v105, 0xffff0000, v68
    v_fmac_f32 v96, v104, v25
    v_fmac_f32 v97, v105, v25
    v_lshlrev_b32 v104, 16, v69
    v_and_b32 v105, 0xffff0000, v69
    v_fmac_f32 v98, v104, v25
    v_fmac_f32 v99, v105, v25
    v_lshlrev_b32 v104, 16, v70
    v_and_b32 v105, 0xffff0000, v70
    v_fmac_f32 v100, v104, v25
    v_fmac_f32 v101, v105, v25
    v_lshlrev_b32 v104, 16, v71
    v_and_b32 v105, 0xffff0000, v71
    v_fmac_f32 v102, v104, v25
    v_fmac_f32 v103, v105, v25
    s_waitcnt vmcnt(5)
    v_lshlrev_b32 v104, 16, v72
    v_and_b32 v105, 0xffff0000, v72
    v_fmac_f32 v96, v104, v26
    v_fmac_f32 v97, v105, v26
    v_lshlrev_b32 v104, 16, v73
    v_and_b32 v105, 0xffff0000, v73
    v_fmac_f32 v98, v104, v26
    v_fmac_f32 v99, v105, v26
    v_lshlrev_b32 v104, 16, v74
    v_and_b32 v105, 0xffff0000, v74
    v_fmac_f32 v100, v104, v26
    v_fmac_f32 v101, v105, v26
    v_lshlrev_b32 v104, 16, v75
    v_and_b32 v105, 0xffff0000, v75
    v_fmac_f32 v102, v104, v26
    v_fmac_f32 v103, v105, v26
    s_waitcnt vmcnt(4)
    v_lshlrev_b32 v104, 16, v76
    v_and_b32 v105, 0xffff0000, v76
    v_fmac_f32 v96, v104, v27
    v_fmac_f32 v97, v105, v27
    v_lshlrev_b32 v104, 16, v77
    v_and_b32 v105, 0xffff0000, v77
    v_fmac_f32 v98, v104, v27
    v_fmac_f32 v99, v105, v27
    v_lshlrev_b32 v104, 16, v78
    v_and_b32 v105, 0xffff0000, v78
    v_fmac_f32 v100, v104, v27
    v_fmac_f32 v101, v105, v27
    v_lshlrev_b32 v104, 16, v79
    v_and_b32 v105, 0xffff0000, v79
    v_fmac_f32 v102, v104, v27
    v_fmac_f32 v103, v105, v27
    s_waitcnt vmcnt(3)
    v_lshlrev_b32 v104, 16, v80
    v_and_b32 v105, 0xffff0000, v80
    v_fmac_f32 v96, v104, v28
    v_fmac_f32 v97, v105, v28
    v_lshlrev_b32 v104, 16, v81
    v_and_b32 v105, 0xffff0000, v81
    v_fmac_f32 v98, v104, v28
    v_fmac_f32 v99, v105, v28
    v_lshlrev_b32 v104, 16, v82
    v_and_b32 v105, 0xffff0000, v82
    v_fmac_f32 v100, v104, v28
    v_fmac_f32 v101, v105, v28
    v_lshlrev_b32 v104, 16, v83
    v_and_b32 v105, 0xffff0000, v83
    v_fmac_f32 v102, v104, v28
    v_fmac_f32 v103, v105, v28
    s_waitcnt vmcnt(2)
    v_lshlrev_b32 v104, 16, v84
    v_and_b32 v105, 0xffff0000, v84
    v_fmac_f32 v96, v104, v29
    v_fmac_f32 v97, v105, v29
    v_lshlrev_b32 v104, 16, v85
    v_and_b32 v105, 0xffff0000, v85
    v_fmac_f32 v98, v104, v29
    v_fmac_f32 v99, v105, v29
    v_lshlrev_b32 v104, 16, v86
    v_and_b32 v105, 0xffff0000, v86
    v_fmac_f32 v100, v104, v29
    v_fmac_f32 v101, v105, v29
    v_lshlrev_b32 v104, 16, v87
    v_and_b32 v105, 0xffff0000, v87
    v_fmac_f32 v102, v104, v29
    v_fmac_f32 v103, v105, v29
    s_waitcnt vmcnt(1)
    v_lshlrev_b32 v104, 16, v88
    v_and_b32 v105, 0xffff0000, v88
    v_fmac_f32 v96, v104, v30
    v_fmac_f32 v97, v105, v30
    v_lshlrev_b32 v104, 16, v89
    v_and_b32 v105, 0xffff0000, v89
    v_fmac_f32 v98, v104, v30
    v_fmac_f32 v99, v105, v30
    v_lshlrev_b32 v104, 16, v90
    v_and_b32 v105, 0xffff0000, v90
    v_fmac_f32 v100, v104, v30
    v_fmac_f32 v101, v105, v30
    v_lshlrev_b32 v104, 16, v91
    v_and_b32 v105, 0xffff0000, v91
    v_fmac_f32 v102, v104, v30
    v_fmac_f32 v103, v105, v30
    s_waitcnt vmcnt(0)
    v_lshlrev_b32 v104, 16, v92
    v_and_b32 v105, 0xffff0000, v92
    v_fmac_f32 v96, v104, v31
    v_fmac_f32 v97, v105, v31
    v_lshlrev_b32 v104, 16, v93
    v_and_b32 v105, 0xffff0000, v93
    v_fmac_f32 v98, v104, v31
    v_fmac_f32 v99, v105, v31
    v_lshlrev_b32 v104, 16, v94
    v_and_b32 v105, 0xffff0000, v94
    v_fmac_f32 v100, v104, v31
    v_fmac_f32 v101, v105, v31
    v_lshlrev_b32 v104, 16, v95
    v_and_b32 v105, 0xffff0000, v95
    v_fmac_f32 v102, v104, v31
    v_fmac_f32 v103, v105, v31
    v_lshlrev_b32 v104, 5, v0
    ds_write_b128 v104, v[96:99]
    ds_write_b128 v104, v[100:103] offset:16
    v_lshlrev_b32 v105, 2, v1
    s_lshl_b32 s46, s44, 11
    v_add_u32 v104, s46, v105
    s_waitcnt lgkmcnt(0)
    ds_read_b32 v96, v104 offset:0
    ds_read_b32 v97, v104 offset:256
    ds_read_b32 v98, v104 offset:512
    ds_read_b32 v99, v104 offset:768
    ds_read_b32 v100, v104 offset:1024
    ds_read_b32 v101, v104 offset:1280
    ds_read_b32 v102, v104 offset:1536
    ds_read_b32 v103, v104 offset:1792
    s_waitcnt lgkmcnt(0)
    v_add_f32 v96, v96, v100
    v_add_f32 v97, v97, v101
    v_add_f32 v98, v98, v102
    v_add_f32 v99, v99, v103
    v_add_f32 v96, v96, v98
    v_add_f32 v97, v97, v99
    v_add_f32 v96, v96, v97
    v_lshlrev_b32 v104, 2, v0
    ds_write_b32 v104, v96 offset:16384
    s_waitcnt lgkmcnt(0)
    s_barrier
    s_cmp_lg_u32 s44, 0
    s_cbranch_scc1 L_m_sk_25
    ds_read_b32 v96, v105 offset:16384
    ds_read_b32 v97, v105 offset:16640
    ds_read_b32 v98, v105 offset:16896
    ds_read_b32 v99, v105 offset:17152
    ds_read_b32 v100, v105 offset:17408
    ds_read_b32 v101, v105 offset:17664
    ds_read_b32 v102, v105 offset:17920
    ds_read_b32 v103, v105 offset:18176
    s_waitcnt lgkmcnt(0)
    v_add_f32 v96, v96, v100
    v_add_f32 v97, v97, v101
    v_add_f32 v98, v98, v102
    v_add_f32 v99, v99, v103
    v_add_f32 v96, v96, v98
    v_add_f32 v97, v97, v99
    v_add_f32 v96, v96, v97
    v_cvt_pk_bf16_f32 v96, 0, v96
    s_lshl_b32 s46, s53, 1
    buffer_store_dword v96, v105, s[12:15], s46 offen sc1
L_m_sk_25:
    s_barrier
    s_add_u32 s53, s53, 128
    s_and_b32 s46, s53, 511
    s_cmp_lg_u32 s46, 0
    s_cbranch_scc1 L_m_loop_24
    s_lshl_b32 s54, s55, 7
    s_add_u32 s54, s54, 0x10e400
    s_mov_b32 s60, 0
    s_waitcnt vmcnt(0)
    s_cmp_lg_u32 s44, 0
    s_cbranch_scc1 L_sf_26
    v_mov_b32 v8, s60
    v_add_u32 v8, 1, v8
    v_mov_b32 v9, 0
    s_mov_b64 exec, 1
    buffer_store_dword v8, v9, s[12:15], s54 offen sc1
    s_mov_b64 exec, -1
L_sf_26:
    s_barrier
L_w_h_17_s:
    s_mov_b32 s77, s48
    s_cmp_eq_u32 s48, 14
    s_cselect_b32 s53, 2, 1
    s_sub_u32 s48, s48, 12
    s_min_u32 s48, s48, 2
    s_mov_b32 s79, 0
L_w_h_17_n:
    s_cmp_eq_u32 s53, 1
    s_cselect_b32 s74, 46, 54
    s_cselect_b32 s75, 64, 64
    s_mov_b32 s76, 65536
    s_branch L_w_g_10_e
L_w_h_17:
    s_mov_b32 s48, s77
    s_cmp_lt_u32 s48, 14
    s_cbranch_scc1 L_w_att_15
    s_and_b32 s42, s40, 3
    s_lshr_b32 s43, s40, 2
    s_cmp_eq_u32 s48, 14
    s_cbranch_scc1 L_w_c_16
    s_mov_b32 s75, 58
    s_mov_b32 s76, 0
    s_mov_b32 s78, 2
L_w_h_17_f:
    s_load_dwordx2 s[4:5], s[0:1], 112
    s_load_dwordx2 s[6:7], s[0:1], 88
    v_lshlrev_b32 v2, 4, v1
    v_lshlrev_b32 v3, 5, v1
    s_waitcnt lgkmcnt(0)
    s_mov_b32 s24, s4
    s_and_b32 s25, s5, 0xffff
    s_mov_b32 s26, 0x400000
    s_mov_b32 s27, 0x00020000
    s_mov_b32 s28, s6
    s_and_b32 s29, s7, 0xffff
    s_mov_b32 s30, 0x800
    s_mov_b32 s31, 0x00020000
    s_cmp_lg_u32 s44, 0
    s_cbranch_scc1 L_mw_27
    v_and_b32 v8, 15, v1
    v_lshlrev_b32 v8, 7, v8
    s_mov_b32 s46, 0x10e400
    s_mov_b32 s47, 0
    s_mov_b32 s70, 0
L_spin_28:
    buffer_load_dword v9, v8, s[12:15], s46 offen sc1
    s_waitcnt vmcnt(0)
    v_cmp_ge_u32 vcc, s47, v9
    s_add_u32 s70, s70, 1
    s_cbranch_vccz L_spok_29
    s_sleep 2
    s_cmp_lt_u32 s70, 524288
    s_cbranch_scc1 L_spin_28
    s_branch L_c_done_1
L_spok_29:
L_mw_27:
    s_barrier
    s_mov_b32 s46, 20480
    buffer_load_dwordx4 v[16:19], v3, s[12:15], s46 offen offset:0 sc1
    buffer_load_dwordx4 v[20:23], v3, s[12:15], s46 offen offset:16 sc1
    buffer_load_dwordx4 v[24:27], v3, s[12:15], s46 offen offset:2048 sc1
    buffer_load_dwordx4 v[28:31], v3, s[12:15], s46 offen offset:2064 sc1
    buffer_load_dwordx4 v[48:51], v2, s[28:31], 0 offen
    buffer_load_dwordx4 v[52:55], v2, s[28:31], 0 offen offset:1024
    s_waitcnt vmcnt(0)
    v_lshlrev_b32 v32, 16, v48
    v_and_b32 v33, 0xffff0000, v48
    v_lshlrev_b32 v34, 16, v49
    v_and_b32 v35, 0xffff0000, v49
    v_lshlrev_b32 v36, 16, v50
    v_and_b32 v37, 0xffff0000, v50
    v_lshlrev_b32 v38, 16, v51
    v_and_b32 v39, 0xffff0000, v51
    v_lshlrev_b32 v40, 16, v52
    v_and_b32 v41, 0xffff0000, v52
    v_lshlrev_b32 v42, 16, v53
    v_and_b32 v43, 0xffff0000, v53
    v_lshlrev_b32 v44, 16, v54
    v_and_b32 v45, 0xffff0000, v54
    v_lshlrev_b32 v46, 16, v55
    v_and_b32 v47, 0xffff0000, v55
    s_lshl_b32 s46, s42, 14
    s_lshl_b32 s47, s44, 11
    s_add_u32 s46, s46, s47
    s_add_u32 s46, s46, 0xb000000
    v_add_u32 v4, s46, v2
    v_and_b32 v5, 31, v1
    v_lshlrev_b32 v5, 7, v5
    v_add_u32 v5, 0x108400, v5
    v_lshlrev_b32 v6, 2, v1
    s_lshl_b32 s46, s44, 9
    v_add_u32 v6, s46, v6
    s_lshl_b32 s46, s44, 12
    v_add_u32 v7, s46, v3
    s_lshl_b32 s46, s42, 3
    s_add_u32 s46, s46, s44
    s_lshl_b32 s46, s46, 11
    v_add_u32 v8, s46, v2
    v_add_u32 v9, 0x800000, v8
    s_mov_b32 s60, s43
L_r_loop_30:
    s_lshl_b32 s61, s60, 18
    s_lshl_b32 s63, s60, 16
    s_cmp_lg_u32 s44, 0
    s_cbranch_scc1 L_r_nsp_31
    s_mov_b32 s70, 0
L_spin_32:
    buffer_load_dword v14, v5, s[12:15], s76 offen sc1
    s_waitcnt vmcnt(0)
    v_cmp_ge_u32 vcc, s60, v14
    s_add_u32 s70, s70, 1
    s_cbranch_vccz L_spok_33
    s_sleep 3
    s_cmp_lt_u32 s70, 524288
    s_cbranch_scc1 L_spin_32
    s_branch L_c_done_1
L_spok_33:
L_r_nsp_31:
    s_barrier
    buffer_load_dwordx4 v[96:99], v4, s[12:15], s61 offen offset:0 sc1
    buffer_load_dwordx4 v[100:103], v4, s[12:15], s61 offen offset:1024 sc1
    s_add_u32 s61, s61, 65536
    buffer_load_dwordx4 v[104:107], v4, s[12:15], s61 offen offset:0 sc1
    buffer_load_dwordx4 v[108:111], v4, s[12:15], s61 offen offset:1024 sc1
    s_add_u32 s61, s61, 65536
    buffer_load_dwordx4 v[112:115], v4, s[12:15], s61 offen offset:0 sc1
    buffer_load_dwordx4 v[116:119], v4, s[12:15], s61 offen offset:1024 sc1
    s_add_u32 s61, s61, 65536
    buffer_load_dwordx4 v[120:123], v4, s[12:15], s61 offen offset:0 sc1
    buffer_load_dwordx4 v[124:127], v4, s[12:15], s61 offen offset:1024 sc1
    buffer_load_dwordx4 a[0:3], v9, s[12:15], s63 offen sc1
    buffer_load_dwordx4 a[4:7], v9, s[12:15], s63 offen offset:1024 sc1
    s_waitcnt vmcnt(8)
    v_lshlrev_b32 v64, 16, v96
    v_and_b32 v65, 0xffff0000, v96
    v_lshlrev_b32 v66, 16, v97
    v_and_b32 v67, 0xffff0000, v97
    v_lshlrev_b32 v68, 16, v98
    v_and_b32 v69, 0xffff0000, v98
    v_lshlrev_b32 v70, 16, v99
    v_and_b32 v71, 0xffff0000, v99
    v_lshlrev_b32 v72, 16, v100
    v_and_b32 v73, 0xffff0000, v100
    v_lshlrev_b32 v74, 16, v101
    v_and_b32 v75, 0xffff0000, v101
    v_lshlrev_b32 v76, 16, v102
    v_and_b32 v77, 0xffff0000, v102
    v_lshlrev_b32 v78, 16, v103
    v_and_b32 v79, 0xffff0000, v103
    s_waitcnt vmcnt(6)
    v_lshlrev_b32 v80, 16, v104
    v_and_b32 v81, 0xffff0000, v104
    v_lshlrev_b32 v82, 16, v105
    v_and_b32 v83, 0xffff0000, v105
    v_lshlrev_b32 v84, 16, v106
    v_and_b32 v85, 0xffff0000, v106
    v_lshlrev_b32 v86, 16, v107
    v_and_b32 v87, 0xffff0000, v107
    v_lshlrev_b32 v88, 16, v108
    v_and_b32 v89, 0xffff0000, v108
    v_lshlrev_b32 v90, 16, v109
    v_and_b32 v91, 0xffff0000, v109
    v_lshlrev_b32 v92, 16, v110
    v_and_b32 v93, 0xffff0000, v110
    v_lshlrev_b32 v94, 16, v111
    v_and_b32 v95, 0xffff0000, v111
    v_pk_add_f32 v[64:65], v[64:65], v[80:81]
    v_pk_add_f32 v[66:67], v[66:67], v[82:83]
    v_pk_add_f32 v[68:69], v[68:69], v[84:85]
    v_pk_add_f32 v[70:71], v[70:71], v[86:87]
    v_pk_add_f32 v[72:73], v[72:73], v[88:89]
    v_pk_add_f32 v[74:75], v[74:75], v[90:91]
    v_pk_add_f32 v[76:77], v[76:77], v[92:93]
    v_pk_add_f32 v[78:79], v[78:79], v[94:95]
    s_waitcnt vmcnt(4)
    v_lshlrev_b32 v80, 16, v112
    v_and_b32 v81, 0xffff0000, v112
    v_lshlrev_b32 v82, 16, v113
    v_and_b32 v83, 0xffff0000, v113
    v_lshlrev_b32 v84, 16, v114
    v_and_b32 v85, 0xffff0000, v114
    v_lshlrev_b32 v86, 16, v115
    v_and_b32 v87, 0xffff0000, v115
    v_lshlrev_b32 v88, 16, v116
    v_and_b32 v89, 0xffff0000, v116
    v_lshlrev_b32 v90, 16, v117
    v_and_b32 v91, 0xffff0000, v117
    v_lshlrev_b32 v92, 16, v118
    v_and_b32 v93, 0xffff0000, v118
    v_lshlrev_b32 v94, 16, v119
    v_and_b32 v95, 0xffff0000, v119
    v_pk_add_f32 v[64:65], v[64:65], v[80:81]
    v_pk_add_f32 v[66:67], v[66:67], v[82:83]
    v_pk_add_f32 v[68:69], v[68:69], v[84:85]
    v_pk_add_f32 v[70:71], v[70:71], v[86:87]
    v_pk_add_f32 v[72:73], v[72:73], v[88:89]
    v_pk_add_f32 v[74:75], v[74:75], v[90:91]
    v_pk_add_f32 v[76:77], v[76:77], v[92:93]
    v_pk_add_f32 v[78:79], v[78:79], v[94:95]
    s_waitcnt vmcnt(2)
    v_lshlrev_b32 v80, 16, v120
    v_and_b32 v81, 0xffff0000, v120
    v_lshlrev_b32 v82, 16, v121
    v_and_b32 v83, 0xffff0000, v121
    v_lshlrev_b32 v84, 16, v122
    v_and_b32 v85, 0xffff0000, v122
    v_lshlrev_b32 v86, 16, v123
    v_and_b32 v87, 0xffff0000, v123
    v_lshlrev_b32 v88, 16, v124
    v_and_b32 v89, 0xffff0000, v124
    v_lshlrev_b32 v90, 16, v125
    v_and_b32 v91, 0xffff0000, v125
    v_lshlrev_b32 v92, 16, v126
    v_and_b32 v93, 0xffff0000, v126
    v_lshlrev_b32 v94, 16, v127
    v_and_b32 v95, 0xffff0000, v127
    v_pk_add_f32 v[64:65], v[64:65], v[80:81]
    v_pk_add_f32 v[66:67], v[66:67], v[82:83]
    v_pk_add_f32 v[68:69], v[68:69], v[84:85]
    v_pk_add_f32 v[70:71], v[70:71], v[86:87]
    v_pk_add_f32 v[72:73], v[72:73], v[88:89]
    v_pk_add_f32 v[74:75], v[74:75], v[90:91]
    v_pk_add_f32 v[76:77], v[76:77], v[92:93]
    v_pk_add_f32 v[78:79], v[78:79], v[94:95]
    ds_write_b32 v6, v64 offset:0
    ds_write_b32 v6, v65 offset:4096
    ds_write_b32 v6, v66 offset:8192
    ds_write_b32 v6, v67 offset:12288
    ds_write_b32 v6, v68 offset:16384
    ds_write_b32 v6, v69 offset:20480
    ds_write_b32 v6, v70 offset:24576
    ds_write_b32 v6, v71 offset:28672
    ds_write_b32 v6, v72 offset:256
    ds_write_b32 v6, v73 offset:4352
    ds_write_b32 v6, v74 offset:8448
    ds_write_b32 v6, v75 offset:12544
    ds_write_b32 v6, v76 offset:16640
    ds_write_b32 v6, v77 offset:20736
    ds_write_b32 v6, v78 offset:24832
    ds_write_b32 v6, v79 offset:28928
    s_waitcnt lgkmcnt(0)
    s_barrier
    ds_read_b128 v[64:67], v7
    ds_read_b128 v[68:71], v7 offset:16
    ds_read_b128 v[72:75], v7 offset:2048
    ds_read_b128 v[76:79], v7 offset:2064
    s_waitcnt vmcnt(0)
    v_accvgpr_read_b32 v96, a0
    v_accvgpr_read_b32 v97, a1
    v_accvgpr_read_b32 v98, a2
    v_accvgpr_read_b32 v99, a3
    v_accvgpr_read_b32 v100, a4
    v_accvgpr_read_b32 v101, a5
    v_accvgpr_read_b32 v102, a6
    v_accvgpr_read_b32 v103, a7
    v_lshlrev_b32 v80, 16, v96
    v_and_b32 v81, 0xffff0000, v96
    v_lshlrev_b32 v82, 16, v97
    v_and_b32 v83, 0xffff0000, v97
    v_lshlrev_b32 v84, 16, v98
    v_and_b32 v85, 0xffff0000, v98
    v_lshlrev_b32 v86, 16, v99
    v_and_b32 v87, 0xffff0000, v99
    v_lshlrev_b32 v88, 16, v100
    v_and_b32 v89, 0xffff0000, v100
    v_lshlrev_b32 v90, 16, v101
    v_and_b32 v91, 0xffff0000, v101
    v_lshlrev_b32 v92, 16, v102
    v_and_b32 v93, 0xffff0000, v102
    v_lshlrev_b32 v94, 16, v103
    v_and_b32 v95, 0xffff0000, v103
    s_waitcnt lgkmcnt(0)
    v_cvt_pk_bf16_f32 v64, 0, v64
    v_cvt_pk_bf16_f32 v65, 0, v65
    v_cvt_pk_bf16_f32 v66, 0, v66
    v_cvt_pk_bf16_f32 v67, 0, v67
    v_cvt_pk_bf16_f32 v68, 0, v68
    v_cvt_pk_bf16_f32 v69, 0, v69
    v_cvt_pk_bf16_f32 v70, 0, v70
    v_cvt_pk_bf16_f32 v71, 0, v71
    v_cvt_pk_bf16_f32 v72, 0, v72
    v_cvt_pk_bf16_f32 v73, 0, v73
    v_cvt_pk_bf16_f32 v74, 0, v74
    v_cvt_pk_bf16_f32 v75, 0, v75
    v_cvt_pk_bf16_f32 v76, 0, v76
    v_cvt_pk_bf16_f32 v77, 0, v77
    v_cvt_pk_bf16_f32 v78, 0, v78
    v_cvt_pk_bf16_f32 v79, 0, v79
    v_pk_add_f32 v[64:65], v[64:65], v[32:33]
    v_pk_add_f32 v[66:67], v[66:67], v[34:35]
    v_pk_add_f32 v[68:69], v[68:69], v[36:37]
    v_pk_add_f32 v[70:71], v[70:71], v[38:39]
    v_pk_add_f32 v[72:73], v[72:73], v[40:41]
    v_pk_add_f32 v[74:75], v[74:75], v[42:43]
    v_pk_add_f32 v[76:77], v[76:77], v[44:45]
    v_pk_add_f32 v[78:79], v[78:79], v[46:47]
    v_cvt_pk_bf16_f32 v64, 0, v64
    v_cvt_pk_bf16_f32 v65, 0, v65
    v_cvt_pk_bf16_f32 v66, 0, v66
    v_cvt_pk_bf16_f32 v67, 0, v67
    v_cvt_pk_bf16_f32 v68, 0, v68
    v_cvt_pk_bf16_f32 v69, 0, v69
    v_cvt_pk_bf16_f32 v70, 0, v70
    v_cvt_pk_bf16_f32 v71, 0, v71
    v_cvt_pk_bf16_f32 v72, 0, v72
    v_cvt_pk_bf16_f32 v73, 0, v73
    v_cvt_pk_bf16_f32 v74, 0, v74
    v_cvt_pk_bf16_f32 v75, 0, v75
    v_cvt_pk_bf16_f32 v76, 0, v76
    v_cvt_pk_bf16_f32 v77, 0, v77
    v_cvt_pk_bf16_f32 v78, 0, v78
    v_cvt_pk_bf16_f32 v79, 0, v79
    v_pk_mul_f32 v[64:65], v[64:65], v[16:17]
    v_pk_mul_f32 v[66:67], v[66:67], v[18:19]
    v_pk_mul_f32 v[68:69], v[68:69], v[20:21]
    v_pk_mul_f32 v[70:71], v[70:71], v[22:23]
    v_pk_mul_f32 v[72:73], v[72:73], v[24:25]
    v_pk_mul_f32 v[74:75], v[74:75], v[26:27]
    v_pk_mul_f32 v[76:77], v[76:77], v[28:29]
    v_pk_mul_f32 v[78:79], v[78:79], v[30:31]
    v_cvt_pk_bf16_f32 v64, 0, v64
    v_cvt_pk_bf16_f32 v65, 0, v65
    v_cvt_pk_bf16_f32 v66, 0, v66
    v_cvt_pk_bf16_f32 v67, 0, v67
    v_cvt_pk_bf16_f32 v68, 0, v68
    v_cvt_pk_bf16_f32 v69, 0, v69
    v_cvt_pk_bf16_f32 v70, 0, v70
    v_cvt_pk_bf16_f32 v71, 0, v71
    v_cvt_pk_bf16_f32 v72, 0, v72
    v_cvt_pk_bf16_f32 v73, 0, v73
    v_cvt_pk_bf16_f32 v74, 0, v74
    v_cvt_pk_bf16_f32 v75, 0, v75
    v_cvt_pk_bf16_f32 v76, 0, v76
    v_cvt_pk_bf16_f32 v77, 0, v77
    v_cvt_pk_bf16_f32 v78, 0, v78
    v_cvt_pk_bf16_f32 v79, 0, v79
    v_pk_add_f32 v[64:65], v[64:65], v[80:81]
    v_pk_add_f32 v[66:67], v[66:67], v[82:83]
    v_pk_add_f32 v[68:69], v[68:69], v[84:85]
    v_pk_add_f32 v[70:71], v[70:71], v[86:87]
    v_pk_add_f32 v[72:73], v[72:73], v[88:89]
    v_pk_add_f32 v[74:75], v[74:75], v[90:91]
    v_pk_add_f32 v[76:77], v[76:77], v[92:93]
    v_pk_add_f32 v[78:79], v[78:79], v[94:95]
    v_cvt_pk_bf16_f32 v96, v64, v65
    v_cvt_pk_bf16_f32 v97, v66, v67
    v_cvt_pk_bf16_f32 v98, v68, v69
    v_cvt_pk_bf16_f32 v99, v70, v71
    v_cvt_pk_bf16_f32 v100, v72, v73
    v_cvt_pk_bf16_f32 v101, v74, v75
    v_cvt_pk_bf16_f32 v102, v76, v77
    v_cvt_pk_bf16_f32 v103, v78, v79
    buffer_store_dwordx4 v[96:99], v8, s[24:27], s63 offen
    buffer_store_dwordx4 v[100:103], v8, s[24:27], s63 offen offset:1024
    s_add_u32 s60, s60, s78
    s_cmp_lt_u32 s60, s75
    s_cbranch_scc1 L_r_loop_30
    s_branch L_c_done_1
L_w_c_16:
    s_load_dwordx2 s[4:5], s[0:1], 0
    s_load_dwordx2 s[6:7], s[0:1], 88
    v_lshlrev_b32 v2, 4, v1
    v_lshlrev_b32 v3, 5, v1
    s_waitcnt lgkmcnt(0)
    s_mov_b32 s24, s4
    s_and_b32 s25, s5, 0xffff
    s_mov_b32 s26, 0x400000
    s_mov_b32 s27, 0x00020000
    s_mov_b32 s28, s6
    s_and_b32 s29, s7, 0xffff
    s_mov_b32 s30, 0x800
    s_mov_b32 s31, 0x00020000
    s_cmp_lg_u32 s44, 0
    s_cbranch_scc1 L_mw_34
    v_and_b32 v8, 15, v1
    v_lshlrev_b32 v8, 7, v8
    s_mov_b32 s46, 0x10e400
    s_mov_b32 s47, 0
    s_mov_b32 s70, 0
L_spin_35:
    buffer_load_dword v9, v8, s[12:15], s46 offen sc1
    s_waitcnt vmcnt(0)
    v_cmp_ge_u32 vcc, s47, v9
    s_add_u32 s70, s70, 1
    s_cbranch_vccz L_spok_36
    s_sleep 2
    s_cmp_lt_u32 s70, 524288
    s_cbranch_scc1 L_spin_35
    s_branch L_c_done_1
L_spok_36:
L_mw_34:
    s_barrier
    s_mov_b32 s46, 8192
    buffer_load_dwordx4 v[16:19], v3, s[12:15], s46 offen offset:0 sc1
    buffer_load_dwordx4 v[20:23], v3, s[12:15], s46 offen offset:16 sc1
    buffer_load_dwordx4 v[24:27], v3, s[12:15], s46 offen offset:2048 sc1
    buffer_load_dwordx4 v[28:31], v3, s[12:15], s46 offen offset:2064 sc1
    s_mov_b32 s46, 16384
    buffer_load_dwordx4 v[32:35], v3, s[12:15], s46 offen offset:0 sc1
    buffer_load_dwordx4 v[36:39], v3, s[12:15], s46 offen offset:16 sc1
    buffer_load_dwordx4 v[40:43], v3, s[12:15], s46 offen offset:2048 sc1
    buffer_load_dwordx4 v[44:47], v3, s[12:15], s46 offen offset:2064 sc1
    s_mov_b32 s46, 12288
    buffer_load_dwordx4 v[48:51], v3, s[12:15], s46 offen offset:0 sc1
    buffer_load_dwordx4 v[52:55], v3, s[12:15], s46 offen offset:16 sc1
    buffer_load_dwordx4 v[56:59], v3, s[12:15], s46 offen offset:2048 sc1
    buffer_load_dwordx4 v[60:63], v3, s[12:15], s46 offen offset:2064 sc1
    s_waitcnt vmcnt(0)
    v_add_f32 v32, 1.0, v32
    v_add_f32 v33, 1.0, v33
    v_add_f32 v34, 1.0, v34
    v_add_f32 v35, 1.0, v35
    v_add_f32 v36, 1.0, v36
    v_add_f32 v37, 1.0, v37
    v_add_f32 v38, 1.0, v38
    v_add_f32 v39, 1.0, v39
    v_add_f32 v40, 1.0, v40
    v_add_f32 v41, 1.0, v41
    v_add_f32 v42, 1.0, v42
    v_add_f32 v43, 1.0, v43
    v_add_f32 v44, 1.0, v44
    v_add_f32 v45, 1.0, v45
    v_add_f32 v46, 1.0, v46
    v_add_f32 v47, 1.0, v47
    v_cvt_pk_bf16_f32 v32, 0, v32
    v_cvt_pk_bf16_f32 v33, 0, v33
    v_cvt_pk_bf16_f32 v34, 0, v34
    v_cvt_pk_bf16_f32 v35, 0, v35
    v_cvt_pk_bf16_f32 v36, 0, v36
    v_cvt_pk_bf16_f32 v37, 0, v37
    v_cvt_pk_bf16_f32 v38, 0, v38
    v_cvt_pk_bf16_f32 v39, 0, v39
    v_cvt_pk_bf16_f32 v40, 0, v40
    v_cvt_pk_bf16_f32 v41, 0, v41
    v_cvt_pk_bf16_f32 v42, 0, v42
    v_cvt_pk_bf16_f32 v43, 0, v43
    v_cvt_pk_bf16_f32 v44, 0, v44
    v_cvt_pk_bf16_f32 v45, 0, v45
    v_cvt_pk_bf16_f32 v46, 0, v46
    v_cvt_pk_bf16_f32 v47, 0, v47
    s_lshl_b32 s46, s42, 14
    s_lshl_b32 s47, s44, 11
    s_add_u32 s46, s46, s47
    s_add_u32 s46, s46, 0x9000000
    v_add_u32 v4, s46, v2
    v_and_b32 v5, 31, v1
    v_lshlrev_b32 v5, 7, v5
    v_add_u32 v5, 0x107400, v5
    v_lshlrev_b32 v6, 2, v1
    s_lshl_b32 s46, s44, 9
    v_add_u32 v6, s46, v6
    s_lshl_b32 s46, s44, 12
    v_add_u32 v7, s46, v3
    s_lshl_b32 s46, s42, 3
    s_add_u32 s46, s46, s44
    s_lshl_b32 s46, s46, 11
    v_add_u32 v8, s46, v2
    v_add_u32 v9, 0x800000, v8
    s_mul_i32 s46, s44, 2064
    s_add_u32 s46, s46, 32768
    v_add_u32 v10, s46, v2
    v_and_b32 v11, 7, v1
    v_lshrrev_b32 v12, 3, v1
    v_mul_u32_u24 v13, 2064, v11
    v_lshl_add_u32 v13, v12, 4, v13
    s_lshl_b32 s46, s44, 8
    s_add_u32 s46, s46, 32768
    v_add_u32 v13, s46, v13
    v_lshlrev_b32 v11, 4, v11
    v_lshl_add_u32 v11, v12, 9, v11
    s_lshl_b32 s46, s44, 13
    s_lshl_b32 s47, s42, 7
    s_add_u32 s46, s46, s47
    s_add_u32 s46, s46, 0xc00000
    v_add_u32 v11, s46, v11
    v_add_u32 v12, 4096, v11
    s_lshl_b32 s52, s43, 9
    s_lshl_b32 s47, s42, 7
    s_add_u32 s52, s52, s47
    s_add_u32 s52, s52, 0x10ec00
    s_mov_b32 s60, s43
L_r_loop_37:
    s_lshl_b32 s61, s60, 18
    s_lshl_b32 s63, s60, 16
    buffer_load_dwordx4 a[0:3], v8, s[24:27], s63 offen
    buffer_load_dwordx4 a[4:7], v8, s[24:27], s63 offen offset:1024
    s_cmp_lg_u32 s44, 0
    s_cbranch_scc1 L_r_nsp_38
    s_mov_b32 s70, 0
L_spin_39:
    buffer_load_dword v14, v5, s[12:15], 0 offen sc1
    s_waitcnt vmcnt(0)
    v_cmp_ge_u32 vcc, s60, v14
    s_add_u32 s70, s70, 1
    s_cbranch_vccz L_spok_40
    s_sleep 3
    s_cmp_lt_u32 s70, 524288
    s_cbranch_scc1 L_spin_39
    s_branch L_c_done_1
L_spok_40:
L_r_nsp_38:
    s_barrier
    buffer_load_dwordx4 v[96:99], v4, s[12:15], s61 offen offset:0 sc1
    buffer_load_dwordx4 v[100:103], v4, s[12:15], s61 offen offset:1024 sc1
    s_add_u32 s61, s61, 65536
    buffer_load_dwordx4 v[104:107], v4, s[12:15], s61 offen offset:0 sc1
    buffer_load_dwordx4 v[108:111], v4, s[12:15], s61 offen offset:1024 sc1
    s_add_u32 s61, s61, 65536
    buffer_load_dwordx4 v[112:115], v4, s[12:15], s61 offen offset:0 sc1
    buffer_load_dwordx4 v[116:119], v4, s[12:15], s61 offen offset:1024 sc1
    s_add_u32 s61, s61, 65536
    buffer_load_dwordx4 v[120:123], v4, s[12:15], s61 offen offset:0 sc1
    buffer_load_dwordx4 v[124:127], v4, s[12:15], s61 offen offset:1024 sc1
    s_waitcnt vmcnt(6)
    v_lshlrev_b32 v64, 16, v96
    v_and_b32 v65, 0xffff0000, v96
    v_lshlrev_b32 v66, 16, v97
    v_and_b32 v67, 0xffff0000, v97
    v_lshlrev_b32 v68, 16, v98
    v_and_b32 v69, 0xffff0000, v98
    v_lshlrev_b32 v70, 16, v99
    v_and_b32 v71, 0xffff0000, v99
    v_lshlrev_b32 v72, 16, v100
    v_and_b32 v73, 0xffff0000, v100
    v_lshlrev_b32 v74, 16, v101
    v_and_b32 v75, 0xffff0000, v101
    v_lshlrev_b32 v76, 16, v102
    v_and_b32 v77, 0xffff0000, v102
    v_lshlrev_b32 v78, 16, v103
    v_and_b32 v79, 0xffff0000, v103
    s_waitcnt vmcnt(4)
    v_lshlrev_b32 v80, 16, v104
    v_and_b32 v81, 0xffff0000, v104
    v_lshlrev_b32 v82, 16, v105
    v_and_b32 v83, 0xffff0000, v105
    v_lshlrev_b32 v84, 16, v106
    v_and_b32 v85, 0xffff0000, v106
    v_lshlrev_b32 v86, 16, v107
    v_and_b32 v87, 0xffff0000, v107
    v_lshlrev_b32 v88, 16, v108
    v_and_b32 v89, 0xffff0000, v108
    v_lshlrev_b32 v90, 16, v109
    v_and_b32 v91, 0xffff0000, v109
    v_lshlrev_b32 v92, 16, v110
    v_and_b32 v93, 0xffff0000, v110
    v_lshlrev_b32 v94, 16, v111
    v_and_b32 v95, 0xffff0000, v111
    v_pk_add_f32 v[64:65], v[64:65], v[80:81]
    v_pk_add_f32 v[66:67], v[66:67], v[82:83]
    v_pk_add_f32 v[68:69], v[68:69], v[84:85]
    v_pk_add_f32 v[70:71], v[70:71], v[86:87]
    v_pk_add_f32 v[72:73], v[72:73], v[88:89]
    v_pk_add_f32 v[74:75], v[74:75], v[90:91]
    v_pk_add_f32 v[76:77], v[76:77], v[92:93]
    v_pk_add_f32 v[78:79], v[78:79], v[94:95]
    s_waitcnt vmcnt(2)
    v_lshlrev_b32 v80, 16, v112
    v_and_b32 v81, 0xffff0000, v112
    v_lshlrev_b32 v82, 16, v113
    v_and_b32 v83, 0xffff0000, v113
    v_lshlrev_b32 v84, 16, v114
    v_and_b32 v85, 0xffff0000, v114
    v_lshlrev_b32 v86, 16, v115
    v_and_b32 v87, 0xffff0000, v115
    v_lshlrev_b32 v88, 16, v116
    v_and_b32 v89, 0xffff0000, v116
    v_lshlrev_b32 v90, 16, v117
    v_and_b32 v91, 0xffff0000, v117
    v_lshlrev_b32 v92, 16, v118
    v_and_b32 v93, 0xffff0000, v118
    v_lshlrev_b32 v94, 16, v119
    v_and_b32 v95, 0xffff0000, v119
    v_pk_add_f32 v[64:65], v[64:65], v[80:81]
    v_pk_add_f32 v[66:67], v[66:67], v[82:83]
    v_pk_add_f32 v[68:69], v[68:69], v[84:85]
    v_pk_add_f32 v[70:71], v[70:71], v[86:87]
    v_pk_add_f32 v[72:73], v[72:73], v[88:89]
    v_pk_add_f32 v[74:75], v[74:75], v[90:91]
    v_pk_add_f32 v[76:77], v[76:77], v[92:93]
    v_pk_add_f32 v[78:79], v[78:79], v[94:95]
    s_waitcnt vmcnt(0)
    v_lshlrev_b32 v80, 16, v120
    v_and_b32 v81, 0xffff0000, v120
    v_lshlrev_b32 v82, 16, v121
    v_and_b32 v83, 0xffff0000, v121
    v_lshlrev_b32 v84, 16, v122
    v_and_b32 v85, 0xffff0000, v122
    v_lshlrev_b32 v86, 16, v123
    v_and_b32 v87, 0xffff0000, v123
    v_lshlrev_b32 v88, 16, v124
    v_and_b32 v89, 0xffff0000, v124
    v_lshlrev_b32 v90, 16, v125
    v_and_b32 v91, 0xffff0000, v125
    v_lshlrev_b32 v92, 16, v126
    v_and_b32 v93, 0xffff0000, v126
    v_lshlrev_b32 v94, 16, v127
    v_and_b32 v95, 0xffff0000, v127
    v_pk_add_f32 v[64:65], v[64:65], v[80:81]
    v_pk_add_f32 v[66:67], v[66:67], v[82:83]
    v_pk_add_f32 v[68:69], v[68:69], v[84:85]
    v_pk_add_f32 v[70:71], v[70:71], v[86:87]
    v_pk_add_f32 v[72:73], v[72:73], v[88:89]
    v_pk_add_f32 v[74:75], v[74:75], v[90:91]
    v_pk_add_f32 v[76:77], v[76:77], v[92:93]
    v_pk_add_f32 v[78:79], v[78:79], v[94:95]
    ds_write_b32 v6, v64 offset:0
    ds_write_b32 v6, v65 offset:4096
    ds_write_b32 v6, v66 offset:8192
    ds_write_b32 v6, v67 offset:12288
    ds_write_b32 v6, v68 offset:16384
    ds_write_b32 v6, v69 offset:20480
    ds_write_b32 v6, v70 offset:24576
    ds_write_b32 v6, v71 offset:28672
    ds_write_b32 v6, v72 offset:256
    ds_write_b32 v6, v73 offset:4352
    ds_write_b32 v6, v74 offset:8448
    ds_write_b32 v6, v75 offset:12544
    ds_write_b32 v6, v76 offset:16640
    ds_write_b32 v6, v77 offset:20736
    ds_write_b32 v6, v78 offset:24832
    ds_write_b32 v6, v79 offset:28928
    s_waitcnt lgkmcnt(0)
    s_barrier
    ds_read_b128 v[64:67], v7
    ds_read_b128 v[68:71], v7 offset:16
    ds_read_b128 v[72:75], v7 offset:2048
    ds_read_b128 v[76:79], v7 offset:2064
    s_waitcnt vmcnt(0)
    v_accvgpr_read_b32 v96, a0
    v_accvgpr_read_b32 v97, a1
    v_accvgpr_read_b32 v98, a2
    v_accvgpr_read_b32 v99, a3
    v_accvgpr_read_b32 v100, a4
    v_accvgpr_read_b32 v101, a5
    v_accvgpr_read_b32 v102, a6
    v_accvgpr_read_b32 v103, a7
    v_lshlrev_b32 v80, 16, v96
    v_and_b32 v81, 0xffff0000, v96
    v_lshlrev_b32 v82, 16, v97
    v_and_b32 v83, 0xffff0000, v97
    v_lshlrev_b32 v84, 16, v98
    v_and_b32 v85, 0xffff0000, v98
    v_lshlrev_b32 v86, 16, v99
    v_and_b32 v87, 0xffff0000, v99
    v_lshlrev_b32 v88, 16, v100
    v_and_b32 v89, 0xffff0000, v100
    v_lshlrev_b32 v90, 16, v101
    v_and_b32 v91, 0xffff0000, v101
    v_lshlrev_b32 v92, 16, v102
    v_and_b32 v93, 0xffff0000, v102
    v_lshlrev_b32 v94, 16, v103
    v_and_b32 v95, 0xffff0000, v103
    s_waitcnt lgkmcnt(0)
    v_cvt_pk_bf16_f32 v64, 0, v64
    v_cvt_pk_bf16_f32 v65, 0, v65
    v_cvt_pk_bf16_f32 v66, 0, v66
    v_cvt_pk_bf16_f32 v67, 0, v67
    v_cvt_pk_bf16_f32 v68, 0, v68
    v_cvt_pk_bf16_f32 v69, 0, v69
    v_cvt_pk_bf16_f32 v70, 0, v70
    v_cvt_pk_bf16_f32 v71, 0, v71
    v_cvt_pk_bf16_f32 v72, 0, v72
    v_cvt_pk_bf16_f32 v73, 0, v73
    v_cvt_pk_bf16_f32 v74, 0, v74
    v_cvt_pk_bf16_f32 v75, 0, v75
    v_cvt_pk_bf16_f32 v76, 0, v76
    v_cvt_pk_bf16_f32 v77, 0, v77
    v_cvt_pk_bf16_f32 v78, 0, v78
    v_cvt_pk_bf16_f32 v79, 0, v79
    v_pk_mul_f32 v[64:65], v[64:65], v[16:17]
    v_pk_mul_f32 v[66:67], v[66:67], v[18:19]
    v_pk_mul_f32 v[68:69], v[68:69], v[20:21]
    v_pk_mul_f32 v[70:71], v[70:71], v[22:23]
    v_pk_mul_f32 v[72:73], v[72:73], v[24:25]
    v_pk_mul_f32 v[74:75], v[74:75], v[26:27]
    v_pk_mul_f32 v[76:77], v[76:77], v[28:29]
    v_pk_mul_f32 v[78:79], v[78:79], v[30:31]
    v_cvt_pk_bf16_f32 v64, 0, v64
    v_cvt_pk_bf16_f32 v65, 0, v65
    v_cvt_pk_bf16_f32 v66, 0, v66
    v_cvt_pk_bf16_f32 v67, 0, v67
    v_cvt_pk_bf16_f32 v68, 0, v68
    v_cvt_pk_bf16_f32 v69, 0, v69
    v_cvt_pk_bf16_f32 v70, 0, v70
    v_cvt_pk_bf16_f32 v71, 0, v71
    v_cvt_pk_bf16_f32 v72, 0, v72
    v_cvt_pk_bf16_f32 v73, 0, v73
    v_cvt_pk_bf16_f32 v74, 0, v74
    v_cvt_pk_bf16_f32 v75, 0, v75
    v_cvt_pk_bf16_f32 v76, 0, v76
    v_cvt_pk_bf16_f32 v77, 0, v77
    v_cvt_pk_bf16_f32 v78, 0, v78
    v_cvt_pk_bf16_f32 v79, 0, v79
    v_pk_add_f32 v[64:65], v[64:65], v[80:81]
    v_pk_add_f32 v[66:67], v[66:67], v[82:83]
    v_pk_add_f32 v[68:69], v[68:69], v[84:85]
    v_pk_add_f32 v[70:71], v[70:71], v[86:87]
    v_pk_add_f32 v[72:73], v[72:73], v[88:89]
    v_pk_add_f32 v[74:75], v[74:75], v[90:91]
    v_pk_add_f32 v[76:77], v[76:77], v[92:93]
    v_pk_add_f32 v[78:79], v[78:79], v[94:95]
    v_cvt_pk_bf16_f32 v96, v64, v65
    v_cvt_pk_bf16_f32 v97, v66, v67
    v_cvt_pk_bf16_f32 v98, v68, v69
    v_cvt_pk_bf16_f32 v99, v70, v71
    v_cvt_pk_bf16_f32 v100, v72, v73
    v_cvt_pk_bf16_f32 v101, v74, v75
    v_cvt_pk_bf16_f32 v102, v76, v77
    v_cvt_pk_bf16_f32 v103, v78, v79
    buffer_store_dwordx4 v[96:99], v9, s[12:15], s63 offen sc1
    buffer_store_dwordx4 v[100:103], v9, s[12:15], s63 offen offset:1024 sc1
    v_lshlrev_b32 v64, 16, v96
    v_and_b32 v65, 0xffff0000, v96
    v_lshlrev_b32 v66, 16, v97
    v_and_b32 v67, 0xffff0000, v97
    v_lshlrev_b32 v68, 16, v98
    v_and_b32 v69, 0xffff0000, v98
    v_lshlrev_b32 v70, 16, v99
    v_and_b32 v71, 0xffff0000, v99
    v_lshlrev_b32 v72, 16, v100
    v_and_b32 v73, 0xffff0000, v100
    v_lshlrev_b32 v74, 16, v101
    v_and_b32 v75, 0xffff0000, v101
    v_lshlrev_b32 v76, 16, v102
    v_and_b32 v77, 0xffff0000, v102
    v_lshlrev_b32 v78, 16, v103
    v_and_b32 v79, 0xffff0000, v103
    v_pk_add_f32 v[80:81], v[64:65], v[72:73]
    v_pk_add_f32 v[82:83], v[66:67], v[74:75]
    v_pk_add_f32 v[84:85], v[68:69], v[76:77]
    v_pk_add_f32 v[86:87], v[70:71], v[78:79]
    v_pk_add_f32 v[80:81], v[80:81], v[84:85]
    v_pk_add_f32 v[82:83], v[82:83], v[86:87]
    v_pk_add_f32 v[80:81], v[80:81], v[82:83]
    v_add_f32 v14, v80, v81
    s_nop 1
    v_add_f32_dpp v14, v14, v14 row_shr:1 row_mask:0xf bank_mask:0xf bound_ctrl:0
    s_nop 1
    v_add_f32_dpp v14, v14, v14 row_shr:2 row_mask:0xf bank_mask:0xf bound_ctrl:0
    s_nop 1
    v_add_f32_dpp v14, v14, v14 row_shr:4 row_mask:0xf bank_mask:0xf bound_ctrl:0
    s_nop 1
    v_add_f32_dpp v14, v14, v14 row_shr:8 row_mask:0xf bank_mask:0xf bound_ctrl:0
    s_nop 1
    v_add_f32_dpp v14, v14, v14 row_bcast:15 row_mask:0xa bank_mask:0xf
    s_nop 1
    v_add_f32_dpp v14, v14, v14 row_bcast:31 row_mask:0xc bank_mask:0xf
    s_nop 1
    v_readlane_b32 s46, v14, 63
    s_nop 1
    v_mov_b32 v15, s46
    v_mul_f32 v15, 0x3a800000, v15
    v_pk_add_f32 v[80:81], v[64:65], v[14:15] op_sel:[0,1] op_sel_hi:[1,1] neg_lo:[0,1] neg_hi:[0,1]
    v_pk_add_f32 v[82:83], v[66:67], v[14:15] op_sel:[0,1] op_sel_hi:[1,1] neg_lo:[0,1] neg_hi:[0,1]
    v_pk_add_f32 v[84:85], v[68:69], v[14:15] op_sel:[0,1] op_sel_hi:[1,1] neg_lo:[0,1] neg_hi:[0,1]
    v_pk_add_f32 v[86:87], v[70:71], v[14:15] op_sel:[0,1] op_sel_hi:[1,1] neg_lo:[0,1] neg_hi:[0,1]
    v_pk_add_f32 v[88:89], v[72:73], v[14:15] op_sel:[0,1] op_sel_hi:[1,1] neg_lo:[0,1] neg_hi:[0,1]
    v_pk_add_f32 v[90:91], v[74:75], v[14:15] op_sel:[0,1] op_sel_hi:[1,1] neg_lo:[0,1] neg_hi:[0,1]
    v_pk_add_f32 v[92:93], v[76:77], v[14:15] op_sel:[0,1] op_sel_hi:[1,1] neg_lo:[0,1] neg_hi:[0,1]
    v_pk_add_f32 v[94:95], v[78:79], v[14:15] op_sel:[0,1] op_sel_hi:[1,1] neg_lo:[0,1] neg_hi:[0,1]
    v_pk_mul_f32 v[104:105], v[80:81], v[80:81]
    v_pk_mul_f32 v[106:107], v[82:83], v[82:83]
    v_pk_fma_f32 v[104:105], v[84:85], v[84:85], v[104:105]
    v_pk_fma_f32 v[106:107], v[86:87], v[86:87], v[106:107]
    v_pk_fma_f32 v[104:105], v[88:89], v[88:89], v[104:105]
    v_pk_fma_f32 v[106:107], v[90:91], v[90:91], v[106:107]
    v_pk_fma_f32 v[104:105], v[92:93], v[92:93], v[104:105]
    v_pk_fma_f32 v[106:107], v[94:95], v[94:95], v[106:107]
    v_pk_add_f32 v[104:105], v[104:105], v[106:107]
    v_add_f32 v14, v104, v105
    v_cvt_pk_bf16_f32 v15, 0, v15
    s_nop 1
    v_add_f32_dpp v14, v14, v14 row_shr:1 row_mask:0xf bank_mask:0xf bound_ctrl:0
    s_nop 1
    v_add_f32_dpp v14, v14, v14 row_shr:2 row_mask:0xf bank_mask:0xf bound_ctrl:0
    s_nop 1
    v_add_f32_dpp v14, v14, v14 row_shr:4 row_mask:0xf bank_mask:0xf bound_ctrl:0
    s_nop 1
    v_add_f32_dpp v14, v14, v14 row_shr:8 row_mask:0xf bank_mask:0xf bound_ctrl:0
    s_nop 1
    v_add_f32_dpp v14, v14, v14 row_bcast:15 row_mask:0xa bank_mask:0xf
    s_nop 1
    v_add_f32_dpp v14, v14, v14 row_bcast:31 row_mask:0xc bank_mask:0xf
    s_nop 1
    v_readlane_b32 s47, v14, 63
    v_pk_add_f32 v[64:65], v[64:65], v[14:15] op_sel:[0,1] op_sel_hi:[1,1] neg_lo:[0,1] neg_hi:[0,1]
    v_pk_add_f32 v[66:67], v[66:67], v[14:15] op_sel:[0,1] op_sel_hi:[1,1] neg_lo:[0,1] neg_hi:[0,1]
    v_pk_add_f32 v[68:69], v[68:69], v[14:15] op_sel:[0,1] op_sel_hi:[1,1] neg_lo:[0,1] neg_hi:[0,1]
    v_pk_add_f32 v[70:71], v[70:71], v[14:15] op_sel:[0,1] op_sel_hi:[1,1] neg_lo:[0,1] neg_hi:[0,1]
    v_pk_add_f32 v[72:73], v[72:73], v[14:15] op_sel:[0,1] op_sel_hi:[1,1] neg_lo:[0,1] neg_hi:[0,1]
    v_pk_add_f32 v[74:75], v[74:75], v[14:15] op_sel:[0,1] op_sel_hi:[1,1] neg_lo:[0,1] neg_hi:[0,1]
    v_pk_add_f32 v[76:77], v[76:77], v[14:15] op_sel:[0,1] op_sel_hi:[1,1] neg_lo:[0,1] neg_hi:[0,1]
    v_pk_add_f32 v[78:79], v[78:79], v[14:15] op_sel:[0,1] op_sel_hi:[1,1] neg_lo:[0,1] neg_hi:[0,1]
    v_mov_b32 v14, s47
    v_mul_f32 v14, 0x3a800000, v14
    v_cvt_pk_bf16_f32 v14, 0, v14
    v_add_f32 v14, 0x3727c5ac, v14
    v_cvt_pk_bf16_f32 v14, 0, v14
    v_sqrt_f32 v14, v14
    s_nop 0
    v_cvt_pk_bf16_f32 v14, 0, v14
    v_rcp_f32 v14, v14
    v_cvt_pk_bf16_f32 v64, 0, v64
    v_cvt_pk_bf16_f32 v65, 0, v65
    v_cvt_pk_bf16_f32 v66, 0, v66
    v_cvt_pk_bf16_f32 v67, 0, v67
    v_cvt_pk_bf16_f32 v68, 0, v68
    v_cvt_pk_bf16_f32 v69, 0, v69
    v_cvt_pk_bf16_f32 v70, 0, v70
    v_cvt_pk_bf16_f32 v71, 0, v71
    v_cvt_pk_bf16_f32 v72, 0, v72
    v_cvt_pk_bf16_f32 v73, 0, v73
    v_cvt_pk_bf16_f32 v74, 0, v74
    v_cvt_pk_bf16_f32 v75, 0, v75
    v_cvt_pk_bf16_f32 v76, 0, v76
    v_cvt_pk_bf16_f32 v77, 0, v77
    v_cvt_pk_bf16_f32 v78, 0, v78
    v_cvt_pk_bf16_f32 v79, 0, v79
    v_pk_mul_f32 v[64:65], v[64:65], v[14:15] op_sel_hi:[1,0]
    v_pk_mul_f32 v[66:67], v[66:67], v[14:15] op_sel_hi:[1,0]
    v_pk_mul_f32 v[68:69], v[68:69], v[14:15] op_sel_hi:[1,0]
    v_pk_mul_f32 v[70:71], v[70:71], v[14:15] op_sel_hi:[1,0]
    v_pk_mul_f32 v[72:73], v[72:73], v[14:15] op_sel_hi:[1,0]
    v_pk_mul_f32 v[74:75], v[74:75], v[14:15] op_sel_hi:[1,0]
    v_pk_mul_f32 v[76:77], v[76:77], v[14:15] op_sel_hi:[1,0]
    v_pk_mul_f32 v[78:79], v[78:79], v[14:15] op_sel_hi:[1,0]
    v_cvt_pk_bf16_f32 v64, 0, v64
    v_cvt_pk_bf16_f32 v65, 0, v65
    v_cvt_pk_bf16_f32 v66, 0, v66
    v_cvt_pk_bf16_f32 v67, 0, v67
    v_cvt_pk_bf16_f32 v68, 0, v68
    v_cvt_pk_bf16_f32 v69, 0, v69
    v_cvt_pk_bf16_f32 v70, 0, v70
    v_cvt_pk_bf16_f32 v71, 0, v71
    v_cvt_pk_bf16_f32 v72, 0, v72
    v_cvt_pk_bf16_f32 v73, 0, v73
    v_cvt_pk_bf16_f32 v74, 0, v74
    v_cvt_pk_bf16_f32 v75, 0, v75
    v_cvt_pk_bf16_f32 v76, 0, v76
    v_cvt_pk_bf16_f32 v77, 0, v77
    v_cvt_pk_bf16_f32 v78, 0, v78
    v_cvt_pk_bf16_f32 v79, 0, v79
    v_pk_mul_f32 v[64:65], v[64:65], v[32:33]
    v_pk_mul_f32 v[66:67], v[66:67], v[34:35]
    v_pk_mul_f32 v[68:69], v[68:69], v[36:37]
    v_pk_mul_f32 v[70:71], v[70:71], v[38:39]
    v_pk_mul_f32 v[72:73], v[72:73], v[40:41]
    v_pk_mul_f32 v[74:75], v[74:75], v[42:43]
    v_pk_mul_f32 v[76:77], v[76:77], v[44:45]
    v_pk_mul_f32 v[78:79], v[78:79], v[46:47]
    v_cvt_pk_bf16_f32 v64, 0, v64
    v_cvt_pk_bf16_f32 v65, 0, v65
    v_cvt_pk_bf16_f32 v66, 0, v66
    v_cvt_pk_bf16_f32 v67, 0, v67
    v_cvt_pk_bf16_f32 v68, 0, v68
    v_cvt_pk_bf16_f32 v69, 0, v69
    v_cvt_pk_bf16_f32 v70, 0, v70
    v_cvt_pk_bf16_f32 v71, 0, v71
    v_cvt_pk_bf16_f32 v72, 0, v72
    v_cvt_pk_bf16_f32 v73, 0, v73
    v_cvt_pk_bf16_f32 v74, 0, v74
    v_cvt_pk_bf16_f32 v75, 0, v75
    v_cvt_pk_bf16_f32 v76, 0, v76
    v_cvt_pk_bf16_f32 v77, 0, v77
    v_cvt_pk_bf16_f32 v78, 0, v78
    v_cvt_pk_bf16_f32 v79, 0, v79
    v_pk_add_f32 v[64:65], v[64:65], v[48:49]
    v_pk_add_f32 v[66:67], v[66:67], v[50:51]
    v_pk_add_f32 v[68:69], v[68:69], v[52:53]
    v_pk_add_f32 v[70:71], v[70:71], v[54:55]
    v_pk_add_f32 v[72:73], v[72:73], v[56:57]
    v_pk_add_f32 v[74:75], v[74:75], v[58:59]
    v_pk_add_f32 v[76:77], v[76:77], v[60:61]
    v_pk_add_f32 v[78:79], v[78:79], v[62:63]
    v_cvt_pk_bf16_f32 v104, v64, v65
    v_cvt_pk_bf16_f32 v105, v66, v67
    v_cvt_pk_bf16_f32 v106, v68, v69
    v_cvt_pk_bf16_f32 v107, v70, v71
    v_cvt_pk_bf16_f32 v108, v72, v73
    v_cvt_pk_bf16_f32 v109, v74, v75
    v_cvt_pk_bf16_f32 v110, v76, v77
    v_cvt_pk_bf16_f32 v111, v78, v79
    ds_write_b128 v10, v[104:107]
    ds_write_b128 v10, v[108:111] offset:1024
    s_waitcnt lgkmcnt(0)
    s_barrier
    ds_read_b128 v[104:107], v13
    ds_read_b128 v[108:111], v13 offset:128
    s_waitcnt lgkmcnt(1)
    buffer_store_dwordx4 v[104:107], v11, s[12:15], s63 offen sc1
    s_waitcnt lgkmcnt(0)
    buffer_store_dwordx4 v[108:111], v12, s[12:15], s63 offen sc1
    s_waitcnt vmcnt(0)
    s_barrier
    s_cmp_lg_u32 s44, 0
    s_cbranch_scc1 L_sf_41
    v_mov_b32 v14, s60
    v_add_u32 v14, 1, v14
    v_mov_b32 v15, 0
    s_mov_b64 exec, 1
    buffer_store_dword v14, v15, s[12:15], s52 offen sc1
    s_mov_b64 exec, -1
L_sf_41:
    s_add_u32 s60, s60, 3
    s_cmp_lt_u32 s60, 64
    s_cbranch_scc1 L_r_loop_37
    s_branch L_c_done_1
L_w_att_15:
    s_lshl_b32 s42, s40, 2
    s_and_b32 s46, s44, 3
    s_add_u32 s42, s42, s46
    s_and_b32 s43, s48, 1
    s_lshl_b32 s43, s43, 1
    s_lshr_b32 s46, s44, 2
    s_add_u32 s43, s43, s46
    s_mul_i32 s46, s42, 24576
    s_add_u32 s46, s46, 0x2000000
    v_lshlrev_b32 v2, 4, v1
    v_add_u32 v3, s46, v2
    v_add_u32 v5, 4096, v3
    v_lshrrev_b32 v4, 4, v1
    v_and_b32 v9, 15, v1
    s_lshl_b32 s46, s42, 12
    s_add_u32 s46, s46, 0x1000000
    v_and_b32 v6, 7, v1
    v_lshlrev_b32 v6, 4, v6
    v_lshl_add_u32 v6, v4, 7, v6
    v_add_u32 v6, s46, v6
    v_and_b32 v7, 31, v1
    v_lshlrev_b32 v7, 4, v7
    v_lshrrev_b32 v10, 5, v1
    v_lshl_add_u32 v7, v10, 10, v7
    v_add_u32 v7, s46, v7
    s_mul_i32 s50, s44, 13056
    v_mul_u32_u24 v8, 272, v9
    v_lshl_add_u32 v8, v4, 4, v8
    v_add_u32 v8, s50, v8
    v_bfe_u32 v11, v1, 2, 3
    v_mul_u32_u24 v11, 272, v11
    v_lshl_add_u32 v11, v10, 6, v11
    v_and_b32 v12, 3, v1
    v_lshl_add_u32 v11, v12, 4, v11
    v_add_u32 v11, s50, v11
    v_mul_u32_u24 v14, 272, v4
    v_lshl_add_u32 v14, v9, 4, v14
    v_add_u32 v14, s50, v14
    v_mov_b32 v16, 0
    v_mov_b32 v17, 0
    v_mov_b32 v18, 0
    v_mov_b32 v19, 0
    ds_write_b128 v14, v[16:19] offset:10880
    ds_write_b128 v14, v[16:19] offset:11968
    v_lshlrev_b32 v12, 2, v4
    v_bfe_u32 v13, v1, 2, 2
    v_add_u32 v12, v12, v13
    v_mul_u32_u24 v12, 272, v12
    v_and_b32 v13, 3, v1
    v_lshl_add_u32 v12, v13, 3, v12
    v_add_u32 v12, s50, v12
    v_lshlrev_b32 v13, 10, v13
    s_lshl_b32 s46, s42, 12
    s_add_u32 s46, s46, 0x1000000
    v_add_u32 v13, s46, v13
    v_lshlrev_b32 v10, 9, v4
    v_lshl_add_u32 v10, v9, 4, v10
    s_lshl_b32 s46, s42, 13
    s_add_u32 s46, s46, 0x5000000
    v_add_u32 v10, s46, v10
    s_lshl_b32 s52, s42, 9
    s_lshl_b32 s47, s43, 7
    s_add_u32 s52, s52, s47
    s_add_u32 s52, s52, 0x102000
    v_min_u32 v42, 2, v1
    v_lshlrev_b32 v42, 9, v42
    s_lshl_b32 s46, s40, 11
    s_and_b32 s47, s42, 3
    s_lshl_b32 s47, s47, 7
    s_add_u32 s46, s46, s47
    s_add_u32 s46, s46, 0x10a400
    v_add_u32 v48, s46, v42
    s_mul_i32 s46, s42, 24576
    s_add_u32 s46, s46, 0x2000000
    v_lshlrev_b32 v49, 7, v1
    v_add_u32 v49, s46, v49
    v_cmp_le_u32 s[56:57], 32, v1
    v_lshlrev_b32 v14, 2, v4
    s_mov_b32 s54, 0x3e0293ee
    s_mov_b32 s60, s43
    v_add_u32 v15, 0, v14
    v_cmp_gt_u32 s[84:85], v15, v9
    v_add_u32 v15, 1, v14
    v_cmp_gt_u32 s[86:87], v15, v9
    v_add_u32 v15, 2, v14
    v_cmp_gt_u32 s[88:89], v15, v9
    v_add_u32 v15, 3, v14
    v_cmp_gt_u32 s[90:91], v15, v9
L_a_loop_42:
    s_mul_i32 s45, s60, 786432
    s_add_u32 s48, s45, 8192
    s_add_u32 s49, s45, 16384
    s_lshl_b32 s61, s60, 17
    s_lshl_b32 s63, s60, 18
    s_mov_b32 s70, 0
L_spin_43:
    buffer_load_dword v40, v48, s[12:15], 0 offen sc1
    s_waitcnt vmcnt(0)
    v_cmp_ge_u32 vcc, s60, v40
    s_add_u32 s70, s70, 1
    s_cbranch_vccz L_spok_44
    s_sleep 3
    s_cmp_lt_u32 s70, 524288
    s_cbranch_scc1 L_spin_43
    s_branch L_c_done_1
L_spok_44:
    buffer_load_dwordx4 a[0:3], v3, s[12:15], s45 offen offset:0 sc1
    buffer_load_dwordx4 a[4:7], v3, s[12:15], s45 offen offset:1024 sc1
    buffer_load_dwordx4 a[8:11], v3, s[12:15], s45 offen offset:2048 sc1
    buffer_load_dwordx4 a[12:15], v3, s[12:15], s45 offen offset:3072 sc1
    buffer_load_dwordx4 a[16:19], v5, s[12:15], s45 offen offset:0 sc1
    buffer_load_dwordx4 a[20:23], v5, s[12:15], s45 offen offset:1024 sc1
    buffer_load_dwordx4 a[24:27], v5, s[12:15], s45 offen offset:2048 sc1
    buffer_load_dwordx4 a[28:31], v5, s[12:15], s45 offen offset:3072 sc1
    buffer_load_dwordx4 a[32:35], v3, s[12:15], s48 offen offset:0 sc1
    buffer_load_dwordx4 a[36:39], v3, s[12:15], s48 offen offset:1024 sc1
    buffer_load_dwordx4 a[40:43], v3, s[12:15], s48 offen offset:2048 sc1
    buffer_load_dwordx4 a[44:47], v3, s[12:15], s48 offen offset:3072 sc1
    buffer_load_dwordx4 a[48:51], v5, s[12:15], s48 offen offset:0 sc1
    buffer_load_dwordx4 a[52:55], v5, s[12:15], s48 offen offset:1024 sc1
    buffer_load_dwordx4 a[56:59], v5, s[12:15], s48 offen offset:2048 sc1
    buffer_load_dwordx4 a[60:63], v5, s[12:15], s48 offen offset:3072 sc1
    buffer_load_dwordx4 v[16:19], v3, s[12:15], s49 offen offset:0 sc1
    buffer_load_dwordx4 v[20:23], v3, s[12:15], s49 offen offset:1024 sc1
    buffer_load_dwordx4 v[24:27], v3, s[12:15], s49 offen offset:2048 sc1
    buffer_load_dwordx4 v[28:31], v3, s[12:15], s49 offen offset:3072 sc1
    buffer_load_dwordx4 v[32:35], v5, s[12:15], s49 offen offset:0 sc1
    buffer_load_dwordx4 v[36:39], v5, s[12:15], s49 offen offset:1024 sc1
    buffer_load_dwordx4 v[40:43], v5, s[12:15], s49 offen offset:2048 sc1
    buffer_load_dwordx4 v[44:47], v5, s[12:15], s49 offen offset:3072 sc1
    s_waitcnt vmcnt(0)
    ds_write_b128 v8, v[16:19] offset:0
    ds_write_b128 v8, v[20:23] offset:64
    ds_write_b128 v8, v[24:27] offset:128
    ds_write_b128 v8, v[28:31] offset:192
    ds_write_b128 v8, v[32:35] offset:4352
    ds_write_b128 v8, v[36:39] offset:4416
    ds_write_b128 v8, v[40:43] offset:4480
    ds_write_b128 v8, v[44:47] offset:4544
    v_mfma_f32_16x16x32_bf16 v[56:59], a[32:35], a[0:3], 0
    v_mfma_f32_16x16x32_bf16 v[60:63], a[32:35], a[16:19], 0
    v_mfma_f32_16x16x32_bf16 v[68:71], a[48:51], a[16:19], 0
    v_mfma_f32_16x16x32_bf16 v[56:59], a[36:39], a[4:7], v[56:59]
    v_mfma_f32_16x16x32_bf16 v[60:63], a[36:39], a[20:23], v[60:63]
    v_mfma_f32_16x16x32_bf16 v[68:71], a[52:55], a[20:23], v[68:71]
    v_mfma_f32_16x16x32_bf16 v[56:59], a[40:43], a[8:11], v[56:59]
    v_mfma_f32_16x16x32_bf16 v[60:63], a[40:43], a[24:27], v[60:63]
    v_mfma_f32_16x16x32_bf16 v[68:71], a[56:59], a[24:27], v[68:71]
    v_mfma_f32_16x16x32_bf16 v[56:59], a[44:47], a[12:15], v[56:59]
    v_mfma_f32_16x16x32_bf16 v[60:63], a[44:47], a[28:31], v[60:63]
    v_mfma_f32_16x16x32_bf16 v[68:71], a[60:63], a[28:31], v[68:71]
    s_waitcnt lgkmcnt(0)
    ds_read_b64_tr_b16 a[80:81], v12 offset:0
    ds_read_b64_tr_b16 a[82:83], v12 offset:4352
    ds_read_b64_tr_b16 a[86:87], v12 offset:32
    ds_read_b64_tr_b16 a[88:89], v12 offset:4384
    ds_read_b64_tr_b16 a[92:93], v12 offset:64
    ds_read_b64_tr_b16 a[94:95], v12 offset:4416
    ds_read_b64_tr_b16 a[98:99], v12 offset:96
    ds_read_b64_tr_b16 a[100:101], v12 offset:4448
    s_waitcnt lgkmcnt(0)
    ds_read_b64_tr_b16 a[104:105], v12 offset:128
    ds_read_b64_tr_b16 a[106:107], v12 offset:4480
    ds_read_b64_tr_b16 a[110:111], v12 offset:160
    ds_read_b64_tr_b16 a[112:113], v12 offset:4512
    ds_read_b64_tr_b16 a[116:117], v12 offset:192
    ds_read_b64_tr_b16 a[118:119], v12 offset:4544
    ds_read_b64_tr_b16 a[122:123], v12 offset:224
    ds_read_b64_tr_b16 a[124:125], v12 offset:4576
    v_mov_b32 v15, 0xff800000
    v_cndmask_b32 v56, v56, v15, s[84:85]
    v_cndmask_b32 v68, v68, v15, s[84:85]
    v_cndmask_b32 v57, v57, v15, s[86:87]
    v_cndmask_b32 v69, v69, v15, s[86:87]
    v_cndmask_b32 v58, v58, v15, s[88:89]
    v_cndmask_b32 v70, v70, v15, s[88:89]
    v_cndmask_b32 v59, v59, v15, s[90:91]
    v_cndmask_b32 v71, v71, v15, s[90:91]
    s_mov_b32 s70, 0
L_a_cp_45:
    buffer_load_dword v40, v13, s[12:15], s61 offen sc1
    s_waitcnt vmcnt(0)
    v_cmp_eq_u32 vcc, -1, v40
    s_add_u32 s70, s70, 1
    s_cbranch_vccz L_a_fl_46
L_a_cp_45_s:
    s_sleep 4
    s_cmp_lt_u32 s70, 524288
    s_cbranch_scc1 L_a_cp_45
    s_branch L_c_done_1
L_a_fl_46:
    buffer_load_dwordx4 v[24:27], v6, s[12:15], s61 offen offset:0 sc1
    buffer_load_dwordx4 v[28:31], v6, s[12:15], s61 offen offset:1024 sc1
    buffer_load_dwordx4 v[32:35], v6, s[12:15], s61 offen offset:2048 sc1
    buffer_load_dwordx4 v[36:39], v6, s[12:15], s61 offen offset:3072 sc1
    buffer_load_dwordx4 v[16:19], v7, s[12:15], s61 offen offset:512 sc1
    buffer_load_dwordx4 v[20:23], v7, s[12:15], s61 offen offset:2560 sc1
    s_waitcnt vmcnt(0)
    v_max_u32 v40, v16, v17
    v_max3_u32 v40, v40, v18, v19
    v_max3_u32 v40, v40, v20, v21
    v_max3_u32 v40, v40, v22, v23
    v_max3_u32 v40, v40, v24, v25
    v_max3_u32 v40, v40, v26, v27
    v_max3_u32 v40, v40, v28, v29
    v_max3_u32 v40, v40, v30, v31
    v_max3_u32 v40, v40, v32, v33
    v_max3_u32 v40, v40, v34, v35
    v_max3_u32 v40, v40, v36, v37
    v_max3_u32 v40, v40, v38, v39
    v_cmp_eq_u32 vcc, -1, v40
    s_nop 0
    s_cbranch_vccnz L_a_cp_45_s
    v_mfma_f32_16x16x32_bf16 v[72:75], v[24:27], a[0:3], 0
    v_mfma_f32_16x16x32_bf16 v[76:79], v[24:27], a[16:19], 0
    v_mfma_f32_16x16x32_bf16 v[72:75], v[28:31], a[4:7], v[72:75]
    v_mfma_f32_16x16x32_bf16 v[76:79], v[28:31], a[20:23], v[76:79]
    v_mfma_f32_16x16x32_bf16 v[72:75], v[32:35], a[8:11], v[72:75]
    v_mfma_f32_16x16x32_bf16 v[76:79], v[32:35], a[24:27], v[76:79]
    v_mfma_f32_16x16x32_bf16 v[72:75], v[36:39], a[12:15], v[72:75]
    v_mfma_f32_16x16x32_bf16 v[76:79], v[36:39], a[28:31], v[76:79]
    ds_write_b128 v11, v[16:19] offset:8704
    ds_write_b128 v11, v[20:23] offset:8832
    s_waitcnt lgkmcnt(0)
    ds_read_b64_tr_b16 a[84:85], v12 offset:8704
    ds_read_b64_tr_b16 a[90:91], v12 offset:8736
    ds_read_b64_tr_b16 a[96:97], v12 offset:8768
    ds_read_b64_tr_b16 a[102:103], v12 offset:8800
    ds_read_b64_tr_b16 a[108:109], v12 offset:8832
    ds_read_b64_tr_b16 a[114:115], v12 offset:8864
    ds_read_b64_tr_b16 a[120:121], v12 offset:8896
    ds_read_b64_tr_b16 a[126:127], v12 offset:8928
    v_cndmask_b32 v72, v72, v15, s[56:57]
    v_cndmask_b32 v73, v73, v15, s[56:57]
    v_cndmask_b32 v74, v74, v15, s[56:57]
    v_cndmask_b32 v75, v75, v15, s[56:57]
    v_cndmask_b32 v76, v76, v15, s[56:57]
    v_cndmask_b32 v77, v77, v15, s[56:57]
    v_cndmask_b32 v78, v78, v15, s[56:57]
    v_cndmask_b32 v79, v79, v15, s[56:57]
    v_max_f32 v40, v56, v57
    v_max3_f32 v40, v40, v58, v59
    v_max3_f32 v40, v40, v72, v73
    v_max3_f32 v40, v40, v74, v75
    v_mov_b32 v41, v40
    s_nop 1
    v_permlane16_swap_b32 v40, v41
    v_max_f32 v40, v40, v41
    v_mov_b32 v41, v40
    s_nop 1
    v_permlane32_swap_b32 v40, v41
    v_max_f32 v40, v40, v41
    v_mul_f32 v40, s54, v40
    v_fma_f32 v56, v56, s54, -v40
    v_fma_f32 v57, v57, s54, -v40
    v_fma_f32 v58, v58, s54, -v40
    v_fma_f32 v59, v59, s54, -v40
    v_fma_f32 v72, v72, s54, -v40
    v_fma_f32 v73, v73, s54, -v40
    v_fma_f32 v74, v74, s54, -v40
    v_fma_f32 v75, v75, s54, -v40
    v_exp_f32 v56, v56
    v_exp_f32 v57, v57
    v_exp_f32 v58, v58
    v_exp_f32 v59, v59
    v_exp_f32 v72, v72
    v_exp_f32 v73, v73
    v_exp_f32 v74, v74
    v_exp_f32 v75, v75
    v_add_f32 v40, v56, v57
    v_add_f32 v40, v40, v58
    v_add_f32 v40, v40, v59
    v_add_f32 v40, v40, v72
    v_add_f32 v40, v40, v73
    v_add_f32 v40, v40, v74
    v_add_f32 v40, v40, v75
    v_mov_b32 v41, v40
    s_nop 1
    v_permlane16_swap_b32 v40, v41
    v_add_f32 v40, v40, v41
    v_mov_b32 v41, v40
    s_nop 1
    v_permlane32_swap_b32 v40, v41
    v_add_f32 v40, v40, v41
    v_rcp_f32 v40, v40
    s_nop 0
    v_mul_f32 v56, v56, v40
    v_mul_f32 v57, v57, v40
    v_mul_f32 v58, v58, v40
    v_mul_f32 v59, v59, v40
    v_mul_f32 v72, v72, v40
    v_mul_f32 v73, v73, v40
    v_mul_f32 v74, v74, v40
    v_mul_f32 v75, v75, v40
    v_cvt_pk_bf16_f32 v24, v56, v57
    v_cvt_pk_bf16_f32 v25, v58, v59
    v_cvt_pk_bf16_f32 v28, v72, v73
    v_cvt_pk_bf16_f32 v29, v74, v75
    v_max_f32 v40, v60, v61
    v_max3_f32 v40, v40, v62, v63
    v_max3_f32 v40, v40, v68, v69
    v_max3_f32 v40, v40, v70, v71
    v_max3_f32 v40, v40, v76, v77
    v_max3_f32 v40, v40, v78, v79
    v_mov_b32 v41, v40
    s_nop 1
    v_permlane16_swap_b32 v40, v41
    v_max_f32 v40, v40, v41
    v_mov_b32 v41, v40
    s_nop 1
    v_permlane32_swap_b32 v40, v41
    v_max_f32 v40, v40, v41
    v_mul_f32 v40, s54, v40
    v_fma_f32 v60, v60, s54, -v40
    v_fma_f32 v61, v61, s54, -v40
    v_fma_f32 v62, v62, s54, -v40
    v_fma_f32 v63, v63, s54, -v40
    v_fma_f32 v68, v68, s54, -v40
    v_fma_f32 v69, v69, s54, -v40
    v_fma_f32 v70, v70, s54, -v40
    v_fma_f32 v71, v71, s54, -v40
    v_fma_f32 v76, v76, s54, -v40
    v_fma_f32 v77, v77, s54, -v40
    v_fma_f32 v78, v78, s54, -v40
    v_fma_f32 v79, v79, s54, -v40
    v_exp_f32 v60, v60
    v_exp_f32 v61, v61
    v_exp_f32 v62, v62
    v_exp_f32 v63, v63
    v_exp_f32 v68, v68
    v_exp_f32 v69, v69
    v_exp_f32 v70, v70
    v_exp_f32 v71, v71
    v_exp_f32 v76, v76
    v_exp_f32 v77, v77
    v_exp_f32 v78, v78
    v_exp_f32 v79, v79
    v_add_f32 v40, v60, v61
    v_add_f32 v40, v40, v62
    v_add_f32 v40, v40, v63
    v_add_f32 v40, v40, v68
    v_add_f32 v40, v40, v69
    v_add_f32 v40, v40, v70
    v_add_f32 v40, v40, v71
    v_add_f32 v40, v40, v76
    v_add_f32 v40, v40, v77
    v_add_f32 v40, v40, v78
    v_add_f32 v40, v40, v79
    v_mov_b32 v41, v40
    s_nop 1
    v_permlane16_swap_b32 v40, v41
    v_add_f32 v40, v40, v41
    v_mov_b32 v41, v40
    s_nop 1
    v_permlane32_swap_b32 v40, v41
    v_add_f32 v40, v40, v41
    v_rcp_f32 v40, v40
    s_nop 0
    v_mul_f32 v60, v60, v40
    v_mul_f32 v61, v61, v40
    v_mul_f32 v62, v62, v40
    v_mul_f32 v63, v63, v40
    v_mul_f32 v68, v68, v40
    v_mul_f32 v69, v69, v40
    v_mul_f32 v70, v70, v40
    v_mul_f32 v71, v71, v40
    v_mul_f32 v76, v76, v40
    v_mul_f32 v77, v77, v40
    v_mul_f32 v78, v78, v40
    v_mul_f32 v79, v79, v40
    v_cvt_pk_bf16_f32 v30, v60, v61
    v_cvt_pk_bf16_f32 v31, v62, v63
    v_cvt_pk_bf16_f32 v32, v68, v69
    v_cvt_pk_bf16_f32 v33, v70, v71
    v_cvt_pk_bf16_f32 v34, v76, v77
    v_cvt_pk_bf16_f32 v35, v78, v79
    s_waitcnt lgkmcnt(0)
    s_nop 0
    v_mfma_f32_16x16x16_bf16 v[64:67], a[80:81], v[24:25], 0
    v_mfma_f32_16x16x16_bf16 v[68:71], a[86:87], v[24:25], 0
    v_mfma_f32_16x16x16_bf16 v[72:75], a[92:93], v[24:25], 0
    v_mfma_f32_16x16x16_bf16 v[76:79], a[98:99], v[24:25], 0
    v_mfma_f32_16x16x16_bf16 v[80:83], a[104:105], v[24:25], 0
    v_mfma_f32_16x16x16_bf16 v[84:87], a[110:111], v[24:25], 0
    v_mfma_f32_16x16x16_bf16 v[88:91], a[116:117], v[24:25], 0
    v_mfma_f32_16x16x16_bf16 v[92:95], a[122:123], v[24:25], 0
    v_mfma_f32_16x16x16_bf16 v[64:67], a[84:85], v[28:29], v[64:67]
    v_mfma_f32_16x16x16_bf16 v[68:71], a[90:91], v[28:29], v[68:71]
    v_mfma_f32_16x16x16_bf16 v[72:75], a[96:97], v[28:29], v[72:75]
    v_mfma_f32_16x16x16_bf16 v[76:79], a[102:103], v[28:29], v[76:79]
    v_mfma_f32_16x16x16_bf16 v[80:83], a[108:109], v[28:29], v[80:83]
    v_mfma_f32_16x16x16_bf16 v[84:87], a[114:115], v[28:29], v[84:87]
    v_mfma_f32_16x16x16_bf16 v[88:91], a[120:121], v[28:29], v[88:91]
    v_mfma_f32_16x16x16_bf16 v[92:95], a[126:127], v[28:29], v[92:95]
    v_mfma_f32_16x16x16_bf16 v[96:99], a[80:81], v[30:31], 0
    v_mfma_f32_16x16x16_bf16 v[100:103], a[86:87], v[30:31], 0
    v_mfma_f32_16x16x16_bf16 v[104:107], a[92:93], v[30:31], 0
    v_mfma_f32_16x16x16_bf16 v[108:111], a[98:99], v[30:31], 0
    v_mfma_f32_16x16x16_bf16 v[112:115], a[104:105], v[30:31], 0
    v_mfma_f32_16x16x16_bf16 v[116:119], a[110:111], v[30:31], 0
    v_mfma_f32_16x16x16_bf16 v[120:123], a[116:117], v[30:31], 0
    v_mfma_f32_16x16x16_bf16 v[124:127], a[122:123], v[30:31], 0
    v_mfma_f32_16x16x16_bf16 v[96:99], a[82:83], v[32:33], v[96:99]
    v_mfma_f32_16x16x16_bf16 v[100:103], a[88:89], v[32:33], v[100:103]
    v_mfma_f32_16x16x16_bf16 v[104:107], a[94:95], v[32:33], v[104:107]
    v_mfma_f32_16x16x16_bf16 v[108:111], a[100:101], v[32:33], v[108:111]
    v_mfma_f32_16x16x16_bf16 v[112:115], a[106:107], v[32:33], v[112:115]
    v_mfma_f32_16x16x16_bf16 v[116:119], a[112:113], v[32:33], v[116:119]
    v_mfma_f32_16x16x16_bf16 v[120:123], a[118:119], v[32:33], v[120:123]
    v_mfma_f32_16x16x16_bf16 v[124:127], a[124:125], v[32:33], v[124:127]
    v_mfma_f32_16x16x16_bf16 v[96:99], a[84:85], v[34:35], v[96:99]
    v_mfma_f32_16x16x16_bf16 v[100:103], a[90:91], v[34:35], v[100:103]
    v_mfma_f32_16x16x16_bf16 v[104:107], a[96:97], v[34:35], v[104:107]
    v_mfma_f32_16x16x16_bf16 v[108:111], a[102:103], v[34:35], v[108:111]
    v_mfma_f32_16x16x16_bf16 v[112:115], a[108:109], v[34:35], v[112:115]
    v_mfma_f32_16x16x16_bf16 v[116:119], a[114:115], v[34:35], v[116:119]
    v_mfma_f32_16x16x16_bf16 v[120:123], a[120:121], v[34:35], v[120:123]
    v_mfma_f32_16x16x16_bf16 v[124:127], a[126:127], v[34:35], v[124:127]
    s_add_u32 s46, s63, 4096
    v_cvt_pk_bf16_f32 v64, v64, v65
    v_cvt_pk_bf16_f32 v65, v66, v67
    v_cvt_pk_bf16_f32 v66, v68, v69
    v_cvt_pk_bf16_f32 v67, v70, v71
    buffer_store_dwordx4 v[64:67], v10, s[12:15], s63 offen offset:0 sc1
    v_cvt_pk_bf16_f32 v72, v72, v73
    v_cvt_pk_bf16_f32 v73, v74, v75
    v_cvt_pk_bf16_f32 v74, v76, v77
    v_cvt_pk_bf16_f32 v75, v78, v79
    buffer_store_dwordx4 v[72:75], v10, s[12:15], s63 offen offset:2048 sc1
    v_cvt_pk_bf16_f32 v80, v80, v81
    v_cvt_pk_bf16_f32 v81, v82, v83
    v_cvt_pk_bf16_f32 v82, v84, v85
    v_cvt_pk_bf16_f32 v83, v86, v87
    buffer_store_dwordx4 v[80:83], v10, s[12:15], s46 offen offset:0 sc1
    v_cvt_pk_bf16_f32 v88, v88, v89
    v_cvt_pk_bf16_f32 v89, v90, v91
    v_cvt_pk_bf16_f32 v90, v92, v93
    v_cvt_pk_bf16_f32 v91, v94, v95
    buffer_store_dwordx4 v[88:91], v10, s[12:15], s46 offen offset:2048 sc1
    v_cvt_pk_bf16_f32 v96, v96, v97
    v_cvt_pk_bf16_f32 v97, v98, v99
    v_cvt_pk_bf16_f32 v98, v100, v101
    v_cvt_pk_bf16_f32 v99, v102, v103
    buffer_store_dwordx4 v[96:99], v10, s[12:15], s63 offen offset:256 sc1
    v_cvt_pk_bf16_f32 v104, v104, v105
    v_cvt_pk_bf16_f32 v105, v106, v107
    v_cvt_pk_bf16_f32 v106, v108, v109
    v_cvt_pk_bf16_f32 v107, v110, v111
    buffer_store_dwordx4 v[104:107], v10, s[12:15], s63 offen offset:2304 sc1
    v_cvt_pk_bf16_f32 v112, v112, v113
    v_cvt_pk_bf16_f32 v113, v114, v115
    v_cvt_pk_bf16_f32 v114, v116, v117
    v_cvt_pk_bf16_f32 v115, v118, v119
    buffer_store_dwordx4 v[112:115], v10, s[12:15], s46 offen offset:256 sc1
    v_cvt_pk_bf16_f32 v120, v120, v121
    v_cvt_pk_bf16_f32 v121, v122, v123
    v_cvt_pk_bf16_f32 v122, v124, v125
    v_cvt_pk_bf16_f32 v123, v126, v127
    buffer_store_dwordx4 v[120:123], v10, s[12:15], s46 offen offset:2304 sc1
    s_waitcnt vmcnt(0)
    v_mov_b32 v16, s60
    v_add_u32 v16, 1, v16
    v_mov_b32 v17, 0
    s_mov_b64 exec, 1
    buffer_store_dword v16, v17, s[12:15], s52 offen sc1
    s_mov_b64 exec, -1
L_sf_48:
    s_add_u32 s60, s60, 4
    s_cmp_lt_u32 s60, 64
    s_cbranch_scc1 L_a_loop_42
    s_branch L_c_done_1
L_w_g_10:
    s_lshr_b32 s53, s48, 2
    s_cmp_lt_u32 s53, 2
    s_cselect_b32 s46, 1, 0
    s_xor_b32 s53, s53, s46
    s_mov_b32 s74, 0
    s_mov_b32 s76, 0
    s_cmp_eq_u32 s53, 1
    s_cselect_b32 s75, 46, 64
    s_cmp_eq_u32 s53, 2
    s_cselect_b32 s75, 54, s75
L_w_g_10_e:
    s_lshl_b32 s46, s53, 3
    s_add_u32 s46, s46, 16
    s_load_dwordx2 s[4:5], s[0:1], s46
    s_lshl_b32 s49, s40, 2
    s_and_b32 s46, s48, 3
    s_add_u32 s49, s49, s46
    s_load_dwordx2 s[6:7], s[0:1], 72
    s_and_b32 s50, s44, 3
    s_lshr_b32 s51, s44, 2
    s_waitcnt lgkmcnt(0)
    s_mov_b32 s24, s4
    s_and_b32 s25, s5, 0xffff
    s_mov_b32 s26, 0x800000
    s_mov_b32 s27, 0x00020000
    s_cmp_lg_u32 s53, 0
    s_cbranch_scc1 L_g_nq_49
    s_load_dwordx4 s[8:11], s[0:1], 24
    v_and_b32 v10, 255, v0
    v_lshlrev_b32 v10, 13, v10
    s_and_b32 s46, s48, 3
    s_lshl_b32 s46, s46, 21
    s_lshl_b32 s47, s40, 10
    s_add_u32 s46, s46, s47
    s_add_u32 s46, s46, 384
    s_waitcnt lgkmcnt(0)
    s_cmp_eq_u32 s51, 1
    s_cselect_b32 s8, s10, s8
    s_cselect_b32 s9, s11, s9
    s_mov_b32 s28, s8
    s_and_b32 s29, s9, 0xffff
    s_mov_b32 s30, 0x800000
    s_mov_b32 s31, 0x00020000
    buffer_load_dword v11, v10, s[28:31], s46 offen
    s_cmp_eq_u32 s51, 1
    s_cbranch_scc1 L_g_nq_49
    buffer_load_dword v12, v10, s[24:27], s46 offen
L_g_nq_49:
    v_lshrrev_b32 v3, 4, v1
    v_and_b32 v4, 15, v1
    v_lshlrev_b32 v5, 2, v3
    v_xor_b32 v4, v4, v5
    v_mul_u32_u24 v3, 8192, v3
    v_lshl_add_u32 v3, v4, 4, v3
    s_mul_i32 s46, s51, 512
    s_mul_i32 s47, s50, 64
    s_add_u32 s46, s46, s47
    s_mul_i32 s46, s46, 8192
    s_lshl_b32 s47, s49, 8
    s_add_u32 s46, s46, s47
    s_lshl_b32 s45, s51, 16
    s_mul_i32 s47, s50, 16384
    s_add_u32 s45, s45, s47
    v_bfe_u32 v4, v1, 2, 2
    v_bfe_u32 v5, v1, 4, 1
    v_lshlrev_b32 v5, 1, v5
    v_bfe_u32 v6, v1, 0, 1
    v_add_u32 v5, v5, v6
    s_lshl_b32 s47, s50, 2
    v_add_u32 v5, s47, v5
    v_lshlrev_b32 v6, 2, v4
    v_xor_b32 v5, v5, v6
    v_lshlrev_b32 v5, 4, v5
    v_lshl_add_u32 v5, v4, 8, v5
    v_bfe_u32 v6, v1, 1, 1
    v_lshl_add_u32 v5, v6, 3, v5
    v_lshrrev_b32 v6, 5, v1
    v_mul_u32_u24 v6, 2048, v6
    v_add_u32 v5, v5, v6
    s_lshl_b32 s47, s51, 16
    v_add_u32 v5, s47, v5
    v_bfe_u32 v4, v1, 2, 2
    v_xor_b32 v5, s50, v4
    v_lshlrev_b32 v5, 6, v5
    v_lshl_add_u32 v5, v4, 8, v5
    v_and_b32 v6, 3, v1
    v_lshl_add_u32 v5, v6, 4, v5
    v_lshrrev_b32 v6, 4, v1
    v_lshl_add_u32 v5, v6, 11, v5
    v_lshrrev_b32 v6, 5, v1
    s_lshl_b32 s47, s51, 16
    v_add_u32 v5, s47, v5
    s_add_u32 m0, s45, 0
    s_add_u32 s47, s46, 0x0
    buffer_load_dwordx4 v3, s[24:27], s47 offen lds
    s_add_u32 m0, s45, 1024
    s_add_u32 s47, s46, 0x8000
    buffer_load_dwordx4 v3, s[24:27], s47 offen lds
    s_add_u32 m0, s45, 2048
    s_add_u32 s47, s46, 0x10000
    buffer_load_dwordx4 v3, s[24:27], s47 offen lds
    s_add_u32 m0, s45, 3072
    s_add_u32 s47, s46, 0x18000
    buffer_load_dwordx4 v3, s[24:27], s47 offen lds
    s_add_u32 m0, s45, 4096
    s_add_u32 s47, s46, 0x20000
    buffer_load_dwordx4 v3, s[24:27], s47 offen lds
    s_add_u32 m0, s45, 5120
    s_add_u32 s47, s46, 0x28000
    buffer_load_dwordx4 v3, s[24:27], s47 offen lds
    s_add_u32 m0, s45, 6144
    s_add_u32 s47, s46, 0x30000
    buffer_load_dwordx4 v3, s[24:27], s47 offen lds
    s_add_u32 m0, s45, 7168
    s_add_u32 s47, s46, 0x38000
    buffer_load_dwordx4 v3, s[24:27], s47 offen lds
    s_add_u32 m0, s45, 8192
    s_add_u32 s47, s46, 0x40000
    buffer_load_dwordx4 v3, s[24:27], s47 offen lds
    s_add_u32 m0, s45, 9216
    s_add_u32 s47, s46, 0x48000
    buffer_load_dwordx4 v3, s[24:27], s47 offen lds
    s_add_u32 m0, s45, 10240
    s_add_u32 s47, s46, 0x50000
    buffer_load_dwordx4 v3, s[24:27], s47 offen lds
    s_add_u32 m0, s45, 11264
    s_add_u32 s47, s46, 0x58000
    buffer_load_dwordx4 v3, s[24:27], s47 offen lds
    s_add_u32 m0, s45, 12288
    s_add_u32 s47, s46, 0x60000
    buffer_load_dwordx4 v3, s[24:27], s47 offen lds
    s_add_u32 m0, s45, 13312
    s_add_u32 s47, s46, 0x68000
    buffer_load_dwordx4 v3, s[24:27], s47 offen lds
    s_add_u32 m0, s45, 14336
    s_add_u32 s47, s46, 0x70000
    buffer_load_dwordx4 v3, s[24:27], s47 offen lds
    s_add_u32 m0, s45, 15360
    s_add_u32 s47, s46, 0x78000
    buffer_load_dwordx4 v3, s[24:27], s47 offen lds
    s_waitcnt vmcnt(0)
    s_barrier
    ds_read_b64_tr_b16 a[0:1], v5 offset:0
    ds_read_b64_tr_b16 a[2:3], v5 offset:1024
    ds_read_b64_tr_b16 a[4:5], v5 offset:8
    ds_read_b64_tr_b16 a[6:7], v5 offset:1032
    ds_read_b64_tr_b16 a[8:9], v5 offset:8192
    ds_read_b64_tr_b16 a[10:11], v5 offset:9216
    ds_read_b64_tr_b16 a[12:13], v5 offset:8200
    ds_read_b64_tr_b16 a[14:15], v5 offset:9224
    s_waitcnt lgkmcnt(0)
    ds_read_b64_tr_b16 a[16:17], v5 offset:16384
    ds_read_b64_tr_b16 a[18:19], v5 offset:17408
    ds_read_b64_tr_b16 a[20:21], v5 offset:16392
    ds_read_b64_tr_b16 a[22:23], v5 offset:17416
    ds_read_b64_tr_b16 a[24:25], v5 offset:24576
    ds_read_b64_tr_b16 a[26:27], v5 offset:25600
    ds_read_b64_tr_b16 a[28:29], v5 offset:24584
    ds_read_b64_tr_b16 a[30:31], v5 offset:25608
    s_waitcnt lgkmcnt(0)
    ds_read_b64_tr_b16 a[32:33], v5 offset:32768
    ds_read_b64_tr_b16 a[34:35], v5 offset:33792
    ds_read_b64_tr_b16 a[36:37], v5 offset:32776
    ds_read_b64_tr_b16 a[38:39], v5 offset:33800
    ds_read_b64_tr_b16 a[40:41], v5 offset:40960
    ds_read_b64_tr_b16 a[42:43], v5 offset:41984
    ds_read_b64_tr_b16 a[44:45], v5 offset:40968
    ds_read_b64_tr_b16 a[46:47], v5 offset:41992
    s_waitcnt lgkmcnt(0)
    ds_read_b64_tr_b16 a[48:49], v5 offset:49152
    ds_read_b64_tr_b16 a[50:51], v5 offset:50176
    ds_read_b64_tr_b16 a[52:53], v5 offset:49160
    ds_read_b64_tr_b16 a[54:55], v5 offset:50184
    ds_read_b64_tr_b16 a[56:57], v5 offset:57344
    ds_read_b64_tr_b16 a[58:59], v5 offset:58368
    ds_read_b64_tr_b16 a[60:61], v5 offset:57352
    ds_read_b64_tr_b16 a[62:63], v5 offset:58376
    s_waitcnt lgkmcnt(0)
    s_waitcnt lgkmcnt(0)
    s_barrier
    s_add_u32 m0, s45, 0
    s_add_u32 s47, s46, 0x200000
    buffer_load_dwordx4 v3, s[24:27], s47 offen lds
    s_add_u32 m0, s45, 1024
    s_add_u32 s47, s46, 0x208000
    buffer_load_dwordx4 v3, s[24:27], s47 offen lds
    s_add_u32 m0, s45, 2048
    s_add_u32 s47, s46, 0x210000
    buffer_load_dwordx4 v3, s[24:27], s47 offen lds
    s_add_u32 m0, s45, 3072
    s_add_u32 s47, s46, 0x218000
    buffer_load_dwordx4 v3, s[24:27], s47 offen lds
    s_add_u32 m0, s45, 4096
    s_add_u32 s47, s46, 0x220000
    buffer_load_dwordx4 v3, s[24:27], s47 offen lds
    s_add_u32 m0, s45, 5120
    s_add_u32 s47, s46, 0x228000
    buffer_load_dwordx4 v3, s[24:27], s47 offen lds
    s_add_u32 m0, s45, 6144
    s_add_u32 s47, s46, 0x230000
    buffer_load_dwordx4 v3, s[24:27], s47 offen lds
    s_add_u32 m0, s45, 7168
    s_add_u32 s47, s46, 0x238000
    buffer_load_dwordx4 v3, s[24:27], s47 offen lds
    s_add_u32 m0, s45, 8192
    s_add_u32 s47, s46, 0x240000
    buffer_load_dwordx4 v3, s[24:27], s47 offen lds
    s_add_u32 m0, s45, 9216
    s_add_u32 s47, s46, 0x248000
    buffer_load_dwordx4 v3, s[24:27], s47 offen lds
    s_add_u32 m0, s45, 10240
    s_add_u32 s47, s46, 0x250000
    buffer_load_dwordx4 v3, s[24:27], s47 offen lds
    s_add_u32 m0, s45, 11264
    s_add_u32 s47, s46, 0x258000
    buffer_load_dwordx4 v3, s[24:27], s47 offen lds
    s_add_u32 m0, s45, 12288
    s_add_u32 s47, s46, 0x260000
    buffer_load_dwordx4 v3, s[24:27], s47 offen lds
    s_add_u32 m0, s45, 13312
    s_add_u32 s47, s46, 0x268000
    buffer_load_dwordx4 v3, s[24:27], s47 offen lds
    s_add_u32 m0, s45, 14336
    s_add_u32 s47, s46, 0x270000
    buffer_load_dwordx4 v3, s[24:27], s47 offen lds
    s_add_u32 m0, s45, 15360
    s_add_u32 s47, s46, 0x278000
    buffer_load_dwordx4 v3, s[24:27], s47 offen lds
    s_waitcnt vmcnt(0)
    s_barrier
    ds_read_b64_tr_b16 a[64:65], v5 offset:0
    ds_read_b64_tr_b16 a[66:67], v5 offset:1024
    ds_read_b64_tr_b16 a[68:69], v5 offset:8
    ds_read_b64_tr_b16 a[70:71], v5 offset:1032
    ds_read_b64_tr_b16 a[72:73], v5 offset:8192
    ds_read_b64_tr_b16 a[74:75], v5 offset:9216
    ds_read_b64_tr_b16 a[76:77], v5 offset:8200
    ds_read_b64_tr_b16 a[78:79], v5 offset:9224
    s_waitcnt lgkmcnt(0)
    ds_read_b64_tr_b16 a[80:81], v5 offset:16384
    ds_read_b64_tr_b16 a[82:83], v5 offset:17408
    ds_read_b64_tr_b16 a[84:85], v5 offset:16392
    ds_read_b64_tr_b16 a[86:87], v5 offset:17416
    ds_read_b64_tr_b16 a[88:89], v5 offset:24576
    ds_read_b64_tr_b16 a[90:91], v5 offset:25600
    ds_read_b64_tr_b16 a[92:93], v5 offset:24584
    ds_read_b64_tr_b16 a[94:95], v5 offset:25608
    s_waitcnt lgkmcnt(0)
    ds_read_b64_tr_b16 a[96:97], v5 offset:32768
    ds_read_b64_tr_b16 a[98:99], v5 offset:33792
    ds_read_b64_tr_b16 a[100:101], v5 offset:32776
    ds_read_b64_tr_b16 a[102:103], v5 offset:33800
    ds_read_b64_tr_b16 a[104:105], v5 offset:40960
    ds_read_b64_tr_b16 a[106:107], v5 offset:41984
    ds_read_b64_tr_b16 a[108:109], v5 offset:40968
    ds_read_b64_tr_b16 a[110:111], v5 offset:41992
    s_waitcnt lgkmcnt(0)
    ds_read_b64_tr_b16 a[112:113], v5 offset:49152
    ds_read_b64_tr_b16 a[114:115], v5 offset:50176
    ds_read_b64_tr_b16 a[116:117], v5 offset:49160
    ds_read_b64_tr_b16 a[118:119], v5 offset:50184
    ds_read_b64_tr_b16 a[120:121], v5 offset:57344
    ds_read_b64_tr_b16 a[122:123], v5 offset:58368
    ds_read_b64_tr_b16 a[124:125], v5 offset:57352
    ds_read_b64_tr_b16 a[126:127], v5 offset:58376
    s_waitcnt lgkmcnt(0)
    s_waitcnt lgkmcnt(0)
    s_barrier
    v_lshlrev_b32 v2, 4, v1
    s_mul_i32 s64, s44, 8192
    s_add_u32 s46, s64, 0x400000
    v_add_u32 v3, s46, v2
    s_mul_i32 s46, s51, 32768
    v_add_u32 v4, s46, v2
    v_and_b32 v6, 15, v1
    v_lshlrev_b32 v6, 4, v6
    v_lshrrev_b32 v7, 4, v1
    v_lshl_add_u32 v6, v7, 9, v6
    v_add_u32 v4, s46, v6
    s_lshl_b32 s46, s50, 12
    s_add_u32 s46, s46, 131072
    v_add_u32 v5, s46, v2
    v_and_b32 v7, 3, v1
    v_lshlrev_b32 v7, 7, v7
    v_add_u32 v7, 0x109400, v7
    s_mul_i32 s46, s49, 24576
    s_lshl_b32 s47, s53, 13
    s_add_u32 s46, s46, s47
    s_lshl_b32 s47, s50, 10
    s_add_u32 s46, s46, s47
    s_add_u32 s46, s46, 0x2000000
    v_and_b32 v8, 15, v1
    v_lshlrev_b32 v8, 4, v8
    v_bfe_u32 v9, v1, 4, 1
    v_lshl_add_u32 v8, v9, 12, v8
    v_lshrrev_b32 v9, 5, v1
    v_lshl_add_u32 v8, v9, 8, v8
    v_add_u32 v8, s46, v2
    v_add_u32 v9, 4096, v8
    s_lshl_b32 s52, s40, 2
    s_add_u32 s52, s52, s53
    s_lshl_b32 s52, s52, 2
    s_and_b32 s47, s48, 3
    s_add_u32 s52, s52, s47
    s_lshl_b32 s52, s52, 7
    s_add_u32 s52, s52, 0x10a400
    s_add_u32 s52, s52, s76
    v_mov_b32 v116, -1
    v_mov_b32 v117, -1
    v_mov_b32 v118, -1
    v_mov_b32 v119, -1
    s_lshl_b32 s46, s49, 12
    s_lshl_b32 s47, s50, 10
    s_add_u32 s46, s46, s47
    s_add_u32 s46, s46, 0x1000000
    v_add_u32 v64, s46, v2
    s_and_b32 s46, s48, 3
    s_lshl_b32 s46, s46, 16
    s_lshl_b32 s47, s50, 14
    s_add_u32 s46, s46, s47
    s_lshl_b32 s47, s40, 8
    s_add_u32 s46, s46, s47
    s_add_u32 s46, s46, 0x7800000
    v_and_b32 v65, 15, v1
    v_lshlrev_b32 v65, 4, v65
    v_lshrrev_b32 v66, 4, v1
    v_lshl_add_u32 v65, v66, 11, v65
    v_add_u32 v65, s46, v65
    v_add_u32 v68, 8192, v65
    s_lshl_b32 s58, s74, 17
    s_lshl_b32 s46, s53, 3
    s_sub_u32 s46, 80, s46
    s_load_dwordx2 s[8:9], s[0:1], s46
    v_lshlrev_b32 v66, 7, v1
    s_mul_i32 s57, s49, 229376
    s_waitcnt lgkmcnt(0)
    s_mov_b32 s32, s8
    s_and_b32 s33, s9, 0xffff
    s_mov_b32 s34, 0x700000
    s_mov_b32 s35, 0x00020000
    s_mov_b32 s60, s74
    s_mul_i32 s61, s74, 65536
    s_mov_b32 s62, s74
    s_mul_i32 s63, s74, 786432
    s_mov_b32 s67, 0
    s_mov_b32 s68, 3
    s_mov_b32 s71, 0
    v_mov_b32 v15, 147456
    v_mov_b32 v14, 0
    ds_write_b32 v15, v14 offset:4
    ds_write_b32 v15, v14 offset:12
    ds_write_b32 v15, v14 offset:16
    v_mov_b32 v114, 1
    v_mov_b32 v115, 0
    v_lshrrev_b32 v113, 4, v1
    s_mov_b32 s72, 0
    s_cmp_lg_u32 s44, 0
    s_cbranch_scc1 L_zwok_59
    v_and_b32 v10, 7, v1
    v_lshlrev_b32 v10, 5, v10
    s_mov_b32 s70, 0
L_zw_58:
    buffer_load_dword v11, v10, s[16:19], 0 offen sc1
    s_waitcnt vmcnt(0)
    v_add_u32_dpp v11, v11, v11 row_ror:1 row_mask:0xf bank_mask:0xf
    s_nop 1
    v_add_u32_dpp v11, v11, v11 row_ror:2 row_mask:0xf bank_mask:0xf
    s_nop 1
    v_add_u32_dpp v11, v11, v11 row_ror:4 row_mask:0xf bank_mask:0xf
    v_cmp_ne_u32 vcc, 0x100, v11
    s_add_u32 s70, s70, 1
    s_cbranch_vccz L_zwok_59
    s_sleep 4
    s_cmp_lt_u32 s70, 524288
    s_cbranch_scc1 L_zw_58
    s_branch L_c_done_1
L_zwok_59:
L_g_restart_50:
    s_cmp_lg_u32 s44, 0
    s_cbranch_scc1 L_g_nsp_51
    s_mov_b32 s70, 0
L_g_sp_57:
    s_add_u32 s54, s60, 0
    v_add_u32 v12, s54, v113
    v_and_b32 v13, 7, v12
    v_lshl_add_u32 v13, v13, 9, v7
    buffer_load_dword v11, v13, s[12:15], 0 offen sc1
    s_waitcnt vmcnt(0)
    v_cmp_ge_u32 vcc, v12, v11
    s_add_u32 s70, s70, 1
    s_and_b32 s46, vcc_lo, 0xffff
    s_cbranch_scc0 L_g_sp_57_ok
    s_sleep 3
    s_cmp_lt_u32 s70, 524288
    s_cbranch_scc1 L_g_sp_57
    s_branch L_c_done_1
L_g_sp_57_ok:
    v_cmp_ge_u32 vcc, v12, v11
    s_nop 0
    s_ff1_i32_b64 s46, vcc
    s_lshr_b32 s46, s46, 4
    s_min_u32 s46, s46, 4
    s_add_u32 s46, s46, s54
    s_min_u32 s46, s46, s75
    v_mov_b32 v11, s46
    ds_write_b32 v15, v11
L_g_nsp_51:
    s_waitcnt lgkmcnt(0)
    s_barrier
    ds_read_b32 v14, v15
    s_waitcnt lgkmcnt(0)
    v_readfirstlane_b32 s66, v14
    s_nop 3
L_g_restart_50_go:
    s_mov_b32 s69, 0
    s_cmp_gt_u32 s62, s60
    s_cbranch_scc1 L_g_nd_60
    s_cmp_ge_u32 s62, s66
    s_cbranch_scc1 L_g_nd_60
    s_add_u32 s47, s61, 4096
    s_add_u32 m0, s64, 0
    s_nop 0
    buffer_load_dwordx4 v3, s[12:15], s61 offen offset:0 sc1 lds
    buffer_load_dwordx4 v3, s[12:15], s61 offen offset:1024 sc1 lds
    buffer_load_dwordx4 v3, s[12:15], s61 offen offset:2048 sc1 lds
    buffer_load_dwordx4 v3, s[12:15], s61 offen offset:3072 sc1 lds
    s_add_u32 m0, s64, 4096
    s_nop 0
    buffer_load_dwordx4 v3, s[12:15], s47 offen offset:0 sc1 lds
    buffer_load_dwordx4 v3, s[12:15], s47 offen offset:1024 sc1 lds
    buffer_load_dwordx4 v3, s[12:15], s47 offen offset:2048 sc1 lds
    buffer_load_dwordx4 v3, s[12:15], s47 offen offset:3072 sc1 lds
    s_add_u32 s61, s61, 65536
    s_add_u32 s62, s62, 1
    s_xor_b32 s64, s64, 0x10000
    s_mov_b32 s69, 1
L_g_nd_60:
    s_cmp_eq_u32 s51, 1
    s_cbranch_scc1 L_g_g1r_52
    s_add_u32 s59, s60, 1
    s_mov_b32 s69, 0
    s_cmp_gt_u32 s62, s59
    s_cbranch_scc1 L_g_nd_61
    s_cmp_ge_u32 s62, s66
    s_cbranch_scc1 L_g_nd_61
    s_add_u32 s47, s61, 4096
    s_add_u32 m0, s64, 0
    s_nop 0
    buffer_load_dwordx4 v3, s[12:15], s61 offen offset:0 sc1 lds
    buffer_load_dwordx4 v3, s[12:15], s61 offen offset:1024 sc1 lds
    buffer_load_dwordx4 v3, s[12:15], s61 offen offset:2048 sc1 lds
    buffer_load_dwordx4 v3, s[12:15], s61 offen offset:3072 sc1 lds
    s_add_u32 m0, s64, 4096
    s_nop 0
    buffer_load_dwordx4 v3, s[12:15], s47 offen offset:0 sc1 lds
    buffer_load_dwordx4 v3, s[12:15], s47 offen offset:1024 sc1 lds
    buffer_load_dwordx4 v3, s[12:15], s47 offen offset:2048 sc1 lds
    buffer_load_dwordx4 v3, s[12:15], s47 offen offset:3072 sc1 lds
    s_add_u32 s61, s61, 65536
    s_add_u32 s62, s62, 1
    s_xor_b32 s64, s64, 0x10000
    s_mov_b32 s69, 1
L_g_nd_61:
    s_cmp_eq_u32 s69, 1
    s_cbranch_scc1 L_g_w0_62
    s_waitcnt vmcnt(0)
L_g_w0_62:
    s_waitcnt vmcnt(8)
    s_cmp_lg_u32 s44, 0
    s_cbranch_scc1 L_g_nl_63
    s_add_u32 s54, s60, 1
    v_add_u32 v12, s54, v113
    v_and_b32 v13, 7, v12
    v_lshl_add_u32 v13, v13, 9, v7
    buffer_load_dword v11, v13, s[12:15], 0 offen sc1
L_g_nl_63:
L_g_loop0_53_l:
    s_barrier
    ds_read_b128 v[32:35], v4 offset:0
    ds_read_b128 v[36:39], v4 offset:256
    ds_read_b128 v[40:43], v4 offset:2048
    ds_read_b128 v[44:47], v4 offset:2304
    ds_read_b128 v[48:51], v4 offset:4096
    ds_read_b128 v[52:55], v4 offset:4352
    ds_read_b128 v[56:59], v4 offset:6144
    ds_read_b128 v[60:63], v4 offset:6400
    s_branch L_g_loop0_53_m
.p2align 6
L_g_loop0_53:
    s_barrier
L_g_loop0_53_m:
    s_setprio 2
    s_waitcnt lgkmcnt(6)
    v_mfma_f32_16x16x32_bf16 v[16:19], a[0:3], v[32:35], 0
    ds_read_b32 v14, v15
    v_mfma_f32_16x16x32_bf16 v[20:23], a[4:7], v[32:35], 0
    ds_read_b128 v[32:35], v4 offset:8192
    v_mfma_f32_16x16x32_bf16 v[28:31], a[4:7], v[36:39], 0
    v_mfma_f32_16x16x32_bf16 v[24:27], a[0:3], v[36:39], 0
    ds_read_b128 v[36:39], v4 offset:8448
    s_waitcnt lgkmcnt(6)
    v_mfma_f32_16x16x32_bf16 v[16:19], a[8:11], v[40:43], v[16:19]
    v_mfma_f32_16x16x32_bf16 v[20:23], a[12:15], v[40:43], v[20:23]
    ds_read_b128 v[40:43], v4 offset:10240
    v_mfma_f32_16x16x32_bf16 v[28:31], a[12:15], v[44:47], v[28:31]
    v_mfma_f32_16x16x32_bf16 v[24:27], a[8:11], v[44:47], v[24:27]
    ds_read_b128 v[44:47], v4 offset:10496
    s_waitcnt lgkmcnt(6)
    v_mfma_f32_16x16x32_bf16 v[16:19], a[16:19], v[48:51], v[16:19]
    v_mfma_f32_16x16x32_bf16 v[20:23], a[20:23], v[48:51], v[20:23]
    ds_read_b128 v[48:51], v4 offset:12288
    v_mfma_f32_16x16x32_bf16 v[28:31], a[20:23], v[52:55], v[28:31]
    v_mfma_f32_16x16x32_bf16 v[24:27], a[16:19], v[52:55], v[24:27]
    ds_read_b128 v[52:55], v4 offset:12544
    s_waitcnt lgkmcnt(6)
    v_mfma_f32_16x16x32_bf16 v[16:19], a[24:27], v[56:59], v[16:19]
    v_mfma_f32_16x16x32_bf16 v[20:23], a[28:31], v[56:59], v[20:23]
    ds_read_b128 v[56:59], v4 offset:14336
    v_mfma_f32_16x16x32_bf16 v[28:31], a[28:31], v[60:63], v[28:31]
    v_mfma_f32_16x16x32_bf16 v[24:27], a[24:27], v[60:63], v[24:27]
    ds_read_b128 v[60:63], v4 offset:14592
    s_waitcnt lgkmcnt(6)
    v_mfma_f32_16x16x32_bf16 v[16:19], a[32:35], v[32:35], v[16:19]
    v_mfma_f32_16x16x32_bf16 v[20:23], a[36:39], v[32:35], v[20:23]
    ds_read_b128 v[32:35], v4 offset:16384
    v_mfma_f32_16x16x32_bf16 v[28:31], a[36:39], v[36:39], v[28:31]
    v_mfma_f32_16x16x32_bf16 v[24:27], a[32:35], v[36:39], v[24:27]
    ds_read_b128 v[36:39], v4 offset:16640
    s_waitcnt lgkmcnt(6)
    v_mfma_f32_16x16x32_bf16 v[16:19], a[40:43], v[40:43], v[16:19]
    v_mfma_f32_16x16x32_bf16 v[20:23], a[44:47], v[40:43], v[20:23]
    ds_read_b128 v[40:43], v4 offset:18432
    v_mfma_f32_16x16x32_bf16 v[28:31], a[44:47], v[44:47], v[28:31]
    v_mfma_f32_16x16x32_bf16 v[24:27], a[40:43], v[44:47], v[24:27]
    ds_read_b128 v[44:47], v4 offset:18688
    s_waitcnt lgkmcnt(6)
    v_mfma_f32_16x16x32_bf16 v[16:19], a[48:51], v[48:51], v[16:19]
    v_mfma_f32_16x16x32_bf16 v[20:23], a[52:55], v[48:51], v[20:23]
    ds_read_b128 v[48:51], v4 offset:20480
    v_mfma_f32_16x16x32_bf16 v[28:31], a[52:55], v[52:55], v[28:31]
    v_mfma_f32_16x16x32_bf16 v[24:27], a[48:51], v[52:55], v[24:27]
    ds_read_b128 v[52:55], v4 offset:20736
    s_waitcnt lgkmcnt(6)
    v_mfma_f32_16x16x32_bf16 v[16:19], a[56:59], v[56:59], v[16:19]
    v_mfma_f32_16x16x32_bf16 v[20:23], a[60:63], v[56:59], v[20:23]
    ds_read_b128 v[56:59], v4 offset:22528
    v_mfma_f32_16x16x32_bf16 v[28:31], a[60:63], v[60:63], v[28:31]
    v_mfma_f32_16x16x32_bf16 v[24:27], a[56:59], v[60:63], v[24:27]
    ds_read_b128 v[60:63], v4 offset:22784
    s_waitcnt lgkmcnt(6)
    v_mfma_f32_16x16x32_bf16 v[16:19], a[64:67], v[32:35], v[16:19]
    v_mfma_f32_16x16x32_bf16 v[20:23], a[68:71], v[32:35], v[20:23]
    ds_read_b128 v[32:35], v4 offset:24576
    v_mfma_f32_16x16x32_bf16 v[28:31], a[68:71], v[36:39], v[28:31]
    v_mfma_f32_16x16x32_bf16 v[24:27], a[64:67], v[36:39], v[24:27]
    ds_read_b128 v[36:39], v4 offset:24832
    s_waitcnt lgkmcnt(6)
    v_mfma_f32_16x16x32_bf16 v[16:19], a[72:75], v[40:43], v[16:19]
    v_mfma_f32_16x16x32_bf16 v[20:23], a[76:79], v[40:43], v[20:23]
    ds_read_b128 v[40:43], v4 offset:26624
    v_mfma_f32_16x16x32_bf16 v[28:31], a[76:79], v[44:47], v[28:31]
    v_mfma_f32_16x16x32_bf16 v[24:27], a[72:75], v[44:47], v[24:27]
    ds_read_b128 v[44:47], v4 offset:26880
    s_waitcnt lgkmcnt(6)
    v_mfma_f32_16x16x32_bf16 v[16:19], a[80:83], v[48:51], v[16:19]
    v_mfma_f32_16x16x32_bf16 v[20:23], a[84:87], v[48:51], v[20:23]
    ds_read_b128 v[48:51], v4 offset:28672
    v_mfma_f32_16x16x32_bf16 v[28:31], a[84:87], v[52:55], v[28:31]
    v_mfma_f32_16x16x32_bf16 v[24:27], a[80:83], v[52:55], v[24:27]
    ds_read_b128 v[52:55], v4 offset:28928
    s_waitcnt lgkmcnt(6)
    v_mfma_f32_16x16x32_bf16 v[16:19], a[88:91], v[56:59], v[16:19]
    v_mfma_f32_16x16x32_bf16 v[20:23], a[92:95], v[56:59], v[20:23]
    ds_read_b128 v[56:59], v4 offset:30720
    v_mfma_f32_16x16x32_bf16 v[28:31], a[92:95], v[60:63], v[28:31]
    v_mfma_f32_16x16x32_bf16 v[24:27], a[88:91], v[60:63], v[24:27]
    ds_read_b128 v[60:63], v4 offset:30976
    s_waitcnt lgkmcnt(6)
    v_mfma_f32_16x16x32_bf16 v[16:19], a[96:99], v[32:35], v[16:19]
    v_mfma_f32_16x16x32_bf16 v[20:23], a[100:103], v[32:35], v[20:23]
    v_mfma_f32_16x16x32_bf16 v[28:31], a[100:103], v[36:39], v[28:31]
    v_mfma_f32_16x16x32_bf16 v[24:27], a[96:99], v[36:39], v[24:27]
    s_waitcnt lgkmcnt(4)
    v_mfma_f32_16x16x32_bf16 v[16:19], a[104:107], v[40:43], v[16:19]
    v_mfma_f32_16x16x32_bf16 v[20:23], a[108:111], v[40:43], v[20:23]
    v_mfma_f32_16x16x32_bf16 v[28:31], a[108:111], v[44:47], v[28:31]
    v_mfma_f32_16x16x32_bf16 v[24:27], a[104:107], v[44:47], v[24:27]
    s_waitcnt lgkmcnt(2)
    v_mfma_f32_16x16x32_bf16 v[16:19], a[112:115], v[48:51], v[16:19]
    v_mfma_f32_16x16x32_bf16 v[20:23], a[116:119], v[48:51], v[20:23]
    v_mfma_f32_16x16x32_bf16 v[28:31], a[116:119], v[52:55], v[28:31]
    v_mfma_f32_16x16x32_bf16 v[24:27], a[112:115], v[52:55], v[24:27]
    s_waitcnt lgkmcnt(0)
    v_mfma_f32_16x16x32_bf16 v[16:19], a[120:123], v[56:59], v[16:19]
    v_mfma_f32_16x16x32_bf16 v[20:23], a[124:127], v[56:59], v[20:23]
    v_mfma_f32_16x16x32_bf16 v[28:31], a[124:127], v[60:63], v[28:31]
    v_mfma_f32_16x16x32_bf16 v[24:27], a[120:123], v[60:63], v[24:27]
    v_xor_b32 v4, 0x10000, v4
    s_setprio 0
    s_waitcnt vmcnt(0)
    v_readfirstlane_b32 s66, v14
    s_barrier
    s_nop 6
    ds_write_b128 v5, v[16:19] offset:0
    ds_write_b128 v5, v[20:23] offset:1024
    ds_write_b128 v5, v[24:27] offset:2048
    ds_write_b128 v5, v[28:31] offset:3072
    s_cmp_lg_u32 s44, 0
    s_cbranch_scc1 L_g_ne_64
    v_cmp_ge_u32 vcc, v12, v11
    s_nop 0
    s_ff1_i32_b64 s46, vcc
    s_lshr_b32 s46, s46, 4
    s_min_u32 s46, s46, 4
    s_add_u32 s46, s46, s54
    s_min_u32 s46, s46, s75
    v_mov_b32 v11, s46
    ds_write_b32 v15, v11
L_g_ne_64:
    s_add_u32 s60, s60, 1
    s_mov_b32 s65, 0
    s_cmp_le_u32 s62, s60
    s_cbranch_scc1 L_g_dp_67_l
L_g_dp_67_a:
    s_cmp_ge_u32 s62, s66
    s_cbranch_scc1 L_g_dp_67_d
    s_add_u32 s47, s61, 4096
    s_mov_b32 m0, s64
    s_add_u32 s62, s62, 1
    buffer_load_dwordx4 v3, s[12:15], s61 offen offset:0 sc1 lds
    buffer_load_dwordx4 v3, s[12:15], s61 offen offset:1024 sc1 lds
    buffer_load_dwordx4 v3, s[12:15], s61 offen offset:2048 sc1 lds
    buffer_load_dwordx4 v3, s[12:15], s61 offen offset:3072 sc1 lds
    s_add_u32 m0, s64, 4096
    s_add_u32 s61, s61, 65536
    buffer_load_dwordx4 v3, s[12:15], s47 offen offset:0 sc1 lds
    buffer_load_dwordx4 v3, s[12:15], s47 offen offset:1024 sc1 lds
    buffer_load_dwordx4 v3, s[12:15], s47 offen offset:2048 sc1 lds
    buffer_load_dwordx4 v3, s[12:15], s47 offen offset:3072 sc1 lds
    s_xor_b32 s64, s64, 0x10000
L_g_dp_67_d:
    s_cmp_le_u32 s66, s60
    s_cbranch_scc1 L_g_ex0_66
    s_cmp_lg_u32 s65, 0
    s_cbranch_scc1 L_g_nw_65
    ds_read_b128 v[32:35], v4 offset:0
    ds_read_b128 v[36:39], v4 offset:256
    ds_read_b128 v[40:43], v4 offset:2048
    ds_read_b128 v[44:47], v4 offset:2304
    ds_read_b128 v[48:51], v4 offset:4096
    ds_read_b128 v[52:55], v4 offset:4352
    ds_read_b128 v[56:59], v4 offset:6144
    ds_read_b128 v[60:63], v4 offset:6400
    s_cmp_lg_u32 s44, 0
    s_cbranch_scc1 L_g_nl_68
    s_add_u32 s54, s60, 1
    v_add_u32 v12, s54, v113
    v_and_b32 v13, 7, v12
    v_lshl_add_u32 v13, v13, 9, v7
    buffer_load_dword v11, v13, s[12:15], 0 offen sc1
L_g_nl_68:
    s_waitcnt lgkmcnt(8)
    s_branch L_g_loop0_53
L_g_ex0_66:
    s_cmp_lg_u32 s44, 0
    s_cbranch_scc1 L_g_ex0_66_n
    s_sleep 6
    s_add_u32 s54, s60, 0
    v_add_u32 v12, s54, v113
    v_and_b32 v13, 7, v12
    v_lshl_add_u32 v13, v13, 9, v7
    buffer_load_dword v11, v13, s[12:15], 0 offen sc1
    s_waitcnt vmcnt(0)
    v_cmp_ge_u32 vcc, v12, v11
    s_nop 0
    s_ff1_i32_b64 s46, vcc
    s_lshr_b32 s46, s46, 4
    s_min_u32 s46, s46, 4
    s_add_u32 s46, s46, s54
    s_min_u32 s46, s46, s75
    v_mov_b32 v11, s46
    ds_write_b32 v15, v11
L_g_ex0_66_n:
    s_waitcnt lgkmcnt(0)
    s_barrier
    ds_read_b32 v14, v15
    s_waitcnt lgkmcnt(0)
    v_readfirstlane_b32 s66, v14
    s_barrier
    s_cmp_gt_u32 s66, s60
    s_cbranch_scc1 L_g_restart_50_go
    s_branch L_g_tail_55
L_g_g1r_52:
    s_mov_b32 s65, 1
    s_branch L_g_loop1_54_e
.p2align 6
L_g_loop1_54:
    s_mov_b32 s65, 0
L_g_loop1_54_e:
    s_barrier
    ds_read_b32 v14, v15
    s_bitcmp1_b32 s67, 1
    s_cbranch_scc0 L_g_nfl_69
    s_cmp_lg_u32 s44, 4
    s_cbranch_scc1 L_g_nfl_69_d
    s_sub_u32 s59, s60, 1
    v_mov_b32 v10, s59
    buffer_store_dword v10, v115, s[12:15], s52 offen sc1
L_g_nfl_69_d:
    s_waitcnt lgkmcnt(0)
    v_readfirstlane_b32 s66, v14
    ds_read_b128 v[80:83], v5 offset:0
    ds_read_b128 v[84:87], v5 offset:1024
    ds_read_b128 v[88:91], v5 offset:2048
    ds_read_b128 v[92:95], v5 offset:3072
    s_cmp_le_u32 s62, s60
    s_cbranch_scc1 L_g_dp_74_l
L_g_dp_74_a:
    s_cmp_ge_u32 s62, s66
    s_cbranch_scc1 L_g_dp_74_d
    s_add_u32 s47, s61, 4096
    s_mov_b32 m0, s64
    s_add_u32 s62, s62, 1
    buffer_load_dwordx4 v3, s[12:15], s61 offen offset:0 sc1 lds
    buffer_load_dwordx4 v3, s[12:15], s61 offen offset:1024 sc1 lds
    buffer_load_dwordx4 v3, s[12:15], s61 offen offset:2048 sc1 lds
    buffer_load_dwordx4 v3, s[12:15], s61 offen offset:3072 sc1 lds
    s_add_u32 m0, s64, 4096
    s_add_u32 s61, s61, 65536
    buffer_load_dwordx4 v3, s[12:15], s47 offen offset:0 sc1 lds
    buffer_load_dwordx4 v3, s[12:15], s47 offen offset:1024 sc1 lds
    buffer_load_dwordx4 v3, s[12:15], s47 offen offset:2048 sc1 lds
    buffer_load_dwordx4 v3, s[12:15], s47 offen offset:3072 sc1 lds
    s_xor_b32 s64, s64, 0x10000
L_g_dp_74_d:
    s_bitcmp1_b32 s67, 0
    s_cbranch_scc0 L_g_nep_70
    s_waitcnt lgkmcnt(0)
    v_add_f32 v80, v80, v16
    v_add_f32 v81, v81, v17
    v_add_f32 v82, v82, v18
    v_add_f32 v83, v83, v19
    v_add_f32 v84, v84, v20
    v_add_f32 v85, v85, v21
    v_add_f32 v86, v86, v22
    v_add_f32 v87, v87, v23
    v_add_f32 v88, v88, v24
    v_add_f32 v89, v89, v25
    v_add_f32 v90, v90, v26
    v_add_f32 v91, v91, v27
    v_add_f32 v92, v92, v28
    v_add_f32 v93, v93, v29
    v_add_f32 v94, v94, v30
    v_add_f32 v95, v95, v31
    v_cvt_pk_bf16_f32 v104, v80, v81
    v_cvt_pk_bf16_f32 v105, v82, v83
    v_cvt_pk_bf16_f32 v106, v84, v85
    v_cvt_pk_bf16_f32 v107, v86, v87
    buffer_store_dwordx4 v[104:107], v8, s[12:15], s63 offen sc1
    v_cvt_pk_bf16_f32 v108, v88, v89
    v_cvt_pk_bf16_f32 v109, v90, v91
    v_cvt_pk_bf16_f32 v110, v92, v93
    v_cvt_pk_bf16_f32 v111, v94, v95
    buffer_store_dwordx4 v[108:111], v9, s[12:15], s63 offen sc1
    s_add_u32 s63, s63, 786432
    s_cmp_lg_u32 s53, 2
    s_cbranch_scc1 L_g_pf_75
    s_lshl_b32 s73, s58, 1
    buffer_store_dwordx4 v[116:119], v64, s[12:15], s58 offen sc1
    buffer_store_dwordx4 v[116:119], v65, s[12:15], s73 offen sc1
    buffer_store_dwordx4 v[116:119], v68, s[12:15], s73 offen sc1
    s_add_u32 s58, s58, 131072
L_g_pf_75:
    s_cmp_le_u32 s60, 2
    s_cbranch_scc1 L_g_nep_70_e
L_g_nep_70:
    s_cmp_lg_u32 s65, 0
    s_cbranch_scc1 L_g_nw1_71
    ds_read_b128 v[32:35], v4 offset:0
    ds_read_b128 v[36:39], v4 offset:256
    ds_read_b128 v[40:43], v4 offset:2048
    ds_read_b128 v[44:47], v4 offset:2304
    ds_read_b128 v[48:51], v4 offset:4096
    ds_read_b128 v[52:55], v4 offset:4352
    ds_read_b128 v[56:59], v4 offset:6144
    ds_read_b128 v[60:63], v4 offset:6400
    s_barrier
L_g_jn_73:
    s_setprio 1
    s_waitcnt lgkmcnt(6)
    v_mfma_f32_16x16x32_bf16 v[16:19], a[0:3], v[32:35], 0
    v_mfma_f32_16x16x32_bf16 v[20:23], a[4:7], v[32:35], 0
    ds_read_b128 v[32:35], v4 offset:8192
    v_mfma_f32_16x16x32_bf16 v[28:31], a[4:7], v[36:39], 0
    v_mfma_f32_16x16x32_bf16 v[24:27], a[0:3], v[36:39], 0
    ds_read_b128 v[36:39], v4 offset:8448
    s_waitcnt lgkmcnt(6)
    v_mfma_f32_16x16x32_bf16 v[16:19], a[8:11], v[40:43], v[16:19]
    v_mfma_f32_16x16x32_bf16 v[20:23], a[12:15], v[40:43], v[20:23]
    ds_read_b128 v[40:43], v4 offset:10240
    v_mfma_f32_16x16x32_bf16 v[28:31], a[12:15], v[44:47], v[28:31]
    v_mfma_f32_16x16x32_bf16 v[24:27], a[8:11], v[44:47], v[24:27]
    ds_read_b128 v[44:47], v4 offset:10496
    s_waitcnt lgkmcnt(6)
    v_mfma_f32_16x16x32_bf16 v[16:19], a[16:19], v[48:51], v[16:19]
    v_mfma_f32_16x16x32_bf16 v[20:23], a[20:23], v[48:51], v[20:23]
    ds_read_b128 v[48:51], v4 offset:12288
    v_mfma_f32_16x16x32_bf16 v[28:31], a[20:23], v[52:55], v[28:31]
    v_mfma_f32_16x16x32_bf16 v[24:27], a[16:19], v[52:55], v[24:27]
    ds_read_b128 v[52:55], v4 offset:12544
    s_waitcnt lgkmcnt(6)
    v_mfma_f32_16x16x32_bf16 v[16:19], a[24:27], v[56:59], v[16:19]
    v_mfma_f32_16x16x32_bf16 v[20:23], a[28:31], v[56:59], v[20:23]
    ds_read_b128 v[56:59], v4 offset:14336
    v_mfma_f32_16x16x32_bf16 v[28:31], a[28:31], v[60:63], v[28:31]
    v_mfma_f32_16x16x32_bf16 v[24:27], a[24:27], v[60:63], v[24:27]
    ds_read_b128 v[60:63], v4 offset:14592
    s_waitcnt lgkmcnt(6)
    v_mfma_f32_16x16x32_bf16 v[16:19], a[32:35], v[32:35], v[16:19]
    v_mfma_f32_16x16x32_bf16 v[20:23], a[36:39], v[32:35], v[20:23]
    ds_read_b128 v[32:35], v4 offset:16384
    v_mfma_f32_16x16x32_bf16 v[28:31], a[36:39], v[36:39], v[28:31]
    v_mfma_f32_16x16x32_bf16 v[24:27], a[32:35], v[36:39], v[24:27]
    ds_read_b128 v[36:39], v4 offset:16640
    s_waitcnt lgkmcnt(6)
    v_mfma_f32_16x16x32_bf16 v[16:19], a[40:43], v[40:43], v[16:19]
    v_mfma_f32_16x16x32_bf16 v[20:23], a[44:47], v[40:43], v[20:23]
    ds_read_b128 v[40:43], v4 offset:18432
    v_mfma_f32_16x16x32_bf16 v[28:31], a[44:47], v[44:47], v[28:31]
    v_mfma_f32_16x16x32_bf16 v[24:27], a[40:43], v[44:47], v[24:27]
    ds_read_b128 v[44:47], v4 offset:18688
    s_waitcnt lgkmcnt(6)
    v_mfma_f32_16x16x32_bf16 v[16:19], a[48:51], v[48:51], v[16:19]
    v_mfma_f32_16x16x32_bf16 v[20:23], a[52:55], v[48:51], v[20:23]
    ds_read_b128 v[48:51], v4 offset:20480
    v_mfma_f32_16x16x32_bf16 v[28:31], a[52:55], v[52:55], v[28:31]
    v_mfma_f32_16x16x32_bf16 v[24:27], a[48:51], v[52:55], v[24:27]
    ds_read_b128 v[52:55], v4 offset:20736
    s_waitcnt lgkmcnt(6)
    v_mfma_f32_16x16x32_bf16 v[16:19], a[56:59], v[56:59], v[16:19]
    v_mfma_f32_16x16x32_bf16 v[20:23], a[60:63], v[56:59], v[20:23]
    ds_read_b128 v[56:59], v4 offset:22528
    v_mfma_f32_16x16x32_bf16 v[28:31], a[60:63], v[60:63], v[28:31]
    v_mfma_f32_16x16x32_bf16 v[24:27], a[56:59], v[60:63], v[24:27]
    ds_read_b128 v[60:63], v4 offset:22784
    s_waitcnt lgkmcnt(6)
    v_mfma_f32_16x16x32_bf16 v[16:19], a[64:67], v[32:35], v[16:19]
    v_mfma_f32_16x16x32_bf16 v[20:23], a[68:71], v[32:35], v[20:23]
    ds_read_b128 v[32:35], v4 offset:24576
    v_mfma_f32_16x16x32_bf16 v[28:31], a[68:71], v[36:39], v[28:31]
    v_mfma_f32_16x16x32_bf16 v[24:27], a[64:67], v[36:39], v[24:27]
    ds_read_b128 v[36:39], v4 offset:24832
    s_waitcnt lgkmcnt(6)
    v_mfma_f32_16x16x32_bf16 v[16:19], a[72:75], v[40:43], v[16:19]
    v_mfma_f32_16x16x32_bf16 v[20:23], a[76:79], v[40:43], v[20:23]
    ds_read_b128 v[40:43], v4 offset:26624
    v_mfma_f32_16x16x32_bf16 v[28:31], a[76:79], v[44:47], v[28:31]
    v_mfma_f32_16x16x32_bf16 v[24:27], a[72:75], v[44:47], v[24:27]
    ds_read_b128 v[44:47], v4 offset:26880
    s_waitcnt lgkmcnt(6)
    v_mfma_f32_16x16x32_bf16 v[16:19], a[80:83], v[48:51], v[16:19]
    v_mfma_f32_16x16x32_bf16 v[20:23], a[84:87], v[48:51], v[20:23]
    ds_read_b128 v[48:51], v4 offset:28672
    v_mfma_f32_16x16x32_bf16 v[28:31], a[84:87], v[52:55], v[28:31]
    v_mfma_f32_16x16x32_bf16 v[24:27], a[80:83], v[52:55], v[24:27]
    ds_read_b128 v[52:55], v4 offset:28928
    s_waitcnt lgkmcnt(6)
    v_mfma_f32_16x16x32_bf16 v[16:19], a[88:91], v[56:59], v[16:19]
    v_mfma_f32_16x16x32_bf16 v[20:23], a[92:95], v[56:59], v[20:23]
    ds_read_b128 v[56:59], v4 offset:30720
    v_mfma_f32_16x16x32_bf16 v[28:31], a[92:95], v[60:63], v[28:31]
    v_mfma_f32_16x16x32_bf16 v[24:27], a[88:91], v[60:63], v[24:27]
    ds_read_b128 v[60:63], v4 offset:30976
    s_waitcnt lgkmcnt(6)
    v_mfma_f32_16x16x32_bf16 v[16:19], a[96:99], v[32:35], v[16:19]
    v_mfma_f32_16x16x32_bf16 v[20:23], a[100:103], v[32:35], v[20:23]
    v_mfma_f32_16x16x32_bf16 v[28:31], a[100:103], v[36:39], v[28:31]
    v_mfma_f32_16x16x32_bf16 v[24:27], a[96:99], v[36:39], v[24:27]
    s_waitcnt lgkmcnt(4)
    v_mfma_f32_16x16x32_bf16 v[16:19], a[104:107], v[40:43], v[16:19]
    v_mfma_f32_16x16x32_bf16 v[20:23], a[108:111], v[40:43], v[20:23]
    v_mfma_f32_16x16x32_bf16 v[28:31], a[108:111], v[44:47], v[28:31]
    v_mfma_f32_16x16x32_bf16 v[24:27], a[104:107], v[44:47], v[24:27]
    s_waitcnt lgkmcnt(2)
    v_mfma_f32_16x16x32_bf16 v[16:19], a[112:115], v[48:51], v[16:19]
    v_mfma_f32_16x16x32_bf16 v[20:23], a[116:119], v[48:51], v[20:23]
    v_mfma_f32_16x16x32_bf16 v[28:31], a[116:119], v[52:55], v[28:31]
    v_mfma_f32_16x16x32_bf16 v[24:27], a[112:115], v[52:55], v[24:27]
    s_waitcnt lgkmcnt(0)
    v_mfma_f32_16x16x32_bf16 v[16:19], a[120:123], v[56:59], v[16:19]
    v_mfma_f32_16x16x32_bf16 v[20:23], a[124:127], v[56:59], v[20:23]
    v_mfma_f32_16x16x32_bf16 v[28:31], a[124:127], v[60:63], v[28:31]
    v_mfma_f32_16x16x32_bf16 v[24:27], a[120:123], v[60:63], v[24:27]
    v_xor_b32 v4, 0x10000, v4
    s_setprio 0
    s_waitcnt vmcnt(0)
    s_lshl_b32 s67, s67, 1
    s_or_b32 s67, s67, 1
    s_add_u32 s60, s60, 1
    s_cmp_gt_u32 s66, s60
    s_cbranch_scc1 L_g_loop1_54
    s_barrier
    ds_read_b32 v14, v15
    s_waitcnt lgkmcnt(0)
    v_readfirstlane_b32 s66, v14
    s_barrier
    s_mov_b32 s69, 0
    s_cmp_gt_u32 s62, s60
    s_cbranch_scc1 L_g_nd_76
    s_cmp_ge_u32 s62, s66
    s_cbranch_scc1 L_g_nd_76
    s_add_u32 s47, s61, 4096
    s_add_u32 m0, s64, 0
    s_nop 0
    buffer_load_dwordx4 v3, s[12:15], s61 offen offset:0 sc1 lds
    buffer_load_dwordx4 v3, s[12:15], s61 offen offset:1024 sc1 lds
    buffer_load_dwordx4 v3, s[12:15], s61 offen offset:2048 sc1 lds
    buffer_load_dwordx4 v3, s[12:15], s61 offen offset:3072 sc1 lds
    s_add_u32 m0, s64, 4096
    s_nop 0
    buffer_load_dwordx4 v3, s[12:15], s47 offen offset:0 sc1 lds
    buffer_load_dwordx4 v3, s[12:15], s47 offen offset:1024 sc1 lds
    buffer_load_dwordx4 v3, s[12:15], s47 offen offset:2048 sc1 lds
    buffer_load_dwordx4 v3, s[12:15], s47 offen offset:3072 sc1 lds
    s_add_u32 s61, s61, 65536
    s_add_u32 s62, s62, 1
    s_xor_b32 s64, s64, 0x10000
    s_mov_b32 s69, 1
L_g_nd_76:
    s_sub_u32 s59, s60, 1
    ds_read_b128 v[80:83], v5 offset:0
    ds_read_b128 v[84:87], v5 offset:1024
    ds_read_b128 v[88:91], v5 offset:2048
    ds_read_b128 v[92:95], v5 offset:3072
    s_nop 7
    s_waitcnt lgkmcnt(3)
    v_add_f32 v80, v80, v16
    v_add_f32 v81, v81, v17
    v_add_f32 v82, v82, v18
    v_add_f32 v83, v83, v19
    s_waitcnt lgkmcnt(2)
    v_add_f32 v84, v84, v20
    v_add_f32 v85, v85, v21
    v_add_f32 v86, v86, v22
    v_add_f32 v87, v87, v23
    s_waitcnt lgkmcnt(1)
    v_add_f32 v88, v88, v24
    v_add_f32 v89, v89, v25
    v_add_f32 v90, v90, v26
    v_add_f32 v91, v91, v27
    s_waitcnt lgkmcnt(0)
    v_add_f32 v92, v92, v28
    v_add_f32 v93, v93, v29
    v_add_f32 v94, v94, v30
    v_add_f32 v95, v95, v31
    v_cvt_pk_bf16_f32 v104, v80, v81
    v_cvt_pk_bf16_f32 v105, v82, v83
    v_cvt_pk_bf16_f32 v106, v84, v85
    v_cvt_pk_bf16_f32 v107, v86, v87
    buffer_store_dwordx4 v[104:107], v8, s[12:15], s63 offen sc1
    v_cvt_pk_bf16_f32 v108, v88, v89
    v_cvt_pk_bf16_f32 v109, v90, v91
    v_cvt_pk_bf16_f32 v110, v92, v93
    v_cvt_pk_bf16_f32 v111, v94, v95
    buffer_store_dwordx4 v[108:111], v9, s[12:15], s63 offen sc1
    s_add_u32 s63, s63, 786432
    s_cmp_lg_u32 s53, 2
    s_cbranch_scc1 L_g_pf_77
    s_lshl_b32 s73, s58, 1
    buffer_store_dwordx4 v[116:119], v64, s[12:15], s58 offen sc1
    buffer_store_dwordx4 v[116:119], v65, s[12:15], s73 offen sc1
    buffer_store_dwordx4 v[116:119], v68, s[12:15], s73 offen sc1
    s_add_u32 s58, s58, 131072
L_g_pf_77:
    s_mov_b32 s67, 0
    s_mov_b32 s71, 1
    s_cmp_gt_u32 s66, s60
    s_cbranch_scc1 L_g_g1r_52
    v_mov_b32 v10, 1
    s_mov_b64 exec, 1
    s_waitcnt vmcnt(0)
    ds_add_rtn_u32 v10, v15, v10 offset:4
    s_waitcnt lgkmcnt(0)
    v_readfirstlane_b32 s46, v10
    s_mov_b64 exec, -1
    s_mov_b32 s71, 0
    s_sub_u32 s59, s60, 1
    s_cmp_lg_u32 s46, s68
    s_cbranch_scc1 L_g_df_78
    v_mov_b32 v10, s59
    v_add_u32 v10, 1, v10
    v_mov_b32 v11, 0
    s_mov_b64 exec, 1
    buffer_store_dword v10, v11, s[12:15], s52 offen sc1
    s_mov_b64 exec, -1
L_sf_79:
L_g_df_78:
    s_add_u32 s68, s68, 4
    s_cmp_gt_u32 s66, s60
    s_cbranch_scc1 L_g_g1r_52
L_g_tail_55:
    s_cmp_lt_u32 s60, s75
    s_cbranch_scc1 L_g_restart_50
    s_waitcnt vmcnt(0)
    s_barrier
    s_branch L_w_p2_11
L_g_dp_67_l:
    s_cmp_ge_u32 s62, s66
    s_cbranch_scc1 L_g_dp_67_d
    s_mov_b32 s65, 1
    s_add_u32 s47, s61, 4096
    s_mov_b32 m0, s64
    s_add_u32 s62, s62, 1
    buffer_load_dwordx4 v3, s[12:15], s61 offen offset:0 sc1 lds
    buffer_load_dwordx4 v3, s[12:15], s61 offen offset:1024 sc1 lds
    buffer_load_dwordx4 v3, s[12:15], s61 offen offset:2048 sc1 lds
    buffer_load_dwordx4 v3, s[12:15], s61 offen offset:3072 sc1 lds
    s_add_u32 m0, s64, 4096
    s_add_u32 s61, s61, 65536
    buffer_load_dwordx4 v3, s[12:15], s47 offen offset:0 sc1 lds
    buffer_load_dwordx4 v3, s[12:15], s47 offen offset:1024 sc1 lds
    buffer_load_dwordx4 v3, s[12:15], s47 offen offset:2048 sc1 lds
    buffer_load_dwordx4 v3, s[12:15], s47 offen offset:3072 sc1 lds
    s_xor_b32 s64, s64, 0x10000
    s_branch L_g_dp_67_a
L_g_nw_65:
    s_waitcnt vmcnt(0) lgkmcnt(0)
    s_cmp_lg_u32 s44, 0
    s_cbranch_scc1 L_g_nl_80
    s_add_u32 s54, s60, 1
    v_add_u32 v12, s54, v113
    v_and_b32 v13, 7, v12
    v_lshl_add_u32 v13, v13, 9, v7
    buffer_load_dword v11, v13, s[12:15], 0 offen sc1
L_g_nl_80:
    s_branch L_g_loop0_53_l
L_g_nfl_69:
    s_cmp_eq_u32 s71, 0
    s_cbranch_scc1 L_g_nfl_69_d
    v_mov_b32 v10, 1
    s_mov_b64 exec, 1
    s_waitcnt vmcnt(0)
    ds_add_rtn_u32 v10, v15, v10 offset:4
    s_waitcnt lgkmcnt(0)
    v_readfirstlane_b32 s46, v10
    s_mov_b64 exec, -1
    s_mov_b32 s71, 0
    s_sub_u32 s59, s60, 1
    s_cmp_lg_u32 s46, s68
    s_cbranch_scc1 L_g_df_81
    v_mov_b32 v10, s59
    v_add_u32 v10, 1, v10
    v_mov_b32 v11, 0
    s_mov_b64 exec, 1
    buffer_store_dword v10, v11, s[12:15], s52 offen sc1
    s_mov_b64 exec, -1
L_sf_82:
L_g_df_81:
    s_add_u32 s68, s68, 4
    s_mov_b32 s65, 2
    s_branch L_g_nfl_69_d
L_g_dp_74_l:
    s_cmp_ge_u32 s62, s66
    s_cbranch_scc1 L_g_dp_74_d
    s_or_b32 s65, s65, 1
    s_add_u32 s47, s61, 4096
    s_mov_b32 m0, s64
    s_add_u32 s62, s62, 1
    buffer_load_dwordx4 v3, s[12:15], s61 offen offset:0 sc1 lds
    buffer_load_dwordx4 v3, s[12:15], s61 offen offset:1024 sc1 lds
    buffer_load_dwordx4 v3, s[12:15], s61 offen offset:2048 sc1 lds
    buffer_load_dwordx4 v3, s[12:15], s61 offen offset:3072 sc1 lds
    s_add_u32 m0, s64, 4096
    s_add_u32 s61, s61, 65536
    buffer_load_dwordx4 v3, s[12:15], s47 offen offset:0 sc1 lds
    buffer_load_dwordx4 v3, s[12:15], s47 offen offset:1024 sc1 lds
    buffer_load_dwordx4 v3, s[12:15], s47 offen offset:2048 sc1 lds
    buffer_load_dwordx4 v3, s[12:15], s47 offen offset:3072 sc1 lds
    s_xor_b32 s64, s64, 0x10000
    s_branch L_g_dp_74_a
L_g_nep_70_e:
    v_mov_b32 v10, 1
    s_mov_b64 exec, 1
    s_waitcnt vmcnt(0)
    ds_add_rtn_u32 v10, v15, v10 offset:4
    s_waitcnt lgkmcnt(0)
    v_readfirstlane_b32 s46, v10
    s_mov_b64 exec, -1
    s_mov_b32 s71, 0
    s_sub_u32 s59, s60, 1
    s_cmp_lg_u32 s46, s68
    s_cbranch_scc1 L_g_df_83
    v_mov_b32 v10, s59
    v_add_u32 v10, 1, v10
    v_mov_b32 v11, 0
    s_mov_b64 exec, 1
    buffer_store_dword v10, v11, s[12:15], s52 offen sc1
    s_mov_b64 exec, -1
L_sf_84:
L_g_df_83:
    s_add_u32 s68, s68, 4
    s_branch L_g_nep_70
L_g_nw1_71:
    s_cmp_eq_u32 s65, 2
    s_cbranch_scc1 L_g_nw1_71_w
    s_waitcnt vmcnt(0)
L_g_nw1_71_w:
    s_barrier
    ds_read_b128 v[32:35], v4 offset:0
    ds_read_b128 v[36:39], v4 offset:256
    ds_read_b128 v[40:43], v4 offset:2048
    ds_read_b128 v[44:47], v4 offset:2304
    ds_read_b128 v[48:51], v4 offset:4096
    ds_read_b128 v[52:55], v4 offset:4352
    ds_read_b128 v[56:59], v4 offset:6144
    ds_read_b128 v[60:63], v4 offset:6400
    s_branch L_g_jn_73
L_w_p2_11:
    s_cmp_lg_u32 s44, 0
    s_cbranch_scc1 L_w_p2_11_h
    s_mov_b32 s47, 63
    s_cmp_eq_u32 s53, 0
    s_cbranch_scc1 L_w_p2_11_q
    s_sub_u32 s52, s52, s76
    v_mov_b32 v10, 1
    v_mov_b32 v11, 131072
    s_mov_b64 exec, 1
    buffer_atomic_add v10, v11, s[12:15], s52 offen sc0
    s_waitcnt vmcnt(0)
    v_readfirstlane_b32 s46, v10
    s_mov_b64 exec, -1
    s_mov_b32 s47, 63
    s_nop 1
    s_cmp_eq_u32 s46, 0
    s_cbranch_scc1 L_w_p2_11_h
L_w_p2_11_q:
    v_mov_b32 v10, s47
    v_add_u32 v10, 1, v10
    v_mov_b32 v11, 0
    s_mov_b64 exec, 1
    buffer_store_dword v10, v11, s[12:15], s52 offen sc1
    s_mov_b64 exec, -1
L_sf_85:
L_w_p2_11_h:
    s_cmp_eq_u32 s76, 0
    s_cbranch_scc1 L_w_p2_11_m
    s_cmp_eq_u32 s79, 1
    s_cbranch_scc1 L_w_h_17
    s_mov_b32 s79, 1
    s_cmp_lt_u32 s77, 14
    s_cselect_b32 s53, 2, s53
    s_cselect_b32 s48, s48, 3
    s_branch L_w_h_17_n
L_w_p2_11_m:
    s_cmp_lt_u32 s48, 8
    s_cselect_b32 s75, 58, 58
    s_cmp_lt_u32 s48, 4
    s_cselect_b32 s75, 64, s75
L_w_p2_11_r:
    s_lshr_b32 s42, s40, 1
    s_and_b32 s43, s40, 1
    s_lshl_b32 s43, s43, 2
    s_and_b32 s46, s48, 3
    s_add_u32 s43, s43, s46
    s_cmp_lt_u32 s48, 4
    s_cbranch_scc1 L_w_wo_12
    s_cmp_lt_u32 s48, 8
    s_cbranch_scc1 L_w_f2_13
    s_cmp_lg_u32 s43, 7
    s_cbranch_scc1 L_w_f1_14
    s_mov_b32 s43, 2
    s_cmp_eq_u32 s76, 0
    s_cbranch_scc1 L_w_c_16
    s_mov_b32 s43, 7
    s_mov_b32 s78, 1
L_w_f1_14_t:
    s_cmp_lt_u32 s41, 8
    s_cselect_b32 s74, 58, 61
    s_cselect_b32 s75, 61, 64
    s_add_u32 s43, s43, s74
    s_cmp_lt_u32 s43, s75
    s_cbranch_scc1 L_w_h_17_f
    s_branch L_c_done_1
L_w_f1_14_d:
    s_cmp_eq_u32 s76, 0
    s_cbranch_scc1 L_c_done_1
    s_and_b32 s42, s49, 3
    s_lshr_b32 s43, s49, 2
    s_mov_b32 s78, 64
    s_branch L_w_f1_14_t
L_replica:
    s_setprio 0
    s_barrier
    s_and_b32 s48, s41, 7
    s_add_u32 s48, s48, 4
    s_cmp_lt_u32 s41, 8
    s_cselect_b32 s74, 58, 61
    s_cselect_b32 s75, 61, 64
    s_cselect_b32 s76, 1, 2
    s_cselect_b32 s46, 58, 61
    s_cselect_b32 s47, 61, 64
    s_mul_i32 s76, s76, 65536
    s_cmp_lt_u32 s48, 8
    s_cselect_b32 s74, s46, s74
    s_cselect_b32 s75, s47, s75
    s_branch L_w_p2_11_r
L_w_f1_14:
    s_load_dwordx2 s[4:5], s[0:1], 64
    s_load_dwordx2 s[6:7], s[0:1], 72
    s_and_b32 s50, s44, 3
    s_lshr_b32 s51, s44, 2
    s_waitcnt lgkmcnt(0)
    s_mov_b32 s24, s4
    s_and_b32 s25, s5, 0xffff
    s_mov_b32 s26, 0x700000
    s_mov_b32 s27, 0x00020000
    s_mul_i32 s49, s42, 7
    s_add_u32 s49, s49, s43
    v_lshrrev_b32 v3, 4, v1
    v_and_b32 v4, 15, v1
    v_lshlrev_b32 v5, 2, v3
    v_xor_b32 v4, v4, v5
    v_mul_u32_u24 v3, 7168, v3
    v_lshl_add_u32 v3, v4, 4, v3
    s_mul_i32 s46, s51, 512
    s_mul_i32 s47, s50, 64
    s_add_u32 s46, s46, s47
    s_mul_i32 s46, s46, 7168
    s_lshl_b32 s47, s49, 8
    s_add_u32 s46, s46, s47
    s_lshl_b32 s45, s51, 16
    s_mul_i32 s47, s50, 16384
    s_add_u32 s45, s45, s47
    v_bfe_u32 v4, v1, 2, 2
    v_bfe_u32 v5, v1, 4, 1
    v_lshlrev_b32 v5, 1, v5
    v_bfe_u32 v6, v1, 1, 1
    v_add_u32 v5, v5, v6
    s_lshl_b32 s47, s50, 2
    v_add_u32 v5, s47, v5
    v_lshlrev_b32 v6, 2, v4
    v_xor_b32 v5, v5, v6
    v_lshlrev_b32 v5, 4, v5
    v_lshl_add_u32 v5, v4, 8, v5
    v_bfe_u32 v6, v1, 0, 1
    v_lshl_add_u32 v5, v6, 3, v5
    v_lshrrev_b32 v6, 5, v1
    v_mul_u32_u24 v6, 2048, v6
    v_add_u32 v5, v5, v6
    s_lshl_b32 s47, s51, 16
    v_add_u32 v5, s47, v5
    s_add_u32 m0, s45, 0
    s_add_u32 s47, s46, 0x0
    buffer_load_dwordx4 v3, s[24:27], s47 offen lds
    s_add_u32 m0, s45, 1024
    s_add_u32 s47, s46, 0x7000
    buffer_load_dwordx4 v3, s[24:27], s47 offen lds
    s_add_u32 m0, s45, 2048
    s_add_u32 s47, s46, 0xe000
    buffer_load_dwordx4 v3, s[24:27], s47 offen lds
    s_add_u32 m0, s45, 3072
    s_add_u32 s47, s46, 0x15000
    buffer_load_dwordx4 v3, s[24:27], s47 offen lds
    s_add_u32 m0, s45, 4096
    s_add_u32 s47, s46, 0x1c000
    buffer_load_dwordx4 v3, s[24:27], s47 offen lds
    s_add_u32 m0, s45, 5120
    s_add_u32 s47, s46, 0x23000
    buffer_load_dwordx4 v3, s[24:27], s47 offen lds
    s_add_u32 m0, s45, 6144
    s_add_u32 s47, s46, 0x2a000
    buffer_load_dwordx4 v3, s[24:27], s47 offen lds
    s_add_u32 m0, s45, 7168
    s_add_u32 s47, s46, 0x31000
    buffer_load_dwordx4 v3, s[24:27], s47 offen lds
    s_add_u32 m0, s45, 8192
    s_add_u32 s47, s46, 0x38000
    buffer_load_dwordx4 v3, s[24:27], s47 offen lds
    s_add_u32 m0, s45, 9216
    s_add_u32 s47, s46, 0x3f000
    buffer_load_dwordx4 v3, s[24:27], s47 offen lds
    s_add_u32 m0, s45, 10240
    s_add_u32 s47, s46, 0x46000
    buffer_load_dwordx4 v3, s[24:27], s47 offen lds
    s_add_u32 m0, s45, 11264
    s_add_u32 s47, s46, 0x4d000
    buffer_load_dwordx4 v3, s[24:27], s47 offen lds
    s_add_u32 m0, s45, 12288
    s_add_u32 s47, s46, 0x54000
    buffer_load_dwordx4 v3, s[24:27], s47 offen lds
    s_add_u32 m0, s45, 13312
    s_add_u32 s47, s46, 0x5b000
    buffer_load_dwordx4 v3, s[24:27], s47 offen lds
    s_add_u32 m0, s45, 14336
    s_add_u32 s47, s46, 0x62000
    buffer_load_dwordx4 v3, s[24:27], s47 offen lds
    s_add_u32 m0, s45, 15360
    s_add_u32 s47, s46, 0x69000
    buffer_load_dwordx4 v3, s[24:27], s47 offen lds
    s_waitcnt vmcnt(0)
    s_barrier
    ds_read_b64_tr_b16 a[0:1], v5 offset:0
    ds_read_b64_tr_b16 a[2:3], v5 offset:1024
    ds_read_b64_tr_b16 a[4:5], v5 offset:4096
    ds_read_b64_tr_b16 a[6:7], v5 offset:5120
    ds_read_b64_tr_b16 a[8:9], v5 offset:8192
    ds_read_b64_tr_b16 a[10:11], v5 offset:9216
    ds_read_b64_tr_b16 a[12:13], v5 offset:12288
    ds_read_b64_tr_b16 a[14:15], v5 offset:13312
    s_waitcnt lgkmcnt(0)
    ds_read_b64_tr_b16 a[16:17], v5 offset:16384
    ds_read_b64_tr_b16 a[18:19], v5 offset:17408
    ds_read_b64_tr_b16 a[20:21], v5 offset:20480
    ds_read_b64_tr_b16 a[22:23], v5 offset:21504
    ds_read_b64_tr_b16 a[24:25], v5 offset:24576
    ds_read_b64_tr_b16 a[26:27], v5 offset:25600
    ds_read_b64_tr_b16 a[28:29], v5 offset:28672
    ds_read_b64_tr_b16 a[30:31], v5 offset:29696
    s_waitcnt lgkmcnt(0)
    ds_read_b64_tr_b16 a[32:33], v5 offset:32768
    ds_read_b64_tr_b16 a[34:35], v5 offset:33792
    ds_read_b64_tr_b16 a[36:37], v5 offset:36864
    ds_read_b64_tr_b16 a[38:39], v5 offset:37888
    ds_read_b64_tr_b16 a[40:41], v5 offset:40960
    ds_read_b64_tr_b16 a[42:43], v5 offset:41984
    ds_read_b64_tr_b16 a[44:45], v5 offset:45056
    ds_read_b64_tr_b16 a[46:47], v5 offset:46080
    s_waitcnt lgkmcnt(0)
    ds_read_b64_tr_b16 a[48:49], v5 offset:49152
    ds_read_b64_tr_b16 a[50:51], v5 offset:50176
    ds_read_b64_tr_b16 a[52:53], v5 offset:53248
    ds_read_b64_tr_b16 a[54:55], v5 offset:54272
    ds_read_b64_tr_b16 a[56:57], v5 offset:57344
    ds_read_b64_tr_b16 a[58:59], v5 offset:58368
    ds_read_b64_tr_b16 a[60:61], v5 offset:61440
    ds_read_b64_tr_b16 a[62:63], v5 offset:62464
    s_waitcnt lgkmcnt(0)
    s_waitcnt lgkmcnt(0)
    s_barrier
    s_add_u32 m0, s45, 0
    s_add_u32 s47, s46, 0x1c0000
    buffer_load_dwordx4 v3, s[24:27], s47 offen lds
    s_add_u32 m0, s45, 1024
    s_add_u32 s47, s46, 0x1c7000
    buffer_load_dwordx4 v3, s[24:27], s47 offen lds
    s_add_u32 m0, s45, 2048
    s_add_u32 s47, s46, 0x1ce000
    buffer_load_dwordx4 v3, s[24:27], s47 offen lds
    s_add_u32 m0, s45, 3072
    s_add_u32 s47, s46, 0x1d5000
    buffer_load_dwordx4 v3, s[24:27], s47 offen lds
    s_add_u32 m0, s45, 4096
    s_add_u32 s47, s46, 0x1dc000
    buffer_load_dwordx4 v3, s[24:27], s47 offen lds
    s_add_u32 m0, s45, 5120
    s_add_u32 s47, s46, 0x1e3000
    buffer_load_dwordx4 v3, s[24:27], s47 offen lds
    s_add_u32 m0, s45, 6144
    s_add_u32 s47, s46, 0x1ea000
    buffer_load_dwordx4 v3, s[24:27], s47 offen lds
    s_add_u32 m0, s45, 7168
    s_add_u32 s47, s46, 0x1f1000
    buffer_load_dwordx4 v3, s[24:27], s47 offen lds
    s_add_u32 m0, s45, 8192
    s_add_u32 s47, s46, 0x1f8000
    buffer_load_dwordx4 v3, s[24:27], s47 offen lds
    s_add_u32 m0, s45, 9216
    s_add_u32 s47, s46, 0x1ff000
    buffer_load_dwordx4 v3, s[24:27], s47 offen lds
    s_add_u32 m0, s45, 10240
    s_add_u32 s47, s46, 0x206000
    buffer_load_dwordx4 v3, s[24:27], s47 offen lds
    s_add_u32 m0, s45, 11264
    s_add_u32 s47, s46, 0x20d000
    buffer_load_dwordx4 v3, s[24:27], s47 offen lds
    s_add_u32 m0, s45, 12288
    s_add_u32 s47, s46, 0x214000
    buffer_load_dwordx4 v3, s[24:27], s47 offen lds
    s_add_u32 m0, s45, 13312
    s_add_u32 s47, s46, 0x21b000
    buffer_load_dwordx4 v3, s[24:27], s47 offen lds
    s_add_u32 m0, s45, 14336
    s_add_u32 s47, s46, 0x222000
    buffer_load_dwordx4 v3, s[24:27], s47 offen lds
    s_add_u32 m0, s45, 15360
    s_add_u32 s47, s46, 0x229000
    buffer_load_dwordx4 v3, s[24:27], s47 offen lds
    s_waitcnt vmcnt(0)
    s_barrier
    ds_read_b64_tr_b16 a[64:65], v5 offset:0
    ds_read_b64_tr_b16 a[66:67], v5 offset:1024
    ds_read_b64_tr_b16 a[68:69], v5 offset:4096
    ds_read_b64_tr_b16 a[70:71], v5 offset:5120
    ds_read_b64_tr_b16 a[72:73], v5 offset:8192
    ds_read_b64_tr_b16 a[74:75], v5 offset:9216
    ds_read_b64_tr_b16 a[76:77], v5 offset:12288
    ds_read_b64_tr_b16 a[78:79], v5 offset:13312
    s_waitcnt lgkmcnt(0)
    ds_read_b64_tr_b16 a[80:81], v5 offset:16384
    ds_read_b64_tr_b16 a[82:83], v5 offset:17408
    ds_read_b64_tr_b16 a[84:85], v5 offset:20480
    ds_read_b64_tr_b16 a[86:87], v5 offset:21504
    ds_read_b64_tr_b16 a[88:89], v5 offset:24576
    ds_read_b64_tr_b16 a[90:91], v5 offset:25600
    ds_read_b64_tr_b16 a[92:93], v5 offset:28672
    ds_read_b64_tr_b16 a[94:95], v5 offset:29696
    s_waitcnt lgkmcnt(0)
    ds_read_b64_tr_b16 a[96:97], v5 offset:32768
    ds_read_b64_tr_b16 a[98:99], v5 offset:33792
    ds_read_b64_tr_b16 a[100:101], v5 offset:36864
    ds_read_b64_tr_b16 a[102:103], v5 offset:37888
    ds_read_b64_tr_b16 a[104:105], v5 offset:40960
    ds_read_b64_tr_b16 a[106:107], v5 offset:41984
    ds_read_b64_tr_b16 a[108:109], v5 offset:45056
    ds_read_b64_tr_b16 a[110:111], v5 offset:46080
    s_waitcnt lgkmcnt(0)
    ds_read_b64_tr_b16 a[112:113], v5 offset:49152
    ds_read_b64_tr_b16 a[114:115], v5 offset:50176
    ds_read_b64_tr_b16 a[116:117], v5 offset:53248
    ds_read_b64_tr_b16 a[118:119], v5 offset:54272
    ds_read_b64_tr_b16 a[120:121], v5 offset:57344
    ds_read_b64_tr_b16 a[122:123], v5 offset:58368
    ds_read_b64_tr_b16 a[124:125], v5 offset:61440
    ds_read_b64_tr_b16 a[126:127], v5 offset:62464
    s_waitcnt lgkmcnt(0)
    s_waitcnt lgkmcnt(0)
    s_barrier
    v_lshlrev_b32 v2, 4, v1
    s_mul_i32 s64, s44, 8192
    s_add_u32 s46, s64, 0xc00000
    v_add_u32 v3, s46, v2
    s_mul_i32 s46, s51, 32768
    v_add_u32 v4, s46, v2
    v_and_b32 v6, 15, v1
    v_lshlrev_b32 v6, 4, v6
    v_lshrrev_b32 v7, 4, v1
    v_lshl_add_u32 v6, v7, 9, v6
    s_lshl_b32 s46, s50, 12
    s_add_u32 s46, s46, 131072
    v_add_u32 v5, s46, v2
    v_and_b32 v7, 3, v1
    v_lshlrev_b32 v7, 7, v7
    v_add_u32 v7, 0x10ec00, v7
    s_lshl_b32 s46, s49, 13
    s_lshl_b32 s47, s50, 11
    s_add_u32 s46, s46, s47
    s_add_u32 s46, s46, 0x6000000
    v_add_u32 v8, s46, v2
    s_lshl_b32 s52, s49, 7
    s_add_u32 s52, s52, 0x106400
    s_add_u32 s52, s52, s76
    s_mov_b32 s28, s6
    s_and_b32 s29, s7, 0xffff
    s_mov_b32 s30, 0x1c00
    s_mov_b32 s31, 0x00020000
    s_lshl_b32 s46, s49, 8
    s_lshl_b32 s47, s50, 6
    s_add_u32 s46, s46, s47
    v_lshrrev_b32 v9, 5, v1
    v_lshlrev_b32 v9, 3, v9
    buffer_load_dwordx2 v[32:33], v9, s[28:31], s46 offen offset:0
    buffer_load_dwordx2 v[34:35], v9, s[28:31], s46 offen offset:16
    buffer_load_dwordx2 v[36:37], v9, s[28:31], s46 offen offset:32
    buffer_load_dwordx2 v[38:39], v9, s[28:31], s46 offen offset:48
    v_add_u32 v9, 1024, v8
    s_mov_b32 s56, 0xbdd2d3e8
    s_mov_b32 s57, 0xbdd2d3e8
    v_mov_b32 v112, 0xc0135761
    s_waitcnt vmcnt(0)
    v_lshlrev_b32 v64, 16, v32
    v_and_b32 v65, 0xffff0000, v32
    v_lshlrev_b32 v66, 16, v33
    v_and_b32 v67, 0xffff0000, v33
    v_lshlrev_b32 v68, 16, v34
    v_and_b32 v69, 0xffff0000, v34
    v_lshlrev_b32 v70, 16, v35
    v_and_b32 v71, 0xffff0000, v35
    v_lshlrev_b32 v72, 16, v36
    v_and_b32 v73, 0xffff0000, v36
    v_lshlrev_b32 v74, 16, v37
    v_and_b32 v75, 0xffff0000, v37
    v_lshlrev_b32 v76, 16, v38
    v_and_b32 v77, 0xffff0000, v38
    v_lshlrev_b32 v78, 16, v39
    v_and_b32 v79, 0xffff0000, v39
    s_mul_i32 s46, s43, 8192
    s_add_u32 s46, s46, 0xc00000
    s_mul_i32 s47, s42, 0
    s_add_u32 s46, s46, s47
    v_min_u32 v116, 63, v1
    v_lshlrev_b32 v116, 7, v116
    v_add_u32 v116, s46, v116
    s_mov_b32 s60, s74
    s_mul_i32 s61, s74, 65536
    s_mov_b32 s62, s74
    s_mul_i32 s63, s74, 229376
    s_mov_b32 s67, 0
    s_mov_b32 s68, 3
    s_mov_b32 s71, 0
    v_mov_b32 v15, 147456
    v_mov_b32 v14, 0
    ds_write_b32 v15, v14 offset:4
    ds_write_b32 v15, v14 offset:12
    ds_write_b32 v15, v14 offset:16
    v_mov_b32 v114, 1
    v_mov_b32 v115, 0
    v_lshrrev_b32 v113, 4, v1
    s_mov_b32 s72, 0
L_g_restart_86:
    s_cmp_lg_u32 s44, 0
    s_cbranch_scc1 L_g_nsp_87
    s_mov_b32 s70, 0
L_g_sp_93:
    s_add_u32 s54, s60, 0
    v_add_u32 v12, s54, v113
    v_mul_u32_u24 v13, 171, v12
    v_lshrrev_b32 v13, 9, v13
    v_mad_i32_i24 v13, v13, -3, v12
    v_lshl_add_u32 v13, v13, 9, v7
    buffer_load_dword v11, v13, s[12:15], 0 offen sc1
    s_waitcnt vmcnt(0)
    v_cmp_ge_u32 vcc, v12, v11
    s_add_u32 s70, s70, 1
    s_and_b32 s46, vcc_lo, 0xffff
    s_cbranch_scc0 L_g_sp_93_ok
    s_sleep 3
    s_cmp_lt_u32 s70, 524288
    s_cbranch_scc1 L_g_sp_93
    s_branch L_c_done_1
L_g_sp_93_ok:
    v_cmp_ge_u32 vcc, v12, v11
    s_nop 0
    s_ff1_i32_b64 s46, vcc
    s_lshr_b32 s46, s46, 4
    s_min_u32 s46, s46, 4
    s_add_u32 s46, s46, s54
    s_min_u32 s46, s46, s75
    v_mov_b32 v11, s46
    ds_write_b32 v15, v11
L_g_nsp_87:
    s_waitcnt lgkmcnt(0)
    s_barrier
    ds_read_b32 v14, v15
    s_waitcnt lgkmcnt(0)
    v_readfirstlane_b32 s66, v14
    s_nop 3
L_g_restart_86_go:
    s_mov_b32 s69, 0
    s_cmp_gt_u32 s62, s60
    s_cbranch_scc1 L_g_nd_94
    s_cmp_ge_u32 s62, s66
    s_cbranch_scc1 L_g_nd_94
    s_add_u32 s47, s61, 4096
    s_add_u32 m0, s64, 0
    s_nop 0
    buffer_load_dwordx4 v3, s[12:15], s61 offen offset:0 sc1 lds
    buffer_load_dwordx4 v3, s[12:15], s61 offen offset:1024 sc1 lds
    buffer_load_dwordx4 v3, s[12:15], s61 offen offset:2048 sc1 lds
    buffer_load_dwordx4 v3, s[12:15], s61 offen offset:3072 sc1 lds
    s_add_u32 m0, s64, 4096
    s_nop 0
    buffer_load_dwordx4 v3, s[12:15], s47 offen offset:0 sc1 lds
    buffer_load_dwordx4 v3, s[12:15], s47 offen offset:1024 sc1 lds
    buffer_load_dwordx4 v3, s[12:15], s47 offen offset:2048 sc1 lds
    buffer_load_dwordx4 v3, s[12:15], s47 offen offset:3072 sc1 lds
    s_add_u32 s61, s61, 65536
    s_add_u32 s62, s62, 1
    s_xor_b32 s64, s64, 0x10000
    s_mov_b32 s69, 1
L_g_nd_94:
    s_cmp_eq_u32 s51, 1
    s_cbranch_scc1 L_g_g1r_88
    s_add_u32 s59, s60, 1
    s_mov_b32 s69, 0
    s_cmp_gt_u32 s62, s59
    s_cbranch_scc1 L_g_nd_95
    s_cmp_ge_u32 s62, s66
    s_cbranch_scc1 L_g_nd_95
    s_add_u32 s47, s61, 4096
    s_add_u32 m0, s64, 0
    s_nop 0
    buffer_load_dwordx4 v3, s[12:15], s61 offen offset:0 sc1 lds
    buffer_load_dwordx4 v3, s[12:15], s61 offen offset:1024 sc1 lds
    buffer_load_dwordx4 v3, s[12:15], s61 offen offset:2048 sc1 lds
    buffer_load_dwordx4 v3, s[12:15], s61 offen offset:3072 sc1 lds
    s_add_u32 m0, s64, 4096
    s_nop 0
    buffer_load_dwordx4 v3, s[12:15], s47 offen offset:0 sc1 lds
    buffer_load_dwordx4 v3, s[12:15], s47 offen offset:1024 sc1 lds
    buffer_load_dwordx4 v3, s[12:15], s47 offen offset:2048 sc1 lds
    buffer_load_dwordx4 v3, s[12:15], s47 offen offset:3072 sc1 lds
    s_add_u32 s61, s61, 65536
    s_add_u32 s62, s62, 1
    s_xor_b32 s64, s64, 0x10000
    s_mov_b32 s69, 1
L_g_nd_95:
    s_cmp_eq_u32 s69, 1
    s_cbranch_scc1 L_g_w0_96
    s_waitcnt vmcnt(0)
L_g_w0_96:
    s_waitcnt vmcnt(8)
    s_cmp_lg_u32 s44, 0
    s_cbranch_scc1 L_g_nl_97
    s_add_u32 s54, s60, 1
    v_add_u32 v12, s54, v113
    v_mul_u32_u24 v13, 171, v12
    v_lshrrev_b32 v13, 9, v13
    v_mad_i32_i24 v13, v13, -3, v12
    v_lshl_add_u32 v13, v13, 9, v7
    buffer_load_dword v11, v13, s[12:15], 0 offen sc1
L_g_nl_97:
L_g_loop0_89_l:
    s_barrier
    ds_read_b128 v[32:35], v4 offset:0
    ds_read_b128 v[36:39], v4 offset:1024
    ds_read_b128 v[40:43], v4 offset:2048
    ds_read_b128 v[44:47], v4 offset:3072
    ds_read_b128 v[48:51], v4 offset:4096
    ds_read_b128 v[52:55], v4 offset:5120
    ds_read_b128 v[56:59], v4 offset:6144
    ds_read_b128 v[60:63], v4 offset:7168
    s_branch L_g_loop0_89_m
.p2align 6
L_g_loop0_89:
    s_barrier
L_g_loop0_89_m:
    s_setprio 2
    s_waitcnt lgkmcnt(6)
    v_mfma_f32_32x32x16_bf16 v[16:31], a[0:3], v[32:35], v[64:79]
    ds_read_b128 v[32:35], v4 offset:8192
    ds_read_b32 v14, v15
    v_mfma_f32_32x32x16_bf16 v[16:31], a[4:7], v[36:39], v[16:31]
    ds_read_b128 v[36:39], v4 offset:9216
    s_waitcnt lgkmcnt(6)
    v_mfma_f32_32x32x16_bf16 v[16:31], a[8:11], v[40:43], v[16:31]
    ds_read_b128 v[40:43], v4 offset:10240
    v_mfma_f32_32x32x16_bf16 v[16:31], a[12:15], v[44:47], v[16:31]
    ds_read_b128 v[44:47], v4 offset:11264
    s_waitcnt lgkmcnt(6)
    v_mfma_f32_32x32x16_bf16 v[16:31], a[16:19], v[48:51], v[16:31]
    ds_read_b128 v[48:51], v4 offset:12288
    v_mfma_f32_32x32x16_bf16 v[16:31], a[20:23], v[52:55], v[16:31]
    ds_read_b128 v[52:55], v4 offset:13312
    s_waitcnt lgkmcnt(6)
    v_mfma_f32_32x32x16_bf16 v[16:31], a[24:27], v[56:59], v[16:31]
    ds_read_b128 v[56:59], v4 offset:14336
    v_mfma_f32_32x32x16_bf16 v[16:31], a[28:31], v[60:63], v[16:31]
    ds_read_b128 v[60:63], v4 offset:15360
    s_waitcnt lgkmcnt(6)
    v_mfma_f32_32x32x16_bf16 v[16:31], a[32:35], v[32:35], v[16:31]
    ds_read_b128 v[32:35], v4 offset:16384
    v_mfma_f32_32x32x16_bf16 v[16:31], a[36:39], v[36:39], v[16:31]
    ds_read_b128 v[36:39], v4 offset:17408
    s_waitcnt lgkmcnt(6)
    v_mfma_f32_32x32x16_bf16 v[16:31], a[40:43], v[40:43], v[16:31]
    ds_read_b128 v[40:43], v4 offset:18432
    v_mfma_f32_32x32x16_bf16 v[16:31], a[44:47], v[44:47], v[16:31]
    ds_read_b128 v[44:47], v4 offset:19456
    s_waitcnt lgkmcnt(6)
    v_mfma_f32_32x32x16_bf16 v[16:31], a[48:51], v[48:51], v[16:31]
    ds_read_b128 v[48:51], v4 offset:20480
    v_mfma_f32_32x32x16_bf16 v[16:31], a[52:55], v[52:55], v[16:31]
    ds_read_b128 v[52:55], v4 offset:21504
    s_waitcnt lgkmcnt(6)
    v_mfma_f32_32x32x16_bf16 v[16:31], a[56:59], v[56:59], v[16:31]
    ds_read_b128 v[56:59], v4 offset:22528
    v_mfma_f32_32x32x16_bf16 v[16:31], a[60:63], v[60:63], v[16:31]
    ds_read_b128 v[60:63], v4 offset:23552
    s_waitcnt lgkmcnt(6)
    v_mfma_f32_32x32x16_bf16 v[16:31], a[64:67], v[32:35], v[16:31]
    ds_read_b128 v[32:35], v4 offset:24576
    v_mfma_f32_32x32x16_bf16 v[16:31], a[68:71], v[36:39], v[16:31]
    ds_read_b128 v[36:39], v4 offset:25600
    s_waitcnt lgkmcnt(6)
    v_mfma_f32_32x32x16_bf16 v[16:31], a[72:75], v[40:43], v[16:31]
    ds_read_b128 v[40:43], v4 offset:26624
    v_mfma_f32_32x32x16_bf16 v[16:31], a[76:79], v[44:47], v[16:31]
    ds_read_b128 v[44:47], v4 offset:27648
    s_waitcnt lgkmcnt(6)
    v_mfma_f32_32x32x16_bf16 v[16:31], a[80:83], v[48:51], v[16:31]
    ds_read_b128 v[48:51], v4 offset:28672
    v_mfma_f32_32x32x16_bf16 v[16:31], a[84:87], v[52:55], v[16:31]
    ds_read_b128 v[52:55], v4 offset:29696
    s_waitcnt lgkmcnt(6)
    v_mfma_f32_32x32x16_bf16 v[16:31], a[88:91], v[56:59], v[16:31]
    ds_read_b128 v[56:59], v4 offset:30720
    v_mfma_f32_32x32x16_bf16 v[16:31], a[92:95], v[60:63], v[16:31]
    ds_read_b128 v[60:63], v4 offset:31744
    s_waitcnt lgkmcnt(6)
    v_mfma_f32_32x32x16_bf16 v[16:31], a[96:99], v[32:35], v[16:31]
    v_mfma_f32_32x32x16_bf16 v[16:31], a[100:103], v[36:39], v[16:31]
    s_waitcnt lgkmcnt(4)
    v_mfma_f32_32x32x16_bf16 v[16:31], a[104:107], v[40:43], v[16:31]
    v_mfma_f32_32x32x16_bf16 v[16:31], a[108:111], v[44:47], v[16:31]
    s_waitcnt lgkmcnt(2)
    v_mfma_f32_32x32x16_bf16 v[16:31], a[112:115], v[48:51], v[16:31]
    v_mfma_f32_32x32x16_bf16 v[16:31], a[116:119], v[52:55], v[16:31]
    s_waitcnt lgkmcnt(0)
    v_mfma_f32_32x32x16_bf16 v[16:31], a[120:123], v[56:59], v[16:31]
    v_mfma_f32_32x32x16_bf16 v[16:31], a[124:127], v[60:63], v[16:31]
    v_xor_b32 v4, 0x10000, v4
    s_setprio 0
    s_waitcnt vmcnt(0)
    v_readfirstlane_b32 s66, v14
    s_barrier
    s_nop 6
    ds_write_b128 v5, v[16:19] offset:0
    ds_write_b128 v5, v[20:23] offset:1024
    ds_write_b128 v5, v[24:27] offset:2048
    ds_write_b128 v5, v[28:31] offset:3072
    s_cmp_lg_u32 s44, 0
    s_cbranch_scc1 L_g_ne_98
    v_cmp_ge_u32 vcc, v12, v11
    s_nop 0
    s_ff1_i32_b64 s46, vcc
    s_lshr_b32 s46, s46, 4
    s_min_u32 s46, s46, 4
    s_add_u32 s46, s46, s54
    s_min_u32 s46, s46, s75
    v_mov_b32 v11, s46
    ds_write_b32 v15, v11
L_g_ne_98:
    s_add_u32 s60, s60, 1
    s_mov_b32 s65, 0
    s_cmp_le_u32 s62, s60
    s_cbranch_scc1 L_g_dp_101_l
L_g_dp_101_a:
    s_cmp_ge_u32 s62, s66
    s_cbranch_scc1 L_g_dp_101_d
    s_add_u32 s47, s61, 4096
    s_mov_b32 m0, s64
    s_add_u32 s62, s62, 1
    buffer_load_dwordx4 v3, s[12:15], s61 offen offset:0 sc1 lds
    buffer_load_dwordx4 v3, s[12:15], s61 offen offset:1024 sc1 lds
    buffer_load_dwordx4 v3, s[12:15], s61 offen offset:2048 sc1 lds
    buffer_load_dwordx4 v3, s[12:15], s61 offen offset:3072 sc1 lds
    s_add_u32 m0, s64, 4096
    s_add_u32 s61, s61, 65536
    buffer_load_dwordx4 v3, s[12:15], s47 offen offset:0 sc1 lds
    buffer_load_dwordx4 v3, s[12:15], s47 offen offset:1024 sc1 lds
    buffer_load_dwordx4 v3, s[12:15], s47 offen offset:2048 sc1 lds
    buffer_load_dwordx4 v3, s[12:15], s47 offen offset:3072 sc1 lds
    s_xor_b32 s64, s64, 0x10000
L_g_dp_101_d:
    s_cmp_le_u32 s66, s60
    s_cbranch_scc1 L_g_ex0_100
    s_cmp_lg_u32 s65, 0
    s_cbranch_scc1 L_g_nw_99
    ds_read_b128 v[32:35], v4 offset:0
    ds_read_b128 v[36:39], v4 offset:1024
    ds_read_b128 v[40:43], v4 offset:2048
    ds_read_b128 v[44:47], v4 offset:3072
    ds_read_b128 v[48:51], v4 offset:4096
    ds_read_b128 v[52:55], v4 offset:5120
    ds_read_b128 v[56:59], v4 offset:6144
    ds_read_b128 v[60:63], v4 offset:7168
    s_cmp_lg_u32 s44, 0
    s_cbranch_scc1 L_g_nl_102
    s_add_u32 s54, s60, 1
    v_add_u32 v12, s54, v113
    v_mul_u32_u24 v13, 171, v12
    v_lshrrev_b32 v13, 9, v13
    v_mad_i32_i24 v13, v13, -3, v12
    v_lshl_add_u32 v13, v13, 9, v7
    buffer_load_dword v11, v13, s[12:15], 0 offen sc1
L_g_nl_102:
    s_waitcnt lgkmcnt(8)
    s_branch L_g_loop0_89
L_g_ex0_100:
    s_cmp_lg_u32 s44, 0
    s_cbranch_scc1 L_g_ex0_100_n
    s_sleep 6
    s_add_u32 s54, s60, 0
    v_add_u32 v12, s54, v113
    v_mul_u32_u24 v13, 171, v12
    v_lshrrev_b32 v13, 9, v13
    v_mad_i32_i24 v13, v13, -3, v12
    v_lshl_add_u32 v13, v13, 9, v7
    buffer_load_dword v11, v13, s[12:15], 0 offen sc1
    s_waitcnt vmcnt(0)
    v_cmp_ge_u32 vcc, v12, v11
    s_nop 0
    s_ff1_i32_b64 s46, vcc
    s_lshr_b32 s46, s46, 4
    s_min_u32 s46, s46, 4
    s_add_u32 s46, s46, s54
    s_min_u32 s46, s46, s75
    v_mov_b32 v11, s46
    ds_write_b32 v15, v11
L_g_ex0_100_n:
    s_waitcnt lgkmcnt(0)
    s_barrier
    ds_read_b32 v14, v15
    s_waitcnt lgkmcnt(0)
    v_readfirstlane_b32 s66, v14
    s_barrier
    s_cmp_gt_u32 s66, s60
    s_cbranch_scc1 L_g_restart_86_go
    s_branch L_g_tail_91
L_g_g1r_88:
    s_mov_b32 s65, 1
    s_branch L_g_loop1_90_e
.p2align 6
L_g_loop1_90:
    s_mov_b32 s65, 0
L_g_loop1_90_e:
    s_barrier
    ds_read_b32 v14, v15
    s_bitcmp1_b32 s67, 2
    s_cbranch_scc0 L_g_nfl_103
    s_cmp_lg_u32 s44, 4
    s_cbranch_scc1 L_g_nfl_103_d
    s_sub_u32 s59, s60, 2
    v_mov_b32 v10, s59
    buffer_store_dword v10, v115, s[12:15], s52 offen sc1
L_g_nfl_103_d:
    s_waitcnt lgkmcnt(0)
    v_readfirstlane_b32 s66, v14
    ds_read_b128 v[80:83], v5 offset:0
    ds_read_b128 v[84:87], v5 offset:1024
    ds_read_b128 v[88:91], v5 offset:2048
    ds_read_b128 v[92:95], v5 offset:3072
    s_cmp_le_u32 s62, s60
    s_cbranch_scc1 L_g_dp_108_l
L_g_dp_108_a:
    s_cmp_ge_u32 s62, s66
    s_cbranch_scc1 L_g_dp_108_d
    s_add_u32 s47, s61, 4096
    s_mov_b32 m0, s64
    s_add_u32 s62, s62, 1
    buffer_load_dwordx4 v3, s[12:15], s61 offen offset:0 sc1 lds
    buffer_load_dwordx4 v3, s[12:15], s61 offen offset:1024 sc1 lds
    buffer_load_dwordx4 v3, s[12:15], s61 offen offset:2048 sc1 lds
    buffer_load_dwordx4 v3, s[12:15], s61 offen offset:3072 sc1 lds
    s_add_u32 m0, s64, 4096
    s_add_u32 s61, s61, 65536
    buffer_load_dwordx4 v3, s[12:15], s47 offen offset:0 sc1 lds
    buffer_load_dwordx4 v3, s[12:15], s47 offen offset:1024 sc1 lds
    buffer_load_dwordx4 v3, s[12:15], s47 offen offset:2048 sc1 lds
    buffer_load_dwordx4 v3, s[12:15], s47 offen offset:3072 sc1 lds
    s_xor_b32 s64, s64, 0x10000
L_g_dp_108_d:
    s_bitcmp1_b32 s67, 0
    s_cbranch_scc0 L_g_nep_104
    s_waitcnt lgkmcnt(0)
    v_add_f32 v80, v80, v16
    v_add_f32 v81, v81, v17
    v_add_f32 v82, v82, v18
    v_add_f32 v83, v83, v19
    v_add_f32 v84, v84, v20
    v_add_f32 v85, v85, v21
    v_add_f32 v86, v86, v22
    v_add_f32 v87, v87, v23
    v_add_f32 v88, v88, v24
    v_add_f32 v89, v89, v25
    v_add_f32 v90, v90, v26
    v_add_f32 v91, v91, v27
    v_add_f32 v92, v92, v28
    v_add_f32 v93, v93, v29
    v_add_f32 v94, v94, v30
    v_add_f32 v95, v95, v31
L_g_nep_104:
    v_mul_f32 v96, v80, v80
    v_mul_f32 v97, v81, v81
    v_mul_f32 v98, v82, v82
    v_mul_f32 v99, v83, v83
    v_mul_f32 v100, v84, v84
    v_mul_f32 v101, v85, v85
    v_mul_f32 v102, v86, v86
    v_mul_f32 v103, v87, v87
    v_fma_f32 v96, v96, s56, v112
    v_fma_f32 v97, v97, s56, v112
    v_fma_f32 v98, v98, s56, v112
    v_fma_f32 v99, v99, s56, v112
    v_fma_f32 v100, v100, s56, v112
    v_fma_f32 v101, v101, s56, v112
    v_fma_f32 v102, v102, s56, v112
    v_fma_f32 v103, v103, s56, v112
    v_mul_f32 v96, v96, v80
    v_mul_f32 v97, v97, v81
    v_mul_f32 v98, v98, v82
    v_mul_f32 v99, v99, v83
    v_mul_f32 v100, v100, v84
    v_mul_f32 v101, v101, v85
    v_mul_f32 v102, v102, v86
    v_mul_f32 v103, v103, v87
    v_exp_f32 v96, v96
    v_exp_f32 v97, v97
    v_exp_f32 v98, v98
    v_exp_f32 v99, v99
    v_exp_f32 v100, v100
    v_exp_f32 v101, v101
    v_exp_f32 v102, v102
    v_exp_f32 v103, v103
    v_add_f32 v96, 1.0, v96
    v_add_f32 v97, 1.0, v97
    v_add_f32 v98, 1.0, v98
    v_add_f32 v99, 1.0, v99
    s_cmp_lg_u32 s65, 0
    s_cbranch_scc1 L_g_nw1_105
    ds_read_b128 v[32:35], v4 offset:0
    ds_read_b128 v[36:39], v4 offset:1024
    ds_read_b128 v[40:43], v4 offset:2048
    ds_read_b128 v[44:47], v4 offset:3072
    ds_read_b128 v[48:51], v4 offset:4096
    ds_read_b128 v[52:55], v4 offset:5120
    ds_read_b128 v[56:59], v4 offset:6144
    ds_read_b128 v[60:63], v4 offset:7168
    s_barrier
L_g_jn_107:
    s_bitcmp1_b32 s67, 0
    s_cbranch_scc0 L_g_mm2_106
    s_setprio 1
    s_waitcnt lgkmcnt(6)
    v_mfma_f32_32x32x16_bf16 v[16:31], a[0:3], v[32:35], 0
    ds_read_b128 v[32:35], v4 offset:8192
    v_add_f32 v100, 1.0, v100
    v_add_f32 v101, 1.0, v101
    v_add_f32 v102, 1.0, v102
    v_add_f32 v103, 1.0, v103
    v_mfma_f32_32x32x16_bf16 v[16:31], a[4:7], v[36:39], v[16:31]
    ds_read_b128 v[36:39], v4 offset:9216
    v_rcp_f32 v96, v96
    v_rcp_f32 v97, v97
    s_waitcnt lgkmcnt(6)
    v_mfma_f32_32x32x16_bf16 v[16:31], a[8:11], v[40:43], v[16:31]
    ds_read_b128 v[40:43], v4 offset:10240
    v_rcp_f32 v98, v98
    v_rcp_f32 v99, v99
    v_mfma_f32_32x32x16_bf16 v[16:31], a[12:15], v[44:47], v[16:31]
    ds_read_b128 v[44:47], v4 offset:11264
    v_rcp_f32 v100, v100
    v_rcp_f32 v101, v101
    s_waitcnt lgkmcnt(6)
    v_mfma_f32_32x32x16_bf16 v[16:31], a[16:19], v[48:51], v[16:31]
    ds_read_b128 v[48:51], v4 offset:12288
    v_rcp_f32 v102, v102
    v_rcp_f32 v103, v103
    v_mfma_f32_32x32x16_bf16 v[16:31], a[20:23], v[52:55], v[16:31]
    ds_read_b128 v[52:55], v4 offset:13312
    v_mul_f32 v80, v80, v96
    v_mul_f32 v81, v81, v97
    v_mul_f32 v82, v82, v98
    v_mul_f32 v83, v83, v99
    s_waitcnt lgkmcnt(6)
    v_mfma_f32_32x32x16_bf16 v[16:31], a[24:27], v[56:59], v[16:31]
    ds_read_b128 v[56:59], v4 offset:14336
    v_mul_f32 v84, v84, v100
    v_mul_f32 v85, v85, v101
    v_mul_f32 v86, v86, v102
    v_mul_f32 v87, v87, v103
    v_mfma_f32_32x32x16_bf16 v[16:31], a[28:31], v[60:63], v[16:31]
    ds_read_b128 v[60:63], v4 offset:15360
    v_cvt_pk_bf16_f32 v104, v80, v81
    v_cvt_pk_bf16_f32 v105, v82, v83
    v_cvt_pk_bf16_f32 v106, v84, v85
    v_cvt_pk_bf16_f32 v107, v86, v87
    s_waitcnt lgkmcnt(6)
    v_mfma_f32_32x32x16_bf16 v[16:31], a[32:35], v[32:35], v[16:31]
    ds_read_b128 v[32:35], v4 offset:16384
    buffer_store_dwordx4 v[104:107], v8, s[12:15], s63 offen sc1
    v_mul_f32 v96, v88, v88
    v_mul_f32 v97, v89, v89
    v_mul_f32 v98, v90, v90
    v_mfma_f32_32x32x16_bf16 v[16:31], a[36:39], v[36:39], v[16:31]
    ds_read_b128 v[36:39], v4 offset:17408
    v_mul_f32 v99, v91, v91
    v_mul_f32 v100, v92, v92
    v_mul_f32 v101, v93, v93
    v_mul_f32 v102, v94, v94
    s_waitcnt lgkmcnt(6)
    v_mfma_f32_32x32x16_bf16 v[16:31], a[40:43], v[40:43], v[16:31]
    ds_read_b128 v[40:43], v4 offset:18432
    v_mul_f32 v103, v95, v95
    v_fma_f32 v96, v96, s56, v112
    v_fma_f32 v97, v97, s56, v112
    v_fma_f32 v98, v98, s56, v112
    v_mfma_f32_32x32x16_bf16 v[16:31], a[44:47], v[44:47], v[16:31]
    ds_read_b128 v[44:47], v4 offset:19456
    v_fma_f32 v99, v99, s56, v112
    v_fma_f32 v100, v100, s56, v112
    v_fma_f32 v101, v101, s56, v112
    v_fma_f32 v102, v102, s56, v112
    s_waitcnt lgkmcnt(6)
    v_mfma_f32_32x32x16_bf16 v[16:31], a[48:51], v[48:51], v[16:31]
    ds_read_b128 v[48:51], v4 offset:20480
    v_fma_f32 v103, v103, s56, v112
    v_mul_f32 v96, v96, v88
    v_mul_f32 v97, v97, v89
    v_mul_f32 v98, v98, v90
    v_mfma_f32_32x32x16_bf16 v[16:31], a[52:55], v[52:55], v[16:31]
    ds_read_b128 v[52:55], v4 offset:21504
    v_mul_f32 v99, v99, v91
    v_mul_f32 v100, v100, v92
    v_mul_f32 v101, v101, v93
    v_mul_f32 v102, v102, v94
    s_waitcnt lgkmcnt(6)
    v_mfma_f32_32x32x16_bf16 v[16:31], a[56:59], v[56:59], v[16:31]
    ds_read_b128 v[56:59], v4 offset:22528
    v_mul_f32 v103, v103, v95
    v_exp_f32 v96, v96
    v_exp_f32 v97, v97
    v_mfma_f32_32x32x16_bf16 v[16:31], a[60:63], v[60:63], v[16:31]
    ds_read_b128 v[60:63], v4 offset:23552
    v_exp_f32 v98, v98
    v_exp_f32 v99, v99
    s_waitcnt lgkmcnt(6)
    v_mfma_f32_32x32x16_bf16 v[16:31], a[64:67], v[32:35], v[16:31]
    ds_read_b128 v[32:35], v4 offset:24576
    v_exp_f32 v100, v100
    v_exp_f32 v101, v101
    v_mfma_f32_32x32x16_bf16 v[16:31], a[68:71], v[36:39], v[16:31]
    ds_read_b128 v[36:39], v4 offset:25600
    v_exp_f32 v102, v102
    v_exp_f32 v103, v103
    s_waitcnt lgkmcnt(6)
    v_mfma_f32_32x32x16_bf16 v[16:31], a[72:75], v[40:43], v[16:31]
    ds_read_b128 v[40:43], v4 offset:26624
    v_add_f32 v96, 1.0, v96
    v_add_f32 v97, 1.0, v97
    v_add_f32 v98, 1.0, v98
    v_add_f32 v99, 1.0, v99
    v_mfma_f32_32x32x16_bf16 v[16:31], a[76:79], v[44:47], v[16:31]
    ds_read_b128 v[44:47], v4 offset:27648
    v_add_f32 v100, 1.0, v100
    v_add_f32 v101, 1.0, v101
    v_add_f32 v102, 1.0, v102
    v_add_f32 v103, 1.0, v103
    s_waitcnt lgkmcnt(6)
    v_mfma_f32_32x32x16_bf16 v[16:31], a[80:83], v[48:51], v[16:31]
    ds_read_b128 v[48:51], v4 offset:28672
    v_rcp_f32 v96, v96
    v_rcp_f32 v97, v97
    v_mfma_f32_32x32x16_bf16 v[16:31], a[84:87], v[52:55], v[16:31]
    ds_read_b128 v[52:55], v4 offset:29696
    v_rcp_f32 v98, v98
    v_rcp_f32 v99, v99
    s_waitcnt lgkmcnt(6)
    v_mfma_f32_32x32x16_bf16 v[16:31], a[88:91], v[56:59], v[16:31]
    ds_read_b128 v[56:59], v4 offset:30720
    v_rcp_f32 v100, v100
    v_rcp_f32 v101, v101
    v_mfma_f32_32x32x16_bf16 v[16:31], a[92:95], v[60:63], v[16:31]
    ds_read_b128 v[60:63], v4 offset:31744
    v_rcp_f32 v102, v102
    v_rcp_f32 v103, v103
    s_waitcnt lgkmcnt(6)
    v_mfma_f32_32x32x16_bf16 v[16:31], a[96:99], v[32:35], v[16:31]
    v_mul_f32 v88, v88, v96
    v_mul_f32 v89, v89, v97
    v_mul_f32 v90, v90, v98
    v_mul_f32 v91, v91, v99
    v_mfma_f32_32x32x16_bf16 v[16:31], a[100:103], v[36:39], v[16:31]
    v_mul_f32 v92, v92, v100
    v_mul_f32 v93, v93, v101
    v_mul_f32 v94, v94, v102
    v_mul_f32 v95, v95, v103
    s_waitcnt lgkmcnt(4)
    v_mfma_f32_32x32x16_bf16 v[16:31], a[104:107], v[40:43], v[16:31]
    v_cvt_pk_bf16_f32 v108, v88, v89
    v_cvt_pk_bf16_f32 v109, v90, v91
    v_cvt_pk_bf16_f32 v110, v92, v93
    v_cvt_pk_bf16_f32 v111, v94, v95
    v_mfma_f32_32x32x16_bf16 v[16:31], a[108:111], v[44:47], v[16:31]
    buffer_store_dwordx4 v[108:111], v9, s[12:15], s63 offen sc1
    s_add_u32 s63, s63, 229376
    s_waitcnt lgkmcnt(2)
    v_mfma_f32_32x32x16_bf16 v[16:31], a[112:115], v[48:51], v[16:31]
    v_mfma_f32_32x32x16_bf16 v[16:31], a[116:119], v[52:55], v[16:31]
    s_waitcnt lgkmcnt(0)
    v_mfma_f32_32x32x16_bf16 v[16:31], a[120:123], v[56:59], v[16:31]
    v_mfma_f32_32x32x16_bf16 v[16:31], a[124:127], v[60:63], v[16:31]
    v_xor_b32 v4, 0x10000, v4
    s_setprio 0
    s_waitcnt vmcnt(2)
L_g_mm2_106_d:
    s_lshl_b32 s67, s67, 1
    s_or_b32 s67, s67, 1
    s_add_u32 s60, s60, 1
    s_cmp_gt_u32 s66, s60
    s_cbranch_scc1 L_g_loop1_90
    s_barrier
    ds_read_b32 v14, v15
    s_waitcnt lgkmcnt(0)
    v_readfirstlane_b32 s66, v14
    s_barrier
    s_mov_b32 s69, 0
    s_cmp_gt_u32 s62, s60
    s_cbranch_scc1 L_g_nd_109
    s_cmp_ge_u32 s62, s66
    s_cbranch_scc1 L_g_nd_109
    s_add_u32 s47, s61, 4096
    s_add_u32 m0, s64, 0
    s_nop 0
    buffer_load_dwordx4 v3, s[12:15], s61 offen offset:0 sc1 lds
    buffer_load_dwordx4 v3, s[12:15], s61 offen offset:1024 sc1 lds
    buffer_load_dwordx4 v3, s[12:15], s61 offen offset:2048 sc1 lds
    buffer_load_dwordx4 v3, s[12:15], s61 offen offset:3072 sc1 lds
    s_add_u32 m0, s64, 4096
    s_nop 0
    buffer_load_dwordx4 v3, s[12:15], s47 offen offset:0 sc1 lds
    buffer_load_dwordx4 v3, s[12:15], s47 offen offset:1024 sc1 lds
    buffer_load_dwordx4 v3, s[12:15], s47 offen offset:2048 sc1 lds
    buffer_load_dwordx4 v3, s[12:15], s47 offen offset:3072 sc1 lds
    s_add_u32 s61, s61, 65536
    s_add_u32 s62, s62, 1
    s_xor_b32 s64, s64, 0x10000
    s_mov_b32 s69, 1
L_g_nd_109:
    s_sub_u32 s59, s60, 1
    ds_read_b128 v[80:83], v5 offset:0
    ds_read_b128 v[84:87], v5 offset:1024
    ds_read_b128 v[88:91], v5 offset:2048
    ds_read_b128 v[92:95], v5 offset:3072
    s_nop 7
    s_waitcnt lgkmcnt(3)
    v_add_f32 v80, v80, v16
    v_add_f32 v81, v81, v17
    v_add_f32 v82, v82, v18
    v_add_f32 v83, v83, v19
    s_waitcnt lgkmcnt(2)
    v_add_f32 v84, v84, v20
    v_add_f32 v85, v85, v21
    v_add_f32 v86, v86, v22
    v_add_f32 v87, v87, v23
    s_waitcnt lgkmcnt(1)
    v_add_f32 v88, v88, v24
    v_add_f32 v89, v89, v25
    v_add_f32 v90, v90, v26
    v_add_f32 v91, v91, v27
    s_waitcnt lgkmcnt(0)
    v_add_f32 v92, v92, v28
    v_add_f32 v93, v93, v29
    v_add_f32 v94, v94, v30
    v_add_f32 v95, v95, v31
    v_mul_f32 v96, v80, v80
    v_mul_f32 v97, v81, v81
    v_mul_f32 v98, v82, v82
    v_mul_f32 v99, v83, v83
    v_mul_f32 v100, v84, v84
    v_mul_f32 v101, v85, v85
    v_mul_f32 v102, v86, v86
    v_mul_f32 v103, v87, v87
    v_fma_f32 v96, v96, s56, v112
    v_fma_f32 v97, v97, s56, v112
    v_fma_f32 v98, v98, s56, v112
    v_fma_f32 v99, v99, s56, v112
    v_fma_f32 v100, v100, s56, v112
    v_fma_f32 v101, v101, s56, v112
    v_fma_f32 v102, v102, s56, v112
    v_fma_f32 v103, v103, s56, v112
    v_mul_f32 v96, v96, v80
    v_mul_f32 v97, v97, v81
    v_mul_f32 v98, v98, v82
    v_mul_f32 v99, v99, v83
    v_mul_f32 v100, v100, v84
    v_mul_f32 v101, v101, v85
    v_mul_f32 v102, v102, v86
    v_mul_f32 v103, v103, v87
    v_exp_f32 v96, v96
    v_exp_f32 v97, v97
    v_exp_f32 v98, v98
    v_exp_f32 v99, v99
    v_exp_f32 v100, v100
    v_exp_f32 v101, v101
    v_exp_f32 v102, v102
    v_exp_f32 v103, v103
    v_add_f32 v96, 1.0, v96
    v_add_f32 v97, 1.0, v97
    v_add_f32 v98, 1.0, v98
    v_add_f32 v99, 1.0, v99
    v_add_f32 v100, 1.0, v100
    v_add_f32 v101, 1.0, v101
    v_add_f32 v102, 1.0, v102
    v_add_f32 v103, 1.0, v103
    v_rcp_f32 v96, v96
    v_rcp_f32 v97, v97
    v_rcp_f32 v98, v98
    v_rcp_f32 v99, v99
    v_rcp_f32 v100, v100
    v_rcp_f32 v101, v101
    v_rcp_f32 v102, v102
    v_rcp_f32 v103, v103
    v_mul_f32 v80, v80, v96
    v_mul_f32 v81, v81, v97
    v_mul_f32 v82, v82, v98
    v_mul_f32 v83, v83, v99
    v_mul_f32 v84, v84, v100
    v_mul_f32 v85, v85, v101
    v_mul_f32 v86, v86, v102
    v_mul_f32 v87, v87, v103
    v_cvt_pk_bf16_f32 v104, v80, v81
    v_cvt_pk_bf16_f32 v105, v82, v83
    v_cvt_pk_bf16_f32 v106, v84, v85
    v_cvt_pk_bf16_f32 v107, v86, v87
    buffer_store_dwordx4 v[104:107], v8, s[12:15], s63 offen sc1
    v_mul_f32 v96, v88, v88
    v_mul_f32 v97, v89, v89
    v_mul_f32 v98, v90, v90
    v_mul_f32 v99, v91, v91
    v_mul_f32 v100, v92, v92
    v_mul_f32 v101, v93, v93
    v_mul_f32 v102, v94, v94
    v_mul_f32 v103, v95, v95
    v_fma_f32 v96, v96, s56, v112
    v_fma_f32 v97, v97, s56, v112
    v_fma_f32 v98, v98, s56, v112
    v_fma_f32 v99, v99, s56, v112
    v_fma_f32 v100, v100, s56, v112
    v_fma_f32 v101, v101, s56, v112
    v_fma_f32 v102, v102, s56, v112
    v_fma_f32 v103, v103, s56, v112
    v_mul_f32 v96, v96, v88
    v_mul_f32 v97, v97, v89
    v_mul_f32 v98, v98, v90
    v_mul_f32 v99, v99, v91
    v_mul_f32 v100, v100, v92
    v_mul_f32 v101, v101, v93
    v_mul_f32 v102, v102, v94
    v_mul_f32 v103, v103, v95
    v_exp_f32 v96, v96
    v_exp_f32 v97, v97
    v_exp_f32 v98, v98
    v_exp_f32 v99, v99
    v_exp_f32 v100, v100
    v_exp_f32 v101, v101
    v_exp_f32 v102, v102
    v_exp_f32 v103, v103
    v_add_f32 v96, 1.0, v96
    v_add_f32 v97, 1.0, v97
    v_add_f32 v98, 1.0, v98
    v_add_f32 v99, 1.0, v99
    v_add_f32 v100, 1.0, v100
    v_add_f32 v101, 1.0, v101
    v_add_f32 v102, 1.0, v102
    v_add_f32 v103, 1.0, v103
    v_rcp_f32 v96, v96
    v_rcp_f32 v97, v97
    v_rcp_f32 v98, v98
    v_rcp_f32 v99, v99
    v_rcp_f32 v100, v100
    v_rcp_f32 v101, v101
    v_rcp_f32 v102, v102
    v_rcp_f32 v103, v103
    v_mul_f32 v88, v88, v96
    v_mul_f32 v89, v89, v97
    v_mul_f32 v90, v90, v98
    v_mul_f32 v91, v91, v99
    v_mul_f32 v92, v92, v100
    v_mul_f32 v93, v93, v101
    v_mul_f32 v94, v94, v102
    v_mul_f32 v95, v95, v103
    v_cvt_pk_bf16_f32 v108, v88, v89
    v_cvt_pk_bf16_f32 v109, v90, v91
    v_cvt_pk_bf16_f32 v110, v92, v93
    v_cvt_pk_bf16_f32 v111, v94, v95
    buffer_store_dwordx4 v[108:111], v9, s[12:15], s63 offen sc1
    s_add_u32 s63, s63, 229376
    s_mov_b32 s67, 0
    s_mov_b32 s71, 1
    s_cmp_gt_u32 s66, s60
    s_cbranch_scc1 L_g_g1r_88
    v_mov_b32 v10, 1
    s_mov_b64 exec, 1
    s_waitcnt vmcnt(0)
    ds_add_rtn_u32 v10, v15, v10 offset:4
    s_waitcnt lgkmcnt(0)
    v_readfirstlane_b32 s46, v10
    s_mov_b64 exec, -1
    s_mov_b32 s71, 0
    s_sub_u32 s59, s60, 1
    s_cmp_lg_u32 s46, s68
    s_cbranch_scc1 L_g_df_110
    v_mov_b32 v10, s59
    v_add_u32 v10, 1, v10
    v_mov_b32 v11, 0
    s_mov_b64 exec, 1
    buffer_store_dword v10, v11, s[12:15], s52 offen sc1
    s_mov_b64 exec, -1
L_sf_111:
L_g_df_110:
    s_add_u32 s68, s68, 4
    s_cmp_gt_u32 s66, s60
    s_cbranch_scc1 L_g_g1r_88
L_g_tail_91:
    s_cmp_lt_u32 s60, s75
    s_cbranch_scc1 L_g_restart_86
    s_waitcnt vmcnt(0)
    s_barrier
    s_branch L_w_f1_14_d
L_g_dp_101_l:
    s_cmp_ge_u32 s62, s66
    s_cbranch_scc1 L_g_dp_101_d
    s_mov_b32 s65, 1
    s_add_u32 s47, s61, 4096
    s_mov_b32 m0, s64
    s_add_u32 s62, s62, 1
    buffer_load_dwordx4 v3, s[12:15], s61 offen offset:0 sc1 lds
    buffer_load_dwordx4 v3, s[12:15], s61 offen offset:1024 sc1 lds
    buffer_load_dwordx4 v3, s[12:15], s61 offen offset:2048 sc1 lds
    buffer_load_dwordx4 v3, s[12:15], s61 offen offset:3072 sc1 lds
    s_add_u32 m0, s64, 4096
    s_add_u32 s61, s61, 65536
    buffer_load_dwordx4 v3, s[12:15], s47 offen offset:0 sc1 lds
    buffer_load_dwordx4 v3, s[12:15], s47 offen offset:1024 sc1 lds
    buffer_load_dwordx4 v3, s[12:15], s47 offen offset:2048 sc1 lds
    buffer_load_dwordx4 v3, s[12:15], s47 offen offset:3072 sc1 lds
    s_xor_b32 s64, s64, 0x10000
    s_branch L_g_dp_101_a
L_g_nw_99:
    s_waitcnt vmcnt(0) lgkmcnt(0)
    s_cmp_lg_u32 s44, 0
    s_cbranch_scc1 L_g_nl_112
    s_add_u32 s54, s60, 1
    v_add_u32 v12, s54, v113
    v_mul_u32_u24 v13, 171, v12
    v_lshrrev_b32 v13, 9, v13
    v_mad_i32_i24 v13, v13, -3, v12
    v_lshl_add_u32 v13, v13, 9, v7
    buffer_load_dword v11, v13, s[12:15], 0 offen sc1
L_g_nl_112:
    s_branch L_g_loop0_89_l
L_g_nfl_103:
    s_cmp_eq_u32 s71, 0
    s_cbranch_scc1 L_g_nfl_103_d
    v_mov_b32 v10, 1
    s_mov_b64 exec, 1
    s_waitcnt vmcnt(0)
    ds_add_rtn_u32 v10, v15, v10 offset:4
    s_waitcnt lgkmcnt(0)
    v_readfirstlane_b32 s46, v10
    s_mov_b64 exec, -1
    s_mov_b32 s71, 0
    s_sub_u32 s59, s60, 1
    s_cmp_lg_u32 s46, s68
    s_cbranch_scc1 L_g_df_113
    v_mov_b32 v10, s59
    v_add_u32 v10, 1, v10
    v_mov_b32 v11, 0
    s_mov_b64 exec, 1
    buffer_store_dword v10, v11, s[12:15], s52 offen sc1
    s_mov_b64 exec, -1
L_sf_114:
L_g_df_113:
    s_add_u32 s68, s68, 4
    s_mov_b32 s65, 2
    s_branch L_g_nfl_103_d
L_g_dp_108_l:
    s_cmp_ge_u32 s62, s66
    s_cbranch_scc1 L_g_dp_108_d
    s_or_b32 s65, s65, 1
    s_add_u32 s47, s61, 4096
    s_mov_b32 m0, s64
    s_add_u32 s62, s62, 1
    buffer_load_dwordx4 v3, s[12:15], s61 offen offset:0 sc1 lds
    buffer_load_dwordx4 v3, s[12:15], s61 offen offset:1024 sc1 lds
    buffer_load_dwordx4 v3, s[12:15], s61 offen offset:2048 sc1 lds
    buffer_load_dwordx4 v3, s[12:15], s61 offen offset:3072 sc1 lds
    s_add_u32 m0, s64, 4096
    s_add_u32 s61, s61, 65536
    buffer_load_dwordx4 v3, s[12:15], s47 offen offset:0 sc1 lds
    buffer_load_dwordx4 v3, s[12:15], s47 offen offset:1024 sc1 lds
    buffer_load_dwordx4 v3, s[12:15], s47 offen offset:2048 sc1 lds
    buffer_load_dwordx4 v3, s[12:15], s47 offen offset:3072 sc1 lds
    s_xor_b32 s64, s64, 0x10000
    s_branch L_g_dp_108_a
L_g_nw1_105:
    s_cmp_eq_u32 s65, 2
    s_cbranch_scc1 L_g_nw1_105_w
    s_waitcnt vmcnt(0)
L_g_nw1_105_w:
    s_barrier
    ds_read_b128 v[32:35], v4 offset:0
    ds_read_b128 v[36:39], v4 offset:1024
    ds_read_b128 v[40:43], v4 offset:2048
    ds_read_b128 v[44:47], v4 offset:3072
    ds_read_b128 v[48:51], v4 offset:4096
    ds_read_b128 v[52:55], v4 offset:5120
    ds_read_b128 v[56:59], v4 offset:6144
    ds_read_b128 v[60:63], v4 offset:7168
    s_branch L_g_jn_107
L_g_mm2_106:
    s_setprio 1
    s_waitcnt lgkmcnt(6)
    v_mfma_f32_32x32x16_bf16 v[16:31], a[0:3], v[32:35], 0
    ds_read_b128 v[32:35], v4 offset:8192
    v_mfma_f32_32x32x16_bf16 v[16:31], a[4:7], v[36:39], v[16:31]
    ds_read_b128 v[36:39], v4 offset:9216
    s_waitcnt lgkmcnt(6)
    v_mfma_f32_32x32x16_bf16 v[16:31], a[8:11], v[40:43], v[16:31]
    ds_read_b128 v[40:43], v4 offset:10240
    v_mfma_f32_32x32x16_bf16 v[16:31], a[12:15], v[44:47], v[16:31]
    ds_read_b128 v[44:47], v4 offset:11264
    s_waitcnt lgkmcnt(6)
    v_mfma_f32_32x32x16_bf16 v[16:31], a[16:19], v[48:51], v[16:31]
    ds_read_b128 v[48:51], v4 offset:12288
    v_mfma_f32_32x32x16_bf16 v[16:31], a[20:23], v[52:55], v[16:31]
    ds_read_b128 v[52:55], v4 offset:13312
    s_waitcnt lgkmcnt(6)
    v_mfma_f32_32x32x16_bf16 v[16:31], a[24:27], v[56:59], v[16:31]
    ds_read_b128 v[56:59], v4 offset:14336
    v_mfma_f32_32x32x16_bf16 v[16:31], a[28:31], v[60:63], v[16:31]
    ds_read_b128 v[60:63], v4 offset:15360
    s_waitcnt lgkmcnt(6)
    v_mfma_f32_32x32x16_bf16 v[16:31], a[32:35], v[32:35], v[16:31]
    ds_read_b128 v[32:35], v4 offset:16384
    v_mfma_f32_32x32x16_bf16 v[16:31], a[36:39], v[36:39], v[16:31]
    ds_read_b128 v[36:39], v4 offset:17408
    s_waitcnt lgkmcnt(6)
    v_mfma_f32_32x32x16_bf16 v[16:31], a[40:43], v[40:43], v[16:31]
    ds_read_b128 v[40:43], v4 offset:18432
    v_mfma_f32_32x32x16_bf16 v[16:31], a[44:47], v[44:47], v[16:31]
    ds_read_b128 v[44:47], v4 offset:19456
    s_waitcnt lgkmcnt(6)
    v_mfma_f32_32x32x16_bf16 v[16:31], a[48:51], v[48:51], v[16:31]
    ds_read_b128 v[48:51], v4 offset:20480
    v_mfma_f32_32x32x16_bf16 v[16:31], a[52:55], v[52:55], v[16:31]
    ds_read_b128 v[52:55], v4 offset:21504
    s_waitcnt lgkmcnt(6)
    v_mfma_f32_32x32x16_bf16 v[16:31], a[56:59], v[56:59], v[16:31]
    ds_read_b128 v[56:59], v4 offset:22528
    v_mfma_f32_32x32x16_bf16 v[16:31], a[60:63], v[60:63], v[16:31]
    ds_read_b128 v[60:63], v4 offset:23552
    s_waitcnt lgkmcnt(6)
    v_mfma_f32_32x32x16_bf16 v[16:31], a[64:67], v[32:35], v[16:31]
    ds_read_b128 v[32:35], v4 offset:24576
    v_mfma_f32_32x32x16_bf16 v[16:31], a[68:71], v[36:39], v[16:31]
    ds_read_b128 v[36:39], v4 offset:25600
    s_waitcnt lgkmcnt(6)
    v_mfma_f32_32x32x16_bf16 v[16:31], a[72:75], v[40:43], v[16:31]
    ds_read_b128 v[40:43], v4 offset:26624
    v_mfma_f32_32x32x16_bf16 v[16:31], a[76:79], v[44:47], v[16:31]
    ds_read_b128 v[44:47], v4 offset:27648
    s_waitcnt lgkmcnt(6)
    v_mfma_f32_32x32x16_bf16 v[16:31], a[80:83], v[48:51], v[16:31]
    ds_read_b128 v[48:51], v4 offset:28672
    v_mfma_f32_32x32x16_bf16 v[16:31], a[84:87], v[52:55], v[16:31]
    ds_read_b128 v[52:55], v4 offset:29696
    s_waitcnt lgkmcnt(6)
    v_mfma_f32_32x32x16_bf16 v[16:31], a[88:91], v[56:59], v[16:31]
    ds_read_b128 v[56:59], v4 offset:30720
    v_mfma_f32_32x32x16_bf16 v[16:31], a[92:95], v[60:63], v[16:31]
    ds_read_b128 v[60:63], v4 offset:31744
    s_waitcnt lgkmcnt(6)
    v_mfma_f32_32x32x16_bf16 v[16:31], a[96:99], v[32:35], v[16:31]
    v_mfma_f32_32x32x16_bf16 v[16:31], a[100:103], v[36:39], v[16:31]
    s_waitcnt lgkmcnt(4)
    v_mfma_f32_32x32x16_bf16 v[16:31], a[104:107], v[40:43], v[16:31]
    v_mfma_f32_32x32x16_bf16 v[16:31], a[108:111], v[44:47], v[16:31]
    s_waitcnt lgkmcnt(2)
    v_mfma_f32_32x32x16_bf16 v[16:31], a[112:115], v[48:51], v[16:31]
    v_mfma_f32_32x32x16_bf16 v[16:31], a[116:119], v[52:55], v[16:31]
    s_waitcnt lgkmcnt(0)
    v_mfma_f32_32x32x16_bf16 v[16:31], a[120:123], v[56:59], v[16:31]
    v_mfma_f32_32x32x16_bf16 v[16:31], a[124:127], v[60:63], v[16:31]
    v_xor_b32 v4, 0x10000, v4
    s_setprio 0
    s_waitcnt vmcnt(0)
    s_branch L_g_mm2_106_d
L_w_f2_13:
    s_load_dwordx2 s[4:5], s[0:1], 80
    s_load_dwordx2 s[6:7], s[0:1], 72
    s_and_b32 s50, s44, 3
    s_lshr_b32 s51, s44, 2
    s_waitcnt lgkmcnt(0)
    s_mov_b32 s24, s4
    s_and_b32 s25, s5, 0xffff
    s_mov_b32 s26, 0x700000
    s_mov_b32 s27, 0x00020000
    v_lshrrev_b32 v3, 4, v1
    v_and_b32 v4, 15, v1
    v_lshlrev_b32 v5, 2, v3
    v_xor_b32 v4, v4, v5
    v_mul_u32_u24 v3, 2048, v3
    v_lshl_add_u32 v3, v4, 4, v3
    s_mul_i32 s46, s51, 448
    s_mul_i32 s47, s50, 56
    s_add_u32 s46, s46, s47
    s_mul_i32 s47, s42, 896
    s_add_u32 s46, s46, s47
    s_mul_i32 s46, s46, 2048
    s_lshl_b32 s47, s43, 8
    s_add_u32 s46, s46, s47
    s_lshl_b32 s45, s51, 16
    s_mul_i32 s47, s50, 14336
    s_add_u32 s45, s45, s47
    v_bfe_u32 v4, v1, 2, 2
    v_bfe_u32 v5, v1, 4, 1
    v_lshlrev_b32 v5, 1, v5
    v_bfe_u32 v6, v1, 1, 1
    v_add_u32 v5, v5, v6
    s_lshl_b32 s47, s50, 2
    v_add_u32 v5, s47, v5
    v_lshlrev_b32 v6, 2, v4
    v_xor_b32 v5, v5, v6
    v_lshlrev_b32 v5, 4, v5
    v_lshl_add_u32 v5, v4, 8, v5
    v_bfe_u32 v6, v1, 0, 1
    v_lshl_add_u32 v5, v6, 3, v5
    v_lshrrev_b32 v6, 5, v1
    v_mul_u32_u24 v6, 1024, v6
    v_add_u32 v5, v5, v6
    s_lshl_b32 s47, s51, 16
    v_add_u32 v5, s47, v5
    v_bfe_u32 v4, v1, 2, 2
    v_xor_b32 v5, s50, v4
    v_lshlrev_b32 v5, 6, v5
    v_lshl_add_u32 v5, v4, 8, v5
    v_and_b32 v6, 3, v1
    v_lshl_add_u32 v5, v6, 3, v5
    v_lshrrev_b32 v6, 4, v1
    v_lshl_add_u32 v5, v6, 10, v5
    v_lshrrev_b32 v6, 5, v1
    v_lshl_add_u32 v5, v6, 11, v5
    s_lshl_b32 s47, s51, 16
    v_add_u32 v5, s47, v5
    s_add_u32 m0, s45, 0
    s_add_u32 s47, s46, 0x0
    buffer_load_dwordx4 v3, s[24:27], s47 offen lds
    s_add_u32 m0, s45, 1024
    s_add_u32 s47, s46, 0x2000
    buffer_load_dwordx4 v3, s[24:27], s47 offen lds
    s_add_u32 m0, s45, 2048
    s_add_u32 s47, s46, 0x4000
    buffer_load_dwordx4 v3, s[24:27], s47 offen lds
    s_add_u32 m0, s45, 3072
    s_add_u32 s47, s46, 0x6000
    buffer_load_dwordx4 v3, s[24:27], s47 offen lds
    s_add_u32 m0, s45, 4096
    s_add_u32 s47, s46, 0x8000
    buffer_load_dwordx4 v3, s[24:27], s47 offen lds
    s_add_u32 m0, s45, 5120
    s_add_u32 s47, s46, 0xa000
    buffer_load_dwordx4 v3, s[24:27], s47 offen lds
    s_add_u32 m0, s45, 6144
    s_add_u32 s47, s46, 0xc000
    buffer_load_dwordx4 v3, s[24:27], s47 offen lds
    s_add_u32 m0, s45, 7168
    s_add_u32 s47, s46, 0xe000
    buffer_load_dwordx4 v3, s[24:27], s47 offen lds
    s_add_u32 m0, s45, 8192
    s_add_u32 s47, s46, 0x10000
    buffer_load_dwordx4 v3, s[24:27], s47 offen lds
    s_add_u32 m0, s45, 9216
    s_add_u32 s47, s46, 0x12000
    buffer_load_dwordx4 v3, s[24:27], s47 offen lds
    s_add_u32 m0, s45, 10240
    s_add_u32 s47, s46, 0x14000
    buffer_load_dwordx4 v3, s[24:27], s47 offen lds
    s_add_u32 m0, s45, 11264
    s_add_u32 s47, s46, 0x16000
    buffer_load_dwordx4 v3, s[24:27], s47 offen lds
    s_add_u32 m0, s45, 12288
    s_add_u32 s47, s46, 0x18000
    buffer_load_dwordx4 v3, s[24:27], s47 offen lds
    s_add_u32 m0, s45, 13312
    s_add_u32 s47, s46, 0x1a000
    buffer_load_dwordx4 v3, s[24:27], s47 offen lds
    s_waitcnt vmcnt(0)
    s_barrier
    ds_read_b64_tr_b16 a[0:1], v5 offset:0
    ds_read_b64_tr_b16 a[2:3], v5 offset:2048
    ds_read_b64_tr_b16 a[4:5], v5 offset:32
    ds_read_b64_tr_b16 a[6:7], v5 offset:2080
    ds_read_b64_tr_b16 a[8:9], v5 offset:8192
    ds_read_b64_tr_b16 a[10:11], v5 offset:10240
    ds_read_b64_tr_b16 a[12:13], v5 offset:8224
    ds_read_b64_tr_b16 a[14:15], v5 offset:10272
    s_waitcnt lgkmcnt(0)
    ds_read_b64_tr_b16 a[16:17], v5 offset:16384
    ds_read_b64_tr_b16 a[18:19], v5 offset:18432
    ds_read_b64_tr_b16 a[20:21], v5 offset:16416
    ds_read_b64_tr_b16 a[22:23], v5 offset:18464
    ds_read_b64_tr_b16 a[24:25], v5 offset:24576
    ds_read_b64_tr_b16 a[26:27], v5 offset:26624
    ds_read_b64_tr_b16 a[28:29], v5 offset:24608
    ds_read_b64_tr_b16 a[30:31], v5 offset:26656
    s_waitcnt lgkmcnt(0)
    ds_read_b64_tr_b16 a[32:33], v5 offset:32768
    ds_read_b64_tr_b16 a[34:35], v5 offset:34816
    ds_read_b64_tr_b16 a[36:37], v5 offset:32800
    ds_read_b64_tr_b16 a[38:39], v5 offset:34848
    ds_read_b64_tr_b16 a[40:41], v5 offset:40960
    ds_read_b64_tr_b16 a[42:43], v5 offset:43008
    ds_read_b64_tr_b16 a[44:45], v5 offset:40992
    ds_read_b64_tr_b16 a[46:47], v5 offset:43040
    s_waitcnt lgkmcnt(0)
    ds_read_b64_tr_b16 a[48:49], v5 offset:49152
    ds_read_b64_tr_b16 a[50:51], v5 offset:51200
    ds_read_b64_tr_b16 a[52:53], v5 offset:49184
    ds_read_b64_tr_b16 a[54:55], v5 offset:51232
    s_waitcnt lgkmcnt(0)
    s_barrier
    s_add_u32 m0, s45, 0
    s_add_u32 s47, s46, 0x70000
    buffer_load_dwordx4 v3, s[24:27], s47 offen lds
    s_add_u32 m0, s45, 1024
    s_add_u32 s47, s46, 0x72000
    buffer_load_dwordx4 v3, s[24:27], s47 offen lds
    s_add_u32 m0, s45, 2048
    s_add_u32 s47, s46, 0x74000
    buffer_load_dwordx4 v3, s[24:27], s47 offen lds
    s_add_u32 m0, s45, 3072
    s_add_u32 s47, s46, 0x76000
    buffer_load_dwordx4 v3, s[24:27], s47 offen lds
    s_add_u32 m0, s45, 4096
    s_add_u32 s47, s46, 0x78000
    buffer_load_dwordx4 v3, s[24:27], s47 offen lds
    s_add_u32 m0, s45, 5120
    s_add_u32 s47, s46, 0x7a000
    buffer_load_dwordx4 v3, s[24:27], s47 offen lds
    s_add_u32 m0, s45, 6144
    s_add_u32 s47, s46, 0x7c000
    buffer_load_dwordx4 v3, s[24:27], s47 offen lds
    s_add_u32 m0, s45, 7168
    s_add_u32 s47, s46, 0x7e000
    buffer_load_dwordx4 v3, s[24:27], s47 offen lds
    s_add_u32 m0, s45, 8192
    s_add_u32 s47, s46, 0x80000
    buffer_load_dwordx4 v3, s[24:27], s47 offen lds
    s_add_u32 m0, s45, 9216
    s_add_u32 s47, s46, 0x82000
    buffer_load_dwordx4 v3, s[24:27], s47 offen lds
    s_add_u32 m0, s45, 10240
    s_add_u32 s47, s46, 0x84000
    buffer_load_dwordx4 v3, s[24:27], s47 offen lds
    s_add_u32 m0, s45, 11264
    s_add_u32 s47, s46, 0x86000
    buffer_load_dwordx4 v3, s[24:27], s47 offen lds
    s_add_u32 m0, s45, 12288
    s_add_u32 s47, s46, 0x88000
    buffer_load_dwordx4 v3, s[24:27], s47 offen lds
    s_add_u32 m0, s45, 13312
    s_add_u32 s47, s46, 0x8a000
    buffer_load_dwordx4 v3, s[24:27], s47 offen lds
    s_waitcnt vmcnt(0)
    s_barrier
    ds_read_b64_tr_b16 a[56:57], v5 offset:0
    ds_read_b64_tr_b16 a[58:59], v5 offset:2048
    ds_read_b64_tr_b16 a[60:61], v5 offset:32
    ds_read_b64_tr_b16 a[62:63], v5 offset:2080
    ds_read_b64_tr_b16 a[64:65], v5 offset:8192
    ds_read_b64_tr_b16 a[66:67], v5 offset:10240
    ds_read_b64_tr_b16 a[68:69], v5 offset:8224
    ds_read_b64_tr_b16 a[70:71], v5 offset:10272
    s_waitcnt lgkmcnt(0)
    ds_read_b64_tr_b16 a[72:73], v5 offset:16384
    ds_read_b64_tr_b16 a[74:75], v5 offset:18432
    ds_read_b64_tr_b16 a[76:77], v5 offset:16416
    ds_read_b64_tr_b16 a[78:79], v5 offset:18464
    ds_read_b64_tr_b16 a[80:81], v5 offset:24576
    ds_read_b64_tr_b16 a[82:83], v5 offset:26624
    ds_read_b64_tr_b16 a[84:85], v5 offset:24608
    ds_read_b64_tr_b16 a[86:87], v5 offset:26656
    s_waitcnt lgkmcnt(0)
    ds_read_b64_tr_b16 a[88:89], v5 offset:32768
    ds_read_b64_tr_b16 a[90:91], v5 offset:34816
    ds_read_b64_tr_b16 a[92:93], v5 offset:32800
    ds_read_b64_tr_b16 a[94:95], v5 offset:34848
    ds_read_b64_tr_b16 a[96:97], v5 offset:40960
    ds_read_b64_tr_b16 a[98:99], v5 offset:43008
    ds_read_b64_tr_b16 a[100:101], v5 offset:40992
    ds_read_b64_tr_b16 a[102:103], v5 offset:43040
    s_waitcnt lgkmcnt(0)
    ds_read_b64_tr_b16 a[104:105], v5 offset:49152
    ds_read_b64_tr_b16 a[106:107], v5 offset:51200
    ds_read_b64_tr_b16 a[108:109], v5 offset:49184
    ds_read_b64_tr_b16 a[110:111], v5 offset:51232
    s_waitcnt lgkmcnt(0)
    s_barrier
    v_lshlrev_b32 v2, 4, v1
    s_mul_i32 s64, s44, 7168
    s_add_u32 s46, s64, 0x6000000
    s_mul_i32 s47, s42, 57344
    s_add_u32 s46, s46, s47
    v_add_u32 v3, s46, v2
    s_mul_i32 s46, s51, 28672
    v_add_u32 v4, s46, v2
    v_and_b32 v6, 15, v1
    v_lshlrev_b32 v6, 4, v6
    v_lshrrev_b32 v7, 4, v1
    v_lshl_add_u32 v6, v7, 9, v6
    v_add_u32 v4, s46, v6
    s_lshl_b32 s46, s50, 12
    s_add_u32 s46, s46, 131072
    v_add_u32 v5, s46, v2
    v_and_b32 v7, 15, v1
    v_min_u32 v7, 6, v7
    v_lshlrev_b32 v7, 7, v7
    s_mul_i32 s46, s42, 896
    s_add_u32 s46, s46, 0x106400
    v_add_u32 v7, s46, v7
    s_lshl_b32 s46, s42, 16
    s_lshl_b32 s47, s43, 11
    s_add_u32 s46, s46, s47
    s_lshl_b32 s47, s50, 9
    s_add_u32 s46, s46, s47
    s_add_u32 s46, s46, 0xb000000
    v_and_b32 v8, 31, v1
    v_lshlrev_b32 v8, 4, v8
    v_lshrrev_b32 v9, 5, v1
    v_lshl_add_u32 v8, v9, 14, v8
    v_add_u32 v8, s46, v8
    v_add_u32 v9, 0x8000, v8
    s_lshl_b32 s52, s43, 9
    s_lshl_b32 s47, s42, 7
    s_add_u32 s52, s52, s47
    s_add_u32 s52, s52, 0x108400
    s_add_u32 s52, s52, s76
    s_mul_i32 s46, s43, 7168
    s_add_u32 s46, s46, 0x6000000
    s_mul_i32 s47, s42, 57344
    s_add_u32 s46, s46, s47
    v_min_u32 v116, 55, v1
    v_lshlrev_b32 v116, 7, v116
    v_add_u32 v116, s46, v116
    s_mov_b32 s60, s74
    s_mul_i32 s61, s74, 229376
    s_mov_b32 s62, s74
    s_mul_i32 s63, s74, 262144
    s_mov_b32 s67, 0
    s_mov_b32 s68, 3
    s_mov_b32 s71, 0
    v_mov_b32 v15, 147456
    v_mov_b32 v14, 0
    ds_write_b32 v15, v14 offset:4
    ds_write_b32 v15, v14 offset:12
    ds_write_b32 v15, v14 offset:16
    v_mov_b32 v114, 1
    v_mov_b32 v115, 0
    v_lshrrev_b32 v113, 4, v1
    s_mov_b32 s72, 0
L_g_restart_115:
    s_cmp_lg_u32 s44, 0
    s_cbranch_scc1 L_g_nsp_116
    s_mov_b32 s70, 0
L_g_sp_122:
    s_add_u32 s54, s60, 0
    v_add_u32 v12, s54, v113
    v_subrev_u32 v13, 58, v12
    v_subrev_u32 v11, 61, v12
    v_ashrrev_i32 v13, 31, v13
    v_ashrrev_i32 v11, 31, v11
    v_add3_u32 v13, v13, v11, 2
    v_lshl_add_u32 v13, v13, 16, v7
    buffer_load_dword v11, v13, s[12:15], 0 offen sc1
    s_waitcnt vmcnt(0)
    v_cmp_ge_u32 vcc, v12, v11
    s_add_u32 s70, s70, 1
    s_and_b32 s46, vcc_lo, 0xffff
    s_cbranch_scc0 L_g_sp_122_ok
    s_sleep 3
    s_cmp_lt_u32 s70, 524288
    s_cbranch_scc1 L_g_sp_122
    s_branch L_c_done_1
L_g_sp_122_ok:
    v_cmp_ge_u32 vcc, v12, v11
    s_nop 0
    s_ff1_i32_b64 s46, vcc
    s_lshr_b32 s46, s46, 4
    s_min_u32 s46, s46, 4
    s_add_u32 s46, s46, s54
    s_min_u32 s46, s46, s75
    v_mov_b32 v11, s46
    ds_write_b32 v15, v11
L_g_nsp_116:
    s_waitcnt lgkmcnt(0)
    s_barrier
    ds_read_b32 v14, v15
    s_waitcnt lgkmcnt(0)
    v_readfirstlane_b32 s66, v14
    s_nop 3
L_g_restart_115_go:
    s_mov_b32 s69, 0
    s_cmp_gt_u32 s62, s60
    s_cbranch_scc1 L_g_nd_123
    s_cmp_ge_u32 s62, s66
    s_cbranch_scc1 L_g_nd_123
    s_add_u32 s47, s61, 4096
    s_add_u32 m0, s64, 0
    s_nop 0
    buffer_load_dwordx4 v3, s[12:15], s61 offen offset:0 sc1 lds
    buffer_load_dwordx4 v3, s[12:15], s61 offen offset:1024 sc1 lds
    buffer_load_dwordx4 v3, s[12:15], s61 offen offset:2048 sc1 lds
    buffer_load_dwordx4 v3, s[12:15], s61 offen offset:3072 sc1 lds
    s_add_u32 m0, s64, 4096
    s_nop 0
    buffer_load_dwordx4 v3, s[12:15], s47 offen offset:0 sc1 lds
    buffer_load_dwordx4 v3, s[12:15], s47 offen offset:1024 sc1 lds
    buffer_load_dwordx4 v3, s[12:15], s47 offen offset:2048 sc1 lds
    s_add_u32 s61, s61, 229376
    s_add_u32 s62, s62, 1
    s_xor_b32 s64, s64, 0x10000
    s_mov_b32 s69, 1
L_g_nd_123:
    s_cmp_eq_u32 s51, 1
    s_cbranch_scc1 L_g_g1r_117
    s_add_u32 s59, s60, 1
    s_mov_b32 s69, 0
    s_cmp_gt_u32 s62, s59
    s_cbranch_scc1 L_g_nd_124
    s_cmp_ge_u32 s62, s66
    s_cbranch_scc1 L_g_nd_124
    s_add_u32 s47, s61, 4096
    s_add_u32 m0, s64, 0
    s_nop 0
    buffer_load_dwordx4 v3, s[12:15], s61 offen offset:0 sc1 lds
    buffer_load_dwordx4 v3, s[12:15], s61 offen offset:1024 sc1 lds
    buffer_load_dwordx4 v3, s[12:15], s61 offen offset:2048 sc1 lds
    buffer_load_dwordx4 v3, s[12:15], s61 offen offset:3072 sc1 lds
    s_add_u32 m0, s64, 4096
    s_nop 0
    buffer_load_dwordx4 v3, s[12:15], s47 offen offset:0 sc1 lds
    buffer_load_dwordx4 v3, s[12:15], s47 offen offset:1024 sc1 lds
    buffer_load_dwordx4 v3, s[12:15], s47 offen offset:2048 sc1 lds
    s_add_u32 s61, s61, 229376
    s_add_u32 s62, s62, 1
    s_xor_b32 s64, s64, 0x10000
    s_mov_b32 s69, 1
L_g_nd_124:
    s_cmp_eq_u32 s69, 1
    s_cbranch_scc1 L_g_w0_125
    s_waitcnt vmcnt(0)
L_g_w0_125:
    s_waitcnt vmcnt(7)
    s_cmp_lg_u32 s44, 0
    s_cbranch_scc1 L_g_nl_126
    s_add_u32 s54, s60, 1
    v_add_u32 v12, s54, v113
    v_subrev_u32 v13, 58, v12
    v_subrev_u32 v11, 61, v12
    v_ashrrev_i32 v13, 31, v13
    v_ashrrev_i32 v11, 31, v11
    v_add3_u32 v13, v13, v11, 2
    v_lshl_add_u32 v13, v13, 16, v7
    buffer_load_dword v11, v13, s[12:15], 0 offen sc1
L_g_nl_126:
L_g_loop0_118_l:
    s_barrier
    ds_read_b128 v[32:35], v4 offset:0
    ds_read_b128 v[36:39], v4 offset:256
    ds_read_b128 v[40:43], v4 offset:2048
    ds_read_b128 v[44:47], v4 offset:2304
    ds_read_b128 v[48:51], v4 offset:4096
    ds_read_b128 v[52:55], v4 offset:4352
    ds_read_b128 v[56:59], v4 offset:6144
    ds_read_b128 v[60:63], v4 offset:6400
    s_branch L_g_loop0_118_m
.p2align 6
L_g_loop0_118:
    s_barrier
L_g_loop0_118_m:
    s_setprio 2
    s_waitcnt lgkmcnt(6)
    v_mfma_f32_16x16x32_bf16 v[16:19], v[32:35], a[0:3], 0
    ds_read_b32 v14, v15
    v_mfma_f32_16x16x32_bf16 v[20:23], v[32:35], a[4:7], 0
    ds_read_b128 v[32:35], v4 offset:8192
    v_mfma_f32_16x16x32_bf16 v[28:31], v[36:39], a[4:7], 0
    v_mfma_f32_16x16x32_bf16 v[24:27], v[36:39], a[0:3], 0
    ds_read_b128 v[36:39], v4 offset:8448
    s_waitcnt lgkmcnt(6)
    v_mfma_f32_16x16x32_bf16 v[16:19], v[40:43], a[8:11], v[16:19]
    v_mfma_f32_16x16x32_bf16 v[20:23], v[40:43], a[12:15], v[20:23]
    ds_read_b128 v[40:43], v4 offset:10240
    v_mfma_f32_16x16x32_bf16 v[28:31], v[44:47], a[12:15], v[28:31]
    v_mfma_f32_16x16x32_bf16 v[24:27], v[44:47], a[8:11], v[24:27]
    ds_read_b128 v[44:47], v4 offset:10496
    s_waitcnt lgkmcnt(6)
    v_mfma_f32_16x16x32_bf16 v[16:19], v[48:51], a[16:19], v[16:19]
    v_mfma_f32_16x16x32_bf16 v[20:23], v[48:51], a[20:23], v[20:23]
    ds_read_b128 v[48:51], v4 offset:12288
    v_mfma_f32_16x16x32_bf16 v[28:31], v[52:55], a[20:23], v[28:31]
    v_mfma_f32_16x16x32_bf16 v[24:27], v[52:55], a[16:19], v[24:27]
    ds_read_b128 v[52:55], v4 offset:12544
    s_waitcnt lgkmcnt(6)
    v_mfma_f32_16x16x32_bf16 v[16:19], v[56:59], a[24:27], v[16:19]
    v_mfma_f32_16x16x32_bf16 v[20:23], v[56:59], a[28:31], v[20:23]
    ds_read_b128 v[56:59], v4 offset:14336
    v_mfma_f32_16x16x32_bf16 v[28:31], v[60:63], a[28:31], v[28:31]
    v_mfma_f32_16x16x32_bf16 v[24:27], v[60:63], a[24:27], v[24:27]
    ds_read_b128 v[60:63], v4 offset:14592
    s_waitcnt lgkmcnt(6)
    v_mfma_f32_16x16x32_bf16 v[16:19], v[32:35], a[32:35], v[16:19]
    v_mfma_f32_16x16x32_bf16 v[20:23], v[32:35], a[36:39], v[20:23]
    ds_read_b128 v[32:35], v4 offset:16384
    v_mfma_f32_16x16x32_bf16 v[28:31], v[36:39], a[36:39], v[28:31]
    v_mfma_f32_16x16x32_bf16 v[24:27], v[36:39], a[32:35], v[24:27]
    ds_read_b128 v[36:39], v4 offset:16640
    s_waitcnt lgkmcnt(6)
    v_mfma_f32_16x16x32_bf16 v[16:19], v[40:43], a[40:43], v[16:19]
    v_mfma_f32_16x16x32_bf16 v[20:23], v[40:43], a[44:47], v[20:23]
    ds_read_b128 v[40:43], v4 offset:18432
    v_mfma_f32_16x16x32_bf16 v[28:31], v[44:47], a[44:47], v[28:31]
    v_mfma_f32_16x16x32_bf16 v[24:27], v[44:47], a[40:43], v[24:27]
    ds_read_b128 v[44:47], v4 offset:18688
    s_waitcnt lgkmcnt(6)
    v_mfma_f32_16x16x32_bf16 v[16:19], v[48:51], a[48:51], v[16:19]
    v_mfma_f32_16x16x32_bf16 v[20:23], v[48:51], a[52:55], v[20:23]
    ds_read_b128 v[48:51], v4 offset:20480
    v_mfma_f32_16x16x32_bf16 v[28:31], v[52:55], a[52:55], v[28:31]
    v_mfma_f32_16x16x32_bf16 v[24:27], v[52:55], a[48:51], v[24:27]
    ds_read_b128 v[52:55], v4 offset:20736
    s_waitcnt lgkmcnt(6)
    v_mfma_f32_16x16x32_bf16 v[16:19], v[56:59], a[56:59], v[16:19]
    v_mfma_f32_16x16x32_bf16 v[20:23], v[56:59], a[60:63], v[20:23]
    ds_read_b128 v[56:59], v4 offset:22528
    v_mfma_f32_16x16x32_bf16 v[28:31], v[60:63], a[60:63], v[28:31]
    v_mfma_f32_16x16x32_bf16 v[24:27], v[60:63], a[56:59], v[24:27]
    ds_read_b128 v[60:63], v4 offset:22784
    s_waitcnt lgkmcnt(6)
    v_mfma_f32_16x16x32_bf16 v[16:19], v[32:35], a[64:67], v[16:19]
    v_mfma_f32_16x16x32_bf16 v[20:23], v[32:35], a[68:71], v[20:23]
    ds_read_b128 v[32:35], v4 offset:24576
    v_mfma_f32_16x16x32_bf16 v[28:31], v[36:39], a[68:71], v[28:31]
    v_mfma_f32_16x16x32_bf16 v[24:27], v[36:39], a[64:67], v[24:27]
    ds_read_b128 v[36:39], v4 offset:24832
    s_waitcnt lgkmcnt(6)
    v_mfma_f32_16x16x32_bf16 v[16:19], v[40:43], a[72:75], v[16:19]
    v_mfma_f32_16x16x32_bf16 v[20:23], v[40:43], a[76:79], v[20:23]
    ds_read_b128 v[40:43], v4 offset:26624
    v_mfma_f32_16x16x32_bf16 v[28:31], v[44:47], a[76:79], v[28:31]
    v_mfma_f32_16x16x32_bf16 v[24:27], v[44:47], a[72:75], v[24:27]
    ds_read_b128 v[44:47], v4 offset:26880
    s_waitcnt lgkmcnt(6)
    v_mfma_f32_16x16x32_bf16 v[16:19], v[48:51], a[80:83], v[16:19]
    v_mfma_f32_16x16x32_bf16 v[20:23], v[48:51], a[84:87], v[20:23]
    v_mfma_f32_16x16x32_bf16 v[28:31], v[52:55], a[84:87], v[28:31]
    v_mfma_f32_16x16x32_bf16 v[24:27], v[52:55], a[80:83], v[24:27]
    s_waitcnt lgkmcnt(4)
    v_mfma_f32_16x16x32_bf16 v[16:19], v[56:59], a[88:91], v[16:19]
    v_mfma_f32_16x16x32_bf16 v[20:23], v[56:59], a[92:95], v[20:23]
    v_mfma_f32_16x16x32_bf16 v[28:31], v[60:63], a[92:95], v[28:31]
    v_mfma_f32_16x16x32_bf16 v[24:27], v[60:63], a[88:91], v[24:27]
    s_waitcnt lgkmcnt(2)
    v_mfma_f32_16x16x32_bf16 v[16:19], v[32:35], a[96:99], v[16:19]
    v_mfma_f32_16x16x32_bf16 v[20:23], v[32:35], a[100:103], v[20:23]
    v_mfma_f32_16x16x32_bf16 v[28:31], v[36:39], a[100:103], v[28:31]
    v_mfma_f32_16x16x32_bf16 v[24:27], v[36:39], a[96:99], v[24:27]
    s_waitcnt lgkmcnt(0)
    v_mfma_f32_16x16x32_bf16 v[16:19], v[40:43], a[104:107], v[16:19]
    v_mfma_f32_16x16x32_bf16 v[20:23], v[40:43], a[108:111], v[20:23]
    v_mfma_f32_16x16x32_bf16 v[28:31], v[44:47], a[108:111], v[28:31]
    v_mfma_f32_16x16x32_bf16 v[24:27], v[44:47], a[104:107], v[24:27]
    v_xor_b32 v4, 0x10000, v4
    s_setprio 0
    s_waitcnt vmcnt(0)
    v_readfirstlane_b32 s66, v14
    s_barrier
    s_nop 6
    ds_write_b128 v5, v[16:19] offset:0
    ds_write_b128 v5, v[20:23] offset:1024
    ds_write_b128 v5, v[24:27] offset:2048
    ds_write_b128 v5, v[28:31] offset:3072
    s_cmp_lg_u32 s44, 0
    s_cbranch_scc1 L_g_ne_127
    v_cmp_ge_u32 vcc, v12, v11
    s_nop 0
    s_ff1_i32_b64 s46, vcc
    s_lshr_b32 s46, s46, 4
    s_min_u32 s46, s46, 4
    s_add_u32 s46, s46, s54
    s_min_u32 s46, s46, s75
    v_mov_b32 v11, s46
    ds_write_b32 v15, v11
L_g_ne_127:
    s_add_u32 s60, s60, 1
    s_mov_b32 s65, 0
    s_cmp_le_u32 s62, s60
    s_cbranch_scc1 L_g_dp_130_l
L_g_dp_130_a:
    s_cmp_ge_u32 s62, s66
    s_cbranch_scc1 L_g_dp_130_d
    s_add_u32 s47, s61, 4096
    s_mov_b32 m0, s64
    s_add_u32 s62, s62, 1
    buffer_load_dwordx4 v3, s[12:15], s61 offen offset:0 sc1 lds
    buffer_load_dwordx4 v3, s[12:15], s61 offen offset:1024 sc1 lds
    buffer_load_dwordx4 v3, s[12:15], s61 offen offset:2048 sc1 lds
    buffer_load_dwordx4 v3, s[12:15], s61 offen offset:3072 sc1 lds
    s_add_u32 m0, s64, 4096
    s_add_u32 s61, s61, 229376
    buffer_load_dwordx4 v3, s[12:15], s47 offen offset:0 sc1 lds
    buffer_load_dwordx4 v3, s[12:15], s47 offen offset:1024 sc1 lds
    buffer_load_dwordx4 v3, s[12:15], s47 offen offset:2048 sc1 lds
    s_xor_b32 s64, s64, 0x10000
L_g_dp_130_d:
    s_cmp_le_u32 s66, s60
    s_cbranch_scc1 L_g_ex0_129
    s_cmp_lg_u32 s65, 0
    s_cbranch_scc1 L_g_nw_128
    ds_read_b128 v[32:35], v4 offset:0
    ds_read_b128 v[36:39], v4 offset:256
    ds_read_b128 v[40:43], v4 offset:2048
    ds_read_b128 v[44:47], v4 offset:2304
    ds_read_b128 v[48:51], v4 offset:4096
    ds_read_b128 v[52:55], v4 offset:4352
    ds_read_b128 v[56:59], v4 offset:6144
    ds_read_b128 v[60:63], v4 offset:6400
    s_cmp_lg_u32 s44, 0
    s_cbranch_scc1 L_g_nl_131
    s_add_u32 s54, s60, 1
    v_add_u32 v12, s54, v113
    v_subrev_u32 v13, 58, v12
    v_subrev_u32 v11, 61, v12
    v_ashrrev_i32 v13, 31, v13
    v_ashrrev_i32 v11, 31, v11
    v_add3_u32 v13, v13, v11, 2
    v_lshl_add_u32 v13, v13, 16, v7
    buffer_load_dword v11, v13, s[12:15], 0 offen sc1
L_g_nl_131:
    s_waitcnt lgkmcnt(8)
    s_branch L_g_loop0_118
L_g_ex0_129:
    s_cmp_lg_u32 s44, 0
    s_cbranch_scc1 L_g_ex0_129_n
    s_sleep 6
    s_add_u32 s54, s60, 0
    v_add_u32 v12, s54, v113
    v_subrev_u32 v13, 58, v12
    v_subrev_u32 v11, 61, v12
    v_ashrrev_i32 v13, 31, v13
    v_ashrrev_i32 v11, 31, v11
    v_add3_u32 v13, v13, v11, 2
    v_lshl_add_u32 v13, v13, 16, v7
    buffer_load_dword v11, v13, s[12:15], 0 offen sc1
    s_waitcnt vmcnt(0)
    v_cmp_ge_u32 vcc, v12, v11
    s_nop 0
    s_ff1_i32_b64 s46, vcc
    s_lshr_b32 s46, s46, 4
    s_min_u32 s46, s46, 4
    s_add_u32 s46, s46, s54
    s_min_u32 s46, s46, s75
    v_mov_b32 v11, s46
    ds_write_b32 v15, v11
L_g_ex0_129_n:
    s_waitcnt lgkmcnt(0)
    s_barrier
    ds_read_b32 v14, v15
    s_waitcnt lgkmcnt(0)
    v_readfirstlane_b32 s66, v14
    s_barrier
    s_cmp_gt_u32 s66, s60
    s_cbranch_scc1 L_g_restart_115_go
    s_branch L_g_tail_120
L_g_g1r_117:
    s_mov_b32 s65, 1
    s_branch L_g_loop1_119_e
.p2align 6
L_g_loop1_119:
    s_mov_b32 s65, 0
L_g_loop1_119_e:
    s_barrier
    ds_read_b32 v14, v15
    s_bitcmp1_b32 s67, 1
    s_cbranch_scc0 L_g_nfl_132
    s_cmp_lg_u32 s44, 4
    s_cbranch_scc1 L_g_nfl_132_d
    s_sub_u32 s59, s60, 1
    v_mov_b32 v10, s59
    buffer_store_dword v10, v115, s[12:15], s52 offen sc1
L_g_nfl_132_d:
    s_waitcnt lgkmcnt(0)
    v_readfirstlane_b32 s66, v14
    ds_read_b128 v[80:83], v5 offset:0
    ds_read_b128 v[84:87], v5 offset:1024
    ds_read_b128 v[88:91], v5 offset:2048
    ds_read_b128 v[92:95], v5 offset:3072
    s_cmp_le_u32 s62, s60
    s_cbranch_scc1 L_g_dp_137_l
L_g_dp_137_a:
    s_cmp_ge_u32 s62, s66
    s_cbranch_scc1 L_g_dp_137_d
    s_add_u32 s47, s61, 4096
    s_mov_b32 m0, s64
    s_add_u32 s62, s62, 1
    buffer_load_dwordx4 v3, s[12:15], s61 offen offset:0 sc1 lds
    buffer_load_dwordx4 v3, s[12:15], s61 offen offset:1024 sc1 lds
    buffer_load_dwordx4 v3, s[12:15], s61 offen offset:2048 sc1 lds
    buffer_load_dwordx4 v3, s[12:15], s61 offen offset:3072 sc1 lds
    s_add_u32 m0, s64, 4096
    s_add_u32 s61, s61, 229376
    buffer_load_dwordx4 v3, s[12:15], s47 offen offset:0 sc1 lds
    buffer_load_dwordx4 v3, s[12:15], s47 offen offset:1024 sc1 lds
    buffer_load_dwordx4 v3, s[12:15], s47 offen offset:2048 sc1 lds
    s_xor_b32 s64, s64, 0x10000
L_g_dp_137_d:
    s_bitcmp1_b32 s67, 0
    s_cbranch_scc0 L_g_nep_133
    s_waitcnt lgkmcnt(0)
    v_add_f32 v80, v80, v16
    v_add_f32 v81, v81, v17
    v_add_f32 v82, v82, v18
    v_add_f32 v83, v83, v19
    v_add_f32 v84, v84, v20
    v_add_f32 v85, v85, v21
    v_add_f32 v86, v86, v22
    v_add_f32 v87, v87, v23
    v_add_f32 v88, v88, v24
    v_add_f32 v89, v89, v25
    v_add_f32 v90, v90, v26
    v_add_f32 v91, v91, v27
    v_add_f32 v92, v92, v28
    v_add_f32 v93, v93, v29
    v_add_f32 v94, v94, v30
    v_add_f32 v95, v95, v31
    v_cvt_pk_bf16_f32 v104, v80, v81
    v_cvt_pk_bf16_f32 v105, v82, v83
    v_cvt_pk_bf16_f32 v106, v84, v85
    v_cvt_pk_bf16_f32 v107, v86, v87
    s_nop 1
    v_permlane16_swap_b32 v104, v106
    v_permlane16_swap_b32 v105, v107
    buffer_store_dwordx4 v[104:107], v8, s[12:15], s63 offen sc1
    v_cvt_pk_bf16_f32 v108, v88, v89
    v_cvt_pk_bf16_f32 v109, v90, v91
    v_cvt_pk_bf16_f32 v110, v92, v93
    v_cvt_pk_bf16_f32 v111, v94, v95
    s_nop 1
    v_permlane16_swap_b32 v108, v110
    v_permlane16_swap_b32 v109, v111
    buffer_store_dwordx4 v[108:111], v9, s[12:15], s63 offen sc1
    s_add_u32 s63, s63, 262144
L_g_nep_133:
    s_cmp_lg_u32 s65, 0
    s_cbranch_scc1 L_g_nw1_134
    ds_read_b128 v[32:35], v4 offset:0
    ds_read_b128 v[36:39], v4 offset:256
    ds_read_b128 v[40:43], v4 offset:2048
    ds_read_b128 v[44:47], v4 offset:2304
    ds_read_b128 v[48:51], v4 offset:4096
    ds_read_b128 v[52:55], v4 offset:4352
    ds_read_b128 v[56:59], v4 offset:6144
    ds_read_b128 v[60:63], v4 offset:6400
    s_barrier
L_g_jn_136:
    s_setprio 1
    s_waitcnt lgkmcnt(6)
    v_mfma_f32_16x16x32_bf16 v[16:19], v[32:35], a[0:3], 0
    v_mfma_f32_16x16x32_bf16 v[20:23], v[32:35], a[4:7], 0
    ds_read_b128 v[32:35], v4 offset:8192
    v_mfma_f32_16x16x32_bf16 v[28:31], v[36:39], a[4:7], 0
    v_mfma_f32_16x16x32_bf16 v[24:27], v[36:39], a[0:3], 0
    ds_read_b128 v[36:39], v4 offset:8448
    s_waitcnt lgkmcnt(6)
    v_mfma_f32_16x16x32_bf16 v[16:19], v[40:43], a[8:11], v[16:19]
    v_mfma_f32_16x16x32_bf16 v[20:23], v[40:43], a[12:15], v[20:23]
    ds_read_b128 v[40:43], v4 offset:10240
    v_mfma_f32_16x16x32_bf16 v[28:31], v[44:47], a[12:15], v[28:31]
    v_mfma_f32_16x16x32_bf16 v[24:27], v[44:47], a[8:11], v[24:27]
    ds_read_b128 v[44:47], v4 offset:10496
    s_waitcnt lgkmcnt(6)
    v_mfma_f32_16x16x32_bf16 v[16:19], v[48:51], a[16:19], v[16:19]
    v_mfma_f32_16x16x32_bf16 v[20:23], v[48:51], a[20:23], v[20:23]
    ds_read_b128 v[48:51], v4 offset:12288
    v_mfma_f32_16x16x32_bf16 v[28:31], v[52:55], a[20:23], v[28:31]
    v_mfma_f32_16x16x32_bf16 v[24:27], v[52:55], a[16:19], v[24:27]
    ds_read_b128 v[52:55], v4 offset:12544
    s_waitcnt lgkmcnt(6)
    v_mfma_f32_16x16x32_bf16 v[16:19], v[56:59], a[24:27], v[16:19]
    v_mfma_f32_16x16x32_bf16 v[20:23], v[56:59], a[28:31], v[20:23]
    ds_read_b128 v[56:59], v4 offset:14336
    v_mfma_f32_16x16x32_bf16 v[28:31], v[60:63], a[28:31], v[28:31]
    v_mfma_f32_16x16x32_bf16 v[24:27], v[60:63], a[24:27], v[24:27]
    ds_read_b128 v[60:63], v4 offset:14592
    s_waitcnt lgkmcnt(6)
    v_mfma_f32_16x16x32_bf16 v[16:19], v[32:35], a[32:35], v[16:19]
    v_mfma_f32_16x16x32_bf16 v[20:23], v[32:35], a[36:39], v[20:23]
    ds_read_b128 v[32:35], v4 offset:16384
    v_mfma_f32_16x16x32_bf16 v[28:31], v[36:39], a[36:39], v[28:31]
    v_mfma_f32_16x16x32_bf16 v[24:27], v[36:39], a[32:35], v[24:27]
    ds_read_b128 v[36:39], v4 offset:16640
    s_waitcnt lgkmcnt(6)
    v_mfma_f32_16x16x32_bf16 v[16:19], v[40:43], a[40:43], v[16:19]
    v_mfma_f32_16x16x32_bf16 v[20:23], v[40:43], a[44:47], v[20:23]
    ds_read_b128 v[40:43], v4 offset:18432
    v_mfma_f32_16x16x32_bf16 v[28:31], v[44:47], a[44:47], v[28:31]
    v_mfma_f32_16x16x32_bf16 v[24:27], v[44:47], a[40:43], v[24:27]
    ds_read_b128 v[44:47], v4 offset:18688
    s_waitcnt lgkmcnt(6)
    v_mfma_f32_16x16x32_bf16 v[16:19], v[48:51], a[48:51], v[16:19]
    v_mfma_f32_16x16x32_bf16 v[20:23], v[48:51], a[52:55], v[20:23]
    ds_read_b128 v[48:51], v4 offset:20480
    v_mfma_f32_16x16x32_bf16 v[28:31], v[52:55], a[52:55], v[28:31]
    v_mfma_f32_16x16x32_bf16 v[24:27], v[52:55], a[48:51], v[24:27]
    ds_read_b128 v[52:55], v4 offset:20736
    s_waitcnt lgkmcnt(6)
    v_mfma_f32_16x16x32_bf16 v[16:19], v[56:59], a[56:59], v[16:19]
    v_mfma_f32_16x16x32_bf16 v[20:23], v[56:59], a[60:63], v[20:23]
    ds_read_b128 v[56:59], v4 offset:22528
    v_mfma_f32_16x16x32_bf16 v[28:31], v[60:63], a[60:63], v[28:31]
    v_mfma_f32_16x16x32_bf16 v[24:27], v[60:63], a[56:59], v[24:27]
    ds_read_b128 v[60:63], v4 offset:22784
    s_waitcnt lgkmcnt(6)
    v_mfma_f32_16x16x32_bf16 v[16:19], v[32:35], a[64:67], v[16:19]
    v_mfma_f32_16x16x32_bf16 v[20:23], v[32:35], a[68:71], v[20:23]
    ds_read_b128 v[32:35], v4 offset:24576
    v_mfma_f32_16x16x32_bf16 v[28:31], v[36:39], a[68:71], v[28:31]
    v_mfma_f32_16x16x32_bf16 v[24:27], v[36:39], a[64:67], v[24:27]
    ds_read_b128 v[36:39], v4 offset:24832
    s_waitcnt lgkmcnt(6)
    v_mfma_f32_16x16x32_bf16 v[16:19], v[40:43], a[72:75], v[16:19]
    v_mfma_f32_16x16x32_bf16 v[20:23], v[40:43], a[76:79], v[20:23]
    ds_read_b128 v[40:43], v4 offset:26624
    v_mfma_f32_16x16x32_bf16 v[28:31], v[44:47], a[76:79], v[28:31]
    v_mfma_f32_16x16x32_bf16 v[24:27], v[44:47], a[72:75], v[24:27]
    ds_read_b128 v[44:47], v4 offset:26880
    s_waitcnt lgkmcnt(6)
    v_mfma_f32_16x16x32_bf16 v[16:19], v[48:51], a[80:83], v[16:19]
    v_mfma_f32_16x16x32_bf16 v[20:23], v[48:51], a[84:87], v[20:23]
    v_mfma_f32_16x16x32_bf16 v[28:31], v[52:55], a[84:87], v[28:31]
    v_mfma_f32_16x16x32_bf16 v[24:27], v[52:55], a[80:83], v[24:27]
    s_waitcnt lgkmcnt(4)
    v_mfma_f32_16x16x32_bf16 v[16:19], v[56:59], a[88:91], v[16:19]
    v_mfma_f32_16x16x32_bf16 v[20:23], v[56:59], a[92:95], v[20:23]
    v_mfma_f32_16x16x32_bf16 v[28:31], v[60:63], a[92:95], v[28:31]
    v_mfma_f32_16x16x32_bf16 v[24:27], v[60:63], a[88:91], v[24:27]
    s_waitcnt lgkmcnt(2)
    v_mfma_f32_16x16x32_bf16 v[16:19], v[32:35], a[96:99], v[16:19]
    v_mfma_f32_16x16x32_bf16 v[20:23], v[32:35], a[100:103], v[20:23]
    v_mfma_f32_16x16x32_bf16 v[28:31], v[36:39], a[100:103], v[28:31]
    v_mfma_f32_16x16x32_bf16 v[24:27], v[36:39], a[96:99], v[24:27]
    s_waitcnt lgkmcnt(0)
    v_mfma_f32_16x16x32_bf16 v[16:19], v[40:43], a[104:107], v[16:19]
    v_mfma_f32_16x16x32_bf16 v[20:23], v[40:43], a[108:111], v[20:23]
    v_mfma_f32_16x16x32_bf16 v[28:31], v[44:47], a[108:111], v[28:31]
    v_mfma_f32_16x16x32_bf16 v[24:27], v[44:47], a[104:107], v[24:27]
    v_xor_b32 v4, 0x10000, v4
    s_setprio 0
    s_waitcnt vmcnt(0)
    s_lshl_b32 s67, s67, 1
    s_or_b32 s67, s67, 1
    s_add_u32 s60, s60, 1
    s_cmp_gt_u32 s66, s60
    s_cbranch_scc1 L_g_loop1_119
    s_barrier
    ds_read_b32 v14, v15
    s_waitcnt lgkmcnt(0)
    v_readfirstlane_b32 s66, v14
    s_barrier
    s_mov_b32 s69, 0
    s_cmp_gt_u32 s62, s60
    s_cbranch_scc1 L_g_nd_138
    s_cmp_ge_u32 s62, s66
    s_cbranch_scc1 L_g_nd_138
    s_add_u32 s47, s61, 4096
    s_add_u32 m0, s64, 0
    s_nop 0
    buffer_load_dwordx4 v3, s[12:15], s61 offen offset:0 sc1 lds
    buffer_load_dwordx4 v3, s[12:15], s61 offen offset:1024 sc1 lds
    buffer_load_dwordx4 v3, s[12:15], s61 offen offset:2048 sc1 lds
    buffer_load_dwordx4 v3, s[12:15], s61 offen offset:3072 sc1 lds
    s_add_u32 m0, s64, 4096
    s_nop 0
    buffer_load_dwordx4 v3, s[12:15], s47 offen offset:0 sc1 lds
    buffer_load_dwordx4 v3, s[12:15], s47 offen offset:1024 sc1 lds
    buffer_load_dwordx4 v3, s[12:15], s47 offen offset:2048 sc1 lds
    s_add_u32 s61, s61, 229376
    s_add_u32 s62, s62, 1
    s_xor_b32 s64, s64, 0x10000
    s_mov_b32 s69, 1
L_g_nd_138:
    s_sub_u32 s59, s60, 1
    ds_read_b128 v[80:83], v5 offset:0
    ds_read_b128 v[84:87], v5 offset:1024
    ds_read_b128 v[88:91], v5 offset:2048
    ds_read_b128 v[92:95], v5 offset:3072
    s_nop 7
    s_waitcnt lgkmcnt(3)
    v_add_f32 v80, v80, v16
    v_add_f32 v81, v81, v17
    v_add_f32 v82, v82, v18
    v_add_f32 v83, v83, v19
    s_waitcnt lgkmcnt(2)
    v_add_f32 v84, v84, v20
    v_add_f32 v85, v85, v21
    v_add_f32 v86, v86, v22
    v_add_f32 v87, v87, v23
    s_waitcnt lgkmcnt(1)
    v_add_f32 v88, v88, v24
    v_add_f32 v89, v89, v25
    v_add_f32 v90, v90, v26
    v_add_f32 v91, v91, v27
    s_waitcnt lgkmcnt(0)
    v_add_f32 v92, v92, v28
    v_add_f32 v93, v93, v29
    v_add_f32 v94, v94, v30
    v_add_f32 v95, v95, v31
    v_cvt_pk_bf16_f32 v104, v80, v81
    v_cvt_pk_bf16_f32 v105, v82, v83
    v_cvt_pk_bf16_f32 v106, v84, v85
    v_cvt_pk_bf16_f32 v107, v86, v87
    s_nop 1
    v_permlane16_swap_b32 v104, v106
    v_permlane16_swap_b32 v105, v107
    buffer_store_dwordx4 v[104:107], v8, s[12:15], s63 offen sc1
    v_cvt_pk_bf16_f32 v108, v88, v89
    v_cvt_pk_bf16_f32 v109, v90, v91
    v_cvt_pk_bf16_f32 v110, v92, v93
    v_cvt_pk_bf16_f32 v111, v94, v95
    s_nop 1
    v_permlane16_swap_b32 v108, v110
    v_permlane16_swap_b32 v109, v111
    buffer_store_dwordx4 v[108:111], v9, s[12:15], s63 offen sc1
    s_add_u32 s63, s63, 262144
    s_mov_b32 s67, 0
    s_mov_b32 s71, 1
    s_cmp_gt_u32 s66, s60
    s_cbranch_scc1 L_g_g1r_117
    v_mov_b32 v10, 1
    s_mov_b64 exec, 1
    s_waitcnt vmcnt(0)
    ds_add_rtn_u32 v10, v15, v10 offset:4
    s_waitcnt lgkmcnt(0)
    v_readfirstlane_b32 s46, v10
    s_mov_b64 exec, -1
    s_mov_b32 s71, 0
    s_sub_u32 s59, s60, 1
    s_cmp_lg_u32 s46, s68
    s_cbranch_scc1 L_g_df_139
    v_mov_b32 v10, s59
    v_add_u32 v10, 1, v10
    v_mov_b32 v11, 0
    s_mov_b64 exec, 1
    buffer_store_dword v10, v11, s[12:15], s52 offen sc1
    s_mov_b64 exec, -1
L_sf_140:
L_g_df_139:
    s_add_u32 s68, s68, 4
    s_cmp_gt_u32 s66, s60
    s_cbranch_scc1 L_g_g1r_117
L_g_tail_120:
    s_cmp_lt_u32 s60, s75
    s_cbranch_scc1 L_g_restart_115
    s_waitcnt vmcnt(0)
    s_barrier
    s_branch L_c_done_1
L_g_dp_130_l:
    s_cmp_ge_u32 s62, s66
    s_cbranch_scc1 L_g_dp_130_d
    s_mov_b32 s65, 1
    s_add_u32 s47, s61, 4096
    s_mov_b32 m0, s64
    s_add_u32 s62, s62, 1
    buffer_load_dwordx4 v3, s[12:15], s61 offen offset:0 sc1 lds
    buffer_load_dwordx4 v3, s[12:15], s61 offen offset:1024 sc1 lds
    buffer_load_dwordx4 v3, s[12:15], s61 offen offset:2048 sc1 lds
    buffer_load_dwordx4 v3, s[12:15], s61 offen offset:3072 sc1 lds
    s_add_u32 m0, s64, 4096
    s_add_u32 s61, s61, 229376
    buffer_load_dwordx4 v3, s[12:15], s47 offen offset:0 sc1 lds
    buffer_load_dwordx4 v3, s[12:15], s47 offen offset:1024 sc1 lds
    buffer_load_dwordx4 v3, s[12:15], s47 offen offset:2048 sc1 lds
    s_xor_b32 s64, s64, 0x10000
    s_branch L_g_dp_130_a
L_g_nw_128:
    s_waitcnt vmcnt(0) lgkmcnt(0)
    s_cmp_lg_u32 s44, 0
    s_cbranch_scc1 L_g_nl_141
    s_add_u32 s54, s60, 1
    v_add_u32 v12, s54, v113
    v_subrev_u32 v13, 58, v12
    v_subrev_u32 v11, 61, v12
    v_ashrrev_i32 v13, 31, v13
    v_ashrrev_i32 v11, 31, v11
    v_add3_u32 v13, v13, v11, 2
    v_lshl_add_u32 v13, v13, 16, v7
    buffer_load_dword v11, v13, s[12:15], 0 offen sc1
L_g_nl_141:
    s_branch L_g_loop0_118_l
L_g_nfl_132:
    s_cmp_eq_u32 s71, 0
    s_cbranch_scc1 L_g_nfl_132_d
    v_mov_b32 v10, 1
    s_mov_b64 exec, 1
    s_waitcnt vmcnt(0)
    ds_add_rtn_u32 v10, v15, v10 offset:4
    s_waitcnt lgkmcnt(0)
    v_readfirstlane_b32 s46, v10
    s_mov_b64 exec, -1
    s_mov_b32 s71, 0
    s_sub_u32 s59, s60, 1
    s_cmp_lg_u32 s46, s68
    s_cbranch_scc1 L_g_df_142
    v_mov_b32 v10, s59
    v_add_u32 v10, 1, v10
    v_mov_b32 v11, 0
    s_mov_b64 exec, 1
    buffer_store_dword v10, v11, s[12:15], s52 offen sc1
    s_mov_b64 exec, -1
L_sf_143:
L_g_df_142:
    s_add_u32 s68, s68, 4
    s_mov_b32 s65, 2
    s_branch L_g_nfl_132_d
L_g_dp_137_l:
    s_cmp_ge_u32 s62, s66
    s_cbranch_scc1 L_g_dp_137_d
    s_or_b32 s65, s65, 1
    s_add_u32 s47, s61, 4096
    s_mov_b32 m0, s64
    s_add_u32 s62, s62, 1
    buffer_load_dwordx4 v3, s[12:15], s61 offen offset:0 sc1 lds
    buffer_load_dwordx4 v3, s[12:15], s61 offen offset:1024 sc1 lds
    buffer_load_dwordx4 v3, s[12:15], s61 offen offset:2048 sc1 lds
    buffer_load_dwordx4 v3, s[12:15], s61 offen offset:3072 sc1 lds
    s_add_u32 m0, s64, 4096
    s_add_u32 s61, s61, 229376
    buffer_load_dwordx4 v3, s[12:15], s47 offen offset:0 sc1 lds
    buffer_load_dwordx4 v3, s[12:15], s47 offen offset:1024 sc1 lds
    buffer_load_dwordx4 v3, s[12:15], s47 offen offset:2048 sc1 lds
    s_xor_b32 s64, s64, 0x10000
    s_branch L_g_dp_137_a
L_g_nw1_134:
    s_cmp_eq_u32 s65, 2
    s_cbranch_scc1 L_g_nw1_134_w
    s_waitcnt vmcnt(0)
L_g_nw1_134_w:
    s_barrier
    ds_read_b128 v[32:35], v4 offset:0
    ds_read_b128 v[36:39], v4 offset:256
    ds_read_b128 v[40:43], v4 offset:2048
    ds_read_b128 v[44:47], v4 offset:2304
    ds_read_b128 v[48:51], v4 offset:4096
    ds_read_b128 v[52:55], v4 offset:4352
    ds_read_b128 v[56:59], v4 offset:6144
    ds_read_b128 v[60:63], v4 offset:6400
    s_branch L_g_jn_136
L_w_wo_12:
    s_load_dwordx2 s[4:5], s[0:1], 40
    s_load_dwordx2 s[6:7], s[0:1], 72
    s_and_b32 s50, s44, 3
    s_lshr_b32 s51, s44, 2
    s_waitcnt lgkmcnt(0)
    s_mov_b32 s24, s4
    s_and_b32 s25, s5, 0xffff
    s_mov_b32 s26, 0x800000
    s_mov_b32 s27, 0x00020000
    v_lshrrev_b32 v3, 4, v1
    v_and_b32 v4, 15, v1
    v_lshlrev_b32 v5, 2, v3
    v_xor_b32 v4, v4, v5
    v_mul_u32_u24 v3, 2048, v3
    v_lshl_add_u32 v3, v4, 4, v3
    s_mul_i32 s46, s51, 512
    s_mul_i32 s47, s50, 64
    s_add_u32 s46, s46, s47
    s_mul_i32 s47, s42, 1024
    s_add_u32 s46, s46, s47
    s_mul_i32 s46, s46, 2048
    s_lshl_b32 s47, s43, 8
    s_add_u32 s46, s46, s47
    s_lshl_b32 s45, s51, 16
    s_mul_i32 s47, s50, 16384
    s_add_u32 s45, s45, s47
    v_bfe_u32 v4, v1, 2, 2
    v_bfe_u32 v5, v1, 4, 1
    v_lshlrev_b32 v5, 1, v5
    v_bfe_u32 v6, v1, 1, 1
    v_add_u32 v5, v5, v6
    s_lshl_b32 s47, s50, 2
    v_add_u32 v5, s47, v5
    v_lshlrev_b32 v6, 2, v4
    v_xor_b32 v5, v5, v6
    v_lshlrev_b32 v5, 4, v5
    v_lshl_add_u32 v5, v4, 8, v5
    v_bfe_u32 v6, v1, 0, 1
    v_lshl_add_u32 v5, v6, 3, v5
    v_lshrrev_b32 v6, 5, v1
    v_mul_u32_u24 v6, 1024, v6
    v_add_u32 v5, v5, v6
    s_lshl_b32 s47, s51, 16
    v_add_u32 v5, s47, v5
    v_bfe_u32 v4, v1, 2, 2
    v_xor_b32 v5, s50, v4
    v_lshlrev_b32 v5, 6, v5
    v_lshl_add_u32 v5, v4, 8, v5
    v_and_b32 v6, 3, v1
    v_lshl_add_u32 v5, v6, 3, v5
    v_lshrrev_b32 v6, 4, v1
    v_lshl_add_u32 v5, v6, 10, v5
    v_lshrrev_b32 v6, 5, v1
    s_lshl_b32 s47, s51, 16
    v_add_u32 v5, s47, v5
    s_add_u32 m0, s45, 0
    s_add_u32 s47, s46, 0x0
    buffer_load_dwordx4 v3, s[24:27], s47 offen lds
    s_add_u32 m0, s45, 1024
    s_add_u32 s47, s46, 0x2000
    buffer_load_dwordx4 v3, s[24:27], s47 offen lds
    s_add_u32 m0, s45, 2048
    s_add_u32 s47, s46, 0x4000
    buffer_load_dwordx4 v3, s[24:27], s47 offen lds
    s_add_u32 m0, s45, 3072
    s_add_u32 s47, s46, 0x6000
    buffer_load_dwordx4 v3, s[24:27], s47 offen lds
    s_add_u32 m0, s45, 4096
    s_add_u32 s47, s46, 0x8000
    buffer_load_dwordx4 v3, s[24:27], s47 offen lds
    s_add_u32 m0, s45, 5120
    s_add_u32 s47, s46, 0xa000
    buffer_load_dwordx4 v3, s[24:27], s47 offen lds
    s_add_u32 m0, s45, 6144
    s_add_u32 s47, s46, 0xc000
    buffer_load_dwordx4 v3, s[24:27], s47 offen lds
    s_add_u32 m0, s45, 7168
    s_add_u32 s47, s46, 0xe000
    buffer_load_dwordx4 v3, s[24:27], s47 offen lds
    s_add_u32 m0, s45, 8192
    s_add_u32 s47, s46, 0x10000
    buffer_load_dwordx4 v3, s[24:27], s47 offen lds
    s_add_u32 m0, s45, 9216
    s_add_u32 s47, s46, 0x12000
    buffer_load_dwordx4 v3, s[24:27], s47 offen lds
    s_add_u32 m0, s45, 10240
    s_add_u32 s47, s46, 0x14000
    buffer_load_dwordx4 v3, s[24:27], s47 offen lds
    s_add_u32 m0, s45, 11264
    s_add_u32 s47, s46, 0x16000
    buffer_load_dwordx4 v3, s[24:27], s47 offen lds
    s_add_u32 m0, s45, 12288
    s_add_u32 s47, s46, 0x18000
    buffer_load_dwordx4 v3, s[24:27], s47 offen lds
    s_add_u32 m0, s45, 13312
    s_add_u32 s47, s46, 0x1a000
    buffer_load_dwordx4 v3, s[24:27], s47 offen lds
    s_add_u32 m0, s45, 14336
    s_add_u32 s47, s46, 0x1c000
    buffer_load_dwordx4 v3, s[24:27], s47 offen lds
    s_add_u32 m0, s45, 15360
    s_add_u32 s47, s46, 0x1e000
    buffer_load_dwordx4 v3, s[24:27], s47 offen lds
    s_waitcnt vmcnt(0)
    s_barrier
    ds_read_b64_tr_b16 a[0:1], v5 offset:0
    ds_read_b64_tr_b16 a[2:3], v5 offset:4096
    ds_read_b64_tr_b16 a[4:5], v5 offset:32
    ds_read_b64_tr_b16 a[6:7], v5 offset:4128
    ds_read_b64_tr_b16 a[8:9], v5 offset:8192
    ds_read_b64_tr_b16 a[10:11], v5 offset:12288
    ds_read_b64_tr_b16 a[12:13], v5 offset:8224
    ds_read_b64_tr_b16 a[14:15], v5 offset:12320
    s_waitcnt lgkmcnt(0)
    ds_read_b64_tr_b16 a[16:17], v5 offset:16384
    ds_read_b64_tr_b16 a[18:19], v5 offset:20480
    ds_read_b64_tr_b16 a[20:21], v5 offset:16416
    ds_read_b64_tr_b16 a[22:23], v5 offset:20512
    ds_read_b64_tr_b16 a[24:25], v5 offset:24576
    ds_read_b64_tr_b16 a[26:27], v5 offset:28672
    ds_read_b64_tr_b16 a[28:29], v5 offset:24608
    ds_read_b64_tr_b16 a[30:31], v5 offset:28704
    s_waitcnt lgkmcnt(0)
    ds_read_b64_tr_b16 a[32:33], v5 offset:32768
    ds_read_b64_tr_b16 a[34:35], v5 offset:36864
    ds_read_b64_tr_b16 a[36:37], v5 offset:32800
    ds_read_b64_tr_b16 a[38:39], v5 offset:36896
    ds_read_b64_tr_b16 a[40:41], v5 offset:40960
    ds_read_b64_tr_b16 a[42:43], v5 offset:45056
    ds_read_b64_tr_b16 a[44:45], v5 offset:40992
    ds_read_b64_tr_b16 a[46:47], v5 offset:45088
    s_waitcnt lgkmcnt(0)
    ds_read_b64_tr_b16 a[48:49], v5 offset:49152
    ds_read_b64_tr_b16 a[50:51], v5 offset:53248
    ds_read_b64_tr_b16 a[52:53], v5 offset:49184
    ds_read_b64_tr_b16 a[54:55], v5 offset:53280
    ds_read_b64_tr_b16 a[56:57], v5 offset:57344
    ds_read_b64_tr_b16 a[58:59], v5 offset:61440
    ds_read_b64_tr_b16 a[60:61], v5 offset:57376
    ds_read_b64_tr_b16 a[62:63], v5 offset:61472
    s_waitcnt lgkmcnt(0)
    s_waitcnt lgkmcnt(0)
    s_barrier
    s_add_u32 m0, s45, 0
    s_add_u32 s47, s46, 0x80000
    buffer_load_dwordx4 v3, s[24:27], s47 offen lds
    s_add_u32 m0, s45, 1024
    s_add_u32 s47, s46, 0x82000
    buffer_load_dwordx4 v3, s[24:27], s47 offen lds
    s_add_u32 m0, s45, 2048
    s_add_u32 s47, s46, 0x84000
    buffer_load_dwordx4 v3, s[24:27], s47 offen lds
    s_add_u32 m0, s45, 3072
    s_add_u32 s47, s46, 0x86000
    buffer_load_dwordx4 v3, s[24:27], s47 offen lds
    s_add_u32 m0, s45, 4096
    s_add_u32 s47, s46, 0x88000
    buffer_load_dwordx4 v3, s[24:27], s47 offen lds
    s_add_u32 m0, s45, 5120
    s_add_u32 s47, s46, 0x8a000
    buffer_load_dwordx4 v3, s[24:27], s47 offen lds
    s_add_u32 m0, s45, 6144
    s_add_u32 s47, s46, 0x8c000
    buffer_load_dwordx4 v3, s[24:27], s47 offen lds
    s_add_u32 m0, s45, 7168
    s_add_u32 s47, s46, 0x8e000
    buffer_load_dwordx4 v3, s[24:27], s47 offen lds
    s_add_u32 m0, s45, 8192
    s_add_u32 s47, s46, 0x90000
    buffer_load_dwordx4 v3, s[24:27], s47 offen lds
    s_add_u32 m0, s45, 9216
    s_add_u32 s47, s46, 0x92000
    buffer_load_dwordx4 v3, s[24:27], s47 offen lds
    s_add_u32 m0, s45, 10240
    s_add_u32 s47, s46, 0x94000
    buffer_load_dwordx4 v3, s[24:27], s47 offen lds
    s_add_u32 m0, s45, 11264
    s_add_u32 s47, s46, 0x96000
    buffer_load_dwordx4 v3, s[24:27], s47 offen lds
    s_add_u32 m0, s45, 12288
    s_add_u32 s47, s46, 0x98000
    buffer_load_dwordx4 v3, s[24:27], s47 offen lds
    s_add_u32 m0, s45, 13312
    s_add_u32 s47, s46, 0x9a000
    buffer_load_dwordx4 v3, s[24:27], s47 offen lds
    s_add_u32 m0, s45, 14336
    s_add_u32 s47, s46, 0x9c000
    buffer_load_dwordx4 v3, s[24:27], s47 offen lds
    s_add_u32 m0, s45, 15360
    s_add_u32 s47, s46, 0x9e000
    buffer_load_dwordx4 v3, s[24:27], s47 offen lds
    s_waitcnt vmcnt(0)
    s_barrier
    ds_read_b64_tr_b16 a[64:65], v5 offset:0
    ds_read_b64_tr_b16 a[66:67], v5 offset:4096
    ds_read_b64_tr_b16 a[68:69], v5 offset:32
    ds_read_b64_tr_b16 a[70:71], v5 offset:4128
    ds_read_b64_tr_b16 a[72:73], v5 offset:8192
    ds_read_b64_tr_b16 a[74:75], v5 offset:12288
    ds_read_b64_tr_b16 a[76:77], v5 offset:8224
    ds_read_b64_tr_b16 a[78:79], v5 offset:12320
    s_waitcnt lgkmcnt(0)
    ds_read_b64_tr_b16 a[80:81], v5 offset:16384
    ds_read_b64_tr_b16 a[82:83], v5 offset:20480
    ds_read_b64_tr_b16 a[84:85], v5 offset:16416
    ds_read_b64_tr_b16 a[86:87], v5 offset:20512
    ds_read_b64_tr_b16 a[88:89], v5 offset:24576
    ds_read_b64_tr_b16 a[90:91], v5 offset:28672
    ds_read_b64_tr_b16 a[92:93], v5 offset:24608
    ds_read_b64_tr_b16 a[94:95], v5 offset:28704
    s_waitcnt lgkmcnt(0)
    ds_read_b64_tr_b16 a[96:97], v5 offset:32768
    ds_read_b64_tr_b16 a[98:99], v5 offset:36864
    ds_read_b64_tr_b16 a[100:101], v5 offset:32800
    ds_read_b64_tr_b16 a[102:103], v5 offset:36896
    ds_read_b64_tr_b16 a[104:105], v5 offset:40960
    ds_read_b64_tr_b16 a[106:107], v5 offset:45056
    ds_read_b64_tr_b16 a[108:109], v5 offset:40992
    ds_read_b64_tr_b16 a[110:111], v5 offset:45088
    s_waitcnt lgkmcnt(0)
    ds_read_b64_tr_b16 a[112:113], v5 offset:49152
    ds_read_b64_tr_b16 a[114:115], v5 offset:53248
    ds_read_b64_tr_b16 a[116:117], v5 offset:49184
    ds_read_b64_tr_b16 a[118:119], v5 offset:53280
    ds_read_b64_tr_b16 a[120:121], v5 offset:57344
    ds_read_b64_tr_b16 a[122:123], v5 offset:61440
    ds_read_b64_tr_b16 a[124:125], v5 offset:57376
    ds_read_b64_tr_b16 a[126:127], v5 offset:61472
    s_waitcnt lgkmcnt(0)
    s_waitcnt lgkmcnt(0)
    s_barrier
    v_lshlrev_b32 v2, 4, v1
    s_mul_i32 s64, s44, 8192
    s_add_u32 s46, s64, 0x5000000
    s_mul_i32 s47, s42, 65536
    s_add_u32 s46, s46, s47
    v_add_u32 v3, s46, v2
    s_mul_i32 s46, s51, 32768
    v_add_u32 v4, s46, v2
    v_and_b32 v6, 15, v1
    v_lshlrev_b32 v6, 4, v6
    v_lshrrev_b32 v7, 4, v1
    v_lshl_add_u32 v6, v7, 9, v6
    v_add_u32 v4, s46, v6
    s_lshl_b32 s46, s50, 12
    s_add_u32 s46, s46, 131072
    v_add_u32 v5, s46, v2
    v_and_b32 v7, 7, v1
    v_lshlrev_b32 v7, 9, v7
    s_lshl_b32 s46, s42, 12
    s_add_u32 s46, s46, 0x102000
    v_add_u32 v7, s46, v7
    s_lshl_b32 s46, s42, 16
    s_lshl_b32 s47, s43, 11
    s_add_u32 s46, s46, s47
    s_lshl_b32 s47, s50, 9
    s_add_u32 s46, s46, s47
    s_add_u32 s46, s46, 0x9000000
    v_and_b32 v8, 31, v1
    v_lshlrev_b32 v8, 4, v8
    v_lshrrev_b32 v9, 5, v1
    v_lshl_add_u32 v8, v9, 14, v8
    v_add_u32 v8, s46, v8
    v_add_u32 v9, 0x8000, v8
    s_lshl_b32 s52, s43, 9
    s_lshl_b32 s47, s42, 7
    s_add_u32 s52, s52, s47
    s_add_u32 s52, s52, 0x107400
    s_add_u32 s52, s52, s76
    s_mul_i32 s46, s43, 8192
    s_add_u32 s46, s46, 0x5000000
    s_mul_i32 s47, s42, 65536
    s_add_u32 s46, s46, s47
    v_min_u32 v116, 63, v1
    v_lshlrev_b32 v116, 7, v116
    v_add_u32 v116, s46, v116
    s_mov_b32 s60, s74
    s_mul_i32 s61, s74, 262144
    s_mov_b32 s62, s74
    s_mul_i32 s63, s74, 262144
    s_mov_b32 s67, 0
    s_mov_b32 s68, 3
    s_mov_b32 s71, 0
    v_mov_b32 v15, 147456
    v_mov_b32 v14, 0
    ds_write_b32 v15, v14 offset:4
    ds_write_b32 v15, v14 offset:12
    ds_write_b32 v15, v14 offset:16
    v_mov_b32 v114, 1
    v_mov_b32 v115, 0
    v_lshrrev_b32 v113, 4, v1
    s_mov_b32 s72, 0
L_g_restart_144:
    s_cmp_lg_u32 s44, 0
    s_cbranch_scc1 L_g_nsp_145
    s_mov_b32 s70, 0
L_g_sp_151:
    s_add_u32 s54, s60, 0
    v_add_u32 v12, s54, v113
    v_and_b32 v13, 3, v12
    v_lshl_add_u32 v13, v13, 7, v7
    buffer_load_dword v11, v13, s[12:15], 0 offen sc1
    s_waitcnt vmcnt(0)
    v_cmp_ge_u32 vcc, v12, v11
    s_add_u32 s70, s70, 1
    s_and_b32 s46, vcc_lo, 0xffff
    s_cbranch_scc0 L_g_sp_151_ok
    s_sleep 3
    s_cmp_lt_u32 s70, 524288
    s_cbranch_scc1 L_g_sp_151
    s_branch L_c_done_1
L_g_sp_151_ok:
    v_cmp_ge_u32 vcc, v12, v11
    s_nop 0
    s_ff1_i32_b64 s46, vcc
    s_lshr_b32 s46, s46, 4
    s_min_u32 s46, s46, 4
    s_add_u32 s46, s46, s54
    s_min_u32 s46, s46, s75
    v_mov_b32 v11, s46
    ds_write_b32 v15, v11
L_g_nsp_145:
    s_waitcnt lgkmcnt(0)
    s_barrier
    ds_read_b32 v14, v15
    s_waitcnt lgkmcnt(0)
    v_readfirstlane_b32 s66, v14
    s_nop 3
L_g_restart_144_go:
    s_mov_b32 s69, 0
    s_cmp_gt_u32 s62, s60
    s_cbranch_scc1 L_g_nd_152
    s_cmp_ge_u32 s62, s66
    s_cbranch_scc1 L_g_nd_152
    s_add_u32 s47, s61, 4096
    s_add_u32 m0, s64, 0
    s_nop 0
    buffer_load_dwordx4 v3, s[12:15], s61 offen offset:0 sc1 lds
    buffer_load_dwordx4 v3, s[12:15], s61 offen offset:1024 sc1 lds
    buffer_load_dwordx4 v3, s[12:15], s61 offen offset:2048 sc1 lds
    buffer_load_dwordx4 v3, s[12:15], s61 offen offset:3072 sc1 lds
    s_add_u32 m0, s64, 4096
    s_nop 0
    buffer_load_dwordx4 v3, s[12:15], s47 offen offset:0 sc1 lds
    buffer_load_dwordx4 v3, s[12:15], s47 offen offset:1024 sc1 lds
    buffer_load_dwordx4 v3, s[12:15], s47 offen offset:2048 sc1 lds
    buffer_load_dwordx4 v3, s[12:15], s47 offen offset:3072 sc1 lds
    s_add_u32 s61, s61, 262144
    s_add_u32 s62, s62, 1
    s_xor_b32 s64, s64, 0x10000
    s_mov_b32 s69, 1
L_g_nd_152:
    s_cmp_eq_u32 s51, 1
    s_cbranch_scc1 L_g_g1r_146
    s_add_u32 s59, s60, 1
    s_mov_b32 s69, 0
    s_cmp_gt_u32 s62, s59
    s_cbranch_scc1 L_g_nd_153
    s_cmp_ge_u32 s62, s66
    s_cbranch_scc1 L_g_nd_153
    s_add_u32 s47, s61, 4096
    s_add_u32 m0, s64, 0
    s_nop 0
    buffer_load_dwordx4 v3, s[12:15], s61 offen offset:0 sc1 lds
    buffer_load_dwordx4 v3, s[12:15], s61 offen offset:1024 sc1 lds
    buffer_load_dwordx4 v3, s[12:15], s61 offen offset:2048 sc1 lds
    buffer_load_dwordx4 v3, s[12:15], s61 offen offset:3072 sc1 lds
    s_add_u32 m0, s64, 4096
    s_nop 0
    buffer_load_dwordx4 v3, s[12:15], s47 offen offset:0 sc1 lds
    buffer_load_dwordx4 v3, s[12:15], s47 offen offset:1024 sc1 lds
    buffer_load_dwordx4 v3, s[12:15], s47 offen offset:2048 sc1 lds
    buffer_load_dwordx4 v3, s[12:15], s47 offen offset:3072 sc1 lds
    s_add_u32 s61, s61, 262144
    s_add_u32 s62, s62, 1
    s_xor_b32 s64, s64, 0x10000
    s_mov_b32 s69, 1
L_g_nd_153:
    s_cmp_eq_u32 s69, 1
    s_cbranch_scc1 L_g_w0_154
    s_waitcnt vmcnt(0)
L_g_w0_154:
    s_waitcnt vmcnt(8)
    s_cmp_lg_u32 s44, 0
    s_cbranch_scc1 L_g_nl_155
    s_add_u32 s54, s60, 1
    v_add_u32 v12, s54, v113
    v_and_b32 v13, 3, v12
    v_lshl_add_u32 v13, v13, 7, v7
    buffer_load_dword v11, v13, s[12:15], 0 offen sc1
L_g_nl_155:
L_g_loop0_147_l:
    s_barrier
    ds_read_b128 v[32:35], v4 offset:0
    ds_read_b128 v[36:39], v4 offset:256
    ds_read_b128 v[40:43], v4 offset:2048
    ds_read_b128 v[44:47], v4 offset:2304
    ds_read_b128 v[48:51], v4 offset:4096
    ds_read_b128 v[52:55], v4 offset:4352
    ds_read_b128 v[56:59], v4 offset:6144
    ds_read_b128 v[60:63], v4 offset:6400
    s_branch L_g_loop0_147_m
.p2align 6
L_g_loop0_147:
    s_barrier
L_g_loop0_147_m:
    s_setprio 2
    s_waitcnt lgkmcnt(6)
    v_mfma_f32_16x16x32_bf16 v[16:19], v[32:35], a[0:3], 0
    ds_read_b32 v14, v15
    v_mfma_f32_16x16x32_bf16 v[20:23], v[32:35], a[4:7], 0
    ds_read_b128 v[32:35], v4 offset:8192
    v_mfma_f32_16x16x32_bf16 v[28:31], v[36:39], a[4:7], 0
    v_mfma_f32_16x16x32_bf16 v[24:27], v[36:39], a[0:3], 0
    ds_read_b128 v[36:39], v4 offset:8448
    s_waitcnt lgkmcnt(6)
    v_mfma_f32_16x16x32_bf16 v[16:19], v[40:43], a[8:11], v[16:19]
    v_mfma_f32_16x16x32_bf16 v[20:23], v[40:43], a[12:15], v[20:23]
    ds_read_b128 v[40:43], v4 offset:10240
    v_mfma_f32_16x16x32_bf16 v[28:31], v[44:47], a[12:15], v[28:31]
    v_mfma_f32_16x16x32_bf16 v[24:27], v[44:47], a[8:11], v[24:27]
    ds_read_b128 v[44:47], v4 offset:10496
    s_waitcnt lgkmcnt(6)
    v_mfma_f32_16x16x32_bf16 v[16:19], v[48:51], a[16:19], v[16:19]
    v_mfma_f32_16x16x32_bf16 v[20:23], v[48:51], a[20:23], v[20:23]
    ds_read_b128 v[48:51], v4 offset:12288
    v_mfma_f32_16x16x32_bf16 v[28:31], v[52:55], a[20:23], v[28:31]
    v_mfma_f32_16x16x32_bf16 v[24:27], v[52:55], a[16:19], v[24:27]
    ds_read_b128 v[52:55], v4 offset:12544
    s_waitcnt lgkmcnt(6)
    v_mfma_f32_16x16x32_bf16 v[16:19], v[56:59], a[24:27], v[16:19]
    v_mfma_f32_16x16x32_bf16 v[20:23], v[56:59], a[28:31], v[20:23]
    ds_read_b128 v[56:59], v4 offset:14336
    v_mfma_f32_16x16x32_bf16 v[28:31], v[60:63], a[28:31], v[28:31]
    v_mfma_f32_16x16x32_bf16 v[24:27], v[60:63], a[24:27], v[24:27]
    ds_read_b128 v[60:63], v4 offset:14592
    s_waitcnt lgkmcnt(6)
    v_mfma_f32_16x16x32_bf16 v[16:19], v[32:35], a[32:35], v[16:19]
    v_mfma_f32_16x16x32_bf16 v[20:23], v[32:35], a[36:39], v[20:23]
    ds_read_b128 v[32:35], v4 offset:16384
    v_mfma_f32_16x16x32_bf16 v[28:31], v[36:39], a[36:39], v[28:31]
    v_mfma_f32_16x16x32_bf16 v[24:27], v[36:39], a[32:35], v[24:27]
    ds_read_b128 v[36:39], v4 offset:16640
    s_waitcnt lgkmcnt(6)
    v_mfma_f32_16x16x32_bf16 v[16:19], v[40:43], a[40:43], v[16:19]
    v_mfma_f32_16x16x32_bf16 v[20:23], v[40:43], a[44:47], v[20:23]
    ds_read_b128 v[40:43], v4 offset:18432
    v_mfma_f32_16x16x32_bf16 v[28:31], v[44:47], a[44:47], v[28:31]
    v_mfma_f32_16x16x32_bf16 v[24:27], v[44:47], a[40:43], v[24:27]
    ds_read_b128 v[44:47], v4 offset:18688
    s_waitcnt lgkmcnt(6)
    v_mfma_f32_16x16x32_bf16 v[16:19], v[48:51], a[48:51], v[16:19]
    v_mfma_f32_16x16x32_bf16 v[20:23], v[48:51], a[52:55], v[20:23]
    ds_read_b128 v[48:51], v4 offset:20480
    v_mfma_f32_16x16x32_bf16 v[28:31], v[52:55], a[52:55], v[28:31]
    v_mfma_f32_16x16x32_bf16 v[24:27], v[52:55], a[48:51], v[24:27]
    ds_read_b128 v[52:55], v4 offset:20736
    s_waitcnt lgkmcnt(6)
    v_mfma_f32_16x16x32_bf16 v[16:19], v[56:59], a[56:59], v[16:19]
    v_mfma_f32_16x16x32_bf16 v[20:23], v[56:59], a[60:63], v[20:23]
    ds_read_b128 v[56:59], v4 offset:22528
    v_mfma_f32_16x16x32_bf16 v[28:31], v[60:63], a[60:63], v[28:31]
    v_mfma_f32_16x16x32_bf16 v[24:27], v[60:63], a[56:59], v[24:27]
    ds_read_b128 v[60:63], v4 offset:22784
    s_waitcnt lgkmcnt(6)
    v_mfma_f32_16x16x32_bf16 v[16:19], v[32:35], a[64:67], v[16:19]
    v_mfma_f32_16x16x32_bf16 v[20:23], v[32:35], a[68:71], v[20:23]
    ds_read_b128 v[32:35], v4 offset:24576
    v_mfma_f32_16x16x32_bf16 v[28:31], v[36:39], a[68:71], v[28:31]
    v_mfma_f32_16x16x32_bf16 v[24:27], v[36:39], a[64:67], v[24:27]
    ds_read_b128 v[36:39], v4 offset:24832
    s_waitcnt lgkmcnt(6)
    v_mfma_f32_16x16x32_bf16 v[16:19], v[40:43], a[72:75], v[16:19]
    v_mfma_f32_16x16x32_bf16 v[20:23], v[40:43], a[76:79], v[20:23]
    ds_read_b128 v[40:43], v4 offset:26624
    v_mfma_f32_16x16x32_bf16 v[28:31], v[44:47], a[76:79], v[28:31]
    v_mfma_f32_16x16x32_bf16 v[24:27], v[44:47], a[72:75], v[24:27]
    ds_read_b128 v[44:47], v4 offset:26880
    s_waitcnt lgkmcnt(6)
    v_mfma_f32_16x16x32_bf16 v[16:19], v[48:51], a[80:83], v[16:19]
    v_mfma_f32_16x16x32_bf16 v[20:23], v[48:51], a[84:87], v[20:23]
    ds_read_b128 v[48:51], v4 offset:28672
    v_mfma_f32_16x16x32_bf16 v[28:31], v[52:55], a[84:87], v[28:31]
    v_mfma_f32_16x16x32_bf16 v[24:27], v[52:55], a[80:83], v[24:27]
    ds_read_b128 v[52:55], v4 offset:28928
    s_waitcnt lgkmcnt(6)
    v_mfma_f32_16x16x32_bf16 v[16:19], v[56:59], a[88:91], v[16:19]
    v_mfma_f32_16x16x32_bf16 v[20:23], v[56:59], a[92:95], v[20:23]
    ds_read_b128 v[56:59], v4 offset:30720
    v_mfma_f32_16x16x32_bf16 v[28:31], v[60:63], a[92:95], v[28:31]
    v_mfma_f32_16x16x32_bf16 v[24:27], v[60:63], a[88:91], v[24:27]
    ds_read_b128 v[60:63], v4 offset:30976
    s_waitcnt lgkmcnt(6)
    v_mfma_f32_16x16x32_bf16 v[16:19], v[32:35], a[96:99], v[16:19]
    v_mfma_f32_16x16x32_bf16 v[20:23], v[32:35], a[100:103], v[20:23]
    v_mfma_f32_16x16x32_bf16 v[28:31], v[36:39], a[100:103], v[28:31]
    v_mfma_f32_16x16x32_bf16 v[24:27], v[36:39], a[96:99], v[24:27]
    s_waitcnt lgkmcnt(4)
    v_mfma_f32_16x16x32_bf16 v[16:19], v[40:43], a[104:107], v[16:19]
    v_mfma_f32_16x16x32_bf16 v[20:23], v[40:43], a[108:111], v[20:23]
    v_mfma_f32_16x16x32_bf16 v[28:31], v[44:47], a[108:111], v[28:31]
    v_mfma_f32_16x16x32_bf16 v[24:27], v[44:47], a[104:107], v[24:27]
    s_waitcnt lgkmcnt(2)
    v_mfma_f32_16x16x32_bf16 v[16:19], v[48:51], a[112:115], v[16:19]
    v_mfma_f32_16x16x32_bf16 v[20:23], v[48:51], a[116:119], v[20:23]
    v_mfma_f32_16x16x32_bf16 v[28:31], v[52:55], a[116:119], v[28:31]
    v_mfma_f32_16x16x32_bf16 v[24:27], v[52:55], a[112:115], v[24:27]
    s_waitcnt lgkmcnt(0)
    v_mfma_f32_16x16x32_bf16 v[16:19], v[56:59], a[120:123], v[16:19]
    v_mfma_f32_16x16x32_bf16 v[20:23], v[56:59], a[124:127], v[20:23]
    v_mfma_f32_16x16x32_bf16 v[28:31], v[60:63], a[124:127], v[28:31]
    v_mfma_f32_16x16x32_bf16 v[24:27], v[60:63], a[120:123], v[24:27]
    v_xor_b32 v4, 0x10000, v4
    s_setprio 0
    s_waitcnt vmcnt(0)
    v_readfirstlane_b32 s66, v14
    s_barrier
    s_nop 6
    ds_write_b128 v5, v[16:19] offset:0
    ds_write_b128 v5, v[20:23] offset:1024
    ds_write_b128 v5, v[24:27] offset:2048
    ds_write_b128 v5, v[28:31] offset:3072
    s_cmp_lg_u32 s44, 0
    s_cbranch_scc1 L_g_ne_156
    v_cmp_ge_u32 vcc, v12, v11
    s_nop 0
    s_ff1_i32_b64 s46, vcc
    s_lshr_b32 s46, s46, 4
    s_min_u32 s46, s46, 4
    s_add_u32 s46, s46, s54
    s_min_u32 s46, s46, s75
    v_mov_b32 v11, s46
    ds_write_b32 v15, v11
L_g_ne_156:
    s_add_u32 s60, s60, 1
    s_mov_b32 s65, 0
    s_cmp_le_u32 s62, s60
    s_cbranch_scc1 L_g_dp_159_l
L_g_dp_159_a:
    s_cmp_ge_u32 s62, s66
    s_cbranch_scc1 L_g_dp_159_d
    s_add_u32 s47, s61, 4096
    s_mov_b32 m0, s64
    s_add_u32 s62, s62, 1
    buffer_load_dwordx4 v3, s[12:15], s61 offen offset:0 sc1 lds
    buffer_load_dwordx4 v3, s[12:15], s61 offen offset:1024 sc1 lds
    buffer_load_dwordx4 v3, s[12:15], s61 offen offset:2048 sc1 lds
    buffer_load_dwordx4 v3, s[12:15], s61 offen offset:3072 sc1 lds
    s_add_u32 m0, s64, 4096
    s_add_u32 s61, s61, 262144
    buffer_load_dwordx4 v3, s[12:15], s47 offen offset:0 sc1 lds
    buffer_load_dwordx4 v3, s[12:15], s47 offen offset:1024 sc1 lds
    buffer_load_dwordx4 v3, s[12:15], s47 offen offset:2048 sc1 lds
    buffer_load_dwordx4 v3, s[12:15], s47 offen offset:3072 sc1 lds
    s_xor_b32 s64, s64, 0x10000
L_g_dp_159_d:
    s_cmp_le_u32 s66, s60
    s_cbranch_scc1 L_g_ex0_158
    s_cmp_lg_u32 s65, 0
    s_cbranch_scc1 L_g_nw_157
    ds_read_b128 v[32:35], v4 offset:0
    ds_read_b128 v[36:39], v4 offset:256
    ds_read_b128 v[40:43], v4 offset:2048
    ds_read_b128 v[44:47], v4 offset:2304
    ds_read_b128 v[48:51], v4 offset:4096
    ds_read_b128 v[52:55], v4 offset:4352
    ds_read_b128 v[56:59], v4 offset:6144
    ds_read_b128 v[60:63], v4 offset:6400
    s_cmp_lg_u32 s44, 0
    s_cbranch_scc1 L_g_nl_160
    s_add_u32 s54, s60, 1
    v_add_u32 v12, s54, v113
    v_and_b32 v13, 3, v12
    v_lshl_add_u32 v13, v13, 7, v7
    buffer_load_dword v11, v13, s[12:15], 0 offen sc1
L_g_nl_160:
    s_waitcnt lgkmcnt(8)
    s_branch L_g_loop0_147
L_g_ex0_158:
    s_cmp_lg_u32 s44, 0
    s_cbranch_scc1 L_g_ex0_158_n
    s_sleep 6
    s_add_u32 s54, s60, 0
    v_add_u32 v12, s54, v113
    v_and_b32 v13, 3, v12
    v_lshl_add_u32 v13, v13, 7, v7
    buffer_load_dword v11, v13, s[12:15], 0 offen sc1
    s_waitcnt vmcnt(0)
    v_cmp_ge_u32 vcc, v12, v11
    s_nop 0
    s_ff1_i32_b64 s46, vcc
    s_lshr_b32 s46, s46, 4
    s_min_u32 s46, s46, 4
    s_add_u32 s46, s46, s54
    s_min_u32 s46, s46, s75
    v_mov_b32 v11, s46
    ds_write_b32 v15, v11
L_g_ex0_158_n:
    s_waitcnt lgkmcnt(0)
    s_barrier
    ds_read_b32 v14, v15
    s_waitcnt lgkmcnt(0)
    v_readfirstlane_b32 s66, v14
    s_barrier
    s_cmp_gt_u32 s66, s60
    s_cbranch_scc1 L_g_restart_144_go
    s_branch L_g_tail_149
L_g_g1r_146:
    s_mov_b32 s65, 1
    s_branch L_g_loop1_148_e
.p2align 6
L_g_loop1_148:
    s_mov_b32 s65, 0
L_g_loop1_148_e:
    s_barrier
    ds_read_b32 v14, v15
    s_bitcmp1_b32 s67, 1
    s_cbranch_scc0 L_g_nfl_161
    s_cmp_lg_u32 s44, 4
    s_cbranch_scc1 L_g_nfl_161_d
    s_sub_u32 s59, s60, 1
    v_mov_b32 v10, s59
    buffer_store_dword v10, v115, s[12:15], s52 offen sc1
L_g_nfl_161_d:
    s_waitcnt lgkmcnt(0)
    v_readfirstlane_b32 s66, v14
    ds_read_b128 v[80:83], v5 offset:0
    ds_read_b128 v[84:87], v5 offset:1024
    ds_read_b128 v[88:91], v5 offset:2048
    ds_read_b128 v[92:95], v5 offset:3072
    s_cmp_le_u32 s62, s60
    s_cbranch_scc1 L_g_dp_166_l
L_g_dp_166_a:
    s_cmp_ge_u32 s62, s66
    s_cbranch_scc1 L_g_dp_166_d
    s_add_u32 s47, s61, 4096
    s_mov_b32 m0, s64
    s_add_u32 s62, s62, 1
    buffer_load_dwordx4 v3, s[12:15], s61 offen offset:0 sc1 lds
    buffer_load_dwordx4 v3, s[12:15], s61 offen offset:1024 sc1 lds
    buffer_load_dwordx4 v3, s[12:15], s61 offen offset:2048 sc1 lds
    buffer_load_dwordx4 v3, s[12:15], s61 offen offset:3072 sc1 lds
    s_add_u32 m0, s64, 4096
    s_add_u32 s61, s61, 262144
    buffer_load_dwordx4 v3, s[12:15], s47 offen offset:0 sc1 lds
    buffer_load_dwordx4 v3, s[12:15], s47 offen offset:1024 sc1 lds
    buffer_load_dwordx4 v3, s[12:15], s47 offen offset:2048 sc1 lds
    buffer_load_dwordx4 v3, s[12:15], s47 offen offset:3072 sc1 lds
    s_xor_b32 s64, s64, 0x10000
L_g_dp_166_d:
    s_bitcmp1_b32 s67, 0
    s_cbranch_scc0 L_g_nep_162
    s_waitcnt lgkmcnt(0)
    v_add_f32 v80, v80, v16
    v_add_f32 v81, v81, v17
    v_add_f32 v82, v82, v18
    v_add_f32 v83, v83, v19
    v_add_f32 v84, v84, v20
    v_add_f32 v85, v85, v21
    v_add_f32 v86, v86, v22
    v_add_f32 v87, v87, v23
    v_add_f32 v88, v88, v24
    v_add_f32 v89, v89, v25
    v_add_f32 v90, v90, v26
    v_add_f32 v91, v91, v27
    v_add_f32 v92, v92, v28
    v_add_f32 v93, v93, v29
    v_add_f32 v94, v94, v30
    v_add_f32 v95, v95, v31
    v_cvt_pk_bf16_f32 v104, v80, v81
    v_cvt_pk_bf16_f32 v105, v82, v83
    v_cvt_pk_bf16_f32 v106, v84, v85
    v_cvt_pk_bf16_f32 v107, v86, v87
    s_nop 1
    v_permlane16_swap_b32 v104, v106
    v_permlane16_swap_b32 v105, v107
    buffer_store_dwordx4 v[104:107], v8, s[12:15], s63 offen sc1
    v_cvt_pk_bf16_f32 v108, v88, v89
    v_cvt_pk_bf16_f32 v109, v90, v91
    v_cvt_pk_bf16_f32 v110, v92, v93
    v_cvt_pk_bf16_f32 v111, v94, v95
    s_nop 1
    v_permlane16_swap_b32 v108, v110
    v_permlane16_swap_b32 v109, v111
    buffer_store_dwordx4 v[108:111], v9, s[12:15], s63 offen sc1
    s_add_u32 s63, s63, 262144
L_g_nep_162:
    s_cmp_lg_u32 s65, 0
    s_cbranch_scc1 L_g_nw1_163
    ds_read_b128 v[32:35], v4 offset:0
    ds_read_b128 v[36:39], v4 offset:256
    ds_read_b128 v[40:43], v4 offset:2048
    ds_read_b128 v[44:47], v4 offset:2304
    ds_read_b128 v[48:51], v4 offset:4096
    ds_read_b128 v[52:55], v4 offset:4352
    ds_read_b128 v[56:59], v4 offset:6144
    ds_read_b128 v[60:63], v4 offset:6400
    s_barrier
L_g_jn_165:
    s_setprio 1
    s_waitcnt lgkmcnt(6)
    v_mfma_f32_16x16x32_bf16 v[16:19], v[32:35], a[0:3], 0
    v_mfma_f32_16x16x32_bf16 v[20:23], v[32:35], a[4:7], 0
    ds_read_b128 v[32:35], v4 offset:8192
    v_mfma_f32_16x16x32_bf16 v[28:31], v[36:39], a[4:7], 0
    v_mfma_f32_16x16x32_bf16 v[24:27], v[36:39], a[0:3], 0
    ds_read_b128 v[36:39], v4 offset:8448
    s_waitcnt lgkmcnt(6)
    v_mfma_f32_16x16x32_bf16 v[16:19], v[40:43], a[8:11], v[16:19]
    v_mfma_f32_16x16x32_bf16 v[20:23], v[40:43], a[12:15], v[20:23]
    ds_read_b128 v[40:43], v4 offset:10240
    v_mfma_f32_16x16x32_bf16 v[28:31], v[44:47], a[12:15], v[28:31]
    v_mfma_f32_16x16x32_bf16 v[24:27], v[44:47], a[8:11], v[24:27]
    ds_read_b128 v[44:47], v4 offset:10496
    s_waitcnt lgkmcnt(6)
    v_mfma_f32_16x16x32_bf16 v[16:19], v[48:51], a[16:19], v[16:19]
    v_mfma_f32_16x16x32_bf16 v[20:23], v[48:51], a[20:23], v[20:23]
    ds_read_b128 v[48:51], v4 offset:12288
    v_mfma_f32_16x16x32_bf16 v[28:31], v[52:55], a[20:23], v[28:31]
    v_mfma_f32_16x16x32_bf16 v[24:27], v[52:55], a[16:19], v[24:27]
    ds_read_b128 v[52:55], v4 offset:12544
    s_waitcnt lgkmcnt(6)
    v_mfma_f32_16x16x32_bf16 v[16:19], v[56:59], a[24:27], v[16:19]
    v_mfma_f32_16x16x32_bf16 v[20:23], v[56:59], a[28:31], v[20:23]
    ds_read_b128 v[56:59], v4 offset:14336
    v_mfma_f32_16x16x32_bf16 v[28:31], v[60:63], a[28:31], v[28:31]
    v_mfma_f32_16x16x32_bf16 v[24:27], v[60:63], a[24:27], v[24:27]
    ds_read_b128 v[60:63], v4 offset:14592
    s_waitcnt lgkmcnt(6)
    v_mfma_f32_16x16x32_bf16 v[16:19], v[32:35], a[32:35], v[16:19]
    v_mfma_f32_16x16x32_bf16 v[20:23], v[32:35], a[36:39], v[20:23]
    ds_read_b128 v[32:35], v4 offset:16384
    v_mfma_f32_16x16x32_bf16 v[28:31], v[36:39], a[36:39], v[28:31]
    v_mfma_f32_16x16x32_bf16 v[24:27], v[36:39], a[32:35], v[24:27]
    ds_read_b128 v[36:39], v4 offset:16640
    s_waitcnt lgkmcnt(6)
    v_mfma_f32_16x16x32_bf16 v[16:19], v[40:43], a[40:43], v[16:19]
    v_mfma_f32_16x16x32_bf16 v[20:23], v[40:43], a[44:47], v[20:23]
    ds_read_b128 v[40:43], v4 offset:18432
    v_mfma_f32_16x16x32_bf16 v[28:31], v[44:47], a[44:47], v[28:31]
    v_mfma_f32_16x16x32_bf16 v[24:27], v[44:47], a[40:43], v[24:27]
    ds_read_b128 v[44:47], v4 offset:18688
    s_waitcnt lgkmcnt(6)
    v_mfma_f32_16x16x32_bf16 v[16:19], v[48:51], a[48:51], v[16:19]
    v_mfma_f32_16x16x32_bf16 v[20:23], v[48:51], a[52:55], v[20:23]
    ds_read_b128 v[48:51], v4 offset:20480
    v_mfma_f32_16x16x32_bf16 v[28:31], v[52:55], a[52:55], v[28:31]
    v_mfma_f32_16x16x32_bf16 v[24:27], v[52:55], a[48:51], v[24:27]
    ds_read_b128 v[52:55], v4 offset:20736
    s_waitcnt lgkmcnt(6)
    v_mfma_f32_16x16x32_bf16 v[16:19], v[56:59], a[56:59], v[16:19]
    v_mfma_f32_16x16x32_bf16 v[20:23], v[56:59], a[60:63], v[20:23]
    ds_read_b128 v[56:59], v4 offset:22528
    v_mfma_f32_16x16x32_bf16 v[28:31], v[60:63], a[60:63], v[28:31]
    v_mfma_f32_16x16x32_bf16 v[24:27], v[60:63], a[56:59], v[24:27]
    ds_read_b128 v[60:63], v4 offset:22784
    s_waitcnt lgkmcnt(6)
    v_mfma_f32_16x16x32_bf16 v[16:19], v[32:35], a[64:67], v[16:19]
    v_mfma_f32_16x16x32_bf16 v[20:23], v[32:35], a[68:71], v[20:23]
    ds_read_b128 v[32:35], v4 offset:24576
    v_mfma_f32_16x16x32_bf16 v[28:31], v[36:39], a[68:71], v[28:31]
    v_mfma_f32_16x16x32_bf16 v[24:27], v[36:39], a[64:67], v[24:27]
    ds_read_b128 v[36:39], v4 offset:24832
    s_waitcnt lgkmcnt(6)
    v_mfma_f32_16x16x32_bf16 v[16:19], v[40:43], a[72:75], v[16:19]
    v_mfma_f32_16x16x32_bf16 v[20:23], v[40:43], a[76:79], v[20:23]
    ds_read_b128 v[40:43], v4 offset:26624
    v_mfma_f32_16x16x32_bf16 v[28:31], v[44:47], a[76:79], v[28:31]
    v_mfma_f32_16x16x32_bf16 v[24:27], v[44:47], a[72:75], v[24:27]
    ds_read_b128 v[44:47], v4 offset:26880
    s_waitcnt lgkmcnt(6)
    v_mfma_f32_16x16x32_bf16 v[16:19], v[48:51], a[80:83], v[16:19]
    v_mfma_f32_16x16x32_bf16 v[20:23], v[48:51], a[84:87], v[20:23]
    ds_read_b128 v[48:51], v4 offset:28672
    v_mfma_f32_16x16x32_bf16 v[28:31], v[52:55], a[84:87], v[28:31]
    v_mfma_f32_16x16x32_bf16 v[24:27], v[52:55], a[80:83], v[24:27]
    ds_read_b128 v[52:55], v4 offset:28928
    s_waitcnt lgkmcnt(6)
    v_mfma_f32_16x16x32_bf16 v[16:19], v[56:59], a[88:91], v[16:19]
    v_mfma_f32_16x16x32_bf16 v[20:23], v[56:59], a[92:95], v[20:23]
    ds_read_b128 v[56:59], v4 offset:30720
    v_mfma_f32_16x16x32_bf16 v[28:31], v[60:63], a[92:95], v[28:31]
    v_mfma_f32_16x16x32_bf16 v[24:27], v[60:63], a[88:91], v[24:27]
    ds_read_b128 v[60:63], v4 offset:30976
    s_waitcnt lgkmcnt(6)
    v_mfma_f32_16x16x32_bf16 v[16:19], v[32:35], a[96:99], v[16:19]
    v_mfma_f32_16x16x32_bf16 v[20:23], v[32:35], a[100:103], v[20:23]
    v_mfma_f32_16x16x32_bf16 v[28:31], v[36:39], a[100:103], v[28:31]
    v_mfma_f32_16x16x32_bf16 v[24:27], v[36:39], a[96:99], v[24:27]
    s_waitcnt lgkmcnt(4)
    v_mfma_f32_16x16x32_bf16 v[16:19], v[40:43], a[104:107], v[16:19]
    v_mfma_f32_16x16x32_bf16 v[20:23], v[40:43], a[108:111], v[20:23]
    v_mfma_f32_16x16x32_bf16 v[28:31], v[44:47], a[108:111], v[28:31]
    v_mfma_f32_16x16x32_bf16 v[24:27], v[44:47], a[104:107], v[24:27]
    s_waitcnt lgkmcnt(2)
    v_mfma_f32_16x16x32_bf16 v[16:19], v[48:51], a[112:115], v[16:19]
    v_mfma_f32_16x16x32_bf16 v[20:23], v[48:51], a[116:119], v[20:23]
    v_mfma_f32_16x16x32_bf16 v[28:31], v[52:55], a[116:119], v[28:31]
    v_mfma_f32_16x16x32_bf16 v[24:27], v[52:55], a[112:115], v[24:27]
    s_waitcnt lgkmcnt(0)
    v_mfma_f32_16x16x32_bf16 v[16:19], v[56:59], a[120:123], v[16:19]
    v_mfma_f32_16x16x32_bf16 v[20:23], v[56:59], a[124:127], v[20:23]
    v_mfma_f32_16x16x32_bf16 v[28:31], v[60:63], a[124:127], v[28:31]
    v_mfma_f32_16x16x32_bf16 v[24:27], v[60:63], a[120:123], v[24:27]
    v_xor_b32 v4, 0x10000, v4
    s_setprio 0
    s_waitcnt vmcnt(0)
    s_lshl_b32 s67, s67, 1
    s_or_b32 s67, s67, 1
    s_add_u32 s60, s60, 1
    s_cmp_gt_u32 s66, s60
    s_cbranch_scc1 L_g_loop1_148
    s_barrier
    ds_read_b32 v14, v15
    s_waitcnt lgkmcnt(0)
    v_readfirstlane_b32 s66, v14
    s_barrier
    s_mov_b32 s69, 0
    s_cmp_gt_u32 s62, s60
    s_cbranch_scc1 L_g_nd_167
    s_cmp_ge_u32 s62, s66
    s_cbranch_scc1 L_g_nd_167
    s_add_u32 s47, s61, 4096
    s_add_u32 m0, s64, 0
    s_nop 0
    buffer_load_dwordx4 v3, s[12:15], s61 offen offset:0 sc1 lds
    buffer_load_dwordx4 v3, s[12:15], s61 offen offset:1024 sc1 lds
    buffer_load_dwordx4 v3, s[12:15], s61 offen offset:2048 sc1 lds
    buffer_load_dwordx4 v3, s[12:15], s61 offen offset:3072 sc1 lds
    s_add_u32 m0, s64, 4096
    s_nop 0
    buffer_load_dwordx4 v3, s[12:15], s47 offen offset:0 sc1 lds
    buffer_load_dwordx4 v3, s[12:15], s47 offen offset:1024 sc1 lds
    buffer_load_dwordx4 v3, s[12:15], s47 offen offset:2048 sc1 lds
    buffer_load_dwordx4 v3, s[12:15], s47 offen offset:3072 sc1 lds
    s_add_u32 s61, s61, 262144
    s_add_u32 s62, s62, 1
    s_xor_b32 s64, s64, 0x10000
    s_mov_b32 s69, 1
L_g_nd_167:
    s_sub_u32 s59, s60, 1
    ds_read_b128 v[80:83], v5 offset:0
    ds_read_b128 v[84:87], v5 offset:1024
    ds_read_b128 v[88:91], v5 offset:2048
    ds_read_b128 v[92:95], v5 offset:3072
    s_nop 7
    s_waitcnt lgkmcnt(3)
    v_add_f32 v80, v80, v16
    v_add_f32 v81, v81, v17
    v_add_f32 v82, v82, v18
    v_add_f32 v83, v83, v19
    s_waitcnt lgkmcnt(2)
    v_add_f32 v84, v84, v20
    v_add_f32 v85, v85, v21
    v_add_f32 v86, v86, v22
    v_add_f32 v87, v87, v23
    s_waitcnt lgkmcnt(1)
    v_add_f32 v88, v88, v24
    v_add_f32 v89, v89, v25
    v_add_f32 v90, v90, v26
    v_add_f32 v91, v91, v27
    s_waitcnt lgkmcnt(0)
    v_add_f32 v92, v92, v28
    v_add_f32 v93, v93, v29
    v_add_f32 v94, v94, v30
    v_add_f32 v95, v95, v31
    v_cvt_pk_bf16_f32 v104, v80, v81
    v_cvt_pk_bf16_f32 v105, v82, v83
    v_cvt_pk_bf16_f32 v106, v84, v85
    v_cvt_pk_bf16_f32 v107, v86, v87
    s_nop 1
    v_permlane16_swap_b32 v104, v106
    v_permlane16_swap_b32 v105, v107
    buffer_store_dwordx4 v[104:107], v8, s[12:15], s63 offen sc1
    v_cvt_pk_bf16_f32 v108, v88, v89
    v_cvt_pk_bf16_f32 v109, v90, v91
    v_cvt_pk_bf16_f32 v110, v92, v93
    v_cvt_pk_bf16_f32 v111, v94, v95
    s_nop 1
    v_permlane16_swap_b32 v108, v110
    v_permlane16_swap_b32 v109, v111
    buffer_store_dwordx4 v[108:111], v9, s[12:15], s63 offen sc1
    s_add_u32 s63, s63, 262144
    s_mov_b32 s67, 0
    s_mov_b32 s71, 1
    s_cmp_gt_u32 s66, s60
    s_cbranch_scc1 L_g_g1r_146
    v_mov_b32 v10, 1
    s_mov_b64 exec, 1
    s_waitcnt vmcnt(0)
    ds_add_rtn_u32 v10, v15, v10 offset:4
    s_waitcnt lgkmcnt(0)
    v_readfirstlane_b32 s46, v10
    s_mov_b64 exec, -1
    s_mov_b32 s71, 0
    s_sub_u32 s59, s60, 1
    s_cmp_lg_u32 s46, s68
    s_cbranch_scc1 L_g_df_168
    v_mov_b32 v10, s59
    v_add_u32 v10, 1, v10
    v_mov_b32 v11, 0
    s_mov_b64 exec, 1
    buffer_store_dword v10, v11, s[12:15], s52 offen sc1
    s_mov_b64 exec, -1
L_sf_169:
L_g_df_168:
    s_add_u32 s68, s68, 4
    s_cmp_gt_u32 s66, s60
    s_cbranch_scc1 L_g_g1r_146
L_g_tail_149:
    s_cmp_lt_u32 s60, s75
    s_cbranch_scc1 L_g_restart_144
    s_waitcnt vmcnt(0)
    s_barrier
    s_branch L_c_done_1
L_g_dp_159_l:
    s_cmp_ge_u32 s62, s66
    s_cbranch_scc1 L_g_dp_159_d
    s_mov_b32 s65, 1
    s_add_u32 s47, s61, 4096
    s_mov_b32 m0, s64
    s_add_u32 s62, s62, 1
    buffer_load_dwordx4 v3, s[12:15], s61 offen offset:0 sc1 lds
    buffer_load_dwordx4 v3, s[12:15], s61 offen offset:1024 sc1 lds
    buffer_load_dwordx4 v3, s[12:15], s61 offen offset:2048 sc1 lds
    buffer_load_dwordx4 v3, s[12:15], s61 offen offset:3072 sc1 lds
    s_add_u32 m0, s64, 4096
    s_add_u32 s61, s61, 262144
    buffer_load_dwordx4 v3, s[12:15], s47 offen offset:0 sc1 lds
    buffer_load_dwordx4 v3, s[12:15], s47 offen offset:1024 sc1 lds
    buffer_load_dwordx4 v3, s[12:15], s47 offen offset:2048 sc1 lds
    buffer_load_dwordx4 v3, s[12:15], s47 offen offset:3072 sc1 lds
    s_xor_b32 s64, s64, 0x10000
    s_branch L_g_dp_159_a
L_g_nw_157:
    s_waitcnt vmcnt(0) lgkmcnt(0)
    s_cmp_lg_u32 s44, 0
    s_cbranch_scc1 L_g_nl_170
    s_add_u32 s54, s60, 1
    v_add_u32 v12, s54, v113
    v_and_b32 v13, 3, v12
    v_lshl_add_u32 v13, v13, 7, v7
    buffer_load_dword v11, v13, s[12:15], 0 offen sc1
L_g_nl_170:
    s_branch L_g_loop0_147_l
L_g_nfl_161:
    s_cmp_eq_u32 s71, 0
    s_cbranch_scc1 L_g_nfl_161_d
    v_mov_b32 v10, 1
    s_mov_b64 exec, 1
    s_waitcnt vmcnt(0)
    ds_add_rtn_u32 v10, v15, v10 offset:4
    s_waitcnt lgkmcnt(0)
    v_readfirstlane_b32 s46, v10
    s_mov_b64 exec, -1
    s_mov_b32 s71, 0
    s_sub_u32 s59, s60, 1
    s_cmp_lg_u32 s46, s68
    s_cbranch_scc1 L_g_df_171
    v_mov_b32 v10, s59
    v_add_u32 v10, 1, v10
    v_mov_b32 v11, 0
    s_mov_b64 exec, 1
    buffer_store_dword v10, v11, s[12:15], s52 offen sc1
    s_mov_b64 exec, -1
L_sf_172:
L_g_df_171:
    s_add_u32 s68, s68, 4
    s_mov_b32 s65, 2
    s_branch L_g_nfl_161_d
L_g_dp_166_l:
    s_cmp_ge_u32 s62, s66
    s_cbranch_scc1 L_g_dp_166_d
    s_or_b32 s65, s65, 1
    s_add_u32 s47, s61, 4096
    s_mov_b32 m0, s64
    s_add_u32 s62, s62, 1
    buffer_load_dwordx4 v3, s[12:15], s61 offen offset:0 sc1 lds
    buffer_load_dwordx4 v3, s[12:15], s61 offen offset:1024 sc1 lds
    buffer_load_dwordx4 v3, s[12:15], s61 offen offset:2048 sc1 lds
    buffer_load_dwordx4 v3, s[12:15], s61 offen offset:3072 sc1 lds
    s_add_u32 m0, s64, 4096
    s_add_u32 s61, s61, 262144
    buffer_load_dwordx4 v3, s[12:15], s47 offen offset:0 sc1 lds
    buffer_load_dwordx4 v3, s[12:15], s47 offen offset:1024 sc1 lds
    buffer_load_dwordx4 v3, s[12:15], s47 offen offset:2048 sc1 lds
    buffer_load_dwordx4 v3, s[12:15], s47 offen offset:3072 sc1 lds
    s_xor_b32 s64, s64, 0x10000
    s_branch L_g_dp_166_a
L_g_nw1_163:
    s_cmp_eq_u32 s65, 2
    s_cbranch_scc1 L_g_nw1_163_w
    s_waitcnt vmcnt(0)
L_g_nw1_163_w:
    s_barrier
    ds_read_b128 v[32:35], v4 offset:0
    ds_read_b128 v[36:39], v4 offset:256
    ds_read_b128 v[40:43], v4 offset:2048
    ds_read_b128 v[44:47], v4 offset:2304
    ds_read_b128 v[48:51], v4 offset:4096
    ds_read_b128 v[52:55], v4 offset:4352
    ds_read_b128 v[56:59], v4 offset:6144
    ds_read_b128 v[60:63], v4 offset:6400
    s_branch L_g_jn_165
L_c_chain_9:
    v_mov_b32 v4, 0
    v_mov_b32 v5, 0
    v_mov_b32 v6, 0
    v_mov_b32 v7, 0
    v_mov_b32 v8, 0
    v_mov_b32 v9, 0
    v_mov_b32 v10, 0
    v_mov_b32 v11, 0
    v_mov_b32 v12, 0
    v_mov_b32 v13, 0
    v_mov_b32 v14, 0
    v_mov_b32 v15, 0
    v_mov_b32 v32, -1
    v_mov_b32 v33, -1
    v_mov_b32 v34, -1
    v_mov_b32 v35, -1
    v_lshlrev_b32 v2, 4, v1
    s_lshl_b32 s45, s40, 16
    s_lshl_b32 s46, s41, 12
    s_add_u32 s45, s45, s46
    s_and_b32 s46, s44, 3
    s_lshl_b32 s46, s46, 10
    s_add_u32 s45, s45, s46
    s_lshr_b32 s46, s44, 2
    s_lshl_b32 s46, s46, 19
    s_add_u32 s45, s45, s46
    s_add_u32 s45, s45, 0x7000000
    buffer_store_dwordx4 v[32:35], v2, s[12:15], s45 offen sc1
    s_lshl_b32 s45, s40, 15
    s_lshl_b32 s46, s41, 11
    s_add_u32 s45, s45, s46
    s_lshl_b32 s46, s44, 8
    s_add_u32 s45, s45, s46
    s_add_u32 s45, s45, 0x7100000
    s_mov_b64 exec, 0xffff
    buffer_store_dwordx4 v[32:35], v2, s[12:15], s45 offen sc1
    s_lshl_b32 s45, s40, 16
    s_lshl_b32 s46, s41, 8
    s_add_u32 s45, s45, s46
    s_and_b32 s46, s44, 3
    s_lshl_b32 s46, s46, 14
    s_add_u32 s45, s45, s46
    s_add_u32 s45, s45, 0x7180000
    buffer_store_dwordx4 v[32:35], v2, s[12:15], s45 offen sc1
    s_mov_b64 exec, -1
    v_lshlrev_b32 v2, 4, v1
    v_and_b32 v3, 8, v1
    v_cmp_eq_u32 vcc, 0, v3
    v_mov_b32 v3, 0xeeeeeeee
    v_mov_b32 v4, 0x44444444
    v_cndmask_b32 v3, v3, v4, vcc
    v_and_b32 v100, 15, v1
    v_lshrrev_b32 v101, 4, v1
    v_and_b32 v102, 1, v101
    v_lshrrev_b32 v103, 1, v101
    v_lshlrev_b32 v104, 2, v102
    v_lshl_add_u32 v104, v103, 1, v104
    v_and_b32 v105, 1, v1
    v_add_u32 v104, v104, v105
    v_and_b32 v106, 7, v1
    v_bfe_u32 v107, v1, 3, 1
    s_lshr_b32 s42, s41, 2
    s_and_b32 s43, s41, 3
    s_lshl_b32 s49, s40, 2
    s_add_u32 s49, s49, s42
    s_lshl_b32 s45, s44, 14
    v_lshlrev_b32 v22, 3, v101
    v_bfe_u32 v23, v1, 2, 2
    v_add_u32 v22, v22, v23
    v_and_b32 v23, 3, v1
    v_lshlrev_b32 v24, 3, v23
    v_lshl_add_u32 v20, v22, 6, v24
    v_lshl_add_u32 v21, v22, 7, v24
    v_lshrrev_b32 v22, 2, v1
    v_lshlrev_b32 v23, 4, v23
    v_lshl_add_u32 v24, v22, 13, v23
    v_lshrrev_b32 v22, 3, v1
    v_lshlrev_b32 v23, 4, v106
    v_lshl_add_u32 v25, v22, 11, v23
    s_cmp_ge_u32 s44, 4
    s_cbranch_scc1 L_v_init_173
    s_lshr_b32 s50, s44, 1
    s_and_b32 s51, s44, 1
    s_load_dwordx4 s[4:7], s[0:1], 16
    s_lshl_b32 s46, s49, 8
    s_lshl_b32 s48, s43, 6
    s_add_u32 s46, s46, s48
    s_lshl_b32 s48, s44, 21
    s_add_u32 s46, s46, s48
    s_lshl_b32 s52, s51, 5
    s_xor_b32 s53, s50, 1
    s_lshl_b32 s53, s53, 16
    s_add_u32 s52, s52, s53
    v_add_u32 v20, s52, v20
    s_waitcnt lgkmcnt(0)
    s_mov_b32 s24, s6
    s_and_b32 s25, s7, 0xffff
    s_mov_b32 s26, 0x800000
    s_mov_b32 s27, 0x00020000
    s_mov_b32 s28, s4
    s_and_b32 s29, s5, 0xffff
    s_mov_b32 s30, 0x800000
    s_mov_b32 s31, 0x00020000
    s_lshl_b32 s52, s51, 9
    s_lshl_b32 s53, s50, 7
    s_add_u32 s52, s52, s53
    s_add_u32 s52, s52, 61440
    v_lshlrev_b32 v5, 1, v106
    v_lshl_add_u32 v5, v107, 8, v5
    v_lshl_add_u32 v5, v102, 6, v5
    v_lshl_add_u32 v5, v103, 5, v5
    v_add_u32 v5, s52, v5
    s_lshl_b32 s67, s49, 12
    s_lshl_b32 s53, s43, 10
    s_add_u32 s67, s67, s53
    s_add_u32 s67, s67, 0x1000000
    s_lshl_b32 s52, s40, 16
    s_lshl_b32 s53, s44, 12
    s_add_u32 s53, s52, s53
    s_add_u32 s53, s53, 0x7080000
    v_add_u32 v7, s53, v2
    s_lshl_b32 s53, s44, 10
    s_add_u32 s53, s52, s53
    s_add_u32 s53, s53, 0x7180000
    v_lshlrev_b32 v28, 7, v103
    v_lshl_add_u32 v28, v106, 4, v28
    v_lshl_add_u32 v28, v102, 3, v28
    v_lshl_add_u32 v28, v107, 2, v28
    v_add_u32 v28, s53, v28
    s_lshl_b32 s52, s44, 10
    s_add_u32 s52, s52, 16384
    v_lshlrev_b32 v8, 8, v101
    v_lshl_add_u32 v8, v106, 4, v8
    v_lshl_add_u32 v8, v107, 3, v8
    v_add_u32 v8, s52, v8
    s_lshl_b32 s52, s44, 8
    s_add_u32 s52, s52, 20480
    v_lshlrev_b32 v9, 4, v106
    v_lshl_add_u32 v9, v101, 2, v9
    v_lshl_add_u32 v9, v107, 1, v9
    v_add_u32 v9, s52, v9
    s_mov_b32 s66, 0x3e0293ee
    s_add_u32 m0, s45, 0
    s_add_u32 s48, s46, 0x0
    buffer_load_dwordx4 v24, s[24:27], s48 offen lds
    s_add_u32 m0, s45, 1024
    s_add_u32 s48, s46, 0x20000
    buffer_load_dwordx4 v24, s[24:27], s48 offen lds
    s_add_u32 m0, s45, 2048
    s_add_u32 s48, s46, 0x40000
    buffer_load_dwordx4 v24, s[24:27], s48 offen lds
    s_add_u32 m0, s45, 3072
    s_add_u32 s48, s46, 0x60000
    buffer_load_dwordx4 v24, s[24:27], s48 offen lds
    s_add_u32 m0, s45, 4096
    s_add_u32 s48, s46, 0x80000
    buffer_load_dwordx4 v24, s[24:27], s48 offen lds
    s_add_u32 m0, s45, 5120
    s_add_u32 s48, s46, 0xa0000
    buffer_load_dwordx4 v24, s[24:27], s48 offen lds
    s_add_u32 m0, s45, 6144
    s_add_u32 s48, s46, 0xc0000
    buffer_load_dwordx4 v24, s[24:27], s48 offen lds
    s_add_u32 m0, s45, 7168
    s_add_u32 s48, s46, 0xe0000
    buffer_load_dwordx4 v24, s[24:27], s48 offen lds
    s_add_u32 m0, s45, 8192
    s_add_u32 s48, s46, 0x100000
    buffer_load_dwordx4 v24, s[24:27], s48 offen lds
    s_add_u32 m0, s45, 9216
    s_add_u32 s48, s46, 0x120000
    buffer_load_dwordx4 v24, s[24:27], s48 offen lds
    s_add_u32 m0, s45, 10240
    s_add_u32 s48, s46, 0x140000
    buffer_load_dwordx4 v24, s[24:27], s48 offen lds
    s_add_u32 m0, s45, 11264
    s_add_u32 s48, s46, 0x160000
    buffer_load_dwordx4 v24, s[24:27], s48 offen lds
    s_add_u32 m0, s45, 12288
    s_add_u32 s48, s46, 0x180000
    buffer_load_dwordx4 v24, s[24:27], s48 offen lds
    s_add_u32 m0, s45, 13312
    s_add_u32 s48, s46, 0x1a0000
    buffer_load_dwordx4 v24, s[24:27], s48 offen lds
    s_add_u32 m0, s45, 14336
    s_add_u32 s48, s46, 0x1c0000
    buffer_load_dwordx4 v24, s[24:27], s48 offen lds
    s_add_u32 m0, s45, 15360
    s_add_u32 s48, s46, 0x1e0000
    buffer_load_dwordx4 v24, s[24:27], s48 offen lds
    s_add_u32 s45, s45, 0x10000
    s_add_u32 m0, s45, 0
    s_add_u32 s48, s46, 0x0
    buffer_load_dwordx4 v24, s[28:31], s48 offen lds
    s_add_u32 m0, s45, 1024
    s_add_u32 s48, s46, 0x20000
    buffer_load_dwordx4 v24, s[28:31], s48 offen lds
    s_add_u32 m0, s45, 2048
    s_add_u32 s48, s46, 0x40000
    buffer_load_dwordx4 v24, s[28:31], s48 offen lds
    s_add_u32 m0, s45, 3072
    s_add_u32 s48, s46, 0x60000
    buffer_load_dwordx4 v24, s[28:31], s48 offen lds
    s_add_u32 m0, s45, 4096
    s_add_u32 s48, s46, 0x80000
    buffer_load_dwordx4 v24, s[28:31], s48 offen lds
    s_add_u32 m0, s45, 5120
    s_add_u32 s48, s46, 0xa0000
    buffer_load_dwordx4 v24, s[28:31], s48 offen lds
    s_add_u32 m0, s45, 6144
    s_add_u32 s48, s46, 0xc0000
    buffer_load_dwordx4 v24, s[28:31], s48 offen lds
    s_add_u32 m0, s45, 7168
    s_add_u32 s48, s46, 0xe0000
    buffer_load_dwordx4 v24, s[28:31], s48 offen lds
    s_add_u32 m0, s45, 8192
    s_add_u32 s48, s46, 0x100000
    buffer_load_dwordx4 v24, s[28:31], s48 offen lds
    s_add_u32 m0, s45, 9216
    s_add_u32 s48, s46, 0x120000
    buffer_load_dwordx4 v24, s[28:31], s48 offen lds
    s_add_u32 m0, s45, 10240
    s_add_u32 s48, s46, 0x140000
    buffer_load_dwordx4 v24, s[28:31], s48 offen lds
    s_add_u32 m0, s45, 11264
    s_add_u32 s48, s46, 0x160000
    buffer_load_dwordx4 v24, s[28:31], s48 offen lds
    s_add_u32 m0, s45, 12288
    s_add_u32 s48, s46, 0x180000
    buffer_load_dwordx4 v24, s[28:31], s48 offen lds
    s_add_u32 m0, s45, 13312
    s_add_u32 s48, s46, 0x1a0000
    buffer_load_dwordx4 v24, s[28:31], s48 offen lds
    s_add_u32 m0, s45, 14336
    s_add_u32 s48, s46, 0x1c0000
    buffer_load_dwordx4 v24, s[28:31], s48 offen lds
    s_add_u32 m0, s45, 15360
    s_add_u32 s48, s46, 0x1e0000
    buffer_load_dwordx4 v24, s[28:31], s48 offen lds
    s_add_u32 s45, s45, 0x10000
    s_waitcnt vmcnt(0)
    s_barrier
    s_cmp_lg_u32 s44, 0
    s_cbranch_scc1 L_zwok_176
    v_and_b32 v16, 7, v1
    v_lshlrev_b32 v16, 5, v16
    s_mov_b32 s70, 0
L_zw_175:
    buffer_load_dword v17, v16, s[16:19], 0 offen sc1
    s_waitcnt vmcnt(0)
    v_add_u32_dpp v17, v17, v17 row_ror:1 row_mask:0xf bank_mask:0xf
    s_nop 1
    v_add_u32_dpp v17, v17, v17 row_ror:2 row_mask:0xf bank_mask:0xf
    s_nop 1
    v_add_u32_dpp v17, v17, v17 row_ror:4 row_mask:0xf bank_mask:0xf
    v_cmp_ne_u32 vcc, 0x100, v17
    s_add_u32 s70, s70, 1
    s_cbranch_vccz L_zwok_176
    s_sleep 4
    s_cmp_lt_u32 s70, 524288
    s_cbranch_scc1 L_zw_175
    s_branch L_c_done_1
L_zwok_176:
    s_cmp_lg_u32 s44, 0
    s_cbranch_scc1 L_c_nr_177
    s_or_b32 s47, s39, 0x100
    v_mov_b32 v16, s47
    s_lshl_b32 s52, s40, 6
    s_lshl_b32 s53, s41, 2
    s_add_u32 s52, s52, s53
    s_add_u32 s52, s52, 0x101000
    v_mov_b32 v17, 0
    s_mov_b64 exec, 1
    buffer_store_dword v16, v17, s[12:15], s52 offen sc1
    s_mov_b64 exec, -1
L_c_nr_177:
    ds_read_b64_tr_b16 a[0:1], v20 offset:0
    ds_read_b64_tr_b16 a[2:3], v20 offset:256
    ds_read_b64_tr_b16 a[4:5], v20 offset:2048
    ds_read_b64_tr_b16 a[6:7], v20 offset:2304
    ds_read_b64_tr_b16 a[8:9], v20 offset:4096
    ds_read_b64_tr_b16 a[10:11], v20 offset:4352
    ds_read_b64_tr_b16 a[12:13], v20 offset:6144
    ds_read_b64_tr_b16 a[14:15], v20 offset:6400
    s_waitcnt lgkmcnt(0)
    ds_read_b64_tr_b16 a[16:17], v20 offset:8192
    ds_read_b64_tr_b16 a[18:19], v20 offset:8448
    ds_read_b64_tr_b16 a[20:21], v20 offset:10240
    ds_read_b64_tr_b16 a[22:23], v20 offset:10496
    ds_read_b64_tr_b16 a[24:25], v20 offset:12288
    ds_read_b64_tr_b16 a[26:27], v20 offset:12544
    ds_read_b64_tr_b16 a[28:29], v20 offset:14336
    ds_read_b64_tr_b16 a[30:31], v20 offset:14592
    s_waitcnt lgkmcnt(0)
    ds_read_b64_tr_b16 a[32:33], v20 offset:16384
    ds_read_b64_tr_b16 a[34:35], v20 offset:16640
    ds_read_b64_tr_b16 a[36:37], v20 offset:18432
    ds_read_b64_tr_b16 a[38:39], v20 offset:18688
    ds_read_b64_tr_b16 a[40:41], v20 offset:20480
    ds_read_b64_tr_b16 a[42:43], v20 offset:20736
    ds_read_b64_tr_b16 a[44:45], v20 offset:22528
    ds_read_b64_tr_b16 a[46:47], v20 offset:22784
    s_waitcnt lgkmcnt(0)
    ds_read_b64_tr_b16 a[48:49], v20 offset:24576
    ds_read_b64_tr_b16 a[50:51], v20 offset:24832
    ds_read_b64_tr_b16 a[52:53], v20 offset:26624
    ds_read_b64_tr_b16 a[54:55], v20 offset:26880
    ds_read_b64_tr_b16 a[56:57], v20 offset:28672
    ds_read_b64_tr_b16 a[58:59], v20 offset:28928
    ds_read_b64_tr_b16 a[60:61], v20 offset:30720
    ds_read_b64_tr_b16 a[62:63], v20 offset:30976
    s_waitcnt lgkmcnt(0)
    ds_read_b64_tr_b16 a[64:65], v20 offset:32768
    ds_read_b64_tr_b16 a[66:67], v20 offset:33024
    ds_read_b64_tr_b16 a[68:69], v20 offset:34816
    ds_read_b64_tr_b16 a[70:71], v20 offset:35072
    ds_read_b64_tr_b16 a[72:73], v20 offset:36864
    ds_read_b64_tr_b16 a[74:75], v20 offset:37120
    ds_read_b64_tr_b16 a[76:77], v20 offset:38912
    ds_read_b64_tr_b16 a[78:79], v20 offset:39168
    s_waitcnt lgkmcnt(0)
    ds_read_b64_tr_b16 a[80:81], v20 offset:40960
    ds_read_b64_tr_b16 a[82:83], v20 offset:41216
    ds_read_b64_tr_b16 a[84:85], v20 offset:43008
    ds_read_b64_tr_b16 a[86:87], v20 offset:43264
    ds_read_b64_tr_b16 a[88:89], v20 offset:45056
    ds_read_b64_tr_b16 a[90:91], v20 offset:45312
    ds_read_b64_tr_b16 a[92:93], v20 offset:47104
    ds_read_b64_tr_b16 a[94:95], v20 offset:47360
    s_waitcnt lgkmcnt(0)
    ds_read_b64_tr_b16 a[96:97], v20 offset:49152
    ds_read_b64_tr_b16 a[98:99], v20 offset:49408
    ds_read_b64_tr_b16 a[100:101], v20 offset:51200
    ds_read_b64_tr_b16 a[102:103], v20 offset:51456
    ds_read_b64_tr_b16 a[104:105], v20 offset:53248
    ds_read_b64_tr_b16 a[106:107], v20 offset:53504
    ds_read_b64_tr_b16 a[108:109], v20 offset:55296
    ds_read_b64_tr_b16 a[110:111], v20 offset:55552
    s_waitcnt lgkmcnt(0)
    ds_read_b64_tr_b16 a[112:113], v20 offset:57344
    ds_read_b64_tr_b16 a[114:115], v20 offset:57600
    ds_read_b64_tr_b16 a[116:117], v20 offset:59392
    ds_read_b64_tr_b16 a[118:119], v20 offset:59648
    ds_read_b64_tr_b16 a[120:121], v20 offset:61440
    ds_read_b64_tr_b16 a[122:123], v20 offset:61696
    ds_read_b64_tr_b16 a[124:125], v20 offset:63488
    ds_read_b64_tr_b16 a[126:127], v20 offset:63744
    s_waitcnt lgkmcnt(0)
    s_mov_b32 s63, 0
    s_barrier
    s_lshl_b32 s52, s40, 2
    s_add_u32 s52, s52, s44
    s_mul_i32 s52, s52, 24576
    s_lshl_b32 s53, s41, 9
    s_add_u32 s52, s52, s53
    s_add_u32 s52, s52, 0x2004000
    v_and_b32 v14, 3, v1
    v_lshlrev_b32 v14, 7, v14
    v_add_u32 v14, s52, v14
    s_lshl_b32 s52, s40, 16
    s_lshl_b32 s53, s41, 10
    s_add_u32 s53, s53, s52
    s_lshl_b32 s54, s44, 7
    s_add_u32 s53, s53, s54
    s_add_u32 s53, s53, 0x7080000
    v_lshlrev_b32 v4, 4, v106
    v_lshl_add_u32 v10, v102, 7, v4
    v_lshl_add_u32 v4, v101, 8, v4
    v_add_u32 v4, s53, v4
    s_lshl_b32 s53, s41, 8
    s_add_u32 s53, s53, s52
    s_add_u32 s53, s53, 0x7180000
    v_add_u32 v10, s53, v10
    s_cmp_ge_u32 s44, 2
    s_cselect_b64 vcc, -1, 0
    v_cndmask_b32 v4, v4, v10, vcc
    s_mul_i32 s52, s49, 24576
    s_lshl_b32 s53, s44, 12
    s_add_u32 s52, s52, s53
    s_lshl_b32 s53, s43, 10
    s_add_u32 s52, s52, s53
    s_add_u32 s52, s52, 0x2002000
    v_add_u32 v6, s52, v2
    v_lshrrev_b32 v10, 3, v1
    v_lshlrev_b32 v10, 8, v10
    v_lshl_add_u32 v10, v106, 4, v10
    v_add_u32 v10, 61568, v10
    v_add_u32 v11, 27648, v2
    v_cmp_gt_u32 s[52:53], 32, v1
    s_nop 1
    v_cndmask_b32 v10, v11, v10, s[52:53]
    v_cndmask_b32 v6, v6, v10, vcc
    v_mov_b32 v24, -1
    v_mov_b32 v25, -1
    v_mov_b32 v26, -1
    v_mov_b32 v27, -1
    s_and_b32 s52, s40, 1
    s_lshl_b32 s52, s52, 14
    s_lshl_b32 s53, s41, 10
    s_add_u32 s52, s52, s53
    s_lshl_b32 s53, s50, 9
    s_add_u32 s52, s52, s53
    s_lshl_b32 s53, s51, 7
    s_add_u32 s52, s52, s53
    s_add_u32 s52, s52, 0x800000
    v_mov_b32 v46, s52
    v_add_u32 v44, 65536, v2
    s_lshl_b32 s52, s50, 10
    s_add_u32 s52, s52, 62464
    v_add_u32 v31, s52, v2
    s_lshl_b32 s53, s51, 9
    s_add_u32 s52, s52, s53
    v_lshlrev_b32 v45, 4, v100
    v_lshl_add_u32 v45, v103, 8, v45
    v_lshl_add_u32 v45, v102, 3, v45
    v_add_u32 v45, s52, v45
    s_mul_i32 s52, s49, 24576
    s_lshl_b32 s53, s50, 13
    s_add_u32 s52, s52, s53
    s_lshl_b32 s53, s43, 10
    s_add_u32 s52, s52, s53
    s_add_u32 s52, s52, 0x5000000
    v_add_u32 v13, s52, v2
    v_mov_b32 v29, 26644
    v_mov_b32 v30, 0
    ds_write_b32 v29, v30
    v_mov_b32 v30, 1
    s_lshl_b32 s58, s40, 11
    s_lshl_b32 s53, s44, 7
    s_add_u32 s58, s58, s53
    s_add_u32 s58, s58, 0x10a600
    s_mov_b32 s69, 0
    v_mov_b32 v0, 0
    s_cmp_ge_u32 s44, 2
    s_cselect_b32 s50, 0, 0x00ff00ff
    s_mov_b32 s51, 0x00ff00ff
    s_xor_b32 s45, s44, 2
    s_or_b32 s45, s45, s41
    s_cbranch_scc1 L_c_join_174_p
    s_lshl_b32 s45, s40, 21
    s_add_u32 s45, s45, 0x79c0000
    v_and_b32 v10, 31, v1
    v_lshlrev_b32 v10, 4, v10
    v_lshl_add_u32 v10, v103, 13, v10
    buffer_store_dwordx4 v[24:27], v10, s[12:15], s45 offen sc1
    s_add_u32 s46, s45, 0x1000
    s_load_dword s47, s[22:23], s46
    s_mov_b32 s60, -1
    s_mov_b32 s61, -1
    s_waitcnt vmcnt(0) lgkmcnt(0)
    s_add_u32 s46, s45, 0
    s_memtime s[84:85]
    s_waitcnt lgkmcnt(0)
    s_load_dword s47, s[22:23], s46
    s_waitcnt lgkmcnt(0)
    s_memtime s[86:87]
    s_waitcnt lgkmcnt(0)
    s_sub_u32 s86, s86, s84
    s_min_u32 s60, s60, s86
    s_add_u32 s46, s45, 8192
    s_memtime s[84:85]
    s_waitcnt lgkmcnt(0)
    s_load_dword s47, s[22:23], s46
    s_waitcnt lgkmcnt(0)
    s_memtime s[86:87]
    s_waitcnt lgkmcnt(0)
    s_sub_u32 s86, s86, s84
    s_min_u32 s61, s61, s86
    s_add_u32 s46, s45, 128
    s_memtime s[84:85]
    s_waitcnt lgkmcnt(0)
    s_load_dword s47, s[22:23], s46
    s_waitcnt lgkmcnt(0)
    s_memtime s[86:87]
    s_waitcnt lgkmcnt(0)
    s_sub_u32 s86, s86, s84
    s_min_u32 s60, s60, s86
    s_add_u32 s46, s45, 8320
    s_memtime s[84:85]
    s_waitcnt lgkmcnt(0)
    s_load_dword s47, s[22:23], s46
    s_waitcnt lgkmcnt(0)
    s_memtime s[86:87]
    s_waitcnt lgkmcnt(0)
    s_sub_u32 s86, s86, s84
    s_min_u32 s61, s61, s86
    s_add_u32 s46, s45, 256
    s_memtime s[84:85]
    s_waitcnt lgkmcnt(0)
    s_load_dword s47, s[22:23], s46
    s_waitcnt lgkmcnt(0)
    s_memtime s[86:87]
    s_waitcnt lgkmcnt(0)
    s_sub_u32 s86, s86, s84
    s_min_u32 s60, s60, s86
    s_add_u32 s46, s45, 8448
    s_memtime s[84:85]
    s_waitcnt lgkmcnt(0)
    s_load_dword s47, s[22:23], s46
    s_waitcnt lgkmcnt(0)
    s_memtime s[86:87]
    s_waitcnt lgkmcnt(0)
    s_sub_u32 s86, s86, s84
    s_min_u32 s61, s61, s86
    s_add_u32 s46, s45, 384
    s_memtime s[84:85]
    s_waitcnt lgkmcnt(0)
    s_load_dword s47, s[22:23], s46
    s_waitcnt lgkmcnt(0)
    s_memtime s[86:87]
    s_waitcnt lgkmcnt(0)
    s_sub_u32 s86, s86, s84
    s_min_u32 s60, s60, s86
    s_add_u32 s46, s45, 8576
    s_memtime s[84:85]
    s_waitcnt lgkmcnt(0)
    s_load_dword s47, s[22:23], s46
    s_waitcnt lgkmcnt(0)
    s_memtime s[86:87]
    s_waitcnt lgkmcnt(0)
    s_sub_u32 s86, s86, s84
    s_min_u32 s61, s61, s86
    s_cmp_gt_u32 s60, s61
    s_cselect_b32 s45, 3, 2
    v_mov_b32 v10, s45
    v_mov_b32 v11, 0
    s_lshl_b32 s45, s40, 7
    s_add_u32 s45, s45, 0x101800
    s_mov_b64 exec, 1
    buffer_store_dword v10, v11, s[12:15], s45 offen sc1
    s_mov_b64 exec, -1
L_c_join_174_p:
    s_setprio 1
    s_branch L_c_join_174
L_v_init_173:
    s_sub_u32 s54, s44, 4
    s_lshr_b32 s51, s54, 1
    s_and_b32 s50, s54, 1
    s_load_dwordx4 s[4:7], s[0:1], 32
    s_load_dwordx2 s[8:9], s[0:1], 8
    s_waitcnt lgkmcnt(0)
    s_mov_b32 s24, s4
    s_and_b32 s25, s5, 0xffff
    s_mov_b32 s26, 0x800000
    s_mov_b32 s27, 0x00020000
    s_mov_b32 s28, s6
    s_and_b32 s29, s7, 0xffff
    s_mov_b32 s30, 0x800000
    s_mov_b32 s31, 0x00020000
    s_mov_b32 s32, s8
    s_and_b32 s33, s9, 0xffff
    s_mov_b32 s34, 0x4000
    s_mov_b32 s35, 0x00020000
    s_lshl_b32 s45, s54, 12
    s_add_u32 s45, s45, 0x20000
    v_add_u32 v20, s45, v20
    v_add_u32 v21, s45, v21
    v_add_u32 v22, s45, v2
    s_lshl_b32 s46, s49, 8
    s_lshl_b32 s48, s43, 6
    s_add_u32 s46, s46, s48
    s_lshl_b32 s48, s54, 21
    s_add_u32 s46, s46, s48
    s_add_u32 s48, s46, 0x0
    buffer_load_dwordx4 a[0:3], v24, s[24:27], s48 offen
    s_add_u32 s48, s46, 0x20000
    buffer_load_dwordx4 a[32:35], v24, s[24:27], s48 offen
    s_add_u32 s48, s46, 0x40000
    buffer_load_dwordx4 a[4:7], v24, s[24:27], s48 offen
    s_add_u32 s48, s46, 0x60000
    buffer_load_dwordx4 a[36:39], v24, s[24:27], s48 offen
    s_add_u32 s48, s46, 0x80000
    buffer_load_dwordx4 a[8:11], v24, s[24:27], s48 offen
    s_add_u32 s48, s46, 0xa0000
    buffer_load_dwordx4 a[40:43], v24, s[24:27], s48 offen
    s_add_u32 s48, s46, 0xc0000
    buffer_load_dwordx4 a[12:15], v24, s[24:27], s48 offen
    s_add_u32 s48, s46, 0xe0000
    buffer_load_dwordx4 a[44:47], v24, s[24:27], s48 offen
    s_add_u32 s48, s46, 0x100000
    buffer_load_dwordx4 a[16:19], v24, s[24:27], s48 offen
    s_add_u32 s48, s46, 0x120000
    buffer_load_dwordx4 a[48:51], v24, s[24:27], s48 offen
    s_add_u32 s48, s46, 0x140000
    buffer_load_dwordx4 a[20:23], v24, s[24:27], s48 offen
    s_add_u32 s48, s46, 0x160000
    buffer_load_dwordx4 a[52:55], v24, s[24:27], s48 offen
    s_add_u32 s48, s46, 0x180000
    buffer_load_dwordx4 a[24:27], v24, s[24:27], s48 offen
    s_add_u32 s48, s46, 0x1a0000
    buffer_load_dwordx4 a[56:59], v24, s[24:27], s48 offen
    s_add_u32 s48, s46, 0x1c0000
    buffer_load_dwordx4 a[28:31], v24, s[24:27], s48 offen
    s_add_u32 s48, s46, 0x1e0000
    buffer_load_dwordx4 a[60:63], v24, s[24:27], s48 offen
    s_lshl_b32 s52, s40, 15
    s_lshl_b32 s53, s42, 11
    s_add_u32 s52, s52, s53
    s_lshl_b32 s53, s43, 9
    s_add_u32 s52, s52, s53
    s_lshl_b32 s53, s51, 8
    s_add_u32 s52, s52, s53
    s_add_u32 s52, s52, 0x7100000
    v_bfe_u32 v4, v1, 1, 1
    v_lshlrev_b32 v4, 7, v4
    v_lshl_add_u32 v4, v104, 4, v4
    v_and_b32 v5, 12, v100
    v_add_u32 v4, v4, v5
    v_add_u32 v4, s52, v4
    v_mov_b32 v26, -1
    s_lshl_b32 s52, s51, 5
    s_add_u32 s52, s52, 28160
    v_and_b32 v5, 14, v100
    v_lshlrev_b32 v5, 1, v5
    v_lshl_add_u32 v5, v104, 6, v5
    v_add_u32 v5, s52, v5
    s_lshl_b32 s52, s41, 14
    s_lshl_b32 s53, s54, 11
    s_add_u32 s52, s52, s53
    s_add_u32 s52, s52, 0x7800000
    v_lshlrev_b32 v6, 3, v101
    v_lshl_add_u32 v6, v106, 5, v6
    v_and_b32 v7, 3, v1
    v_lshlrev_b32 v7, 3, v7
    v_bfe_u32 v30, v1, 2, 3
    v_lshl_add_u32 v7, v30, 5, v7
    v_lshl_add_u32 v7, v103, 2, v7
    v_add_u32 v7, s52, v7
    s_lshl_b32 s53, s40, 8
    s_add_u32 s52, s52, s53
    v_add_u32 v6, s52, v6
    v_lshlrev_b32 v30, 4, v100
    v_lshl_add_u32 v30, v101, 18, v30
    v_add_u32 v30, s52, v30
    v_mov_b32 v32, -1
    v_mov_b32 v33, -1
    v_mov_b32 v34, -1
    v_mov_b32 v35, -1
    buffer_store_dwordx4 v[32:35], v30, s[12:15], 0 offen sc1
    s_mov_b32 s53, 8192
    buffer_store_dwordx4 v[32:35], v30, s[12:15], s53 offen sc1
    s_lshl_b32 s55, s40, 16
    s_add_u32 s55, s55, 0x7000000
    s_lshl_b32 s52, s41, 10
    s_lshl_b32 s53, s54, 8
    s_add_u32 s52, s52, s53
    s_add_u32 s52, s52, s55
    v_lshlrev_b32 v8, 2, v1
    v_add_u32 v8, s52, v8
    s_lshl_b32 s53, s54, 12
    v_add_u32 v10, s53, v2
    v_add_u32 v9, s55, v10
    s_lshl_b32 s52, s40, 15
    s_lshl_b32 s53, s54, 11
    s_add_u32 s52, s52, s53
    s_add_u32 s52, s52, 0x7100000
    v_add_u32 v11, s52, v2
    s_lshl_b32 s52, s54, 9
    s_add_u32 s52, s52, 53248
    v_lshlrev_b32 v12, 4, v100
    v_lshl_add_u32 v12, v102, 3, v12
    v_lshl_add_u32 v12, v103, 8, v12
    v_add_u32 v12, s52, v12
    s_lshl_b32 s52, s51, 3
    s_add_u32 s52, s52, 49152
    v_add_u32 v13, s52, v2
    s_lshl_b32 s52, s54, 10
    s_add_u32 s52, s52, 49152
    v_add_u32 v14, s52, v2
    s_lshl_b32 s52, s40, 2
    s_add_u32 s52, s52, s54
    s_mul_i32 s52, s52, 24576
    s_add_u32 s52, s52, 0x2004000
    v_add_u32 v15, s52, v2
    s_lshl_b32 s52, s54, 10
    v_add_u32 v27, s52, v2
    v_lshlrev_b32 v30, 11, v106
    v_lshl_add_u32 v30, v101, 5, v30
    v_lshl_add_u32 v30, v107, 2, v30
    s_lshl_b32 s52, s54, 9
    buffer_load_dword v112, v30, s[32:35], s52 offen offset:0
    buffer_load_dword v113, v30, s[32:35], s52 offen offset:8
    buffer_load_dword v114, v30, s[32:35], s52 offen offset:16
    buffer_load_dword v115, v30, s[32:35], s52 offen offset:24
    buffer_load_dword v116, v30, s[32:35], s52 offen offset:128
    buffer_load_dword v117, v30, s[32:35], s52 offen offset:136
    buffer_load_dword v118, v30, s[32:35], s52 offen offset:144
    buffer_load_dword v119, v30, s[32:35], s52 offen offset:152
    buffer_load_dword v120, v30, s[32:35], s52 offen offset:256
    buffer_load_dword v121, v30, s[32:35], s52 offen offset:264
    buffer_load_dword v122, v30, s[32:35], s52 offen offset:272
    buffer_load_dword v123, v30, s[32:35], s52 offen offset:280
    buffer_load_dword v124, v30, s[32:35], s52 offen offset:384
    buffer_load_dword v125, v30, s[32:35], s52 offen offset:392
    buffer_load_dword v126, v30, s[32:35], s52 offen offset:400
    buffer_load_dword v127, v30, s[32:35], s52 offen offset:408
    s_lshl_b32 s46, s40, 2
    s_add_u32 s46, s46, s54
    s_lshl_b32 s46, s46, 18
    s_lshl_b32 s48, s41, 7
    s_add_u32 s46, s46, s48
    s_add_u32 s48, s46, 0x0
    buffer_load_dwordx4 a[64:67], v25, s[28:31], s48 offen
    s_add_u32 s48, s46, 0x4000
    buffer_load_dwordx4 a[80:83], v25, s[28:31], s48 offen
    s_add_u32 s48, s46, 0x8000
    buffer_load_dwordx4 a[96:99], v25, s[28:31], s48 offen
    s_add_u32 s48, s46, 0xc000
    buffer_load_dwordx4 a[112:115], v25, s[28:31], s48 offen
    s_add_u32 s48, s46, 0x10000
    buffer_load_dwordx4 a[68:71], v25, s[28:31], s48 offen
    s_add_u32 s48, s46, 0x14000
    buffer_load_dwordx4 a[84:87], v25, s[28:31], s48 offen
    s_add_u32 s48, s46, 0x18000
    buffer_load_dwordx4 a[100:103], v25, s[28:31], s48 offen
    s_add_u32 s48, s46, 0x1c000
    buffer_load_dwordx4 a[116:119], v25, s[28:31], s48 offen
    s_add_u32 s48, s46, 0x20000
    buffer_load_dwordx4 a[72:75], v25, s[28:31], s48 offen
    s_add_u32 s48, s46, 0x24000
    buffer_load_dwordx4 a[88:91], v25, s[28:31], s48 offen
    s_add_u32 s48, s46, 0x28000
    buffer_load_dwordx4 a[104:107], v25, s[28:31], s48 offen
    s_add_u32 s48, s46, 0x2c000
    buffer_load_dwordx4 a[120:123], v25, s[28:31], s48 offen
    s_add_u32 s48, s46, 0x30000
    buffer_load_dwordx4 a[76:79], v25, s[28:31], s48 offen
    s_add_u32 s48, s46, 0x34000
    buffer_load_dwordx4 a[92:95], v25, s[28:31], s48 offen
    s_add_u32 s48, s46, 0x38000
    buffer_load_dwordx4 a[108:111], v25, s[28:31], s48 offen
    s_add_u32 s48, s46, 0x3c000
    buffer_load_dwordx4 a[124:127], v25, s[28:31], s48 offen
    s_waitcnt vmcnt(16)
    ds_write_b128 v22, a[0:3] offset:0
    ds_write_b128 v22, a[32:35] offset:1024
    ds_write_b128 v22, a[4:7] offset:2048
    ds_write_b128 v22, a[36:39] offset:3072
    s_waitcnt lgkmcnt(0)
    ds_read_b64_tr_b16 a[0:1], v20 offset:0
    ds_read_b64_tr_b16 a[2:3], v20 offset:256
    ds_read_b64_tr_b16 a[32:33], v20 offset:32
    ds_read_b64_tr_b16 a[34:35], v20 offset:288
    ds_read_b64_tr_b16 a[4:5], v20 offset:2048
    ds_read_b64_tr_b16 a[6:7], v20 offset:2304
    ds_read_b64_tr_b16 a[36:37], v20 offset:2080
    ds_read_b64_tr_b16 a[38:39], v20 offset:2336
    s_waitcnt lgkmcnt(0)
    ds_write_b128 v22, a[8:11] offset:0
    ds_write_b128 v22, a[40:43] offset:1024
    ds_write_b128 v22, a[12:15] offset:2048
    ds_write_b128 v22, a[44:47] offset:3072
    s_waitcnt lgkmcnt(0)
    ds_read_b64_tr_b16 a[8:9], v20 offset:0
    ds_read_b64_tr_b16 a[10:11], v20 offset:256
    ds_read_b64_tr_b16 a[40:41], v20 offset:32
    ds_read_b64_tr_b16 a[42:43], v20 offset:288
    ds_read_b64_tr_b16 a[12:13], v20 offset:2048
    ds_read_b64_tr_b16 a[14:15], v20 offset:2304
    ds_read_b64_tr_b16 a[44:45], v20 offset:2080
    ds_read_b64_tr_b16 a[46:47], v20 offset:2336
    s_waitcnt lgkmcnt(0)
    ds_write_b128 v22, a[16:19] offset:0
    ds_write_b128 v22, a[48:51] offset:1024
    ds_write_b128 v22, a[20:23] offset:2048
    ds_write_b128 v22, a[52:55] offset:3072
    s_waitcnt lgkmcnt(0)
    ds_read_b64_tr_b16 a[16:17], v20 offset:0
    ds_read_b64_tr_b16 a[18:19], v20 offset:256
    ds_read_b64_tr_b16 a[48:49], v20 offset:32
    ds_read_b64_tr_b16 a[50:51], v20 offset:288
    ds_read_b64_tr_b16 a[20:21], v20 offset:2048
    ds_read_b64_tr_b16 a[22:23], v20 offset:2304
    ds_read_b64_tr_b16 a[52:53], v20 offset:2080
    ds_read_b64_tr_b16 a[54:55], v20 offset:2336
    s_waitcnt lgkmcnt(0)
    ds_write_b128 v22, a[24:27] offset:0
    ds_write_b128 v22, a[56:59] offset:1024
    ds_write_b128 v22, a[28:31] offset:2048
    ds_write_b128 v22, a[60:63] offset:3072
    s_waitcnt lgkmcnt(0)
    ds_read_b64_tr_b16 a[24:25], v20 offset:0
    ds_read_b64_tr_b16 a[26:27], v20 offset:256
    ds_read_b64_tr_b16 a[56:57], v20 offset:32
    ds_read_b64_tr_b16 a[58:59], v20 offset:288
    ds_read_b64_tr_b16 a[28:29], v20 offset:2048
    ds_read_b64_tr_b16 a[30:31], v20 offset:2304
    ds_read_b64_tr_b16 a[60:61], v20 offset:2080
    ds_read_b64_tr_b16 a[62:63], v20 offset:2336
    s_waitcnt lgkmcnt(0)
    s_barrier
    s_waitcnt vmcnt(0)
    ds_write_b128 v22, a[64:67] offset:0
    ds_write_b128 v22, a[80:83] offset:1024
    ds_write_b128 v22, a[96:99] offset:2048
    ds_write_b128 v22, a[112:115] offset:3072
    s_waitcnt lgkmcnt(0)
    ds_read_b64_tr_b16 a[64:65], v21 offset:0
    ds_read_b64_tr_b16 a[66:67], v21 offset:512
    ds_read_b64_tr_b16 a[80:81], v21 offset:32
    ds_read_b64_tr_b16 a[82:83], v21 offset:544
    ds_read_b64_tr_b16 a[96:97], v21 offset:64
    ds_read_b64_tr_b16 a[98:99], v21 offset:576
    ds_read_b64_tr_b16 a[112:113], v21 offset:96
    ds_read_b64_tr_b16 a[114:115], v21 offset:608
    s_waitcnt lgkmcnt(0)
    ds_write_b128 v22, a[68:71] offset:0
    ds_write_b128 v22, a[84:87] offset:1024
    ds_write_b128 v22, a[100:103] offset:2048
    ds_write_b128 v22, a[116:119] offset:3072
    s_waitcnt lgkmcnt(0)
    ds_read_b64_tr_b16 a[68:69], v21 offset:0
    ds_read_b64_tr_b16 a[70:71], v21 offset:512
    ds_read_b64_tr_b16 a[84:85], v21 offset:32
    ds_read_b64_tr_b16 a[86:87], v21 offset:544
    ds_read_b64_tr_b16 a[100:101], v21 offset:64
    ds_read_b64_tr_b16 a[102:103], v21 offset:576
    ds_read_b64_tr_b16 a[116:117], v21 offset:96
    ds_read_b64_tr_b16 a[118:119], v21 offset:608
    s_waitcnt lgkmcnt(0)
    ds_write_b128 v22, a[72:75] offset:0
    ds_write_b128 v22, a[88:91] offset:1024
    ds_write_b128 v22, a[104:107] offset:2048
    ds_write_b128 v22, a[120:123] offset:3072
    s_waitcnt lgkmcnt(0)
    ds_read_b64_tr_b16 a[72:73], v21 offset:0
    ds_read_b64_tr_b16 a[74:75], v21 offset:512
    ds_read_b64_tr_b16 a[88:89], v21 offset:32
    ds_read_b64_tr_b16 a[90:91], v21 offset:544
    ds_read_b64_tr_b16 a[104:105], v21 offset:64
    ds_read_b64_tr_b16 a[106:107], v21 offset:576
    ds_read_b64_tr_b16 a[120:121], v21 offset:96
    ds_read_b64_tr_b16 a[122:123], v21 offset:608
    s_waitcnt lgkmcnt(0)
    ds_write_b128 v22, a[76:79] offset:0
    ds_write_b128 v22, a[92:95] offset:1024
    ds_write_b128 v22, a[108:111] offset:2048
    ds_write_b128 v22, a[124:127] offset:3072
    s_waitcnt lgkmcnt(0)
    ds_read_b64_tr_b16 a[76:77], v21 offset:0
    ds_read_b64_tr_b16 a[78:79], v21 offset:512
    ds_read_b64_tr_b16 a[92:93], v21 offset:32
    ds_read_b64_tr_b16 a[94:95], v21 offset:544
    ds_read_b64_tr_b16 a[108:109], v21 offset:64
    ds_read_b64_tr_b16 a[110:111], v21 offset:576
    ds_read_b64_tr_b16 a[124:125], v21 offset:96
    ds_read_b64_tr_b16 a[126:127], v21 offset:608
    s_waitcnt lgkmcnt(0)
    s_mov_b32 s65, 0
    s_waitcnt vmcnt(0)
    s_barrier
    s_lshl_b32 s57, s40, 11
    s_lshl_b32 s53, s54, 7
    s_add_u32 s57, s57, s53
    s_add_u32 s57, s57, 0x10a600
    s_mov_b32 s69, 0
    s_mov_b32 s68, 0
    s_cmp_gt_u32 s69, s68
    s_cbranch_scc1 L_kv_ok_179
    s_mov_b32 s70, 0
L_kv_lp_178:
    v_and_b32 v22, 1, v1
    v_lshlrev_b32 v22, 9, v22
    buffer_load_dword v23, v22, s[12:15], s57 offen sc1
    s_waitcnt vmcnt(0)
    v_readlane_b32 s69, v23, 0
    v_readlane_b32 s45, v23, 1
    s_add_u32 s70, s70, 1
    s_nop 2
    s_min_u32 s69, s69, s45
    s_cmp_gt_u32 s69, s68
    s_cbranch_scc1 L_kv_ok_179
    s_sleep 4
    s_cmp_lt_u32 s70, 524288
    s_cbranch_scc1 L_kv_lp_178
    s_branch L_c_done_1
L_kv_ok_179:
    v_lshlrev_b32 v28, 9, v101
    v_lshl_add_u32 v28, v100, 4, v28
    s_lshl_b32 s52, s54, 13
    s_add_u32 s52, s52, 0x800000
    v_add_u32 v28, s52, v28
    s_lshl_b32 s59, s54, 12
    s_add_u32 s59, s59, 65536
    v_lshlrev_b32 v31, 4, v100
    v_lshl_add_u32 v31, v103, 8, v31
    v_add_u32 v31, 20480, v31
    s_lshl_b32 s52, s54, 11
    s_add_u32 s52, s52, 53248
    v_add_u32 v25, s52, v2
    v_mov_b32 v29, 26640
    v_mov_b32 v30, 0
    ds_write_b32 v29, v30
    v_mov_b32 v30, 1
    s_mov_b32 s58, 0
    s_mov_b32 s64, 0
    s_add_u32 s46, s65, 4096
    buffer_load_dwordx4 v[32:35], v15, s[12:15], s65 offen offset:0 sc1
    buffer_load_dwordx4 v[48:51], v15, s[12:15], s46 offen offset:0 sc1
    buffer_load_dwordx4 v[36:39], v15, s[12:15], s65 offen offset:1024 sc1
    buffer_load_dwordx4 v[52:55], v15, s[12:15], s46 offen offset:1024 sc1
    buffer_load_dwordx4 v[40:43], v15, s[12:15], s65 offen offset:2048 sc1
    buffer_load_dwordx4 v[56:59], v15, s[12:15], s46 offen offset:2048 sc1
    buffer_load_dwordx4 v[44:47], v15, s[12:15], s65 offen offset:3072 sc1
    buffer_load_dwordx4 v[60:63], v15, s[12:15], s46 offen offset:3072 sc1
    s_add_u32 s65, s65, 786432
    s_waitcnt vmcnt(0)
    v_mfma_f32_16x16x32_bf16 v[64:67], v[32:35], a[64:67], 0
    v_mfma_f32_16x16x32_bf16 v[68:71], v[48:51], a[64:67], 0
    v_mfma_f32_16x16x32_bf16 v[64:67], v[36:39], a[68:71], v[64:67]
    v_mfma_f32_16x16x32_bf16 v[68:71], v[52:55], a[68:71], v[68:71]
    v_mfma_f32_16x16x32_bf16 v[64:67], v[40:43], a[72:75], v[64:67]
    v_mfma_f32_16x16x32_bf16 v[68:71], v[56:59], a[72:75], v[68:71]
    v_mfma_f32_16x16x32_bf16 v[64:67], v[44:47], a[76:79], v[64:67]
    v_mfma_f32_16x16x32_bf16 v[68:71], v[60:63], a[76:79], v[68:71]
    v_mfma_f32_16x16x32_bf16 v[72:75], v[32:35], a[80:83], 0
    v_mfma_f32_16x16x32_bf16 v[76:79], v[48:51], a[80:83], 0
    v_mfma_f32_16x16x32_bf16 v[72:75], v[36:39], a[84:87], v[72:75]
    v_mfma_f32_16x16x32_bf16 v[76:79], v[52:55], a[84:87], v[76:79]
    v_mfma_f32_16x16x32_bf16 v[72:75], v[40:43], a[88:91], v[72:75]
    v_mfma_f32_16x16x32_bf16 v[76:79], v[56:59], a[88:91], v[76:79]
    v_mfma_f32_16x16x32_bf16 v[72:75], v[44:47], a[92:95], v[72:75]
    v_mfma_f32_16x16x32_bf16 v[76:79], v[60:63], a[92:95], v[76:79]
    v_cvt_pk_bf16_f32 v64, v64, v65
    v_cvt_pk_bf16_f32 v65, v66, v67
    v_cvt_pk_bf16_f32 v66, v68, v69
    v_cvt_pk_bf16_f32 v67, v70, v71
    ds_write_b128 v10, v[64:67] offset:32768
    v_mfma_f32_16x16x32_bf16 v[80:83], v[32:35], a[96:99], 0
    v_mfma_f32_16x16x32_bf16 v[84:87], v[48:51], a[96:99], 0
    v_mfma_f32_16x16x32_bf16 v[80:83], v[36:39], a[100:103], v[80:83]
    v_mfma_f32_16x16x32_bf16 v[84:87], v[52:55], a[100:103], v[84:87]
    v_mfma_f32_16x16x32_bf16 v[80:83], v[40:43], a[104:107], v[80:83]
    v_mfma_f32_16x16x32_bf16 v[84:87], v[56:59], a[104:107], v[84:87]
    v_mfma_f32_16x16x32_bf16 v[80:83], v[44:47], a[108:111], v[80:83]
    v_mfma_f32_16x16x32_bf16 v[84:87], v[60:63], a[108:111], v[84:87]
    v_cvt_pk_bf16_f32 v72, v72, v73
    v_cvt_pk_bf16_f32 v73, v74, v75
    v_cvt_pk_bf16_f32 v74, v76, v77
    v_cvt_pk_bf16_f32 v75, v78, v79
    ds_write_b128 v10, v[72:75] offset:33792
    v_mfma_f32_16x16x32_bf16 v[88:91], v[32:35], a[112:115], 0
    v_mfma_f32_16x16x32_bf16 v[92:95], v[48:51], a[112:115], 0
    v_mfma_f32_16x16x32_bf16 v[88:91], v[36:39], a[116:119], v[88:91]
    v_mfma_f32_16x16x32_bf16 v[92:95], v[52:55], a[116:119], v[92:95]
    v_mfma_f32_16x16x32_bf16 v[88:91], v[40:43], a[120:123], v[88:91]
    v_mfma_f32_16x16x32_bf16 v[92:95], v[56:59], a[120:123], v[92:95]
    v_mfma_f32_16x16x32_bf16 v[88:91], v[44:47], a[124:127], v[88:91]
    v_mfma_f32_16x16x32_bf16 v[92:95], v[60:63], a[124:127], v[92:95]
    v_cvt_pk_bf16_f32 v80, v80, v81
    v_cvt_pk_bf16_f32 v81, v82, v83
    v_cvt_pk_bf16_f32 v82, v84, v85
    v_cvt_pk_bf16_f32 v83, v86, v87
    ds_write_b128 v10, v[80:83] offset:34816
    s_nop 2
    v_cvt_pk_bf16_f32 v88, v88, v89
    v_cvt_pk_bf16_f32 v89, v90, v91
    v_cvt_pk_bf16_f32 v90, v92, v93
    v_cvt_pk_bf16_f32 v91, v94, v95
    ds_write_b128 v10, v[88:91] offset:35840
    s_mov_b64 s[66:67], 0
    s_mov_b32 s63, 0
    s_mov_b32 s68, 1
    s_cmp_gt_u32 s69, s68
    s_cbranch_scc1 L_kv_ok_181
    s_mov_b32 s70, 0
L_kv_lp_180:
    v_and_b32 v22, 1, v1
    v_lshlrev_b32 v22, 9, v22
    buffer_load_dword v23, v22, s[12:15], s57 offen sc1
    s_waitcnt vmcnt(0)
    v_readlane_b32 s69, v23, 0
    v_readlane_b32 s45, v23, 1
    s_add_u32 s70, s70, 1
    s_nop 2
    s_min_u32 s69, s69, s45
    s_cmp_gt_u32 s69, s68
    s_cbranch_scc1 L_kv_ok_181
    s_sleep 4
    s_cmp_lt_u32 s70, 524288
    s_cbranch_scc1 L_kv_lp_180
    s_branch L_c_done_1
L_kv_ok_181:
    v_lshrrev_b32 v22, 3, v1
    v_lshlrev_b32 v22, 7, v22
    s_mov_b32 s45, 0x101800
    s_mov_b32 s46, 0
    s_mov_b32 s70, 0
L_spin_182:
    buffer_load_dword v23, v22, s[12:15], s45 offen sc1
    s_waitcnt vmcnt(0)
    v_cmp_ge_u32 vcc, s46, v23
    s_add_u32 s70, s70, 1
    s_cbranch_vccz L_spok_183
    s_sleep 3
    s_cmp_lt_u32 s70, 524288
    s_cbranch_scc1 L_spin_182
    s_branch L_c_done_1
L_spok_183:
    v_cmp_eq_u32 s[66:67], 3, v23
    s_nop 3
    s_bitcmp1_b32 s66, 0
    s_cselect_b32 s63, 8192, 0
    s_waitcnt lgkmcnt(0)
    v_min_u32 v64, -2, v112
    v_min_u32 v65, -2, v113
    v_min_u32 v66, -2, v114
    v_min_u32 v67, -2, v115
    v_min_u32 v68, -2, v116
    v_min_u32 v69, -2, v117
    v_min_u32 v70, -2, v118
    v_min_u32 v71, -2, v119
    v_min_u32 v72, -2, v120
    v_min_u32 v73, -2, v121
    v_min_u32 v74, -2, v122
    v_min_u32 v75, -2, v123
    v_min_u32 v76, -2, v124
    v_min_u32 v77, -2, v125
    v_min_u32 v78, -2, v126
    v_min_u32 v79, -2, v127
    v_mov_b32 v16, 0
    v_mov_b32 v17, 0
    v_mov_b32 v18, 0
    v_mov_b32 v19, 0
    v_mov_b32 v20, 0
    v_mov_b32 v21, 0
    v_mov_b32 v22, 0
    v_mov_b32 v23, 0
L_c_join_174:
    s_mov_b32 s60, 0
    s_mov_b32 s61, 0
    s_mov_b32 s62, 0
    s_cmp_lg_u32 s44, 0
    s_cbranch_scc1 L_c_nh_184
    v_lshlrev_b32 v17, 3, v1
    s_lshl_b32 s46, s40, 3
    v_mov_b32 v21, s46
    s_mov_b32 s45, 0x101000
    s_mov_b32 s70, 0
L_c_rp_185:
    buffer_load_dwordx2 v[18:19], v17, s[12:15], s45 offen sc1
    buffer_load_dwordx2 v[22:23], v21, s[12:15], s45 offen offset:512 sc1
    s_waitcnt vmcnt(0)
    v_min3_u32 v20, v18, v19, v22
    v_min_u32 v20, v20, v23
    v_cmp_eq_u32 vcc, 0, v20
    s_cbranch_vccnz L_rt_186
    v_cmp_eq_u32 s[52:53], v18, v16
    v_cmp_eq_u32 vcc, v19, v16
    v_cmp_eq_u32 s[54:55], v22, v16
    v_cmp_eq_u32 s[56:57], v23, v16
    s_lshl_b32 s46, s40, 3
    s_nop 3
    s_and_b64 s[52:53], s[52:53], vcc
    s_lshr_b64 s[52:53], s[52:53], s46
    s_and_b32 s52, s52, 0xff
    s_cmp_eq_u32 s52, 0xff
    s_cselect_b32 s52, 1, 0
    v_mov_b32 v16, s52
    v_mov_b32 v17, 26624
    ds_write_b32 v17, v16
L_c_nh_184:
    s_waitcnt lgkmcnt(0)
    s_barrier
    v_mov_b32 v17, 26624
    ds_read_b32 v16, v17
    s_waitcnt lgkmcnt(0)
    v_readfirstlane_b32 s52, v16
    s_nop 3
    s_cmp_ge_u32 s44, 4
    s_cbranch_scc1 L_vf_189
    s_mov_b32 s57, s58
    s_mov_b32 s58, 0
    s_cmp_ge_u32 s44, 2
    s_cbranch_scc1 L_sf_187
    buffer_load_dwordx4 v[32:35], v6, s[12:15], 0 offen sc1
L_sf_187:
    s_cmp_eq_u32 s52, 0
    s_cbranch_scc1 L_ss_188
.p2align 6
L_s_loop_191:
    v_mov_b32 v16, 0
    v_mov_b32 v17, 0
    v_mov_b32 v18, 0
    v_mov_b32 v19, 0
    s_add_u32 s58, s58, 4
    s_mov_b32 s70, 1
    s_waitcnt vmcnt(0)
    s_barrier
    ds_read_b128 v[64:67], v2 offset:0
    ds_read_b128 v[68:71], v2 offset:1024
    ds_read_b128 v[72:75], v2 offset:2048
    ds_read_b128 v[76:79], v2 offset:3072
    ds_read_b128 v[80:83], v2 offset:4096
    ds_read_b128 v[84:87], v2 offset:5120
    ds_read_b128 v[88:91], v2 offset:6144
    ds_read_b128 v[92:95], v2 offset:7168
    ds_read_b128 v[96:99], v2 offset:8192
    ds_read_b128 v[100:103], v2 offset:9216
    ds_read_b128 v[104:107], v2 offset:10240
    ds_read_b128 v[108:111], v2 offset:11264
    s_waitcnt lgkmcnt(11)
    v_smfmac_f32_16x16x64_bf16 v[16:19], v[64:67], a[0:7], v3
    ds_read_b128 v[112:115], v2 offset:12288
    s_waitcnt lgkmcnt(11)
    v_smfmac_f32_16x16x64_bf16 v[16:19], v[68:71], a[8:15], v3
    ds_read_b128 v[116:119], v2 offset:13312
    s_waitcnt lgkmcnt(11)
    v_smfmac_f32_16x16x64_bf16 v[16:19], v[72:75], a[16:23], v3
    ds_read_b128 v[120:123], v2 offset:14336
    s_waitcnt lgkmcnt(11)
    v_smfmac_f32_16x16x64_bf16 v[16:19], v[76:79], a[24:31], v3
    ds_read_b128 v[124:127], v2 offset:15360
    s_waitcnt lgkmcnt(11)
    v_smfmac_f32_16x16x64_bf16 v[16:19], v[80:83], a[32:39], v3
    s_waitcnt lgkmcnt(10)
    v_smfmac_f32_16x16x64_bf16 v[16:19], v[84:87], a[40:47], v3
    s_waitcnt lgkmcnt(9)
    v_smfmac_f32_16x16x64_bf16 v[16:19], v[88:91], a[48:55], v3
    s_waitcnt lgkmcnt(8)
    v_smfmac_f32_16x16x64_bf16 v[16:19], v[92:95], a[56:63], v3
    s_waitcnt lgkmcnt(7)
    v_smfmac_f32_16x16x64_bf16 v[16:19], v[96:99], a[64:71], v3
    s_waitcnt lgkmcnt(6)
    v_smfmac_f32_16x16x64_bf16 v[16:19], v[100:103], a[72:79], v3
    s_waitcnt lgkmcnt(5)
    v_smfmac_f32_16x16x64_bf16 v[16:19], v[104:107], a[80:87], v3
    s_waitcnt lgkmcnt(4)
    v_smfmac_f32_16x16x64_bf16 v[16:19], v[108:111], a[88:95], v3
    s_waitcnt lgkmcnt(3)
    v_smfmac_f32_16x16x64_bf16 v[16:19], v[112:115], a[96:103], v3
    s_waitcnt lgkmcnt(2)
    v_smfmac_f32_16x16x64_bf16 v[16:19], v[116:119], a[104:111], v3
    s_waitcnt lgkmcnt(1)
    v_smfmac_f32_16x16x64_bf16 v[16:19], v[120:123], a[112:119], v3
    s_waitcnt lgkmcnt(0)
    v_smfmac_f32_16x16x64_bf16 v[16:19], v[124:127], a[120:127], v3
    s_nop 7
    v_permlane32_swap_b32 v16, v18
    v_permlane32_swap_b32 v17, v19
    v_add_f32 v16, v16, v18
    v_add_f32 v17, v17, v19
    v_cvt_pk_bf16_f32 v16, v16, v17
    ds_write_b16 v5, v16
    ds_write_b16_d16_hi v5, v16 offset:16
    s_mov_b64 exec, 1
    ds_add_u32 v29, v30
    s_mov_b64 exec, -1
L_s_xl_193:
    ds_read_b32 v10, v29
    ds_read_b128 v[64:67], v2 offset:61440
    s_cmp_eq_u32 s60, 63
    s_cbranch_scc1 L_s_last_192
    s_cmp_ge_u32 s44, 2
    s_cbranch_scc1 L_s_w2_194
    s_waitcnt lgkmcnt(0)
    v_mfma_f32_16x16x32_bf16 v[16:19], v[32:35], v[64:67], 0
L_s_w2_194_b:
    v_cmp_ne_u32 vcc, s58, v10
    s_nop 0
    s_cbranch_vccnz L_rt_196
    s_mov_b64 exec, s[50:51]
    s_nop 3
    v_min_u32 v16, -2, v16
    v_min_u32 v17, -2, v17
    v_min_u32 v18, -2, v18
    v_min_u32 v19, -2, v19
    buffer_store_dwordx4 v[16:19], v4, s[12:15], s61 offen
    s_mov_b64 exec, -1
L_s_w3_195_b:
    s_sleep 5
    s_mov_b32 s70, 1
L_s_xp_197:
    buffer_load_dwordx4 v[64:67], v7, s[12:15], s61 offen offset:0 sc1
    buffer_load_dword v80, v28, s[12:15], s61 offen offset:0 sc1
    buffer_load_dwordx4 v[68:71], v7, s[12:15], s61 offen offset:1024 sc1
    buffer_load_dword v81, v28, s[12:15], s61 offen offset:256 sc1
    buffer_load_dwordx4 v[72:75], v7, s[12:15], s61 offen offset:2048 sc1
    buffer_load_dword v82, v28, s[12:15], s61 offen offset:512 sc1
    buffer_load_dwordx4 v[76:79], v7, s[12:15], s61 offen offset:3072 sc1
    buffer_load_dword v83, v28, s[12:15], s61 offen offset:768 sc1
    s_waitcnt vmcnt(4)
    v_add_f32 v16, v64, v68
    v_add_f32 v17, v65, v69
    v_add_f32 v18, v66, v70
    v_add_f32 v19, v67, v71
    v_add_f32 v20, v80, v81
    s_waitcnt vmcnt(2)
    v_add_f32 v16, v16, v72
    v_add_f32 v17, v17, v73
    v_add_f32 v18, v18, v74
    v_add_f32 v19, v19, v75
    v_add_f32 v20, v20, v82
    s_waitcnt vmcnt(0)
    v_add_f32 v16, v16, v76
    v_add_f32 v17, v17, v77
    v_add_f32 v18, v18, v78
    v_add_f32 v19, v19, v79
    v_add_f32 v20, v20, v83
    v_cmp_u_f32 s[46:47], v16, v17
    v_cmp_u_f32 s[48:49], v18, v19
    v_cmp_u_f32 vcc, v20, v20
    v_max3_f32 v10, v16, v17, v18
    s_or_b64 s[46:47], s[46:47], s[48:49]
    v_max3_f32 v10, v10, v19, v20
    s_or_b64 vcc, vcc, s[46:47]
    s_cbranch_scc1 L_s_xf_198
L_s_xok_199:
    v_max_f32_dpp v11, v10, v10 row_ror:8 row_mask:0xf bank_mask:0xf
    v_max_f32_dpp v10, v10, v10 row_ror:8 row_mask:0xf bank_mask:0xf
    s_nop 1
    v_permlane16_swap_b32 v10, v11
    v_max_f32 v12, v10, v11
    v_max_f32 v10, v10, v11
    s_nop 1
    v_permlane32_swap_b32 v10, v12
    v_max_f32 v10, v10, v12
    v_mul_f32 v10, s66, v10
    v_fma_f32 v16, v16, s66, -v10
    v_fma_f32 v17, v17, s66, -v10
    v_fma_f32 v18, v18, s66, -v10
    v_fma_f32 v19, v19, s66, -v10
    v_fma_f32 v20, v20, s66, -v10
    v_exp_f32 v16, v16
    v_exp_f32 v17, v17
    v_exp_f32 v18, v18
    v_exp_f32 v19, v19
    v_exp_f32 v20, v20
    v_add_f32 v10, v16, v17
    v_add_f32 v11, v18, v19
    v_add_f32 v10, v10, v20
    v_add_f32 v10, v10, v11
    s_nop 1
    v_add_f32_dpp v11, v10, v10 row_ror:8 row_mask:0xf bank_mask:0xf
    v_add_f32_dpp v10, v10, v10 row_ror:8 row_mask:0xf bank_mask:0xf
    s_nop 1
    v_permlane16_swap_b32 v10, v11
    v_add_f32 v12, v10, v11
    v_add_f32 v10, v10, v11
    s_nop 1
    v_permlane32_swap_b32 v10, v12
    v_add_f32 v10, v10, v12
    v_rcp_f32 v10, v10
    s_nop 0
    v_mul_f32 v16, v16, v10
    v_mul_f32 v17, v17, v10
    v_mul_f32 v18, v18, v10
    v_mul_f32 v19, v19, v10
    v_mul_f32 v20, v20, v10
    v_cvt_pk_bf16_f32 v16, v16, v17
    v_cvt_pk_bf16_f32 v17, v18, v19
    v_cvt_pk_bf16_f32 v18, v20, v20
    ds_write_b64 v8, v[16:17]
    ds_write_b16 v9, v18
    s_waitcnt lgkmcnt(0)
    s_barrier
    s_add_u32 s63, s63, 786432
    s_cmp_ge_u32 s44, 2
    s_cbranch_scc1 L_s_nk_200
    buffer_load_dwordx4 v[32:35], v6, s[12:15], s63 offen sc1
L_s_nk_200:
    s_add_u32 s45, s60, 2
    s_cmp_le_u32 s69, s45
    s_cbranch_scc1 L_s_nk_200_w
    s_add_u32 s45, s63, 786432
    s_mov_b64 exec, 0xf
    buffer_load_dword v15, v14, s[12:15], s45 offen sc1
    s_mov_b64 exec, -1
L_s_nk_200_w:
    s_cmp_eq_u32 s44, 3
    s_cbranch_scc1 L_s_nr_201
    s_xor_b32 s45, s61, 0x8000
    s_mov_b64 exec, s[50:51]
    buffer_store_dwordx4 v[24:27], v4, s[12:15], s45 offen
    s_mov_b64 exec, -1
L_s_nr_201:
    s_cmp_lg_u32 s44, 3
    s_cbranch_scc1 L_s_np_202
    ds_read_b128 v[20:23], v6
    s_lshl_b32 s45, s60, 17
    s_add_u32 s45, s45, s67
    s_waitcnt lgkmcnt(0)
    v_min_u32 v20, -2, v20
    v_min_u32 v21, -2, v21
    v_min_u32 v22, -2, v22
    v_min_u32 v23, -2, v23
    buffer_store_dwordx4 v[20:23], v2, s[12:15], s45 offen sc1
L_s_np_202:
    s_add_u32 s68, s60, 2
    s_min_u32 s68, s68, 63
    v_readlane_b32 s45, v0, 0
    v_readlane_b32 s46, v0, 1
    s_nop 0
    s_min_u32 s45, s45, s46
    s_max_u32 s69, s69, s45
    s_cmp_gt_u32 s69, s68
    s_cbranch_scc1 L_kv_ok_205
    s_mov_b32 s70, 0
L_kv_lp_204:
    v_and_b32 v22, 1, v1
    v_lshlrev_b32 v22, 9, v22
    buffer_load_dword v23, v22, s[12:15], s57 offen sc1
    s_waitcnt vmcnt(0)
    v_readlane_b32 s69, v23, 0
    v_readlane_b32 s45, v23, 1
    s_add_u32 s70, s70, 1
    s_nop 2
    s_min_u32 s69, s69, s45
    s_cmp_gt_u32 s69, s68
    s_cbranch_scc1 L_kv_ok_205
    s_sleep 4
    s_cmp_lt_u32 s70, 524288
    s_cbranch_scc1 L_kv_lp_204
    s_branch L_c_done_1
L_kv_ok_205:
    s_add_u32 s45, s60, 7
    s_min_u32 s45, s45, 63
    s_cmp_gt_u32 s69, s45
    s_cbranch_scc1 L_s_na_203
    v_and_b32 v22, 1, v1
    v_lshlrev_b32 v22, 9, v22
    buffer_load_dword v0, v22, s[12:15], s57 offen sc1
L_s_na_203:
    s_add_u32 s60, s60, 1
    s_add_u32 s61, s61, 0x4000
    s_and_b32 s61, s61, 0xffff
    s_branch L_s_loop_191
L_s_last_192:
    s_waitcnt lgkmcnt(0)
    s_barrier
    s_cmp_lg_u32 s44, 3
    s_cbranch_scc1 L_s_np_206
    ds_read_b128 v[20:23], v6
    s_lshl_b32 s45, s60, 17
    s_add_u32 s45, s45, s67
    s_waitcnt lgkmcnt(0)
    v_min_u32 v20, -2, v20
    v_min_u32 v21, -2, v21
    v_min_u32 v22, -2, v22
    v_min_u32 v23, -2, v23
    buffer_store_dwordx4 v[20:23], v2, s[12:15], s45 offen sc1
L_s_np_206:
    s_branch L_replica
L_rt_186:
    s_add_u32 s70, s70, 1
    s_cmp_lt_u32 s70, 524288
    s_cbranch_scc1 L_c_rp_185
    s_branch L_c_done_1
L_rt_196:
    s_add_u32 s70, s70, 1
    s_cmp_lt_u32 s70, 524288
    s_cbranch_scc1 L_s_xl_193
    s_branch L_c_done_1
L_s_w2_194:
    s_cmp_eq_u32 s44, 3
    s_cbranch_scc1 L_s_w3_195
    s_waitcnt lgkmcnt(0)
    v_mfma_f32_16x16x32_bf16 v[16:19], v[64:67], v[64:67], 0
    s_branch L_s_w2_194_b
L_s_w3_195:
    s_sleep 3
    s_branch L_s_w3_195_b
L_s_xf_198:
    v_max3_u32 v11, v64, v65, v66
    v_max3_u32 v11, v11, v67, v68
    v_max3_u32 v11, v11, v69, v70
    v_max3_u32 v11, v11, v71, v72
    v_max3_u32 v11, v11, v73, v74
    v_max3_u32 v11, v11, v75, v76
    v_max3_u32 v11, v11, v77, v78
    v_max3_u32 v11, v11, v79, v80
    v_max3_u32 v11, v11, v81, v82
    v_max_u32 v11, v11, v83
    v_cmp_eq_u32 vcc, -1, v11
    s_add_u32 s70, s70, 1
    s_cbranch_vccz L_s_xok_199
    s_cmp_lt_u32 s70, 524288
    s_cbranch_scc1 L_s_xp_197
    s_branch L_c_done_1
L_ss_188:
.p2align 6
L_s_loop_207:
    v_mov_b32 v16, 0
    v_mov_b32 v17, 0
    v_mov_b32 v18, 0
    v_mov_b32 v19, 0
    s_add_u32 s58, s58, 4
    s_mov_b32 s70, 1
    s_waitcnt vmcnt(0)
    s_barrier
    ds_read_b128 v[64:67], v2 offset:0
    ds_read_b128 v[68:71], v2 offset:1024
    ds_read_b128 v[72:75], v2 offset:2048
    ds_read_b128 v[76:79], v2 offset:3072
    ds_read_b128 v[80:83], v2 offset:4096
    ds_read_b128 v[84:87], v2 offset:5120
    ds_read_b128 v[88:91], v2 offset:6144
    ds_read_b128 v[92:95], v2 offset:7168
    ds_read_b128 v[96:99], v2 offset:8192
    ds_read_b128 v[100:103], v2 offset:9216
    ds_read_b128 v[104:107], v2 offset:10240
    ds_read_b128 v[108:111], v2 offset:11264
    s_waitcnt lgkmcnt(11)
    v_smfmac_f32_16x16x64_bf16 v[16:19], v[64:67], a[0:7], v3
    ds_read_b128 v[112:115], v2 offset:12288
    s_waitcnt lgkmcnt(11)
    v_smfmac_f32_16x16x64_bf16 v[16:19], v[68:71], a[8:15], v3
    ds_read_b128 v[116:119], v2 offset:13312
    s_waitcnt lgkmcnt(11)
    v_smfmac_f32_16x16x64_bf16 v[16:19], v[72:75], a[16:23], v3
    ds_read_b128 v[120:123], v2 offset:14336
    s_waitcnt lgkmcnt(11)
    v_smfmac_f32_16x16x64_bf16 v[16:19], v[76:79], a[24:31], v3
    ds_read_b128 v[124:127], v2 offset:15360
    s_waitcnt lgkmcnt(11)
    v_smfmac_f32_16x16x64_bf16 v[16:19], v[80:83], a[32:39], v3
    s_waitcnt lgkmcnt(10)
    v_smfmac_f32_16x16x64_bf16 v[16:19], v[84:87], a[40:47], v3
    s_waitcnt lgkmcnt(9)
    v_smfmac_f32_16x16x64_bf16 v[16:19], v[88:91], a[48:55], v3
    s_waitcnt lgkmcnt(8)
    v_smfmac_f32_16x16x64_bf16 v[16:19], v[92:95], a[56:63], v3
    s_waitcnt lgkmcnt(7)
    v_smfmac_f32_16x16x64_bf16 v[16:19], v[96:99], a[64:71], v3
    s_waitcnt lgkmcnt(6)
    v_smfmac_f32_16x16x64_bf16 v[16:19], v[100:103], a[72:79], v3
    s_waitcnt lgkmcnt(5)
    v_smfmac_f32_16x16x64_bf16 v[16:19], v[104:107], a[80:87], v3
    s_waitcnt lgkmcnt(4)
    v_smfmac_f32_16x16x64_bf16 v[16:19], v[108:111], a[88:95], v3
    s_waitcnt lgkmcnt(3)
    v_smfmac_f32_16x16x64_bf16 v[16:19], v[112:115], a[96:103], v3
    s_waitcnt lgkmcnt(2)
    v_smfmac_f32_16x16x64_bf16 v[16:19], v[116:119], a[104:111], v3
    s_waitcnt lgkmcnt(1)
    v_smfmac_f32_16x16x64_bf16 v[16:19], v[120:123], a[112:119], v3
    s_waitcnt lgkmcnt(0)
    v_smfmac_f32_16x16x64_bf16 v[16:19], v[124:127], a[120:127], v3
    s_nop 7
    v_permlane32_swap_b32 v16, v18
    v_permlane32_swap_b32 v17, v19
    v_add_f32 v16, v16, v18
    v_add_f32 v17, v17, v19
    v_cvt_pk_bf16_f32 v16, v16, v17
    ds_write_b16 v5, v16
    ds_write_b16_d16_hi v5, v16 offset:16
    s_mov_b64 exec, 1
    ds_add_u32 v29, v30
    s_mov_b64 exec, -1
L_s_xl_209:
    ds_read_b32 v10, v29
    ds_read_b128 v[64:67], v2 offset:61440
    s_cmp_eq_u32 s60, 63
    s_cbranch_scc1 L_s_last_208
    s_cmp_ge_u32 s44, 2
    s_cbranch_scc1 L_s_w2_210
    s_waitcnt lgkmcnt(0)
    v_mfma_f32_16x16x32_bf16 v[16:19], v[32:35], v[64:67], 0
L_s_w2_210_b:
    v_cmp_ne_u32 vcc, s58, v10
    s_nop 0
    s_cbranch_vccnz L_rt_212
    s_mov_b64 exec, s[50:51]
    s_nop 3
    v_min_u32 v16, -2, v16
    v_min_u32 v17, -2, v17
    v_min_u32 v18, -2, v18
    v_min_u32 v19, -2, v19
    buffer_store_dwordx4 v[16:19], v4, s[12:15], s61 offen sc1
    s_mov_b64 exec, -1
L_s_w3_211_b:
    s_sleep 5
    s_mov_b32 s70, 1
L_s_xp_213:
    buffer_load_dwordx4 v[64:67], v7, s[12:15], s61 offen offset:0 sc1
    buffer_load_dword v80, v28, s[12:15], s61 offen offset:0 sc1
    buffer_load_dwordx4 v[68:71], v7, s[12:15], s61 offen offset:1024 sc1
    buffer_load_dword v81, v28, s[12:15], s61 offen offset:256 sc1
    buffer_load_dwordx4 v[72:75], v7, s[12:15], s61 offen offset:2048 sc1
    buffer_load_dword v82, v28, s[12:15], s61 offen offset:512 sc1
    buffer_load_dwordx4 v[76:79], v7, s[12:15], s61 offen offset:3072 sc1
    buffer_load_dword v83, v28, s[12:15], s61 offen offset:768 sc1
    s_waitcnt vmcnt(4)
    v_add_f32 v16, v64, v68
    v_add_f32 v17, v65, v69
    v_add_f32 v18, v66, v70
    v_add_f32 v19, v67, v71
    v_add_f32 v20, v80, v81
    s_waitcnt vmcnt(2)
    v_add_f32 v16, v16, v72
    v_add_f32 v17, v17, v73
    v_add_f32 v18, v18, v74
    v_add_f32 v19, v19, v75
    v_add_f32 v20, v20, v82
    s_waitcnt vmcnt(0)
    v_add_f32 v16, v16, v76
    v_add_f32 v17, v17, v77
    v_add_f32 v18, v18, v78
    v_add_f32 v19, v19, v79
    v_add_f32 v20, v20, v83
    v_cmp_u_f32 s[46:47], v16, v17
    v_cmp_u_f32 s[48:49], v18, v19
    v_cmp_u_f32 vcc, v20, v20
    v_max3_f32 v10, v16, v17, v18
    s_or_b64 s[46:47], s[46:47], s[48:49]
    v_max3_f32 v10, v10, v19, v20
    s_or_b64 vcc, vcc, s[46:47]
    s_cbranch_scc1 L_s_xf_214
L_s_xok_215:
    v_max_f32_dpp v11, v10, v10 row_ror:8 row_mask:0xf bank_mask:0xf
    v_max_f32_dpp v10, v10, v10 row_ror:8 row_mask:0xf bank_mask:0xf
    s_nop 1
    v_permlane16_swap_b32 v10, v11
    v_max_f32 v12, v10, v11
    v_max_f32 v10, v10, v11
    s_nop 1
    v_permlane32_swap_b32 v10, v12
    v_max_f32 v10, v10, v12
    v_mul_f32 v10, s66, v10
    v_fma_f32 v16, v16, s66, -v10
    v_fma_f32 v17, v17, s66, -v10
    v_fma_f32 v18, v18, s66, -v10
    v_fma_f32 v19, v19, s66, -v10
    v_fma_f32 v20, v20, s66, -v10
    v_exp_f32 v16, v16
    v_exp_f32 v17, v17
    v_exp_f32 v18, v18
    v_exp_f32 v19, v19
    v_exp_f32 v20, v20
    v_add_f32 v10, v16, v17
    v_add_f32 v11, v18, v19
    v_add_f32 v10, v10, v20
    v_add_f32 v10, v10, v11
    s_nop 1
    v_add_f32_dpp v11, v10, v10 row_ror:8 row_mask:0xf bank_mask:0xf
    v_add_f32_dpp v10, v10, v10 row_ror:8 row_mask:0xf bank_mask:0xf
    s_nop 1
    v_permlane16_swap_b32 v10, v11
    v_add_f32 v12, v10, v11
    v_add_f32 v10, v10, v11
    s_nop 1
    v_permlane32_swap_b32 v10, v12
    v_add_f32 v10, v10, v12
    v_rcp_f32 v10, v10
    s_nop 0
    v_mul_f32 v16, v16, v10
    v_mul_f32 v17, v17, v10
    v_mul_f32 v18, v18, v10
    v_mul_f32 v19, v19, v10
    v_mul_f32 v20, v20, v10
    v_cvt_pk_bf16_f32 v16, v16, v17
    v_cvt_pk_bf16_f32 v17, v18, v19
    v_cvt_pk_bf16_f32 v18, v20, v20
    ds_write_b64 v8, v[16:17]
    ds_write_b16 v9, v18
    s_waitcnt lgkmcnt(0)
    s_barrier
    s_add_u32 s63, s63, 786432
    s_cmp_ge_u32 s44, 2
    s_cbranch_scc1 L_s_nk_216
    buffer_load_dwordx4 v[32:35], v6, s[12:15], s63 offen sc1
L_s_nk_216:
    s_add_u32 s45, s60, 2
    s_cmp_le_u32 s69, s45
    s_cbranch_scc1 L_s_nk_216_w
    s_add_u32 s45, s63, 786432
    s_mov_b64 exec, 0xf
    buffer_load_dword v15, v14, s[12:15], s45 offen sc1
    s_mov_b64 exec, -1
L_s_nk_216_w:
    s_cmp_eq_u32 s44, 3
    s_cbranch_scc1 L_s_nr_217
    s_xor_b32 s45, s61, 0x8000
    s_mov_b64 exec, s[50:51]
    buffer_store_dwordx4 v[24:27], v4, s[12:15], s45 offen sc1
    s_mov_b64 exec, -1
L_s_nr_217:
    s_cmp_lg_u32 s44, 3
    s_cbranch_scc1 L_s_np_218
    ds_read_b128 v[20:23], v6
    s_lshl_b32 s45, s60, 17
    s_add_u32 s45, s45, s67
    s_waitcnt lgkmcnt(0)
    v_min_u32 v20, -2, v20
    v_min_u32 v21, -2, v21
    v_min_u32 v22, -2, v22
    v_min_u32 v23, -2, v23
    buffer_store_dwordx4 v[20:23], v2, s[12:15], s45 offen sc1
L_s_np_218:
    s_add_u32 s68, s60, 2
    s_min_u32 s68, s68, 63
    v_readlane_b32 s45, v0, 0
    v_readlane_b32 s46, v0, 1
    s_nop 0
    s_min_u32 s45, s45, s46
    s_max_u32 s69, s69, s45
    s_cmp_gt_u32 s69, s68
    s_cbranch_scc1 L_kv_ok_221
    s_mov_b32 s70, 0
L_kv_lp_220:
    v_and_b32 v22, 1, v1
    v_lshlrev_b32 v22, 9, v22
    buffer_load_dword v23, v22, s[12:15], s57 offen sc1
    s_waitcnt vmcnt(0)
    v_readlane_b32 s69, v23, 0
    v_readlane_b32 s45, v23, 1
    s_add_u32 s70, s70, 1
    s_nop 2
    s_min_u32 s69, s69, s45
    s_cmp_gt_u32 s69, s68
    s_cbranch_scc1 L_kv_ok_221
    s_sleep 4
    s_cmp_lt_u32 s70, 524288
    s_cbranch_scc1 L_kv_lp_220
    s_branch L_c_done_1
L_kv_ok_221:
    s_add_u32 s45, s60, 7
    s_min_u32 s45, s45, 63
    s_cmp_gt_u32 s69, s45
    s_cbranch_scc1 L_s_na_219
    v_and_b32 v22, 1, v1
    v_lshlrev_b32 v22, 9, v22
    buffer_load_dword v0, v22, s[12:15], s57 offen sc1
L_s_na_219:
    s_add_u32 s60, s60, 1
    s_add_u32 s61, s61, 0x4000
    s_and_b32 s61, s61, 0xffff
    s_branch L_s_loop_207
L_s_last_208:
    s_waitcnt lgkmcnt(0)
    s_barrier
    s_cmp_lg_u32 s44, 3
    s_cbranch_scc1 L_s_np_222
    ds_read_b128 v[20:23], v6
    s_lshl_b32 s45, s60, 17
    s_add_u32 s45, s45, s67
    s_waitcnt lgkmcnt(0)
    v_min_u32 v20, -2, v20
    v_min_u32 v21, -2, v21
    v_min_u32 v22, -2, v22
    v_min_u32 v23, -2, v23
    buffer_store_dwordx4 v[20:23], v2, s[12:15], s45 offen sc1
L_s_np_222:
    s_branch L_replica
L_rt_212:
    s_add_u32 s70, s70, 1
    s_cmp_lt_u32 s70, 524288
    s_cbranch_scc1 L_s_xl_209
    s_branch L_c_done_1
L_s_w2_210:
    s_cmp_eq_u32 s44, 3
    s_cbranch_scc1 L_s_w3_211
    s_waitcnt lgkmcnt(0)
    v_mfma_f32_16x16x32_bf16 v[16:19], v[64:67], v[64:67], 0
    s_branch L_s_w2_210_b
L_s_w3_211:
    s_sleep 3
    s_branch L_s_w3_211_b
L_s_xf_214:
    v_max3_u32 v11, v64, v65, v66
    v_max3_u32 v11, v11, v67, v68
    v_max3_u32 v11, v11, v69, v70
    v_max3_u32 v11, v11, v71, v72
    v_max3_u32 v11, v11, v73, v74
    v_max3_u32 v11, v11, v75, v76
    v_max3_u32 v11, v11, v77, v78
    v_max3_u32 v11, v11, v79, v80
    v_max3_u32 v11, v11, v81, v82
    v_max_u32 v11, v11, v83
    v_cmp_eq_u32 vcc, -1, v11
    s_add_u32 s70, s70, 1
    s_cbranch_vccz L_s_xok_215
    s_cmp_lt_u32 s70, 524288
    s_cbranch_scc1 L_s_xp_213
    s_branch L_c_done_1
L_vf_189:
    s_cmp_eq_u32 s52, 0
    s_cbranch_scc1 L_vs_190
    s_mov_b32 s70, 1
    v_mov_b32 v16, 0
    v_mov_b32 v17, 0
    s_branch L_v_l1m_225
.p2align 6
L_v_loop_223:
    s_mov_b32 s70, 1
    buffer_load_dwordx4 v[64:67], v9, s[12:15], s61 offen offset:0 sc1
    buffer_load_dwordx4 v[68:71], v9, s[12:15], s61 offen offset:1024 sc1
    buffer_load_dwordx4 v[72:75], v9, s[12:15], s61 offen offset:2048 sc1
    buffer_load_dwordx4 v[76:79], v9, s[12:15], s61 offen offset:3072 sc1
    v_mov_b32 v16, 0
    v_mov_b32 v17, 0
    v_mov_b32 v18, 0
    v_mov_b32 v19, 0
    v_mov_b32 v20, 0
    v_mov_b32 v21, 0
    v_mov_b32 v22, 0
    v_mov_b32 v23, 0
L_v_l1m_225:
    s_waitcnt vmcnt(3)
    ds_write_b128 v10, v[64:67] offset:0
    v_max3_u32 v24, v64, v65, v66
    v_max_u32 v24, v24, v67
    v_cmp_eq_u32 s[48:49], -1, v24
    s_waitcnt vmcnt(2)
    ds_write_b128 v10, v[68:71] offset:1024
    v_max3_u32 v24, v68, v69, v70
    v_max_u32 v24, v24, v71
    v_cmp_eq_u32 s[50:51], -1, v24
    s_waitcnt vmcnt(1)
    ds_write_b128 v10, v[72:75] offset:2048
    v_max3_u32 v24, v72, v73, v74
    v_max_u32 v24, v24, v75
    v_cmp_eq_u32 s[52:53], -1, v24
    s_waitcnt vmcnt(0)
    ds_write_b128 v10, v[76:79] offset:3072
    v_max3_u32 v24, v76, v77, v78
    v_max_u32 v24, v24, v79
    v_cmp_eq_u32 s[54:55], -1, v24
    s_or_b64 s[46:47], s[48:49], s[50:51]
    s_or_b64 vcc, s[52:53], s[54:55]
    s_or_b64 vcc, vcc, s[46:47]
    s_cbranch_scc1 L_v_l1_224
L_v_l1ok_226:
    s_waitcnt lgkmcnt(0)
    s_barrier
    v_smfmac_f32_16x16x64_bf16 v[16:19], v[64:67], a[0:7], v3
    v_smfmac_f32_16x16x64_bf16 v[20:23], v[64:67], a[32:39], v3
    v_smfmac_f32_16x16x64_bf16 v[16:19], v[68:71], a[8:15], v3
    v_smfmac_f32_16x16x64_bf16 v[20:23], v[68:71], a[40:47], v3
    v_smfmac_f32_16x16x64_bf16 v[16:19], v[72:75], a[16:23], v3
    v_smfmac_f32_16x16x64_bf16 v[20:23], v[72:75], a[48:55], v3
    v_smfmac_f32_16x16x64_bf16 v[16:19], v[76:79], a[24:31], v3
    v_smfmac_f32_16x16x64_bf16 v[20:23], v[76:79], a[56:63], v3
    s_add_u32 s46, s65, 4096
    buffer_load_dwordx4 v[32:35], v15, s[12:15], s65 offen offset:0 sc1
    buffer_load_dwordx4 v[48:51], v15, s[12:15], s46 offen offset:0 sc1
    buffer_load_dwordx4 v[36:39], v15, s[12:15], s65 offen offset:1024 sc1
    buffer_load_dwordx4 v[52:55], v15, s[12:15], s46 offen offset:1024 sc1
    buffer_load_dwordx4 v[40:43], v15, s[12:15], s65 offen offset:2048 sc1
    buffer_load_dwordx4 v[56:59], v15, s[12:15], s46 offen offset:2048 sc1
    buffer_load_dwordx4 v[44:47], v15, s[12:15], s65 offen offset:3072 sc1
    buffer_load_dwordx4 v[60:63], v15, s[12:15], s46 offen offset:3072 sc1
    s_add_u32 s65, s65, 786432
    v_permlane32_swap_b32 v16, v18
    v_permlane32_swap_b32 v17, v19
    v_permlane32_swap_b32 v20, v22
    v_permlane32_swap_b32 v21, v23
    v_add_f32 v16, v16, v18
    v_add_f32 v17, v17, v19
    v_add_f32 v18, v20, v22
    v_add_f32 v19, v21, v23
    ds_write_b128 v14, v[16:19]
    s_mov_b64 exec, 1
    ds_add_u32 v29, v30
    s_mov_b64 exec, -1
    s_add_u32 s58, s58, 4
    s_bitcmp1_b32 s44, 0
    s_cbranch_scc1 L_v_k1_228_c
    s_mov_b32 s70, 0
L_v_rl_229:
    ds_read_b32 v24, v29
    ds_read_b64 v[16:17], v13 offset:0
    ds_read_b64 v[18:19], v13 offset:1024
    ds_read_b64 v[20:21], v13 offset:2048
    ds_read_b64 v[22:23], v13 offset:3072
    s_waitcnt lgkmcnt(2)
    v_cmp_ne_u32 vcc, s58, v24
    v_add_f32 v16, v16, v18
    v_add_f32 v17, v17, v19
    s_waitcnt lgkmcnt(0)
    s_cbranch_vccnz L_rt_230
    v_add_f32 v20, v20, v22
    v_add_f32 v21, v21, v23
    v_add_f32 v16, v16, v20
    v_add_f32 v17, v17, v21
    s_mov_b32 vcc_lo, 0x55555555
    s_mov_b32 vcc_hi, 0x55555555
    v_cndmask_b32_dpp v18, v17, v16, vcc quad_perm:[1,0,3,2] row_mask:0xf bank_mask:0xf
    s_not_b64 vcc, vcc
    v_cndmask_b32_dpp v19, v16, v17, vcc quad_perm:[1,0,3,2] row_mask:0xf bank_mask:0xf
    v_cvt_pk_bf16_f32 v18, v18, v19
    v_min_u32 v18, -2, v18
    buffer_store_dword v18, v4, s[12:15], s62 offen
    ds_write_b32 v5, v18
L_v_k1_228:
    s_cmp_eq_u32 s60, 63
    s_cbranch_scc1 L_v_last_227
    ds_read_b128 v[80:83], v27 offset:32768
    ds_read_b128 v[84:87], v27 offset:36864
    ds_read_b128 v[88:91], v27 offset:40960
    ds_read_b128 v[92:95], v27 offset:45056
    v_mov_b32 v96, 0
    v_mov_b32 v97, 0
    v_mov_b32 v98, 0
    v_mov_b32 v99, 0
    v_mov_b32 v100, 0
    v_mov_b32 v101, 0
    v_mov_b32 v102, 0
    v_mov_b32 v103, 0
    v_mov_b32 v104, 0
    v_mov_b32 v105, 0
    v_mov_b32 v106, 0
    v_mov_b32 v107, 0
    v_mov_b32 v108, 0
    v_mov_b32 v109, 0
    v_mov_b32 v110, 0
    v_mov_b32 v111, 0
    s_bitcmp1_b32 s44, 0
    s_cbranch_scc0 L_v_sv_231
    s_sleep 3
L_v_sv_231:
    s_sleep 4
    s_mov_b32 s70, 1
    buffer_load_dwordx4 v[64:67], v11, s[12:15], s62 offen offset:0 sc1
    buffer_load_dwordx4 v[68:71], v11, s[12:15], s62 offen offset:1024 sc1
L_v_vp_232_m:
    s_waitcnt vmcnt(0)
    v_max3_u32 v20, v64, v65, v66
    v_max3_u32 v20, v20, v67, v68
    v_max3_u32 v20, v20, v69, v70
    v_max_u32 v20, v20, v71
    v_cmp_eq_u32 vcc, -1, v20
    s_cbranch_vccnz L_rt_233
    v_smfmac_f32_16x16x64_bf16 v[96:99], v[64:67], a[64:71], v3
    v_smfmac_f32_16x16x64_bf16 v[96:99], v[68:71], a[72:79], v3
    v_smfmac_f32_16x16x64_bf16 v[100:103], v[64:67], a[80:87], v3
    v_smfmac_f32_16x16x64_bf16 v[100:103], v[68:71], a[88:95], v3
    v_smfmac_f32_16x16x64_bf16 v[104:107], v[64:67], a[96:103], v3
    v_smfmac_f32_16x16x64_bf16 v[104:107], v[68:71], a[104:111], v3
    v_smfmac_f32_16x16x64_bf16 v[108:111], v[64:67], a[112:119], v3
    v_smfmac_f32_16x16x64_bf16 v[108:111], v[68:71], a[120:127], v3
    s_nop 1
    v_cvt_pk_bf16_f32 v96, v96, v97
    v_cvt_pk_bf16_f32 v97, v98, v99
    ds_write_b64 v12, v[96:97] offset:0
    v_cvt_pk_bf16_f32 v100, v100, v101
    v_cvt_pk_bf16_f32 v101, v102, v103
    ds_write_b64 v12, v[100:101] offset:2048
    v_cvt_pk_bf16_f32 v104, v104, v105
    v_cvt_pk_bf16_f32 v105, v106, v107
    ds_write_b64 v12, v[104:105] offset:4096
    v_cvt_pk_bf16_f32 v108, v108, v109
    v_cvt_pk_bf16_f32 v109, v110, v111
    ds_write_b64 v12, v[108:109] offset:6144
    s_waitcnt lgkmcnt(0)
    s_barrier
    ds_read_b128 v[96:99], v2 offset:16384
    ds_read_b128 v[100:103], v2 offset:17408
    ds_read_b128 v[104:107], v2 offset:18432
    ds_read_b128 v[108:111], v2 offset:19456
    ds_read_b128 v[112:115], v31 offset:0
    ds_read_b128 v[116:119], v25 offset:0
    ds_read_b128 v[120:123], v31 offset:512
    ds_read_b128 v[124:127], v25 offset:1024
    s_waitcnt lgkmcnt(7)
    v_mfma_f32_16x16x32_bf16 v[16:19], v[80:83], v[96:99], 0
    s_waitcnt lgkmcnt(6)
    v_mfma_f32_16x16x32_bf16 v[16:19], v[84:87], v[100:103], v[16:19]
    s_waitcnt lgkmcnt(5)
    v_mfma_f32_16x16x32_bf16 v[16:19], v[88:91], v[104:107], v[16:19]
    s_waitcnt lgkmcnt(4)
    v_mfma_f32_16x16x32_bf16 v[16:19], v[92:95], v[108:111], v[16:19]
    s_waitcnt lgkmcnt(2)
    v_mfma_f32_16x16x32_bf16 v[16:19], v[116:119], v[112:115], v[16:19]
    s_waitcnt lgkmcnt(0)
    v_mfma_f32_16x16x32_bf16 v[16:19], v[124:127], v[120:123], v[16:19]
    s_mov_b32 exec_lo, 0x00ff00ff
    s_mov_b32 exec_hi, 0x00ff00ff
    s_nop 5
    v_cvt_pk_bf16_f32 v16, v16, v17
    v_cvt_pk_bf16_f32 v17, v18, v19
    v_min_u32 v16, -2, v16
    v_min_u32 v17, -2, v17
    buffer_store_dwordx2 v[16:17], v6, s[12:15], s63 offen sc1
    s_mov_b64 exec, -1
    s_add_u32 s61, s61, 0x4000
    s_and_b32 s61, s61, 0xffff
    s_mov_b32 s70, 1
    s_sleep 8
    buffer_load_dword v96, v7, s[12:15], s63 offen offset:0 sc1
    buffer_load_dword v97, v7, s[12:15], s63 offen offset:256 sc1
    buffer_load_dword v98, v7, s[12:15], s63 offen offset:512 sc1
    buffer_load_dword v99, v7, s[12:15], s63 offen offset:768 sc1
    buffer_load_dword v100, v7, s[12:15], s63 offen offset:1024 sc1
    buffer_load_dword v101, v7, s[12:15], s63 offen offset:1280 sc1
    buffer_load_dword v102, v7, s[12:15], s63 offen offset:1536 sc1
    buffer_load_dword v103, v7, s[12:15], s63 offen offset:1792 sc1
    v_mfma_f32_16x16x32_bf16 v[64:67], v[32:35], a[64:67], 0
    v_mfma_f32_16x16x32_bf16 v[68:71], v[48:51], a[64:67], 0
    v_mfma_f32_16x16x32_bf16 v[64:67], v[36:39], a[68:71], v[64:67]
    v_mfma_f32_16x16x32_bf16 v[68:71], v[52:55], a[68:71], v[68:71]
    v_mfma_f32_16x16x32_bf16 v[64:67], v[40:43], a[72:75], v[64:67]
    v_mfma_f32_16x16x32_bf16 v[68:71], v[56:59], a[72:75], v[68:71]
    v_mfma_f32_16x16x32_bf16 v[64:67], v[44:47], a[76:79], v[64:67]
    v_mfma_f32_16x16x32_bf16 v[68:71], v[60:63], a[76:79], v[68:71]
    v_mfma_f32_16x16x32_bf16 v[72:75], v[32:35], a[80:83], 0
    v_mfma_f32_16x16x32_bf16 v[76:79], v[48:51], a[80:83], 0
    v_mfma_f32_16x16x32_bf16 v[72:75], v[36:39], a[84:87], v[72:75]
    v_mfma_f32_16x16x32_bf16 v[76:79], v[52:55], a[84:87], v[76:79]
    v_mfma_f32_16x16x32_bf16 v[72:75], v[40:43], a[88:91], v[72:75]
    v_mfma_f32_16x16x32_bf16 v[76:79], v[56:59], a[88:91], v[76:79]
    v_mfma_f32_16x16x32_bf16 v[72:75], v[44:47], a[92:95], v[72:75]
    v_mfma_f32_16x16x32_bf16 v[76:79], v[60:63], a[92:95], v[76:79]
    v_cvt_pk_bf16_f32 v64, v64, v65
    v_cvt_pk_bf16_f32 v65, v66, v67
    v_cvt_pk_bf16_f32 v66, v68, v69
    v_cvt_pk_bf16_f32 v67, v70, v71
    ds_write_b128 v10, v[64:67] offset:32768
    v_mfma_f32_16x16x32_bf16 v[80:83], v[32:35], a[96:99], 0
    v_mfma_f32_16x16x32_bf16 v[84:87], v[48:51], a[96:99], 0
    v_mfma_f32_16x16x32_bf16 v[80:83], v[36:39], a[100:103], v[80:83]
    v_mfma_f32_16x16x32_bf16 v[84:87], v[52:55], a[100:103], v[84:87]
    v_mfma_f32_16x16x32_bf16 v[80:83], v[40:43], a[104:107], v[80:83]
    v_mfma_f32_16x16x32_bf16 v[84:87], v[56:59], a[104:107], v[84:87]
    v_mfma_f32_16x16x32_bf16 v[80:83], v[44:47], a[108:111], v[80:83]
    v_mfma_f32_16x16x32_bf16 v[84:87], v[60:63], a[108:111], v[84:87]
    v_cvt_pk_bf16_f32 v72, v72, v73
    v_cvt_pk_bf16_f32 v73, v74, v75
    v_cvt_pk_bf16_f32 v74, v76, v77
    v_cvt_pk_bf16_f32 v75, v78, v79
    ds_write_b128 v10, v[72:75] offset:33792
L_v_gp_234:
    s_waitcnt vmcnt(7)
    v_lshlrev_b32 v20, 16, v96
    v_and_b32 v21, 0xffff0000, v96
    s_waitcnt vmcnt(6)
    v_lshlrev_b32 v22, 16, v97
    v_and_b32 v23, 0xffff0000, v97
    v_add_f32 v20, v20, v22
    v_add_f32 v21, v21, v23
    s_waitcnt vmcnt(5)
    v_lshlrev_b32 v22, 16, v98
    v_and_b32 v23, 0xffff0000, v98
    v_add_f32 v20, v20, v22
    v_add_f32 v21, v21, v23
    s_waitcnt vmcnt(4)
    v_lshlrev_b32 v22, 16, v99
    v_and_b32 v23, 0xffff0000, v99
    v_add_f32 v20, v20, v22
    v_add_f32 v21, v21, v23
    s_waitcnt vmcnt(3)
    v_lshlrev_b32 v22, 16, v100
    v_and_b32 v23, 0xffff0000, v100
    v_add_f32 v20, v20, v22
    v_add_f32 v21, v21, v23
    s_waitcnt vmcnt(2)
    v_lshlrev_b32 v22, 16, v101
    v_and_b32 v23, 0xffff0000, v101
    v_add_f32 v20, v20, v22
    v_add_f32 v21, v21, v23
    s_waitcnt vmcnt(1)
    v_lshlrev_b32 v22, 16, v102
    v_and_b32 v23, 0xffff0000, v102
    v_add_f32 v20, v20, v22
    v_add_f32 v21, v21, v23
    s_waitcnt vmcnt(0)
    v_lshlrev_b32 v22, 16, v103
    v_and_b32 v23, 0xffff0000, v103
    v_add_f32 v20, v20, v22
    v_add_f32 v21, v21, v23
    v_cmp_u_f32 vcc, v20, v21
    v_cvt_pk_bf16_f32 v20, v20, v21
    s_cbranch_vccnz L_v_gf_236
L_v_gok_235:
    buffer_store_dword v20, v8, s[12:15], s61 offen
    s_xor_b32 s45, s61, 0x8000
    buffer_store_dword v26, v8, s[12:15], s45 offen
    s_bitcmp1_b32 s44, 0
    s_cbranch_scc1 L_v_nr_237
    s_xor_b32 s45, s62, 0x4000
    buffer_store_dword v26, v4, s[12:15], s45 offen
L_v_nr_237:
    s_add_u32 s60, s60, 1
    s_add_u32 s62, s62, 0x2000
    s_and_b32 s62, s62, 0x7fff
    s_and_b32 s45, s60, 0x38
    s_bitcmp1_b64 s[66:67], s45
    s_cselect_b32 s45, 8192, 0
    s_lshl_b32 s63, s60, 18
    s_add_u32 s63, s63, s45
    v_mfma_f32_16x16x32_bf16 v[88:91], v[32:35], a[112:115], 0
    v_mfma_f32_16x16x32_bf16 v[92:95], v[48:51], a[112:115], 0
    v_mfma_f32_16x16x32_bf16 v[88:91], v[36:39], a[116:119], v[88:91]
    v_mfma_f32_16x16x32_bf16 v[92:95], v[52:55], a[116:119], v[92:95]
    v_mfma_f32_16x16x32_bf16 v[88:91], v[40:43], a[120:123], v[88:91]
    v_mfma_f32_16x16x32_bf16 v[92:95], v[56:59], a[120:123], v[92:95]
    v_mfma_f32_16x16x32_bf16 v[88:91], v[44:47], a[124:127], v[88:91]
    v_mfma_f32_16x16x32_bf16 v[92:95], v[60:63], a[124:127], v[92:95]
    v_cvt_pk_bf16_f32 v80, v80, v81
    v_cvt_pk_bf16_f32 v81, v82, v83
    v_cvt_pk_bf16_f32 v82, v84, v85
    v_cvt_pk_bf16_f32 v83, v86, v87
    ds_write_b128 v10, v[80:83] offset:34816
    s_nop 2
    v_cvt_pk_bf16_f32 v88, v88, v89
    v_cvt_pk_bf16_f32 v89, v90, v91
    v_cvt_pk_bf16_f32 v90, v92, v93
    v_cvt_pk_bf16_f32 v91, v94, v95
    ds_write_b128 v10, v[88:91] offset:35840
    s_sleep 3
    s_branch L_v_loop_223
L_v_last_227:
    s_waitcnt lgkmcnt(0)
    s_barrier
    s_branch L_replica
L_v_l1_224:
    s_mov_b64 exec, s[48:49]
    s_cbranch_execz L_v_ls_238
    buffer_load_dwordx4 v[64:67], v9, s[12:15], s61 offen offset:0 sc1
L_v_ls_238:
    s_mov_b64 exec, s[50:51]
    s_cbranch_execz L_v_ls_239
    buffer_load_dwordx4 v[68:71], v9, s[12:15], s61 offen offset:1024 sc1
L_v_ls_239:
    s_mov_b64 exec, s[52:53]
    s_cbranch_execz L_v_ls_240
    buffer_load_dwordx4 v[72:75], v9, s[12:15], s61 offen offset:2048 sc1
L_v_ls_240:
    s_mov_b64 exec, s[54:55]
    s_cbranch_execz L_v_ls_241
    buffer_load_dwordx4 v[76:79], v9, s[12:15], s61 offen offset:3072 sc1
L_v_ls_241:
    s_mov_b64 exec, -1
    s_add_u32 s70, s70, 1
    s_cmp_ge_u32 s70, 524288
    s_cbranch_scc1 L_c_done_1
    s_waitcnt vmcnt(0)
    s_cmp_eq_u64 s[48:49], 0
    s_cbranch_scc1 L_v_lc_242
    ds_write_b128 v10, v[64:67] offset:0
    v_max3_u32 v24, v64, v65, v66
    v_max_u32 v24, v24, v67
    v_cmp_eq_u32 s[48:49], -1, v24
L_v_lc_242:
    s_cmp_eq_u64 s[50:51], 0
    s_cbranch_scc1 L_v_lc_243
    ds_write_b128 v10, v[68:71] offset:1024
    v_max3_u32 v24, v68, v69, v70
    v_max_u32 v24, v24, v71
    v_cmp_eq_u32 s[50:51], -1, v24
L_v_lc_243:
    s_cmp_eq_u64 s[52:53], 0
    s_cbranch_scc1 L_v_lc_244
    ds_write_b128 v10, v[72:75] offset:2048
    v_max3_u32 v24, v72, v73, v74
    v_max_u32 v24, v24, v75
    v_cmp_eq_u32 s[52:53], -1, v24
L_v_lc_244:
    s_cmp_eq_u64 s[54:55], 0
    s_cbranch_scc1 L_v_lc_245
    ds_write_b128 v10, v[76:79] offset:3072
    v_max3_u32 v24, v76, v77, v78
    v_max_u32 v24, v24, v79
    v_cmp_eq_u32 s[54:55], -1, v24
L_v_lc_245:
    s_or_b64 s[46:47], s[48:49], s[50:51]
    s_or_b64 vcc, s[52:53], s[54:55]
    s_or_b64 vcc, vcc, s[46:47]
    s_cbranch_scc1 L_v_l1_224
    s_branch L_v_l1ok_226
L_v_k1_228_c:
    s_waitcnt vmcnt(0)
    s_branch L_v_k1_228
L_rt_230:
    s_add_u32 s70, s70, 1
    s_cmp_lt_u32 s70, 524288
    s_cbranch_scc1 L_v_rl_229
    s_branch L_c_done_1
L_v_vp_232:
    buffer_load_dwordx4 v[64:67], v11, s[12:15], s62 offen offset:0 sc1
    buffer_load_dwordx4 v[68:71], v11, s[12:15], s62 offen offset:1024 sc1
    s_branch L_v_vp_232_m
L_rt_233:
    s_add_u32 s70, s70, 1
    s_cmp_lt_u32 s70, 524288
    s_cbranch_scc1 L_v_vp_232
    s_branch L_c_done_1
L_v_gf_236:
    v_max3_u32 v24, v96, v97, v98
    v_max3_u32 v24, v24, v99, v100
    v_max3_u32 v24, v24, v101, v102
    v_max_u32 v24, v24, v103
    v_cmp_eq_u32 vcc, -1, v24
    v_min_u32 v20, -2, v20
    s_add_u32 s70, s70, 1
    s_cbranch_vccz L_v_gok_235
    buffer_load_dword v96, v7, s[12:15], s63 offen offset:0 sc1
    buffer_load_dword v97, v7, s[12:15], s63 offen offset:256 sc1
    buffer_load_dword v98, v7, s[12:15], s63 offen offset:512 sc1
    buffer_load_dword v99, v7, s[12:15], s63 offen offset:768 sc1
    buffer_load_dword v100, v7, s[12:15], s63 offen offset:1024 sc1
    buffer_load_dword v101, v7, s[12:15], s63 offen offset:1280 sc1
    buffer_load_dword v102, v7, s[12:15], s63 offen offset:1536 sc1
    buffer_load_dword v103, v7, s[12:15], s63 offen offset:1792 sc1
    s_cmp_lt_u32 s70, 524288
    s_cbranch_scc1 L_v_gp_234
    s_branch L_c_done_1
L_vs_190:
    s_mov_b32 s70, 1
    v_mov_b32 v16, 0
    v_mov_b32 v17, 0
    s_branch L_v_l1m_248
.p2align 6
L_v_loop_246:
    s_mov_b32 s70, 1
    buffer_load_dwordx4 v[64:67], v9, s[12:15], s61 offen offset:0 sc1
    buffer_load_dwordx4 v[68:71], v9, s[12:15], s61 offen offset:1024 sc1
    buffer_load_dwordx4 v[72:75], v9, s[12:15], s61 offen offset:2048 sc1
    buffer_load_dwordx4 v[76:79], v9, s[12:15], s61 offen offset:3072 sc1
    v_mov_b32 v16, 0
    v_mov_b32 v17, 0
    v_mov_b32 v18, 0
    v_mov_b32 v19, 0
    v_mov_b32 v20, 0
    v_mov_b32 v21, 0
    v_mov_b32 v22, 0
    v_mov_b32 v23, 0
L_v_l1m_248:
    s_waitcnt vmcnt(3)
    ds_write_b128 v10, v[64:67] offset:0
    v_max3_u32 v24, v64, v65, v66
    v_max_u32 v24, v24, v67
    v_cmp_eq_u32 s[48:49], -1, v24
    s_waitcnt vmcnt(2)
    ds_write_b128 v10, v[68:71] offset:1024
    v_max3_u32 v24, v68, v69, v70
    v_max_u32 v24, v24, v71
    v_cmp_eq_u32 s[50:51], -1, v24
    s_waitcnt vmcnt(1)
    ds_write_b128 v10, v[72:75] offset:2048
    v_max3_u32 v24, v72, v73, v74
    v_max_u32 v24, v24, v75
    v_cmp_eq_u32 s[52:53], -1, v24
    s_waitcnt vmcnt(0)
    ds_write_b128 v10, v[76:79] offset:3072
    v_max3_u32 v24, v76, v77, v78
    v_max_u32 v24, v24, v79
    v_cmp_eq_u32 s[54:55], -1, v24
    s_or_b64 s[46:47], s[48:49], s[50:51]
    s_or_b64 vcc, s[52:53], s[54:55]
    s_or_b64 vcc, vcc, s[46:47]
    s_cbranch_scc1 L_v_l1_247
L_v_l1ok_249:
    s_waitcnt lgkmcnt(0)
    s_barrier
    v_smfmac_f32_16x16x64_bf16 v[16:19], v[64:67], a[0:7], v3
    v_smfmac_f32_16x16x64_bf16 v[20:23], v[64:67], a[32:39], v3
    v_smfmac_f32_16x16x64_bf16 v[16:19], v[68:71], a[8:15], v3
    v_smfmac_f32_16x16x64_bf16 v[20:23], v[68:71], a[40:47], v3
    v_smfmac_f32_16x16x64_bf16 v[16:19], v[72:75], a[16:23], v3
    v_smfmac_f32_16x16x64_bf16 v[20:23], v[72:75], a[48:55], v3
    v_smfmac_f32_16x16x64_bf16 v[16:19], v[76:79], a[24:31], v3
    v_smfmac_f32_16x16x64_bf16 v[20:23], v[76:79], a[56:63], v3
    s_add_u32 s46, s65, 4096
    buffer_load_dwordx4 v[32:35], v15, s[12:15], s65 offen offset:0 sc1
    buffer_load_dwordx4 v[48:51], v15, s[12:15], s46 offen offset:0 sc1
    buffer_load_dwordx4 v[36:39], v15, s[12:15], s65 offen offset:1024 sc1
    buffer_load_dwordx4 v[52:55], v15, s[12:15], s46 offen offset:1024 sc1
    buffer_load_dwordx4 v[40:43], v15, s[12:15], s65 offen offset:2048 sc1
    buffer_load_dwordx4 v[56:59], v15, s[12:15], s46 offen offset:2048 sc1
    buffer_load_dwordx4 v[44:47], v15, s[12:15], s65 offen offset:3072 sc1
    buffer_load_dwordx4 v[60:63], v15, s[12:15], s46 offen offset:3072 sc1
    s_add_u32 s65, s65, 786432
    v_permlane32_swap_b32 v16, v18
    v_permlane32_swap_b32 v17, v19
    v_permlane32_swap_b32 v20, v22
    v_permlane32_swap_b32 v21, v23
    v_add_f32 v16, v16, v18
    v_add_f32 v17, v17, v19
    v_add_f32 v18, v20, v22
    v_add_f32 v19, v21, v23
    ds_write_b128 v14, v[16:19]
    s_mov_b64 exec, 1
    ds_add_u32 v29, v30
    s_mov_b64 exec, -1
    s_add_u32 s58, s58, 4
    s_bitcmp1_b32 s44, 0
    s_cbranch_scc1 L_v_k1_251_c
    s_mov_b32 s70, 0
L_v_rl_252:
    ds_read_b32 v24, v29
    ds_read_b64 v[16:17], v13 offset:0
    ds_read_b64 v[18:19], v13 offset:1024
    ds_read_b64 v[20:21], v13 offset:2048
    ds_read_b64 v[22:23], v13 offset:3072
    s_waitcnt lgkmcnt(2)
    v_cmp_ne_u32 vcc, s58, v24
    v_add_f32 v16, v16, v18
    v_add_f32 v17, v17, v19
    s_waitcnt lgkmcnt(0)
    s_cbranch_vccnz L_rt_253
    v_add_f32 v20, v20, v22
    v_add_f32 v21, v21, v23
    v_add_f32 v16, v16, v20
    v_add_f32 v17, v17, v21
    s_mov_b32 vcc_lo, 0x55555555
    s_mov_b32 vcc_hi, 0x55555555
    v_cndmask_b32_dpp v18, v17, v16, vcc quad_perm:[1,0,3,2] row_mask:0xf bank_mask:0xf
    s_not_b64 vcc, vcc
    v_cndmask_b32_dpp v19, v16, v17, vcc quad_perm:[1,0,3,2] row_mask:0xf bank_mask:0xf
    v_cvt_pk_bf16_f32 v18, v18, v19
    v_min_u32 v18, -2, v18
    buffer_store_dword v18, v4, s[12:15], s62 offen sc1
    ds_write_b32 v5, v18
L_v_k1_251:
    s_cmp_eq_u32 s60, 63
    s_cbranch_scc1 L_v_last_250
    ds_read_b128 v[80:83], v27 offset:32768
    ds_read_b128 v[84:87], v27 offset:36864
    ds_read_b128 v[88:91], v27 offset:40960
    ds_read_b128 v[92:95], v27 offset:45056
    v_mov_b32 v96, 0
    v_mov_b32 v97, 0
    v_mov_b32 v98, 0
    v_mov_b32 v99, 0
    v_mov_b32 v100, 0
    v_mov_b32 v101, 0
    v_mov_b32 v102, 0
    v_mov_b32 v103, 0
    v_mov_b32 v104, 0
    v_mov_b32 v105, 0
    v_mov_b32 v106, 0
    v_mov_b32 v107, 0
    v_mov_b32 v108, 0
    v_mov_b32 v109, 0
    v_mov_b32 v110, 0
    v_mov_b32 v111, 0
    s_bitcmp1_b32 s44, 0
    s_cbranch_scc0 L_v_sv_254
    s_sleep 3
L_v_sv_254:
    s_sleep 4
    s_mov_b32 s70, 1
    buffer_load_dwordx4 v[64:67], v11, s[12:15], s62 offen offset:0 sc1
    buffer_load_dwordx4 v[68:71], v11, s[12:15], s62 offen offset:1024 sc1
L_v_vp_255_m:
    s_waitcnt vmcnt(0)
    v_max3_u32 v20, v64, v65, v66
    v_max3_u32 v20, v20, v67, v68
    v_max3_u32 v20, v20, v69, v70
    v_max_u32 v20, v20, v71
    v_cmp_eq_u32 vcc, -1, v20
    s_cbranch_vccnz L_rt_256
    v_smfmac_f32_16x16x64_bf16 v[96:99], v[64:67], a[64:71], v3
    v_smfmac_f32_16x16x64_bf16 v[96:99], v[68:71], a[72:79], v3
    v_smfmac_f32_16x16x64_bf16 v[100:103], v[64:67], a[80:87], v3
    v_smfmac_f32_16x16x64_bf16 v[100:103], v[68:71], a[88:95], v3
    v_smfmac_f32_16x16x64_bf16 v[104:107], v[64:67], a[96:103], v3
    v_smfmac_f32_16x16x64_bf16 v[104:107], v[68:71], a[104:111], v3
    v_smfmac_f32_16x16x64_bf16 v[108:111], v[64:67], a[112:119], v3
    v_smfmac_f32_16x16x64_bf16 v[108:111], v[68:71], a[120:127], v3
    s_nop 1
    v_cvt_pk_bf16_f32 v96, v96, v97
    v_cvt_pk_bf16_f32 v97, v98, v99
    ds_write_b64 v12, v[96:97] offset:0
    v_cvt_pk_bf16_f32 v100, v100, v101
    v_cvt_pk_bf16_f32 v101, v102, v103
    ds_write_b64 v12, v[100:101] offset:2048
    v_cvt_pk_bf16_f32 v104, v104, v105
    v_cvt_pk_bf16_f32 v105, v106, v107
    ds_write_b64 v12, v[104:105] offset:4096
    v_cvt_pk_bf16_f32 v108, v108, v109
    v_cvt_pk_bf16_f32 v109, v110, v111
    ds_write_b64 v12, v[108:109] offset:6144
    s_waitcnt lgkmcnt(0)
    s_barrier
    ds_read_b128 v[96:99], v2 offset:16384
    ds_read_b128 v[100:103], v2 offset:17408
    ds_read_b128 v[104:107], v2 offset:18432
    ds_read_b128 v[108:111], v2 offset:19456
    ds_read_b128 v[112:115], v31 offset:0
    ds_read_b128 v[116:119], v25 offset:0
    ds_read_b128 v[120:123], v31 offset:512
    ds_read_b128 v[124:127], v25 offset:1024
    s_waitcnt lgkmcnt(7)
    v_mfma_f32_16x16x32_bf16 v[16:19], v[80:83], v[96:99], 0
    s_waitcnt lgkmcnt(6)
    v_mfma_f32_16x16x32_bf16 v[16:19], v[84:87], v[100:103], v[16:19]
    s_waitcnt lgkmcnt(5)
    v_mfma_f32_16x16x32_bf16 v[16:19], v[88:91], v[104:107], v[16:19]
    s_waitcnt lgkmcnt(4)
    v_mfma_f32_16x16x32_bf16 v[16:19], v[92:95], v[108:111], v[16:19]
    s_waitcnt lgkmcnt(2)
    v_mfma_f32_16x16x32_bf16 v[16:19], v[116:119], v[112:115], v[16:19]
    s_waitcnt lgkmcnt(0)
    v_mfma_f32_16x16x32_bf16 v[16:19], v[124:127], v[120:123], v[16:19]
    s_mov_b32 exec_lo, 0x00ff00ff
    s_mov_b32 exec_hi, 0x00ff00ff
    s_nop 5
    v_cvt_pk_bf16_f32 v16, v16, v17
    v_cvt_pk_bf16_f32 v17, v18, v19
    v_min_u32 v16, -2, v16
    v_min_u32 v17, -2, v17
    buffer_store_dwordx2 v[16:17], v6, s[12:15], s63 offen sc1
    s_mov_b64 exec, -1
    s_add_u32 s61, s61, 0x4000
    s_and_b32 s61, s61, 0xffff
    s_mov_b32 s70, 1
    s_sleep 8
    buffer_load_dword v96, v7, s[12:15], s63 offen offset:0 sc1
    buffer_load_dword v97, v7, s[12:15], s63 offen offset:256 sc1
    buffer_load_dword v98, v7, s[12:15], s63 offen offset:512 sc1
    buffer_load_dword v99, v7, s[12:15], s63 offen offset:768 sc1
    buffer_load_dword v100, v7, s[12:15], s63 offen offset:1024 sc1
    buffer_load_dword v101, v7, s[12:15], s63 offen offset:1280 sc1
    buffer_load_dword v102, v7, s[12:15], s63 offen offset:1536 sc1
    buffer_load_dword v103, v7, s[12:15], s63 offen offset:1792 sc1
    v_mfma_f32_16x16x32_bf16 v[64:67], v[32:35], a[64:67], 0
    v_mfma_f32_16x16x32_bf16 v[68:71], v[48:51], a[64:67], 0
    v_mfma_f32_16x16x32_bf16 v[64:67], v[36:39], a[68:71], v[64:67]
    v_mfma_f32_16x16x32_bf16 v[68:71], v[52:55], a[68:71], v[68:71]
    v_mfma_f32_16x16x32_bf16 v[64:67], v[40:43], a[72:75], v[64:67]
    v_mfma_f32_16x16x32_bf16 v[68:71], v[56:59], a[72:75], v[68:71]
    v_mfma_f32_16x16x32_bf16 v[64:67], v[44:47], a[76:79], v[64:67]
    v_mfma_f32_16x16x32_bf16 v[68:71], v[60:63], a[76:79], v[68:71]
    v_mfma_f32_16x16x32_bf16 v[72:75], v[32:35], a[80:83], 0
    v_mfma_f32_16x16x32_bf16 v[76:79], v[48:51], a[80:83], 0
    v_mfma_f32_16x16x32_bf16 v[72:75], v[36:39], a[84:87], v[72:75]
    v_mfma_f32_16x16x32_bf16 v[76:79], v[52:55], a[84:87], v[76:79]
    v_mfma_f32_16x16x32_bf16 v[72:75], v[40:43], a[88:91], v[72:75]
    v_mfma_f32_16x16x32_bf16 v[76:79], v[56:59], a[88:91], v[76:79]
    v_mfma_f32_16x16x32_bf16 v[72:75], v[44:47], a[92:95], v[72:75]
    v_mfma_f32_16x16x32_bf16 v[76:79], v[60:63], a[92:95], v[76:79]
    v_cvt_pk_bf16_f32 v64, v64, v65
    v_cvt_pk_bf16_f32 v65, v66, v67
    v_cvt_pk_bf16_f32 v66, v68, v69
    v_cvt_pk_bf16_f32 v67, v70, v71
    ds_write_b128 v10, v[64:67] offset:32768
    v_mfma_f32_16x16x32_bf16 v[80:83], v[32:35], a[96:99], 0
    v_mfma_f32_16x16x32_bf16 v[84:87], v[48:51], a[96:99], 0
    v_mfma_f32_16x16x32_bf16 v[80:83], v[36:39], a[100:103], v[80:83]
    v_mfma_f32_16x16x32_bf16 v[84:87], v[52:55], a[100:103], v[84:87]
    v_mfma_f32_16x16x32_bf16 v[80:83], v[40:43], a[104:107], v[80:83]
    v_mfma_f32_16x16x32_bf16 v[84:87], v[56:59], a[104:107], v[84:87]
    v_mfma_f32_16x16x32_bf16 v[80:83], v[44:47], a[108:111], v[80:83]
    v_mfma_f32_16x16x32_bf16 v[84:87], v[60:63], a[108:111], v[84:87]
    v_cvt_pk_bf16_f32 v72, v72, v73
    v_cvt_pk_bf16_f32 v73, v74, v75
    v_cvt_pk_bf16_f32 v74, v76, v77
    v_cvt_pk_bf16_f32 v75, v78, v79
    ds_write_b128 v10, v[72:75] offset:33792
L_v_gp_257:
    s_waitcnt vmcnt(7)
    v_lshlrev_b32 v20, 16, v96
    v_and_b32 v21, 0xffff0000, v96
    s_waitcnt vmcnt(6)
    v_lshlrev_b32 v22, 16, v97
    v_and_b32 v23, 0xffff0000, v97
    v_add_f32 v20, v20, v22
    v_add_f32 v21, v21, v23
    s_waitcnt vmcnt(5)
    v_lshlrev_b32 v22, 16, v98
    v_and_b32 v23, 0xffff0000, v98
    v_add_f32 v20, v20, v22
    v_add_f32 v21, v21, v23
    s_waitcnt vmcnt(4)
    v_lshlrev_b32 v22, 16, v99
    v_and_b32 v23, 0xffff0000, v99
    v_add_f32 v20, v20, v22
    v_add_f32 v21, v21, v23
    s_waitcnt vmcnt(3)
    v_lshlrev_b32 v22, 16, v100
    v_and_b32 v23, 0xffff0000, v100
    v_add_f32 v20, v20, v22
    v_add_f32 v21, v21, v23
    s_waitcnt vmcnt(2)
    v_lshlrev_b32 v22, 16, v101
    v_and_b32 v23, 0xffff0000, v101
    v_add_f32 v20, v20, v22
    v_add_f32 v21, v21, v23
    s_waitcnt vmcnt(1)
    v_lshlrev_b32 v22, 16, v102
    v_and_b32 v23, 0xffff0000, v102
    v_add_f32 v20, v20, v22
    v_add_f32 v21, v21, v23
    s_waitcnt vmcnt(0)
    v_lshlrev_b32 v22, 16, v103
    v_and_b32 v23, 0xffff0000, v103
    v_add_f32 v20, v20, v22
    v_add_f32 v21, v21, v23
    v_cmp_u_f32 vcc, v20, v21
    v_cvt_pk_bf16_f32 v20, v20, v21
    s_cbranch_vccnz L_v_gf_259
L_v_gok_258:
    buffer_store_dword v20, v8, s[12:15], s61 offen sc1
    s_xor_b32 s45, s61, 0x8000
    buffer_store_dword v26, v8, s[12:15], s45 offen sc1
    s_bitcmp1_b32 s44, 0
    s_cbranch_scc1 L_v_nr_260
    s_xor_b32 s45, s62, 0x4000
    buffer_store_dword v26, v4, s[12:15], s45 offen sc1
L_v_nr_260:
    s_add_u32 s60, s60, 1
    s_add_u32 s62, s62, 0x2000
    s_and_b32 s62, s62, 0x7fff
    s_and_b32 s45, s60, 0x38
    s_bitcmp1_b64 s[66:67], s45
    s_cselect_b32 s45, 8192, 0
    s_lshl_b32 s63, s60, 18
    s_add_u32 s63, s63, s45
    v_mfma_f32_16x16x32_bf16 v[88:91], v[32:35], a[112:115], 0
    v_mfma_f32_16x16x32_bf16 v[92:95], v[48:51], a[112:115], 0
    v_mfma_f32_16x16x32_bf16 v[88:91], v[36:39], a[116:119], v[88:91]
    v_mfma_f32_16x16x32_bf16 v[92:95], v[52:55], a[116:119], v[92:95]
    v_mfma_f32_16x16x32_bf16 v[88:91], v[40:43], a[120:123], v[88:91]
    v_mfma_f32_16x16x32_bf16 v[92:95], v[56:59], a[120:123], v[92:95]
    v_mfma_f32_16x16x32_bf16 v[88:91], v[44:47], a[124:127], v[88:91]
    v_mfma_f32_16x16x32_bf16 v[92:95], v[60:63], a[124:127], v[92:95]
    v_cvt_pk_bf16_f32 v80, v80, v81
    v_cvt_pk_bf16_f32 v81, v82, v83
    v_cvt_pk_bf16_f32 v82, v84, v85
    v_cvt_pk_bf16_f32 v83, v86, v87
    ds_write_b128 v10, v[80:83] offset:34816
    s_nop 2
    v_cvt_pk_bf16_f32 v88, v88, v89
    v_cvt_pk_bf16_f32 v89, v90, v91
    v_cvt_pk_bf16_f32 v90, v92, v93
    v_cvt_pk_bf16_f32 v91, v94, v95
    ds_write_b128 v10, v[88:91] offset:35840
    s_sleep 3
    s_branch L_v_loop_246
L_v_last_250:
    s_waitcnt lgkmcnt(0)
    s_barrier
    s_branch L_replica
L_v_l1_247:
    s_mov_b64 exec, s[48:49]
    s_cbranch_execz L_v_ls_261
    buffer_load_dwordx4 v[64:67], v9, s[12:15], s61 offen offset:0 sc1
L_v_ls_261:
    s_mov_b64 exec, s[50:51]
    s_cbranch_execz L_v_ls_262
    buffer_load_dwordx4 v[68:71], v9, s[12:15], s61 offen offset:1024 sc1
L_v_ls_262:
    s_mov_b64 exec, s[52:53]
    s_cbranch_execz L_v_ls_263
    buffer_load_dwordx4 v[72:75], v9, s[12:15], s61 offen offset:2048 sc1
L_v_ls_263:
    s_mov_b64 exec, s[54:55]
    s_cbranch_execz L_v_ls_264
    buffer_load_dwordx4 v[76:79], v9, s[12:15], s61 offen offset:3072 sc1
L_v_ls_264:
    s_mov_b64 exec, -1
    s_add_u32 s70, s70, 1
    s_cmp_ge_u32 s70, 524288
    s_cbranch_scc1 L_c_done_1
    s_waitcnt vmcnt(0)
    s_cmp_eq_u64 s[48:49], 0
    s_cbranch_scc1 L_v_lc_265
    ds_write_b128 v10, v[64:67] offset:0
    v_max3_u32 v24, v64, v65, v66
    v_max_u32 v24, v24, v67
    v_cmp_eq_u32 s[48:49], -1, v24
L_v_lc_265:
    s_cmp_eq_u64 s[50:51], 0
    s_cbranch_scc1 L_v_lc_266
    ds_write_b128 v10, v[68:71] offset:1024
    v_max3_u32 v24, v68, v69, v70
    v_max_u32 v24, v24, v71
    v_cmp_eq_u32 s[50:51], -1, v24
L_v_lc_266:
    s_cmp_eq_u64 s[52:53], 0
    s_cbranch_scc1 L_v_lc_267
    ds_write_b128 v10, v[72:75] offset:2048
    v_max3_u32 v24, v72, v73, v74
    v_max_u32 v24, v24, v75
    v_cmp_eq_u32 s[52:53], -1, v24
L_v_lc_267:
    s_cmp_eq_u64 s[54:55], 0
    s_cbranch_scc1 L_v_lc_268
    ds_write_b128 v10, v[76:79] offset:3072
    v_max3_u32 v24, v76, v77, v78
    v_max_u32 v24, v24, v79
    v_cmp_eq_u32 s[54:55], -1, v24
L_v_lc_268:
    s_or_b64 s[46:47], s[48:49], s[50:51]
    s_or_b64 vcc, s[52:53], s[54:55]
    s_or_b64 vcc, vcc, s[46:47]
    s_cbranch_scc1 L_v_l1_247
    s_branch L_v_l1ok_249
L_v_k1_251_c:
    s_waitcnt vmcnt(0)
    s_branch L_v_k1_251
L_rt_253:
    s_add_u32 s70, s70, 1
    s_cmp_lt_u32 s70, 524288
    s_cbranch_scc1 L_v_rl_252
    s_branch L_c_done_1
L_v_vp_255:
    buffer_load_dwordx4 v[64:67], v11, s[12:15], s62 offen offset:0 sc1
    buffer_load_dwordx4 v[68:71], v11, s[12:15], s62 offen offset:1024 sc1
    s_branch L_v_vp_255_m
L_rt_256:
    s_add_u32 s70, s70, 1
    s_cmp_lt_u32 s70, 524288
    s_cbranch_scc1 L_v_vp_255
    s_branch L_c_done_1
L_v_gf_259:
    v_max3_u32 v24, v96, v97, v98
    v_max3_u32 v24, v24, v99, v100
    v_max3_u32 v24, v24, v101, v102
    v_max_u32 v24, v24, v103
    v_cmp_eq_u32 vcc, -1, v24
    v_min_u32 v20, -2, v20
    s_add_u32 s70, s70, 1
    s_cbranch_vccz L_v_gok_258
    buffer_load_dword v96, v7, s[12:15], s63 offen offset:0 sc1
    buffer_load_dword v97, v7, s[12:15], s63 offen offset:256 sc1
    buffer_load_dword v98, v7, s[12:15], s63 offen offset:512 sc1
    buffer_load_dword v99, v7, s[12:15], s63 offen offset:768 sc1
    buffer_load_dword v100, v7, s[12:15], s63 offen offset:1024 sc1
    buffer_load_dword v101, v7, s[12:15], s63 offen offset:1280 sc1
    buffer_load_dword v102, v7, s[12:15], s63 offen offset:1536 sc1
    buffer_load_dword v103, v7, s[12:15], s63 offen offset:1792 sc1
    s_cmp_lt_u32 s70, 524288
    s_cbranch_scc1 L_v_gp_257
    s_branch L_c_done_1
L_c_done_1:
    s_endpgm
.section .rodata,"a"
.p2align 6
.amdhsa_kernel k3_chain_kernel
  .amdhsa_next_free_vgpr 256
  .amdhsa_next_free_sgpr 102
  .amdhsa_accum_offset 128
  .amdhsa_group_segment_fixed_size 0
  .amdhsa_kernarg_size 136
  .amdhsa_user_sgpr_count 2
  .amdhsa_user_sgpr_kernarg_segment_ptr 1
  .amdhsa_system_sgpr_workgroup_id_x 1
.end_amdhsa_kernel
```

```asm
; @launch kernel=k3_chain_kernel grid=(256,1,1) block=(512,1,1) lds=147712
.amdgcn_target "amdgcn-amd-amdhsa--gfx950"
.text
.globl k3_chain_kernel
.p2align 8
.type k3_chain_kernel,@function
k3_chain_kernel:
    s_cmp_ge_u32 s2, 256
    s_cbranch_scc1 L_c_done_1
    s_load_dwordx4 s[20:23], s[0:1], 120
    v_and_b32 v1, 63, v0
    v_lshrrev_b32 v2, 6, v0
    s_nop 0
    v_readfirstlane_b32 s44, v2
    s_waitcnt lgkmcnt(0)
    s_mov_b32 s12, s22
    s_and_b32 s13, s23, 0xffff
    s_mov_b32 s14, 0x10000000
    s_mov_b32 s15, 0x00020000
    s_mov_b32 s16, s20
    s_and_b32 s17, s21, 0xffff
    s_mov_b32 s18, 0x100
    s_mov_b32 s19, 0x00020000
    s_getpc_b64 s[24:25]
L_c_here_2:
    v_lshlrev_b32 v3, 7, v0
    v_mov_b32 v5, s25
    v_add_co_u32 v4, vcc, s24, v3
    s_nop 1
    v_addc_co_u32 v5, vcc, 0, v5, vcc
    v_cmp_gt_u32 vcc, L_c_done_1 - L_c_here_2, v3
    s_and_saveexec_b64 s[26:27], vcc
    s_cbranch_execz L_c_ct_3
    global_load_dword v109, v[4:5], off
L_c_ct_3:
    s_mov_b64 exec, s[26:27]
    s_load_dwordx4 s[8:11], s[0:1], 96
    v_lshrrev_b32 v5, 3, v0
    v_mul_u32_u24 v6, 24576, v5
    v_and_b32 v7, 7, v0
    v_lshl_add_u32 v6, v7, 4, v6
    v_add_u32 v7, 12288, v6
    v_lshlrev_b32 v5, 2, v5
    s_lshr_b32 s50, s2, 5
    s_and_b32 s51, s2, 31
    s_mul_i32 s52, s50, 1572864
    s_lshl_b32 s53, s51, 7
    s_add_u32 s52, s52, s53
    s_lshl_b32 s53, s50, 8
    s_waitcnt lgkmcnt(0)
    s_mov_b32 s28, s10
    s_and_b32 s29, s11, 0xffff
    s_mov_b32 s30, 0xc00000
    s_mov_b32 s31, 0x00020000
    s_mov_b32 s32, s8
    s_and_b32 s33, s9, 0xffff
    s_mov_b32 s34, 0x800
    s_mov_b32 s35, 0x00020000
    buffer_load_dword v8, v5, s[32:35], s53 offen
    buffer_load_dwordx4 v[12:15], v6, s[28:31], s52 offen
    buffer_load_dwordx4 v[16:19], v7, s[28:31], s52 offen
    s_getreg_b32 s39, hwreg(HW_REG_XCC_ID)
    s_and_b32 s39, s39, 7
    s_cmp_lg_u32 s44, 1
    s_cbranch_scc1 L_nz_7
    v_mov_b32 v32, 0
    v_mov_b32 v33, 0
    v_mov_b32 v34, 0
    v_mov_b32 v35, 0
    v_lshlrev_b32 v4, 4, v1
    s_lshl_b32 s45, s2, 10
    s_add_u32 s45, s45, 0x100000
    buffer_store_dwordx4 v[32:35], v4, s[12:15], s45 offen sc1
L_nz_7:
    s_waitcnt vmcnt(0)
    v_lshlrev_b32 v9, 16, v8
    v_and_b32 v10, 0xffff0000, v8
    v_mul_f32 v20, 0xbfb8aa3b, v9
    v_mul_f32 v21, 0xbfb8aa3b, v10
    v_exp_f32 v20, v20
    v_exp_f32 v21, v21
    s_nop 0
    v_add_f32 v20, 1.0, v20
    v_add_f32 v21, 1.0, v21
    v_rcp_f32 v20, v20
    v_rcp_f32 v21, v21
    s_nop 0
    v_mul_f32 v9, v9, v20
    v_mul_f32 v10, v10, v21
    v_cvt_pk_bf16_f32 v9, 0, v9
    v_cvt_pk_bf16_f32 v10, 0, v10
    v_lshlrev_b32 v28, 16, v12
    v_and_b32 v29, 0xffff0000, v12
    v_lshlrev_b32 v30, 16, v16
    v_and_b32 v31, 0xffff0000, v16
    v_mul_f32 v20, v28, v9
    v_mul_f32 v21, v29, v9
    v_fmac_f32 v20, v30, v10
    v_fmac_f32 v21, v31, v10
    v_lshlrev_b32 v28, 16, v13
    v_and_b32 v29, 0xffff0000, v13
    v_lshlrev_b32 v30, 16, v17
    v_and_b32 v31, 0xffff0000, v17
    v_mul_f32 v22, v28, v9
    v_mul_f32 v23, v29, v9
    v_fmac_f32 v22, v30, v10
    v_fmac_f32 v23, v31, v10
    v_lshlrev_b32 v28, 16, v14
    v_and_b32 v29, 0xffff0000, v14
    v_lshlrev_b32 v30, 16, v18
    v_and_b32 v31, 0xffff0000, v18
    v_mul_f32 v24, v28, v9
    v_mul_f32 v25, v29, v9
    v_fmac_f32 v24, v30, v10
    v_fmac_f32 v25, v31, v10
    v_lshlrev_b32 v28, 16, v15
    v_and_b32 v29, 0xffff0000, v15
    v_lshlrev_b32 v30, 16, v19
    v_and_b32 v31, 0xffff0000, v19
    v_mul_f32 v26, v28, v9
    v_mul_f32 v27, v29, v9
    v_fmac_f32 v26, v30, v10
    v_fmac_f32 v27, v31, v10
    s_nop 1
    v_add_f32_dpp v20, v20, v20 row_ror:8 row_mask:0xf bank_mask:0xf
    v_add_f32_dpp v21, v21, v21 row_ror:8 row_mask:0xf bank_mask:0xf
    v_add_f32_dpp v22, v22, v22 row_ror:8 row_mask:0xf bank_mask:0xf
    v_add_f32_dpp v23, v23, v23 row_ror:8 row_mask:0xf bank_mask:0xf
    v_add_f32_dpp v24, v24, v24 row_ror:8 row_mask:0xf bank_mask:0xf
    v_add_f32_dpp v25, v25, v25 row_ror:8 row_mask:0xf bank_mask:0xf
    v_add_f32_dpp v26, v26, v26 row_ror:8 row_mask:0xf bank_mask:0xf
    v_add_f32_dpp v27, v27, v27 row_ror:8 row_mask:0xf bank_mask:0xf
    s_nop 1
    v_permlane16_swap_b32 v20, v24
    v_permlane16_swap_b32 v21, v25
    v_permlane16_swap_b32 v22, v26
    v_permlane16_swap_b32 v23, v27
    v_add_f32 v20, v20, v24
    v_add_f32 v21, v21, v25
    v_add_f32 v22, v22, v26
    v_add_f32 v23, v23, v27
    s_nop 1
    v_permlane32_swap_b32 v20, v22
    v_permlane32_swap_b32 v21, v23
    v_add_f32 v20, v20, v22
    v_add_f32 v21, v21, v23
    v_and_b32 v22, 7, v1
    v_lshlrev_b32 v22, 5, v22
    v_bfe_u32 v23, v1, 4, 1
    v_lshl_add_u32 v22, v23, 4, v22
    v_lshrrev_b32 v23, 5, v1
    v_lshl_add_u32 v22, v23, 3, v22
    s_lshl_b32 s52, s44, 8
    s_add_u32 s52, s52, 139776
    v_add_u32 v22, s52, v22
    ds_write_b64 v22, v[20:21]
    s_waitcnt lgkmcnt(0)
    s_barrier
    s_cmp_lg_u32 s44, 1
    s_cbranch_scc1 L_m1_8
    v_lshlrev_b32 v22, 2, v1
    v_add_u32 v23, 139776, v22
    ds_read_b32 v24, v23 offset:0
    ds_read_b32 v25, v23 offset:256
    ds_read_b32 v26, v23 offset:512
    ds_read_b32 v27, v23 offset:768
    ds_read_b32 v28, v23 offset:1024
    ds_read_b32 v29, v23 offset:1280
    ds_read_b32 v30, v23 offset:1536
    ds_read_b32 v31, v23 offset:1792
    s_waitcnt lgkmcnt(0)
    v_add_f32 v24, v24, v28
    v_add_f32 v25, v25, v29
    v_add_f32 v26, v26, v30
    v_add_f32 v27, v27, v31
    v_add_f32 v24, v24, v26
    v_add_f32 v25, v25, v27
    v_add_f32 v24, v24, v25
    s_lshl_b32 s52, s2, 8
    s_add_u32 s52, s52, 0x10000
    buffer_store_dword v24, v22, s[12:15], s52 offen sc1
L_m1_8:
    s_cmp_lg_u32 s44, 1
    s_cbranch_scc1 L_tk_4
    v_mov_b32 v3, 1
    s_mov_b32 s40, s39
    s_lshl_b32 s45, s40, 5
    v_mov_b32 v4, 0
    s_waitcnt vmcnt(0)
    s_mov_b64 exec, 1
    buffer_atomic_add v3, v4, s[16:19], s45 offen sc0
    s_waitcnt vmcnt(0)
    v_readfirstlane_b32 s41, v3
    s_nop 3
    s_cmp_lt_u32 s41, 32
    s_cbranch_scc1 L_got_5
    v_mov_b32 v3, 1
    buffer_atomic_add v3, v4, s[16:19], 0 offen offset:16 sc0
    s_waitcnt vmcnt(0)
    v_readfirstlane_b32 s46, v3
    s_mov_b64 exec, -1
    v_and_b32 v4, 7, v1
    v_lshlrev_b32 v4, 5, v4
    s_mov_b32 s70, 0
L_sp_6:
    s_sleep 8
    buffer_load_dword v3, v4, s[16:19], 0 offen sc1
    s_waitcnt vmcnt(0)
    s_mov_b32 s48, 0
    v_readlane_b32 s50, v3, 0
    v_readlane_b32 s51, v3, 1
    v_readlane_b32 s52, v3, 2
    v_readlane_b32 s53, v3, 3
    v_readlane_b32 s54, v3, 4
    v_readlane_b32 s55, v3, 5
    v_readlane_b32 s56, v3, 6
    v_readlane_b32 s57, v3, 7
    s_nop 3
    s_add_u32 s48, s48, s50
    s_add_u32 s48, s48, s51
    s_add_u32 s48, s48, s52
    s_add_u32 s48, s48, s53
    s_add_u32 s48, s48, s54
    s_add_u32 s48, s48, s55
    s_add_u32 s48, s48, s56
    s_add_u32 s48, s48, s57
    s_add_u32 s70, s70, 1
    s_cmp_ge_u32 s70, 524288
    s_cbranch_scc1 L_c_done_1
    s_cmp_lt_u32 s48, 256
    s_cbranch_scc1 L_sp_6
    s_min_u32 s48, s50, 32
    s_mov_b32 s40, 0
    s_add_u32 s41, s48, s46
    s_cmp_lt_u32 s41, 32
    s_cbranch_scc1 L_got_5
    s_sub_u32 s46, s41, 32
    s_min_u32 s48, s51, 32
    s_mov_b32 s40, 1
    s_add_u32 s41, s48, s46
    s_cmp_lt_u32 s41, 32
    s_cbranch_scc1 L_got_5
    s_sub_u32 s46, s41, 32
    s_min_u32 s48, s52, 32
    s_mov_b32 s40, 2
    s_add_u32 s41, s48, s46
    s_cmp_lt_u32 s41, 32
    s_cbranch_scc1 L_got_5
    s_sub_u32 s46, s41, 32
    s_min_u32 s48, s53, 32
    s_mov_b32 s40, 3
    s_add_u32 s41, s48, s46
    s_cmp_lt_u32 s41, 32
    s_cbranch_scc1 L_got_5
    s_sub_u32 s46, s41, 32
    s_min_u32 s48, s54, 32
    s_mov_b32 s40, 4
    s_add_u32 s41, s48, s46
    s_cmp_lt_u32 s41, 32
    s_cbranch_scc1 L_got_5
    s_sub_u32 s46, s41, 32
    s_min_u32 s48, s55, 32
    s_mov_b32 s40, 5
    s_add_u32 s41, s48, s46
    s_cmp_lt_u32 s41, 32
    s_cbranch_scc1 L_got_5
    s_sub_u32 s46, s41, 32
    s_min_u32 s48, s56, 32
    s_mov_b32 s40, 6
    s_add_u32 s41, s48, s46
    s_cmp_lt_u32 s41, 32
    s_cbranch_scc1 L_got_5
    s_sub_u32 s46, s41, 32
    s_min_u32 s48, s57, 32
    s_mov_b32 s40, 7
    s_add_u32 s41, s48, s46
    s_cmp_lt_u32 s41, 32
    s_cbranch_scc1 L_got_5
    s_sub_u32 s46, s41, 32
    s_branch L_c_done_1
L_got_5:
    s_mov_b64 exec, -1
    s_lshl_b32 s45, s40, 8
    s_or_b32 s45, s45, s41
    v_mov_b32 v3, s45
    v_mov_b32 v4, 147464
    ds_write_b32 v4, v3
    s_waitcnt lgkmcnt(0)
L_tk_4:
    s_barrier
    v_mov_b32 v4, 147464
    ds_read_b32 v3, v4
    s_waitcnt lgkmcnt(0)
    v_readfirstlane_b32 s45, v3
    s_nop 3
    s_lshr_b32 s40, s45, 8
    s_and_b32 s41, s45, 0xff
    s_lshr_b32 s45, s40, 2
    s_xor_b32 s45, s45, 1
    s_lshl_b32 s45, s45, 4
    s_and_b32 s40, s40, 3
    s_lshl_b32 s40, s40, 1
    s_lshr_b32 s46, s41, 4
    s_add_u32 s40, s40, s46
    s_and_b32 s41, s41, 15
    s_add_u32 s41, s41, s45
    s_cmp_lt_u32 s41, 16
    s_cbranch_scc1 L_c_chain_9
    s_sub_u32 s48, s41, 16
    s_cmp_lt_u32 s48, 12
    s_cbranch_scc1 L_w_g_10
    s_and_b32 s42, s48, 3
    s_mov_b32 s43, s40
    s_load_dwordx2 s[4:5], s[0:1], 0
    v_lshlrev_b32 v2, 4, v1
    v_lshlrev_b32 v3, 5, v1
    s_lshl_b32 s55, s43, 2
    s_add_u32 s55, s55, s42
    s_waitcnt lgkmcnt(0)
    s_mov_b32 s24, s4
    s_and_b32 s25, s5, 0xffff
    s_mov_b32 s26, 0x400000
    s_mov_b32 s27, 0x00020000
    s_lshl_b32 s46, s42, 3
    s_add_u32 s46, s46, s44
    s_lshl_b32 s46, s46, 11
    v_add_u32 v7, s46, v2
    s_lshl_b32 s63, s43, 16
    buffer_load_dwordx4 a[0:3], v7, s[24:27], s63 offen
    buffer_load_dwordx4 a[4:7], v7, s[24:27], s63 offen offset:1024
    s_cmp_lg_u32 s44, 0
    s_cbranch_scc1 L_zwok_19
    v_and_b32 v8, 7, v1
    v_lshlrev_b32 v8, 5, v8
    s_mov_b32 s70, 0
L_zw_18:
    buffer_load_dword v9, v8, s[16:19], 0 offen sc1
    s_waitcnt vmcnt(0)
    v_add_u32_dpp v9, v9, v9 row_ror:1 row_mask:0xf bank_mask:0xf
    s_nop 1
    v_add_u32_dpp v9, v9, v9 row_ror:2 row_mask:0xf bank_mask:0xf
    s_nop 1
    v_add_u32_dpp v9, v9, v9 row_ror:4 row_mask:0xf bank_mask:0xf
    v_cmp_ne_u32 vcc, 0x100, v9
    s_add_u32 s70, s70, 1
    s_cbranch_vccz L_zwok_19
    s_sleep 4
    s_cmp_lt_u32 s70, 524288
    s_cbranch_scc1 L_zw_18
    s_branch L_c_done_1
L_zwok_19:
    s_barrier
    v_lshlrev_b32 v4, 4, v0
    s_mov_b32 s46, 0x10000
    buffer_load_dwordx4 v[32:35], v4, s[12:15], s46 offen sc1
    s_mov_b32 s46, 0x12000
    buffer_load_dwordx4 v[36:39], v4, s[12:15], s46 offen sc1
    s_mov_b32 s46, 0x14000
    buffer_load_dwordx4 v[40:43], v4, s[12:15], s46 offen sc1
    s_mov_b32 s46, 0x16000
    buffer_load_dwordx4 v[44:47], v4, s[12:15], s46 offen sc1
    s_mov_b32 s46, 0x18000
    buffer_load_dwordx4 v[48:51], v4, s[12:15], s46 offen sc1
    s_mov_b32 s46, 0x1a000
    buffer_load_dwordx4 v[52:55], v4, s[12:15], s46 offen sc1
    s_mov_b32 s46, 0x1c000
    buffer_load_dwordx4 v[56:59], v4, s[12:15], s46 offen sc1
    s_mov_b32 s46, 0x1e000
    buffer_load_dwordx4 v[60:63], v4, s[12:15], s46 offen sc1
    s_cmp_lg_u32 s44, 0
    s_cbranch_scc1 L_l_nx_20
    s_cmp_ge_u32 s42, 2
    s_cbranch_scc1 L_l_nx_20
    s_or_b32 s47, s39, 0x100
    v_mov_b32 v8, s47
    v_mov_b32 v9, 0
    s_lshl_b32 s46, s40, 3
    s_lshl_b32 s47, s42, 2
    s_add_u32 s46, s46, s47
    s_add_u32 s46, s46, 0x101200
    s_mov_b64 exec, 1
    buffer_store_dword v8, v9, s[12:15], s46 offen sc1
    s_mov_b64 exec, -1
L_l_nx_20:
    s_mul_i32 s46, s44, 2064
    s_add_u32 s46, s46, 32768
    v_add_u32 v10, s46, v2
    v_and_b32 v11, 7, v1
    v_lshrrev_b32 v12, 3, v1
    v_mul_u32_u24 v13, 2064, v11
    v_lshl_add_u32 v13, v12, 4, v13
    s_lshl_b32 s46, s44, 8
    s_add_u32 s46, s46, 32768
    v_add_u32 v13, s46, v13
    v_lshlrev_b32 v11, 4, v11
    v_lshl_add_u32 v11, v12, 9, v11
    s_lshl_b32 s46, s44, 13
    s_lshl_b32 s47, s42, 7
    s_add_u32 s46, s46, s47
    s_add_u32 s46, s46, 0x400000
    v_add_u32 v11, s46, v11
    v_add_u32 v12, 4096, v11
    s_lshl_b32 s52, s43, 9
    s_lshl_b32 s47, s42, 7
    s_add_u32 s52, s52, s47
    s_add_u32 s52, s52, 0x109400
    s_mov_b32 s60, s43
    s_waitcnt vmcnt(0)
    v_add_f32 v32, v32, v48
    v_add_f32 v33, v33, v49
    v_add_f32 v34, v34, v50
    v_add_f32 v35, v35, v51
    v_add_f32 v36, v36, v52
    v_add_f32 v37, v37, v53
    v_add_f32 v38, v38, v54
    v_add_f32 v39, v39, v55
    v_add_f32 v40, v40, v56
    v_add_f32 v41, v41, v57
    v_add_f32 v42, v42, v58
    v_add_f32 v43, v43, v59
    v_add_f32 v44, v44, v60
    v_add_f32 v45, v45, v61
    v_add_f32 v46, v46, v62
    v_add_f32 v47, v47, v63
    v_add_f32 v32, v32, v40
    v_add_f32 v33, v33, v41
    v_add_f32 v34, v34, v42
    v_add_f32 v35, v35, v43
    v_add_f32 v36, v36, v44
    v_add_f32 v37, v37, v45
    v_add_f32 v38, v38, v46
    v_add_f32 v39, v39, v47
    v_add_f32 v32, v32, v36
    v_add_f32 v33, v33, v37
    v_add_f32 v34, v34, v38
    v_add_f32 v35, v35, v39
    v_cvt_pk_bf16_f32 v32, 0, v32
    v_cvt_pk_bf16_f32 v33, 0, v33
    v_cvt_pk_bf16_f32 v34, 0, v34
    v_cvt_pk_bf16_f32 v35, 0, v35
    ds_write_b128 v4, v[32:35]
    s_waitcnt lgkmcnt(0)
    s_barrier
    ds_read_b128 v[48:51], v3 offset:0
    ds_read_b128 v[52:55], v3 offset:16
    ds_read_b128 v[56:59], v3 offset:2048
    ds_read_b128 v[60:63], v3 offset:2064
    ds_read_b128 v[32:35], v3 offset:4096
    ds_read_b128 v[36:39], v3 offset:4112
    ds_read_b128 v[40:43], v3 offset:6144
    ds_read_b128 v[44:47], v3 offset:6160
    s_waitcnt lgkmcnt(0)
    v_add_f32 v32, 1.0, v32
    v_add_f32 v33, 1.0, v33
    v_add_f32 v34, 1.0, v34
    v_add_f32 v35, 1.0, v35
    v_add_f32 v36, 1.0, v36
    v_add_f32 v37, 1.0, v37
    v_add_f32 v38, 1.0, v38
    v_add_f32 v39, 1.0, v39
    v_add_f32 v40, 1.0, v40
    v_add_f32 v41, 1.0, v41
    v_add_f32 v42, 1.0, v42
    v_add_f32 v43, 1.0, v43
    v_add_f32 v44, 1.0, v44
    v_add_f32 v45, 1.0, v45
    v_add_f32 v46, 1.0, v46
    v_add_f32 v47, 1.0, v47
    v_cvt_pk_bf16_f32 v32, 0, v32
    v_cvt_pk_bf16_f32 v33, 0, v33
    v_cvt_pk_bf16_f32 v34, 0, v34
    v_cvt_pk_bf16_f32 v35, 0, v35
    v_cvt_pk_bf16_f32 v36, 0, v36
    v_cvt_pk_bf16_f32 v37, 0, v37
    v_cvt_pk_bf16_f32 v38, 0, v38
    v_cvt_pk_bf16_f32 v39, 0, v39
    v_cvt_pk_bf16_f32 v40, 0, v40
    v_cvt_pk_bf16_f32 v41, 0, v41
    v_cvt_pk_bf16_f32 v42, 0, v42
    v_cvt_pk_bf16_f32 v43, 0, v43
    v_cvt_pk_bf16_f32 v44, 0, v44
    v_cvt_pk_bf16_f32 v45, 0, v45
    v_cvt_pk_bf16_f32 v46, 0, v46
    v_cvt_pk_bf16_f32 v47, 0, v47
L_l_sub_21:
    s_lshl_b32 s63, s60, 16
    v_accvgpr_read_b32 v96, a0
    v_accvgpr_read_b32 v97, a1
    v_accvgpr_read_b32 v98, a2
    v_accvgpr_read_b32 v99, a3
    v_accvgpr_read_b32 v100, a4
    v_accvgpr_read_b32 v101, a5
    v_accvgpr_read_b32 v102, a6
    v_accvgpr_read_b32 v103, a7
    v_lshlrev_b32 v64, 16, v96
    v_and_b32 v65, 0xffff0000, v96
    v_lshlrev_b32 v66, 16, v97
    v_and_b32 v67, 0xffff0000, v97
    v_lshlrev_b32 v68, 16, v98
    v_and_b32 v69, 0xffff0000, v98
    v_lshlrev_b32 v70, 16, v99
    v_and_b32 v71, 0xffff0000, v99
    v_lshlrev_b32 v72, 16, v100
    v_and_b32 v73, 0xffff0000, v100
    v_lshlrev_b32 v74, 16, v101
    v_and_b32 v75, 0xffff0000, v101
    v_lshlrev_b32 v76, 16, v102
    v_and_b32 v77, 0xffff0000, v102
    v_lshlrev_b32 v78, 16, v103
    v_and_b32 v79, 0xffff0000, v103
    v_pk_add_f32 v[80:81], v[64:65], v[72:73]
    v_pk_add_f32 v[82:83], v[66:67], v[74:75]
    v_pk_add_f32 v[84:85], v[68:69], v[76:77]
    v_pk_add_f32 v[86:87], v[70:71], v[78:79]
    v_pk_add_f32 v[80:81], v[80:81], v[84:85]
    v_pk_add_f32 v[82:83], v[82:83], v[86:87]
    v_pk_add_f32 v[80:81], v[80:81], v[82:83]
    v_add_f32 v14, v80, v81
    s_nop 1
    v_add_f32_dpp v14, v14, v14 row_shr:1 row_mask:0xf bank_mask:0xf bound_ctrl:0
    s_nop 1
    v_add_f32_dpp v14, v14, v14 row_shr:2 row_mask:0xf bank_mask:0xf bound_ctrl:0
    s_nop 1
    v_add_f32_dpp v14, v14, v14 row_shr:4 row_mask:0xf bank_mask:0xf bound_ctrl:0
    s_nop 1
    v_add_f32_dpp v14, v14, v14 row_shr:8 row_mask:0xf bank_mask:0xf bound_ctrl:0
    s_nop 1
    v_add_f32_dpp v14, v14, v14 row_bcast:15 row_mask:0xa bank_mask:0xf
    s_nop 1
    v_add_f32_dpp v14, v14, v14 row_bcast:31 row_mask:0xc bank_mask:0xf
    s_nop 1
    v_readlane_b32 s46, v14, 63
    s_nop 1
    v_mov_b32 v15, s46
    v_mul_f32 v15, 0x3a800000, v15
    v_pk_add_f32 v[80:81], v[64:65], v[14:15] op_sel:[0,1] op_sel_hi:[1,1] neg_lo:[0,1] neg_hi:[0,1]
    v_pk_add_f32 v[82:83], v[66:67], v[14:15] op_sel:[0,1] op_sel_hi:[1,1] neg_lo:[0,1] neg_hi:[0,1]
    v_pk_add_f32 v[84:85], v[68:69], v[14:15] op_sel:[0,1] op_sel_hi:[1,1] neg_lo:[0,1] neg_hi:[0,1]
    v_pk_add_f32 v[86:87], v[70:71], v[14:15] op_sel:[0,1] op_sel_hi:[1,1] neg_lo:[0,1] neg_hi:[0,1]
    v_pk_add_f32 v[88:89], v[72:73], v[14:15] op_sel:[0,1] op_sel_hi:[1,1] neg_lo:[0,1] neg_hi:[0,1]
    v_pk_add_f32 v[90:91], v[74:75], v[14:15] op_sel:[0,1] op_sel_hi:[1,1] neg_lo:[0,1] neg_hi:[0,1]
    v_pk_add_f32 v[92:93], v[76:77], v[14:15] op_sel:[0,1] op_sel_hi:[1,1] neg_lo:[0,1] neg_hi:[0,1]
    v_pk_add_f32 v[94:95], v[78:79], v[14:15] op_sel:[0,1] op_sel_hi:[1,1] neg_lo:[0,1] neg_hi:[0,1]
    v_pk_mul_f32 v[104:105], v[80:81], v[80:81]
    v_pk_mul_f32 v[106:107], v[82:83], v[82:83]
    v_pk_fma_f32 v[104:105], v[84:85], v[84:85], v[104:105]
    v_pk_fma_f32 v[106:107], v[86:87], v[86:87], v[106:107]
    v_pk_fma_f32 v[104:105], v[88:89], v[88:89], v[104:105]
    v_pk_fma_f32 v[106:107], v[90:91], v[90:91], v[106:107]
    v_pk_fma_f32 v[104:105], v[92:93], v[92:93], v[104:105]
    v_pk_fma_f32 v[106:107], v[94:95], v[94:95], v[106:107]
    v_pk_add_f32 v[104:105], v[104:105], v[106:107]
    v_add_f32 v14, v104, v105
    v_cvt_pk_bf16_f32 v15, 0, v15
    s_nop 1
    v_add_f32_dpp v14, v14, v14 row_shr:1 row_mask:0xf bank_mask:0xf bound_ctrl:0
    s_nop 1
    v_add_f32_dpp v14, v14, v14 row_shr:2 row_mask:0xf bank_mask:0xf bound_ctrl:0
    s_nop 1
    v_add_f32_dpp v14, v14, v14 row_shr:4 row_mask:0xf bank_mask:0xf bound_ctrl:0
    s_nop 1
    v_add_f32_dpp v14, v14, v14 row_shr:8 row_mask:0xf bank_mask:0xf bound_ctrl:0
    s_nop 1
    v_add_f32_dpp v14, v14, v14 row_bcast:15 row_mask:0xa bank_mask:0xf
    s_nop 1
    v_add_f32_dpp v14, v14, v14 row_bcast:31 row_mask:0xc bank_mask:0xf
    s_nop 1
    v_readlane_b32 s47, v14, 63
    v_pk_add_f32 v[64:65], v[64:65], v[14:15] op_sel:[0,1] op_sel_hi:[1,1] neg_lo:[0,1] neg_hi:[0,1]
    v_pk_add_f32 v[66:67], v[66:67], v[14:15] op_sel:[0,1] op_sel_hi:[1,1] neg_lo:[0,1] neg_hi:[0,1]
    v_pk_add_f32 v[68:69], v[68:69], v[14:15] op_sel:[0,1] op_sel_hi:[1,1] neg_lo:[0,1] neg_hi:[0,1]
    v_pk_add_f32 v[70:71], v[70:71], v[14:15] op_sel:[0,1] op_sel_hi:[1,1] neg_lo:[0,1] neg_hi:[0,1]
    v_pk_add_f32 v[72:73], v[72:73], v[14:15] op_sel:[0,1] op_sel_hi:[1,1] neg_lo:[0,1] neg_hi:[0,1]
    v_pk_add_f32 v[74:75], v[74:75], v[14:15] op_sel:[0,1] op_sel_hi:[1,1] neg_lo:[0,1] neg_hi:[0,1]
    v_pk_add_f32 v[76:77], v[76:77], v[14:15] op_sel:[0,1] op_sel_hi:[1,1] neg_lo:[0,1] neg_hi:[0,1]
    v_pk_add_f32 v[78:79], v[78:79], v[14:15] op_sel:[0,1] op_sel_hi:[1,1] neg_lo:[0,1] neg_hi:[0,1]
    v_mov_b32 v14, s47
    v_mul_f32 v14, 0x3a800000, v14
    v_cvt_pk_bf16_f32 v14, 0, v14
    v_add_f32 v14, 0x3727c5ac, v14
    v_cvt_pk_bf16_f32 v14, 0, v14
    v_sqrt_f32 v14, v14
    s_nop 0
    v_cvt_pk_bf16_f32 v14, 0, v14
    v_rcp_f32 v14, v14
    v_cvt_pk_bf16_f32 v64, 0, v64
    v_cvt_pk_bf16_f32 v65, 0, v65
    v_cvt_pk_bf16_f32 v66, 0, v66
    v_cvt_pk_bf16_f32 v67, 0, v67
    v_cvt_pk_bf16_f32 v68, 0, v68
    v_cvt_pk_bf16_f32 v69, 0, v69
    v_cvt_pk_bf16_f32 v70, 0, v70
    v_cvt_pk_bf16_f32 v71, 0, v71
    v_cvt_pk_bf16_f32 v72, 0, v72
    v_cvt_pk_bf16_f32 v73, 0, v73
    v_cvt_pk_bf16_f32 v74, 0, v74
    v_cvt_pk_bf16_f32 v75, 0, v75
    v_cvt_pk_bf16_f32 v76, 0, v76
    v_cvt_pk_bf16_f32 v77, 0, v77
    v_cvt_pk_bf16_f32 v78, 0, v78
    v_cvt_pk_bf16_f32 v79, 0, v79
    v_pk_mul_f32 v[64:65], v[64:65], v[14:15] op_sel_hi:[1,0]
    v_pk_mul_f32 v[66:67], v[66:67], v[14:15] op_sel_hi:[1,0]
    v_pk_mul_f32 v[68:69], v[68:69], v[14:15] op_sel_hi:[1,0]
    v_pk_mul_f32 v[70:71], v[70:71], v[14:15] op_sel_hi:[1,0]
    v_pk_mul_f32 v[72:73], v[72:73], v[14:15] op_sel_hi:[1,0]
    v_pk_mul_f32 v[74:75], v[74:75], v[14:15] op_sel_hi:[1,0]
    v_pk_mul_f32 v[76:77], v[76:77], v[14:15] op_sel_hi:[1,0]
    v_pk_mul_f32 v[78:79], v[78:79], v[14:15] op_sel_hi:[1,0]
    v_cvt_pk_bf16_f32 v64, 0, v64
    v_cvt_pk_bf16_f32 v65, 0, v65
    v_cvt_pk_bf16_f32 v66, 0, v66
    v_cvt_pk_bf16_f32 v67, 0, v67
    v_cvt_pk_bf16_f32 v68, 0, v68
    v_cvt_pk_bf16_f32 v69, 0, v69
    v_cvt_pk_bf16_f32 v70, 0, v70
    v_cvt_pk_bf16_f32 v71, 0, v71
    v_cvt_pk_bf16_f32 v72, 0, v72
    v_cvt_pk_bf16_f32 v73, 0, v73
    v_cvt_pk_bf16_f32 v74, 0, v74
    v_cvt_pk_bf16_f32 v75, 0, v75
    v_cvt_pk_bf16_f32 v76, 0, v76
    v_cvt_pk_bf16_f32 v77, 0, v77
    v_cvt_pk_bf16_f32 v78, 0, v78
    v_cvt_pk_bf16_f32 v79, 0, v79
    v_pk_mul_f32 v[64:65], v[64:65], v[32:33]
    v_pk_mul_f32 v[66:67], v[66:67], v[34:35]
    v_pk_mul_f32 v[68:69], v[68:69], v[36:37]
    v_pk_mul_f32 v[70:71], v[70:71], v[38:39]
    v_pk_mul_f32 v[72:73], v[72:73], v[40:41]
    v_pk_mul_f32 v[74:75], v[74:75], v[42:43]
    v_pk_mul_f32 v[76:77], v[76:77], v[44:45]
    v_pk_mul_f32 v[78:79], v[78:79], v[46:47]
    v_cvt_pk_bf16_f32 v64, 0, v64
    v_cvt_pk_bf16_f32 v65, 0, v65
    v_cvt_pk_bf16_f32 v66, 0, v66
    v_cvt_pk_bf16_f32 v67, 0, v67
    v_cvt_pk_bf16_f32 v68, 0, v68
    v_cvt_pk_bf16_f32 v69, 0, v69
    v_cvt_pk_bf16_f32 v70, 0, v70
    v_cvt_pk_bf16_f32 v71, 0, v71
    v_cvt_pk_bf16_f32 v72, 0, v72
    v_cvt_pk_bf16_f32 v73, 0, v73
    v_cvt_pk_bf16_f32 v74, 0, v74
    v_cvt_pk_bf16_f32 v75, 0, v75
    v_cvt_pk_bf16_f32 v76, 0, v76
    v_cvt_pk_bf16_f32 v77, 0, v77
    v_cvt_pk_bf16_f32 v78, 0, v78
    v_cvt_pk_bf16_f32 v79, 0, v79
    v_pk_add_f32 v[64:65], v[64:65], v[48:49]
    v_pk_add_f32 v[66:67], v[66:67], v[50:51]
    v_pk_add_f32 v[68:69], v[68:69], v[52:53]
    v_pk_add_f32 v[70:71], v[70:71], v[54:55]
    v_pk_add_f32 v[72:73], v[72:73], v[56:57]
    v_pk_add_f32 v[74:75], v[74:75], v[58:59]
    v_pk_add_f32 v[76:77], v[76:77], v[60:61]
    v_pk_add_f32 v[78:79], v[78:79], v[62:63]
    v_cvt_pk_bf16_f32 v104, v64, v65
    v_cvt_pk_bf16_f32 v105, v66, v67
    v_cvt_pk_bf16_f32 v106, v68, v69
    v_cvt_pk_bf16_f32 v107, v70, v71
    v_cvt_pk_bf16_f32 v108, v72, v73
    v_cvt_pk_bf16_f32 v109, v74, v75
    v_cvt_pk_bf16_f32 v110, v76, v77
    v_cvt_pk_bf16_f32 v111, v78, v79
    ds_write_b128 v10, v[104:107]
    ds_write_b128 v10, v[108:111] offset:1024
    s_waitcnt lgkmcnt(0)
    s_barrier
    ds_read_b128 v[104:107], v13
    ds_read_b128 v[108:111], v13 offset:128
    s_waitcnt lgkmcnt(1)
    buffer_store_dwordx4 v[104:107], v11, s[12:15], s63 offen sc1
    s_waitcnt lgkmcnt(0)
    buffer_store_dwordx4 v[108:111], v12, s[12:15], s63 offen sc1
    s_waitcnt vmcnt(0)
    s_barrier
    s_cmp_lg_u32 s44, 0
    s_cbranch_scc1 L_sf_23
    v_mov_b32 v14, s60
    v_add_u32 v14, 1, v14
    v_mov_b32 v15, 0
    s_mov_b64 exec, 1
    buffer_store_dword v14, v15, s[12:15], s52 offen sc1
    s_mov_b64 exec, -1
L_sf_23:
    s_cmp_ge_u32 s60, 8
    s_cbranch_scc1 L_l_end_22
    s_add_u32 s63, s63, 524288
    buffer_load_dwordx4 a[8:11], v7, s[24:27], s63 offen
    buffer_load_dwordx4 a[12:15], v7, s[24:27], s63 offen offset:1024
    s_add_u32 s63, s63, 524288
    buffer_load_dwordx4 a[16:19], v7, s[24:27], s63 offen
    buffer_load_dwordx4 a[20:23], v7, s[24:27], s63 offen offset:1024
    s_add_u32 s63, s63, 524288
    buffer_load_dwordx4 a[24:27], v7, s[24:27], s63 offen
    buffer_load_dwordx4 a[28:31], v7, s[24:27], s63 offen offset:1024
    s_add_u32 s63, s63, 524288
    buffer_load_dwordx4 a[32:35], v7, s[24:27], s63 offen
    buffer_load_dwordx4 a[36:39], v7, s[24:27], s63 offen offset:1024
    s_add_u32 s63, s63, 524288
    buffer_load_dwordx4 a[40:43], v7, s[24:27], s63 offen
    buffer_load_dwordx4 a[44:47], v7, s[24:27], s63 offen offset:1024
    s_add_u32 s63, s63, 524288
    buffer_load_dwordx4 a[48:51], v7, s[24:27], s63 offen
    buffer_load_dwordx4 a[52:55], v7, s[24:27], s63 offen offset:1024
    s_add_u32 s63, s63, 524288
    buffer_load_dwordx4 a[56:59], v7, s[24:27], s63 offen
    buffer_load_dwordx4 a[60:63], v7, s[24:27], s63 offen offset:1024
    s_waitcnt vmcnt(0)
L_l_end_22:
    v_accvgpr_mov_b32 a0, a8
    v_accvgpr_mov_b32 a1, a9
    v_accvgpr_mov_b32 a2, a10
    v_accvgpr_mov_b32 a3, a11
    v_accvgpr_mov_b32 a4, a12
    v_accvgpr_mov_b32 a5, a13
    v_accvgpr_mov_b32 a6, a14
    v_accvgpr_mov_b32 a7, a15
    v_accvgpr_mov_b32 a8, a16
    v_accvgpr_mov_b32 a9, a17
    v_accvgpr_mov_b32 a10, a18
    v_accvgpr_mov_b32 a11, a19
    v_accvgpr_mov_b32 a12, a20
    v_accvgpr_mov_b32 a13, a21
    v_accvgpr_mov_b32 a14, a22
    v_accvgpr_mov_b32 a15, a23
    v_accvgpr_mov_b32 a16, a24
    v_accvgpr_mov_b32 a17, a25
    v_accvgpr_mov_b32 a18, a26
    v_accvgpr_mov_b32 a19, a27
    v_accvgpr_mov_b32 a20, a28
    v_accvgpr_mov_b32 a21, a29
    v_accvgpr_mov_b32 a22, a30
    v_accvgpr_mov_b32 a23, a31
    v_accvgpr_mov_b32 a24, a32
    v_accvgpr_mov_b32 a25, a33
    v_accvgpr_mov_b32 a26, a34
    v_accvgpr_mov_b32 a27, a35
    v_accvgpr_mov_b32 a28, a36
    v_accvgpr_mov_b32 a29, a37
    v_accvgpr_mov_b32 a30, a38
    v_accvgpr_mov_b32 a31, a39
    v_accvgpr_mov_b32 a32, a40
    v_accvgpr_mov_b32 a33, a41
    v_accvgpr_mov_b32 a34, a42
    v_accvgpr_mov_b32 a35, a43
    v_accvgpr_mov_b32 a36, a44
    v_accvgpr_mov_b32 a37, a45
    v_accvgpr_mov_b32 a38, a46
    v_accvgpr_mov_b32 a39, a47
    v_accvgpr_mov_b32 a40, a48
    v_accvgpr_mov_b32 a41, a49
    v_accvgpr_mov_b32 a42, a50
    v_accvgpr_mov_b32 a43, a51
    v_accvgpr_mov_b32 a44, a52
    v_accvgpr_mov_b32 a45, a53
    v_accvgpr_mov_b32 a46, a54
    v_accvgpr_mov_b32 a47, a55
    v_accvgpr_mov_b32 a48, a56
    v_accvgpr_mov_b32 a49, a57
    v_accvgpr_mov_b32 a50, a58
    v_accvgpr_mov_b32 a51, a59
    v_accvgpr_mov_b32 a52, a60
    v_accvgpr_mov_b32 a53, a61
    v_accvgpr_mov_b32 a54, a62
    v_accvgpr_mov_b32 a55, a63
    s_add_u32 s60, s60, 8
    s_cmp_lt_u32 s60, 64
    s_cbranch_scc1 L_l_sub_21
    s_cmp_lt_u32 s48, 14
    s_cbranch_scc1 L_w_h_17_s
    s_and_b32 s55, s48, 1
    s_lshl_b32 s55, s55, 3
    s_add_u32 s55, s55, s40
    s_load_dwordx4 s[8:11], s[0:1], 96
    v_lshrrev_b32 v5, 3, v0
    s_mov_b32 s46, 196608
    v_mul_lo_u32 v4, v5, s46
    v_and_b32 v6, 7, v0
    v_lshl_add_u32 v4, v6, 4, v4
    v_lshlrev_b32 v5, 5, v5
    s_waitcnt lgkmcnt(0)
    s_mov_b32 s28, s10
    s_and_b32 s29, s11, 0xffff
    s_mov_b32 s30, 0xc00000
    s_mov_b32 s31, 0x00020000
    s_mov_b32 s32, s8
    s_and_b32 s33, s9, 0xffff
    s_mov_b32 s34, 0x800
    s_mov_b32 s35, 0x00020000
    buffer_load_dwordx4 v[8:11], v5, s[32:35], 0 offen
    buffer_load_dwordx4 v[12:15], v5, s[32:35], 0 offen offset:16
    s_waitcnt vmcnt(0)
    v_lshlrev_b32 v16, 16, v8
    v_and_b32 v17, 0xffff0000, v8
    v_lshlrev_b32 v18, 16, v9
    v_and_b32 v19, 0xffff0000, v9
    v_lshlrev_b32 v20, 16, v10
    v_and_b32 v21, 0xffff0000, v10
    v_lshlrev_b32 v22, 16, v11
    v_and_b32 v23, 0xffff0000, v11
    v_lshlrev_b32 v24, 16, v12
    v_and_b32 v25, 0xffff0000, v12
    v_lshlrev_b32 v26, 16, v13
    v_and_b32 v27, 0xffff0000, v13
    v_lshlrev_b32 v28, 16, v14
    v_and_b32 v29, 0xffff0000, v14
    v_lshlrev_b32 v30, 16, v15
    v_and_b32 v31, 0xffff0000, v15
    v_mul_f32 v112, 0xbfb8aa3b, v16
    v_mul_f32 v113, 0xbfb8aa3b, v17
    v_mul_f32 v114, 0xbfb8aa3b, v18
    v_mul_f32 v115, 0xbfb8aa3b, v19
    v_mul_f32 v116, 0xbfb8aa3b, v20
    v_mul_f32 v117, 0xbfb8aa3b, v21
    v_mul_f32 v118, 0xbfb8aa3b, v22
    v_mul_f32 v119, 0xbfb8aa3b, v23
    v_mul_f32 v120, 0xbfb8aa3b, v24
    v_mul_f32 v121, 0xbfb8aa3b, v25
    v_mul_f32 v122, 0xbfb8aa3b, v26
    v_mul_f32 v123, 0xbfb8aa3b, v27
    v_mul_f32 v124, 0xbfb8aa3b, v28
    v_mul_f32 v125, 0xbfb8aa3b, v29
    v_mul_f32 v126, 0xbfb8aa3b, v30
    v_mul_f32 v127, 0xbfb8aa3b, v31
    v_exp_f32 v112, v112
    v_exp_f32 v113, v113
    v_exp_f32 v114, v114
    v_exp_f32 v115, v115
    v_exp_f32 v116, v116
    v_exp_f32 v117, v117
    v_exp_f32 v118, v118
    v_exp_f32 v119, v119
    v_exp_f32 v120, v120
    v_exp_f32 v121, v121
    v_exp_f32 v122, v122
    v_exp_f32 v123, v123
    v_exp_f32 v124, v124
    v_exp_f32 v125, v125
    v_exp_f32 v126, v126
    v_exp_f32 v127, v127
    v_add_f32 v112, 1.0, v112
    v_add_f32 v113, 1.0, v113
    v_add_f32 v114, 1.0, v114
    v_add_f32 v115, 1.0, v115
    v_add_f32 v116, 1.0, v116
    v_add_f32 v117, 1.0, v117
    v_add_f32 v118, 1.0, v118
    v_add_f32 v119, 1.0, v119
    v_add_f32 v120, 1.0, v120
    v_add_f32 v121, 1.0, v121
    v_add_f32 v122, 1.0, v122
    v_add_f32 v123, 1.0, v123
    v_add_f32 v124, 1.0, v124
    v_add_f32 v125, 1.0, v125
    v_add_f32 v126, 1.0, v126
    v_add_f32 v127, 1.0, v127
    v_rcp_f32 v112, v112
    v_rcp_f32 v113, v113
    v_rcp_f32 v114, v114
    v_rcp_f32 v115, v115
    v_rcp_f32 v116, v116
    v_rcp_f32 v117, v117
    v_rcp_f32 v118, v118
    v_rcp_f32 v119, v119
    v_rcp_f32 v120, v120
    v_rcp_f32 v121, v121
    v_rcp_f32 v122, v122
    v_rcp_f32 v123, v123
    v_rcp_f32 v124, v124
    v_rcp_f32 v125, v125
    v_rcp_f32 v126, v126
    v_rcp_f32 v127, v127
    v_mul_f32 v16, v16, v112
    v_mul_f32 v17, v17, v113
    v_mul_f32 v18, v18, v114
    v_mul_f32 v19, v19, v115
    v_mul_f32 v20, v20, v116
    v_mul_f32 v21, v21, v117
    v_mul_f32 v22, v22, v118
    v_mul_f32 v23, v23, v119
    v_mul_f32 v24, v24, v120
    v_mul_f32 v25, v25, v121
    v_mul_f32 v26, v26, v122
    v_mul_f32 v27, v27, v123
    v_mul_f32 v28, v28, v124
    v_mul_f32 v29, v29, v125
    v_mul_f32 v30, v30, v126
    v_mul_f32 v31, v31, v127
    v_cvt_pk_bf16_f32 v16, 0, v16
    v_cvt_pk_bf16_f32 v17, 0, v17
    v_cvt_pk_bf16_f32 v18, 0, v18
    v_cvt_pk_bf16_f32 v19, 0, v19
    v_cvt_pk_bf16_f32 v20, 0, v20
    v_cvt_pk_bf16_f32 v21, 0, v21
    v_cvt_pk_bf16_f32 v22, 0, v22
    v_cvt_pk_bf16_f32 v23, 0, v23
    v_cvt_pk_bf16_f32 v24, 0, v24
    v_cvt_pk_bf16_f32 v25, 0, v25
    v_cvt_pk_bf16_f32 v26, 0, v26
    v_cvt_pk_bf16_f32 v27, 0, v27
    v_cvt_pk_bf16_f32 v28, 0, v28
    v_cvt_pk_bf16_f32 v29, 0, v29
    v_cvt_pk_bf16_f32 v30, 0, v30
    v_cvt_pk_bf16_f32 v31, 0, v31
    s_lshl_b32 s53, s55, 9
    s_add_u32 s53, s53, 4096
L_m_loop_24:
    s_add_u32 s46, s53, 0
    buffer_load_dwordx4 v[32:35], v4, s[28:31], s46 offen
    s_add_u32 s46, s53, 12288
    buffer_load_dwordx4 v[36:39], v4, s[28:31], s46 offen
    s_add_u32 s46, s53, 24576
    buffer_load_dwordx4 v[40:43], v4, s[28:31], s46 offen
    s_add_u32 s46, s53, 36864
    buffer_load_dwordx4 v[44:47], v4, s[28:31], s46 offen
    s_add_u32 s46, s53, 49152
    buffer_load_dwordx4 v[48:51], v4, s[28:31], s46 offen
    s_add_u32 s46, s53, 61440
    buffer_load_dwordx4 v[52:55], v4, s[28:31], s46 offen
    s_add_u32 s46, s53, 73728
    buffer_load_dwordx4 v[56:59], v4, s[28:31], s46 offen
    s_add_u32 s46, s53, 86016
    buffer_load_dwordx4 v[60:63], v4, s[28:31], s46 offen
    s_add_u32 s46, s53, 98304
    buffer_load_dwordx4 v[64:67], v4, s[28:31], s46 offen
    s_add_u32 s46, s53, 110592
    buffer_load_dwordx4 v[68:71], v4, s[28:31], s46 offen
    s_add_u32 s46, s53, 122880
    buffer_load_dwordx4 v[72:75], v4, s[28:31], s46 offen
    s_add_u32 s46, s53, 135168
    buffer_load_dwordx4 v[76:79], v4, s[28:31], s46 offen
    s_add_u32 s46, s53, 147456
    buffer_load_dwordx4 v[80:83], v4, s[28:31], s46 offen
    s_add_u32 s46, s53, 159744
    buffer_load_dwordx4 v[84:87], v4, s[28:31], s46 offen
    s_add_u32 s46, s53, 172032
    buffer_load_dwordx4 v[88:91], v4, s[28:31], s46 offen
    s_add_u32 s46, s53, 184320
    buffer_load_dwordx4 v[92:95], v4, s[28:31], s46 offen
    s_waitcnt vmcnt(15)
    v_lshlrev_b32 v104, 16, v32
    v_and_b32 v105, 0xffff0000, v32
    v_mul_f32 v96, v104, v16
    v_mul_f32 v97, v105, v16
    v_lshlrev_b32 v104, 16, v33
    v_and_b32 v105, 0xffff0000, v33
    v_mul_f32 v98, v104, v16
    v_mul_f32 v99, v105, v16
    v_lshlrev_b32 v104, 16, v34
    v_and_b32 v105, 0xffff0000, v34
    v_mul_f32 v100, v104, v16
    v_mul_f32 v101, v105, v16
    v_lshlrev_b32 v104, 16, v35
    v_and_b32 v105, 0xffff0000, v35
    v_mul_f32 v102, v104, v16
    v_mul_f32 v103, v105, v16
    s_waitcnt vmcnt(14)
    v_lshlrev_b32 v104, 16, v36
    v_and_b32 v105, 0xffff0000, v36
    v_fmac_f32 v96, v104, v17
    v_fmac_f32 v97, v105, v17
    v_lshlrev_b32 v104, 16, v37
    v_and_b32 v105, 0xffff0000, v37
    v_fmac_f32 v98, v104, v17
    v_fmac_f32 v99, v105, v17
    v_lshlrev_b32 v104, 16, v38
    v_and_b32 v105, 0xffff0000, v38
    v_fmac_f32 v100, v104, v17
    v_fmac_f32 v101, v105, v17
    v_lshlrev_b32 v104, 16, v39
    v_and_b32 v105, 0xffff0000, v39
    v_fmac_f32 v102, v104, v17
    v_fmac_f32 v103, v105, v17
    s_waitcnt vmcnt(13)
    v_lshlrev_b32 v104, 16, v40
    v_and_b32 v105, 0xffff0000, v40
    v_fmac_f32 v96, v104, v18
    v_fmac_f32 v97, v105, v18
    v_lshlrev_b32 v104, 16, v41
    v_and_b32 v105, 0xffff0000, v41
    v_fmac_f32 v98, v104, v18
    v_fmac_f32 v99, v105, v18
    v_lshlrev_b32 v104, 16, v42
    v_and_b32 v105, 0xffff0000, v42
    v_fmac_f32 v100, v104, v18
    v_fmac_f32 v101, v105, v18
    v_lshlrev_b32 v104, 16, v43
    v_and_b32 v105, 0xffff0000, v43
    v_fmac_f32 v102, v104, v18
    v_fmac_f32 v103, v105, v18
    s_waitcnt vmcnt(12)
    v_lshlrev_b32 v104, 16, v44
    v_and_b32 v105, 0xffff0000, v44
    v_fmac_f32 v96, v104, v19
    v_fmac_f32 v97, v105, v19
    v_lshlrev_b32 v104, 16, v45
    v_and_b32 v105, 0xffff0000, v45
    v_fmac_f32 v98, v104, v19
    v_fmac_f32 v99, v105, v19
    v_lshlrev_b32 v104, 16, v46
    v_and_b32 v105, 0xffff0000, v46
    v_fmac_f32 v100, v104, v19
    v_fmac_f32 v101, v105, v19
    v_lshlrev_b32 v104, 16, v47
    v_and_b32 v105, 0xffff0000, v47
    v_fmac_f32 v102, v104, v19
    v_fmac_f32 v103, v105, v19
    s_waitcnt vmcnt(11)
    v_lshlrev_b32 v104, 16, v48
    v_and_b32 v105, 0xffff0000, v48
    v_fmac_f32 v96, v104, v20
    v_fmac_f32 v97, v105, v20
    v_lshlrev_b32 v104, 16, v49
    v_and_b32 v105, 0xffff0000, v49
    v_fmac_f32 v98, v104, v20
    v_fmac_f32 v99, v105, v20
    v_lshlrev_b32 v104, 16, v50
    v_and_b32 v105, 0xffff0000, v50
    v_fmac_f32 v100, v104, v20
    v_fmac_f32 v101, v105, v20
    v_lshlrev_b32 v104, 16, v51
    v_and_b32 v105, 0xffff0000, v51
    v_fmac_f32 v102, v104, v20
    v_fmac_f32 v103, v105, v20
    s_waitcnt vmcnt(10)
    v_lshlrev_b32 v104, 16, v52
    v_and_b32 v105, 0xffff0000, v52
    v_fmac_f32 v96, v104, v21
    v_fmac_f32 v97, v105, v21
    v_lshlrev_b32 v104, 16, v53
    v_and_b32 v105, 0xffff0000, v53
    v_fmac_f32 v98, v104, v21
    v_fmac_f32 v99, v105, v21
    v_lshlrev_b32 v104, 16, v54
    v_and_b32 v105, 0xffff0000, v54
    v_fmac_f32 v100, v104, v21
    v_fmac_f32 v101, v105, v21
    v_lshlrev_b32 v104, 16, v55
    v_and_b32 v105, 0xffff0000, v55
    v_fmac_f32 v102, v104, v21
    v_fmac_f32 v103, v105, v21
    s_waitcnt vmcnt(9)
    v_lshlrev_b32 v104, 16, v56
    v_and_b32 v105, 0xffff0000, v56
    v_fmac_f32 v96, v104, v22
    v_fmac_f32 v97, v105, v22
    v_lshlrev_b32 v104, 16, v57
    v_and_b32 v105, 0xffff0000, v57
    v_fmac_f32 v98, v104, v22
    v_fmac_f32 v99, v105, v22
    v_lshlrev_b32 v104, 16, v58
    v_and_b32 v105, 0xffff0000, v58
    v_fmac_f32 v100, v104, v22
    v_fmac_f32 v101, v105, v22
    v_lshlrev_b32 v104, 16, v59
    v_and_b32 v105, 0xffff0000, v59
    v_fmac_f32 v102, v104, v22
    v_fmac_f32 v103, v105, v22
    s_waitcnt vmcnt(8)
    v_lshlrev_b32 v104, 16, v60
    v_and_b32 v105, 0xffff0000, v60
    v_fmac_f32 v96, v104, v23
    v_fmac_f32 v97, v105, v23
    v_lshlrev_b32 v104, 16, v61
    v_and_b32 v105, 0xffff0000, v61
    v_fmac_f32 v98, v104, v23
    v_fmac_f32 v99, v105, v23
    v_lshlrev_b32 v104, 16, v62
    v_and_b32 v105, 0xffff0000, v62
    v_fmac_f32 v100, v104, v23
    v_fmac_f32 v101, v105, v23
    v_lshlrev_b32 v104, 16, v63
    v_and_b32 v105, 0xffff0000, v63
    v_fmac_f32 v102, v104, v23
    v_fmac_f32 v103, v105, v23
    s_waitcnt vmcnt(7)
    v_lshlrev_b32 v104, 16, v64
    v_and_b32 v105, 0xffff0000, v64
    v_fmac_f32 v96, v104, v24
    v_fmac_f32 v97, v105, v24
    v_lshlrev_b32 v104, 16, v65
    v_and_b32 v105, 0xffff0000, v65
    v_fmac_f32 v98, v104, v24
    v_fmac_f32 v99, v105, v24
    v_lshlrev_b32 v104, 16, v66
    v_and_b32 v105, 0xffff0000, v66
    v_fmac_f32 v100, v104, v24
    v_fmac_f32 v101, v105, v24
    v_lshlrev_b32 v104, 16, v67
    v_and_b32 v105, 0xffff0000, v67
    v_fmac_f32 v102, v104, v24
    v_fmac_f32 v103, v105, v24
    s_waitcnt vmcnt(6)
    v_lshlrev_b32 v104, 16, v68
    v_and_b32 v105, 0xffff0000, v68
    v_fmac_f32 v96, v104, v25
    v_fmac_f32 v97, v105, v25
    v_lshlrev_b32 v104, 16, v69
    v_and_b32 v105, 0xffff0000, v69
    v_fmac_f32 v98, v104, v25
    v_fmac_f32 v99, v105, v25
    v_lshlrev_b32 v104, 16, v70
    v_and_b32 v105, 0xffff0000, v70
    v_fmac_f32 v100, v104, v25
    v_fmac_f32 v101, v105, v25
    v_lshlrev_b32 v104, 16, v71
    v_and_b32 v105, 0xffff0000, v71
    v_fmac_f32 v102, v104, v25
    v_fmac_f32 v103, v105, v25
    s_waitcnt vmcnt(5)
    v_lshlrev_b32 v104, 16, v72
    v_and_b32 v105, 0xffff0000, v72
    v_fmac_f32 v96, v104, v26
    v_fmac_f32 v97, v105, v26
    v_lshlrev_b32 v104, 16, v73
    v_and_b32 v105, 0xffff0000, v73
    v_fmac_f32 v98, v104, v26
    v_fmac_f32 v99, v105, v26
    v_lshlrev_b32 v104, 16, v74
    v_and_b32 v105, 0xffff0000, v74
    v_fmac_f32 v100, v104, v26
    v_fmac_f32 v101, v105, v26
    v_lshlrev_b32 v104, 16, v75
    v_and_b32 v105, 0xffff0000, v75
    v_fmac_f32 v102, v104, v26
    v_fmac_f32 v103, v105, v26
    s_waitcnt vmcnt(4)
    v_lshlrev_b32 v104, 16, v76
    v_and_b32 v105, 0xffff0000, v76
    v_fmac_f32 v96, v104, v27
    v_fmac_f32 v97, v105, v27
    v_lshlrev_b32 v104, 16, v77
    v_and_b32 v105, 0xffff0000, v77
    v_fmac_f32 v98, v104, v27
    v_fmac_f32 v99, v105, v27
    v_lshlrev_b32 v104, 16, v78
    v_and_b32 v105, 0xffff0000, v78
    v_fmac_f32 v100, v104, v27
    v_fmac_f32 v101, v105, v27
    v_lshlrev_b32 v104, 16, v79
    v_and_b32 v105, 0xffff0000, v79
    v_fmac_f32 v102, v104, v27
    v_fmac_f32 v103, v105, v27
    s_waitcnt vmcnt(3)
    v_lshlrev_b32 v104, 16, v80
    v_and_b32 v105, 0xffff0000, v80
    v_fmac_f32 v96, v104, v28
    v_fmac_f32 v97, v105, v28
    v_lshlrev_b32 v104, 16, v81
    v_and_b32 v105, 0xffff0000, v81
    v_fmac_f32 v98, v104, v28
    v_fmac_f32 v99, v105, v28
    v_lshlrev_b32 v104, 16, v82
    v_and_b32 v105, 0xffff0000, v82
    v_fmac_f32 v100, v104, v28
    v_fmac_f32 v101, v105, v28
    v_lshlrev_b32 v104, 16, v83
    v_and_b32 v105, 0xffff0000, v83
    v_fmac_f32 v102, v104, v28
    v_fmac_f32 v103, v105, v28
    s_waitcnt vmcnt(2)
    v_lshlrev_b32 v104, 16, v84
    v_and_b32 v105, 0xffff0000, v84
    v_fmac_f32 v96, v104, v29
    v_fmac_f32 v97, v105, v29
    v_lshlrev_b32 v104, 16, v85
    v_and_b32 v105, 0xffff0000, v85
    v_fmac_f32 v98, v104, v29
    v_fmac_f32 v99, v105, v29
    v_lshlrev_b32 v104, 16, v86
    v_and_b32 v105, 0xffff0000, v86
    v_fmac_f32 v100, v104, v29
    v_fmac_f32 v101, v105, v29
    v_lshlrev_b32 v104, 16, v87
    v_and_b32 v105, 0xffff0000, v87
    v_fmac_f32 v102, v104, v29
    v_fmac_f32 v103, v105, v29
    s_waitcnt vmcnt(1)
    v_lshlrev_b32 v104, 16, v88
    v_and_b32 v105, 0xffff0000, v88
    v_fmac_f32 v96, v104, v30
    v_fmac_f32 v97, v105, v30
    v_lshlrev_b32 v104, 16, v89
    v_and_b32 v105, 0xffff0000, v89
    v_fmac_f32 v98, v104, v30
    v_fmac_f32 v99, v105, v30
    v_lshlrev_b32 v104, 16, v90
    v_and_b32 v105, 0xffff0000, v90
    v_fmac_f32 v100, v104, v30
    v_fmac_f32 v101, v105, v30
    v_lshlrev_b32 v104, 16, v91
    v_and_b32 v105, 0xffff0000, v91
    v_fmac_f32 v102, v104, v30
    v_fmac_f32 v103, v105, v30
    s_waitcnt vmcnt(0)
    v_lshlrev_b32 v104, 16, v92
    v_and_b32 v105, 0xffff0000, v92
    v_fmac_f32 v96, v104, v31
    v_fmac_f32 v97, v105, v31
    v_lshlrev_b32 v104, 16, v93
    v_and_b32 v105, 0xffff0000, v93
    v_fmac_f32 v98, v104, v31
    v_fmac_f32 v99, v105, v31
    v_lshlrev_b32 v104, 16, v94
    v_and_b32 v105, 0xffff0000, v94
    v_fmac_f32 v100, v104, v31
    v_fmac_f32 v101, v105, v31
    v_lshlrev_b32 v104, 16, v95
    v_and_b32 v105, 0xffff0000, v95
    v_fmac_f32 v102, v104, v31
    v_fmac_f32 v103, v105, v31
    v_lshlrev_b32 v104, 5, v0
    ds_write_b128 v104, v[96:99]
    ds_write_b128 v104, v[100:103] offset:16
    v_lshlrev_b32 v105, 2, v1
    s_lshl_b32 s46, s44, 11
    v_add_u32 v104, s46, v105
    s_waitcnt lgkmcnt(0)
    ds_read_b32 v96, v104 offset:0
    ds_read_b32 v97, v104 offset:256
    ds_read_b32 v98, v104 offset:512
    ds_read_b32 v99, v104 offset:768
    ds_read_b32 v100, v104 offset:1024
    ds_read_b32 v101, v104 offset:1280
    ds_read_b32 v102, v104 offset:1536
    ds_read_b32 v103, v104 offset:1792
    s_waitcnt lgkmcnt(0)
    v_add_f32 v96, v96, v100
    v_add_f32 v97, v97, v101
    v_add_f32 v98, v98, v102
    v_add_f32 v99, v99, v103
    v_add_f32 v96, v96, v98
    v_add_f32 v97, v97, v99
    v_add_f32 v96, v96, v97
    v_lshlrev_b32 v104, 2, v0
    ds_write_b32 v104, v96 offset:16384
    s_waitcnt lgkmcnt(0)
    s_barrier
    s_cmp_lg_u32 s44, 0
    s_cbranch_scc1 L_m_sk_25
    ds_read_b32 v96, v105 offset:16384
    ds_read_b32 v97, v105 offset:16640
    ds_read_b32 v98, v105 offset:16896
    ds_read_b32 v99, v105 offset:17152
    ds_read_b32 v100, v105 offset:17408
    ds_read_b32 v101, v105 offset:17664
    ds_read_b32 v102, v105 offset:17920
    ds_read_b32 v103, v105 offset:18176
    s_waitcnt lgkmcnt(0)
    v_add_f32 v96, v96, v100
    v_add_f32 v97, v97, v101
    v_add_f32 v98, v98, v102
    v_add_f32 v99, v99, v103
    v_add_f32 v96, v96, v98
    v_add_f32 v97, v97, v99
    v_add_f32 v96, v96, v97
    v_cvt_pk_bf16_f32 v96, 0, v96
    s_lshl_b32 s46, s53, 1
    buffer_store_dword v96, v105, s[12:15], s46 offen sc1
L_m_sk_25:
    s_barrier
    s_add_u32 s53, s53, 128
    s_and_b32 s46, s53, 511
    s_cmp_lg_u32 s46, 0
    s_cbranch_scc1 L_m_loop_24
    s_lshl_b32 s54, s55, 7
    s_add_u32 s54, s54, 0x10e400
    s_mov_b32 s60, 0
    s_waitcnt vmcnt(0)
    s_cmp_lg_u32 s44, 0
    s_cbranch_scc1 L_sf_26
    v_mov_b32 v8, s60
    v_add_u32 v8, 1, v8
    v_mov_b32 v9, 0
    s_mov_b64 exec, 1
    buffer_store_dword v8, v9, s[12:15], s54 offen sc1
    s_mov_b64 exec, -1
L_sf_26:
    s_barrier
L_w_h_17_s:
    s_mov_b32 s77, s48
    s_cmp_eq_u32 s48, 14
    s_cselect_b32 s53, 2, 1
    s_sub_u32 s48, s48, 12
    s_min_u32 s48, s48, 2
    s_mov_b32 s79, 0
L_w_h_17_n:
    s_cmp_eq_u32 s53, 1
    s_cselect_b32 s74, 44, 55
    s_cselect_b32 s75, 64, 64
    s_mov_b32 s76, 65536
    s_branch L_w_g_10_e
L_w_h_17:
    s_mov_b32 s48, s77
    s_cmp_lt_u32 s48, 14
    s_cbranch_scc1 L_w_att_15
    s_and_b32 s42, s40, 3
    s_lshr_b32 s43, s40, 2
    s_cmp_eq_u32 s48, 14
    s_cbranch_scc1 L_w_c_16
    s_mov_b32 s75, 59
    s_mov_b32 s76, 0
    s_mov_b32 s78, 2
L_w_h_17_f:
    s_load_dwordx2 s[4:5], s[0:1], 112
    s_load_dwordx2 s[6:7], s[0:1], 88
    v_lshlrev_b32 v2, 4, v1
    v_lshlrev_b32 v3, 5, v1
    s_waitcnt lgkmcnt(0)
    s_mov_b32 s24, s4
    s_and_b32 s25, s5, 0xffff
    s_mov_b32 s26, 0x400000
    s_mov_b32 s27, 0x00020000
    s_mov_b32 s28, s6
    s_and_b32 s29, s7, 0xffff
    s_mov_b32 s30, 0x800
    s_mov_b32 s31, 0x00020000
    s_cmp_lg_u32 s44, 0
    s_cbranch_scc1 L_mw_27
    v_and_b32 v8, 15, v1
    v_lshlrev_b32 v8, 7, v8
    s_mov_b32 s46, 0x10e400
    s_mov_b32 s47, 0
    s_mov_b32 s70, 0
L_spin_28:
    buffer_load_dword v9, v8, s[12:15], s46 offen sc1
    s_waitcnt vmcnt(0)
    v_cmp_ge_u32 vcc, s47, v9
    s_add_u32 s70, s70, 1
    s_cbranch_vccz L_spok_29
    s_sleep 2
    s_cmp_lt_u32 s70, 524288
    s_cbranch_scc1 L_spin_28
    s_branch L_c_done_1
L_spok_29:
L_mw_27:
    s_barrier
    s_mov_b32 s46, 20480
    buffer_load_dwordx4 v[16:19], v3, s[12:15], s46 offen offset:0 sc1
    buffer_load_dwordx4 v[20:23], v3, s[12:15], s46 offen offset:16 sc1
    buffer_load_dwordx4 v[24:27], v3, s[12:15], s46 offen offset:2048 sc1
    buffer_load_dwordx4 v[28:31], v3, s[12:15], s46 offen offset:2064 sc1
    buffer_load_dwordx4 v[48:51], v2, s[28:31], 0 offen
    buffer_load_dwordx4 v[52:55], v2, s[28:31], 0 offen offset:1024
    s_waitcnt vmcnt(0)
    v_lshlrev_b32 v32, 16, v48
    v_and_b32 v33, 0xffff0000, v48
    v_lshlrev_b32 v34, 16, v49
    v_and_b32 v35, 0xffff0000, v49
    v_lshlrev_b32 v36, 16, v50
    v_and_b32 v37, 0xffff0000, v50
    v_lshlrev_b32 v38, 16, v51
    v_and_b32 v39, 0xffff0000, v51
    v_lshlrev_b32 v40, 16, v52
    v_and_b32 v41, 0xffff0000, v52
    v_lshlrev_b32 v42, 16, v53
    v_and_b32 v43, 0xffff0000, v53
    v_lshlrev_b32 v44, 16, v54
    v_and_b32 v45, 0xffff0000, v54
    v_lshlrev_b32 v46, 16, v55
    v_and_b32 v47, 0xffff0000, v55
    s_lshl_b32 s46, s42, 14
    s_lshl_b32 s47, s44, 11
    s_add_u32 s46, s46, s47
    s_add_u32 s46, s46, 0xb000000
    v_add_u32 v4, s46, v2
    v_and_b32 v5, 31, v1
    v_lshlrev_b32 v5, 7, v5
    v_add_u32 v5, 0x108400, v5
    v_lshlrev_b32 v6, 2, v1
    s_lshl_b32 s46, s44, 9
    v_add_u32 v6, s46, v6
    s_lshl_b32 s46, s44, 12
    v_add_u32 v7, s46, v3
    s_lshl_b32 s46, s42, 3
    s_add_u32 s46, s46, s44
    s_lshl_b32 s46, s46, 11
    v_add_u32 v8, s46, v2
    v_add_u32 v9, 0x800000, v8
    s_mov_b32 s60, s43
L_r_loop_30:
    s_lshl_b32 s61, s60, 18
    s_lshl_b32 s63, s60, 16
    s_cmp_lg_u32 s44, 0
    s_cbranch_scc1 L_r_nsp_31
    s_mov_b32 s70, 0
L_spin_32:
    buffer_load_dword v14, v5, s[12:15], s76 offen sc1
    s_waitcnt vmcnt(0)
    v_cmp_ge_u32 vcc, s60, v14
    s_add_u32 s70, s70, 1
    s_cbranch_vccz L_spok_33
    s_sleep 3
    s_cmp_lt_u32 s70, 524288
    s_cbranch_scc1 L_spin_32
    s_branch L_c_done_1
L_spok_33:
L_r_nsp_31:
    s_barrier
    buffer_load_dwordx4 v[96:99], v4, s[12:15], s61 offen offset:0 sc1
    buffer_load_dwordx4 v[100:103], v4, s[12:15], s61 offen offset:1024 sc1
    s_add_u32 s61, s61, 65536
    buffer_load_dwordx4 v[104:107], v4, s[12:15], s61 offen offset:0 sc1
    buffer_load_dwordx4 v[108:111], v4, s[12:15], s61 offen offset:1024 sc1
    s_add_u32 s61, s61, 65536
    buffer_load_dwordx4 v[112:115], v4, s[12:15], s61 offen offset:0 sc1
    buffer_load_dwordx4 v[116:119], v4, s[12:15], s61 offen offset:1024 sc1
    s_add_u32 s61, s61, 65536
    buffer_load_dwordx4 v[120:123], v4, s[12:15], s61 offen offset:0 sc1
    buffer_load_dwordx4 v[124:127], v4, s[12:15], s61 offen offset:1024 sc1
    buffer_load_dwordx4 a[0:3], v9, s[12:15], s63 offen sc1
    buffer_load_dwordx4 a[4:7], v9, s[12:15], s63 offen offset:1024 sc1
    s_waitcnt vmcnt(8)
    v_lshlrev_b32 v64, 16, v96
    v_and_b32 v65, 0xffff0000, v96
    v_lshlrev_b32 v66, 16, v97
    v_and_b32 v67, 0xffff0000, v97
    v_lshlrev_b32 v68, 16, v98
    v_and_b32 v69, 0xffff0000, v98
    v_lshlrev_b32 v70, 16, v99
    v_and_b32 v71, 0xffff0000, v99
    v_lshlrev_b32 v72, 16, v100
    v_and_b32 v73, 0xffff0000, v100
    v_lshlrev_b32 v74, 16, v101
    v_and_b32 v75, 0xffff0000, v101
    v_lshlrev_b32 v76, 16, v102
    v_and_b32 v77, 0xffff0000, v102
    v_lshlrev_b32 v78, 16, v103
    v_and_b32 v79, 0xffff0000, v103
    s_waitcnt vmcnt(6)
    v_lshlrev_b32 v80, 16, v104
    v_and_b32 v81, 0xffff0000, v104
    v_lshlrev_b32 v82, 16, v105
    v_and_b32 v83, 0xffff0000, v105
    v_lshlrev_b32 v84, 16, v106
    v_and_b32 v85, 0xffff0000, v106
    v_lshlrev_b32 v86, 16, v107
    v_and_b32 v87, 0xffff0000, v107
    v_lshlrev_b32 v88, 16, v108
    v_and_b32 v89, 0xffff0000, v108
    v_lshlrev_b32 v90, 16, v109
    v_and_b32 v91, 0xffff0000, v109
    v_lshlrev_b32 v92, 16, v110
    v_and_b32 v93, 0xffff0000, v110
    v_lshlrev_b32 v94, 16, v111
    v_and_b32 v95, 0xffff0000, v111
    v_pk_add_f32 v[64:65], v[64:65], v[80:81]
    v_pk_add_f32 v[66:67], v[66:67], v[82:83]
    v_pk_add_f32 v[68:69], v[68:69], v[84:85]
    v_pk_add_f32 v[70:71], v[70:71], v[86:87]
    v_pk_add_f32 v[72:73], v[72:73], v[88:89]
    v_pk_add_f32 v[74:75], v[74:75], v[90:91]
    v_pk_add_f32 v[76:77], v[76:77], v[92:93]
    v_pk_add_f32 v[78:79], v[78:79], v[94:95]
    s_waitcnt vmcnt(4)
    v_lshlrev_b32 v80, 16, v112
    v_and_b32 v81, 0xffff0000, v112
    v_lshlrev_b32 v82, 16, v113
    v_and_b32 v83, 0xffff0000, v113
    v_lshlrev_b32 v84, 16, v114
    v_and_b32 v85, 0xffff0000, v114
    v_lshlrev_b32 v86, 16, v115
    v_and_b32 v87, 0xffff0000, v115
    v_lshlrev_b32 v88, 16, v116
    v_and_b32 v89, 0xffff0000, v116
    v_lshlrev_b32 v90, 16, v117
    v_and_b32 v91, 0xffff0000, v117
    v_lshlrev_b32 v92, 16, v118
    v_and_b32 v93, 0xffff0000, v118
    v_lshlrev_b32 v94, 16, v119
    v_and_b32 v95, 0xffff0000, v119
    v_pk_add_f32 v[64:65], v[64:65], v[80:81]
    v_pk_add_f32 v[66:67], v[66:67], v[82:83]
    v_pk_add_f32 v[68:69], v[68:69], v[84:85]
    v_pk_add_f32 v[70:71], v[70:71], v[86:87]
    v_pk_add_f32 v[72:73], v[72:73], v[88:89]
    v_pk_add_f32 v[74:75], v[74:75], v[90:91]
    v_pk_add_f32 v[76:77], v[76:77], v[92:93]
    v_pk_add_f32 v[78:79], v[78:79], v[94:95]
    s_waitcnt vmcnt(2)
    v_lshlrev_b32 v80, 16, v120
    v_and_b32 v81, 0xffff0000, v120
    v_lshlrev_b32 v82, 16, v121
    v_and_b32 v83, 0xffff0000, v121
    v_lshlrev_b32 v84, 16, v122
    v_and_b32 v85, 0xffff0000, v122
    v_lshlrev_b32 v86, 16, v123
    v_and_b32 v87, 0xffff0000, v123
    v_lshlrev_b32 v88, 16, v124
    v_and_b32 v89, 0xffff0000, v124
    v_lshlrev_b32 v90, 16, v125
    v_and_b32 v91, 0xffff0000, v125
    v_lshlrev_b32 v92, 16, v126
    v_and_b32 v93, 0xffff0000, v126
    v_lshlrev_b32 v94, 16, v127
    v_and_b32 v95, 0xffff0000, v127
    v_pk_add_f32 v[64:65], v[64:65], v[80:81]
    v_pk_add_f32 v[66:67], v[66:67], v[82:83]
    v_pk_add_f32 v[68:69], v[68:69], v[84:85]
    v_pk_add_f32 v[70:71], v[70:71], v[86:87]
    v_pk_add_f32 v[72:73], v[72:73], v[88:89]
    v_pk_add_f32 v[74:75], v[74:75], v[90:91]
    v_pk_add_f32 v[76:77], v[76:77], v[92:93]
    v_pk_add_f32 v[78:79], v[78:79], v[94:95]
    ds_write_b32 v6, v64 offset:0
    ds_write_b32 v6, v65 offset:4096
    ds_write_b32 v6, v66 offset:8192
    ds_write_b32 v6, v67 offset:12288
    ds_write_b32 v6, v68 offset:16384
    ds_write_b32 v6, v69 offset:20480
    ds_write_b32 v6, v70 offset:24576
    ds_write_b32 v6, v71 offset:28672
    ds_write_b32 v6, v72 offset:256
    ds_write_b32 v6, v73 offset:4352
    ds_write_b32 v6, v74 offset:8448
    ds_write_b32 v6, v75 offset:12544
    ds_write_b32 v6, v76 offset:16640
    ds_write_b32 v6, v77 offset:20736
    ds_write_b32 v6, v78 offset:24832
    ds_write_b32 v6, v79 offset:28928
    s_waitcnt lgkmcnt(0)
    s_barrier
    ds_read_b128 v[64:67], v7
    ds_read_b128 v[68:71], v7 offset:16
    ds_read_b128 v[72:75], v7 offset:2048
    ds_read_b128 v[76:79], v7 offset:2064
    s_waitcnt vmcnt(0)
    v_accvgpr_read_b32 v96, a0
    v_accvgpr_read_b32 v97, a1
    v_accvgpr_read_b32 v98, a2
    v_accvgpr_read_b32 v99, a3
    v_accvgpr_read_b32 v100, a4
    v_accvgpr_read_b32 v101, a5
    v_accvgpr_read_b32 v102, a6
    v_accvgpr_read_b32 v103, a7
    v_lshlrev_b32 v80, 16, v96
    v_and_b32 v81, 0xffff0000, v96
    v_lshlrev_b32 v82, 16, v97
    v_and_b32 v83, 0xffff0000, v97
    v_lshlrev_b32 v84, 16, v98
    v_and_b32 v85, 0xffff0000, v98
    v_lshlrev_b32 v86, 16, v99
    v_and_b32 v87, 0xffff0000, v99
    v_lshlrev_b32 v88, 16, v100
    v_and_b32 v89, 0xffff0000, v100
    v_lshlrev_b32 v90, 16, v101
    v_and_b32 v91, 0xffff0000, v101
    v_lshlrev_b32 v92, 16, v102
    v_and_b32 v93, 0xffff0000, v102
    v_lshlrev_b32 v94, 16, v103
    v_and_b32 v95, 0xffff0000, v103
    s_waitcnt lgkmcnt(0)
    v_cvt_pk_bf16_f32 v64, 0, v64
    v_cvt_pk_bf16_f32 v65, 0, v65
    v_cvt_pk_bf16_f32 v66, 0, v66
    v_cvt_pk_bf16_f32 v67, 0, v67
    v_cvt_pk_bf16_f32 v68, 0, v68
    v_cvt_pk_bf16_f32 v69, 0, v69
    v_cvt_pk_bf16_f32 v70, 0, v70
    v_cvt_pk_bf16_f32 v71, 0, v71
    v_cvt_pk_bf16_f32 v72, 0, v72
    v_cvt_pk_bf16_f32 v73, 0, v73
    v_cvt_pk_bf16_f32 v74, 0, v74
    v_cvt_pk_bf16_f32 v75, 0, v75
    v_cvt_pk_bf16_f32 v76, 0, v76
    v_cvt_pk_bf16_f32 v77, 0, v77
    v_cvt_pk_bf16_f32 v78, 0, v78
    v_cvt_pk_bf16_f32 v79, 0, v79
    v_pk_add_f32 v[64:65], v[64:65], v[32:33]
    v_pk_add_f32 v[66:67], v[66:67], v[34:35]
    v_pk_add_f32 v[68:69], v[68:69], v[36:37]
    v_pk_add_f32 v[70:71], v[70:71], v[38:39]
    v_pk_add_f32 v[72:73], v[72:73], v[40:41]
    v_pk_add_f32 v[74:75], v[74:75], v[42:43]
    v_pk_add_f32 v[76:77], v[76:77], v[44:45]
    v_pk_add_f32 v[78:79], v[78:79], v[46:47]
    v_cvt_pk_bf16_f32 v64, 0, v64
    v_cvt_pk_bf16_f32 v65, 0, v65
    v_cvt_pk_bf16_f32 v66, 0, v66
    v_cvt_pk_bf16_f32 v67, 0, v67
    v_cvt_pk_bf16_f32 v68, 0, v68
    v_cvt_pk_bf16_f32 v69, 0, v69
    v_cvt_pk_bf16_f32 v70, 0, v70
    v_cvt_pk_bf16_f32 v71, 0, v71
    v_cvt_pk_bf16_f32 v72, 0, v72
    v_cvt_pk_bf16_f32 v73, 0, v73
    v_cvt_pk_bf16_f32 v74, 0, v74
    v_cvt_pk_bf16_f32 v75, 0, v75
    v_cvt_pk_bf16_f32 v76, 0, v76
    v_cvt_pk_bf16_f32 v77, 0, v77
    v_cvt_pk_bf16_f32 v78, 0, v78
    v_cvt_pk_bf16_f32 v79, 0, v79
    v_pk_mul_f32 v[64:65], v[64:65], v[16:17]
    v_pk_mul_f32 v[66:67], v[66:67], v[18:19]
    v_pk_mul_f32 v[68:69], v[68:69], v[20:21]
    v_pk_mul_f32 v[70:71], v[70:71], v[22:23]
    v_pk_mul_f32 v[72:73], v[72:73], v[24:25]
    v_pk_mul_f32 v[74:75], v[74:75], v[26:27]
    v_pk_mul_f32 v[76:77], v[76:77], v[28:29]
    v_pk_mul_f32 v[78:79], v[78:79], v[30:31]
    v_cvt_pk_bf16_f32 v64, 0, v64
    v_cvt_pk_bf16_f32 v65, 0, v65
    v_cvt_pk_bf16_f32 v66, 0, v66
    v_cvt_pk_bf16_f32 v67, 0, v67
    v_cvt_pk_bf16_f32 v68, 0, v68
    v_cvt_pk_bf16_f32 v69, 0, v69
    v_cvt_pk_bf16_f32 v70, 0, v70
    v_cvt_pk_bf16_f32 v71, 0, v71
    v_cvt_pk_bf16_f32 v72, 0, v72
    v_cvt_pk_bf16_f32 v73, 0, v73
    v_cvt_pk_bf16_f32 v74, 0, v74
    v_cvt_pk_bf16_f32 v75, 0, v75
    v_cvt_pk_bf16_f32 v76, 0, v76
    v_cvt_pk_bf16_f32 v77, 0, v77
    v_cvt_pk_bf16_f32 v78, 0, v78
    v_cvt_pk_bf16_f32 v79, 0, v79
    v_pk_add_f32 v[64:65], v[64:65], v[80:81]
    v_pk_add_f32 v[66:67], v[66:67], v[82:83]
    v_pk_add_f32 v[68:69], v[68:69], v[84:85]
    v_pk_add_f32 v[70:71], v[70:71], v[86:87]
    v_pk_add_f32 v[72:73], v[72:73], v[88:89]
    v_pk_add_f32 v[74:75], v[74:75], v[90:91]
    v_pk_add_f32 v[76:77], v[76:77], v[92:93]
    v_pk_add_f32 v[78:79], v[78:79], v[94:95]
    v_cvt_pk_bf16_f32 v96, v64, v65
    v_cvt_pk_bf16_f32 v97, v66, v67
    v_cvt_pk_bf16_f32 v98, v68, v69
    v_cvt_pk_bf16_f32 v99, v70, v71
    v_cvt_pk_bf16_f32 v100, v72, v73
    v_cvt_pk_bf16_f32 v101, v74, v75
    v_cvt_pk_bf16_f32 v102, v76, v77
    v_cvt_pk_bf16_f32 v103, v78, v79
    buffer_store_dwordx4 v[96:99], v8, s[24:27], s63 offen
    buffer_store_dwordx4 v[100:103], v8, s[24:27], s63 offen offset:1024
    s_add_u32 s60, s60, s78
    s_cmp_lt_u32 s60, s75
    s_cbranch_scc1 L_r_loop_30
    s_branch L_c_done_1
L_w_c_16:
    s_load_dwordx2 s[4:5], s[0:1], 0
    s_load_dwordx2 s[6:7], s[0:1], 88
    v_lshlrev_b32 v2, 4, v1
    v_lshlrev_b32 v3, 5, v1
    s_waitcnt lgkmcnt(0)
    s_mov_b32 s24, s4
    s_and_b32 s25, s5, 0xffff
    s_mov_b32 s26, 0x400000
    s_mov_b32 s27, 0x00020000
    s_mov_b32 s28, s6
    s_and_b32 s29, s7, 0xffff
    s_mov_b32 s30, 0x800
    s_mov_b32 s31, 0x00020000
    s_cmp_lg_u32 s44, 0
    s_cbranch_scc1 L_mw_34
    v_and_b32 v8, 15, v1
    v_lshlrev_b32 v8, 7, v8
    s_mov_b32 s46, 0x10e400
    s_mov_b32 s47, 0
    s_mov_b32 s70, 0
L_spin_35:
    buffer_load_dword v9, v8, s[12:15], s46 offen sc1
    s_waitcnt vmcnt(0)
    v_cmp_ge_u32 vcc, s47, v9
    s_add_u32 s70, s70, 1
    s_cbranch_vccz L_spok_36
    s_sleep 2
    s_cmp_lt_u32 s70, 524288
    s_cbranch_scc1 L_spin_35
    s_branch L_c_done_1
L_spok_36:
L_mw_34:
    s_barrier
    s_mov_b32 s46, 8192
    buffer_load_dwordx4 v[16:19], v3, s[12:15], s46 offen offset:0 sc1
    buffer_load_dwordx4 v[20:23], v3, s[12:15], s46 offen offset:16 sc1
    buffer_load_dwordx4 v[24:27], v3, s[12:15], s46 offen offset:2048 sc1
    buffer_load_dwordx4 v[28:31], v3, s[12:15], s46 offen offset:2064 sc1
    s_mov_b32 s46, 16384
    buffer_load_dwordx4 v[32:35], v3, s[12:15], s46 offen offset:0 sc1
    buffer_load_dwordx4 v[36:39], v3, s[12:15], s46 offen offset:16 sc1
    buffer_load_dwordx4 v[40:43], v3, s[12:15], s46 offen offset:2048 sc1
    buffer_load_dwordx4 v[44:47], v3, s[12:15], s46 offen offset:2064 sc1
    s_mov_b32 s46, 12288
    buffer_load_dwordx4 v[48:51], v3, s[12:15], s46 offen offset:0 sc1
    buffer_load_dwordx4 v[52:55], v3, s[12:15], s46 offen offset:16 sc1
    buffer_load_dwordx4 v[56:59], v3, s[12:15], s46 offen offset:2048 sc1
    buffer_load_dwordx4 v[60:63], v3, s[12:15], s46 offen offset:2064 sc1
    s_waitcnt vmcnt(0)
    v_add_f32 v32, 1.0, v32
    v_add_f32 v33, 1.0, v33
    v_add_f32 v34, 1.0, v34
    v_add_f32 v35, 1.0, v35
    v_add_f32 v36, 1.0, v36
    v_add_f32 v37, 1.0, v37
    v_add_f32 v38, 1.0, v38
    v_add_f32 v39, 1.0, v39
    v_add_f32 v40, 1.0, v40
    v_add_f32 v41, 1.0, v41
    v_add_f32 v42, 1.0, v42
    v_add_f32 v43, 1.0, v43
    v_add_f32 v44, 1.0, v44
    v_add_f32 v45, 1.0, v45
    v_add_f32 v46, 1.0, v46
    v_add_f32 v47, 1.0, v47
    v_cvt_pk_bf16_f32 v32, 0, v32
    v_cvt_pk_bf16_f32 v33, 0, v33
    v_cvt_pk_bf16_f32 v34, 0, v34
    v_cvt_pk_bf16_f32 v35, 0, v35
    v_cvt_pk_bf16_f32 v36, 0, v36
    v_cvt_pk_bf16_f32 v37, 0, v37
    v_cvt_pk_bf16_f32 v38, 0, v38
    v_cvt_pk_bf16_f32 v39, 0, v39
    v_cvt_pk_bf16_f32 v40, 0, v40
    v_cvt_pk_bf16_f32 v41, 0, v41
    v_cvt_pk_bf16_f32 v42, 0, v42
    v_cvt_pk_bf16_f32 v43, 0, v43
    v_cvt_pk_bf16_f32 v44, 0, v44
    v_cvt_pk_bf16_f32 v45, 0, v45
    v_cvt_pk_bf16_f32 v46, 0, v46
    v_cvt_pk_bf16_f32 v47, 0, v47
    s_lshl_b32 s46, s42, 14
    s_lshl_b32 s47, s44, 11
    s_add_u32 s46, s46, s47
    s_add_u32 s46, s46, 0x9000000
    v_add_u32 v4, s46, v2
    v_and_b32 v5, 31, v1
    v_lshlrev_b32 v5, 7, v5
    v_add_u32 v5, 0x107400, v5
    v_lshlrev_b32 v6, 2, v1
    s_lshl_b32 s46, s44, 9
    v_add_u32 v6, s46, v6
    s_lshl_b32 s46, s44, 12
    v_add_u32 v7, s46, v3
    s_lshl_b32 s46, s42, 3
    s_add_u32 s46, s46, s44
    s_lshl_b32 s46, s46, 11
    v_add_u32 v8, s46, v2
    v_add_u32 v9, 0x800000, v8
    s_mul_i32 s46, s44, 2064
    s_add_u32 s46, s46, 32768
    v_add_u32 v10, s46, v2
    v_and_b32 v11, 7, v1
    v_lshrrev_b32 v12, 3, v1
    v_mul_u32_u24 v13, 2064, v11
    v_lshl_add_u32 v13, v12, 4, v13
    s_lshl_b32 s46, s44, 8
    s_add_u32 s46, s46, 32768
    v_add_u32 v13, s46, v13
    v_lshlrev_b32 v11, 4, v11
    v_lshl_add_u32 v11, v12, 9, v11
    s_lshl_b32 s46, s44, 13
    s_lshl_b32 s47, s42, 7
    s_add_u32 s46, s46, s47
    s_add_u32 s46, s46, 0xc00000
    v_add_u32 v11, s46, v11
    v_add_u32 v12, 4096, v11
    s_lshl_b32 s52, s43, 9
    s_lshl_b32 s47, s42, 7
    s_add_u32 s52, s52, s47
    s_add_u32 s52, s52, 0x10ec00
    s_mov_b32 s60, s43
L_r_loop_37:
    s_lshl_b32 s61, s60, 18
    s_lshl_b32 s63, s60, 16
    buffer_load_dwordx4 a[0:3], v8, s[24:27], s63 offen
    buffer_load_dwordx4 a[4:7], v8, s[24:27], s63 offen offset:1024
    s_cmp_lg_u32 s44, 0
    s_cbranch_scc1 L_r_nsp_38
    s_mov_b32 s70, 0
L_spin_39:
    buffer_load_dword v14, v5, s[12:15], 0 offen sc1
    s_waitcnt vmcnt(0)
    v_cmp_ge_u32 vcc, s60, v14
    s_add_u32 s70, s70, 1
    s_cbranch_vccz L_spok_40
    s_sleep 3
    s_cmp_lt_u32 s70, 524288
    s_cbranch_scc1 L_spin_39
    s_branch L_c_done_1
L_spok_40:
L_r_nsp_38:
    s_barrier
    buffer_load_dwordx4 v[96:99], v4, s[12:15], s61 offen offset:0 sc1
    buffer_load_dwordx4 v[100:103], v4, s[12:15], s61 offen offset:1024 sc1
    s_add_u32 s61, s61, 65536
    buffer_load_dwordx4 v[104:107], v4, s[12:15], s61 offen offset:0 sc1
    buffer_load_dwordx4 v[108:111], v4, s[12:15], s61 offen offset:1024 sc1
    s_add_u32 s61, s61, 65536
    buffer_load_dwordx4 v[112:115], v4, s[12:15], s61 offen offset:0 sc1
    buffer_load_dwordx4 v[116:119], v4, s[12:15], s61 offen offset:1024 sc1
    s_add_u32 s61, s61, 65536
    buffer_load_dwordx4 v[120:123], v4, s[12:15], s61 offen offset:0 sc1
    buffer_load_dwordx4 v[124:127], v4, s[12:15], s61 offen offset:1024 sc1
    s_waitcnt vmcnt(6)
    v_lshlrev_b32 v64, 16, v96
    v_and_b32 v65, 0xffff0000, v96
    v_lshlrev_b32 v66, 16, v97
    v_and_b32 v67, 0xffff0000, v97
    v_lshlrev_b32 v68, 16, v98
    v_and_b32 v69, 0xffff0000, v98
    v_lshlrev_b32 v70, 16, v99
    v_and_b32 v71, 0xffff0000, v99
    v_lshlrev_b32 v72, 16, v100
    v_and_b32 v73, 0xffff0000, v100
    v_lshlrev_b32 v74, 16, v101
    v_and_b32 v75, 0xffff0000, v101
    v_lshlrev_b32 v76, 16, v102
    v_and_b32 v77, 0xffff0000, v102
    v_lshlrev_b32 v78, 16, v103
    v_and_b32 v79, 0xffff0000, v103
    s_waitcnt vmcnt(4)
    v_lshlrev_b32 v80, 16, v104
    v_and_b32 v81, 0xffff0000, v104
    v_lshlrev_b32 v82, 16, v105
    v_and_b32 v83, 0xffff0000, v105
    v_lshlrev_b32 v84, 16, v106
    v_and_b32 v85, 0xffff0000, v106
    v_lshlrev_b32 v86, 16, v107
    v_and_b32 v87, 0xffff0000, v107
    v_lshlrev_b32 v88, 16, v108
    v_and_b32 v89, 0xffff0000, v108
    v_lshlrev_b32 v90, 16, v109
    v_and_b32 v91, 0xffff0000, v109
    v_lshlrev_b32 v92, 16, v110
    v_and_b32 v93, 0xffff0000, v110
    v_lshlrev_b32 v94, 16, v111
    v_and_b32 v95, 0xffff0000, v111
    v_pk_add_f32 v[64:65], v[64:65], v[80:81]
    v_pk_add_f32 v[66:67], v[66:67], v[82:83]
    v_pk_add_f32 v[68:69], v[68:69], v[84:85]
    v_pk_add_f32 v[70:71], v[70:71], v[86:87]
    v_pk_add_f32 v[72:73], v[72:73], v[88:89]
    v_pk_add_f32 v[74:75], v[74:75], v[90:91]
    v_pk_add_f32 v[76:77], v[76:77], v[92:93]
    v_pk_add_f32 v[78:79], v[78:79], v[94:95]
    s_waitcnt vmcnt(2)
    v_lshlrev_b32 v80, 16, v112
    v_and_b32 v81, 0xffff0000, v112
    v_lshlrev_b32 v82, 16, v113
    v_and_b32 v83, 0xffff0000, v113
    v_lshlrev_b32 v84, 16, v114
    v_and_b32 v85, 0xffff0000, v114
    v_lshlrev_b32 v86, 16, v115
    v_and_b32 v87, 0xffff0000, v115
    v_lshlrev_b32 v88, 16, v116
    v_and_b32 v89, 0xffff0000, v116
    v_lshlrev_b32 v90, 16, v117
    v_and_b32 v91, 0xffff0000, v117
    v_lshlrev_b32 v92, 16, v118
    v_and_b32 v93, 0xffff0000, v118
    v_lshlrev_b32 v94, 16, v119
    v_and_b32 v95, 0xffff0000, v119
    v_pk_add_f32 v[64:65], v[64:65], v[80:81]
    v_pk_add_f32 v[66:67], v[66:67], v[82:83]
    v_pk_add_f32 v[68:69], v[68:69], v[84:85]
    v_pk_add_f32 v[70:71], v[70:71], v[86:87]
    v_pk_add_f32 v[72:73], v[72:73], v[88:89]
    v_pk_add_f32 v[74:75], v[74:75], v[90:91]
    v_pk_add_f32 v[76:77], v[76:77], v[92:93]
    v_pk_add_f32 v[78:79], v[78:79], v[94:95]
    s_waitcnt vmcnt(0)
    v_lshlrev_b32 v80, 16, v120
    v_and_b32 v81, 0xffff0000, v120
    v_lshlrev_b32 v82, 16, v121
    v_and_b32 v83, 0xffff0000, v121
    v_lshlrev_b32 v84, 16, v122
    v_and_b32 v85, 0xffff0000, v122
    v_lshlrev_b32 v86, 16, v123
    v_and_b32 v87, 0xffff0000, v123
    v_lshlrev_b32 v88, 16, v124
    v_and_b32 v89, 0xffff0000, v124
    v_lshlrev_b32 v90, 16, v125
    v_and_b32 v91, 0xffff0000, v125
    v_lshlrev_b32 v92, 16, v126
    v_and_b32 v93, 0xffff0000, v126
    v_lshlrev_b32 v94, 16, v127
    v_and_b32 v95, 0xffff0000, v127
    v_pk_add_f32 v[64:65], v[64:65], v[80:81]
    v_pk_add_f32 v[66:67], v[66:67], v[82:83]
    v_pk_add_f32 v[68:69], v[68:69], v[84:85]
    v_pk_add_f32 v[70:71], v[70:71], v[86:87]
    v_pk_add_f32 v[72:73], v[72:73], v[88:89]
    v_pk_add_f32 v[74:75], v[74:75], v[90:91]
    v_pk_add_f32 v[76:77], v[76:77], v[92:93]
    v_pk_add_f32 v[78:79], v[78:79], v[94:95]
    ds_write_b32 v6, v64 offset:0
    ds_write_b32 v6, v65 offset:4096
    ds_write_b32 v6, v66 offset:8192
    ds_write_b32 v6, v67 offset:12288
    ds_write_b32 v6, v68 offset:16384
    ds_write_b32 v6, v69 offset:20480
    ds_write_b32 v6, v70 offset:24576
    ds_write_b32 v6, v71 offset:28672
    ds_write_b32 v6, v72 offset:256
    ds_write_b32 v6, v73 offset:4352
    ds_write_b32 v6, v74 offset:8448
    ds_write_b32 v6, v75 offset:12544
    ds_write_b32 v6, v76 offset:16640
    ds_write_b32 v6, v77 offset:20736
    ds_write_b32 v6, v78 offset:24832
    ds_write_b32 v6, v79 offset:28928
    s_waitcnt lgkmcnt(0)
    s_barrier
    ds_read_b128 v[64:67], v7
    ds_read_b128 v[68:71], v7 offset:16
    ds_read_b128 v[72:75], v7 offset:2048
    ds_read_b128 v[76:79], v7 offset:2064
    s_waitcnt vmcnt(0)
    v_accvgpr_read_b32 v96, a0
    v_accvgpr_read_b32 v97, a1
    v_accvgpr_read_b32 v98, a2
    v_accvgpr_read_b32 v99, a3
    v_accvgpr_read_b32 v100, a4
    v_accvgpr_read_b32 v101, a5
    v_accvgpr_read_b32 v102, a6
    v_accvgpr_read_b32 v103, a7
    v_lshlrev_b32 v80, 16, v96
    v_and_b32 v81, 0xffff0000, v96
    v_lshlrev_b32 v82, 16, v97
    v_and_b32 v83, 0xffff0000, v97
    v_lshlrev_b32 v84, 16, v98
    v_and_b32 v85, 0xffff0000, v98
    v_lshlrev_b32 v86, 16, v99
    v_and_b32 v87, 0xffff0000, v99
    v_lshlrev_b32 v88, 16, v100
    v_and_b32 v89, 0xffff0000, v100
    v_lshlrev_b32 v90, 16, v101
    v_and_b32 v91, 0xffff0000, v101
    v_lshlrev_b32 v92, 16, v102
    v_and_b32 v93, 0xffff0000, v102
    v_lshlrev_b32 v94, 16, v103
    v_and_b32 v95, 0xffff0000, v103
    s_waitcnt lgkmcnt(0)
    v_cvt_pk_bf16_f32 v64, 0, v64
    v_cvt_pk_bf16_f32 v65, 0, v65
    v_cvt_pk_bf16_f32 v66, 0, v66
    v_cvt_pk_bf16_f32 v67, 0, v67
    v_cvt_pk_bf16_f32 v68, 0, v68
    v_cvt_pk_bf16_f32 v69, 0, v69
    v_cvt_pk_bf16_f32 v70, 0, v70
    v_cvt_pk_bf16_f32 v71, 0, v71
    v_cvt_pk_bf16_f32 v72, 0, v72
    v_cvt_pk_bf16_f32 v73, 0, v73
    v_cvt_pk_bf16_f32 v74, 0, v74
    v_cvt_pk_bf16_f32 v75, 0, v75
    v_cvt_pk_bf16_f32 v76, 0, v76
    v_cvt_pk_bf16_f32 v77, 0, v77
    v_cvt_pk_bf16_f32 v78, 0, v78
    v_cvt_pk_bf16_f32 v79, 0, v79
    v_pk_mul_f32 v[64:65], v[64:65], v[16:17]
    v_pk_mul_f32 v[66:67], v[66:67], v[18:19]
    v_pk_mul_f32 v[68:69], v[68:69], v[20:21]
    v_pk_mul_f32 v[70:71], v[70:71], v[22:23]
    v_pk_mul_f32 v[72:73], v[72:73], v[24:25]
    v_pk_mul_f32 v[74:75], v[74:75], v[26:27]
    v_pk_mul_f32 v[76:77], v[76:77], v[28:29]
    v_pk_mul_f32 v[78:79], v[78:79], v[30:31]
    v_cvt_pk_bf16_f32 v64, 0, v64
    v_cvt_pk_bf16_f32 v65, 0, v65
    v_cvt_pk_bf16_f32 v66, 0, v66
    v_cvt_pk_bf16_f32 v67, 0, v67
    v_cvt_pk_bf16_f32 v68, 0, v68
    v_cvt_pk_bf16_f32 v69, 0, v69
    v_cvt_pk_bf16_f32 v70, 0, v70
    v_cvt_pk_bf16_f32 v71, 0, v71
    v_cvt_pk_bf16_f32 v72, 0, v72
    v_cvt_pk_bf16_f32 v73, 0, v73
    v_cvt_pk_bf16_f32 v74, 0, v74
    v_cvt_pk_bf16_f32 v75, 0, v75
    v_cvt_pk_bf16_f32 v76, 0, v76
    v_cvt_pk_bf16_f32 v77, 0, v77
    v_cvt_pk_bf16_f32 v78, 0, v78
    v_cvt_pk_bf16_f32 v79, 0, v79
    v_pk_add_f32 v[64:65], v[64:65], v[80:81]
    v_pk_add_f32 v[66:67], v[66:67], v[82:83]
    v_pk_add_f32 v[68:69], v[68:69], v[84:85]
    v_pk_add_f32 v[70:71], v[70:71], v[86:87]
    v_pk_add_f32 v[72:73], v[72:73], v[88:89]
    v_pk_add_f32 v[74:75], v[74:75], v[90:91]
    v_pk_add_f32 v[76:77], v[76:77], v[92:93]
    v_pk_add_f32 v[78:79], v[78:79], v[94:95]
    v_cvt_pk_bf16_f32 v96, v64, v65
    v_cvt_pk_bf16_f32 v97, v66, v67
    v_cvt_pk_bf16_f32 v98, v68, v69
    v_cvt_pk_bf16_f32 v99, v70, v71
    v_cvt_pk_bf16_f32 v100, v72, v73
    v_cvt_pk_bf16_f32 v101, v74, v75
    v_cvt_pk_bf16_f32 v102, v76, v77
    v_cvt_pk_bf16_f32 v103, v78, v79
    buffer_store_dwordx4 v[96:99], v9, s[12:15], s63 offen sc1
    buffer_store_dwordx4 v[100:103], v9, s[12:15], s63 offen offset:1024 sc1
    v_lshlrev_b32 v64, 16, v96
    v_and_b32 v65, 0xffff0000, v96
    v_lshlrev_b32 v66, 16, v97
    v_and_b32 v67, 0xffff0000, v97
    v_lshlrev_b32 v68, 16, v98
    v_and_b32 v69, 0xffff0000, v98
    v_lshlrev_b32 v70, 16, v99
    v_and_b32 v71, 0xffff0000, v99
    v_lshlrev_b32 v72, 16, v100
    v_and_b32 v73, 0xffff0000, v100
    v_lshlrev_b32 v74, 16, v101
    v_and_b32 v75, 0xffff0000, v101
    v_lshlrev_b32 v76, 16, v102
    v_and_b32 v77, 0xffff0000, v102
    v_lshlrev_b32 v78, 16, v103
    v_and_b32 v79, 0xffff0000, v103
    v_pk_add_f32 v[80:81], v[64:65], v[72:73]
    v_pk_add_f32 v[82:83], v[66:67], v[74:75]
    v_pk_add_f32 v[84:85], v[68:69], v[76:77]
    v_pk_add_f32 v[86:87], v[70:71], v[78:79]
    v_pk_add_f32 v[80:81], v[80:81], v[84:85]
    v_pk_add_f32 v[82:83], v[82:83], v[86:87]
    v_pk_add_f32 v[80:81], v[80:81], v[82:83]
    v_add_f32 v14, v80, v81
    s_nop 1
    v_add_f32_dpp v14, v14, v14 row_shr:1 row_mask:0xf bank_mask:0xf bound_ctrl:0
    s_nop 1
    v_add_f32_dpp v14, v14, v14 row_shr:2 row_mask:0xf bank_mask:0xf bound_ctrl:0
    s_nop 1
    v_add_f32_dpp v14, v14, v14 row_shr:4 row_mask:0xf bank_mask:0xf bound_ctrl:0
    s_nop 1
    v_add_f32_dpp v14, v14, v14 row_shr:8 row_mask:0xf bank_mask:0xf bound_ctrl:0
    s_nop 1
    v_add_f32_dpp v14, v14, v14 row_bcast:15 row_mask:0xa bank_mask:0xf
    s_nop 1
    v_add_f32_dpp v14, v14, v14 row_bcast:31 row_mask:0xc bank_mask:0xf
    s_nop 1
    v_readlane_b32 s46, v14, 63
    s_nop 1
    v_mov_b32 v15, s46
    v_mul_f32 v15, 0x3a800000, v15
    v_pk_add_f32 v[80:81], v[64:65], v[14:15] op_sel:[0,1] op_sel_hi:[1,1] neg_lo:[0,1] neg_hi:[0,1]
    v_pk_add_f32 v[82:83], v[66:67], v[14:15] op_sel:[0,1] op_sel_hi:[1,1] neg_lo:[0,1] neg_hi:[0,1]
    v_pk_add_f32 v[84:85], v[68:69], v[14:15] op_sel:[0,1] op_sel_hi:[1,1] neg_lo:[0,1] neg_hi:[0,1]
    v_pk_add_f32 v[86:87], v[70:71], v[14:15] op_sel:[0,1] op_sel_hi:[1,1] neg_lo:[0,1] neg_hi:[0,1]
    v_pk_add_f32 v[88:89], v[72:73], v[14:15] op_sel:[0,1] op_sel_hi:[1,1] neg_lo:[0,1] neg_hi:[0,1]
    v_pk_add_f32 v[90:91], v[74:75], v[14:15] op_sel:[0,1] op_sel_hi:[1,1] neg_lo:[0,1] neg_hi:[0,1]
    v_pk_add_f32 v[92:93], v[76:77], v[14:15] op_sel:[0,1] op_sel_hi:[1,1] neg_lo:[0,1] neg_hi:[0,1]
    v_pk_add_f32 v[94:95], v[78:79], v[14:15] op_sel:[0,1] op_sel_hi:[1,1] neg_lo:[0,1] neg_hi:[0,1]
    v_pk_mul_f32 v[104:105], v[80:81], v[80:81]
    v_pk_mul_f32 v[106:107], v[82:83], v[82:83]
    v_pk_fma_f32 v[104:105], v[84:85], v[84:85], v[104:105]
    v_pk_fma_f32 v[106:107], v[86:87], v[86:87], v[106:107]
    v_pk_fma_f32 v[104:105], v[88:89], v[88:89], v[104:105]
    v_pk_fma_f32 v[106:107], v[90:91], v[90:91], v[106:107]
    v_pk_fma_f32 v[104:105], v[92:93], v[92:93], v[104:105]
    v_pk_fma_f32 v[106:107], v[94:95], v[94:95], v[106:107]
    v_pk_add_f32 v[104:105], v[104:105], v[106:107]
    v_add_f32 v14, v104, v105
    v_cvt_pk_bf16_f32 v15, 0, v15
    s_nop 1
    v_add_f32_dpp v14, v14, v14 row_shr:1 row_mask:0xf bank_mask:0xf bound_ctrl:0
    s_nop 1
    v_add_f32_dpp v14, v14, v14 row_shr:2 row_mask:0xf bank_mask:0xf bound_ctrl:0
    s_nop 1
    v_add_f32_dpp v14, v14, v14 row_shr:4 row_mask:0xf bank_mask:0xf bound_ctrl:0
    s_nop 1
    v_add_f32_dpp v14, v14, v14 row_shr:8 row_mask:0xf bank_mask:0xf bound_ctrl:0
    s_nop 1
    v_add_f32_dpp v14, v14, v14 row_bcast:15 row_mask:0xa bank_mask:0xf
    s_nop 1
    v_add_f32_dpp v14, v14, v14 row_bcast:31 row_mask:0xc bank_mask:0xf
    s_nop 1
    v_readlane_b32 s47, v14, 63
    v_pk_add_f32 v[64:65], v[64:65], v[14:15] op_sel:[0,1] op_sel_hi:[1,1] neg_lo:[0,1] neg_hi:[0,1]
    v_pk_add_f32 v[66:67], v[66:67], v[14:15] op_sel:[0,1] op_sel_hi:[1,1] neg_lo:[0,1] neg_hi:[0,1]
    v_pk_add_f32 v[68:69], v[68:69], v[14:15] op_sel:[0,1] op_sel_hi:[1,1] neg_lo:[0,1] neg_hi:[0,1]
    v_pk_add_f32 v[70:71], v[70:71], v[14:15] op_sel:[0,1] op_sel_hi:[1,1] neg_lo:[0,1] neg_hi:[0,1]
    v_pk_add_f32 v[72:73], v[72:73], v[14:15] op_sel:[0,1] op_sel_hi:[1,1] neg_lo:[0,1] neg_hi:[0,1]
    v_pk_add_f32 v[74:75], v[74:75], v[14:15] op_sel:[0,1] op_sel_hi:[1,1] neg_lo:[0,1] neg_hi:[0,1]
    v_pk_add_f32 v[76:77], v[76:77], v[14:15] op_sel:[0,1] op_sel_hi:[1,1] neg_lo:[0,1] neg_hi:[0,1]
    v_pk_add_f32 v[78:79], v[78:79], v[14:15] op_sel:[0,1] op_sel_hi:[1,1] neg_lo:[0,1] neg_hi:[0,1]
    v_mov_b32 v14, s47
    v_mul_f32 v14, 0x3a800000, v14
    v_cvt_pk_bf16_f32 v14, 0, v14
    v_add_f32 v14, 0x3727c5ac, v14
    v_cvt_pk_bf16_f32 v14, 0, v14
    v_sqrt_f32 v14, v14
    s_nop 0
    v_cvt_pk_bf16_f32 v14, 0, v14
    v_rcp_f32 v14, v14
    v_cvt_pk_bf16_f32 v64, 0, v64
    v_cvt_pk_bf16_f32 v65, 0, v65
    v_cvt_pk_bf16_f32 v66, 0, v66
    v_cvt_pk_bf16_f32 v67, 0, v67
    v_cvt_pk_bf16_f32 v68, 0, v68
    v_cvt_pk_bf16_f32 v69, 0, v69
    v_cvt_pk_bf16_f32 v70, 0, v70
    v_cvt_pk_bf16_f32 v71, 0, v71
    v_cvt_pk_bf16_f32 v72, 0, v72
    v_cvt_pk_bf16_f32 v73, 0, v73
    v_cvt_pk_bf16_f32 v74, 0, v74
    v_cvt_pk_bf16_f32 v75, 0, v75
    v_cvt_pk_bf16_f32 v76, 0, v76
    v_cvt_pk_bf16_f32 v77, 0, v77
    v_cvt_pk_bf16_f32 v78, 0, v78
    v_cvt_pk_bf16_f32 v79, 0, v79
    v_pk_mul_f32 v[64:65], v[64:65], v[14:15] op_sel_hi:[1,0]
    v_pk_mul_f32 v[66:67], v[66:67], v[14:15] op_sel_hi:[1,0]
    v_pk_mul_f32 v[68:69], v[68:69], v[14:15] op_sel_hi:[1,0]
    v_pk_mul_f32 v[70:71], v[70:71], v[14:15] op_sel_hi:[1,0]
    v_pk_mul_f32 v[72:73], v[72:73], v[14:15] op_sel_hi:[1,0]
    v_pk_mul_f32 v[74:75], v[74:75], v[14:15] op_sel_hi:[1,0]
    v_pk_mul_f32 v[76:77], v[76:77], v[14:15] op_sel_hi:[1,0]
    v_pk_mul_f32 v[78:79], v[78:79], v[14:15] op_sel_hi:[1,0]
    v_cvt_pk_bf16_f32 v64, 0, v64
    v_cvt_pk_bf16_f32 v65, 0, v65
    v_cvt_pk_bf16_f32 v66, 0, v66
    v_cvt_pk_bf16_f32 v67, 0, v67
    v_cvt_pk_bf16_f32 v68, 0, v68
    v_cvt_pk_bf16_f32 v69, 0, v69
    v_cvt_pk_bf16_f32 v70, 0, v70
    v_cvt_pk_bf16_f32 v71, 0, v71
    v_cvt_pk_bf16_f32 v72, 0, v72
    v_cvt_pk_bf16_f32 v73, 0, v73
    v_cvt_pk_bf16_f32 v74, 0, v74
    v_cvt_pk_bf16_f32 v75, 0, v75
    v_cvt_pk_bf16_f32 v76, 0, v76
    v_cvt_pk_bf16_f32 v77, 0, v77
    v_cvt_pk_bf16_f32 v78, 0, v78
    v_cvt_pk_bf16_f32 v79, 0, v79
    v_pk_mul_f32 v[64:65], v[64:65], v[32:33]
    v_pk_mul_f32 v[66:67], v[66:67], v[34:35]
    v_pk_mul_f32 v[68:69], v[68:69], v[36:37]
    v_pk_mul_f32 v[70:71], v[70:71], v[38:39]
    v_pk_mul_f32 v[72:73], v[72:73], v[40:41]
    v_pk_mul_f32 v[74:75], v[74:75], v[42:43]
    v_pk_mul_f32 v[76:77], v[76:77], v[44:45]
    v_pk_mul_f32 v[78:79], v[78:79], v[46:47]
    v_cvt_pk_bf16_f32 v64, 0, v64
    v_cvt_pk_bf16_f32 v65, 0, v65
    v_cvt_pk_bf16_f32 v66, 0, v66
    v_cvt_pk_bf16_f32 v67, 0, v67
    v_cvt_pk_bf16_f32 v68, 0, v68
    v_cvt_pk_bf16_f32 v69, 0, v69
    v_cvt_pk_bf16_f32 v70, 0, v70
    v_cvt_pk_bf16_f32 v71, 0, v71
    v_cvt_pk_bf16_f32 v72, 0, v72
    v_cvt_pk_bf16_f32 v73, 0, v73
    v_cvt_pk_bf16_f32 v74, 0, v74
    v_cvt_pk_bf16_f32 v75, 0, v75
    v_cvt_pk_bf16_f32 v76, 0, v76
    v_cvt_pk_bf16_f32 v77, 0, v77
    v_cvt_pk_bf16_f32 v78, 0, v78
    v_cvt_pk_bf16_f32 v79, 0, v79
    v_pk_add_f32 v[64:65], v[64:65], v[48:49]
    v_pk_add_f32 v[66:67], v[66:67], v[50:51]
    v_pk_add_f32 v[68:69], v[68:69], v[52:53]
    v_pk_add_f32 v[70:71], v[70:71], v[54:55]
    v_pk_add_f32 v[72:73], v[72:73], v[56:57]
    v_pk_add_f32 v[74:75], v[74:75], v[58:59]
    v_pk_add_f32 v[76:77], v[76:77], v[60:61]
    v_pk_add_f32 v[78:79], v[78:79], v[62:63]
    v_cvt_pk_bf16_f32 v104, v64, v65
    v_cvt_pk_bf16_f32 v105, v66, v67
    v_cvt_pk_bf16_f32 v106, v68, v69
    v_cvt_pk_bf16_f32 v107, v70, v71
    v_cvt_pk_bf16_f32 v108, v72, v73
    v_cvt_pk_bf16_f32 v109, v74, v75
    v_cvt_pk_bf16_f32 v110, v76, v77
    v_cvt_pk_bf16_f32 v111, v78, v79
    ds_write_b128 v10, v[104:107]
    ds_write_b128 v10, v[108:111] offset:1024
    s_waitcnt lgkmcnt(0)
    s_barrier
    ds_read_b128 v[104:107], v13
    ds_read_b128 v[108:111], v13 offset:128
    s_waitcnt lgkmcnt(1)
    buffer_store_dwordx4 v[104:107], v11, s[12:15], s63 offen sc1
    s_waitcnt lgkmcnt(0)
    buffer_store_dwordx4 v[108:111], v12, s[12:15], s63 offen sc1
    s_waitcnt vmcnt(0)
    s_barrier
    s_cmp_lg_u32 s44, 0
    s_cbranch_scc1 L_sf_41
    v_mov_b32 v14, s60
    v_add_u32 v14, 1, v14
    v_mov_b32 v15, 0
    s_mov_b64 exec, 1
    buffer_store_dword v14, v15, s[12:15], s52 offen sc1
    s_mov_b64 exec, -1
L_sf_41:
    s_add_u32 s60, s60, 3
    s_cmp_lt_u32 s60, 64
    s_cbranch_scc1 L_r_loop_37
    s_branch L_c_done_1
L_w_att_15:
    s_lshl_b32 s42, s40, 2
    s_and_b32 s46, s44, 3
    s_add_u32 s42, s42, s46
    s_and_b32 s43, s48, 1
    s_lshl_b32 s43, s43, 1
    s_lshr_b32 s46, s44, 2
    s_add_u32 s43, s43, s46
    s_mul_i32 s46, s42, 24576
    s_add_u32 s46, s46, 0x2000000
    v_lshlrev_b32 v2, 4, v1
    v_add_u32 v3, s46, v2
    v_add_u32 v5, 4096, v3
    v_lshrrev_b32 v4, 4, v1
    v_and_b32 v9, 15, v1
    s_lshl_b32 s46, s42, 12
    s_add_u32 s46, s46, 0x1000000
    v_and_b32 v6, 7, v1
    v_lshlrev_b32 v6, 4, v6
    v_lshl_add_u32 v6, v4, 7, v6
    v_add_u32 v6, s46, v6
    v_and_b32 v7, 31, v1
    v_lshlrev_b32 v7, 4, v7
    v_lshrrev_b32 v10, 5, v1
    v_lshl_add_u32 v7, v10, 10, v7
    v_add_u32 v7, s46, v7
    s_mul_i32 s50, s44, 13056
    v_mul_u32_u24 v8, 272, v9
    v_lshl_add_u32 v8, v4, 4, v8
    v_add_u32 v8, s50, v8
    v_bfe_u32 v11, v1, 2, 3
    v_mul_u32_u24 v11, 272, v11
    v_lshl_add_u32 v11, v10, 6, v11
    v_and_b32 v12, 3, v1
    v_lshl_add_u32 v11, v12, 4, v11
    v_add_u32 v11, s50, v11
    v_mul_u32_u24 v14, 272, v4
    v_lshl_add_u32 v14, v9, 4, v14
    v_add_u32 v14, s50, v14
    v_mov_b32 v16, 0
    v_mov_b32 v17, 0
    v_mov_b32 v18, 0
    v_mov_b32 v19, 0
    ds_write_b128 v14, v[16:19] offset:10880
    ds_write_b128 v14, v[16:19] offset:11968
    v_lshlrev_b32 v12, 2, v4
    v_bfe_u32 v13, v1, 2, 2
    v_add_u32 v12, v12, v13
    v_mul_u32_u24 v12, 272, v12
    v_and_b32 v13, 3, v1
    v_lshl_add_u32 v12, v13, 3, v12
    v_add_u32 v12, s50, v12
    v_lshlrev_b32 v13, 10, v13
    s_lshl_b32 s46, s42, 12
    s_add_u32 s46, s46, 0x1000000
    v_add_u32 v13, s46, v13
    v_lshlrev_b32 v10, 9, v4
    v_lshl_add_u32 v10, v9, 4, v10
    s_lshl_b32 s46, s42, 13
    s_add_u32 s46, s46, 0x5000000
    v_add_u32 v10, s46, v10
    s_lshl_b32 s52, s42, 9
    s_lshl_b32 s47, s43, 7
    s_add_u32 s52, s52, s47
    s_add_u32 s52, s52, 0x102000
    v_min_u32 v42, 2, v1
    v_lshlrev_b32 v42, 9, v42
    s_lshl_b32 s46, s40, 11
    s_and_b32 s47, s42, 3
    s_lshl_b32 s47, s47, 7
    s_add_u32 s46, s46, s47
    s_add_u32 s46, s46, 0x10a400
    v_add_u32 v48, s46, v42
    s_mul_i32 s46, s42, 24576
    s_add_u32 s46, s46, 0x2000000
    v_lshlrev_b32 v49, 7, v1
    v_add_u32 v49, s46, v49
    v_cmp_le_u32 s[56:57], 32, v1
    v_lshlrev_b32 v14, 2, v4
    s_mov_b32 s54, 0x3e0293ee
    s_mov_b32 s60, s43
    v_add_u32 v15, 0, v14
    v_cmp_gt_u32 s[84:85], v15, v9
    v_add_u32 v15, 1, v14
    v_cmp_gt_u32 s[86:87], v15, v9
    v_add_u32 v15, 2, v14
    v_cmp_gt_u32 s[88:89], v15, v9
    v_add_u32 v15, 3, v14
    v_cmp_gt_u32 s[90:91], v15, v9
L_a_loop_42:
    s_mul_i32 s45, s60, 786432
    s_add_u32 s48, s45, 8192
    s_add_u32 s49, s45, 16384
    s_lshl_b32 s61, s60, 17
    s_lshl_b32 s63, s60, 18
    s_mov_b32 s70, 0
L_spin_43:
    buffer_load_dword v40, v48, s[12:15], 0 offen sc1
    s_waitcnt vmcnt(0)
    v_cmp_ge_u32 vcc, s60, v40
    s_add_u32 s70, s70, 1
    s_cbranch_vccz L_spok_44
    s_sleep 3
    s_cmp_lt_u32 s70, 524288
    s_cbranch_scc1 L_spin_43
    s_branch L_c_done_1
L_spok_44:
    buffer_load_dwordx4 a[0:3], v3, s[12:15], s45 offen offset:0 sc1
    buffer_load_dwordx4 a[4:7], v3, s[12:15], s45 offen offset:1024 sc1
    buffer_load_dwordx4 a[8:11], v3, s[12:15], s45 offen offset:2048 sc1
    buffer_load_dwordx4 a[12:15], v3, s[12:15], s45 offen offset:3072 sc1
    buffer_load_dwordx4 a[16:19], v5, s[12:15], s45 offen offset:0 sc1
    buffer_load_dwordx4 a[20:23], v5, s[12:15], s45 offen offset:1024 sc1
    buffer_load_dwordx4 a[24:27], v5, s[12:15], s45 offen offset:2048 sc1
    buffer_load_dwordx4 a[28:31], v5, s[12:15], s45 offen offset:3072 sc1
    buffer_load_dwordx4 a[32:35], v3, s[12:15], s48 offen offset:0 sc1
    buffer_load_dwordx4 a[36:39], v3, s[12:15], s48 offen offset:1024 sc1
    buffer_load_dwordx4 a[40:43], v3, s[12:15], s48 offen offset:2048 sc1
    buffer_load_dwordx4 a[44:47], v3, s[12:15], s48 offen offset:3072 sc1
    buffer_load_dwordx4 a[48:51], v5, s[12:15], s48 offen offset:0 sc1
    buffer_load_dwordx4 a[52:55], v5, s[12:15], s48 offen offset:1024 sc1
    buffer_load_dwordx4 a[56:59], v5, s[12:15], s48 offen offset:2048 sc1
    buffer_load_dwordx4 a[60:63], v5, s[12:15], s48 offen offset:3072 sc1
    buffer_load_dwordx4 v[16:19], v3, s[12:15], s49 offen offset:0 sc1
    buffer_load_dwordx4 v[20:23], v3, s[12:15], s49 offen offset:1024 sc1
    buffer_load_dwordx4 v[24:27], v3, s[12:15], s49 offen offset:2048 sc1
    buffer_load_dwordx4 v[28:31], v3, s[12:15], s49 offen offset:3072 sc1
    buffer_load_dwordx4 v[32:35], v5, s[12:15], s49 offen offset:0 sc1
    buffer_load_dwordx4 v[36:39], v5, s[12:15], s49 offen offset:1024 sc1
    buffer_load_dwordx4 v[40:43], v5, s[12:15], s49 offen offset:2048 sc1
    buffer_load_dwordx4 v[44:47], v5, s[12:15], s49 offen offset:3072 sc1
    s_waitcnt vmcnt(0)
    ds_write_b128 v8, v[16:19] offset:0
    ds_write_b128 v8, v[20:23] offset:64
    ds_write_b128 v8, v[24:27] offset:128
    ds_write_b128 v8, v[28:31] offset:192
    ds_write_b128 v8, v[32:35] offset:4352
    ds_write_b128 v8, v[36:39] offset:4416
    ds_write_b128 v8, v[40:43] offset:4480
    ds_write_b128 v8, v[44:47] offset:4544
    v_mfma_f32_16x16x32_bf16 v[56:59], a[32:35], a[0:3], 0
    v_mfma_f32_16x16x32_bf16 v[60:63], a[32:35], a[16:19], 0
    v_mfma_f32_16x16x32_bf16 v[68:71], a[48:51], a[16:19], 0
    v_mfma_f32_16x16x32_bf16 v[56:59], a[36:39], a[4:7], v[56:59]
    v_mfma_f32_16x16x32_bf16 v[60:63], a[36:39], a[20:23], v[60:63]
    v_mfma_f32_16x16x32_bf16 v[68:71], a[52:55], a[20:23], v[68:71]
    v_mfma_f32_16x16x32_bf16 v[56:59], a[40:43], a[8:11], v[56:59]
    v_mfma_f32_16x16x32_bf16 v[60:63], a[40:43], a[24:27], v[60:63]
    v_mfma_f32_16x16x32_bf16 v[68:71], a[56:59], a[24:27], v[68:71]
    v_mfma_f32_16x16x32_bf16 v[56:59], a[44:47], a[12:15], v[56:59]
    v_mfma_f32_16x16x32_bf16 v[60:63], a[44:47], a[28:31], v[60:63]
    v_mfma_f32_16x16x32_bf16 v[68:71], a[60:63], a[28:31], v[68:71]
    s_waitcnt lgkmcnt(0)
    ds_read_b64_tr_b16 a[80:81], v12 offset:0
    ds_read_b64_tr_b16 a[82:83], v12 offset:4352
    ds_read_b64_tr_b16 a[86:87], v12 offset:32
    ds_read_b64_tr_b16 a[88:89], v12 offset:4384
    ds_read_b64_tr_b16 a[92:93], v12 offset:64
    ds_read_b64_tr_b16 a[94:95], v12 offset:4416
    ds_read_b64_tr_b16 a[98:99], v12 offset:96
    ds_read_b64_tr_b16 a[100:101], v12 offset:4448
    s_waitcnt lgkmcnt(0)
    ds_read_b64_tr_b16 a[104:105], v12 offset:128
    ds_read_b64_tr_b16 a[106:107], v12 offset:4480
    ds_read_b64_tr_b16 a[110:111], v12 offset:160
    ds_read_b64_tr_b16 a[112:113], v12 offset:4512
    ds_read_b64_tr_b16 a[116:117], v12 offset:192
    ds_read_b64_tr_b16 a[118:119], v12 offset:4544
    ds_read_b64_tr_b16 a[122:123], v12 offset:224
    ds_read_b64_tr_b16 a[124:125], v12 offset:4576
    v_mov_b32 v15, 0xff800000
    v_cndmask_b32 v56, v56, v15, s[84:85]
    v_cndmask_b32 v68, v68, v15, s[84:85]
    v_cndmask_b32 v57, v57, v15, s[86:87]
    v_cndmask_b32 v69, v69, v15, s[86:87]
    v_cndmask_b32 v58, v58, v15, s[88:89]
    v_cndmask_b32 v70, v70, v15, s[88:89]
    v_cndmask_b32 v59, v59, v15, s[90:91]
    v_cndmask_b32 v71, v71, v15, s[90:91]
    s_mov_b32 s70, 0
L_a_cp_45:
    buffer_load_dword v40, v13, s[12:15], s61 offen sc1
    s_waitcnt vmcnt(0)
    v_cmp_eq_u32 vcc, -1, v40
    s_add_u32 s70, s70, 1
    s_cbranch_vccz L_a_fl_46
L_a_cp_45_s:
    s_sleep 4
    s_cmp_lt_u32 s70, 524288
    s_cbranch_scc1 L_a_cp_45
    s_branch L_c_done_1
L_a_fl_46:
    buffer_load_dwordx4 v[24:27], v6, s[12:15], s61 offen offset:0 sc1
    buffer_load_dwordx4 v[28:31], v6, s[12:15], s61 offen offset:1024 sc1
    buffer_load_dwordx4 v[32:35], v6, s[12:15], s61 offen offset:2048 sc1
    buffer_load_dwordx4 v[36:39], v6, s[12:15], s61 offen offset:3072 sc1
    buffer_load_dwordx4 v[16:19], v7, s[12:15], s61 offen offset:512 sc1
    buffer_load_dwordx4 v[20:23], v7, s[12:15], s61 offen offset:2560 sc1
    s_waitcnt vmcnt(0)
    v_max_u32 v40, v16, v17
    v_max3_u32 v40, v40, v18, v19
    v_max3_u32 v40, v40, v20, v21
    v_max3_u32 v40, v40, v22, v23
    v_max3_u32 v40, v40, v24, v25
    v_max3_u32 v40, v40, v26, v27
    v_max3_u32 v40, v40, v28, v29
    v_max3_u32 v40, v40, v30, v31
    v_max3_u32 v40, v40, v32, v33
    v_max3_u32 v40, v40, v34, v35
    v_max3_u32 v40, v40, v36, v37
    v_max3_u32 v40, v40, v38, v39
    v_cmp_eq_u32 vcc, -1, v40
    s_nop 0
    s_cbranch_vccnz L_a_cp_45_s
    v_mfma_f32_16x16x32_bf16 v[72:75], v[24:27], a[0:3], 0
    v_mfma_f32_16x16x32_bf16 v[76:79], v[24:27], a[16:19], 0
    v_mfma_f32_16x16x32_bf16 v[72:75], v[28:31], a[4:7], v[72:75]
    v_mfma_f32_16x16x32_bf16 v[76:79], v[28:31], a[20:23], v[76:79]
    v_mfma_f32_16x16x32_bf16 v[72:75], v[32:35], a[8:11], v[72:75]
    v_mfma_f32_16x16x32_bf16 v[76:79], v[32:35], a[24:27], v[76:79]
    v_mfma_f32_16x16x32_bf16 v[72:75], v[36:39], a[12:15], v[72:75]
    v_mfma_f32_16x16x32_bf16 v[76:79], v[36:39], a[28:31], v[76:79]
    ds_write_b128 v11, v[16:19] offset:8704
    ds_write_b128 v11, v[20:23] offset:8832
    s_waitcnt lgkmcnt(0)
    ds_read_b64_tr_b16 a[84:85], v12 offset:8704
    ds_read_b64_tr_b16 a[90:91], v12 offset:8736
    ds_read_b64_tr_b16 a[96:97], v12 offset:8768
    ds_read_b64_tr_b16 a[102:103], v12 offset:8800
    ds_read_b64_tr_b16 a[108:109], v12 offset:8832
    ds_read_b64_tr_b16 a[114:115], v12 offset:8864
    ds_read_b64_tr_b16 a[120:121], v12 offset:8896
    ds_read_b64_tr_b16 a[126:127], v12 offset:8928
    v_cndmask_b32 v72, v72, v15, s[56:57]
    v_cndmask_b32 v73, v73, v15, s[56:57]
    v_cndmask_b32 v74, v74, v15, s[56:57]
    v_cndmask_b32 v75, v75, v15, s[56:57]
    v_cndmask_b32 v76, v76, v15, s[56:57]
    v_cndmask_b32 v77, v77, v15, s[56:57]
    v_cndmask_b32 v78, v78, v15, s[56:57]
    v_cndmask_b32 v79, v79, v15, s[56:57]
    v_max_f32 v40, v56, v57
    v_max3_f32 v40, v40, v58, v59
    v_max3_f32 v40, v40, v72, v73
    v_max3_f32 v40, v40, v74, v75
    v_mov_b32 v41, v40
    s_nop 1
    v_permlane16_swap_b32 v40, v41
    v_max_f32 v40, v40, v41
    v_mov_b32 v41, v40
    s_nop 1
    v_permlane32_swap_b32 v40, v41
    v_max_f32 v40, v40, v41
    v_mul_f32 v40, s54, v40
    v_fma_f32 v56, v56, s54, -v40
    v_fma_f32 v57, v57, s54, -v40
    v_fma_f32 v58, v58, s54, -v40
    v_fma_f32 v59, v59, s54, -v40
    v_fma_f32 v72, v72, s54, -v40
    v_fma_f32 v73, v73, s54, -v40
    v_fma_f32 v74, v74, s54, -v40
    v_fma_f32 v75, v75, s54, -v40
    v_exp_f32 v56, v56
    v_exp_f32 v57, v57
    v_exp_f32 v58, v58
    v_exp_f32 v59, v59
    v_exp_f32 v72, v72
    v_exp_f32 v73, v73
    v_exp_f32 v74, v74
    v_exp_f32 v75, v75
    v_add_f32 v40, v56, v57
    v_add_f32 v40, v40, v58
    v_add_f32 v40, v40, v59
    v_add_f32 v40, v40, v72
    v_add_f32 v40, v40, v73
    v_add_f32 v40, v40, v74
    v_add_f32 v40, v40, v75
    v_mov_b32 v41, v40
    s_nop 1
    v_permlane16_swap_b32 v40, v41
    v_add_f32 v40, v40, v41
    v_mov_b32 v41, v40
    s_nop 1
    v_permlane32_swap_b32 v40, v41
    v_add_f32 v40, v40, v41
    v_rcp_f32 v40, v40
    s_nop 0
    v_mul_f32 v56, v56, v40
    v_mul_f32 v57, v57, v40
    v_mul_f32 v58, v58, v40
    v_mul_f32 v59, v59, v40
    v_mul_f32 v72, v72, v40
    v_mul_f32 v73, v73, v40
    v_mul_f32 v74, v74, v40
    v_mul_f32 v75, v75, v40
    v_cvt_pk_bf16_f32 v24, v56, v57
    v_cvt_pk_bf16_f32 v25, v58, v59
    v_cvt_pk_bf16_f32 v28, v72, v73
    v_cvt_pk_bf16_f32 v29, v74, v75
    v_max_f32 v40, v60, v61
    v_max3_f32 v40, v40, v62, v63
    v_max3_f32 v40, v40, v68, v69
    v_max3_f32 v40, v40, v70, v71
    v_max3_f32 v40, v40, v76, v77
    v_max3_f32 v40, v40, v78, v79
    v_mov_b32 v41, v40
    s_nop 1
    v_permlane16_swap_b32 v40, v41
    v_max_f32 v40, v40, v41
    v_mov_b32 v41, v40
    s_nop 1
    v_permlane32_swap_b32 v40, v41
    v_max_f32 v40, v40, v41
    v_mul_f32 v40, s54, v40
    v_fma_f32 v60, v60, s54, -v40
    v_fma_f32 v61, v61, s54, -v40
    v_fma_f32 v62, v62, s54, -v40
    v_fma_f32 v63, v63, s54, -v40
    v_fma_f32 v68, v68, s54, -v40
    v_fma_f32 v69, v69, s54, -v40
    v_fma_f32 v70, v70, s54, -v40
    v_fma_f32 v71, v71, s54, -v40
    v_fma_f32 v76, v76, s54, -v40
    v_fma_f32 v77, v77, s54, -v40
    v_fma_f32 v78, v78, s54, -v40
    v_fma_f32 v79, v79, s54, -v40
    v_exp_f32 v60, v60
    v_exp_f32 v61, v61
    v_exp_f32 v62, v62
    v_exp_f32 v63, v63
    v_exp_f32 v68, v68
    v_exp_f32 v69, v69
    v_exp_f32 v70, v70
    v_exp_f32 v71, v71
    v_exp_f32 v76, v76
    v_exp_f32 v77, v77
    v_exp_f32 v78, v78
    v_exp_f32 v79, v79
    v_add_f32 v40, v60, v61
    v_add_f32 v40, v40, v62
    v_add_f32 v40, v40, v63
    v_add_f32 v40, v40, v68
    v_add_f32 v40, v40, v69
    v_add_f32 v40, v40, v70
    v_add_f32 v40, v40, v71
    v_add_f32 v40, v40, v76
    v_add_f32 v40, v40, v77
    v_add_f32 v40, v40, v78
    v_add_f32 v40, v40, v79
    v_mov_b32 v41, v40
    s_nop 1
    v_permlane16_swap_b32 v40, v41
    v_add_f32 v40, v40, v41
    v_mov_b32 v41, v40
    s_nop 1
    v_permlane32_swap_b32 v40, v41
    v_add_f32 v40, v40, v41
    v_rcp_f32 v40, v40
    s_nop 0
    v_mul_f32 v60, v60, v40
    v_mul_f32 v61, v61, v40
    v_mul_f32 v62, v62, v40
    v_mul_f32 v63, v63, v40
    v_mul_f32 v68, v68, v40
    v_mul_f32 v69, v69, v40
    v_mul_f32 v70, v70, v40
    v_mul_f32 v71, v71, v40
    v_mul_f32 v76, v76, v40
    v_mul_f32 v77, v77, v40
    v_mul_f32 v78, v78, v40
    v_mul_f32 v79, v79, v40
    v_cvt_pk_bf16_f32 v30, v60, v61
    v_cvt_pk_bf16_f32 v31, v62, v63
    v_cvt_pk_bf16_f32 v32, v68, v69
    v_cvt_pk_bf16_f32 v33, v70, v71
    v_cvt_pk_bf16_f32 v34, v76, v77
    v_cvt_pk_bf16_f32 v35, v78, v79
    s_waitcnt lgkmcnt(0)
    s_nop 0
    v_mfma_f32_16x16x16_bf16 v[64:67], a[80:81], v[24:25], 0
    v_mfma_f32_16x16x16_bf16 v[68:71], a[86:87], v[24:25], 0
    v_mfma_f32_16x16x16_bf16 v[72:75], a[92:93], v[24:25], 0
    v_mfma_f32_16x16x16_bf16 v[76:79], a[98:99], v[24:25], 0
    v_mfma_f32_16x16x16_bf16 v[80:83], a[104:105], v[24:25], 0
    v_mfma_f32_16x16x16_bf16 v[84:87], a[110:111], v[24:25], 0
    v_mfma_f32_16x16x16_bf16 v[88:91], a[116:117], v[24:25], 0
    v_mfma_f32_16x16x16_bf16 v[92:95], a[122:123], v[24:25], 0
    v_mfma_f32_16x16x16_bf16 v[64:67], a[84:85], v[28:29], v[64:67]
    v_mfma_f32_16x16x16_bf16 v[68:71], a[90:91], v[28:29], v[68:71]
    v_mfma_f32_16x16x16_bf16 v[72:75], a[96:97], v[28:29], v[72:75]
    v_mfma_f32_16x16x16_bf16 v[76:79], a[102:103], v[28:29], v[76:79]
    v_mfma_f32_16x16x16_bf16 v[80:83], a[108:109], v[28:29], v[80:83]
    v_mfma_f32_16x16x16_bf16 v[84:87], a[114:115], v[28:29], v[84:87]
    v_mfma_f32_16x16x16_bf16 v[88:91], a[120:121], v[28:29], v[88:91]
    v_mfma_f32_16x16x16_bf16 v[92:95], a[126:127], v[28:29], v[92:95]
    v_mfma_f32_16x16x16_bf16 v[96:99], a[80:81], v[30:31], 0
    v_mfma_f32_16x16x16_bf16 v[100:103], a[86:87], v[30:31], 0
    v_mfma_f32_16x16x16_bf16 v[104:107], a[92:93], v[30:31], 0
    v_mfma_f32_16x16x16_bf16 v[108:111], a[98:99], v[30:31], 0
    v_mfma_f32_16x16x16_bf16 v[112:115], a[104:105], v[30:31], 0
    v_mfma_f32_16x16x16_bf16 v[116:119], a[110:111], v[30:31], 0
    v_mfma_f32_16x16x16_bf16 v[120:123], a[116:117], v[30:31], 0
    v_mfma_f32_16x16x16_bf16 v[124:127], a[122:123], v[30:31], 0
    v_mfma_f32_16x16x16_bf16 v[96:99], a[82:83], v[32:33], v[96:99]
    v_mfma_f32_16x16x16_bf16 v[100:103], a[88:89], v[32:33], v[100:103]
    v_mfma_f32_16x16x16_bf16 v[104:107], a[94:95], v[32:33], v[104:107]
    v_mfma_f32_16x16x16_bf16 v[108:111], a[100:101], v[32:33], v[108:111]
    v_mfma_f32_16x16x16_bf16 v[112:115], a[106:107], v[32:33], v[112:115]
    v_mfma_f32_16x16x16_bf16 v[116:119], a[112:113], v[32:33], v[116:119]
    v_mfma_f32_16x16x16_bf16 v[120:123], a[118:119], v[32:33], v[120:123]
    v_mfma_f32_16x16x16_bf16 v[124:127], a[124:125], v[32:33], v[124:127]
    v_mfma_f32_16x16x16_bf16 v[96:99], a[84:85], v[34:35], v[96:99]
    v_mfma_f32_16x16x16_bf16 v[100:103], a[90:91], v[34:35], v[100:103]
    v_mfma_f32_16x16x16_bf16 v[104:107], a[96:97], v[34:35], v[104:107]
    v_mfma_f32_16x16x16_bf16 v[108:111], a[102:103], v[34:35], v[108:111]
    v_mfma_f32_16x16x16_bf16 v[112:115], a[108:109], v[34:35], v[112:115]
    v_mfma_f32_16x16x16_bf16 v[116:119], a[114:115], v[34:35], v[116:119]
    v_mfma_f32_16x16x16_bf16 v[120:123], a[120:121], v[34:35], v[120:123]
    v_mfma_f32_16x16x16_bf16 v[124:127], a[126:127], v[34:35], v[124:127]
    s_add_u32 s46, s63, 4096
    v_cvt_pk_bf16_f32 v64, v64, v65
    v_cvt_pk_bf16_f32 v65, v66, v67
    v_cvt_pk_bf16_f32 v66, v68, v69
    v_cvt_pk_bf16_f32 v67, v70, v71
    buffer_store_dwordx4 v[64:67], v10, s[12:15], s63 offen offset:0 sc1
    v_cvt_pk_bf16_f32 v72, v72, v73
    v_cvt_pk_bf16_f32 v73, v74, v75
    v_cvt_pk_bf16_f32 v74, v76, v77
    v_cvt_pk_bf16_f32 v75, v78, v79
    buffer_store_dwordx4 v[72:75], v10, s[12:15], s63 offen offset:2048 sc1
    v_cvt_pk_bf16_f32 v80, v80, v81
    v_cvt_pk_bf16_f32 v81, v82, v83
    v_cvt_pk_bf16_f32 v82, v84, v85
    v_cvt_pk_bf16_f32 v83, v86, v87
    buffer_store_dwordx4 v[80:83], v10, s[12:15], s46 offen offset:0 sc1
    v_cvt_pk_bf16_f32 v88, v88, v89
    v_cvt_pk_bf16_f32 v89, v90, v91
    v_cvt_pk_bf16_f32 v90, v92, v93
    v_cvt_pk_bf16_f32 v91, v94, v95
    buffer_store_dwordx4 v[88:91], v10, s[12:15], s46 offen offset:2048 sc1
    v_cvt_pk_bf16_f32 v96, v96, v97
    v_cvt_pk_bf16_f32 v97, v98, v99
    v_cvt_pk_bf16_f32 v98, v100, v101
    v_cvt_pk_bf16_f32 v99, v102, v103
    buffer_store_dwordx4 v[96:99], v10, s[12:15], s63 offen offset:256 sc1
    v_cvt_pk_bf16_f32 v104, v104, v105
    v_cvt_pk_bf16_f32 v105, v106, v107
    v_cvt_pk_bf16_f32 v106, v108, v109
    v_cvt_pk_bf16_f32 v107, v110, v111
    buffer_store_dwordx4 v[104:107], v10, s[12:15], s63 offen offset:2304 sc1
    v_cvt_pk_bf16_f32 v112, v112, v113
    v_cvt_pk_bf16_f32 v113, v114, v115
    v_cvt_pk_bf16_f32 v114, v116, v117
    v_cvt_pk_bf16_f32 v115, v118, v119
    buffer_store_dwordx4 v[112:115], v10, s[12:15], s46 offen offset:256 sc1
    v_cvt_pk_bf16_f32 v120, v120, v121
    v_cvt_pk_bf16_f32 v121, v122, v123
    v_cvt_pk_bf16_f32 v122, v124, v125
    v_cvt_pk_bf16_f32 v123, v126, v127
    buffer_store_dwordx4 v[120:123], v10, s[12:15], s46 offen offset:2304 sc1
    s_waitcnt vmcnt(0)
    v_mov_b32 v16, s60
    v_add_u32 v16, 1, v16
    v_mov_b32 v17, 0
    s_mov_b64 exec, 1
    buffer_store_dword v16, v17, s[12:15], s52 offen sc1
    s_mov_b64 exec, -1
L_sf_48:
    s_add_u32 s60, s60, 4
    s_cmp_lt_u32 s60, 64
    s_cbranch_scc1 L_a_loop_42
    s_branch L_c_done_1
L_w_g_10:
    s_lshr_b32 s53, s48, 2
    s_cmp_lt_u32 s53, 2
    s_cselect_b32 s46, 1, 0
    s_xor_b32 s53, s53, s46
    s_mov_b32 s74, 0
    s_mov_b32 s76, 0
    s_cmp_eq_u32 s53, 1
    s_cselect_b32 s75, 44, 64
    s_cmp_eq_u32 s53, 2
    s_cselect_b32 s75, 55, s75
L_w_g_10_e:
    s_lshl_b32 s46, s53, 3
    s_add_u32 s46, s46, 16
    s_load_dwordx2 s[4:5], s[0:1], s46
    s_lshl_b32 s49, s40, 2
    s_and_b32 s46, s48, 3
    s_add_u32 s49, s49, s46
    s_load_dwordx2 s[6:7], s[0:1], 72
    s_and_b32 s50, s44, 3
    s_lshr_b32 s51, s44, 2
    s_waitcnt lgkmcnt(0)
    s_mov_b32 s24, s4
    s_and_b32 s25, s5, 0xffff
    s_mov_b32 s26, 0x800000
    s_mov_b32 s27, 0x00020000
    s_cmp_lg_u32 s53, 0
    s_cbranch_scc1 L_g_nq_49
    s_load_dwordx4 s[8:11], s[0:1], 24
    v_and_b32 v10, 255, v0
    v_lshlrev_b32 v10, 13, v10
    s_and_b32 s46, s48, 3
    s_lshl_b32 s46, s46, 21
    s_lshl_b32 s47, s40, 10
    s_add_u32 s46, s46, s47
    s_add_u32 s46, s46, 384
    s_waitcnt lgkmcnt(0)
    s_cmp_eq_u32 s51, 1
    s_cselect_b32 s8, s10, s8
    s_cselect_b32 s9, s11, s9
    s_mov_b32 s28, s8
    s_and_b32 s29, s9, 0xffff
    s_mov_b32 s30, 0x800000
    s_mov_b32 s31, 0x00020000
    buffer_load_dword v11, v10, s[28:31], s46 offen
    s_cmp_eq_u32 s51, 1
    s_cbranch_scc1 L_g_nq_49
    buffer_load_dword v12, v10, s[24:27], s46 offen
L_g_nq_49:
    v_lshrrev_b32 v3, 4, v1
    v_and_b32 v4, 15, v1
    v_lshlrev_b32 v5, 2, v3
    v_xor_b32 v4, v4, v5
    v_mul_u32_u24 v3, 8192, v3
    v_lshl_add_u32 v3, v4, 4, v3
    s_mul_i32 s46, s51, 512
    s_mul_i32 s47, s50, 16
    s_add_u32 s46, s46, s47
    s_mul_i32 s46, s46, 8192
    s_lshl_b32 s47, s49, 8
    s_add_u32 s46, s46, s47
    s_lshl_b32 s45, s51, 16
    s_mul_i32 s47, s50, 4096
    s_add_u32 s45, s45, s47
    v_bfe_u32 v4, v1, 2, 2
    v_bfe_u32 v5, v1, 4, 1
    v_lshlrev_b32 v5, 1, v5
    v_bfe_u32 v6, v1, 0, 1
    v_add_u32 v5, v5, v6
    s_lshl_b32 s47, s50, 2
    v_add_u32 v5, s47, v5
    v_lshlrev_b32 v6, 2, v4
    v_xor_b32 v5, v5, v6
    v_lshlrev_b32 v5, 4, v5
    v_lshl_add_u32 v5, v4, 8, v5
    v_bfe_u32 v6, v1, 1, 1
    v_lshl_add_u32 v5, v6, 3, v5
    v_lshrrev_b32 v6, 5, v1
    v_mul_u32_u24 v6, 2048, v6
    v_add_u32 v5, v5, v6
    s_lshl_b32 s47, s51, 16
    v_add_u32 v5, s47, v5
    v_bfe_u32 v4, v1, 2, 2
    v_xor_b32 v5, s50, v4
    v_lshlrev_b32 v5, 6, v5
    v_lshl_add_u32 v5, v4, 8, v5
    v_and_b32 v6, 3, v1
    v_lshl_add_u32 v5, v6, 4, v5
    v_lshrrev_b32 v6, 4, v1
    v_lshl_add_u32 v5, v6, 11, v5
    v_lshrrev_b32 v6, 5, v1
    s_lshl_b32 s47, s51, 16
    v_add_u32 v5, s47, v5
    s_add_u32 m0, s45, 0
    s_add_u32 s47, s46, 0x0
    buffer_load_dwordx4 v3, s[24:27], s47 offen lds
    s_add_u32 m0, s45, 1024
    s_add_u32 s47, s46, 0x8000
    buffer_load_dwordx4 v3, s[24:27], s47 offen lds
    s_add_u32 m0, s45, 2048
    s_add_u32 s47, s46, 0x10000
    buffer_load_dwordx4 v3, s[24:27], s47 offen lds
    s_add_u32 m0, s45, 3072
    s_add_u32 s47, s46, 0x18000
    buffer_load_dwordx4 v3, s[24:27], s47 offen lds
    s_add_u32 m0, s45, 16384
    s_add_u32 s47, s46, 0x80000
    buffer_load_dwordx4 v3, s[24:27], s47 offen lds
    s_add_u32 m0, s45, 17408
    s_add_u32 s47, s46, 0x88000
    buffer_load_dwordx4 v3, s[24:27], s47 offen lds
    s_add_u32 m0, s45, 18432
    s_add_u32 s47, s46, 0x90000
    buffer_load_dwordx4 v3, s[24:27], s47 offen lds
    s_add_u32 m0, s45, 19456
    s_add_u32 s47, s46, 0x98000
    buffer_load_dwordx4 v3, s[24:27], s47 offen lds
    s_add_u32 m0, s45, 32768
    s_add_u32 s47, s46, 0x100000
    buffer_load_dwordx4 v3, s[24:27], s47 offen lds
    s_add_u32 m0, s45, 33792
    s_add_u32 s47, s46, 0x108000
    buffer_load_dwordx4 v3, s[24:27], s47 offen lds
    s_add_u32 m0, s45, 34816
    s_add_u32 s47, s46, 0x110000
    buffer_load_dwordx4 v3, s[24:27], s47 offen lds
    s_add_u32 m0, s45, 35840
    s_add_u32 s47, s46, 0x118000
    buffer_load_dwordx4 v3, s[24:27], s47 offen lds
    s_add_u32 m0, s45, 49152
    s_add_u32 s47, s46, 0x180000
    buffer_load_dwordx4 v3, s[24:27], s47 offen lds
    s_add_u32 m0, s45, 50176
    s_add_u32 s47, s46, 0x188000
    buffer_load_dwordx4 v3, s[24:27], s47 offen lds
    s_add_u32 m0, s45, 51200
    s_add_u32 s47, s46, 0x190000
    buffer_load_dwordx4 v3, s[24:27], s47 offen lds
    s_add_u32 m0, s45, 52224
    s_add_u32 s47, s46, 0x198000
    buffer_load_dwordx4 v3, s[24:27], s47 offen lds
    s_waitcnt vmcnt(12) lgkmcnt(0)
    s_barrier
    ds_read_b64_tr_b16 a[0:1], v5 offset:0
    ds_read_b64_tr_b16 a[2:3], v5 offset:1024
    ds_read_b64_tr_b16 a[4:5], v5 offset:8
    ds_read_b64_tr_b16 a[6:7], v5 offset:1032
    ds_read_b64_tr_b16 a[8:9], v5 offset:8192
    ds_read_b64_tr_b16 a[10:11], v5 offset:9216
    ds_read_b64_tr_b16 a[12:13], v5 offset:8200
    ds_read_b64_tr_b16 a[14:15], v5 offset:9224
    s_waitcnt vmcnt(8) lgkmcnt(0)
    s_barrier
    s_add_u32 m0, s45, 0
    s_add_u32 s47, s46, 0x200000
    buffer_load_dwordx4 v3, s[24:27], s47 offen lds
    s_add_u32 m0, s45, 1024
    s_add_u32 s47, s46, 0x208000
    buffer_load_dwordx4 v3, s[24:27], s47 offen lds
    s_add_u32 m0, s45, 2048
    s_add_u32 s47, s46, 0x210000
    buffer_load_dwordx4 v3, s[24:27], s47 offen lds
    s_add_u32 m0, s45, 3072
    s_add_u32 s47, s46, 0x218000
    buffer_load_dwordx4 v3, s[24:27], s47 offen lds
    ds_read_b64_tr_b16 a[16:17], v5 offset:16384
    ds_read_b64_tr_b16 a[18:19], v5 offset:17408
    ds_read_b64_tr_b16 a[20:21], v5 offset:16392
    ds_read_b64_tr_b16 a[22:23], v5 offset:17416
    ds_read_b64_tr_b16 a[24:25], v5 offset:24576
    ds_read_b64_tr_b16 a[26:27], v5 offset:25600
    ds_read_b64_tr_b16 a[28:29], v5 offset:24584
    ds_read_b64_tr_b16 a[30:31], v5 offset:25608
    s_waitcnt vmcnt(8) lgkmcnt(0)
    s_barrier
    s_add_u32 m0, s45, 16384
    s_add_u32 s47, s46, 0x280000
    buffer_load_dwordx4 v3, s[24:27], s47 offen lds
    s_add_u32 m0, s45, 17408
    s_add_u32 s47, s46, 0x288000
    buffer_load_dwordx4 v3, s[24:27], s47 offen lds
    s_add_u32 m0, s45, 18432
    s_add_u32 s47, s46, 0x290000
    buffer_load_dwordx4 v3, s[24:27], s47 offen lds
    s_add_u32 m0, s45, 19456
    s_add_u32 s47, s46, 0x298000
    buffer_load_dwordx4 v3, s[24:27], s47 offen lds
    ds_read_b64_tr_b16 a[32:33], v5 offset:32768
    ds_read_b64_tr_b16 a[34:35], v5 offset:33792
    ds_read_b64_tr_b16 a[36:37], v5 offset:32776
    ds_read_b64_tr_b16 a[38:39], v5 offset:33800
    ds_read_b64_tr_b16 a[40:41], v5 offset:40960
    ds_read_b64_tr_b16 a[42:43], v5 offset:41984
    ds_read_b64_tr_b16 a[44:45], v5 offset:40968
    ds_read_b64_tr_b16 a[46:47], v5 offset:41992
    s_waitcnt vmcnt(8) lgkmcnt(0)
    s_barrier
    s_add_u32 m0, s45, 32768
    s_add_u32 s47, s46, 0x300000
    buffer_load_dwordx4 v3, s[24:27], s47 offen lds
    s_add_u32 m0, s45, 33792
    s_add_u32 s47, s46, 0x308000
    buffer_load_dwordx4 v3, s[24:27], s47 offen lds
    s_add_u32 m0, s45, 34816
    s_add_u32 s47, s46, 0x310000
    buffer_load_dwordx4 v3, s[24:27], s47 offen lds
    s_add_u32 m0, s45, 35840
    s_add_u32 s47, s46, 0x318000
    buffer_load_dwordx4 v3, s[24:27], s47 offen lds
    ds_read_b64_tr_b16 a[48:49], v5 offset:49152
    ds_read_b64_tr_b16 a[50:51], v5 offset:50176
    ds_read_b64_tr_b16 a[52:53], v5 offset:49160
    ds_read_b64_tr_b16 a[54:55], v5 offset:50184
    ds_read_b64_tr_b16 a[56:57], v5 offset:57344
    ds_read_b64_tr_b16 a[58:59], v5 offset:58368
    ds_read_b64_tr_b16 a[60:61], v5 offset:57352
    ds_read_b64_tr_b16 a[62:63], v5 offset:58376
    s_waitcnt vmcnt(8) lgkmcnt(0)
    s_barrier
    s_add_u32 m0, s45, 49152
    s_add_u32 s47, s46, 0x380000
    buffer_load_dwordx4 v3, s[24:27], s47 offen lds
    s_add_u32 m0, s45, 50176
    s_add_u32 s47, s46, 0x388000
    buffer_load_dwordx4 v3, s[24:27], s47 offen lds
    s_add_u32 m0, s45, 51200
    s_add_u32 s47, s46, 0x390000
    buffer_load_dwordx4 v3, s[24:27], s47 offen lds
    s_add_u32 m0, s45, 52224
    s_add_u32 s47, s46, 0x398000
    buffer_load_dwordx4 v3, s[24:27], s47 offen lds
    ds_read_b64_tr_b16 a[64:65], v5 offset:0
    ds_read_b64_tr_b16 a[66:67], v5 offset:1024
    ds_read_b64_tr_b16 a[68:69], v5 offset:8
    ds_read_b64_tr_b16 a[70:71], v5 offset:1032
    ds_read_b64_tr_b16 a[72:73], v5 offset:8192
    ds_read_b64_tr_b16 a[74:75], v5 offset:9216
    ds_read_b64_tr_b16 a[76:77], v5 offset:8200
    ds_read_b64_tr_b16 a[78:79], v5 offset:9224
    s_waitcnt vmcnt(8) lgkmcnt(0)
    s_barrier
    ds_read_b64_tr_b16 a[80:81], v5 offset:16384
    ds_read_b64_tr_b16 a[82:83], v5 offset:17408
    ds_read_b64_tr_b16 a[84:85], v5 offset:16392
    ds_read_b64_tr_b16 a[86:87], v5 offset:17416
    ds_read_b64_tr_b16 a[88:89], v5 offset:24576
    ds_read_b64_tr_b16 a[90:91], v5 offset:25600
    ds_read_b64_tr_b16 a[92:93], v5 offset:24584
    ds_read_b64_tr_b16 a[94:95], v5 offset:25608
    s_waitcnt vmcnt(4) lgkmcnt(0)
    s_barrier
    ds_read_b64_tr_b16 a[96:97], v5 offset:32768
    ds_read_b64_tr_b16 a[98:99], v5 offset:33792
    ds_read_b64_tr_b16 a[100:101], v5 offset:32776
    ds_read_b64_tr_b16 a[102:103], v5 offset:33800
    ds_read_b64_tr_b16 a[104:105], v5 offset:40960
    ds_read_b64_tr_b16 a[106:107], v5 offset:41984
    ds_read_b64_tr_b16 a[108:109], v5 offset:40968
    ds_read_b64_tr_b16 a[110:111], v5 offset:41992
    s_waitcnt vmcnt(0) lgkmcnt(0)
    s_barrier
    ds_read_b64_tr_b16 a[112:113], v5 offset:49152
    ds_read_b64_tr_b16 a[114:115], v5 offset:50176
    ds_read_b64_tr_b16 a[116:117], v5 offset:49160
    ds_read_b64_tr_b16 a[118:119], v5 offset:50184
    ds_read_b64_tr_b16 a[120:121], v5 offset:57344
    ds_read_b64_tr_b16 a[122:123], v5 offset:58368
    ds_read_b64_tr_b16 a[124:125], v5 offset:57352
    ds_read_b64_tr_b16 a[126:127], v5 offset:58376
    s_waitcnt lgkmcnt(0)
    s_barrier
    v_lshlrev_b32 v2, 4, v1
    s_mul_i32 s64, s44, 8192
    s_add_u32 s46, s64, 0x400000
    v_add_u32 v3, s46, v2
    s_mul_i32 s46, s51, 32768
    v_add_u32 v4, s46, v2
    v_and_b32 v6, 15, v1
    v_lshlrev_b32 v6, 4, v6
    v_lshrrev_b32 v7, 4, v1
    v_lshl_add_u32 v6, v7, 9, v6
    v_add_u32 v4, s46, v6
    s_lshl_b32 s46, s50, 12
    s_add_u32 s46, s46, 131072
    v_add_u32 v5, s46, v2
    v_and_b32 v7, 3, v1
    v_lshlrev_b32 v7, 7, v7
    v_add_u32 v7, 0x109400, v7
    s_mul_i32 s46, s49, 24576
    s_lshl_b32 s47, s53, 13
    s_add_u32 s46, s46, s47
    s_lshl_b32 s47, s50, 10
    s_add_u32 s46, s46, s47
    s_add_u32 s46, s46, 0x2000000
    v_and_b32 v8, 15, v1
    v_lshlrev_b32 v8, 4, v8
    v_bfe_u32 v9, v1, 4, 1
    v_lshl_add_u32 v8, v9, 12, v8
    v_lshrrev_b32 v9, 5, v1
    v_lshl_add_u32 v8, v9, 8, v8
    v_add_u32 v8, s46, v2
    v_add_u32 v9, 4096, v8
    s_lshl_b32 s52, s40, 2
    s_add_u32 s52, s52, s53
    s_lshl_b32 s52, s52, 2
    s_and_b32 s47, s48, 3
    s_add_u32 s52, s52, s47
    s_lshl_b32 s52, s52, 7
    s_add_u32 s52, s52, 0x10a400
    s_add_u32 s52, s52, s76
    v_mov_b32 v116, -1
    v_mov_b32 v117, -1
    v_mov_b32 v118, -1
    v_mov_b32 v119, -1
    s_lshl_b32 s46, s49, 12
    s_lshl_b32 s47, s50, 10
    s_add_u32 s46, s46, s47
    s_add_u32 s46, s46, 0x1000000
    v_add_u32 v64, s46, v2
    s_and_b32 s46, s48, 3
    s_lshl_b32 s46, s46, 16
    s_lshl_b32 s47, s50, 14
    s_add_u32 s46, s46, s47
    s_lshl_b32 s47, s40, 8
    s_add_u32 s46, s46, s47
    s_add_u32 s46, s46, 0x7800000
    v_and_b32 v65, 15, v1
    v_lshlrev_b32 v65, 4, v65
    v_lshrrev_b32 v66, 4, v1
    v_lshl_add_u32 v65, v66, 11, v65
    v_add_u32 v65, s46, v65
    v_add_u32 v68, 8192, v65
    s_lshl_b32 s58, s74, 17
    s_lshl_b32 s46, s53, 3
    s_sub_u32 s46, 80, s46
    s_load_dwordx2 s[8:9], s[0:1], s46
    v_lshlrev_b32 v66, 7, v1
    s_mul_i32 s57, s49, 229376
    s_waitcnt lgkmcnt(0)
    s_mov_b32 s32, s8
    s_and_b32 s33, s9, 0xffff
    s_mov_b32 s34, 0x700000
    s_mov_b32 s35, 0x00020000
    s_mov_b32 s60, s74
    s_mul_i32 s61, s74, 65536
    s_mov_b32 s62, s74
    s_mul_i32 s63, s74, 786432
    s_mov_b32 s67, 0
    s_mov_b32 s68, 3
    s_mov_b32 s71, 0
    v_mov_b32 v15, 147456
    v_mov_b32 v14, 0
    ds_write_b32 v15, v14 offset:4
    ds_write_b32 v15, v14 offset:12
    ds_write_b32 v15, v14 offset:16
    v_mov_b32 v114, 1
    v_mov_b32 v115, 0
    v_lshrrev_b32 v113, 4, v1
    s_mov_b32 s72, 0
    s_cmp_lg_u32 s44, 0
    s_cbranch_scc1 L_zwok_59
    v_and_b32 v10, 7, v1
    v_lshlrev_b32 v10, 5, v10
    s_mov_b32 s70, 0
L_zw_58:
    buffer_load_dword v11, v10, s[16:19], 0 offen sc1
    s_waitcnt vmcnt(0)
    v_add_u32_dpp v11, v11, v11 row_ror:1 row_mask:0xf bank_mask:0xf
    s_nop 1
    v_add_u32_dpp v11, v11, v11 row_ror:2 row_mask:0xf bank_mask:0xf
    s_nop 1
    v_add_u32_dpp v11, v11, v11 row_ror:4 row_mask:0xf bank_mask:0xf
    v_cmp_ne_u32 vcc, 0x100, v11
    s_add_u32 s70, s70, 1
    s_cbranch_vccz L_zwok_59
    s_sleep 4
    s_cmp_lt_u32 s70, 524288
    s_cbranch_scc1 L_zw_58
    s_branch L_c_done_1
L_zwok_59:
L_g_restart_50:
    s_cmp_lg_u32 s44, 0
    s_cbranch_scc1 L_g_nsp_51
    s_mov_b32 s70, 0
L_g_sp_57:
    s_add_u32 s54, s60, 0
    v_add_u32 v12, s54, v113
    v_and_b32 v13, 7, v12
    v_lshl_add_u32 v13, v13, 9, v7
    buffer_load_dword v11, v13, s[12:15], 0 offen sc1
    s_waitcnt vmcnt(0)
    v_cmp_ge_u32 vcc, v12, v11
    s_add_u32 s70, s70, 1
    s_and_b32 s46, vcc_lo, 0xffff
    s_cbranch_scc0 L_g_sp_57_ok
    s_sleep 3
    s_cmp_lt_u32 s70, 524288
    s_cbranch_scc1 L_g_sp_57
    s_branch L_c_done_1
L_g_sp_57_ok:
    v_cmp_ge_u32 vcc, v12, v11
    s_nop 0
    s_ff1_i32_b64 s46, vcc
    s_lshr_b32 s46, s46, 4
    s_min_u32 s46, s46, 4
    s_add_u32 s46, s46, s54
    s_min_u32 s46, s46, s75
    v_mov_b32 v11, s46
    ds_write_b32 v15, v11 offset:0
L_g_nsp_51:
    s_waitcnt lgkmcnt(0)
    s_barrier
    ds_read_b32 v14, v15 offset:0
    s_waitcnt lgkmcnt(0)
    v_readfirstlane_b32 s66, v14
    s_nop 3
L_g_restart_50_go:
    s_mov_b32 s69, 0
    s_cmp_gt_u32 s62, s60
    s_cbranch_scc1 L_g_nd_60
    s_cmp_ge_u32 s62, s66
    s_cbranch_scc1 L_g_nd_60
    s_add_u32 s47, s61, 4096
    s_add_u32 m0, s64, 0
    s_nop 0
    buffer_load_dwordx4 v3, s[12:15], s61 offen offset:0 sc1 lds
    buffer_load_dwordx4 v3, s[12:15], s61 offen offset:1024 sc1 lds
    buffer_load_dwordx4 v3, s[12:15], s61 offen offset:2048 sc1 lds
    buffer_load_dwordx4 v3, s[12:15], s61 offen offset:3072 sc1 lds
    s_add_u32 m0, s64, 4096
    s_nop 0
    buffer_load_dwordx4 v3, s[12:15], s47 offen offset:0 sc1 lds
    buffer_load_dwordx4 v3, s[12:15], s47 offen offset:1024 sc1 lds
    buffer_load_dwordx4 v3, s[12:15], s47 offen offset:2048 sc1 lds
    buffer_load_dwordx4 v3, s[12:15], s47 offen offset:3072 sc1 lds
    s_add_u32 s61, s61, 65536
    s_add_u32 s62, s62, 1
    s_xor_b32 s64, s64, 0x10000
    s_mov_b32 s69, 1
L_g_nd_60:
    s_cmp_eq_u32 s51, 1
    s_cbranch_scc1 L_g_g1r_52
    s_add_u32 s59, s60, 1
    s_mov_b32 s69, 0
    s_cmp_gt_u32 s62, s59
    s_cbranch_scc1 L_g_nd_61
    s_cmp_ge_u32 s62, s66
    s_cbranch_scc1 L_g_nd_61
    s_add_u32 s47, s61, 4096
    s_add_u32 m0, s64, 0
    s_nop 0
    buffer_load_dwordx4 v3, s[12:15], s61 offen offset:0 sc1 lds
    buffer_load_dwordx4 v3, s[12:15], s61 offen offset:1024 sc1 lds
    buffer_load_dwordx4 v3, s[12:15], s61 offen offset:2048 sc1 lds
    buffer_load_dwordx4 v3, s[12:15], s61 offen offset:3072 sc1 lds
    s_add_u32 m0, s64, 4096
    s_nop 0
    buffer_load_dwordx4 v3, s[12:15], s47 offen offset:0 sc1 lds
    buffer_load_dwordx4 v3, s[12:15], s47 offen offset:1024 sc1 lds
    buffer_load_dwordx4 v3, s[12:15], s47 offen offset:2048 sc1 lds
    buffer_load_dwordx4 v3, s[12:15], s47 offen offset:3072 sc1 lds
    s_add_u32 s61, s61, 65536
    s_add_u32 s62, s62, 1
    s_xor_b32 s64, s64, 0x10000
    s_mov_b32 s69, 1
L_g_nd_61:
    s_cmp_eq_u32 s69, 1
    s_cbranch_scc1 L_g_w0_62
    s_waitcnt vmcnt(0)
L_g_w0_62:
    s_waitcnt vmcnt(8)
    s_cmp_lg_u32 s44, 0
    s_cbranch_scc1 L_g_nl_63
    s_add_u32 s54, s60, 1
    v_add_u32 v12, s54, v113
    v_and_b32 v13, 7, v12
    v_lshl_add_u32 v13, v13, 9, v7
    buffer_load_dword v11, v13, s[12:15], 0 offen sc1
L_g_nl_63:
L_g_loop0_53_l:
    s_barrier
    ds_read_b128 v[32:35], v4 offset:0
    ds_read_b128 v[36:39], v4 offset:256
    ds_read_b128 v[40:43], v4 offset:2048
    ds_read_b128 v[44:47], v4 offset:2304
    ds_read_b128 v[48:51], v4 offset:4096
    ds_read_b128 v[52:55], v4 offset:4352
    ds_read_b128 v[56:59], v4 offset:6144
    ds_read_b128 v[60:63], v4 offset:6400
    s_branch L_g_loop0_53_m
.p2align 6
L_g_loop0_53:
    s_barrier
L_g_loop0_53_m:
    s_setprio 2
    s_waitcnt lgkmcnt(6)
    v_mfma_f32_16x16x32_bf16 v[16:19], a[0:3], v[32:35], 0
    ds_read_b32 v14, v15
    v_mfma_f32_16x16x32_bf16 v[20:23], a[4:7], v[32:35], 0
    ds_read_b128 v[32:35], v4 offset:8192
    v_mfma_f32_16x16x32_bf16 v[28:31], a[4:7], v[36:39], 0
    v_mfma_f32_16x16x32_bf16 v[24:27], a[0:3], v[36:39], 0
    ds_read_b128 v[36:39], v4 offset:8448
    s_waitcnt lgkmcnt(6)
    v_mfma_f32_16x16x32_bf16 v[16:19], a[8:11], v[40:43], v[16:19]
    v_mfma_f32_16x16x32_bf16 v[20:23], a[12:15], v[40:43], v[20:23]
    ds_read_b128 v[40:43], v4 offset:10240
    v_mfma_f32_16x16x32_bf16 v[28:31], a[12:15], v[44:47], v[28:31]
    v_mfma_f32_16x16x32_bf16 v[24:27], a[8:11], v[44:47], v[24:27]
    ds_read_b128 v[44:47], v4 offset:10496
    s_waitcnt lgkmcnt(6)
    v_mfma_f32_16x16x32_bf16 v[16:19], a[16:19], v[48:51], v[16:19]
    v_mfma_f32_16x16x32_bf16 v[20:23], a[20:23], v[48:51], v[20:23]
    ds_read_b128 v[48:51], v4 offset:12288
    v_mfma_f32_16x16x32_bf16 v[28:31], a[20:23], v[52:55], v[28:31]
    v_mfma_f32_16x16x32_bf16 v[24:27], a[16:19], v[52:55], v[24:27]
    ds_read_b128 v[52:55], v4 offset:12544
    s_waitcnt lgkmcnt(6)
    v_mfma_f32_16x16x32_bf16 v[16:19], a[24:27], v[56:59], v[16:19]
    v_mfma_f32_16x16x32_bf16 v[20:23], a[28:31], v[56:59], v[20:23]
    ds_read_b128 v[56:59], v4 offset:14336
    v_mfma_f32_16x16x32_bf16 v[28:31], a[28:31], v[60:63], v[28:31]
    v_mfma_f32_16x16x32_bf16 v[24:27], a[24:27], v[60:63], v[24:27]
    ds_read_b128 v[60:63], v4 offset:14592
    s_waitcnt lgkmcnt(6)
    v_mfma_f32_16x16x32_bf16 v[16:19], a[32:35], v[32:35], v[16:19]
    v_mfma_f32_16x16x32_bf16 v[20:23], a[36:39], v[32:35], v[20:23]
    ds_read_b128 v[32:35], v4 offset:16384
    v_mfma_f32_16x16x32_bf16 v[28:31], a[36:39], v[36:39], v[28:31]
    v_mfma_f32_16x16x32_bf16 v[24:27], a[32:35], v[36:39], v[24:27]
    ds_read_b128 v[36:39], v4 offset:16640
    s_waitcnt lgkmcnt(6)
    v_mfma_f32_16x16x32_bf16 v[16:19], a[40:43], v[40:43], v[16:19]
    v_mfma_f32_16x16x32_bf16 v[20:23], a[44:47], v[40:43], v[20:23]
    ds_read_b128 v[40:43], v4 offset:18432
    v_mfma_f32_16x16x32_bf16 v[28:31], a[44:47], v[44:47], v[28:31]
    v_mfma_f32_16x16x32_bf16 v[24:27], a[40:43], v[44:47], v[24:27]
    ds_read_b128 v[44:47], v4 offset:18688
    s_waitcnt lgkmcnt(6)
    v_mfma_f32_16x16x32_bf16 v[16:19], a[48:51], v[48:51], v[16:19]
    v_mfma_f32_16x16x32_bf16 v[20:23], a[52:55], v[48:51], v[20:23]
    ds_read_b128 v[48:51], v4 offset:20480
    v_mfma_f32_16x16x32_bf16 v[28:31], a[52:55], v[52:55], v[28:31]
    v_mfma_f32_16x16x32_bf16 v[24:27], a[48:51], v[52:55], v[24:27]
    ds_read_b128 v[52:55], v4 offset:20736
    s_waitcnt lgkmcnt(6)
    v_mfma_f32_16x16x32_bf16 v[16:19], a[56:59], v[56:59], v[16:19]
    v_mfma_f32_16x16x32_bf16 v[20:23], a[60:63], v[56:59], v[20:23]
    ds_read_b128 v[56:59], v4 offset:22528
    v_mfma_f32_16x16x32_bf16 v[28:31], a[60:63], v[60:63], v[28:31]
    v_mfma_f32_16x16x32_bf16 v[24:27], a[56:59], v[60:63], v[24:27]
    ds_read_b128 v[60:63], v4 offset:22784
    s_waitcnt lgkmcnt(6)
    v_mfma_f32_16x16x32_bf16 v[16:19], a[64:67], v[32:35], v[16:19]
    v_mfma_f32_16x16x32_bf16 v[20:23], a[68:71], v[32:35], v[20:23]
    ds_read_b128 v[32:35], v4 offset:24576
    v_mfma_f32_16x16x32_bf16 v[28:31], a[68:71], v[36:39], v[28:31]
    v_mfma_f32_16x16x32_bf16 v[24:27], a[64:67], v[36:39], v[24:27]
    ds_read_b128 v[36:39], v4 offset:24832
    s_waitcnt lgkmcnt(6)
    v_mfma_f32_16x16x32_bf16 v[16:19], a[72:75], v[40:43], v[16:19]
    v_mfma_f32_16x16x32_bf16 v[20:23], a[76:79], v[40:43], v[20:23]
    ds_read_b128 v[40:43], v4 offset:26624
    v_mfma_f32_16x16x32_bf16 v[28:31], a[76:79], v[44:47], v[28:31]
    v_mfma_f32_16x16x32_bf16 v[24:27], a[72:75], v[44:47], v[24:27]
    ds_read_b128 v[44:47], v4 offset:26880
    s_waitcnt lgkmcnt(6)
    v_mfma_f32_16x16x32_bf16 v[16:19], a[80:83], v[48:51], v[16:19]
    v_mfma_f32_16x16x32_bf16 v[20:23], a[84:87], v[48:51], v[20:23]
    ds_read_b128 v[48:51], v4 offset:28672
    v_mfma_f32_16x16x32_bf16 v[28:31], a[84:87], v[52:55], v[28:31]
    v_mfma_f32_16x16x32_bf16 v[24:27], a[80:83], v[52:55], v[24:27]
    ds_read_b128 v[52:55], v4 offset:28928
    s_waitcnt lgkmcnt(6)
    v_mfma_f32_16x16x32_bf16 v[16:19], a[88:91], v[56:59], v[16:19]
    v_mfma_f32_16x16x32_bf16 v[20:23], a[92:95], v[56:59], v[20:23]
    ds_read_b128 v[56:59], v4 offset:30720
    v_mfma_f32_16x16x32_bf16 v[28:31], a[92:95], v[60:63], v[28:31]
    v_mfma_f32_16x16x32_bf16 v[24:27], a[88:91], v[60:63], v[24:27]
    ds_read_b128 v[60:63], v4 offset:30976
    s_waitcnt lgkmcnt(6)
    v_mfma_f32_16x16x32_bf16 v[16:19], a[96:99], v[32:35], v[16:19]
    v_mfma_f32_16x16x32_bf16 v[20:23], a[100:103], v[32:35], v[20:23]
    v_mfma_f32_16x16x32_bf16 v[28:31], a[100:103], v[36:39], v[28:31]
    v_mfma_f32_16x16x32_bf16 v[24:27], a[96:99], v[36:39], v[24:27]
    s_waitcnt lgkmcnt(4)
    v_mfma_f32_16x16x32_bf16 v[16:19], a[104:107], v[40:43], v[16:19]
    v_mfma_f32_16x16x32_bf16 v[20:23], a[108:111], v[40:43], v[20:23]
    v_mfma_f32_16x16x32_bf16 v[28:31], a[108:111], v[44:47], v[28:31]
    v_mfma_f32_16x16x32_bf16 v[24:27], a[104:107], v[44:47], v[24:27]
    s_waitcnt lgkmcnt(2)
    v_mfma_f32_16x16x32_bf16 v[16:19], a[112:115], v[48:51], v[16:19]
    v_mfma_f32_16x16x32_bf16 v[20:23], a[116:119], v[48:51], v[20:23]
    v_mfma_f32_16x16x32_bf16 v[28:31], a[116:119], v[52:55], v[28:31]
    v_mfma_f32_16x16x32_bf16 v[24:27], a[112:115], v[52:55], v[24:27]
    s_waitcnt lgkmcnt(0)
    v_mfma_f32_16x16x32_bf16 v[16:19], a[120:123], v[56:59], v[16:19]
    v_mfma_f32_16x16x32_bf16 v[20:23], a[124:127], v[56:59], v[20:23]
    v_mfma_f32_16x16x32_bf16 v[28:31], a[124:127], v[60:63], v[28:31]
    v_mfma_f32_16x16x32_bf16 v[24:27], a[120:123], v[60:63], v[24:27]
    v_xor_b32 v4, 0x10000, v4
    s_setprio 0
    s_waitcnt vmcnt(0)
    v_readfirstlane_b32 s66, v14
    s_barrier
    s_nop 6
    ds_write_b128 v5, v[16:19] offset:0
    ds_write_b128 v5, v[20:23] offset:1024
    ds_write_b128 v5, v[24:27] offset:2048
    ds_write_b128 v5, v[28:31] offset:3072
    s_cmp_lg_u32 s44, 0
    s_cbranch_scc1 L_g_ne_64
    v_cmp_ge_u32 vcc, v12, v11
    s_nop 0
    s_ff1_i32_b64 s46, vcc
    s_lshr_b32 s46, s46, 4
    s_min_u32 s46, s46, 4
    s_add_u32 s46, s46, s54
    s_min_u32 s46, s46, s75
    v_mov_b32 v11, s46
    ds_write_b32 v15, v11 offset:0
L_g_ne_64:
    s_add_u32 s60, s60, 1
    s_mov_b32 s65, 0
    s_cmp_le_u32 s62, s60
    s_cbranch_scc1 L_g_dp_67_l
L_g_dp_67_a:
    s_cmp_ge_u32 s62, s66
    s_cbranch_scc1 L_g_dp_67_d
    s_add_u32 s47, s61, 4096
    s_mov_b32 m0, s64
    s_add_u32 s62, s62, 1
    buffer_load_dwordx4 v3, s[12:15], s61 offen offset:0 sc1 lds
    buffer_load_dwordx4 v3, s[12:15], s61 offen offset:1024 sc1 lds
    buffer_load_dwordx4 v3, s[12:15], s61 offen offset:2048 sc1 lds
    buffer_load_dwordx4 v3, s[12:15], s61 offen offset:3072 sc1 lds
    s_add_u32 m0, s64, 4096
    s_add_u32 s61, s61, 65536
    buffer_load_dwordx4 v3, s[12:15], s47 offen offset:0 sc1 lds
    buffer_load_dwordx4 v3, s[12:15], s47 offen offset:1024 sc1 lds
    buffer_load_dwordx4 v3, s[12:15], s47 offen offset:2048 sc1 lds
    buffer_load_dwordx4 v3, s[12:15], s47 offen offset:3072 sc1 lds
    s_xor_b32 s64, s64, 0x10000
L_g_dp_67_d:
    s_cmp_le_u32 s66, s60
    s_cbranch_scc1 L_g_ex0_66
    s_cmp_lg_u32 s65, 0
    s_cbranch_scc1 L_g_nw_65
    ds_read_b128 v[32:35], v4 offset:0
    ds_read_b128 v[36:39], v4 offset:256
    ds_read_b128 v[40:43], v4 offset:2048
    ds_read_b128 v[44:47], v4 offset:2304
    ds_read_b128 v[48:51], v4 offset:4096
    ds_read_b128 v[52:55], v4 offset:4352
    ds_read_b128 v[56:59], v4 offset:6144
    ds_read_b128 v[60:63], v4 offset:6400
    s_cmp_lg_u32 s44, 0
    s_cbranch_scc1 L_g_nl_68
    s_add_u32 s54, s60, 1
    v_add_u32 v12, s54, v113
    v_and_b32 v13, 7, v12
    v_lshl_add_u32 v13, v13, 9, v7
    buffer_load_dword v11, v13, s[12:15], 0 offen sc1
L_g_nl_68:
    s_waitcnt lgkmcnt(8)
    s_branch L_g_loop0_53
L_g_ex0_66:
    s_cmp_lg_u32 s44, 0
    s_cbranch_scc1 L_g_ex0_66_n
    s_sleep 6
    s_add_u32 s54, s60, 0
    v_add_u32 v12, s54, v113
    v_and_b32 v13, 7, v12
    v_lshl_add_u32 v13, v13, 9, v7
    buffer_load_dword v11, v13, s[12:15], 0 offen sc1
    s_waitcnt vmcnt(0)
    v_cmp_ge_u32 vcc, v12, v11
    s_nop 0
    s_ff1_i32_b64 s46, vcc
    s_lshr_b32 s46, s46, 4
    s_min_u32 s46, s46, 4
    s_add_u32 s46, s46, s54
    s_min_u32 s46, s46, s75
    v_mov_b32 v11, s46
    ds_write_b32 v15, v11 offset:0
L_g_ex0_66_n:
    s_waitcnt lgkmcnt(0)
    s_barrier
    ds_read_b32 v14, v15 offset:0
    s_waitcnt lgkmcnt(0)
    v_readfirstlane_b32 s66, v14
    s_barrier
    s_cmp_gt_u32 s66, s60
    s_cbranch_scc1 L_g_restart_50_go
    s_branch L_g_tail_55
L_g_g1r_52:
    s_mov_b32 s65, 1
    s_branch L_g_loop1_54_e
.p2align 6
L_g_loop1_54:
    s_mov_b32 s65, 0
L_g_loop1_54_e:
    s_barrier
    ds_read_b32 v14, v15
    s_bitcmp1_b32 s67, 1
    s_cbranch_scc0 L_g_nfl_69
    s_cmp_lg_u32 s44, 4
    s_cbranch_scc1 L_g_nfl_69_d
    s_sub_u32 s59, s60, 1
    v_mov_b32 v10, s59
    buffer_store_dword v10, v115, s[12:15], s52 offen sc1
L_g_nfl_69_d:
    s_waitcnt lgkmcnt(0)
    v_readfirstlane_b32 s66, v14
    ds_read_b128 v[80:83], v5 offset:0
    ds_read_b128 v[84:87], v5 offset:1024
    ds_read_b128 v[88:91], v5 offset:2048
    ds_read_b128 v[92:95], v5 offset:3072
    s_cmp_le_u32 s62, s60
    s_cbranch_scc1 L_g_dp_74_l
L_g_dp_74_a:
    s_cmp_ge_u32 s62, s66
    s_cbranch_scc1 L_g_dp_74_d
    s_add_u32 s47, s61, 4096
    s_mov_b32 m0, s64
    s_add_u32 s62, s62, 1
    buffer_load_dwordx4 v3, s[12:15], s61 offen offset:0 sc1 lds
    buffer_load_dwordx4 v3, s[12:15], s61 offen offset:1024 sc1 lds
    buffer_load_dwordx4 v3, s[12:15], s61 offen offset:2048 sc1 lds
    buffer_load_dwordx4 v3, s[12:15], s61 offen offset:3072 sc1 lds
    s_add_u32 m0, s64, 4096
    s_add_u32 s61, s61, 65536
    buffer_load_dwordx4 v3, s[12:15], s47 offen offset:0 sc1 lds
    buffer_load_dwordx4 v3, s[12:15], s47 offen offset:1024 sc1 lds
    buffer_load_dwordx4 v3, s[12:15], s47 offen offset:2048 sc1 lds
    buffer_load_dwordx4 v3, s[12:15], s47 offen offset:3072 sc1 lds
    s_xor_b32 s64, s64, 0x10000
L_g_dp_74_d:
    s_bitcmp1_b32 s67, 0
    s_cbranch_scc0 L_g_nep_70
    s_waitcnt lgkmcnt(0)
    v_add_f32 v80, v80, v16
    v_add_f32 v81, v81, v17
    v_add_f32 v82, v82, v18
    v_add_f32 v83, v83, v19
    v_add_f32 v84, v84, v20
    v_add_f32 v85, v85, v21
    v_add_f32 v86, v86, v22
    v_add_f32 v87, v87, v23
    v_add_f32 v88, v88, v24
    v_add_f32 v89, v89, v25
    v_add_f32 v90, v90, v26
    v_add_f32 v91, v91, v27
    v_add_f32 v92, v92, v28
    v_add_f32 v93, v93, v29
    v_add_f32 v94, v94, v30
    v_add_f32 v95, v95, v31
    v_cvt_pk_bf16_f32 v104, v80, v81
    v_cvt_pk_bf16_f32 v105, v82, v83
    v_cvt_pk_bf16_f32 v106, v84, v85
    v_cvt_pk_bf16_f32 v107, v86, v87
    buffer_store_dwordx4 v[104:107], v8, s[12:15], s63 offen sc1
    v_cvt_pk_bf16_f32 v108, v88, v89
    v_cvt_pk_bf16_f32 v109, v90, v91
    v_cvt_pk_bf16_f32 v110, v92, v93
    v_cvt_pk_bf16_f32 v111, v94, v95
    buffer_store_dwordx4 v[108:111], v9, s[12:15], s63 offen sc1
    s_add_u32 s63, s63, 786432
    s_cmp_lg_u32 s53, 2
    s_cbranch_scc1 L_g_pf_75
    s_lshl_b32 s73, s58, 1
    buffer_store_dwordx4 v[116:119], v64, s[12:15], s58 offen sc1
    buffer_store_dwordx4 v[116:119], v65, s[12:15], s73 offen sc1
    buffer_store_dwordx4 v[116:119], v68, s[12:15], s73 offen sc1
    s_add_u32 s58, s58, 131072
L_g_pf_75:
    s_cmp_le_u32 s60, 2
    s_cbranch_scc1 L_g_nep_70_e
L_g_nep_70:
    s_cmp_lg_u32 s65, 0
    s_cbranch_scc1 L_g_nw1_71
    ds_read_b128 v[32:35], v4 offset:0
    ds_read_b128 v[36:39], v4 offset:256
    ds_read_b128 v[40:43], v4 offset:2048
    ds_read_b128 v[44:47], v4 offset:2304
    ds_read_b128 v[48:51], v4 offset:4096
    ds_read_b128 v[52:55], v4 offset:4352
    ds_read_b128 v[56:59], v4 offset:6144
    ds_read_b128 v[60:63], v4 offset:6400
    s_barrier
L_g_jn_73:
    s_setprio 1
    s_waitcnt lgkmcnt(6)
    v_mfma_f32_16x16x32_bf16 v[16:19], a[0:3], v[32:35], 0
    v_mfma_f32_16x16x32_bf16 v[20:23], a[4:7], v[32:35], 0
    ds_read_b128 v[32:35], v4 offset:8192
    v_mfma_f32_16x16x32_bf16 v[28:31], a[4:7], v[36:39], 0
    v_mfma_f32_16x16x32_bf16 v[24:27], a[0:3], v[36:39], 0
    ds_read_b128 v[36:39], v4 offset:8448
    s_waitcnt lgkmcnt(6)
    v_mfma_f32_16x16x32_bf16 v[16:19], a[8:11], v[40:43], v[16:19]
    v_mfma_f32_16x16x32_bf16 v[20:23], a[12:15], v[40:43], v[20:23]
    ds_read_b128 v[40:43], v4 offset:10240
    v_mfma_f32_16x16x32_bf16 v[28:31], a[12:15], v[44:47], v[28:31]
    v_mfma_f32_16x16x32_bf16 v[24:27], a[8:11], v[44:47], v[24:27]
    ds_read_b128 v[44:47], v4 offset:10496
    s_waitcnt lgkmcnt(6)
    v_mfma_f32_16x16x32_bf16 v[16:19], a[16:19], v[48:51], v[16:19]
    v_mfma_f32_16x16x32_bf16 v[20:23], a[20:23], v[48:51], v[20:23]
    ds_read_b128 v[48:51], v4 offset:12288
    v_mfma_f32_16x16x32_bf16 v[28:31], a[20:23], v[52:55], v[28:31]
    v_mfma_f32_16x16x32_bf16 v[24:27], a[16:19], v[52:55], v[24:27]
    ds_read_b128 v[52:55], v4 offset:12544
    s_waitcnt lgkmcnt(6)
    v_mfma_f32_16x16x32_bf16 v[16:19], a[24:27], v[56:59], v[16:19]
    v_mfma_f32_16x16x32_bf16 v[20:23], a[28:31], v[56:59], v[20:23]
    ds_read_b128 v[56:59], v4 offset:14336
    v_mfma_f32_16x16x32_bf16 v[28:31], a[28:31], v[60:63], v[28:31]
    v_mfma_f32_16x16x32_bf16 v[24:27], a[24:27], v[60:63], v[24:27]
    ds_read_b128 v[60:63], v4 offset:14592
    s_waitcnt lgkmcnt(6)
    v_mfma_f32_16x16x32_bf16 v[16:19], a[32:35], v[32:35], v[16:19]
    v_mfma_f32_16x16x32_bf16 v[20:23], a[36:39], v[32:35], v[20:23]
    ds_read_b128 v[32:35], v4 offset:16384
    v_mfma_f32_16x16x32_bf16 v[28:31], a[36:39], v[36:39], v[28:31]
    v_mfma_f32_16x16x32_bf16 v[24:27], a[32:35], v[36:39], v[24:27]
    ds_read_b128 v[36:39], v4 offset:16640
    s_waitcnt lgkmcnt(6)
    v_mfma_f32_16x16x32_bf16 v[16:19], a[40:43], v[40:43], v[16:19]
    v_mfma_f32_16x16x32_bf16 v[20:23], a[44:47], v[40:43], v[20:23]
    ds_read_b128 v[40:43], v4 offset:18432
    v_mfma_f32_16x16x32_bf16 v[28:31], a[44:47], v[44:47], v[28:31]
    v_mfma_f32_16x16x32_bf16 v[24:27], a[40:43], v[44:47], v[24:27]
    ds_read_b128 v[44:47], v4 offset:18688
    s_waitcnt lgkmcnt(6)
    v_mfma_f32_16x16x32_bf16 v[16:19], a[48:51], v[48:51], v[16:19]
    v_mfma_f32_16x16x32_bf16 v[20:23], a[52:55], v[48:51], v[20:23]
    ds_read_b128 v[48:51], v4 offset:20480
    v_mfma_f32_16x16x32_bf16 v[28:31], a[52:55], v[52:55], v[28:31]
    v_mfma_f32_16x16x32_bf16 v[24:27], a[48:51], v[52:55], v[24:27]
    ds_read_b128 v[52:55], v4 offset:20736
    s_waitcnt lgkmcnt(6)
    v_mfma_f32_16x16x32_bf16 v[16:19], a[56:59], v[56:59], v[16:19]
    v_mfma_f32_16x16x32_bf16 v[20:23], a[60:63], v[56:59], v[20:23]
    ds_read_b128 v[56:59], v4 offset:22528
    v_mfma_f32_16x16x32_bf16 v[28:31], a[60:63], v[60:63], v[28:31]
    v_mfma_f32_16x16x32_bf16 v[24:27], a[56:59], v[60:63], v[24:27]
    ds_read_b128 v[60:63], v4 offset:22784
    s_waitcnt lgkmcnt(6)
    v_mfma_f32_16x16x32_bf16 v[16:19], a[64:67], v[32:35], v[16:19]
    v_mfma_f32_16x16x32_bf16 v[20:23], a[68:71], v[32:35], v[20:23]
    ds_read_b128 v[32:35], v4 offset:24576
    v_mfma_f32_16x16x32_bf16 v[28:31], a[68:71], v[36:39], v[28:31]
    v_mfma_f32_16x16x32_bf16 v[24:27], a[64:67], v[36:39], v[24:27]
    ds_read_b128 v[36:39], v4 offset:24832
    s_waitcnt lgkmcnt(6)
    v_mfma_f32_16x16x32_bf16 v[16:19], a[72:75], v[40:43], v[16:19]
    v_mfma_f32_16x16x32_bf16 v[20:23], a[76:79], v[40:43], v[20:23]
    ds_read_b128 v[40:43], v4 offset:26624
    v_mfma_f32_16x16x32_bf16 v[28:31], a[76:79], v[44:47], v[28:31]
    v_mfma_f32_16x16x32_bf16 v[24:27], a[72:75], v[44:47], v[24:27]
    ds_read_b128 v[44:47], v4 offset:26880
    s_waitcnt lgkmcnt(6)
    v_mfma_f32_16x16x32_bf16 v[16:19], a[80:83], v[48:51], v[16:19]
    v_mfma_f32_16x16x32_bf16 v[20:23], a[84:87], v[48:51], v[20:23]
    ds_read_b128 v[48:51], v4 offset:28672
    v_mfma_f32_16x16x32_bf16 v[28:31], a[84:87], v[52:55], v[28:31]
    v_mfma_f32_16x16x32_bf16 v[24:27], a[80:83], v[52:55], v[24:27]
    ds_read_b128 v[52:55], v4 offset:28928
    s_waitcnt lgkmcnt(6)
    v_mfma_f32_16x16x32_bf16 v[16:19], a[88:91], v[56:59], v[16:19]
    v_mfma_f32_16x16x32_bf16 v[20:23], a[92:95], v[56:59], v[20:23]
    ds_read_b128 v[56:59], v4 offset:30720
    v_mfma_f32_16x16x32_bf16 v[28:31], a[92:95], v[60:63], v[28:31]
    v_mfma_f32_16x16x32_bf16 v[24:27], a[88:91], v[60:63], v[24:27]
    ds_read_b128 v[60:63], v4 offset:30976
    s_waitcnt lgkmcnt(6)
    v_mfma_f32_16x16x32_bf16 v[16:19], a[96:99], v[32:35], v[16:19]
    v_mfma_f32_16x16x32_bf16 v[20:23], a[100:103], v[32:35], v[20:23]
    v_mfma_f32_16x16x32_bf16 v[28:31], a[100:103], v[36:39], v[28:31]
    v_mfma_f32_16x16x32_bf16 v[24:27], a[96:99], v[36:39], v[24:27]
    s_waitcnt lgkmcnt(4)
    v_mfma_f32_16x16x32_bf16 v[16:19], a[104:107], v[40:43], v[16:19]
    v_mfma_f32_16x16x32_bf16 v[20:23], a[108:111], v[40:43], v[20:23]
    v_mfma_f32_16x16x32_bf16 v[28:31], a[108:111], v[44:47], v[28:31]
    v_mfma_f32_16x16x32_bf16 v[24:27], a[104:107], v[44:47], v[24:27]
    s_waitcnt lgkmcnt(2)
    v_mfma_f32_16x16x32_bf16 v[16:19], a[112:115], v[48:51], v[16:19]
    v_mfma_f32_16x16x32_bf16 v[20:23], a[116:119], v[48:51], v[20:23]
    v_mfma_f32_16x16x32_bf16 v[28:31], a[116:119], v[52:55], v[28:31]
    v_mfma_f32_16x16x32_bf16 v[24:27], a[112:115], v[52:55], v[24:27]
    s_waitcnt lgkmcnt(0)
    v_mfma_f32_16x16x32_bf16 v[16:19], a[120:123], v[56:59], v[16:19]
    v_mfma_f32_16x16x32_bf16 v[20:23], a[124:127], v[56:59], v[20:23]
    v_mfma_f32_16x16x32_bf16 v[28:31], a[124:127], v[60:63], v[28:31]
    v_mfma_f32_16x16x32_bf16 v[24:27], a[120:123], v[60:63], v[24:27]
    v_xor_b32 v4, 0x10000, v4
    s_setprio 0
    s_waitcnt vmcnt(0)
    s_lshl_b32 s67, s67, 1
    s_or_b32 s67, s67, 1
    s_add_u32 s60, s60, 1
    s_cmp_gt_u32 s66, s60
    s_cbranch_scc1 L_g_loop1_54
    s_barrier
    ds_read_b32 v14, v15 offset:0
    s_waitcnt lgkmcnt(0)
    v_readfirstlane_b32 s66, v14
    s_barrier
    s_mov_b32 s69, 0
    s_cmp_gt_u32 s62, s60
    s_cbranch_scc1 L_g_nd_76
    s_cmp_ge_u32 s62, s66
    s_cbranch_scc1 L_g_nd_76
    s_add_u32 s47, s61, 4096
    s_add_u32 m0, s64, 0
    s_nop 0
    buffer_load_dwordx4 v3, s[12:15], s61 offen offset:0 sc1 lds
    buffer_load_dwordx4 v3, s[12:15], s61 offen offset:1024 sc1 lds
    buffer_load_dwordx4 v3, s[12:15], s61 offen offset:2048 sc1 lds
    buffer_load_dwordx4 v3, s[12:15], s61 offen offset:3072 sc1 lds
    s_add_u32 m0, s64, 4096
    s_nop 0
    buffer_load_dwordx4 v3, s[12:15], s47 offen offset:0 sc1 lds
    buffer_load_dwordx4 v3, s[12:15], s47 offen offset:1024 sc1 lds
    buffer_load_dwordx4 v3, s[12:15], s47 offen offset:2048 sc1 lds
    buffer_load_dwordx4 v3, s[12:15], s47 offen offset:3072 sc1 lds
    s_add_u32 s61, s61, 65536
    s_add_u32 s62, s62, 1
    s_xor_b32 s64, s64, 0x10000
    s_mov_b32 s69, 1
L_g_nd_76:
    s_sub_u32 s59, s60, 1
    ds_read_b128 v[80:83], v5 offset:0
    ds_read_b128 v[84:87], v5 offset:1024
    ds_read_b128 v[88:91], v5 offset:2048
    ds_read_b128 v[92:95], v5 offset:3072
    s_nop 7
    s_waitcnt lgkmcnt(3)
    v_add_f32 v80, v80, v16
    v_add_f32 v81, v81, v17
    v_add_f32 v82, v82, v18
    v_add_f32 v83, v83, v19
    s_waitcnt lgkmcnt(2)
    v_add_f32 v84, v84, v20
    v_add_f32 v85, v85, v21
    v_add_f32 v86, v86, v22
    v_add_f32 v87, v87, v23
    s_waitcnt lgkmcnt(1)
    v_add_f32 v88, v88, v24
    v_add_f32 v89, v89, v25
    v_add_f32 v90, v90, v26
    v_add_f32 v91, v91, v27
    s_waitcnt lgkmcnt(0)
    v_add_f32 v92, v92, v28
    v_add_f32 v93, v93, v29
    v_add_f32 v94, v94, v30
    v_add_f32 v95, v95, v31
    v_cvt_pk_bf16_f32 v104, v80, v81
    v_cvt_pk_bf16_f32 v105, v82, v83
    v_cvt_pk_bf16_f32 v106, v84, v85
    v_cvt_pk_bf16_f32 v107, v86, v87
    buffer_store_dwordx4 v[104:107], v8, s[12:15], s63 offen sc1
    v_cvt_pk_bf16_f32 v108, v88, v89
    v_cvt_pk_bf16_f32 v109, v90, v91
    v_cvt_pk_bf16_f32 v110, v92, v93
    v_cvt_pk_bf16_f32 v111, v94, v95
    buffer_store_dwordx4 v[108:111], v9, s[12:15], s63 offen sc1
    s_add_u32 s63, s63, 786432
    s_cmp_lg_u32 s53, 2
    s_cbranch_scc1 L_g_pf_77
    s_lshl_b32 s73, s58, 1
    buffer_store_dwordx4 v[116:119], v64, s[12:15], s58 offen sc1
    buffer_store_dwordx4 v[116:119], v65, s[12:15], s73 offen sc1
    buffer_store_dwordx4 v[116:119], v68, s[12:15], s73 offen sc1
    s_add_u32 s58, s58, 131072
L_g_pf_77:
    s_mov_b32 s67, 0
    s_mov_b32 s71, 1
    s_cmp_gt_u32 s66, s60
    s_cbranch_scc1 L_g_g1r_52
    v_mov_b32 v10, 1
    s_mov_b64 exec, 1
    s_waitcnt vmcnt(0)
    ds_add_rtn_u32 v10, v15, v10 offset:4
    s_waitcnt lgkmcnt(0)
    v_readfirstlane_b32 s46, v10
    s_mov_b64 exec, -1
    s_mov_b32 s71, 0
    s_sub_u32 s59, s60, 1
    s_cmp_lg_u32 s46, s68
    s_cbranch_scc1 L_g_df_78
    v_mov_b32 v10, s59
    v_add_u32 v10, 1, v10
    v_mov_b32 v11, 0
    s_mov_b64 exec, 1
    buffer_store_dword v10, v11, s[12:15], s52 offen sc1
    s_mov_b64 exec, -1
L_sf_79:
L_g_df_78:
    s_add_u32 s68, s68, 4
    s_cmp_gt_u32 s66, s60
    s_cbranch_scc1 L_g_g1r_52
L_g_tail_55:
    s_cmp_lt_u32 s60, s75
    s_cbranch_scc1 L_g_restart_50
    s_waitcnt vmcnt(0)
    s_barrier
    s_branch L_w_p2_11
L_g_dp_67_l:
    s_cmp_ge_u32 s62, s66
    s_cbranch_scc1 L_g_dp_67_d
    s_mov_b32 s65, 1
    s_add_u32 s47, s61, 4096
    s_mov_b32 m0, s64
    s_add_u32 s62, s62, 1
    buffer_load_dwordx4 v3, s[12:15], s61 offen offset:0 sc1 lds
    buffer_load_dwordx4 v3, s[12:15], s61 offen offset:1024 sc1 lds
    buffer_load_dwordx4 v3, s[12:15], s61 offen offset:2048 sc1 lds
    buffer_load_dwordx4 v3, s[12:15], s61 offen offset:3072 sc1 lds
    s_add_u32 m0, s64, 4096
    s_add_u32 s61, s61, 65536
    buffer_load_dwordx4 v3, s[12:15], s47 offen offset:0 sc1 lds
    buffer_load_dwordx4 v3, s[12:15], s47 offen offset:1024 sc1 lds
    buffer_load_dwordx4 v3, s[12:15], s47 offen offset:2048 sc1 lds
    buffer_load_dwordx4 v3, s[12:15], s47 offen offset:3072 sc1 lds
    s_xor_b32 s64, s64, 0x10000
    s_branch L_g_dp_67_a
L_g_nw_65:
    s_waitcnt vmcnt(0) lgkmcnt(0)
    s_cmp_lg_u32 s44, 0
    s_cbranch_scc1 L_g_nl_80
    s_add_u32 s54, s60, 1
    v_add_u32 v12, s54, v113
    v_and_b32 v13, 7, v12
    v_lshl_add_u32 v13, v13, 9, v7
    buffer_load_dword v11, v13, s[12:15], 0 offen sc1
L_g_nl_80:
    s_branch L_g_loop0_53_l
L_g_nfl_69:
    s_cmp_eq_u32 s71, 0
    s_cbranch_scc1 L_g_nfl_69_d
    v_mov_b32 v10, 1
    s_mov_b64 exec, 1
    s_waitcnt vmcnt(0)
    ds_add_rtn_u32 v10, v15, v10 offset:4
    s_waitcnt lgkmcnt(0)
    v_readfirstlane_b32 s46, v10
    s_mov_b64 exec, -1
    s_mov_b32 s71, 0
    s_sub_u32 s59, s60, 1
    s_cmp_lg_u32 s46, s68
    s_cbranch_scc1 L_g_df_81
    v_mov_b32 v10, s59
    v_add_u32 v10, 1, v10
    v_mov_b32 v11, 0
    s_mov_b64 exec, 1
    buffer_store_dword v10, v11, s[12:15], s52 offen sc1
    s_mov_b64 exec, -1
L_sf_82:
L_g_df_81:
    s_add_u32 s68, s68, 4
    s_mov_b32 s65, 2
    s_branch L_g_nfl_69_d
L_g_dp_74_l:
    s_cmp_ge_u32 s62, s66
    s_cbranch_scc1 L_g_dp_74_d
    s_or_b32 s65, s65, 1
    s_add_u32 s47, s61, 4096
    s_mov_b32 m0, s64
    s_add_u32 s62, s62, 1
    buffer_load_dwordx4 v3, s[12:15], s61 offen offset:0 sc1 lds
    buffer_load_dwordx4 v3, s[12:15], s61 offen offset:1024 sc1 lds
    buffer_load_dwordx4 v3, s[12:15], s61 offen offset:2048 sc1 lds
    buffer_load_dwordx4 v3, s[12:15], s61 offen offset:3072 sc1 lds
    s_add_u32 m0, s64, 4096
    s_add_u32 s61, s61, 65536
    buffer_load_dwordx4 v3, s[12:15], s47 offen offset:0 sc1 lds
    buffer_load_dwordx4 v3, s[12:15], s47 offen offset:1024 sc1 lds
    buffer_load_dwordx4 v3, s[12:15], s47 offen offset:2048 sc1 lds
    buffer_load_dwordx4 v3, s[12:15], s47 offen offset:3072 sc1 lds
    s_xor_b32 s64, s64, 0x10000
    s_branch L_g_dp_74_a
L_g_nep_70_e:
    v_mov_b32 v10, 1
    s_mov_b64 exec, 1
    s_waitcnt vmcnt(0)
    ds_add_rtn_u32 v10, v15, v10 offset:4
    s_waitcnt lgkmcnt(0)
    v_readfirstlane_b32 s46, v10
    s_mov_b64 exec, -1
    s_mov_b32 s71, 0
    s_sub_u32 s59, s60, 1
    s_cmp_lg_u32 s46, s68
    s_cbranch_scc1 L_g_df_83
    v_mov_b32 v10, s59
    v_add_u32 v10, 1, v10
    v_mov_b32 v11, 0
    s_mov_b64 exec, 1
    buffer_store_dword v10, v11, s[12:15], s52 offen sc1
    s_mov_b64 exec, -1
L_sf_84:
L_g_df_83:
    s_add_u32 s68, s68, 4
    s_branch L_g_nep_70
L_g_nw1_71:
    s_cmp_eq_u32 s65, 2
    s_cbranch_scc1 L_g_nw1_71_w
    s_waitcnt vmcnt(0)
L_g_nw1_71_w:
    s_barrier
    ds_read_b128 v[32:35], v4 offset:0
    ds_read_b128 v[36:39], v4 offset:256
    ds_read_b128 v[40:43], v4 offset:2048
    ds_read_b128 v[44:47], v4 offset:2304
    ds_read_b128 v[48:51], v4 offset:4096
    ds_read_b128 v[52:55], v4 offset:4352
    ds_read_b128 v[56:59], v4 offset:6144
    ds_read_b128 v[60:63], v4 offset:6400
    s_branch L_g_jn_73
L_w_p2_11:
    s_cmp_lg_u32 s44, 0
    s_cbranch_scc1 L_w_p2_11_h
    s_mov_b32 s47, 63
    s_cmp_eq_u32 s53, 0
    s_cbranch_scc1 L_w_p2_11_q
    s_sub_u32 s52, s52, s76
    v_mov_b32 v10, 1
    v_mov_b32 v11, 131072
    s_mov_b64 exec, 1
    buffer_atomic_add v10, v11, s[12:15], s52 offen sc0
    s_waitcnt vmcnt(0)
    v_readfirstlane_b32 s46, v10
    s_mov_b64 exec, -1
    s_mov_b32 s47, 63
    s_nop 1
    s_cmp_eq_u32 s46, 0
    s_cbranch_scc1 L_w_p2_11_h
L_w_p2_11_q:
    v_mov_b32 v10, s47
    v_add_u32 v10, 1, v10
    v_mov_b32 v11, 0
    s_mov_b64 exec, 1
    buffer_store_dword v10, v11, s[12:15], s52 offen sc1
    s_mov_b64 exec, -1
L_sf_85:
L_w_p2_11_h:
    s_cmp_eq_u32 s76, 0
    s_cbranch_scc1 L_w_p2_11_m
    s_cmp_eq_u32 s79, 1
    s_cbranch_scc1 L_w_h_17
    s_mov_b32 s79, 1
    s_cmp_lt_u32 s77, 14
    s_cselect_b32 s53, 2, s53
    s_cselect_b32 s48, s48, 3
    s_branch L_w_h_17_n
L_w_p2_11_m:
    s_cmp_lt_u32 s48, 8
    s_cselect_b32 s75, 59, 59
    s_cmp_lt_u32 s48, 4
    s_cselect_b32 s75, 64, s75
L_w_p2_11_r:
    s_lshr_b32 s42, s40, 1
    s_and_b32 s43, s40, 1
    s_lshl_b32 s43, s43, 2
    s_and_b32 s46, s48, 3
    s_add_u32 s43, s43, s46
    s_cmp_lt_u32 s48, 4
    s_cbranch_scc1 L_w_wo_12
    s_cmp_lt_u32 s48, 8
    s_cbranch_scc1 L_w_f2_13
    s_cmp_lg_u32 s43, 7
    s_cbranch_scc1 L_w_f1_14
    s_mov_b32 s43, 2
    s_cmp_eq_u32 s76, 0
    s_cbranch_scc1 L_w_c_16
    s_mov_b32 s43, 7
    s_mov_b32 s78, 1
L_w_f1_14_t:
    s_cmp_lt_u32 s41, 8
    s_cselect_b32 s74, 59, 63
    s_cselect_b32 s75, 63, 64
    s_add_u32 s43, s43, s74
    s_cmp_lt_u32 s43, s75
    s_cbranch_scc1 L_w_h_17_f
    s_branch L_c_done_1
L_w_f1_14_d:
    s_cmp_eq_u32 s76, 0
    s_cbranch_scc1 L_c_done_1
    s_and_b32 s42, s49, 3
    s_lshr_b32 s43, s49, 2
    s_mov_b32 s78, 64
    s_branch L_w_f1_14_t
L_replica:
    s_setprio 0
    s_barrier
    s_and_b32 s48, s41, 7
    s_add_u32 s48, s48, 4
    s_cmp_lt_u32 s41, 8
    s_cselect_b32 s74, 59, 63
    s_cselect_b32 s75, 63, 64
    s_cselect_b32 s76, 1, 2
    s_cselect_b32 s46, 59, 63
    s_cselect_b32 s47, 63, 64
    s_mul_i32 s76, s76, 65536
    s_cmp_lt_u32 s48, 8
    s_cselect_b32 s74, s46, s74
    s_cselect_b32 s75, s47, s75
    s_branch L_w_p2_11_r
L_w_f1_14:
    s_load_dwordx2 s[4:5], s[0:1], 64
    s_load_dwordx2 s[6:7], s[0:1], 72
    s_and_b32 s50, s44, 3
    s_lshr_b32 s51, s44, 2
    s_waitcnt lgkmcnt(0)
    s_mov_b32 s24, s4
    s_and_b32 s25, s5, 0xffff
    s_mov_b32 s26, 0x700000
    s_mov_b32 s27, 0x00020000
    s_mul_i32 s49, s42, 7
    s_add_u32 s49, s49, s43
    v_lshrrev_b32 v3, 4, v1
    v_and_b32 v4, 15, v1
    v_lshlrev_b32 v5, 2, v3
    v_xor_b32 v4, v4, v5
    v_mul_u32_u24 v3, 7168, v3
    v_lshl_add_u32 v3, v4, 4, v3
    s_mul_i32 s46, s51, 512
    s_mul_i32 s47, s50, 16
    s_add_u32 s46, s46, s47
    s_mul_i32 s46, s46, 7168
    s_lshl_b32 s47, s49, 8
    s_add_u32 s46, s46, s47
    s_lshl_b32 s45, s51, 16
    s_mul_i32 s47, s50, 4096
    s_add_u32 s45, s45, s47
    v_bfe_u32 v4, v1, 2, 2
    v_bfe_u32 v5, v1, 4, 1
    v_lshlrev_b32 v5, 1, v5
    v_bfe_u32 v6, v1, 1, 1
    v_add_u32 v5, v5, v6
    s_lshl_b32 s47, s50, 2
    v_add_u32 v5, s47, v5
    v_lshlrev_b32 v6, 2, v4
    v_xor_b32 v5, v5, v6
    v_lshlrev_b32 v5, 4, v5
    v_lshl_add_u32 v5, v4, 8, v5
    v_bfe_u32 v6, v1, 0, 1
    v_lshl_add_u32 v5, v6, 3, v5
    v_lshrrev_b32 v6, 5, v1
    v_mul_u32_u24 v6, 2048, v6
    v_add_u32 v5, v5, v6
    s_lshl_b32 s47, s51, 16
    v_add_u32 v5, s47, v5
    s_add_u32 m0, s45, 0
    s_add_u32 s47, s46, 0x0
    buffer_load_dwordx4 v3, s[24:27], s47 offen lds
    s_add_u32 m0, s45, 1024
    s_add_u32 s47, s46, 0x7000
    buffer_load_dwordx4 v3, s[24:27], s47 offen lds
    s_add_u32 m0, s45, 2048
    s_add_u32 s47, s46, 0xe000
    buffer_load_dwordx4 v3, s[24:27], s47 offen lds
    s_add_u32 m0, s45, 3072
    s_add_u32 s47, s46, 0x15000
    buffer_load_dwordx4 v3, s[24:27], s47 offen lds
    s_add_u32 m0, s45, 16384
    s_add_u32 s47, s46, 0x70000
    buffer_load_dwordx4 v3, s[24:27], s47 offen lds
    s_add_u32 m0, s45, 17408
    s_add_u32 s47, s46, 0x77000
    buffer_load_dwordx4 v3, s[24:27], s47 offen lds
    s_add_u32 m0, s45, 18432
    s_add_u32 s47, s46, 0x7e000
    buffer_load_dwordx4 v3, s[24:27], s47 offen lds
    s_add_u32 m0, s45, 19456
    s_add_u32 s47, s46, 0x85000
    buffer_load_dwordx4 v3, s[24:27], s47 offen lds
    s_add_u32 m0, s45, 32768
    s_add_u32 s47, s46, 0xe0000
    buffer_load_dwordx4 v3, s[24:27], s47 offen lds
    s_add_u32 m0, s45, 33792
    s_add_u32 s47, s46, 0xe7000
    buffer_load_dwordx4 v3, s[24:27], s47 offen lds
    s_add_u32 m0, s45, 34816
    s_add_u32 s47, s46, 0xee000
    buffer_load_dwordx4 v3, s[24:27], s47 offen lds
    s_add_u32 m0, s45, 35840
    s_add_u32 s47, s46, 0xf5000
    buffer_load_dwordx4 v3, s[24:27], s47 offen lds
    s_add_u32 m0, s45, 49152
    s_add_u32 s47, s46, 0x150000
    buffer_load_dwordx4 v3, s[24:27], s47 offen lds
    s_add_u32 m0, s45, 50176
    s_add_u32 s47, s46, 0x157000
    buffer_load_dwordx4 v3, s[24:27], s47 offen lds
    s_add_u32 m0, s45, 51200
    s_add_u32 s47, s46, 0x15e000
    buffer_load_dwordx4 v3, s[24:27], s47 offen lds
    s_add_u32 m0, s45, 52224
    s_add_u32 s47, s46, 0x165000
    buffer_load_dwordx4 v3, s[24:27], s47 offen lds
    s_waitcnt vmcnt(12) lgkmcnt(0)
    s_barrier
    ds_read_b64_tr_b16 a[0:1], v5 offset:0
    ds_read_b64_tr_b16 a[2:3], v5 offset:1024
    ds_read_b64_tr_b16 a[4:5], v5 offset:4096
    ds_read_b64_tr_b16 a[6:7], v5 offset:5120
    ds_read_b64_tr_b16 a[8:9], v5 offset:8192
    ds_read_b64_tr_b16 a[10:11], v5 offset:9216
    ds_read_b64_tr_b16 a[12:13], v5 offset:12288
    ds_read_b64_tr_b16 a[14:15], v5 offset:13312
    s_waitcnt vmcnt(8) lgkmcnt(0)
    s_barrier
    s_add_u32 m0, s45, 0
    s_add_u32 s47, s46, 0x1c0000
    buffer_load_dwordx4 v3, s[24:27], s47 offen lds
    s_add_u32 m0, s45, 1024
    s_add_u32 s47, s46, 0x1c7000
    buffer_load_dwordx4 v3, s[24:27], s47 offen lds
    s_add_u32 m0, s45, 2048
    s_add_u32 s47, s46, 0x1ce000
    buffer_load_dwordx4 v3, s[24:27], s47 offen lds
    s_add_u32 m0, s45, 3072
    s_add_u32 s47, s46, 0x1d5000
    buffer_load_dwordx4 v3, s[24:27], s47 offen lds
    ds_read_b64_tr_b16 a[16:17], v5 offset:16384
    ds_read_b64_tr_b16 a[18:19], v5 offset:17408
    ds_read_b64_tr_b16 a[20:21], v5 offset:20480
    ds_read_b64_tr_b16 a[22:23], v5 offset:21504
    ds_read_b64_tr_b16 a[24:25], v5 offset:24576
    ds_read_b64_tr_b16 a[26:27], v5 offset:25600
    ds_read_b64_tr_b16 a[28:29], v5 offset:28672
    ds_read_b64_tr_b16 a[30:31], v5 offset:29696
    s_waitcnt vmcnt(8) lgkmcnt(0)
    s_barrier
    s_add_u32 m0, s45, 16384
    s_add_u32 s47, s46, 0x230000
    buffer_load_dwordx4 v3, s[24:27], s47 offen lds
    s_add_u32 m0, s45, 17408
    s_add_u32 s47, s46, 0x237000
    buffer_load_dwordx4 v3, s[24:27], s47 offen lds
    s_add_u32 m0, s45, 18432
    s_add_u32 s47, s46, 0x23e000
    buffer_load_dwordx4 v3, s[24:27], s47 offen lds
    s_add_u32 m0, s45, 19456
    s_add_u32 s47, s46, 0x245000
    buffer_load_dwordx4 v3, s[24:27], s47 offen lds
    ds_read_b64_tr_b16 a[32:33], v5 offset:32768
    ds_read_b64_tr_b16 a[34:35], v5 offset:33792
    ds_read_b64_tr_b16 a[36:37], v5 offset:36864
    ds_read_b64_tr_b16 a[38:39], v5 offset:37888
    ds_read_b64_tr_b16 a[40:41], v5 offset:40960
    ds_read_b64_tr_b16 a[42:43], v5 offset:41984
    ds_read_b64_tr_b16 a[44:45], v5 offset:45056
    ds_read_b64_tr_b16 a[46:47], v5 offset:46080
    s_waitcnt vmcnt(8) lgkmcnt(0)
    s_barrier
    s_add_u32 m0, s45, 32768
    s_add_u32 s47, s46, 0x2a0000
    buffer_load_dwordx4 v3, s[24:27], s47 offen lds
    s_add_u32 m0, s45, 33792
    s_add_u32 s47, s46, 0x2a7000
    buffer_load_dwordx4 v3, s[24:27], s47 offen lds
    s_add_u32 m0, s45, 34816
    s_add_u32 s47, s46, 0x2ae000
    buffer_load_dwordx4 v3, s[24:27], s47 offen lds
    s_add_u32 m0, s45, 35840
    s_add_u32 s47, s46, 0x2b5000
    buffer_load_dwordx4 v3, s[24:27], s47 offen lds
    ds_read_b64_tr_b16 a[48:49], v5 offset:49152
    ds_read_b64_tr_b16 a[50:51], v5 offset:50176
    ds_read_b64_tr_b16 a[52:53], v5 offset:53248
    ds_read_b64_tr_b16 a[54:55], v5 offset:54272
    ds_read_b64_tr_b16 a[56:57], v5 offset:57344
    ds_read_b64_tr_b16 a[58:59], v5 offset:58368
    ds_read_b64_tr_b16 a[60:61], v5 offset:61440
    ds_read_b64_tr_b16 a[62:63], v5 offset:62464
    s_waitcnt vmcnt(8) lgkmcnt(0)
    s_barrier
    s_add_u32 m0, s45, 49152
    s_add_u32 s47, s46, 0x310000
    buffer_load_dwordx4 v3, s[24:27], s47 offen lds
    s_add_u32 m0, s45, 50176
    s_add_u32 s47, s46, 0x317000
    buffer_load_dwordx4 v3, s[24:27], s47 offen lds
    s_add_u32 m0, s45, 51200
    s_add_u32 s47, s46, 0x31e000
    buffer_load_dwordx4 v3, s[24:27], s47 offen lds
    s_add_u32 m0, s45, 52224
    s_add_u32 s47, s46, 0x325000
    buffer_load_dwordx4 v3, s[24:27], s47 offen lds
    ds_read_b64_tr_b16 a[64:65], v5 offset:0
    ds_read_b64_tr_b16 a[66:67], v5 offset:1024
    ds_read_b64_tr_b16 a[68:69], v5 offset:4096
    ds_read_b64_tr_b16 a[70:71], v5 offset:5120
    ds_read_b64_tr_b16 a[72:73], v5 offset:8192
    ds_read_b64_tr_b16 a[74:75], v5 offset:9216
    ds_read_b64_tr_b16 a[76:77], v5 offset:12288
    ds_read_b64_tr_b16 a[78:79], v5 offset:13312
    s_waitcnt vmcnt(8) lgkmcnt(0)
    s_barrier
    ds_read_b64_tr_b16 a[80:81], v5 offset:16384
    ds_read_b64_tr_b16 a[82:83], v5 offset:17408
    ds_read_b64_tr_b16 a[84:85], v5 offset:20480
    ds_read_b64_tr_b16 a[86:87], v5 offset:21504
    ds_read_b64_tr_b16 a[88:89], v5 offset:24576
    ds_read_b64_tr_b16 a[90:91], v5 offset:25600
    ds_read_b64_tr_b16 a[92:93], v5 offset:28672
    ds_read_b64_tr_b16 a[94:95], v5 offset:29696
    s_waitcnt vmcnt(4) lgkmcnt(0)
    s_barrier
    ds_read_b64_tr_b16 a[96:97], v5 offset:32768
    ds_read_b64_tr_b16 a[98:99], v5 offset:33792
    ds_read_b64_tr_b16 a[100:101], v5 offset:36864
    ds_read_b64_tr_b16 a[102:103], v5 offset:37888
    ds_read_b64_tr_b16 a[104:105], v5 offset:40960
    ds_read_b64_tr_b16 a[106:107], v5 offset:41984
    ds_read_b64_tr_b16 a[108:109], v5 offset:45056
    ds_read_b64_tr_b16 a[110:111], v5 offset:46080
    s_waitcnt vmcnt(0) lgkmcnt(0)
    s_barrier
    ds_read_b64_tr_b16 a[112:113], v5 offset:49152
    ds_read_b64_tr_b16 a[114:115], v5 offset:50176
    ds_read_b64_tr_b16 a[116:117], v5 offset:53248
    ds_read_b64_tr_b16 a[118:119], v5 offset:54272
    ds_read_b64_tr_b16 a[120:121], v5 offset:57344
    ds_read_b64_tr_b16 a[122:123], v5 offset:58368
    ds_read_b64_tr_b16 a[124:125], v5 offset:61440
    ds_read_b64_tr_b16 a[126:127], v5 offset:62464
    s_waitcnt lgkmcnt(0)
    s_barrier
    v_lshlrev_b32 v2, 4, v1
    s_mul_i32 s64, s44, 8192
    s_add_u32 s46, s64, 0xc00000
    v_add_u32 v3, s46, v2
    s_mul_i32 s46, s51, 32768
    v_add_u32 v4, s46, v2
    v_and_b32 v6, 15, v1
    v_lshlrev_b32 v6, 4, v6
    v_lshrrev_b32 v7, 4, v1
    v_lshl_add_u32 v6, v7, 9, v6
    s_lshl_b32 s46, s50, 12
    s_add_u32 s46, s46, 131072
    v_add_u32 v5, s46, v2
    v_and_b32 v7, 3, v1
    v_lshlrev_b32 v7, 7, v7
    v_add_u32 v7, 0x10ec00, v7
    s_lshl_b32 s46, s49, 13
    s_lshl_b32 s47, s50, 11
    s_add_u32 s46, s46, s47
    s_add_u32 s46, s46, 0x6000000
    v_add_u32 v8, s46, v2
    s_lshl_b32 s52, s49, 7
    s_add_u32 s52, s52, 0x106400
    s_add_u32 s52, s52, s76
    s_mov_b32 s28, s6
    s_and_b32 s29, s7, 0xffff
    s_mov_b32 s30, 0x1c00
    s_mov_b32 s31, 0x00020000
    s_lshl_b32 s46, s49, 8
    s_lshl_b32 s47, s50, 6
    s_add_u32 s46, s46, s47
    v_lshrrev_b32 v9, 5, v1
    v_lshlrev_b32 v9, 3, v9
    buffer_load_dwordx2 v[32:33], v9, s[28:31], s46 offen offset:0
    buffer_load_dwordx2 v[34:35], v9, s[28:31], s46 offen offset:16
    buffer_load_dwordx2 v[36:37], v9, s[28:31], s46 offen offset:32
    buffer_load_dwordx2 v[38:39], v9, s[28:31], s46 offen offset:48
    v_add_u32 v9, 1024, v8
    s_mov_b32 s56, 0xbdd2d3e8
    s_mov_b32 s57, 0xbdd2d3e8
    v_mov_b32 v112, 0xc0135761
    s_waitcnt vmcnt(0)
    v_lshlrev_b32 v64, 16, v32
    v_and_b32 v65, 0xffff0000, v32
    v_lshlrev_b32 v66, 16, v33
    v_and_b32 v67, 0xffff0000, v33
    v_lshlrev_b32 v68, 16, v34
    v_and_b32 v69, 0xffff0000, v34
    v_lshlrev_b32 v70, 16, v35
    v_and_b32 v71, 0xffff0000, v35
    v_lshlrev_b32 v72, 16, v36
    v_and_b32 v73, 0xffff0000, v36
    v_lshlrev_b32 v74, 16, v37
    v_and_b32 v75, 0xffff0000, v37
    v_lshlrev_b32 v76, 16, v38
    v_and_b32 v77, 0xffff0000, v38
    v_lshlrev_b32 v78, 16, v39
    v_and_b32 v79, 0xffff0000, v39
    s_mul_i32 s46, s43, 8192
    s_add_u32 s46, s46, 0xc00000
    s_mul_i32 s47, s42, 0
    s_add_u32 s46, s46, s47
    v_min_u32 v116, 63, v1
    v_lshlrev_b32 v116, 7, v116
    v_add_u32 v116, s46, v116
    s_mov_b32 s60, s74
    s_mul_i32 s61, s74, 65536
    s_mov_b32 s62, s74
    s_mul_i32 s63, s74, 229376
    s_mov_b32 s67, 0
    s_mov_b32 s68, 3
    s_mov_b32 s71, 0
    v_mov_b32 v15, 147456
    v_mov_b32 v14, 0
    ds_write_b32 v15, v14 offset:4
    ds_write_b32 v15, v14 offset:12
    ds_write_b32 v15, v14 offset:16
    v_mov_b32 v114, 1
    v_mov_b32 v115, 0
    v_lshrrev_b32 v113, 4, v1
    s_mov_b32 s72, 0
L_g_restart_86:
    s_cmp_lg_u32 s44, 0
    s_cbranch_scc1 L_g_nsp_87
    s_mov_b32 s70, 0
L_g_sp_93:
    s_add_u32 s54, s60, 0
    v_add_u32 v12, s54, v113
    v_mul_u32_u24 v13, 171, v12
    v_lshrrev_b32 v13, 9, v13
    v_mad_i32_i24 v13, v13, -3, v12
    v_lshl_add_u32 v13, v13, 9, v7
    buffer_load_dword v11, v13, s[12:15], 0 offen sc1
    s_waitcnt vmcnt(0)
    v_cmp_ge_u32 vcc, v12, v11
    s_add_u32 s70, s70, 1
    s_and_b32 s46, vcc_lo, 0xffff
    s_cbranch_scc0 L_g_sp_93_ok
    s_sleep 3
    s_cmp_lt_u32 s70, 524288
    s_cbranch_scc1 L_g_sp_93
    s_branch L_c_done_1
L_g_sp_93_ok:
    v_cmp_ge_u32 vcc, v12, v11
    s_nop 0
    s_ff1_i32_b64 s46, vcc
    s_lshr_b32 s46, s46, 4
    s_min_u32 s46, s46, 4
    s_add_u32 s46, s46, s54
    s_min_u32 s46, s46, s75
    v_mov_b32 v11, s46
    ds_write_b32 v15, v11 offset:0
L_g_nsp_87:
    s_waitcnt lgkmcnt(0)
    s_barrier
    ds_read_b32 v14, v15 offset:0
    s_waitcnt lgkmcnt(0)
    v_readfirstlane_b32 s66, v14
    s_nop 3
L_g_restart_86_go:
    s_mov_b32 s69, 0
    s_cmp_gt_u32 s62, s60
    s_cbranch_scc1 L_g_nd_94
    s_cmp_ge_u32 s62, s66
    s_cbranch_scc1 L_g_nd_94
    s_add_u32 s47, s61, 4096
    s_add_u32 m0, s64, 0
    s_nop 0
    buffer_load_dwordx4 v3, s[12:15], s61 offen offset:0 sc1 lds
    buffer_load_dwordx4 v3, s[12:15], s61 offen offset:1024 sc1 lds
    buffer_load_dwordx4 v3, s[12:15], s61 offen offset:2048 sc1 lds
    buffer_load_dwordx4 v3, s[12:15], s61 offen offset:3072 sc1 lds
    s_add_u32 m0, s64, 4096
    s_nop 0
    buffer_load_dwordx4 v3, s[12:15], s47 offen offset:0 sc1 lds
    buffer_load_dwordx4 v3, s[12:15], s47 offen offset:1024 sc1 lds
    buffer_load_dwordx4 v3, s[12:15], s47 offen offset:2048 sc1 lds
    buffer_load_dwordx4 v3, s[12:15], s47 offen offset:3072 sc1 lds
    s_add_u32 s61, s61, 65536
    s_add_u32 s62, s62, 1
    s_xor_b32 s64, s64, 0x10000
    s_mov_b32 s69, 1
L_g_nd_94:
    s_cmp_eq_u32 s51, 1
    s_cbranch_scc1 L_g_g1r_88
    s_add_u32 s59, s60, 1
    s_mov_b32 s69, 0
    s_cmp_gt_u32 s62, s59
    s_cbranch_scc1 L_g_nd_95
    s_cmp_ge_u32 s62, s66
    s_cbranch_scc1 L_g_nd_95
    s_add_u32 s47, s61, 4096
    s_add_u32 m0, s64, 0
    s_nop 0
    buffer_load_dwordx4 v3, s[12:15], s61 offen offset:0 sc1 lds
    buffer_load_dwordx4 v3, s[12:15], s61 offen offset:1024 sc1 lds
    buffer_load_dwordx4 v3, s[12:15], s61 offen offset:2048 sc1 lds
    buffer_load_dwordx4 v3, s[12:15], s61 offen offset:3072 sc1 lds
    s_add_u32 m0, s64, 4096
    s_nop 0
    buffer_load_dwordx4 v3, s[12:15], s47 offen offset:0 sc1 lds
    buffer_load_dwordx4 v3, s[12:15], s47 offen offset:1024 sc1 lds
    buffer_load_dwordx4 v3, s[12:15], s47 offen offset:2048 sc1 lds
    buffer_load_dwordx4 v3, s[12:15], s47 offen offset:3072 sc1 lds
    s_add_u32 s61, s61, 65536
    s_add_u32 s62, s62, 1
    s_xor_b32 s64, s64, 0x10000
    s_mov_b32 s69, 1
L_g_nd_95:
    s_cmp_eq_u32 s69, 1
    s_cbranch_scc1 L_g_w0_96
    s_waitcnt vmcnt(0)
L_g_w0_96:
    s_waitcnt vmcnt(8)
    s_cmp_lg_u32 s44, 0
    s_cbranch_scc1 L_g_nl_97
    s_add_u32 s54, s60, 1
    v_add_u32 v12, s54, v113
    v_mul_u32_u24 v13, 171, v12
    v_lshrrev_b32 v13, 9, v13
    v_mad_i32_i24 v13, v13, -3, v12
    v_lshl_add_u32 v13, v13, 9, v7
    buffer_load_dword v11, v13, s[12:15], 0 offen sc1
L_g_nl_97:
L_g_loop0_89_l:
    s_barrier
    ds_read_b128 v[32:35], v4 offset:0
    ds_read_b128 v[36:39], v4 offset:1024
    ds_read_b128 v[40:43], v4 offset:2048
    ds_read_b128 v[44:47], v4 offset:3072
    ds_read_b128 v[48:51], v4 offset:4096
    ds_read_b128 v[52:55], v4 offset:5120
    ds_read_b128 v[56:59], v4 offset:6144
    ds_read_b128 v[60:63], v4 offset:7168
    s_branch L_g_loop0_89_m
.p2align 6
L_g_loop0_89:
    s_barrier
L_g_loop0_89_m:
    s_setprio 2
    s_waitcnt lgkmcnt(6)
    v_mfma_f32_32x32x16_bf16 v[16:31], a[0:3], v[32:35], v[64:79]
    ds_read_b128 v[32:35], v4 offset:8192
    ds_read_b32 v14, v15
    v_mfma_f32_32x32x16_bf16 v[16:31], a[4:7], v[36:39], v[16:31]
    ds_read_b128 v[36:39], v4 offset:9216
    s_waitcnt lgkmcnt(6)
    v_mfma_f32_32x32x16_bf16 v[16:31], a[8:11], v[40:43], v[16:31]
    ds_read_b128 v[40:43], v4 offset:10240
    v_mfma_f32_32x32x16_bf16 v[16:31], a[12:15], v[44:47], v[16:31]
    ds_read_b128 v[44:47], v4 offset:11264
    s_waitcnt lgkmcnt(6)
    v_mfma_f32_32x32x16_bf16 v[16:31], a[16:19], v[48:51], v[16:31]
    ds_read_b128 v[48:51], v4 offset:12288
    v_mfma_f32_32x32x16_bf16 v[16:31], a[20:23], v[52:55], v[16:31]
    ds_read_b128 v[52:55], v4 offset:13312
    s_waitcnt lgkmcnt(6)
    v_mfma_f32_32x32x16_bf16 v[16:31], a[24:27], v[56:59], v[16:31]
    ds_read_b128 v[56:59], v4 offset:14336
    v_mfma_f32_32x32x16_bf16 v[16:31], a[28:31], v[60:63], v[16:31]
    ds_read_b128 v[60:63], v4 offset:15360
    s_waitcnt lgkmcnt(6)
    v_mfma_f32_32x32x16_bf16 v[16:31], a[32:35], v[32:35], v[16:31]
    ds_read_b128 v[32:35], v4 offset:16384
    v_mfma_f32_32x32x16_bf16 v[16:31], a[36:39], v[36:39], v[16:31]
    ds_read_b128 v[36:39], v4 offset:17408
    s_waitcnt lgkmcnt(6)
    v_mfma_f32_32x32x16_bf16 v[16:31], a[40:43], v[40:43], v[16:31]
    ds_read_b128 v[40:43], v4 offset:18432
    v_mfma_f32_32x32x16_bf16 v[16:31], a[44:47], v[44:47], v[16:31]
    ds_read_b128 v[44:47], v4 offset:19456
    s_waitcnt lgkmcnt(6)
    v_mfma_f32_32x32x16_bf16 v[16:31], a[48:51], v[48:51], v[16:31]
    ds_read_b128 v[48:51], v4 offset:20480
    v_mfma_f32_32x32x16_bf16 v[16:31], a[52:55], v[52:55], v[16:31]
    ds_read_b128 v[52:55], v4 offset:21504
    s_waitcnt lgkmcnt(6)
    v_mfma_f32_32x32x16_bf16 v[16:31], a[56:59], v[56:59], v[16:31]
    ds_read_b128 v[56:59], v4 offset:22528
    v_mfma_f32_32x32x16_bf16 v[16:31], a[60:63], v[60:63], v[16:31]
    ds_read_b128 v[60:63], v4 offset:23552
    s_waitcnt lgkmcnt(6)
    v_mfma_f32_32x32x16_bf16 v[16:31], a[64:67], v[32:35], v[16:31]
    ds_read_b128 v[32:35], v4 offset:24576
    v_mfma_f32_32x32x16_bf16 v[16:31], a[68:71], v[36:39], v[16:31]
    ds_read_b128 v[36:39], v4 offset:25600
    s_waitcnt lgkmcnt(6)
    v_mfma_f32_32x32x16_bf16 v[16:31], a[72:75], v[40:43], v[16:31]
    ds_read_b128 v[40:43], v4 offset:26624
    v_mfma_f32_32x32x16_bf16 v[16:31], a[76:79], v[44:47], v[16:31]
    ds_read_b128 v[44:47], v4 offset:27648
    s_waitcnt lgkmcnt(6)
    v_mfma_f32_32x32x16_bf16 v[16:31], a[80:83], v[48:51], v[16:31]
    ds_read_b128 v[48:51], v4 offset:28672
    v_mfma_f32_32x32x16_bf16 v[16:31], a[84:87], v[52:55], v[16:31]
    ds_read_b128 v[52:55], v4 offset:29696
    s_waitcnt lgkmcnt(6)
    v_mfma_f32_32x32x16_bf16 v[16:31], a[88:91], v[56:59], v[16:31]
    ds_read_b128 v[56:59], v4 offset:30720
    v_mfma_f32_32x32x16_bf16 v[16:31], a[92:95], v[60:63], v[16:31]
    ds_read_b128 v[60:63], v4 offset:31744
    s_waitcnt lgkmcnt(6)
    v_mfma_f32_32x32x16_bf16 v[16:31], a[96:99], v[32:35], v[16:31]
    v_mfma_f32_32x32x16_bf16 v[16:31], a[100:103], v[36:39], v[16:31]
    s_waitcnt lgkmcnt(4)
    v_mfma_f32_32x32x16_bf16 v[16:31], a[104:107], v[40:43], v[16:31]
    v_mfma_f32_32x32x16_bf16 v[16:31], a[108:111], v[44:47], v[16:31]
    s_waitcnt lgkmcnt(2)
    v_mfma_f32_32x32x16_bf16 v[16:31], a[112:115], v[48:51], v[16:31]
    v_mfma_f32_32x32x16_bf16 v[16:31], a[116:119], v[52:55], v[16:31]
    s_waitcnt lgkmcnt(0)
    v_mfma_f32_32x32x16_bf16 v[16:31], a[120:123], v[56:59], v[16:31]
    v_mfma_f32_32x32x16_bf16 v[16:31], a[124:127], v[60:63], v[16:31]
    v_xor_b32 v4, 0x10000, v4
    s_setprio 0
    s_waitcnt vmcnt(0)
    v_readfirstlane_b32 s66, v14
    s_barrier
    s_nop 6
    ds_write_b128 v5, v[16:19] offset:0
    ds_write_b128 v5, v[20:23] offset:1024
    ds_write_b128 v5, v[24:27] offset:2048
    ds_write_b128 v5, v[28:31] offset:3072
    s_cmp_lg_u32 s44, 0
    s_cbranch_scc1 L_g_ne_98
    v_cmp_ge_u32 vcc, v12, v11
    s_nop 0
    s_ff1_i32_b64 s46, vcc
    s_lshr_b32 s46, s46, 4
    s_min_u32 s46, s46, 4
    s_add_u32 s46, s46, s54
    s_min_u32 s46, s46, s75
    v_mov_b32 v11, s46
    ds_write_b32 v15, v11 offset:0
L_g_ne_98:
    s_add_u32 s60, s60, 1
    s_mov_b32 s65, 0
    s_cmp_le_u32 s62, s60
    s_cbranch_scc1 L_g_dp_101_l
L_g_dp_101_a:
    s_cmp_ge_u32 s62, s66
    s_cbranch_scc1 L_g_dp_101_d
    s_add_u32 s47, s61, 4096
    s_mov_b32 m0, s64
    s_add_u32 s62, s62, 1
    buffer_load_dwordx4 v3, s[12:15], s61 offen offset:0 sc1 lds
    buffer_load_dwordx4 v3, s[12:15], s61 offen offset:1024 sc1 lds
    buffer_load_dwordx4 v3, s[12:15], s61 offen offset:2048 sc1 lds
    buffer_load_dwordx4 v3, s[12:15], s61 offen offset:3072 sc1 lds
    s_add_u32 m0, s64, 4096
    s_add_u32 s61, s61, 65536
    buffer_load_dwordx4 v3, s[12:15], s47 offen offset:0 sc1 lds
    buffer_load_dwordx4 v3, s[12:15], s47 offen offset:1024 sc1 lds
    buffer_load_dwordx4 v3, s[12:15], s47 offen offset:2048 sc1 lds
    buffer_load_dwordx4 v3, s[12:15], s47 offen offset:3072 sc1 lds
    s_xor_b32 s64, s64, 0x10000
L_g_dp_101_d:
    s_cmp_le_u32 s66, s60
    s_cbranch_scc1 L_g_ex0_100
    s_cmp_lg_u32 s65, 0
    s_cbranch_scc1 L_g_nw_99
    ds_read_b128 v[32:35], v4 offset:0
    ds_read_b128 v[36:39], v4 offset:1024
    ds_read_b128 v[40:43], v4 offset:2048
    ds_read_b128 v[44:47], v4 offset:3072
    ds_read_b128 v[48:51], v4 offset:4096
    ds_read_b128 v[52:55], v4 offset:5120
    ds_read_b128 v[56:59], v4 offset:6144
    ds_read_b128 v[60:63], v4 offset:7168
    s_cmp_lg_u32 s44, 0
    s_cbranch_scc1 L_g_nl_102
    s_add_u32 s54, s60, 1
    v_add_u32 v12, s54, v113
    v_mul_u32_u24 v13, 171, v12
    v_lshrrev_b32 v13, 9, v13
    v_mad_i32_i24 v13, v13, -3, v12
    v_lshl_add_u32 v13, v13, 9, v7
    buffer_load_dword v11, v13, s[12:15], 0 offen sc1
L_g_nl_102:
    s_waitcnt lgkmcnt(8)
    s_branch L_g_loop0_89
L_g_ex0_100:
    s_cmp_lg_u32 s44, 0
    s_cbranch_scc1 L_g_ex0_100_n
    s_sleep 6
    s_add_u32 s54, s60, 0
    v_add_u32 v12, s54, v113
    v_mul_u32_u24 v13, 171, v12
    v_lshrrev_b32 v13, 9, v13
    v_mad_i32_i24 v13, v13, -3, v12
    v_lshl_add_u32 v13, v13, 9, v7
    buffer_load_dword v11, v13, s[12:15], 0 offen sc1
    s_waitcnt vmcnt(0)
    v_cmp_ge_u32 vcc, v12, v11
    s_nop 0
    s_ff1_i32_b64 s46, vcc
    s_lshr_b32 s46, s46, 4
    s_min_u32 s46, s46, 4
    s_add_u32 s46, s46, s54
    s_min_u32 s46, s46, s75
    v_mov_b32 v11, s46
    ds_write_b32 v15, v11 offset:0
L_g_ex0_100_n:
    s_waitcnt lgkmcnt(0)
    s_barrier
    ds_read_b32 v14, v15 offset:0
    s_waitcnt lgkmcnt(0)
    v_readfirstlane_b32 s66, v14
    s_barrier
    s_cmp_gt_u32 s66, s60
    s_cbranch_scc1 L_g_restart_86_go
    s_branch L_g_tail_91
L_g_g1r_88:
    s_mov_b32 s65, 1
    s_branch L_g_loop1_90_e
.p2align 6
L_g_loop1_90:
    s_mov_b32 s65, 0
L_g_loop1_90_e:
    s_barrier
    ds_read_b32 v14, v15
    s_bitcmp1_b32 s67, 2
    s_cbranch_scc0 L_g_nfl_103
    s_cmp_lg_u32 s44, 4
    s_cbranch_scc1 L_g_nfl_103_d
    s_sub_u32 s59, s60, 2
    v_mov_b32 v10, s59
    buffer_store_dword v10, v115, s[12:15], s52 offen sc1
L_g_nfl_103_d:
    s_waitcnt lgkmcnt(0)
    v_readfirstlane_b32 s66, v14
    ds_read_b128 v[80:83], v5 offset:0
    ds_read_b128 v[84:87], v5 offset:1024
    ds_read_b128 v[88:91], v5 offset:2048
    ds_read_b128 v[92:95], v5 offset:3072
    s_cmp_le_u32 s62, s60
    s_cbranch_scc1 L_g_dp_108_l
L_g_dp_108_a:
    s_cmp_ge_u32 s62, s66
    s_cbranch_scc1 L_g_dp_108_d
    s_add_u32 s47, s61, 4096
    s_mov_b32 m0, s64
    s_add_u32 s62, s62, 1
    buffer_load_dwordx4 v3, s[12:15], s61 offen offset:0 sc1 lds
    buffer_load_dwordx4 v3, s[12:15], s61 offen offset:1024 sc1 lds
    buffer_load_dwordx4 v3, s[12:15], s61 offen offset:2048 sc1 lds
    buffer_load_dwordx4 v3, s[12:15], s61 offen offset:3072 sc1 lds
    s_add_u32 m0, s64, 4096
    s_add_u32 s61, s61, 65536
    buffer_load_dwordx4 v3, s[12:15], s47 offen offset:0 sc1 lds
    buffer_load_dwordx4 v3, s[12:15], s47 offen offset:1024 sc1 lds
    buffer_load_dwordx4 v3, s[12:15], s47 offen offset:2048 sc1 lds
    buffer_load_dwordx4 v3, s[12:15], s47 offen offset:3072 sc1 lds
    s_xor_b32 s64, s64, 0x10000
L_g_dp_108_d:
    s_bitcmp1_b32 s67, 0
    s_cbranch_scc0 L_g_nep_104
    s_waitcnt lgkmcnt(0)
    v_add_f32 v80, v80, v16
    v_add_f32 v81, v81, v17
    v_add_f32 v82, v82, v18
    v_add_f32 v83, v83, v19
    v_add_f32 v84, v84, v20
    v_add_f32 v85, v85, v21
    v_add_f32 v86, v86, v22
    v_add_f32 v87, v87, v23
    v_add_f32 v88, v88, v24
    v_add_f32 v89, v89, v25
    v_add_f32 v90, v90, v26
    v_add_f32 v91, v91, v27
    v_add_f32 v92, v92, v28
    v_add_f32 v93, v93, v29
    v_add_f32 v94, v94, v30
    v_add_f32 v95, v95, v31
L_g_nep_104:
    v_mul_f32 v96, v80, v80
    v_mul_f32 v97, v81, v81
    v_mul_f32 v98, v82, v82
    v_mul_f32 v99, v83, v83
    v_mul_f32 v100, v84, v84
    v_mul_f32 v101, v85, v85
    v_mul_f32 v102, v86, v86
    v_mul_f32 v103, v87, v87
    v_fma_f32 v96, v96, s56, v112
    v_fma_f32 v97, v97, s56, v112
    v_fma_f32 v98, v98, s56, v112
    v_fma_f32 v99, v99, s56, v112
    v_fma_f32 v100, v100, s56, v112
    v_fma_f32 v101, v101, s56, v112
    v_fma_f32 v102, v102, s56, v112
    v_fma_f32 v103, v103, s56, v112
    v_mul_f32 v96, v96, v80
    v_mul_f32 v97, v97, v81
    v_mul_f32 v98, v98, v82
    v_mul_f32 v99, v99, v83
    v_mul_f32 v100, v100, v84
    v_mul_f32 v101, v101, v85
    v_mul_f32 v102, v102, v86
    v_mul_f32 v103, v103, v87
    v_exp_f32 v96, v96
    v_exp_f32 v97, v97
    v_exp_f32 v98, v98
    v_exp_f32 v99, v99
    v_exp_f32 v100, v100
    v_exp_f32 v101, v101
    v_exp_f32 v102, v102
    v_exp_f32 v103, v103
    v_add_f32 v96, 1.0, v96
    v_add_f32 v97, 1.0, v97
    v_add_f32 v98, 1.0, v98
    v_add_f32 v99, 1.0, v99
    s_cmp_lg_u32 s65, 0
    s_cbranch_scc1 L_g_nw1_105
    ds_read_b128 v[32:35], v4 offset:0
    ds_read_b128 v[36:39], v4 offset:1024
    ds_read_b128 v[40:43], v4 offset:2048
    ds_read_b128 v[44:47], v4 offset:3072
    ds_read_b128 v[48:51], v4 offset:4096
    ds_read_b128 v[52:55], v4 offset:5120
    ds_read_b128 v[56:59], v4 offset:6144
    ds_read_b128 v[60:63], v4 offset:7168
    s_barrier
L_g_jn_107:
    s_bitcmp1_b32 s67, 0
    s_cbranch_scc0 L_g_mm2_106
    s_setprio 1
    s_waitcnt lgkmcnt(6)
    v_mfma_f32_32x32x16_bf16 v[16:31], a[0:3], v[32:35], 0
    ds_read_b128 v[32:35], v4 offset:8192
    v_add_f32 v100, 1.0, v100
    v_add_f32 v101, 1.0, v101
    v_add_f32 v102, 1.0, v102
    v_add_f32 v103, 1.0, v103
    v_mfma_f32_32x32x16_bf16 v[16:31], a[4:7], v[36:39], v[16:31]
    ds_read_b128 v[36:39], v4 offset:9216
    v_rcp_f32 v96, v96
    v_rcp_f32 v97, v97
    s_waitcnt lgkmcnt(6)
    v_mfma_f32_32x32x16_bf16 v[16:31], a[8:11], v[40:43], v[16:31]
    ds_read_b128 v[40:43], v4 offset:10240
    v_rcp_f32 v98, v98
    v_rcp_f32 v99, v99
    v_mfma_f32_32x32x16_bf16 v[16:31], a[12:15], v[44:47], v[16:31]
    ds_read_b128 v[44:47], v4 offset:11264
    v_rcp_f32 v100, v100
    v_rcp_f32 v101, v101
    s_waitcnt lgkmcnt(6)
    v_mfma_f32_32x32x16_bf16 v[16:31], a[16:19], v[48:51], v[16:31]
    ds_read_b128 v[48:51], v4 offset:12288
    v_rcp_f32 v102, v102
    v_rcp_f32 v103, v103
    v_mfma_f32_32x32x16_bf16 v[16:31], a[20:23], v[52:55], v[16:31]
    ds_read_b128 v[52:55], v4 offset:13312
    v_mul_f32 v80, v80, v96
    v_mul_f32 v81, v81, v97
    v_mul_f32 v82, v82, v98
    v_mul_f32 v83, v83, v99
    s_waitcnt lgkmcnt(6)
    v_mfma_f32_32x32x16_bf16 v[16:31], a[24:27], v[56:59], v[16:31]
    ds_read_b128 v[56:59], v4 offset:14336
    v_mul_f32 v84, v84, v100
    v_mul_f32 v85, v85, v101
    v_mul_f32 v86, v86, v102
    v_mul_f32 v87, v87, v103
    v_mfma_f32_32x32x16_bf16 v[16:31], a[28:31], v[60:63], v[16:31]
    ds_read_b128 v[60:63], v4 offset:15360
    v_cvt_pk_bf16_f32 v104, v80, v81
    v_cvt_pk_bf16_f32 v105, v82, v83
    v_cvt_pk_bf16_f32 v106, v84, v85
    v_cvt_pk_bf16_f32 v107, v86, v87
    s_waitcnt lgkmcnt(6)
    v_mfma_f32_32x32x16_bf16 v[16:31], a[32:35], v[32:35], v[16:31]
    ds_read_b128 v[32:35], v4 offset:16384
    buffer_store_dwordx4 v[104:107], v8, s[12:15], s63 offen sc1
    v_mul_f32 v96, v88, v88
    v_mul_f32 v97, v89, v89
    v_mul_f32 v98, v90, v90
    v_mfma_f32_32x32x16_bf16 v[16:31], a[36:39], v[36:39], v[16:31]
    ds_read_b128 v[36:39], v4 offset:17408
    v_mul_f32 v99, v91, v91
    v_mul_f32 v100, v92, v92
    v_mul_f32 v101, v93, v93
    v_mul_f32 v102, v94, v94
    s_waitcnt lgkmcnt(6)
    v_mfma_f32_32x32x16_bf16 v[16:31], a[40:43], v[40:43], v[16:31]
    ds_read_b128 v[40:43], v4 offset:18432
    v_mul_f32 v103, v95, v95
    v_fma_f32 v96, v96, s56, v112
    v_fma_f32 v97, v97, s56, v112
    v_fma_f32 v98, v98, s56, v112
    v_mfma_f32_32x32x16_bf16 v[16:31], a[44:47], v[44:47], v[16:31]
    ds_read_b128 v[44:47], v4 offset:19456
    v_fma_f32 v99, v99, s56, v112
    v_fma_f32 v100, v100, s56, v112
    v_fma_f32 v101, v101, s56, v112
    v_fma_f32 v102, v102, s56, v112
    s_waitcnt lgkmcnt(6)
    v_mfma_f32_32x32x16_bf16 v[16:31], a[48:51], v[48:51], v[16:31]
    ds_read_b128 v[48:51], v4 offset:20480
    v_fma_f32 v103, v103, s56, v112
    v_mul_f32 v96, v96, v88
    v_mul_f32 v97, v97, v89
    v_mul_f32 v98, v98, v90
    v_mfma_f32_32x32x16_bf16 v[16:31], a[52:55], v[52:55], v[16:31]
    ds_read_b128 v[52:55], v4 offset:21504
    v_mul_f32 v99, v99, v91
    v_mul_f32 v100, v100, v92
    v_mul_f32 v101, v101, v93
    v_mul_f32 v102, v102, v94
    s_waitcnt lgkmcnt(6)
    v_mfma_f32_32x32x16_bf16 v[16:31], a[56:59], v[56:59], v[16:31]
    ds_read_b128 v[56:59], v4 offset:22528
    v_mul_f32 v103, v103, v95
    v_exp_f32 v96, v96
    v_exp_f32 v97, v97
    v_mfma_f32_32x32x16_bf16 v[16:31], a[60:63], v[60:63], v[16:31]
    ds_read_b128 v[60:63], v4 offset:23552
    v_exp_f32 v98, v98
    v_exp_f32 v99, v99
    s_waitcnt lgkmcnt(6)
    v_mfma_f32_32x32x16_bf16 v[16:31], a[64:67], v[32:35], v[16:31]
    ds_read_b128 v[32:35], v4 offset:24576
    v_exp_f32 v100, v100
    v_exp_f32 v101, v101
    v_mfma_f32_32x32x16_bf16 v[16:31], a[68:71], v[36:39], v[16:31]
    ds_read_b128 v[36:39], v4 offset:25600
    v_exp_f32 v102, v102
    v_exp_f32 v103, v103
    s_waitcnt lgkmcnt(6)
    v_mfma_f32_32x32x16_bf16 v[16:31], a[72:75], v[40:43], v[16:31]
    ds_read_b128 v[40:43], v4 offset:26624
    v_add_f32 v96, 1.0, v96
    v_add_f32 v97, 1.0, v97
    v_add_f32 v98, 1.0, v98
    v_add_f32 v99, 1.0, v99
    v_mfma_f32_32x32x16_bf16 v[16:31], a[76:79], v[44:47], v[16:31]
    ds_read_b128 v[44:47], v4 offset:27648
    v_add_f32 v100, 1.0, v100
    v_add_f32 v101, 1.0, v101
    v_add_f32 v102, 1.0, v102
    v_add_f32 v103, 1.0, v103
    s_waitcnt lgkmcnt(6)
    v_mfma_f32_32x32x16_bf16 v[16:31], a[80:83], v[48:51], v[16:31]
    ds_read_b128 v[48:51], v4 offset:28672
    v_rcp_f32 v96, v96
    v_rcp_f32 v97, v97
    v_mfma_f32_32x32x16_bf16 v[16:31], a[84:87], v[52:55], v[16:31]
    ds_read_b128 v[52:55], v4 offset:29696
    v_rcp_f32 v98, v98
    v_rcp_f32 v99, v99
    s_waitcnt lgkmcnt(6)
    v_mfma_f32_32x32x16_bf16 v[16:31], a[88:91], v[56:59], v[16:31]
    ds_read_b128 v[56:59], v4 offset:30720
    v_rcp_f32 v100, v100
    v_rcp_f32 v101, v101
    v_mfma_f32_32x32x16_bf16 v[16:31], a[92:95], v[60:63], v[16:31]
    ds_read_b128 v[60:63], v4 offset:31744
    v_rcp_f32 v102, v102
    v_rcp_f32 v103, v103
    s_waitcnt lgkmcnt(6)
    v_mfma_f32_32x32x16_bf16 v[16:31], a[96:99], v[32:35], v[16:31]
    v_mul_f32 v88, v88, v96
    v_mul_f32 v89, v89, v97
    v_mul_f32 v90, v90, v98
    v_mul_f32 v91, v91, v99
    v_mfma_f32_32x32x16_bf16 v[16:31], a[100:103], v[36:39], v[16:31]
    v_mul_f32 v92, v92, v100
    v_mul_f32 v93, v93, v101
    v_mul_f32 v94, v94, v102
    v_mul_f32 v95, v95, v103
    s_waitcnt lgkmcnt(4)
    v_mfma_f32_32x32x16_bf16 v[16:31], a[104:107], v[40:43], v[16:31]
    v_cvt_pk_bf16_f32 v108, v88, v89
    v_cvt_pk_bf16_f32 v109, v90, v91
    v_cvt_pk_bf16_f32 v110, v92, v93
    v_cvt_pk_bf16_f32 v111, v94, v95
    v_mfma_f32_32x32x16_bf16 v[16:31], a[108:111], v[44:47], v[16:31]
    buffer_store_dwordx4 v[108:111], v9, s[12:15], s63 offen sc1
    s_add_u32 s63, s63, 229376
    s_waitcnt lgkmcnt(2)
    v_mfma_f32_32x32x16_bf16 v[16:31], a[112:115], v[48:51], v[16:31]
    v_mfma_f32_32x32x16_bf16 v[16:31], a[116:119], v[52:55], v[16:31]
    s_waitcnt lgkmcnt(0)
    v_mfma_f32_32x32x16_bf16 v[16:31], a[120:123], v[56:59], v[16:31]
    v_mfma_f32_32x32x16_bf16 v[16:31], a[124:127], v[60:63], v[16:31]
    v_xor_b32 v4, 0x10000, v4
    s_setprio 0
    s_waitcnt vmcnt(2)
L_g_mm2_106_d:
    s_lshl_b32 s67, s67, 1
    s_or_b32 s67, s67, 1
    s_add_u32 s60, s60, 1
    s_cmp_gt_u32 s66, s60
    s_cbranch_scc1 L_g_loop1_90
    s_barrier
    ds_read_b32 v14, v15 offset:0
    s_waitcnt lgkmcnt(0)
    v_readfirstlane_b32 s66, v14
    s_barrier
    s_mov_b32 s69, 0
    s_cmp_gt_u32 s62, s60
    s_cbranch_scc1 L_g_nd_109
    s_cmp_ge_u32 s62, s66
    s_cbranch_scc1 L_g_nd_109
    s_add_u32 s47, s61, 4096
    s_add_u32 m0, s64, 0
    s_nop 0
    buffer_load_dwordx4 v3, s[12:15], s61 offen offset:0 sc1 lds
    buffer_load_dwordx4 v3, s[12:15], s61 offen offset:1024 sc1 lds
    buffer_load_dwordx4 v3, s[12:15], s61 offen offset:2048 sc1 lds
    buffer_load_dwordx4 v3, s[12:15], s61 offen offset:3072 sc1 lds
    s_add_u32 m0, s64, 4096
    s_nop 0
    buffer_load_dwordx4 v3, s[12:15], s47 offen offset:0 sc1 lds
    buffer_load_dwordx4 v3, s[12:15], s47 offen offset:1024 sc1 lds
    buffer_load_dwordx4 v3, s[12:15], s47 offen offset:2048 sc1 lds
    buffer_load_dwordx4 v3, s[12:15], s47 offen offset:3072 sc1 lds
    s_add_u32 s61, s61, 65536
    s_add_u32 s62, s62, 1
    s_xor_b32 s64, s64, 0x10000
    s_mov_b32 s69, 1
L_g_nd_109:
    s_sub_u32 s59, s60, 1
    ds_read_b128 v[80:83], v5 offset:0
    ds_read_b128 v[84:87], v5 offset:1024
    ds_read_b128 v[88:91], v5 offset:2048
    ds_read_b128 v[92:95], v5 offset:3072
    s_nop 7
    s_waitcnt lgkmcnt(3)
    v_add_f32 v80, v80, v16
    v_add_f32 v81, v81, v17
    v_add_f32 v82, v82, v18
    v_add_f32 v83, v83, v19
    s_waitcnt lgkmcnt(2)
    v_add_f32 v84, v84, v20
    v_add_f32 v85, v85, v21
    v_add_f32 v86, v86, v22
    v_add_f32 v87, v87, v23
    s_waitcnt lgkmcnt(1)
    v_add_f32 v88, v88, v24
    v_add_f32 v89, v89, v25
    v_add_f32 v90, v90, v26
    v_add_f32 v91, v91, v27
    s_waitcnt lgkmcnt(0)
    v_add_f32 v92, v92, v28
    v_add_f32 v93, v93, v29
    v_add_f32 v94, v94, v30
    v_add_f32 v95, v95, v31
    v_mul_f32 v96, v80, v80
    v_mul_f32 v97, v81, v81
    v_mul_f32 v98, v82, v82
    v_mul_f32 v99, v83, v83
    v_mul_f32 v100, v84, v84
    v_mul_f32 v101, v85, v85
    v_mul_f32 v102, v86, v86
    v_mul_f32 v103, v87, v87
    v_fma_f32 v96, v96, s56, v112
    v_fma_f32 v97, v97, s56, v112
    v_fma_f32 v98, v98, s56, v112
    v_fma_f32 v99, v99, s56, v112
    v_fma_f32 v100, v100, s56, v112
    v_fma_f32 v101, v101, s56, v112
    v_fma_f32 v102, v102, s56, v112
    v_fma_f32 v103, v103, s56, v112
    v_mul_f32 v96, v96, v80
    v_mul_f32 v97, v97, v81
    v_mul_f32 v98, v98, v82
    v_mul_f32 v99, v99, v83
    v_mul_f32 v100, v100, v84
    v_mul_f32 v101, v101, v85
    v_mul_f32 v102, v102, v86
    v_mul_f32 v103, v103, v87
    v_exp_f32 v96, v96
    v_exp_f32 v97, v97
    v_exp_f32 v98, v98
    v_exp_f32 v99, v99
    v_exp_f32 v100, v100
    v_exp_f32 v101, v101
    v_exp_f32 v102, v102
    v_exp_f32 v103, v103
    v_add_f32 v96, 1.0, v96
    v_add_f32 v97, 1.0, v97
    v_add_f32 v98, 1.0, v98
    v_add_f32 v99, 1.0, v99
    v_add_f32 v100, 1.0, v100
    v_add_f32 v101, 1.0, v101
    v_add_f32 v102, 1.0, v102
    v_add_f32 v103, 1.0, v103
    v_rcp_f32 v96, v96
    v_rcp_f32 v97, v97
    v_rcp_f32 v98, v98
    v_rcp_f32 v99, v99
    v_rcp_f32 v100, v100
    v_rcp_f32 v101, v101
    v_rcp_f32 v102, v102
    v_rcp_f32 v103, v103
    v_mul_f32 v80, v80, v96
    v_mul_f32 v81, v81, v97
    v_mul_f32 v82, v82, v98
    v_mul_f32 v83, v83, v99
    v_mul_f32 v84, v84, v100
    v_mul_f32 v85, v85, v101
    v_mul_f32 v86, v86, v102
    v_mul_f32 v87, v87, v103
    v_cvt_pk_bf16_f32 v104, v80, v81
    v_cvt_pk_bf16_f32 v105, v82, v83
    v_cvt_pk_bf16_f32 v106, v84, v85
    v_cvt_pk_bf16_f32 v107, v86, v87
    buffer_store_dwordx4 v[104:107], v8, s[12:15], s63 offen sc1
    v_mul_f32 v96, v88, v88
    v_mul_f32 v97, v89, v89
    v_mul_f32 v98, v90, v90
    v_mul_f32 v99, v91, v91
    v_mul_f32 v100, v92, v92
    v_mul_f32 v101, v93, v93
    v_mul_f32 v102, v94, v94
    v_mul_f32 v103, v95, v95
    v_fma_f32 v96, v96, s56, v112
    v_fma_f32 v97, v97, s56, v112
    v_fma_f32 v98, v98, s56, v112
    v_fma_f32 v99, v99, s56, v112
    v_fma_f32 v100, v100, s56, v112
    v_fma_f32 v101, v101, s56, v112
    v_fma_f32 v102, v102, s56, v112
    v_fma_f32 v103, v103, s56, v112
    v_mul_f32 v96, v96, v88
    v_mul_f32 v97, v97, v89
    v_mul_f32 v98, v98, v90
    v_mul_f32 v99, v99, v91
    v_mul_f32 v100, v100, v92
    v_mul_f32 v101, v101, v93
    v_mul_f32 v102, v102, v94
    v_mul_f32 v103, v103, v95
    v_exp_f32 v96, v96
    v_exp_f32 v97, v97
    v_exp_f32 v98, v98
    v_exp_f32 v99, v99
    v_exp_f32 v100, v100
    v_exp_f32 v101, v101
    v_exp_f32 v102, v102
    v_exp_f32 v103, v103
    v_add_f32 v96, 1.0, v96
    v_add_f32 v97, 1.0, v97
    v_add_f32 v98, 1.0, v98
    v_add_f32 v99, 1.0, v99
    v_add_f32 v100, 1.0, v100
    v_add_f32 v101, 1.0, v101
    v_add_f32 v102, 1.0, v102
    v_add_f32 v103, 1.0, v103
    v_rcp_f32 v96, v96
    v_rcp_f32 v97, v97
    v_rcp_f32 v98, v98
    v_rcp_f32 v99, v99
    v_rcp_f32 v100, v100
    v_rcp_f32 v101, v101
    v_rcp_f32 v102, v102
    v_rcp_f32 v103, v103
    v_mul_f32 v88, v88, v96
    v_mul_f32 v89, v89, v97
    v_mul_f32 v90, v90, v98
    v_mul_f32 v91, v91, v99
    v_mul_f32 v92, v92, v100
    v_mul_f32 v93, v93, v101
    v_mul_f32 v94, v94, v102
    v_mul_f32 v95, v95, v103
    v_cvt_pk_bf16_f32 v108, v88, v89
    v_cvt_pk_bf16_f32 v109, v90, v91
    v_cvt_pk_bf16_f32 v110, v92, v93
    v_cvt_pk_bf16_f32 v111, v94, v95
    buffer_store_dwordx4 v[108:111], v9, s[12:15], s63 offen sc1
    s_add_u32 s63, s63, 229376
    s_mov_b32 s67, 0
    s_mov_b32 s71, 1
    s_cmp_gt_u32 s66, s60
    s_cbranch_scc1 L_g_g1r_88
    v_mov_b32 v10, 1
    s_mov_b64 exec, 1
    s_waitcnt vmcnt(0)
    ds_add_rtn_u32 v10, v15, v10 offset:4
    s_waitcnt lgkmcnt(0)
    v_readfirstlane_b32 s46, v10
    s_mov_b64 exec, -1
    s_mov_b32 s71, 0
    s_sub_u32 s59, s60, 1
    s_cmp_lg_u32 s46, s68
    s_cbranch_scc1 L_g_df_110
    v_mov_b32 v10, s59
    v_add_u32 v10, 1, v10
    v_mov_b32 v11, 0
    s_mov_b64 exec, 1
    buffer_store_dword v10, v11, s[12:15], s52 offen sc1
    s_mov_b64 exec, -1
L_sf_111:
L_g_df_110:
    s_add_u32 s68, s68, 4
    s_cmp_gt_u32 s66, s60
    s_cbranch_scc1 L_g_g1r_88
L_g_tail_91:
    s_cmp_lt_u32 s60, s75
    s_cbranch_scc1 L_g_restart_86
    s_waitcnt vmcnt(0)
    s_barrier
    s_branch L_w_f1_14_d
L_g_dp_101_l:
    s_cmp_ge_u32 s62, s66
    s_cbranch_scc1 L_g_dp_101_d
    s_mov_b32 s65, 1
    s_add_u32 s47, s61, 4096
    s_mov_b32 m0, s64
    s_add_u32 s62, s62, 1
    buffer_load_dwordx4 v3, s[12:15], s61 offen offset:0 sc1 lds
    buffer_load_dwordx4 v3, s[12:15], s61 offen offset:1024 sc1 lds
    buffer_load_dwordx4 v3, s[12:15], s61 offen offset:2048 sc1 lds
    buffer_load_dwordx4 v3, s[12:15], s61 offen offset:3072 sc1 lds
    s_add_u32 m0, s64, 4096
    s_add_u32 s61, s61, 65536
    buffer_load_dwordx4 v3, s[12:15], s47 offen offset:0 sc1 lds
    buffer_load_dwordx4 v3, s[12:15], s47 offen offset:1024 sc1 lds
    buffer_load_dwordx4 v3, s[12:15], s47 offen offset:2048 sc1 lds
    buffer_load_dwordx4 v3, s[12:15], s47 offen offset:3072 sc1 lds
    s_xor_b32 s64, s64, 0x10000
    s_branch L_g_dp_101_a
L_g_nw_99:
    s_waitcnt vmcnt(0) lgkmcnt(0)
    s_cmp_lg_u32 s44, 0
    s_cbranch_scc1 L_g_nl_112
    s_add_u32 s54, s60, 1
    v_add_u32 v12, s54, v113
    v_mul_u32_u24 v13, 171, v12
    v_lshrrev_b32 v13, 9, v13
    v_mad_i32_i24 v13, v13, -3, v12
    v_lshl_add_u32 v13, v13, 9, v7
    buffer_load_dword v11, v13, s[12:15], 0 offen sc1
L_g_nl_112:
    s_branch L_g_loop0_89_l
L_g_nfl_103:
    s_cmp_eq_u32 s71, 0
    s_cbranch_scc1 L_g_nfl_103_d
    v_mov_b32 v10, 1
    s_mov_b64 exec, 1
    s_waitcnt vmcnt(0)
    ds_add_rtn_u32 v10, v15, v10 offset:4
    s_waitcnt lgkmcnt(0)
    v_readfirstlane_b32 s46, v10
    s_mov_b64 exec, -1
    s_mov_b32 s71, 0
    s_sub_u32 s59, s60, 1
    s_cmp_lg_u32 s46, s68
    s_cbranch_scc1 L_g_df_113
    v_mov_b32 v10, s59
    v_add_u32 v10, 1, v10
    v_mov_b32 v11, 0
    s_mov_b64 exec, 1
    buffer_store_dword v10, v11, s[12:15], s52 offen sc1
    s_mov_b64 exec, -1
L_sf_114:
L_g_df_113:
    s_add_u32 s68, s68, 4
    s_mov_b32 s65, 2
    s_branch L_g_nfl_103_d
L_g_dp_108_l:
    s_cmp_ge_u32 s62, s66
    s_cbranch_scc1 L_g_dp_108_d
    s_or_b32 s65, s65, 1
    s_add_u32 s47, s61, 4096
    s_mov_b32 m0, s64
    s_add_u32 s62, s62, 1
    buffer_load_dwordx4 v3, s[12:15], s61 offen offset:0 sc1 lds
    buffer_load_dwordx4 v3, s[12:15], s61 offen offset:1024 sc1 lds
    buffer_load_dwordx4 v3, s[12:15], s61 offen offset:2048 sc1 lds
    buffer_load_dwordx4 v3, s[12:15], s61 offen offset:3072 sc1 lds
    s_add_u32 m0, s64, 4096
    s_add_u32 s61, s61, 65536
    buffer_load_dwordx4 v3, s[12:15], s47 offen offset:0 sc1 lds
    buffer_load_dwordx4 v3, s[12:15], s47 offen offset:1024 sc1 lds
    buffer_load_dwordx4 v3, s[12:15], s47 offen offset:2048 sc1 lds
    buffer_load_dwordx4 v3, s[12:15], s47 offen offset:3072 sc1 lds
    s_xor_b32 s64, s64, 0x10000
    s_branch L_g_dp_108_a
L_g_nw1_105:
    s_cmp_eq_u32 s65, 2
    s_cbranch_scc1 L_g_nw1_105_w
    s_waitcnt vmcnt(0)
L_g_nw1_105_w:
    s_barrier
    ds_read_b128 v[32:35], v4 offset:0
    ds_read_b128 v[36:39], v4 offset:1024
    ds_read_b128 v[40:43], v4 offset:2048
    ds_read_b128 v[44:47], v4 offset:3072
    ds_read_b128 v[48:51], v4 offset:4096
    ds_read_b128 v[52:55], v4 offset:5120
    ds_read_b128 v[56:59], v4 offset:6144
    ds_read_b128 v[60:63], v4 offset:7168
    s_branch L_g_jn_107
L_g_mm2_106:
    s_setprio 1
    s_waitcnt lgkmcnt(6)
    v_mfma_f32_32x32x16_bf16 v[16:31], a[0:3], v[32:35], 0
    ds_read_b128 v[32:35], v4 offset:8192
    v_mfma_f32_32x32x16_bf16 v[16:31], a[4:7], v[36:39], v[16:31]
    ds_read_b128 v[36:39], v4 offset:9216
    s_waitcnt lgkmcnt(6)
    v_mfma_f32_32x32x16_bf16 v[16:31], a[8:11], v[40:43], v[16:31]
    ds_read_b128 v[40:43], v4 offset:10240
    v_mfma_f32_32x32x16_bf16 v[16:31], a[12:15], v[44:47], v[16:31]
    ds_read_b128 v[44:47], v4 offset:11264
    s_waitcnt lgkmcnt(6)
    v_mfma_f32_32x32x16_bf16 v[16:31], a[16:19], v[48:51], v[16:31]
    ds_read_b128 v[48:51], v4 offset:12288
    v_mfma_f32_32x32x16_bf16 v[16:31], a[20:23], v[52:55], v[16:31]
    ds_read_b128 v[52:55], v4 offset:13312
    s_waitcnt lgkmcnt(6)
    v_mfma_f32_32x32x16_bf16 v[16:31], a[24:27], v[56:59], v[16:31]
    ds_read_b128 v[56:59], v4 offset:14336
    v_mfma_f32_32x32x16_bf16 v[16:31], a[28:31], v[60:63], v[16:31]
    ds_read_b128 v[60:63], v4 offset:15360
    s_waitcnt lgkmcnt(6)
    v_mfma_f32_32x32x16_bf16 v[16:31], a[32:35], v[32:35], v[16:31]
    ds_read_b128 v[32:35], v4 offset:16384
    v_mfma_f32_32x32x16_bf16 v[16:31], a[36:39], v[36:39], v[16:31]
    ds_read_b128 v[36:39], v4 offset:17408
    s_waitcnt lgkmcnt(6)
    v_mfma_f32_32x32x16_bf16 v[16:31], a[40:43], v[40:43], v[16:31]
    ds_read_b128 v[40:43], v4 offset:18432
    v_mfma_f32_32x32x16_bf16 v[16:31], a[44:47], v[44:47], v[16:31]
    ds_read_b128 v[44:47], v4 offset:19456
    s_waitcnt lgkmcnt(6)
    v_mfma_f32_32x32x16_bf16 v[16:31], a[48:51], v[48:51], v[16:31]
    ds_read_b128 v[48:51], v4 offset:20480
    v_mfma_f32_32x32x16_bf16 v[16:31], a[52:55], v[52:55], v[16:31]
    ds_read_b128 v[52:55], v4 offset:21504
    s_waitcnt lgkmcnt(6)
    v_mfma_f32_32x32x16_bf16 v[16:31], a[56:59], v[56:59], v[16:31]
    ds_read_b128 v[56:59], v4 offset:22528
    v_mfma_f32_32x32x16_bf16 v[16:31], a[60:63], v[60:63], v[16:31]
    ds_read_b128 v[60:63], v4 offset:23552
    s_waitcnt lgkmcnt(6)
    v_mfma_f32_32x32x16_bf16 v[16:31], a[64:67], v[32:35], v[16:31]
    ds_read_b128 v[32:35], v4 offset:24576
    v_mfma_f32_32x32x16_bf16 v[16:31], a[68:71], v[36:39], v[16:31]
    ds_read_b128 v[36:39], v4 offset:25600
    s_waitcnt lgkmcnt(6)
    v_mfma_f32_32x32x16_bf16 v[16:31], a[72:75], v[40:43], v[16:31]
    ds_read_b128 v[40:43], v4 offset:26624
    v_mfma_f32_32x32x16_bf16 v[16:31], a[76:79], v[44:47], v[16:31]
    ds_read_b128 v[44:47], v4 offset:27648
    s_waitcnt lgkmcnt(6)
    v_mfma_f32_32x32x16_bf16 v[16:31], a[80:83], v[48:51], v[16:31]
    ds_read_b128 v[48:51], v4 offset:28672
    v_mfma_f32_32x32x16_bf16 v[16:31], a[84:87], v[52:55], v[16:31]
    ds_read_b128 v[52:55], v4 offset:29696
    s_waitcnt lgkmcnt(6)
    v_mfma_f32_32x32x16_bf16 v[16:31], a[88:91], v[56:59], v[16:31]
    ds_read_b128 v[56:59], v4 offset:30720
    v_mfma_f32_32x32x16_bf16 v[16:31], a[92:95], v[60:63], v[16:31]
    ds_read_b128 v[60:63], v4 offset:31744
    s_waitcnt lgkmcnt(6)
    v_mfma_f32_32x32x16_bf16 v[16:31], a[96:99], v[32:35], v[16:31]
    v_mfma_f32_32x32x16_bf16 v[16:31], a[100:103], v[36:39], v[16:31]
    s_waitcnt lgkmcnt(4)
    v_mfma_f32_32x32x16_bf16 v[16:31], a[104:107], v[40:43], v[16:31]
    v_mfma_f32_32x32x16_bf16 v[16:31], a[108:111], v[44:47], v[16:31]
    s_waitcnt lgkmcnt(2)
    v_mfma_f32_32x32x16_bf16 v[16:31], a[112:115], v[48:51], v[16:31]
    v_mfma_f32_32x32x16_bf16 v[16:31], a[116:119], v[52:55], v[16:31]
    s_waitcnt lgkmcnt(0)
    v_mfma_f32_32x32x16_bf16 v[16:31], a[120:123], v[56:59], v[16:31]
    v_mfma_f32_32x32x16_bf16 v[16:31], a[124:127], v[60:63], v[16:31]
    v_xor_b32 v4, 0x10000, v4
    s_setprio 0
    s_waitcnt vmcnt(0)
    s_branch L_g_mm2_106_d
L_w_f2_13:
    s_load_dwordx2 s[4:5], s[0:1], 80
    s_load_dwordx2 s[6:7], s[0:1], 72
    s_and_b32 s50, s44, 3
    s_lshr_b32 s51, s44, 2
    s_waitcnt lgkmcnt(0)
    s_mov_b32 s24, s4
    s_and_b32 s25, s5, 0xffff
    s_mov_b32 s26, 0x700000
    s_mov_b32 s27, 0x00020000
    v_lshrrev_b32 v3, 4, v1
    v_and_b32 v4, 15, v1
    v_lshlrev_b32 v5, 2, v3
    v_xor_b32 v4, v4, v5
    v_mul_u32_u24 v3, 2048, v3
    v_lshl_add_u32 v3, v4, 4, v3
    s_mul_i32 s46, s51, 448
    s_mul_i32 s47, s50, 16
    s_add_u32 s46, s46, s47
    s_mul_i32 s47, s42, 896
    s_add_u32 s46, s46, s47
    s_mul_i32 s46, s46, 2048
    s_lshl_b32 s47, s43, 8
    s_add_u32 s46, s46, s47
    s_lshl_b32 s45, s51, 16
    s_mul_i32 s47, s50, 4096
    s_add_u32 s45, s45, s47
    v_bfe_u32 v4, v1, 2, 2
    v_bfe_u32 v5, v1, 4, 1
    v_lshlrev_b32 v5, 1, v5
    v_bfe_u32 v6, v1, 1, 1
    v_add_u32 v5, v5, v6
    s_lshl_b32 s47, s50, 2
    v_add_u32 v5, s47, v5
    v_lshlrev_b32 v6, 2, v4
    v_xor_b32 v5, v5, v6
    v_lshlrev_b32 v5, 4, v5
    v_lshl_add_u32 v5, v4, 8, v5
    v_bfe_u32 v6, v1, 0, 1
    v_lshl_add_u32 v5, v6, 3, v5
    v_lshrrev_b32 v6, 5, v1
    v_mul_u32_u24 v6, 1024, v6
    v_add_u32 v5, v5, v6
    s_lshl_b32 s47, s51, 16
    v_add_u32 v5, s47, v5
    v_bfe_u32 v4, v1, 2, 2
    v_xor_b32 v5, s50, v4
    v_lshlrev_b32 v5, 6, v5
    v_lshl_add_u32 v5, v4, 8, v5
    v_and_b32 v6, 3, v1
    v_lshl_add_u32 v5, v6, 3, v5
    v_lshrrev_b32 v6, 4, v1
    v_lshl_add_u32 v5, v6, 10, v5
    v_lshrrev_b32 v6, 5, v1
    v_lshl_add_u32 v5, v6, 11, v5
    s_lshl_b32 s47, s51, 16
    v_add_u32 v5, s47, v5
    s_add_u32 m0, s45, 0
    s_add_u32 s47, s46, 0x0
    buffer_load_dwordx4 v3, s[24:27], s47 offen lds
    s_add_u32 m0, s45, 1024
    s_add_u32 s47, s46, 0x2000
    buffer_load_dwordx4 v3, s[24:27], s47 offen lds
    s_add_u32 m0, s45, 2048
    s_add_u32 s47, s46, 0x4000
    buffer_load_dwordx4 v3, s[24:27], s47 offen lds
    s_add_u32 m0, s45, 3072
    s_add_u32 s47, s46, 0x6000
    buffer_load_dwordx4 v3, s[24:27], s47 offen lds
    s_add_u32 m0, s45, 16384
    s_add_u32 s47, s46, 0x20000
    buffer_load_dwordx4 v3, s[24:27], s47 offen lds
    s_add_u32 m0, s45, 17408
    s_add_u32 s47, s46, 0x22000
    buffer_load_dwordx4 v3, s[24:27], s47 offen lds
    s_add_u32 m0, s45, 18432
    s_add_u32 s47, s46, 0x24000
    buffer_load_dwordx4 v3, s[24:27], s47 offen lds
    s_add_u32 m0, s45, 19456
    s_add_u32 s47, s46, 0x26000
    buffer_load_dwordx4 v3, s[24:27], s47 offen lds
    s_add_u32 m0, s45, 32768
    s_add_u32 s47, s46, 0x40000
    buffer_load_dwordx4 v3, s[24:27], s47 offen lds
    s_add_u32 m0, s45, 33792
    s_add_u32 s47, s46, 0x42000
    buffer_load_dwordx4 v3, s[24:27], s47 offen lds
    s_add_u32 m0, s45, 34816
    s_add_u32 s47, s46, 0x44000
    buffer_load_dwordx4 v3, s[24:27], s47 offen lds
    s_add_u32 m0, s45, 35840
    s_add_u32 s47, s46, 0x46000
    buffer_load_dwordx4 v3, s[24:27], s47 offen lds
    s_add_u32 m0, s45, 49152
    s_add_u32 s47, s46, 0x60000
    buffer_load_dwordx4 v3, s[24:27], s47 offen lds
    s_add_u32 m0, s45, 50176
    s_add_u32 s47, s46, 0x62000
    buffer_load_dwordx4 v3, s[24:27], s47 offen lds
    s_add_u32 m0, s45, 51200
    s_add_u32 s47, s46, 0x64000
    buffer_load_dwordx4 v3, s[24:27], s47 offen lds
    s_add_u32 m0, s45, 52224
    s_add_u32 s47, s46, 0x66000
    buffer_load_dwordx4 v3, s[24:27], s47 offen lds
    s_waitcnt vmcnt(12) lgkmcnt(0)
    s_barrier
    ds_read_b64_tr_b16 a[0:1], v5 offset:0
    ds_read_b64_tr_b16 a[2:3], v5 offset:2048
    ds_read_b64_tr_b16 a[4:5], v5 offset:32
    ds_read_b64_tr_b16 a[6:7], v5 offset:2080
    ds_read_b64_tr_b16 a[8:9], v5 offset:8192
    ds_read_b64_tr_b16 a[10:11], v5 offset:10240
    ds_read_b64_tr_b16 a[12:13], v5 offset:8224
    ds_read_b64_tr_b16 a[14:15], v5 offset:10272
    s_waitcnt vmcnt(8) lgkmcnt(0)
    s_barrier
    s_add_u32 m0, s45, 0
    s_add_u32 s47, s46, 0x80000
    buffer_load_dwordx4 v3, s[24:27], s47 offen lds
    s_add_u32 m0, s45, 1024
    s_add_u32 s47, s46, 0x82000
    buffer_load_dwordx4 v3, s[24:27], s47 offen lds
    s_add_u32 m0, s45, 2048
    s_add_u32 s47, s46, 0x84000
    buffer_load_dwordx4 v3, s[24:27], s47 offen lds
    s_add_u32 m0, s45, 3072
    s_add_u32 s47, s46, 0x86000
    buffer_load_dwordx4 v3, s[24:27], s47 offen lds
    ds_read_b64_tr_b16 a[16:17], v5 offset:16384
    ds_read_b64_tr_b16 a[18:19], v5 offset:18432
    ds_read_b64_tr_b16 a[20:21], v5 offset:16416
    ds_read_b64_tr_b16 a[22:23], v5 offset:18464
    ds_read_b64_tr_b16 a[24:25], v5 offset:24576
    ds_read_b64_tr_b16 a[26:27], v5 offset:26624
    ds_read_b64_tr_b16 a[28:29], v5 offset:24608
    ds_read_b64_tr_b16 a[30:31], v5 offset:26656
    s_waitcnt vmcnt(8) lgkmcnt(0)
    s_barrier
    s_add_u32 m0, s45, 16384
    s_add_u32 s47, s46, 0xa0000
    buffer_load_dwordx4 v3, s[24:27], s47 offen lds
    s_add_u32 m0, s45, 17408
    s_add_u32 s47, s46, 0xa2000
    buffer_load_dwordx4 v3, s[24:27], s47 offen lds
    s_add_u32 m0, s45, 18432
    s_add_u32 s47, s46, 0xa4000
    buffer_load_dwordx4 v3, s[24:27], s47 offen lds
    s_add_u32 m0, s45, 19456
    s_add_u32 s47, s46, 0xa6000
    buffer_load_dwordx4 v3, s[24:27], s47 offen lds
    ds_read_b64_tr_b16 a[32:33], v5 offset:32768
    ds_read_b64_tr_b16 a[34:35], v5 offset:34816
    ds_read_b64_tr_b16 a[36:37], v5 offset:32800
    ds_read_b64_tr_b16 a[38:39], v5 offset:34848
    ds_read_b64_tr_b16 a[40:41], v5 offset:40960
    ds_read_b64_tr_b16 a[42:43], v5 offset:43008
    ds_read_b64_tr_b16 a[44:45], v5 offset:40992
    ds_read_b64_tr_b16 a[46:47], v5 offset:43040
    s_waitcnt vmcnt(8) lgkmcnt(0)
    s_barrier
    s_add_u32 m0, s45, 32768
    s_add_u32 s47, s46, 0xc0000
    buffer_load_dwordx4 v3, s[24:27], s47 offen lds
    s_add_u32 m0, s45, 33792
    s_add_u32 s47, s46, 0xc2000
    buffer_load_dwordx4 v3, s[24:27], s47 offen lds
    s_add_u32 m0, s45, 34816
    s_add_u32 s47, s46, 0xc4000
    buffer_load_dwordx4 v3, s[24:27], s47 offen lds
    s_add_u32 m0, s45, 35840
    s_add_u32 s47, s46, 0xc6000
    buffer_load_dwordx4 v3, s[24:27], s47 offen lds
    ds_read_b64_tr_b16 a[48:49], v5 offset:49152
    ds_read_b64_tr_b16 a[50:51], v5 offset:51200
    ds_read_b64_tr_b16 a[52:53], v5 offset:49184
    ds_read_b64_tr_b16 a[54:55], v5 offset:51232
    ds_read_b64_tr_b16 a[56:57], v5 offset:57344
    ds_read_b64_tr_b16 a[58:59], v5 offset:59392
    ds_read_b64_tr_b16 a[60:61], v5 offset:57376
    ds_read_b64_tr_b16 a[62:63], v5 offset:59424
    s_waitcnt vmcnt(8) lgkmcnt(0)
    s_barrier
    ds_read_b64_tr_b16 a[64:65], v5 offset:0
    ds_read_b64_tr_b16 a[66:67], v5 offset:2048
    ds_read_b64_tr_b16 a[68:69], v5 offset:32
    ds_read_b64_tr_b16 a[70:71], v5 offset:2080
    ds_read_b64_tr_b16 a[72:73], v5 offset:8192
    ds_read_b64_tr_b16 a[74:75], v5 offset:10240
    ds_read_b64_tr_b16 a[76:77], v5 offset:8224
    ds_read_b64_tr_b16 a[78:79], v5 offset:10272
    s_waitcnt vmcnt(4) lgkmcnt(0)
    s_barrier
    ds_read_b64_tr_b16 a[80:81], v5 offset:16384
    ds_read_b64_tr_b16 a[82:83], v5 offset:18432
    ds_read_b64_tr_b16 a[84:85], v5 offset:16416
    ds_read_b64_tr_b16 a[86:87], v5 offset:18464
    ds_read_b64_tr_b16 a[88:89], v5 offset:24576
    ds_read_b64_tr_b16 a[90:91], v5 offset:26624
    ds_read_b64_tr_b16 a[92:93], v5 offset:24608
    ds_read_b64_tr_b16 a[94:95], v5 offset:26656
    s_waitcnt vmcnt(0) lgkmcnt(0)
    s_barrier
    ds_read_b64_tr_b16 a[96:97], v5 offset:32768
    ds_read_b64_tr_b16 a[98:99], v5 offset:34816
    ds_read_b64_tr_b16 a[100:101], v5 offset:32800
    ds_read_b64_tr_b16 a[102:103], v5 offset:34848
    ds_read_b64_tr_b16 a[104:105], v5 offset:40960
    ds_read_b64_tr_b16 a[106:107], v5 offset:43008
    ds_read_b64_tr_b16 a[108:109], v5 offset:40992
    ds_read_b64_tr_b16 a[110:111], v5 offset:43040
    s_waitcnt lgkmcnt(0)
    s_barrier
    v_lshlrev_b32 v2, 4, v1
    s_mul_i32 s64, s44, 7168
    s_add_u32 s46, s64, 0x6000000
    s_mul_i32 s47, s42, 57344
    s_add_u32 s46, s46, s47
    v_add_u32 v3, s46, v2
    s_mul_i32 s46, s51, 28672
    v_add_u32 v4, s46, v2
    v_and_b32 v6, 15, v1
    v_lshlrev_b32 v6, 4, v6
    v_lshrrev_b32 v7, 4, v1
    v_lshl_add_u32 v6, v7, 9, v6
    v_add_u32 v4, s46, v6
    s_lshl_b32 s46, s50, 12
    s_add_u32 s46, s46, 131072
    v_add_u32 v5, s46, v2
    v_and_b32 v7, 15, v1
    v_min_u32 v7, 6, v7
    v_lshlrev_b32 v7, 7, v7
    s_mul_i32 s46, s42, 896
    s_add_u32 s46, s46, 0x106400
    v_add_u32 v7, s46, v7
    s_lshl_b32 s46, s42, 16
    s_lshl_b32 s47, s43, 11
    s_add_u32 s46, s46, s47
    s_lshl_b32 s47, s50, 9
    s_add_u32 s46, s46, s47
    s_add_u32 s46, s46, 0xb000000
    v_and_b32 v8, 31, v1
    v_lshlrev_b32 v8, 4, v8
    v_lshrrev_b32 v9, 5, v1
    v_lshl_add_u32 v8, v9, 14, v8
    v_add_u32 v8, s46, v8
    v_add_u32 v9, 0x8000, v8
    s_lshl_b32 s52, s43, 9
    s_lshl_b32 s47, s42, 7
    s_add_u32 s52, s52, s47
    s_add_u32 s52, s52, 0x108400
    s_add_u32 s52, s52, s76
    s_mul_i32 s46, s43, 7168
    s_add_u32 s46, s46, 0x6000000
    s_mul_i32 s47, s42, 57344
    s_add_u32 s46, s46, s47
    v_min_u32 v116, 55, v1
    v_lshlrev_b32 v116, 7, v116
    v_add_u32 v116, s46, v116
    s_mov_b32 s60, s74
    s_mul_i32 s61, s74, 229376
    s_mov_b32 s62, s74
    s_mul_i32 s63, s74, 262144
    s_mov_b32 s67, 0
    s_mov_b32 s68, 3
    s_mov_b32 s71, 0
    v_mov_b32 v15, 147456
    v_mov_b32 v14, 0
    ds_write_b32 v15, v14 offset:4
    ds_write_b32 v15, v14 offset:12
    ds_write_b32 v15, v14 offset:16
    v_mov_b32 v114, 1
    v_mov_b32 v115, 0
    v_lshrrev_b32 v113, 4, v1
    s_mov_b32 s72, 0
L_g_restart_115:
    s_cmp_lg_u32 s44, 0
    s_cbranch_scc1 L_g_nsp_116
    s_mov_b32 s70, 0
L_g_sp_122:
    s_add_u32 s54, s60, 0
    v_add_u32 v12, s54, v113
    v_subrev_u32 v13, 59, v12
    v_subrev_u32 v11, 63, v12
    v_ashrrev_i32 v13, 31, v13
    v_ashrrev_i32 v11, 31, v11
    v_add3_u32 v13, v13, v11, 2
    v_lshl_add_u32 v13, v13, 16, v7
    buffer_load_dword v11, v13, s[12:15], 0 offen sc1
    s_waitcnt vmcnt(0)
    v_cmp_ge_u32 vcc, v12, v11
    s_add_u32 s70, s70, 1
    s_and_b32 s46, vcc_lo, 0xffff
    s_cbranch_scc0 L_g_sp_122_ok
    s_sleep 3
    s_cmp_lt_u32 s70, 524288
    s_cbranch_scc1 L_g_sp_122
    s_branch L_c_done_1
L_g_sp_122_ok:
    v_cmp_ge_u32 vcc, v12, v11
    s_nop 0
    s_ff1_i32_b64 s46, vcc
    s_lshr_b32 s46, s46, 4
    s_min_u32 s46, s46, 4
    s_add_u32 s46, s46, s54
    s_min_u32 s46, s46, s75
    v_mov_b32 v11, s46
    ds_write_b32 v15, v11 offset:20
L_g_nsp_116:
    s_waitcnt lgkmcnt(0)
    s_barrier
    ds_read_b32 v14, v15 offset:20
    s_waitcnt lgkmcnt(0)
    v_readfirstlane_b32 s66, v14
    s_nop 3
L_g_restart_115_go:
    s_mov_b32 s69, 0
    s_cmp_gt_u32 s62, s60
    s_cbranch_scc1 L_g_nd_123
    s_cmp_ge_u32 s62, s66
    s_cbranch_scc1 L_g_nd_123
    s_add_u32 s47, s61, 4096
    s_add_u32 m0, s64, 0
    s_nop 0
    buffer_load_dwordx4 v3, s[12:15], s61 offen offset:0 sc1 lds
    buffer_load_dwordx4 v3, s[12:15], s61 offen offset:1024 sc1 lds
    buffer_load_dwordx4 v3, s[12:15], s61 offen offset:2048 sc1 lds
    buffer_load_dwordx4 v3, s[12:15], s61 offen offset:3072 sc1 lds
    s_add_u32 m0, s64, 4096
    s_nop 0
    buffer_load_dwordx4 v3, s[12:15], s47 offen offset:0 sc1 lds
    buffer_load_dwordx4 v3, s[12:15], s47 offen offset:1024 sc1 lds
    buffer_load_dwordx4 v3, s[12:15], s47 offen offset:2048 sc1 lds
    s_add_u32 s61, s61, 229376
    s_add_u32 s62, s62, 1
    s_xor_b32 s64, s64, 0x10000
    s_mov_b32 s69, 1
L_g_nd_123:
    s_cmp_eq_u32 s51, 1
    s_cbranch_scc1 L_g_g1r_117
    s_add_u32 s59, s60, 1
    s_mov_b32 s69, 0
    s_cmp_gt_u32 s62, s59
    s_cbranch_scc1 L_g_nd_124
    s_cmp_ge_u32 s62, s66
    s_cbranch_scc1 L_g_nd_124
    s_add_u32 s47, s61, 4096
    s_add_u32 m0, s64, 0
    s_nop 0
    buffer_load_dwordx4 v3, s[12:15], s61 offen offset:0 sc1 lds
    buffer_load_dwordx4 v3, s[12:15], s61 offen offset:1024 sc1 lds
    buffer_load_dwordx4 v3, s[12:15], s61 offen offset:2048 sc1 lds
    buffer_load_dwordx4 v3, s[12:15], s61 offen offset:3072 sc1 lds
    s_add_u32 m0, s64, 4096
    s_nop 0
    buffer_load_dwordx4 v3, s[12:15], s47 offen offset:0 sc1 lds
    buffer_load_dwordx4 v3, s[12:15], s47 offen offset:1024 sc1 lds
    buffer_load_dwordx4 v3, s[12:15], s47 offen offset:2048 sc1 lds
    s_add_u32 s61, s61, 229376
    s_add_u32 s62, s62, 1
    s_xor_b32 s64, s64, 0x10000
    s_mov_b32 s69, 1
L_g_nd_124:
    s_cmp_eq_u32 s69, 1
    s_cbranch_scc1 L_g_w0_125
    s_waitcnt vmcnt(0)
L_g_w0_125:
    s_waitcnt vmcnt(7)
L_g_loop0_118_l:
    s_barrier
    ds_read_b128 v[32:35], v4 offset:0
    ds_read_b128 v[36:39], v4 offset:256
    ds_read_b128 v[40:43], v4 offset:2048
    ds_read_b128 v[44:47], v4 offset:2304
    ds_read_b128 v[48:51], v4 offset:4096
    ds_read_b128 v[52:55], v4 offset:4352
    ds_read_b128 v[56:59], v4 offset:6144
    ds_read_b128 v[60:63], v4 offset:6400
    s_branch L_g_loop0_118_m
.p2align 6
L_g_loop0_118:
    s_barrier
L_g_loop0_118_m:
    s_setprio 2
    s_waitcnt lgkmcnt(6)
    v_mfma_f32_16x16x32_bf16 v[16:19], v[32:35], a[0:3], 0
    v_mfma_f32_16x16x32_bf16 v[20:23], v[32:35], a[4:7], 0
    ds_read_b128 v[32:35], v4 offset:8192
    v_mfma_f32_16x16x32_bf16 v[28:31], v[36:39], a[4:7], 0
    v_mfma_f32_16x16x32_bf16 v[24:27], v[36:39], a[0:3], 0
    ds_read_b128 v[36:39], v4 offset:8448
    s_cmp_lg_u32 s44, 0
    s_cbranch_scc1 L_g_nl_129
    s_add_u32 s54, s60, 1
    v_add_u32 v12, s54, v113
    v_subrev_u32 v13, 59, v12
    v_subrev_u32 v11, 63, v12
    v_ashrrev_i32 v13, 31, v13
    v_ashrrev_i32 v11, 31, v11
    v_add3_u32 v13, v13, v11, 2
    v_lshl_add_u32 v13, v13, 16, v7
    buffer_load_dword v11, v13, s[12:15], 0 offen sc1
L_g_nl_129:
    s_waitcnt lgkmcnt(6)
    v_mfma_f32_16x16x32_bf16 v[16:19], v[40:43], a[8:11], v[16:19]
    v_mfma_f32_16x16x32_bf16 v[20:23], v[40:43], a[12:15], v[20:23]
    ds_read_b128 v[40:43], v4 offset:10240
    v_mfma_f32_16x16x32_bf16 v[28:31], v[44:47], a[12:15], v[28:31]
    v_mfma_f32_16x16x32_bf16 v[24:27], v[44:47], a[8:11], v[24:27]
    ds_read_b128 v[44:47], v4 offset:10496
    s_waitcnt lgkmcnt(6)
    v_mfma_f32_16x16x32_bf16 v[16:19], v[48:51], a[16:19], v[16:19]
    v_mfma_f32_16x16x32_bf16 v[20:23], v[48:51], a[20:23], v[20:23]
    ds_read_b128 v[48:51], v4 offset:12288
    v_mfma_f32_16x16x32_bf16 v[28:31], v[52:55], a[20:23], v[28:31]
    v_mfma_f32_16x16x32_bf16 v[24:27], v[52:55], a[16:19], v[24:27]
    ds_read_b128 v[52:55], v4 offset:12544
    s_waitcnt lgkmcnt(6)
    v_mfma_f32_16x16x32_bf16 v[16:19], v[56:59], a[24:27], v[16:19]
    v_mfma_f32_16x16x32_bf16 v[20:23], v[56:59], a[28:31], v[20:23]
    ds_read_b128 v[56:59], v4 offset:14336
    v_mfma_f32_16x16x32_bf16 v[28:31], v[60:63], a[28:31], v[28:31]
    v_mfma_f32_16x16x32_bf16 v[24:27], v[60:63], a[24:27], v[24:27]
    ds_read_b128 v[60:63], v4 offset:14592
    s_waitcnt lgkmcnt(6)
    v_mfma_f32_16x16x32_bf16 v[16:19], v[32:35], a[32:35], v[16:19]
    v_mfma_f32_16x16x32_bf16 v[20:23], v[32:35], a[36:39], v[20:23]
    ds_read_b128 v[32:35], v4 offset:16384
    v_mfma_f32_16x16x32_bf16 v[28:31], v[36:39], a[36:39], v[28:31]
    v_mfma_f32_16x16x32_bf16 v[24:27], v[36:39], a[32:35], v[24:27]
    ds_read_b128 v[36:39], v4 offset:16640
    s_waitcnt lgkmcnt(6)
    v_mfma_f32_16x16x32_bf16 v[16:19], v[40:43], a[40:43], v[16:19]
    v_mfma_f32_16x16x32_bf16 v[20:23], v[40:43], a[44:47], v[20:23]
    ds_read_b128 v[40:43], v4 offset:18432
    v_mfma_f32_16x16x32_bf16 v[28:31], v[44:47], a[44:47], v[28:31]
    v_mfma_f32_16x16x32_bf16 v[24:27], v[44:47], a[40:43], v[24:27]
    ds_read_b128 v[44:47], v4 offset:18688
    s_waitcnt lgkmcnt(6)
    v_mfma_f32_16x16x32_bf16 v[16:19], v[48:51], a[48:51], v[16:19]
    v_mfma_f32_16x16x32_bf16 v[20:23], v[48:51], a[52:55], v[20:23]
    ds_read_b128 v[48:51], v4 offset:20480
    v_mfma_f32_16x16x32_bf16 v[28:31], v[52:55], a[52:55], v[28:31]
    v_mfma_f32_16x16x32_bf16 v[24:27], v[52:55], a[48:51], v[24:27]
    ds_read_b128 v[52:55], v4 offset:20736
    s_waitcnt lgkmcnt(6)
    v_mfma_f32_16x16x32_bf16 v[16:19], v[56:59], a[56:59], v[16:19]
    v_mfma_f32_16x16x32_bf16 v[20:23], v[56:59], a[60:63], v[20:23]
    ds_read_b128 v[56:59], v4 offset:22528
    v_mfma_f32_16x16x32_bf16 v[28:31], v[60:63], a[60:63], v[28:31]
    v_mfma_f32_16x16x32_bf16 v[24:27], v[60:63], a[56:59], v[24:27]
    ds_read_b128 v[60:63], v4 offset:22784
    s_waitcnt lgkmcnt(6)
    v_mfma_f32_16x16x32_bf16 v[16:19], v[32:35], a[64:67], v[16:19]
    v_mfma_f32_16x16x32_bf16 v[20:23], v[32:35], a[68:71], v[20:23]
    ds_read_b128 v[32:35], v4 offset:24576
    v_mfma_f32_16x16x32_bf16 v[28:31], v[36:39], a[68:71], v[28:31]
    v_mfma_f32_16x16x32_bf16 v[24:27], v[36:39], a[64:67], v[24:27]
    ds_read_b128 v[36:39], v4 offset:24832
    s_waitcnt lgkmcnt(6)
    v_mfma_f32_16x16x32_bf16 v[16:19], v[40:43], a[72:75], v[16:19]
    v_mfma_f32_16x16x32_bf16 v[20:23], v[40:43], a[76:79], v[20:23]
    ds_read_b128 v[40:43], v4 offset:26624
    v_mfma_f32_16x16x32_bf16 v[28:31], v[44:47], a[76:79], v[28:31]
    v_mfma_f32_16x16x32_bf16 v[24:27], v[44:47], a[72:75], v[24:27]
    ds_read_b128 v[44:47], v4 offset:26880
    s_waitcnt lgkmcnt(6)
    v_mfma_f32_16x16x32_bf16 v[16:19], v[48:51], a[80:83], v[16:19]
    v_mfma_f32_16x16x32_bf16 v[20:23], v[48:51], a[84:87], v[20:23]
    v_mfma_f32_16x16x32_bf16 v[28:31], v[52:55], a[84:87], v[28:31]
    v_mfma_f32_16x16x32_bf16 v[24:27], v[52:55], a[80:83], v[24:27]
    s_waitcnt lgkmcnt(4)
    v_mfma_f32_16x16x32_bf16 v[16:19], v[56:59], a[88:91], v[16:19]
    v_mfma_f32_16x16x32_bf16 v[20:23], v[56:59], a[92:95], v[20:23]
    v_mfma_f32_16x16x32_bf16 v[28:31], v[60:63], a[92:95], v[28:31]
    v_mfma_f32_16x16x32_bf16 v[24:27], v[60:63], a[88:91], v[24:27]
    s_waitcnt lgkmcnt(2)
    v_mfma_f32_16x16x32_bf16 v[16:19], v[32:35], a[96:99], v[16:19]
    v_mfma_f32_16x16x32_bf16 v[20:23], v[32:35], a[100:103], v[20:23]
    s_cmp_lg_u32 s44, 0
    s_cbranch_scc1 L_g_ne_126
    s_waitcnt vmcnt(0)
    v_cmp_ge_u32 vcc, v12, v11
    s_nop 0
    s_ff1_i32_b64 s46, vcc
    s_lshr_b32 s46, s46, 4
    s_min_u32 s46, s46, 4
    s_add_u32 s46, s46, s54
    s_min_u32 s46, s46, s75
    v_mov_b32 v11, s46
    ds_write_b32 v15, v11 offset:0
L_g_ne_126:
    v_mfma_f32_16x16x32_bf16 v[28:31], v[36:39], a[100:103], v[28:31]
    v_mfma_f32_16x16x32_bf16 v[24:27], v[36:39], a[96:99], v[24:27]
    s_waitcnt lgkmcnt(0)
    v_mfma_f32_16x16x32_bf16 v[16:19], v[40:43], a[104:107], v[16:19]
    v_mfma_f32_16x16x32_bf16 v[20:23], v[40:43], a[108:111], v[20:23]
    v_mfma_f32_16x16x32_bf16 v[28:31], v[44:47], a[108:111], v[28:31]
    v_mfma_f32_16x16x32_bf16 v[24:27], v[44:47], a[104:107], v[24:27]
    v_xor_b32 v4, 0x10000, v4
    s_setprio 0
    s_waitcnt vmcnt(0)
    s_waitcnt lgkmcnt(0)
    s_barrier
    ds_read_b32 v14, v15
    s_nop 6
    ds_write_b128 v5, v[16:19] offset:0
    ds_write_b128 v5, v[20:23] offset:1024
    ds_write_b128 v5, v[24:27] offset:2048
    ds_write_b128 v5, v[28:31] offset:3072
    s_waitcnt lgkmcnt(4)
    v_readfirstlane_b32 s66, v14
    s_add_u32 s60, s60, 1
    s_mov_b32 s65, 0
    s_cmp_le_u32 s62, s60
    s_cbranch_scc1 L_g_dp_130_l
L_g_dp_130_a:
    s_cmp_ge_u32 s62, s66
    s_cbranch_scc1 L_g_dp_130_d
    s_add_u32 s47, s61, 4096
    s_mov_b32 m0, s64
    s_add_u32 s62, s62, 1
    buffer_load_dwordx4 v3, s[12:15], s61 offen offset:0 sc1 lds
    buffer_load_dwordx4 v3, s[12:15], s61 offen offset:1024 sc1 lds
    buffer_load_dwordx4 v3, s[12:15], s61 offen offset:2048 sc1 lds
    buffer_load_dwordx4 v3, s[12:15], s61 offen offset:3072 sc1 lds
    s_add_u32 m0, s64, 4096
    s_add_u32 s61, s61, 229376
    buffer_load_dwordx4 v3, s[12:15], s47 offen offset:0 sc1 lds
    buffer_load_dwordx4 v3, s[12:15], s47 offen offset:1024 sc1 lds
    buffer_load_dwordx4 v3, s[12:15], s47 offen offset:2048 sc1 lds
    s_xor_b32 s64, s64, 0x10000
L_g_dp_130_d:
    s_cmp_le_u32 s66, s60
    s_cbranch_scc1 L_g_ex0_128
    s_cmp_lg_u32 s65, 0
    s_cbranch_scc1 L_g_nw_127
    ds_read_b128 v[32:35], v4 offset:0
    ds_read_b128 v[36:39], v4 offset:256
    ds_read_b128 v[40:43], v4 offset:2048
    ds_read_b128 v[44:47], v4 offset:2304
    ds_read_b128 v[48:51], v4 offset:4096
    ds_read_b128 v[52:55], v4 offset:4352
    ds_read_b128 v[56:59], v4 offset:6144
    ds_read_b128 v[60:63], v4 offset:6400
    s_waitcnt lgkmcnt(8)
    s_branch L_g_loop0_118
L_g_ex0_128:
    s_cmp_lg_u32 s44, 0
    s_cbranch_scc1 L_g_ex0_128_n
    s_sleep 6
    s_add_u32 s54, s60, 0
    v_add_u32 v12, s54, v113
    v_subrev_u32 v13, 59, v12
    v_subrev_u32 v11, 63, v12
    v_ashrrev_i32 v13, 31, v13
    v_ashrrev_i32 v11, 31, v11
    v_add3_u32 v13, v13, v11, 2
    v_lshl_add_u32 v13, v13, 16, v7
    buffer_load_dword v11, v13, s[12:15], 0 offen sc1
    s_waitcnt vmcnt(0)
    v_cmp_ge_u32 vcc, v12, v11
    s_nop 0
    s_ff1_i32_b64 s46, vcc
    s_lshr_b32 s46, s46, 4
    s_min_u32 s46, s46, 4
    s_add_u32 s46, s46, s54
    s_min_u32 s46, s46, s75
    v_mov_b32 v11, s46
    ds_write_b32 v15, v11 offset:20
L_g_ex0_128_n:
    s_waitcnt lgkmcnt(0)
    s_barrier
    ds_read_b32 v14, v15 offset:20
    s_waitcnt lgkmcnt(0)
    v_readfirstlane_b32 s66, v14
    s_barrier
    s_cmp_gt_u32 s66, s60
    s_cbranch_scc1 L_g_restart_115_go
    s_branch L_g_tail_120
L_g_g1r_117:
    s_mov_b32 s65, 1
    s_branch L_g_loop1_119_e
.p2align 6
L_g_loop1_119:
    s_mov_b32 s65, 0
L_g_loop1_119_e:
    s_barrier
    s_bitcmp1_b32 s67, 1
    s_cbranch_scc0 L_g_nfl_131
    s_cmp_lg_u32 s44, 4
    s_cbranch_scc1 L_g_nfl_131_d
    s_sub_u32 s59, s60, 1
    v_mov_b32 v10, s59
    buffer_store_dword v10, v115, s[12:15], s52 offen sc1
L_g_nfl_131_d:
    ds_read_b128 v[80:83], v5 offset:0
    ds_read_b128 v[84:87], v5 offset:1024
    ds_read_b128 v[88:91], v5 offset:2048
    ds_read_b128 v[92:95], v5 offset:3072
    s_cmp_le_u32 s62, s60
    s_cbranch_scc1 L_g_dp_136_l
L_g_dp_136_a:
    s_cmp_ge_u32 s62, s66
    s_cbranch_scc1 L_g_dp_136_d
    s_add_u32 s47, s61, 4096
    s_mov_b32 m0, s64
    s_add_u32 s62, s62, 1
    buffer_load_dwordx4 v3, s[12:15], s61 offen offset:0 sc1 lds
    buffer_load_dwordx4 v3, s[12:15], s61 offen offset:1024 sc1 lds
    buffer_load_dwordx4 v3, s[12:15], s61 offen offset:2048 sc1 lds
    buffer_load_dwordx4 v3, s[12:15], s61 offen offset:3072 sc1 lds
    s_add_u32 m0, s64, 4096
    s_add_u32 s61, s61, 229376
    buffer_load_dwordx4 v3, s[12:15], s47 offen offset:0 sc1 lds
    buffer_load_dwordx4 v3, s[12:15], s47 offen offset:1024 sc1 lds
    buffer_load_dwordx4 v3, s[12:15], s47 offen offset:2048 sc1 lds
    s_xor_b32 s64, s64, 0x10000
L_g_dp_136_d:
    s_bitcmp1_b32 s67, 0
    s_cbranch_scc0 L_g_nep_132
    s_waitcnt lgkmcnt(0)
    v_add_f32 v80, v80, v16
    v_add_f32 v81, v81, v17
    v_add_f32 v82, v82, v18
    v_add_f32 v83, v83, v19
    v_add_f32 v84, v84, v20
    v_add_f32 v85, v85, v21
    v_add_f32 v86, v86, v22
    v_add_f32 v87, v87, v23
    v_add_f32 v88, v88, v24
    v_add_f32 v89, v89, v25
    v_add_f32 v90, v90, v26
    v_add_f32 v91, v91, v27
    v_add_f32 v92, v92, v28
    v_add_f32 v93, v93, v29
    v_add_f32 v94, v94, v30
    v_add_f32 v95, v95, v31
    v_cvt_pk_bf16_f32 v104, v80, v81
    v_cvt_pk_bf16_f32 v105, v82, v83
    v_cvt_pk_bf16_f32 v106, v84, v85
    v_cvt_pk_bf16_f32 v107, v86, v87
    s_nop 1
    v_permlane16_swap_b32 v104, v106
    v_permlane16_swap_b32 v105, v107
    buffer_store_dwordx4 v[104:107], v8, s[12:15], s63 offen sc1
    v_cvt_pk_bf16_f32 v108, v88, v89
    v_cvt_pk_bf16_f32 v109, v90, v91
    v_cvt_pk_bf16_f32 v110, v92, v93
    v_cvt_pk_bf16_f32 v111, v94, v95
    s_nop 1
    v_permlane16_swap_b32 v108, v110
    v_permlane16_swap_b32 v109, v111
    buffer_store_dwordx4 v[108:111], v9, s[12:15], s63 offen sc1
    s_add_u32 s63, s63, 262144
L_g_nep_132:
    s_cmp_lg_u32 s65, 0
    s_cbranch_scc1 L_g_nw1_133
    ds_read_b128 v[32:35], v4 offset:0
    ds_read_b128 v[36:39], v4 offset:256
    ds_read_b128 v[40:43], v4 offset:2048
    ds_read_b128 v[44:47], v4 offset:2304
    ds_read_b128 v[48:51], v4 offset:4096
    ds_read_b128 v[52:55], v4 offset:4352
    ds_read_b128 v[56:59], v4 offset:6144
    ds_read_b128 v[60:63], v4 offset:6400
    s_barrier
L_g_jn_135:
    s_setprio 1
    s_waitcnt lgkmcnt(6)
    v_mfma_f32_16x16x32_bf16 v[16:19], v[32:35], a[0:3], 0
    ds_read_b32 v14, v15
    v_mfma_f32_16x16x32_bf16 v[20:23], v[32:35], a[4:7], 0
    ds_read_b128 v[32:35], v4 offset:8192
    v_mfma_f32_16x16x32_bf16 v[28:31], v[36:39], a[4:7], 0
    v_mfma_f32_16x16x32_bf16 v[24:27], v[36:39], a[0:3], 0
    ds_read_b128 v[36:39], v4 offset:8448
    s_waitcnt lgkmcnt(6)
    v_mfma_f32_16x16x32_bf16 v[16:19], v[40:43], a[8:11], v[16:19]
    v_mfma_f32_16x16x32_bf16 v[20:23], v[40:43], a[12:15], v[20:23]
    ds_read_b128 v[40:43], v4 offset:10240
    v_mfma_f32_16x16x32_bf16 v[28:31], v[44:47], a[12:15], v[28:31]
    v_mfma_f32_16x16x32_bf16 v[24:27], v[44:47], a[8:11], v[24:27]
    ds_read_b128 v[44:47], v4 offset:10496
    s_waitcnt lgkmcnt(6)
    v_mfma_f32_16x16x32_bf16 v[16:19], v[48:51], a[16:19], v[16:19]
    v_mfma_f32_16x16x32_bf16 v[20:23], v[48:51], a[20:23], v[20:23]
    ds_read_b128 v[48:51], v4 offset:12288
    v_mfma_f32_16x16x32_bf16 v[28:31], v[52:55], a[20:23], v[28:31]
    v_mfma_f32_16x16x32_bf16 v[24:27], v[52:55], a[16:19], v[24:27]
    ds_read_b128 v[52:55], v4 offset:12544
    s_waitcnt lgkmcnt(6)
    v_mfma_f32_16x16x32_bf16 v[16:19], v[56:59], a[24:27], v[16:19]
    v_mfma_f32_16x16x32_bf16 v[20:23], v[56:59], a[28:31], v[20:23]
    ds_read_b128 v[56:59], v4 offset:14336
    v_mfma_f32_16x16x32_bf16 v[28:31], v[60:63], a[28:31], v[28:31]
    v_mfma_f32_16x16x32_bf16 v[24:27], v[60:63], a[24:27], v[24:27]
    ds_read_b128 v[60:63], v4 offset:14592
    s_waitcnt lgkmcnt(6)
    v_mfma_f32_16x16x32_bf16 v[16:19], v[32:35], a[32:35], v[16:19]
    v_mfma_f32_16x16x32_bf16 v[20:23], v[32:35], a[36:39], v[20:23]
    ds_read_b128 v[32:35], v4 offset:16384
    v_mfma_f32_16x16x32_bf16 v[28:31], v[36:39], a[36:39], v[28:31]
    v_mfma_f32_16x16x32_bf16 v[24:27], v[36:39], a[32:35], v[24:27]
    ds_read_b128 v[36:39], v4 offset:16640
    s_waitcnt lgkmcnt(6)
    v_mfma_f32_16x16x32_bf16 v[16:19], v[40:43], a[40:43], v[16:19]
    v_mfma_f32_16x16x32_bf16 v[20:23], v[40:43], a[44:47], v[20:23]
    ds_read_b128 v[40:43], v4 offset:18432
    v_mfma_f32_16x16x32_bf16 v[28:31], v[44:47], a[44:47], v[28:31]
    v_mfma_f32_16x16x32_bf16 v[24:27], v[44:47], a[40:43], v[24:27]
    ds_read_b128 v[44:47], v4 offset:18688
    s_waitcnt lgkmcnt(6)
    v_mfma_f32_16x16x32_bf16 v[16:19], v[48:51], a[48:51], v[16:19]
    v_mfma_f32_16x16x32_bf16 v[20:23], v[48:51], a[52:55], v[20:23]
    ds_read_b128 v[48:51], v4 offset:20480
    v_mfma_f32_16x16x32_bf16 v[28:31], v[52:55], a[52:55], v[28:31]
    v_mfma_f32_16x16x32_bf16 v[24:27], v[52:55], a[48:51], v[24:27]
    ds_read_b128 v[52:55], v4 offset:20736
    s_waitcnt lgkmcnt(6)
    v_mfma_f32_16x16x32_bf16 v[16:19], v[56:59], a[56:59], v[16:19]
    v_mfma_f32_16x16x32_bf16 v[20:23], v[56:59], a[60:63], v[20:23]
    ds_read_b128 v[56:59], v4 offset:22528
    v_mfma_f32_16x16x32_bf16 v[28:31], v[60:63], a[60:63], v[28:31]
    v_mfma_f32_16x16x32_bf16 v[24:27], v[60:63], a[56:59], v[24:27]
    ds_read_b128 v[60:63], v4 offset:22784
    s_waitcnt lgkmcnt(6)
    v_mfma_f32_16x16x32_bf16 v[16:19], v[32:35], a[64:67], v[16:19]
    v_mfma_f32_16x16x32_bf16 v[20:23], v[32:35], a[68:71], v[20:23]
    ds_read_b128 v[32:35], v4 offset:24576
    v_mfma_f32_16x16x32_bf16 v[28:31], v[36:39], a[68:71], v[28:31]
    v_mfma_f32_16x16x32_bf16 v[24:27], v[36:39], a[64:67], v[24:27]
    ds_read_b128 v[36:39], v4 offset:24832
    s_waitcnt lgkmcnt(6)
    v_mfma_f32_16x16x32_bf16 v[16:19], v[40:43], a[72:75], v[16:19]
    v_mfma_f32_16x16x32_bf16 v[20:23], v[40:43], a[76:79], v[20:23]
    ds_read_b128 v[40:43], v4 offset:26624
    v_mfma_f32_16x16x32_bf16 v[28:31], v[44:47], a[76:79], v[28:31]
    v_mfma_f32_16x16x32_bf16 v[24:27], v[44:47], a[72:75], v[24:27]
    ds_read_b128 v[44:47], v4 offset:26880
    s_waitcnt lgkmcnt(6)
    v_mfma_f32_16x16x32_bf16 v[16:19], v[48:51], a[80:83], v[16:19]
    v_mfma_f32_16x16x32_bf16 v[20:23], v[48:51], a[84:87], v[20:23]
    v_mfma_f32_16x16x32_bf16 v[28:31], v[52:55], a[84:87], v[28:31]
    v_mfma_f32_16x16x32_bf16 v[24:27], v[52:55], a[80:83], v[24:27]
    s_waitcnt lgkmcnt(4)
    v_mfma_f32_16x16x32_bf16 v[16:19], v[56:59], a[88:91], v[16:19]
    v_mfma_f32_16x16x32_bf16 v[20:23], v[56:59], a[92:95], v[20:23]
    v_mfma_f32_16x16x32_bf16 v[28:31], v[60:63], a[92:95], v[28:31]
    v_mfma_f32_16x16x32_bf16 v[24:27], v[60:63], a[88:91], v[24:27]
    s_waitcnt lgkmcnt(2)
    v_mfma_f32_16x16x32_bf16 v[16:19], v[32:35], a[96:99], v[16:19]
    v_mfma_f32_16x16x32_bf16 v[20:23], v[32:35], a[100:103], v[20:23]
    v_mfma_f32_16x16x32_bf16 v[28:31], v[36:39], a[100:103], v[28:31]
    v_mfma_f32_16x16x32_bf16 v[24:27], v[36:39], a[96:99], v[24:27]
    s_waitcnt lgkmcnt(0)
    v_mfma_f32_16x16x32_bf16 v[16:19], v[40:43], a[104:107], v[16:19]
    v_mfma_f32_16x16x32_bf16 v[20:23], v[40:43], a[108:111], v[20:23]
    v_mfma_f32_16x16x32_bf16 v[28:31], v[44:47], a[108:111], v[28:31]
    v_mfma_f32_16x16x32_bf16 v[24:27], v[44:47], a[104:107], v[24:27]
    v_xor_b32 v4, 0x10000, v4
    s_setprio 0
    s_waitcnt vmcnt(0)
    v_readfirstlane_b32 s66, v14
    s_lshl_b32 s67, s67, 1
    s_or_b32 s67, s67, 1
    s_add_u32 s60, s60, 1
    s_cmp_gt_u32 s66, s60
    s_cbranch_scc1 L_g_loop1_119
    s_barrier
    ds_read_b32 v14, v15 offset:20
    s_waitcnt lgkmcnt(0)
    v_readfirstlane_b32 s66, v14
    s_barrier
    s_mov_b32 s69, 0
    s_cmp_gt_u32 s62, s60
    s_cbranch_scc1 L_g_nd_137
    s_cmp_ge_u32 s62, s66
    s_cbranch_scc1 L_g_nd_137
    s_add_u32 s47, s61, 4096
    s_add_u32 m0, s64, 0
    s_nop 0
    buffer_load_dwordx4 v3, s[12:15], s61 offen offset:0 sc1 lds
    buffer_load_dwordx4 v3, s[12:15], s61 offen offset:1024 sc1 lds
    buffer_load_dwordx4 v3, s[12:15], s61 offen offset:2048 sc1 lds
    buffer_load_dwordx4 v3, s[12:15], s61 offen offset:3072 sc1 lds
    s_add_u32 m0, s64, 4096
    s_nop 0
    buffer_load_dwordx4 v3, s[12:15], s47 offen offset:0 sc1 lds
    buffer_load_dwordx4 v3, s[12:15], s47 offen offset:1024 sc1 lds
    buffer_load_dwordx4 v3, s[12:15], s47 offen offset:2048 sc1 lds
    s_add_u32 s61, s61, 229376
    s_add_u32 s62, s62, 1
    s_xor_b32 s64, s64, 0x10000
    s_mov_b32 s69, 1
L_g_nd_137:
    s_sub_u32 s59, s60, 1
    ds_read_b128 v[80:83], v5 offset:0
    ds_read_b128 v[84:87], v5 offset:1024
    ds_read_b128 v[88:91], v5 offset:2048
    ds_read_b128 v[92:95], v5 offset:3072
    s_nop 7
    s_waitcnt lgkmcnt(3)
    v_add_f32 v80, v80, v16
    v_add_f32 v81, v81, v17
    v_add_f32 v82, v82, v18
    v_add_f32 v83, v83, v19
    s_waitcnt lgkmcnt(2)
    v_add_f32 v84, v84, v20
    v_add_f32 v85, v85, v21
    v_add_f32 v86, v86, v22
    v_add_f32 v87, v87, v23
    s_waitcnt lgkmcnt(1)
    v_add_f32 v88, v88, v24
    v_add_f32 v89, v89, v25
    v_add_f32 v90, v90, v26
    v_add_f32 v91, v91, v27
    s_waitcnt lgkmcnt(0)
    v_add_f32 v92, v92, v28
    v_add_f32 v93, v93, v29
    v_add_f32 v94, v94, v30
    v_add_f32 v95, v95, v31
    v_cvt_pk_bf16_f32 v104, v80, v81
    v_cvt_pk_bf16_f32 v105, v82, v83
    v_cvt_pk_bf16_f32 v106, v84, v85
    v_cvt_pk_bf16_f32 v107, v86, v87
    s_nop 1
    v_permlane16_swap_b32 v104, v106
    v_permlane16_swap_b32 v105, v107
    buffer_store_dwordx4 v[104:107], v8, s[12:15], s63 offen sc1
    v_cvt_pk_bf16_f32 v108, v88, v89
    v_cvt_pk_bf16_f32 v109, v90, v91
    v_cvt_pk_bf16_f32 v110, v92, v93
    v_cvt_pk_bf16_f32 v111, v94, v95
    s_nop 1
    v_permlane16_swap_b32 v108, v110
    v_permlane16_swap_b32 v109, v111
    buffer_store_dwordx4 v[108:111], v9, s[12:15], s63 offen sc1
    s_add_u32 s63, s63, 262144
    s_mov_b32 s67, 0
    s_mov_b32 s71, 1
    s_cmp_gt_u32 s66, s60
    s_cbranch_scc1 L_g_g1r_117
    v_mov_b32 v10, 1
    s_mov_b64 exec, 1
    s_waitcnt vmcnt(0)
    ds_add_rtn_u32 v10, v15, v10 offset:4
    s_waitcnt lgkmcnt(0)
    v_readfirstlane_b32 s46, v10
    s_mov_b64 exec, -1
    s_mov_b32 s71, 0
    s_sub_u32 s59, s60, 1
    s_cmp_lg_u32 s46, s68
    s_cbranch_scc1 L_g_df_138
    v_mov_b32 v10, s59
    v_add_u32 v10, 1, v10
    v_mov_b32 v11, 0
    s_mov_b64 exec, 1
    buffer_store_dword v10, v11, s[12:15], s52 offen sc1
    s_mov_b64 exec, -1
L_sf_139:
L_g_df_138:
    s_add_u32 s68, s68, 4
    s_cmp_gt_u32 s66, s60
    s_cbranch_scc1 L_g_g1r_117
L_g_tail_120:
    s_cmp_lt_u32 s60, s75
    s_cbranch_scc1 L_g_restart_115
    s_waitcnt vmcnt(0)
    s_barrier
    s_branch L_c_done_1
L_g_dp_130_l:
    s_cmp_ge_u32 s62, s66
    s_cbranch_scc1 L_g_dp_130_d
    s_mov_b32 s65, 1
    s_add_u32 s47, s61, 4096
    s_mov_b32 m0, s64
    s_add_u32 s62, s62, 1
    buffer_load_dwordx4 v3, s[12:15], s61 offen offset:0 sc1 lds
    buffer_load_dwordx4 v3, s[12:15], s61 offen offset:1024 sc1 lds
    buffer_load_dwordx4 v3, s[12:15], s61 offen offset:2048 sc1 lds
    buffer_load_dwordx4 v3, s[12:15], s61 offen offset:3072 sc1 lds
    s_add_u32 m0, s64, 4096
    s_add_u32 s61, s61, 229376
    buffer_load_dwordx4 v3, s[12:15], s47 offen offset:0 sc1 lds
    buffer_load_dwordx4 v3, s[12:15], s47 offen offset:1024 sc1 lds
    buffer_load_dwordx4 v3, s[12:15], s47 offen offset:2048 sc1 lds
    s_xor_b32 s64, s64, 0x10000
    s_branch L_g_dp_130_a
L_g_nw_127:
    s_waitcnt vmcnt(0) lgkmcnt(0)
    s_branch L_g_loop0_118_l
L_g_nfl_131:
    s_cmp_eq_u32 s71, 0
    s_cbranch_scc1 L_g_nfl_131_d
    v_mov_b32 v10, 1
    s_mov_b64 exec, 1
    s_waitcnt vmcnt(0)
    ds_add_rtn_u32 v10, v15, v10 offset:4
    s_waitcnt lgkmcnt(0)
    v_readfirstlane_b32 s46, v10
    s_mov_b64 exec, -1
    s_mov_b32 s71, 0
    s_sub_u32 s59, s60, 1
    s_cmp_lg_u32 s46, s68
    s_cbranch_scc1 L_g_df_140
    v_mov_b32 v10, s59
    v_add_u32 v10, 1, v10
    v_mov_b32 v11, 0
    s_mov_b64 exec, 1
    buffer_store_dword v10, v11, s[12:15], s52 offen sc1
    s_mov_b64 exec, -1
L_sf_141:
L_g_df_140:
    s_add_u32 s68, s68, 4
    s_mov_b32 s65, 2
    s_branch L_g_nfl_131_d
L_g_dp_136_l:
    s_cmp_ge_u32 s62, s66
    s_cbranch_scc1 L_g_dp_136_d
    s_or_b32 s65, s65, 1
    s_add_u32 s47, s61, 4096
    s_mov_b32 m0, s64
    s_add_u32 s62, s62, 1
    buffer_load_dwordx4 v3, s[12:15], s61 offen offset:0 sc1 lds
    buffer_load_dwordx4 v3, s[12:15], s61 offen offset:1024 sc1 lds
    buffer_load_dwordx4 v3, s[12:15], s61 offen offset:2048 sc1 lds
    buffer_load_dwordx4 v3, s[12:15], s61 offen offset:3072 sc1 lds
    s_add_u32 m0, s64, 4096
    s_add_u32 s61, s61, 229376
    buffer_load_dwordx4 v3, s[12:15], s47 offen offset:0 sc1 lds
    buffer_load_dwordx4 v3, s[12:15], s47 offen offset:1024 sc1 lds
    buffer_load_dwordx4 v3, s[12:15], s47 offen offset:2048 sc1 lds
    s_xor_b32 s64, s64, 0x10000
    s_branch L_g_dp_136_a
L_g_nw1_133:
    s_cmp_eq_u32 s65, 2
    s_cbranch_scc1 L_g_nw1_133_w
    s_waitcnt vmcnt(0)
L_g_nw1_133_w:
    s_barrier
    ds_read_b128 v[32:35], v4 offset:0
    ds_read_b128 v[36:39], v4 offset:256
    ds_read_b128 v[40:43], v4 offset:2048
    ds_read_b128 v[44:47], v4 offset:2304
    ds_read_b128 v[48:51], v4 offset:4096
    ds_read_b128 v[52:55], v4 offset:4352
    ds_read_b128 v[56:59], v4 offset:6144
    ds_read_b128 v[60:63], v4 offset:6400
    s_branch L_g_jn_135
L_w_wo_12:
    s_load_dwordx2 s[4:5], s[0:1], 40
    s_load_dwordx2 s[6:7], s[0:1], 72
    s_and_b32 s50, s44, 3
    s_lshr_b32 s51, s44, 2
    s_waitcnt lgkmcnt(0)
    s_mov_b32 s24, s4
    s_and_b32 s25, s5, 0xffff
    s_mov_b32 s26, 0x800000
    s_mov_b32 s27, 0x00020000
    v_lshrrev_b32 v3, 4, v1
    v_and_b32 v4, 15, v1
    v_lshlrev_b32 v5, 2, v3
    v_xor_b32 v4, v4, v5
    v_mul_u32_u24 v3, 2048, v3
    v_lshl_add_u32 v3, v4, 4, v3
    s_mul_i32 s46, s51, 512
    s_mul_i32 s47, s50, 16
    s_add_u32 s46, s46, s47
    s_mul_i32 s47, s42, 1024
    s_add_u32 s46, s46, s47
    s_mul_i32 s46, s46, 2048
    s_lshl_b32 s47, s43, 8
    s_add_u32 s46, s46, s47
    s_lshl_b32 s45, s51, 16
    s_mul_i32 s47, s50, 4096
    s_add_u32 s45, s45, s47
    v_bfe_u32 v4, v1, 2, 2
    v_bfe_u32 v5, v1, 4, 1
    v_lshlrev_b32 v5, 1, v5
    v_bfe_u32 v6, v1, 1, 1
    v_add_u32 v5, v5, v6
    s_lshl_b32 s47, s50, 2
    v_add_u32 v5, s47, v5
    v_lshlrev_b32 v6, 2, v4
    v_xor_b32 v5, v5, v6
    v_lshlrev_b32 v5, 4, v5
    v_lshl_add_u32 v5, v4, 8, v5
    v_bfe_u32 v6, v1, 0, 1
    v_lshl_add_u32 v5, v6, 3, v5
    v_lshrrev_b32 v6, 5, v1
    v_mul_u32_u24 v6, 1024, v6
    v_add_u32 v5, v5, v6
    s_lshl_b32 s47, s51, 16
    v_add_u32 v5, s47, v5
    v_bfe_u32 v4, v1, 2, 2
    v_xor_b32 v5, s50, v4
    v_lshlrev_b32 v5, 6, v5
    v_lshl_add_u32 v5, v4, 8, v5
    v_and_b32 v6, 3, v1
    v_lshl_add_u32 v5, v6, 3, v5
    v_lshrrev_b32 v6, 4, v1
    v_lshl_add_u32 v5, v6, 10, v5
    v_lshrrev_b32 v6, 5, v1
    s_lshl_b32 s47, s51, 16
    v_add_u32 v5, s47, v5
    s_add_u32 m0, s45, 0
    s_add_u32 s47, s46, 0x0
    buffer_load_dwordx4 v3, s[24:27], s47 offen lds
    s_add_u32 m0, s45, 1024
    s_add_u32 s47, s46, 0x2000
    buffer_load_dwordx4 v3, s[24:27], s47 offen lds
    s_add_u32 m0, s45, 2048
    s_add_u32 s47, s46, 0x4000
    buffer_load_dwordx4 v3, s[24:27], s47 offen lds
    s_add_u32 m0, s45, 3072
    s_add_u32 s47, s46, 0x6000
    buffer_load_dwordx4 v3, s[24:27], s47 offen lds
    s_add_u32 m0, s45, 16384
    s_add_u32 s47, s46, 0x20000
    buffer_load_dwordx4 v3, s[24:27], s47 offen lds
    s_add_u32 m0, s45, 17408
    s_add_u32 s47, s46, 0x22000
    buffer_load_dwordx4 v3, s[24:27], s47 offen lds
    s_add_u32 m0, s45, 18432
    s_add_u32 s47, s46, 0x24000
    buffer_load_dwordx4 v3, s[24:27], s47 offen lds
    s_add_u32 m0, s45, 19456
    s_add_u32 s47, s46, 0x26000
    buffer_load_dwordx4 v3, s[24:27], s47 offen lds
    s_add_u32 m0, s45, 32768
    s_add_u32 s47, s46, 0x40000
    buffer_load_dwordx4 v3, s[24:27], s47 offen lds
    s_add_u32 m0, s45, 33792
    s_add_u32 s47, s46, 0x42000
    buffer_load_dwordx4 v3, s[24:27], s47 offen lds
    s_add_u32 m0, s45, 34816
    s_add_u32 s47, s46, 0x44000
    buffer_load_dwordx4 v3, s[24:27], s47 offen lds
    s_add_u32 m0, s45, 35840
    s_add_u32 s47, s46, 0x46000
    buffer_load_dwordx4 v3, s[24:27], s47 offen lds
    s_add_u32 m0, s45, 49152
    s_add_u32 s47, s46, 0x60000
    buffer_load_dwordx4 v3, s[24:27], s47 offen lds
    s_add_u32 m0, s45, 50176
    s_add_u32 s47, s46, 0x62000
    buffer_load_dwordx4 v3, s[24:27], s47 offen lds
    s_add_u32 m0, s45, 51200
    s_add_u32 s47, s46, 0x64000
    buffer_load_dwordx4 v3, s[24:27], s47 offen lds
    s_add_u32 m0, s45, 52224
    s_add_u32 s47, s46, 0x66000
    buffer_load_dwordx4 v3, s[24:27], s47 offen lds
    s_waitcnt vmcnt(12) lgkmcnt(0)
    s_barrier
    ds_read_b64_tr_b16 a[0:1], v5 offset:0
    ds_read_b64_tr_b16 a[2:3], v5 offset:4096
    ds_read_b64_tr_b16 a[4:5], v5 offset:32
    ds_read_b64_tr_b16 a[6:7], v5 offset:4128
    ds_read_b64_tr_b16 a[8:9], v5 offset:8192
    ds_read_b64_tr_b16 a[10:11], v5 offset:12288
    ds_read_b64_tr_b16 a[12:13], v5 offset:8224
    ds_read_b64_tr_b16 a[14:15], v5 offset:12320
    s_waitcnt vmcnt(8) lgkmcnt(0)
    s_barrier
    s_add_u32 m0, s45, 0
    s_add_u32 s47, s46, 0x80000
    buffer_load_dwordx4 v3, s[24:27], s47 offen lds
    s_add_u32 m0, s45, 1024
    s_add_u32 s47, s46, 0x82000
    buffer_load_dwordx4 v3, s[24:27], s47 offen lds
    s_add_u32 m0, s45, 2048
    s_add_u32 s47, s46, 0x84000
    buffer_load_dwordx4 v3, s[24:27], s47 offen lds
    s_add_u32 m0, s45, 3072
    s_add_u32 s47, s46, 0x86000
    buffer_load_dwordx4 v3, s[24:27], s47 offen lds
    ds_read_b64_tr_b16 a[16:17], v5 offset:16384
    ds_read_b64_tr_b16 a[18:19], v5 offset:20480
    ds_read_b64_tr_b16 a[20:21], v5 offset:16416
    ds_read_b64_tr_b16 a[22:23], v5 offset:20512
    ds_read_b64_tr_b16 a[24:25], v5 offset:24576
    ds_read_b64_tr_b16 a[26:27], v5 offset:28672
    ds_read_b64_tr_b16 a[28:29], v5 offset:24608
    ds_read_b64_tr_b16 a[30:31], v5 offset:28704
    s_waitcnt vmcnt(8) lgkmcnt(0)
    s_barrier
    s_add_u32 m0, s45, 16384
    s_add_u32 s47, s46, 0xa0000
    buffer_load_dwordx4 v3, s[24:27], s47 offen lds
    s_add_u32 m0, s45, 17408
    s_add_u32 s47, s46, 0xa2000
    buffer_load_dwordx4 v3, s[24:27], s47 offen lds
    s_add_u32 m0, s45, 18432
    s_add_u32 s47, s46, 0xa4000
    buffer_load_dwordx4 v3, s[24:27], s47 offen lds
    s_add_u32 m0, s45, 19456
    s_add_u32 s47, s46, 0xa6000
    buffer_load_dwordx4 v3, s[24:27], s47 offen lds
    ds_read_b64_tr_b16 a[32:33], v5 offset:32768
    ds_read_b64_tr_b16 a[34:35], v5 offset:36864
    ds_read_b64_tr_b16 a[36:37], v5 offset:32800
    ds_read_b64_tr_b16 a[38:39], v5 offset:36896
    ds_read_b64_tr_b16 a[40:41], v5 offset:40960
    ds_read_b64_tr_b16 a[42:43], v5 offset:45056
    ds_read_b64_tr_b16 a[44:45], v5 offset:40992
    ds_read_b64_tr_b16 a[46:47], v5 offset:45088
    s_waitcnt vmcnt(8) lgkmcnt(0)
    s_barrier
    s_add_u32 m0, s45, 32768
    s_add_u32 s47, s46, 0xc0000
    buffer_load_dwordx4 v3, s[24:27], s47 offen lds
    s_add_u32 m0, s45, 33792
    s_add_u32 s47, s46, 0xc2000
    buffer_load_dwordx4 v3, s[24:27], s47 offen lds
    s_add_u32 m0, s45, 34816
    s_add_u32 s47, s46, 0xc4000
    buffer_load_dwordx4 v3, s[24:27], s47 offen lds
    s_add_u32 m0, s45, 35840
    s_add_u32 s47, s46, 0xc6000
    buffer_load_dwordx4 v3, s[24:27], s47 offen lds
    ds_read_b64_tr_b16 a[48:49], v5 offset:49152
    ds_read_b64_tr_b16 a[50:51], v5 offset:53248
    ds_read_b64_tr_b16 a[52:53], v5 offset:49184
    ds_read_b64_tr_b16 a[54:55], v5 offset:53280
    ds_read_b64_tr_b16 a[56:57], v5 offset:57344
    ds_read_b64_tr_b16 a[58:59], v5 offset:61440
    ds_read_b64_tr_b16 a[60:61], v5 offset:57376
    ds_read_b64_tr_b16 a[62:63], v5 offset:61472
    s_waitcnt vmcnt(8) lgkmcnt(0)
    s_barrier
    s_add_u32 m0, s45, 49152
    s_add_u32 s47, s46, 0xe0000
    buffer_load_dwordx4 v3, s[24:27], s47 offen lds
    s_add_u32 m0, s45, 50176
    s_add_u32 s47, s46, 0xe2000
    buffer_load_dwordx4 v3, s[24:27], s47 offen lds
    s_add_u32 m0, s45, 51200
    s_add_u32 s47, s46, 0xe4000
    buffer_load_dwordx4 v3, s[24:27], s47 offen lds
    s_add_u32 m0, s45, 52224
    s_add_u32 s47, s46, 0xe6000
    buffer_load_dwordx4 v3, s[24:27], s47 offen lds
    ds_read_b64_tr_b16 a[64:65], v5 offset:0
    ds_read_b64_tr_b16 a[66:67], v5 offset:4096
    ds_read_b64_tr_b16 a[68:69], v5 offset:32
    ds_read_b64_tr_b16 a[70:71], v5 offset:4128
    ds_read_b64_tr_b16 a[72:73], v5 offset:8192
    ds_read_b64_tr_b16 a[74:75], v5 offset:12288
    ds_read_b64_tr_b16 a[76:77], v5 offset:8224
    ds_read_b64_tr_b16 a[78:79], v5 offset:12320
    s_waitcnt vmcnt(8) lgkmcnt(0)
    s_barrier
    ds_read_b64_tr_b16 a[80:81], v5 offset:16384
    ds_read_b64_tr_b16 a[82:83], v5 offset:20480
    ds_read_b64_tr_b16 a[84:85], v5 offset:16416
    ds_read_b64_tr_b16 a[86:87], v5 offset:20512
    ds_read_b64_tr_b16 a[88:89], v5 offset:24576
    ds_read_b64_tr_b16 a[90:91], v5 offset:28672
    ds_read_b64_tr_b16 a[92:93], v5 offset:24608
    ds_read_b64_tr_b16 a[94:95], v5 offset:28704
    s_waitcnt vmcnt(4) lgkmcnt(0)
    s_barrier
    ds_read_b64_tr_b16 a[96:97], v5 offset:32768
    ds_read_b64_tr_b16 a[98:99], v5 offset:36864
    ds_read_b64_tr_b16 a[100:101], v5 offset:32800
    ds_read_b64_tr_b16 a[102:103], v5 offset:36896
    ds_read_b64_tr_b16 a[104:105], v5 offset:40960
    ds_read_b64_tr_b16 a[106:107], v5 offset:45056
    ds_read_b64_tr_b16 a[108:109], v5 offset:40992
    ds_read_b64_tr_b16 a[110:111], v5 offset:45088
    s_waitcnt vmcnt(0) lgkmcnt(0)
    s_barrier
    ds_read_b64_tr_b16 a[112:113], v5 offset:49152
    ds_read_b64_tr_b16 a[114:115], v5 offset:53248
    ds_read_b64_tr_b16 a[116:117], v5 offset:49184
    ds_read_b64_tr_b16 a[118:119], v5 offset:53280
    ds_read_b64_tr_b16 a[120:121], v5 offset:57344
    ds_read_b64_tr_b16 a[122:123], v5 offset:61440
    ds_read_b64_tr_b16 a[124:125], v5 offset:57376
    ds_read_b64_tr_b16 a[126:127], v5 offset:61472
    s_waitcnt lgkmcnt(0)
    s_barrier
    s_load_dwordx2 s[8:9], s[0:1], 64
    s_load_dwordx2 s[10:11], s[0:1], 80
    s_lshl_b32 s46, s42, 3
    s_add_u32 s46, s46, s43
    s_mul_i32 s46, s46, 229376
    s_mul_i32 s47, s44, 28672
    s_add_u32 s46, s46, s47
    v_lshlrev_b32 v10, 7, v1
    s_waitcnt lgkmcnt(0)
    s_mov_b32 s28, s8
    s_and_b32 s29, s9, 0xffff
    s_mov_b32 s30, 0x700000
    s_mov_b32 s31, 0x00020000
    s_mov_b32 s32, s10
    s_and_b32 s33, s11, 0xffff
    s_mov_b32 s34, 0x700000
    s_mov_b32 s35, 0x00020000
    s_add_u32 s47, s46, 0
    buffer_load_dword v120, v10, s[28:31], s47 offen
    s_add_u32 s47, s46, 8192
    buffer_load_dword v121, v10, s[28:31], s47 offen
    s_add_u32 s47, s46, 16384
    buffer_load_dword v122, v10, s[28:31], s47 offen
    s_add_u32 s47, s46, 20480
    buffer_load_dword v123, v10, s[28:31], s47 offen
    v_lshlrev_b32 v2, 4, v1
    s_mul_i32 s64, s44, 8192
    s_add_u32 s46, s64, 0x5000000
    s_mul_i32 s47, s42, 65536
    s_add_u32 s46, s46, s47
    v_add_u32 v3, s46, v2
    s_mul_i32 s46, s51, 32768
    v_add_u32 v4, s46, v2
    v_and_b32 v6, 15, v1
    v_lshlrev_b32 v6, 4, v6
    v_lshrrev_b32 v7, 4, v1
    v_lshl_add_u32 v6, v7, 9, v6
    v_add_u32 v4, s46, v6
    s_lshl_b32 s46, s50, 12
    s_add_u32 s46, s46, 131072
    v_add_u32 v5, s46, v2
    v_and_b32 v7, 7, v1
    v_lshlrev_b32 v7, 9, v7
    s_lshl_b32 s46, s42, 12
    s_add_u32 s46, s46, 0x102000
    v_add_u32 v7, s46, v7
    s_lshl_b32 s46, s42, 16
    s_lshl_b32 s47, s43, 11
    s_add_u32 s46, s46, s47
    s_lshl_b32 s47, s50, 9
    s_add_u32 s46, s46, s47
    s_add_u32 s46, s46, 0x9000000
    v_and_b32 v8, 31, v1
    v_lshlrev_b32 v8, 4, v8
    v_lshrrev_b32 v9, 5, v1
    v_lshl_add_u32 v8, v9, 14, v8
    v_add_u32 v8, s46, v8
    v_add_u32 v9, 0x8000, v8
    s_lshl_b32 s52, s43, 9
    s_lshl_b32 s47, s42, 7
    s_add_u32 s52, s52, s47
    s_add_u32 s52, s52, 0x107400
    s_add_u32 s52, s52, s76
    s_mul_i32 s46, s43, 8192
    s_add_u32 s46, s46, 0x5000000
    s_mul_i32 s47, s42, 65536
    s_add_u32 s46, s46, s47
    v_min_u32 v116, 63, v1
    v_lshlrev_b32 v116, 7, v116
    v_add_u32 v116, s46, v116
    s_mov_b32 s60, s74
    s_mul_i32 s61, s74, 262144
    s_mov_b32 s62, s74
    s_mul_i32 s63, s74, 262144
    s_mov_b32 s67, 0
    s_mov_b32 s68, 3
    s_mov_b32 s71, 0
    v_mov_b32 v15, 147456
    v_mov_b32 v14, 0
    ds_write_b32 v15, v14 offset:4
    ds_write_b32 v15, v14 offset:12
    ds_write_b32 v15, v14 offset:16
    v_mov_b32 v114, 1
    v_mov_b32 v115, 0
    v_lshrrev_b32 v113, 4, v1
    s_mov_b32 s72, 0
L_g_restart_142:
    s_cmp_lg_u32 s44, 0
    s_cbranch_scc1 L_g_nsp_143
    s_mov_b32 s70, 0
L_g_sp_149:
    s_add_u32 s54, s60, 0
    v_add_u32 v12, s54, v113
    v_and_b32 v13, 3, v12
    v_lshl_add_u32 v13, v13, 7, v7
    buffer_load_dword v11, v13, s[12:15], 0 offen sc1
    s_waitcnt vmcnt(0)
    v_cmp_ge_u32 vcc, v12, v11
    s_add_u32 s70, s70, 1
    s_and_b32 s46, vcc_lo, 0xffff
    s_cbranch_scc0 L_g_sp_149_ok
    s_sleep 3
    s_cmp_lt_u32 s70, 524288
    s_cbranch_scc1 L_g_sp_149
    s_branch L_c_done_1
L_g_sp_149_ok:
    v_cmp_ge_u32 vcc, v12, v11
    s_nop 0
    s_ff1_i32_b64 s46, vcc
    s_lshr_b32 s46, s46, 4
    s_min_u32 s46, s46, 4
    s_add_u32 s46, s46, s54
    s_min_u32 s46, s46, s75
    v_mov_b32 v11, s46
    ds_write_b32 v15, v11 offset:0
L_g_nsp_143:
    s_waitcnt lgkmcnt(0)
    s_barrier
    ds_read_b32 v14, v15 offset:0
    s_waitcnt lgkmcnt(0)
    v_readfirstlane_b32 s66, v14
    s_nop 3
L_g_restart_142_go:
    s_mov_b32 s69, 0
    s_cmp_gt_u32 s62, s60
    s_cbranch_scc1 L_g_nd_150
    s_cmp_ge_u32 s62, s66
    s_cbranch_scc1 L_g_nd_150
    s_add_u32 s47, s61, 4096
    s_add_u32 m0, s64, 0
    s_nop 0
    buffer_load_dwordx4 v3, s[12:15], s61 offen offset:0 sc1 lds
    buffer_load_dwordx4 v3, s[12:15], s61 offen offset:1024 sc1 lds
    buffer_load_dwordx4 v3, s[12:15], s61 offen offset:2048 sc1 lds
    buffer_load_dwordx4 v3, s[12:15], s61 offen offset:3072 sc1 lds
    s_add_u32 m0, s64, 4096
    s_nop 0
    buffer_load_dwordx4 v3, s[12:15], s47 offen offset:0 sc1 lds
    buffer_load_dwordx4 v3, s[12:15], s47 offen offset:1024 sc1 lds
    buffer_load_dwordx4 v3, s[12:15], s47 offen offset:2048 sc1 lds
    buffer_load_dwordx4 v3, s[12:15], s47 offen offset:3072 sc1 lds
    s_add_u32 s61, s61, 262144
    s_add_u32 s62, s62, 1
    s_xor_b32 s64, s64, 0x10000
    s_mov_b32 s69, 1
L_g_nd_150:
    s_cmp_eq_u32 s51, 1
    s_cbranch_scc1 L_g_g1r_144
    s_add_u32 s59, s60, 1
    s_mov_b32 s69, 0
    s_cmp_gt_u32 s62, s59
    s_cbranch_scc1 L_g_nd_151
    s_cmp_ge_u32 s62, s66
    s_cbranch_scc1 L_g_nd_151
    s_add_u32 s47, s61, 4096
    s_add_u32 m0, s64, 0
    s_nop 0
    buffer_load_dwordx4 v3, s[12:15], s61 offen offset:0 sc1 lds
    buffer_load_dwordx4 v3, s[12:15], s61 offen offset:1024 sc1 lds
    buffer_load_dwordx4 v3, s[12:15], s61 offen offset:2048 sc1 lds
    buffer_load_dwordx4 v3, s[12:15], s61 offen offset:3072 sc1 lds
    s_add_u32 m0, s64, 4096
    s_nop 0
    buffer_load_dwordx4 v3, s[12:15], s47 offen offset:0 sc1 lds
    buffer_load_dwordx4 v3, s[12:15], s47 offen offset:1024 sc1 lds
    buffer_load_dwordx4 v3, s[12:15], s47 offen offset:2048 sc1 lds
    buffer_load_dwordx4 v3, s[12:15], s47 offen offset:3072 sc1 lds
    s_add_u32 s61, s61, 262144
    s_add_u32 s62, s62, 1
    s_xor_b32 s64, s64, 0x10000
    s_mov_b32 s69, 1
L_g_nd_151:
    s_cmp_eq_u32 s69, 1
    s_cbranch_scc1 L_g_w0_152
    s_waitcnt vmcnt(0)
L_g_w0_152:
    s_waitcnt vmcnt(8)
    s_cmp_lg_u32 s44, 0
    s_cbranch_scc1 L_g_nl_153
    s_add_u32 s54, s60, 1
    v_add_u32 v12, s54, v113
    v_and_b32 v13, 3, v12
    v_lshl_add_u32 v13, v13, 7, v7
    buffer_load_dword v11, v13, s[12:15], 0 offen sc1
L_g_nl_153:
L_g_loop0_145_l:
    s_barrier
    ds_read_b128 v[32:35], v4 offset:0
    ds_read_b128 v[36:39], v4 offset:256
    ds_read_b128 v[40:43], v4 offset:2048
    ds_read_b128 v[44:47], v4 offset:2304
    ds_read_b128 v[48:51], v4 offset:4096
    ds_read_b128 v[52:55], v4 offset:4352
    ds_read_b128 v[56:59], v4 offset:6144
    ds_read_b128 v[60:63], v4 offset:6400
    s_branch L_g_loop0_145_m
.p2align 6
L_g_loop0_145:
    s_barrier
L_g_loop0_145_m:
    s_setprio 2
    s_waitcnt lgkmcnt(6)
    v_mfma_f32_16x16x32_bf16 v[16:19], v[32:35], a[0:3], 0
    ds_read_b32 v14, v15
    v_mfma_f32_16x16x32_bf16 v[20:23], v[32:35], a[4:7], 0
    ds_read_b128 v[32:35], v4 offset:8192
    v_mfma_f32_16x16x32_bf16 v[28:31], v[36:39], a[4:7], 0
    v_mfma_f32_16x16x32_bf16 v[24:27], v[36:39], a[0:3], 0
    ds_read_b128 v[36:39], v4 offset:8448
    s_waitcnt lgkmcnt(6)
    v_mfma_f32_16x16x32_bf16 v[16:19], v[40:43], a[8:11], v[16:19]
    v_mfma_f32_16x16x32_bf16 v[20:23], v[40:43], a[12:15], v[20:23]
    ds_read_b128 v[40:43], v4 offset:10240
    v_mfma_f32_16x16x32_bf16 v[28:31], v[44:47], a[12:15], v[28:31]
    v_mfma_f32_16x16x32_bf16 v[24:27], v[44:47], a[8:11], v[24:27]
    ds_read_b128 v[44:47], v4 offset:10496
    s_waitcnt lgkmcnt(6)
    v_mfma_f32_16x16x32_bf16 v[16:19], v[48:51], a[16:19], v[16:19]
    v_mfma_f32_16x16x32_bf16 v[20:23], v[48:51], a[20:23], v[20:23]
    ds_read_b128 v[48:51], v4 offset:12288
    v_mfma_f32_16x16x32_bf16 v[28:31], v[52:55], a[20:23], v[28:31]
    v_mfma_f32_16x16x32_bf16 v[24:27], v[52:55], a[16:19], v[24:27]
    ds_read_b128 v[52:55], v4 offset:12544
    s_waitcnt lgkmcnt(6)
    v_mfma_f32_16x16x32_bf16 v[16:19], v[56:59], a[24:27], v[16:19]
    v_mfma_f32_16x16x32_bf16 v[20:23], v[56:59], a[28:31], v[20:23]
    ds_read_b128 v[56:59], v4 offset:14336
    v_mfma_f32_16x16x32_bf16 v[28:31], v[60:63], a[28:31], v[28:31]
    v_mfma_f32_16x16x32_bf16 v[24:27], v[60:63], a[24:27], v[24:27]
    ds_read_b128 v[60:63], v4 offset:14592
    s_waitcnt lgkmcnt(6)
    v_mfma_f32_16x16x32_bf16 v[16:19], v[32:35], a[32:35], v[16:19]
    v_mfma_f32_16x16x32_bf16 v[20:23], v[32:35], a[36:39], v[20:23]
    ds_read_b128 v[32:35], v4 offset:16384
    v_mfma_f32_16x16x32_bf16 v[28:31], v[36:39], a[36:39], v[28:31]
    v_mfma_f32_16x16x32_bf16 v[24:27], v[36:39], a[32:35], v[24:27]
    ds_read_b128 v[36:39], v4 offset:16640
    s_waitcnt lgkmcnt(6)
    v_mfma_f32_16x16x32_bf16 v[16:19], v[40:43], a[40:43], v[16:19]
    v_mfma_f32_16x16x32_bf16 v[20:23], v[40:43], a[44:47], v[20:23]
    ds_read_b128 v[40:43], v4 offset:18432
    v_mfma_f32_16x16x32_bf16 v[28:31], v[44:47], a[44:47], v[28:31]
    v_mfma_f32_16x16x32_bf16 v[24:27], v[44:47], a[40:43], v[24:27]
    ds_read_b128 v[44:47], v4 offset:18688
    s_waitcnt lgkmcnt(6)
    v_mfma_f32_16x16x32_bf16 v[16:19], v[48:51], a[48:51], v[16:19]
    v_mfma_f32_16x16x32_bf16 v[20:23], v[48:51], a[52:55], v[20:23]
    ds_read_b128 v[48:51], v4 offset:20480
    v_mfma_f32_16x16x32_bf16 v[28:31], v[52:55], a[52:55], v[28:31]
    v_mfma_f32_16x16x32_bf16 v[24:27], v[52:55], a[48:51], v[24:27]
    ds_read_b128 v[52:55], v4 offset:20736
    s_waitcnt lgkmcnt(6)
    v_mfma_f32_16x16x32_bf16 v[16:19], v[56:59], a[56:59], v[16:19]
    v_mfma_f32_16x16x32_bf16 v[20:23], v[56:59], a[60:63], v[20:23]
    ds_read_b128 v[56:59], v4 offset:22528
    v_mfma_f32_16x16x32_bf16 v[28:31], v[60:63], a[60:63], v[28:31]
    v_mfma_f32_16x16x32_bf16 v[24:27], v[60:63], a[56:59], v[24:27]
    ds_read_b128 v[60:63], v4 offset:22784
    s_waitcnt lgkmcnt(6)
    v_mfma_f32_16x16x32_bf16 v[16:19], v[32:35], a[64:67], v[16:19]
    v_mfma_f32_16x16x32_bf16 v[20:23], v[32:35], a[68:71], v[20:23]
    ds_read_b128 v[32:35], v4 offset:24576
    v_mfma_f32_16x16x32_bf16 v[28:31], v[36:39], a[68:71], v[28:31]
    v_mfma_f32_16x16x32_bf16 v[24:27], v[36:39], a[64:67], v[24:27]
    ds_read_b128 v[36:39], v4 offset:24832
    s_waitcnt lgkmcnt(6)
    v_mfma_f32_16x16x32_bf16 v[16:19], v[40:43], a[72:75], v[16:19]
    v_mfma_f32_16x16x32_bf16 v[20:23], v[40:43], a[76:79], v[20:23]
    ds_read_b128 v[40:43], v4 offset:26624
    v_mfma_f32_16x16x32_bf16 v[28:31], v[44:47], a[76:79], v[28:31]
    v_mfma_f32_16x16x32_bf16 v[24:27], v[44:47], a[72:75], v[24:27]
    ds_read_b128 v[44:47], v4 offset:26880
    s_waitcnt lgkmcnt(6)
    v_mfma_f32_16x16x32_bf16 v[16:19], v[48:51], a[80:83], v[16:19]
    v_mfma_f32_16x16x32_bf16 v[20:23], v[48:51], a[84:87], v[20:23]
    ds_read_b128 v[48:51], v4 offset:28672
    v_mfma_f32_16x16x32_bf16 v[28:31], v[52:55], a[84:87], v[28:31]
    v_mfma_f32_16x16x32_bf16 v[24:27], v[52:55], a[80:83], v[24:27]
    ds_read_b128 v[52:55], v4 offset:28928
    s_waitcnt lgkmcnt(6)
    v_mfma_f32_16x16x32_bf16 v[16:19], v[56:59], a[88:91], v[16:19]
    v_mfma_f32_16x16x32_bf16 v[20:23], v[56:59], a[92:95], v[20:23]
    ds_read_b128 v[56:59], v4 offset:30720
    v_mfma_f32_16x16x32_bf16 v[28:31], v[60:63], a[92:95], v[28:31]
    v_mfma_f32_16x16x32_bf16 v[24:27], v[60:63], a[88:91], v[24:27]
    ds_read_b128 v[60:63], v4 offset:30976
    s_waitcnt lgkmcnt(6)
    v_mfma_f32_16x16x32_bf16 v[16:19], v[32:35], a[96:99], v[16:19]
    v_mfma_f32_16x16x32_bf16 v[20:23], v[32:35], a[100:103], v[20:23]
    v_mfma_f32_16x16x32_bf16 v[28:31], v[36:39], a[100:103], v[28:31]
    v_mfma_f32_16x16x32_bf16 v[24:27], v[36:39], a[96:99], v[24:27]
    s_waitcnt lgkmcnt(4)
    v_mfma_f32_16x16x32_bf16 v[16:19], v[40:43], a[104:107], v[16:19]
    v_mfma_f32_16x16x32_bf16 v[20:23], v[40:43], a[108:111], v[20:23]
    v_mfma_f32_16x16x32_bf16 v[28:31], v[44:47], a[108:111], v[28:31]
    v_mfma_f32_16x16x32_bf16 v[24:27], v[44:47], a[104:107], v[24:27]
    s_waitcnt lgkmcnt(2)
    v_mfma_f32_16x16x32_bf16 v[16:19], v[48:51], a[112:115], v[16:19]
    v_mfma_f32_16x16x32_bf16 v[20:23], v[48:51], a[116:119], v[20:23]
    v_mfma_f32_16x16x32_bf16 v[28:31], v[52:55], a[116:119], v[28:31]
    v_mfma_f32_16x16x32_bf16 v[24:27], v[52:55], a[112:115], v[24:27]
    s_waitcnt lgkmcnt(0)
    v_mfma_f32_16x16x32_bf16 v[16:19], v[56:59], a[120:123], v[16:19]
    v_mfma_f32_16x16x32_bf16 v[20:23], v[56:59], a[124:127], v[20:23]
    v_mfma_f32_16x16x32_bf16 v[28:31], v[60:63], a[124:127], v[28:31]
    v_mfma_f32_16x16x32_bf16 v[24:27], v[60:63], a[120:123], v[24:27]
    v_xor_b32 v4, 0x10000, v4
    s_setprio 0
    s_waitcnt vmcnt(0)
    v_readfirstlane_b32 s66, v14
    s_barrier
    s_nop 6
    ds_write_b128 v5, v[16:19] offset:0
    ds_write_b128 v5, v[20:23] offset:1024
    ds_write_b128 v5, v[24:27] offset:2048
    ds_write_b128 v5, v[28:31] offset:3072
    s_cmp_lg_u32 s44, 0
    s_cbranch_scc1 L_g_ne_154
    v_cmp_ge_u32 vcc, v12, v11
    s_nop 0
    s_ff1_i32_b64 s46, vcc
    s_lshr_b32 s46, s46, 4
    s_min_u32 s46, s46, 4
    s_add_u32 s46, s46, s54
    s_min_u32 s46, s46, s75
    v_mov_b32 v11, s46
    ds_write_b32 v15, v11 offset:0
L_g_ne_154:
    s_add_u32 s60, s60, 1
    s_mov_b32 s65, 0
    s_cmp_le_u32 s62, s60
    s_cbranch_scc1 L_g_dp_157_l
L_g_dp_157_a:
    s_cmp_ge_u32 s62, s66
    s_cbranch_scc1 L_g_dp_157_d
    s_add_u32 s47, s61, 4096
    s_mov_b32 m0, s64
    s_add_u32 s62, s62, 1
    buffer_load_dwordx4 v3, s[12:15], s61 offen offset:0 sc1 lds
    buffer_load_dwordx4 v3, s[12:15], s61 offen offset:1024 sc1 lds
    buffer_load_dwordx4 v3, s[12:15], s61 offen offset:2048 sc1 lds
    buffer_load_dwordx4 v3, s[12:15], s61 offen offset:3072 sc1 lds
    s_add_u32 m0, s64, 4096
    s_add_u32 s61, s61, 262144
    buffer_load_dwordx4 v3, s[12:15], s47 offen offset:0 sc1 lds
    buffer_load_dwordx4 v3, s[12:15], s47 offen offset:1024 sc1 lds
    buffer_load_dwordx4 v3, s[12:15], s47 offen offset:2048 sc1 lds
    buffer_load_dwordx4 v3, s[12:15], s47 offen offset:3072 sc1 lds
    s_xor_b32 s64, s64, 0x10000
L_g_dp_157_d:
    s_cmp_le_u32 s66, s60
    s_cbranch_scc1 L_g_ex0_156
    s_cmp_lg_u32 s65, 0
    s_cbranch_scc1 L_g_nw_155
    ds_read_b128 v[32:35], v4 offset:0
    ds_read_b128 v[36:39], v4 offset:256
    ds_read_b128 v[40:43], v4 offset:2048
    ds_read_b128 v[44:47], v4 offset:2304
    ds_read_b128 v[48:51], v4 offset:4096
    ds_read_b128 v[52:55], v4 offset:4352
    ds_read_b128 v[56:59], v4 offset:6144
    ds_read_b128 v[60:63], v4 offset:6400
    s_cmp_lg_u32 s44, 0
    s_cbranch_scc1 L_g_nl_158
    s_add_u32 s54, s60, 1
    v_add_u32 v12, s54, v113
    v_and_b32 v13, 3, v12
    v_lshl_add_u32 v13, v13, 7, v7
    buffer_load_dword v11, v13, s[12:15], 0 offen sc1
L_g_nl_158:
    s_waitcnt lgkmcnt(8)
    s_branch L_g_loop0_145
L_g_ex0_156:
    s_cmp_lg_u32 s44, 0
    s_cbranch_scc1 L_g_ex0_156_n
    s_sleep 6
    s_add_u32 s54, s60, 0
    v_add_u32 v12, s54, v113
    v_and_b32 v13, 3, v12
    v_lshl_add_u32 v13, v13, 7, v7
    buffer_load_dword v11, v13, s[12:15], 0 offen sc1
    s_waitcnt vmcnt(0)
    v_cmp_ge_u32 vcc, v12, v11
    s_nop 0
    s_ff1_i32_b64 s46, vcc
    s_lshr_b32 s46, s46, 4
    s_min_u32 s46, s46, 4
    s_add_u32 s46, s46, s54
    s_min_u32 s46, s46, s75
    v_mov_b32 v11, s46
    ds_write_b32 v15, v11 offset:0
L_g_ex0_156_n:
    s_waitcnt lgkmcnt(0)
    s_barrier
    ds_read_b32 v14, v15 offset:0
    s_waitcnt lgkmcnt(0)
    v_readfirstlane_b32 s66, v14
    s_barrier
    s_cmp_gt_u32 s66, s60
    s_cbranch_scc1 L_g_restart_142_go
    s_branch L_g_tail_147
L_g_g1r_144:
    s_mov_b32 s65, 1
    s_branch L_g_loop1_146_e
.p2align 6
L_g_loop1_146:
    s_mov_b32 s65, 0
L_g_loop1_146_e:
    s_barrier
    ds_read_b32 v14, v15
    s_bitcmp1_b32 s67, 1
    s_cbranch_scc0 L_g_nfl_159
    s_cmp_lg_u32 s44, 4
    s_cbranch_scc1 L_g_nfl_159_d
    s_sub_u32 s59, s60, 1
    v_mov_b32 v10, s59
    buffer_store_dword v10, v115, s[12:15], s52 offen sc1
L_g_nfl_159_d:
    s_waitcnt lgkmcnt(0)
    v_readfirstlane_b32 s66, v14
    ds_read_b128 v[80:83], v5 offset:0
    ds_read_b128 v[84:87], v5 offset:1024
    ds_read_b128 v[88:91], v5 offset:2048
    ds_read_b128 v[92:95], v5 offset:3072
    s_cmp_le_u32 s62, s60
    s_cbranch_scc1 L_g_dp_164_l
L_g_dp_164_a:
    s_cmp_ge_u32 s62, s66
    s_cbranch_scc1 L_g_dp_164_d
    s_add_u32 s47, s61, 4096
    s_mov_b32 m0, s64
    s_add_u32 s62, s62, 1
    buffer_load_dwordx4 v3, s[12:15], s61 offen offset:0 sc1 lds
    buffer_load_dwordx4 v3, s[12:15], s61 offen offset:1024 sc1 lds
    buffer_load_dwordx4 v3, s[12:15], s61 offen offset:2048 sc1 lds
    buffer_load_dwordx4 v3, s[12:15], s61 offen offset:3072 sc1 lds
    s_add_u32 m0, s64, 4096
    s_add_u32 s61, s61, 262144
    buffer_load_dwordx4 v3, s[12:15], s47 offen offset:0 sc1 lds
    buffer_load_dwordx4 v3, s[12:15], s47 offen offset:1024 sc1 lds
    buffer_load_dwordx4 v3, s[12:15], s47 offen offset:2048 sc1 lds
    buffer_load_dwordx4 v3, s[12:15], s47 offen offset:3072 sc1 lds
    s_xor_b32 s64, s64, 0x10000
L_g_dp_164_d:
    s_bitcmp1_b32 s67, 0
    s_cbranch_scc0 L_g_nep_160
    s_waitcnt lgkmcnt(0)
    v_add_f32 v80, v80, v16
    v_add_f32 v81, v81, v17
    v_add_f32 v82, v82, v18
    v_add_f32 v83, v83, v19
    v_add_f32 v84, v84, v20
    v_add_f32 v85, v85, v21
    v_add_f32 v86, v86, v22
    v_add_f32 v87, v87, v23
    v_add_f32 v88, v88, v24
    v_add_f32 v89, v89, v25
    v_add_f32 v90, v90, v26
    v_add_f32 v91, v91, v27
    v_add_f32 v92, v92, v28
    v_add_f32 v93, v93, v29
    v_add_f32 v94, v94, v30
    v_add_f32 v95, v95, v31
    v_cvt_pk_bf16_f32 v104, v80, v81
    v_cvt_pk_bf16_f32 v105, v82, v83
    v_cvt_pk_bf16_f32 v106, v84, v85
    v_cvt_pk_bf16_f32 v107, v86, v87
    s_nop 1
    v_permlane16_swap_b32 v104, v106
    v_permlane16_swap_b32 v105, v107
    buffer_store_dwordx4 v[104:107], v8, s[12:15], s63 offen sc1
    v_cvt_pk_bf16_f32 v108, v88, v89
    v_cvt_pk_bf16_f32 v109, v90, v91
    v_cvt_pk_bf16_f32 v110, v92, v93
    v_cvt_pk_bf16_f32 v111, v94, v95
    s_nop 1
    v_permlane16_swap_b32 v108, v110
    v_permlane16_swap_b32 v109, v111
    buffer_store_dwordx4 v[108:111], v9, s[12:15], s63 offen sc1
    s_add_u32 s63, s63, 262144
L_g_nep_160:
    s_cmp_lg_u32 s65, 0
    s_cbranch_scc1 L_g_nw1_161
    ds_read_b128 v[32:35], v4 offset:0
    ds_read_b128 v[36:39], v4 offset:256
    ds_read_b128 v[40:43], v4 offset:2048
    ds_read_b128 v[44:47], v4 offset:2304
    ds_read_b128 v[48:51], v4 offset:4096
    ds_read_b128 v[52:55], v4 offset:4352
    ds_read_b128 v[56:59], v4 offset:6144
    ds_read_b128 v[60:63], v4 offset:6400
    s_barrier
L_g_jn_163:
    s_setprio 1
    s_waitcnt lgkmcnt(6)
    v_mfma_f32_16x16x32_bf16 v[16:19], v[32:35], a[0:3], 0
    v_mfma_f32_16x16x32_bf16 v[20:23], v[32:35], a[4:7], 0
    ds_read_b128 v[32:35], v4 offset:8192
    v_mfma_f32_16x16x32_bf16 v[28:31], v[36:39], a[4:7], 0
    v_mfma_f32_16x16x32_bf16 v[24:27], v[36:39], a[0:3], 0
    ds_read_b128 v[36:39], v4 offset:8448
    s_waitcnt lgkmcnt(6)
    v_mfma_f32_16x16x32_bf16 v[16:19], v[40:43], a[8:11], v[16:19]
    v_mfma_f32_16x16x32_bf16 v[20:23], v[40:43], a[12:15], v[20:23]
    ds_read_b128 v[40:43], v4 offset:10240
    v_mfma_f32_16x16x32_bf16 v[28:31], v[44:47], a[12:15], v[28:31]
    v_mfma_f32_16x16x32_bf16 v[24:27], v[44:47], a[8:11], v[24:27]
    ds_read_b128 v[44:47], v4 offset:10496
    s_waitcnt lgkmcnt(6)
    v_mfma_f32_16x16x32_bf16 v[16:19], v[48:51], a[16:19], v[16:19]
    v_mfma_f32_16x16x32_bf16 v[20:23], v[48:51], a[20:23], v[20:23]
    ds_read_b128 v[48:51], v4 offset:12288
    v_mfma_f32_16x16x32_bf16 v[28:31], v[52:55], a[20:23], v[28:31]
    v_mfma_f32_16x16x32_bf16 v[24:27], v[52:55], a[16:19], v[24:27]
    ds_read_b128 v[52:55], v4 offset:12544
    s_waitcnt lgkmcnt(6)
    v_mfma_f32_16x16x32_bf16 v[16:19], v[56:59], a[24:27], v[16:19]
    v_mfma_f32_16x16x32_bf16 v[20:23], v[56:59], a[28:31], v[20:23]
    ds_read_b128 v[56:59], v4 offset:14336
    v_mfma_f32_16x16x32_bf16 v[28:31], v[60:63], a[28:31], v[28:31]
    v_mfma_f32_16x16x32_bf16 v[24:27], v[60:63], a[24:27], v[24:27]
    ds_read_b128 v[60:63], v4 offset:14592
    s_waitcnt lgkmcnt(6)
    v_mfma_f32_16x16x32_bf16 v[16:19], v[32:35], a[32:35], v[16:19]
    v_mfma_f32_16x16x32_bf16 v[20:23], v[32:35], a[36:39], v[20:23]
    ds_read_b128 v[32:35], v4 offset:16384
    v_mfma_f32_16x16x32_bf16 v[28:31], v[36:39], a[36:39], v[28:31]
    v_mfma_f32_16x16x32_bf16 v[24:27], v[36:39], a[32:35], v[24:27]
    ds_read_b128 v[36:39], v4 offset:16640
    s_waitcnt lgkmcnt(6)
    v_mfma_f32_16x16x32_bf16 v[16:19], v[40:43], a[40:43], v[16:19]
    v_mfma_f32_16x16x32_bf16 v[20:23], v[40:43], a[44:47], v[20:23]
    ds_read_b128 v[40:43], v4 offset:18432
    v_mfma_f32_16x16x32_bf16 v[28:31], v[44:47], a[44:47], v[28:31]
    v_mfma_f32_16x16x32_bf16 v[24:27], v[44:47], a[40:43], v[24:27]
    ds_read_b128 v[44:47], v4 offset:18688
    s_waitcnt lgkmcnt(6)
    v_mfma_f32_16x16x32_bf16 v[16:19], v[48:51], a[48:51], v[16:19]
    v_mfma_f32_16x16x32_bf16 v[20:23], v[48:51], a[52:55], v[20:23]
    ds_read_b128 v[48:51], v4 offset:20480
    v_mfma_f32_16x16x32_bf16 v[28:31], v[52:55], a[52:55], v[28:31]
    v_mfma_f32_16x16x32_bf16 v[24:27], v[52:55], a[48:51], v[24:27]
    ds_read_b128 v[52:55], v4 offset:20736
    s_waitcnt lgkmcnt(6)
    v_mfma_f32_16x16x32_bf16 v[16:19], v[56:59], a[56:59], v[16:19]
    v_mfma_f32_16x16x32_bf16 v[20:23], v[56:59], a[60:63], v[20:23]
    ds_read_b128 v[56:59], v4 offset:22528
    v_mfma_f32_16x16x32_bf16 v[28:31], v[60:63], a[60:63], v[28:31]
    v_mfma_f32_16x16x32_bf16 v[24:27], v[60:63], a[56:59], v[24:27]
    ds_read_b128 v[60:63], v4 offset:22784
    s_waitcnt lgkmcnt(6)
    v_mfma_f32_16x16x32_bf16 v[16:19], v[32:35], a[64:67], v[16:19]
    v_mfma_f32_16x16x32_bf16 v[20:23], v[32:35], a[68:71], v[20:23]
    ds_read_b128 v[32:35], v4 offset:24576
    v_mfma_f32_16x16x32_bf16 v[28:31], v[36:39], a[68:71], v[28:31]
    v_mfma_f32_16x16x32_bf16 v[24:27], v[36:39], a[64:67], v[24:27]
    ds_read_b128 v[36:39], v4 offset:24832
    s_waitcnt lgkmcnt(6)
    v_mfma_f32_16x16x32_bf16 v[16:19], v[40:43], a[72:75], v[16:19]
    v_mfma_f32_16x16x32_bf16 v[20:23], v[40:43], a[76:79], v[20:23]
    ds_read_b128 v[40:43], v4 offset:26624
    v_mfma_f32_16x16x32_bf16 v[28:31], v[44:47], a[76:79], v[28:31]
    v_mfma_f32_16x16x32_bf16 v[24:27], v[44:47], a[72:75], v[24:27]
    ds_read_b128 v[44:47], v4 offset:26880
    s_waitcnt lgkmcnt(6)
    v_mfma_f32_16x16x32_bf16 v[16:19], v[48:51], a[80:83], v[16:19]
    v_mfma_f32_16x16x32_bf16 v[20:23], v[48:51], a[84:87], v[20:23]
    ds_read_b128 v[48:51], v4 offset:28672
    v_mfma_f32_16x16x32_bf16 v[28:31], v[52:55], a[84:87], v[28:31]
    v_mfma_f32_16x16x32_bf16 v[24:27], v[52:55], a[80:83], v[24:27]
    ds_read_b128 v[52:55], v4 offset:28928
    s_waitcnt lgkmcnt(6)
    v_mfma_f32_16x16x32_bf16 v[16:19], v[56:59], a[88:91], v[16:19]
    v_mfma_f32_16x16x32_bf16 v[20:23], v[56:59], a[92:95], v[20:23]
    ds_read_b128 v[56:59], v4 offset:30720
    v_mfma_f32_16x16x32_bf16 v[28:31], v[60:63], a[92:95], v[28:31]
    v_mfma_f32_16x16x32_bf16 v[24:27], v[60:63], a[88:91], v[24:27]
    ds_read_b128 v[60:63], v4 offset:30976
    s_waitcnt lgkmcnt(6)
    v_mfma_f32_16x16x32_bf16 v[16:19], v[32:35], a[96:99], v[16:19]
    v_mfma_f32_16x16x32_bf16 v[20:23], v[32:35], a[100:103], v[20:23]
    v_mfma_f32_16x16x32_bf16 v[28:31], v[36:39], a[100:103], v[28:31]
    v_mfma_f32_16x16x32_bf16 v[24:27], v[36:39], a[96:99], v[24:27]
    s_waitcnt lgkmcnt(4)
    v_mfma_f32_16x16x32_bf16 v[16:19], v[40:43], a[104:107], v[16:19]
    v_mfma_f32_16x16x32_bf16 v[20:23], v[40:43], a[108:111], v[20:23]
    v_mfma_f32_16x16x32_bf16 v[28:31], v[44:47], a[108:111], v[28:31]
    v_mfma_f32_16x16x32_bf16 v[24:27], v[44:47], a[104:107], v[24:27]
    s_waitcnt lgkmcnt(2)
    v_mfma_f32_16x16x32_bf16 v[16:19], v[48:51], a[112:115], v[16:19]
    v_mfma_f32_16x16x32_bf16 v[20:23], v[48:51], a[116:119], v[20:23]
    v_mfma_f32_16x16x32_bf16 v[28:31], v[52:55], a[116:119], v[28:31]
    v_mfma_f32_16x16x32_bf16 v[24:27], v[52:55], a[112:115], v[24:27]
    s_waitcnt lgkmcnt(0)
    v_mfma_f32_16x16x32_bf16 v[16:19], v[56:59], a[120:123], v[16:19]
    v_mfma_f32_16x16x32_bf16 v[20:23], v[56:59], a[124:127], v[20:23]
    v_mfma_f32_16x16x32_bf16 v[28:31], v[60:63], a[124:127], v[28:31]
    v_mfma_f32_16x16x32_bf16 v[24:27], v[60:63], a[120:123], v[24:27]
    v_xor_b32 v4, 0x10000, v4
    s_setprio 0
    s_waitcnt vmcnt(0)
    s_lshl_b32 s67, s67, 1
    s_or_b32 s67, s67, 1
    s_add_u32 s60, s60, 1
    s_cmp_gt_u32 s66, s60
    s_cbranch_scc1 L_g_loop1_146
    s_barrier
    ds_read_b32 v14, v15 offset:0
    s_waitcnt lgkmcnt(0)
    v_readfirstlane_b32 s66, v14
    s_barrier
    s_mov_b32 s69, 0
    s_cmp_gt_u32 s62, s60
    s_cbranch_scc1 L_g_nd_165
    s_cmp_ge_u32 s62, s66
    s_cbranch_scc1 L_g_nd_165
    s_add_u32 s47, s61, 4096
    s_add_u32 m0, s64, 0
    s_nop 0
    buffer_load_dwordx4 v3, s[12:15], s61 offen offset:0 sc1 lds
    buffer_load_dwordx4 v3, s[12:15], s61 offen offset:1024 sc1 lds
    buffer_load_dwordx4 v3, s[12:15], s61 offen offset:2048 sc1 lds
    buffer_load_dwordx4 v3, s[12:15], s61 offen offset:3072 sc1 lds
    s_add_u32 m0, s64, 4096
    s_nop 0
    buffer_load_dwordx4 v3, s[12:15], s47 offen offset:0 sc1 lds
    buffer_load_dwordx4 v3, s[12:15], s47 offen offset:1024 sc1 lds
    buffer_load_dwordx4 v3, s[12:15], s47 offen offset:2048 sc1 lds
    buffer_load_dwordx4 v3, s[12:15], s47 offen offset:3072 sc1 lds
    s_add_u32 s61, s61, 262144
    s_add_u32 s62, s62, 1
    s_xor_b32 s64, s64, 0x10000
    s_mov_b32 s69, 1
L_g_nd_165:
    s_sub_u32 s59, s60, 1
    ds_read_b128 v[80:83], v5 offset:0
    ds_read_b128 v[84:87], v5 offset:1024
    ds_read_b128 v[88:91], v5 offset:2048
    ds_read_b128 v[92:95], v5 offset:3072
    s_nop 7
    s_waitcnt lgkmcnt(3)
    v_add_f32 v80, v80, v16
    v_add_f32 v81, v81, v17
    v_add_f32 v82, v82, v18
    v_add_f32 v83, v83, v19
    s_waitcnt lgkmcnt(2)
    v_add_f32 v84, v84, v20
    v_add_f32 v85, v85, v21
    v_add_f32 v86, v86, v22
    v_add_f32 v87, v87, v23
    s_waitcnt lgkmcnt(1)
    v_add_f32 v88, v88, v24
    v_add_f32 v89, v89, v25
    v_add_f32 v90, v90, v26
    v_add_f32 v91, v91, v27
    s_waitcnt lgkmcnt(0)
    v_add_f32 v92, v92, v28
    v_add_f32 v93, v93, v29
    v_add_f32 v94, v94, v30
    v_add_f32 v95, v95, v31
    v_cvt_pk_bf16_f32 v104, v80, v81
    v_cvt_pk_bf16_f32 v105, v82, v83
    v_cvt_pk_bf16_f32 v106, v84, v85
    v_cvt_pk_bf16_f32 v107, v86, v87
    s_nop 1
    v_permlane16_swap_b32 v104, v106
    v_permlane16_swap_b32 v105, v107
    buffer_store_dwordx4 v[104:107], v8, s[12:15], s63 offen sc1
    v_cvt_pk_bf16_f32 v108, v88, v89
    v_cvt_pk_bf16_f32 v109, v90, v91
    v_cvt_pk_bf16_f32 v110, v92, v93
    v_cvt_pk_bf16_f32 v111, v94, v95
    s_nop 1
    v_permlane16_swap_b32 v108, v110
    v_permlane16_swap_b32 v109, v111
    buffer_store_dwordx4 v[108:111], v9, s[12:15], s63 offen sc1
    s_add_u32 s63, s63, 262144
    s_mov_b32 s67, 0
    s_mov_b32 s71, 1
    s_cmp_gt_u32 s66, s60
    s_cbranch_scc1 L_g_g1r_144
    v_mov_b32 v10, 1
    s_mov_b64 exec, 1
    s_waitcnt vmcnt(0)
    ds_add_rtn_u32 v10, v15, v10 offset:4
    s_waitcnt lgkmcnt(0)
    v_readfirstlane_b32 s46, v10
    s_mov_b64 exec, -1
    s_mov_b32 s71, 0
    s_sub_u32 s59, s60, 1
    s_cmp_lg_u32 s46, s68
    s_cbranch_scc1 L_g_df_166
    v_mov_b32 v10, s59
    v_add_u32 v10, 1, v10
    v_mov_b32 v11, 0
    s_mov_b64 exec, 1
    buffer_store_dword v10, v11, s[12:15], s52 offen sc1
    s_mov_b64 exec, -1
L_sf_167:
L_g_df_166:
    s_add_u32 s68, s68, 4
    s_cmp_gt_u32 s66, s60
    s_cbranch_scc1 L_g_g1r_144
L_g_tail_147:
    s_cmp_lt_u32 s60, s75
    s_cbranch_scc1 L_g_restart_142
    s_waitcnt vmcnt(0)
    s_barrier
    s_branch L_c_done_1
L_g_dp_157_l:
    s_cmp_ge_u32 s62, s66
    s_cbranch_scc1 L_g_dp_157_d
    s_mov_b32 s65, 1
    s_add_u32 s47, s61, 4096
    s_mov_b32 m0, s64
    s_add_u32 s62, s62, 1
    buffer_load_dwordx4 v3, s[12:15], s61 offen offset:0 sc1 lds
    buffer_load_dwordx4 v3, s[12:15], s61 offen offset:1024 sc1 lds
    buffer_load_dwordx4 v3, s[12:15], s61 offen offset:2048 sc1 lds
    buffer_load_dwordx4 v3, s[12:15], s61 offen offset:3072 sc1 lds
    s_add_u32 m0, s64, 4096
    s_add_u32 s61, s61, 262144
    buffer_load_dwordx4 v3, s[12:15], s47 offen offset:0 sc1 lds
    buffer_load_dwordx4 v3, s[12:15], s47 offen offset:1024 sc1 lds
    buffer_load_dwordx4 v3, s[12:15], s47 offen offset:2048 sc1 lds
    buffer_load_dwordx4 v3, s[12:15], s47 offen offset:3072 sc1 lds
    s_xor_b32 s64, s64, 0x10000
    s_branch L_g_dp_157_a
L_g_nw_155:
    s_waitcnt vmcnt(0) lgkmcnt(0)
    s_cmp_lg_u32 s44, 0
    s_cbranch_scc1 L_g_nl_168
    s_add_u32 s54, s60, 1
    v_add_u32 v12, s54, v113
    v_and_b32 v13, 3, v12
    v_lshl_add_u32 v13, v13, 7, v7
    buffer_load_dword v11, v13, s[12:15], 0 offen sc1
L_g_nl_168:
    s_branch L_g_loop0_145_l
L_g_nfl_159:
    s_cmp_eq_u32 s71, 0
    s_cbranch_scc1 L_g_nfl_159_d
    v_mov_b32 v10, 1
    s_mov_b64 exec, 1
    s_waitcnt vmcnt(0)
    ds_add_rtn_u32 v10, v15, v10 offset:4
    s_waitcnt lgkmcnt(0)
    v_readfirstlane_b32 s46, v10
    s_mov_b64 exec, -1
    s_mov_b32 s71, 0
    s_sub_u32 s59, s60, 1
    s_cmp_lg_u32 s46, s68
    s_cbranch_scc1 L_g_df_169
    v_mov_b32 v10, s59
    v_add_u32 v10, 1, v10
    v_mov_b32 v11, 0
    s_mov_b64 exec, 1
    buffer_store_dword v10, v11, s[12:15], s52 offen sc1
    s_mov_b64 exec, -1
L_sf_170:
L_g_df_169:
    s_add_u32 s68, s68, 4
    s_mov_b32 s65, 2
    s_branch L_g_nfl_159_d
L_g_dp_164_l:
    s_cmp_ge_u32 s62, s66
    s_cbranch_scc1 L_g_dp_164_d
    s_or_b32 s65, s65, 1
    s_add_u32 s47, s61, 4096
    s_mov_b32 m0, s64
    s_add_u32 s62, s62, 1
    buffer_load_dwordx4 v3, s[12:15], s61 offen offset:0 sc1 lds
    buffer_load_dwordx4 v3, s[12:15], s61 offen offset:1024 sc1 lds
    buffer_load_dwordx4 v3, s[12:15], s61 offen offset:2048 sc1 lds
    buffer_load_dwordx4 v3, s[12:15], s61 offen offset:3072 sc1 lds
    s_add_u32 m0, s64, 4096
    s_add_u32 s61, s61, 262144
    buffer_load_dwordx4 v3, s[12:15], s47 offen offset:0 sc1 lds
    buffer_load_dwordx4 v3, s[12:15], s47 offen offset:1024 sc1 lds
    buffer_load_dwordx4 v3, s[12:15], s47 offen offset:2048 sc1 lds
    buffer_load_dwordx4 v3, s[12:15], s47 offen offset:3072 sc1 lds
    s_xor_b32 s64, s64, 0x10000
    s_branch L_g_dp_164_a
L_g_nw1_161:
    s_cmp_eq_u32 s65, 2
    s_cbranch_scc1 L_g_nw1_161_w
    s_waitcnt vmcnt(0)
L_g_nw1_161_w:
    s_barrier
    ds_read_b128 v[32:35], v4 offset:0
    ds_read_b128 v[36:39], v4 offset:256
    ds_read_b128 v[40:43], v4 offset:2048
    ds_read_b128 v[44:47], v4 offset:2304
    ds_read_b128 v[48:51], v4 offset:4096
    ds_read_b128 v[52:55], v4 offset:4352
    ds_read_b128 v[56:59], v4 offset:6144
    ds_read_b128 v[60:63], v4 offset:6400
    s_branch L_g_jn_163
L_c_chain_9:
    v_mov_b32 v4, 0
    v_mov_b32 v5, 0
    v_mov_b32 v6, 0
    v_mov_b32 v7, 0
    v_mov_b32 v8, 0
    v_mov_b32 v9, 0
    v_mov_b32 v10, 0
    v_mov_b32 v11, 0
    v_mov_b32 v12, 0
    v_mov_b32 v13, 0
    v_mov_b32 v14, 0
    v_mov_b32 v15, 0
    v_mov_b32 v32, -1
    v_mov_b32 v33, -1
    v_mov_b32 v34, -1
    v_mov_b32 v35, -1
    v_lshlrev_b32 v2, 4, v1
    s_lshl_b32 s45, s40, 16
    s_lshl_b32 s46, s41, 12
    s_add_u32 s45, s45, s46
    s_and_b32 s46, s44, 3
    s_lshl_b32 s46, s46, 10
    s_add_u32 s45, s45, s46
    s_lshr_b32 s46, s44, 2
    s_lshl_b32 s46, s46, 19
    s_add_u32 s45, s45, s46
    s_add_u32 s45, s45, 0x7000000
    buffer_store_dwordx4 v[32:35], v2, s[12:15], s45 offen sc1
    s_lshl_b32 s45, s40, 15
    s_lshl_b32 s46, s41, 11
    s_add_u32 s45, s45, s46
    s_lshl_b32 s46, s44, 8
    s_add_u32 s45, s45, s46
    s_add_u32 s45, s45, 0x7100000
    s_mov_b64 exec, 0xffff
    buffer_store_dwordx4 v[32:35], v2, s[12:15], s45 offen sc1
    s_lshl_b32 s45, s40, 16
    s_lshl_b32 s46, s41, 8
    s_add_u32 s45, s45, s46
    s_and_b32 s46, s44, 3
    s_lshl_b32 s46, s46, 14
    s_add_u32 s45, s45, s46
    s_add_u32 s45, s45, 0x7180000
    buffer_store_dwordx4 v[32:35], v2, s[12:15], s45 offen sc1
    s_mov_b64 exec, -1
    v_lshlrev_b32 v2, 4, v1
    v_and_b32 v3, 8, v1
    v_cmp_eq_u32 vcc, 0, v3
    v_mov_b32 v3, 0xeeeeeeee
    v_mov_b32 v4, 0x44444444
    v_cndmask_b32 v3, v3, v4, vcc
    v_and_b32 v100, 15, v1
    v_lshrrev_b32 v101, 4, v1
    v_and_b32 v102, 1, v101
    v_lshrrev_b32 v103, 1, v101
    v_lshlrev_b32 v104, 2, v102
    v_lshl_add_u32 v104, v103, 1, v104
    v_and_b32 v105, 1, v1
    v_add_u32 v104, v104, v105
    v_and_b32 v106, 7, v1
    v_bfe_u32 v107, v1, 3, 1
    s_lshr_b32 s42, s41, 2
    s_and_b32 s43, s41, 3
    s_lshl_b32 s49, s40, 2
    s_add_u32 s49, s49, s42
    s_lshl_b32 s45, s44, 14
    v_lshlrev_b32 v22, 3, v101
    v_bfe_u32 v23, v1, 2, 2
    v_add_u32 v22, v22, v23
    v_and_b32 v23, 3, v1
    v_lshlrev_b32 v24, 3, v23
    v_lshl_add_u32 v20, v22, 6, v24
    v_lshl_add_u32 v21, v22, 7, v24
    v_lshrrev_b32 v22, 2, v1
    v_lshlrev_b32 v23, 4, v23
    v_lshl_add_u32 v24, v22, 13, v23
    v_lshrrev_b32 v22, 3, v1
    v_lshlrev_b32 v23, 4, v106
    v_lshl_add_u32 v25, v22, 11, v23
    s_cmp_ge_u32 s44, 4
    s_cbranch_scc1 L_v_init_171
    s_lshr_b32 s50, s44, 1
    s_and_b32 s51, s44, 1
    s_load_dwordx4 s[4:7], s[0:1], 16
    s_lshl_b32 s46, s49, 8
    s_lshl_b32 s48, s43, 6
    s_add_u32 s46, s46, s48
    s_lshl_b32 s48, s44, 21
    s_add_u32 s46, s46, s48
    s_lshl_b32 s52, s51, 5
    s_xor_b32 s53, s50, 1
    s_lshl_b32 s53, s53, 16
    s_add_u32 s52, s52, s53
    v_add_u32 v20, s52, v20
    s_waitcnt lgkmcnt(0)
    s_mov_b32 s24, s6
    s_and_b32 s25, s7, 0xffff
    s_mov_b32 s26, 0x800000
    s_mov_b32 s27, 0x00020000
    s_mov_b32 s28, s4
    s_and_b32 s29, s5, 0xffff
    s_mov_b32 s30, 0x800000
    s_mov_b32 s31, 0x00020000
    s_lshl_b32 s52, s51, 9
    s_lshl_b32 s53, s50, 7
    s_add_u32 s52, s52, s53
    s_add_u32 s52, s52, 61440
    v_lshlrev_b32 v5, 1, v106
    v_lshl_add_u32 v5, v107, 8, v5
    v_lshl_add_u32 v5, v102, 6, v5
    v_lshl_add_u32 v5, v103, 5, v5
    v_add_u32 v5, s52, v5
    s_lshl_b32 s67, s49, 12
    s_lshl_b32 s53, s43, 10
    s_add_u32 s67, s67, s53
    s_add_u32 s67, s67, 0x1000000
    s_lshl_b32 s52, s40, 16
    s_lshl_b32 s53, s44, 11
    s_add_u32 s53, s52, s53
    s_add_u32 s53, s53, 0x7080000
    v_lshlrev_b32 v7, 3, v1
    v_add_u32 v7, s53, v7
    s_lshl_b32 s53, s44, 9
    s_add_u32 s53, s52, s53
    s_add_u32 s53, s53, 0x7180000
    v_lshlrev_b32 v28, 6, v103
    v_lshl_add_u32 v28, v106, 3, v28
    v_lshl_add_u32 v28, v102, 2, v28
    v_lshl_add_u32 v28, v107, 1, v28
    v_add_u32 v28, s53, v28
    s_lshl_b32 s52, s44, 10
    s_add_u32 s52, s52, 16384
    v_lshlrev_b32 v8, 8, v101
    v_lshl_add_u32 v8, v106, 4, v8
    v_lshl_add_u32 v8, v107, 3, v8
    v_add_u32 v8, s52, v8
    s_lshl_b32 s52, s44, 8
    s_add_u32 s52, s52, 20480
    v_lshlrev_b32 v9, 4, v106
    v_lshl_add_u32 v9, v101, 2, v9
    v_lshl_add_u32 v9, v107, 1, v9
    v_add_u32 v9, s52, v9
    s_mov_b32 s66, 0x3e0293ee
    s_add_u32 m0, s45, 0
    s_add_u32 s48, s46, 0x0
    buffer_load_dwordx4 v24, s[24:27], s48 offen lds
    s_add_u32 m0, s45, 1024
    s_add_u32 s48, s46, 0x20000
    buffer_load_dwordx4 v24, s[24:27], s48 offen lds
    s_add_u32 m0, s45, 2048
    s_add_u32 s48, s46, 0x40000
    buffer_load_dwordx4 v24, s[24:27], s48 offen lds
    s_add_u32 m0, s45, 3072
    s_add_u32 s48, s46, 0x60000
    buffer_load_dwordx4 v24, s[24:27], s48 offen lds
    s_add_u32 m0, s45, 4096
    s_add_u32 s48, s46, 0x80000
    buffer_load_dwordx4 v24, s[24:27], s48 offen lds
    s_add_u32 m0, s45, 5120
    s_add_u32 s48, s46, 0xa0000
    buffer_load_dwordx4 v24, s[24:27], s48 offen lds
    s_add_u32 m0, s45, 6144
    s_add_u32 s48, s46, 0xc0000
    buffer_load_dwordx4 v24, s[24:27], s48 offen lds
    s_add_u32 m0, s45, 7168
    s_add_u32 s48, s46, 0xe0000
    buffer_load_dwordx4 v24, s[24:27], s48 offen lds
    s_add_u32 m0, s45, 8192
    s_add_u32 s48, s46, 0x100000
    buffer_load_dwordx4 v24, s[24:27], s48 offen lds
    s_add_u32 m0, s45, 9216
    s_add_u32 s48, s46, 0x120000
    buffer_load_dwordx4 v24, s[24:27], s48 offen lds
    s_add_u32 m0, s45, 10240
    s_add_u32 s48, s46, 0x140000
    buffer_load_dwordx4 v24, s[24:27], s48 offen lds
    s_add_u32 m0, s45, 11264
    s_add_u32 s48, s46, 0x160000
    buffer_load_dwordx4 v24, s[24:27], s48 offen lds
    s_add_u32 m0, s45, 12288
    s_add_u32 s48, s46, 0x180000
    buffer_load_dwordx4 v24, s[24:27], s48 offen lds
    s_add_u32 m0, s45, 13312
    s_add_u32 s48, s46, 0x1a0000
    buffer_load_dwordx4 v24, s[24:27], s48 offen lds
    s_add_u32 m0, s45, 14336
    s_add_u32 s48, s46, 0x1c0000
    buffer_load_dwordx4 v24, s[24:27], s48 offen lds
    s_add_u32 m0, s45, 15360
    s_add_u32 s48, s46, 0x1e0000
    buffer_load_dwordx4 v24, s[24:27], s48 offen lds
    s_add_u32 s45, s45, 0x10000
    s_add_u32 m0, s45, 0
    s_add_u32 s48, s46, 0x0
    buffer_load_dwordx4 v24, s[28:31], s48 offen lds
    s_add_u32 m0, s45, 1024
    s_add_u32 s48, s46, 0x20000
    buffer_load_dwordx4 v24, s[28:31], s48 offen lds
    s_add_u32 m0, s45, 2048
    s_add_u32 s48, s46, 0x40000
    buffer_load_dwordx4 v24, s[28:31], s48 offen lds
    s_add_u32 m0, s45, 3072
    s_add_u32 s48, s46, 0x60000
    buffer_load_dwordx4 v24, s[28:31], s48 offen lds
    s_add_u32 m0, s45, 4096
    s_add_u32 s48, s46, 0x80000
    buffer_load_dwordx4 v24, s[28:31], s48 offen lds
    s_add_u32 m0, s45, 5120
    s_add_u32 s48, s46, 0xa0000
    buffer_load_dwordx4 v24, s[28:31], s48 offen lds
    s_add_u32 m0, s45, 6144
    s_add_u32 s48, s46, 0xc0000
    buffer_load_dwordx4 v24, s[28:31], s48 offen lds
    s_add_u32 m0, s45, 7168
    s_add_u32 s48, s46, 0xe0000
    buffer_load_dwordx4 v24, s[28:31], s48 offen lds
    s_add_u32 m0, s45, 8192
    s_add_u32 s48, s46, 0x100000
    buffer_load_dwordx4 v24, s[28:31], s48 offen lds
    s_add_u32 m0, s45, 9216
    s_add_u32 s48, s46, 0x120000
    buffer_load_dwordx4 v24, s[28:31], s48 offen lds
    s_add_u32 m0, s45, 10240
    s_add_u32 s48, s46, 0x140000
    buffer_load_dwordx4 v24, s[28:31], s48 offen lds
    s_add_u32 m0, s45, 11264
    s_add_u32 s48, s46, 0x160000
    buffer_load_dwordx4 v24, s[28:31], s48 offen lds
    s_add_u32 m0, s45, 12288
    s_add_u32 s48, s46, 0x180000
    buffer_load_dwordx4 v24, s[28:31], s48 offen lds
    s_add_u32 m0, s45, 13312
    s_add_u32 s48, s46, 0x1a0000
    buffer_load_dwordx4 v24, s[28:31], s48 offen lds
    s_add_u32 m0, s45, 14336
    s_add_u32 s48, s46, 0x1c0000
    buffer_load_dwordx4 v24, s[28:31], s48 offen lds
    s_add_u32 m0, s45, 15360
    s_add_u32 s48, s46, 0x1e0000
    buffer_load_dwordx4 v24, s[28:31], s48 offen lds
    s_add_u32 s45, s45, 0x10000
    s_waitcnt vmcnt(0)
    s_barrier
    s_cmp_lg_u32 s44, 0
    s_cbranch_scc1 L_zwok_174
    v_and_b32 v16, 7, v1
    v_lshlrev_b32 v16, 5, v16
    s_mov_b32 s70, 0
L_zw_173:
    buffer_load_dword v17, v16, s[16:19], 0 offen sc1
    s_waitcnt vmcnt(0)
    v_add_u32_dpp v17, v17, v17 row_ror:1 row_mask:0xf bank_mask:0xf
    s_nop 1
    v_add_u32_dpp v17, v17, v17 row_ror:2 row_mask:0xf bank_mask:0xf
    s_nop 1
    v_add_u32_dpp v17, v17, v17 row_ror:4 row_mask:0xf bank_mask:0xf
    v_cmp_ne_u32 vcc, 0x100, v17
    s_add_u32 s70, s70, 1
    s_cbranch_vccz L_zwok_174
    s_sleep 4
    s_cmp_lt_u32 s70, 524288
    s_cbranch_scc1 L_zw_173
    s_branch L_c_done_1
L_zwok_174:
    s_cmp_lg_u32 s44, 0
    s_cbranch_scc1 L_c_nr_175
    s_or_b32 s47, s39, 0x100
    v_mov_b32 v16, s47
    s_lshl_b32 s52, s40, 6
    s_lshl_b32 s53, s41, 2
    s_add_u32 s52, s52, s53
    s_add_u32 s52, s52, 0x101000
    v_mov_b32 v17, 0
    s_mov_b64 exec, 1
    buffer_store_dword v16, v17, s[12:15], s52 offen sc1
    s_mov_b64 exec, -1
L_c_nr_175:
    ds_read_b64_tr_b16 a[0:1], v20 offset:0
    ds_read_b64_tr_b16 a[2:3], v20 offset:256
    ds_read_b64_tr_b16 a[4:5], v20 offset:2048
    ds_read_b64_tr_b16 a[6:7], v20 offset:2304
    ds_read_b64_tr_b16 a[8:9], v20 offset:4096
    ds_read_b64_tr_b16 a[10:11], v20 offset:4352
    ds_read_b64_tr_b16 a[12:13], v20 offset:6144
    ds_read_b64_tr_b16 a[14:15], v20 offset:6400
    s_waitcnt lgkmcnt(0)
    ds_read_b64_tr_b16 a[16:17], v20 offset:8192
    ds_read_b64_tr_b16 a[18:19], v20 offset:8448
    ds_read_b64_tr_b16 a[20:21], v20 offset:10240
    ds_read_b64_tr_b16 a[22:23], v20 offset:10496
    ds_read_b64_tr_b16 a[24:25], v20 offset:12288
    ds_read_b64_tr_b16 a[26:27], v20 offset:12544
    ds_read_b64_tr_b16 a[28:29], v20 offset:14336
    ds_read_b64_tr_b16 a[30:31], v20 offset:14592
    s_waitcnt lgkmcnt(0)
    ds_read_b64_tr_b16 a[32:33], v20 offset:16384
    ds_read_b64_tr_b16 a[34:35], v20 offset:16640
    ds_read_b64_tr_b16 a[36:37], v20 offset:18432
    ds_read_b64_tr_b16 a[38:39], v20 offset:18688
    ds_read_b64_tr_b16 a[40:41], v20 offset:20480
    ds_read_b64_tr_b16 a[42:43], v20 offset:20736
    ds_read_b64_tr_b16 a[44:45], v20 offset:22528
    ds_read_b64_tr_b16 a[46:47], v20 offset:22784
    s_waitcnt lgkmcnt(0)
    ds_read_b64_tr_b16 a[48:49], v20 offset:24576
    ds_read_b64_tr_b16 a[50:51], v20 offset:24832
    ds_read_b64_tr_b16 a[52:53], v20 offset:26624
    ds_read_b64_tr_b16 a[54:55], v20 offset:26880
    ds_read_b64_tr_b16 a[56:57], v20 offset:28672
    ds_read_b64_tr_b16 a[58:59], v20 offset:28928
    ds_read_b64_tr_b16 a[60:61], v20 offset:30720
    ds_read_b64_tr_b16 a[62:63], v20 offset:30976
    s_waitcnt lgkmcnt(0)
    ds_read_b64_tr_b16 a[64:65], v20 offset:32768
    ds_read_b64_tr_b16 a[66:67], v20 offset:33024
    ds_read_b64_tr_b16 a[68:69], v20 offset:34816
    ds_read_b64_tr_b16 a[70:71], v20 offset:35072
    ds_read_b64_tr_b16 a[72:73], v20 offset:36864
    ds_read_b64_tr_b16 a[74:75], v20 offset:37120
    ds_read_b64_tr_b16 a[76:77], v20 offset:38912
    ds_read_b64_tr_b16 a[78:79], v20 offset:39168
    s_waitcnt lgkmcnt(0)
    ds_read_b64_tr_b16 a[80:81], v20 offset:40960
    ds_read_b64_tr_b16 a[82:83], v20 offset:41216
    ds_read_b64_tr_b16 a[84:85], v20 offset:43008
    ds_read_b64_tr_b16 a[86:87], v20 offset:43264
    ds_read_b64_tr_b16 a[88:89], v20 offset:45056
    ds_read_b64_tr_b16 a[90:91], v20 offset:45312
    ds_read_b64_tr_b16 a[92:93], v20 offset:47104
    ds_read_b64_tr_b16 a[94:95], v20 offset:47360
    s_waitcnt lgkmcnt(0)
    ds_read_b64_tr_b16 a[96:97], v20 offset:49152
    ds_read_b64_tr_b16 a[98:99], v20 offset:49408
    ds_read_b64_tr_b16 a[100:101], v20 offset:51200
    ds_read_b64_tr_b16 a[102:103], v20 offset:51456
    ds_read_b64_tr_b16 a[104:105], v20 offset:53248
    ds_read_b64_tr_b16 a[106:107], v20 offset:53504
    ds_read_b64_tr_b16 a[108:109], v20 offset:55296
    ds_read_b64_tr_b16 a[110:111], v20 offset:55552
    s_waitcnt lgkmcnt(0)
    ds_read_b64_tr_b16 a[112:113], v20 offset:57344
    ds_read_b64_tr_b16 a[114:115], v20 offset:57600
    ds_read_b64_tr_b16 a[116:117], v20 offset:59392
    ds_read_b64_tr_b16 a[118:119], v20 offset:59648
    ds_read_b64_tr_b16 a[120:121], v20 offset:61440
    ds_read_b64_tr_b16 a[122:123], v20 offset:61696
    ds_read_b64_tr_b16 a[124:125], v20 offset:63488
    ds_read_b64_tr_b16 a[126:127], v20 offset:63744
    s_waitcnt lgkmcnt(0)
    s_mov_b32 s63, 0
    s_barrier
    s_lshl_b32 s52, s40, 2
    s_add_u32 s52, s52, s44
    s_mul_i32 s52, s52, 24576
    s_lshl_b32 s53, s41, 9
    s_add_u32 s52, s52, s53
    s_add_u32 s52, s52, 0x2004000
    v_and_b32 v14, 3, v1
    v_lshlrev_b32 v14, 7, v14
    v_add_u32 v14, s52, v14
    s_lshl_b32 s52, s40, 16
    s_lshl_b32 s53, s41, 9
    s_add_u32 s53, s53, s52
    s_lshl_b32 s54, s44, 6
    s_add_u32 s53, s53, s54
    s_add_u32 s53, s53, 0x7080000
    v_lshlrev_b32 v4, 3, v106
    v_lshl_add_u32 v10, v102, 6, v4
    v_lshl_add_u32 v4, v101, 7, v4
    v_add_u32 v4, s53, v4
    v_mov_b32 v54, 0xfffefffe
    v_mov_b32 v56, 0
    v_mov_b32 v57, 0
    v_mov_b32 v58, 0
    v_mov_b32 v59, 0
    s_lshl_b32 s53, s41, 7
    s_add_u32 s53, s53, s52
    s_add_u32 s53, s53, 0x7180000
    v_add_u32 v10, s53, v10
    s_cmp_ge_u32 s44, 2
    s_cselect_b64 vcc, -1, 0
    v_cndmask_b32 v4, v4, v10, vcc
    s_mul_i32 s52, s49, 24576
    s_lshl_b32 s53, s44, 12
    s_add_u32 s52, s52, s53
    s_lshl_b32 s53, s43, 10
    s_add_u32 s52, s52, s53
    s_add_u32 s52, s52, 0x2002000
    v_add_u32 v6, s52, v2
    v_lshrrev_b32 v10, 3, v1
    v_lshlrev_b32 v10, 8, v10
    v_lshl_add_u32 v10, v106, 4, v10
    v_add_u32 v10, 61568, v10
    v_add_u32 v11, 27648, v2
    v_cmp_gt_u32 s[52:53], 32, v1
    s_nop 1
    v_cndmask_b32 v10, v11, v10, s[52:53]
    v_cndmask_b32 v6, v6, v10, vcc
    v_mov_b32 v24, -1
    v_mov_b32 v25, -1
    v_mov_b32 v26, -1
    v_mov_b32 v27, -1
    s_and_b32 s52, s40, 1
    s_lshl_b32 s52, s52, 14
    s_lshl_b32 s53, s41, 10
    s_add_u32 s52, s52, s53
    s_lshl_b32 s53, s50, 9
    s_add_u32 s52, s52, s53
    s_lshl_b32 s53, s51, 7
    s_add_u32 s52, s52, s53
    s_add_u32 s52, s52, 0x800000
    v_mov_b32 v46, s52
    v_add_u32 v44, 65536, v2
    s_lshl_b32 s52, s50, 10
    s_add_u32 s52, s52, 62464
    v_add_u32 v31, s52, v2
    s_lshl_b32 s53, s51, 9
    s_add_u32 s52, s52, s53
    v_lshlrev_b32 v45, 4, v100
    v_lshl_add_u32 v45, v103, 8, v45
    v_lshl_add_u32 v45, v102, 3, v45
    v_add_u32 v45, s52, v45
    s_mul_i32 s52, s49, 24576
    s_lshl_b32 s53, s50, 13
    s_add_u32 s52, s52, s53
    s_lshl_b32 s53, s43, 10
    s_add_u32 s52, s52, s53
    s_add_u32 s52, s52, 0x5000000
    v_add_u32 v13, s52, v2
    v_mov_b32 v29, 26644
    v_mov_b32 v30, 0
    ds_write_b32 v29, v30
    v_mov_b32 v30, 1
    s_lshl_b32 s58, s40, 11
    s_lshl_b32 s53, s44, 7
    s_add_u32 s58, s58, s53
    s_add_u32 s58, s58, 0x10a600
    s_mov_b32 s69, 0
    v_mov_b32 v0, 0
    s_cmp_ge_u32 s44, 2
    s_cselect_b32 s50, 0, 0x00ff00ff
    s_mov_b32 s51, 0x00ff00ff
    s_xor_b32 s45, s44, 2
    s_or_b32 s45, s45, s41
    s_cbranch_scc1 L_c_join_172_p
    s_lshl_b32 s45, s40, 21
    s_add_u32 s45, s45, 0x79c0000
    v_and_b32 v10, 31, v1
    v_lshlrev_b32 v10, 4, v10
    v_lshl_add_u32 v10, v103, 13, v10
    buffer_store_dwordx4 v[24:27], v10, s[12:15], s45 offen sc1
    s_add_u32 s46, s45, 0x1000
    s_load_dword s47, s[22:23], s46
    s_mov_b32 s60, -1
    s_mov_b32 s61, -1
    s_waitcnt vmcnt(0) lgkmcnt(0)
    s_add_u32 s46, s45, 0
    s_memtime s[84:85]
    s_waitcnt lgkmcnt(0)
    s_load_dword s47, s[22:23], s46
    s_waitcnt lgkmcnt(0)
    s_memtime s[86:87]
    s_waitcnt lgkmcnt(0)
    s_sub_u32 s86, s86, s84
    s_min_u32 s60, s60, s86
    s_add_u32 s46, s45, 8192
    s_memtime s[84:85]
    s_waitcnt lgkmcnt(0)
    s_load_dword s47, s[22:23], s46
    s_waitcnt lgkmcnt(0)
    s_memtime s[86:87]
    s_waitcnt lgkmcnt(0)
    s_sub_u32 s86, s86, s84
    s_min_u32 s61, s61, s86
    s_add_u32 s46, s45, 128
    s_memtime s[84:85]
    s_waitcnt lgkmcnt(0)
    s_load_dword s47, s[22:23], s46
    s_waitcnt lgkmcnt(0)
    s_memtime s[86:87]
    s_waitcnt lgkmcnt(0)
    s_sub_u32 s86, s86, s84
    s_min_u32 s60, s60, s86
    s_add_u32 s46, s45, 8320
    s_memtime s[84:85]
    s_waitcnt lgkmcnt(0)
    s_load_dword s47, s[22:23], s46
    s_waitcnt lgkmcnt(0)
    s_memtime s[86:87]
    s_waitcnt lgkmcnt(0)
    s_sub_u32 s86, s86, s84
    s_min_u32 s61, s61, s86
    s_add_u32 s46, s45, 256
    s_memtime s[84:85]
    s_waitcnt lgkmcnt(0)
    s_load_dword s47, s[22:23], s46
    s_waitcnt lgkmcnt(0)
    s_memtime s[86:87]
    s_waitcnt lgkmcnt(0)
    s_sub_u32 s86, s86, s84
    s_min_u32 s60, s60, s86
    s_add_u32 s46, s45, 8448
    s_memtime s[84:85]
    s_waitcnt lgkmcnt(0)
    s_load_dword s47, s[22:23], s46
    s_waitcnt lgkmcnt(0)
    s_memtime s[86:87]
    s_waitcnt lgkmcnt(0)
    s_sub_u32 s86, s86, s84
    s_min_u32 s61, s61, s86
    s_add_u32 s46, s45, 384
    s_memtime s[84:85]
    s_waitcnt lgkmcnt(0)
    s_load_dword s47, s[22:23], s46
    s_waitcnt lgkmcnt(0)
    s_memtime s[86:87]
    s_waitcnt lgkmcnt(0)
    s_sub_u32 s86, s86, s84
    s_min_u32 s60, s60, s86
    s_add_u32 s46, s45, 8576
    s_memtime s[84:85]
    s_waitcnt lgkmcnt(0)
    s_load_dword s47, s[22:23], s46
    s_waitcnt lgkmcnt(0)
    s_memtime s[86:87]
    s_waitcnt lgkmcnt(0)
    s_sub_u32 s86, s86, s84
    s_min_u32 s61, s61, s86
    s_cmp_gt_u32 s60, s61
    s_cselect_b32 s45, 3, 2
    v_mov_b32 v10, s45
    v_mov_b32 v11, 0
    s_lshl_b32 s45, s40, 7
    s_add_u32 s45, s45, 0x101800
    s_mov_b64 exec, 1
    buffer_store_dword v10, v11, s[12:15], s45 offen sc1
    s_mov_b64 exec, -1
L_c_join_172_p:
    s_setprio 1
    s_branch L_c_join_172
L_v_init_171:
    s_sub_u32 s54, s44, 4
    s_lshr_b32 s51, s54, 1
    s_and_b32 s50, s54, 1
    s_load_dwordx4 s[4:7], s[0:1], 32
    s_load_dwordx2 s[8:9], s[0:1], 8
    s_waitcnt lgkmcnt(0)
    s_mov_b32 s24, s4
    s_and_b32 s25, s5, 0xffff
    s_mov_b32 s26, 0x800000
    s_mov_b32 s27, 0x00020000
    s_mov_b32 s28, s6
    s_and_b32 s29, s7, 0xffff
    s_mov_b32 s30, 0x800000
    s_mov_b32 s31, 0x00020000
    s_mov_b32 s32, s8
    s_and_b32 s33, s9, 0xffff
    s_mov_b32 s34, 0x4000
    s_mov_b32 s35, 0x00020000
    s_lshl_b32 s45, s54, 12
    s_add_u32 s45, s45, 0x20000
    v_add_u32 v20, s45, v20
    v_add_u32 v21, s45, v21
    v_add_u32 v22, s45, v2
    s_lshl_b32 s46, s49, 8
    s_lshl_b32 s48, s43, 6
    s_add_u32 s46, s46, s48
    s_lshl_b32 s48, s54, 21
    s_add_u32 s46, s46, s48
    s_add_u32 s48, s46, 0x0
    buffer_load_dwordx4 a[0:3], v24, s[24:27], s48 offen
    s_add_u32 s48, s46, 0x20000
    buffer_load_dwordx4 a[32:35], v24, s[24:27], s48 offen
    s_add_u32 s48, s46, 0x40000
    buffer_load_dwordx4 a[4:7], v24, s[24:27], s48 offen
    s_add_u32 s48, s46, 0x60000
    buffer_load_dwordx4 a[36:39], v24, s[24:27], s48 offen
    s_add_u32 s48, s46, 0x80000
    buffer_load_dwordx4 a[8:11], v24, s[24:27], s48 offen
    s_add_u32 s48, s46, 0xa0000
    buffer_load_dwordx4 a[40:43], v24, s[24:27], s48 offen
    s_add_u32 s48, s46, 0xc0000
    buffer_load_dwordx4 a[12:15], v24, s[24:27], s48 offen
    s_add_u32 s48, s46, 0xe0000
    buffer_load_dwordx4 a[44:47], v24, s[24:27], s48 offen
    s_add_u32 s48, s46, 0x100000
    buffer_load_dwordx4 a[16:19], v24, s[24:27], s48 offen
    s_add_u32 s48, s46, 0x120000
    buffer_load_dwordx4 a[48:51], v24, s[24:27], s48 offen
    s_add_u32 s48, s46, 0x140000
    buffer_load_dwordx4 a[20:23], v24, s[24:27], s48 offen
    s_add_u32 s48, s46, 0x160000
    buffer_load_dwordx4 a[52:55], v24, s[24:27], s48 offen
    s_add_u32 s48, s46, 0x180000
    buffer_load_dwordx4 a[24:27], v24, s[24:27], s48 offen
    s_add_u32 s48, s46, 0x1a0000
    buffer_load_dwordx4 a[56:59], v24, s[24:27], s48 offen
    s_add_u32 s48, s46, 0x1c0000
    buffer_load_dwordx4 a[28:31], v24, s[24:27], s48 offen
    s_add_u32 s48, s46, 0x1e0000
    buffer_load_dwordx4 a[60:63], v24, s[24:27], s48 offen
    s_lshl_b32 s52, s40, 15
    s_lshl_b32 s53, s42, 11
    s_add_u32 s52, s52, s53
    s_lshl_b32 s53, s43, 9
    s_add_u32 s52, s52, s53
    s_lshl_b32 s53, s51, 8
    s_add_u32 s52, s52, s53
    s_add_u32 s52, s52, 0x7100000
    v_bfe_u32 v4, v1, 1, 1
    v_lshlrev_b32 v4, 7, v4
    v_lshl_add_u32 v4, v104, 4, v4
    v_and_b32 v5, 12, v100
    v_add_u32 v4, v4, v5
    v_add_u32 v4, s52, v4
    v_mov_b32 v26, -1
    s_lshl_b32 s52, s51, 5
    s_add_u32 s52, s52, 28160
    v_and_b32 v5, 14, v100
    v_lshlrev_b32 v5, 1, v5
    v_lshl_add_u32 v5, v104, 6, v5
    v_add_u32 v5, s52, v5
    s_lshl_b32 s52, s41, 14
    s_lshl_b32 s53, s54, 11
    s_add_u32 s52, s52, s53
    s_add_u32 s52, s52, 0x7800000
    v_lshlrev_b32 v6, 3, v101
    v_lshl_add_u32 v6, v106, 5, v6
    v_and_b32 v7, 3, v1
    v_lshlrev_b32 v7, 3, v7
    v_bfe_u32 v30, v1, 2, 3
    v_lshl_add_u32 v7, v30, 5, v7
    v_lshl_add_u32 v7, v103, 2, v7
    v_add_u32 v7, s52, v7
    s_lshl_b32 s53, s40, 8
    s_add_u32 s52, s52, s53
    v_add_u32 v6, s52, v6
    v_lshlrev_b32 v30, 4, v100
    v_lshl_add_u32 v30, v101, 18, v30
    v_add_u32 v30, s52, v30
    v_mov_b32 v32, -1
    v_mov_b32 v33, -1
    v_mov_b32 v34, -1
    v_mov_b32 v35, -1
    buffer_store_dwordx4 v[32:35], v30, s[12:15], 0 offen sc1
    s_mov_b32 s53, 8192
    buffer_store_dwordx4 v[32:35], v30, s[12:15], s53 offen sc1
    s_lshl_b32 s55, s40, 16
    s_add_u32 s55, s55, 0x7000000
    s_lshl_b32 s52, s41, 10
    s_lshl_b32 s53, s54, 8
    s_add_u32 s52, s52, s53
    s_add_u32 s52, s52, s55
    v_lshlrev_b32 v8, 2, v1
    v_add_u32 v8, s52, v8
    s_lshl_b32 s53, s54, 12
    v_add_u32 v10, s53, v2
    v_add_u32 v9, s55, v10
    s_lshl_b32 s52, s40, 15
    s_lshl_b32 s53, s54, 11
    s_add_u32 s52, s52, s53
    s_add_u32 s52, s52, 0x7100000
    v_add_u32 v11, s52, v2
    s_lshl_b32 s52, s54, 9
    s_add_u32 s52, s52, 53248
    v_lshlrev_b32 v12, 4, v100
    v_lshl_add_u32 v12, v102, 3, v12
    v_lshl_add_u32 v12, v103, 8, v12
    v_add_u32 v12, s52, v12
    s_lshl_b32 s52, s51, 3
    s_add_u32 s52, s52, 49152
    v_add_u32 v13, s52, v2
    s_lshl_b32 s52, s54, 10
    s_add_u32 s52, s52, 49152
    v_add_u32 v14, s52, v2
    s_lshl_b32 s52, s40, 2
    s_add_u32 s52, s52, s54
    s_mul_i32 s52, s52, 24576
    s_add_u32 s52, s52, 0x2004000
    v_add_u32 v15, s52, v2
    s_lshl_b32 s52, s54, 10
    v_add_u32 v27, s52, v2
    v_lshlrev_b32 v30, 11, v106
    v_lshl_add_u32 v30, v101, 5, v30
    v_lshl_add_u32 v30, v107, 2, v30
    s_lshl_b32 s52, s54, 9
    buffer_load_dword v112, v30, s[32:35], s52 offen offset:0
    buffer_load_dword v113, v30, s[32:35], s52 offen offset:8
    buffer_load_dword v114, v30, s[32:35], s52 offen offset:16
    buffer_load_dword v115, v30, s[32:35], s52 offen offset:24
    buffer_load_dword v116, v30, s[32:35], s52 offen offset:128
    buffer_load_dword v117, v30, s[32:35], s52 offen offset:136
    buffer_load_dword v118, v30, s[32:35], s52 offen offset:144
    buffer_load_dword v119, v30, s[32:35], s52 offen offset:152
    buffer_load_dword v120, v30, s[32:35], s52 offen offset:256
    buffer_load_dword v121, v30, s[32:35], s52 offen offset:264
    buffer_load_dword v122, v30, s[32:35], s52 offen offset:272
    buffer_load_dword v123, v30, s[32:35], s52 offen offset:280
    buffer_load_dword v124, v30, s[32:35], s52 offen offset:384
    buffer_load_dword v125, v30, s[32:35], s52 offen offset:392
    buffer_load_dword v126, v30, s[32:35], s52 offen offset:400
    buffer_load_dword v127, v30, s[32:35], s52 offen offset:408
    s_lshl_b32 s46, s40, 2
    s_add_u32 s46, s46, s54
    s_lshl_b32 s46, s46, 18
    s_lshl_b32 s48, s41, 7
    s_add_u32 s46, s46, s48
    s_add_u32 s48, s46, 0x0
    buffer_load_dwordx4 a[64:67], v25, s[28:31], s48 offen
    s_add_u32 s48, s46, 0x4000
    buffer_load_dwordx4 a[80:83], v25, s[28:31], s48 offen
    s_add_u32 s48, s46, 0x8000
    buffer_load_dwordx4 a[96:99], v25, s[28:31], s48 offen
    s_add_u32 s48, s46, 0xc000
    buffer_load_dwordx4 a[112:115], v25, s[28:31], s48 offen
    s_add_u32 s48, s46, 0x10000
    buffer_load_dwordx4 a[68:71], v25, s[28:31], s48 offen
    s_add_u32 s48, s46, 0x14000
    buffer_load_dwordx4 a[84:87], v25, s[28:31], s48 offen
    s_add_u32 s48, s46, 0x18000
    buffer_load_dwordx4 a[100:103], v25, s[28:31], s48 offen
    s_add_u32 s48, s46, 0x1c000
    buffer_load_dwordx4 a[116:119], v25, s[28:31], s48 offen
    s_add_u32 s48, s46, 0x20000
    buffer_load_dwordx4 a[72:75], v25, s[28:31], s48 offen
    s_add_u32 s48, s46, 0x24000
    buffer_load_dwordx4 a[88:91], v25, s[28:31], s48 offen
    s_add_u32 s48, s46, 0x28000
    buffer_load_dwordx4 a[104:107], v25, s[28:31], s48 offen
    s_add_u32 s48, s46, 0x2c000
    buffer_load_dwordx4 a[120:123], v25, s[28:31], s48 offen
    s_add_u32 s48, s46, 0x30000
    buffer_load_dwordx4 a[76:79], v25, s[28:31], s48 offen
    s_add_u32 s48, s46, 0x34000
    buffer_load_dwordx4 a[92:95], v25, s[28:31], s48 offen
    s_add_u32 s48, s46, 0x38000
    buffer_load_dwordx4 a[108:111], v25, s[28:31], s48 offen
    s_add_u32 s48, s46, 0x3c000
    buffer_load_dwordx4 a[124:127], v25, s[28:31], s48 offen
    s_waitcnt vmcnt(16)
    ds_write_b128 v22, a[0:3] offset:0
    ds_write_b128 v22, a[32:35] offset:1024
    ds_write_b128 v22, a[4:7] offset:2048
    ds_write_b128 v22, a[36:39] offset:3072
    s_waitcnt lgkmcnt(0)
    ds_read_b64_tr_b16 a[0:1], v20 offset:0
    ds_read_b64_tr_b16 a[2:3], v20 offset:256
    ds_read_b64_tr_b16 a[32:33], v20 offset:32
    ds_read_b64_tr_b16 a[34:35], v20 offset:288
    ds_read_b64_tr_b16 a[4:5], v20 offset:2048
    ds_read_b64_tr_b16 a[6:7], v20 offset:2304
    ds_read_b64_tr_b16 a[36:37], v20 offset:2080
    ds_read_b64_tr_b16 a[38:39], v20 offset:2336
    s_waitcnt lgkmcnt(0)
    ds_write_b128 v22, a[8:11] offset:0
    ds_write_b128 v22, a[40:43] offset:1024
    ds_write_b128 v22, a[12:15] offset:2048
    ds_write_b128 v22, a[44:47] offset:3072
    s_waitcnt lgkmcnt(0)
    ds_read_b64_tr_b16 a[8:9], v20 offset:0
    ds_read_b64_tr_b16 a[10:11], v20 offset:256
    ds_read_b64_tr_b16 a[40:41], v20 offset:32
    ds_read_b64_tr_b16 a[42:43], v20 offset:288
    ds_read_b64_tr_b16 a[12:13], v20 offset:2048
    ds_read_b64_tr_b16 a[14:15], v20 offset:2304
    ds_read_b64_tr_b16 a[44:45], v20 offset:2080
    ds_read_b64_tr_b16 a[46:47], v20 offset:2336
    s_waitcnt lgkmcnt(0)
    ds_write_b128 v22, a[16:19] offset:0
    ds_write_b128 v22, a[48:51] offset:1024
    ds_write_b128 v22, a[20:23] offset:2048
    ds_write_b128 v22, a[52:55] offset:3072
    s_waitcnt lgkmcnt(0)
    ds_read_b64_tr_b16 a[16:17], v20 offset:0
    ds_read_b64_tr_b16 a[18:19], v20 offset:256
    ds_read_b64_tr_b16 a[48:49], v20 offset:32
    ds_read_b64_tr_b16 a[50:51], v20 offset:288
    ds_read_b64_tr_b16 a[20:21], v20 offset:2048
    ds_read_b64_tr_b16 a[22:23], v20 offset:2304
    ds_read_b64_tr_b16 a[52:53], v20 offset:2080
    ds_read_b64_tr_b16 a[54:55], v20 offset:2336
    s_waitcnt lgkmcnt(0)
    ds_write_b128 v22, a[24:27] offset:0
    ds_write_b128 v22, a[56:59] offset:1024
    ds_write_b128 v22, a[28:31] offset:2048
    ds_write_b128 v22, a[60:63] offset:3072
    s_waitcnt lgkmcnt(0)
    ds_read_b64_tr_b16 a[24:25], v20 offset:0
    ds_read_b64_tr_b16 a[26:27], v20 offset:256
    ds_read_b64_tr_b16 a[56:57], v20 offset:32
    ds_read_b64_tr_b16 a[58:59], v20 offset:288
    ds_read_b64_tr_b16 a[28:29], v20 offset:2048
    ds_read_b64_tr_b16 a[30:31], v20 offset:2304
    ds_read_b64_tr_b16 a[60:61], v20 offset:2080
    ds_read_b64_tr_b16 a[62:63], v20 offset:2336
    s_waitcnt lgkmcnt(0)
    s_barrier
    s_waitcnt vmcnt(0)
    ds_write_b128 v22, a[64:67] offset:0
    ds_write_b128 v22, a[80:83] offset:1024
    ds_write_b128 v22, a[96:99] offset:2048
    ds_write_b128 v22, a[112:115] offset:3072
    s_waitcnt lgkmcnt(0)
    ds_read_b64_tr_b16 a[64:65], v21 offset:0
    ds_read_b64_tr_b16 a[66:67], v21 offset:512
    ds_read_b64_tr_b16 a[80:81], v21 offset:32
    ds_read_b64_tr_b16 a[82:83], v21 offset:544
    ds_read_b64_tr_b16 a[96:97], v21 offset:64
    ds_read_b64_tr_b16 a[98:99], v21 offset:576
    ds_read_b64_tr_b16 a[112:113], v21 offset:96
    ds_read_b64_tr_b16 a[114:115], v21 offset:608
    s_waitcnt lgkmcnt(0)
    ds_write_b128 v22, a[68:71] offset:0
    ds_write_b128 v22, a[84:87] offset:1024
    ds_write_b128 v22, a[100:103] offset:2048
    ds_write_b128 v22, a[116:119] offset:3072
    s_waitcnt lgkmcnt(0)
    ds_read_b64_tr_b16 a[68:69], v21 offset:0
    ds_read_b64_tr_b16 a[70:71], v21 offset:512
    ds_read_b64_tr_b16 a[84:85], v21 offset:32
    ds_read_b64_tr_b16 a[86:87], v21 offset:544
    ds_read_b64_tr_b16 a[100:101], v21 offset:64
    ds_read_b64_tr_b16 a[102:103], v21 offset:576
    ds_read_b64_tr_b16 a[116:117], v21 offset:96
    ds_read_b64_tr_b16 a[118:119], v21 offset:608
    s_waitcnt lgkmcnt(0)
    ds_write_b128 v22, a[72:75] offset:0
    ds_write_b128 v22, a[88:91] offset:1024
    ds_write_b128 v22, a[104:107] offset:2048
    ds_write_b128 v22, a[120:123] offset:3072
    s_waitcnt lgkmcnt(0)
    ds_read_b64_tr_b16 a[72:73], v21 offset:0
    ds_read_b64_tr_b16 a[74:75], v21 offset:512
    ds_read_b64_tr_b16 a[88:89], v21 offset:32
    ds_read_b64_tr_b16 a[90:91], v21 offset:544
    ds_read_b64_tr_b16 a[104:105], v21 offset:64
    ds_read_b64_tr_b16 a[106:107], v21 offset:576
    ds_read_b64_tr_b16 a[120:121], v21 offset:96
    ds_read_b64_tr_b16 a[122:123], v21 offset:608
    s_waitcnt lgkmcnt(0)
    ds_write_b128 v22, a[76:79] offset:0
    ds_write_b128 v22, a[92:95] offset:1024
    ds_write_b128 v22, a[108:111] offset:2048
    ds_write_b128 v22, a[124:127] offset:3072
    s_waitcnt lgkmcnt(0)
    ds_read_b64_tr_b16 a[76:77], v21 offset:0
    ds_read_b64_tr_b16 a[78:79], v21 offset:512
    ds_read_b64_tr_b16 a[92:93], v21 offset:32
    ds_read_b64_tr_b16 a[94:95], v21 offset:544
    ds_read_b64_tr_b16 a[108:109], v21 offset:64
    ds_read_b64_tr_b16 a[110:111], v21 offset:576
    ds_read_b64_tr_b16 a[124:125], v21 offset:96
    ds_read_b64_tr_b16 a[126:127], v21 offset:608
    s_waitcnt lgkmcnt(0)
    s_mov_b32 s65, 0
    s_waitcnt vmcnt(0)
    s_barrier
    s_lshl_b32 s57, s40, 11
    s_lshl_b32 s53, s54, 7
    s_add_u32 s57, s57, s53
    s_add_u32 s57, s57, 0x10a600
    s_mov_b32 s69, 0
    s_mov_b32 s68, 0
    s_cmp_gt_u32 s69, s68
    s_cbranch_scc1 L_kv_ok_177
    s_mov_b32 s70, 0
L_kv_lp_176:
    v_and_b32 v22, 1, v1
    v_lshlrev_b32 v22, 9, v22
    buffer_load_dword v23, v22, s[12:15], s57 offen sc1
    s_waitcnt vmcnt(0)
    v_readlane_b32 s69, v23, 0
    v_readlane_b32 s45, v23, 1
    s_add_u32 s70, s70, 1
    s_nop 2
    s_min_u32 s69, s69, s45
    s_cmp_gt_u32 s69, s68
    s_cbranch_scc1 L_kv_ok_177
    s_sleep 4
    s_cmp_lt_u32 s70, 524288
    s_cbranch_scc1 L_kv_lp_176
    s_branch L_c_done_1
L_kv_ok_177:
    v_lshlrev_b32 v28, 9, v101
    v_lshl_add_u32 v28, v100, 4, v28
    s_lshl_b32 s52, s54, 13
    s_add_u32 s52, s52, 0x800000
    v_add_u32 v28, s52, v28
    s_lshl_b32 s59, s54, 12
    s_add_u32 s59, s59, 65536
    v_lshlrev_b32 v31, 4, v100
    v_lshl_add_u32 v31, v103, 8, v31
    v_add_u32 v31, 20480, v31
    s_lshl_b32 s52, s54, 11
    s_add_u32 s52, s52, 53248
    v_add_u32 v25, s52, v2
    v_mov_b32 v29, 26640
    v_mov_b32 v30, 0
    ds_write_b32 v29, v30
    v_mov_b32 v30, 1
    s_mov_b32 s58, 0
    s_mov_b32 s64, 0
    s_add_u32 s46, s65, 4096
    buffer_load_dwordx4 v[32:35], v15, s[12:15], s65 offen offset:0 sc1
    buffer_load_dwordx4 v[48:51], v15, s[12:15], s46 offen offset:0 sc1
    buffer_load_dwordx4 v[36:39], v15, s[12:15], s65 offen offset:1024 sc1
    buffer_load_dwordx4 v[52:55], v15, s[12:15], s46 offen offset:1024 sc1
    buffer_load_dwordx4 v[40:43], v15, s[12:15], s65 offen offset:2048 sc1
    buffer_load_dwordx4 v[56:59], v15, s[12:15], s46 offen offset:2048 sc1
    buffer_load_dwordx4 v[44:47], v15, s[12:15], s65 offen offset:3072 sc1
    buffer_load_dwordx4 v[60:63], v15, s[12:15], s46 offen offset:3072 sc1
    s_add_u32 s65, s65, 786432
    s_waitcnt vmcnt(0)
    v_mfma_f32_16x16x32_bf16 v[64:67], v[32:35], a[64:67], 0
    v_mfma_f32_16x16x32_bf16 v[68:71], v[48:51], a[64:67], 0
    v_mfma_f32_16x16x32_bf16 v[64:67], v[36:39], a[68:71], v[64:67]
    v_mfma_f32_16x16x32_bf16 v[68:71], v[52:55], a[68:71], v[68:71]
    v_mfma_f32_16x16x32_bf16 v[64:67], v[40:43], a[72:75], v[64:67]
    v_mfma_f32_16x16x32_bf16 v[68:71], v[56:59], a[72:75], v[68:71]
    v_mfma_f32_16x16x32_bf16 v[64:67], v[44:47], a[76:79], v[64:67]
    v_mfma_f32_16x16x32_bf16 v[68:71], v[60:63], a[76:79], v[68:71]
    v_mfma_f32_16x16x32_bf16 v[72:75], v[32:35], a[80:83], 0
    v_mfma_f32_16x16x32_bf16 v[76:79], v[48:51], a[80:83], 0
    v_mfma_f32_16x16x32_bf16 v[72:75], v[36:39], a[84:87], v[72:75]
    v_mfma_f32_16x16x32_bf16 v[76:79], v[52:55], a[84:87], v[76:79]
    v_mfma_f32_16x16x32_bf16 v[72:75], v[40:43], a[88:91], v[72:75]
    v_mfma_f32_16x16x32_bf16 v[76:79], v[56:59], a[88:91], v[76:79]
    v_mfma_f32_16x16x32_bf16 v[72:75], v[44:47], a[92:95], v[72:75]
    v_mfma_f32_16x16x32_bf16 v[76:79], v[60:63], a[92:95], v[76:79]
    v_cvt_pk_bf16_f32 v64, v64, v65
    v_cvt_pk_bf16_f32 v65, v66, v67
    v_cvt_pk_bf16_f32 v66, v68, v69
    v_cvt_pk_bf16_f32 v67, v70, v71
    ds_write_b128 v10, v[64:67] offset:32768
    v_mfma_f32_16x16x32_bf16 v[80:83], v[32:35], a[96:99], 0
    v_mfma_f32_16x16x32_bf16 v[84:87], v[48:51], a[96:99], 0
    v_mfma_f32_16x16x32_bf16 v[80:83], v[36:39], a[100:103], v[80:83]
    v_mfma_f32_16x16x32_bf16 v[84:87], v[52:55], a[100:103], v[84:87]
    v_mfma_f32_16x16x32_bf16 v[80:83], v[40:43], a[104:107], v[80:83]
    v_mfma_f32_16x16x32_bf16 v[84:87], v[56:59], a[104:107], v[84:87]
    v_mfma_f32_16x16x32_bf16 v[80:83], v[44:47], a[108:111], v[80:83]
    v_mfma_f32_16x16x32_bf16 v[84:87], v[60:63], a[108:111], v[84:87]
    v_cvt_pk_bf16_f32 v72, v72, v73
    v_cvt_pk_bf16_f32 v73, v74, v75
    v_cvt_pk_bf16_f32 v74, v76, v77
    v_cvt_pk_bf16_f32 v75, v78, v79
    ds_write_b128 v10, v[72:75] offset:33792
    v_mfma_f32_16x16x32_bf16 v[88:91], v[32:35], a[112:115], 0
    v_mfma_f32_16x16x32_bf16 v[92:95], v[48:51], a[112:115], 0
    v_mfma_f32_16x16x32_bf16 v[88:91], v[36:39], a[116:119], v[88:91]
    v_mfma_f32_16x16x32_bf16 v[92:95], v[52:55], a[116:119], v[92:95]
    v_mfma_f32_16x16x32_bf16 v[88:91], v[40:43], a[120:123], v[88:91]
    v_mfma_f32_16x16x32_bf16 v[92:95], v[56:59], a[120:123], v[92:95]
    v_mfma_f32_16x16x32_bf16 v[88:91], v[44:47], a[124:127], v[88:91]
    v_mfma_f32_16x16x32_bf16 v[92:95], v[60:63], a[124:127], v[92:95]
    v_cvt_pk_bf16_f32 v80, v80, v81
    v_cvt_pk_bf16_f32 v81, v82, v83
    v_cvt_pk_bf16_f32 v82, v84, v85
    v_cvt_pk_bf16_f32 v83, v86, v87
    ds_write_b128 v10, v[80:83] offset:34816
    s_nop 2
    v_cvt_pk_bf16_f32 v88, v88, v89
    v_cvt_pk_bf16_f32 v89, v90, v91
    v_cvt_pk_bf16_f32 v90, v92, v93
    v_cvt_pk_bf16_f32 v91, v94, v95
    ds_write_b128 v10, v[88:91] offset:35840
    s_mov_b64 s[66:67], 0
    s_mov_b32 s63, 0
    s_mov_b32 s68, 1
    s_cmp_gt_u32 s69, s68
    s_cbranch_scc1 L_kv_ok_179
    s_mov_b32 s70, 0
L_kv_lp_178:
    v_and_b32 v22, 1, v1
    v_lshlrev_b32 v22, 9, v22
    buffer_load_dword v23, v22, s[12:15], s57 offen sc1
    s_waitcnt vmcnt(0)
    v_readlane_b32 s69, v23, 0
    v_readlane_b32 s45, v23, 1
    s_add_u32 s70, s70, 1
    s_nop 2
    s_min_u32 s69, s69, s45
    s_cmp_gt_u32 s69, s68
    s_cbranch_scc1 L_kv_ok_179
    s_sleep 4
    s_cmp_lt_u32 s70, 524288
    s_cbranch_scc1 L_kv_lp_178
    s_branch L_c_done_1
L_kv_ok_179:
    v_lshrrev_b32 v22, 3, v1
    v_lshlrev_b32 v22, 7, v22
    s_mov_b32 s45, 0x101800
    s_mov_b32 s46, 0
    s_mov_b32 s70, 0
L_spin_180:
    buffer_load_dword v23, v22, s[12:15], s45 offen sc1
    s_waitcnt vmcnt(0)
    v_cmp_ge_u32 vcc, s46, v23
    s_add_u32 s70, s70, 1
    s_cbranch_vccz L_spok_181
    s_sleep 3
    s_cmp_lt_u32 s70, 524288
    s_cbranch_scc1 L_spin_180
    s_branch L_c_done_1
L_spok_181:
    v_cmp_eq_u32 s[66:67], 3, v23
    s_nop 3
    s_bitcmp1_b32 s66, 0
    s_cselect_b32 s63, 8192, 0
    s_waitcnt lgkmcnt(0)
    v_min_u32 v64, -2, v112
    v_min_u32 v65, -2, v113
    v_min_u32 v66, -2, v114
    v_min_u32 v67, -2, v115
    v_min_u32 v68, -2, v116
    v_min_u32 v69, -2, v117
    v_min_u32 v70, -2, v118
    v_min_u32 v71, -2, v119
    v_min_u32 v72, -2, v120
    v_min_u32 v73, -2, v121
    v_min_u32 v74, -2, v122
    v_min_u32 v75, -2, v123
    v_min_u32 v76, -2, v124
    v_min_u32 v77, -2, v125
    v_min_u32 v78, -2, v126
    v_min_u32 v79, -2, v127
    v_mov_b32 v16, 0
    v_mov_b32 v17, 0
    v_mov_b32 v18, 0
    v_mov_b32 v19, 0
    v_mov_b32 v20, 0
    v_mov_b32 v21, 0
    v_mov_b32 v22, 0
    v_mov_b32 v23, 0
L_c_join_172:
    s_mov_b32 s60, 0
    s_mov_b32 s61, 0
    s_mov_b32 s62, 0
    s_cmp_lg_u32 s44, 0
    s_cbranch_scc1 L_c_nh_182
    v_lshlrev_b32 v17, 3, v1
    s_lshl_b32 s46, s40, 3
    v_mov_b32 v21, s46
    s_mov_b32 s45, 0x101000
    s_mov_b32 s70, 0
L_c_rp_183:
    buffer_load_dwordx2 v[18:19], v17, s[12:15], s45 offen sc1
    buffer_load_dwordx2 v[22:23], v21, s[12:15], s45 offen offset:512 sc1
    s_waitcnt vmcnt(0)
    v_min3_u32 v20, v18, v19, v22
    v_min_u32 v20, v20, v23
    v_cmp_eq_u32 vcc, 0, v20
    s_cbranch_vccnz L_rt_184
    v_cmp_eq_u32 s[52:53], v18, v16
    v_cmp_eq_u32 vcc, v19, v16
    v_cmp_eq_u32 s[54:55], v22, v16
    v_cmp_eq_u32 s[56:57], v23, v16
    s_lshl_b32 s46, s40, 3
    s_nop 3
    s_and_b64 s[52:53], s[52:53], vcc
    s_lshr_b64 s[52:53], s[52:53], s46
    s_and_b32 s52, s52, 0xff
    s_cmp_eq_u32 s52, 0xff
    s_cselect_b32 s52, 1, 0
    v_mov_b32 v16, s52
    v_mov_b32 v17, 26624
    ds_write_b32 v17, v16
L_c_nh_182:
    s_waitcnt lgkmcnt(0)
    s_barrier
    v_mov_b32 v17, 26624
    ds_read_b32 v16, v17
    s_waitcnt lgkmcnt(0)
    v_readfirstlane_b32 s52, v16
    s_nop 3
    s_cmp_ge_u32 s44, 4
    s_cbranch_scc1 L_vf_187
    s_mov_b32 s57, s58
    s_mov_b32 s58, 0
    s_cmp_ge_u32 s44, 2
    s_cbranch_scc1 L_sf_185
    buffer_load_dwordx4 v[32:35], v6, s[12:15], 0 offen sc1
L_sf_185:
    s_mov_b32 s54, s52
    v_add_u32 v52, 786432, v6
    s_mul_i32 s53, s49, 24576
    s_lshl_b32 s55, s43, 11
    s_add_u32 s53, s53, s55
    s_and_b32 s55, s44, 1
    s_lshl_b32 s55, s55, 10
    s_add_u32 s53, s53, s55
    s_add_u32 s53, s53, 0x2184000
    v_and_b32 v53, 7, v1
    v_lshlrev_b32 v53, 7, v53
    v_add_u32 v53, s53, v53
    s_cmp_ge_u32 s44, 2
    s_cselect_b64 vcc, -1, 0
    s_cselect_b64 s[52:53], 0xff, -1
    v_cndmask_b32 v52, v52, v53, vcc
    s_cselect_b32 s55, 786432, 0
    v_readfirstlane_b32 s56, v52
    s_nop 3
    s_sub_u32 s56, s56, s55
    s_cmp_eq_u32 s54, 0
    s_cbranch_scc1 L_ss_186
.p2align 6
L_s_loop_189:
    v_mov_b32 v16, 0
    v_mov_b32 v17, 0
    v_mov_b32 v18, 0
    v_mov_b32 v19, 0
    s_add_u32 s58, s58, 4
    s_mov_b32 s70, 1
    s_waitcnt vmcnt(0) lgkmcnt(0)
    s_barrier
    ds_read_b128 v[64:67], v2 offset:0
    ds_read_b128 v[68:71], v2 offset:1024
    ds_read_b128 v[72:75], v2 offset:2048
    ds_read_b128 v[76:79], v2 offset:3072
    ds_read_b128 v[80:83], v2 offset:4096
    ds_read_b128 v[84:87], v2 offset:5120
    ds_read_b128 v[88:91], v2 offset:6144
    ds_read_b128 v[92:95], v2 offset:7168
    ds_read_b128 v[96:99], v2 offset:8192
    ds_read_b128 v[100:103], v2 offset:9216
    ds_read_b128 v[104:107], v2 offset:10240
    ds_read_b128 v[108:111], v2 offset:11264
    s_waitcnt lgkmcnt(11)
    v_smfmac_f32_16x16x64_bf16 v[16:19], v[64:67], a[0:7], v3
    ds_read_b128 v[112:115], v2 offset:12288
    s_waitcnt lgkmcnt(11)
    v_smfmac_f32_16x16x64_bf16 v[16:19], v[68:71], a[8:15], v3
    ds_read_b128 v[116:119], v2 offset:13312
    s_waitcnt lgkmcnt(11)
    v_smfmac_f32_16x16x64_bf16 v[16:19], v[72:75], a[16:23], v3
    ds_read_b128 v[120:123], v2 offset:14336
    s_waitcnt lgkmcnt(11)
    v_smfmac_f32_16x16x64_bf16 v[16:19], v[76:79], a[24:31], v3
    ds_read_b128 v[124:127], v2 offset:15360
    s_waitcnt lgkmcnt(11)
    v_smfmac_f32_16x16x64_bf16 v[16:19], v[80:83], a[32:39], v3
    s_waitcnt lgkmcnt(10)
    v_smfmac_f32_16x16x64_bf16 v[16:19], v[84:87], a[40:47], v3
    s_waitcnt lgkmcnt(9)
    v_smfmac_f32_16x16x64_bf16 v[16:19], v[88:91], a[48:55], v3
    s_waitcnt lgkmcnt(8)
    v_smfmac_f32_16x16x64_bf16 v[16:19], v[92:95], a[56:63], v3
    s_waitcnt lgkmcnt(7)
    v_smfmac_f32_16x16x64_bf16 v[16:19], v[96:99], a[64:71], v3
    s_waitcnt lgkmcnt(6)
    v_smfmac_f32_16x16x64_bf16 v[16:19], v[100:103], a[72:79], v3
    s_waitcnt lgkmcnt(5)
    v_smfmac_f32_16x16x64_bf16 v[16:19], v[104:107], a[80:87], v3
    s_waitcnt lgkmcnt(4)
    v_smfmac_f32_16x16x64_bf16 v[16:19], v[108:111], a[88:95], v3
    s_waitcnt lgkmcnt(3)
    v_smfmac_f32_16x16x64_bf16 v[16:19], v[112:115], a[96:103], v3
    s_waitcnt lgkmcnt(2)
    v_smfmac_f32_16x16x64_bf16 v[16:19], v[116:119], a[104:111], v3
    s_waitcnt lgkmcnt(1)
    v_smfmac_f32_16x16x64_bf16 v[16:19], v[120:123], a[112:119], v3
    s_waitcnt lgkmcnt(0)
    v_smfmac_f32_16x16x64_bf16 v[16:19], v[124:127], a[120:127], v3
    s_nop 7
    v_permlane32_swap_b32 v16, v18
    v_permlane32_swap_b32 v17, v19
    v_add_f32 v16, v16, v18
    v_add_f32 v17, v17, v19
    v_cvt_pk_bf16_f32 v16, v16, v17
    ds_write_b16 v5, v16
    ds_write_b16_d16_hi v5, v16 offset:16
    s_mov_b64 exec, 1
    ds_add_u32 v29, v30
    s_mov_b64 exec, -1
L_s_xl_191:
    ds_read_b32 v10, v29
    ds_read_b128 v[64:67], v2 offset:61440
    s_cmp_eq_u32 s60, 63
    s_cbranch_scc1 L_s_last_190
    s_cmp_ge_u32 s44, 2
    s_cbranch_scc1 L_s_w2_192
    s_waitcnt lgkmcnt(0)
    v_mfma_f32_16x16x32_bf16 v[16:19], v[32:35], v[64:67], 0
L_s_w2_192_b:
    v_cmp_ne_u32 vcc, s58, v10
    s_nop 0
    s_cbranch_vccnz L_rt_194
    s_mov_b64 exec, s[50:51]
    s_nop 3
    v_cvt_pk_bf16_f32 v16, v16, v17
    v_cvt_pk_bf16_f32 v17, v18, v19
    v_pk_min_u16 v16, v16, v54
    v_pk_min_u16 v17, v17, v54
    buffer_store_dwordx2 v[16:17], v4, s[12:15], s61 offen
    s_mov_b64 exec, -1
L_s_w3_193_b:
    s_sleep 5
    s_mov_b32 s70, 1
L_s_xp_195:
    buffer_load_dwordx2 v[64:65], v7, s[12:15], s61 offen offset:0 sc1
    buffer_load_short_d16_hi v56, v28, s[12:15], s61 offen offset:0 sc1
    buffer_load_dwordx2 v[66:67], v7, s[12:15], s61 offen offset:512 sc1
    buffer_load_short_d16_hi v57, v28, s[12:15], s61 offen offset:128 sc1
    buffer_load_dwordx2 v[68:69], v7, s[12:15], s61 offen offset:1024 sc1
    buffer_load_short_d16_hi v58, v28, s[12:15], s61 offen offset:256 sc1
    buffer_load_dwordx2 v[70:71], v7, s[12:15], s61 offen offset:1536 sc1
    buffer_load_short_d16_hi v59, v28, s[12:15], s61 offen offset:384 sc1
    s_mov_b32 s46, 0x00003f80
    s_mov_b32 s47, 0x3f800000
    s_waitcnt vmcnt(6)
    v_dot2_f32_bf16 v16, v64, s46, 0
    v_dot2_f32_bf16 v17, v64, s47, 0
    v_dot2_f32_bf16 v18, v65, s46, 0
    v_dot2_f32_bf16 v19, v65, s47, 0
    s_waitcnt vmcnt(4)
    v_dot2_f32_bf16 v16, v66, s46, v16
    v_dot2_f32_bf16 v17, v66, s47, v17
    v_dot2_f32_bf16 v18, v67, s46, v18
    v_dot2_f32_bf16 v19, v67, s47, v19
    v_add_f32 v20, v56, v57
    s_waitcnt vmcnt(2)
    v_dot2_f32_bf16 v16, v68, s46, v16
    v_dot2_f32_bf16 v17, v68, s47, v17
    v_dot2_f32_bf16 v18, v69, s46, v18
    v_dot2_f32_bf16 v19, v69, s47, v19
    v_add_f32 v20, v20, v58
    s_waitcnt vmcnt(0)
    v_dot2_f32_bf16 v16, v70, s46, v16
    v_dot2_f32_bf16 v17, v70, s47, v17
    v_dot2_f32_bf16 v18, v71, s46, v18
    v_dot2_f32_bf16 v19, v71, s47, v19
    v_add_f32 v20, v20, v59
    s_nop 0
    v_cmp_u_f32 s[46:47], v16, v17
    v_cmp_u_f32 s[48:49], v18, v19
    v_cmp_u_f32 vcc, v20, v20
    v_max3_f32 v10, v16, v17, v18
    s_or_b64 s[46:47], s[46:47], s[48:49]
    v_max3_f32 v10, v10, v19, v20
    s_or_b64 vcc, vcc, s[46:47]
    s_cbranch_scc1 L_s_xf_196
L_s_xok_197:
    v_max_f32_dpp v11, v10, v10 row_ror:8 row_mask:0xf bank_mask:0xf
    v_max_f32_dpp v10, v10, v10 row_ror:8 row_mask:0xf bank_mask:0xf
    s_nop 1
    v_permlane16_swap_b32 v10, v11
    v_max_f32 v12, v10, v11
    v_max_f32 v10, v10, v11
    s_nop 1
    v_permlane32_swap_b32 v10, v12
    v_max_f32 v10, v10, v12
    v_mul_f32 v10, s66, v10
    v_fma_f32 v16, v16, s66, -v10
    v_fma_f32 v17, v17, s66, -v10
    v_fma_f32 v18, v18, s66, -v10
    v_fma_f32 v19, v19, s66, -v10
    v_fma_f32 v20, v20, s66, -v10
    v_exp_f32 v16, v16
    v_exp_f32 v17, v17
    v_exp_f32 v18, v18
    v_exp_f32 v19, v19
    v_exp_f32 v20, v20
    v_add_f32 v10, v16, v17
    v_add_f32 v11, v18, v19
    v_add_f32 v10, v10, v20
    v_add_f32 v10, v10, v11
    s_nop 1
    v_add_f32_dpp v11, v10, v10 row_ror:8 row_mask:0xf bank_mask:0xf
    v_add_f32_dpp v10, v10, v10 row_ror:8 row_mask:0xf bank_mask:0xf
    s_nop 1
    v_permlane16_swap_b32 v10, v11
    v_add_f32 v12, v10, v11
    v_add_f32 v10, v10, v11
    s_nop 1
    v_permlane32_swap_b32 v10, v12
    v_add_f32 v10, v10, v12
    v_rcp_f32 v10, v10
    s_nop 0
    v_mul_f32 v16, v16, v10
    v_mul_f32 v17, v17, v10
    v_mul_f32 v18, v18, v10
    v_mul_f32 v19, v19, v10
    v_mul_f32 v20, v20, v10
    v_cvt_pk_bf16_f32 v16, v16, v17
    v_cvt_pk_bf16_f32 v17, v18, v19
    v_cvt_pk_bf16_f32 v18, v20, v20
    ds_write_b64 v8, v[16:17]
    ds_write_b16 v9, v18
    s_waitcnt lgkmcnt(0)
    s_barrier
    s_add_u32 s63, s63, 786432
    s_cmp_ge_u32 s44, 2
    s_cbranch_scc1 L_s_nk_198
    buffer_load_dwordx4 v[32:35], v6, s[12:15], s63 offen sc1
L_s_nk_198:
    s_add_u32 s45, s60, 2
    s_cmp_le_u32 s69, s45
    s_cbranch_scc1 L_s_nk_198_w
    s_add_u32 s45, s63, 786432
    s_mov_b64 exec, 0xf
    buffer_load_dword v15, v14, s[12:15], s45 offen sc1
    s_mov_b64 exec, -1
L_s_nk_198_w:
    s_cmp_eq_u32 s44, 3
    s_cbranch_scc1 L_s_nr_199
    s_xor_b32 s45, s61, 0x8000
    s_mov_b64 exec, s[50:51]
    buffer_store_dwordx2 v[24:25], v4, s[12:15], s45 offen
    s_mov_b64 exec, -1
L_s_nr_199:
    s_cmp_lg_u32 s44, 3
    s_cbranch_scc1 L_s_np_200
    ds_read_b128 v[20:23], v6
    s_lshl_b32 s45, s60, 17
    s_add_u32 s45, s45, s67
    s_waitcnt lgkmcnt(0)
    v_min_u32 v20, -2, v20
    v_min_u32 v21, -2, v21
    v_min_u32 v22, -2, v22
    v_min_u32 v23, -2, v23
    buffer_store_dwordx4 v[20:23], v2, s[12:15], s45 offen sc1
L_s_np_200:
    s_add_u32 s68, s60, 2
    s_min_u32 s68, s68, 63
    v_readlane_b32 s45, v0, 0
    v_readlane_b32 s46, v0, 1
    s_nop 0
    s_min_u32 s45, s45, s46
    s_max_u32 s69, s69, s45
    s_cmp_gt_u32 s69, s68
    s_cbranch_scc1 L_kv_ok_203
    s_mov_b32 s70, 0
L_kv_lp_202:
    v_and_b32 v22, 1, v1
    v_lshlrev_b32 v22, 9, v22
    buffer_load_dword v23, v22, s[12:15], s57 offen sc1
    s_waitcnt vmcnt(0)
    v_readlane_b32 s69, v23, 0
    v_readlane_b32 s45, v23, 1
    s_add_u32 s70, s70, 1
    s_nop 2
    s_min_u32 s69, s69, s45
    s_cmp_gt_u32 s69, s68
    s_cbranch_scc1 L_kv_ok_203
    s_sleep 4
    s_cmp_lt_u32 s70, 524288
    s_cbranch_scc1 L_kv_lp_202
    s_branch L_c_done_1
L_kv_ok_203:
    s_add_u32 s45, s60, 7
    s_min_u32 s45, s45, 63
    s_cmp_gt_u32 s69, s45
    s_cbranch_scc1 L_s_na_201
    v_and_b32 v22, 1, v1
    v_lshlrev_b32 v22, 9, v22
    buffer_load_dword v0, v22, s[12:15], s57 offen sc1
L_s_na_201:
    s_add_u32 s60, s60, 1
    s_add_u32 s61, s61, 0x4000
    s_and_b32 s61, s61, 0xffff
    s_branch L_s_loop_189
L_s_last_190:
    s_waitcnt lgkmcnt(0)
    s_barrier
    s_cmp_lg_u32 s44, 3
    s_cbranch_scc1 L_s_np_204
    ds_read_b128 v[20:23], v6
    s_lshl_b32 s45, s60, 17
    s_add_u32 s45, s45, s67
    s_waitcnt lgkmcnt(0)
    v_min_u32 v20, -2, v20
    v_min_u32 v21, -2, v21
    v_min_u32 v22, -2, v22
    v_min_u32 v23, -2, v23
    buffer_store_dwordx4 v[20:23], v2, s[12:15], s45 offen sc1
L_s_np_204:
    s_branch L_replica
L_rt_184:
    s_add_u32 s70, s70, 1
    s_cmp_lt_u32 s70, 524288
    s_cbranch_scc1 L_c_rp_183
    s_branch L_c_done_1
L_rt_194:
    s_add_u32 s70, s70, 1
    s_cmp_lt_u32 s70, 524288
    s_cbranch_scc1 L_s_xl_191
    s_branch L_c_done_1
L_s_w2_192:
    s_cmp_eq_u32 s44, 3
    s_cbranch_scc1 L_s_w3_193
    s_waitcnt lgkmcnt(0)
    v_mfma_f32_16x16x32_bf16 v[16:19], v[64:67], v[64:67], 0
    s_branch L_s_w2_192_b
L_s_w3_193:
    s_sleep 3
    s_branch L_s_w3_193_b
L_s_xf_196:
    v_or_b32 v72, 0xffff, v56
    v_or_b32 v73, 0xffff, v57
    v_or_b32 v74, 0xffff, v58
    v_or_b32 v75, 0xffff, v59
    v_max3_u32 v11, v64, v65, v66
    v_max3_u32 v11, v11, v67, v68
    v_max3_u32 v11, v11, v69, v70
    v_max3_u32 v11, v11, v71, v72
    v_max3_u32 v11, v11, v73, v74
    v_max_u32 v11, v11, v75
    v_cmp_eq_u32 vcc, -1, v11
    s_add_u32 s70, s70, 1
    s_cbranch_vccz L_s_xok_197
    s_cmp_lt_u32 s70, 524288
    s_cbranch_scc1 L_s_xp_195
    s_branch L_c_done_1
L_ss_186:
.p2align 6
L_s_loop_205:
    v_mov_b32 v16, 0
    v_mov_b32 v17, 0
    v_mov_b32 v18, 0
    v_mov_b32 v19, 0
    s_add_u32 s58, s58, 4
    s_mov_b32 s70, 1
    s_waitcnt vmcnt(0) lgkmcnt(0)
    s_barrier
    ds_read_b128 v[64:67], v2 offset:0
    ds_read_b128 v[68:71], v2 offset:1024
    ds_read_b128 v[72:75], v2 offset:2048
    ds_read_b128 v[76:79], v2 offset:3072
    ds_read_b128 v[80:83], v2 offset:4096
    ds_read_b128 v[84:87], v2 offset:5120
    ds_read_b128 v[88:91], v2 offset:6144
    ds_read_b128 v[92:95], v2 offset:7168
    ds_read_b128 v[96:99], v2 offset:8192
    ds_read_b128 v[100:103], v2 offset:9216
    ds_read_b128 v[104:107], v2 offset:10240
    ds_read_b128 v[108:111], v2 offset:11264
    s_waitcnt lgkmcnt(11)
    v_smfmac_f32_16x16x64_bf16 v[16:19], v[64:67], a[0:7], v3
    ds_read_b128 v[112:115], v2 offset:12288
    s_waitcnt lgkmcnt(11)
    v_smfmac_f32_16x16x64_bf16 v[16:19], v[68:71], a[8:15], v3
    ds_read_b128 v[116:119], v2 offset:13312
    s_waitcnt lgkmcnt(11)
    v_smfmac_f32_16x16x64_bf16 v[16:19], v[72:75], a[16:23], v3
    ds_read_b128 v[120:123], v2 offset:14336
    s_waitcnt lgkmcnt(11)
    v_smfmac_f32_16x16x64_bf16 v[16:19], v[76:79], a[24:31], v3
    ds_read_b128 v[124:127], v2 offset:15360
    s_waitcnt lgkmcnt(11)
    v_smfmac_f32_16x16x64_bf16 v[16:19], v[80:83], a[32:39], v3
    s_waitcnt lgkmcnt(10)
    v_smfmac_f32_16x16x64_bf16 v[16:19], v[84:87], a[40:47], v3
    s_waitcnt lgkmcnt(9)
    v_smfmac_f32_16x16x64_bf16 v[16:19], v[88:91], a[48:55], v3
    s_waitcnt lgkmcnt(8)
    v_smfmac_f32_16x16x64_bf16 v[16:19], v[92:95], a[56:63], v3
    s_waitcnt lgkmcnt(7)
    v_smfmac_f32_16x16x64_bf16 v[16:19], v[96:99], a[64:71], v3
    s_waitcnt lgkmcnt(6)
    v_smfmac_f32_16x16x64_bf16 v[16:19], v[100:103], a[72:79], v3
    s_waitcnt lgkmcnt(5)
    v_smfmac_f32_16x16x64_bf16 v[16:19], v[104:107], a[80:87], v3
    s_waitcnt lgkmcnt(4)
    v_smfmac_f32_16x16x64_bf16 v[16:19], v[108:111], a[88:95], v3
    s_waitcnt lgkmcnt(3)
    v_smfmac_f32_16x16x64_bf16 v[16:19], v[112:115], a[96:103], v3
    s_waitcnt lgkmcnt(2)
    v_smfmac_f32_16x16x64_bf16 v[16:19], v[116:119], a[104:111], v3
    s_waitcnt lgkmcnt(1)
    v_smfmac_f32_16x16x64_bf16 v[16:19], v[120:123], a[112:119], v3
    s_waitcnt lgkmcnt(0)
    v_smfmac_f32_16x16x64_bf16 v[16:19], v[124:127], a[120:127], v3
    s_nop 7
    v_permlane32_swap_b32 v16, v18
    v_permlane32_swap_b32 v17, v19
    v_add_f32 v16, v16, v18
    v_add_f32 v17, v17, v19
    v_cvt_pk_bf16_f32 v16, v16, v17
    ds_write_b16 v5, v16
    ds_write_b16_d16_hi v5, v16 offset:16
    s_mov_b64 exec, 1
    ds_add_u32 v29, v30
    s_mov_b64 exec, -1
L_s_xl_207:
    ds_read_b32 v10, v29
    ds_read_b128 v[64:67], v2 offset:61440
    s_cmp_eq_u32 s60, 63
    s_cbranch_scc1 L_s_last_206
    s_cmp_ge_u32 s44, 2
    s_cbranch_scc1 L_s_w2_208
    s_waitcnt lgkmcnt(0)
    v_mfma_f32_16x16x32_bf16 v[16:19], v[32:35], v[64:67], 0
L_s_w2_208_b:
    v_cmp_ne_u32 vcc, s58, v10
    s_nop 0
    s_cbranch_vccnz L_rt_210
    s_mov_b64 exec, s[50:51]
    s_nop 3
    v_cvt_pk_bf16_f32 v16, v16, v17
    v_cvt_pk_bf16_f32 v17, v18, v19
    v_pk_min_u16 v16, v16, v54
    v_pk_min_u16 v17, v17, v54
    buffer_store_dwordx2 v[16:17], v4, s[12:15], s61 offen sc1
    s_mov_b64 exec, -1
L_s_w3_209_b:
    s_sleep 5
    s_mov_b32 s70, 1
L_s_xp_211:
    buffer_load_dwordx2 v[64:65], v7, s[12:15], s61 offen offset:0 sc1
    buffer_load_short_d16_hi v56, v28, s[12:15], s61 offen offset:0 sc1
    buffer_load_dwordx2 v[66:67], v7, s[12:15], s61 offen offset:512 sc1
    buffer_load_short_d16_hi v57, v28, s[12:15], s61 offen offset:128 sc1
    buffer_load_dwordx2 v[68:69], v7, s[12:15], s61 offen offset:1024 sc1
    buffer_load_short_d16_hi v58, v28, s[12:15], s61 offen offset:256 sc1
    buffer_load_dwordx2 v[70:71], v7, s[12:15], s61 offen offset:1536 sc1
    buffer_load_short_d16_hi v59, v28, s[12:15], s61 offen offset:384 sc1
    s_mov_b32 s46, 0x00003f80
    s_mov_b32 s47, 0x3f800000
    s_waitcnt vmcnt(6)
    v_dot2_f32_bf16 v16, v64, s46, 0
    v_dot2_f32_bf16 v17, v64, s47, 0
    v_dot2_f32_bf16 v18, v65, s46, 0
    v_dot2_f32_bf16 v19, v65, s47, 0
    s_waitcnt vmcnt(4)
    v_dot2_f32_bf16 v16, v66, s46, v16
    v_dot2_f32_bf16 v17, v66, s47, v17
    v_dot2_f32_bf16 v18, v67, s46, v18
    v_dot2_f32_bf16 v19, v67, s47, v19
    v_add_f32 v20, v56, v57
    s_waitcnt vmcnt(2)
    v_dot2_f32_bf16 v16, v68, s46, v16
    v_dot2_f32_bf16 v17, v68, s47, v17
    v_dot2_f32_bf16 v18, v69, s46, v18
    v_dot2_f32_bf16 v19, v69, s47, v19
    v_add_f32 v20, v20, v58
    s_waitcnt vmcnt(0)
    v_dot2_f32_bf16 v16, v70, s46, v16
    v_dot2_f32_bf16 v17, v70, s47, v17
    v_dot2_f32_bf16 v18, v71, s46, v18
    v_dot2_f32_bf16 v19, v71, s47, v19
    v_add_f32 v20, v20, v59
    s_nop 0
    v_cmp_u_f32 s[46:47], v16, v17
    v_cmp_u_f32 s[48:49], v18, v19
    v_cmp_u_f32 vcc, v20, v20
    v_max3_f32 v10, v16, v17, v18
    s_or_b64 s[46:47], s[46:47], s[48:49]
    v_max3_f32 v10, v10, v19, v20
    s_or_b64 vcc, vcc, s[46:47]
    s_cbranch_scc1 L_s_xf_212
L_s_xok_213:
    v_max_f32_dpp v11, v10, v10 row_ror:8 row_mask:0xf bank_mask:0xf
    v_max_f32_dpp v10, v10, v10 row_ror:8 row_mask:0xf bank_mask:0xf
    s_nop 1
    v_permlane16_swap_b32 v10, v11
    v_max_f32 v12, v10, v11
    v_max_f32 v10, v10, v11
    s_nop 1
    v_permlane32_swap_b32 v10, v12
    v_max_f32 v10, v10, v12
    v_mul_f32 v10, s66, v10
    v_fma_f32 v16, v16, s66, -v10
    v_fma_f32 v17, v17, s66, -v10
    v_fma_f32 v18, v18, s66, -v10
    v_fma_f32 v19, v19, s66, -v10
    v_fma_f32 v20, v20, s66, -v10
    v_exp_f32 v16, v16
    v_exp_f32 v17, v17
    v_exp_f32 v18, v18
    v_exp_f32 v19, v19
    v_exp_f32 v20, v20
    v_add_f32 v10, v16, v17
    v_add_f32 v11, v18, v19
    v_add_f32 v10, v10, v20
    v_add_f32 v10, v10, v11
    s_nop 1
    v_add_f32_dpp v11, v10, v10 row_ror:8 row_mask:0xf bank_mask:0xf
    v_add_f32_dpp v10, v10, v10 row_ror:8 row_mask:0xf bank_mask:0xf
    s_nop 1
    v_permlane16_swap_b32 v10, v11
    v_add_f32 v12, v10, v11
    v_add_f32 v10, v10, v11
    s_nop 1
    v_permlane32_swap_b32 v10, v12
    v_add_f32 v10, v10, v12
    v_rcp_f32 v10, v10
    s_nop 0
    v_mul_f32 v16, v16, v10
    v_mul_f32 v17, v17, v10
    v_mul_f32 v18, v18, v10
    v_mul_f32 v19, v19, v10
    v_mul_f32 v20, v20, v10
    v_cvt_pk_bf16_f32 v16, v16, v17
    v_cvt_pk_bf16_f32 v17, v18, v19
    v_cvt_pk_bf16_f32 v18, v20, v20
    ds_write_b64 v8, v[16:17]
    ds_write_b16 v9, v18
    s_waitcnt lgkmcnt(0)
    s_barrier
    s_add_u32 s63, s63, 786432
    s_cmp_ge_u32 s44, 2
    s_cbranch_scc1 L_s_nk_214
    buffer_load_dwordx4 v[32:35], v6, s[12:15], s63 offen sc1
L_s_nk_214:
    s_add_u32 s45, s60, 2
    s_cmp_le_u32 s69, s45
    s_cbranch_scc1 L_s_nk_214_w
    s_add_u32 s45, s63, 786432
    s_mov_b64 exec, 0xf
    buffer_load_dword v15, v14, s[12:15], s45 offen sc1
    s_mov_b64 exec, -1
L_s_nk_214_w:
    s_cmp_eq_u32 s44, 3
    s_cbranch_scc1 L_s_nr_215
    s_xor_b32 s45, s61, 0x8000
    s_mov_b64 exec, s[50:51]
    buffer_store_dwordx2 v[24:25], v4, s[12:15], s45 offen sc1
    s_mov_b64 exec, -1
L_s_nr_215:
    s_cmp_lg_u32 s44, 3
    s_cbranch_scc1 L_s_np_216
    ds_read_b128 v[20:23], v6
    s_lshl_b32 s45, s60, 17
    s_add_u32 s45, s45, s67
    s_waitcnt lgkmcnt(0)
    v_min_u32 v20, -2, v20
    v_min_u32 v21, -2, v21
    v_min_u32 v22, -2, v22
    v_min_u32 v23, -2, v23
    buffer_store_dwordx4 v[20:23], v2, s[12:15], s45 offen sc1
L_s_np_216:
    s_add_u32 s68, s60, 2
    s_min_u32 s68, s68, 63
    v_readlane_b32 s45, v0, 0
    v_readlane_b32 s46, v0, 1
    s_nop 0
    s_min_u32 s45, s45, s46
    s_max_u32 s69, s69, s45
    s_cmp_gt_u32 s69, s68
    s_cbranch_scc1 L_kv_ok_219
    s_mov_b32 s70, 0
L_kv_lp_218:
    v_and_b32 v22, 1, v1
    v_lshlrev_b32 v22, 9, v22
    buffer_load_dword v23, v22, s[12:15], s57 offen sc1
    s_waitcnt vmcnt(0)
    v_readlane_b32 s69, v23, 0
    v_readlane_b32 s45, v23, 1
    s_add_u32 s70, s70, 1
    s_nop 2
    s_min_u32 s69, s69, s45
    s_cmp_gt_u32 s69, s68
    s_cbranch_scc1 L_kv_ok_219
    s_sleep 4
    s_cmp_lt_u32 s70, 524288
    s_cbranch_scc1 L_kv_lp_218
    s_branch L_c_done_1
L_kv_ok_219:
    s_add_u32 s45, s60, 7
    s_min_u32 s45, s45, 63
    s_cmp_gt_u32 s69, s45
    s_cbranch_scc1 L_s_na_217
    v_and_b32 v22, 1, v1
    v_lshlrev_b32 v22, 9, v22
    buffer_load_dword v0, v22, s[12:15], s57 offen sc1
L_s_na_217:
    s_add_u32 s60, s60, 1
    s_add_u32 s61, s61, 0x4000
    s_and_b32 s61, s61, 0xffff
    s_branch L_s_loop_205
L_s_last_206:
    s_waitcnt lgkmcnt(0)
    s_barrier
    s_cmp_lg_u32 s44, 3
    s_cbranch_scc1 L_s_np_220
    ds_read_b128 v[20:23], v6
    s_lshl_b32 s45, s60, 17
    s_add_u32 s45, s45, s67
    s_waitcnt lgkmcnt(0)
    v_min_u32 v20, -2, v20
    v_min_u32 v21, -2, v21
    v_min_u32 v22, -2, v22
    v_min_u32 v23, -2, v23
    buffer_store_dwordx4 v[20:23], v2, s[12:15], s45 offen sc1
L_s_np_220:
    s_branch L_replica
L_rt_210:
    s_add_u32 s70, s70, 1
    s_cmp_lt_u32 s70, 524288
    s_cbranch_scc1 L_s_xl_207
    s_branch L_c_done_1
L_s_w2_208:
    s_cmp_eq_u32 s44, 3
    s_cbranch_scc1 L_s_w3_209
    s_waitcnt lgkmcnt(0)
    v_mfma_f32_16x16x32_bf16 v[16:19], v[64:67], v[64:67], 0
    s_branch L_s_w2_208_b
L_s_w3_209:
    s_sleep 3
    s_branch L_s_w3_209_b
L_s_xf_212:
    v_or_b32 v72, 0xffff, v56
    v_or_b32 v73, 0xffff, v57
    v_or_b32 v74, 0xffff, v58
    v_or_b32 v75, 0xffff, v59
    v_max3_u32 v11, v64, v65, v66
    v_max3_u32 v11, v11, v67, v68
    v_max3_u32 v11, v11, v69, v70
    v_max3_u32 v11, v11, v71, v72
    v_max3_u32 v11, v11, v73, v74
    v_max_u32 v11, v11, v75
    v_cmp_eq_u32 vcc, -1, v11
    s_add_u32 s70, s70, 1
    s_cbranch_vccz L_s_xok_213
    s_cmp_lt_u32 s70, 524288
    s_cbranch_scc1 L_s_xp_211
    s_branch L_c_done_1
L_vf_187:
    s_cmp_eq_u32 s52, 0
    s_cbranch_scc1 L_vs_188
    s_mov_b32 s70, 1
    v_mov_b32 v16, 0
    v_mov_b32 v17, 0
    s_branch L_v_l1m_223
.p2align 6
L_v_loop_221:
    s_mov_b32 s70, 1
    buffer_load_dwordx4 v[64:67], v9, s[12:15], s61 offen offset:0 sc1
    buffer_load_dwordx4 v[68:71], v9, s[12:15], s61 offen offset:1024 sc1
    buffer_load_dwordx4 v[72:75], v9, s[12:15], s61 offen offset:2048 sc1
    buffer_load_dwordx4 v[76:79], v9, s[12:15], s61 offen offset:3072 sc1
    v_mov_b32 v16, 0
    v_mov_b32 v17, 0
    v_mov_b32 v18, 0
    v_mov_b32 v19, 0
    v_mov_b32 v20, 0
    v_mov_b32 v21, 0
    v_mov_b32 v22, 0
    v_mov_b32 v23, 0
L_v_l1m_223:
    s_waitcnt vmcnt(3)
    ds_write_b128 v10, v[64:67] offset:0
    v_max3_u32 v24, v64, v65, v66
    v_max_u32 v24, v24, v67
    v_cmp_eq_u32 s[48:49], -1, v24
    s_waitcnt vmcnt(2)
    ds_write_b128 v10, v[68:71] offset:1024
    v_max3_u32 v24, v68, v69, v70
    v_max_u32 v24, v24, v71
    v_cmp_eq_u32 s[50:51], -1, v24
    s_waitcnt vmcnt(1)
    ds_write_b128 v10, v[72:75] offset:2048
    v_max3_u32 v24, v72, v73, v74
    v_max_u32 v24, v24, v75
    v_cmp_eq_u32 s[52:53], -1, v24
    s_waitcnt vmcnt(0)
    ds_write_b128 v10, v[76:79] offset:3072
    v_max3_u32 v24, v76, v77, v78
    v_max_u32 v24, v24, v79
    v_cmp_eq_u32 s[54:55], -1, v24
    s_or_b64 s[46:47], s[48:49], s[50:51]
    s_or_b64 vcc, s[52:53], s[54:55]
    s_or_b64 vcc, vcc, s[46:47]
    s_cbranch_scc1 L_v_l1_222
L_v_l1ok_224:
    s_waitcnt lgkmcnt(0)
    s_barrier
    v_smfmac_f32_16x16x64_bf16 v[16:19], v[64:67], a[0:7], v3
    v_smfmac_f32_16x16x64_bf16 v[20:23], v[64:67], a[32:39], v3
    v_smfmac_f32_16x16x64_bf16 v[16:19], v[68:71], a[8:15], v3
    v_smfmac_f32_16x16x64_bf16 v[20:23], v[68:71], a[40:47], v3
    v_smfmac_f32_16x16x64_bf16 v[16:19], v[72:75], a[16:23], v3
    v_smfmac_f32_16x16x64_bf16 v[20:23], v[72:75], a[48:55], v3
    v_smfmac_f32_16x16x64_bf16 v[16:19], v[76:79], a[24:31], v3
    v_smfmac_f32_16x16x64_bf16 v[20:23], v[76:79], a[56:63], v3
    s_nop 6
    v_permlane32_swap_b32 v16, v18
    v_permlane32_swap_b32 v17, v19
    v_permlane32_swap_b32 v20, v22
    v_permlane32_swap_b32 v21, v23
    v_add_f32 v16, v16, v18
    v_add_f32 v17, v17, v19
    v_add_f32 v18, v20, v22
    v_add_f32 v19, v21, v23
    ds_write_b128 v14, v[16:19]
    s_mov_b64 exec, 1
    ds_add_u32 v29, v30
    s_mov_b64 exec, -1
    s_add_u32 s58, s58, 4
    s_bitcmp1_b32 s44, 0
    s_cbranch_scc1 L_v_k1_226_c
    s_mov_b32 s70, 0
L_v_rl_227:
    ds_read_b32 v24, v29
    ds_read_b64 v[16:17], v13 offset:0
    ds_read_b64 v[18:19], v13 offset:1024
    ds_read_b64 v[20:21], v13 offset:2048
    ds_read_b64 v[22:23], v13 offset:3072
    s_waitcnt lgkmcnt(2)
    v_cmp_ne_u32 vcc, s58, v24
    v_add_f32 v16, v16, v18
    v_add_f32 v17, v17, v19
    s_waitcnt lgkmcnt(0)
    s_cbranch_vccnz L_rt_228
    v_add_f32 v20, v20, v22
    v_add_f32 v21, v21, v23
    v_add_f32 v16, v16, v20
    v_add_f32 v17, v17, v21
    s_mov_b32 vcc_lo, 0x55555555
    s_mov_b32 vcc_hi, 0x55555555
    v_cndmask_b32_dpp v18, v17, v16, vcc quad_perm:[1,0,3,2] row_mask:0xf bank_mask:0xf
    s_not_b64 vcc, vcc
    v_cndmask_b32_dpp v19, v16, v17, vcc quad_perm:[1,0,3,2] row_mask:0xf bank_mask:0xf
    v_cvt_pk_bf16_f32 v18, v18, v19
    v_min_u32 v18, -2, v18
    buffer_store_dword v18, v4, s[12:15], s62 offen
    ds_write_b32 v5, v18
L_v_k1_226:
    s_cmp_eq_u32 s60, 63
    s_cbranch_scc1 L_v_last_225
    ds_read_b128 v[80:83], v27 offset:32768
    ds_read_b128 v[84:87], v27 offset:36864
    ds_read_b128 v[88:91], v27 offset:40960
    ds_read_b128 v[92:95], v27 offset:45056
    v_mov_b32 v96, 0
    v_mov_b32 v97, 0
    v_mov_b32 v98, 0
    v_mov_b32 v99, 0
    v_mov_b32 v100, 0
    v_mov_b32 v101, 0
    v_mov_b32 v102, 0
    v_mov_b32 v103, 0
    v_mov_b32 v104, 0
    v_mov_b32 v105, 0
    v_mov_b32 v106, 0
    v_mov_b32 v107, 0
    v_mov_b32 v108, 0
    v_mov_b32 v109, 0
    v_mov_b32 v110, 0
    v_mov_b32 v111, 0
    s_bitcmp1_b32 s44, 0
    s_cbranch_scc0 L_v_sv_229
    s_sleep 1
L_v_sv_229:
    s_sleep 3
    s_mov_b32 s70, 1
    buffer_load_dwordx4 v[64:67], v11, s[12:15], s62 offen offset:0 sc1
    buffer_load_dwordx4 v[68:71], v11, s[12:15], s62 offen offset:1024 sc1
L_v_vp_230_m:
    s_waitcnt vmcnt(0)
    v_max3_u32 v20, v64, v65, v66
    v_max3_u32 v20, v20, v67, v68
    v_max3_u32 v20, v20, v69, v70
    v_max_u32 v20, v20, v71
    v_cmp_eq_u32 vcc, -1, v20
    s_cbranch_vccnz L_rt_231
    v_smfmac_f32_16x16x64_bf16 v[96:99], v[64:67], a[64:71], v3
    v_smfmac_f32_16x16x64_bf16 v[96:99], v[68:71], a[72:79], v3
    v_smfmac_f32_16x16x64_bf16 v[100:103], v[64:67], a[80:87], v3
    v_smfmac_f32_16x16x64_bf16 v[100:103], v[68:71], a[88:95], v3
    v_smfmac_f32_16x16x64_bf16 v[104:107], v[64:67], a[96:103], v3
    v_smfmac_f32_16x16x64_bf16 v[104:107], v[68:71], a[104:111], v3
    v_smfmac_f32_16x16x64_bf16 v[108:111], v[64:67], a[112:119], v3
    v_smfmac_f32_16x16x64_bf16 v[108:111], v[68:71], a[120:127], v3
    s_nop 1
    v_cvt_pk_bf16_f32 v96, v96, v97
    v_cvt_pk_bf16_f32 v97, v98, v99
    ds_write_b64 v12, v[96:97] offset:0
    v_cvt_pk_bf16_f32 v100, v100, v101
    v_cvt_pk_bf16_f32 v101, v102, v103
    ds_write_b64 v12, v[100:101] offset:2048
    v_cvt_pk_bf16_f32 v104, v104, v105
    v_cvt_pk_bf16_f32 v105, v106, v107
    ds_write_b64 v12, v[104:105] offset:4096
    v_cvt_pk_bf16_f32 v108, v108, v109
    v_cvt_pk_bf16_f32 v109, v110, v111
    ds_write_b64 v12, v[108:109] offset:6144
    s_bitcmp1_b32 s44, 0
    s_cbranch_scc1 L_v_r8_232
    s_add_u32 s46, s65, 4096
    buffer_load_dwordx4 v[32:35], v15, s[12:15], s65 offen offset:0 sc1
    buffer_load_dwordx4 v[48:51], v15, s[12:15], s46 offen offset:0 sc1
    buffer_load_dwordx4 v[36:39], v15, s[12:15], s65 offen offset:1024 sc1
    buffer_load_dwordx4 v[52:55], v15, s[12:15], s46 offen offset:1024 sc1
    buffer_load_dwordx4 v[40:43], v15, s[12:15], s65 offen offset:2048 sc1
    buffer_load_dwordx4 v[56:59], v15, s[12:15], s46 offen offset:2048 sc1
    buffer_load_dwordx4 v[44:47], v15, s[12:15], s65 offen offset:3072 sc1
    buffer_load_dwordx4 v[60:63], v15, s[12:15], s46 offen offset:3072 sc1
    s_add_u32 s65, s65, 786432
L_v_r8_232:
    s_waitcnt lgkmcnt(0)
    s_barrier
    ds_read_b128 v[96:99], v2 offset:16384
    ds_read_b128 v[100:103], v2 offset:17408
    ds_read_b128 v[104:107], v2 offset:18432
    ds_read_b128 v[108:111], v2 offset:19456
    ds_read_b128 v[112:115], v31 offset:0
    ds_read_b128 v[116:119], v25 offset:0
    ds_read_b128 v[120:123], v31 offset:512
    ds_read_b128 v[124:127], v25 offset:1024
    s_waitcnt lgkmcnt(7)
    v_mfma_f32_16x16x32_bf16 v[16:19], v[80:83], v[96:99], 0
    s_waitcnt lgkmcnt(6)
    v_mfma_f32_16x16x32_bf16 v[16:19], v[84:87], v[100:103], v[16:19]
    s_waitcnt lgkmcnt(5)
    v_mfma_f32_16x16x32_bf16 v[16:19], v[88:91], v[104:107], v[16:19]
    s_waitcnt lgkmcnt(4)
    v_mfma_f32_16x16x32_bf16 v[16:19], v[92:95], v[108:111], v[16:19]
    s_waitcnt lgkmcnt(2)
    v_mfma_f32_16x16x32_bf16 v[16:19], v[116:119], v[112:115], v[16:19]
    s_waitcnt lgkmcnt(0)
    v_mfma_f32_16x16x32_bf16 v[16:19], v[124:127], v[120:123], v[16:19]
    s_mov_b32 exec_lo, 0x00ff00ff
    s_mov_b32 exec_hi, 0x00ff00ff
    s_nop 5
    v_cvt_pk_bf16_f32 v16, v16, v17
    v_cvt_pk_bf16_f32 v17, v18, v19
    v_min_u32 v16, -2, v16
    v_min_u32 v17, -2, v17
    buffer_store_dwordx2 v[16:17], v6, s[12:15], s63 offen sc1
    s_mov_b64 exec, -1
    s_add_u32 s61, s61, 0x4000
    s_and_b32 s61, s61, 0xffff
    s_mov_b32 s70, 1
    s_waitcnt vmcnt(1)
    s_sleep 8
    buffer_load_dword v96, v7, s[12:15], s63 offen offset:0 sc1
    buffer_load_dword v97, v7, s[12:15], s63 offen offset:256 sc1
    buffer_load_dword v98, v7, s[12:15], s63 offen offset:512 sc1
    buffer_load_dword v99, v7, s[12:15], s63 offen offset:768 sc1
    buffer_load_dword v100, v7, s[12:15], s63 offen offset:1024 sc1
    buffer_load_dword v101, v7, s[12:15], s63 offen offset:1280 sc1
    buffer_load_dword v102, v7, s[12:15], s63 offen offset:1536 sc1
    buffer_load_dword v103, v7, s[12:15], s63 offen offset:1792 sc1
    v_mfma_f32_16x16x32_bf16 v[64:67], v[32:35], a[64:67], 0
    v_mfma_f32_16x16x32_bf16 v[68:71], v[48:51], a[64:67], 0
    v_mfma_f32_16x16x32_bf16 v[64:67], v[36:39], a[68:71], v[64:67]
    v_mfma_f32_16x16x32_bf16 v[68:71], v[52:55], a[68:71], v[68:71]
    v_mfma_f32_16x16x32_bf16 v[64:67], v[40:43], a[72:75], v[64:67]
    v_mfma_f32_16x16x32_bf16 v[68:71], v[56:59], a[72:75], v[68:71]
    v_mfma_f32_16x16x32_bf16 v[64:67], v[44:47], a[76:79], v[64:67]
    v_mfma_f32_16x16x32_bf16 v[68:71], v[60:63], a[76:79], v[68:71]
    v_mfma_f32_16x16x32_bf16 v[72:75], v[32:35], a[80:83], 0
    v_mfma_f32_16x16x32_bf16 v[76:79], v[48:51], a[80:83], 0
    v_mfma_f32_16x16x32_bf16 v[72:75], v[36:39], a[84:87], v[72:75]
    v_mfma_f32_16x16x32_bf16 v[76:79], v[52:55], a[84:87], v[76:79]
    v_mfma_f32_16x16x32_bf16 v[72:75], v[40:43], a[88:91], v[72:75]
    v_mfma_f32_16x16x32_bf16 v[76:79], v[56:59], a[88:91], v[76:79]
    v_mfma_f32_16x16x32_bf16 v[72:75], v[44:47], a[92:95], v[72:75]
    v_mfma_f32_16x16x32_bf16 v[76:79], v[60:63], a[92:95], v[76:79]
    v_cvt_pk_bf16_f32 v64, v64, v65
    v_cvt_pk_bf16_f32 v65, v66, v67
    v_cvt_pk_bf16_f32 v66, v68, v69
    v_cvt_pk_bf16_f32 v67, v70, v71
    ds_write_b128 v10, v[64:67] offset:32768
    v_mfma_f32_16x16x32_bf16 v[80:83], v[32:35], a[96:99], 0
    v_mfma_f32_16x16x32_bf16 v[84:87], v[48:51], a[96:99], 0
    v_mfma_f32_16x16x32_bf16 v[80:83], v[36:39], a[100:103], v[80:83]
    v_mfma_f32_16x16x32_bf16 v[84:87], v[52:55], a[100:103], v[84:87]
    v_mfma_f32_16x16x32_bf16 v[80:83], v[40:43], a[104:107], v[80:83]
    v_mfma_f32_16x16x32_bf16 v[84:87], v[56:59], a[104:107], v[84:87]
    v_mfma_f32_16x16x32_bf16 v[80:83], v[44:47], a[108:111], v[80:83]
    v_mfma_f32_16x16x32_bf16 v[84:87], v[60:63], a[108:111], v[84:87]
    v_cvt_pk_bf16_f32 v72, v72, v73
    v_cvt_pk_bf16_f32 v73, v74, v75
    v_cvt_pk_bf16_f32 v74, v76, v77
    v_cvt_pk_bf16_f32 v75, v78, v79
    ds_write_b128 v10, v[72:75] offset:33792
L_v_gp_233:
    s_waitcnt vmcnt(7)
    v_lshlrev_b32 v20, 16, v96
    v_and_b32 v21, 0xffff0000, v96
    s_waitcnt vmcnt(6)
    v_lshlrev_b32 v22, 16, v97
    v_and_b32 v23, 0xffff0000, v97
    v_add_f32 v20, v20, v22
    v_add_f32 v21, v21, v23
    s_waitcnt vmcnt(5)
    v_lshlrev_b32 v22, 16, v98
    v_and_b32 v23, 0xffff0000, v98
    v_add_f32 v20, v20, v22
    v_add_f32 v21, v21, v23
    s_waitcnt vmcnt(4)
    v_lshlrev_b32 v22, 16, v99
    v_and_b32 v23, 0xffff0000, v99
    v_add_f32 v20, v20, v22
    v_add_f32 v21, v21, v23
    s_waitcnt vmcnt(3)
    v_lshlrev_b32 v22, 16, v100
    v_and_b32 v23, 0xffff0000, v100
    v_add_f32 v20, v20, v22
    v_add_f32 v21, v21, v23
    s_waitcnt vmcnt(2)
    v_lshlrev_b32 v22, 16, v101
    v_and_b32 v23, 0xffff0000, v101
    v_add_f32 v20, v20, v22
    v_add_f32 v21, v21, v23
    s_waitcnt vmcnt(1)
    v_lshlrev_b32 v22, 16, v102
    v_and_b32 v23, 0xffff0000, v102
    v_add_f32 v20, v20, v22
    v_add_f32 v21, v21, v23
    s_waitcnt vmcnt(0)
    v_lshlrev_b32 v22, 16, v103
    v_and_b32 v23, 0xffff0000, v103
    v_add_f32 v20, v20, v22
    v_add_f32 v21, v21, v23
    v_cmp_u_f32 vcc, v20, v21
    v_cvt_pk_bf16_f32 v20, v20, v21
    s_cbranch_vccnz L_v_gf_235
L_v_gok_234:
    buffer_store_dword v20, v8, s[12:15], s61 offen
    s_xor_b32 s45, s61, 0x8000
    buffer_store_dword v26, v8, s[12:15], s45 offen
    s_bitcmp1_b32 s44, 0
    s_cbranch_scc1 L_v_nr_236
    s_xor_b32 s45, s62, 0x4000
    buffer_store_dword v26, v4, s[12:15], s45 offen
L_v_nr_236:
    s_add_u32 s60, s60, 1
    s_add_u32 s62, s62, 0x2000
    s_and_b32 s62, s62, 0x7fff
    s_and_b32 s45, s60, 0x38
    s_bitcmp1_b64 s[66:67], s45
    s_cselect_b32 s45, 8192, 0
    s_lshl_b32 s63, s60, 18
    s_add_u32 s63, s63, s45
    v_mfma_f32_16x16x32_bf16 v[88:91], v[32:35], a[112:115], 0
    v_mfma_f32_16x16x32_bf16 v[92:95], v[48:51], a[112:115], 0
    v_mfma_f32_16x16x32_bf16 v[88:91], v[36:39], a[116:119], v[88:91]
    v_mfma_f32_16x16x32_bf16 v[92:95], v[52:55], a[116:119], v[92:95]
    v_mfma_f32_16x16x32_bf16 v[88:91], v[40:43], a[120:123], v[88:91]
    v_mfma_f32_16x16x32_bf16 v[92:95], v[56:59], a[120:123], v[92:95]
    v_mfma_f32_16x16x32_bf16 v[88:91], v[44:47], a[124:127], v[88:91]
    v_mfma_f32_16x16x32_bf16 v[92:95], v[60:63], a[124:127], v[92:95]
    v_cvt_pk_bf16_f32 v80, v80, v81
    v_cvt_pk_bf16_f32 v81, v82, v83
    v_cvt_pk_bf16_f32 v82, v84, v85
    v_cvt_pk_bf16_f32 v83, v86, v87
    ds_write_b128 v10, v[80:83] offset:34816
    s_nop 2
    v_cvt_pk_bf16_f32 v88, v88, v89
    v_cvt_pk_bf16_f32 v89, v90, v91
    v_cvt_pk_bf16_f32 v90, v92, v93
    v_cvt_pk_bf16_f32 v91, v94, v95
    ds_write_b128 v10, v[88:91] offset:35840
    s_sleep 3
    s_branch L_v_loop_221
L_v_last_225:
    s_waitcnt lgkmcnt(0)
    s_barrier
    s_branch L_replica
L_v_l1_222:
    s_mov_b64 exec, s[48:49]
    s_cbranch_execz L_v_ls_237
    buffer_load_dwordx4 v[64:67], v9, s[12:15], s61 offen offset:0 sc1
L_v_ls_237:
    s_mov_b64 exec, s[50:51]
    s_cbranch_execz L_v_ls_238
    buffer_load_dwordx4 v[68:71], v9, s[12:15], s61 offen offset:1024 sc1
L_v_ls_238:
    s_mov_b64 exec, s[52:53]
    s_cbranch_execz L_v_ls_239
    buffer_load_dwordx4 v[72:75], v9, s[12:15], s61 offen offset:2048 sc1
L_v_ls_239:
    s_mov_b64 exec, s[54:55]
    s_cbranch_execz L_v_ls_240
    buffer_load_dwordx4 v[76:79], v9, s[12:15], s61 offen offset:3072 sc1
L_v_ls_240:
    s_mov_b64 exec, -1
    s_add_u32 s70, s70, 1
    s_cmp_ge_u32 s70, 524288
    s_cbranch_scc1 L_c_done_1
    s_waitcnt vmcnt(0)
    s_cmp_eq_u64 s[48:49], 0
    s_cbranch_scc1 L_v_lc_241
    ds_write_b128 v10, v[64:67] offset:0
    v_max3_u32 v24, v64, v65, v66
    v_max_u32 v24, v24, v67
    v_cmp_eq_u32 s[48:49], -1, v24
L_v_lc_241:
    s_cmp_eq_u64 s[50:51], 0
    s_cbranch_scc1 L_v_lc_242
    ds_write_b128 v10, v[68:71] offset:1024
    v_max3_u32 v24, v68, v69, v70
    v_max_u32 v24, v24, v71
    v_cmp_eq_u32 s[50:51], -1, v24
L_v_lc_242:
    s_cmp_eq_u64 s[52:53], 0
    s_cbranch_scc1 L_v_lc_243
    ds_write_b128 v10, v[72:75] offset:2048
    v_max3_u32 v24, v72, v73, v74
    v_max_u32 v24, v24, v75
    v_cmp_eq_u32 s[52:53], -1, v24
L_v_lc_243:
    s_cmp_eq_u64 s[54:55], 0
    s_cbranch_scc1 L_v_lc_244
    ds_write_b128 v10, v[76:79] offset:3072
    v_max3_u32 v24, v76, v77, v78
    v_max_u32 v24, v24, v79
    v_cmp_eq_u32 s[54:55], -1, v24
L_v_lc_244:
    s_or_b64 s[46:47], s[48:49], s[50:51]
    s_or_b64 vcc, s[52:53], s[54:55]
    s_or_b64 vcc, vcc, s[46:47]
    s_cbranch_scc1 L_v_l1_222
    s_branch L_v_l1ok_224
L_v_k1_226_c:
    s_add_u32 s46, s65, 4096
    buffer_load_dwordx4 v[32:35], v15, s[12:15], s65 offen offset:0 sc1
    buffer_load_dwordx4 v[48:51], v15, s[12:15], s46 offen offset:0 sc1
    buffer_load_dwordx4 v[36:39], v15, s[12:15], s65 offen offset:1024 sc1
    buffer_load_dwordx4 v[52:55], v15, s[12:15], s46 offen offset:1024 sc1
    buffer_load_dwordx4 v[40:43], v15, s[12:15], s65 offen offset:2048 sc1
    buffer_load_dwordx4 v[56:59], v15, s[12:15], s46 offen offset:2048 sc1
    buffer_load_dwordx4 v[44:47], v15, s[12:15], s65 offen offset:3072 sc1
    buffer_load_dwordx4 v[60:63], v15, s[12:15], s46 offen offset:3072 sc1
    s_add_u32 s65, s65, 786432
    s_branch L_v_k1_226
L_rt_228:
    s_add_u32 s70, s70, 1
    s_cmp_lt_u32 s70, 524288
    s_cbranch_scc1 L_v_rl_227
    s_branch L_c_done_1
L_v_vp_230:
    buffer_load_dwordx4 v[64:67], v11, s[12:15], s62 offen offset:0 sc1
    buffer_load_dwordx4 v[68:71], v11, s[12:15], s62 offen offset:1024 sc1
    s_branch L_v_vp_230_m
L_rt_231:
    s_add_u32 s70, s70, 1
    s_cmp_lt_u32 s70, 524288
    s_cbranch_scc1 L_v_vp_230
    s_branch L_c_done_1
L_v_gf_235:
    v_max3_u32 v24, v96, v97, v98
    v_max3_u32 v24, v24, v99, v100
    v_max3_u32 v24, v24, v101, v102
    v_max_u32 v24, v24, v103
    v_cmp_eq_u32 vcc, -1, v24
    v_min_u32 v20, -2, v20
    s_add_u32 s70, s70, 1
    s_cbranch_vccz L_v_gok_234
    buffer_load_dword v96, v7, s[12:15], s63 offen offset:0 sc1
    buffer_load_dword v97, v7, s[12:15], s63 offen offset:256 sc1
    buffer_load_dword v98, v7, s[12:15], s63 offen offset:512 sc1
    buffer_load_dword v99, v7, s[12:15], s63 offen offset:768 sc1
    buffer_load_dword v100, v7, s[12:15], s63 offen offset:1024 sc1
    buffer_load_dword v101, v7, s[12:15], s63 offen offset:1280 sc1
    buffer_load_dword v102, v7, s[12:15], s63 offen offset:1536 sc1
    buffer_load_dword v103, v7, s[12:15], s63 offen offset:1792 sc1
    s_cmp_lt_u32 s70, 524288
    s_cbranch_scc1 L_v_gp_233
    s_branch L_c_done_1
L_vs_188:
    s_mov_b32 s70, 1
    v_mov_b32 v16, 0
    v_mov_b32 v17, 0
    s_branch L_v_l1m_247
.p2align 6
L_v_loop_245:
    s_mov_b32 s70, 1
    buffer_load_dwordx4 v[64:67], v9, s[12:15], s61 offen offset:0 sc1
    buffer_load_dwordx4 v[68:71], v9, s[12:15], s61 offen offset:1024 sc1
    buffer_load_dwordx4 v[72:75], v9, s[12:15], s61 offen offset:2048 sc1
    buffer_load_dwordx4 v[76:79], v9, s[12:15], s61 offen offset:3072 sc1
    v_mov_b32 v16, 0
    v_mov_b32 v17, 0
    v_mov_b32 v18, 0
    v_mov_b32 v19, 0
    v_mov_b32 v20, 0
    v_mov_b32 v21, 0
    v_mov_b32 v22, 0
    v_mov_b32 v23, 0
L_v_l1m_247:
    s_waitcnt vmcnt(3)
    ds_write_b128 v10, v[64:67] offset:0
    v_max3_u32 v24, v64, v65, v66
    v_max_u32 v24, v24, v67
    v_cmp_eq_u32 s[48:49], -1, v24
    s_waitcnt vmcnt(2)
    ds_write_b128 v10, v[68:71] offset:1024
    v_max3_u32 v24, v68, v69, v70
    v_max_u32 v24, v24, v71
    v_cmp_eq_u32 s[50:51], -1, v24
    s_waitcnt vmcnt(1)
    ds_write_b128 v10, v[72:75] offset:2048
    v_max3_u32 v24, v72, v73, v74
    v_max_u32 v24, v24, v75
    v_cmp_eq_u32 s[52:53], -1, v24
    s_waitcnt vmcnt(0)
    ds_write_b128 v10, v[76:79] offset:3072
    v_max3_u32 v24, v76, v77, v78
    v_max_u32 v24, v24, v79
    v_cmp_eq_u32 s[54:55], -1, v24
    s_or_b64 s[46:47], s[48:49], s[50:51]
    s_or_b64 vcc, s[52:53], s[54:55]
    s_or_b64 vcc, vcc, s[46:47]
    s_cbranch_scc1 L_v_l1_246
L_v_l1ok_248:
    s_waitcnt lgkmcnt(0)
    s_barrier
    v_smfmac_f32_16x16x64_bf16 v[16:19], v[64:67], a[0:7], v3
    v_smfmac_f32_16x16x64_bf16 v[20:23], v[64:67], a[32:39], v3
    v_smfmac_f32_16x16x64_bf16 v[16:19], v[68:71], a[8:15], v3
    v_smfmac_f32_16x16x64_bf16 v[20:23], v[68:71], a[40:47], v3
    v_smfmac_f32_16x16x64_bf16 v[16:19], v[72:75], a[16:23], v3
    v_smfmac_f32_16x16x64_bf16 v[20:23], v[72:75], a[48:55], v3
    v_smfmac_f32_16x16x64_bf16 v[16:19], v[76:79], a[24:31], v3
    v_smfmac_f32_16x16x64_bf16 v[20:23], v[76:79], a[56:63], v3
    s_nop 6
    v_permlane32_swap_b32 v16, v18
    v_permlane32_swap_b32 v17, v19
    v_permlane32_swap_b32 v20, v22
    v_permlane32_swap_b32 v21, v23
    v_add_f32 v16, v16, v18
    v_add_f32 v17, v17, v19
    v_add_f32 v18, v20, v22
    v_add_f32 v19, v21, v23
    ds_write_b128 v14, v[16:19]
    s_mov_b64 exec, 1
    ds_add_u32 v29, v30
    s_mov_b64 exec, -1
    s_add_u32 s58, s58, 4
    s_bitcmp1_b32 s44, 0
    s_cbranch_scc1 L_v_k1_250_c
    s_mov_b32 s70, 0
L_v_rl_251:
    ds_read_b32 v24, v29
    ds_read_b64 v[16:17], v13 offset:0
    ds_read_b64 v[18:19], v13 offset:1024
    ds_read_b64 v[20:21], v13 offset:2048
    ds_read_b64 v[22:23], v13 offset:3072
    s_waitcnt lgkmcnt(2)
    v_cmp_ne_u32 vcc, s58, v24
    v_add_f32 v16, v16, v18
    v_add_f32 v17, v17, v19
    s_waitcnt lgkmcnt(0)
    s_cbranch_vccnz L_rt_252
    v_add_f32 v20, v20, v22
    v_add_f32 v21, v21, v23
    v_add_f32 v16, v16, v20
    v_add_f32 v17, v17, v21
    s_mov_b32 vcc_lo, 0x55555555
    s_mov_b32 vcc_hi, 0x55555555
    v_cndmask_b32_dpp v18, v17, v16, vcc quad_perm:[1,0,3,2] row_mask:0xf bank_mask:0xf
    s_not_b64 vcc, vcc
    v_cndmask_b32_dpp v19, v16, v17, vcc quad_perm:[1,0,3,2] row_mask:0xf bank_mask:0xf
    v_cvt_pk_bf16_f32 v18, v18, v19
    v_min_u32 v18, -2, v18
    buffer_store_dword v18, v4, s[12:15], s62 offen sc1
    ds_write_b32 v5, v18
L_v_k1_250:
    s_cmp_eq_u32 s60, 63
    s_cbranch_scc1 L_v_last_249
    ds_read_b128 v[80:83], v27 offset:32768
    ds_read_b128 v[84:87], v27 offset:36864
    ds_read_b128 v[88:91], v27 offset:40960
    ds_read_b128 v[92:95], v27 offset:45056
    v_mov_b32 v96, 0
    v_mov_b32 v97, 0
    v_mov_b32 v98, 0
    v_mov_b32 v99, 0
    v_mov_b32 v100, 0
    v_mov_b32 v101, 0
    v_mov_b32 v102, 0
    v_mov_b32 v103, 0
    v_mov_b32 v104, 0
    v_mov_b32 v105, 0
    v_mov_b32 v106, 0
    v_mov_b32 v107, 0
    v_mov_b32 v108, 0
    v_mov_b32 v109, 0
    v_mov_b32 v110, 0
    v_mov_b32 v111, 0
    s_bitcmp1_b32 s44, 0
    s_cbranch_scc0 L_v_sv_253
    s_sleep 1
L_v_sv_253:
    s_sleep 3
    s_mov_b32 s70, 1
    buffer_load_dwordx4 v[64:67], v11, s[12:15], s62 offen offset:0 sc1
    buffer_load_dwordx4 v[68:71], v11, s[12:15], s62 offen offset:1024 sc1
L_v_vp_254_m:
    s_waitcnt vmcnt(0)
    v_max3_u32 v20, v64, v65, v66
    v_max3_u32 v20, v20, v67, v68
    v_max3_u32 v20, v20, v69, v70
    v_max_u32 v20, v20, v71
    v_cmp_eq_u32 vcc, -1, v20
    s_cbranch_vccnz L_rt_255
    v_smfmac_f32_16x16x64_bf16 v[96:99], v[64:67], a[64:71], v3
    v_smfmac_f32_16x16x64_bf16 v[96:99], v[68:71], a[72:79], v3
    v_smfmac_f32_16x16x64_bf16 v[100:103], v[64:67], a[80:87], v3
    v_smfmac_f32_16x16x64_bf16 v[100:103], v[68:71], a[88:95], v3
    v_smfmac_f32_16x16x64_bf16 v[104:107], v[64:67], a[96:103], v3
    v_smfmac_f32_16x16x64_bf16 v[104:107], v[68:71], a[104:111], v3
    v_smfmac_f32_16x16x64_bf16 v[108:111], v[64:67], a[112:119], v3
    v_smfmac_f32_16x16x64_bf16 v[108:111], v[68:71], a[120:127], v3
    s_nop 1
    v_cvt_pk_bf16_f32 v96, v96, v97
    v_cvt_pk_bf16_f32 v97, v98, v99
    ds_write_b64 v12, v[96:97] offset:0
    v_cvt_pk_bf16_f32 v100, v100, v101
    v_cvt_pk_bf16_f32 v101, v102, v103
    ds_write_b64 v12, v[100:101] offset:2048
    v_cvt_pk_bf16_f32 v104, v104, v105
    v_cvt_pk_bf16_f32 v105, v106, v107
    ds_write_b64 v12, v[104:105] offset:4096
    v_cvt_pk_bf16_f32 v108, v108, v109
    v_cvt_pk_bf16_f32 v109, v110, v111
    ds_write_b64 v12, v[108:109] offset:6144
    s_bitcmp1_b32 s44, 0
    s_cbranch_scc1 L_v_r8_256
    s_add_u32 s46, s65, 4096
    buffer_load_dwordx4 v[32:35], v15, s[12:15], s65 offen offset:0 sc1
    buffer_load_dwordx4 v[48:51], v15, s[12:15], s46 offen offset:0 sc1
    buffer_load_dwordx4 v[36:39], v15, s[12:15], s65 offen offset:1024 sc1
    buffer_load_dwordx4 v[52:55], v15, s[12:15], s46 offen offset:1024 sc1
    buffer_load_dwordx4 v[40:43], v15, s[12:15], s65 offen offset:2048 sc1
    buffer_load_dwordx4 v[56:59], v15, s[12:15], s46 offen offset:2048 sc1
    buffer_load_dwordx4 v[44:47], v15, s[12:15], s65 offen offset:3072 sc1
    buffer_load_dwordx4 v[60:63], v15, s[12:15], s46 offen offset:3072 sc1
    s_add_u32 s65, s65, 786432
L_v_r8_256:
    s_waitcnt lgkmcnt(0)
    s_barrier
    ds_read_b128 v[96:99], v2 offset:16384
    ds_read_b128 v[100:103], v2 offset:17408
    ds_read_b128 v[104:107], v2 offset:18432
    ds_read_b128 v[108:111], v2 offset:19456
    ds_read_b128 v[112:115], v31 offset:0
    ds_read_b128 v[116:119], v25 offset:0
    ds_read_b128 v[120:123], v31 offset:512
    ds_read_b128 v[124:127], v25 offset:1024
    s_waitcnt lgkmcnt(7)
    v_mfma_f32_16x16x32_bf16 v[16:19], v[80:83], v[96:99], 0
    s_waitcnt lgkmcnt(6)
    v_mfma_f32_16x16x32_bf16 v[16:19], v[84:87], v[100:103], v[16:19]
    s_waitcnt lgkmcnt(5)
    v_mfma_f32_16x16x32_bf16 v[16:19], v[88:91], v[104:107], v[16:19]
    s_waitcnt lgkmcnt(4)
    v_mfma_f32_16x16x32_bf16 v[16:19], v[92:95], v[108:111], v[16:19]
    s_waitcnt lgkmcnt(2)
    v_mfma_f32_16x16x32_bf16 v[16:19], v[116:119], v[112:115], v[16:19]
    s_waitcnt lgkmcnt(0)
    v_mfma_f32_16x16x32_bf16 v[16:19], v[124:127], v[120:123], v[16:19]
    s_mov_b32 exec_lo, 0x00ff00ff
    s_mov_b32 exec_hi, 0x00ff00ff
    s_nop 5
    v_cvt_pk_bf16_f32 v16, v16, v17
    v_cvt_pk_bf16_f32 v17, v18, v19
    v_min_u32 v16, -2, v16
    v_min_u32 v17, -2, v17
    buffer_store_dwordx2 v[16:17], v6, s[12:15], s63 offen sc1
    s_mov_b64 exec, -1
    s_add_u32 s61, s61, 0x4000
    s_and_b32 s61, s61, 0xffff
    s_mov_b32 s70, 1
    s_waitcnt vmcnt(1)
    s_sleep 8
    buffer_load_dword v96, v7, s[12:15], s63 offen offset:0 sc1
    buffer_load_dword v97, v7, s[12:15], s63 offen offset:256 sc1
    buffer_load_dword v98, v7, s[12:15], s63 offen offset:512 sc1
    buffer_load_dword v99, v7, s[12:15], s63 offen offset:768 sc1
    buffer_load_dword v100, v7, s[12:15], s63 offen offset:1024 sc1
    buffer_load_dword v101, v7, s[12:15], s63 offen offset:1280 sc1
    buffer_load_dword v102, v7, s[12:15], s63 offen offset:1536 sc1
    buffer_load_dword v103, v7, s[12:15], s63 offen offset:1792 sc1
    v_mfma_f32_16x16x32_bf16 v[64:67], v[32:35], a[64:67], 0
    v_mfma_f32_16x16x32_bf16 v[68:71], v[48:51], a[64:67], 0
    v_mfma_f32_16x16x32_bf16 v[64:67], v[36:39], a[68:71], v[64:67]
    v_mfma_f32_16x16x32_bf16 v[68:71], v[52:55], a[68:71], v[68:71]
    v_mfma_f32_16x16x32_bf16 v[64:67], v[40:43], a[72:75], v[64:67]
    v_mfma_f32_16x16x32_bf16 v[68:71], v[56:59], a[72:75], v[68:71]
    v_mfma_f32_16x16x32_bf16 v[64:67], v[44:47], a[76:79], v[64:67]
    v_mfma_f32_16x16x32_bf16 v[68:71], v[60:63], a[76:79], v[68:71]
    v_mfma_f32_16x16x32_bf16 v[72:75], v[32:35], a[80:83], 0
    v_mfma_f32_16x16x32_bf16 v[76:79], v[48:51], a[80:83], 0
    v_mfma_f32_16x16x32_bf16 v[72:75], v[36:39], a[84:87], v[72:75]
    v_mfma_f32_16x16x32_bf16 v[76:79], v[52:55], a[84:87], v[76:79]
    v_mfma_f32_16x16x32_bf16 v[72:75], v[40:43], a[88:91], v[72:75]
    v_mfma_f32_16x16x32_bf16 v[76:79], v[56:59], a[88:91], v[76:79]
    v_mfma_f32_16x16x32_bf16 v[72:75], v[44:47], a[92:95], v[72:75]
    v_mfma_f32_16x16x32_bf16 v[76:79], v[60:63], a[92:95], v[76:79]
    v_cvt_pk_bf16_f32 v64, v64, v65
    v_cvt_pk_bf16_f32 v65, v66, v67
    v_cvt_pk_bf16_f32 v66, v68, v69
    v_cvt_pk_bf16_f32 v67, v70, v71
    ds_write_b128 v10, v[64:67] offset:32768
    v_mfma_f32_16x16x32_bf16 v[80:83], v[32:35], a[96:99], 0
    v_mfma_f32_16x16x32_bf16 v[84:87], v[48:51], a[96:99], 0
    v_mfma_f32_16x16x32_bf16 v[80:83], v[36:39], a[100:103], v[80:83]
    v_mfma_f32_16x16x32_bf16 v[84:87], v[52:55], a[100:103], v[84:87]
    v_mfma_f32_16x16x32_bf16 v[80:83], v[40:43], a[104:107], v[80:83]
    v_mfma_f32_16x16x32_bf16 v[84:87], v[56:59], a[104:107], v[84:87]
    v_mfma_f32_16x16x32_bf16 v[80:83], v[44:47], a[108:111], v[80:83]
    v_mfma_f32_16x16x32_bf16 v[84:87], v[60:63], a[108:111], v[84:87]
    v_cvt_pk_bf16_f32 v72, v72, v73
    v_cvt_pk_bf16_f32 v73, v74, v75
    v_cvt_pk_bf16_f32 v74, v76, v77
    v_cvt_pk_bf16_f32 v75, v78, v79
    ds_write_b128 v10, v[72:75] offset:33792
L_v_gp_257:
    s_waitcnt vmcnt(7)
    v_lshlrev_b32 v20, 16, v96
    v_and_b32 v21, 0xffff0000, v96
    s_waitcnt vmcnt(6)
    v_lshlrev_b32 v22, 16, v97
    v_and_b32 v23, 0xffff0000, v97
    v_add_f32 v20, v20, v22
    v_add_f32 v21, v21, v23
    s_waitcnt vmcnt(5)
    v_lshlrev_b32 v22, 16, v98
    v_and_b32 v23, 0xffff0000, v98
    v_add_f32 v20, v20, v22
    v_add_f32 v21, v21, v23
    s_waitcnt vmcnt(4)
    v_lshlrev_b32 v22, 16, v99
    v_and_b32 v23, 0xffff0000, v99
    v_add_f32 v20, v20, v22
    v_add_f32 v21, v21, v23
    s_waitcnt vmcnt(3)
    v_lshlrev_b32 v22, 16, v100
    v_and_b32 v23, 0xffff0000, v100
    v_add_f32 v20, v20, v22
    v_add_f32 v21, v21, v23
    s_waitcnt vmcnt(2)
    v_lshlrev_b32 v22, 16, v101
    v_and_b32 v23, 0xffff0000, v101
    v_add_f32 v20, v20, v22
    v_add_f32 v21, v21, v23
    s_waitcnt vmcnt(1)
    v_lshlrev_b32 v22, 16, v102
    v_and_b32 v23, 0xffff0000, v102
    v_add_f32 v20, v20, v22
    v_add_f32 v21, v21, v23
    s_waitcnt vmcnt(0)
    v_lshlrev_b32 v22, 16, v103
    v_and_b32 v23, 0xffff0000, v103
    v_add_f32 v20, v20, v22
    v_add_f32 v21, v21, v23
    v_cmp_u_f32 vcc, v20, v21
    v_cvt_pk_bf16_f32 v20, v20, v21
    s_cbranch_vccnz L_v_gf_259
L_v_gok_258:
    buffer_store_dword v20, v8, s[12:15], s61 offen sc1
    s_xor_b32 s45, s61, 0x8000
    buffer_store_dword v26, v8, s[12:15], s45 offen sc1
    s_bitcmp1_b32 s44, 0
    s_cbranch_scc1 L_v_nr_260
    s_xor_b32 s45, s62, 0x4000
    buffer_store_dword v26, v4, s[12:15], s45 offen sc1
L_v_nr_260:
    s_add_u32 s60, s60, 1
    s_add_u32 s62, s62, 0x2000
    s_and_b32 s62, s62, 0x7fff
    s_and_b32 s45, s60, 0x38
    s_bitcmp1_b64 s[66:67], s45
    s_cselect_b32 s45, 8192, 0
    s_lshl_b32 s63, s60, 18
    s_add_u32 s63, s63, s45
    v_mfma_f32_16x16x32_bf16 v[88:91], v[32:35], a[112:115], 0
    v_mfma_f32_16x16x32_bf16 v[92:95], v[48:51], a[112:115], 0
    v_mfma_f32_16x16x32_bf16 v[88:91], v[36:39], a[116:119], v[88:91]
    v_mfma_f32_16x16x32_bf16 v[92:95], v[52:55], a[116:119], v[92:95]
    v_mfma_f32_16x16x32_bf16 v[88:91], v[40:43], a[120:123], v[88:91]
    v_mfma_f32_16x16x32_bf16 v[92:95], v[56:59], a[120:123], v[92:95]
    v_mfma_f32_16x16x32_bf16 v[88:91], v[44:47], a[124:127], v[88:91]
    v_mfma_f32_16x16x32_bf16 v[92:95], v[60:63], a[124:127], v[92:95]
    v_cvt_pk_bf16_f32 v80, v80, v81
    v_cvt_pk_bf16_f32 v81, v82, v83
    v_cvt_pk_bf16_f32 v82, v84, v85
    v_cvt_pk_bf16_f32 v83, v86, v87
    ds_write_b128 v10, v[80:83] offset:34816
    s_nop 2
    v_cvt_pk_bf16_f32 v88, v88, v89
    v_cvt_pk_bf16_f32 v89, v90, v91
    v_cvt_pk_bf16_f32 v90, v92, v93
    v_cvt_pk_bf16_f32 v91, v94, v95
    ds_write_b128 v10, v[88:91] offset:35840
    s_sleep 3
    s_branch L_v_loop_245
L_v_last_249:
    s_waitcnt lgkmcnt(0)
    s_barrier
    s_branch L_replica
L_v_l1_246:
    s_mov_b64 exec, s[48:49]
    s_cbranch_execz L_v_ls_261
    buffer_load_dwordx4 v[64:67], v9, s[12:15], s61 offen offset:0 sc1
L_v_ls_261:
    s_mov_b64 exec, s[50:51]
    s_cbranch_execz L_v_ls_262
    buffer_load_dwordx4 v[68:71], v9, s[12:15], s61 offen offset:1024 sc1
L_v_ls_262:
    s_mov_b64 exec, s[52:53]
    s_cbranch_execz L_v_ls_263
    buffer_load_dwordx4 v[72:75], v9, s[12:15], s61 offen offset:2048 sc1
L_v_ls_263:
    s_mov_b64 exec, s[54:55]
    s_cbranch_execz L_v_ls_264
    buffer_load_dwordx4 v[76:79], v9, s[12:15], s61 offen offset:3072 sc1
L_v_ls_264:
    s_mov_b64 exec, -1
    s_add_u32 s70, s70, 1
    s_cmp_ge_u32 s70, 524288
    s_cbranch_scc1 L_c_done_1
    s_waitcnt vmcnt(0)
    s_cmp_eq_u64 s[48:49], 0
    s_cbranch_scc1 L_v_lc_265
    ds_write_b128 v10, v[64:67] offset:0
    v_max3_u32 v24, v64, v65, v66
    v_max_u32 v24, v24, v67
    v_cmp_eq_u32 s[48:49], -1, v24
L_v_lc_265:
    s_cmp_eq_u64 s[50:51], 0
    s_cbranch_scc1 L_v_lc_266
    ds_write_b128 v10, v[68:71] offset:1024
    v_max3_u32 v24, v68, v69, v70
    v_max_u32 v24, v24, v71
    v_cmp_eq_u32 s[50:51], -1, v24
L_v_lc_266:
    s_cmp_eq_u64 s[52:53], 0
    s_cbranch_scc1 L_v_lc_267
    ds_write_b128 v10, v[72:75] offset:2048
    v_max3_u32 v24, v72, v73, v74
    v_max_u32 v24, v24, v75
    v_cmp_eq_u32 s[52:53], -1, v24
L_v_lc_267:
    s_cmp_eq_u64 s[54:55], 0
    s_cbranch_scc1 L_v_lc_268
    ds_write_b128 v10, v[76:79] offset:3072
    v_max3_u32 v24, v76, v77, v78
    v_max_u32 v24, v24, v79
    v_cmp_eq_u32 s[54:55], -1, v24
L_v_lc_268:
    s_or_b64 s[46:47], s[48:49], s[50:51]
    s_or_b64 vcc, s[52:53], s[54:55]
    s_or_b64 vcc, vcc, s[46:47]
    s_cbranch_scc1 L_v_l1_246
    s_branch L_v_l1ok_248
L_v_k1_250_c:
    s_add_u32 s46, s65, 4096
    buffer_load_dwordx4 v[32:35], v15, s[12:15], s65 offen offset:0 sc1
    buffer_load_dwordx4 v[48:51], v15, s[12:15], s46 offen offset:0 sc1
    buffer_load_dwordx4 v[36:39], v15, s[12:15], s65 offen offset:1024 sc1
    buffer_load_dwordx4 v[52:55], v15, s[12:15], s46 offen offset:1024 sc1
    buffer_load_dwordx4 v[40:43], v15, s[12:15], s65 offen offset:2048 sc1
    buffer_load_dwordx4 v[56:59], v15, s[12:15], s46 offen offset:2048 sc1
    buffer_load_dwordx4 v[44:47], v15, s[12:15], s65 offen offset:3072 sc1
    buffer_load_dwordx4 v[60:63], v15, s[12:15], s46 offen offset:3072 sc1
    s_add_u32 s65, s65, 786432
    s_branch L_v_k1_250
L_rt_252:
    s_add_u32 s70, s70, 1
    s_cmp_lt_u32 s70, 524288
    s_cbranch_scc1 L_v_rl_251
    s_branch L_c_done_1
L_v_vp_254:
    buffer_load_dwordx4 v[64:67], v11, s[12:15], s62 offen offset:0 sc1
    buffer_load_dwordx4 v[68:71], v11, s[12:15], s62 offen offset:1024 sc1
    s_branch L_v_vp_254_m
L_rt_255:
    s_add_u32 s70, s70, 1
    s_cmp_lt_u32 s70, 524288
    s_cbranch_scc1 L_v_vp_254
    s_branch L_c_done_1
L_v_gf_259:
    v_max3_u32 v24, v96, v97, v98
    v_max3_u32 v24, v24, v99, v100
    v_max3_u32 v24, v24, v101, v102
    v_max_u32 v24, v24, v103
    v_cmp_eq_u32 vcc, -1, v24
    v_min_u32 v20, -2, v20
    s_add_u32 s70, s70, 1
    s_cbranch_vccz L_v_gok_258
    buffer_load_dword v96, v7, s[12:15], s63 offen offset:0 sc1
    buffer_load_dword v97, v7, s[12:15], s63 offen offset:256 sc1
    buffer_load_dword v98, v7, s[12:15], s63 offen offset:512 sc1
    buffer_load_dword v99, v7, s[12:15], s63 offen offset:768 sc1
    buffer_load_dword v100, v7, s[12:15], s63 offen offset:1024 sc1
    buffer_load_dword v101, v7, s[12:15], s63 offen offset:1280 sc1
    buffer_load_dword v102, v7, s[12:15], s63 offen offset:1536 sc1
    buffer_load_dword v103, v7, s[12:15], s63 offen offset:1792 sc1
    s_cmp_lt_u32 s70, 524288
    s_cbranch_scc1 L_v_gp_257
    s_branch L_c_done_1
L_c_done_1:
    s_endpgm
.section .rodata,"a"
.p2align 6
.amdhsa_kernel k3_chain_kernel
  .amdhsa_next_free_vgpr 256
  .amdhsa_next_free_sgpr 102
  .amdhsa_accum_offset 128
  .amdhsa_group_segment_fixed_size 0
  .amdhsa_kernarg_size 136
  .amdhsa_user_sgpr_count 2
  .amdhsa_user_sgpr_kernarg_segment_ptr 1
  .amdhsa_system_sgpr_workgroup_id_x 1
.end_amdhsa_kernel
```

```asm
; @launch kernel=k3_chain_kernel grid=(256,1,1) block=(512,1,1) lds=147712
.amdgcn_target "amdgcn-amd-amdhsa--gfx950"
.text
.globl k3_chain_kernel
.p2align 8
.type k3_chain_kernel,@function
k3_chain_kernel:
    s_cmp_ge_u32 s2, 256
    s_cbranch_scc1 L_c_done_1
    s_load_dwordx4 s[20:23], s[0:1], 120
    v_and_b32 v1, 63, v0
    v_lshrrev_b32 v2, 6, v0
    s_nop 0
    v_readfirstlane_b32 s44, v2
    s_waitcnt lgkmcnt(0)
    s_mov_b32 s12, s22
    s_and_b32 s13, s23, 0xffff
    s_mov_b32 s14, 0x10000000
    s_mov_b32 s15, 0x00020000
    s_mov_b32 s16, s20
    s_and_b32 s17, s21, 0xffff
    s_mov_b32 s18, 0x100
    s_mov_b32 s19, 0x00020000
    s_getpc_b64 s[24:25]
L_c_here_2:
    v_lshlrev_b32 v3, 7, v0
    v_mov_b32 v5, s25
    v_add_co_u32 v4, vcc, s24, v3
    s_nop 1
    v_addc_co_u32 v5, vcc, 0, v5, vcc
    v_cmp_gt_u32 vcc, L_c_done_1 - L_c_here_2, v3
    s_and_saveexec_b64 s[26:27], vcc
    s_cbranch_execz L_c_ct_3
    global_load_dword v109, v[4:5], off
L_c_ct_3:
    s_mov_b64 exec, s[26:27]
    s_load_dwordx4 s[8:11], s[0:1], 96
    v_lshrrev_b32 v5, 3, v0
    v_mul_u32_u24 v6, 24576, v5
    v_and_b32 v7, 7, v0
    v_lshl_add_u32 v6, v7, 4, v6
    v_add_u32 v7, 12288, v6
    v_lshlrev_b32 v5, 2, v5
    s_lshr_b32 s50, s2, 5
    s_and_b32 s51, s2, 31
    s_mul_i32 s52, s50, 1572864
    s_lshl_b32 s53, s51, 7
    s_add_u32 s52, s52, s53
    s_lshl_b32 s53, s50, 8
    s_waitcnt lgkmcnt(0)
    s_mov_b32 s28, s10
    s_and_b32 s29, s11, 0xffff
    s_mov_b32 s30, 0xc00000
    s_mov_b32 s31, 0x00020000
    s_mov_b32 s32, s8
    s_and_b32 s33, s9, 0xffff
    s_mov_b32 s34, 0x800
    s_mov_b32 s35, 0x00020000
    buffer_load_dword v8, v5, s[32:35], s53 offen
    buffer_load_dwordx4 v[12:15], v6, s[28:31], s52 offen
    buffer_load_dwordx4 v[16:19], v7, s[28:31], s52 offen
    s_getreg_b32 s39, hwreg(HW_REG_XCC_ID)
    s_and_b32 s39, s39, 7
    s_cmp_lg_u32 s44, 1
    s_cbranch_scc1 L_nz_7
    v_mov_b32 v32, 0
    v_mov_b32 v33, 0
    v_mov_b32 v34, 0
    v_mov_b32 v35, 0
    v_lshlrev_b32 v4, 4, v1
    s_lshl_b32 s45, s2, 10
    s_add_u32 s45, s45, 0x100000
    buffer_store_dwordx4 v[32:35], v4, s[12:15], s45 offen sc1
L_nz_7:
    s_waitcnt vmcnt(0)
    v_lshlrev_b32 v9, 16, v8
    v_and_b32 v10, 0xffff0000, v8
    v_mul_f32 v20, 0xbfb8aa3b, v9
    v_mul_f32 v21, 0xbfb8aa3b, v10
    v_exp_f32 v20, v20
    v_exp_f32 v21, v21
    s_nop 0
    v_add_f32 v20, 1.0, v20
    v_add_f32 v21, 1.0, v21
    v_rcp_f32 v20, v20
    v_rcp_f32 v21, v21
    s_nop 0
    v_mul_f32 v9, v9, v20
    v_mul_f32 v10, v10, v21
    v_cvt_pk_bf16_f32 v9, 0, v9
    v_cvt_pk_bf16_f32 v10, 0, v10
    v_lshlrev_b32 v28, 16, v12
    v_and_b32 v29, 0xffff0000, v12
    v_lshlrev_b32 v30, 16, v16
    v_and_b32 v31, 0xffff0000, v16
    v_mul_f32 v20, v28, v9
    v_mul_f32 v21, v29, v9
    v_fmac_f32 v20, v30, v10
    v_fmac_f32 v21, v31, v10
    v_lshlrev_b32 v28, 16, v13
    v_and_b32 v29, 0xffff0000, v13
    v_lshlrev_b32 v30, 16, v17
    v_and_b32 v31, 0xffff0000, v17
    v_mul_f32 v22, v28, v9
    v_mul_f32 v23, v29, v9
    v_fmac_f32 v22, v30, v10
    v_fmac_f32 v23, v31, v10
    v_lshlrev_b32 v28, 16, v14
    v_and_b32 v29, 0xffff0000, v14
    v_lshlrev_b32 v30, 16, v18
    v_and_b32 v31, 0xffff0000, v18
    v_mul_f32 v24, v28, v9
    v_mul_f32 v25, v29, v9
    v_fmac_f32 v24, v30, v10
    v_fmac_f32 v25, v31, v10
    v_lshlrev_b32 v28, 16, v15
    v_and_b32 v29, 0xffff0000, v15
    v_lshlrev_b32 v30, 16, v19
    v_and_b32 v31, 0xffff0000, v19
    v_mul_f32 v26, v28, v9
    v_mul_f32 v27, v29, v9
    v_fmac_f32 v26, v30, v10
    v_fmac_f32 v27, v31, v10
    s_nop 1
    v_add_f32_dpp v20, v20, v20 row_ror:8 row_mask:0xf bank_mask:0xf
    v_add_f32_dpp v21, v21, v21 row_ror:8 row_mask:0xf bank_mask:0xf
    v_add_f32_dpp v22, v22, v22 row_ror:8 row_mask:0xf bank_mask:0xf
    v_add_f32_dpp v23, v23, v23 row_ror:8 row_mask:0xf bank_mask:0xf
    v_add_f32_dpp v24, v24, v24 row_ror:8 row_mask:0xf bank_mask:0xf
    v_add_f32_dpp v25, v25, v25 row_ror:8 row_mask:0xf bank_mask:0xf
    v_add_f32_dpp v26, v26, v26 row_ror:8 row_mask:0xf bank_mask:0xf
    v_add_f32_dpp v27, v27, v27 row_ror:8 row_mask:0xf bank_mask:0xf
    s_nop 1
    v_permlane16_swap_b32 v20, v24
    v_permlane16_swap_b32 v21, v25
    v_permlane16_swap_b32 v22, v26
    v_permlane16_swap_b32 v23, v27
    v_add_f32 v20, v20, v24
    v_add_f32 v21, v21, v25
    v_add_f32 v22, v22, v26
    v_add_f32 v23, v23, v27
    s_nop 1
    v_permlane32_swap_b32 v20, v22
    v_permlane32_swap_b32 v21, v23
    v_add_f32 v20, v20, v22
    v_add_f32 v21, v21, v23
    v_and_b32 v22, 7, v1
    v_lshlrev_b32 v22, 5, v22
    v_bfe_u32 v23, v1, 4, 1
    v_lshl_add_u32 v22, v23, 4, v22
    v_lshrrev_b32 v23, 5, v1
    v_lshl_add_u32 v22, v23, 3, v22
    s_lshl_b32 s52, s44, 8
    s_add_u32 s52, s52, 139776
    v_add_u32 v22, s52, v22
    ds_write_b64 v22, v[20:21]
    s_waitcnt lgkmcnt(0)
    s_barrier
    s_cmp_lg_u32 s44, 1
    s_cbranch_scc1 L_m1_8
    v_lshlrev_b32 v22, 2, v1
    v_add_u32 v23, 139776, v22
    ds_read_b32 v24, v23 offset:0
    ds_read_b32 v25, v23 offset:256
    ds_read_b32 v26, v23 offset:512
    ds_read_b32 v27, v23 offset:768
    ds_read_b32 v28, v23 offset:1024
    ds_read_b32 v29, v23 offset:1280
    ds_read_b32 v30, v23 offset:1536
    ds_read_b32 v31, v23 offset:1792
    s_waitcnt lgkmcnt(0)
    v_add_f32 v24, v24, v28
    v_add_f32 v25, v25, v29
    v_add_f32 v26, v26, v30
    v_add_f32 v27, v27, v31
    v_add_f32 v24, v24, v26
    v_add_f32 v25, v25, v27
    v_add_f32 v24, v24, v25
    s_lshl_b32 s52, s2, 8
    s_add_u32 s52, s52, 0x10000
    buffer_store_dword v24, v22, s[12:15], s52 offen sc1
L_m1_8:
    s_cmp_lg_u32 s44, 1
    s_cbranch_scc1 L_tk_4
    v_mov_b32 v3, 1
    s_mov_b32 s40, s39
    s_lshl_b32 s45, s40, 5
    v_mov_b32 v4, 0
    s_waitcnt vmcnt(0)
    s_mov_b64 exec, 1
    buffer_atomic_add v3, v4, s[16:19], s45 offen sc0
    s_waitcnt vmcnt(0)
    v_readfirstlane_b32 s41, v3
    s_nop 3
    s_cmp_lt_u32 s41, 32
    s_cbranch_scc1 L_got_5
    v_mov_b32 v3, 1
    buffer_atomic_add v3, v4, s[16:19], 0 offen offset:16 sc0
    s_waitcnt vmcnt(0)
    v_readfirstlane_b32 s46, v3
    s_mov_b64 exec, -1
    v_and_b32 v4, 7, v1
    v_lshlrev_b32 v4, 5, v4
    s_mov_b32 s70, 0
L_sp_6:
    s_sleep 8
    buffer_load_dword v3, v4, s[16:19], 0 offen sc1
    s_waitcnt vmcnt(0)
    s_mov_b32 s48, 0
    v_readlane_b32 s50, v3, 0
    v_readlane_b32 s51, v3, 1
    v_readlane_b32 s52, v3, 2
    v_readlane_b32 s53, v3, 3
    v_readlane_b32 s54, v3, 4
    v_readlane_b32 s55, v3, 5
    v_readlane_b32 s56, v3, 6
    v_readlane_b32 s57, v3, 7
    s_nop 3
    s_add_u32 s48, s48, s50
    s_add_u32 s48, s48, s51
    s_add_u32 s48, s48, s52
    s_add_u32 s48, s48, s53
    s_add_u32 s48, s48, s54
    s_add_u32 s48, s48, s55
    s_add_u32 s48, s48, s56
    s_add_u32 s48, s48, s57
    s_add_u32 s70, s70, 1
    s_cmp_ge_u32 s70, 524288
    s_cbranch_scc1 L_c_done_1
    s_cmp_lt_u32 s48, 256
    s_cbranch_scc1 L_sp_6
    s_min_u32 s48, s50, 32
    s_mov_b32 s40, 0
    s_add_u32 s41, s48, s46
    s_cmp_lt_u32 s41, 32
    s_cbranch_scc1 L_got_5
    s_sub_u32 s46, s41, 32
    s_min_u32 s48, s51, 32
    s_mov_b32 s40, 1
    s_add_u32 s41, s48, s46
    s_cmp_lt_u32 s41, 32
    s_cbranch_scc1 L_got_5
    s_sub_u32 s46, s41, 32
    s_min_u32 s48, s52, 32
    s_mov_b32 s40, 2
    s_add_u32 s41, s48, s46
    s_cmp_lt_u32 s41, 32
    s_cbranch_scc1 L_got_5
    s_sub_u32 s46, s41, 32
    s_min_u32 s48, s53, 32
    s_mov_b32 s40, 3
    s_add_u32 s41, s48, s46
    s_cmp_lt_u32 s41, 32
    s_cbranch_scc1 L_got_5
    s_sub_u32 s46, s41, 32
    s_min_u32 s48, s54, 32
    s_mov_b32 s40, 4
    s_add_u32 s41, s48, s46
    s_cmp_lt_u32 s41, 32
    s_cbranch_scc1 L_got_5
    s_sub_u32 s46, s41, 32
    s_min_u32 s48, s55, 32
    s_mov_b32 s40, 5
    s_add_u32 s41, s48, s46
    s_cmp_lt_u32 s41, 32
    s_cbranch_scc1 L_got_5
    s_sub_u32 s46, s41, 32
    s_min_u32 s48, s56, 32
    s_mov_b32 s40, 6
    s_add_u32 s41, s48, s46
    s_cmp_lt_u32 s41, 32
    s_cbranch_scc1 L_got_5
    s_sub_u32 s46, s41, 32
    s_min_u32 s48, s57, 32
    s_mov_b32 s40, 7
    s_add_u32 s41, s48, s46
    s_cmp_lt_u32 s41, 32
    s_cbranch_scc1 L_got_5
    s_sub_u32 s46, s41, 32
    s_branch L_c_done_1
L_got_5:
    s_mov_b64 exec, -1
    s_lshl_b32 s45, s40, 8
    s_or_b32 s45, s45, s41
    v_mov_b32 v3, s45
    v_mov_b32 v4, 147464
    ds_write_b32 v4, v3
    s_waitcnt lgkmcnt(0)
L_tk_4:
    s_barrier
    v_mov_b32 v4, 147464
    ds_read_b32 v3, v4
    s_waitcnt lgkmcnt(0)
    v_readfirstlane_b32 s45, v3
    s_nop 3
    s_lshr_b32 s40, s45, 8
    s_and_b32 s41, s45, 0xff
    s_lshr_b32 s45, s40, 2
    s_xor_b32 s45, s45, 1
    s_lshl_b32 s45, s45, 4
    s_and_b32 s40, s40, 3
    s_lshl_b32 s40, s40, 1
    s_lshr_b32 s46, s41, 4
    s_add_u32 s40, s40, s46
    s_and_b32 s41, s41, 15
    s_add_u32 s41, s41, s45
    s_cmp_lt_u32 s41, 16
    s_cbranch_scc1 L_c_chain_9
    s_sub_u32 s48, s41, 16
    s_cmp_lt_u32 s48, 12
    s_cbranch_scc1 L_w_g_10
    s_and_b32 s42, s48, 3
    s_mov_b32 s43, s40
    s_load_dwordx2 s[4:5], s[0:1], 0
    v_lshlrev_b32 v2, 4, v1
    v_lshlrev_b32 v3, 5, v1
    s_lshl_b32 s55, s43, 2
    s_add_u32 s55, s55, s42
    s_waitcnt lgkmcnt(0)
    s_mov_b32 s24, s4
    s_and_b32 s25, s5, 0xffff
    s_mov_b32 s26, 0x400000
    s_mov_b32 s27, 0x00020000
    s_lshl_b32 s46, s42, 3
    s_add_u32 s46, s46, s44
    s_lshl_b32 s46, s46, 11
    v_add_u32 v7, s46, v2
    s_lshl_b32 s63, s43, 16
    buffer_load_dwordx4 a[0:3], v7, s[24:27], s63 offen
    buffer_load_dwordx4 a[4:7], v7, s[24:27], s63 offen offset:1024
    s_cmp_lg_u32 s44, 0
    s_cbranch_scc1 L_zwok_19
    v_and_b32 v8, 7, v1
    v_lshlrev_b32 v8, 5, v8
    s_mov_b32 s70, 0
L_zw_18:
    buffer_load_dword v9, v8, s[16:19], 0 offen sc1
    s_waitcnt vmcnt(0)
    v_add_u32_dpp v9, v9, v9 row_ror:1 row_mask:0xf bank_mask:0xf
    s_nop 1
    v_add_u32_dpp v9, v9, v9 row_ror:2 row_mask:0xf bank_mask:0xf
    s_nop 1
    v_add_u32_dpp v9, v9, v9 row_ror:4 row_mask:0xf bank_mask:0xf
    v_cmp_ne_u32 vcc, 0x100, v9
    s_add_u32 s70, s70, 1
    s_cbranch_vccz L_zwok_19
    s_sleep 4
    s_cmp_lt_u32 s70, 524288
    s_cbranch_scc1 L_zw_18
    s_branch L_c_done_1
L_zwok_19:
    s_barrier
    v_lshlrev_b32 v4, 4, v0
    s_mov_b32 s46, 0x10000
    buffer_load_dwordx4 v[32:35], v4, s[12:15], s46 offen sc1
    s_mov_b32 s46, 0x12000
    buffer_load_dwordx4 v[36:39], v4, s[12:15], s46 offen sc1
    s_mov_b32 s46, 0x14000
    buffer_load_dwordx4 v[40:43], v4, s[12:15], s46 offen sc1
    s_mov_b32 s46, 0x16000
    buffer_load_dwordx4 v[44:47], v4, s[12:15], s46 offen sc1
    s_mov_b32 s46, 0x18000
    buffer_load_dwordx4 v[48:51], v4, s[12:15], s46 offen sc1
    s_mov_b32 s46, 0x1a000
    buffer_load_dwordx4 v[52:55], v4, s[12:15], s46 offen sc1
    s_mov_b32 s46, 0x1c000
    buffer_load_dwordx4 v[56:59], v4, s[12:15], s46 offen sc1
    s_mov_b32 s46, 0x1e000
    buffer_load_dwordx4 v[60:63], v4, s[12:15], s46 offen sc1
    s_cmp_lg_u32 s44, 0
    s_cbranch_scc1 L_l_nx_20
    s_cmp_ge_u32 s42, 2
    s_cbranch_scc1 L_l_nx_20
    s_or_b32 s47, s39, 0x100
    v_mov_b32 v8, s47
    v_mov_b32 v9, 0
    s_lshl_b32 s46, s40, 3
    s_lshl_b32 s47, s42, 2
    s_add_u32 s46, s46, s47
    s_add_u32 s46, s46, 0x101200
    s_mov_b64 exec, 1
    buffer_store_dword v8, v9, s[12:15], s46 offen sc1
    s_mov_b64 exec, -1
L_l_nx_20:
    s_mul_i32 s46, s44, 2064
    s_add_u32 s46, s46, 32768
    v_add_u32 v10, s46, v2
    v_and_b32 v11, 7, v1
    v_lshrrev_b32 v12, 3, v1
    v_mul_u32_u24 v13, 2064, v11
    v_lshl_add_u32 v13, v12, 4, v13
    s_lshl_b32 s46, s44, 8
    s_add_u32 s46, s46, 32768
    v_add_u32 v13, s46, v13
    v_lshlrev_b32 v11, 4, v11
    v_lshl_add_u32 v11, v12, 9, v11
    s_lshl_b32 s46, s44, 13
    s_lshl_b32 s47, s42, 7
    s_add_u32 s46, s46, s47
    s_add_u32 s46, s46, 0x400000
    v_add_u32 v11, s46, v11
    v_add_u32 v12, 4096, v11
    s_lshl_b32 s52, s43, 9
    s_lshl_b32 s47, s42, 7
    s_add_u32 s52, s52, s47
    s_add_u32 s52, s52, 0x109400
    s_mov_b32 s60, s43
    s_waitcnt vmcnt(0)
    v_add_f32 v32, v32, v48
    v_add_f32 v33, v33, v49
    v_add_f32 v34, v34, v50
    v_add_f32 v35, v35, v51
    v_add_f32 v36, v36, v52
    v_add_f32 v37, v37, v53
    v_add_f32 v38, v38, v54
    v_add_f32 v39, v39, v55
    v_add_f32 v40, v40, v56
    v_add_f32 v41, v41, v57
    v_add_f32 v42, v42, v58
    v_add_f32 v43, v43, v59
    v_add_f32 v44, v44, v60
    v_add_f32 v45, v45, v61
    v_add_f32 v46, v46, v62
    v_add_f32 v47, v47, v63
    v_add_f32 v32, v32, v40
    v_add_f32 v33, v33, v41
    v_add_f32 v34, v34, v42
    v_add_f32 v35, v35, v43
    v_add_f32 v36, v36, v44
    v_add_f32 v37, v37, v45
    v_add_f32 v38, v38, v46
    v_add_f32 v39, v39, v47
    v_add_f32 v32, v32, v36
    v_add_f32 v33, v33, v37
    v_add_f32 v34, v34, v38
    v_add_f32 v35, v35, v39
    v_cvt_pk_bf16_f32 v32, 0, v32
    v_cvt_pk_bf16_f32 v33, 0, v33
    v_cvt_pk_bf16_f32 v34, 0, v34
    v_cvt_pk_bf16_f32 v35, 0, v35
    ds_write_b128 v4, v[32:35]
    s_waitcnt lgkmcnt(0)
    s_barrier
    ds_read_b128 v[48:51], v3 offset:0
    ds_read_b128 v[52:55], v3 offset:16
    ds_read_b128 v[56:59], v3 offset:2048
    ds_read_b128 v[60:63], v3 offset:2064
    ds_read_b128 v[32:35], v3 offset:4096
    ds_read_b128 v[36:39], v3 offset:4112
    ds_read_b128 v[40:43], v3 offset:6144
    ds_read_b128 v[44:47], v3 offset:6160
    s_waitcnt lgkmcnt(0)
    v_add_f32 v32, 1.0, v32
    v_add_f32 v33, 1.0, v33
    v_add_f32 v34, 1.0, v34
    v_add_f32 v35, 1.0, v35
    v_add_f32 v36, 1.0, v36
    v_add_f32 v37, 1.0, v37
    v_add_f32 v38, 1.0, v38
    v_add_f32 v39, 1.0, v39
    v_add_f32 v40, 1.0, v40
    v_add_f32 v41, 1.0, v41
    v_add_f32 v42, 1.0, v42
    v_add_f32 v43, 1.0, v43
    v_add_f32 v44, 1.0, v44
    v_add_f32 v45, 1.0, v45
    v_add_f32 v46, 1.0, v46
    v_add_f32 v47, 1.0, v47
    v_cvt_pk_bf16_f32 v32, 0, v32
    v_cvt_pk_bf16_f32 v33, 0, v33
    v_cvt_pk_bf16_f32 v34, 0, v34
    v_cvt_pk_bf16_f32 v35, 0, v35
    v_cvt_pk_bf16_f32 v36, 0, v36
    v_cvt_pk_bf16_f32 v37, 0, v37
    v_cvt_pk_bf16_f32 v38, 0, v38
    v_cvt_pk_bf16_f32 v39, 0, v39
    v_cvt_pk_bf16_f32 v40, 0, v40
    v_cvt_pk_bf16_f32 v41, 0, v41
    v_cvt_pk_bf16_f32 v42, 0, v42
    v_cvt_pk_bf16_f32 v43, 0, v43
    v_cvt_pk_bf16_f32 v44, 0, v44
    v_cvt_pk_bf16_f32 v45, 0, v45
    v_cvt_pk_bf16_f32 v46, 0, v46
    v_cvt_pk_bf16_f32 v47, 0, v47
L_l_sub_21:
    s_lshl_b32 s63, s60, 16
    v_accvgpr_read_b32 v96, a0
    v_accvgpr_read_b32 v97, a1
    v_accvgpr_read_b32 v98, a2
    v_accvgpr_read_b32 v99, a3
    v_accvgpr_read_b32 v100, a4
    v_accvgpr_read_b32 v101, a5
    v_accvgpr_read_b32 v102, a6
    v_accvgpr_read_b32 v103, a7
    v_lshlrev_b32 v64, 16, v96
    v_and_b32 v65, 0xffff0000, v96
    v_lshlrev_b32 v66, 16, v97
    v_and_b32 v67, 0xffff0000, v97
    v_lshlrev_b32 v68, 16, v98
    v_and_b32 v69, 0xffff0000, v98
    v_lshlrev_b32 v70, 16, v99
    v_and_b32 v71, 0xffff0000, v99
    v_lshlrev_b32 v72, 16, v100
    v_and_b32 v73, 0xffff0000, v100
    v_lshlrev_b32 v74, 16, v101
    v_and_b32 v75, 0xffff0000, v101
    v_lshlrev_b32 v76, 16, v102
    v_and_b32 v77, 0xffff0000, v102
    v_lshlrev_b32 v78, 16, v103
    v_and_b32 v79, 0xffff0000, v103
    v_pk_add_f32 v[80:81], v[64:65], v[72:73]
    v_pk_add_f32 v[82:83], v[66:67], v[74:75]
    v_pk_add_f32 v[84:85], v[68:69], v[76:77]
    v_pk_add_f32 v[86:87], v[70:71], v[78:79]
    v_pk_add_f32 v[80:81], v[80:81], v[84:85]
    v_pk_add_f32 v[82:83], v[82:83], v[86:87]
    v_pk_add_f32 v[80:81], v[80:81], v[82:83]
    v_add_f32 v14, v80, v81
    s_nop 1
    v_add_f32_dpp v14, v14, v14 row_shr:1 row_mask:0xf bank_mask:0xf bound_ctrl:0
    s_nop 1
    v_add_f32_dpp v14, v14, v14 row_shr:2 row_mask:0xf bank_mask:0xf bound_ctrl:0
    s_nop 1
    v_add_f32_dpp v14, v14, v14 row_shr:4 row_mask:0xf bank_mask:0xf bound_ctrl:0
    s_nop 1
    v_add_f32_dpp v14, v14, v14 row_shr:8 row_mask:0xf bank_mask:0xf bound_ctrl:0
    s_nop 1
    v_add_f32_dpp v14, v14, v14 row_bcast:15 row_mask:0xa bank_mask:0xf
    s_nop 1
    v_add_f32_dpp v14, v14, v14 row_bcast:31 row_mask:0xc bank_mask:0xf
    s_nop 1
    v_readlane_b32 s46, v14, 63
    s_nop 1
    v_mov_b32 v15, s46
    v_mul_f32 v15, 0x3a800000, v15
    v_pk_add_f32 v[80:81], v[64:65], v[14:15] op_sel:[0,1] op_sel_hi:[1,1] neg_lo:[0,1] neg_hi:[0,1]
    v_pk_add_f32 v[82:83], v[66:67], v[14:15] op_sel:[0,1] op_sel_hi:[1,1] neg_lo:[0,1] neg_hi:[0,1]
    v_pk_add_f32 v[84:85], v[68:69], v[14:15] op_sel:[0,1] op_sel_hi:[1,1] neg_lo:[0,1] neg_hi:[0,1]
    v_pk_add_f32 v[86:87], v[70:71], v[14:15] op_sel:[0,1] op_sel_hi:[1,1] neg_lo:[0,1] neg_hi:[0,1]
    v_pk_add_f32 v[88:89], v[72:73], v[14:15] op_sel:[0,1] op_sel_hi:[1,1] neg_lo:[0,1] neg_hi:[0,1]
    v_pk_add_f32 v[90:91], v[74:75], v[14:15] op_sel:[0,1] op_sel_hi:[1,1] neg_lo:[0,1] neg_hi:[0,1]
    v_pk_add_f32 v[92:93], v[76:77], v[14:15] op_sel:[0,1] op_sel_hi:[1,1] neg_lo:[0,1] neg_hi:[0,1]
    v_pk_add_f32 v[94:95], v[78:79], v[14:15] op_sel:[0,1] op_sel_hi:[1,1] neg_lo:[0,1] neg_hi:[0,1]
    v_pk_mul_f32 v[104:105], v[80:81], v[80:81]
    v_pk_mul_f32 v[106:107], v[82:83], v[82:83]
    v_pk_fma_f32 v[104:105], v[84:85], v[84:85], v[104:105]
    v_pk_fma_f32 v[106:107], v[86:87], v[86:87], v[106:107]
    v_pk_fma_f32 v[104:105], v[88:89], v[88:89], v[104:105]
    v_pk_fma_f32 v[106:107], v[90:91], v[90:91], v[106:107]
    v_pk_fma_f32 v[104:105], v[92:93], v[92:93], v[104:105]
    v_pk_fma_f32 v[106:107], v[94:95], v[94:95], v[106:107]
    v_pk_add_f32 v[104:105], v[104:105], v[106:107]
    v_add_f32 v14, v104, v105
    v_cvt_pk_bf16_f32 v15, 0, v15
    s_nop 1
    v_add_f32_dpp v14, v14, v14 row_shr:1 row_mask:0xf bank_mask:0xf bound_ctrl:0
    s_nop 1
    v_add_f32_dpp v14, v14, v14 row_shr:2 row_mask:0xf bank_mask:0xf bound_ctrl:0
    s_nop 1
    v_add_f32_dpp v14, v14, v14 row_shr:4 row_mask:0xf bank_mask:0xf bound_ctrl:0
    s_nop 1
    v_add_f32_dpp v14, v14, v14 row_shr:8 row_mask:0xf bank_mask:0xf bound_ctrl:0
    s_nop 1
    v_add_f32_dpp v14, v14, v14 row_bcast:15 row_mask:0xa bank_mask:0xf
    s_nop 1
    v_add_f32_dpp v14, v14, v14 row_bcast:31 row_mask:0xc bank_mask:0xf
    s_nop 1
    v_readlane_b32 s47, v14, 63
    v_pk_add_f32 v[64:65], v[64:65], v[14:15] op_sel:[0,1] op_sel_hi:[1,1] neg_lo:[0,1] neg_hi:[0,1]
    v_pk_add_f32 v[66:67], v[66:67], v[14:15] op_sel:[0,1] op_sel_hi:[1,1] neg_lo:[0,1] neg_hi:[0,1]
    v_pk_add_f32 v[68:69], v[68:69], v[14:15] op_sel:[0,1] op_sel_hi:[1,1] neg_lo:[0,1] neg_hi:[0,1]
    v_pk_add_f32 v[70:71], v[70:71], v[14:15] op_sel:[0,1] op_sel_hi:[1,1] neg_lo:[0,1] neg_hi:[0,1]
    v_pk_add_f32 v[72:73], v[72:73], v[14:15] op_sel:[0,1] op_sel_hi:[1,1] neg_lo:[0,1] neg_hi:[0,1]
    v_pk_add_f32 v[74:75], v[74:75], v[14:15] op_sel:[0,1] op_sel_hi:[1,1] neg_lo:[0,1] neg_hi:[0,1]
    v_pk_add_f32 v[76:77], v[76:77], v[14:15] op_sel:[0,1] op_sel_hi:[1,1] neg_lo:[0,1] neg_hi:[0,1]
    v_pk_add_f32 v[78:79], v[78:79], v[14:15] op_sel:[0,1] op_sel_hi:[1,1] neg_lo:[0,1] neg_hi:[0,1]
    v_mov_b32 v14, s47
    v_mul_f32 v14, 0x3a800000, v14
    v_cvt_pk_bf16_f32 v14, 0, v14
    v_add_f32 v14, 0x3727c5ac, v14
    v_cvt_pk_bf16_f32 v14, 0, v14
    v_sqrt_f32 v14, v14
    s_nop 0
    v_cvt_pk_bf16_f32 v14, 0, v14
    v_rcp_f32 v14, v14
    v_cvt_pk_bf16_f32 v64, 0, v64
    v_cvt_pk_bf16_f32 v65, 0, v65
    v_cvt_pk_bf16_f32 v66, 0, v66
    v_cvt_pk_bf16_f32 v67, 0, v67
    v_cvt_pk_bf16_f32 v68, 0, v68
    v_cvt_pk_bf16_f32 v69, 0, v69
    v_cvt_pk_bf16_f32 v70, 0, v70
    v_cvt_pk_bf16_f32 v71, 0, v71
    v_cvt_pk_bf16_f32 v72, 0, v72
    v_cvt_pk_bf16_f32 v73, 0, v73
    v_cvt_pk_bf16_f32 v74, 0, v74
    v_cvt_pk_bf16_f32 v75, 0, v75
    v_cvt_pk_bf16_f32 v76, 0, v76
    v_cvt_pk_bf16_f32 v77, 0, v77
    v_cvt_pk_bf16_f32 v78, 0, v78
    v_cvt_pk_bf16_f32 v79, 0, v79
    v_pk_mul_f32 v[64:65], v[64:65], v[14:15] op_sel_hi:[1,0]
    v_pk_mul_f32 v[66:67], v[66:67], v[14:15] op_sel_hi:[1,0]
    v_pk_mul_f32 v[68:69], v[68:69], v[14:15] op_sel_hi:[1,0]
    v_pk_mul_f32 v[70:71], v[70:71], v[14:15] op_sel_hi:[1,0]
    v_pk_mul_f32 v[72:73], v[72:73], v[14:15] op_sel_hi:[1,0]
    v_pk_mul_f32 v[74:75], v[74:75], v[14:15] op_sel_hi:[1,0]
    v_pk_mul_f32 v[76:77], v[76:77], v[14:15] op_sel_hi:[1,0]
    v_pk_mul_f32 v[78:79], v[78:79], v[14:15] op_sel_hi:[1,0]
    v_cvt_pk_bf16_f32 v64, 0, v64
    v_cvt_pk_bf16_f32 v65, 0, v65
    v_cvt_pk_bf16_f32 v66, 0, v66
    v_cvt_pk_bf16_f32 v67, 0, v67
    v_cvt_pk_bf16_f32 v68, 0, v68
    v_cvt_pk_bf16_f32 v69, 0, v69
    v_cvt_pk_bf16_f32 v70, 0, v70
    v_cvt_pk_bf16_f32 v71, 0, v71
    v_cvt_pk_bf16_f32 v72, 0, v72
    v_cvt_pk_bf16_f32 v73, 0, v73
    v_cvt_pk_bf16_f32 v74, 0, v74
    v_cvt_pk_bf16_f32 v75, 0, v75
    v_cvt_pk_bf16_f32 v76, 0, v76
    v_cvt_pk_bf16_f32 v77, 0, v77
    v_cvt_pk_bf16_f32 v78, 0, v78
    v_cvt_pk_bf16_f32 v79, 0, v79
    v_pk_mul_f32 v[64:65], v[64:65], v[32:33]
    v_pk_mul_f32 v[66:67], v[66:67], v[34:35]
    v_pk_mul_f32 v[68:69], v[68:69], v[36:37]
    v_pk_mul_f32 v[70:71], v[70:71], v[38:39]
    v_pk_mul_f32 v[72:73], v[72:73], v[40:41]
    v_pk_mul_f32 v[74:75], v[74:75], v[42:43]
    v_pk_mul_f32 v[76:77], v[76:77], v[44:45]
    v_pk_mul_f32 v[78:79], v[78:79], v[46:47]
    v_cvt_pk_bf16_f32 v64, 0, v64
    v_cvt_pk_bf16_f32 v65, 0, v65
    v_cvt_pk_bf16_f32 v66, 0, v66
    v_cvt_pk_bf16_f32 v67, 0, v67
    v_cvt_pk_bf16_f32 v68, 0, v68
    v_cvt_pk_bf16_f32 v69, 0, v69
    v_cvt_pk_bf16_f32 v70, 0, v70
    v_cvt_pk_bf16_f32 v71, 0, v71
    v_cvt_pk_bf16_f32 v72, 0, v72
    v_cvt_pk_bf16_f32 v73, 0, v73
    v_cvt_pk_bf16_f32 v74, 0, v74
    v_cvt_pk_bf16_f32 v75, 0, v75
    v_cvt_pk_bf16_f32 v76, 0, v76
    v_cvt_pk_bf16_f32 v77, 0, v77
    v_cvt_pk_bf16_f32 v78, 0, v78
    v_cvt_pk_bf16_f32 v79, 0, v79
    v_pk_add_f32 v[64:65], v[64:65], v[48:49]
    v_pk_add_f32 v[66:67], v[66:67], v[50:51]
    v_pk_add_f32 v[68:69], v[68:69], v[52:53]
    v_pk_add_f32 v[70:71], v[70:71], v[54:55]
    v_pk_add_f32 v[72:73], v[72:73], v[56:57]
    v_pk_add_f32 v[74:75], v[74:75], v[58:59]
    v_pk_add_f32 v[76:77], v[76:77], v[60:61]
    v_pk_add_f32 v[78:79], v[78:79], v[62:63]
    v_cvt_pk_bf16_f32 v104, v64, v65
    v_cvt_pk_bf16_f32 v105, v66, v67
    v_cvt_pk_bf16_f32 v106, v68, v69
    v_cvt_pk_bf16_f32 v107, v70, v71
    v_cvt_pk_bf16_f32 v108, v72, v73
    v_cvt_pk_bf16_f32 v109, v74, v75
    v_cvt_pk_bf16_f32 v110, v76, v77
    v_cvt_pk_bf16_f32 v111, v78, v79
    ds_write_b128 v10, v[104:107]
    ds_write_b128 v10, v[108:111] offset:1024
    s_waitcnt lgkmcnt(0)
    s_barrier
    ds_read_b128 v[104:107], v13
    ds_read_b128 v[108:111], v13 offset:128
    s_waitcnt lgkmcnt(1)
    buffer_store_dwordx4 v[104:107], v11, s[12:15], s63 offen sc1
    s_waitcnt lgkmcnt(0)
    buffer_store_dwordx4 v[108:111], v12, s[12:15], s63 offen sc1
    s_waitcnt vmcnt(0)
    s_barrier
    s_cmp_lg_u32 s44, 0
    s_cbranch_scc1 L_sf_23
    v_mov_b32 v14, s60
    v_add_u32 v14, 1, v14
    v_mov_b32 v15, 0
    s_mov_b64 exec, 1
    buffer_store_dword v14, v15, s[12:15], s52 offen sc1
    s_mov_b64 exec, -1
L_sf_23:
    s_cmp_ge_u32 s60, 8
    s_cbranch_scc1 L_l_end_22
    s_add_u32 s63, s63, 524288
    buffer_load_dwordx4 a[8:11], v7, s[24:27], s63 offen
    buffer_load_dwordx4 a[12:15], v7, s[24:27], s63 offen offset:1024
    s_add_u32 s63, s63, 524288
    buffer_load_dwordx4 a[16:19], v7, s[24:27], s63 offen
    buffer_load_dwordx4 a[20:23], v7, s[24:27], s63 offen offset:1024
    s_add_u32 s63, s63, 524288
    buffer_load_dwordx4 a[24:27], v7, s[24:27], s63 offen
    buffer_load_dwordx4 a[28:31], v7, s[24:27], s63 offen offset:1024
    s_add_u32 s63, s63, 524288
    buffer_load_dwordx4 a[32:35], v7, s[24:27], s63 offen
    buffer_load_dwordx4 a[36:39], v7, s[24:27], s63 offen offset:1024
    s_add_u32 s63, s63, 524288
    buffer_load_dwordx4 a[40:43], v7, s[24:27], s63 offen
    buffer_load_dwordx4 a[44:47], v7, s[24:27], s63 offen offset:1024
    s_add_u32 s63, s63, 524288
    buffer_load_dwordx4 a[48:51], v7, s[24:27], s63 offen
    buffer_load_dwordx4 a[52:55], v7, s[24:27], s63 offen offset:1024
    s_add_u32 s63, s63, 524288
    buffer_load_dwordx4 a[56:59], v7, s[24:27], s63 offen
    buffer_load_dwordx4 a[60:63], v7, s[24:27], s63 offen offset:1024
    s_waitcnt vmcnt(0)
L_l_end_22:
    v_accvgpr_mov_b32 a0, a8
    v_accvgpr_mov_b32 a1, a9
    v_accvgpr_mov_b32 a2, a10
    v_accvgpr_mov_b32 a3, a11
    v_accvgpr_mov_b32 a4, a12
    v_accvgpr_mov_b32 a5, a13
    v_accvgpr_mov_b32 a6, a14
    v_accvgpr_mov_b32 a7, a15
    v_accvgpr_mov_b32 a8, a16
    v_accvgpr_mov_b32 a9, a17
    v_accvgpr_mov_b32 a10, a18
    v_accvgpr_mov_b32 a11, a19
    v_accvgpr_mov_b32 a12, a20
    v_accvgpr_mov_b32 a13, a21
    v_accvgpr_mov_b32 a14, a22
    v_accvgpr_mov_b32 a15, a23
    v_accvgpr_mov_b32 a16, a24
    v_accvgpr_mov_b32 a17, a25
    v_accvgpr_mov_b32 a18, a26
    v_accvgpr_mov_b32 a19, a27
    v_accvgpr_mov_b32 a20, a28
    v_accvgpr_mov_b32 a21, a29
    v_accvgpr_mov_b32 a22, a30
    v_accvgpr_mov_b32 a23, a31
    v_accvgpr_mov_b32 a24, a32
    v_accvgpr_mov_b32 a25, a33
    v_accvgpr_mov_b32 a26, a34
    v_accvgpr_mov_b32 a27, a35
    v_accvgpr_mov_b32 a28, a36
    v_accvgpr_mov_b32 a29, a37
    v_accvgpr_mov_b32 a30, a38
    v_accvgpr_mov_b32 a31, a39
    v_accvgpr_mov_b32 a32, a40
    v_accvgpr_mov_b32 a33, a41
    v_accvgpr_mov_b32 a34, a42
    v_accvgpr_mov_b32 a35, a43
    v_accvgpr_mov_b32 a36, a44
    v_accvgpr_mov_b32 a37, a45
    v_accvgpr_mov_b32 a38, a46
    v_accvgpr_mov_b32 a39, a47
    v_accvgpr_mov_b32 a40, a48
    v_accvgpr_mov_b32 a41, a49
    v_accvgpr_mov_b32 a42, a50
    v_accvgpr_mov_b32 a43, a51
    v_accvgpr_mov_b32 a44, a52
    v_accvgpr_mov_b32 a45, a53
    v_accvgpr_mov_b32 a46, a54
    v_accvgpr_mov_b32 a47, a55
    v_accvgpr_mov_b32 a48, a56
    v_accvgpr_mov_b32 a49, a57
    v_accvgpr_mov_b32 a50, a58
    v_accvgpr_mov_b32 a51, a59
    v_accvgpr_mov_b32 a52, a60
    v_accvgpr_mov_b32 a53, a61
    v_accvgpr_mov_b32 a54, a62
    v_accvgpr_mov_b32 a55, a63
    s_add_u32 s60, s60, 8
    s_cmp_lt_u32 s60, 64
    s_cbranch_scc1 L_l_sub_21
    s_cmp_lt_u32 s48, 14
    s_cbranch_scc1 L_w_h_17_s
    s_and_b32 s55, s48, 1
    s_lshl_b32 s55, s55, 3
    s_add_u32 s55, s55, s40
    s_load_dwordx4 s[8:11], s[0:1], 96
    v_lshrrev_b32 v5, 3, v0
    s_mov_b32 s46, 196608
    v_mul_lo_u32 v4, v5, s46
    v_and_b32 v6, 7, v0
    v_lshl_add_u32 v4, v6, 4, v4
    v_lshlrev_b32 v5, 5, v5
    s_waitcnt lgkmcnt(0)
    s_mov_b32 s28, s10
    s_and_b32 s29, s11, 0xffff
    s_mov_b32 s30, 0xc00000
    s_mov_b32 s31, 0x00020000
    s_mov_b32 s32, s8
    s_and_b32 s33, s9, 0xffff
    s_mov_b32 s34, 0x800
    s_mov_b32 s35, 0x00020000
    buffer_load_dwordx4 v[8:11], v5, s[32:35], 0 offen
    buffer_load_dwordx4 v[12:15], v5, s[32:35], 0 offen offset:16
    s_waitcnt vmcnt(0)
    v_lshlrev_b32 v16, 16, v8
    v_and_b32 v17, 0xffff0000, v8
    v_lshlrev_b32 v18, 16, v9
    v_and_b32 v19, 0xffff0000, v9
    v_lshlrev_b32 v20, 16, v10
    v_and_b32 v21, 0xffff0000, v10
    v_lshlrev_b32 v22, 16, v11
    v_and_b32 v23, 0xffff0000, v11
    v_lshlrev_b32 v24, 16, v12
    v_and_b32 v25, 0xffff0000, v12
    v_lshlrev_b32 v26, 16, v13
    v_and_b32 v27, 0xffff0000, v13
    v_lshlrev_b32 v28, 16, v14
    v_and_b32 v29, 0xffff0000, v14
    v_lshlrev_b32 v30, 16, v15
    v_and_b32 v31, 0xffff0000, v15
    v_mul_f32 v112, 0xbfb8aa3b, v16
    v_mul_f32 v113, 0xbfb8aa3b, v17
    v_mul_f32 v114, 0xbfb8aa3b, v18
    v_mul_f32 v115, 0xbfb8aa3b, v19
    v_mul_f32 v116, 0xbfb8aa3b, v20
    v_mul_f32 v117, 0xbfb8aa3b, v21
    v_mul_f32 v118, 0xbfb8aa3b, v22
    v_mul_f32 v119, 0xbfb8aa3b, v23
    v_mul_f32 v120, 0xbfb8aa3b, v24
    v_mul_f32 v121, 0xbfb8aa3b, v25
    v_mul_f32 v122, 0xbfb8aa3b, v26
    v_mul_f32 v123, 0xbfb8aa3b, v27
    v_mul_f32 v124, 0xbfb8aa3b, v28
    v_mul_f32 v125, 0xbfb8aa3b, v29
    v_mul_f32 v126, 0xbfb8aa3b, v30
    v_mul_f32 v127, 0xbfb8aa3b, v31
    v_exp_f32 v112, v112
    v_exp_f32 v113, v113
    v_exp_f32 v114, v114
    v_exp_f32 v115, v115
    v_exp_f32 v116, v116
    v_exp_f32 v117, v117
    v_exp_f32 v118, v118
    v_exp_f32 v119, v119
    v_exp_f32 v120, v120
    v_exp_f32 v121, v121
    v_exp_f32 v122, v122
    v_exp_f32 v123, v123
    v_exp_f32 v124, v124
    v_exp_f32 v125, v125
    v_exp_f32 v126, v126
    v_exp_f32 v127, v127
    v_add_f32 v112, 1.0, v112
    v_add_f32 v113, 1.0, v113
    v_add_f32 v114, 1.0, v114
    v_add_f32 v115, 1.0, v115
    v_add_f32 v116, 1.0, v116
    v_add_f32 v117, 1.0, v117
    v_add_f32 v118, 1.0, v118
    v_add_f32 v119, 1.0, v119
    v_add_f32 v120, 1.0, v120
    v_add_f32 v121, 1.0, v121
    v_add_f32 v122, 1.0, v122
    v_add_f32 v123, 1.0, v123
    v_add_f32 v124, 1.0, v124
    v_add_f32 v125, 1.0, v125
    v_add_f32 v126, 1.0, v126
    v_add_f32 v127, 1.0, v127
    v_rcp_f32 v112, v112
    v_rcp_f32 v113, v113
    v_rcp_f32 v114, v114
    v_rcp_f32 v115, v115
    v_rcp_f32 v116, v116
    v_rcp_f32 v117, v117
    v_rcp_f32 v118, v118
    v_rcp_f32 v119, v119
    v_rcp_f32 v120, v120
    v_rcp_f32 v121, v121
    v_rcp_f32 v122, v122
    v_rcp_f32 v123, v123
    v_rcp_f32 v124, v124
    v_rcp_f32 v125, v125
    v_rcp_f32 v126, v126
    v_rcp_f32 v127, v127
    v_mul_f32 v16, v16, v112
    v_mul_f32 v17, v17, v113
    v_mul_f32 v18, v18, v114
    v_mul_f32 v19, v19, v115
    v_mul_f32 v20, v20, v116
    v_mul_f32 v21, v21, v117
    v_mul_f32 v22, v22, v118
    v_mul_f32 v23, v23, v119
    v_mul_f32 v24, v24, v120
    v_mul_f32 v25, v25, v121
    v_mul_f32 v26, v26, v122
    v_mul_f32 v27, v27, v123
    v_mul_f32 v28, v28, v124
    v_mul_f32 v29, v29, v125
    v_mul_f32 v30, v30, v126
    v_mul_f32 v31, v31, v127
    v_cvt_pk_bf16_f32 v16, 0, v16
    v_cvt_pk_bf16_f32 v17, 0, v17
    v_cvt_pk_bf16_f32 v18, 0, v18
    v_cvt_pk_bf16_f32 v19, 0, v19
    v_cvt_pk_bf16_f32 v20, 0, v20
    v_cvt_pk_bf16_f32 v21, 0, v21
    v_cvt_pk_bf16_f32 v22, 0, v22
    v_cvt_pk_bf16_f32 v23, 0, v23
    v_cvt_pk_bf16_f32 v24, 0, v24
    v_cvt_pk_bf16_f32 v25, 0, v25
    v_cvt_pk_bf16_f32 v26, 0, v26
    v_cvt_pk_bf16_f32 v27, 0, v27
    v_cvt_pk_bf16_f32 v28, 0, v28
    v_cvt_pk_bf16_f32 v29, 0, v29
    v_cvt_pk_bf16_f32 v30, 0, v30
    v_cvt_pk_bf16_f32 v31, 0, v31
    s_lshl_b32 s53, s55, 9
    s_add_u32 s53, s53, 4096
L_m_loop_24:
    s_add_u32 s46, s53, 0
    buffer_load_dwordx4 v[32:35], v4, s[28:31], s46 offen
    s_add_u32 s46, s53, 12288
    buffer_load_dwordx4 v[36:39], v4, s[28:31], s46 offen
    s_add_u32 s46, s53, 24576
    buffer_load_dwordx4 v[40:43], v4, s[28:31], s46 offen
    s_add_u32 s46, s53, 36864
    buffer_load_dwordx4 v[44:47], v4, s[28:31], s46 offen
    s_add_u32 s46, s53, 49152
    buffer_load_dwordx4 v[48:51], v4, s[28:31], s46 offen
    s_add_u32 s46, s53, 61440
    buffer_load_dwordx4 v[52:55], v4, s[28:31], s46 offen
    s_add_u32 s46, s53, 73728
    buffer_load_dwordx4 v[56:59], v4, s[28:31], s46 offen
    s_add_u32 s46, s53, 86016
    buffer_load_dwordx4 v[60:63], v4, s[28:31], s46 offen
    s_add_u32 s46, s53, 98304
    buffer_load_dwordx4 v[64:67], v4, s[28:31], s46 offen
    s_add_u32 s46, s53, 110592
    buffer_load_dwordx4 v[68:71], v4, s[28:31], s46 offen
    s_add_u32 s46, s53, 122880
    buffer_load_dwordx4 v[72:75], v4, s[28:31], s46 offen
    s_add_u32 s46, s53, 135168
    buffer_load_dwordx4 v[76:79], v4, s[28:31], s46 offen
    s_add_u32 s46, s53, 147456
    buffer_load_dwordx4 v[80:83], v4, s[28:31], s46 offen
    s_add_u32 s46, s53, 159744
    buffer_load_dwordx4 v[84:87], v4, s[28:31], s46 offen
    s_add_u32 s46, s53, 172032
    buffer_load_dwordx4 v[88:91], v4, s[28:31], s46 offen
    s_add_u32 s46, s53, 184320
    buffer_load_dwordx4 v[92:95], v4, s[28:31], s46 offen
    s_waitcnt vmcnt(15)
    v_lshlrev_b32 v104, 16, v32
    v_and_b32 v105, 0xffff0000, v32
    v_mul_f32 v96, v104, v16
    v_mul_f32 v97, v105, v16
    v_lshlrev_b32 v104, 16, v33
    v_and_b32 v105, 0xffff0000, v33
    v_mul_f32 v98, v104, v16
    v_mul_f32 v99, v105, v16
    v_lshlrev_b32 v104, 16, v34
    v_and_b32 v105, 0xffff0000, v34
    v_mul_f32 v100, v104, v16
    v_mul_f32 v101, v105, v16
    v_lshlrev_b32 v104, 16, v35
    v_and_b32 v105, 0xffff0000, v35
    v_mul_f32 v102, v104, v16
    v_mul_f32 v103, v105, v16
    s_waitcnt vmcnt(14)
    v_lshlrev_b32 v104, 16, v36
    v_and_b32 v105, 0xffff0000, v36
    v_fmac_f32 v96, v104, v17
    v_fmac_f32 v97, v105, v17
    v_lshlrev_b32 v104, 16, v37
    v_and_b32 v105, 0xffff0000, v37
    v_fmac_f32 v98, v104, v17
    v_fmac_f32 v99, v105, v17
    v_lshlrev_b32 v104, 16, v38
    v_and_b32 v105, 0xffff0000, v38
    v_fmac_f32 v100, v104, v17
    v_fmac_f32 v101, v105, v17
    v_lshlrev_b32 v104, 16, v39
    v_and_b32 v105, 0xffff0000, v39
    v_fmac_f32 v102, v104, v17
    v_fmac_f32 v103, v105, v17
    s_waitcnt vmcnt(13)
    v_lshlrev_b32 v104, 16, v40
    v_and_b32 v105, 0xffff0000, v40
    v_fmac_f32 v96, v104, v18
    v_fmac_f32 v97, v105, v18
    v_lshlrev_b32 v104, 16, v41
    v_and_b32 v105, 0xffff0000, v41
    v_fmac_f32 v98, v104, v18
    v_fmac_f32 v99, v105, v18
    v_lshlrev_b32 v104, 16, v42
    v_and_b32 v105, 0xffff0000, v42
    v_fmac_f32 v100, v104, v18
    v_fmac_f32 v101, v105, v18
    v_lshlrev_b32 v104, 16, v43
    v_and_b32 v105, 0xffff0000, v43
    v_fmac_f32 v102, v104, v18
    v_fmac_f32 v103, v105, v18
    s_waitcnt vmcnt(12)
    v_lshlrev_b32 v104, 16, v44
    v_and_b32 v105, 0xffff0000, v44
    v_fmac_f32 v96, v104, v19
    v_fmac_f32 v97, v105, v19
    v_lshlrev_b32 v104, 16, v45
    v_and_b32 v105, 0xffff0000, v45
    v_fmac_f32 v98, v104, v19
    v_fmac_f32 v99, v105, v19
    v_lshlrev_b32 v104, 16, v46
    v_and_b32 v105, 0xffff0000, v46
    v_fmac_f32 v100, v104, v19
    v_fmac_f32 v101, v105, v19
    v_lshlrev_b32 v104, 16, v47
    v_and_b32 v105, 0xffff0000, v47
    v_fmac_f32 v102, v104, v19
    v_fmac_f32 v103, v105, v19
    s_waitcnt vmcnt(11)
    v_lshlrev_b32 v104, 16, v48
    v_and_b32 v105, 0xffff0000, v48
    v_fmac_f32 v96, v104, v20
    v_fmac_f32 v97, v105, v20
    v_lshlrev_b32 v104, 16, v49
    v_and_b32 v105, 0xffff0000, v49
    v_fmac_f32 v98, v104, v20
    v_fmac_f32 v99, v105, v20
    v_lshlrev_b32 v104, 16, v50
    v_and_b32 v105, 0xffff0000, v50
    v_fmac_f32 v100, v104, v20
    v_fmac_f32 v101, v105, v20
    v_lshlrev_b32 v104, 16, v51
    v_and_b32 v105, 0xffff0000, v51
    v_fmac_f32 v102, v104, v20
    v_fmac_f32 v103, v105, v20
    s_waitcnt vmcnt(10)
    v_lshlrev_b32 v104, 16, v52
    v_and_b32 v105, 0xffff0000, v52
    v_fmac_f32 v96, v104, v21
    v_fmac_f32 v97, v105, v21
    v_lshlrev_b32 v104, 16, v53
    v_and_b32 v105, 0xffff0000, v53
    v_fmac_f32 v98, v104, v21
    v_fmac_f32 v99, v105, v21
    v_lshlrev_b32 v104, 16, v54
    v_and_b32 v105, 0xffff0000, v54
    v_fmac_f32 v100, v104, v21
    v_fmac_f32 v101, v105, v21
    v_lshlrev_b32 v104, 16, v55
    v_and_b32 v105, 0xffff0000, v55
    v_fmac_f32 v102, v104, v21
    v_fmac_f32 v103, v105, v21
    s_waitcnt vmcnt(9)
    v_lshlrev_b32 v104, 16, v56
    v_and_b32 v105, 0xffff0000, v56
    v_fmac_f32 v96, v104, v22
    v_fmac_f32 v97, v105, v22
    v_lshlrev_b32 v104, 16, v57
    v_and_b32 v105, 0xffff0000, v57
    v_fmac_f32 v98, v104, v22
    v_fmac_f32 v99, v105, v22
    v_lshlrev_b32 v104, 16, v58
    v_and_b32 v105, 0xffff0000, v58
    v_fmac_f32 v100, v104, v22
    v_fmac_f32 v101, v105, v22
    v_lshlrev_b32 v104, 16, v59
    v_and_b32 v105, 0xffff0000, v59
    v_fmac_f32 v102, v104, v22
    v_fmac_f32 v103, v105, v22
    s_waitcnt vmcnt(8)
    v_lshlrev_b32 v104, 16, v60
    v_and_b32 v105, 0xffff0000, v60
    v_fmac_f32 v96, v104, v23
    v_fmac_f32 v97, v105, v23
    v_lshlrev_b32 v104, 16, v61
    v_and_b32 v105, 0xffff0000, v61
    v_fmac_f32 v98, v104, v23
    v_fmac_f32 v99, v105, v23
    v_lshlrev_b32 v104, 16, v62
    v_and_b32 v105, 0xffff0000, v62
    v_fmac_f32 v100, v104, v23
    v_fmac_f32 v101, v105, v23
    v_lshlrev_b32 v104, 16, v63
    v_and_b32 v105, 0xffff0000, v63
    v_fmac_f32 v102, v104, v23
    v_fmac_f32 v103, v105, v23
    s_waitcnt vmcnt(7)
    v_lshlrev_b32 v104, 16, v64
    v_and_b32 v105, 0xffff0000, v64
    v_fmac_f32 v96, v104, v24
    v_fmac_f32 v97, v105, v24
    v_lshlrev_b32 v104, 16, v65
    v_and_b32 v105, 0xffff0000, v65
    v_fmac_f32 v98, v104, v24
    v_fmac_f32 v99, v105, v24
    v_lshlrev_b32 v104, 16, v66
    v_and_b32 v105, 0xffff0000, v66
    v_fmac_f32 v100, v104, v24
    v_fmac_f32 v101, v105, v24
    v_lshlrev_b32 v104, 16, v67
    v_and_b32 v105, 0xffff0000, v67
    v_fmac_f32 v102, v104, v24
    v_fmac_f32 v103, v105, v24
    s_waitcnt vmcnt(6)
    v_lshlrev_b32 v104, 16, v68
    v_and_b32 v105, 0xffff0000, v68
    v_fmac_f32 v96, v104, v25
    v_fmac_f32 v97, v105, v25
    v_lshlrev_b32 v104, 16, v69
    v_and_b32 v105, 0xffff0000, v69
    v_fmac_f32 v98, v104, v25
    v_fmac_f32 v99, v105, v25
    v_lshlrev_b32 v104, 16, v70
    v_and_b32 v105, 0xffff0000, v70
    v_fmac_f32 v100, v104, v25
    v_fmac_f32 v101, v105, v25
    v_lshlrev_b32 v104, 16, v71
    v_and_b32 v105, 0xffff0000, v71
    v_fmac_f32 v102, v104, v25
    v_fmac_f32 v103, v105, v25
    s_waitcnt vmcnt(5)
    v_lshlrev_b32 v104, 16, v72
    v_and_b32 v105, 0xffff0000, v72
    v_fmac_f32 v96, v104, v26
    v_fmac_f32 v97, v105, v26
    v_lshlrev_b32 v104, 16, v73
    v_and_b32 v105, 0xffff0000, v73
    v_fmac_f32 v98, v104, v26
    v_fmac_f32 v99, v105, v26
    v_lshlrev_b32 v104, 16, v74
    v_and_b32 v105, 0xffff0000, v74
    v_fmac_f32 v100, v104, v26
    v_fmac_f32 v101, v105, v26
    v_lshlrev_b32 v104, 16, v75
    v_and_b32 v105, 0xffff0000, v75
    v_fmac_f32 v102, v104, v26
    v_fmac_f32 v103, v105, v26
    s_waitcnt vmcnt(4)
    v_lshlrev_b32 v104, 16, v76
    v_and_b32 v105, 0xffff0000, v76
    v_fmac_f32 v96, v104, v27
    v_fmac_f32 v97, v105, v27
    v_lshlrev_b32 v104, 16, v77
    v_and_b32 v105, 0xffff0000, v77
    v_fmac_f32 v98, v104, v27
    v_fmac_f32 v99, v105, v27
    v_lshlrev_b32 v104, 16, v78
    v_and_b32 v105, 0xffff0000, v78
    v_fmac_f32 v100, v104, v27
    v_fmac_f32 v101, v105, v27
    v_lshlrev_b32 v104, 16, v79
    v_and_b32 v105, 0xffff0000, v79
    v_fmac_f32 v102, v104, v27
    v_fmac_f32 v103, v105, v27
    s_waitcnt vmcnt(3)
    v_lshlrev_b32 v104, 16, v80
    v_and_b32 v105, 0xffff0000, v80
    v_fmac_f32 v96, v104, v28
    v_fmac_f32 v97, v105, v28
    v_lshlrev_b32 v104, 16, v81
    v_and_b32 v105, 0xffff0000, v81
    v_fmac_f32 v98, v104, v28
    v_fmac_f32 v99, v105, v28
    v_lshlrev_b32 v104, 16, v82
    v_and_b32 v105, 0xffff0000, v82
    v_fmac_f32 v100, v104, v28
    v_fmac_f32 v101, v105, v28
    v_lshlrev_b32 v104, 16, v83
    v_and_b32 v105, 0xffff0000, v83
    v_fmac_f32 v102, v104, v28
    v_fmac_f32 v103, v105, v28
    s_waitcnt vmcnt(2)
    v_lshlrev_b32 v104, 16, v84
    v_and_b32 v105, 0xffff0000, v84
    v_fmac_f32 v96, v104, v29
    v_fmac_f32 v97, v105, v29
    v_lshlrev_b32 v104, 16, v85
    v_and_b32 v105, 0xffff0000, v85
    v_fmac_f32 v98, v104, v29
    v_fmac_f32 v99, v105, v29
    v_lshlrev_b32 v104, 16, v86
    v_and_b32 v105, 0xffff0000, v86
    v_fmac_f32 v100, v104, v29
    v_fmac_f32 v101, v105, v29
    v_lshlrev_b32 v104, 16, v87
    v_and_b32 v105, 0xffff0000, v87
    v_fmac_f32 v102, v104, v29
    v_fmac_f32 v103, v105, v29
    s_waitcnt vmcnt(1)
    v_lshlrev_b32 v104, 16, v88
    v_and_b32 v105, 0xffff0000, v88
    v_fmac_f32 v96, v104, v30
    v_fmac_f32 v97, v105, v30
    v_lshlrev_b32 v104, 16, v89
    v_and_b32 v105, 0xffff0000, v89
    v_fmac_f32 v98, v104, v30
    v_fmac_f32 v99, v105, v30
    v_lshlrev_b32 v104, 16, v90
    v_and_b32 v105, 0xffff0000, v90
    v_fmac_f32 v100, v104, v30
    v_fmac_f32 v101, v105, v30
    v_lshlrev_b32 v104, 16, v91
    v_and_b32 v105, 0xffff0000, v91
    v_fmac_f32 v102, v104, v30
    v_fmac_f32 v103, v105, v30
    s_waitcnt vmcnt(0)
    v_lshlrev_b32 v104, 16, v92
    v_and_b32 v105, 0xffff0000, v92
    v_fmac_f32 v96, v104, v31
    v_fmac_f32 v97, v105, v31
    v_lshlrev_b32 v104, 16, v93
    v_and_b32 v105, 0xffff0000, v93
    v_fmac_f32 v98, v104, v31
    v_fmac_f32 v99, v105, v31
    v_lshlrev_b32 v104, 16, v94
    v_and_b32 v105, 0xffff0000, v94
    v_fmac_f32 v100, v104, v31
    v_fmac_f32 v101, v105, v31
    v_lshlrev_b32 v104, 16, v95
    v_and_b32 v105, 0xffff0000, v95
    v_fmac_f32 v102, v104, v31
    v_fmac_f32 v103, v105, v31
    v_lshlrev_b32 v104, 5, v0
    ds_write_b128 v104, v[96:99]
    ds_write_b128 v104, v[100:103] offset:16
    v_lshlrev_b32 v105, 2, v1
    s_lshl_b32 s46, s44, 11
    v_add_u32 v104, s46, v105
    s_waitcnt lgkmcnt(0)
    ds_read_b32 v96, v104 offset:0
    ds_read_b32 v97, v104 offset:256
    ds_read_b32 v98, v104 offset:512
    ds_read_b32 v99, v104 offset:768
    ds_read_b32 v100, v104 offset:1024
    ds_read_b32 v101, v104 offset:1280
    ds_read_b32 v102, v104 offset:1536
    ds_read_b32 v103, v104 offset:1792
    s_waitcnt lgkmcnt(0)
    v_add_f32 v96, v96, v100
    v_add_f32 v97, v97, v101
    v_add_f32 v98, v98, v102
    v_add_f32 v99, v99, v103
    v_add_f32 v96, v96, v98
    v_add_f32 v97, v97, v99
    v_add_f32 v96, v96, v97
    v_lshlrev_b32 v104, 2, v0
    ds_write_b32 v104, v96 offset:16384
    s_waitcnt lgkmcnt(0)
    s_barrier
    s_cmp_lg_u32 s44, 0
    s_cbranch_scc1 L_m_sk_25
    ds_read_b32 v96, v105 offset:16384
    ds_read_b32 v97, v105 offset:16640
    ds_read_b32 v98, v105 offset:16896
    ds_read_b32 v99, v105 offset:17152
    ds_read_b32 v100, v105 offset:17408
    ds_read_b32 v101, v105 offset:17664
    ds_read_b32 v102, v105 offset:17920
    ds_read_b32 v103, v105 offset:18176
    s_waitcnt lgkmcnt(0)
    v_add_f32 v96, v96, v100
    v_add_f32 v97, v97, v101
    v_add_f32 v98, v98, v102
    v_add_f32 v99, v99, v103
    v_add_f32 v96, v96, v98
    v_add_f32 v97, v97, v99
    v_add_f32 v96, v96, v97
    v_cvt_pk_bf16_f32 v96, 0, v96
    s_lshl_b32 s46, s53, 1
    buffer_store_dword v96, v105, s[12:15], s46 offen sc1
L_m_sk_25:
    s_barrier
    s_add_u32 s53, s53, 128
    s_and_b32 s46, s53, 511
    s_cmp_lg_u32 s46, 0
    s_cbranch_scc1 L_m_loop_24
    s_lshl_b32 s54, s55, 7
    s_add_u32 s54, s54, 0x10e400
    s_mov_b32 s60, 0
    s_waitcnt vmcnt(0)
    s_cmp_lg_u32 s44, 0
    s_cbranch_scc1 L_sf_26
    v_mov_b32 v8, s60
    v_add_u32 v8, 1, v8
    v_mov_b32 v9, 0
    s_mov_b64 exec, 1
    buffer_store_dword v8, v9, s[12:15], s54 offen sc1
    s_mov_b64 exec, -1
L_sf_26:
    s_barrier
L_w_h_17_s:
    s_mov_b32 s77, s48
    s_cmp_eq_u32 s48, 14
    s_cselect_b32 s53, 2, 1
    s_sub_u32 s48, s48, 12
    s_min_u32 s48, s48, 2
    s_mov_b32 s79, 0
L_w_h_17_n:
    s_cmp_eq_u32 s53, 1
    s_cselect_b32 s74, 41, 54
    s_cselect_b32 s75, 58, 64
    s_mov_b32 s76, 65536
    s_branch L_w_g_10_e
L_w_h_17:
    s_mov_b32 s48, s77
    s_cmp_lt_u32 s48, 14
    s_cbranch_scc1 L_w_att_15
    s_and_b32 s42, s40, 3
    s_lshr_b32 s43, s40, 2
    s_cmp_eq_u32 s48, 14
    s_cbranch_scc1 L_w_c_16
    s_mov_b32 s75, 60
    s_mov_b32 s76, 0
    s_mov_b32 s78, 2
L_w_h_17_f:
    s_load_dwordx2 s[4:5], s[0:1], 112
    s_load_dwordx2 s[6:7], s[0:1], 88
    v_lshlrev_b32 v2, 4, v1
    v_lshlrev_b32 v3, 5, v1
    s_waitcnt lgkmcnt(0)
    s_mov_b32 s24, s4
    s_and_b32 s25, s5, 0xffff
    s_mov_b32 s26, 0x400000
    s_mov_b32 s27, 0x00020000
    s_mov_b32 s28, s6
    s_and_b32 s29, s7, 0xffff
    s_mov_b32 s30, 0x800
    s_mov_b32 s31, 0x00020000
    s_cmp_lg_u32 s44, 0
    s_cbranch_scc1 L_mw_27
    v_and_b32 v8, 15, v1
    v_lshlrev_b32 v8, 7, v8
    s_mov_b32 s46, 0x10e400
    s_mov_b32 s47, 0
    s_mov_b32 s70, 0
L_spin_28:
    buffer_load_dword v9, v8, s[12:15], s46 offen sc1
    s_waitcnt vmcnt(0)
    v_cmp_ge_u32 vcc, s47, v9
    s_add_u32 s70, s70, 1
    s_cbranch_vccz L_spok_29
    s_sleep 2
    s_cmp_lt_u32 s70, 524288
    s_cbranch_scc1 L_spin_28
    s_branch L_c_done_1
L_spok_29:
L_mw_27:
    s_barrier
    s_mov_b32 s46, 20480
    buffer_load_dwordx4 v[16:19], v3, s[12:15], s46 offen offset:0 sc1
    buffer_load_dwordx4 v[20:23], v3, s[12:15], s46 offen offset:16 sc1
    buffer_load_dwordx4 v[24:27], v3, s[12:15], s46 offen offset:2048 sc1
    buffer_load_dwordx4 v[28:31], v3, s[12:15], s46 offen offset:2064 sc1
    buffer_load_dwordx4 v[48:51], v2, s[28:31], 0 offen
    buffer_load_dwordx4 v[52:55], v2, s[28:31], 0 offen offset:1024
    s_waitcnt vmcnt(0)
    v_lshlrev_b32 v32, 16, v48
    v_and_b32 v33, 0xffff0000, v48
    v_lshlrev_b32 v34, 16, v49
    v_and_b32 v35, 0xffff0000, v49
    v_lshlrev_b32 v36, 16, v50
    v_and_b32 v37, 0xffff0000, v50
    v_lshlrev_b32 v38, 16, v51
    v_and_b32 v39, 0xffff0000, v51
    v_lshlrev_b32 v40, 16, v52
    v_and_b32 v41, 0xffff0000, v52
    v_lshlrev_b32 v42, 16, v53
    v_and_b32 v43, 0xffff0000, v53
    v_lshlrev_b32 v44, 16, v54
    v_and_b32 v45, 0xffff0000, v54
    v_lshlrev_b32 v46, 16, v55
    v_and_b32 v47, 0xffff0000, v55
    s_lshl_b32 s46, s42, 14
    s_lshl_b32 s47, s44, 11
    s_add_u32 s46, s46, s47
    s_add_u32 s46, s46, 0xb000000
    v_add_u32 v4, s46, v2
    v_and_b32 v5, 31, v1
    v_lshlrev_b32 v5, 7, v5
    v_add_u32 v5, 0x108400, v5
    v_lshlrev_b32 v6, 2, v1
    s_lshl_b32 s46, s44, 9
    v_add_u32 v6, s46, v6
    s_lshl_b32 s46, s44, 12
    v_add_u32 v7, s46, v3
    s_lshl_b32 s46, s42, 3
    s_add_u32 s46, s46, s44
    s_lshl_b32 s46, s46, 11
    v_add_u32 v8, s46, v2
    v_add_u32 v9, 0x800000, v8
    s_mov_b32 s60, s43
L_r_loop_30:
    s_lshl_b32 s61, s60, 18
    s_lshl_b32 s63, s60, 16
    s_cmp_lg_u32 s44, 0
    s_cbranch_scc1 L_r_nsp_31
    s_mov_b32 s70, 0
L_spin_32:
    buffer_load_dword v14, v5, s[12:15], s76 offen sc1
    s_waitcnt vmcnt(0)
    v_cmp_ge_u32 vcc, s60, v14
    s_add_u32 s70, s70, 1
    s_cbranch_vccz L_spok_33
    s_sleep 3
    s_cmp_lt_u32 s70, 524288
    s_cbranch_scc1 L_spin_32
    s_branch L_c_done_1
L_spok_33:
L_r_nsp_31:
    s_barrier
    buffer_load_dwordx4 v[96:99], v4, s[12:15], s61 offen offset:0 sc1
    buffer_load_dwordx4 v[100:103], v4, s[12:15], s61 offen offset:1024 sc1
    s_add_u32 s61, s61, 65536
    buffer_load_dwordx4 v[104:107], v4, s[12:15], s61 offen offset:0 sc1
    buffer_load_dwordx4 v[108:111], v4, s[12:15], s61 offen offset:1024 sc1
    s_add_u32 s61, s61, 65536
    buffer_load_dwordx4 v[112:115], v4, s[12:15], s61 offen offset:0 sc1
    buffer_load_dwordx4 v[116:119], v4, s[12:15], s61 offen offset:1024 sc1
    s_add_u32 s61, s61, 65536
    buffer_load_dwordx4 v[120:123], v4, s[12:15], s61 offen offset:0 sc1
    buffer_load_dwordx4 v[124:127], v4, s[12:15], s61 offen offset:1024 sc1
    buffer_load_dwordx4 a[0:3], v9, s[12:15], s63 offen sc1
    buffer_load_dwordx4 a[4:7], v9, s[12:15], s63 offen offset:1024 sc1
    s_waitcnt vmcnt(8)
    v_lshlrev_b32 v64, 16, v96
    v_and_b32 v65, 0xffff0000, v96
    v_lshlrev_b32 v66, 16, v97
    v_and_b32 v67, 0xffff0000, v97
    v_lshlrev_b32 v68, 16, v98
    v_and_b32 v69, 0xffff0000, v98
    v_lshlrev_b32 v70, 16, v99
    v_and_b32 v71, 0xffff0000, v99
    v_lshlrev_b32 v72, 16, v100
    v_and_b32 v73, 0xffff0000, v100
    v_lshlrev_b32 v74, 16, v101
    v_and_b32 v75, 0xffff0000, v101
    v_lshlrev_b32 v76, 16, v102
    v_and_b32 v77, 0xffff0000, v102
    v_lshlrev_b32 v78, 16, v103
    v_and_b32 v79, 0xffff0000, v103
    s_waitcnt vmcnt(6)
    v_lshlrev_b32 v80, 16, v104
    v_and_b32 v81, 0xffff0000, v104
    v_lshlrev_b32 v82, 16, v105
    v_and_b32 v83, 0xffff0000, v105
    v_lshlrev_b32 v84, 16, v106
    v_and_b32 v85, 0xffff0000, v106
    v_lshlrev_b32 v86, 16, v107
    v_and_b32 v87, 0xffff0000, v107
    v_lshlrev_b32 v88, 16, v108
    v_and_b32 v89, 0xffff0000, v108
    v_lshlrev_b32 v90, 16, v109
    v_and_b32 v91, 0xffff0000, v109
    v_lshlrev_b32 v92, 16, v110
    v_and_b32 v93, 0xffff0000, v110
    v_lshlrev_b32 v94, 16, v111
    v_and_b32 v95, 0xffff0000, v111
    v_pk_add_f32 v[64:65], v[64:65], v[80:81]
    v_pk_add_f32 v[66:67], v[66:67], v[82:83]
    v_pk_add_f32 v[68:69], v[68:69], v[84:85]
    v_pk_add_f32 v[70:71], v[70:71], v[86:87]
    v_pk_add_f32 v[72:73], v[72:73], v[88:89]
    v_pk_add_f32 v[74:75], v[74:75], v[90:91]
    v_pk_add_f32 v[76:77], v[76:77], v[92:93]
    v_pk_add_f32 v[78:79], v[78:79], v[94:95]
    s_waitcnt vmcnt(4)
    v_lshlrev_b32 v80, 16, v112
    v_and_b32 v81, 0xffff0000, v112
    v_lshlrev_b32 v82, 16, v113
    v_and_b32 v83, 0xffff0000, v113
    v_lshlrev_b32 v84, 16, v114
    v_and_b32 v85, 0xffff0000, v114
    v_lshlrev_b32 v86, 16, v115
    v_and_b32 v87, 0xffff0000, v115
    v_lshlrev_b32 v88, 16, v116
    v_and_b32 v89, 0xffff0000, v116
    v_lshlrev_b32 v90, 16, v117
    v_and_b32 v91, 0xffff0000, v117
    v_lshlrev_b32 v92, 16, v118
    v_and_b32 v93, 0xffff0000, v118
    v_lshlrev_b32 v94, 16, v119
    v_and_b32 v95, 0xffff0000, v119
    v_pk_add_f32 v[64:65], v[64:65], v[80:81]
    v_pk_add_f32 v[66:67], v[66:67], v[82:83]
    v_pk_add_f32 v[68:69], v[68:69], v[84:85]
    v_pk_add_f32 v[70:71], v[70:71], v[86:87]
    v_pk_add_f32 v[72:73], v[72:73], v[88:89]
    v_pk_add_f32 v[74:75], v[74:75], v[90:91]
    v_pk_add_f32 v[76:77], v[76:77], v[92:93]
    v_pk_add_f32 v[78:79], v[78:79], v[94:95]
    s_waitcnt vmcnt(2)
    v_lshlrev_b32 v80, 16, v120
    v_and_b32 v81, 0xffff0000, v120
    v_lshlrev_b32 v82, 16, v121
    v_and_b32 v83, 0xffff0000, v121
    v_lshlrev_b32 v84, 16, v122
    v_and_b32 v85, 0xffff0000, v122
    v_lshlrev_b32 v86, 16, v123
    v_and_b32 v87, 0xffff0000, v123
    v_lshlrev_b32 v88, 16, v124
    v_and_b32 v89, 0xffff0000, v124
    v_lshlrev_b32 v90, 16, v125
    v_and_b32 v91, 0xffff0000, v125
    v_lshlrev_b32 v92, 16, v126
    v_and_b32 v93, 0xffff0000, v126
    v_lshlrev_b32 v94, 16, v127
    v_and_b32 v95, 0xffff0000, v127
    v_pk_add_f32 v[64:65], v[64:65], v[80:81]
    v_pk_add_f32 v[66:67], v[66:67], v[82:83]
    v_pk_add_f32 v[68:69], v[68:69], v[84:85]
    v_pk_add_f32 v[70:71], v[70:71], v[86:87]
    v_pk_add_f32 v[72:73], v[72:73], v[88:89]
    v_pk_add_f32 v[74:75], v[74:75], v[90:91]
    v_pk_add_f32 v[76:77], v[76:77], v[92:93]
    v_pk_add_f32 v[78:79], v[78:79], v[94:95]
    ds_write_b32 v6, v64 offset:0
    ds_write_b32 v6, v65 offset:4096
    ds_write_b32 v6, v66 offset:8192
    ds_write_b32 v6, v67 offset:12288
    ds_write_b32 v6, v68 offset:16384
    ds_write_b32 v6, v69 offset:20480
    ds_write_b32 v6, v70 offset:24576
    ds_write_b32 v6, v71 offset:28672
    ds_write_b32 v6, v72 offset:256
    ds_write_b32 v6, v73 offset:4352
    ds_write_b32 v6, v74 offset:8448
    ds_write_b32 v6, v75 offset:12544
    ds_write_b32 v6, v76 offset:16640
    ds_write_b32 v6, v77 offset:20736
    ds_write_b32 v6, v78 offset:24832
    ds_write_b32 v6, v79 offset:28928
    s_waitcnt lgkmcnt(0)
    s_barrier
    ds_read_b128 v[64:67], v7
    ds_read_b128 v[68:71], v7 offset:16
    ds_read_b128 v[72:75], v7 offset:2048
    ds_read_b128 v[76:79], v7 offset:2064
    s_waitcnt vmcnt(0)
    v_accvgpr_read_b32 v96, a0
    v_accvgpr_read_b32 v97, a1
    v_accvgpr_read_b32 v98, a2
    v_accvgpr_read_b32 v99, a3
    v_accvgpr_read_b32 v100, a4
    v_accvgpr_read_b32 v101, a5
    v_accvgpr_read_b32 v102, a6
    v_accvgpr_read_b32 v103, a7
    v_lshlrev_b32 v80, 16, v96
    v_and_b32 v81, 0xffff0000, v96
    v_lshlrev_b32 v82, 16, v97
    v_and_b32 v83, 0xffff0000, v97
    v_lshlrev_b32 v84, 16, v98
    v_and_b32 v85, 0xffff0000, v98
    v_lshlrev_b32 v86, 16, v99
    v_and_b32 v87, 0xffff0000, v99
    v_lshlrev_b32 v88, 16, v100
    v_and_b32 v89, 0xffff0000, v100
    v_lshlrev_b32 v90, 16, v101
    v_and_b32 v91, 0xffff0000, v101
    v_lshlrev_b32 v92, 16, v102
    v_and_b32 v93, 0xffff0000, v102
    v_lshlrev_b32 v94, 16, v103
    v_and_b32 v95, 0xffff0000, v103
    s_waitcnt lgkmcnt(0)
    v_cvt_pk_bf16_f32 v64, 0, v64
    v_cvt_pk_bf16_f32 v65, 0, v65
    v_cvt_pk_bf16_f32 v66, 0, v66
    v_cvt_pk_bf16_f32 v67, 0, v67
    v_cvt_pk_bf16_f32 v68, 0, v68
    v_cvt_pk_bf16_f32 v69, 0, v69
    v_cvt_pk_bf16_f32 v70, 0, v70
    v_cvt_pk_bf16_f32 v71, 0, v71
    v_cvt_pk_bf16_f32 v72, 0, v72
    v_cvt_pk_bf16_f32 v73, 0, v73
    v_cvt_pk_bf16_f32 v74, 0, v74
    v_cvt_pk_bf16_f32 v75, 0, v75
    v_cvt_pk_bf16_f32 v76, 0, v76
    v_cvt_pk_bf16_f32 v77, 0, v77
    v_cvt_pk_bf16_f32 v78, 0, v78
    v_cvt_pk_bf16_f32 v79, 0, v79
    v_pk_add_f32 v[64:65], v[64:65], v[32:33]
    v_pk_add_f32 v[66:67], v[66:67], v[34:35]
    v_pk_add_f32 v[68:69], v[68:69], v[36:37]
    v_pk_add_f32 v[70:71], v[70:71], v[38:39]
    v_pk_add_f32 v[72:73], v[72:73], v[40:41]
    v_pk_add_f32 v[74:75], v[74:75], v[42:43]
    v_pk_add_f32 v[76:77], v[76:77], v[44:45]
    v_pk_add_f32 v[78:79], v[78:79], v[46:47]
    v_cvt_pk_bf16_f32 v64, 0, v64
    v_cvt_pk_bf16_f32 v65, 0, v65
    v_cvt_pk_bf16_f32 v66, 0, v66
    v_cvt_pk_bf16_f32 v67, 0, v67
    v_cvt_pk_bf16_f32 v68, 0, v68
    v_cvt_pk_bf16_f32 v69, 0, v69
    v_cvt_pk_bf16_f32 v70, 0, v70
    v_cvt_pk_bf16_f32 v71, 0, v71
    v_cvt_pk_bf16_f32 v72, 0, v72
    v_cvt_pk_bf16_f32 v73, 0, v73
    v_cvt_pk_bf16_f32 v74, 0, v74
    v_cvt_pk_bf16_f32 v75, 0, v75
    v_cvt_pk_bf16_f32 v76, 0, v76
    v_cvt_pk_bf16_f32 v77, 0, v77
    v_cvt_pk_bf16_f32 v78, 0, v78
    v_cvt_pk_bf16_f32 v79, 0, v79
    v_pk_mul_f32 v[64:65], v[64:65], v[16:17]
    v_pk_mul_f32 v[66:67], v[66:67], v[18:19]
    v_pk_mul_f32 v[68:69], v[68:69], v[20:21]
    v_pk_mul_f32 v[70:71], v[70:71], v[22:23]
    v_pk_mul_f32 v[72:73], v[72:73], v[24:25]
    v_pk_mul_f32 v[74:75], v[74:75], v[26:27]
    v_pk_mul_f32 v[76:77], v[76:77], v[28:29]
    v_pk_mul_f32 v[78:79], v[78:79], v[30:31]
    v_cvt_pk_bf16_f32 v64, 0, v64
    v_cvt_pk_bf16_f32 v65, 0, v65
    v_cvt_pk_bf16_f32 v66, 0, v66
    v_cvt_pk_bf16_f32 v67, 0, v67
    v_cvt_pk_bf16_f32 v68, 0, v68
    v_cvt_pk_bf16_f32 v69, 0, v69
    v_cvt_pk_bf16_f32 v70, 0, v70
    v_cvt_pk_bf16_f32 v71, 0, v71
    v_cvt_pk_bf16_f32 v72, 0, v72
    v_cvt_pk_bf16_f32 v73, 0, v73
    v_cvt_pk_bf16_f32 v74, 0, v74
    v_cvt_pk_bf16_f32 v75, 0, v75
    v_cvt_pk_bf16_f32 v76, 0, v76
    v_cvt_pk_bf16_f32 v77, 0, v77
    v_cvt_pk_bf16_f32 v78, 0, v78
    v_cvt_pk_bf16_f32 v79, 0, v79
    v_pk_add_f32 v[64:65], v[64:65], v[80:81]
    v_pk_add_f32 v[66:67], v[66:67], v[82:83]
    v_pk_add_f32 v[68:69], v[68:69], v[84:85]
    v_pk_add_f32 v[70:71], v[70:71], v[86:87]
    v_pk_add_f32 v[72:73], v[72:73], v[88:89]
    v_pk_add_f32 v[74:75], v[74:75], v[90:91]
    v_pk_add_f32 v[76:77], v[76:77], v[92:93]
    v_pk_add_f32 v[78:79], v[78:79], v[94:95]
    v_cvt_pk_bf16_f32 v96, v64, v65
    v_cvt_pk_bf16_f32 v97, v66, v67
    v_cvt_pk_bf16_f32 v98, v68, v69
    v_cvt_pk_bf16_f32 v99, v70, v71
    v_cvt_pk_bf16_f32 v100, v72, v73
    v_cvt_pk_bf16_f32 v101, v74, v75
    v_cvt_pk_bf16_f32 v102, v76, v77
    v_cvt_pk_bf16_f32 v103, v78, v79
    buffer_store_dwordx4 v[96:99], v8, s[24:27], s63 offen
    buffer_store_dwordx4 v[100:103], v8, s[24:27], s63 offen offset:1024
    s_add_u32 s60, s60, s78
    s_cmp_lt_u32 s60, s75
    s_cbranch_scc1 L_r_loop_30
    s_branch L_c_done_1
L_w_c_16:
    s_load_dwordx2 s[4:5], s[0:1], 0
    s_load_dwordx2 s[6:7], s[0:1], 88
    v_lshlrev_b32 v2, 4, v1
    v_lshlrev_b32 v3, 5, v1
    s_waitcnt lgkmcnt(0)
    s_mov_b32 s24, s4
    s_and_b32 s25, s5, 0xffff
    s_mov_b32 s26, 0x400000
    s_mov_b32 s27, 0x00020000
    s_mov_b32 s28, s6
    s_and_b32 s29, s7, 0xffff
    s_mov_b32 s30, 0x800
    s_mov_b32 s31, 0x00020000
    s_cmp_lg_u32 s44, 0
    s_cbranch_scc1 L_mw_34
    v_and_b32 v8, 15, v1
    v_lshlrev_b32 v8, 7, v8
    s_mov_b32 s46, 0x10e400
    s_mov_b32 s47, 0
    s_mov_b32 s70, 0
L_spin_35:
    buffer_load_dword v9, v8, s[12:15], s46 offen sc1
    s_waitcnt vmcnt(0)
    v_cmp_ge_u32 vcc, s47, v9
    s_add_u32 s70, s70, 1
    s_cbranch_vccz L_spok_36
    s_sleep 2
    s_cmp_lt_u32 s70, 524288
    s_cbranch_scc1 L_spin_35
    s_branch L_c_done_1
L_spok_36:
L_mw_34:
    s_barrier
    s_mov_b32 s46, 8192
    buffer_load_dwordx4 v[16:19], v3, s[12:15], s46 offen offset:0 sc1
    buffer_load_dwordx4 v[20:23], v3, s[12:15], s46 offen offset:16 sc1
    buffer_load_dwordx4 v[24:27], v3, s[12:15], s46 offen offset:2048 sc1
    buffer_load_dwordx4 v[28:31], v3, s[12:15], s46 offen offset:2064 sc1
    s_mov_b32 s46, 16384
    buffer_load_dwordx4 v[32:35], v3, s[12:15], s46 offen offset:0 sc1
    buffer_load_dwordx4 v[36:39], v3, s[12:15], s46 offen offset:16 sc1
    buffer_load_dwordx4 v[40:43], v3, s[12:15], s46 offen offset:2048 sc1
    buffer_load_dwordx4 v[44:47], v3, s[12:15], s46 offen offset:2064 sc1
    s_mov_b32 s46, 12288
    buffer_load_dwordx4 v[48:51], v3, s[12:15], s46 offen offset:0 sc1
    buffer_load_dwordx4 v[52:55], v3, s[12:15], s46 offen offset:16 sc1
    buffer_load_dwordx4 v[56:59], v3, s[12:15], s46 offen offset:2048 sc1
    buffer_load_dwordx4 v[60:63], v3, s[12:15], s46 offen offset:2064 sc1
    s_waitcnt vmcnt(0)
    v_add_f32 v32, 1.0, v32
    v_add_f32 v33, 1.0, v33
    v_add_f32 v34, 1.0, v34
    v_add_f32 v35, 1.0, v35
    v_add_f32 v36, 1.0, v36
    v_add_f32 v37, 1.0, v37
    v_add_f32 v38, 1.0, v38
    v_add_f32 v39, 1.0, v39
    v_add_f32 v40, 1.0, v40
    v_add_f32 v41, 1.0, v41
    v_add_f32 v42, 1.0, v42
    v_add_f32 v43, 1.0, v43
    v_add_f32 v44, 1.0, v44
    v_add_f32 v45, 1.0, v45
    v_add_f32 v46, 1.0, v46
    v_add_f32 v47, 1.0, v47
    v_cvt_pk_bf16_f32 v32, 0, v32
    v_cvt_pk_bf16_f32 v33, 0, v33
    v_cvt_pk_bf16_f32 v34, 0, v34
    v_cvt_pk_bf16_f32 v35, 0, v35
    v_cvt_pk_bf16_f32 v36, 0, v36
    v_cvt_pk_bf16_f32 v37, 0, v37
    v_cvt_pk_bf16_f32 v38, 0, v38
    v_cvt_pk_bf16_f32 v39, 0, v39
    v_cvt_pk_bf16_f32 v40, 0, v40
    v_cvt_pk_bf16_f32 v41, 0, v41
    v_cvt_pk_bf16_f32 v42, 0, v42
    v_cvt_pk_bf16_f32 v43, 0, v43
    v_cvt_pk_bf16_f32 v44, 0, v44
    v_cvt_pk_bf16_f32 v45, 0, v45
    v_cvt_pk_bf16_f32 v46, 0, v46
    v_cvt_pk_bf16_f32 v47, 0, v47
    s_lshl_b32 s46, s42, 14
    s_lshl_b32 s47, s44, 11
    s_add_u32 s46, s46, s47
    s_add_u32 s46, s46, 0x9000000
    v_add_u32 v4, s46, v2
    v_and_b32 v5, 31, v1
    v_lshlrev_b32 v5, 7, v5
    v_add_u32 v5, 0x107400, v5
    v_lshlrev_b32 v6, 2, v1
    s_lshl_b32 s46, s44, 9
    v_add_u32 v6, s46, v6
    s_lshl_b32 s46, s44, 12
    v_add_u32 v7, s46, v3
    s_lshl_b32 s46, s42, 3
    s_add_u32 s46, s46, s44
    s_lshl_b32 s46, s46, 11
    v_add_u32 v8, s46, v2
    v_add_u32 v9, 0x800000, v8
    s_mul_i32 s46, s44, 2064
    s_add_u32 s46, s46, 32768
    v_add_u32 v10, s46, v2
    v_and_b32 v11, 7, v1
    v_lshrrev_b32 v12, 3, v1
    v_mul_u32_u24 v13, 2064, v11
    v_lshl_add_u32 v13, v12, 4, v13
    s_lshl_b32 s46, s44, 8
    s_add_u32 s46, s46, 32768
    v_add_u32 v13, s46, v13
    v_lshlrev_b32 v11, 4, v11
    v_lshl_add_u32 v11, v12, 9, v11
    s_lshl_b32 s46, s44, 13
    s_lshl_b32 s47, s42, 7
    s_add_u32 s46, s46, s47
    s_add_u32 s46, s46, 0xc00000
    v_add_u32 v11, s46, v11
    v_add_u32 v12, 4096, v11
    s_lshl_b32 s52, s43, 9
    s_lshl_b32 s47, s42, 7
    s_add_u32 s52, s52, s47
    s_add_u32 s52, s52, 0x10ec00
    s_mov_b32 s60, s43
L_r_loop_37:
    s_lshl_b32 s61, s60, 18
    s_lshl_b32 s63, s60, 16
    buffer_load_dwordx4 a[0:3], v8, s[24:27], s63 offen
    buffer_load_dwordx4 a[4:7], v8, s[24:27], s63 offen offset:1024
    s_cmp_lg_u32 s44, 0
    s_cbranch_scc1 L_r_nsp_38
    s_mov_b32 s70, 0
L_spin_39:
    buffer_load_dword v14, v5, s[12:15], 0 offen sc1
    s_waitcnt vmcnt(0)
    v_cmp_ge_u32 vcc, s60, v14
    s_add_u32 s70, s70, 1
    s_cbranch_vccz L_spok_40
    s_sleep 3
    s_cmp_lt_u32 s70, 524288
    s_cbranch_scc1 L_spin_39
    s_branch L_c_done_1
L_spok_40:
L_r_nsp_38:
    s_barrier
    buffer_load_dwordx4 v[96:99], v4, s[12:15], s61 offen offset:0 sc1
    buffer_load_dwordx4 v[100:103], v4, s[12:15], s61 offen offset:1024 sc1
    s_add_u32 s61, s61, 65536
    buffer_load_dwordx4 v[104:107], v4, s[12:15], s61 offen offset:0 sc1
    buffer_load_dwordx4 v[108:111], v4, s[12:15], s61 offen offset:1024 sc1
    s_add_u32 s61, s61, 65536
    buffer_load_dwordx4 v[112:115], v4, s[12:15], s61 offen offset:0 sc1
    buffer_load_dwordx4 v[116:119], v4, s[12:15], s61 offen offset:1024 sc1
    s_add_u32 s61, s61, 65536
    buffer_load_dwordx4 v[120:123], v4, s[12:15], s61 offen offset:0 sc1
    buffer_load_dwordx4 v[124:127], v4, s[12:15], s61 offen offset:1024 sc1
    s_waitcnt vmcnt(6)
    v_lshlrev_b32 v64, 16, v96
    v_and_b32 v65, 0xffff0000, v96
    v_lshlrev_b32 v66, 16, v97
    v_and_b32 v67, 0xffff0000, v97
    v_lshlrev_b32 v68, 16, v98
    v_and_b32 v69, 0xffff0000, v98
    v_lshlrev_b32 v70, 16, v99
    v_and_b32 v71, 0xffff0000, v99
    v_lshlrev_b32 v72, 16, v100
    v_and_b32 v73, 0xffff0000, v100
    v_lshlrev_b32 v74, 16, v101
    v_and_b32 v75, 0xffff0000, v101
    v_lshlrev_b32 v76, 16, v102
    v_and_b32 v77, 0xffff0000, v102
    v_lshlrev_b32 v78, 16, v103
    v_and_b32 v79, 0xffff0000, v103
    s_waitcnt vmcnt(4)
    v_lshlrev_b32 v80, 16, v104
    v_and_b32 v81, 0xffff0000, v104
    v_lshlrev_b32 v82, 16, v105
    v_and_b32 v83, 0xffff0000, v105
    v_lshlrev_b32 v84, 16, v106
    v_and_b32 v85, 0xffff0000, v106
    v_lshlrev_b32 v86, 16, v107
    v_and_b32 v87, 0xffff0000, v107
    v_lshlrev_b32 v88, 16, v108
    v_and_b32 v89, 0xffff0000, v108
    v_lshlrev_b32 v90, 16, v109
    v_and_b32 v91, 0xffff0000, v109
    v_lshlrev_b32 v92, 16, v110
    v_and_b32 v93, 0xffff0000, v110
    v_lshlrev_b32 v94, 16, v111
    v_and_b32 v95, 0xffff0000, v111
    v_pk_add_f32 v[64:65], v[64:65], v[80:81]
    v_pk_add_f32 v[66:67], v[66:67], v[82:83]
    v_pk_add_f32 v[68:69], v[68:69], v[84:85]
    v_pk_add_f32 v[70:71], v[70:71], v[86:87]
    v_pk_add_f32 v[72:73], v[72:73], v[88:89]
    v_pk_add_f32 v[74:75], v[74:75], v[90:91]
    v_pk_add_f32 v[76:77], v[76:77], v[92:93]
    v_pk_add_f32 v[78:79], v[78:79], v[94:95]
    s_waitcnt vmcnt(2)
    v_lshlrev_b32 v80, 16, v112
    v_and_b32 v81, 0xffff0000, v112
    v_lshlrev_b32 v82, 16, v113
    v_and_b32 v83, 0xffff0000, v113
    v_lshlrev_b32 v84, 16, v114
    v_and_b32 v85, 0xffff0000, v114
    v_lshlrev_b32 v86, 16, v115
    v_and_b32 v87, 0xffff0000, v115
    v_lshlrev_b32 v88, 16, v116
    v_and_b32 v89, 0xffff0000, v116
    v_lshlrev_b32 v90, 16, v117
    v_and_b32 v91, 0xffff0000, v117
    v_lshlrev_b32 v92, 16, v118
    v_and_b32 v93, 0xffff0000, v118
    v_lshlrev_b32 v94, 16, v119
    v_and_b32 v95, 0xffff0000, v119
    v_pk_add_f32 v[64:65], v[64:65], v[80:81]
    v_pk_add_f32 v[66:67], v[66:67], v[82:83]
    v_pk_add_f32 v[68:69], v[68:69], v[84:85]
    v_pk_add_f32 v[70:71], v[70:71], v[86:87]
    v_pk_add_f32 v[72:73], v[72:73], v[88:89]
    v_pk_add_f32 v[74:75], v[74:75], v[90:91]
    v_pk_add_f32 v[76:77], v[76:77], v[92:93]
    v_pk_add_f32 v[78:79], v[78:79], v[94:95]
    s_waitcnt vmcnt(0)
    v_lshlrev_b32 v80, 16, v120
    v_and_b32 v81, 0xffff0000, v120
    v_lshlrev_b32 v82, 16, v121
    v_and_b32 v83, 0xffff0000, v121
    v_lshlrev_b32 v84, 16, v122
    v_and_b32 v85, 0xffff0000, v122
    v_lshlrev_b32 v86, 16, v123
    v_and_b32 v87, 0xffff0000, v123
    v_lshlrev_b32 v88, 16, v124
    v_and_b32 v89, 0xffff0000, v124
    v_lshlrev_b32 v90, 16, v125
    v_and_b32 v91, 0xffff0000, v125
    v_lshlrev_b32 v92, 16, v126
    v_and_b32 v93, 0xffff0000, v126
    v_lshlrev_b32 v94, 16, v127
    v_and_b32 v95, 0xffff0000, v127
    v_pk_add_f32 v[64:65], v[64:65], v[80:81]
    v_pk_add_f32 v[66:67], v[66:67], v[82:83]
    v_pk_add_f32 v[68:69], v[68:69], v[84:85]
    v_pk_add_f32 v[70:71], v[70:71], v[86:87]
    v_pk_add_f32 v[72:73], v[72:73], v[88:89]
    v_pk_add_f32 v[74:75], v[74:75], v[90:91]
    v_pk_add_f32 v[76:77], v[76:77], v[92:93]
    v_pk_add_f32 v[78:79], v[78:79], v[94:95]
    ds_write_b32 v6, v64 offset:0
    ds_write_b32 v6, v65 offset:4096
    ds_write_b32 v6, v66 offset:8192
    ds_write_b32 v6, v67 offset:12288
    ds_write_b32 v6, v68 offset:16384
    ds_write_b32 v6, v69 offset:20480
    ds_write_b32 v6, v70 offset:24576
    ds_write_b32 v6, v71 offset:28672
    ds_write_b32 v6, v72 offset:256
    ds_write_b32 v6, v73 offset:4352
    ds_write_b32 v6, v74 offset:8448
    ds_write_b32 v6, v75 offset:12544
    ds_write_b32 v6, v76 offset:16640
    ds_write_b32 v6, v77 offset:20736
    ds_write_b32 v6, v78 offset:24832
    ds_write_b32 v6, v79 offset:28928
    s_waitcnt lgkmcnt(0)
    s_barrier
    ds_read_b128 v[64:67], v7
    ds_read_b128 v[68:71], v7 offset:16
    ds_read_b128 v[72:75], v7 offset:2048
    ds_read_b128 v[76:79], v7 offset:2064
    s_waitcnt vmcnt(0)
    v_accvgpr_read_b32 v96, a0
    v_accvgpr_read_b32 v97, a1
    v_accvgpr_read_b32 v98, a2
    v_accvgpr_read_b32 v99, a3
    v_accvgpr_read_b32 v100, a4
    v_accvgpr_read_b32 v101, a5
    v_accvgpr_read_b32 v102, a6
    v_accvgpr_read_b32 v103, a7
    v_lshlrev_b32 v80, 16, v96
    v_and_b32 v81, 0xffff0000, v96
    v_lshlrev_b32 v82, 16, v97
    v_and_b32 v83, 0xffff0000, v97
    v_lshlrev_b32 v84, 16, v98
    v_and_b32 v85, 0xffff0000, v98
    v_lshlrev_b32 v86, 16, v99
    v_and_b32 v87, 0xffff0000, v99
    v_lshlrev_b32 v88, 16, v100
    v_and_b32 v89, 0xffff0000, v100
    v_lshlrev_b32 v90, 16, v101
    v_and_b32 v91, 0xffff0000, v101
    v_lshlrev_b32 v92, 16, v102
    v_and_b32 v93, 0xffff0000, v102
    v_lshlrev_b32 v94, 16, v103
    v_and_b32 v95, 0xffff0000, v103
    s_waitcnt lgkmcnt(0)
    v_cvt_pk_bf16_f32 v64, 0, v64
    v_cvt_pk_bf16_f32 v65, 0, v65
    v_cvt_pk_bf16_f32 v66, 0, v66
    v_cvt_pk_bf16_f32 v67, 0, v67
    v_cvt_pk_bf16_f32 v68, 0, v68
    v_cvt_pk_bf16_f32 v69, 0, v69
    v_cvt_pk_bf16_f32 v70, 0, v70
    v_cvt_pk_bf16_f32 v71, 0, v71
    v_cvt_pk_bf16_f32 v72, 0, v72
    v_cvt_pk_bf16_f32 v73, 0, v73
    v_cvt_pk_bf16_f32 v74, 0, v74
    v_cvt_pk_bf16_f32 v75, 0, v75
    v_cvt_pk_bf16_f32 v76, 0, v76
    v_cvt_pk_bf16_f32 v77, 0, v77
    v_cvt_pk_bf16_f32 v78, 0, v78
    v_cvt_pk_bf16_f32 v79, 0, v79
    v_pk_mul_f32 v[64:65], v[64:65], v[16:17]
    v_pk_mul_f32 v[66:67], v[66:67], v[18:19]
    v_pk_mul_f32 v[68:69], v[68:69], v[20:21]
    v_pk_mul_f32 v[70:71], v[70:71], v[22:23]
    v_pk_mul_f32 v[72:73], v[72:73], v[24:25]
    v_pk_mul_f32 v[74:75], v[74:75], v[26:27]
    v_pk_mul_f32 v[76:77], v[76:77], v[28:29]
    v_pk_mul_f32 v[78:79], v[78:79], v[30:31]
    v_cvt_pk_bf16_f32 v64, 0, v64
    v_cvt_pk_bf16_f32 v65, 0, v65
    v_cvt_pk_bf16_f32 v66, 0, v66
    v_cvt_pk_bf16_f32 v67, 0, v67
    v_cvt_pk_bf16_f32 v68, 0, v68
    v_cvt_pk_bf16_f32 v69, 0, v69
    v_cvt_pk_bf16_f32 v70, 0, v70
    v_cvt_pk_bf16_f32 v71, 0, v71
    v_cvt_pk_bf16_f32 v72, 0, v72
    v_cvt_pk_bf16_f32 v73, 0, v73
    v_cvt_pk_bf16_f32 v74, 0, v74
    v_cvt_pk_bf16_f32 v75, 0, v75
    v_cvt_pk_bf16_f32 v76, 0, v76
    v_cvt_pk_bf16_f32 v77, 0, v77
    v_cvt_pk_bf16_f32 v78, 0, v78
    v_cvt_pk_bf16_f32 v79, 0, v79
    v_pk_add_f32 v[64:65], v[64:65], v[80:81]
    v_pk_add_f32 v[66:67], v[66:67], v[82:83]
    v_pk_add_f32 v[68:69], v[68:69], v[84:85]
    v_pk_add_f32 v[70:71], v[70:71], v[86:87]
    v_pk_add_f32 v[72:73], v[72:73], v[88:89]
    v_pk_add_f32 v[74:75], v[74:75], v[90:91]
    v_pk_add_f32 v[76:77], v[76:77], v[92:93]
    v_pk_add_f32 v[78:79], v[78:79], v[94:95]
    v_cvt_pk_bf16_f32 v96, v64, v65
    v_cvt_pk_bf16_f32 v97, v66, v67
    v_cvt_pk_bf16_f32 v98, v68, v69
    v_cvt_pk_bf16_f32 v99, v70, v71
    v_cvt_pk_bf16_f32 v100, v72, v73
    v_cvt_pk_bf16_f32 v101, v74, v75
    v_cvt_pk_bf16_f32 v102, v76, v77
    v_cvt_pk_bf16_f32 v103, v78, v79
    buffer_store_dwordx4 v[96:99], v9, s[12:15], s63 offen sc1
    buffer_store_dwordx4 v[100:103], v9, s[12:15], s63 offen offset:1024 sc1
    v_lshlrev_b32 v64, 16, v96
    v_and_b32 v65, 0xffff0000, v96
    v_lshlrev_b32 v66, 16, v97
    v_and_b32 v67, 0xffff0000, v97
    v_lshlrev_b32 v68, 16, v98
    v_and_b32 v69, 0xffff0000, v98
    v_lshlrev_b32 v70, 16, v99
    v_and_b32 v71, 0xffff0000, v99
    v_lshlrev_b32 v72, 16, v100
    v_and_b32 v73, 0xffff0000, v100
    v_lshlrev_b32 v74, 16, v101
    v_and_b32 v75, 0xffff0000, v101
    v_lshlrev_b32 v76, 16, v102
    v_and_b32 v77, 0xffff0000, v102
    v_lshlrev_b32 v78, 16, v103
    v_and_b32 v79, 0xffff0000, v103
    v_pk_add_f32 v[80:81], v[64:65], v[72:73]
    v_pk_add_f32 v[82:83], v[66:67], v[74:75]
    v_pk_add_f32 v[84:85], v[68:69], v[76:77]
    v_pk_add_f32 v[86:87], v[70:71], v[78:79]
    v_pk_add_f32 v[80:81], v[80:81], v[84:85]
    v_pk_add_f32 v[82:83], v[82:83], v[86:87]
    v_pk_add_f32 v[80:81], v[80:81], v[82:83]
    v_add_f32 v14, v80, v81
    s_nop 1
    v_add_f32_dpp v14, v14, v14 row_shr:1 row_mask:0xf bank_mask:0xf bound_ctrl:0
    s_nop 1
    v_add_f32_dpp v14, v14, v14 row_shr:2 row_mask:0xf bank_mask:0xf bound_ctrl:0
    s_nop 1
    v_add_f32_dpp v14, v14, v14 row_shr:4 row_mask:0xf bank_mask:0xf bound_ctrl:0
    s_nop 1
    v_add_f32_dpp v14, v14, v14 row_shr:8 row_mask:0xf bank_mask:0xf bound_ctrl:0
    s_nop 1
    v_add_f32_dpp v14, v14, v14 row_bcast:15 row_mask:0xa bank_mask:0xf
    s_nop 1
    v_add_f32_dpp v14, v14, v14 row_bcast:31 row_mask:0xc bank_mask:0xf
    s_nop 1
    v_readlane_b32 s46, v14, 63
    s_nop 1
    v_mov_b32 v15, s46
    v_mul_f32 v15, 0x3a800000, v15
    v_pk_add_f32 v[80:81], v[64:65], v[14:15] op_sel:[0,1] op_sel_hi:[1,1] neg_lo:[0,1] neg_hi:[0,1]
    v_pk_add_f32 v[82:83], v[66:67], v[14:15] op_sel:[0,1] op_sel_hi:[1,1] neg_lo:[0,1] neg_hi:[0,1]
    v_pk_add_f32 v[84:85], v[68:69], v[14:15] op_sel:[0,1] op_sel_hi:[1,1] neg_lo:[0,1] neg_hi:[0,1]
    v_pk_add_f32 v[86:87], v[70:71], v[14:15] op_sel:[0,1] op_sel_hi:[1,1] neg_lo:[0,1] neg_hi:[0,1]
    v_pk_add_f32 v[88:89], v[72:73], v[14:15] op_sel:[0,1] op_sel_hi:[1,1] neg_lo:[0,1] neg_hi:[0,1]
    v_pk_add_f32 v[90:91], v[74:75], v[14:15] op_sel:[0,1] op_sel_hi:[1,1] neg_lo:[0,1] neg_hi:[0,1]
    v_pk_add_f32 v[92:93], v[76:77], v[14:15] op_sel:[0,1] op_sel_hi:[1,1] neg_lo:[0,1] neg_hi:[0,1]
    v_pk_add_f32 v[94:95], v[78:79], v[14:15] op_sel:[0,1] op_sel_hi:[1,1] neg_lo:[0,1] neg_hi:[0,1]
    v_pk_mul_f32 v[104:105], v[80:81], v[80:81]
    v_pk_mul_f32 v[106:107], v[82:83], v[82:83]
    v_pk_fma_f32 v[104:105], v[84:85], v[84:85], v[104:105]
    v_pk_fma_f32 v[106:107], v[86:87], v[86:87], v[106:107]
    v_pk_fma_f32 v[104:105], v[88:89], v[88:89], v[104:105]
    v_pk_fma_f32 v[106:107], v[90:91], v[90:91], v[106:107]
    v_pk_fma_f32 v[104:105], v[92:93], v[92:93], v[104:105]
    v_pk_fma_f32 v[106:107], v[94:95], v[94:95], v[106:107]
    v_pk_add_f32 v[104:105], v[104:105], v[106:107]
    v_add_f32 v14, v104, v105
    v_cvt_pk_bf16_f32 v15, 0, v15
    s_nop 1
    v_add_f32_dpp v14, v14, v14 row_shr:1 row_mask:0xf bank_mask:0xf bound_ctrl:0
    s_nop 1
    v_add_f32_dpp v14, v14, v14 row_shr:2 row_mask:0xf bank_mask:0xf bound_ctrl:0
    s_nop 1
    v_add_f32_dpp v14, v14, v14 row_shr:4 row_mask:0xf bank_mask:0xf bound_ctrl:0
    s_nop 1
    v_add_f32_dpp v14, v14, v14 row_shr:8 row_mask:0xf bank_mask:0xf bound_ctrl:0
    s_nop 1
    v_add_f32_dpp v14, v14, v14 row_bcast:15 row_mask:0xa bank_mask:0xf
    s_nop 1
    v_add_f32_dpp v14, v14, v14 row_bcast:31 row_mask:0xc bank_mask:0xf
    s_nop 1
    v_readlane_b32 s47, v14, 63
    v_pk_add_f32 v[64:65], v[64:65], v[14:15] op_sel:[0,1] op_sel_hi:[1,1] neg_lo:[0,1] neg_hi:[0,1]
    v_pk_add_f32 v[66:67], v[66:67], v[14:15] op_sel:[0,1] op_sel_hi:[1,1] neg_lo:[0,1] neg_hi:[0,1]
    v_pk_add_f32 v[68:69], v[68:69], v[14:15] op_sel:[0,1] op_sel_hi:[1,1] neg_lo:[0,1] neg_hi:[0,1]
    v_pk_add_f32 v[70:71], v[70:71], v[14:15] op_sel:[0,1] op_sel_hi:[1,1] neg_lo:[0,1] neg_hi:[0,1]
    v_pk_add_f32 v[72:73], v[72:73], v[14:15] op_sel:[0,1] op_sel_hi:[1,1] neg_lo:[0,1] neg_hi:[0,1]
    v_pk_add_f32 v[74:75], v[74:75], v[14:15] op_sel:[0,1] op_sel_hi:[1,1] neg_lo:[0,1] neg_hi:[0,1]
    v_pk_add_f32 v[76:77], v[76:77], v[14:15] op_sel:[0,1] op_sel_hi:[1,1] neg_lo:[0,1] neg_hi:[0,1]
    v_pk_add_f32 v[78:79], v[78:79], v[14:15] op_sel:[0,1] op_sel_hi:[1,1] neg_lo:[0,1] neg_hi:[0,1]
    v_mov_b32 v14, s47
    v_mul_f32 v14, 0x3a800000, v14
    v_cvt_pk_bf16_f32 v14, 0, v14
    v_add_f32 v14, 0x3727c5ac, v14
    v_cvt_pk_bf16_f32 v14, 0, v14
    v_sqrt_f32 v14, v14
    s_nop 0
    v_cvt_pk_bf16_f32 v14, 0, v14
    v_rcp_f32 v14, v14
    v_cvt_pk_bf16_f32 v64, 0, v64
    v_cvt_pk_bf16_f32 v65, 0, v65
    v_cvt_pk_bf16_f32 v66, 0, v66
    v_cvt_pk_bf16_f32 v67, 0, v67
    v_cvt_pk_bf16_f32 v68, 0, v68
    v_cvt_pk_bf16_f32 v69, 0, v69
    v_cvt_pk_bf16_f32 v70, 0, v70
    v_cvt_pk_bf16_f32 v71, 0, v71
    v_cvt_pk_bf16_f32 v72, 0, v72
    v_cvt_pk_bf16_f32 v73, 0, v73
    v_cvt_pk_bf16_f32 v74, 0, v74
    v_cvt_pk_bf16_f32 v75, 0, v75
    v_cvt_pk_bf16_f32 v76, 0, v76
    v_cvt_pk_bf16_f32 v77, 0, v77
    v_cvt_pk_bf16_f32 v78, 0, v78
    v_cvt_pk_bf16_f32 v79, 0, v79
    v_pk_mul_f32 v[64:65], v[64:65], v[14:15] op_sel_hi:[1,0]
    v_pk_mul_f32 v[66:67], v[66:67], v[14:15] op_sel_hi:[1,0]
    v_pk_mul_f32 v[68:69], v[68:69], v[14:15] op_sel_hi:[1,0]
    v_pk_mul_f32 v[70:71], v[70:71], v[14:15] op_sel_hi:[1,0]
    v_pk_mul_f32 v[72:73], v[72:73], v[14:15] op_sel_hi:[1,0]
    v_pk_mul_f32 v[74:75], v[74:75], v[14:15] op_sel_hi:[1,0]
    v_pk_mul_f32 v[76:77], v[76:77], v[14:15] op_sel_hi:[1,0]
    v_pk_mul_f32 v[78:79], v[78:79], v[14:15] op_sel_hi:[1,0]
    v_cvt_pk_bf16_f32 v64, 0, v64
    v_cvt_pk_bf16_f32 v65, 0, v65
    v_cvt_pk_bf16_f32 v66, 0, v66
    v_cvt_pk_bf16_f32 v67, 0, v67
    v_cvt_pk_bf16_f32 v68, 0, v68
    v_cvt_pk_bf16_f32 v69, 0, v69
    v_cvt_pk_bf16_f32 v70, 0, v70
    v_cvt_pk_bf16_f32 v71, 0, v71
    v_cvt_pk_bf16_f32 v72, 0, v72
    v_cvt_pk_bf16_f32 v73, 0, v73
    v_cvt_pk_bf16_f32 v74, 0, v74
    v_cvt_pk_bf16_f32 v75, 0, v75
    v_cvt_pk_bf16_f32 v76, 0, v76
    v_cvt_pk_bf16_f32 v77, 0, v77
    v_cvt_pk_bf16_f32 v78, 0, v78
    v_cvt_pk_bf16_f32 v79, 0, v79
    v_pk_mul_f32 v[64:65], v[64:65], v[32:33]
    v_pk_mul_f32 v[66:67], v[66:67], v[34:35]
    v_pk_mul_f32 v[68:69], v[68:69], v[36:37]
    v_pk_mul_f32 v[70:71], v[70:71], v[38:39]
    v_pk_mul_f32 v[72:73], v[72:73], v[40:41]
    v_pk_mul_f32 v[74:75], v[74:75], v[42:43]
    v_pk_mul_f32 v[76:77], v[76:77], v[44:45]
    v_pk_mul_f32 v[78:79], v[78:79], v[46:47]
    v_cvt_pk_bf16_f32 v64, 0, v64
    v_cvt_pk_bf16_f32 v65, 0, v65
    v_cvt_pk_bf16_f32 v66, 0, v66
    v_cvt_pk_bf16_f32 v67, 0, v67
    v_cvt_pk_bf16_f32 v68, 0, v68
    v_cvt_pk_bf16_f32 v69, 0, v69
    v_cvt_pk_bf16_f32 v70, 0, v70
    v_cvt_pk_bf16_f32 v71, 0, v71
    v_cvt_pk_bf16_f32 v72, 0, v72
    v_cvt_pk_bf16_f32 v73, 0, v73
    v_cvt_pk_bf16_f32 v74, 0, v74
    v_cvt_pk_bf16_f32 v75, 0, v75
    v_cvt_pk_bf16_f32 v76, 0, v76
    v_cvt_pk_bf16_f32 v77, 0, v77
    v_cvt_pk_bf16_f32 v78, 0, v78
    v_cvt_pk_bf16_f32 v79, 0, v79
    v_pk_add_f32 v[64:65], v[64:65], v[48:49]
    v_pk_add_f32 v[66:67], v[66:67], v[50:51]
    v_pk_add_f32 v[68:69], v[68:69], v[52:53]
    v_pk_add_f32 v[70:71], v[70:71], v[54:55]
    v_pk_add_f32 v[72:73], v[72:73], v[56:57]
    v_pk_add_f32 v[74:75], v[74:75], v[58:59]
    v_pk_add_f32 v[76:77], v[76:77], v[60:61]
    v_pk_add_f32 v[78:79], v[78:79], v[62:63]
    v_cvt_pk_bf16_f32 v104, v64, v65
    v_cvt_pk_bf16_f32 v105, v66, v67
    v_cvt_pk_bf16_f32 v106, v68, v69
    v_cvt_pk_bf16_f32 v107, v70, v71
    v_cvt_pk_bf16_f32 v108, v72, v73
    v_cvt_pk_bf16_f32 v109, v74, v75
    v_cvt_pk_bf16_f32 v110, v76, v77
    v_cvt_pk_bf16_f32 v111, v78, v79
    ds_write_b128 v10, v[104:107]
    ds_write_b128 v10, v[108:111] offset:1024
    s_waitcnt lgkmcnt(0)
    s_barrier
    ds_read_b128 v[104:107], v13
    ds_read_b128 v[108:111], v13 offset:128
    s_waitcnt lgkmcnt(1)
    buffer_store_dwordx4 v[104:107], v11, s[12:15], s63 offen sc1
    s_waitcnt lgkmcnt(0)
    buffer_store_dwordx4 v[108:111], v12, s[12:15], s63 offen sc1
    s_waitcnt vmcnt(0)
    s_barrier
    s_cmp_lg_u32 s44, 0
    s_cbranch_scc1 L_sf_41
    v_mov_b32 v14, s60
    v_add_u32 v14, 1, v14
    v_mov_b32 v15, 0
    s_mov_b64 exec, 1
    buffer_store_dword v14, v15, s[12:15], s52 offen sc1
    s_mov_b64 exec, -1
L_sf_41:
    s_add_u32 s60, s60, 3
    s_cmp_lt_u32 s60, 64
    s_cbranch_scc1 L_r_loop_37
    s_branch L_c_done_1
L_w_att_15:
    s_lshl_b32 s42, s40, 2
    s_and_b32 s46, s44, 3
    s_add_u32 s42, s42, s46
    s_and_b32 s43, s48, 1
    s_lshl_b32 s43, s43, 1
    s_lshr_b32 s46, s44, 2
    s_add_u32 s43, s43, s46
    s_mul_i32 s46, s42, 24576
    s_add_u32 s46, s46, 0x2000000
    v_lshlrev_b32 v2, 4, v1
    v_add_u32 v3, s46, v2
    v_add_u32 v5, 4096, v3
    v_lshrrev_b32 v4, 4, v1
    v_and_b32 v9, 15, v1
    s_lshl_b32 s46, s42, 12
    s_add_u32 s46, s46, 0x1000000
    v_and_b32 v6, 7, v1
    v_lshlrev_b32 v6, 4, v6
    v_lshl_add_u32 v6, v4, 7, v6
    v_add_u32 v6, s46, v6
    v_and_b32 v7, 31, v1
    v_lshlrev_b32 v7, 4, v7
    v_lshrrev_b32 v10, 5, v1
    v_lshl_add_u32 v7, v10, 10, v7
    v_add_u32 v7, s46, v7
    s_mul_i32 s50, s44, 13056
    v_mul_u32_u24 v8, 272, v9
    v_lshl_add_u32 v8, v4, 4, v8
    v_add_u32 v8, s50, v8
    v_bfe_u32 v11, v1, 2, 3
    v_mul_u32_u24 v11, 272, v11
    v_lshl_add_u32 v11, v10, 6, v11
    v_and_b32 v12, 3, v1
    v_lshl_add_u32 v11, v12, 4, v11
    v_add_u32 v11, s50, v11
    v_mul_u32_u24 v14, 272, v4
    v_lshl_add_u32 v14, v9, 4, v14
    v_add_u32 v14, s50, v14
    v_mov_b32 v16, 0
    v_mov_b32 v17, 0
    v_mov_b32 v18, 0
    v_mov_b32 v19, 0
    ds_write_b128 v14, v[16:19] offset:10880
    ds_write_b128 v14, v[16:19] offset:11968
    v_lshlrev_b32 v12, 2, v4
    v_bfe_u32 v13, v1, 2, 2
    v_add_u32 v12, v12, v13
    v_mul_u32_u24 v12, 272, v12
    v_and_b32 v13, 3, v1
    v_lshl_add_u32 v12, v13, 3, v12
    v_add_u32 v12, s50, v12
    v_lshlrev_b32 v13, 10, v13
    s_lshl_b32 s46, s42, 12
    s_add_u32 s46, s46, 0x1000000
    v_add_u32 v13, s46, v13
    v_lshlrev_b32 v10, 9, v4
    v_lshl_add_u32 v10, v9, 4, v10
    s_lshl_b32 s46, s42, 13
    s_add_u32 s46, s46, 0x5000000
    v_add_u32 v10, s46, v10
    s_lshl_b32 s52, s42, 9
    s_lshl_b32 s47, s43, 7
    s_add_u32 s52, s52, s47
    s_add_u32 s52, s52, 0x102000
    v_min_u32 v42, 2, v1
    v_lshlrev_b32 v42, 9, v42
    s_lshl_b32 s46, s40, 11
    s_and_b32 s47, s42, 3
    s_lshl_b32 s47, s47, 7
    s_add_u32 s46, s46, s47
    s_add_u32 s46, s46, 0x10a400
    v_add_u32 v48, s46, v42
    s_mul_i32 s46, s42, 24576
    s_add_u32 s46, s46, 0x2000000
    v_lshlrev_b32 v49, 7, v1
    v_add_u32 v49, s46, v49
    v_cmp_le_u32 s[56:57], 32, v1
    v_lshlrev_b32 v14, 2, v4
    s_mov_b32 s54, 0x3e0293ee
    s_mov_b32 s60, s43
    v_add_u32 v15, 0, v14
    v_cmp_gt_u32 s[84:85], v15, v9
    v_add_u32 v15, 1, v14
    v_cmp_gt_u32 s[86:87], v15, v9
    v_add_u32 v15, 2, v14
    v_cmp_gt_u32 s[88:89], v15, v9
    v_add_u32 v15, 3, v14
    v_cmp_gt_u32 s[90:91], v15, v9
L_a_loop_42:
    s_mul_i32 s45, s60, 786432
    s_add_u32 s48, s45, 8192
    s_add_u32 s49, s45, 16384
    s_lshl_b32 s61, s60, 17
    s_lshl_b32 s63, s60, 18
    s_mov_b32 s70, 0
L_spin_43:
    buffer_load_dword v40, v48, s[12:15], 0 offen sc1
    s_waitcnt vmcnt(0)
    v_cmp_ge_u32 vcc, s60, v40
    s_add_u32 s70, s70, 1
    s_cbranch_vccz L_spok_44
    s_sleep 3
    s_cmp_lt_u32 s70, 524288
    s_cbranch_scc1 L_spin_43
    s_branch L_c_done_1
L_spok_44:
    buffer_load_dwordx4 a[0:3], v3, s[12:15], s45 offen offset:0 sc1
    buffer_load_dwordx4 a[4:7], v3, s[12:15], s45 offen offset:1024 sc1
    buffer_load_dwordx4 a[8:11], v3, s[12:15], s45 offen offset:2048 sc1
    buffer_load_dwordx4 a[12:15], v3, s[12:15], s45 offen offset:3072 sc1
    buffer_load_dwordx4 a[16:19], v5, s[12:15], s45 offen offset:0 sc1
    buffer_load_dwordx4 a[20:23], v5, s[12:15], s45 offen offset:1024 sc1
    buffer_load_dwordx4 a[24:27], v5, s[12:15], s45 offen offset:2048 sc1
    buffer_load_dwordx4 a[28:31], v5, s[12:15], s45 offen offset:3072 sc1
    buffer_load_dwordx4 a[32:35], v3, s[12:15], s48 offen offset:0 sc1
    buffer_load_dwordx4 a[36:39], v3, s[12:15], s48 offen offset:1024 sc1
    buffer_load_dwordx4 a[40:43], v3, s[12:15], s48 offen offset:2048 sc1
    buffer_load_dwordx4 a[44:47], v3, s[12:15], s48 offen offset:3072 sc1
    buffer_load_dwordx4 a[48:51], v5, s[12:15], s48 offen offset:0 sc1
    buffer_load_dwordx4 a[52:55], v5, s[12:15], s48 offen offset:1024 sc1
    buffer_load_dwordx4 a[56:59], v5, s[12:15], s48 offen offset:2048 sc1
    buffer_load_dwordx4 a[60:63], v5, s[12:15], s48 offen offset:3072 sc1
    buffer_load_dwordx4 v[16:19], v3, s[12:15], s49 offen offset:0 sc1
    buffer_load_dwordx4 v[20:23], v3, s[12:15], s49 offen offset:1024 sc1
    buffer_load_dwordx4 v[24:27], v3, s[12:15], s49 offen offset:2048 sc1
    buffer_load_dwordx4 v[28:31], v3, s[12:15], s49 offen offset:3072 sc1
    buffer_load_dwordx4 v[32:35], v5, s[12:15], s49 offen offset:0 sc1
    buffer_load_dwordx4 v[36:39], v5, s[12:15], s49 offen offset:1024 sc1
    buffer_load_dwordx4 v[40:43], v5, s[12:15], s49 offen offset:2048 sc1
    buffer_load_dwordx4 v[44:47], v5, s[12:15], s49 offen offset:3072 sc1
    s_waitcnt vmcnt(0)
    ds_write_b128 v8, v[16:19] offset:0
    ds_write_b128 v8, v[20:23] offset:64
    ds_write_b128 v8, v[24:27] offset:128
    ds_write_b128 v8, v[28:31] offset:192
    ds_write_b128 v8, v[32:35] offset:4352
    ds_write_b128 v8, v[36:39] offset:4416
    ds_write_b128 v8, v[40:43] offset:4480
    ds_write_b128 v8, v[44:47] offset:4544
    v_mfma_f32_16x16x32_bf16 v[56:59], a[32:35], a[0:3], 0
    v_mfma_f32_16x16x32_bf16 v[60:63], a[32:35], a[16:19], 0
    v_mfma_f32_16x16x32_bf16 v[68:71], a[48:51], a[16:19], 0
    v_mfma_f32_16x16x32_bf16 v[56:59], a[36:39], a[4:7], v[56:59]
    v_mfma_f32_16x16x32_bf16 v[60:63], a[36:39], a[20:23], v[60:63]
    v_mfma_f32_16x16x32_bf16 v[68:71], a[52:55], a[20:23], v[68:71]
    v_mfma_f32_16x16x32_bf16 v[56:59], a[40:43], a[8:11], v[56:59]
    v_mfma_f32_16x16x32_bf16 v[60:63], a[40:43], a[24:27], v[60:63]
    v_mfma_f32_16x16x32_bf16 v[68:71], a[56:59], a[24:27], v[68:71]
    v_mfma_f32_16x16x32_bf16 v[56:59], a[44:47], a[12:15], v[56:59]
    v_mfma_f32_16x16x32_bf16 v[60:63], a[44:47], a[28:31], v[60:63]
    v_mfma_f32_16x16x32_bf16 v[68:71], a[60:63], a[28:31], v[68:71]
    s_waitcnt lgkmcnt(0)
    ds_read_b64_tr_b16 a[80:81], v12 offset:0
    ds_read_b64_tr_b16 a[82:83], v12 offset:4352
    ds_read_b64_tr_b16 a[86:87], v12 offset:32
    ds_read_b64_tr_b16 a[88:89], v12 offset:4384
    ds_read_b64_tr_b16 a[92:93], v12 offset:64
    ds_read_b64_tr_b16 a[94:95], v12 offset:4416
    ds_read_b64_tr_b16 a[98:99], v12 offset:96
    ds_read_b64_tr_b16 a[100:101], v12 offset:4448
    s_waitcnt lgkmcnt(0)
    ds_read_b64_tr_b16 a[104:105], v12 offset:128
    ds_read_b64_tr_b16 a[106:107], v12 offset:4480
    ds_read_b64_tr_b16 a[110:111], v12 offset:160
    ds_read_b64_tr_b16 a[112:113], v12 offset:4512
    ds_read_b64_tr_b16 a[116:117], v12 offset:192
    ds_read_b64_tr_b16 a[118:119], v12 offset:4544
    ds_read_b64_tr_b16 a[122:123], v12 offset:224
    ds_read_b64_tr_b16 a[124:125], v12 offset:4576
    v_mov_b32 v15, 0xff800000
    v_cndmask_b32 v56, v56, v15, s[84:85]
    v_cndmask_b32 v68, v68, v15, s[84:85]
    v_cndmask_b32 v57, v57, v15, s[86:87]
    v_cndmask_b32 v69, v69, v15, s[86:87]
    v_cndmask_b32 v58, v58, v15, s[88:89]
    v_cndmask_b32 v70, v70, v15, s[88:89]
    v_cndmask_b32 v59, v59, v15, s[90:91]
    v_cndmask_b32 v71, v71, v15, s[90:91]
    s_mov_b32 s70, 0
L_a_cp_45:
    buffer_load_dword v40, v13, s[12:15], s61 offen sc1
    s_waitcnt vmcnt(0)
    v_cmp_eq_u32 vcc, -1, v40
    s_add_u32 s70, s70, 1
    s_cbranch_vccz L_a_fl_46
L_a_cp_45_s:
    s_sleep 4
    s_cmp_lt_u32 s70, 524288
    s_cbranch_scc1 L_a_cp_45
    s_branch L_c_done_1
L_a_fl_46:
    buffer_load_dwordx4 v[24:27], v6, s[12:15], s61 offen offset:0 sc1
    buffer_load_dwordx4 v[28:31], v6, s[12:15], s61 offen offset:1024 sc1
    buffer_load_dwordx4 v[32:35], v6, s[12:15], s61 offen offset:2048 sc1
    buffer_load_dwordx4 v[36:39], v6, s[12:15], s61 offen offset:3072 sc1
    buffer_load_dwordx4 v[16:19], v7, s[12:15], s61 offen offset:512 sc1
    buffer_load_dwordx4 v[20:23], v7, s[12:15], s61 offen offset:2560 sc1
    s_waitcnt vmcnt(0)
    v_max_u32 v40, v16, v17
    v_max3_u32 v40, v40, v18, v19
    v_max3_u32 v40, v40, v20, v21
    v_max3_u32 v40, v40, v22, v23
    v_max3_u32 v40, v40, v24, v25
    v_max3_u32 v40, v40, v26, v27
    v_max3_u32 v40, v40, v28, v29
    v_max3_u32 v40, v40, v30, v31
    v_max3_u32 v40, v40, v32, v33
    v_max3_u32 v40, v40, v34, v35
    v_max3_u32 v40, v40, v36, v37
    v_max3_u32 v40, v40, v38, v39
    v_cmp_eq_u32 vcc, -1, v40
    s_nop 0
    s_cbranch_vccnz L_a_cp_45_s
    v_mfma_f32_16x16x32_bf16 v[72:75], v[24:27], a[0:3], 0
    v_mfma_f32_16x16x32_bf16 v[76:79], v[24:27], a[16:19], 0
    v_mfma_f32_16x16x32_bf16 v[72:75], v[28:31], a[4:7], v[72:75]
    v_mfma_f32_16x16x32_bf16 v[76:79], v[28:31], a[20:23], v[76:79]
    v_mfma_f32_16x16x32_bf16 v[72:75], v[32:35], a[8:11], v[72:75]
    v_mfma_f32_16x16x32_bf16 v[76:79], v[32:35], a[24:27], v[76:79]
    v_mfma_f32_16x16x32_bf16 v[72:75], v[36:39], a[12:15], v[72:75]
    v_mfma_f32_16x16x32_bf16 v[76:79], v[36:39], a[28:31], v[76:79]
    ds_write_b128 v11, v[16:19] offset:8704
    ds_write_b128 v11, v[20:23] offset:8832
    s_waitcnt lgkmcnt(0)
    ds_read_b64_tr_b16 a[84:85], v12 offset:8704
    ds_read_b64_tr_b16 a[90:91], v12 offset:8736
    ds_read_b64_tr_b16 a[96:97], v12 offset:8768
    ds_read_b64_tr_b16 a[102:103], v12 offset:8800
    ds_read_b64_tr_b16 a[108:109], v12 offset:8832
    ds_read_b64_tr_b16 a[114:115], v12 offset:8864
    ds_read_b64_tr_b16 a[120:121], v12 offset:8896
    ds_read_b64_tr_b16 a[126:127], v12 offset:8928
    v_cndmask_b32 v72, v72, v15, s[56:57]
    v_cndmask_b32 v73, v73, v15, s[56:57]
    v_cndmask_b32 v74, v74, v15, s[56:57]
    v_cndmask_b32 v75, v75, v15, s[56:57]
    v_cndmask_b32 v76, v76, v15, s[56:57]
    v_cndmask_b32 v77, v77, v15, s[56:57]
    v_cndmask_b32 v78, v78, v15, s[56:57]
    v_cndmask_b32 v79, v79, v15, s[56:57]
    v_max_f32 v40, v56, v57
    v_max3_f32 v40, v40, v58, v59
    v_max3_f32 v40, v40, v72, v73
    v_max3_f32 v40, v40, v74, v75
    v_mov_b32 v41, v40
    s_nop 1
    v_permlane16_swap_b32 v40, v41
    v_max_f32 v40, v40, v41
    v_mov_b32 v41, v40
    s_nop 1
    v_permlane32_swap_b32 v40, v41
    v_max_f32 v40, v40, v41
    v_mul_f32 v40, s54, v40
    v_fma_f32 v56, v56, s54, -v40
    v_fma_f32 v57, v57, s54, -v40
    v_fma_f32 v58, v58, s54, -v40
    v_fma_f32 v59, v59, s54, -v40
    v_fma_f32 v72, v72, s54, -v40
    v_fma_f32 v73, v73, s54, -v40
    v_fma_f32 v74, v74, s54, -v40
    v_fma_f32 v75, v75, s54, -v40
    v_exp_f32 v56, v56
    v_exp_f32 v57, v57
    v_exp_f32 v58, v58
    v_exp_f32 v59, v59
    v_exp_f32 v72, v72
    v_exp_f32 v73, v73
    v_exp_f32 v74, v74
    v_exp_f32 v75, v75
    v_add_f32 v40, v56, v57
    v_add_f32 v40, v40, v58
    v_add_f32 v40, v40, v59
    v_add_f32 v40, v40, v72
    v_add_f32 v40, v40, v73
    v_add_f32 v40, v40, v74
    v_add_f32 v40, v40, v75
    v_mov_b32 v41, v40
    s_nop 1
    v_permlane16_swap_b32 v40, v41
    v_add_f32 v40, v40, v41
    v_mov_b32 v41, v40
    s_nop 1
    v_permlane32_swap_b32 v40, v41
    v_add_f32 v40, v40, v41
    v_rcp_f32 v40, v40
    s_nop 0
    v_mul_f32 v56, v56, v40
    v_mul_f32 v57, v57, v40
    v_mul_f32 v58, v58, v40
    v_mul_f32 v59, v59, v40
    v_mul_f32 v72, v72, v40
    v_mul_f32 v73, v73, v40
    v_mul_f32 v74, v74, v40
    v_mul_f32 v75, v75, v40
    v_cvt_pk_bf16_f32 v24, v56, v57
    v_cvt_pk_bf16_f32 v25, v58, v59
    v_cvt_pk_bf16_f32 v28, v72, v73
    v_cvt_pk_bf16_f32 v29, v74, v75
    v_max_f32 v40, v60, v61
    v_max3_f32 v40, v40, v62, v63
    v_max3_f32 v40, v40, v68, v69
    v_max3_f32 v40, v40, v70, v71
    v_max3_f32 v40, v40, v76, v77
    v_max3_f32 v40, v40, v78, v79
    v_mov_b32 v41, v40
    s_nop 1
    v_permlane16_swap_b32 v40, v41
    v_max_f32 v40, v40, v41
    v_mov_b32 v41, v40
    s_nop 1
    v_permlane32_swap_b32 v40, v41
    v_max_f32 v40, v40, v41
    v_mul_f32 v40, s54, v40
    v_fma_f32 v60, v60, s54, -v40
    v_fma_f32 v61, v61, s54, -v40
    v_fma_f32 v62, v62, s54, -v40
    v_fma_f32 v63, v63, s54, -v40
    v_fma_f32 v68, v68, s54, -v40
    v_fma_f32 v69, v69, s54, -v40
    v_fma_f32 v70, v70, s54, -v40
    v_fma_f32 v71, v71, s54, -v40
    v_fma_f32 v76, v76, s54, -v40
    v_fma_f32 v77, v77, s54, -v40
    v_fma_f32 v78, v78, s54, -v40
    v_fma_f32 v79, v79, s54, -v40
    v_exp_f32 v60, v60
    v_exp_f32 v61, v61
    v_exp_f32 v62, v62
    v_exp_f32 v63, v63
    v_exp_f32 v68, v68
    v_exp_f32 v69, v69
    v_exp_f32 v70, v70
    v_exp_f32 v71, v71
    v_exp_f32 v76, v76
    v_exp_f32 v77, v77
    v_exp_f32 v78, v78
    v_exp_f32 v79, v79
    v_add_f32 v40, v60, v61
    v_add_f32 v40, v40, v62
    v_add_f32 v40, v40, v63
    v_add_f32 v40, v40, v68
    v_add_f32 v40, v40, v69
    v_add_f32 v40, v40, v70
    v_add_f32 v40, v40, v71
    v_add_f32 v40, v40, v76
    v_add_f32 v40, v40, v77
    v_add_f32 v40, v40, v78
    v_add_f32 v40, v40, v79
    v_mov_b32 v41, v40
    s_nop 1
    v_permlane16_swap_b32 v40, v41
    v_add_f32 v40, v40, v41
    v_mov_b32 v41, v40
    s_nop 1
    v_permlane32_swap_b32 v40, v41
    v_add_f32 v40, v40, v41
    v_rcp_f32 v40, v40
    s_nop 0
    v_mul_f32 v60, v60, v40
    v_mul_f32 v61, v61, v40
    v_mul_f32 v62, v62, v40
    v_mul_f32 v63, v63, v40
    v_mul_f32 v68, v68, v40
    v_mul_f32 v69, v69, v40
    v_mul_f32 v70, v70, v40
    v_mul_f32 v71, v71, v40
    v_mul_f32 v76, v76, v40
    v_mul_f32 v77, v77, v40
    v_mul_f32 v78, v78, v40
    v_mul_f32 v79, v79, v40
    v_cvt_pk_bf16_f32 v30, v60, v61
    v_cvt_pk_bf16_f32 v31, v62, v63
    v_cvt_pk_bf16_f32 v32, v68, v69
    v_cvt_pk_bf16_f32 v33, v70, v71
    v_cvt_pk_bf16_f32 v34, v76, v77
    v_cvt_pk_bf16_f32 v35, v78, v79
    s_waitcnt lgkmcnt(0)
    s_nop 0
    v_mfma_f32_16x16x16_bf16 v[64:67], a[80:81], v[24:25], 0
    v_mfma_f32_16x16x16_bf16 v[68:71], a[86:87], v[24:25], 0
    v_mfma_f32_16x16x16_bf16 v[72:75], a[92:93], v[24:25], 0
    v_mfma_f32_16x16x16_bf16 v[76:79], a[98:99], v[24:25], 0
    v_mfma_f32_16x16x16_bf16 v[80:83], a[104:105], v[24:25], 0
    v_mfma_f32_16x16x16_bf16 v[84:87], a[110:111], v[24:25], 0
    v_mfma_f32_16x16x16_bf16 v[88:91], a[116:117], v[24:25], 0
    v_mfma_f32_16x16x16_bf16 v[92:95], a[122:123], v[24:25], 0
    v_mfma_f32_16x16x16_bf16 v[64:67], a[84:85], v[28:29], v[64:67]
    v_mfma_f32_16x16x16_bf16 v[68:71], a[90:91], v[28:29], v[68:71]
    v_mfma_f32_16x16x16_bf16 v[72:75], a[96:97], v[28:29], v[72:75]
    v_mfma_f32_16x16x16_bf16 v[76:79], a[102:103], v[28:29], v[76:79]
    v_mfma_f32_16x16x16_bf16 v[80:83], a[108:109], v[28:29], v[80:83]
    v_mfma_f32_16x16x16_bf16 v[84:87], a[114:115], v[28:29], v[84:87]
    v_mfma_f32_16x16x16_bf16 v[88:91], a[120:121], v[28:29], v[88:91]
    v_mfma_f32_16x16x16_bf16 v[92:95], a[126:127], v[28:29], v[92:95]
    v_mfma_f32_16x16x16_bf16 v[96:99], a[80:81], v[30:31], 0
    v_mfma_f32_16x16x16_bf16 v[100:103], a[86:87], v[30:31], 0
    v_mfma_f32_16x16x16_bf16 v[104:107], a[92:93], v[30:31], 0
    v_mfma_f32_16x16x16_bf16 v[108:111], a[98:99], v[30:31], 0
    v_mfma_f32_16x16x16_bf16 v[112:115], a[104:105], v[30:31], 0
    v_mfma_f32_16x16x16_bf16 v[116:119], a[110:111], v[30:31], 0
    v_mfma_f32_16x16x16_bf16 v[120:123], a[116:117], v[30:31], 0
    v_mfma_f32_16x16x16_bf16 v[124:127], a[122:123], v[30:31], 0
    v_mfma_f32_16x16x16_bf16 v[96:99], a[82:83], v[32:33], v[96:99]
    v_mfma_f32_16x16x16_bf16 v[100:103], a[88:89], v[32:33], v[100:103]
    v_mfma_f32_16x16x16_bf16 v[104:107], a[94:95], v[32:33], v[104:107]
    v_mfma_f32_16x16x16_bf16 v[108:111], a[100:101], v[32:33], v[108:111]
    v_mfma_f32_16x16x16_bf16 v[112:115], a[106:107], v[32:33], v[112:115]
    v_mfma_f32_16x16x16_bf16 v[116:119], a[112:113], v[32:33], v[116:119]
    v_mfma_f32_16x16x16_bf16 v[120:123], a[118:119], v[32:33], v[120:123]
    v_mfma_f32_16x16x16_bf16 v[124:127], a[124:125], v[32:33], v[124:127]
    v_mfma_f32_16x16x16_bf16 v[96:99], a[84:85], v[34:35], v[96:99]
    v_mfma_f32_16x16x16_bf16 v[100:103], a[90:91], v[34:35], v[100:103]
    v_mfma_f32_16x16x16_bf16 v[104:107], a[96:97], v[34:35], v[104:107]
    v_mfma_f32_16x16x16_bf16 v[108:111], a[102:103], v[34:35], v[108:111]
    v_mfma_f32_16x16x16_bf16 v[112:115], a[108:109], v[34:35], v[112:115]
    v_mfma_f32_16x16x16_bf16 v[116:119], a[114:115], v[34:35], v[116:119]
    v_mfma_f32_16x16x16_bf16 v[120:123], a[120:121], v[34:35], v[120:123]
    v_mfma_f32_16x16x16_bf16 v[124:127], a[126:127], v[34:35], v[124:127]
    s_add_u32 s46, s63, 4096
    v_cvt_pk_bf16_f32 v64, v64, v65
    v_cvt_pk_bf16_f32 v65, v66, v67
    v_cvt_pk_bf16_f32 v66, v68, v69
    v_cvt_pk_bf16_f32 v67, v70, v71
    buffer_store_dwordx4 v[64:67], v10, s[12:15], s63 offen offset:0 sc1
    v_cvt_pk_bf16_f32 v72, v72, v73
    v_cvt_pk_bf16_f32 v73, v74, v75
    v_cvt_pk_bf16_f32 v74, v76, v77
    v_cvt_pk_bf16_f32 v75, v78, v79
    buffer_store_dwordx4 v[72:75], v10, s[12:15], s63 offen offset:2048 sc1
    v_cvt_pk_bf16_f32 v80, v80, v81
    v_cvt_pk_bf16_f32 v81, v82, v83
    v_cvt_pk_bf16_f32 v82, v84, v85
    v_cvt_pk_bf16_f32 v83, v86, v87
    buffer_store_dwordx4 v[80:83], v10, s[12:15], s46 offen offset:0 sc1
    v_cvt_pk_bf16_f32 v88, v88, v89
    v_cvt_pk_bf16_f32 v89, v90, v91
    v_cvt_pk_bf16_f32 v90, v92, v93
    v_cvt_pk_bf16_f32 v91, v94, v95
    buffer_store_dwordx4 v[88:91], v10, s[12:15], s46 offen offset:2048 sc1
    v_cvt_pk_bf16_f32 v96, v96, v97
    v_cvt_pk_bf16_f32 v97, v98, v99
    v_cvt_pk_bf16_f32 v98, v100, v101
    v_cvt_pk_bf16_f32 v99, v102, v103
    buffer_store_dwordx4 v[96:99], v10, s[12:15], s63 offen offset:256 sc1
    v_cvt_pk_bf16_f32 v104, v104, v105
    v_cvt_pk_bf16_f32 v105, v106, v107
    v_cvt_pk_bf16_f32 v106, v108, v109
    v_cvt_pk_bf16_f32 v107, v110, v111
    buffer_store_dwordx4 v[104:107], v10, s[12:15], s63 offen offset:2304 sc1
    v_cvt_pk_bf16_f32 v112, v112, v113
    v_cvt_pk_bf16_f32 v113, v114, v115
    v_cvt_pk_bf16_f32 v114, v116, v117
    v_cvt_pk_bf16_f32 v115, v118, v119
    buffer_store_dwordx4 v[112:115], v10, s[12:15], s46 offen offset:256 sc1
    v_cvt_pk_bf16_f32 v120, v120, v121
    v_cvt_pk_bf16_f32 v121, v122, v123
    v_cvt_pk_bf16_f32 v122, v124, v125
    v_cvt_pk_bf16_f32 v123, v126, v127
    buffer_store_dwordx4 v[120:123], v10, s[12:15], s46 offen offset:2304 sc1
    s_waitcnt vmcnt(0)
    v_mov_b32 v16, s60
    v_add_u32 v16, 1, v16
    v_mov_b32 v17, 0
    s_mov_b64 exec, 1
    buffer_store_dword v16, v17, s[12:15], s52 offen sc1
    s_mov_b64 exec, -1
L_sf_48:
    s_add_u32 s60, s60, 4
    s_cmp_lt_u32 s60, 64
    s_cbranch_scc1 L_a_loop_42
    s_branch L_c_done_1
L_w_g_10:
    s_lshr_b32 s53, s48, 2
    s_cmp_lt_u32 s53, 2
    s_cselect_b32 s46, 1, 0
    s_xor_b32 s53, s53, s46
    s_mov_b32 s74, 0
    s_mov_b32 s76, 0
    s_cmp_eq_u32 s53, 1
    s_cselect_b32 s75, 41, 58
    s_cmp_eq_u32 s53, 2
    s_cselect_b32 s75, 54, s75
L_w_g_10_e:
    s_lshl_b32 s46, s53, 3
    s_add_u32 s46, s46, 16
    s_load_dwordx2 s[4:5], s[0:1], s46
    s_lshl_b32 s49, s40, 2
    s_and_b32 s46, s48, 3
    s_add_u32 s49, s49, s46
    s_load_dwordx2 s[6:7], s[0:1], 72
    s_and_b32 s50, s44, 3
    s_lshr_b32 s51, s44, 2
    s_waitcnt lgkmcnt(0)
    s_mov_b32 s24, s4
    s_and_b32 s25, s5, 0xffff
    s_mov_b32 s26, 0x800000
    s_mov_b32 s27, 0x00020000
    s_cmp_lg_u32 s53, 0
    s_cbranch_scc1 L_g_nq_49
    s_load_dwordx4 s[8:11], s[0:1], 24
    v_and_b32 v10, 255, v0
    v_lshlrev_b32 v10, 13, v10
    s_and_b32 s46, s48, 3
    s_lshl_b32 s46, s46, 21
    s_lshl_b32 s47, s40, 10
    s_add_u32 s46, s46, s47
    s_add_u32 s46, s46, 384
    s_waitcnt lgkmcnt(0)
    s_cmp_eq_u32 s51, 1
    s_cselect_b32 s8, s10, s8
    s_cselect_b32 s9, s11, s9
    s_mov_b32 s28, s8
    s_and_b32 s29, s9, 0xffff
    s_mov_b32 s30, 0x800000
    s_mov_b32 s31, 0x00020000
    buffer_load_dword v11, v10, s[28:31], s46 offen
    s_cmp_eq_u32 s51, 1
    s_cbranch_scc1 L_g_nq_49
    buffer_load_dword v12, v10, s[24:27], s46 offen
L_g_nq_49:
    v_lshrrev_b32 v3, 4, v1
    v_and_b32 v4, 15, v1
    v_lshlrev_b32 v5, 2, v3
    v_xor_b32 v4, v4, v5
    v_mul_u32_u24 v3, 8192, v3
    v_lshl_add_u32 v3, v4, 4, v3
    s_mul_i32 s46, s51, 512
    s_mul_i32 s47, s50, 16
    s_add_u32 s46, s46, s47
    s_mul_i32 s46, s46, 8192
    s_lshl_b32 s47, s49, 8
    s_add_u32 s46, s46, s47
    s_lshl_b32 s45, s51, 16
    s_mul_i32 s47, s50, 4096
    s_add_u32 s45, s45, s47
    v_bfe_u32 v4, v1, 2, 2
    v_bfe_u32 v5, v1, 4, 1
    v_lshlrev_b32 v5, 1, v5
    v_bfe_u32 v6, v1, 0, 1
    v_add_u32 v5, v5, v6
    s_lshl_b32 s47, s50, 2
    v_add_u32 v5, s47, v5
    v_lshlrev_b32 v6, 2, v4
    v_xor_b32 v5, v5, v6
    v_lshlrev_b32 v5, 4, v5
    v_lshl_add_u32 v5, v4, 8, v5
    v_bfe_u32 v6, v1, 1, 1
    v_lshl_add_u32 v5, v6, 3, v5
    v_lshrrev_b32 v6, 5, v1
    v_mul_u32_u24 v6, 2048, v6
    v_add_u32 v5, v5, v6
    s_lshl_b32 s47, s51, 16
    v_add_u32 v5, s47, v5
    v_bfe_u32 v4, v1, 2, 2
    v_xor_b32 v5, s50, v4
    v_lshlrev_b32 v5, 6, v5
    v_lshl_add_u32 v5, v4, 8, v5
    v_and_b32 v6, 3, v1
    v_lshl_add_u32 v5, v6, 4, v5
    v_lshrrev_b32 v6, 4, v1
    v_lshl_add_u32 v5, v6, 11, v5
    v_lshrrev_b32 v6, 5, v1
    s_lshl_b32 s47, s51, 16
    v_add_u32 v5, s47, v5
    s_add_u32 m0, s45, 0
    s_add_u32 s47, s46, 0x0
    buffer_load_dwordx4 v3, s[24:27], s47 offen lds
    s_add_u32 m0, s45, 1024
    s_add_u32 s47, s46, 0x8000
    buffer_load_dwordx4 v3, s[24:27], s47 offen lds
    s_add_u32 m0, s45, 2048
    s_add_u32 s47, s46, 0x10000
    buffer_load_dwordx4 v3, s[24:27], s47 offen lds
    s_add_u32 m0, s45, 3072
    s_add_u32 s47, s46, 0x18000
    buffer_load_dwordx4 v3, s[24:27], s47 offen lds
    s_add_u32 m0, s45, 16384
    s_add_u32 s47, s46, 0x80000
    buffer_load_dwordx4 v3, s[24:27], s47 offen lds
    s_add_u32 m0, s45, 17408
    s_add_u32 s47, s46, 0x88000
    buffer_load_dwordx4 v3, s[24:27], s47 offen lds
    s_add_u32 m0, s45, 18432
    s_add_u32 s47, s46, 0x90000
    buffer_load_dwordx4 v3, s[24:27], s47 offen lds
    s_add_u32 m0, s45, 19456
    s_add_u32 s47, s46, 0x98000
    buffer_load_dwordx4 v3, s[24:27], s47 offen lds
    s_add_u32 m0, s45, 32768
    s_add_u32 s47, s46, 0x100000
    buffer_load_dwordx4 v3, s[24:27], s47 offen lds
    s_add_u32 m0, s45, 33792
    s_add_u32 s47, s46, 0x108000
    buffer_load_dwordx4 v3, s[24:27], s47 offen lds
    s_add_u32 m0, s45, 34816
    s_add_u32 s47, s46, 0x110000
    buffer_load_dwordx4 v3, s[24:27], s47 offen lds
    s_add_u32 m0, s45, 35840
    s_add_u32 s47, s46, 0x118000
    buffer_load_dwordx4 v3, s[24:27], s47 offen lds
    s_add_u32 m0, s45, 49152
    s_add_u32 s47, s46, 0x180000
    buffer_load_dwordx4 v3, s[24:27], s47 offen lds
    s_add_u32 m0, s45, 50176
    s_add_u32 s47, s46, 0x188000
    buffer_load_dwordx4 v3, s[24:27], s47 offen lds
    s_add_u32 m0, s45, 51200
    s_add_u32 s47, s46, 0x190000
    buffer_load_dwordx4 v3, s[24:27], s47 offen lds
    s_add_u32 m0, s45, 52224
    s_add_u32 s47, s46, 0x198000
    buffer_load_dwordx4 v3, s[24:27], s47 offen lds
    s_waitcnt vmcnt(12) lgkmcnt(0)
    s_barrier
    ds_read_b64_tr_b16 a[0:1], v5 offset:0
    ds_read_b64_tr_b16 a[2:3], v5 offset:1024
    ds_read_b64_tr_b16 a[4:5], v5 offset:8
    ds_read_b64_tr_b16 a[6:7], v5 offset:1032
    ds_read_b64_tr_b16 a[8:9], v5 offset:8192
    ds_read_b64_tr_b16 a[10:11], v5 offset:9216
    ds_read_b64_tr_b16 a[12:13], v5 offset:8200
    ds_read_b64_tr_b16 a[14:15], v5 offset:9224
    s_waitcnt vmcnt(8) lgkmcnt(0)
    s_barrier
    s_add_u32 m0, s45, 0
    s_add_u32 s47, s46, 0x200000
    buffer_load_dwordx4 v3, s[24:27], s47 offen lds
    s_add_u32 m0, s45, 1024
    s_add_u32 s47, s46, 0x208000
    buffer_load_dwordx4 v3, s[24:27], s47 offen lds
    s_add_u32 m0, s45, 2048
    s_add_u32 s47, s46, 0x210000
    buffer_load_dwordx4 v3, s[24:27], s47 offen lds
    s_add_u32 m0, s45, 3072
    s_add_u32 s47, s46, 0x218000
    buffer_load_dwordx4 v3, s[24:27], s47 offen lds
    ds_read_b64_tr_b16 a[16:17], v5 offset:16384
    ds_read_b64_tr_b16 a[18:19], v5 offset:17408
    ds_read_b64_tr_b16 a[20:21], v5 offset:16392
    ds_read_b64_tr_b16 a[22:23], v5 offset:17416
    ds_read_b64_tr_b16 a[24:25], v5 offset:24576
    ds_read_b64_tr_b16 a[26:27], v5 offset:25600
    ds_read_b64_tr_b16 a[28:29], v5 offset:24584
    ds_read_b64_tr_b16 a[30:31], v5 offset:25608
    s_waitcnt vmcnt(8) lgkmcnt(0)
    s_barrier
    s_add_u32 m0, s45, 16384
    s_add_u32 s47, s46, 0x280000
    buffer_load_dwordx4 v3, s[24:27], s47 offen lds
    s_add_u32 m0, s45, 17408
    s_add_u32 s47, s46, 0x288000
    buffer_load_dwordx4 v3, s[24:27], s47 offen lds
    s_add_u32 m0, s45, 18432
    s_add_u32 s47, s46, 0x290000
    buffer_load_dwordx4 v3, s[24:27], s47 offen lds
    s_add_u32 m0, s45, 19456
    s_add_u32 s47, s46, 0x298000
    buffer_load_dwordx4 v3, s[24:27], s47 offen lds
    ds_read_b64_tr_b16 a[32:33], v5 offset:32768
    ds_read_b64_tr_b16 a[34:35], v5 offset:33792
    ds_read_b64_tr_b16 a[36:37], v5 offset:32776
    ds_read_b64_tr_b16 a[38:39], v5 offset:33800
    ds_read_b64_tr_b16 a[40:41], v5 offset:40960
    ds_read_b64_tr_b16 a[42:43], v5 offset:41984
    ds_read_b64_tr_b16 a[44:45], v5 offset:40968
    ds_read_b64_tr_b16 a[46:47], v5 offset:41992
    s_waitcnt vmcnt(8) lgkmcnt(0)
    s_barrier
    s_add_u32 m0, s45, 32768
    s_add_u32 s47, s46, 0x300000
    buffer_load_dwordx4 v3, s[24:27], s47 offen lds
    s_add_u32 m0, s45, 33792
    s_add_u32 s47, s46, 0x308000
    buffer_load_dwordx4 v3, s[24:27], s47 offen lds
    s_add_u32 m0, s45, 34816
    s_add_u32 s47, s46, 0x310000
    buffer_load_dwordx4 v3, s[24:27], s47 offen lds
    s_add_u32 m0, s45, 35840
    s_add_u32 s47, s46, 0x318000
    buffer_load_dwordx4 v3, s[24:27], s47 offen lds
    ds_read_b64_tr_b16 a[48:49], v5 offset:49152
    ds_read_b64_tr_b16 a[50:51], v5 offset:50176
    ds_read_b64_tr_b16 a[52:53], v5 offset:49160
    ds_read_b64_tr_b16 a[54:55], v5 offset:50184
    ds_read_b64_tr_b16 a[56:57], v5 offset:57344
    ds_read_b64_tr_b16 a[58:59], v5 offset:58368
    ds_read_b64_tr_b16 a[60:61], v5 offset:57352
    ds_read_b64_tr_b16 a[62:63], v5 offset:58376
    s_waitcnt vmcnt(8) lgkmcnt(0)
    s_barrier
    s_add_u32 m0, s45, 49152
    s_add_u32 s47, s46, 0x380000
    buffer_load_dwordx4 v3, s[24:27], s47 offen lds
    s_add_u32 m0, s45, 50176
    s_add_u32 s47, s46, 0x388000
    buffer_load_dwordx4 v3, s[24:27], s47 offen lds
    s_add_u32 m0, s45, 51200
    s_add_u32 s47, s46, 0x390000
    buffer_load_dwordx4 v3, s[24:27], s47 offen lds
    s_add_u32 m0, s45, 52224
    s_add_u32 s47, s46, 0x398000
    buffer_load_dwordx4 v3, s[24:27], s47 offen lds
    ds_read_b64_tr_b16 a[64:65], v5 offset:0
    ds_read_b64_tr_b16 a[66:67], v5 offset:1024
    ds_read_b64_tr_b16 a[68:69], v5 offset:8
    ds_read_b64_tr_b16 a[70:71], v5 offset:1032
    ds_read_b64_tr_b16 a[72:73], v5 offset:8192
    ds_read_b64_tr_b16 a[74:75], v5 offset:9216
    ds_read_b64_tr_b16 a[76:77], v5 offset:8200
    ds_read_b64_tr_b16 a[78:79], v5 offset:9224
    s_waitcnt vmcnt(8) lgkmcnt(0)
    s_barrier
    ds_read_b64_tr_b16 a[80:81], v5 offset:16384
    ds_read_b64_tr_b16 a[82:83], v5 offset:17408
    ds_read_b64_tr_b16 a[84:85], v5 offset:16392
    ds_read_b64_tr_b16 a[86:87], v5 offset:17416
    ds_read_b64_tr_b16 a[88:89], v5 offset:24576
    ds_read_b64_tr_b16 a[90:91], v5 offset:25600
    ds_read_b64_tr_b16 a[92:93], v5 offset:24584
    ds_read_b64_tr_b16 a[94:95], v5 offset:25608
    s_waitcnt vmcnt(4) lgkmcnt(0)
    s_barrier
    ds_read_b64_tr_b16 a[96:97], v5 offset:32768
    ds_read_b64_tr_b16 a[98:99], v5 offset:33792
    ds_read_b64_tr_b16 a[100:101], v5 offset:32776
    ds_read_b64_tr_b16 a[102:103], v5 offset:33800
    ds_read_b64_tr_b16 a[104:105], v5 offset:40960
    ds_read_b64_tr_b16 a[106:107], v5 offset:41984
    ds_read_b64_tr_b16 a[108:109], v5 offset:40968
    ds_read_b64_tr_b16 a[110:111], v5 offset:41992
    s_waitcnt vmcnt(0) lgkmcnt(0)
    s_barrier
    ds_read_b64_tr_b16 a[112:113], v5 offset:49152
    ds_read_b64_tr_b16 a[114:115], v5 offset:50176
    ds_read_b64_tr_b16 a[116:117], v5 offset:49160
    ds_read_b64_tr_b16 a[118:119], v5 offset:50184
    ds_read_b64_tr_b16 a[120:121], v5 offset:57344
    ds_read_b64_tr_b16 a[122:123], v5 offset:58368
    ds_read_b64_tr_b16 a[124:125], v5 offset:57352
    ds_read_b64_tr_b16 a[126:127], v5 offset:58376
    s_waitcnt lgkmcnt(0)
    s_barrier
    v_lshlrev_b32 v2, 4, v1
    s_mul_i32 s64, s44, 8192
    s_add_u32 s46, s64, 0x400000
    v_add_u32 v3, s46, v2
    s_mul_i32 s46, s51, 32768
    v_add_u32 v4, s46, v2
    v_and_b32 v6, 15, v1
    v_lshlrev_b32 v6, 4, v6
    v_lshrrev_b32 v7, 4, v1
    v_lshl_add_u32 v6, v7, 9, v6
    v_add_u32 v4, s46, v6
    s_lshl_b32 s46, s50, 12
    s_add_u32 s46, s46, 131072
    v_add_u32 v5, s46, v2
    v_and_b32 v7, 3, v1
    v_lshlrev_b32 v7, 7, v7
    v_add_u32 v7, 0x109400, v7
    s_mul_i32 s46, s49, 24576
    s_lshl_b32 s47, s53, 13
    s_add_u32 s46, s46, s47
    s_lshl_b32 s47, s50, 10
    s_add_u32 s46, s46, s47
    s_add_u32 s46, s46, 0x2000000
    v_and_b32 v8, 15, v1
    v_lshlrev_b32 v8, 4, v8
    v_bfe_u32 v9, v1, 4, 1
    v_lshl_add_u32 v8, v9, 12, v8
    v_lshrrev_b32 v9, 5, v1
    v_lshl_add_u32 v8, v9, 8, v8
    v_add_u32 v8, s46, v2
    v_add_u32 v9, 4096, v8
    s_lshl_b32 s52, s40, 2
    s_add_u32 s52, s52, s53
    s_lshl_b32 s52, s52, 2
    s_and_b32 s47, s48, 3
    s_add_u32 s52, s52, s47
    s_lshl_b32 s52, s52, 7
    s_add_u32 s52, s52, 0x10a400
    s_add_u32 s52, s52, s76
    v_mov_b32 v116, -1
    v_mov_b32 v117, -1
    v_mov_b32 v118, -1
    v_mov_b32 v119, -1
    s_lshl_b32 s46, s49, 12
    s_lshl_b32 s47, s50, 10
    s_add_u32 s46, s46, s47
    s_add_u32 s46, s46, 0x1000000
    v_add_u32 v64, s46, v2
    s_and_b32 s46, s48, 3
    s_lshl_b32 s46, s46, 16
    s_lshl_b32 s47, s50, 14
    s_add_u32 s46, s46, s47
    s_lshl_b32 s47, s40, 8
    s_add_u32 s46, s46, s47
    s_add_u32 s46, s46, 0x7800000
    v_and_b32 v65, 15, v1
    v_lshlrev_b32 v65, 4, v65
    v_lshrrev_b32 v66, 4, v1
    v_lshl_add_u32 v65, v66, 11, v65
    v_add_u32 v65, s46, v65
    v_add_u32 v68, 8192, v65
    s_lshl_b32 s58, s74, 17
    s_lshl_b32 s46, s53, 3
    s_sub_u32 s46, 80, s46
    s_load_dwordx2 s[8:9], s[0:1], s46
    v_lshlrev_b32 v66, 7, v1
    s_mul_i32 s57, s49, 229376
    s_waitcnt lgkmcnt(0)
    s_mov_b32 s32, s8
    s_and_b32 s33, s9, 0xffff
    s_mov_b32 s34, 0x700000
    s_mov_b32 s35, 0x00020000
    s_mov_b32 s60, s74
    s_mul_i32 s61, s74, 65536
    s_mov_b32 s62, s74
    s_mul_i32 s63, s74, 786432
    s_mov_b32 s67, 0
    s_mov_b32 s68, 3
    s_mov_b32 s71, 0
    v_mov_b32 v15, 147456
    v_mov_b32 v14, 0
    ds_write_b32 v15, v14 offset:4
    ds_write_b32 v15, v14 offset:12
    ds_write_b32 v15, v14 offset:16
    v_mov_b32 v114, 1
    v_mov_b32 v115, 0
    v_lshrrev_b32 v113, 4, v1
    s_mov_b32 s72, 0
    s_cmp_lg_u32 s44, 0
    s_cbranch_scc1 L_zwok_59
    v_and_b32 v10, 7, v1
    v_lshlrev_b32 v10, 5, v10
    s_mov_b32 s70, 0
L_zw_58:
    buffer_load_dword v11, v10, s[16:19], 0 offen sc1
    s_waitcnt vmcnt(0)
    v_add_u32_dpp v11, v11, v11 row_ror:1 row_mask:0xf bank_mask:0xf
    s_nop 1
    v_add_u32_dpp v11, v11, v11 row_ror:2 row_mask:0xf bank_mask:0xf
    s_nop 1
    v_add_u32_dpp v11, v11, v11 row_ror:4 row_mask:0xf bank_mask:0xf
    v_cmp_ne_u32 vcc, 0x100, v11
    s_add_u32 s70, s70, 1
    s_cbranch_vccz L_zwok_59
    s_sleep 4
    s_cmp_lt_u32 s70, 524288
    s_cbranch_scc1 L_zw_58
    s_branch L_c_done_1
L_zwok_59:
L_g_restart_50:
    s_cmp_lg_u32 s44, 0
    s_cbranch_scc1 L_g_nsp_51
    s_mov_b32 s70, 0
L_g_sp_57:
    s_add_u32 s54, s60, 0
    v_add_u32 v12, s54, v113
    v_and_b32 v13, 7, v12
    v_lshl_add_u32 v13, v13, 9, v7
    buffer_load_dword v11, v13, s[12:15], 0 offen sc1
    s_waitcnt vmcnt(0)
    v_cmp_ge_u32 vcc, v12, v11
    s_add_u32 s70, s70, 1
    s_and_b32 s46, vcc_lo, 0xffff
    s_cbranch_scc0 L_g_sp_57_ok
    s_sleep 3
    s_cmp_lt_u32 s70, 524288
    s_cbranch_scc1 L_g_sp_57
    s_branch L_c_done_1
L_g_sp_57_ok:
    v_cmp_ge_u32 vcc, v12, v11
    s_nop 0
    s_ff1_i32_b64 s46, vcc
    s_lshr_b32 s46, s46, 4
    s_min_u32 s46, s46, 4
    s_add_u32 s46, s46, s54
    s_min_u32 s46, s46, s75
    v_mov_b32 v11, s46
    ds_write_b32 v15, v11 offset:0
L_g_nsp_51:
    s_waitcnt lgkmcnt(0)
    s_barrier
    ds_read_b32 v14, v15 offset:0
    s_waitcnt lgkmcnt(0)
    v_readfirstlane_b32 s66, v14
    s_nop 3
L_g_restart_50_go:
    s_mov_b32 s69, 0
    s_cmp_gt_u32 s62, s60
    s_cbranch_scc1 L_g_nd_60
    s_cmp_ge_u32 s62, s66
    s_cbranch_scc1 L_g_nd_60
    s_add_u32 s47, s61, 4096
    s_add_u32 m0, s64, 0
    s_nop 0
    buffer_load_dwordx4 v3, s[12:15], s61 offen offset:0 sc1 lds
    buffer_load_dwordx4 v3, s[12:15], s61 offen offset:1024 sc1 lds
    buffer_load_dwordx4 v3, s[12:15], s61 offen offset:2048 sc1 lds
    buffer_load_dwordx4 v3, s[12:15], s61 offen offset:3072 sc1 lds
    s_add_u32 m0, s64, 4096
    s_nop 0
    buffer_load_dwordx4 v3, s[12:15], s47 offen offset:0 sc1 lds
    buffer_load_dwordx4 v3, s[12:15], s47 offen offset:1024 sc1 lds
    buffer_load_dwordx4 v3, s[12:15], s47 offen offset:2048 sc1 lds
    buffer_load_dwordx4 v3, s[12:15], s47 offen offset:3072 sc1 lds
    s_add_u32 s61, s61, 65536
    s_add_u32 s62, s62, 1
    s_xor_b32 s64, s64, 0x10000
    s_mov_b32 s69, 1
L_g_nd_60:
    s_cmp_eq_u32 s51, 1
    s_cbranch_scc1 L_g_g1r_52
    s_add_u32 s59, s60, 1
    s_mov_b32 s69, 0
    s_cmp_gt_u32 s62, s59
    s_cbranch_scc1 L_g_nd_61
    s_cmp_ge_u32 s62, s66
    s_cbranch_scc1 L_g_nd_61
    s_add_u32 s47, s61, 4096
    s_add_u32 m0, s64, 0
    s_nop 0
    buffer_load_dwordx4 v3, s[12:15], s61 offen offset:0 sc1 lds
    buffer_load_dwordx4 v3, s[12:15], s61 offen offset:1024 sc1 lds
    buffer_load_dwordx4 v3, s[12:15], s61 offen offset:2048 sc1 lds
    buffer_load_dwordx4 v3, s[12:15], s61 offen offset:3072 sc1 lds
    s_add_u32 m0, s64, 4096
    s_nop 0
    buffer_load_dwordx4 v3, s[12:15], s47 offen offset:0 sc1 lds
    buffer_load_dwordx4 v3, s[12:15], s47 offen offset:1024 sc1 lds
    buffer_load_dwordx4 v3, s[12:15], s47 offen offset:2048 sc1 lds
    buffer_load_dwordx4 v3, s[12:15], s47 offen offset:3072 sc1 lds
    s_add_u32 s61, s61, 65536
    s_add_u32 s62, s62, 1
    s_xor_b32 s64, s64, 0x10000
    s_mov_b32 s69, 1
L_g_nd_61:
    s_cmp_eq_u32 s69, 1
    s_cbranch_scc1 L_g_w0_62
    s_waitcnt vmcnt(0)
L_g_w0_62:
    s_waitcnt vmcnt(8)
    s_cmp_lg_u32 s44, 0
    s_cbranch_scc1 L_g_nl_63
    s_add_u32 s54, s60, 1
    v_add_u32 v12, s54, v113
    v_and_b32 v13, 7, v12
    v_lshl_add_u32 v13, v13, 9, v7
    buffer_load_dword v11, v13, s[12:15], 0 offen sc1
L_g_nl_63:
L_g_loop0_53_l:
    s_barrier
    ds_read_b128 v[32:35], v4 offset:0
    ds_read_b128 v[36:39], v4 offset:256
    ds_read_b128 v[40:43], v4 offset:2048
    ds_read_b128 v[44:47], v4 offset:2304
    ds_read_b128 v[48:51], v4 offset:4096
    ds_read_b128 v[52:55], v4 offset:4352
    ds_read_b128 v[56:59], v4 offset:6144
    ds_read_b128 v[60:63], v4 offset:6400
    s_branch L_g_loop0_53_m
.p2align 6
L_g_loop0_53:
    s_barrier
L_g_loop0_53_m:
    s_setprio 2
    s_waitcnt lgkmcnt(6)
    v_mfma_f32_16x16x32_bf16 v[16:19], a[0:3], v[32:35], 0
    ds_read_b32 v14, v15
    v_mfma_f32_16x16x32_bf16 v[20:23], a[4:7], v[32:35], 0
    ds_read_b128 v[32:35], v4 offset:8192
    v_mfma_f32_16x16x32_bf16 v[28:31], a[4:7], v[36:39], 0
    v_mfma_f32_16x16x32_bf16 v[24:27], a[0:3], v[36:39], 0
    ds_read_b128 v[36:39], v4 offset:8448
    s_waitcnt lgkmcnt(6)
    v_mfma_f32_16x16x32_bf16 v[16:19], a[8:11], v[40:43], v[16:19]
    v_mfma_f32_16x16x32_bf16 v[20:23], a[12:15], v[40:43], v[20:23]
    ds_read_b128 v[40:43], v4 offset:10240
    v_mfma_f32_16x16x32_bf16 v[28:31], a[12:15], v[44:47], v[28:31]
    v_mfma_f32_16x16x32_bf16 v[24:27], a[8:11], v[44:47], v[24:27]
    ds_read_b128 v[44:47], v4 offset:10496
    s_waitcnt lgkmcnt(6)
    v_mfma_f32_16x16x32_bf16 v[16:19], a[16:19], v[48:51], v[16:19]
    v_mfma_f32_16x16x32_bf16 v[20:23], a[20:23], v[48:51], v[20:23]
    ds_read_b128 v[48:51], v4 offset:12288
    v_mfma_f32_16x16x32_bf16 v[28:31], a[20:23], v[52:55], v[28:31]
    v_mfma_f32_16x16x32_bf16 v[24:27], a[16:19], v[52:55], v[24:27]
    ds_read_b128 v[52:55], v4 offset:12544
    s_waitcnt lgkmcnt(6)
    v_mfma_f32_16x16x32_bf16 v[16:19], a[24:27], v[56:59], v[16:19]
    v_mfma_f32_16x16x32_bf16 v[20:23], a[28:31], v[56:59], v[20:23]
    ds_read_b128 v[56:59], v4 offset:14336
    v_mfma_f32_16x16x32_bf16 v[28:31], a[28:31], v[60:63], v[28:31]
    v_mfma_f32_16x16x32_bf16 v[24:27], a[24:27], v[60:63], v[24:27]
    ds_read_b128 v[60:63], v4 offset:14592
    s_waitcnt lgkmcnt(6)
    v_mfma_f32_16x16x32_bf16 v[16:19], a[32:35], v[32:35], v[16:19]
    v_mfma_f32_16x16x32_bf16 v[20:23], a[36:39], v[32:35], v[20:23]
    ds_read_b128 v[32:35], v4 offset:16384
    v_mfma_f32_16x16x32_bf16 v[28:31], a[36:39], v[36:39], v[28:31]
    v_mfma_f32_16x16x32_bf16 v[24:27], a[32:35], v[36:39], v[24:27]
    ds_read_b128 v[36:39], v4 offset:16640
    s_waitcnt lgkmcnt(6)
    v_mfma_f32_16x16x32_bf16 v[16:19], a[40:43], v[40:43], v[16:19]
    v_mfma_f32_16x16x32_bf16 v[20:23], a[44:47], v[40:43], v[20:23]
    ds_read_b128 v[40:43], v4 offset:18432
    v_mfma_f32_16x16x32_bf16 v[28:31], a[44:47], v[44:47], v[28:31]
    v_mfma_f32_16x16x32_bf16 v[24:27], a[40:43], v[44:47], v[24:27]
    ds_read_b128 v[44:47], v4 offset:18688
    s_waitcnt lgkmcnt(6)
    v_mfma_f32_16x16x32_bf16 v[16:19], a[48:51], v[48:51], v[16:19]
    v_mfma_f32_16x16x32_bf16 v[20:23], a[52:55], v[48:51], v[20:23]
    ds_read_b128 v[48:51], v4 offset:20480
    v_mfma_f32_16x16x32_bf16 v[28:31], a[52:55], v[52:55], v[28:31]
    v_mfma_f32_16x16x32_bf16 v[24:27], a[48:51], v[52:55], v[24:27]
    ds_read_b128 v[52:55], v4 offset:20736
    s_waitcnt lgkmcnt(6)
    v_mfma_f32_16x16x32_bf16 v[16:19], a[56:59], v[56:59], v[16:19]
    v_mfma_f32_16x16x32_bf16 v[20:23], a[60:63], v[56:59], v[20:23]
    ds_read_b128 v[56:59], v4 offset:22528
    v_mfma_f32_16x16x32_bf16 v[28:31], a[60:63], v[60:63], v[28:31]
    v_mfma_f32_16x16x32_bf16 v[24:27], a[56:59], v[60:63], v[24:27]
    ds_read_b128 v[60:63], v4 offset:22784
    s_waitcnt lgkmcnt(6)
    v_mfma_f32_16x16x32_bf16 v[16:19], a[64:67], v[32:35], v[16:19]
    v_mfma_f32_16x16x32_bf16 v[20:23], a[68:71], v[32:35], v[20:23]
    ds_read_b128 v[32:35], v4 offset:24576
    v_mfma_f32_16x16x32_bf16 v[28:31], a[68:71], v[36:39], v[28:31]
    v_mfma_f32_16x16x32_bf16 v[24:27], a[64:67], v[36:39], v[24:27]
    ds_read_b128 v[36:39], v4 offset:24832
    s_waitcnt lgkmcnt(6)
    v_mfma_f32_16x16x32_bf16 v[16:19], a[72:75], v[40:43], v[16:19]
    v_mfma_f32_16x16x32_bf16 v[20:23], a[76:79], v[40:43], v[20:23]
    ds_read_b128 v[40:43], v4 offset:26624
    v_mfma_f32_16x16x32_bf16 v[28:31], a[76:79], v[44:47], v[28:31]
    v_mfma_f32_16x16x32_bf16 v[24:27], a[72:75], v[44:47], v[24:27]
    ds_read_b128 v[44:47], v4 offset:26880
    s_waitcnt lgkmcnt(6)
    v_mfma_f32_16x16x32_bf16 v[16:19], a[80:83], v[48:51], v[16:19]
    v_mfma_f32_16x16x32_bf16 v[20:23], a[84:87], v[48:51], v[20:23]
    ds_read_b128 v[48:51], v4 offset:28672
    v_mfma_f32_16x16x32_bf16 v[28:31], a[84:87], v[52:55], v[28:31]
    v_mfma_f32_16x16x32_bf16 v[24:27], a[80:83], v[52:55], v[24:27]
    ds_read_b128 v[52:55], v4 offset:28928
    s_waitcnt lgkmcnt(6)
    v_mfma_f32_16x16x32_bf16 v[16:19], a[88:91], v[56:59], v[16:19]
    v_mfma_f32_16x16x32_bf16 v[20:23], a[92:95], v[56:59], v[20:23]
    ds_read_b128 v[56:59], v4 offset:30720
    v_mfma_f32_16x16x32_bf16 v[28:31], a[92:95], v[60:63], v[28:31]
    v_mfma_f32_16x16x32_bf16 v[24:27], a[88:91], v[60:63], v[24:27]
    ds_read_b128 v[60:63], v4 offset:30976
    s_waitcnt lgkmcnt(6)
    v_mfma_f32_16x16x32_bf16 v[16:19], a[96:99], v[32:35], v[16:19]
    v_mfma_f32_16x16x32_bf16 v[20:23], a[100:103], v[32:35], v[20:23]
    v_mfma_f32_16x16x32_bf16 v[28:31], a[100:103], v[36:39], v[28:31]
    v_mfma_f32_16x16x32_bf16 v[24:27], a[96:99], v[36:39], v[24:27]
    s_waitcnt lgkmcnt(4)
    v_mfma_f32_16x16x32_bf16 v[16:19], a[104:107], v[40:43], v[16:19]
    v_mfma_f32_16x16x32_bf16 v[20:23], a[108:111], v[40:43], v[20:23]
    v_mfma_f32_16x16x32_bf16 v[28:31], a[108:111], v[44:47], v[28:31]
    v_mfma_f32_16x16x32_bf16 v[24:27], a[104:107], v[44:47], v[24:27]
    s_waitcnt lgkmcnt(2)
    v_mfma_f32_16x16x32_bf16 v[16:19], a[112:115], v[48:51], v[16:19]
    v_mfma_f32_16x16x32_bf16 v[20:23], a[116:119], v[48:51], v[20:23]
    v_mfma_f32_16x16x32_bf16 v[28:31], a[116:119], v[52:55], v[28:31]
    v_mfma_f32_16x16x32_bf16 v[24:27], a[112:115], v[52:55], v[24:27]
    s_waitcnt lgkmcnt(0)
    v_mfma_f32_16x16x32_bf16 v[16:19], a[120:123], v[56:59], v[16:19]
    v_mfma_f32_16x16x32_bf16 v[20:23], a[124:127], v[56:59], v[20:23]
    v_mfma_f32_16x16x32_bf16 v[28:31], a[124:127], v[60:63], v[28:31]
    v_mfma_f32_16x16x32_bf16 v[24:27], a[120:123], v[60:63], v[24:27]
    v_xor_b32 v4, 0x10000, v4
    s_setprio 0
    s_waitcnt vmcnt(0)
    v_readfirstlane_b32 s66, v14
    s_barrier
    s_nop 6
    ds_write_b128 v5, v[16:19] offset:0
    ds_write_b128 v5, v[20:23] offset:1024
    ds_write_b128 v5, v[24:27] offset:2048
    ds_write_b128 v5, v[28:31] offset:3072
    s_cmp_lg_u32 s44, 0
    s_cbranch_scc1 L_g_ne_64
    v_cmp_ge_u32 vcc, v12, v11
    s_nop 0
    s_ff1_i32_b64 s46, vcc
    s_lshr_b32 s46, s46, 4
    s_min_u32 s46, s46, 4
    s_add_u32 s46, s46, s54
    s_min_u32 s46, s46, s75
    v_mov_b32 v11, s46
    ds_write_b32 v15, v11 offset:0
L_g_ne_64:
    s_add_u32 s60, s60, 1
    s_mov_b32 s65, 0
    s_cmp_le_u32 s62, s60
    s_cbranch_scc1 L_g_dp_67_l
L_g_dp_67_a:
    s_cmp_ge_u32 s62, s66
    s_cbranch_scc1 L_g_dp_67_d
    s_add_u32 s47, s61, 4096
    s_mov_b32 m0, s64
    s_add_u32 s62, s62, 1
    buffer_load_dwordx4 v3, s[12:15], s61 offen offset:0 sc1 lds
    buffer_load_dwordx4 v3, s[12:15], s61 offen offset:1024 sc1 lds
    buffer_load_dwordx4 v3, s[12:15], s61 offen offset:2048 sc1 lds
    buffer_load_dwordx4 v3, s[12:15], s61 offen offset:3072 sc1 lds
    s_add_u32 m0, s64, 4096
    s_add_u32 s61, s61, 65536
    buffer_load_dwordx4 v3, s[12:15], s47 offen offset:0 sc1 lds
    buffer_load_dwordx4 v3, s[12:15], s47 offen offset:1024 sc1 lds
    buffer_load_dwordx4 v3, s[12:15], s47 offen offset:2048 sc1 lds
    buffer_load_dwordx4 v3, s[12:15], s47 offen offset:3072 sc1 lds
    s_xor_b32 s64, s64, 0x10000
L_g_dp_67_d:
    s_cmp_le_u32 s66, s60
    s_cbranch_scc1 L_g_ex0_66
    s_cmp_lg_u32 s65, 0
    s_cbranch_scc1 L_g_nw_65
    ds_read_b128 v[32:35], v4 offset:0
    ds_read_b128 v[36:39], v4 offset:256
    ds_read_b128 v[40:43], v4 offset:2048
    ds_read_b128 v[44:47], v4 offset:2304
    ds_read_b128 v[48:51], v4 offset:4096
    ds_read_b128 v[52:55], v4 offset:4352
    ds_read_b128 v[56:59], v4 offset:6144
    ds_read_b128 v[60:63], v4 offset:6400
    s_cmp_lg_u32 s44, 0
    s_cbranch_scc1 L_g_nl_68
    s_add_u32 s54, s60, 1
    v_add_u32 v12, s54, v113
    v_and_b32 v13, 7, v12
    v_lshl_add_u32 v13, v13, 9, v7
    buffer_load_dword v11, v13, s[12:15], 0 offen sc1
L_g_nl_68:
    s_waitcnt lgkmcnt(8)
    s_branch L_g_loop0_53
L_g_ex0_66:
    s_cmp_lg_u32 s44, 0
    s_cbranch_scc1 L_g_ex0_66_n
    s_sleep 6
    s_add_u32 s54, s60, 0
    v_add_u32 v12, s54, v113
    v_and_b32 v13, 7, v12
    v_lshl_add_u32 v13, v13, 9, v7
    buffer_load_dword v11, v13, s[12:15], 0 offen sc1
    s_waitcnt vmcnt(0)
    v_cmp_ge_u32 vcc, v12, v11
    s_nop 0
    s_ff1_i32_b64 s46, vcc
    s_lshr_b32 s46, s46, 4
    s_min_u32 s46, s46, 4
    s_add_u32 s46, s46, s54
    s_min_u32 s46, s46, s75
    v_mov_b32 v11, s46
    ds_write_b32 v15, v11 offset:0
L_g_ex0_66_n:
    s_waitcnt lgkmcnt(0)
    s_barrier
    ds_read_b32 v14, v15 offset:0
    s_waitcnt lgkmcnt(0)
    v_readfirstlane_b32 s66, v14
    s_barrier
    s_cmp_gt_u32 s66, s60
    s_cbranch_scc1 L_g_restart_50_go
    s_branch L_g_tail_55
L_g_g1r_52:
    s_mov_b32 s65, 1
    s_branch L_g_loop1_54_e
.p2align 6
L_g_loop1_54:
    s_mov_b32 s65, 0
L_g_loop1_54_e:
    s_barrier
    ds_read_b32 v14, v15
    s_bitcmp1_b32 s67, 1
    s_cbranch_scc0 L_g_nfl_69
    s_cmp_lg_u32 s44, 4
    s_cbranch_scc1 L_g_nfl_69_d
    s_sub_u32 s59, s60, 1
    v_mov_b32 v10, s59
    buffer_store_dword v10, v115, s[12:15], s52 offen sc1
L_g_nfl_69_d:
    s_waitcnt lgkmcnt(0)
    v_readfirstlane_b32 s66, v14
    ds_read_b128 v[80:83], v5 offset:0
    ds_read_b128 v[84:87], v5 offset:1024
    ds_read_b128 v[88:91], v5 offset:2048
    ds_read_b128 v[92:95], v5 offset:3072
    s_cmp_le_u32 s62, s60
    s_cbranch_scc1 L_g_dp_74_l
L_g_dp_74_a:
    s_cmp_ge_u32 s62, s66
    s_cbranch_scc1 L_g_dp_74_d
    s_add_u32 s47, s61, 4096
    s_mov_b32 m0, s64
    s_add_u32 s62, s62, 1
    buffer_load_dwordx4 v3, s[12:15], s61 offen offset:0 sc1 lds
    buffer_load_dwordx4 v3, s[12:15], s61 offen offset:1024 sc1 lds
    buffer_load_dwordx4 v3, s[12:15], s61 offen offset:2048 sc1 lds
    buffer_load_dwordx4 v3, s[12:15], s61 offen offset:3072 sc1 lds
    s_add_u32 m0, s64, 4096
    s_add_u32 s61, s61, 65536
    buffer_load_dwordx4 v3, s[12:15], s47 offen offset:0 sc1 lds
    buffer_load_dwordx4 v3, s[12:15], s47 offen offset:1024 sc1 lds
    buffer_load_dwordx4 v3, s[12:15], s47 offen offset:2048 sc1 lds
    buffer_load_dwordx4 v3, s[12:15], s47 offen offset:3072 sc1 lds
    s_xor_b32 s64, s64, 0x10000
L_g_dp_74_d:
    s_bitcmp1_b32 s67, 0
    s_cbranch_scc0 L_g_nep_70
    s_waitcnt lgkmcnt(0)
    v_add_f32 v80, v80, v16
    v_add_f32 v81, v81, v17
    v_add_f32 v82, v82, v18
    v_add_f32 v83, v83, v19
    v_add_f32 v84, v84, v20
    v_add_f32 v85, v85, v21
    v_add_f32 v86, v86, v22
    v_add_f32 v87, v87, v23
    v_add_f32 v88, v88, v24
    v_add_f32 v89, v89, v25
    v_add_f32 v90, v90, v26
    v_add_f32 v91, v91, v27
    v_add_f32 v92, v92, v28
    v_add_f32 v93, v93, v29
    v_add_f32 v94, v94, v30
    v_add_f32 v95, v95, v31
    v_cvt_pk_bf16_f32 v104, v80, v81
    v_cvt_pk_bf16_f32 v105, v82, v83
    v_cvt_pk_bf16_f32 v106, v84, v85
    v_cvt_pk_bf16_f32 v107, v86, v87
    buffer_store_dwordx4 v[104:107], v8, s[12:15], s63 offen sc1
    v_cvt_pk_bf16_f32 v108, v88, v89
    v_cvt_pk_bf16_f32 v109, v90, v91
    v_cvt_pk_bf16_f32 v110, v92, v93
    v_cvt_pk_bf16_f32 v111, v94, v95
    buffer_store_dwordx4 v[108:111], v9, s[12:15], s63 offen sc1
    s_add_u32 s63, s63, 786432
    s_cmp_lg_u32 s53, 2
    s_cbranch_scc1 L_g_pf_75
    s_lshl_b32 s73, s58, 1
    buffer_store_dwordx4 v[116:119], v64, s[12:15], s58 offen sc1
    buffer_store_dwordx4 v[116:119], v65, s[12:15], s73 offen sc1
    buffer_store_dwordx4 v[116:119], v68, s[12:15], s73 offen sc1
    s_add_u32 s58, s58, 131072
L_g_pf_75:
    s_cmp_le_u32 s60, 2
    s_cbranch_scc1 L_g_nep_70_e
L_g_nep_70:
    s_cmp_lg_u32 s65, 0
    s_cbranch_scc1 L_g_nw1_71
    ds_read_b128 v[32:35], v4 offset:0
    ds_read_b128 v[36:39], v4 offset:256
    ds_read_b128 v[40:43], v4 offset:2048
    ds_read_b128 v[44:47], v4 offset:2304
    ds_read_b128 v[48:51], v4 offset:4096
    ds_read_b128 v[52:55], v4 offset:4352
    ds_read_b128 v[56:59], v4 offset:6144
    ds_read_b128 v[60:63], v4 offset:6400
    s_barrier
L_g_jn_73:
    s_setprio 1
    s_waitcnt lgkmcnt(6)
    v_mfma_f32_16x16x32_bf16 v[16:19], a[0:3], v[32:35], 0
    v_mfma_f32_16x16x32_bf16 v[20:23], a[4:7], v[32:35], 0
    ds_read_b128 v[32:35], v4 offset:8192
    v_mfma_f32_16x16x32_bf16 v[28:31], a[4:7], v[36:39], 0
    v_mfma_f32_16x16x32_bf16 v[24:27], a[0:3], v[36:39], 0
    ds_read_b128 v[36:39], v4 offset:8448
    s_waitcnt lgkmcnt(6)
    v_mfma_f32_16x16x32_bf16 v[16:19], a[8:11], v[40:43], v[16:19]
    v_mfma_f32_16x16x32_bf16 v[20:23], a[12:15], v[40:43], v[20:23]
    ds_read_b128 v[40:43], v4 offset:10240
    v_mfma_f32_16x16x32_bf16 v[28:31], a[12:15], v[44:47], v[28:31]
    v_mfma_f32_16x16x32_bf16 v[24:27], a[8:11], v[44:47], v[24:27]
    ds_read_b128 v[44:47], v4 offset:10496
    s_waitcnt lgkmcnt(6)
    v_mfma_f32_16x16x32_bf16 v[16:19], a[16:19], v[48:51], v[16:19]
    v_mfma_f32_16x16x32_bf16 v[20:23], a[20:23], v[48:51], v[20:23]
    ds_read_b128 v[48:51], v4 offset:12288
    v_mfma_f32_16x16x32_bf16 v[28:31], a[20:23], v[52:55], v[28:31]
    v_mfma_f32_16x16x32_bf16 v[24:27], a[16:19], v[52:55], v[24:27]
    ds_read_b128 v[52:55], v4 offset:12544
    s_waitcnt lgkmcnt(6)
    v_mfma_f32_16x16x32_bf16 v[16:19], a[24:27], v[56:59], v[16:19]
    v_mfma_f32_16x16x32_bf16 v[20:23], a[28:31], v[56:59], v[20:23]
    ds_read_b128 v[56:59], v4 offset:14336
    v_mfma_f32_16x16x32_bf16 v[28:31], a[28:31], v[60:63], v[28:31]
    v_mfma_f32_16x16x32_bf16 v[24:27], a[24:27], v[60:63], v[24:27]
    ds_read_b128 v[60:63], v4 offset:14592
    s_waitcnt lgkmcnt(6)
    v_mfma_f32_16x16x32_bf16 v[16:19], a[32:35], v[32:35], v[16:19]
    v_mfma_f32_16x16x32_bf16 v[20:23], a[36:39], v[32:35], v[20:23]
    ds_read_b128 v[32:35], v4 offset:16384
    v_mfma_f32_16x16x32_bf16 v[28:31], a[36:39], v[36:39], v[28:31]
    v_mfma_f32_16x16x32_bf16 v[24:27], a[32:35], v[36:39], v[24:27]
    ds_read_b128 v[36:39], v4 offset:16640
    s_waitcnt lgkmcnt(6)
    v_mfma_f32_16x16x32_bf16 v[16:19], a[40:43], v[40:43], v[16:19]
    v_mfma_f32_16x16x32_bf16 v[20:23], a[44:47], v[40:43], v[20:23]
    ds_read_b128 v[40:43], v4 offset:18432
    v_mfma_f32_16x16x32_bf16 v[28:31], a[44:47], v[44:47], v[28:31]
    v_mfma_f32_16x16x32_bf16 v[24:27], a[40:43], v[44:47], v[24:27]
    ds_read_b128 v[44:47], v4 offset:18688
    s_waitcnt lgkmcnt(6)
    v_mfma_f32_16x16x32_bf16 v[16:19], a[48:51], v[48:51], v[16:19]
    v_mfma_f32_16x16x32_bf16 v[20:23], a[52:55], v[48:51], v[20:23]
    ds_read_b128 v[48:51], v4 offset:20480
    v_mfma_f32_16x16x32_bf16 v[28:31], a[52:55], v[52:55], v[28:31]
    v_mfma_f32_16x16x32_bf16 v[24:27], a[48:51], v[52:55], v[24:27]
    ds_read_b128 v[52:55], v4 offset:20736
    s_waitcnt lgkmcnt(6)
    v_mfma_f32_16x16x32_bf16 v[16:19], a[56:59], v[56:59], v[16:19]
    v_mfma_f32_16x16x32_bf16 v[20:23], a[60:63], v[56:59], v[20:23]
    ds_read_b128 v[56:59], v4 offset:22528
    v_mfma_f32_16x16x32_bf16 v[28:31], a[60:63], v[60:63], v[28:31]
    v_mfma_f32_16x16x32_bf16 v[24:27], a[56:59], v[60:63], v[24:27]
    ds_read_b128 v[60:63], v4 offset:22784
    s_waitcnt lgkmcnt(6)
    v_mfma_f32_16x16x32_bf16 v[16:19], a[64:67], v[32:35], v[16:19]
    v_mfma_f32_16x16x32_bf16 v[20:23], a[68:71], v[32:35], v[20:23]
    ds_read_b128 v[32:35], v4 offset:24576
    v_mfma_f32_16x16x32_bf16 v[28:31], a[68:71], v[36:39], v[28:31]
    v_mfma_f32_16x16x32_bf16 v[24:27], a[64:67], v[36:39], v[24:27]
    ds_read_b128 v[36:39], v4 offset:24832
    s_waitcnt lgkmcnt(6)
    v_mfma_f32_16x16x32_bf16 v[16:19], a[72:75], v[40:43], v[16:19]
    v_mfma_f32_16x16x32_bf16 v[20:23], a[76:79], v[40:43], v[20:23]
    ds_read_b128 v[40:43], v4 offset:26624
    v_mfma_f32_16x16x32_bf16 v[28:31], a[76:79], v[44:47], v[28:31]
    v_mfma_f32_16x16x32_bf16 v[24:27], a[72:75], v[44:47], v[24:27]
    ds_read_b128 v[44:47], v4 offset:26880
    s_waitcnt lgkmcnt(6)
    v_mfma_f32_16x16x32_bf16 v[16:19], a[80:83], v[48:51], v[16:19]
    v_mfma_f32_16x16x32_bf16 v[20:23], a[84:87], v[48:51], v[20:23]
    ds_read_b128 v[48:51], v4 offset:28672
    v_mfma_f32_16x16x32_bf16 v[28:31], a[84:87], v[52:55], v[28:31]
    v_mfma_f32_16x16x32_bf16 v[24:27], a[80:83], v[52:55], v[24:27]
    ds_read_b128 v[52:55], v4 offset:28928
    s_waitcnt lgkmcnt(6)
    v_mfma_f32_16x16x32_bf16 v[16:19], a[88:91], v[56:59], v[16:19]
    v_mfma_f32_16x16x32_bf16 v[20:23], a[92:95], v[56:59], v[20:23]
    ds_read_b128 v[56:59], v4 offset:30720
    v_mfma_f32_16x16x32_bf16 v[28:31], a[92:95], v[60:63], v[28:31]
    v_mfma_f32_16x16x32_bf16 v[24:27], a[88:91], v[60:63], v[24:27]
    ds_read_b128 v[60:63], v4 offset:30976
    s_waitcnt lgkmcnt(6)
    v_mfma_f32_16x16x32_bf16 v[16:19], a[96:99], v[32:35], v[16:19]
    v_mfma_f32_16x16x32_bf16 v[20:23], a[100:103], v[32:35], v[20:23]
    v_mfma_f32_16x16x32_bf16 v[28:31], a[100:103], v[36:39], v[28:31]
    v_mfma_f32_16x16x32_bf16 v[24:27], a[96:99], v[36:39], v[24:27]
    s_waitcnt lgkmcnt(4)
    v_mfma_f32_16x16x32_bf16 v[16:19], a[104:107], v[40:43], v[16:19]
    v_mfma_f32_16x16x32_bf16 v[20:23], a[108:111], v[40:43], v[20:23]
    v_mfma_f32_16x16x32_bf16 v[28:31], a[108:111], v[44:47], v[28:31]
    v_mfma_f32_16x16x32_bf16 v[24:27], a[104:107], v[44:47], v[24:27]
    s_waitcnt lgkmcnt(2)
    v_mfma_f32_16x16x32_bf16 v[16:19], a[112:115], v[48:51], v[16:19]
    v_mfma_f32_16x16x32_bf16 v[20:23], a[116:119], v[48:51], v[20:23]
    v_mfma_f32_16x16x32_bf16 v[28:31], a[116:119], v[52:55], v[28:31]
    v_mfma_f32_16x16x32_bf16 v[24:27], a[112:115], v[52:55], v[24:27]
    s_waitcnt lgkmcnt(0)
    v_mfma_f32_16x16x32_bf16 v[16:19], a[120:123], v[56:59], v[16:19]
    v_mfma_f32_16x16x32_bf16 v[20:23], a[124:127], v[56:59], v[20:23]
    v_mfma_f32_16x16x32_bf16 v[28:31], a[124:127], v[60:63], v[28:31]
    v_mfma_f32_16x16x32_bf16 v[24:27], a[120:123], v[60:63], v[24:27]
    v_xor_b32 v4, 0x10000, v4
    s_setprio 0
    s_waitcnt vmcnt(0)
    s_lshl_b32 s67, s67, 1
    s_or_b32 s67, s67, 1
    s_add_u32 s60, s60, 1
    s_cmp_gt_u32 s66, s60
    s_cbranch_scc1 L_g_loop1_54
    s_barrier
    ds_read_b32 v14, v15 offset:0
    s_waitcnt lgkmcnt(0)
    v_readfirstlane_b32 s66, v14
    s_barrier
    s_mov_b32 s69, 0
    s_cmp_gt_u32 s62, s60
    s_cbranch_scc1 L_g_nd_76
    s_cmp_ge_u32 s62, s66
    s_cbranch_scc1 L_g_nd_76
    s_add_u32 s47, s61, 4096
    s_add_u32 m0, s64, 0
    s_nop 0
    buffer_load_dwordx4 v3, s[12:15], s61 offen offset:0 sc1 lds
    buffer_load_dwordx4 v3, s[12:15], s61 offen offset:1024 sc1 lds
    buffer_load_dwordx4 v3, s[12:15], s61 offen offset:2048 sc1 lds
    buffer_load_dwordx4 v3, s[12:15], s61 offen offset:3072 sc1 lds
    s_add_u32 m0, s64, 4096
    s_nop 0
    buffer_load_dwordx4 v3, s[12:15], s47 offen offset:0 sc1 lds
    buffer_load_dwordx4 v3, s[12:15], s47 offen offset:1024 sc1 lds
    buffer_load_dwordx4 v3, s[12:15], s47 offen offset:2048 sc1 lds
    buffer_load_dwordx4 v3, s[12:15], s47 offen offset:3072 sc1 lds
    s_add_u32 s61, s61, 65536
    s_add_u32 s62, s62, 1
    s_xor_b32 s64, s64, 0x10000
    s_mov_b32 s69, 1
L_g_nd_76:
    s_sub_u32 s59, s60, 1
    ds_read_b128 v[80:83], v5 offset:0
    ds_read_b128 v[84:87], v5 offset:1024
    ds_read_b128 v[88:91], v5 offset:2048
    ds_read_b128 v[92:95], v5 offset:3072
    s_nop 7
    s_waitcnt lgkmcnt(3)
    v_add_f32 v80, v80, v16
    v_add_f32 v81, v81, v17
    v_add_f32 v82, v82, v18
    v_add_f32 v83, v83, v19
    s_waitcnt lgkmcnt(2)
    v_add_f32 v84, v84, v20
    v_add_f32 v85, v85, v21
    v_add_f32 v86, v86, v22
    v_add_f32 v87, v87, v23
    s_waitcnt lgkmcnt(1)
    v_add_f32 v88, v88, v24
    v_add_f32 v89, v89, v25
    v_add_f32 v90, v90, v26
    v_add_f32 v91, v91, v27
    s_waitcnt lgkmcnt(0)
    v_add_f32 v92, v92, v28
    v_add_f32 v93, v93, v29
    v_add_f32 v94, v94, v30
    v_add_f32 v95, v95, v31
    v_cvt_pk_bf16_f32 v104, v80, v81
    v_cvt_pk_bf16_f32 v105, v82, v83
    v_cvt_pk_bf16_f32 v106, v84, v85
    v_cvt_pk_bf16_f32 v107, v86, v87
    buffer_store_dwordx4 v[104:107], v8, s[12:15], s63 offen sc1
    v_cvt_pk_bf16_f32 v108, v88, v89
    v_cvt_pk_bf16_f32 v109, v90, v91
    v_cvt_pk_bf16_f32 v110, v92, v93
    v_cvt_pk_bf16_f32 v111, v94, v95
    buffer_store_dwordx4 v[108:111], v9, s[12:15], s63 offen sc1
    s_add_u32 s63, s63, 786432
    s_cmp_lg_u32 s53, 2
    s_cbranch_scc1 L_g_pf_77
    s_lshl_b32 s73, s58, 1
    buffer_store_dwordx4 v[116:119], v64, s[12:15], s58 offen sc1
    buffer_store_dwordx4 v[116:119], v65, s[12:15], s73 offen sc1
    buffer_store_dwordx4 v[116:119], v68, s[12:15], s73 offen sc1
    s_add_u32 s58, s58, 131072
L_g_pf_77:
    s_mov_b32 s67, 0
    s_mov_b32 s71, 1
    s_cmp_gt_u32 s66, s60
    s_cbranch_scc1 L_g_g1r_52
    v_mov_b32 v10, 1
    s_mov_b64 exec, 1
    s_waitcnt vmcnt(0)
    ds_add_rtn_u32 v10, v15, v10 offset:4
    s_waitcnt lgkmcnt(0)
    v_readfirstlane_b32 s46, v10
    s_mov_b64 exec, -1
    s_mov_b32 s71, 0
    s_sub_u32 s59, s60, 1
    s_cmp_lg_u32 s46, s68
    s_cbranch_scc1 L_g_df_78
    v_mov_b32 v10, s59
    v_add_u32 v10, 1, v10
    v_mov_b32 v11, 0
    s_mov_b64 exec, 1
    buffer_store_dword v10, v11, s[12:15], s52 offen sc1
    s_mov_b64 exec, -1
L_sf_79:
L_g_df_78:
    s_add_u32 s68, s68, 4
    s_cmp_gt_u32 s66, s60
    s_cbranch_scc1 L_g_g1r_52
L_g_tail_55:
    s_cmp_lt_u32 s60, s75
    s_cbranch_scc1 L_g_restart_50
    s_waitcnt vmcnt(0)
    s_barrier
    s_branch L_w_p2_11
L_g_dp_67_l:
    s_cmp_ge_u32 s62, s66
    s_cbranch_scc1 L_g_dp_67_d
    s_mov_b32 s65, 1
    s_add_u32 s47, s61, 4096
    s_mov_b32 m0, s64
    s_add_u32 s62, s62, 1
    buffer_load_dwordx4 v3, s[12:15], s61 offen offset:0 sc1 lds
    buffer_load_dwordx4 v3, s[12:15], s61 offen offset:1024 sc1 lds
    buffer_load_dwordx4 v3, s[12:15], s61 offen offset:2048 sc1 lds
    buffer_load_dwordx4 v3, s[12:15], s61 offen offset:3072 sc1 lds
    s_add_u32 m0, s64, 4096
    s_add_u32 s61, s61, 65536
    buffer_load_dwordx4 v3, s[12:15], s47 offen offset:0 sc1 lds
    buffer_load_dwordx4 v3, s[12:15], s47 offen offset:1024 sc1 lds
    buffer_load_dwordx4 v3, s[12:15], s47 offen offset:2048 sc1 lds
    buffer_load_dwordx4 v3, s[12:15], s47 offen offset:3072 sc1 lds
    s_xor_b32 s64, s64, 0x10000
    s_branch L_g_dp_67_a
L_g_nw_65:
    s_waitcnt vmcnt(0) lgkmcnt(0)
    s_cmp_lg_u32 s44, 0
    s_cbranch_scc1 L_g_nl_80
    s_add_u32 s54, s60, 1
    v_add_u32 v12, s54, v113
    v_and_b32 v13, 7, v12
    v_lshl_add_u32 v13, v13, 9, v7
    buffer_load_dword v11, v13, s[12:15], 0 offen sc1
L_g_nl_80:
    s_branch L_g_loop0_53_l
L_g_nfl_69:
    s_cmp_eq_u32 s71, 0
    s_cbranch_scc1 L_g_nfl_69_d
    v_mov_b32 v10, 1
    s_mov_b64 exec, 1
    s_waitcnt vmcnt(0)
    ds_add_rtn_u32 v10, v15, v10 offset:4
    s_waitcnt lgkmcnt(0)
    v_readfirstlane_b32 s46, v10
    s_mov_b64 exec, -1
    s_mov_b32 s71, 0
    s_sub_u32 s59, s60, 1
    s_cmp_lg_u32 s46, s68
    s_cbranch_scc1 L_g_df_81
    v_mov_b32 v10, s59
    v_add_u32 v10, 1, v10
    v_mov_b32 v11, 0
    s_mov_b64 exec, 1
    buffer_store_dword v10, v11, s[12:15], s52 offen sc1
    s_mov_b64 exec, -1
L_sf_82:
L_g_df_81:
    s_add_u32 s68, s68, 4
    s_mov_b32 s65, 2
    s_branch L_g_nfl_69_d
L_g_dp_74_l:
    s_cmp_ge_u32 s62, s66
    s_cbranch_scc1 L_g_dp_74_d
    s_or_b32 s65, s65, 1
    s_add_u32 s47, s61, 4096
    s_mov_b32 m0, s64
    s_add_u32 s62, s62, 1
    buffer_load_dwordx4 v3, s[12:15], s61 offen offset:0 sc1 lds
    buffer_load_dwordx4 v3, s[12:15], s61 offen offset:1024 sc1 lds
    buffer_load_dwordx4 v3, s[12:15], s61 offen offset:2048 sc1 lds
    buffer_load_dwordx4 v3, s[12:15], s61 offen offset:3072 sc1 lds
    s_add_u32 m0, s64, 4096
    s_add_u32 s61, s61, 65536
    buffer_load_dwordx4 v3, s[12:15], s47 offen offset:0 sc1 lds
    buffer_load_dwordx4 v3, s[12:15], s47 offen offset:1024 sc1 lds
    buffer_load_dwordx4 v3, s[12:15], s47 offen offset:2048 sc1 lds
    buffer_load_dwordx4 v3, s[12:15], s47 offen offset:3072 sc1 lds
    s_xor_b32 s64, s64, 0x10000
    s_branch L_g_dp_74_a
L_g_nep_70_e:
    v_mov_b32 v10, 1
    s_mov_b64 exec, 1
    s_waitcnt vmcnt(0)
    ds_add_rtn_u32 v10, v15, v10 offset:4
    s_waitcnt lgkmcnt(0)
    v_readfirstlane_b32 s46, v10
    s_mov_b64 exec, -1
    s_mov_b32 s71, 0
    s_sub_u32 s59, s60, 1
    s_cmp_lg_u32 s46, s68
    s_cbranch_scc1 L_g_df_83
    v_mov_b32 v10, s59
    v_add_u32 v10, 1, v10
    v_mov_b32 v11, 0
    s_mov_b64 exec, 1
    buffer_store_dword v10, v11, s[12:15], s52 offen sc1
    s_mov_b64 exec, -1
L_sf_84:
L_g_df_83:
    s_add_u32 s68, s68, 4
    s_branch L_g_nep_70
L_g_nw1_71:
    s_cmp_eq_u32 s65, 2
    s_cbranch_scc1 L_g_nw1_71_w
    s_waitcnt vmcnt(0)
L_g_nw1_71_w:
    s_barrier
    ds_read_b128 v[32:35], v4 offset:0
    ds_read_b128 v[36:39], v4 offset:256
    ds_read_b128 v[40:43], v4 offset:2048
    ds_read_b128 v[44:47], v4 offset:2304
    ds_read_b128 v[48:51], v4 offset:4096
    ds_read_b128 v[52:55], v4 offset:4352
    ds_read_b128 v[56:59], v4 offset:6144
    ds_read_b128 v[60:63], v4 offset:6400
    s_branch L_g_jn_73
L_w_p2_11:
    s_cmp_lg_u32 s44, 0
    s_cbranch_scc1 L_w_p2_11_h
    s_mov_b32 s47, 63
    s_cmp_eq_u32 s53, 0
    s_cbranch_scc1 L_w_p2_11_q
    s_sub_u32 s52, s52, s76
    v_mov_b32 v10, 1
    v_mov_b32 v11, 131072
    s_mov_b64 exec, 1
    buffer_atomic_add v10, v11, s[12:15], s52 offen sc0
    s_waitcnt vmcnt(0)
    v_readfirstlane_b32 s46, v10
    s_mov_b64 exec, -1
    s_mov_b32 s47, 63
    s_nop 1
    s_cmp_eq_u32 s46, 0
    s_cbranch_scc1 L_w_p2_11_h
L_w_p2_11_q:
    v_mov_b32 v10, s47
    v_add_u32 v10, 1, v10
    v_mov_b32 v11, 0
    s_mov_b64 exec, 1
    buffer_store_dword v10, v11, s[12:15], s52 offen sc1
    s_mov_b64 exec, -1
L_sf_85:
L_w_p2_11_h:
    s_cmp_eq_u32 s76, 0
    s_cbranch_scc1 L_w_p2_11_m
    s_cmp_eq_u32 s79, 1
    s_cbranch_scc1 L_w_h_17
    s_mov_b32 s79, 1
    s_cmp_lt_u32 s77, 14
    s_cselect_b32 s53, 2, s53
    s_cselect_b32 s48, s48, 3
    s_branch L_w_h_17_n
L_w_p2_11_m:
    s_cmp_lt_u32 s48, 8
    s_cselect_b32 s75, 60, 60
    s_cmp_lt_u32 s48, 4
    s_cselect_b32 s75, 64, s75
L_w_p2_11_r:
    s_lshr_b32 s42, s40, 1
    s_and_b32 s43, s40, 1
    s_lshl_b32 s43, s43, 2
    s_and_b32 s46, s48, 3
    s_add_u32 s43, s43, s46
    s_cmp_lt_u32 s48, 4
    s_cbranch_scc1 L_w_wo_12
    s_cmp_lt_u32 s48, 8
    s_cbranch_scc1 L_w_f2_13
    s_cmp_lg_u32 s43, 7
    s_cbranch_scc1 L_w_f1_14
    s_mov_b32 s43, 2
    s_cmp_eq_u32 s76, 0
    s_cbranch_scc1 L_w_c_16
    s_mov_b32 s43, 7
    s_mov_b32 s78, 1
L_w_f1_14_t:
    s_cmp_lt_u32 s41, 8
    s_cselect_b32 s74, 60, 63
    s_cselect_b32 s75, 63, 64
    s_add_u32 s43, s43, s74
    s_cmp_lt_u32 s43, s75
    s_cbranch_scc1 L_w_h_17_f
    s_branch L_c_done_1
L_w_f1_14_d:
    s_cmp_eq_u32 s76, 0
    s_cbranch_scc1 L_c_done_1
    s_and_b32 s42, s49, 3
    s_lshr_b32 s43, s49, 2
    s_mov_b32 s78, 64
    s_branch L_w_f1_14_t
L_replica:
    s_setprio 0
    s_barrier
    s_and_b32 s48, s41, 7
    s_add_u32 s48, s48, 4
    s_cmp_lt_u32 s41, 8
    s_cselect_b32 s74, 60, 63
    s_cselect_b32 s75, 63, 64
    s_cselect_b32 s76, 1, 2
    s_cselect_b32 s46, 60, 63
    s_cselect_b32 s47, 63, 64
    s_mul_i32 s76, s76, 65536
    s_cmp_lt_u32 s48, 8
    s_cselect_b32 s74, s46, s74
    s_cselect_b32 s75, s47, s75
    s_branch L_w_p2_11_r
L_w_f1_14:
    s_load_dwordx2 s[4:5], s[0:1], 64
    s_load_dwordx2 s[6:7], s[0:1], 72
    s_and_b32 s50, s44, 3
    s_lshr_b32 s51, s44, 2
    s_waitcnt lgkmcnt(0)
    s_mov_b32 s24, s4
    s_and_b32 s25, s5, 0xffff
    s_mov_b32 s26, 0x700000
    s_mov_b32 s27, 0x00020000
    s_mul_i32 s49, s42, 7
    s_add_u32 s49, s49, s43
    v_lshrrev_b32 v3, 4, v1
    v_and_b32 v4, 15, v1
    v_lshlrev_b32 v5, 2, v3
    v_xor_b32 v4, v4, v5
    v_mul_u32_u24 v3, 7168, v3
    v_lshl_add_u32 v3, v4, 4, v3
    s_mul_i32 s46, s51, 512
    s_mul_i32 s47, s50, 16
    s_add_u32 s46, s46, s47
    s_mul_i32 s46, s46, 7168
    s_lshl_b32 s47, s49, 8
    s_add_u32 s46, s46, s47
    s_lshl_b32 s45, s51, 16
    s_mul_i32 s47, s50, 4096
    s_add_u32 s45, s45, s47
    v_bfe_u32 v4, v1, 2, 2
    v_bfe_u32 v5, v1, 4, 1
    v_lshlrev_b32 v5, 1, v5
    v_bfe_u32 v6, v1, 1, 1
    v_add_u32 v5, v5, v6
    s_lshl_b32 s47, s50, 2
    v_add_u32 v5, s47, v5
    v_lshlrev_b32 v6, 2, v4
    v_xor_b32 v5, v5, v6
    v_lshlrev_b32 v5, 4, v5
    v_lshl_add_u32 v5, v4, 8, v5
    v_bfe_u32 v6, v1, 0, 1
    v_lshl_add_u32 v5, v6, 3, v5
    v_lshrrev_b32 v6, 5, v1
    v_mul_u32_u24 v6, 2048, v6
    v_add_u32 v5, v5, v6
    s_lshl_b32 s47, s51, 16
    v_add_u32 v5, s47, v5
    s_add_u32 m0, s45, 0
    s_add_u32 s47, s46, 0x0
    buffer_load_dwordx4 v3, s[24:27], s47 offen lds
    s_add_u32 m0, s45, 1024
    s_add_u32 s47, s46, 0x7000
    buffer_load_dwordx4 v3, s[24:27], s47 offen lds
    s_add_u32 m0, s45, 2048
    s_add_u32 s47, s46, 0xe000
    buffer_load_dwordx4 v3, s[24:27], s47 offen lds
    s_add_u32 m0, s45, 3072
    s_add_u32 s47, s46, 0x15000
    buffer_load_dwordx4 v3, s[24:27], s47 offen lds
    s_add_u32 m0, s45, 16384
    s_add_u32 s47, s46, 0x70000
    buffer_load_dwordx4 v3, s[24:27], s47 offen lds
    s_add_u32 m0, s45, 17408
    s_add_u32 s47, s46, 0x77000
    buffer_load_dwordx4 v3, s[24:27], s47 offen lds
    s_add_u32 m0, s45, 18432
    s_add_u32 s47, s46, 0x7e000
    buffer_load_dwordx4 v3, s[24:27], s47 offen lds
    s_add_u32 m0, s45, 19456
    s_add_u32 s47, s46, 0x85000
    buffer_load_dwordx4 v3, s[24:27], s47 offen lds
    s_add_u32 m0, s45, 32768
    s_add_u32 s47, s46, 0xe0000
    buffer_load_dwordx4 v3, s[24:27], s47 offen lds
    s_add_u32 m0, s45, 33792
    s_add_u32 s47, s46, 0xe7000
    buffer_load_dwordx4 v3, s[24:27], s47 offen lds
    s_add_u32 m0, s45, 34816
    s_add_u32 s47, s46, 0xee000
    buffer_load_dwordx4 v3, s[24:27], s47 offen lds
    s_add_u32 m0, s45, 35840
    s_add_u32 s47, s46, 0xf5000
    buffer_load_dwordx4 v3, s[24:27], s47 offen lds
    s_add_u32 m0, s45, 49152
    s_add_u32 s47, s46, 0x150000
    buffer_load_dwordx4 v3, s[24:27], s47 offen lds
    s_add_u32 m0, s45, 50176
    s_add_u32 s47, s46, 0x157000
    buffer_load_dwordx4 v3, s[24:27], s47 offen lds
    s_add_u32 m0, s45, 51200
    s_add_u32 s47, s46, 0x15e000
    buffer_load_dwordx4 v3, s[24:27], s47 offen lds
    s_add_u32 m0, s45, 52224
    s_add_u32 s47, s46, 0x165000
    buffer_load_dwordx4 v3, s[24:27], s47 offen lds
    s_waitcnt vmcnt(12) lgkmcnt(0)
    s_barrier
    ds_read_b64_tr_b16 a[0:1], v5 offset:0
    ds_read_b64_tr_b16 a[2:3], v5 offset:1024
    ds_read_b64_tr_b16 a[4:5], v5 offset:4096
    ds_read_b64_tr_b16 a[6:7], v5 offset:5120
    ds_read_b64_tr_b16 a[8:9], v5 offset:8192
    ds_read_b64_tr_b16 a[10:11], v5 offset:9216
    ds_read_b64_tr_b16 a[12:13], v5 offset:12288
    ds_read_b64_tr_b16 a[14:15], v5 offset:13312
    s_waitcnt vmcnt(8) lgkmcnt(0)
    s_barrier
    s_add_u32 m0, s45, 0
    s_add_u32 s47, s46, 0x1c0000
    buffer_load_dwordx4 v3, s[24:27], s47 offen lds
    s_add_u32 m0, s45, 1024
    s_add_u32 s47, s46, 0x1c7000
    buffer_load_dwordx4 v3, s[24:27], s47 offen lds
    s_add_u32 m0, s45, 2048
    s_add_u32 s47, s46, 0x1ce000
    buffer_load_dwordx4 v3, s[24:27], s47 offen lds
    s_add_u32 m0, s45, 3072
    s_add_u32 s47, s46, 0x1d5000
    buffer_load_dwordx4 v3, s[24:27], s47 offen lds
    ds_read_b64_tr_b16 a[16:17], v5 offset:16384
    ds_read_b64_tr_b16 a[18:19], v5 offset:17408
    ds_read_b64_tr_b16 a[20:21], v5 offset:20480
    ds_read_b64_tr_b16 a[22:23], v5 offset:21504
    ds_read_b64_tr_b16 a[24:25], v5 offset:24576
    ds_read_b64_tr_b16 a[26:27], v5 offset:25600
    ds_read_b64_tr_b16 a[28:29], v5 offset:28672
    ds_read_b64_tr_b16 a[30:31], v5 offset:29696
    s_waitcnt vmcnt(8) lgkmcnt(0)
    s_barrier
    s_add_u32 m0, s45, 16384
    s_add_u32 s47, s46, 0x230000
    buffer_load_dwordx4 v3, s[24:27], s47 offen lds
    s_add_u32 m0, s45, 17408
    s_add_u32 s47, s46, 0x237000
    buffer_load_dwordx4 v3, s[24:27], s47 offen lds
    s_add_u32 m0, s45, 18432
    s_add_u32 s47, s46, 0x23e000
    buffer_load_dwordx4 v3, s[24:27], s47 offen lds
    s_add_u32 m0, s45, 19456
    s_add_u32 s47, s46, 0x245000
    buffer_load_dwordx4 v3, s[24:27], s47 offen lds
    ds_read_b64_tr_b16 a[32:33], v5 offset:32768
    ds_read_b64_tr_b16 a[34:35], v5 offset:33792
    ds_read_b64_tr_b16 a[36:37], v5 offset:36864
    ds_read_b64_tr_b16 a[38:39], v5 offset:37888
    ds_read_b64_tr_b16 a[40:41], v5 offset:40960
    ds_read_b64_tr_b16 a[42:43], v5 offset:41984
    ds_read_b64_tr_b16 a[44:45], v5 offset:45056
    ds_read_b64_tr_b16 a[46:47], v5 offset:46080
    s_waitcnt vmcnt(8) lgkmcnt(0)
    s_barrier
    s_add_u32 m0, s45, 32768
    s_add_u32 s47, s46, 0x2a0000
    buffer_load_dwordx4 v3, s[24:27], s47 offen lds
    s_add_u32 m0, s45, 33792
    s_add_u32 s47, s46, 0x2a7000
    buffer_load_dwordx4 v3, s[24:27], s47 offen lds
    s_add_u32 m0, s45, 34816
    s_add_u32 s47, s46, 0x2ae000
    buffer_load_dwordx4 v3, s[24:27], s47 offen lds
    s_add_u32 m0, s45, 35840
    s_add_u32 s47, s46, 0x2b5000
    buffer_load_dwordx4 v3, s[24:27], s47 offen lds
    ds_read_b64_tr_b16 a[48:49], v5 offset:49152
    ds_read_b64_tr_b16 a[50:51], v5 offset:50176
    ds_read_b64_tr_b16 a[52:53], v5 offset:53248
    ds_read_b64_tr_b16 a[54:55], v5 offset:54272
    ds_read_b64_tr_b16 a[56:57], v5 offset:57344
    ds_read_b64_tr_b16 a[58:59], v5 offset:58368
    ds_read_b64_tr_b16 a[60:61], v5 offset:61440
    ds_read_b64_tr_b16 a[62:63], v5 offset:62464
    s_waitcnt vmcnt(8) lgkmcnt(0)
    s_barrier
    s_add_u32 m0, s45, 49152
    s_add_u32 s47, s46, 0x310000
    buffer_load_dwordx4 v3, s[24:27], s47 offen lds
    s_add_u32 m0, s45, 50176
    s_add_u32 s47, s46, 0x317000
    buffer_load_dwordx4 v3, s[24:27], s47 offen lds
    s_add_u32 m0, s45, 51200
    s_add_u32 s47, s46, 0x31e000
    buffer_load_dwordx4 v3, s[24:27], s47 offen lds
    s_add_u32 m0, s45, 52224
    s_add_u32 s47, s46, 0x325000
    buffer_load_dwordx4 v3, s[24:27], s47 offen lds
    ds_read_b64_tr_b16 a[64:65], v5 offset:0
    ds_read_b64_tr_b16 a[66:67], v5 offset:1024
    ds_read_b64_tr_b16 a[68:69], v5 offset:4096
    ds_read_b64_tr_b16 a[70:71], v5 offset:5120
    ds_read_b64_tr_b16 a[72:73], v5 offset:8192
    ds_read_b64_tr_b16 a[74:75], v5 offset:9216
    ds_read_b64_tr_b16 a[76:77], v5 offset:12288
    ds_read_b64_tr_b16 a[78:79], v5 offset:13312
    s_waitcnt vmcnt(8) lgkmcnt(0)
    s_barrier
    ds_read_b64_tr_b16 a[80:81], v5 offset:16384
    ds_read_b64_tr_b16 a[82:83], v5 offset:17408
    ds_read_b64_tr_b16 a[84:85], v5 offset:20480
    ds_read_b64_tr_b16 a[86:87], v5 offset:21504
    ds_read_b64_tr_b16 a[88:89], v5 offset:24576
    ds_read_b64_tr_b16 a[90:91], v5 offset:25600
    ds_read_b64_tr_b16 a[92:93], v5 offset:28672
    ds_read_b64_tr_b16 a[94:95], v5 offset:29696
    s_waitcnt vmcnt(4) lgkmcnt(0)
    s_barrier
    ds_read_b64_tr_b16 a[96:97], v5 offset:32768
    ds_read_b64_tr_b16 a[98:99], v5 offset:33792
    ds_read_b64_tr_b16 a[100:101], v5 offset:36864
    ds_read_b64_tr_b16 a[102:103], v5 offset:37888
    ds_read_b64_tr_b16 a[104:105], v5 offset:40960
    ds_read_b64_tr_b16 a[106:107], v5 offset:41984
    ds_read_b64_tr_b16 a[108:109], v5 offset:45056
    ds_read_b64_tr_b16 a[110:111], v5 offset:46080
    s_waitcnt vmcnt(0) lgkmcnt(0)
    s_barrier
    ds_read_b64_tr_b16 a[112:113], v5 offset:49152
    ds_read_b64_tr_b16 a[114:115], v5 offset:50176
    ds_read_b64_tr_b16 a[116:117], v5 offset:53248
    ds_read_b64_tr_b16 a[118:119], v5 offset:54272
    ds_read_b64_tr_b16 a[120:121], v5 offset:57344
    ds_read_b64_tr_b16 a[122:123], v5 offset:58368
    ds_read_b64_tr_b16 a[124:125], v5 offset:61440
    ds_read_b64_tr_b16 a[126:127], v5 offset:62464
    s_waitcnt lgkmcnt(0)
    s_barrier
    v_lshlrev_b32 v2, 4, v1
    s_mul_i32 s64, s44, 8192
    s_add_u32 s46, s64, 0xc00000
    v_add_u32 v3, s46, v2
    s_mul_i32 s46, s51, 32768
    v_add_u32 v4, s46, v2
    v_and_b32 v6, 15, v1
    v_lshlrev_b32 v6, 4, v6
    v_lshrrev_b32 v7, 4, v1
    v_lshl_add_u32 v6, v7, 9, v6
    s_lshl_b32 s46, s50, 12
    s_add_u32 s46, s46, 131072
    v_add_u32 v5, s46, v2
    v_and_b32 v7, 3, v1
    v_lshlrev_b32 v7, 7, v7
    v_add_u32 v7, 0x10ec00, v7
    s_lshl_b32 s46, s49, 13
    s_lshl_b32 s47, s50, 11
    s_add_u32 s46, s46, s47
    s_add_u32 s46, s46, 0x6000000
    v_add_u32 v8, s46, v2
    s_lshl_b32 s52, s49, 7
    s_add_u32 s52, s52, 0x106400
    s_add_u32 s52, s52, s76
    s_mov_b32 s28, s6
    s_and_b32 s29, s7, 0xffff
    s_mov_b32 s30, 0x1c00
    s_mov_b32 s31, 0x00020000
    s_lshl_b32 s46, s49, 8
    s_lshl_b32 s47, s50, 6
    s_add_u32 s46, s46, s47
    v_lshrrev_b32 v9, 5, v1
    v_lshlrev_b32 v9, 3, v9
    buffer_load_dwordx2 v[32:33], v9, s[28:31], s46 offen offset:0
    buffer_load_dwordx2 v[34:35], v9, s[28:31], s46 offen offset:16
    buffer_load_dwordx2 v[36:37], v9, s[28:31], s46 offen offset:32
    buffer_load_dwordx2 v[38:39], v9, s[28:31], s46 offen offset:48
    v_add_u32 v9, 1024, v8
    s_mov_b32 s56, 0xbdd2d3e8
    s_mov_b32 s57, 0xbdd2d3e8
    v_mov_b32 v112, 0xc0135761
    s_waitcnt vmcnt(0)
    v_lshlrev_b32 v64, 16, v32
    v_and_b32 v65, 0xffff0000, v32
    v_lshlrev_b32 v66, 16, v33
    v_and_b32 v67, 0xffff0000, v33
    v_lshlrev_b32 v68, 16, v34
    v_and_b32 v69, 0xffff0000, v34
    v_lshlrev_b32 v70, 16, v35
    v_and_b32 v71, 0xffff0000, v35
    v_lshlrev_b32 v72, 16, v36
    v_and_b32 v73, 0xffff0000, v36
    v_lshlrev_b32 v74, 16, v37
    v_and_b32 v75, 0xffff0000, v37
    v_lshlrev_b32 v76, 16, v38
    v_and_b32 v77, 0xffff0000, v38
    v_lshlrev_b32 v78, 16, v39
    v_and_b32 v79, 0xffff0000, v39
    s_mul_i32 s46, s43, 8192
    s_add_u32 s46, s46, 0xc00000
    s_mul_i32 s47, s42, 0
    s_add_u32 s46, s46, s47
    v_min_u32 v116, 63, v1
    v_lshlrev_b32 v116, 7, v116
    v_add_u32 v116, s46, v116
    s_mov_b32 s60, s74
    s_mul_i32 s61, s74, 65536
    s_mov_b32 s62, s74
    s_mul_i32 s63, s74, 229376
    s_mov_b32 s67, 0
    s_mov_b32 s68, 3
    s_mov_b32 s71, 0
    v_mov_b32 v15, 147456
    v_mov_b32 v14, 0
    ds_write_b32 v15, v14 offset:4
    ds_write_b32 v15, v14 offset:12
    ds_write_b32 v15, v14 offset:16
    v_mov_b32 v114, 1
    v_mov_b32 v115, 0
    v_lshrrev_b32 v113, 4, v1
    s_mov_b32 s72, 0
L_g_restart_86:
    s_cmp_lg_u32 s44, 0
    s_cbranch_scc1 L_g_nsp_87
    s_mov_b32 s70, 0
L_g_sp_93:
    s_add_u32 s54, s60, 0
    v_add_u32 v12, s54, v113
    v_mul_u32_u24 v13, 171, v12
    v_lshrrev_b32 v13, 9, v13
    v_mad_i32_i24 v13, v13, -3, v12
    v_lshl_add_u32 v13, v13, 9, v7
    buffer_load_dword v11, v13, s[12:15], 0 offen sc1
    s_waitcnt vmcnt(0)
    v_cmp_ge_u32 vcc, v12, v11
    s_add_u32 s70, s70, 1
    s_and_b32 s46, vcc_lo, 0xffff
    s_cbranch_scc0 L_g_sp_93_ok
    s_sleep 3
    s_cmp_lt_u32 s70, 524288
    s_cbranch_scc1 L_g_sp_93
    s_branch L_c_done_1
L_g_sp_93_ok:
    v_cmp_ge_u32 vcc, v12, v11
    s_nop 0
    s_ff1_i32_b64 s46, vcc
    s_lshr_b32 s46, s46, 4
    s_min_u32 s46, s46, 4
    s_add_u32 s46, s46, s54
    s_min_u32 s46, s46, s75
    v_mov_b32 v11, s46
    ds_write_b32 v15, v11 offset:0
L_g_nsp_87:
    s_waitcnt lgkmcnt(0)
    s_barrier
    ds_read_b32 v14, v15 offset:0
    s_waitcnt lgkmcnt(0)
    v_readfirstlane_b32 s66, v14
    s_nop 3
L_g_restart_86_go:
    s_mov_b32 s69, 0
    s_cmp_gt_u32 s62, s60
    s_cbranch_scc1 L_g_nd_94
    s_cmp_ge_u32 s62, s66
    s_cbranch_scc1 L_g_nd_94
    s_add_u32 s47, s61, 4096
    s_add_u32 m0, s64, 0
    s_nop 0
    buffer_load_dwordx4 v3, s[12:15], s61 offen offset:0 sc1 lds
    buffer_load_dwordx4 v3, s[12:15], s61 offen offset:1024 sc1 lds
    buffer_load_dwordx4 v3, s[12:15], s61 offen offset:2048 sc1 lds
    buffer_load_dwordx4 v3, s[12:15], s61 offen offset:3072 sc1 lds
    s_add_u32 m0, s64, 4096
    s_nop 0
    buffer_load_dwordx4 v3, s[12:15], s47 offen offset:0 sc1 lds
    buffer_load_dwordx4 v3, s[12:15], s47 offen offset:1024 sc1 lds
    buffer_load_dwordx4 v3, s[12:15], s47 offen offset:2048 sc1 lds
    buffer_load_dwordx4 v3, s[12:15], s47 offen offset:3072 sc1 lds
    s_add_u32 s61, s61, 65536
    s_add_u32 s62, s62, 1
    s_xor_b32 s64, s64, 0x10000
    s_mov_b32 s69, 1
L_g_nd_94:
    s_cmp_eq_u32 s51, 1
    s_cbranch_scc1 L_g_g1r_88
    s_add_u32 s59, s60, 1
    s_mov_b32 s69, 0
    s_cmp_gt_u32 s62, s59
    s_cbranch_scc1 L_g_nd_95
    s_cmp_ge_u32 s62, s66
    s_cbranch_scc1 L_g_nd_95
    s_add_u32 s47, s61, 4096
    s_add_u32 m0, s64, 0
    s_nop 0
    buffer_load_dwordx4 v3, s[12:15], s61 offen offset:0 sc1 lds
    buffer_load_dwordx4 v3, s[12:15], s61 offen offset:1024 sc1 lds
    buffer_load_dwordx4 v3, s[12:15], s61 offen offset:2048 sc1 lds
    buffer_load_dwordx4 v3, s[12:15], s61 offen offset:3072 sc1 lds
    s_add_u32 m0, s64, 4096
    s_nop 0
    buffer_load_dwordx4 v3, s[12:15], s47 offen offset:0 sc1 lds
    buffer_load_dwordx4 v3, s[12:15], s47 offen offset:1024 sc1 lds
    buffer_load_dwordx4 v3, s[12:15], s47 offen offset:2048 sc1 lds
    buffer_load_dwordx4 v3, s[12:15], s47 offen offset:3072 sc1 lds
    s_add_u32 s61, s61, 65536
    s_add_u32 s62, s62, 1
    s_xor_b32 s64, s64, 0x10000
    s_mov_b32 s69, 1
L_g_nd_95:
    s_cmp_eq_u32 s69, 1
    s_cbranch_scc1 L_g_w0_96
    s_waitcnt vmcnt(0)
L_g_w0_96:
    s_waitcnt vmcnt(8)
    s_cmp_lg_u32 s44, 0
    s_cbranch_scc1 L_g_nl_97
    s_add_u32 s54, s60, 1
    v_add_u32 v12, s54, v113
    v_mul_u32_u24 v13, 171, v12
    v_lshrrev_b32 v13, 9, v13
    v_mad_i32_i24 v13, v13, -3, v12
    v_lshl_add_u32 v13, v13, 9, v7
    buffer_load_dword v11, v13, s[12:15], 0 offen sc1
L_g_nl_97:
L_g_loop0_89_l:
    s_barrier
    ds_read_b128 v[32:35], v4 offset:0
    ds_read_b128 v[36:39], v4 offset:1024
    ds_read_b128 v[40:43], v4 offset:2048
    ds_read_b128 v[44:47], v4 offset:3072
    ds_read_b128 v[48:51], v4 offset:4096
    ds_read_b128 v[52:55], v4 offset:5120
    ds_read_b128 v[56:59], v4 offset:6144
    ds_read_b128 v[60:63], v4 offset:7168
    s_branch L_g_loop0_89_m
.p2align 6
L_g_loop0_89:
    s_barrier
L_g_loop0_89_m:
    s_setprio 2
    s_waitcnt lgkmcnt(6)
    v_mfma_f32_32x32x16_bf16 v[16:31], a[0:3], v[32:35], v[64:79]
    ds_read_b128 v[32:35], v4 offset:8192
    ds_read_b32 v14, v15
    v_mfma_f32_32x32x16_bf16 v[16:31], a[4:7], v[36:39], v[16:31]
    ds_read_b128 v[36:39], v4 offset:9216
    s_waitcnt lgkmcnt(6)
    v_mfma_f32_32x32x16_bf16 v[16:31], a[8:11], v[40:43], v[16:31]
    ds_read_b128 v[40:43], v4 offset:10240
    v_mfma_f32_32x32x16_bf16 v[16:31], a[12:15], v[44:47], v[16:31]
    ds_read_b128 v[44:47], v4 offset:11264
    s_waitcnt lgkmcnt(6)
    v_mfma_f32_32x32x16_bf16 v[16:31], a[16:19], v[48:51], v[16:31]
    ds_read_b128 v[48:51], v4 offset:12288
    v_mfma_f32_32x32x16_bf16 v[16:31], a[20:23], v[52:55], v[16:31]
    ds_read_b128 v[52:55], v4 offset:13312
    s_waitcnt lgkmcnt(6)
    v_mfma_f32_32x32x16_bf16 v[16:31], a[24:27], v[56:59], v[16:31]
    ds_read_b128 v[56:59], v4 offset:14336
    v_mfma_f32_32x32x16_bf16 v[16:31], a[28:31], v[60:63], v[16:31]
    ds_read_b128 v[60:63], v4 offset:15360
    s_waitcnt lgkmcnt(6)
    v_mfma_f32_32x32x16_bf16 v[16:31], a[32:35], v[32:35], v[16:31]
    ds_read_b128 v[32:35], v4 offset:16384
    v_mfma_f32_32x32x16_bf16 v[16:31], a[36:39], v[36:39], v[16:31]
    ds_read_b128 v[36:39], v4 offset:17408
    s_waitcnt lgkmcnt(6)
    v_mfma_f32_32x32x16_bf16 v[16:31], a[40:43], v[40:43], v[16:31]
    ds_read_b128 v[40:43], v4 offset:18432
    v_mfma_f32_32x32x16_bf16 v[16:31], a[44:47], v[44:47], v[16:31]
    ds_read_b128 v[44:47], v4 offset:19456
    s_waitcnt lgkmcnt(6)
    v_mfma_f32_32x32x16_bf16 v[16:31], a[48:51], v[48:51], v[16:31]
    ds_read_b128 v[48:51], v4 offset:20480
    v_mfma_f32_32x32x16_bf16 v[16:31], a[52:55], v[52:55], v[16:31]
    ds_read_b128 v[52:55], v4 offset:21504
    s_waitcnt lgkmcnt(6)
    v_mfma_f32_32x32x16_bf16 v[16:31], a[56:59], v[56:59], v[16:31]
    ds_read_b128 v[56:59], v4 offset:22528
    v_mfma_f32_32x32x16_bf16 v[16:31], a[60:63], v[60:63], v[16:31]
    ds_read_b128 v[60:63], v4 offset:23552
    s_waitcnt lgkmcnt(6)
    v_mfma_f32_32x32x16_bf16 v[16:31], a[64:67], v[32:35], v[16:31]
    ds_read_b128 v[32:35], v4 offset:24576
    v_mfma_f32_32x32x16_bf16 v[16:31], a[68:71], v[36:39], v[16:31]
    ds_read_b128 v[36:39], v4 offset:25600
    s_waitcnt lgkmcnt(6)
    v_mfma_f32_32x32x16_bf16 v[16:31], a[72:75], v[40:43], v[16:31]
    ds_read_b128 v[40:43], v4 offset:26624
    v_mfma_f32_32x32x16_bf16 v[16:31], a[76:79], v[44:47], v[16:31]
    ds_read_b128 v[44:47], v4 offset:27648
    s_waitcnt lgkmcnt(6)
    v_mfma_f32_32x32x16_bf16 v[16:31], a[80:83], v[48:51], v[16:31]
    ds_read_b128 v[48:51], v4 offset:28672
    v_mfma_f32_32x32x16_bf16 v[16:31], a[84:87], v[52:55], v[16:31]
    ds_read_b128 v[52:55], v4 offset:29696
    s_waitcnt lgkmcnt(6)
    v_mfma_f32_32x32x16_bf16 v[16:31], a[88:91], v[56:59], v[16:31]
    ds_read_b128 v[56:59], v4 offset:30720
    v_mfma_f32_32x32x16_bf16 v[16:31], a[92:95], v[60:63], v[16:31]
    ds_read_b128 v[60:63], v4 offset:31744
    s_waitcnt lgkmcnt(6)
    v_mfma_f32_32x32x16_bf16 v[16:31], a[96:99], v[32:35], v[16:31]
    v_mfma_f32_32x32x16_bf16 v[16:31], a[100:103], v[36:39], v[16:31]
    s_waitcnt lgkmcnt(4)
    v_mfma_f32_32x32x16_bf16 v[16:31], a[104:107], v[40:43], v[16:31]
    v_mfma_f32_32x32x16_bf16 v[16:31], a[108:111], v[44:47], v[16:31]
    s_waitcnt lgkmcnt(2)
    v_mfma_f32_32x32x16_bf16 v[16:31], a[112:115], v[48:51], v[16:31]
    v_mfma_f32_32x32x16_bf16 v[16:31], a[116:119], v[52:55], v[16:31]
    s_waitcnt lgkmcnt(0)
    v_mfma_f32_32x32x16_bf16 v[16:31], a[120:123], v[56:59], v[16:31]
    v_mfma_f32_32x32x16_bf16 v[16:31], a[124:127], v[60:63], v[16:31]
    v_xor_b32 v4, 0x10000, v4
    s_setprio 0
    s_waitcnt vmcnt(0)
    v_readfirstlane_b32 s66, v14
    s_barrier
    s_nop 6
    ds_write_b128 v5, v[16:19] offset:0
    ds_write_b128 v5, v[20:23] offset:1024
    ds_write_b128 v5, v[24:27] offset:2048
    ds_write_b128 v5, v[28:31] offset:3072
    s_cmp_lg_u32 s44, 0
    s_cbranch_scc1 L_g_ne_98
    v_cmp_ge_u32 vcc, v12, v11
    s_nop 0
    s_ff1_i32_b64 s46, vcc
    s_lshr_b32 s46, s46, 4
    s_min_u32 s46, s46, 4
    s_add_u32 s46, s46, s54
    s_min_u32 s46, s46, s75
    v_mov_b32 v11, s46
    ds_write_b32 v15, v11 offset:0
L_g_ne_98:
    s_add_u32 s60, s60, 1
    s_mov_b32 s65, 0
    s_cmp_le_u32 s62, s60
    s_cbranch_scc1 L_g_dp_101_l
L_g_dp_101_a:
    s_cmp_ge_u32 s62, s66
    s_cbranch_scc1 L_g_dp_101_d
    s_add_u32 s47, s61, 4096
    s_mov_b32 m0, s64
    s_add_u32 s62, s62, 1
    buffer_load_dwordx4 v3, s[12:15], s61 offen offset:0 sc1 lds
    buffer_load_dwordx4 v3, s[12:15], s61 offen offset:1024 sc1 lds
    buffer_load_dwordx4 v3, s[12:15], s61 offen offset:2048 sc1 lds
    buffer_load_dwordx4 v3, s[12:15], s61 offen offset:3072 sc1 lds
    s_add_u32 m0, s64, 4096
    s_add_u32 s61, s61, 65536
    buffer_load_dwordx4 v3, s[12:15], s47 offen offset:0 sc1 lds
    buffer_load_dwordx4 v3, s[12:15], s47 offen offset:1024 sc1 lds
    buffer_load_dwordx4 v3, s[12:15], s47 offen offset:2048 sc1 lds
    buffer_load_dwordx4 v3, s[12:15], s47 offen offset:3072 sc1 lds
    s_xor_b32 s64, s64, 0x10000
L_g_dp_101_d:
    s_cmp_lg_u32 s44, 2
    s_cbranch_scc1 L_g_pf_102
    s_cmp_ge_u32 s62, s66
    s_cbranch_scc1 L_g_pf_102
    buffer_load_dword v117, v116, s[12:15], s61 offen sc1
L_g_pf_102:
    s_cmp_le_u32 s66, s60
    s_cbranch_scc1 L_g_ex0_100
    s_cmp_lg_u32 s65, 0
    s_cbranch_scc1 L_g_nw_99
    ds_read_b128 v[32:35], v4 offset:0
    ds_read_b128 v[36:39], v4 offset:1024
    ds_read_b128 v[40:43], v4 offset:2048
    ds_read_b128 v[44:47], v4 offset:3072
    ds_read_b128 v[48:51], v4 offset:4096
    ds_read_b128 v[52:55], v4 offset:5120
    ds_read_b128 v[56:59], v4 offset:6144
    ds_read_b128 v[60:63], v4 offset:7168
    s_cmp_lg_u32 s44, 0
    s_cbranch_scc1 L_g_nl_103
    s_add_u32 s54, s60, 1
    v_add_u32 v12, s54, v113
    v_mul_u32_u24 v13, 171, v12
    v_lshrrev_b32 v13, 9, v13
    v_mad_i32_i24 v13, v13, -3, v12
    v_lshl_add_u32 v13, v13, 9, v7
    buffer_load_dword v11, v13, s[12:15], 0 offen sc1
L_g_nl_103:
    s_waitcnt lgkmcnt(8)
    s_branch L_g_loop0_89
L_g_ex0_100:
    s_cmp_lg_u32 s44, 0
    s_cbranch_scc1 L_g_ex0_100_n
    s_sleep 6
    s_add_u32 s54, s60, 0
    v_add_u32 v12, s54, v113
    v_mul_u32_u24 v13, 171, v12
    v_lshrrev_b32 v13, 9, v13
    v_mad_i32_i24 v13, v13, -3, v12
    v_lshl_add_u32 v13, v13, 9, v7
    buffer_load_dword v11, v13, s[12:15], 0 offen sc1
    s_waitcnt vmcnt(0)
    v_cmp_ge_u32 vcc, v12, v11
    s_nop 0
    s_ff1_i32_b64 s46, vcc
    s_lshr_b32 s46, s46, 4
    s_min_u32 s46, s46, 4
    s_add_u32 s46, s46, s54
    s_min_u32 s46, s46, s75
    v_mov_b32 v11, s46
    ds_write_b32 v15, v11 offset:0
L_g_ex0_100_n:
    s_waitcnt lgkmcnt(0)
    s_barrier
    ds_read_b32 v14, v15 offset:0
    s_waitcnt lgkmcnt(0)
    v_readfirstlane_b32 s66, v14
    s_barrier
    s_cmp_gt_u32 s66, s60
    s_cbranch_scc1 L_g_restart_86_go
    s_branch L_g_tail_91
L_g_g1r_88:
    s_mov_b32 s65, 1
    s_branch L_g_loop1_90_e
.p2align 6
L_g_loop1_90:
    s_mov_b32 s65, 0
L_g_loop1_90_e:
    s_barrier
    ds_read_b32 v14, v15
    s_bitcmp1_b32 s67, 2
    s_cbranch_scc0 L_g_nfl_104
    s_cmp_lg_u32 s44, 4
    s_cbranch_scc1 L_g_nfl_104_d
    s_sub_u32 s59, s60, 2
    v_mov_b32 v10, s59
    buffer_store_dword v10, v115, s[12:15], s52 offen sc1
L_g_nfl_104_d:
    s_waitcnt lgkmcnt(0)
    v_readfirstlane_b32 s66, v14
    ds_read_b128 v[80:83], v5 offset:0
    ds_read_b128 v[84:87], v5 offset:1024
    ds_read_b128 v[88:91], v5 offset:2048
    ds_read_b128 v[92:95], v5 offset:3072
    s_cmp_le_u32 s62, s60
    s_cbranch_scc1 L_g_dp_109_l
L_g_dp_109_a:
    s_cmp_ge_u32 s62, s66
    s_cbranch_scc1 L_g_dp_109_d
    s_add_u32 s47, s61, 4096
    s_mov_b32 m0, s64
    s_add_u32 s62, s62, 1
    buffer_load_dwordx4 v3, s[12:15], s61 offen offset:0 sc1 lds
    buffer_load_dwordx4 v3, s[12:15], s61 offen offset:1024 sc1 lds
    buffer_load_dwordx4 v3, s[12:15], s61 offen offset:2048 sc1 lds
    buffer_load_dwordx4 v3, s[12:15], s61 offen offset:3072 sc1 lds
    s_add_u32 m0, s64, 4096
    s_add_u32 s61, s61, 65536
    buffer_load_dwordx4 v3, s[12:15], s47 offen offset:0 sc1 lds
    buffer_load_dwordx4 v3, s[12:15], s47 offen offset:1024 sc1 lds
    buffer_load_dwordx4 v3, s[12:15], s47 offen offset:2048 sc1 lds
    buffer_load_dwordx4 v3, s[12:15], s47 offen offset:3072 sc1 lds
    s_xor_b32 s64, s64, 0x10000
L_g_dp_109_d:
    s_bitcmp1_b32 s67, 0
    s_cbranch_scc0 L_g_nep_105
    s_waitcnt lgkmcnt(0)
    v_add_f32 v80, v80, v16
    v_add_f32 v81, v81, v17
    v_add_f32 v82, v82, v18
    v_add_f32 v83, v83, v19
    v_add_f32 v84, v84, v20
    v_add_f32 v85, v85, v21
    v_add_f32 v86, v86, v22
    v_add_f32 v87, v87, v23
    v_add_f32 v88, v88, v24
    v_add_f32 v89, v89, v25
    v_add_f32 v90, v90, v26
    v_add_f32 v91, v91, v27
    v_add_f32 v92, v92, v28
    v_add_f32 v93, v93, v29
    v_add_f32 v94, v94, v30
    v_add_f32 v95, v95, v31
L_g_nep_105:
    v_mul_f32 v96, v80, v80
    v_mul_f32 v97, v81, v81
    v_mul_f32 v98, v82, v82
    v_mul_f32 v99, v83, v83
    v_mul_f32 v100, v84, v84
    v_mul_f32 v101, v85, v85
    v_mul_f32 v102, v86, v86
    v_mul_f32 v103, v87, v87
    v_fma_f32 v96, v96, s56, v112
    v_fma_f32 v97, v97, s56, v112
    v_fma_f32 v98, v98, s56, v112
    v_fma_f32 v99, v99, s56, v112
    v_fma_f32 v100, v100, s56, v112
    v_fma_f32 v101, v101, s56, v112
    v_fma_f32 v102, v102, s56, v112
    v_fma_f32 v103, v103, s56, v112
    v_mul_f32 v96, v96, v80
    v_mul_f32 v97, v97, v81
    v_mul_f32 v98, v98, v82
    v_mul_f32 v99, v99, v83
    v_mul_f32 v100, v100, v84
    v_mul_f32 v101, v101, v85
    v_mul_f32 v102, v102, v86
    v_mul_f32 v103, v103, v87
    v_exp_f32 v96, v96
    v_exp_f32 v97, v97
    v_exp_f32 v98, v98
    v_exp_f32 v99, v99
    v_exp_f32 v100, v100
    v_exp_f32 v101, v101
    v_exp_f32 v102, v102
    v_exp_f32 v103, v103
    v_add_f32 v96, 1.0, v96
    v_add_f32 v97, 1.0, v97
    v_add_f32 v98, 1.0, v98
    v_add_f32 v99, 1.0, v99
    v_add_f32 v100, 1.0, v100
    v_add_f32 v101, 1.0, v101
    v_add_f32 v102, 1.0, v102
    v_add_f32 v103, 1.0, v103
    v_rcp_f32 v96, v96
    v_rcp_f32 v97, v97
    v_rcp_f32 v98, v98
    v_rcp_f32 v99, v99
    v_rcp_f32 v100, v100
    v_rcp_f32 v101, v101
    v_rcp_f32 v102, v102
    v_rcp_f32 v103, v103
    v_mul_f32 v80, v80, v96
    v_mul_f32 v81, v81, v97
    s_cmp_lg_u32 s65, 0
    s_cbranch_scc1 L_g_nw1_106
    ds_read_b128 v[32:35], v4 offset:0
    ds_read_b128 v[36:39], v4 offset:1024
    ds_read_b128 v[40:43], v4 offset:2048
    ds_read_b128 v[44:47], v4 offset:3072
    ds_read_b128 v[48:51], v4 offset:4096
    ds_read_b128 v[52:55], v4 offset:5120
    ds_read_b128 v[56:59], v4 offset:6144
    ds_read_b128 v[60:63], v4 offset:7168
    s_barrier
L_g_jn_108:
    s_bitcmp1_b32 s67, 0
    s_cbranch_scc0 L_g_mm2_107
    s_setprio 1
    s_waitcnt lgkmcnt(6)
    v_mfma_f32_32x32x16_bf16 v[16:31], a[0:3], v[32:35], 0
    ds_read_b128 v[32:35], v4 offset:8192
    v_mul_f32 v82, v82, v98
    v_mul_f32 v83, v83, v99
    v_mul_f32 v84, v84, v100
    v_mul_f32 v85, v85, v101
    v_mfma_f32_32x32x16_bf16 v[16:31], a[4:7], v[36:39], v[16:31]
    ds_read_b128 v[36:39], v4 offset:9216
    v_mul_f32 v86, v86, v102
    v_mul_f32 v87, v87, v103
    v_cvt_pk_bf16_f32 v104, v80, v81
    v_cvt_pk_bf16_f32 v105, v82, v83
    s_waitcnt lgkmcnt(6)
    v_mfma_f32_32x32x16_bf16 v[16:31], a[8:11], v[40:43], v[16:31]
    ds_read_b128 v[40:43], v4 offset:10240
    v_cvt_pk_bf16_f32 v106, v84, v85
    v_cvt_pk_bf16_f32 v107, v86, v87
    buffer_store_dwordx4 v[104:107], v8, s[12:15], s63 offen sc1
    v_mul_f32 v96, v88, v88
    v_mfma_f32_32x32x16_bf16 v[16:31], a[12:15], v[44:47], v[16:31]
    ds_read_b128 v[44:47], v4 offset:11264
    v_mul_f32 v97, v89, v89
    v_mul_f32 v98, v90, v90
    v_mul_f32 v99, v91, v91
    v_mul_f32 v100, v92, v92
    s_waitcnt lgkmcnt(6)
    v_mfma_f32_32x32x16_bf16 v[16:31], a[16:19], v[48:51], v[16:31]
    ds_read_b128 v[48:51], v4 offset:12288
    v_mul_f32 v101, v93, v93
    v_mul_f32 v102, v94, v94
    v_mul_f32 v103, v95, v95
    v_fma_f32 v96, v96, s56, v112
    v_mfma_f32_32x32x16_bf16 v[16:31], a[20:23], v[52:55], v[16:31]
    ds_read_b128 v[52:55], v4 offset:13312
    v_fma_f32 v97, v97, s56, v112
    v_fma_f32 v98, v98, s56, v112
    v_fma_f32 v99, v99, s56, v112
    v_fma_f32 v100, v100, s56, v112
    s_waitcnt lgkmcnt(6)
    v_mfma_f32_32x32x16_bf16 v[16:31], a[24:27], v[56:59], v[16:31]
    ds_read_b128 v[56:59], v4 offset:14336
    v_fma_f32 v101, v101, s56, v112
    v_fma_f32 v102, v102, s56, v112
    v_fma_f32 v103, v103, s56, v112
    v_mul_f32 v96, v96, v88
    v_mfma_f32_32x32x16_bf16 v[16:31], a[28:31], v[60:63], v[16:31]
    ds_read_b128 v[60:63], v4 offset:15360
    v_mul_f32 v97, v97, v89
    v_mul_f32 v98, v98, v90
    v_mul_f32 v99, v99, v91
    v_mul_f32 v100, v100, v92
    s_waitcnt lgkmcnt(6)
    v_mfma_f32_32x32x16_bf16 v[16:31], a[32:35], v[32:35], v[16:31]
    ds_read_b128 v[32:35], v4 offset:16384
    v_mul_f32 v101, v101, v93
    v_mul_f32 v102, v102, v94
    v_mul_f32 v103, v103, v95
    v_exp_f32 v96, v96
    v_mfma_f32_32x32x16_bf16 v[16:31], a[36:39], v[36:39], v[16:31]
    ds_read_b128 v[36:39], v4 offset:17408
    v_exp_f32 v97, v97
    v_exp_f32 v98, v98
    s_waitcnt lgkmcnt(6)
    v_mfma_f32_32x32x16_bf16 v[16:31], a[40:43], v[40:43], v[16:31]
    ds_read_b128 v[40:43], v4 offset:18432
    v_exp_f32 v99, v99
    v_exp_f32 v100, v100
    v_mfma_f32_32x32x16_bf16 v[16:31], a[44:47], v[44:47], v[16:31]
    ds_read_b128 v[44:47], v4 offset:19456
    v_exp_f32 v101, v101
    v_exp_f32 v102, v102
    s_waitcnt lgkmcnt(6)
    v_mfma_f32_32x32x16_bf16 v[16:31], a[48:51], v[48:51], v[16:31]
    ds_read_b128 v[48:51], v4 offset:20480
    v_exp_f32 v103, v103
    v_add_f32 v96, 1.0, v96
    v_add_f32 v97, 1.0, v97
    v_mfma_f32_32x32x16_bf16 v[16:31], a[52:55], v[52:55], v[16:31]
    ds_read_b128 v[52:55], v4 offset:21504
    v_add_f32 v98, 1.0, v98
    v_add_f32 v99, 1.0, v99
    v_add_f32 v100, 1.0, v100
    v_add_f32 v101, 1.0, v101
    s_waitcnt lgkmcnt(6)
    v_mfma_f32_32x32x16_bf16 v[16:31], a[56:59], v[56:59], v[16:31]
    ds_read_b128 v[56:59], v4 offset:22528
    v_add_f32 v102, 1.0, v102
    v_add_f32 v103, 1.0, v103
    v_rcp_f32 v96, v96
    v_mfma_f32_32x32x16_bf16 v[16:31], a[60:63], v[60:63], v[16:31]
    ds_read_b128 v[60:63], v4 offset:23552
    v_rcp_f32 v97, v97
    v_rcp_f32 v98, v98
    s_waitcnt lgkmcnt(6)
    v_mfma_f32_32x32x16_bf16 v[16:31], a[64:67], v[32:35], v[16:31]
    ds_read_b128 v[32:35], v4 offset:24576
    v_rcp_f32 v99, v99
    v_rcp_f32 v100, v100
    v_mfma_f32_32x32x16_bf16 v[16:31], a[68:71], v[36:39], v[16:31]
    ds_read_b128 v[36:39], v4 offset:25600
    v_rcp_f32 v101, v101
    v_rcp_f32 v102, v102
    s_waitcnt lgkmcnt(6)
    v_mfma_f32_32x32x16_bf16 v[16:31], a[72:75], v[40:43], v[16:31]
    ds_read_b128 v[40:43], v4 offset:26624
    v_rcp_f32 v103, v103
    v_mul_f32 v88, v88, v96
    v_mul_f32 v89, v89, v97
    v_mfma_f32_32x32x16_bf16 v[16:31], a[76:79], v[44:47], v[16:31]
    ds_read_b128 v[44:47], v4 offset:27648
    v_mul_f32 v90, v90, v98
    v_mul_f32 v91, v91, v99
    v_mul_f32 v92, v92, v100
    v_mul_f32 v93, v93, v101
    s_waitcnt lgkmcnt(6)
    v_mfma_f32_32x32x16_bf16 v[16:31], a[80:83], v[48:51], v[16:31]
    ds_read_b128 v[48:51], v4 offset:28672
    v_mul_f32 v94, v94, v102
    v_mul_f32 v95, v95, v103
    v_cvt_pk_bf16_f32 v108, v88, v89
    v_cvt_pk_bf16_f32 v109, v90, v91
    v_mfma_f32_32x32x16_bf16 v[16:31], a[84:87], v[52:55], v[16:31]
    ds_read_b128 v[52:55], v4 offset:29696
    v_cvt_pk_bf16_f32 v110, v92, v93
    v_cvt_pk_bf16_f32 v111, v94, v95
    buffer_store_dwordx4 v[108:111], v9, s[12:15], s63 offen sc1
    s_add_u32 s63, s63, 229376
    s_waitcnt lgkmcnt(6)
    v_mfma_f32_32x32x16_bf16 v[16:31], a[88:91], v[56:59], v[16:31]
    ds_read_b128 v[56:59], v4 offset:30720
    v_mfma_f32_32x32x16_bf16 v[16:31], a[92:95], v[60:63], v[16:31]
    ds_read_b128 v[60:63], v4 offset:31744
    s_waitcnt lgkmcnt(6)
    v_mfma_f32_32x32x16_bf16 v[16:31], a[96:99], v[32:35], v[16:31]
    v_mfma_f32_32x32x16_bf16 v[16:31], a[100:103], v[36:39], v[16:31]
    s_waitcnt lgkmcnt(4)
    v_mfma_f32_32x32x16_bf16 v[16:31], a[104:107], v[40:43], v[16:31]
    v_mfma_f32_32x32x16_bf16 v[16:31], a[108:111], v[44:47], v[16:31]
    s_waitcnt lgkmcnt(2)
    v_mfma_f32_32x32x16_bf16 v[16:31], a[112:115], v[48:51], v[16:31]
    v_mfma_f32_32x32x16_bf16 v[16:31], a[116:119], v[52:55], v[16:31]
    s_waitcnt lgkmcnt(0)
    v_mfma_f32_32x32x16_bf16 v[16:31], a[120:123], v[56:59], v[16:31]
    v_mfma_f32_32x32x16_bf16 v[16:31], a[124:127], v[60:63], v[16:31]
    v_xor_b32 v4, 0x10000, v4
    s_setprio 0
    s_waitcnt vmcnt(2)
L_g_mm2_107_d:
    s_lshl_b32 s67, s67, 1
    s_or_b32 s67, s67, 1
    s_add_u32 s60, s60, 1
    s_cmp_gt_u32 s66, s60
    s_cbranch_scc1 L_g_loop1_90
    s_barrier
    ds_read_b32 v14, v15 offset:0
    s_waitcnt lgkmcnt(0)
    v_readfirstlane_b32 s66, v14
    s_barrier
    s_mov_b32 s69, 0
    s_cmp_gt_u32 s62, s60
    s_cbranch_scc1 L_g_nd_110
    s_cmp_ge_u32 s62, s66
    s_cbranch_scc1 L_g_nd_110
    s_add_u32 s47, s61, 4096
    s_add_u32 m0, s64, 0
    s_nop 0
    buffer_load_dwordx4 v3, s[12:15], s61 offen offset:0 sc1 lds
    buffer_load_dwordx4 v3, s[12:15], s61 offen offset:1024 sc1 lds
    buffer_load_dwordx4 v3, s[12:15], s61 offen offset:2048 sc1 lds
    buffer_load_dwordx4 v3, s[12:15], s61 offen offset:3072 sc1 lds
    s_add_u32 m0, s64, 4096
    s_nop 0
    buffer_load_dwordx4 v3, s[12:15], s47 offen offset:0 sc1 lds
    buffer_load_dwordx4 v3, s[12:15], s47 offen offset:1024 sc1 lds
    buffer_load_dwordx4 v3, s[12:15], s47 offen offset:2048 sc1 lds
    buffer_load_dwordx4 v3, s[12:15], s47 offen offset:3072 sc1 lds
    s_add_u32 s61, s61, 65536
    s_add_u32 s62, s62, 1
    s_xor_b32 s64, s64, 0x10000
    s_mov_b32 s69, 1
L_g_nd_110:
    s_sub_u32 s59, s60, 1
    ds_read_b128 v[80:83], v5 offset:0
    ds_read_b128 v[84:87], v5 offset:1024
    ds_read_b128 v[88:91], v5 offset:2048
    ds_read_b128 v[92:95], v5 offset:3072
    s_nop 7
    s_waitcnt lgkmcnt(3)
    v_add_f32 v80, v80, v16
    v_add_f32 v81, v81, v17
    v_add_f32 v82, v82, v18
    v_add_f32 v83, v83, v19
    s_waitcnt lgkmcnt(2)
    v_add_f32 v84, v84, v20
    v_add_f32 v85, v85, v21
    v_add_f32 v86, v86, v22
    v_add_f32 v87, v87, v23
    s_waitcnt lgkmcnt(1)
    v_add_f32 v88, v88, v24
    v_add_f32 v89, v89, v25
    v_add_f32 v90, v90, v26
    v_add_f32 v91, v91, v27
    s_waitcnt lgkmcnt(0)
    v_add_f32 v92, v92, v28
    v_add_f32 v93, v93, v29
    v_add_f32 v94, v94, v30
    v_add_f32 v95, v95, v31
    v_mul_f32 v96, v80, v80
    v_mul_f32 v97, v81, v81
    v_mul_f32 v98, v82, v82
    v_mul_f32 v99, v83, v83
    v_mul_f32 v100, v84, v84
    v_mul_f32 v101, v85, v85
    v_mul_f32 v102, v86, v86
    v_mul_f32 v103, v87, v87
    v_fma_f32 v96, v96, s56, v112
    v_fma_f32 v97, v97, s56, v112
    v_fma_f32 v98, v98, s56, v112
    v_fma_f32 v99, v99, s56, v112
    v_fma_f32 v100, v100, s56, v112
    v_fma_f32 v101, v101, s56, v112
    v_fma_f32 v102, v102, s56, v112
    v_fma_f32 v103, v103, s56, v112
    v_mul_f32 v96, v96, v80
    v_mul_f32 v97, v97, v81
    v_mul_f32 v98, v98, v82
    v_mul_f32 v99, v99, v83
    v_mul_f32 v100, v100, v84
    v_mul_f32 v101, v101, v85
    v_mul_f32 v102, v102, v86
    v_mul_f32 v103, v103, v87
    v_exp_f32 v96, v96
    v_exp_f32 v97, v97
    v_exp_f32 v98, v98
    v_exp_f32 v99, v99
    v_exp_f32 v100, v100
    v_exp_f32 v101, v101
    v_exp_f32 v102, v102
    v_exp_f32 v103, v103
    v_add_f32 v96, 1.0, v96
    v_add_f32 v97, 1.0, v97
    v_add_f32 v98, 1.0, v98
    v_add_f32 v99, 1.0, v99
    v_add_f32 v100, 1.0, v100
    v_add_f32 v101, 1.0, v101
    v_add_f32 v102, 1.0, v102
    v_add_f32 v103, 1.0, v103
    v_rcp_f32 v96, v96
    v_rcp_f32 v97, v97
    v_rcp_f32 v98, v98
    v_rcp_f32 v99, v99
    v_rcp_f32 v100, v100
    v_rcp_f32 v101, v101
    v_rcp_f32 v102, v102
    v_rcp_f32 v103, v103
    v_mul_f32 v80, v80, v96
    v_mul_f32 v81, v81, v97
    v_mul_f32 v82, v82, v98
    v_mul_f32 v83, v83, v99
    v_mul_f32 v84, v84, v100
    v_mul_f32 v85, v85, v101
    v_mul_f32 v86, v86, v102
    v_mul_f32 v87, v87, v103
    v_cvt_pk_bf16_f32 v104, v80, v81
    v_cvt_pk_bf16_f32 v105, v82, v83
    v_cvt_pk_bf16_f32 v106, v84, v85
    v_cvt_pk_bf16_f32 v107, v86, v87
    buffer_store_dwordx4 v[104:107], v8, s[12:15], s63 offen sc1
    v_mul_f32 v96, v88, v88
    v_mul_f32 v97, v89, v89
    v_mul_f32 v98, v90, v90
    v_mul_f32 v99, v91, v91
    v_mul_f32 v100, v92, v92
    v_mul_f32 v101, v93, v93
    v_mul_f32 v102, v94, v94
    v_mul_f32 v103, v95, v95
    v_fma_f32 v96, v96, s56, v112
    v_fma_f32 v97, v97, s56, v112
    v_fma_f32 v98, v98, s56, v112
    v_fma_f32 v99, v99, s56, v112
    v_fma_f32 v100, v100, s56, v112
    v_fma_f32 v101, v101, s56, v112
    v_fma_f32 v102, v102, s56, v112
    v_fma_f32 v103, v103, s56, v112
    v_mul_f32 v96, v96, v88
    v_mul_f32 v97, v97, v89
    v_mul_f32 v98, v98, v90
    v_mul_f32 v99, v99, v91
    v_mul_f32 v100, v100, v92
    v_mul_f32 v101, v101, v93
    v_mul_f32 v102, v102, v94
    v_mul_f32 v103, v103, v95
    v_exp_f32 v96, v96
    v_exp_f32 v97, v97
    v_exp_f32 v98, v98
    v_exp_f32 v99, v99
    v_exp_f32 v100, v100
    v_exp_f32 v101, v101
    v_exp_f32 v102, v102
    v_exp_f32 v103, v103
    v_add_f32 v96, 1.0, v96
    v_add_f32 v97, 1.0, v97
    v_add_f32 v98, 1.0, v98
    v_add_f32 v99, 1.0, v99
    v_add_f32 v100, 1.0, v100
    v_add_f32 v101, 1.0, v101
    v_add_f32 v102, 1.0, v102
    v_add_f32 v103, 1.0, v103
    v_rcp_f32 v96, v96
    v_rcp_f32 v97, v97
    v_rcp_f32 v98, v98
    v_rcp_f32 v99, v99
    v_rcp_f32 v100, v100
    v_rcp_f32 v101, v101
    v_rcp_f32 v102, v102
    v_rcp_f32 v103, v103
    v_mul_f32 v88, v88, v96
    v_mul_f32 v89, v89, v97
    v_mul_f32 v90, v90, v98
    v_mul_f32 v91, v91, v99
    v_mul_f32 v92, v92, v100
    v_mul_f32 v93, v93, v101
    v_mul_f32 v94, v94, v102
    v_mul_f32 v95, v95, v103
    v_cvt_pk_bf16_f32 v108, v88, v89
    v_cvt_pk_bf16_f32 v109, v90, v91
    v_cvt_pk_bf16_f32 v110, v92, v93
    v_cvt_pk_bf16_f32 v111, v94, v95
    buffer_store_dwordx4 v[108:111], v9, s[12:15], s63 offen sc1
    s_add_u32 s63, s63, 229376
    s_mov_b32 s67, 0
    s_mov_b32 s71, 1
    s_cmp_gt_u32 s66, s60
    s_cbranch_scc1 L_g_g1r_88
    v_mov_b32 v10, 1
    s_mov_b64 exec, 1
    s_waitcnt vmcnt(0)
    ds_add_rtn_u32 v10, v15, v10 offset:4
    s_waitcnt lgkmcnt(0)
    v_readfirstlane_b32 s46, v10
    s_mov_b64 exec, -1
    s_mov_b32 s71, 0
    s_sub_u32 s59, s60, 1
    s_cmp_lg_u32 s46, s68
    s_cbranch_scc1 L_g_df_111
    v_mov_b32 v10, s59
    v_add_u32 v10, 1, v10
    v_mov_b32 v11, 0
    s_mov_b64 exec, 1
    buffer_store_dword v10, v11, s[12:15], s52 offen sc1
    s_mov_b64 exec, -1
L_sf_112:
L_g_df_111:
    s_add_u32 s68, s68, 4
    s_cmp_gt_u32 s66, s60
    s_cbranch_scc1 L_g_g1r_88
L_g_tail_91:
    s_cmp_lt_u32 s60, s75
    s_cbranch_scc1 L_g_restart_86
    s_waitcnt vmcnt(0)
    s_barrier
    s_branch L_w_f1_14_d
L_g_dp_101_l:
    s_cmp_ge_u32 s62, s66
    s_cbranch_scc1 L_g_dp_101_d
    s_mov_b32 s65, 1
    s_add_u32 s47, s61, 4096
    s_mov_b32 m0, s64
    s_add_u32 s62, s62, 1
    buffer_load_dwordx4 v3, s[12:15], s61 offen offset:0 sc1 lds
    buffer_load_dwordx4 v3, s[12:15], s61 offen offset:1024 sc1 lds
    buffer_load_dwordx4 v3, s[12:15], s61 offen offset:2048 sc1 lds
    buffer_load_dwordx4 v3, s[12:15], s61 offen offset:3072 sc1 lds
    s_add_u32 m0, s64, 4096
    s_add_u32 s61, s61, 65536
    buffer_load_dwordx4 v3, s[12:15], s47 offen offset:0 sc1 lds
    buffer_load_dwordx4 v3, s[12:15], s47 offen offset:1024 sc1 lds
    buffer_load_dwordx4 v3, s[12:15], s47 offen offset:2048 sc1 lds
    buffer_load_dwordx4 v3, s[12:15], s47 offen offset:3072 sc1 lds
    s_xor_b32 s64, s64, 0x10000
    s_branch L_g_dp_101_a
L_g_nw_99:
    s_waitcnt vmcnt(0) lgkmcnt(0)
    s_cmp_lg_u32 s44, 0
    s_cbranch_scc1 L_g_nl_113
    s_add_u32 s54, s60, 1
    v_add_u32 v12, s54, v113
    v_mul_u32_u24 v13, 171, v12
    v_lshrrev_b32 v13, 9, v13
    v_mad_i32_i24 v13, v13, -3, v12
    v_lshl_add_u32 v13, v13, 9, v7
    buffer_load_dword v11, v13, s[12:15], 0 offen sc1
L_g_nl_113:
    s_branch L_g_loop0_89_l
L_g_nfl_104:
    s_cmp_eq_u32 s71, 0
    s_cbranch_scc1 L_g_nfl_104_d
    v_mov_b32 v10, 1
    s_mov_b64 exec, 1
    s_waitcnt vmcnt(0)
    ds_add_rtn_u32 v10, v15, v10 offset:4
    s_waitcnt lgkmcnt(0)
    v_readfirstlane_b32 s46, v10
    s_mov_b64 exec, -1
    s_mov_b32 s71, 0
    s_sub_u32 s59, s60, 1
    s_cmp_lg_u32 s46, s68
    s_cbranch_scc1 L_g_df_114
    v_mov_b32 v10, s59
    v_add_u32 v10, 1, v10
    v_mov_b32 v11, 0
    s_mov_b64 exec, 1
    buffer_store_dword v10, v11, s[12:15], s52 offen sc1
    s_mov_b64 exec, -1
L_sf_115:
L_g_df_114:
    s_add_u32 s68, s68, 4
    s_mov_b32 s65, 2
    s_branch L_g_nfl_104_d
L_g_dp_109_l:
    s_cmp_ge_u32 s62, s66
    s_cbranch_scc1 L_g_dp_109_d
    s_or_b32 s65, s65, 1
    s_add_u32 s47, s61, 4096
    s_mov_b32 m0, s64
    s_add_u32 s62, s62, 1
    buffer_load_dwordx4 v3, s[12:15], s61 offen offset:0 sc1 lds
    buffer_load_dwordx4 v3, s[12:15], s61 offen offset:1024 sc1 lds
    buffer_load_dwordx4 v3, s[12:15], s61 offen offset:2048 sc1 lds
    buffer_load_dwordx4 v3, s[12:15], s61 offen offset:3072 sc1 lds
    s_add_u32 m0, s64, 4096
    s_add_u32 s61, s61, 65536
    buffer_load_dwordx4 v3, s[12:15], s47 offen offset:0 sc1 lds
    buffer_load_dwordx4 v3, s[12:15], s47 offen offset:1024 sc1 lds
    buffer_load_dwordx4 v3, s[12:15], s47 offen offset:2048 sc1 lds
    buffer_load_dwordx4 v3, s[12:15], s47 offen offset:3072 sc1 lds
    s_xor_b32 s64, s64, 0x10000
    s_branch L_g_dp_109_a
L_g_nw1_106:
    s_cmp_eq_u32 s65, 2
    s_cbranch_scc1 L_g_nw1_106_w
    s_waitcnt vmcnt(0)
L_g_nw1_106_w:
    s_barrier
    ds_read_b128 v[32:35], v4 offset:0
    ds_read_b128 v[36:39], v4 offset:1024
    ds_read_b128 v[40:43], v4 offset:2048
    ds_read_b128 v[44:47], v4 offset:3072
    ds_read_b128 v[48:51], v4 offset:4096
    ds_read_b128 v[52:55], v4 offset:5120
    ds_read_b128 v[56:59], v4 offset:6144
    ds_read_b128 v[60:63], v4 offset:7168
    s_branch L_g_jn_108
L_g_mm2_107:
    s_setprio 1
    s_waitcnt lgkmcnt(6)
    v_mfma_f32_32x32x16_bf16 v[16:31], a[0:3], v[32:35], 0
    ds_read_b128 v[32:35], v4 offset:8192
    v_mfma_f32_32x32x16_bf16 v[16:31], a[4:7], v[36:39], v[16:31]
    ds_read_b128 v[36:39], v4 offset:9216
    s_waitcnt lgkmcnt(6)
    v_mfma_f32_32x32x16_bf16 v[16:31], a[8:11], v[40:43], v[16:31]
    ds_read_b128 v[40:43], v4 offset:10240
    v_mfma_f32_32x32x16_bf16 v[16:31], a[12:15], v[44:47], v[16:31]
    ds_read_b128 v[44:47], v4 offset:11264
    s_waitcnt lgkmcnt(6)
    v_mfma_f32_32x32x16_bf16 v[16:31], a[16:19], v[48:51], v[16:31]
    ds_read_b128 v[48:51], v4 offset:12288
    v_mfma_f32_32x32x16_bf16 v[16:31], a[20:23], v[52:55], v[16:31]
    ds_read_b128 v[52:55], v4 offset:13312
    s_waitcnt lgkmcnt(6)
    v_mfma_f32_32x32x16_bf16 v[16:31], a[24:27], v[56:59], v[16:31]
    ds_read_b128 v[56:59], v4 offset:14336
    v_mfma_f32_32x32x16_bf16 v[16:31], a[28:31], v[60:63], v[16:31]
    ds_read_b128 v[60:63], v4 offset:15360
    s_waitcnt lgkmcnt(6)
    v_mfma_f32_32x32x16_bf16 v[16:31], a[32:35], v[32:35], v[16:31]
    ds_read_b128 v[32:35], v4 offset:16384
    v_mfma_f32_32x32x16_bf16 v[16:31], a[36:39], v[36:39], v[16:31]
    ds_read_b128 v[36:39], v4 offset:17408
    s_waitcnt lgkmcnt(6)
    v_mfma_f32_32x32x16_bf16 v[16:31], a[40:43], v[40:43], v[16:31]
    ds_read_b128 v[40:43], v4 offset:18432
    v_mfma_f32_32x32x16_bf16 v[16:31], a[44:47], v[44:47], v[16:31]
    ds_read_b128 v[44:47], v4 offset:19456
    s_waitcnt lgkmcnt(6)
    v_mfma_f32_32x32x16_bf16 v[16:31], a[48:51], v[48:51], v[16:31]
    ds_read_b128 v[48:51], v4 offset:20480
    v_mfma_f32_32x32x16_bf16 v[16:31], a[52:55], v[52:55], v[16:31]
    ds_read_b128 v[52:55], v4 offset:21504
    s_waitcnt lgkmcnt(6)
    v_mfma_f32_32x32x16_bf16 v[16:31], a[56:59], v[56:59], v[16:31]
    ds_read_b128 v[56:59], v4 offset:22528
    v_mfma_f32_32x32x16_bf16 v[16:31], a[60:63], v[60:63], v[16:31]
    ds_read_b128 v[60:63], v4 offset:23552
    s_waitcnt lgkmcnt(6)
    v_mfma_f32_32x32x16_bf16 v[16:31], a[64:67], v[32:35], v[16:31]
    ds_read_b128 v[32:35], v4 offset:24576
    v_mfma_f32_32x32x16_bf16 v[16:31], a[68:71], v[36:39], v[16:31]
    ds_read_b128 v[36:39], v4 offset:25600
    s_waitcnt lgkmcnt(6)
    v_mfma_f32_32x32x16_bf16 v[16:31], a[72:75], v[40:43], v[16:31]
    ds_read_b128 v[40:43], v4 offset:26624
    v_mfma_f32_32x32x16_bf16 v[16:31], a[76:79], v[44:47], v[16:31]
    ds_read_b128 v[44:47], v4 offset:27648
    s_waitcnt lgkmcnt(6)
    v_mfma_f32_32x32x16_bf16 v[16:31], a[80:83], v[48:51], v[16:31]
    ds_read_b128 v[48:51], v4 offset:28672
    v_mfma_f32_32x32x16_bf16 v[16:31], a[84:87], v[52:55], v[16:31]
    ds_read_b128 v[52:55], v4 offset:29696
    s_waitcnt lgkmcnt(6)
    v_mfma_f32_32x32x16_bf16 v[16:31], a[88:91], v[56:59], v[16:31]
    ds_read_b128 v[56:59], v4 offset:30720
    v_mfma_f32_32x32x16_bf16 v[16:31], a[92:95], v[60:63], v[16:31]
    ds_read_b128 v[60:63], v4 offset:31744
    s_waitcnt lgkmcnt(6)
    v_mfma_f32_32x32x16_bf16 v[16:31], a[96:99], v[32:35], v[16:31]
    v_mfma_f32_32x32x16_bf16 v[16:31], a[100:103], v[36:39], v[16:31]
    s_waitcnt lgkmcnt(4)
    v_mfma_f32_32x32x16_bf16 v[16:31], a[104:107], v[40:43], v[16:31]
    v_mfma_f32_32x32x16_bf16 v[16:31], a[108:111], v[44:47], v[16:31]
    s_waitcnt lgkmcnt(2)
    v_mfma_f32_32x32x16_bf16 v[16:31], a[112:115], v[48:51], v[16:31]
    v_mfma_f32_32x32x16_bf16 v[16:31], a[116:119], v[52:55], v[16:31]
    s_waitcnt lgkmcnt(0)
    v_mfma_f32_32x32x16_bf16 v[16:31], a[120:123], v[56:59], v[16:31]
    v_mfma_f32_32x32x16_bf16 v[16:31], a[124:127], v[60:63], v[16:31]
    v_xor_b32 v4, 0x10000, v4
    s_setprio 0
    s_waitcnt vmcnt(0)
    s_branch L_g_mm2_107_d
L_w_f2_13:
    s_load_dwordx2 s[4:5], s[0:1], 80
    s_load_dwordx2 s[6:7], s[0:1], 72
    s_and_b32 s50, s44, 3
    s_lshr_b32 s51, s44, 2
    s_waitcnt lgkmcnt(0)
    s_mov_b32 s24, s4
    s_and_b32 s25, s5, 0xffff
    s_mov_b32 s26, 0x700000
    s_mov_b32 s27, 0x00020000
    v_lshrrev_b32 v3, 4, v1
    v_and_b32 v4, 15, v1
    v_lshlrev_b32 v5, 2, v3
    v_xor_b32 v4, v4, v5
    v_mul_u32_u24 v3, 2048, v3
    v_lshl_add_u32 v3, v4, 4, v3
    s_mul_i32 s46, s51, 448
    s_mul_i32 s47, s50, 16
    s_add_u32 s46, s46, s47
    s_mul_i32 s47, s42, 896
    s_add_u32 s46, s46, s47
    s_mul_i32 s46, s46, 2048
    s_lshl_b32 s47, s43, 8
    s_add_u32 s46, s46, s47
    s_lshl_b32 s45, s51, 16
    s_mul_i32 s47, s50, 4096
    s_add_u32 s45, s45, s47
    v_bfe_u32 v4, v1, 2, 2
    v_bfe_u32 v5, v1, 4, 1
    v_lshlrev_b32 v5, 1, v5
    v_bfe_u32 v6, v1, 1, 1
    v_add_u32 v5, v5, v6
    s_lshl_b32 s47, s50, 2
    v_add_u32 v5, s47, v5
    v_lshlrev_b32 v6, 2, v4
    v_xor_b32 v5, v5, v6
    v_lshlrev_b32 v5, 4, v5
    v_lshl_add_u32 v5, v4, 8, v5
    v_bfe_u32 v6, v1, 0, 1
    v_lshl_add_u32 v5, v6, 3, v5
    v_lshrrev_b32 v6, 5, v1
    v_mul_u32_u24 v6, 1024, v6
    v_add_u32 v5, v5, v6
    s_lshl_b32 s47, s51, 16
    v_add_u32 v5, s47, v5
    v_bfe_u32 v4, v1, 2, 2
    v_xor_b32 v5, s50, v4
    v_lshlrev_b32 v5, 6, v5
    v_lshl_add_u32 v5, v4, 8, v5
    v_and_b32 v6, 3, v1
    v_lshl_add_u32 v5, v6, 3, v5
    v_lshrrev_b32 v6, 4, v1
    v_lshl_add_u32 v5, v6, 10, v5
    v_lshrrev_b32 v6, 5, v1
    v_lshl_add_u32 v5, v6, 11, v5
    s_lshl_b32 s47, s51, 16
    v_add_u32 v5, s47, v5
    s_add_u32 m0, s45, 0
    s_add_u32 s47, s46, 0x0
    buffer_load_dwordx4 v3, s[24:27], s47 offen lds
    s_add_u32 m0, s45, 1024
    s_add_u32 s47, s46, 0x2000
    buffer_load_dwordx4 v3, s[24:27], s47 offen lds
    s_add_u32 m0, s45, 2048
    s_add_u32 s47, s46, 0x4000
    buffer_load_dwordx4 v3, s[24:27], s47 offen lds
    s_add_u32 m0, s45, 3072
    s_add_u32 s47, s46, 0x6000
    buffer_load_dwordx4 v3, s[24:27], s47 offen lds
    s_add_u32 m0, s45, 16384
    s_add_u32 s47, s46, 0x20000
    buffer_load_dwordx4 v3, s[24:27], s47 offen lds
    s_add_u32 m0, s45, 17408
    s_add_u32 s47, s46, 0x22000
    buffer_load_dwordx4 v3, s[24:27], s47 offen lds
    s_add_u32 m0, s45, 18432
    s_add_u32 s47, s46, 0x24000
    buffer_load_dwordx4 v3, s[24:27], s47 offen lds
    s_add_u32 m0, s45, 19456
    s_add_u32 s47, s46, 0x26000
    buffer_load_dwordx4 v3, s[24:27], s47 offen lds
    s_add_u32 m0, s45, 32768
    s_add_u32 s47, s46, 0x40000
    buffer_load_dwordx4 v3, s[24:27], s47 offen lds
    s_add_u32 m0, s45, 33792
    s_add_u32 s47, s46, 0x42000
    buffer_load_dwordx4 v3, s[24:27], s47 offen lds
    s_add_u32 m0, s45, 34816
    s_add_u32 s47, s46, 0x44000
    buffer_load_dwordx4 v3, s[24:27], s47 offen lds
    s_add_u32 m0, s45, 35840
    s_add_u32 s47, s46, 0x46000
    buffer_load_dwordx4 v3, s[24:27], s47 offen lds
    s_add_u32 m0, s45, 49152
    s_add_u32 s47, s46, 0x60000
    buffer_load_dwordx4 v3, s[24:27], s47 offen lds
    s_add_u32 m0, s45, 50176
    s_add_u32 s47, s46, 0x62000
    buffer_load_dwordx4 v3, s[24:27], s47 offen lds
    s_add_u32 m0, s45, 51200
    s_add_u32 s47, s46, 0x64000
    buffer_load_dwordx4 v3, s[24:27], s47 offen lds
    s_add_u32 m0, s45, 52224
    s_add_u32 s47, s46, 0x66000
    buffer_load_dwordx4 v3, s[24:27], s47 offen lds
    s_waitcnt vmcnt(12) lgkmcnt(0)
    s_barrier
    ds_read_b64_tr_b16 a[0:1], v5 offset:0
    ds_read_b64_tr_b16 a[2:3], v5 offset:2048
    ds_read_b64_tr_b16 a[4:5], v5 offset:32
    ds_read_b64_tr_b16 a[6:7], v5 offset:2080
    ds_read_b64_tr_b16 a[8:9], v5 offset:8192
    ds_read_b64_tr_b16 a[10:11], v5 offset:10240
    ds_read_b64_tr_b16 a[12:13], v5 offset:8224
    ds_read_b64_tr_b16 a[14:15], v5 offset:10272
    s_waitcnt vmcnt(8) lgkmcnt(0)
    s_barrier
    s_add_u32 m0, s45, 0
    s_add_u32 s47, s46, 0x80000
    buffer_load_dwordx4 v3, s[24:27], s47 offen lds
    s_add_u32 m0, s45, 1024
    s_add_u32 s47, s46, 0x82000
    buffer_load_dwordx4 v3, s[24:27], s47 offen lds
    s_add_u32 m0, s45, 2048
    s_add_u32 s47, s46, 0x84000
    buffer_load_dwordx4 v3, s[24:27], s47 offen lds
    s_add_u32 m0, s45, 3072
    s_add_u32 s47, s46, 0x86000
    buffer_load_dwordx4 v3, s[24:27], s47 offen lds
    ds_read_b64_tr_b16 a[16:17], v5 offset:16384
    ds_read_b64_tr_b16 a[18:19], v5 offset:18432
    ds_read_b64_tr_b16 a[20:21], v5 offset:16416
    ds_read_b64_tr_b16 a[22:23], v5 offset:18464
    ds_read_b64_tr_b16 a[24:25], v5 offset:24576
    ds_read_b64_tr_b16 a[26:27], v5 offset:26624
    ds_read_b64_tr_b16 a[28:29], v5 offset:24608
    ds_read_b64_tr_b16 a[30:31], v5 offset:26656
    s_waitcnt vmcnt(8) lgkmcnt(0)
    s_barrier
    s_add_u32 m0, s45, 16384
    s_add_u32 s47, s46, 0xa0000
    buffer_load_dwordx4 v3, s[24:27], s47 offen lds
    s_add_u32 m0, s45, 17408
    s_add_u32 s47, s46, 0xa2000
    buffer_load_dwordx4 v3, s[24:27], s47 offen lds
    s_add_u32 m0, s45, 18432
    s_add_u32 s47, s46, 0xa4000
    buffer_load_dwordx4 v3, s[24:27], s47 offen lds
    s_add_u32 m0, s45, 19456
    s_add_u32 s47, s46, 0xa6000
    buffer_load_dwordx4 v3, s[24:27], s47 offen lds
    ds_read_b64_tr_b16 a[32:33], v5 offset:32768
    ds_read_b64_tr_b16 a[34:35], v5 offset:34816
    ds_read_b64_tr_b16 a[36:37], v5 offset:32800
    ds_read_b64_tr_b16 a[38:39], v5 offset:34848
    ds_read_b64_tr_b16 a[40:41], v5 offset:40960
    ds_read_b64_tr_b16 a[42:43], v5 offset:43008
    ds_read_b64_tr_b16 a[44:45], v5 offset:40992
    ds_read_b64_tr_b16 a[46:47], v5 offset:43040
    s_waitcnt vmcnt(8) lgkmcnt(0)
    s_barrier
    s_add_u32 m0, s45, 32768
    s_add_u32 s47, s46, 0xc0000
    buffer_load_dwordx4 v3, s[24:27], s47 offen lds
    s_add_u32 m0, s45, 33792
    s_add_u32 s47, s46, 0xc2000
    buffer_load_dwordx4 v3, s[24:27], s47 offen lds
    s_add_u32 m0, s45, 34816
    s_add_u32 s47, s46, 0xc4000
    buffer_load_dwordx4 v3, s[24:27], s47 offen lds
    s_add_u32 m0, s45, 35840
    s_add_u32 s47, s46, 0xc6000
    buffer_load_dwordx4 v3, s[24:27], s47 offen lds
    ds_read_b64_tr_b16 a[48:49], v5 offset:49152
    ds_read_b64_tr_b16 a[50:51], v5 offset:51200
    ds_read_b64_tr_b16 a[52:53], v5 offset:49184
    ds_read_b64_tr_b16 a[54:55], v5 offset:51232
    ds_read_b64_tr_b16 a[56:57], v5 offset:57344
    ds_read_b64_tr_b16 a[58:59], v5 offset:59392
    ds_read_b64_tr_b16 a[60:61], v5 offset:57376
    ds_read_b64_tr_b16 a[62:63], v5 offset:59424
    s_waitcnt vmcnt(8) lgkmcnt(0)
    s_barrier
    ds_read_b64_tr_b16 a[64:65], v5 offset:0
    ds_read_b64_tr_b16 a[66:67], v5 offset:2048
    ds_read_b64_tr_b16 a[68:69], v5 offset:32
    ds_read_b64_tr_b16 a[70:71], v5 offset:2080
    ds_read_b64_tr_b16 a[72:73], v5 offset:8192
    ds_read_b64_tr_b16 a[74:75], v5 offset:10240
    ds_read_b64_tr_b16 a[76:77], v5 offset:8224
    ds_read_b64_tr_b16 a[78:79], v5 offset:10272
    s_waitcnt vmcnt(4) lgkmcnt(0)
    s_barrier
    ds_read_b64_tr_b16 a[80:81], v5 offset:16384
    ds_read_b64_tr_b16 a[82:83], v5 offset:18432
    ds_read_b64_tr_b16 a[84:85], v5 offset:16416
    ds_read_b64_tr_b16 a[86:87], v5 offset:18464
    ds_read_b64_tr_b16 a[88:89], v5 offset:24576
    ds_read_b64_tr_b16 a[90:91], v5 offset:26624
    ds_read_b64_tr_b16 a[92:93], v5 offset:24608
    ds_read_b64_tr_b16 a[94:95], v5 offset:26656
    s_waitcnt vmcnt(0) lgkmcnt(0)
    s_barrier
    ds_read_b64_tr_b16 a[96:97], v5 offset:32768
    ds_read_b64_tr_b16 a[98:99], v5 offset:34816
    ds_read_b64_tr_b16 a[100:101], v5 offset:32800
    ds_read_b64_tr_b16 a[102:103], v5 offset:34848
    ds_read_b64_tr_b16 a[104:105], v5 offset:40960
    ds_read_b64_tr_b16 a[106:107], v5 offset:43008
    ds_read_b64_tr_b16 a[108:109], v5 offset:40992
    ds_read_b64_tr_b16 a[110:111], v5 offset:43040
    s_waitcnt lgkmcnt(0)
    s_barrier
    v_lshlrev_b32 v2, 4, v1
    s_mul_i32 s64, s44, 7168
    s_add_u32 s46, s64, 0x6000000
    s_mul_i32 s47, s42, 57344
    s_add_u32 s46, s46, s47
    v_add_u32 v3, s46, v2
    s_mul_i32 s46, s51, 28672
    v_add_u32 v4, s46, v2
    v_and_b32 v6, 15, v1
    v_lshlrev_b32 v6, 4, v6
    v_lshrrev_b32 v7, 4, v1
    v_lshl_add_u32 v6, v7, 9, v6
    v_add_u32 v4, s46, v6
    s_lshl_b32 s46, s50, 12
    s_add_u32 s46, s46, 131072
    v_add_u32 v5, s46, v2
    v_and_b32 v7, 15, v1
    v_min_u32 v7, 6, v7
    v_lshlrev_b32 v7, 7, v7
    s_mul_i32 s46, s42, 896
    s_add_u32 s46, s46, 0x106400
    v_add_u32 v7, s46, v7
    s_lshl_b32 s46, s42, 16
    s_lshl_b32 s47, s43, 11
    s_add_u32 s46, s46, s47
    s_lshl_b32 s47, s50, 9
    s_add_u32 s46, s46, s47
    s_add_u32 s46, s46, 0xb000000
    v_and_b32 v8, 31, v1
    v_lshlrev_b32 v8, 4, v8
    v_lshrrev_b32 v9, 5, v1
    v_lshl_add_u32 v8, v9, 14, v8
    v_add_u32 v8, s46, v8
    v_add_u32 v9, 0x8000, v8
    s_lshl_b32 s52, s43, 9
    s_lshl_b32 s47, s42, 7
    s_add_u32 s52, s52, s47
    s_add_u32 s52, s52, 0x108400
    s_add_u32 s52, s52, s76
    s_mul_i32 s46, s43, 7168
    s_add_u32 s46, s46, 0x6000000
    s_mul_i32 s47, s42, 57344
    s_add_u32 s46, s46, s47
    v_min_u32 v116, 55, v1
    v_lshlrev_b32 v116, 7, v116
    v_add_u32 v116, s46, v116
    s_mov_b32 s60, s74
    s_mul_i32 s61, s74, 229376
    s_mov_b32 s62, s74
    s_mul_i32 s63, s74, 262144
    s_mov_b32 s67, 0
    s_mov_b32 s68, 3
    s_mov_b32 s71, 0
    v_mov_b32 v15, 147456
    v_mov_b32 v14, 0
    ds_write_b32 v15, v14 offset:4
    ds_write_b32 v15, v14 offset:12
    ds_write_b32 v15, v14 offset:16
    v_mov_b32 v114, 1
    v_mov_b32 v115, 0
    v_lshrrev_b32 v113, 4, v1
    s_mov_b32 s72, 0
L_g_restart_116:
    s_cmp_lg_u32 s44, 0
    s_cbranch_scc1 L_g_nsp_117
    s_mov_b32 s70, 0
L_g_sp_123:
    s_add_u32 s54, s60, 0
    v_add_u32 v12, s54, v113
    v_subrev_u32 v13, 60, v12
    v_subrev_u32 v11, 63, v12
    v_ashrrev_i32 v13, 31, v13
    v_ashrrev_i32 v11, 31, v11
    v_add3_u32 v13, v13, v11, 2
    v_lshl_add_u32 v13, v13, 16, v7
    buffer_load_dword v11, v13, s[12:15], 0 offen sc1
    s_waitcnt vmcnt(0)
    v_cmp_ge_u32 vcc, v12, v11
    s_add_u32 s70, s70, 1
    s_and_b32 s46, vcc_lo, 0xffff
    s_cbranch_scc0 L_g_sp_123_ok
    s_sleep 3
    s_cmp_lt_u32 s70, 524288
    s_cbranch_scc1 L_g_sp_123
    s_branch L_c_done_1
L_g_sp_123_ok:
    v_cmp_ge_u32 vcc, v12, v11
    s_nop 0
    s_ff1_i32_b64 s46, vcc
    s_lshr_b32 s46, s46, 4
    s_min_u32 s46, s46, 4
    s_add_u32 s46, s46, s54
    s_min_u32 s46, s46, s75
    v_mov_b32 v11, s46
    ds_write_b32 v15, v11 offset:20
L_g_nsp_117:
    s_waitcnt lgkmcnt(0)
    s_barrier
    ds_read_b32 v14, v15 offset:20
    s_waitcnt lgkmcnt(0)
    v_readfirstlane_b32 s66, v14
    s_nop 3
L_g_restart_116_go:
    s_mov_b32 s69, 0
    s_cmp_gt_u32 s62, s60
    s_cbranch_scc1 L_g_nd_124
    s_cmp_ge_u32 s62, s66
    s_cbranch_scc1 L_g_nd_124
    s_add_u32 s47, s61, 4096
    s_add_u32 m0, s64, 0
    s_nop 0
    buffer_load_dwordx4 v3, s[12:15], s61 offen offset:0 sc1 lds
    buffer_load_dwordx4 v3, s[12:15], s61 offen offset:1024 sc1 lds
    buffer_load_dwordx4 v3, s[12:15], s61 offen offset:2048 sc1 lds
    buffer_load_dwordx4 v3, s[12:15], s61 offen offset:3072 sc1 lds
    s_add_u32 m0, s64, 4096
    s_nop 0
    buffer_load_dwordx4 v3, s[12:15], s47 offen offset:0 sc1 lds
    buffer_load_dwordx4 v3, s[12:15], s47 offen offset:1024 sc1 lds
    buffer_load_dwordx4 v3, s[12:15], s47 offen offset:2048 sc1 lds
    s_add_u32 s61, s61, 229376
    s_add_u32 s62, s62, 1
    s_xor_b32 s64, s64, 0x10000
    s_mov_b32 s69, 1
L_g_nd_124:
    s_cmp_eq_u32 s51, 1
    s_cbranch_scc1 L_g_g1r_118
    s_add_u32 s59, s60, 1
    s_mov_b32 s69, 0
    s_cmp_gt_u32 s62, s59
    s_cbranch_scc1 L_g_nd_125
    s_cmp_ge_u32 s62, s66
    s_cbranch_scc1 L_g_nd_125
    s_add_u32 s47, s61, 4096
    s_add_u32 m0, s64, 0
    s_nop 0
    buffer_load_dwordx4 v3, s[12:15], s61 offen offset:0 sc1 lds
    buffer_load_dwordx4 v3, s[12:15], s61 offen offset:1024 sc1 lds
    buffer_load_dwordx4 v3, s[12:15], s61 offen offset:2048 sc1 lds
    buffer_load_dwordx4 v3, s[12:15], s61 offen offset:3072 sc1 lds
    s_add_u32 m0, s64, 4096
    s_nop 0
    buffer_load_dwordx4 v3, s[12:15], s47 offen offset:0 sc1 lds
    buffer_load_dwordx4 v3, s[12:15], s47 offen offset:1024 sc1 lds
    buffer_load_dwordx4 v3, s[12:15], s47 offen offset:2048 sc1 lds
    s_add_u32 s61, s61, 229376
    s_add_u32 s62, s62, 1
    s_xor_b32 s64, s64, 0x10000
    s_mov_b32 s69, 1
L_g_nd_125:
    s_cmp_eq_u32 s69, 1
    s_cbranch_scc1 L_g_w0_126
    s_waitcnt vmcnt(0)
L_g_w0_126:
    s_waitcnt vmcnt(7)
L_g_loop0_119_l:
    s_barrier
    ds_read_b128 v[32:35], v4 offset:0
    ds_read_b128 v[36:39], v4 offset:256
    ds_read_b128 v[40:43], v4 offset:2048
    ds_read_b128 v[44:47], v4 offset:2304
    ds_read_b128 v[48:51], v4 offset:4096
    ds_read_b128 v[52:55], v4 offset:4352
    ds_read_b128 v[56:59], v4 offset:6144
    ds_read_b128 v[60:63], v4 offset:6400
    s_branch L_g_loop0_119_m
.p2align 6
L_g_loop0_119:
    s_barrier
L_g_loop0_119_m:
    s_setprio 2
    s_waitcnt lgkmcnt(6)
    v_mfma_f32_16x16x32_bf16 v[16:19], v[32:35], a[0:3], 0
    v_mfma_f32_16x16x32_bf16 v[20:23], v[32:35], a[4:7], 0
    ds_read_b128 v[32:35], v4 offset:8192
    v_mfma_f32_16x16x32_bf16 v[28:31], v[36:39], a[4:7], 0
    v_mfma_f32_16x16x32_bf16 v[24:27], v[36:39], a[0:3], 0
    ds_read_b128 v[36:39], v4 offset:8448
    s_cmp_lg_u32 s44, 0
    s_cbranch_scc1 L_g_nl_130
    s_add_u32 s54, s60, 1
    v_add_u32 v12, s54, v113
    v_subrev_u32 v13, 60, v12
    v_subrev_u32 v11, 63, v12
    v_ashrrev_i32 v13, 31, v13
    v_ashrrev_i32 v11, 31, v11
    v_add3_u32 v13, v13, v11, 2
    v_lshl_add_u32 v13, v13, 16, v7
    buffer_load_dword v11, v13, s[12:15], 0 offen sc1
L_g_nl_130:
    s_waitcnt lgkmcnt(6)
    v_mfma_f32_16x16x32_bf16 v[16:19], v[40:43], a[8:11], v[16:19]
    v_mfma_f32_16x16x32_bf16 v[20:23], v[40:43], a[12:15], v[20:23]
    ds_read_b128 v[40:43], v4 offset:10240
    v_mfma_f32_16x16x32_bf16 v[28:31], v[44:47], a[12:15], v[28:31]
    v_mfma_f32_16x16x32_bf16 v[24:27], v[44:47], a[8:11], v[24:27]
    ds_read_b128 v[44:47], v4 offset:10496
    s_waitcnt lgkmcnt(6)
    v_mfma_f32_16x16x32_bf16 v[16:19], v[48:51], a[16:19], v[16:19]
    v_mfma_f32_16x16x32_bf16 v[20:23], v[48:51], a[20:23], v[20:23]
    ds_read_b128 v[48:51], v4 offset:12288
    v_mfma_f32_16x16x32_bf16 v[28:31], v[52:55], a[20:23], v[28:31]
    v_mfma_f32_16x16x32_bf16 v[24:27], v[52:55], a[16:19], v[24:27]
    ds_read_b128 v[52:55], v4 offset:12544
    s_waitcnt lgkmcnt(6)
    v_mfma_f32_16x16x32_bf16 v[16:19], v[56:59], a[24:27], v[16:19]
    v_mfma_f32_16x16x32_bf16 v[20:23], v[56:59], a[28:31], v[20:23]
    ds_read_b128 v[56:59], v4 offset:14336
    v_mfma_f32_16x16x32_bf16 v[28:31], v[60:63], a[28:31], v[28:31]
    v_mfma_f32_16x16x32_bf16 v[24:27], v[60:63], a[24:27], v[24:27]
    ds_read_b128 v[60:63], v4 offset:14592
    s_waitcnt lgkmcnt(6)
    v_mfma_f32_16x16x32_bf16 v[16:19], v[32:35], a[32:35], v[16:19]
    v_mfma_f32_16x16x32_bf16 v[20:23], v[32:35], a[36:39], v[20:23]
    ds_read_b128 v[32:35], v4 offset:16384
    v_mfma_f32_16x16x32_bf16 v[28:31], v[36:39], a[36:39], v[28:31]
    v_mfma_f32_16x16x32_bf16 v[24:27], v[36:39], a[32:35], v[24:27]
    ds_read_b128 v[36:39], v4 offset:16640
    s_waitcnt lgkmcnt(6)
    v_mfma_f32_16x16x32_bf16 v[16:19], v[40:43], a[40:43], v[16:19]
    v_mfma_f32_16x16x32_bf16 v[20:23], v[40:43], a[44:47], v[20:23]
    ds_read_b128 v[40:43], v4 offset:18432
    v_mfma_f32_16x16x32_bf16 v[28:31], v[44:47], a[44:47], v[28:31]
    v_mfma_f32_16x16x32_bf16 v[24:27], v[44:47], a[40:43], v[24:27]
    ds_read_b128 v[44:47], v4 offset:18688
    s_waitcnt lgkmcnt(6)
    v_mfma_f32_16x16x32_bf16 v[16:19], v[48:51], a[48:51], v[16:19]
    v_mfma_f32_16x16x32_bf16 v[20:23], v[48:51], a[52:55], v[20:23]
    ds_read_b128 v[48:51], v4 offset:20480
    v_mfma_f32_16x16x32_bf16 v[28:31], v[52:55], a[52:55], v[28:31]
    v_mfma_f32_16x16x32_bf16 v[24:27], v[52:55], a[48:51], v[24:27]
    ds_read_b128 v[52:55], v4 offset:20736
    s_waitcnt lgkmcnt(6)
    v_mfma_f32_16x16x32_bf16 v[16:19], v[56:59], a[56:59], v[16:19]
    v_mfma_f32_16x16x32_bf16 v[20:23], v[56:59], a[60:63], v[20:23]
    ds_read_b128 v[56:59], v4 offset:22528
    v_mfma_f32_16x16x32_bf16 v[28:31], v[60:63], a[60:63], v[28:31]
    v_mfma_f32_16x16x32_bf16 v[24:27], v[60:63], a[56:59], v[24:27]
    ds_read_b128 v[60:63], v4 offset:22784
    s_waitcnt lgkmcnt(6)
    v_mfma_f32_16x16x32_bf16 v[16:19], v[32:35], a[64:67], v[16:19]
    v_mfma_f32_16x16x32_bf16 v[20:23], v[32:35], a[68:71], v[20:23]
    ds_read_b128 v[32:35], v4 offset:24576
    v_mfma_f32_16x16x32_bf16 v[28:31], v[36:39], a[68:71], v[28:31]
    v_mfma_f32_16x16x32_bf16 v[24:27], v[36:39], a[64:67], v[24:27]
    ds_read_b128 v[36:39], v4 offset:24832
    s_waitcnt lgkmcnt(6)
    v_mfma_f32_16x16x32_bf16 v[16:19], v[40:43], a[72:75], v[16:19]
    v_mfma_f32_16x16x32_bf16 v[20:23], v[40:43], a[76:79], v[20:23]
    ds_read_b128 v[40:43], v4 offset:26624
    v_mfma_f32_16x16x32_bf16 v[28:31], v[44:47], a[76:79], v[28:31]
    v_mfma_f32_16x16x32_bf16 v[24:27], v[44:47], a[72:75], v[24:27]
    ds_read_b128 v[44:47], v4 offset:26880
    s_waitcnt lgkmcnt(6)
    v_mfma_f32_16x16x32_bf16 v[16:19], v[48:51], a[80:83], v[16:19]
    v_mfma_f32_16x16x32_bf16 v[20:23], v[48:51], a[84:87], v[20:23]
    v_mfma_f32_16x16x32_bf16 v[28:31], v[52:55], a[84:87], v[28:31]
    v_mfma_f32_16x16x32_bf16 v[24:27], v[52:55], a[80:83], v[24:27]
    s_waitcnt lgkmcnt(4)
    v_mfma_f32_16x16x32_bf16 v[16:19], v[56:59], a[88:91], v[16:19]
    v_mfma_f32_16x16x32_bf16 v[20:23], v[56:59], a[92:95], v[20:23]
    v_mfma_f32_16x16x32_bf16 v[28:31], v[60:63], a[92:95], v[28:31]
    v_mfma_f32_16x16x32_bf16 v[24:27], v[60:63], a[88:91], v[24:27]
    s_waitcnt lgkmcnt(2)
    v_mfma_f32_16x16x32_bf16 v[16:19], v[32:35], a[96:99], v[16:19]
    v_mfma_f32_16x16x32_bf16 v[20:23], v[32:35], a[100:103], v[20:23]
    s_cmp_lg_u32 s44, 0
    s_cbranch_scc1 L_g_ne_127
    s_waitcnt vmcnt(0)
    v_cmp_ge_u32 vcc, v12, v11
    s_nop 0
    s_ff1_i32_b64 s46, vcc
    s_lshr_b32 s46, s46, 4
    s_min_u32 s46, s46, 4
    s_add_u32 s46, s46, s54
    s_min_u32 s46, s46, s75
    v_mov_b32 v11, s46
    ds_write_b32 v15, v11 offset:0
L_g_ne_127:
    v_mfma_f32_16x16x32_bf16 v[28:31], v[36:39], a[100:103], v[28:31]
    v_mfma_f32_16x16x32_bf16 v[24:27], v[36:39], a[96:99], v[24:27]
    s_waitcnt lgkmcnt(0)
    v_mfma_f32_16x16x32_bf16 v[16:19], v[40:43], a[104:107], v[16:19]
    v_mfma_f32_16x16x32_bf16 v[20:23], v[40:43], a[108:111], v[20:23]
    v_mfma_f32_16x16x32_bf16 v[28:31], v[44:47], a[108:111], v[28:31]
    v_mfma_f32_16x16x32_bf16 v[24:27], v[44:47], a[104:107], v[24:27]
    v_xor_b32 v4, 0x10000, v4
    s_setprio 0
    s_waitcnt vmcnt(0)
    s_waitcnt lgkmcnt(0)
    s_barrier
    ds_read_b32 v14, v15
    s_nop 6
    ds_write_b128 v5, v[16:19] offset:0
    ds_write_b128 v5, v[20:23] offset:1024
    ds_write_b128 v5, v[24:27] offset:2048
    ds_write_b128 v5, v[28:31] offset:3072
    s_waitcnt lgkmcnt(4)
    v_readfirstlane_b32 s66, v14
    s_add_u32 s60, s60, 1
    s_mov_b32 s65, 0
    s_cmp_le_u32 s62, s60
    s_cbranch_scc1 L_g_dp_131_l
L_g_dp_131_a:
    s_cmp_ge_u32 s62, s66
    s_cbranch_scc1 L_g_dp_131_d
    s_add_u32 s47, s61, 4096
    s_mov_b32 m0, s64
    s_add_u32 s62, s62, 1
    buffer_load_dwordx4 v3, s[12:15], s61 offen offset:0 sc1 lds
    buffer_load_dwordx4 v3, s[12:15], s61 offen offset:1024 sc1 lds
    buffer_load_dwordx4 v3, s[12:15], s61 offen offset:2048 sc1 lds
    buffer_load_dwordx4 v3, s[12:15], s61 offen offset:3072 sc1 lds
    s_add_u32 m0, s64, 4096
    s_add_u32 s61, s61, 229376
    buffer_load_dwordx4 v3, s[12:15], s47 offen offset:0 sc1 lds
    buffer_load_dwordx4 v3, s[12:15], s47 offen offset:1024 sc1 lds
    buffer_load_dwordx4 v3, s[12:15], s47 offen offset:2048 sc1 lds
    s_xor_b32 s64, s64, 0x10000
L_g_dp_131_d:
    s_cmp_lg_u32 s44, 2
    s_cbranch_scc1 L_g_pf_132
    s_cmp_ge_u32 s62, s66
    s_cbranch_scc1 L_g_pf_132
    buffer_load_dword v117, v116, s[12:15], s61 offen sc1
L_g_pf_132:
    s_cmp_le_u32 s66, s60
    s_cbranch_scc1 L_g_ex0_129
    s_cmp_lg_u32 s65, 0
    s_cbranch_scc1 L_g_nw_128
    ds_read_b128 v[32:35], v4 offset:0
    ds_read_b128 v[36:39], v4 offset:256
    ds_read_b128 v[40:43], v4 offset:2048
    ds_read_b128 v[44:47], v4 offset:2304
    ds_read_b128 v[48:51], v4 offset:4096
    ds_read_b128 v[52:55], v4 offset:4352
    ds_read_b128 v[56:59], v4 offset:6144
    ds_read_b128 v[60:63], v4 offset:6400
    s_waitcnt lgkmcnt(8)
    s_branch L_g_loop0_119
L_g_ex0_129:
    s_cmp_lg_u32 s44, 0
    s_cbranch_scc1 L_g_ex0_129_n
    s_sleep 6
    s_add_u32 s54, s60, 0
    v_add_u32 v12, s54, v113
    v_subrev_u32 v13, 60, v12
    v_subrev_u32 v11, 63, v12
    v_ashrrev_i32 v13, 31, v13
    v_ashrrev_i32 v11, 31, v11
    v_add3_u32 v13, v13, v11, 2
    v_lshl_add_u32 v13, v13, 16, v7
    buffer_load_dword v11, v13, s[12:15], 0 offen sc1
    s_waitcnt vmcnt(0)
    v_cmp_ge_u32 vcc, v12, v11
    s_nop 0
    s_ff1_i32_b64 s46, vcc
    s_lshr_b32 s46, s46, 4
    s_min_u32 s46, s46, 4
    s_add_u32 s46, s46, s54
    s_min_u32 s46, s46, s75
    v_mov_b32 v11, s46
    ds_write_b32 v15, v11 offset:20
L_g_ex0_129_n:
    s_waitcnt lgkmcnt(0)
    s_barrier
    ds_read_b32 v14, v15 offset:20
    s_waitcnt lgkmcnt(0)
    v_readfirstlane_b32 s66, v14
    s_barrier
    s_cmp_gt_u32 s66, s60
    s_cbranch_scc1 L_g_restart_116_go
    s_branch L_g_tail_121
L_g_g1r_118:
    s_mov_b32 s65, 1
    s_branch L_g_loop1_120_e
.p2align 6
L_g_loop1_120:
    s_mov_b32 s65, 0
L_g_loop1_120_e:
    s_barrier
    s_bitcmp1_b32 s67, 1
    s_cbranch_scc0 L_g_nfl_133
    s_cmp_lg_u32 s44, 4
    s_cbranch_scc1 L_g_nfl_133_d
    s_sub_u32 s59, s60, 1
    v_mov_b32 v10, s59
    buffer_store_dword v10, v115, s[12:15], s52 offen sc1
L_g_nfl_133_d:
    ds_read_b128 v[80:83], v5 offset:0
    ds_read_b128 v[84:87], v5 offset:1024
    ds_read_b128 v[88:91], v5 offset:2048
    ds_read_b128 v[92:95], v5 offset:3072
    s_cmp_le_u32 s62, s60
    s_cbranch_scc1 L_g_dp_138_l
L_g_dp_138_a:
    s_cmp_ge_u32 s62, s66
    s_cbranch_scc1 L_g_dp_138_d
    s_add_u32 s47, s61, 4096
    s_mov_b32 m0, s64
    s_add_u32 s62, s62, 1
    buffer_load_dwordx4 v3, s[12:15], s61 offen offset:0 sc1 lds
    buffer_load_dwordx4 v3, s[12:15], s61 offen offset:1024 sc1 lds
    buffer_load_dwordx4 v3, s[12:15], s61 offen offset:2048 sc1 lds
    buffer_load_dwordx4 v3, s[12:15], s61 offen offset:3072 sc1 lds
    s_add_u32 m0, s64, 4096
    s_add_u32 s61, s61, 229376
    buffer_load_dwordx4 v3, s[12:15], s47 offen offset:0 sc1 lds
    buffer_load_dwordx4 v3, s[12:15], s47 offen offset:1024 sc1 lds
    buffer_load_dwordx4 v3, s[12:15], s47 offen offset:2048 sc1 lds
    s_xor_b32 s64, s64, 0x10000
L_g_dp_138_d:
    s_bitcmp1_b32 s67, 0
    s_cbranch_scc0 L_g_nep_134
    s_waitcnt lgkmcnt(0)
    v_add_f32 v80, v80, v16
    v_add_f32 v81, v81, v17
    v_add_f32 v82, v82, v18
    v_add_f32 v83, v83, v19
    v_add_f32 v84, v84, v20
    v_add_f32 v85, v85, v21
    v_add_f32 v86, v86, v22
    v_add_f32 v87, v87, v23
    v_add_f32 v88, v88, v24
    v_add_f32 v89, v89, v25
    v_add_f32 v90, v90, v26
    v_add_f32 v91, v91, v27
    v_add_f32 v92, v92, v28
    v_add_f32 v93, v93, v29
    v_add_f32 v94, v94, v30
    v_add_f32 v95, v95, v31
    v_cvt_pk_bf16_f32 v104, v80, v81
    v_cvt_pk_bf16_f32 v105, v82, v83
    v_cvt_pk_bf16_f32 v106, v84, v85
    v_cvt_pk_bf16_f32 v107, v86, v87
    s_nop 1
    v_permlane16_swap_b32 v104, v106
    v_permlane16_swap_b32 v105, v107
    buffer_store_dwordx4 v[104:107], v8, s[12:15], s63 offen sc1
    v_cvt_pk_bf16_f32 v108, v88, v89
    v_cvt_pk_bf16_f32 v109, v90, v91
    v_cvt_pk_bf16_f32 v110, v92, v93
    v_cvt_pk_bf16_f32 v111, v94, v95
    s_nop 1
    v_permlane16_swap_b32 v108, v110
    v_permlane16_swap_b32 v109, v111
    buffer_store_dwordx4 v[108:111], v9, s[12:15], s63 offen sc1
    s_add_u32 s63, s63, 262144
L_g_nep_134:
    s_cmp_lg_u32 s65, 0
    s_cbranch_scc1 L_g_nw1_135
    ds_read_b128 v[32:35], v4 offset:0
    ds_read_b128 v[36:39], v4 offset:256
    ds_read_b128 v[40:43], v4 offset:2048
    ds_read_b128 v[44:47], v4 offset:2304
    ds_read_b128 v[48:51], v4 offset:4096
    ds_read_b128 v[52:55], v4 offset:4352
    ds_read_b128 v[56:59], v4 offset:6144
    ds_read_b128 v[60:63], v4 offset:6400
    s_barrier
L_g_jn_137:
    s_setprio 1
    s_waitcnt lgkmcnt(6)
    v_mfma_f32_16x16x32_bf16 v[16:19], v[32:35], a[0:3], 0
    ds_read_b32 v14, v15
    v_mfma_f32_16x16x32_bf16 v[20:23], v[32:35], a[4:7], 0
    ds_read_b128 v[32:35], v4 offset:8192
    v_mfma_f32_16x16x32_bf16 v[28:31], v[36:39], a[4:7], 0
    v_mfma_f32_16x16x32_bf16 v[24:27], v[36:39], a[0:3], 0
    ds_read_b128 v[36:39], v4 offset:8448
    s_waitcnt lgkmcnt(6)
    v_mfma_f32_16x16x32_bf16 v[16:19], v[40:43], a[8:11], v[16:19]
    v_mfma_f32_16x16x32_bf16 v[20:23], v[40:43], a[12:15], v[20:23]
    ds_read_b128 v[40:43], v4 offset:10240
    v_mfma_f32_16x16x32_bf16 v[28:31], v[44:47], a[12:15], v[28:31]
    v_mfma_f32_16x16x32_bf16 v[24:27], v[44:47], a[8:11], v[24:27]
    ds_read_b128 v[44:47], v4 offset:10496
    s_waitcnt lgkmcnt(6)
    v_mfma_f32_16x16x32_bf16 v[16:19], v[48:51], a[16:19], v[16:19]
    v_mfma_f32_16x16x32_bf16 v[20:23], v[48:51], a[20:23], v[20:23]
    ds_read_b128 v[48:51], v4 offset:12288
    v_mfma_f32_16x16x32_bf16 v[28:31], v[52:55], a[20:23], v[28:31]
    v_mfma_f32_16x16x32_bf16 v[24:27], v[52:55], a[16:19], v[24:27]
    ds_read_b128 v[52:55], v4 offset:12544
    s_waitcnt lgkmcnt(6)
    v_mfma_f32_16x16x32_bf16 v[16:19], v[56:59], a[24:27], v[16:19]
    v_mfma_f32_16x16x32_bf16 v[20:23], v[56:59], a[28:31], v[20:23]
    ds_read_b128 v[56:59], v4 offset:14336
    v_mfma_f32_16x16x32_bf16 v[28:31], v[60:63], a[28:31], v[28:31]
    v_mfma_f32_16x16x32_bf16 v[24:27], v[60:63], a[24:27], v[24:27]
    ds_read_b128 v[60:63], v4 offset:14592
    s_waitcnt lgkmcnt(6)
    v_mfma_f32_16x16x32_bf16 v[16:19], v[32:35], a[32:35], v[16:19]
    v_mfma_f32_16x16x32_bf16 v[20:23], v[32:35], a[36:39], v[20:23]
    ds_read_b128 v[32:35], v4 offset:16384
    v_mfma_f32_16x16x32_bf16 v[28:31], v[36:39], a[36:39], v[28:31]
    v_mfma_f32_16x16x32_bf16 v[24:27], v[36:39], a[32:35], v[24:27]
    ds_read_b128 v[36:39], v4 offset:16640
    s_waitcnt lgkmcnt(6)
    v_mfma_f32_16x16x32_bf16 v[16:19], v[40:43], a[40:43], v[16:19]
    v_mfma_f32_16x16x32_bf16 v[20:23], v[40:43], a[44:47], v[20:23]
    ds_read_b128 v[40:43], v4 offset:18432
    v_mfma_f32_16x16x32_bf16 v[28:31], v[44:47], a[44:47], v[28:31]
    v_mfma_f32_16x16x32_bf16 v[24:27], v[44:47], a[40:43], v[24:27]
    ds_read_b128 v[44:47], v4 offset:18688
    s_waitcnt lgkmcnt(6)
    v_mfma_f32_16x16x32_bf16 v[16:19], v[48:51], a[48:51], v[16:19]
    v_mfma_f32_16x16x32_bf16 v[20:23], v[48:51], a[52:55], v[20:23]
    ds_read_b128 v[48:51], v4 offset:20480
    v_mfma_f32_16x16x32_bf16 v[28:31], v[52:55], a[52:55], v[28:31]
    v_mfma_f32_16x16x32_bf16 v[24:27], v[52:55], a[48:51], v[24:27]
    ds_read_b128 v[52:55], v4 offset:20736
    s_waitcnt lgkmcnt(6)
    v_mfma_f32_16x16x32_bf16 v[16:19], v[56:59], a[56:59], v[16:19]
    v_mfma_f32_16x16x32_bf16 v[20:23], v[56:59], a[60:63], v[20:23]
    ds_read_b128 v[56:59], v4 offset:22528
    v_mfma_f32_16x16x32_bf16 v[28:31], v[60:63], a[60:63], v[28:31]
    v_mfma_f32_16x16x32_bf16 v[24:27], v[60:63], a[56:59], v[24:27]
    ds_read_b128 v[60:63], v4 offset:22784
    s_waitcnt lgkmcnt(6)
    v_mfma_f32_16x16x32_bf16 v[16:19], v[32:35], a[64:67], v[16:19]
    v_mfma_f32_16x16x32_bf16 v[20:23], v[32:35], a[68:71], v[20:23]
    ds_read_b128 v[32:35], v4 offset:24576
    v_mfma_f32_16x16x32_bf16 v[28:31], v[36:39], a[68:71], v[28:31]
    v_mfma_f32_16x16x32_bf16 v[24:27], v[36:39], a[64:67], v[24:27]
    ds_read_b128 v[36:39], v4 offset:24832
    s_waitcnt lgkmcnt(6)
    v_mfma_f32_16x16x32_bf16 v[16:19], v[40:43], a[72:75], v[16:19]
    v_mfma_f32_16x16x32_bf16 v[20:23], v[40:43], a[76:79], v[20:23]
    ds_read_b128 v[40:43], v4 offset:26624
    v_mfma_f32_16x16x32_bf16 v[28:31], v[44:47], a[76:79], v[28:31]
    v_mfma_f32_16x16x32_bf16 v[24:27], v[44:47], a[72:75], v[24:27]
    ds_read_b128 v[44:47], v4 offset:26880
    s_waitcnt lgkmcnt(6)
    v_mfma_f32_16x16x32_bf16 v[16:19], v[48:51], a[80:83], v[16:19]
    v_mfma_f32_16x16x32_bf16 v[20:23], v[48:51], a[84:87], v[20:23]
    v_mfma_f32_16x16x32_bf16 v[28:31], v[52:55], a[84:87], v[28:31]
    v_mfma_f32_16x16x32_bf16 v[24:27], v[52:55], a[80:83], v[24:27]
    s_waitcnt lgkmcnt(4)
    v_mfma_f32_16x16x32_bf16 v[16:19], v[56:59], a[88:91], v[16:19]
    v_mfma_f32_16x16x32_bf16 v[20:23], v[56:59], a[92:95], v[20:23]
    v_mfma_f32_16x16x32_bf16 v[28:31], v[60:63], a[92:95], v[28:31]
    v_mfma_f32_16x16x32_bf16 v[24:27], v[60:63], a[88:91], v[24:27]
    s_waitcnt lgkmcnt(2)
    v_mfma_f32_16x16x32_bf16 v[16:19], v[32:35], a[96:99], v[16:19]
    v_mfma_f32_16x16x32_bf16 v[20:23], v[32:35], a[100:103], v[20:23]
    v_mfma_f32_16x16x32_bf16 v[28:31], v[36:39], a[100:103], v[28:31]
    v_mfma_f32_16x16x32_bf16 v[24:27], v[36:39], a[96:99], v[24:27]
    s_waitcnt lgkmcnt(0)
    v_mfma_f32_16x16x32_bf16 v[16:19], v[40:43], a[104:107], v[16:19]
    v_mfma_f32_16x16x32_bf16 v[20:23], v[40:43], a[108:111], v[20:23]
    v_mfma_f32_16x16x32_bf16 v[28:31], v[44:47], a[108:111], v[28:31]
    v_mfma_f32_16x16x32_bf16 v[24:27], v[44:47], a[104:107], v[24:27]
    v_xor_b32 v4, 0x10000, v4
    s_setprio 0
    s_waitcnt vmcnt(0)
    v_readfirstlane_b32 s66, v14
    s_lshl_b32 s67, s67, 1
    s_or_b32 s67, s67, 1
    s_add_u32 s60, s60, 1
    s_cmp_gt_u32 s66, s60
    s_cbranch_scc1 L_g_loop1_120
    s_barrier
    ds_read_b32 v14, v15 offset:20
    s_waitcnt lgkmcnt(0)
    v_readfirstlane_b32 s66, v14
    s_barrier
    s_mov_b32 s69, 0
    s_cmp_gt_u32 s62, s60
    s_cbranch_scc1 L_g_nd_139
    s_cmp_ge_u32 s62, s66
    s_cbranch_scc1 L_g_nd_139
    s_add_u32 s47, s61, 4096
    s_add_u32 m0, s64, 0
    s_nop 0
    buffer_load_dwordx4 v3, s[12:15], s61 offen offset:0 sc1 lds
    buffer_load_dwordx4 v3, s[12:15], s61 offen offset:1024 sc1 lds
    buffer_load_dwordx4 v3, s[12:15], s61 offen offset:2048 sc1 lds
    buffer_load_dwordx4 v3, s[12:15], s61 offen offset:3072 sc1 lds
    s_add_u32 m0, s64, 4096
    s_nop 0
    buffer_load_dwordx4 v3, s[12:15], s47 offen offset:0 sc1 lds
    buffer_load_dwordx4 v3, s[12:15], s47 offen offset:1024 sc1 lds
    buffer_load_dwordx4 v3, s[12:15], s47 offen offset:2048 sc1 lds
    s_add_u32 s61, s61, 229376
    s_add_u32 s62, s62, 1
    s_xor_b32 s64, s64, 0x10000
    s_mov_b32 s69, 1
L_g_nd_139:
    s_sub_u32 s59, s60, 1
    ds_read_b128 v[80:83], v5 offset:0
    ds_read_b128 v[84:87], v5 offset:1024
    ds_read_b128 v[88:91], v5 offset:2048
    ds_read_b128 v[92:95], v5 offset:3072
    s_nop 7
    s_waitcnt lgkmcnt(3)
    v_add_f32 v80, v80, v16
    v_add_f32 v81, v81, v17
    v_add_f32 v82, v82, v18
    v_add_f32 v83, v83, v19
    s_waitcnt lgkmcnt(2)
    v_add_f32 v84, v84, v20
    v_add_f32 v85, v85, v21
    v_add_f32 v86, v86, v22
    v_add_f32 v87, v87, v23
    s_waitcnt lgkmcnt(1)
    v_add_f32 v88, v88, v24
    v_add_f32 v89, v89, v25
    v_add_f32 v90, v90, v26
    v_add_f32 v91, v91, v27
    s_waitcnt lgkmcnt(0)
    v_add_f32 v92, v92, v28
    v_add_f32 v93, v93, v29
    v_add_f32 v94, v94, v30
    v_add_f32 v95, v95, v31
    v_cvt_pk_bf16_f32 v104, v80, v81
    v_cvt_pk_bf16_f32 v105, v82, v83
    v_cvt_pk_bf16_f32 v106, v84, v85
    v_cvt_pk_bf16_f32 v107, v86, v87
    s_nop 1
    v_permlane16_swap_b32 v104, v106
    v_permlane16_swap_b32 v105, v107
    buffer_store_dwordx4 v[104:107], v8, s[12:15], s63 offen sc1
    v_cvt_pk_bf16_f32 v108, v88, v89
    v_cvt_pk_bf16_f32 v109, v90, v91
    v_cvt_pk_bf16_f32 v110, v92, v93
    v_cvt_pk_bf16_f32 v111, v94, v95
    s_nop 1
    v_permlane16_swap_b32 v108, v110
    v_permlane16_swap_b32 v109, v111
    buffer_store_dwordx4 v[108:111], v9, s[12:15], s63 offen sc1
    s_add_u32 s63, s63, 262144
    s_mov_b32 s67, 0
    s_mov_b32 s71, 1
    s_cmp_gt_u32 s66, s60
    s_cbranch_scc1 L_g_g1r_118
    v_mov_b32 v10, 1
    s_mov_b64 exec, 1
    s_waitcnt vmcnt(0)
    ds_add_rtn_u32 v10, v15, v10 offset:4
    s_waitcnt lgkmcnt(0)
    v_readfirstlane_b32 s46, v10
    s_mov_b64 exec, -1
    s_mov_b32 s71, 0
    s_sub_u32 s59, s60, 1
    s_cmp_lg_u32 s46, s68
    s_cbranch_scc1 L_g_df_140
    v_mov_b32 v10, s59
    v_add_u32 v10, 1, v10
    v_mov_b32 v11, 0
    s_mov_b64 exec, 1
    buffer_store_dword v10, v11, s[12:15], s52 offen sc1
    s_mov_b64 exec, -1
L_sf_141:
L_g_df_140:
    s_add_u32 s68, s68, 4
    s_cmp_gt_u32 s66, s60
    s_cbranch_scc1 L_g_g1r_118
L_g_tail_121:
    s_cmp_lt_u32 s60, s75
    s_cbranch_scc1 L_g_restart_116
    s_waitcnt vmcnt(0)
    s_barrier
    s_branch L_c_done_1
L_g_dp_131_l:
    s_cmp_ge_u32 s62, s66
    s_cbranch_scc1 L_g_dp_131_d
    s_mov_b32 s65, 1
    s_add_u32 s47, s61, 4096
    s_mov_b32 m0, s64
    s_add_u32 s62, s62, 1
    buffer_load_dwordx4 v3, s[12:15], s61 offen offset:0 sc1 lds
    buffer_load_dwordx4 v3, s[12:15], s61 offen offset:1024 sc1 lds
    buffer_load_dwordx4 v3, s[12:15], s61 offen offset:2048 sc1 lds
    buffer_load_dwordx4 v3, s[12:15], s61 offen offset:3072 sc1 lds
    s_add_u32 m0, s64, 4096
    s_add_u32 s61, s61, 229376
    buffer_load_dwordx4 v3, s[12:15], s47 offen offset:0 sc1 lds
    buffer_load_dwordx4 v3, s[12:15], s47 offen offset:1024 sc1 lds
    buffer_load_dwordx4 v3, s[12:15], s47 offen offset:2048 sc1 lds
    s_xor_b32 s64, s64, 0x10000
    s_branch L_g_dp_131_a
L_g_nw_128:
    s_waitcnt vmcnt(0) lgkmcnt(0)
    s_branch L_g_loop0_119_l
L_g_nfl_133:
    s_cmp_eq_u32 s71, 0
    s_cbranch_scc1 L_g_nfl_133_d
    v_mov_b32 v10, 1
    s_mov_b64 exec, 1
    s_waitcnt vmcnt(0)
    ds_add_rtn_u32 v10, v15, v10 offset:4
    s_waitcnt lgkmcnt(0)
    v_readfirstlane_b32 s46, v10
    s_mov_b64 exec, -1
    s_mov_b32 s71, 0
    s_sub_u32 s59, s60, 1
    s_cmp_lg_u32 s46, s68
    s_cbranch_scc1 L_g_df_142
    v_mov_b32 v10, s59
    v_add_u32 v10, 1, v10
    v_mov_b32 v11, 0
    s_mov_b64 exec, 1
    buffer_store_dword v10, v11, s[12:15], s52 offen sc1
    s_mov_b64 exec, -1
L_sf_143:
L_g_df_142:
    s_add_u32 s68, s68, 4
    s_mov_b32 s65, 2
    s_branch L_g_nfl_133_d
L_g_dp_138_l:
    s_cmp_ge_u32 s62, s66
    s_cbranch_scc1 L_g_dp_138_d
    s_or_b32 s65, s65, 1
    s_add_u32 s47, s61, 4096
    s_mov_b32 m0, s64
    s_add_u32 s62, s62, 1
    buffer_load_dwordx4 v3, s[12:15], s61 offen offset:0 sc1 lds
    buffer_load_dwordx4 v3, s[12:15], s61 offen offset:1024 sc1 lds
    buffer_load_dwordx4 v3, s[12:15], s61 offen offset:2048 sc1 lds
    buffer_load_dwordx4 v3, s[12:15], s61 offen offset:3072 sc1 lds
    s_add_u32 m0, s64, 4096
    s_add_u32 s61, s61, 229376
    buffer_load_dwordx4 v3, s[12:15], s47 offen offset:0 sc1 lds
    buffer_load_dwordx4 v3, s[12:15], s47 offen offset:1024 sc1 lds
    buffer_load_dwordx4 v3, s[12:15], s47 offen offset:2048 sc1 lds
    s_xor_b32 s64, s64, 0x10000
    s_branch L_g_dp_138_a
L_g_nw1_135:
    s_cmp_eq_u32 s65, 2
    s_cbranch_scc1 L_g_nw1_135_w
    s_waitcnt vmcnt(0)
L_g_nw1_135_w:
    s_barrier
    ds_read_b128 v[32:35], v4 offset:0
    ds_read_b128 v[36:39], v4 offset:256
    ds_read_b128 v[40:43], v4 offset:2048
    ds_read_b128 v[44:47], v4 offset:2304
    ds_read_b128 v[48:51], v4 offset:4096
    ds_read_b128 v[52:55], v4 offset:4352
    ds_read_b128 v[56:59], v4 offset:6144
    ds_read_b128 v[60:63], v4 offset:6400
    s_branch L_g_jn_137
L_w_wo_12:
    s_load_dwordx2 s[4:5], s[0:1], 40
    s_load_dwordx2 s[6:7], s[0:1], 72
    s_and_b32 s50, s44, 3
    s_lshr_b32 s51, s44, 2
    s_waitcnt lgkmcnt(0)
    s_mov_b32 s24, s4
    s_and_b32 s25, s5, 0xffff
    s_mov_b32 s26, 0x800000
    s_mov_b32 s27, 0x00020000
    v_lshrrev_b32 v3, 4, v1
    v_and_b32 v4, 15, v1
    v_lshlrev_b32 v5, 2, v3
    v_xor_b32 v4, v4, v5
    v_mul_u32_u24 v3, 2048, v3
    v_lshl_add_u32 v3, v4, 4, v3
    s_mul_i32 s46, s51, 512
    s_mul_i32 s47, s50, 16
    s_add_u32 s46, s46, s47
    s_mul_i32 s47, s42, 1024
    s_add_u32 s46, s46, s47
    s_mul_i32 s46, s46, 2048
    s_lshl_b32 s47, s43, 8
    s_add_u32 s46, s46, s47
    s_lshl_b32 s45, s51, 16
    s_mul_i32 s47, s50, 4096
    s_add_u32 s45, s45, s47
    v_bfe_u32 v4, v1, 2, 2
    v_bfe_u32 v5, v1, 4, 1
    v_lshlrev_b32 v5, 1, v5
    v_bfe_u32 v6, v1, 1, 1
    v_add_u32 v5, v5, v6
    s_lshl_b32 s47, s50, 2
    v_add_u32 v5, s47, v5
    v_lshlrev_b32 v6, 2, v4
    v_xor_b32 v5, v5, v6
    v_lshlrev_b32 v5, 4, v5
    v_lshl_add_u32 v5, v4, 8, v5
    v_bfe_u32 v6, v1, 0, 1
    v_lshl_add_u32 v5, v6, 3, v5
    v_lshrrev_b32 v6, 5, v1
    v_mul_u32_u24 v6, 1024, v6
    v_add_u32 v5, v5, v6
    s_lshl_b32 s47, s51, 16
    v_add_u32 v5, s47, v5
    v_bfe_u32 v4, v1, 2, 2
    v_xor_b32 v5, s50, v4
    v_lshlrev_b32 v5, 6, v5
    v_lshl_add_u32 v5, v4, 8, v5
    v_and_b32 v6, 3, v1
    v_lshl_add_u32 v5, v6, 3, v5
    v_lshrrev_b32 v6, 4, v1
    v_lshl_add_u32 v5, v6, 10, v5
    v_lshrrev_b32 v6, 5, v1
    s_lshl_b32 s47, s51, 16
    v_add_u32 v5, s47, v5
    s_add_u32 m0, s45, 0
    s_add_u32 s47, s46, 0x0
    buffer_load_dwordx4 v3, s[24:27], s47 offen lds
    s_add_u32 m0, s45, 1024
    s_add_u32 s47, s46, 0x2000
    buffer_load_dwordx4 v3, s[24:27], s47 offen lds
    s_add_u32 m0, s45, 2048
    s_add_u32 s47, s46, 0x4000
    buffer_load_dwordx4 v3, s[24:27], s47 offen lds
    s_add_u32 m0, s45, 3072
    s_add_u32 s47, s46, 0x6000
    buffer_load_dwordx4 v3, s[24:27], s47 offen lds
    s_add_u32 m0, s45, 16384
    s_add_u32 s47, s46, 0x20000
    buffer_load_dwordx4 v3, s[24:27], s47 offen lds
    s_add_u32 m0, s45, 17408
    s_add_u32 s47, s46, 0x22000
    buffer_load_dwordx4 v3, s[24:27], s47 offen lds
    s_add_u32 m0, s45, 18432
    s_add_u32 s47, s46, 0x24000
    buffer_load_dwordx4 v3, s[24:27], s47 offen lds
    s_add_u32 m0, s45, 19456
    s_add_u32 s47, s46, 0x26000
    buffer_load_dwordx4 v3, s[24:27], s47 offen lds
    s_add_u32 m0, s45, 32768
    s_add_u32 s47, s46, 0x40000
    buffer_load_dwordx4 v3, s[24:27], s47 offen lds
    s_add_u32 m0, s45, 33792
    s_add_u32 s47, s46, 0x42000
    buffer_load_dwordx4 v3, s[24:27], s47 offen lds
    s_add_u32 m0, s45, 34816
    s_add_u32 s47, s46, 0x44000
    buffer_load_dwordx4 v3, s[24:27], s47 offen lds
    s_add_u32 m0, s45, 35840
    s_add_u32 s47, s46, 0x46000
    buffer_load_dwordx4 v3, s[24:27], s47 offen lds
    s_add_u32 m0, s45, 49152
    s_add_u32 s47, s46, 0x60000
    buffer_load_dwordx4 v3, s[24:27], s47 offen lds
    s_add_u32 m0, s45, 50176
    s_add_u32 s47, s46, 0x62000
    buffer_load_dwordx4 v3, s[24:27], s47 offen lds
    s_add_u32 m0, s45, 51200
    s_add_u32 s47, s46, 0x64000
    buffer_load_dwordx4 v3, s[24:27], s47 offen lds
    s_add_u32 m0, s45, 52224
    s_add_u32 s47, s46, 0x66000
    buffer_load_dwordx4 v3, s[24:27], s47 offen lds
    s_waitcnt vmcnt(12) lgkmcnt(0)
    s_barrier
    ds_read_b64_tr_b16 a[0:1], v5 offset:0
    ds_read_b64_tr_b16 a[2:3], v5 offset:4096
    ds_read_b64_tr_b16 a[4:5], v5 offset:32
    ds_read_b64_tr_b16 a[6:7], v5 offset:4128
    ds_read_b64_tr_b16 a[8:9], v5 offset:8192
    ds_read_b64_tr_b16 a[10:11], v5 offset:12288
    ds_read_b64_tr_b16 a[12:13], v5 offset:8224
    ds_read_b64_tr_b16 a[14:15], v5 offset:12320
    s_waitcnt vmcnt(8) lgkmcnt(0)
    s_barrier
    s_add_u32 m0, s45, 0
    s_add_u32 s47, s46, 0x80000
    buffer_load_dwordx4 v3, s[24:27], s47 offen lds
    s_add_u32 m0, s45, 1024
    s_add_u32 s47, s46, 0x82000
    buffer_load_dwordx4 v3, s[24:27], s47 offen lds
    s_add_u32 m0, s45, 2048
    s_add_u32 s47, s46, 0x84000
    buffer_load_dwordx4 v3, s[24:27], s47 offen lds
    s_add_u32 m0, s45, 3072
    s_add_u32 s47, s46, 0x86000
    buffer_load_dwordx4 v3, s[24:27], s47 offen lds
    ds_read_b64_tr_b16 a[16:17], v5 offset:16384
    ds_read_b64_tr_b16 a[18:19], v5 offset:20480
    ds_read_b64_tr_b16 a[20:21], v5 offset:16416
    ds_read_b64_tr_b16 a[22:23], v5 offset:20512
    ds_read_b64_tr_b16 a[24:25], v5 offset:24576
    ds_read_b64_tr_b16 a[26:27], v5 offset:28672
    ds_read_b64_tr_b16 a[28:29], v5 offset:24608
    ds_read_b64_tr_b16 a[30:31], v5 offset:28704
    s_waitcnt vmcnt(8) lgkmcnt(0)
    s_barrier
    s_add_u32 m0, s45, 16384
    s_add_u32 s47, s46, 0xa0000
    buffer_load_dwordx4 v3, s[24:27], s47 offen lds
    s_add_u32 m0, s45, 17408
    s_add_u32 s47, s46, 0xa2000
    buffer_load_dwordx4 v3, s[24:27], s47 offen lds
    s_add_u32 m0, s45, 18432
    s_add_u32 s47, s46, 0xa4000
    buffer_load_dwordx4 v3, s[24:27], s47 offen lds
    s_add_u32 m0, s45, 19456
    s_add_u32 s47, s46, 0xa6000
    buffer_load_dwordx4 v3, s[24:27], s47 offen lds
    ds_read_b64_tr_b16 a[32:33], v5 offset:32768
    ds_read_b64_tr_b16 a[34:35], v5 offset:36864
    ds_read_b64_tr_b16 a[36:37], v5 offset:32800
    ds_read_b64_tr_b16 a[38:39], v5 offset:36896
    ds_read_b64_tr_b16 a[40:41], v5 offset:40960
    ds_read_b64_tr_b16 a[42:43], v5 offset:45056
    ds_read_b64_tr_b16 a[44:45], v5 offset:40992
    ds_read_b64_tr_b16 a[46:47], v5 offset:45088
    s_waitcnt vmcnt(8) lgkmcnt(0)
    s_barrier
    s_add_u32 m0, s45, 32768
    s_add_u32 s47, s46, 0xc0000
    buffer_load_dwordx4 v3, s[24:27], s47 offen lds
    s_add_u32 m0, s45, 33792
    s_add_u32 s47, s46, 0xc2000
    buffer_load_dwordx4 v3, s[24:27], s47 offen lds
    s_add_u32 m0, s45, 34816
    s_add_u32 s47, s46, 0xc4000
    buffer_load_dwordx4 v3, s[24:27], s47 offen lds
    s_add_u32 m0, s45, 35840
    s_add_u32 s47, s46, 0xc6000
    buffer_load_dwordx4 v3, s[24:27], s47 offen lds
    ds_read_b64_tr_b16 a[48:49], v5 offset:49152
    ds_read_b64_tr_b16 a[50:51], v5 offset:53248
    ds_read_b64_tr_b16 a[52:53], v5 offset:49184
    ds_read_b64_tr_b16 a[54:55], v5 offset:53280
    ds_read_b64_tr_b16 a[56:57], v5 offset:57344
    ds_read_b64_tr_b16 a[58:59], v5 offset:61440
    ds_read_b64_tr_b16 a[60:61], v5 offset:57376
    ds_read_b64_tr_b16 a[62:63], v5 offset:61472
    s_waitcnt vmcnt(8) lgkmcnt(0)
    s_barrier
    s_add_u32 m0, s45, 49152
    s_add_u32 s47, s46, 0xe0000
    buffer_load_dwordx4 v3, s[24:27], s47 offen lds
    s_add_u32 m0, s45, 50176
    s_add_u32 s47, s46, 0xe2000
    buffer_load_dwordx4 v3, s[24:27], s47 offen lds
    s_add_u32 m0, s45, 51200
    s_add_u32 s47, s46, 0xe4000
    buffer_load_dwordx4 v3, s[24:27], s47 offen lds
    s_add_u32 m0, s45, 52224
    s_add_u32 s47, s46, 0xe6000
    buffer_load_dwordx4 v3, s[24:27], s47 offen lds
    ds_read_b64_tr_b16 a[64:65], v5 offset:0
    ds_read_b64_tr_b16 a[66:67], v5 offset:4096
    ds_read_b64_tr_b16 a[68:69], v5 offset:32
    ds_read_b64_tr_b16 a[70:71], v5 offset:4128
    ds_read_b64_tr_b16 a[72:73], v5 offset:8192
    ds_read_b64_tr_b16 a[74:75], v5 offset:12288
    ds_read_b64_tr_b16 a[76:77], v5 offset:8224
    ds_read_b64_tr_b16 a[78:79], v5 offset:12320
    s_waitcnt vmcnt(8) lgkmcnt(0)
    s_barrier
    ds_read_b64_tr_b16 a[80:81], v5 offset:16384
    ds_read_b64_tr_b16 a[82:83], v5 offset:20480
    ds_read_b64_tr_b16 a[84:85], v5 offset:16416
    ds_read_b64_tr_b16 a[86:87], v5 offset:20512
    ds_read_b64_tr_b16 a[88:89], v5 offset:24576
    ds_read_b64_tr_b16 a[90:91], v5 offset:28672
    ds_read_b64_tr_b16 a[92:93], v5 offset:24608
    ds_read_b64_tr_b16 a[94:95], v5 offset:28704
    s_waitcnt vmcnt(4) lgkmcnt(0)
    s_barrier
    ds_read_b64_tr_b16 a[96:97], v5 offset:32768
    ds_read_b64_tr_b16 a[98:99], v5 offset:36864
    ds_read_b64_tr_b16 a[100:101], v5 offset:32800
    ds_read_b64_tr_b16 a[102:103], v5 offset:36896
    ds_read_b64_tr_b16 a[104:105], v5 offset:40960
    ds_read_b64_tr_b16 a[106:107], v5 offset:45056
    ds_read_b64_tr_b16 a[108:109], v5 offset:40992
    ds_read_b64_tr_b16 a[110:111], v5 offset:45088
    s_waitcnt vmcnt(0) lgkmcnt(0)
    s_barrier
    ds_read_b64_tr_b16 a[112:113], v5 offset:49152
    ds_read_b64_tr_b16 a[114:115], v5 offset:53248
    ds_read_b64_tr_b16 a[116:117], v5 offset:49184
    ds_read_b64_tr_b16 a[118:119], v5 offset:53280
    ds_read_b64_tr_b16 a[120:121], v5 offset:57344
    ds_read_b64_tr_b16 a[122:123], v5 offset:61440
    ds_read_b64_tr_b16 a[124:125], v5 offset:57376
    ds_read_b64_tr_b16 a[126:127], v5 offset:61472
    s_waitcnt lgkmcnt(0)
    s_barrier
    s_load_dwordx2 s[8:9], s[0:1], 64
    s_load_dwordx2 s[10:11], s[0:1], 80
    s_lshl_b32 s46, s42, 3
    s_add_u32 s46, s46, s43
    s_mul_i32 s46, s46, 229376
    s_mul_i32 s47, s44, 28672
    s_add_u32 s46, s46, s47
    v_lshlrev_b32 v10, 7, v1
    s_waitcnt lgkmcnt(0)
    s_mov_b32 s28, s8
    s_and_b32 s29, s9, 0xffff
    s_mov_b32 s30, 0x700000
    s_mov_b32 s31, 0x00020000
    s_mov_b32 s32, s10
    s_and_b32 s33, s11, 0xffff
    s_mov_b32 s34, 0x700000
    s_mov_b32 s35, 0x00020000
    s_add_u32 s47, s46, 0
    buffer_load_dword v120, v10, s[28:31], s47 offen
    s_add_u32 s47, s46, 8192
    buffer_load_dword v121, v10, s[28:31], s47 offen
    s_add_u32 s47, s46, 16384
    buffer_load_dword v122, v10, s[28:31], s47 offen
    s_add_u32 s47, s46, 20480
    buffer_load_dword v123, v10, s[28:31], s47 offen
    v_lshlrev_b32 v2, 4, v1
    s_mul_i32 s64, s44, 8192
    s_add_u32 s46, s64, 0x5000000
    s_mul_i32 s47, s42, 65536
    s_add_u32 s46, s46, s47
    v_add_u32 v3, s46, v2
    s_mul_i32 s46, s51, 32768
    v_add_u32 v4, s46, v2
    v_and_b32 v6, 15, v1
    v_lshlrev_b32 v6, 4, v6
    v_lshrrev_b32 v7, 4, v1
    v_lshl_add_u32 v6, v7, 9, v6
    v_add_u32 v4, s46, v6
    s_lshl_b32 s46, s50, 12
    s_add_u32 s46, s46, 131072
    v_add_u32 v5, s46, v2
    v_and_b32 v7, 7, v1
    v_lshlrev_b32 v7, 9, v7
    s_lshl_b32 s46, s42, 12
    s_add_u32 s46, s46, 0x102000
    v_add_u32 v7, s46, v7
    s_lshl_b32 s46, s42, 16
    s_lshl_b32 s47, s43, 11
    s_add_u32 s46, s46, s47
    s_lshl_b32 s47, s50, 9
    s_add_u32 s46, s46, s47
    s_add_u32 s46, s46, 0x9000000
    v_and_b32 v8, 31, v1
    v_lshlrev_b32 v8, 4, v8
    v_lshrrev_b32 v9, 5, v1
    v_lshl_add_u32 v8, v9, 14, v8
    v_add_u32 v8, s46, v8
    v_add_u32 v9, 0x8000, v8
    s_lshl_b32 s52, s43, 9
    s_lshl_b32 s47, s42, 7
    s_add_u32 s52, s52, s47
    s_add_u32 s52, s52, 0x107400
    s_add_u32 s52, s52, s76
    s_mul_i32 s46, s43, 8192
    s_add_u32 s46, s46, 0x5000000
    s_mul_i32 s47, s42, 65536
    s_add_u32 s46, s46, s47
    v_min_u32 v116, 63, v1
    v_lshlrev_b32 v116, 7, v116
    v_add_u32 v116, s46, v116
    s_mov_b32 s60, s74
    s_mul_i32 s61, s74, 262144
    s_mov_b32 s62, s74
    s_mul_i32 s63, s74, 262144
    s_mov_b32 s67, 0
    s_mov_b32 s68, 3
    s_mov_b32 s71, 0
    v_mov_b32 v15, 147456
    v_mov_b32 v14, 0
    ds_write_b32 v15, v14 offset:4
    ds_write_b32 v15, v14 offset:12
    ds_write_b32 v15, v14 offset:16
    v_mov_b32 v114, 1
    v_mov_b32 v115, 0
    v_lshrrev_b32 v113, 4, v1
    s_mov_b32 s72, 0
L_g_restart_144:
    s_cmp_lg_u32 s44, 0
    s_cbranch_scc1 L_g_nsp_145
    s_mov_b32 s70, 0
L_g_sp_151:
    s_add_u32 s54, s60, 0
    v_add_u32 v12, s54, v113
    v_and_b32 v13, 3, v12
    v_lshl_add_u32 v13, v13, 7, v7
    buffer_load_dword v11, v13, s[12:15], 0 offen sc1
    s_waitcnt vmcnt(0)
    v_cmp_ge_u32 vcc, v12, v11
    s_add_u32 s70, s70, 1
    s_and_b32 s46, vcc_lo, 0xffff
    s_cbranch_scc0 L_g_sp_151_ok
    s_sleep 3
    s_cmp_lt_u32 s70, 524288
    s_cbranch_scc1 L_g_sp_151
    s_branch L_c_done_1
L_g_sp_151_ok:
    v_cmp_ge_u32 vcc, v12, v11
    s_nop 0
    s_ff1_i32_b64 s46, vcc
    s_lshr_b32 s46, s46, 4
    s_min_u32 s46, s46, 4
    s_add_u32 s46, s46, s54
    s_min_u32 s46, s46, s75
    v_mov_b32 v11, s46
    ds_write_b32 v15, v11 offset:0
L_g_nsp_145:
    s_waitcnt lgkmcnt(0)
    s_barrier
    ds_read_b32 v14, v15 offset:0
    s_waitcnt lgkmcnt(0)
    v_readfirstlane_b32 s66, v14
    s_nop 3
L_g_restart_144_go:
    s_mov_b32 s69, 0
    s_cmp_gt_u32 s62, s60
    s_cbranch_scc1 L_g_nd_152
    s_cmp_ge_u32 s62, s66
    s_cbranch_scc1 L_g_nd_152
    s_add_u32 s47, s61, 4096
    s_add_u32 m0, s64, 0
    s_nop 0
    buffer_load_dwordx4 v3, s[12:15], s61 offen offset:0 sc1 lds
    buffer_load_dwordx4 v3, s[12:15], s61 offen offset:1024 sc1 lds
    buffer_load_dwordx4 v3, s[12:15], s61 offen offset:2048 sc1 lds
    buffer_load_dwordx4 v3, s[12:15], s61 offen offset:3072 sc1 lds
    s_add_u32 m0, s64, 4096
    s_nop 0
    buffer_load_dwordx4 v3, s[12:15], s47 offen offset:0 sc1 lds
    buffer_load_dwordx4 v3, s[12:15], s47 offen offset:1024 sc1 lds
    buffer_load_dwordx4 v3, s[12:15], s47 offen offset:2048 sc1 lds
    buffer_load_dwordx4 v3, s[12:15], s47 offen offset:3072 sc1 lds
    s_add_u32 s61, s61, 262144
    s_add_u32 s62, s62, 1
    s_xor_b32 s64, s64, 0x10000
    s_mov_b32 s69, 1
L_g_nd_152:
    s_cmp_eq_u32 s51, 1
    s_cbranch_scc1 L_g_g1r_146
    s_add_u32 s59, s60, 1
    s_mov_b32 s69, 0
    s_cmp_gt_u32 s62, s59
    s_cbranch_scc1 L_g_nd_153
    s_cmp_ge_u32 s62, s66
    s_cbranch_scc1 L_g_nd_153
    s_add_u32 s47, s61, 4096
    s_add_u32 m0, s64, 0
    s_nop 0
    buffer_load_dwordx4 v3, s[12:15], s61 offen offset:0 sc1 lds
    buffer_load_dwordx4 v3, s[12:15], s61 offen offset:1024 sc1 lds
    buffer_load_dwordx4 v3, s[12:15], s61 offen offset:2048 sc1 lds
    buffer_load_dwordx4 v3, s[12:15], s61 offen offset:3072 sc1 lds
    s_add_u32 m0, s64, 4096
    s_nop 0
    buffer_load_dwordx4 v3, s[12:15], s47 offen offset:0 sc1 lds
    buffer_load_dwordx4 v3, s[12:15], s47 offen offset:1024 sc1 lds
    buffer_load_dwordx4 v3, s[12:15], s47 offen offset:2048 sc1 lds
    buffer_load_dwordx4 v3, s[12:15], s47 offen offset:3072 sc1 lds
    s_add_u32 s61, s61, 262144
    s_add_u32 s62, s62, 1
    s_xor_b32 s64, s64, 0x10000
    s_mov_b32 s69, 1
L_g_nd_153:
    s_cmp_eq_u32 s69, 1
    s_cbranch_scc1 L_g_w0_154
    s_waitcnt vmcnt(0)
L_g_w0_154:
    s_waitcnt vmcnt(8)
    s_cmp_lg_u32 s44, 0
    s_cbranch_scc1 L_g_nl_155
    s_add_u32 s54, s60, 1
    v_add_u32 v12, s54, v113
    v_and_b32 v13, 3, v12
    v_lshl_add_u32 v13, v13, 7, v7
    buffer_load_dword v11, v13, s[12:15], 0 offen sc1
L_g_nl_155:
L_g_loop0_147_l:
    s_barrier
    ds_read_b128 v[32:35], v4 offset:0
    ds_read_b128 v[36:39], v4 offset:256
    ds_read_b128 v[40:43], v4 offset:2048
    ds_read_b128 v[44:47], v4 offset:2304
    ds_read_b128 v[48:51], v4 offset:4096
    ds_read_b128 v[52:55], v4 offset:4352
    ds_read_b128 v[56:59], v4 offset:6144
    ds_read_b128 v[60:63], v4 offset:6400
    s_branch L_g_loop0_147_m
.p2align 6
L_g_loop0_147:
    s_barrier
L_g_loop0_147_m:
    s_setprio 2
    s_waitcnt lgkmcnt(6)
    v_mfma_f32_16x16x32_bf16 v[16:19], v[32:35], a[0:3], 0
    ds_read_b32 v14, v15
    v_mfma_f32_16x16x32_bf16 v[20:23], v[32:35], a[4:7], 0
    ds_read_b128 v[32:35], v4 offset:8192
    v_mfma_f32_16x16x32_bf16 v[28:31], v[36:39], a[4:7], 0
    v_mfma_f32_16x16x32_bf16 v[24:27], v[36:39], a[0:3], 0
    ds_read_b128 v[36:39], v4 offset:8448
    s_waitcnt lgkmcnt(6)
    v_mfma_f32_16x16x32_bf16 v[16:19], v[40:43], a[8:11], v[16:19]
    v_mfma_f32_16x16x32_bf16 v[20:23], v[40:43], a[12:15], v[20:23]
    ds_read_b128 v[40:43], v4 offset:10240
    v_mfma_f32_16x16x32_bf16 v[28:31], v[44:47], a[12:15], v[28:31]
    v_mfma_f32_16x16x32_bf16 v[24:27], v[44:47], a[8:11], v[24:27]
    ds_read_b128 v[44:47], v4 offset:10496
    s_waitcnt lgkmcnt(6)
    v_mfma_f32_16x16x32_bf16 v[16:19], v[48:51], a[16:19], v[16:19]
    v_mfma_f32_16x16x32_bf16 v[20:23], v[48:51], a[20:23], v[20:23]
    ds_read_b128 v[48:51], v4 offset:12288
    v_mfma_f32_16x16x32_bf16 v[28:31], v[52:55], a[20:23], v[28:31]
    v_mfma_f32_16x16x32_bf16 v[24:27], v[52:55], a[16:19], v[24:27]
    ds_read_b128 v[52:55], v4 offset:12544
    s_waitcnt lgkmcnt(6)
    v_mfma_f32_16x16x32_bf16 v[16:19], v[56:59], a[24:27], v[16:19]
    v_mfma_f32_16x16x32_bf16 v[20:23], v[56:59], a[28:31], v[20:23]
    ds_read_b128 v[56:59], v4 offset:14336
    v_mfma_f32_16x16x32_bf16 v[28:31], v[60:63], a[28:31], v[28:31]
    v_mfma_f32_16x16x32_bf16 v[24:27], v[60:63], a[24:27], v[24:27]
    ds_read_b128 v[60:63], v4 offset:14592
    s_waitcnt lgkmcnt(6)
    v_mfma_f32_16x16x32_bf16 v[16:19], v[32:35], a[32:35], v[16:19]
    v_mfma_f32_16x16x32_bf16 v[20:23], v[32:35], a[36:39], v[20:23]
    ds_read_b128 v[32:35], v4 offset:16384
    v_mfma_f32_16x16x32_bf16 v[28:31], v[36:39], a[36:39], v[28:31]
    v_mfma_f32_16x16x32_bf16 v[24:27], v[36:39], a[32:35], v[24:27]
    ds_read_b128 v[36:39], v4 offset:16640
    s_waitcnt lgkmcnt(6)
    v_mfma_f32_16x16x32_bf16 v[16:19], v[40:43], a[40:43], v[16:19]
    v_mfma_f32_16x16x32_bf16 v[20:23], v[40:43], a[44:47], v[20:23]
    ds_read_b128 v[40:43], v4 offset:18432
    v_mfma_f32_16x16x32_bf16 v[28:31], v[44:47], a[44:47], v[28:31]
    v_mfma_f32_16x16x32_bf16 v[24:27], v[44:47], a[40:43], v[24:27]
    ds_read_b128 v[44:47], v4 offset:18688
    s_waitcnt lgkmcnt(6)
    v_mfma_f32_16x16x32_bf16 v[16:19], v[48:51], a[48:51], v[16:19]
    v_mfma_f32_16x16x32_bf16 v[20:23], v[48:51], a[52:55], v[20:23]
    ds_read_b128 v[48:51], v4 offset:20480
    v_mfma_f32_16x16x32_bf16 v[28:31], v[52:55], a[52:55], v[28:31]
    v_mfma_f32_16x16x32_bf16 v[24:27], v[52:55], a[48:51], v[24:27]
    ds_read_b128 v[52:55], v4 offset:20736
    s_waitcnt lgkmcnt(6)
    v_mfma_f32_16x16x32_bf16 v[16:19], v[56:59], a[56:59], v[16:19]
    v_mfma_f32_16x16x32_bf16 v[20:23], v[56:59], a[60:63], v[20:23]
    ds_read_b128 v[56:59], v4 offset:22528
    v_mfma_f32_16x16x32_bf16 v[28:31], v[60:63], a[60:63], v[28:31]
    v_mfma_f32_16x16x32_bf16 v[24:27], v[60:63], a[56:59], v[24:27]
    ds_read_b128 v[60:63], v4 offset:22784
    s_waitcnt lgkmcnt(6)
    v_mfma_f32_16x16x32_bf16 v[16:19], v[32:35], a[64:67], v[16:19]
    v_mfma_f32_16x16x32_bf16 v[20:23], v[32:35], a[68:71], v[20:23]
    ds_read_b128 v[32:35], v4 offset:24576
    v_mfma_f32_16x16x32_bf16 v[28:31], v[36:39], a[68:71], v[28:31]
    v_mfma_f32_16x16x32_bf16 v[24:27], v[36:39], a[64:67], v[24:27]
    ds_read_b128 v[36:39], v4 offset:24832
    s_waitcnt lgkmcnt(6)
    v_mfma_f32_16x16x32_bf16 v[16:19], v[40:43], a[72:75], v[16:19]
    v_mfma_f32_16x16x32_bf16 v[20:23], v[40:43], a[76:79], v[20:23]
    ds_read_b128 v[40:43], v4 offset:26624
    v_mfma_f32_16x16x32_bf16 v[28:31], v[44:47], a[76:79], v[28:31]
    v_mfma_f32_16x16x32_bf16 v[24:27], v[44:47], a[72:75], v[24:27]
    ds_read_b128 v[44:47], v4 offset:26880
    s_waitcnt lgkmcnt(6)
    v_mfma_f32_16x16x32_bf16 v[16:19], v[48:51], a[80:83], v[16:19]
    v_mfma_f32_16x16x32_bf16 v[20:23], v[48:51], a[84:87], v[20:23]
    ds_read_b128 v[48:51], v4 offset:28672
    v_mfma_f32_16x16x32_bf16 v[28:31], v[52:55], a[84:87], v[28:31]
    v_mfma_f32_16x16x32_bf16 v[24:27], v[52:55], a[80:83], v[24:27]
    ds_read_b128 v[52:55], v4 offset:28928
    s_waitcnt lgkmcnt(6)
    v_mfma_f32_16x16x32_bf16 v[16:19], v[56:59], a[88:91], v[16:19]
    v_mfma_f32_16x16x32_bf16 v[20:23], v[56:59], a[92:95], v[20:23]
    ds_read_b128 v[56:59], v4 offset:30720
    v_mfma_f32_16x16x32_bf16 v[28:31], v[60:63], a[92:95], v[28:31]
    v_mfma_f32_16x16x32_bf16 v[24:27], v[60:63], a[88:91], v[24:27]
    ds_read_b128 v[60:63], v4 offset:30976
    s_waitcnt lgkmcnt(6)
    v_mfma_f32_16x16x32_bf16 v[16:19], v[32:35], a[96:99], v[16:19]
    v_mfma_f32_16x16x32_bf16 v[20:23], v[32:35], a[100:103], v[20:23]
    v_mfma_f32_16x16x32_bf16 v[28:31], v[36:39], a[100:103], v[28:31]
    v_mfma_f32_16x16x32_bf16 v[24:27], v[36:39], a[96:99], v[24:27]
    s_waitcnt lgkmcnt(4)
    v_mfma_f32_16x16x32_bf16 v[16:19], v[40:43], a[104:107], v[16:19]
    v_mfma_f32_16x16x32_bf16 v[20:23], v[40:43], a[108:111], v[20:23]
    v_mfma_f32_16x16x32_bf16 v[28:31], v[44:47], a[108:111], v[28:31]
    v_mfma_f32_16x16x32_bf16 v[24:27], v[44:47], a[104:107], v[24:27]
    s_waitcnt lgkmcnt(2)
    v_mfma_f32_16x16x32_bf16 v[16:19], v[48:51], a[112:115], v[16:19]
    v_mfma_f32_16x16x32_bf16 v[20:23], v[48:51], a[116:119], v[20:23]
    v_mfma_f32_16x16x32_bf16 v[28:31], v[52:55], a[116:119], v[28:31]
    v_mfma_f32_16x16x32_bf16 v[24:27], v[52:55], a[112:115], v[24:27]
    s_waitcnt lgkmcnt(0)
    v_mfma_f32_16x16x32_bf16 v[16:19], v[56:59], a[120:123], v[16:19]
    v_mfma_f32_16x16x32_bf16 v[20:23], v[56:59], a[124:127], v[20:23]
    v_mfma_f32_16x16x32_bf16 v[28:31], v[60:63], a[124:127], v[28:31]
    v_mfma_f32_16x16x32_bf16 v[24:27], v[60:63], a[120:123], v[24:27]
    v_xor_b32 v4, 0x10000, v4
    s_setprio 0
    s_waitcnt vmcnt(0)
    v_readfirstlane_b32 s66, v14
    s_barrier
    s_nop 6
    ds_write_b128 v5, v[16:19] offset:0
    ds_write_b128 v5, v[20:23] offset:1024
    ds_write_b128 v5, v[24:27] offset:2048
    ds_write_b128 v5, v[28:31] offset:3072
    s_cmp_lg_u32 s44, 0
    s_cbranch_scc1 L_g_ne_156
    v_cmp_ge_u32 vcc, v12, v11
    s_nop 0
    s_ff1_i32_b64 s46, vcc
    s_lshr_b32 s46, s46, 4
    s_min_u32 s46, s46, 4
    s_add_u32 s46, s46, s54
    s_min_u32 s46, s46, s75
    v_mov_b32 v11, s46
    ds_write_b32 v15, v11 offset:0
L_g_ne_156:
    s_add_u32 s60, s60, 1
    s_mov_b32 s65, 0
    s_cmp_le_u32 s62, s60
    s_cbranch_scc1 L_g_dp_159_l
L_g_dp_159_a:
    s_cmp_ge_u32 s62, s66
    s_cbranch_scc1 L_g_dp_159_d
    s_add_u32 s47, s61, 4096
    s_mov_b32 m0, s64
    s_add_u32 s62, s62, 1
    buffer_load_dwordx4 v3, s[12:15], s61 offen offset:0 sc1 lds
    buffer_load_dwordx4 v3, s[12:15], s61 offen offset:1024 sc1 lds
    buffer_load_dwordx4 v3, s[12:15], s61 offen offset:2048 sc1 lds
    buffer_load_dwordx4 v3, s[12:15], s61 offen offset:3072 sc1 lds
    s_add_u32 m0, s64, 4096
    s_add_u32 s61, s61, 262144
    buffer_load_dwordx4 v3, s[12:15], s47 offen offset:0 sc1 lds
    buffer_load_dwordx4 v3, s[12:15], s47 offen offset:1024 sc1 lds
    buffer_load_dwordx4 v3, s[12:15], s47 offen offset:2048 sc1 lds
    buffer_load_dwordx4 v3, s[12:15], s47 offen offset:3072 sc1 lds
    s_xor_b32 s64, s64, 0x10000
L_g_dp_159_d:
    s_cmp_lg_u32 s44, 2
    s_cbranch_scc1 L_g_pf_160
    s_cmp_ge_u32 s62, s66
    s_cbranch_scc1 L_g_pf_160
    buffer_load_dword v117, v116, s[12:15], s61 offen sc1
L_g_pf_160:
    s_cmp_le_u32 s66, s60
    s_cbranch_scc1 L_g_ex0_158
    s_cmp_lg_u32 s65, 0
    s_cbranch_scc1 L_g_nw_157
    ds_read_b128 v[32:35], v4 offset:0
    ds_read_b128 v[36:39], v4 offset:256
    ds_read_b128 v[40:43], v4 offset:2048
    ds_read_b128 v[44:47], v4 offset:2304
    ds_read_b128 v[48:51], v4 offset:4096
    ds_read_b128 v[52:55], v4 offset:4352
    ds_read_b128 v[56:59], v4 offset:6144
    ds_read_b128 v[60:63], v4 offset:6400
    s_cmp_lg_u32 s44, 0
    s_cbranch_scc1 L_g_nl_161
    s_add_u32 s54, s60, 1
    v_add_u32 v12, s54, v113
    v_and_b32 v13, 3, v12
    v_lshl_add_u32 v13, v13, 7, v7
    buffer_load_dword v11, v13, s[12:15], 0 offen sc1
L_g_nl_161:
    s_waitcnt lgkmcnt(8)
    s_branch L_g_loop0_147
L_g_ex0_158:
    s_cmp_lg_u32 s44, 0
    s_cbranch_scc1 L_g_ex0_158_n
    s_sleep 6
    s_add_u32 s54, s60, 0
    v_add_u32 v12, s54, v113
    v_and_b32 v13, 3, v12
    v_lshl_add_u32 v13, v13, 7, v7
    buffer_load_dword v11, v13, s[12:15], 0 offen sc1
    s_waitcnt vmcnt(0)
    v_cmp_ge_u32 vcc, v12, v11
    s_nop 0
    s_ff1_i32_b64 s46, vcc
    s_lshr_b32 s46, s46, 4
    s_min_u32 s46, s46, 4
    s_add_u32 s46, s46, s54
    s_min_u32 s46, s46, s75
    v_mov_b32 v11, s46
    ds_write_b32 v15, v11 offset:0
L_g_ex0_158_n:
    s_waitcnt lgkmcnt(0)
    s_barrier
    ds_read_b32 v14, v15 offset:0
    s_waitcnt lgkmcnt(0)
    v_readfirstlane_b32 s66, v14
    s_barrier
    s_cmp_gt_u32 s66, s60
    s_cbranch_scc1 L_g_restart_144_go
    s_branch L_g_tail_149
L_g_g1r_146:
    s_mov_b32 s65, 1
    s_branch L_g_loop1_148_e
.p2align 6
L_g_loop1_148:
    s_mov_b32 s65, 0
L_g_loop1_148_e:
    s_barrier
    ds_read_b32 v14, v15
    s_bitcmp1_b32 s67, 1
    s_cbranch_scc0 L_g_nfl_162
    s_cmp_lg_u32 s44, 4
    s_cbranch_scc1 L_g_nfl_162_d
    s_sub_u32 s59, s60, 1
    v_mov_b32 v10, s59
    buffer_store_dword v10, v115, s[12:15], s52 offen sc1
L_g_nfl_162_d:
    s_waitcnt lgkmcnt(0)
    v_readfirstlane_b32 s66, v14
    ds_read_b128 v[80:83], v5 offset:0
    ds_read_b128 v[84:87], v5 offset:1024
    ds_read_b128 v[88:91], v5 offset:2048
    ds_read_b128 v[92:95], v5 offset:3072
    s_cmp_le_u32 s62, s60
    s_cbranch_scc1 L_g_dp_167_l
L_g_dp_167_a:
    s_cmp_ge_u32 s62, s66
    s_cbranch_scc1 L_g_dp_167_d
    s_add_u32 s47, s61, 4096
    s_mov_b32 m0, s64
    s_add_u32 s62, s62, 1
    buffer_load_dwordx4 v3, s[12:15], s61 offen offset:0 sc1 lds
    buffer_load_dwordx4 v3, s[12:15], s61 offen offset:1024 sc1 lds
    buffer_load_dwordx4 v3, s[12:15], s61 offen offset:2048 sc1 lds
    buffer_load_dwordx4 v3, s[12:15], s61 offen offset:3072 sc1 lds
    s_add_u32 m0, s64, 4096
    s_add_u32 s61, s61, 262144
    buffer_load_dwordx4 v3, s[12:15], s47 offen offset:0 sc1 lds
    buffer_load_dwordx4 v3, s[12:15], s47 offen offset:1024 sc1 lds
    buffer_load_dwordx4 v3, s[12:15], s47 offen offset:2048 sc1 lds
    buffer_load_dwordx4 v3, s[12:15], s47 offen offset:3072 sc1 lds
    s_xor_b32 s64, s64, 0x10000
L_g_dp_167_d:
    s_bitcmp1_b32 s67, 0
    s_cbranch_scc0 L_g_nep_163
    s_waitcnt lgkmcnt(0)
    v_add_f32 v80, v80, v16
    v_add_f32 v81, v81, v17
    v_add_f32 v82, v82, v18
    v_add_f32 v83, v83, v19
    v_add_f32 v84, v84, v20
    v_add_f32 v85, v85, v21
    v_add_f32 v86, v86, v22
    v_add_f32 v87, v87, v23
    v_add_f32 v88, v88, v24
    v_add_f32 v89, v89, v25
    v_add_f32 v90, v90, v26
    v_add_f32 v91, v91, v27
    v_add_f32 v92, v92, v28
    v_add_f32 v93, v93, v29
    v_add_f32 v94, v94, v30
    v_add_f32 v95, v95, v31
    v_cvt_pk_bf16_f32 v104, v80, v81
    v_cvt_pk_bf16_f32 v105, v82, v83
    v_cvt_pk_bf16_f32 v106, v84, v85
    v_cvt_pk_bf16_f32 v107, v86, v87
    s_nop 1
    v_permlane16_swap_b32 v104, v106
    v_permlane16_swap_b32 v105, v107
    buffer_store_dwordx4 v[104:107], v8, s[12:15], s63 offen sc1
    v_cvt_pk_bf16_f32 v108, v88, v89
    v_cvt_pk_bf16_f32 v109, v90, v91
    v_cvt_pk_bf16_f32 v110, v92, v93
    v_cvt_pk_bf16_f32 v111, v94, v95
    s_nop 1
    v_permlane16_swap_b32 v108, v110
    v_permlane16_swap_b32 v109, v111
    buffer_store_dwordx4 v[108:111], v9, s[12:15], s63 offen sc1
    s_add_u32 s63, s63, 262144
L_g_nep_163:
    s_cmp_lg_u32 s65, 0
    s_cbranch_scc1 L_g_nw1_164
    ds_read_b128 v[32:35], v4 offset:0
    ds_read_b128 v[36:39], v4 offset:256
    ds_read_b128 v[40:43], v4 offset:2048
    ds_read_b128 v[44:47], v4 offset:2304
    ds_read_b128 v[48:51], v4 offset:4096
    ds_read_b128 v[52:55], v4 offset:4352
    ds_read_b128 v[56:59], v4 offset:6144
    ds_read_b128 v[60:63], v4 offset:6400
    s_barrier
L_g_jn_166:
    s_setprio 1
    s_waitcnt lgkmcnt(6)
    v_mfma_f32_16x16x32_bf16 v[16:19], v[32:35], a[0:3], 0
    v_mfma_f32_16x16x32_bf16 v[20:23], v[32:35], a[4:7], 0
    ds_read_b128 v[32:35], v4 offset:8192
    v_mfma_f32_16x16x32_bf16 v[28:31], v[36:39], a[4:7], 0
    v_mfma_f32_16x16x32_bf16 v[24:27], v[36:39], a[0:3], 0
    ds_read_b128 v[36:39], v4 offset:8448
    s_waitcnt lgkmcnt(6)
    v_mfma_f32_16x16x32_bf16 v[16:19], v[40:43], a[8:11], v[16:19]
    v_mfma_f32_16x16x32_bf16 v[20:23], v[40:43], a[12:15], v[20:23]
    ds_read_b128 v[40:43], v4 offset:10240
    v_mfma_f32_16x16x32_bf16 v[28:31], v[44:47], a[12:15], v[28:31]
    v_mfma_f32_16x16x32_bf16 v[24:27], v[44:47], a[8:11], v[24:27]
    ds_read_b128 v[44:47], v4 offset:10496
    s_waitcnt lgkmcnt(6)
    v_mfma_f32_16x16x32_bf16 v[16:19], v[48:51], a[16:19], v[16:19]
    v_mfma_f32_16x16x32_bf16 v[20:23], v[48:51], a[20:23], v[20:23]
    ds_read_b128 v[48:51], v4 offset:12288
    v_mfma_f32_16x16x32_bf16 v[28:31], v[52:55], a[20:23], v[28:31]
    v_mfma_f32_16x16x32_bf16 v[24:27], v[52:55], a[16:19], v[24:27]
    ds_read_b128 v[52:55], v4 offset:12544
    s_waitcnt lgkmcnt(6)
    v_mfma_f32_16x16x32_bf16 v[16:19], v[56:59], a[24:27], v[16:19]
    v_mfma_f32_16x16x32_bf16 v[20:23], v[56:59], a[28:31], v[20:23]
    ds_read_b128 v[56:59], v4 offset:14336
    v_mfma_f32_16x16x32_bf16 v[28:31], v[60:63], a[28:31], v[28:31]
    v_mfma_f32_16x16x32_bf16 v[24:27], v[60:63], a[24:27], v[24:27]
    ds_read_b128 v[60:63], v4 offset:14592
    s_waitcnt lgkmcnt(6)
    v_mfma_f32_16x16x32_bf16 v[16:19], v[32:35], a[32:35], v[16:19]
    v_mfma_f32_16x16x32_bf16 v[20:23], v[32:35], a[36:39], v[20:23]
    ds_read_b128 v[32:35], v4 offset:16384
    v_mfma_f32_16x16x32_bf16 v[28:31], v[36:39], a[36:39], v[28:31]
    v_mfma_f32_16x16x32_bf16 v[24:27], v[36:39], a[32:35], v[24:27]
    ds_read_b128 v[36:39], v4 offset:16640
    s_waitcnt lgkmcnt(6)
    v_mfma_f32_16x16x32_bf16 v[16:19], v[40:43], a[40:43], v[16:19]
    v_mfma_f32_16x16x32_bf16 v[20:23], v[40:43], a[44:47], v[20:23]
    ds_read_b128 v[40:43], v4 offset:18432
    v_mfma_f32_16x16x32_bf16 v[28:31], v[44:47], a[44:47], v[28:31]
    v_mfma_f32_16x16x32_bf16 v[24:27], v[44:47], a[40:43], v[24:27]
    ds_read_b128 v[44:47], v4 offset:18688
    s_waitcnt lgkmcnt(6)
    v_mfma_f32_16x16x32_bf16 v[16:19], v[48:51], a[48:51], v[16:19]
    v_mfma_f32_16x16x32_bf16 v[20:23], v[48:51], a[52:55], v[20:23]
    ds_read_b128 v[48:51], v4 offset:20480
    v_mfma_f32_16x16x32_bf16 v[28:31], v[52:55], a[52:55], v[28:31]
    v_mfma_f32_16x16x32_bf16 v[24:27], v[52:55], a[48:51], v[24:27]
    ds_read_b128 v[52:55], v4 offset:20736
    s_waitcnt lgkmcnt(6)
    v_mfma_f32_16x16x32_bf16 v[16:19], v[56:59], a[56:59], v[16:19]
    v_mfma_f32_16x16x32_bf16 v[20:23], v[56:59], a[60:63], v[20:23]
    ds_read_b128 v[56:59], v4 offset:22528
    v_mfma_f32_16x16x32_bf16 v[28:31], v[60:63], a[60:63], v[28:31]
    v_mfma_f32_16x16x32_bf16 v[24:27], v[60:63], a[56:59], v[24:27]
    ds_read_b128 v[60:63], v4 offset:22784
    s_waitcnt lgkmcnt(6)
    v_mfma_f32_16x16x32_bf16 v[16:19], v[32:35], a[64:67], v[16:19]
    v_mfma_f32_16x16x32_bf16 v[20:23], v[32:35], a[68:71], v[20:23]
    ds_read_b128 v[32:35], v4 offset:24576
    v_mfma_f32_16x16x32_bf16 v[28:31], v[36:39], a[68:71], v[28:31]
    v_mfma_f32_16x16x32_bf16 v[24:27], v[36:39], a[64:67], v[24:27]
    ds_read_b128 v[36:39], v4 offset:24832
    s_waitcnt lgkmcnt(6)
    v_mfma_f32_16x16x32_bf16 v[16:19], v[40:43], a[72:75], v[16:19]
    v_mfma_f32_16x16x32_bf16 v[20:23], v[40:43], a[76:79], v[20:23]
    ds_read_b128 v[40:43], v4 offset:26624
    v_mfma_f32_16x16x32_bf16 v[28:31], v[44:47], a[76:79], v[28:31]
    v_mfma_f32_16x16x32_bf16 v[24:27], v[44:47], a[72:75], v[24:27]
    ds_read_b128 v[44:47], v4 offset:26880
    s_waitcnt lgkmcnt(6)
    v_mfma_f32_16x16x32_bf16 v[16:19], v[48:51], a[80:83], v[16:19]
    v_mfma_f32_16x16x32_bf16 v[20:23], v[48:51], a[84:87], v[20:23]
    ds_read_b128 v[48:51], v4 offset:28672
    v_mfma_f32_16x16x32_bf16 v[28:31], v[52:55], a[84:87], v[28:31]
    v_mfma_f32_16x16x32_bf16 v[24:27], v[52:55], a[80:83], v[24:27]
    ds_read_b128 v[52:55], v4 offset:28928
    s_waitcnt lgkmcnt(6)
    v_mfma_f32_16x16x32_bf16 v[16:19], v[56:59], a[88:91], v[16:19]
    v_mfma_f32_16x16x32_bf16 v[20:23], v[56:59], a[92:95], v[20:23]
    ds_read_b128 v[56:59], v4 offset:30720
    v_mfma_f32_16x16x32_bf16 v[28:31], v[60:63], a[92:95], v[28:31]
    v_mfma_f32_16x16x32_bf16 v[24:27], v[60:63], a[88:91], v[24:27]
    ds_read_b128 v[60:63], v4 offset:30976
    s_waitcnt lgkmcnt(6)
    v_mfma_f32_16x16x32_bf16 v[16:19], v[32:35], a[96:99], v[16:19]
    v_mfma_f32_16x16x32_bf16 v[20:23], v[32:35], a[100:103], v[20:23]
    v_mfma_f32_16x16x32_bf16 v[28:31], v[36:39], a[100:103], v[28:31]
    v_mfma_f32_16x16x32_bf16 v[24:27], v[36:39], a[96:99], v[24:27]
    s_waitcnt lgkmcnt(4)
    v_mfma_f32_16x16x32_bf16 v[16:19], v[40:43], a[104:107], v[16:19]
    v_mfma_f32_16x16x32_bf16 v[20:23], v[40:43], a[108:111], v[20:23]
    v_mfma_f32_16x16x32_bf16 v[28:31], v[44:47], a[108:111], v[28:31]
    v_mfma_f32_16x16x32_bf16 v[24:27], v[44:47], a[104:107], v[24:27]
    s_waitcnt lgkmcnt(2)
    v_mfma_f32_16x16x32_bf16 v[16:19], v[48:51], a[112:115], v[16:19]
    v_mfma_f32_16x16x32_bf16 v[20:23], v[48:51], a[116:119], v[20:23]
    v_mfma_f32_16x16x32_bf16 v[28:31], v[52:55], a[116:119], v[28:31]
    v_mfma_f32_16x16x32_bf16 v[24:27], v[52:55], a[112:115], v[24:27]
    s_waitcnt lgkmcnt(0)
    v_mfma_f32_16x16x32_bf16 v[16:19], v[56:59], a[120:123], v[16:19]
    v_mfma_f32_16x16x32_bf16 v[20:23], v[56:59], a[124:127], v[20:23]
    v_mfma_f32_16x16x32_bf16 v[28:31], v[60:63], a[124:127], v[28:31]
    v_mfma_f32_16x16x32_bf16 v[24:27], v[60:63], a[120:123], v[24:27]
    v_xor_b32 v4, 0x10000, v4
    s_setprio 0
    s_waitcnt vmcnt(0)
    s_lshl_b32 s67, s67, 1
    s_or_b32 s67, s67, 1
    s_add_u32 s60, s60, 1
    s_cmp_gt_u32 s66, s60
    s_cbranch_scc1 L_g_loop1_148
    s_barrier
    ds_read_b32 v14, v15 offset:0
    s_waitcnt lgkmcnt(0)
    v_readfirstlane_b32 s66, v14
    s_barrier
    s_mov_b32 s69, 0
    s_cmp_gt_u32 s62, s60
    s_cbranch_scc1 L_g_nd_168
    s_cmp_ge_u32 s62, s66
    s_cbranch_scc1 L_g_nd_168
    s_add_u32 s47, s61, 4096
    s_add_u32 m0, s64, 0
    s_nop 0
    buffer_load_dwordx4 v3, s[12:15], s61 offen offset:0 sc1 lds
    buffer_load_dwordx4 v3, s[12:15], s61 offen offset:1024 sc1 lds
    buffer_load_dwordx4 v3, s[12:15], s61 offen offset:2048 sc1 lds
    buffer_load_dwordx4 v3, s[12:15], s61 offen offset:3072 sc1 lds
    s_add_u32 m0, s64, 4096
    s_nop 0
    buffer_load_dwordx4 v3, s[12:15], s47 offen offset:0 sc1 lds
    buffer_load_dwordx4 v3, s[12:15], s47 offen offset:1024 sc1 lds
    buffer_load_dwordx4 v3, s[12:15], s47 offen offset:2048 sc1 lds
    buffer_load_dwordx4 v3, s[12:15], s47 offen offset:3072 sc1 lds
    s_add_u32 s61, s61, 262144
    s_add_u32 s62, s62, 1
    s_xor_b32 s64, s64, 0x10000
    s_mov_b32 s69, 1
L_g_nd_168:
    s_sub_u32 s59, s60, 1
    ds_read_b128 v[80:83], v5 offset:0
    ds_read_b128 v[84:87], v5 offset:1024
    ds_read_b128 v[88:91], v5 offset:2048
    ds_read_b128 v[92:95], v5 offset:3072
    s_nop 7
    s_waitcnt lgkmcnt(3)
    v_add_f32 v80, v80, v16
    v_add_f32 v81, v81, v17
    v_add_f32 v82, v82, v18
    v_add_f32 v83, v83, v19
    s_waitcnt lgkmcnt(2)
    v_add_f32 v84, v84, v20
    v_add_f32 v85, v85, v21
    v_add_f32 v86, v86, v22
    v_add_f32 v87, v87, v23
    s_waitcnt lgkmcnt(1)
    v_add_f32 v88, v88, v24
    v_add_f32 v89, v89, v25
    v_add_f32 v90, v90, v26
    v_add_f32 v91, v91, v27
    s_waitcnt lgkmcnt(0)
    v_add_f32 v92, v92, v28
    v_add_f32 v93, v93, v29
    v_add_f32 v94, v94, v30
    v_add_f32 v95, v95, v31
    v_cvt_pk_bf16_f32 v104, v80, v81
    v_cvt_pk_bf16_f32 v105, v82, v83
    v_cvt_pk_bf16_f32 v106, v84, v85
    v_cvt_pk_bf16_f32 v107, v86, v87
    s_nop 1
    v_permlane16_swap_b32 v104, v106
    v_permlane16_swap_b32 v105, v107
    buffer_store_dwordx4 v[104:107], v8, s[12:15], s63 offen sc1
    v_cvt_pk_bf16_f32 v108, v88, v89
    v_cvt_pk_bf16_f32 v109, v90, v91
    v_cvt_pk_bf16_f32 v110, v92, v93
    v_cvt_pk_bf16_f32 v111, v94, v95
    s_nop 1
    v_permlane16_swap_b32 v108, v110
    v_permlane16_swap_b32 v109, v111
    buffer_store_dwordx4 v[108:111], v9, s[12:15], s63 offen sc1
    s_add_u32 s63, s63, 262144
    s_mov_b32 s67, 0
    s_mov_b32 s71, 1
    s_cmp_gt_u32 s66, s60
    s_cbranch_scc1 L_g_g1r_146
    v_mov_b32 v10, 1
    s_mov_b64 exec, 1
    s_waitcnt vmcnt(0)
    ds_add_rtn_u32 v10, v15, v10 offset:4
    s_waitcnt lgkmcnt(0)
    v_readfirstlane_b32 s46, v10
    s_mov_b64 exec, -1
    s_mov_b32 s71, 0
    s_sub_u32 s59, s60, 1
    s_cmp_lg_u32 s46, s68
    s_cbranch_scc1 L_g_df_169
    v_mov_b32 v10, s59
    v_add_u32 v10, 1, v10
    v_mov_b32 v11, 0
    s_mov_b64 exec, 1
    buffer_store_dword v10, v11, s[12:15], s52 offen sc1
    s_mov_b64 exec, -1
L_sf_170:
L_g_df_169:
    s_add_u32 s68, s68, 4
    s_cmp_gt_u32 s66, s60
    s_cbranch_scc1 L_g_g1r_146
L_g_tail_149:
    s_cmp_lt_u32 s60, s75
    s_cbranch_scc1 L_g_restart_144
    s_waitcnt vmcnt(0)
    s_barrier
    s_branch L_c_done_1
L_g_dp_159_l:
    s_cmp_ge_u32 s62, s66
    s_cbranch_scc1 L_g_dp_159_d
    s_mov_b32 s65, 1
    s_add_u32 s47, s61, 4096
    s_mov_b32 m0, s64
    s_add_u32 s62, s62, 1
    buffer_load_dwordx4 v3, s[12:15], s61 offen offset:0 sc1 lds
    buffer_load_dwordx4 v3, s[12:15], s61 offen offset:1024 sc1 lds
    buffer_load_dwordx4 v3, s[12:15], s61 offen offset:2048 sc1 lds
    buffer_load_dwordx4 v3, s[12:15], s61 offen offset:3072 sc1 lds
    s_add_u32 m0, s64, 4096
    s_add_u32 s61, s61, 262144
    buffer_load_dwordx4 v3, s[12:15], s47 offen offset:0 sc1 lds
    buffer_load_dwordx4 v3, s[12:15], s47 offen offset:1024 sc1 lds
    buffer_load_dwordx4 v3, s[12:15], s47 offen offset:2048 sc1 lds
    buffer_load_dwordx4 v3, s[12:15], s47 offen offset:3072 sc1 lds
    s_xor_b32 s64, s64, 0x10000
    s_branch L_g_dp_159_a
L_g_nw_157:
    s_waitcnt vmcnt(0) lgkmcnt(0)
    s_cmp_lg_u32 s44, 0
    s_cbranch_scc1 L_g_nl_171
    s_add_u32 s54, s60, 1
    v_add_u32 v12, s54, v113
    v_and_b32 v13, 3, v12
    v_lshl_add_u32 v13, v13, 7, v7
    buffer_load_dword v11, v13, s[12:15], 0 offen sc1
L_g_nl_171:
    s_branch L_g_loop0_147_l
L_g_nfl_162:
    s_cmp_eq_u32 s71, 0
    s_cbranch_scc1 L_g_nfl_162_d
    v_mov_b32 v10, 1
    s_mov_b64 exec, 1
    s_waitcnt vmcnt(0)
    ds_add_rtn_u32 v10, v15, v10 offset:4
    s_waitcnt lgkmcnt(0)
    v_readfirstlane_b32 s46, v10
    s_mov_b64 exec, -1
    s_mov_b32 s71, 0
    s_sub_u32 s59, s60, 1
    s_cmp_lg_u32 s46, s68
    s_cbranch_scc1 L_g_df_172
    v_mov_b32 v10, s59
    v_add_u32 v10, 1, v10
    v_mov_b32 v11, 0
    s_mov_b64 exec, 1
    buffer_store_dword v10, v11, s[12:15], s52 offen sc1
    s_mov_b64 exec, -1
L_sf_173:
L_g_df_172:
    s_add_u32 s68, s68, 4
    s_mov_b32 s65, 2
    s_branch L_g_nfl_162_d
L_g_dp_167_l:
    s_cmp_ge_u32 s62, s66
    s_cbranch_scc1 L_g_dp_167_d
    s_or_b32 s65, s65, 1
    s_add_u32 s47, s61, 4096
    s_mov_b32 m0, s64
    s_add_u32 s62, s62, 1
    buffer_load_dwordx4 v3, s[12:15], s61 offen offset:0 sc1 lds
    buffer_load_dwordx4 v3, s[12:15], s61 offen offset:1024 sc1 lds
    buffer_load_dwordx4 v3, s[12:15], s61 offen offset:2048 sc1 lds
    buffer_load_dwordx4 v3, s[12:15], s61 offen offset:3072 sc1 lds
    s_add_u32 m0, s64, 4096
    s_add_u32 s61, s61, 262144
    buffer_load_dwordx4 v3, s[12:15], s47 offen offset:0 sc1 lds
    buffer_load_dwordx4 v3, s[12:15], s47 offen offset:1024 sc1 lds
    buffer_load_dwordx4 v3, s[12:15], s47 offen offset:2048 sc1 lds
    buffer_load_dwordx4 v3, s[12:15], s47 offen offset:3072 sc1 lds
    s_xor_b32 s64, s64, 0x10000
    s_branch L_g_dp_167_a
L_g_nw1_164:
    s_cmp_eq_u32 s65, 2
    s_cbranch_scc1 L_g_nw1_164_w
    s_waitcnt vmcnt(0)
L_g_nw1_164_w:
    s_barrier
    ds_read_b128 v[32:35], v4 offset:0
    ds_read_b128 v[36:39], v4 offset:256
    ds_read_b128 v[40:43], v4 offset:2048
    ds_read_b128 v[44:47], v4 offset:2304
    ds_read_b128 v[48:51], v4 offset:4096
    ds_read_b128 v[52:55], v4 offset:4352
    ds_read_b128 v[56:59], v4 offset:6144
    ds_read_b128 v[60:63], v4 offset:6400
    s_branch L_g_jn_166
L_c_chain_9:
    v_mov_b32 v4, 0
    v_mov_b32 v5, 0
    v_mov_b32 v6, 0
    v_mov_b32 v7, 0
    v_mov_b32 v8, 0
    v_mov_b32 v9, 0
    v_mov_b32 v10, 0
    v_mov_b32 v11, 0
    v_mov_b32 v12, 0
    v_mov_b32 v13, 0
    v_mov_b32 v14, 0
    v_mov_b32 v15, 0
    v_mov_b32 v32, -1
    v_mov_b32 v33, -1
    v_mov_b32 v34, -1
    v_mov_b32 v35, -1
    v_lshlrev_b32 v2, 4, v1
    s_lshl_b32 s45, s40, 16
    s_lshl_b32 s46, s41, 12
    s_add_u32 s45, s45, s46
    s_and_b32 s46, s44, 3
    s_lshl_b32 s46, s46, 10
    s_add_u32 s45, s45, s46
    s_lshr_b32 s46, s44, 2
    s_lshl_b32 s46, s46, 19
    s_add_u32 s45, s45, s46
    s_add_u32 s45, s45, 0x7000000
    buffer_store_dwordx4 v[32:35], v2, s[12:15], s45 offen sc1
    s_lshl_b32 s45, s40, 15
    s_lshl_b32 s46, s41, 11
    s_add_u32 s45, s45, s46
    s_lshl_b32 s46, s44, 8
    s_add_u32 s45, s45, s46
    s_add_u32 s45, s45, 0x7100000
    s_mov_b64 exec, 0xffff
    buffer_store_dwordx4 v[32:35], v2, s[12:15], s45 offen sc1
    s_lshl_b32 s45, s40, 16
    s_lshl_b32 s46, s41, 8
    s_add_u32 s45, s45, s46
    s_and_b32 s46, s44, 3
    s_lshl_b32 s46, s46, 14
    s_add_u32 s45, s45, s46
    s_add_u32 s45, s45, 0x7180000
    buffer_store_dwordx4 v[32:35], v2, s[12:15], s45 offen sc1
    s_mov_b64 exec, -1
    v_lshlrev_b32 v2, 4, v1
    v_and_b32 v3, 8, v1
    v_cmp_eq_u32 vcc, 0, v3
    v_mov_b32 v3, 0xeeeeeeee
    v_mov_b32 v4, 0x44444444
    v_cndmask_b32 v3, v3, v4, vcc
    v_and_b32 v100, 15, v1
    v_lshrrev_b32 v101, 4, v1
    v_and_b32 v102, 1, v101
    v_lshrrev_b32 v103, 1, v101
    v_lshlrev_b32 v104, 2, v102
    v_lshl_add_u32 v104, v103, 1, v104
    v_and_b32 v105, 1, v1
    v_add_u32 v104, v104, v105
    v_and_b32 v106, 7, v1
    v_bfe_u32 v107, v1, 3, 1
    s_lshr_b32 s42, s41, 2
    s_and_b32 s43, s41, 3
    s_lshl_b32 s49, s40, 2
    s_add_u32 s49, s49, s42
    s_lshl_b32 s45, s44, 14
    v_lshlrev_b32 v22, 3, v101
    v_bfe_u32 v23, v1, 2, 2
    v_add_u32 v22, v22, v23
    v_and_b32 v23, 3, v1
    v_lshlrev_b32 v24, 3, v23
    v_lshl_add_u32 v20, v22, 6, v24
    v_lshl_add_u32 v21, v22, 7, v24
    v_lshrrev_b32 v22, 2, v1
    v_lshlrev_b32 v23, 4, v23
    v_lshl_add_u32 v24, v22, 13, v23
    v_lshrrev_b32 v22, 3, v1
    v_lshlrev_b32 v23, 4, v106
    v_lshl_add_u32 v25, v22, 11, v23
    s_cmp_ge_u32 s44, 4
    s_cbranch_scc1 L_v_init_174
    s_lshr_b32 s50, s44, 1
    s_and_b32 s51, s44, 1
    s_load_dwordx4 s[4:7], s[0:1], 16
    s_lshl_b32 s46, s49, 8
    s_lshl_b32 s48, s43, 6
    s_add_u32 s46, s46, s48
    s_lshl_b32 s48, s44, 21
    s_add_u32 s46, s46, s48
    s_lshl_b32 s52, s51, 5
    s_xor_b32 s53, s50, 1
    s_lshl_b32 s53, s53, 16
    s_add_u32 s52, s52, s53
    v_add_u32 v20, s52, v20
    s_waitcnt lgkmcnt(0)
    s_mov_b32 s24, s6
    s_and_b32 s25, s7, 0xffff
    s_mov_b32 s26, 0x800000
    s_mov_b32 s27, 0x00020000
    s_mov_b32 s28, s4
    s_and_b32 s29, s5, 0xffff
    s_mov_b32 s30, 0x800000
    s_mov_b32 s31, 0x00020000
    s_lshl_b32 s52, s51, 9
    s_lshl_b32 s53, s50, 7
    s_add_u32 s52, s52, s53
    s_add_u32 s52, s52, 61440
    v_lshlrev_b32 v5, 1, v106
    v_lshl_add_u32 v5, v107, 8, v5
    v_lshl_add_u32 v5, v102, 6, v5
    v_lshl_add_u32 v5, v103, 5, v5
    v_add_u32 v5, s52, v5
    s_lshl_b32 s67, s49, 12
    s_lshl_b32 s53, s43, 10
    s_add_u32 s67, s67, s53
    s_add_u32 s67, s67, 0x1000000
    s_lshl_b32 s52, s40, 16
    s_lshl_b32 s53, s44, 11
    s_add_u32 s53, s52, s53
    s_add_u32 s53, s53, 0x7080000
    v_lshlrev_b32 v7, 3, v1
    v_add_u32 v7, s53, v7
    s_lshl_b32 s53, s44, 9
    s_add_u32 s53, s52, s53
    s_add_u32 s53, s53, 0x7180000
    v_lshlrev_b32 v28, 6, v103
    v_lshl_add_u32 v28, v106, 3, v28
    v_lshl_add_u32 v28, v102, 2, v28
    v_lshl_add_u32 v28, v107, 1, v28
    v_add_u32 v28, s53, v28
    s_lshl_b32 s52, s44, 10
    s_add_u32 s52, s52, 16384
    v_lshlrev_b32 v8, 8, v101
    v_lshl_add_u32 v8, v106, 4, v8
    v_lshl_add_u32 v8, v107, 3, v8
    v_add_u32 v8, s52, v8
    s_lshl_b32 s52, s44, 8
    s_add_u32 s52, s52, 20480
    v_lshlrev_b32 v9, 4, v106
    v_lshl_add_u32 v9, v101, 2, v9
    v_lshl_add_u32 v9, v107, 1, v9
    v_add_u32 v9, s52, v9
    s_mov_b32 s66, 0x3e0293ee
    s_add_u32 m0, s45, 0
    s_add_u32 s48, s46, 0x0
    buffer_load_dwordx4 v24, s[24:27], s48 offen lds
    s_add_u32 m0, s45, 1024
    s_add_u32 s48, s46, 0x20000
    buffer_load_dwordx4 v24, s[24:27], s48 offen lds
    s_add_u32 m0, s45, 2048
    s_add_u32 s48, s46, 0x40000
    buffer_load_dwordx4 v24, s[24:27], s48 offen lds
    s_add_u32 m0, s45, 3072
    s_add_u32 s48, s46, 0x60000
    buffer_load_dwordx4 v24, s[24:27], s48 offen lds
    s_add_u32 m0, s45, 4096
    s_add_u32 s48, s46, 0x80000
    buffer_load_dwordx4 v24, s[24:27], s48 offen lds
    s_add_u32 m0, s45, 5120
    s_add_u32 s48, s46, 0xa0000
    buffer_load_dwordx4 v24, s[24:27], s48 offen lds
    s_add_u32 m0, s45, 6144
    s_add_u32 s48, s46, 0xc0000
    buffer_load_dwordx4 v24, s[24:27], s48 offen lds
    s_add_u32 m0, s45, 7168
    s_add_u32 s48, s46, 0xe0000
    buffer_load_dwordx4 v24, s[24:27], s48 offen lds
    s_add_u32 m0, s45, 8192
    s_add_u32 s48, s46, 0x100000
    buffer_load_dwordx4 v24, s[24:27], s48 offen lds
    s_add_u32 m0, s45, 9216
    s_add_u32 s48, s46, 0x120000
    buffer_load_dwordx4 v24, s[24:27], s48 offen lds
    s_add_u32 m0, s45, 10240
    s_add_u32 s48, s46, 0x140000
    buffer_load_dwordx4 v24, s[24:27], s48 offen lds
    s_add_u32 m0, s45, 11264
    s_add_u32 s48, s46, 0x160000
    buffer_load_dwordx4 v24, s[24:27], s48 offen lds
    s_add_u32 m0, s45, 12288
    s_add_u32 s48, s46, 0x180000
    buffer_load_dwordx4 v24, s[24:27], s48 offen lds
    s_add_u32 m0, s45, 13312
    s_add_u32 s48, s46, 0x1a0000
    buffer_load_dwordx4 v24, s[24:27], s48 offen lds
    s_add_u32 m0, s45, 14336
    s_add_u32 s48, s46, 0x1c0000
    buffer_load_dwordx4 v24, s[24:27], s48 offen lds
    s_add_u32 m0, s45, 15360
    s_add_u32 s48, s46, 0x1e0000
    buffer_load_dwordx4 v24, s[24:27], s48 offen lds
    s_add_u32 s45, s45, 0x10000
    s_add_u32 m0, s45, 0
    s_add_u32 s48, s46, 0x0
    buffer_load_dwordx4 v24, s[28:31], s48 offen lds
    s_add_u32 m0, s45, 1024
    s_add_u32 s48, s46, 0x20000
    buffer_load_dwordx4 v24, s[28:31], s48 offen lds
    s_add_u32 m0, s45, 2048
    s_add_u32 s48, s46, 0x40000
    buffer_load_dwordx4 v24, s[28:31], s48 offen lds
    s_add_u32 m0, s45, 3072
    s_add_u32 s48, s46, 0x60000
    buffer_load_dwordx4 v24, s[28:31], s48 offen lds
    s_add_u32 m0, s45, 4096
    s_add_u32 s48, s46, 0x80000
    buffer_load_dwordx4 v24, s[28:31], s48 offen lds
    s_add_u32 m0, s45, 5120
    s_add_u32 s48, s46, 0xa0000
    buffer_load_dwordx4 v24, s[28:31], s48 offen lds
    s_add_u32 m0, s45, 6144
    s_add_u32 s48, s46, 0xc0000
    buffer_load_dwordx4 v24, s[28:31], s48 offen lds
    s_add_u32 m0, s45, 7168
    s_add_u32 s48, s46, 0xe0000
    buffer_load_dwordx4 v24, s[28:31], s48 offen lds
    s_add_u32 m0, s45, 8192
    s_add_u32 s48, s46, 0x100000
    buffer_load_dwordx4 v24, s[28:31], s48 offen lds
    s_add_u32 m0, s45, 9216
    s_add_u32 s48, s46, 0x120000
    buffer_load_dwordx4 v24, s[28:31], s48 offen lds
    s_add_u32 m0, s45, 10240
    s_add_u32 s48, s46, 0x140000
    buffer_load_dwordx4 v24, s[28:31], s48 offen lds
    s_add_u32 m0, s45, 11264
    s_add_u32 s48, s46, 0x160000
    buffer_load_dwordx4 v24, s[28:31], s48 offen lds
    s_add_u32 m0, s45, 12288
    s_add_u32 s48, s46, 0x180000
    buffer_load_dwordx4 v24, s[28:31], s48 offen lds
    s_add_u32 m0, s45, 13312
    s_add_u32 s48, s46, 0x1a0000
    buffer_load_dwordx4 v24, s[28:31], s48 offen lds
    s_add_u32 m0, s45, 14336
    s_add_u32 s48, s46, 0x1c0000
    buffer_load_dwordx4 v24, s[28:31], s48 offen lds
    s_add_u32 m0, s45, 15360
    s_add_u32 s48, s46, 0x1e0000
    buffer_load_dwordx4 v24, s[28:31], s48 offen lds
    s_add_u32 s45, s45, 0x10000
    s_waitcnt vmcnt(0)
    s_barrier
    s_cmp_lg_u32 s44, 0
    s_cbranch_scc1 L_zwok_177
    v_and_b32 v16, 7, v1
    v_lshlrev_b32 v16, 5, v16
    s_mov_b32 s70, 0
L_zw_176:
    buffer_load_dword v17, v16, s[16:19], 0 offen sc1
    s_waitcnt vmcnt(0)
    v_add_u32_dpp v17, v17, v17 row_ror:1 row_mask:0xf bank_mask:0xf
    s_nop 1
    v_add_u32_dpp v17, v17, v17 row_ror:2 row_mask:0xf bank_mask:0xf
    s_nop 1
    v_add_u32_dpp v17, v17, v17 row_ror:4 row_mask:0xf bank_mask:0xf
    v_cmp_ne_u32 vcc, 0x100, v17
    s_add_u32 s70, s70, 1
    s_cbranch_vccz L_zwok_177
    s_sleep 4
    s_cmp_lt_u32 s70, 524288
    s_cbranch_scc1 L_zw_176
    s_branch L_c_done_1
L_zwok_177:
    s_cmp_lg_u32 s44, 0
    s_cbranch_scc1 L_c_nr_178
    s_or_b32 s47, s39, 0x100
    v_mov_b32 v16, s47
    s_lshl_b32 s52, s40, 6
    s_lshl_b32 s53, s41, 2
    s_add_u32 s52, s52, s53
    s_add_u32 s52, s52, 0x101000
    v_mov_b32 v17, 0
    s_mov_b64 exec, 1
    buffer_store_dword v16, v17, s[12:15], s52 offen sc1
    s_mov_b64 exec, -1
L_c_nr_178:
    ds_read_b64_tr_b16 a[0:1], v20 offset:0
    ds_read_b64_tr_b16 a[2:3], v20 offset:256
    ds_read_b64_tr_b16 a[4:5], v20 offset:2048
    ds_read_b64_tr_b16 a[6:7], v20 offset:2304
    ds_read_b64_tr_b16 a[8:9], v20 offset:4096
    ds_read_b64_tr_b16 a[10:11], v20 offset:4352
    ds_read_b64_tr_b16 a[12:13], v20 offset:6144
    ds_read_b64_tr_b16 a[14:15], v20 offset:6400
    s_waitcnt lgkmcnt(0)
    ds_read_b64_tr_b16 a[16:17], v20 offset:8192
    ds_read_b64_tr_b16 a[18:19], v20 offset:8448
    ds_read_b64_tr_b16 a[20:21], v20 offset:10240
    ds_read_b64_tr_b16 a[22:23], v20 offset:10496
    ds_read_b64_tr_b16 a[24:25], v20 offset:12288
    ds_read_b64_tr_b16 a[26:27], v20 offset:12544
    ds_read_b64_tr_b16 a[28:29], v20 offset:14336
    ds_read_b64_tr_b16 a[30:31], v20 offset:14592
    s_waitcnt lgkmcnt(0)
    ds_read_b64_tr_b16 a[32:33], v20 offset:16384
    ds_read_b64_tr_b16 a[34:35], v20 offset:16640
    ds_read_b64_tr_b16 a[36:37], v20 offset:18432
    ds_read_b64_tr_b16 a[38:39], v20 offset:18688
    ds_read_b64_tr_b16 a[40:41], v20 offset:20480
    ds_read_b64_tr_b16 a[42:43], v20 offset:20736
    ds_read_b64_tr_b16 a[44:45], v20 offset:22528
    ds_read_b64_tr_b16 a[46:47], v20 offset:22784
    s_waitcnt lgkmcnt(0)
    ds_read_b64_tr_b16 a[48:49], v20 offset:24576
    ds_read_b64_tr_b16 a[50:51], v20 offset:24832
    ds_read_b64_tr_b16 a[52:53], v20 offset:26624
    ds_read_b64_tr_b16 a[54:55], v20 offset:26880
    ds_read_b64_tr_b16 a[56:57], v20 offset:28672
    ds_read_b64_tr_b16 a[58:59], v20 offset:28928
    ds_read_b64_tr_b16 a[60:61], v20 offset:30720
    ds_read_b64_tr_b16 a[62:63], v20 offset:30976
    s_waitcnt lgkmcnt(0)
    ds_read_b64_tr_b16 a[64:65], v20 offset:32768
    ds_read_b64_tr_b16 a[66:67], v20 offset:33024
    ds_read_b64_tr_b16 a[68:69], v20 offset:34816
    ds_read_b64_tr_b16 a[70:71], v20 offset:35072
    ds_read_b64_tr_b16 a[72:73], v20 offset:36864
    ds_read_b64_tr_b16 a[74:75], v20 offset:37120
    ds_read_b64_tr_b16 a[76:77], v20 offset:38912
    ds_read_b64_tr_b16 a[78:79], v20 offset:39168
    s_waitcnt lgkmcnt(0)
    ds_read_b64_tr_b16 a[80:81], v20 offset:40960
    ds_read_b64_tr_b16 a[82:83], v20 offset:41216
    ds_read_b64_tr_b16 a[84:85], v20 offset:43008
    ds_read_b64_tr_b16 a[86:87], v20 offset:43264
    ds_read_b64_tr_b16 a[88:89], v20 offset:45056
    ds_read_b64_tr_b16 a[90:91], v20 offset:45312
    ds_read_b64_tr_b16 a[92:93], v20 offset:47104
    ds_read_b64_tr_b16 a[94:95], v20 offset:47360
    s_waitcnt lgkmcnt(0)
    ds_read_b64_tr_b16 a[96:97], v20 offset:49152
    ds_read_b64_tr_b16 a[98:99], v20 offset:49408
    ds_read_b64_tr_b16 a[100:101], v20 offset:51200
    ds_read_b64_tr_b16 a[102:103], v20 offset:51456
    ds_read_b64_tr_b16 a[104:105], v20 offset:53248
    ds_read_b64_tr_b16 a[106:107], v20 offset:53504
    ds_read_b64_tr_b16 a[108:109], v20 offset:55296
    ds_read_b64_tr_b16 a[110:111], v20 offset:55552
    s_waitcnt lgkmcnt(0)
    ds_read_b64_tr_b16 a[112:113], v20 offset:57344
    ds_read_b64_tr_b16 a[114:115], v20 offset:57600
    ds_read_b64_tr_b16 a[116:117], v20 offset:59392
    ds_read_b64_tr_b16 a[118:119], v20 offset:59648
    ds_read_b64_tr_b16 a[120:121], v20 offset:61440
    ds_read_b64_tr_b16 a[122:123], v20 offset:61696
    ds_read_b64_tr_b16 a[124:125], v20 offset:63488
    ds_read_b64_tr_b16 a[126:127], v20 offset:63744
    s_waitcnt lgkmcnt(0)
    s_mov_b32 s63, 0
    s_barrier
    s_lshl_b32 s52, s40, 2
    s_add_u32 s52, s52, s44
    s_mul_i32 s52, s52, 24576
    s_lshl_b32 s53, s41, 9
    s_add_u32 s52, s52, s53
    s_add_u32 s52, s52, 0x2004000
    v_and_b32 v14, 3, v1
    v_lshlrev_b32 v14, 7, v14
    v_add_u32 v14, s52, v14
    s_lshl_b32 s52, s40, 16
    s_lshl_b32 s53, s41, 9
    s_add_u32 s53, s53, s52
    s_lshl_b32 s54, s44, 6
    s_add_u32 s53, s53, s54
    s_add_u32 s53, s53, 0x7080000
    v_lshlrev_b32 v4, 3, v106
    v_lshl_add_u32 v10, v102, 6, v4
    v_lshl_add_u32 v4, v101, 7, v4
    v_add_u32 v4, s53, v4
    v_mov_b32 v54, 0xfffefffe
    v_mov_b32 v56, 0
    v_mov_b32 v57, 0
    v_mov_b32 v58, 0
    v_mov_b32 v59, 0
    s_lshl_b32 s53, s41, 7
    s_add_u32 s53, s53, s52
    s_add_u32 s53, s53, 0x7180000
    v_add_u32 v10, s53, v10
    s_cmp_ge_u32 s44, 2
    s_cselect_b64 vcc, -1, 0
    v_cndmask_b32 v4, v4, v10, vcc
    s_mul_i32 s52, s49, 24576
    s_lshl_b32 s53, s44, 12
    s_add_u32 s52, s52, s53
    s_lshl_b32 s53, s43, 10
    s_add_u32 s52, s52, s53
    s_add_u32 s52, s52, 0x2002000
    v_add_u32 v6, s52, v2
    v_lshrrev_b32 v10, 3, v1
    v_lshlrev_b32 v10, 8, v10
    v_lshl_add_u32 v10, v106, 4, v10
    v_add_u32 v10, 61568, v10
    v_add_u32 v11, 27648, v2
    v_cmp_gt_u32 s[52:53], 32, v1
    s_nop 1
    v_cndmask_b32 v10, v11, v10, s[52:53]
    v_cndmask_b32 v6, v6, v10, vcc
    v_mov_b32 v24, -1
    v_mov_b32 v25, -1
    v_mov_b32 v26, -1
    v_mov_b32 v27, -1
    s_and_b32 s52, s40, 1
    s_lshl_b32 s52, s52, 14
    s_lshl_b32 s53, s41, 10
    s_add_u32 s52, s52, s53
    s_lshl_b32 s53, s50, 9
    s_add_u32 s52, s52, s53
    s_lshl_b32 s53, s51, 7
    s_add_u32 s52, s52, s53
    s_add_u32 s52, s52, 0x7a0000
    v_mov_b32 v46, s52
    v_add_u32 v44, 65536, v2
    s_lshl_b32 s52, s50, 10
    s_add_u32 s52, s52, 62464
    v_add_u32 v31, s52, v2
    s_lshl_b32 s53, s51, 9
    s_add_u32 s52, s52, s53
    v_lshlrev_b32 v45, 4, v100
    v_lshl_add_u32 v45, v103, 8, v45
    v_lshl_add_u32 v45, v102, 3, v45
    v_add_u32 v45, s52, v45
    s_mul_i32 s52, s49, 24576
    s_lshl_b32 s53, s50, 13
    s_add_u32 s52, s52, s53
    s_lshl_b32 s53, s43, 10
    s_add_u32 s52, s52, s53
    s_add_u32 s52, s52, 0x4b80000
    v_add_u32 v13, s52, v2
    v_mov_b32 v29, 26644
    v_mov_b32 v30, 0
    ds_write_b32 v29, v30
    v_mov_b32 v30, 1
    s_lshl_b32 s58, s40, 11
    s_lshl_b32 s53, s44, 7
    s_add_u32 s58, s58, s53
    s_add_u32 s58, s58, 0x10a600
    s_mov_b32 s69, 0
    v_mov_b32 v0, 0
    s_cmp_ge_u32 s44, 2
    s_cselect_b32 s50, 0, 0x00ff00ff
    s_mov_b32 s51, 0x00ff00ff
    s_xor_b32 s45, s44, 2
    s_or_b32 s45, s45, s41
    s_cbranch_scc1 L_c_join_175_p
    s_lshl_b32 s45, s40, 21
    s_add_u32 s45, s45, 0x79c0000
    v_and_b32 v10, 31, v1
    v_lshlrev_b32 v10, 4, v10
    v_lshl_add_u32 v10, v103, 13, v10
    buffer_store_dwordx4 v[24:27], v10, s[12:15], s45 offen sc1
    s_add_u32 s46, s45, 0x1000
    s_load_dword s47, s[22:23], s46
    s_mov_b32 s60, -1
    s_mov_b32 s61, -1
    s_waitcnt vmcnt(0) lgkmcnt(0)
    s_add_u32 s46, s45, 0
    s_memtime s[84:85]
    s_waitcnt lgkmcnt(0)
    s_load_dword s47, s[22:23], s46
    s_waitcnt lgkmcnt(0)
    s_memtime s[86:87]
    s_waitcnt lgkmcnt(0)
    s_sub_u32 s86, s86, s84
    s_min_u32 s60, s60, s86
    s_add_u32 s46, s45, 8192
    s_memtime s[84:85]
    s_waitcnt lgkmcnt(0)
    s_load_dword s47, s[22:23], s46
    s_waitcnt lgkmcnt(0)
    s_memtime s[86:87]
    s_waitcnt lgkmcnt(0)
    s_sub_u32 s86, s86, s84
    s_min_u32 s61, s61, s86
    s_add_u32 s46, s45, 128
    s_memtime s[84:85]
    s_waitcnt lgkmcnt(0)
    s_load_dword s47, s[22:23], s46
    s_waitcnt lgkmcnt(0)
    s_memtime s[86:87]
    s_waitcnt lgkmcnt(0)
    s_sub_u32 s86, s86, s84
    s_min_u32 s60, s60, s86
    s_add_u32 s46, s45, 8320
    s_memtime s[84:85]
    s_waitcnt lgkmcnt(0)
    s_load_dword s47, s[22:23], s46
    s_waitcnt lgkmcnt(0)
    s_memtime s[86:87]
    s_waitcnt lgkmcnt(0)
    s_sub_u32 s86, s86, s84
    s_min_u32 s61, s61, s86
    s_add_u32 s46, s45, 256
    s_memtime s[84:85]
    s_waitcnt lgkmcnt(0)
    s_load_dword s47, s[22:23], s46
    s_waitcnt lgkmcnt(0)
    s_memtime s[86:87]
    s_waitcnt lgkmcnt(0)
    s_sub_u32 s86, s86, s84
    s_min_u32 s60, s60, s86
    s_add_u32 s46, s45, 8448
    s_memtime s[84:85]
    s_waitcnt lgkmcnt(0)
    s_load_dword s47, s[22:23], s46
    s_waitcnt lgkmcnt(0)
    s_memtime s[86:87]
    s_waitcnt lgkmcnt(0)
    s_sub_u32 s86, s86, s84
    s_min_u32 s61, s61, s86
    s_add_u32 s46, s45, 384
    s_memtime s[84:85]
    s_waitcnt lgkmcnt(0)
    s_load_dword s47, s[22:23], s46
    s_waitcnt lgkmcnt(0)
    s_memtime s[86:87]
    s_waitcnt lgkmcnt(0)
    s_sub_u32 s86, s86, s84
    s_min_u32 s60, s60, s86
    s_add_u32 s46, s45, 8576
    s_memtime s[84:85]
    s_waitcnt lgkmcnt(0)
    s_load_dword s47, s[22:23], s46
    s_waitcnt lgkmcnt(0)
    s_memtime s[86:87]
    s_waitcnt lgkmcnt(0)
    s_sub_u32 s86, s86, s84
    s_min_u32 s61, s61, s86
    s_cmp_gt_u32 s60, s61
    s_cselect_b32 s45, 3, 2
    v_mov_b32 v10, s45
    v_mov_b32 v11, 0
    s_lshl_b32 s45, s40, 7
    s_add_u32 s45, s45, 0x101800
    s_mov_b64 exec, 1
    buffer_store_dword v10, v11, s[12:15], s45 offen sc1
    s_mov_b64 exec, -1
L_c_join_175_p:
    s_setprio 1
    s_branch L_c_join_175
L_v_init_174:
    s_sub_u32 s54, s44, 4
    s_lshr_b32 s51, s54, 1
    s_and_b32 s50, s54, 1
    s_load_dwordx4 s[4:7], s[0:1], 32
    s_load_dwordx2 s[8:9], s[0:1], 8
    s_waitcnt lgkmcnt(0)
    s_mov_b32 s24, s4
    s_and_b32 s25, s5, 0xffff
    s_mov_b32 s26, 0x800000
    s_mov_b32 s27, 0x00020000
    s_mov_b32 s28, s6
    s_and_b32 s29, s7, 0xffff
    s_mov_b32 s30, 0x800000
    s_mov_b32 s31, 0x00020000
    s_mov_b32 s32, s8
    s_and_b32 s33, s9, 0xffff
    s_mov_b32 s34, 0x4000
    s_mov_b32 s35, 0x00020000
    s_lshl_b32 s45, s54, 12
    s_add_u32 s45, s45, 0x20000
    v_add_u32 v20, s45, v20
    v_add_u32 v21, s45, v21
    v_add_u32 v22, s45, v2
    s_lshl_b32 s46, s49, 8
    s_lshl_b32 s48, s43, 6
    s_add_u32 s46, s46, s48
    s_lshl_b32 s48, s54, 21
    s_add_u32 s46, s46, s48
    s_add_u32 s48, s46, 0x0
    buffer_load_dwordx4 a[0:3], v24, s[24:27], s48 offen
    s_add_u32 s48, s46, 0x20000
    buffer_load_dwordx4 a[32:35], v24, s[24:27], s48 offen
    s_add_u32 s48, s46, 0x40000
    buffer_load_dwordx4 a[4:7], v24, s[24:27], s48 offen
    s_add_u32 s48, s46, 0x60000
    buffer_load_dwordx4 a[36:39], v24, s[24:27], s48 offen
    s_add_u32 s48, s46, 0x80000
    buffer_load_dwordx4 a[8:11], v24, s[24:27], s48 offen
    s_add_u32 s48, s46, 0xa0000
    buffer_load_dwordx4 a[40:43], v24, s[24:27], s48 offen
    s_add_u32 s48, s46, 0xc0000
    buffer_load_dwordx4 a[12:15], v24, s[24:27], s48 offen
    s_add_u32 s48, s46, 0xe0000
    buffer_load_dwordx4 a[44:47], v24, s[24:27], s48 offen
    s_add_u32 s48, s46, 0x100000
    buffer_load_dwordx4 a[16:19], v24, s[24:27], s48 offen
    s_add_u32 s48, s46, 0x120000
    buffer_load_dwordx4 a[48:51], v24, s[24:27], s48 offen
    s_add_u32 s48, s46, 0x140000
    buffer_load_dwordx4 a[20:23], v24, s[24:27], s48 offen
    s_add_u32 s48, s46, 0x160000
    buffer_load_dwordx4 a[52:55], v24, s[24:27], s48 offen
    s_add_u32 s48, s46, 0x180000
    buffer_load_dwordx4 a[24:27], v24, s[24:27], s48 offen
    s_add_u32 s48, s46, 0x1a0000
    buffer_load_dwordx4 a[56:59], v24, s[24:27], s48 offen
    s_add_u32 s48, s46, 0x1c0000
    buffer_load_dwordx4 a[28:31], v24, s[24:27], s48 offen
    s_add_u32 s48, s46, 0x1e0000
    buffer_load_dwordx4 a[60:63], v24, s[24:27], s48 offen
    s_lshl_b32 s52, s40, 15
    s_lshl_b32 s53, s42, 11
    s_add_u32 s52, s52, s53
    s_lshl_b32 s53, s43, 9
    s_add_u32 s52, s52, s53
    s_lshl_b32 s53, s51, 8
    s_add_u32 s52, s52, s53
    s_add_u32 s52, s52, 0x7100000
    v_bfe_u32 v4, v1, 1, 1
    v_lshlrev_b32 v4, 7, v4
    v_lshl_add_u32 v4, v104, 4, v4
    v_and_b32 v5, 12, v100
    v_add_u32 v4, v4, v5
    v_add_u32 v4, s52, v4
    v_mov_b32 v26, -1
    s_lshl_b32 s52, s51, 5
    s_add_u32 s52, s52, 28160
    v_and_b32 v5, 14, v100
    v_lshlrev_b32 v5, 1, v5
    v_lshl_add_u32 v5, v104, 6, v5
    v_add_u32 v5, s52, v5
    s_lshl_b32 s52, s41, 14
    s_lshl_b32 s53, s54, 11
    s_add_u32 s52, s52, s53
    s_add_u32 s52, s52, 0x7800000
    v_lshlrev_b32 v6, 3, v101
    v_lshl_add_u32 v6, v106, 5, v6
    v_and_b32 v7, 3, v1
    v_lshlrev_b32 v7, 3, v7
    v_bfe_u32 v30, v1, 2, 3
    v_lshl_add_u32 v7, v30, 5, v7
    v_lshl_add_u32 v7, v103, 2, v7
    v_add_u32 v7, s52, v7
    s_lshl_b32 s53, s40, 8
    s_add_u32 s52, s52, s53
    v_add_u32 v6, s52, v6
    v_lshlrev_b32 v30, 4, v100
    v_lshl_add_u32 v30, v101, 18, v30
    v_add_u32 v30, s52, v30
    v_mov_b32 v32, -1
    v_mov_b32 v33, -1
    v_mov_b32 v34, -1
    v_mov_b32 v35, -1
    buffer_store_dwordx4 v[32:35], v30, s[12:15], 0 offen sc1
    s_mov_b32 s53, 8192
    buffer_store_dwordx4 v[32:35], v30, s[12:15], s53 offen sc1
    s_lshl_b32 s55, s40, 16
    s_add_u32 s55, s55, 0x7000000
    s_lshl_b32 s52, s41, 10
    s_lshl_b32 s53, s54, 8
    s_add_u32 s52, s52, s53
    s_add_u32 s52, s52, s55
    v_lshlrev_b32 v8, 2, v1
    v_add_u32 v8, s52, v8
    s_lshl_b32 s53, s54, 12
    v_add_u32 v10, s53, v2
    v_add_u32 v9, s55, v10
    s_lshl_b32 s52, s40, 15
    s_lshl_b32 s53, s54, 11
    s_add_u32 s52, s52, s53
    s_add_u32 s52, s52, 0x7100000
    v_add_u32 v11, s52, v2
    s_lshl_b32 s52, s54, 9
    s_add_u32 s52, s52, 53248
    v_lshlrev_b32 v12, 4, v100
    v_lshl_add_u32 v12, v102, 3, v12
    v_lshl_add_u32 v12, v103, 8, v12
    v_add_u32 v12, s52, v12
    s_lshl_b32 s52, s51, 3
    s_add_u32 s52, s52, 49152
    v_add_u32 v13, s52, v2
    s_lshl_b32 s52, s54, 10
    s_add_u32 s52, s52, 49152
    v_add_u32 v14, s52, v2
    s_lshl_b32 s52, s40, 2
    s_add_u32 s52, s52, s54
    s_mul_i32 s52, s52, 24576
    s_add_u32 s52, s52, 0x2004000
    v_add_u32 v15, s52, v2
    s_lshl_b32 s52, s54, 10
    v_add_u32 v27, s52, v2
    v_lshlrev_b32 v30, 11, v106
    v_lshl_add_u32 v30, v101, 5, v30
    v_lshl_add_u32 v30, v107, 2, v30
    s_lshl_b32 s52, s54, 9
    buffer_load_dword v112, v30, s[32:35], s52 offen offset:0
    buffer_load_dword v113, v30, s[32:35], s52 offen offset:8
    buffer_load_dword v114, v30, s[32:35], s52 offen offset:16
    buffer_load_dword v115, v30, s[32:35], s52 offen offset:24
    buffer_load_dword v116, v30, s[32:35], s52 offen offset:128
    buffer_load_dword v117, v30, s[32:35], s52 offen offset:136
    buffer_load_dword v118, v30, s[32:35], s52 offen offset:144
    buffer_load_dword v119, v30, s[32:35], s52 offen offset:152
    buffer_load_dword v120, v30, s[32:35], s52 offen offset:256
    buffer_load_dword v121, v30, s[32:35], s52 offen offset:264
    buffer_load_dword v122, v30, s[32:35], s52 offen offset:272
    buffer_load_dword v123, v30, s[32:35], s52 offen offset:280
    buffer_load_dword v124, v30, s[32:35], s52 offen offset:384
    buffer_load_dword v125, v30, s[32:35], s52 offen offset:392
    buffer_load_dword v126, v30, s[32:35], s52 offen offset:400
    buffer_load_dword v127, v30, s[32:35], s52 offen offset:408
    s_lshl_b32 s46, s40, 2
    s_add_u32 s46, s46, s54
    s_lshl_b32 s46, s46, 18
    s_lshl_b32 s48, s41, 7
    s_add_u32 s46, s46, s48
    s_add_u32 s48, s46, 0x0
    buffer_load_dwordx4 a[64:67], v25, s[28:31], s48 offen
    s_add_u32 s48, s46, 0x4000
    buffer_load_dwordx4 a[80:83], v25, s[28:31], s48 offen
    s_add_u32 s48, s46, 0x8000
    buffer_load_dwordx4 a[96:99], v25, s[28:31], s48 offen
    s_add_u32 s48, s46, 0xc000
    buffer_load_dwordx4 a[112:115], v25, s[28:31], s48 offen
    s_add_u32 s48, s46, 0x10000
    buffer_load_dwordx4 a[68:71], v25, s[28:31], s48 offen
    s_add_u32 s48, s46, 0x14000
    buffer_load_dwordx4 a[84:87], v25, s[28:31], s48 offen
    s_add_u32 s48, s46, 0x18000
    buffer_load_dwordx4 a[100:103], v25, s[28:31], s48 offen
    s_add_u32 s48, s46, 0x1c000
    buffer_load_dwordx4 a[116:119], v25, s[28:31], s48 offen
    s_add_u32 s48, s46, 0x20000
    buffer_load_dwordx4 a[72:75], v25, s[28:31], s48 offen
    s_add_u32 s48, s46, 0x24000
    buffer_load_dwordx4 a[88:91], v25, s[28:31], s48 offen
    s_add_u32 s48, s46, 0x28000
    buffer_load_dwordx4 a[104:107], v25, s[28:31], s48 offen
    s_add_u32 s48, s46, 0x2c000
    buffer_load_dwordx4 a[120:123], v25, s[28:31], s48 offen
    s_add_u32 s48, s46, 0x30000
    buffer_load_dwordx4 a[76:79], v25, s[28:31], s48 offen
    s_add_u32 s48, s46, 0x34000
    buffer_load_dwordx4 a[92:95], v25, s[28:31], s48 offen
    s_add_u32 s48, s46, 0x38000
    buffer_load_dwordx4 a[108:111], v25, s[28:31], s48 offen
    s_add_u32 s48, s46, 0x3c000
    buffer_load_dwordx4 a[124:127], v25, s[28:31], s48 offen
    s_waitcnt vmcnt(16)
    ds_write_b128 v22, a[0:3] offset:0
    ds_write_b128 v22, a[32:35] offset:1024
    ds_write_b128 v22, a[4:7] offset:2048
    ds_write_b128 v22, a[36:39] offset:3072
    s_waitcnt lgkmcnt(0)
    ds_read_b64_tr_b16 a[0:1], v20 offset:0
    ds_read_b64_tr_b16 a[2:3], v20 offset:256
    ds_read_b64_tr_b16 a[32:33], v20 offset:32
    ds_read_b64_tr_b16 a[34:35], v20 offset:288
    ds_read_b64_tr_b16 a[4:5], v20 offset:2048
    ds_read_b64_tr_b16 a[6:7], v20 offset:2304
    ds_read_b64_tr_b16 a[36:37], v20 offset:2080
    ds_read_b64_tr_b16 a[38:39], v20 offset:2336
    s_waitcnt lgkmcnt(0)
    ds_write_b128 v22, a[8:11] offset:0
    ds_write_b128 v22, a[40:43] offset:1024
    ds_write_b128 v22, a[12:15] offset:2048
    ds_write_b128 v22, a[44:47] offset:3072
    s_waitcnt lgkmcnt(0)
    ds_read_b64_tr_b16 a[8:9], v20 offset:0
    ds_read_b64_tr_b16 a[10:11], v20 offset:256
    ds_read_b64_tr_b16 a[40:41], v20 offset:32
    ds_read_b64_tr_b16 a[42:43], v20 offset:288
    ds_read_b64_tr_b16 a[12:13], v20 offset:2048
    ds_read_b64_tr_b16 a[14:15], v20 offset:2304
    ds_read_b64_tr_b16 a[44:45], v20 offset:2080
    ds_read_b64_tr_b16 a[46:47], v20 offset:2336
    s_waitcnt lgkmcnt(0)
    ds_write_b128 v22, a[16:19] offset:0
    ds_write_b128 v22, a[48:51] offset:1024
    ds_write_b128 v22, a[20:23] offset:2048
    ds_write_b128 v22, a[52:55] offset:3072
    s_waitcnt lgkmcnt(0)
    ds_read_b64_tr_b16 a[16:17], v20 offset:0
    ds_read_b64_tr_b16 a[18:19], v20 offset:256
    ds_read_b64_tr_b16 a[48:49], v20 offset:32
    ds_read_b64_tr_b16 a[50:51], v20 offset:288
    ds_read_b64_tr_b16 a[20:21], v20 offset:2048
    ds_read_b64_tr_b16 a[22:23], v20 offset:2304
    ds_read_b64_tr_b16 a[52:53], v20 offset:2080
    ds_read_b64_tr_b16 a[54:55], v20 offset:2336
    s_waitcnt lgkmcnt(0)
    ds_write_b128 v22, a[24:27] offset:0
    ds_write_b128 v22, a[56:59] offset:1024
    ds_write_b128 v22, a[28:31] offset:2048
    ds_write_b128 v22, a[60:63] offset:3072
    s_waitcnt lgkmcnt(0)
    ds_read_b64_tr_b16 a[24:25], v20 offset:0
    ds_read_b64_tr_b16 a[26:27], v20 offset:256
    ds_read_b64_tr_b16 a[56:57], v20 offset:32
    ds_read_b64_tr_b16 a[58:59], v20 offset:288
    ds_read_b64_tr_b16 a[28:29], v20 offset:2048
    ds_read_b64_tr_b16 a[30:31], v20 offset:2304
    ds_read_b64_tr_b16 a[60:61], v20 offset:2080
    ds_read_b64_tr_b16 a[62:63], v20 offset:2336
    s_waitcnt lgkmcnt(0)
    s_barrier
    s_waitcnt vmcnt(0)
    ds_write_b128 v22, a[64:67] offset:0
    ds_write_b128 v22, a[80:83] offset:1024
    ds_write_b128 v22, a[96:99] offset:2048
    ds_write_b128 v22, a[112:115] offset:3072
    s_waitcnt lgkmcnt(0)
    ds_read_b64_tr_b16 a[64:65], v21 offset:0
    ds_read_b64_tr_b16 a[66:67], v21 offset:512
    ds_read_b64_tr_b16 a[80:81], v21 offset:32
    ds_read_b64_tr_b16 a[82:83], v21 offset:544
    ds_read_b64_tr_b16 a[96:97], v21 offset:64
    ds_read_b64_tr_b16 a[98:99], v21 offset:576
    ds_read_b64_tr_b16 a[112:113], v21 offset:96
    ds_read_b64_tr_b16 a[114:115], v21 offset:608
    s_waitcnt lgkmcnt(0)
    ds_write_b128 v22, a[68:71] offset:0
    ds_write_b128 v22, a[84:87] offset:1024
    ds_write_b128 v22, a[100:103] offset:2048
    ds_write_b128 v22, a[116:119] offset:3072
    s_waitcnt lgkmcnt(0)
    ds_read_b64_tr_b16 a[68:69], v21 offset:0
    ds_read_b64_tr_b16 a[70:71], v21 offset:512
    ds_read_b64_tr_b16 a[84:85], v21 offset:32
    ds_read_b64_tr_b16 a[86:87], v21 offset:544
    ds_read_b64_tr_b16 a[100:101], v21 offset:64
    ds_read_b64_tr_b16 a[102:103], v21 offset:576
    ds_read_b64_tr_b16 a[116:117], v21 offset:96
    ds_read_b64_tr_b16 a[118:119], v21 offset:608
    s_waitcnt lgkmcnt(0)
    ds_write_b128 v22, a[72:75] offset:0
    ds_write_b128 v22, a[88:91] offset:1024
    ds_write_b128 v22, a[104:107] offset:2048
    ds_write_b128 v22, a[120:123] offset:3072
    s_waitcnt lgkmcnt(0)
    ds_read_b64_tr_b16 a[72:73], v21 offset:0
    ds_read_b64_tr_b16 a[74:75], v21 offset:512
    ds_read_b64_tr_b16 a[88:89], v21 offset:32
    ds_read_b64_tr_b16 a[90:91], v21 offset:544
    ds_read_b64_tr_b16 a[104:105], v21 offset:64
    ds_read_b64_tr_b16 a[106:107], v21 offset:576
    ds_read_b64_tr_b16 a[120:121], v21 offset:96
    ds_read_b64_tr_b16 a[122:123], v21 offset:608
    s_waitcnt lgkmcnt(0)
    ds_write_b128 v22, a[76:79] offset:0
    ds_write_b128 v22, a[92:95] offset:1024
    ds_write_b128 v22, a[108:111] offset:2048
    ds_write_b128 v22, a[124:127] offset:3072
    s_waitcnt lgkmcnt(0)
    ds_read_b64_tr_b16 a[76:77], v21 offset:0
    ds_read_b64_tr_b16 a[78:79], v21 offset:512
    ds_read_b64_tr_b16 a[92:93], v21 offset:32
    ds_read_b64_tr_b16 a[94:95], v21 offset:544
    ds_read_b64_tr_b16 a[108:109], v21 offset:64
    ds_read_b64_tr_b16 a[110:111], v21 offset:576
    ds_read_b64_tr_b16 a[124:125], v21 offset:96
    ds_read_b64_tr_b16 a[126:127], v21 offset:608
    s_waitcnt lgkmcnt(0)
    s_mov_b32 s65, 0
    s_waitcnt vmcnt(0)
    s_barrier
    s_lshl_b32 s57, s40, 11
    s_lshl_b32 s53, s54, 7
    s_add_u32 s57, s57, s53
    s_add_u32 s57, s57, 0x10a600
    s_mov_b32 s69, 0
    s_mov_b32 s68, 0
    s_cmp_gt_u32 s69, s68
    s_cbranch_scc1 L_kv_ok_180
    s_mov_b32 s70, 0
L_kv_lp_179:
    v_and_b32 v22, 1, v1
    v_lshlrev_b32 v22, 9, v22
    buffer_load_dword v23, v22, s[12:15], s57 offen sc1
    s_waitcnt vmcnt(0)
    v_readlane_b32 s69, v23, 0
    v_readlane_b32 s45, v23, 1
    s_add_u32 s70, s70, 1
    s_nop 2
    s_min_u32 s69, s69, s45
    s_cmp_gt_u32 s69, s68
    s_cbranch_scc1 L_kv_ok_180
    s_sleep 4
    s_cmp_lt_u32 s70, 524288
    s_cbranch_scc1 L_kv_lp_179
    s_branch L_c_done_1
L_kv_ok_180:
    v_lshlrev_b32 v28, 9, v101
    v_lshl_add_u32 v28, v100, 4, v28
    s_lshl_b32 s52, s54, 13
    s_add_u32 s52, s52, 0x7a0000
    v_add_u32 v28, s52, v28
    s_lshl_b32 s59, s54, 12
    s_add_u32 s59, s59, 65536
    v_lshlrev_b32 v31, 4, v100
    v_lshl_add_u32 v31, v103, 8, v31
    v_add_u32 v31, 20480, v31
    s_lshl_b32 s52, s54, 11
    s_add_u32 s52, s52, 53248
    v_add_u32 v25, s52, v2
    v_mov_b32 v29, 26640
    v_mov_b32 v30, 0
    ds_write_b32 v29, v30
    v_mov_b32 v30, 1
    s_mov_b32 s58, 0
    s_mov_b32 s64, 0
    s_add_u32 s46, s65, 4096
    buffer_load_dwordx4 v[32:35], v15, s[12:15], s65 offen offset:0 sc1
    buffer_load_dwordx4 v[48:51], v15, s[12:15], s46 offen offset:0 sc1
    buffer_load_dwordx4 v[36:39], v15, s[12:15], s65 offen offset:1024 sc1
    buffer_load_dwordx4 v[52:55], v15, s[12:15], s46 offen offset:1024 sc1
    buffer_load_dwordx4 v[40:43], v15, s[12:15], s65 offen offset:2048 sc1
    buffer_load_dwordx4 v[56:59], v15, s[12:15], s46 offen offset:2048 sc1
    buffer_load_dwordx4 v[44:47], v15, s[12:15], s65 offen offset:3072 sc1
    buffer_load_dwordx4 v[60:63], v15, s[12:15], s46 offen offset:3072 sc1
    s_add_u32 s65, s65, 786432
    s_waitcnt vmcnt(0)
    v_mfma_f32_16x16x32_bf16 v[64:67], v[32:35], a[64:67], 0
    v_mfma_f32_16x16x32_bf16 v[68:71], v[48:51], a[64:67], 0
    v_mfma_f32_16x16x32_bf16 v[64:67], v[36:39], a[68:71], v[64:67]
    v_mfma_f32_16x16x32_bf16 v[68:71], v[52:55], a[68:71], v[68:71]
    v_mfma_f32_16x16x32_bf16 v[64:67], v[40:43], a[72:75], v[64:67]
    v_mfma_f32_16x16x32_bf16 v[68:71], v[56:59], a[72:75], v[68:71]
    v_mfma_f32_16x16x32_bf16 v[64:67], v[44:47], a[76:79], v[64:67]
    v_mfma_f32_16x16x32_bf16 v[68:71], v[60:63], a[76:79], v[68:71]
    v_mfma_f32_16x16x32_bf16 v[72:75], v[32:35], a[80:83], 0
    v_mfma_f32_16x16x32_bf16 v[76:79], v[48:51], a[80:83], 0
    v_mfma_f32_16x16x32_bf16 v[72:75], v[36:39], a[84:87], v[72:75]
    v_mfma_f32_16x16x32_bf16 v[76:79], v[52:55], a[84:87], v[76:79]
    v_mfma_f32_16x16x32_bf16 v[72:75], v[40:43], a[88:91], v[72:75]
    v_mfma_f32_16x16x32_bf16 v[76:79], v[56:59], a[88:91], v[76:79]
    v_mfma_f32_16x16x32_bf16 v[72:75], v[44:47], a[92:95], v[72:75]
    v_mfma_f32_16x16x32_bf16 v[76:79], v[60:63], a[92:95], v[76:79]
    v_cvt_pk_bf16_f32 v64, v64, v65
    v_cvt_pk_bf16_f32 v65, v66, v67
    v_cvt_pk_bf16_f32 v66, v68, v69
    v_cvt_pk_bf16_f32 v67, v70, v71
    ds_write_b128 v10, v[64:67] offset:32768
    v_mfma_f32_16x16x32_bf16 v[80:83], v[32:35], a[96:99], 0
    v_mfma_f32_16x16x32_bf16 v[84:87], v[48:51], a[96:99], 0
    v_mfma_f32_16x16x32_bf16 v[80:83], v[36:39], a[100:103], v[80:83]
    v_mfma_f32_16x16x32_bf16 v[84:87], v[52:55], a[100:103], v[84:87]
    v_mfma_f32_16x16x32_bf16 v[80:83], v[40:43], a[104:107], v[80:83]
    v_mfma_f32_16x16x32_bf16 v[84:87], v[56:59], a[104:107], v[84:87]
    v_mfma_f32_16x16x32_bf16 v[80:83], v[44:47], a[108:111], v[80:83]
    v_mfma_f32_16x16x32_bf16 v[84:87], v[60:63], a[108:111], v[84:87]
    v_cvt_pk_bf16_f32 v72, v72, v73
    v_cvt_pk_bf16_f32 v73, v74, v75
    v_cvt_pk_bf16_f32 v74, v76, v77
    v_cvt_pk_bf16_f32 v75, v78, v79
    ds_write_b128 v10, v[72:75] offset:33792
    v_mfma_f32_16x16x32_bf16 v[88:91], v[32:35], a[112:115], 0
    v_mfma_f32_16x16x32_bf16 v[92:95], v[48:51], a[112:115], 0
    v_mfma_f32_16x16x32_bf16 v[88:91], v[36:39], a[116:119], v[88:91]
    v_mfma_f32_16x16x32_bf16 v[92:95], v[52:55], a[116:119], v[92:95]
    v_mfma_f32_16x16x32_bf16 v[88:91], v[40:43], a[120:123], v[88:91]
    v_mfma_f32_16x16x32_bf16 v[92:95], v[56:59], a[120:123], v[92:95]
    v_mfma_f32_16x16x32_bf16 v[88:91], v[44:47], a[124:127], v[88:91]
    v_mfma_f32_16x16x32_bf16 v[92:95], v[60:63], a[124:127], v[92:95]
    v_cvt_pk_bf16_f32 v80, v80, v81
    v_cvt_pk_bf16_f32 v81, v82, v83
    v_cvt_pk_bf16_f32 v82, v84, v85
    v_cvt_pk_bf16_f32 v83, v86, v87
    ds_write_b128 v10, v[80:83] offset:34816
    s_nop 2
    v_cvt_pk_bf16_f32 v88, v88, v89
    v_cvt_pk_bf16_f32 v89, v90, v91
    v_cvt_pk_bf16_f32 v90, v92, v93
    v_cvt_pk_bf16_f32 v91, v94, v95
    ds_write_b128 v10, v[88:91] offset:35840
    s_mov_b64 s[66:67], 0
    s_mov_b32 s63, 0
    s_mov_b32 s68, 1
    s_cmp_gt_u32 s69, s68
    s_cbranch_scc1 L_kv_ok_182
    s_mov_b32 s70, 0
L_kv_lp_181:
    v_and_b32 v22, 1, v1
    v_lshlrev_b32 v22, 9, v22
    buffer_load_dword v23, v22, s[12:15], s57 offen sc1
    s_waitcnt vmcnt(0)
    v_readlane_b32 s69, v23, 0
    v_readlane_b32 s45, v23, 1
    s_add_u32 s70, s70, 1
    s_nop 2
    s_min_u32 s69, s69, s45
    s_cmp_gt_u32 s69, s68
    s_cbranch_scc1 L_kv_ok_182
    s_sleep 4
    s_cmp_lt_u32 s70, 524288
    s_cbranch_scc1 L_kv_lp_181
    s_branch L_c_done_1
L_kv_ok_182:
    v_lshrrev_b32 v22, 3, v1
    v_lshlrev_b32 v22, 7, v22
    s_mov_b32 s45, 0x101800
    s_mov_b32 s46, 0
    s_mov_b32 s70, 0
L_spin_183:
    buffer_load_dword v23, v22, s[12:15], s45 offen sc1
    s_waitcnt vmcnt(0)
    v_cmp_ge_u32 vcc, s46, v23
    s_add_u32 s70, s70, 1
    s_cbranch_vccz L_spok_184
    s_sleep 3
    s_cmp_lt_u32 s70, 524288
    s_cbranch_scc1 L_spin_183
    s_branch L_c_done_1
L_spok_184:
    v_cmp_eq_u32 s[66:67], 3, v23
    s_nop 3
    s_bitcmp1_b32 s66, 0
    s_cselect_b32 s63, 8192, 0
    s_waitcnt lgkmcnt(0)
    v_min_u32 v64, -2, v112
    v_min_u32 v65, -2, v113
    v_min_u32 v66, -2, v114
    v_min_u32 v67, -2, v115
    v_min_u32 v68, -2, v116
    v_min_u32 v69, -2, v117
    v_min_u32 v70, -2, v118
    v_min_u32 v71, -2, v119
    v_min_u32 v72, -2, v120
    v_min_u32 v73, -2, v121
    v_min_u32 v74, -2, v122
    v_min_u32 v75, -2, v123
    v_min_u32 v76, -2, v124
    v_min_u32 v77, -2, v125
    v_min_u32 v78, -2, v126
    v_min_u32 v79, -2, v127
    v_mov_b32 v16, 0
    v_mov_b32 v17, 0
    v_mov_b32 v18, 0
    v_mov_b32 v19, 0
    v_mov_b32 v20, 0
    v_mov_b32 v21, 0
    v_mov_b32 v22, 0
    v_mov_b32 v23, 0
L_c_join_175:
    s_mov_b32 s60, 0
    s_mov_b32 s61, 0
    s_mov_b32 s62, 0
    s_cmp_lg_u32 s44, 0
    s_cbranch_scc1 L_c_nh_185
    v_lshlrev_b32 v17, 3, v1
    s_lshl_b32 s46, s40, 3
    v_mov_b32 v21, s46
    s_mov_b32 s45, 0x101000
    s_mov_b32 s70, 0
L_c_rp_186:
    buffer_load_dwordx2 v[18:19], v17, s[12:15], s45 offen sc1
    buffer_load_dwordx2 v[22:23], v21, s[12:15], s45 offen offset:512 sc1
    s_waitcnt vmcnt(0)
    v_min3_u32 v20, v18, v19, v22
    v_min_u32 v20, v20, v23
    v_cmp_eq_u32 vcc, 0, v20
    s_cbranch_vccnz L_rt_187
    v_cmp_eq_u32 s[52:53], v18, v16
    v_cmp_eq_u32 vcc, v19, v16
    v_cmp_eq_u32 s[54:55], v22, v16
    v_cmp_eq_u32 s[56:57], v23, v16
    s_lshl_b32 s46, s40, 3
    s_nop 3
    s_and_b64 s[52:53], s[52:53], vcc
    s_lshr_b64 s[52:53], s[52:53], s46
    s_and_b32 s52, s52, 0xff
    s_cmp_eq_u32 s52, 0xff
    s_cselect_b32 s52, 1, 0
    v_mov_b32 v16, s52
    v_mov_b32 v17, 26624
    ds_write_b32 v17, v16
L_c_nh_185:
    s_waitcnt lgkmcnt(0)
    s_barrier
    v_mov_b32 v17, 26624
    ds_read_b32 v16, v17
    s_waitcnt lgkmcnt(0)
    v_readfirstlane_b32 s52, v16
    s_nop 3
    s_cmp_ge_u32 s44, 4
    s_cbranch_scc1 L_vf_190
    s_mov_b32 s57, s58
    s_mov_b32 s58, 0
    s_cmp_ge_u32 s44, 2
    s_cbranch_scc1 L_sf_188
    buffer_load_dwordx4 v[32:35], v6, s[12:15], 0 offen sc1
L_sf_188:
    s_mov_b32 s54, s52
    v_add_u32 v52, 786432, v6
    s_mul_i32 s53, s49, 24576
    s_lshl_b32 s55, s43, 11
    s_add_u32 s53, s53, s55
    s_and_b32 s55, s44, 1
    s_lshl_b32 s55, s55, 10
    s_add_u32 s53, s53, s55
    s_add_u32 s53, s53, 0x2184000
    v_and_b32 v53, 7, v1
    v_lshlrev_b32 v53, 7, v53
    v_add_u32 v53, s53, v53
    s_cmp_ge_u32 s44, 2
    s_cselect_b64 vcc, -1, 0
    s_cselect_b64 s[52:53], 0xff, -1
    v_cndmask_b32 v52, v52, v53, vcc
    s_cselect_b32 s55, 786432, 0
    v_readfirstlane_b32 s56, v52
    s_nop 3
    s_sub_u32 s56, s56, s55
    s_cmp_eq_u32 s54, 0
    s_cbranch_scc1 L_ss_189
.p2align 6
L_s_loop_192:
    v_mov_b32 v16, 0
    v_mov_b32 v17, 0
    v_mov_b32 v18, 0
    v_mov_b32 v19, 0
    s_add_u32 s58, s58, 4
    s_mov_b32 s70, 1
    s_waitcnt vmcnt(0) lgkmcnt(0)
    s_barrier
    ds_read_b128 v[64:67], v2 offset:0
    ds_read_b128 v[68:71], v2 offset:1024
    ds_read_b128 v[72:75], v2 offset:2048
    ds_read_b128 v[76:79], v2 offset:3072
    ds_read_b128 v[80:83], v2 offset:4096
    ds_read_b128 v[84:87], v2 offset:5120
    ds_read_b128 v[88:91], v2 offset:6144
    ds_read_b128 v[92:95], v2 offset:7168
    ds_read_b128 v[96:99], v2 offset:8192
    ds_read_b128 v[100:103], v2 offset:9216
    ds_read_b128 v[104:107], v2 offset:10240
    ds_read_b128 v[108:111], v2 offset:11264
    s_waitcnt lgkmcnt(11)
    v_smfmac_f32_16x16x64_bf16 v[16:19], v[64:67], a[0:7], v3
    ds_read_b128 v[112:115], v2 offset:12288
    s_waitcnt lgkmcnt(11)
    v_smfmac_f32_16x16x64_bf16 v[16:19], v[68:71], a[8:15], v3
    ds_read_b128 v[116:119], v2 offset:13312
    s_waitcnt lgkmcnt(11)
    v_smfmac_f32_16x16x64_bf16 v[16:19], v[72:75], a[16:23], v3
    ds_read_b128 v[120:123], v2 offset:14336
    s_waitcnt lgkmcnt(11)
    v_smfmac_f32_16x16x64_bf16 v[16:19], v[76:79], a[24:31], v3
    ds_read_b128 v[124:127], v2 offset:15360
    s_waitcnt lgkmcnt(11)
    v_smfmac_f32_16x16x64_bf16 v[16:19], v[80:83], a[32:39], v3
    s_waitcnt lgkmcnt(10)
    v_smfmac_f32_16x16x64_bf16 v[16:19], v[84:87], a[40:47], v3
    s_waitcnt lgkmcnt(9)
    v_smfmac_f32_16x16x64_bf16 v[16:19], v[88:91], a[48:55], v3
    s_waitcnt lgkmcnt(8)
    v_smfmac_f32_16x16x64_bf16 v[16:19], v[92:95], a[56:63], v3
    s_waitcnt lgkmcnt(7)
    v_smfmac_f32_16x16x64_bf16 v[16:19], v[96:99], a[64:71], v3
    s_waitcnt lgkmcnt(6)
    v_smfmac_f32_16x16x64_bf16 v[16:19], v[100:103], a[72:79], v3
    s_waitcnt lgkmcnt(5)
    v_smfmac_f32_16x16x64_bf16 v[16:19], v[104:107], a[80:87], v3
    s_waitcnt lgkmcnt(4)
    v_smfmac_f32_16x16x64_bf16 v[16:19], v[108:111], a[88:95], v3
    s_waitcnt lgkmcnt(3)
    v_smfmac_f32_16x16x64_bf16 v[16:19], v[112:115], a[96:103], v3
    s_waitcnt lgkmcnt(2)
    v_smfmac_f32_16x16x64_bf16 v[16:19], v[116:119], a[104:111], v3
    s_waitcnt lgkmcnt(1)
    v_smfmac_f32_16x16x64_bf16 v[16:19], v[120:123], a[112:119], v3
    s_waitcnt lgkmcnt(0)
    v_smfmac_f32_16x16x64_bf16 v[16:19], v[124:127], a[120:127], v3
    s_nop 7
    v_permlane32_swap_b32 v16, v18
    v_permlane32_swap_b32 v17, v19
    v_add_f32 v16, v16, v18
    v_add_f32 v17, v17, v19
    v_cvt_pk_bf16_f32 v16, v16, v17
    ds_write_b16 v5, v16
    ds_write_b16_d16_hi v5, v16 offset:16
    s_mov_b64 exec, 1
    ds_add_u32 v29, v30
    s_mov_b64 exec, -1
L_s_xl_194:
    ds_read_b32 v10, v29
    ds_read_b128 v[64:67], v2 offset:61440
    s_cmp_eq_u32 s60, 63
    s_cbranch_scc1 L_s_last_193
    s_cmp_ge_u32 s44, 2
    s_cbranch_scc1 L_s_w2_195
    s_waitcnt lgkmcnt(0)
    v_mfma_f32_16x16x32_bf16 v[16:19], v[32:35], v[64:67], 0
L_s_w2_195_b:
    v_cmp_ne_u32 vcc, s58, v10
    s_nop 0
    s_cbranch_vccnz L_rt_197
    s_mov_b64 exec, s[50:51]
    s_nop 3
    v_cvt_pk_bf16_f32 v16, v16, v17
    v_cvt_pk_bf16_f32 v17, v18, v19
    v_pk_min_u16 v16, v16, v54
    v_pk_min_u16 v17, v17, v54
    buffer_store_dwordx2 v[16:17], v4, s[12:15], s61 offen
    s_mov_b64 exec, -1
L_s_w3_196_b:
    s_sleep 5
    s_mov_b32 s70, 1
L_s_xp_198:
    buffer_load_dwordx2 v[64:65], v7, s[12:15], s61 offen offset:0 sc1
    buffer_load_short_d16_hi v56, v28, s[12:15], s61 offen offset:0 sc1
    buffer_load_dwordx2 v[66:67], v7, s[12:15], s61 offen offset:512 sc1
    buffer_load_short_d16_hi v57, v28, s[12:15], s61 offen offset:128 sc1
    buffer_load_dwordx2 v[68:69], v7, s[12:15], s61 offen offset:1024 sc1
    buffer_load_short_d16_hi v58, v28, s[12:15], s61 offen offset:256 sc1
    buffer_load_dwordx2 v[70:71], v7, s[12:15], s61 offen offset:1536 sc1
    buffer_load_short_d16_hi v59, v28, s[12:15], s61 offen offset:384 sc1
    s_mov_b32 s46, 0x00003f80
    s_mov_b32 s47, 0x3f800000
    s_waitcnt vmcnt(6)
    v_dot2_f32_bf16 v16, v64, s46, 0
    v_dot2_f32_bf16 v17, v64, s47, 0
    v_dot2_f32_bf16 v18, v65, s46, 0
    v_dot2_f32_bf16 v19, v65, s47, 0
    s_waitcnt vmcnt(4)
    v_dot2_f32_bf16 v16, v66, s46, v16
    v_dot2_f32_bf16 v17, v66, s47, v17
    v_dot2_f32_bf16 v18, v67, s46, v18
    v_dot2_f32_bf16 v19, v67, s47, v19
    v_add_f32 v20, v56, v57
    s_waitcnt vmcnt(2)
    v_dot2_f32_bf16 v16, v68, s46, v16
    v_dot2_f32_bf16 v17, v68, s47, v17
    v_dot2_f32_bf16 v18, v69, s46, v18
    v_dot2_f32_bf16 v19, v69, s47, v19
    v_add_f32 v20, v20, v58
    s_waitcnt vmcnt(0)
    v_dot2_f32_bf16 v16, v70, s46, v16
    v_dot2_f32_bf16 v17, v70, s47, v17
    v_dot2_f32_bf16 v18, v71, s46, v18
    v_dot2_f32_bf16 v19, v71, s47, v19
    v_add_f32 v20, v20, v59
    s_nop 0
    v_cmp_u_f32 s[46:47], v16, v17
    v_cmp_u_f32 s[48:49], v18, v19
    v_cmp_u_f32 vcc, v20, v20
    v_max3_f32 v10, v16, v17, v18
    s_or_b64 s[46:47], s[46:47], s[48:49]
    v_max3_f32 v10, v10, v19, v20
    s_or_b64 vcc, vcc, s[46:47]
    s_cbranch_scc1 L_s_xf_199
L_s_xok_200:
    v_max_f32_dpp v11, v10, v10 row_ror:8 row_mask:0xf bank_mask:0xf
    v_max_f32_dpp v10, v10, v10 row_ror:8 row_mask:0xf bank_mask:0xf
    s_nop 1
    v_permlane16_swap_b32 v10, v11
    v_max_f32 v12, v10, v11
    v_max_f32 v10, v10, v11
    s_nop 1
    v_permlane32_swap_b32 v10, v12
    v_max_f32 v10, v10, v12
    v_mul_f32 v10, s66, v10
    v_fma_f32 v16, v16, s66, -v10
    v_fma_f32 v17, v17, s66, -v10
    v_fma_f32 v18, v18, s66, -v10
    v_fma_f32 v19, v19, s66, -v10
    v_fma_f32 v20, v20, s66, -v10
    v_exp_f32 v16, v16
    v_exp_f32 v17, v17
    v_exp_f32 v18, v18
    v_exp_f32 v19, v19
    v_exp_f32 v20, v20
    v_add_f32 v10, v16, v17
    v_add_f32 v11, v18, v19
    v_add_f32 v10, v10, v20
    v_add_f32 v10, v10, v11
    s_nop 1
    v_add_f32_dpp v11, v10, v10 row_ror:8 row_mask:0xf bank_mask:0xf
    v_add_f32_dpp v10, v10, v10 row_ror:8 row_mask:0xf bank_mask:0xf
    s_nop 1
    v_permlane16_swap_b32 v10, v11
    v_add_f32 v12, v10, v11
    v_add_f32 v10, v10, v11
    s_nop 1
    v_permlane32_swap_b32 v10, v12
    v_add_f32 v10, v10, v12
    v_rcp_f32 v10, v10
    s_nop 0
    v_mul_f32 v16, v16, v10
    v_mul_f32 v17, v17, v10
    v_mul_f32 v18, v18, v10
    v_mul_f32 v19, v19, v10
    v_mul_f32 v20, v20, v10
    v_cvt_pk_bf16_f32 v16, v16, v17
    v_cvt_pk_bf16_f32 v17, v18, v19
    v_cvt_pk_bf16_f32 v18, v20, v20
    ds_write_b64 v8, v[16:17]
    ds_write_b16 v9, v18
    s_waitcnt lgkmcnt(0)
    s_barrier
    s_add_u32 s63, s63, 786432
    s_cmp_ge_u32 s44, 2
    s_cbranch_scc1 L_s_nk_201
    buffer_load_dwordx4 v[32:35], v6, s[12:15], s63 offen sc1
L_s_nk_201:
    s_add_u32 s45, s60, 2
    s_cmp_le_u32 s69, s45
    s_cbranch_scc1 L_s_nk_201_w
    s_add_u32 s45, s63, 786432
    s_mov_b64 exec, 0xf
    buffer_load_dword v15, v14, s[12:15], s45 offen sc1
    s_mov_b64 exec, -1
L_s_nk_201_w:
    s_cmp_eq_u32 s44, 3
    s_cbranch_scc1 L_s_nr_202
    s_xor_b32 s45, s61, 0x8000
    s_mov_b64 exec, s[50:51]
    buffer_store_dwordx2 v[24:25], v4, s[12:15], s45 offen
    s_mov_b64 exec, -1
L_s_nr_202:
    s_cmp_lg_u32 s44, 3
    s_cbranch_scc1 L_s_np_203
    ds_read_b128 v[20:23], v6
    s_lshl_b32 s45, s60, 17
    s_add_u32 s45, s45, s67
    s_waitcnt lgkmcnt(0)
    v_min_u32 v20, -2, v20
    v_min_u32 v21, -2, v21
    v_min_u32 v22, -2, v22
    v_min_u32 v23, -2, v23
    buffer_store_dwordx4 v[20:23], v2, s[12:15], s45 offen sc1
L_s_np_203:
    s_add_u32 s68, s60, 2
    s_min_u32 s68, s68, 63
    v_readlane_b32 s45, v0, 0
    v_readlane_b32 s46, v0, 1
    s_nop 0
    s_min_u32 s45, s45, s46
    s_max_u32 s69, s69, s45
    s_cmp_gt_u32 s69, s68
    s_cbranch_scc1 L_kv_ok_206
    s_mov_b32 s70, 0
L_kv_lp_205:
    v_and_b32 v22, 1, v1
    v_lshlrev_b32 v22, 9, v22
    buffer_load_dword v23, v22, s[12:15], s57 offen sc1
    s_waitcnt vmcnt(0)
    v_readlane_b32 s69, v23, 0
    v_readlane_b32 s45, v23, 1
    s_add_u32 s70, s70, 1
    s_nop 2
    s_min_u32 s69, s69, s45
    s_cmp_gt_u32 s69, s68
    s_cbranch_scc1 L_kv_ok_206
    s_sleep 4
    s_cmp_lt_u32 s70, 524288
    s_cbranch_scc1 L_kv_lp_205
    s_branch L_c_done_1
L_kv_ok_206:
    s_add_u32 s45, s60, 7
    s_min_u32 s45, s45, 63
    s_cmp_gt_u32 s69, s45
    s_cbranch_scc1 L_s_na_204
    v_and_b32 v22, 1, v1
    v_lshlrev_b32 v22, 9, v22
    buffer_load_dword v0, v22, s[12:15], s57 offen sc1
L_s_na_204:
    s_sub_u32 s45, s60, 4
    s_cmp_gt_u32 s45, 24
    s_cbranch_scc1 L_s_xe_207
    s_sleep 1
    s_setprio 0
    s_bitcmp1_b32 s45, 0
    s_cbranch_scc1 L_s_x1_208
    s_cmp_eq_u32 s45, 0
    s_cbranch_scc1 L_s_x0_209
    s_bitcmp1_b32 s44, 0
    s_cbranch_scc1 L_s_x0_209
    ds_read_b128 v[40:43], v31
    s_sub_u32 s46, s45, 2
    s_lshr_b32 s47, s46, 2
    s_mul_i32 s47, s47, 786432
    s_and_b32 s46, s46, 2
    s_lshl_b32 s46, s46, 11
    s_add_u32 s47, s47, s46
    s_waitcnt lgkmcnt(0)
    buffer_store_dwordx4 v[40:43], v13, s[12:15], s47 offen sc1
L_s_x0_209:
    s_cmp_eq_u32 s45, 24
    s_cbranch_scc1 L_s_xe_207
    ds_read_b128 v[64:67], v44 offset:0
    ds_read_b128 v[68:71], v44 offset:1024
    ds_read_b128 v[72:75], v44 offset:2048
    ds_read_b128 v[76:79], v44 offset:3072
    ds_read_b128 v[80:83], v44 offset:4096
    ds_read_b128 v[84:87], v44 offset:5120
    ds_read_b128 v[88:91], v44 offset:6144
    ds_read_b128 v[92:95], v44 offset:7168
    ds_read_b128 v[96:99], v44 offset:8192
    ds_read_b128 v[100:103], v44 offset:9216
    ds_read_b128 v[104:107], v44 offset:10240
    ds_read_b128 v[108:111], v44 offset:11264
    s_waitcnt lgkmcnt(11)
    v_mfma_f32_16x16x32_bf16 v[36:39], a[0:3], v[64:67], 0
    ds_read_b128 v[112:115], v44 offset:12288
    s_waitcnt lgkmcnt(11)
    v_mfma_f32_16x16x32_bf16 v[36:39], a[4:7], v[68:71], v[36:39]
    ds_read_b128 v[116:119], v44 offset:13312
    s_waitcnt lgkmcnt(11)
    v_mfma_f32_16x16x32_bf16 v[36:39], a[8:11], v[72:75], v[36:39]
    ds_read_b128 v[120:123], v44 offset:14336
    s_waitcnt lgkmcnt(11)
    v_mfma_f32_16x16x32_bf16 v[36:39], a[12:15], v[76:79], v[36:39]
    ds_read_b128 v[124:127], v44 offset:15360
    s_waitcnt lgkmcnt(11)
    v_mfma_f32_16x16x32_bf16 v[36:39], a[16:19], v[80:83], v[36:39]
    s_waitcnt lgkmcnt(10)
    v_mfma_f32_16x16x32_bf16 v[36:39], a[20:23], v[84:87], v[36:39]
    s_waitcnt lgkmcnt(9)
    v_mfma_f32_16x16x32_bf16 v[36:39], a[24:27], v[88:91], v[36:39]
    s_waitcnt lgkmcnt(8)
    v_mfma_f32_16x16x32_bf16 v[36:39], a[28:31], v[92:95], v[36:39]
    s_waitcnt lgkmcnt(7)
    v_mfma_f32_16x16x32_bf16 v[36:39], a[32:35], v[96:99], v[36:39]
    s_waitcnt lgkmcnt(6)
    v_mfma_f32_16x16x32_bf16 v[36:39], a[36:39], v[100:103], v[36:39]
    s_waitcnt lgkmcnt(5)
    v_mfma_f32_16x16x32_bf16 v[36:39], a[40:43], v[104:107], v[36:39]
    s_waitcnt lgkmcnt(4)
    v_mfma_f32_16x16x32_bf16 v[36:39], a[44:47], v[108:111], v[36:39]
    s_waitcnt lgkmcnt(3)
    v_mfma_f32_16x16x32_bf16 v[36:39], a[48:51], v[112:115], v[36:39]
    s_waitcnt lgkmcnt(2)
    v_mfma_f32_16x16x32_bf16 v[36:39], a[52:55], v[116:119], v[36:39]
    s_waitcnt lgkmcnt(1)
    v_mfma_f32_16x16x32_bf16 v[36:39], a[56:59], v[120:123], v[36:39]
    s_waitcnt lgkmcnt(0)
    v_mfma_f32_16x16x32_bf16 v[36:39], a[60:63], v[124:127], v[36:39]
    s_branch L_s_xe_207
L_s_x1_208:
    ds_read_b128 v[64:67], v44 offset:16384
    ds_read_b128 v[68:71], v44 offset:17408
    ds_read_b128 v[72:75], v44 offset:18432
    ds_read_b128 v[76:79], v44 offset:19456
    ds_read_b128 v[80:83], v44 offset:20480
    ds_read_b128 v[84:87], v44 offset:21504
    ds_read_b128 v[88:91], v44 offset:22528
    ds_read_b128 v[92:95], v44 offset:23552
    ds_read_b128 v[96:99], v44 offset:24576
    ds_read_b128 v[100:103], v44 offset:25600
    ds_read_b128 v[104:107], v44 offset:26624
    ds_read_b128 v[108:111], v44 offset:27648
    s_waitcnt lgkmcnt(11)
    v_mfma_f32_16x16x32_bf16 v[36:39], a[64:67], v[64:67], v[36:39]
    ds_read_b128 v[112:115], v44 offset:28672
    s_waitcnt lgkmcnt(11)
    v_mfma_f32_16x16x32_bf16 v[36:39], a[68:71], v[68:71], v[36:39]
    ds_read_b128 v[116:119], v44 offset:29696
    s_waitcnt lgkmcnt(11)
    v_mfma_f32_16x16x32_bf16 v[36:39], a[72:75], v[72:75], v[36:39]
    ds_read_b128 v[120:123], v44 offset:30720
    s_waitcnt lgkmcnt(11)
    v_mfma_f32_16x16x32_bf16 v[36:39], a[76:79], v[76:79], v[36:39]
    ds_read_b128 v[124:127], v44 offset:31744
    s_waitcnt lgkmcnt(11)
    v_mfma_f32_16x16x32_bf16 v[36:39], a[80:83], v[80:83], v[36:39]
    s_waitcnt lgkmcnt(10)
    v_mfma_f32_16x16x32_bf16 v[36:39], a[84:87], v[84:87], v[36:39]
    s_waitcnt lgkmcnt(9)
    v_mfma_f32_16x16x32_bf16 v[36:39], a[88:91], v[88:91], v[36:39]
    s_waitcnt lgkmcnt(8)
    v_mfma_f32_16x16x32_bf16 v[36:39], a[92:95], v[92:95], v[36:39]
    s_waitcnt lgkmcnt(7)
    v_mfma_f32_16x16x32_bf16 v[36:39], a[96:99], v[96:99], v[36:39]
    s_waitcnt lgkmcnt(6)
    v_mfma_f32_16x16x32_bf16 v[36:39], a[100:103], v[100:103], v[36:39]
    s_waitcnt lgkmcnt(5)
    v_mfma_f32_16x16x32_bf16 v[36:39], a[104:107], v[104:107], v[36:39]
    s_waitcnt lgkmcnt(4)
    v_mfma_f32_16x16x32_bf16 v[36:39], a[108:111], v[108:111], v[36:39]
    s_waitcnt lgkmcnt(3)
    v_mfma_f32_16x16x32_bf16 v[36:39], a[112:115], v[112:115], v[36:39]
    s_waitcnt lgkmcnt(2)
    v_mfma_f32_16x16x32_bf16 v[36:39], a[116:119], v[116:119], v[36:39]
    s_waitcnt lgkmcnt(1)
    v_mfma_f32_16x16x32_bf16 v[36:39], a[120:123], v[120:123], v[36:39]
    s_waitcnt lgkmcnt(0)
    v_mfma_f32_16x16x32_bf16 v[36:39], a[124:127], v[124:127], v[36:39]
    s_nop 7
    v_cvt_pk_bf16_f32 v40, v36, v37
    v_cvt_pk_bf16_f32 v41, v38, v39
    ds_write_b64 v45, v[40:41]
    s_waitcnt lgkmcnt(0)
L_s_xe_207:
    s_setprio 1
    s_add_u32 s60, s60, 1
    s_add_u32 s61, s61, 0x4000
    s_and_b32 s61, s61, 0xffff
    s_branch L_s_loop_192
L_s_last_193:
    s_waitcnt lgkmcnt(0)
    s_barrier
    s_cmp_lg_u32 s44, 3
    s_cbranch_scc1 L_s_np_210
    ds_read_b128 v[20:23], v6
    s_lshl_b32 s45, s60, 17
    s_add_u32 s45, s45, s67
    s_waitcnt lgkmcnt(0)
    v_min_u32 v20, -2, v20
    v_min_u32 v21, -2, v21
    v_min_u32 v22, -2, v22
    v_min_u32 v23, -2, v23
    buffer_store_dwordx4 v[20:23], v2, s[12:15], s45 offen sc1
L_s_np_210:
    s_branch L_replica
L_rt_187:
    s_add_u32 s70, s70, 1
    s_cmp_lt_u32 s70, 524288
    s_cbranch_scc1 L_c_rp_186
    s_branch L_c_done_1
L_rt_197:
    s_add_u32 s70, s70, 1
    s_cmp_lt_u32 s70, 524288
    s_cbranch_scc1 L_s_xl_194
    s_branch L_c_done_1
L_s_w2_195:
    s_cmp_eq_u32 s44, 3
    s_cbranch_scc1 L_s_w3_196
    s_waitcnt lgkmcnt(0)
    v_mfma_f32_16x16x32_bf16 v[16:19], v[64:67], v[64:67], 0
    s_branch L_s_w2_195_b
L_s_w3_196:
    s_sleep 3
    s_branch L_s_w3_196_b
L_s_xf_199:
    v_or_b32 v72, 0xffff, v56
    v_or_b32 v73, 0xffff, v57
    v_or_b32 v74, 0xffff, v58
    v_or_b32 v75, 0xffff, v59
    v_max3_u32 v11, v64, v65, v66
    v_max3_u32 v11, v11, v67, v68
    v_max3_u32 v11, v11, v69, v70
    v_max3_u32 v11, v11, v71, v72
    v_max3_u32 v11, v11, v73, v74
    v_max_u32 v11, v11, v75
    v_cmp_eq_u32 vcc, -1, v11
    s_add_u32 s70, s70, 1
    s_cbranch_vccz L_s_xok_200
    s_cmp_lt_u32 s70, 524288
    s_cbranch_scc1 L_s_xp_198
    s_branch L_c_done_1
L_ss_189:
.p2align 6
L_s_loop_211:
    v_mov_b32 v16, 0
    v_mov_b32 v17, 0
    v_mov_b32 v18, 0
    v_mov_b32 v19, 0
    s_add_u32 s58, s58, 4
    s_mov_b32 s70, 1
    s_waitcnt vmcnt(0) lgkmcnt(0)
    s_barrier
    ds_read_b128 v[64:67], v2 offset:0
    ds_read_b128 v[68:71], v2 offset:1024
    ds_read_b128 v[72:75], v2 offset:2048
    ds_read_b128 v[76:79], v2 offset:3072
    ds_read_b128 v[80:83], v2 offset:4096
    ds_read_b128 v[84:87], v2 offset:5120
    ds_read_b128 v[88:91], v2 offset:6144
    ds_read_b128 v[92:95], v2 offset:7168
    ds_read_b128 v[96:99], v2 offset:8192
    ds_read_b128 v[100:103], v2 offset:9216
    ds_read_b128 v[104:107], v2 offset:10240
    ds_read_b128 v[108:111], v2 offset:11264
    s_waitcnt lgkmcnt(11)
    v_smfmac_f32_16x16x64_bf16 v[16:19], v[64:67], a[0:7], v3
    ds_read_b128 v[112:115], v2 offset:12288
    s_waitcnt lgkmcnt(11)
    v_smfmac_f32_16x16x64_bf16 v[16:19], v[68:71], a[8:15], v3
    ds_read_b128 v[116:119], v2 offset:13312
    s_waitcnt lgkmcnt(11)
    v_smfmac_f32_16x16x64_bf16 v[16:19], v[72:75], a[16:23], v3
    ds_read_b128 v[120:123], v2 offset:14336
    s_waitcnt lgkmcnt(11)
    v_smfmac_f32_16x16x64_bf16 v[16:19], v[76:79], a[24:31], v3
    ds_read_b128 v[124:127], v2 offset:15360
    s_waitcnt lgkmcnt(11)
    v_smfmac_f32_16x16x64_bf16 v[16:19], v[80:83], a[32:39], v3
    s_waitcnt lgkmcnt(10)
    v_smfmac_f32_16x16x64_bf16 v[16:19], v[84:87], a[40:47], v3
    s_waitcnt lgkmcnt(9)
    v_smfmac_f32_16x16x64_bf16 v[16:19], v[88:91], a[48:55], v3
    s_waitcnt lgkmcnt(8)
    v_smfmac_f32_16x16x64_bf16 v[16:19], v[92:95], a[56:63], v3
    s_waitcnt lgkmcnt(7)
    v_smfmac_f32_16x16x64_bf16 v[16:19], v[96:99], a[64:71], v3
    s_waitcnt lgkmcnt(6)
    v_smfmac_f32_16x16x64_bf16 v[16:19], v[100:103], a[72:79], v3
    s_waitcnt lgkmcnt(5)
    v_smfmac_f32_16x16x64_bf16 v[16:19], v[104:107], a[80:87], v3
    s_waitcnt lgkmcnt(4)
    v_smfmac_f32_16x16x64_bf16 v[16:19], v[108:111], a[88:95], v3
    s_waitcnt lgkmcnt(3)
    v_smfmac_f32_16x16x64_bf16 v[16:19], v[112:115], a[96:103], v3
    s_waitcnt lgkmcnt(2)
    v_smfmac_f32_16x16x64_bf16 v[16:19], v[116:119], a[104:111], v3
    s_waitcnt lgkmcnt(1)
    v_smfmac_f32_16x16x64_bf16 v[16:19], v[120:123], a[112:119], v3
    s_waitcnt lgkmcnt(0)
    v_smfmac_f32_16x16x64_bf16 v[16:19], v[124:127], a[120:127], v3
    s_nop 7
    v_permlane32_swap_b32 v16, v18
    v_permlane32_swap_b32 v17, v19
    v_add_f32 v16, v16, v18
    v_add_f32 v17, v17, v19
    v_cvt_pk_bf16_f32 v16, v16, v17
    ds_write_b16 v5, v16
    ds_write_b16_d16_hi v5, v16 offset:16
    s_mov_b64 exec, 1
    ds_add_u32 v29, v30
    s_mov_b64 exec, -1
L_s_xl_213:
    ds_read_b32 v10, v29
    ds_read_b128 v[64:67], v2 offset:61440
    s_cmp_eq_u32 s60, 63
    s_cbranch_scc1 L_s_last_212
    s_cmp_ge_u32 s44, 2
    s_cbranch_scc1 L_s_w2_214
    s_waitcnt lgkmcnt(0)
    v_mfma_f32_16x16x32_bf16 v[16:19], v[32:35], v[64:67], 0
L_s_w2_214_b:
    v_cmp_ne_u32 vcc, s58, v10
    s_nop 0
    s_cbranch_vccnz L_rt_216
    s_mov_b64 exec, s[50:51]
    s_nop 3
    v_cvt_pk_bf16_f32 v16, v16, v17
    v_cvt_pk_bf16_f32 v17, v18, v19
    v_pk_min_u16 v16, v16, v54
    v_pk_min_u16 v17, v17, v54
    buffer_store_dwordx2 v[16:17], v4, s[12:15], s61 offen sc1
    s_mov_b64 exec, -1
L_s_w3_215_b:
    s_sleep 5
    s_mov_b32 s70, 1
L_s_xp_217:
    buffer_load_dwordx2 v[64:65], v7, s[12:15], s61 offen offset:0 sc1
    buffer_load_short_d16_hi v56, v28, s[12:15], s61 offen offset:0 sc1
    buffer_load_dwordx2 v[66:67], v7, s[12:15], s61 offen offset:512 sc1
    buffer_load_short_d16_hi v57, v28, s[12:15], s61 offen offset:128 sc1
    buffer_load_dwordx2 v[68:69], v7, s[12:15], s61 offen offset:1024 sc1
    buffer_load_short_d16_hi v58, v28, s[12:15], s61 offen offset:256 sc1
    buffer_load_dwordx2 v[70:71], v7, s[12:15], s61 offen offset:1536 sc1
    buffer_load_short_d16_hi v59, v28, s[12:15], s61 offen offset:384 sc1
    s_mov_b32 s46, 0x00003f80
    s_mov_b32 s47, 0x3f800000
    s_waitcnt vmcnt(6)
    v_dot2_f32_bf16 v16, v64, s46, 0
    v_dot2_f32_bf16 v17, v64, s47, 0
    v_dot2_f32_bf16 v18, v65, s46, 0
    v_dot2_f32_bf16 v19, v65, s47, 0
    s_waitcnt vmcnt(4)
    v_dot2_f32_bf16 v16, v66, s46, v16
    v_dot2_f32_bf16 v17, v66, s47, v17
    v_dot2_f32_bf16 v18, v67, s46, v18
    v_dot2_f32_bf16 v19, v67, s47, v19
    v_add_f32 v20, v56, v57
    s_waitcnt vmcnt(2)
    v_dot2_f32_bf16 v16, v68, s46, v16
    v_dot2_f32_bf16 v17, v68, s47, v17
    v_dot2_f32_bf16 v18, v69, s46, v18
    v_dot2_f32_bf16 v19, v69, s47, v19
    v_add_f32 v20, v20, v58
    s_waitcnt vmcnt(0)
    v_dot2_f32_bf16 v16, v70, s46, v16
    v_dot2_f32_bf16 v17, v70, s47, v17
    v_dot2_f32_bf16 v18, v71, s46, v18
    v_dot2_f32_bf16 v19, v71, s47, v19
    v_add_f32 v20, v20, v59
    s_nop 0
    v_cmp_u_f32 s[46:47], v16, v17
    v_cmp_u_f32 s[48:49], v18, v19
    v_cmp_u_f32 vcc, v20, v20
    v_max3_f32 v10, v16, v17, v18
    s_or_b64 s[46:47], s[46:47], s[48:49]
    v_max3_f32 v10, v10, v19, v20
    s_or_b64 vcc, vcc, s[46:47]
    s_cbranch_scc1 L_s_xf_218
L_s_xok_219:
    v_max_f32_dpp v11, v10, v10 row_ror:8 row_mask:0xf bank_mask:0xf
    v_max_f32_dpp v10, v10, v10 row_ror:8 row_mask:0xf bank_mask:0xf
    s_nop 1
    v_permlane16_swap_b32 v10, v11
    v_max_f32 v12, v10, v11
    v_max_f32 v10, v10, v11
    s_nop 1
    v_permlane32_swap_b32 v10, v12
    v_max_f32 v10, v10, v12
    v_mul_f32 v10, s66, v10
    v_fma_f32 v16, v16, s66, -v10
    v_fma_f32 v17, v17, s66, -v10
    v_fma_f32 v18, v18, s66, -v10
    v_fma_f32 v19, v19, s66, -v10
    v_fma_f32 v20, v20, s66, -v10
    v_exp_f32 v16, v16
    v_exp_f32 v17, v17
    v_exp_f32 v18, v18
    v_exp_f32 v19, v19
    v_exp_f32 v20, v20
    v_add_f32 v10, v16, v17
    v_add_f32 v11, v18, v19
    v_add_f32 v10, v10, v20
    v_add_f32 v10, v10, v11
    s_nop 1
    v_add_f32_dpp v11, v10, v10 row_ror:8 row_mask:0xf bank_mask:0xf
    v_add_f32_dpp v10, v10, v10 row_ror:8 row_mask:0xf bank_mask:0xf
    s_nop 1
    v_permlane16_swap_b32 v10, v11
    v_add_f32 v12, v10, v11
    v_add_f32 v10, v10, v11
    s_nop 1
    v_permlane32_swap_b32 v10, v12
    v_add_f32 v10, v10, v12
    v_rcp_f32 v10, v10
    s_nop 0
    v_mul_f32 v16, v16, v10
    v_mul_f32 v17, v17, v10
    v_mul_f32 v18, v18, v10
    v_mul_f32 v19, v19, v10
    v_mul_f32 v20, v20, v10
    v_cvt_pk_bf16_f32 v16, v16, v17
    v_cvt_pk_bf16_f32 v17, v18, v19
    v_cvt_pk_bf16_f32 v18, v20, v20
    ds_write_b64 v8, v[16:17]
    ds_write_b16 v9, v18
    s_waitcnt lgkmcnt(0)
    s_barrier
    s_add_u32 s63, s63, 786432
    s_cmp_ge_u32 s44, 2
    s_cbranch_scc1 L_s_nk_220
    buffer_load_dwordx4 v[32:35], v6, s[12:15], s63 offen sc1
L_s_nk_220:
    s_add_u32 s45, s60, 2
    s_cmp_le_u32 s69, s45
    s_cbranch_scc1 L_s_nk_220_w
    s_add_u32 s45, s63, 786432
    s_mov_b64 exec, 0xf
    buffer_load_dword v15, v14, s[12:15], s45 offen sc1
    s_mov_b64 exec, -1
L_s_nk_220_w:
    s_cmp_eq_u32 s44, 3
    s_cbranch_scc1 L_s_nr_221
    s_xor_b32 s45, s61, 0x8000
    s_mov_b64 exec, s[50:51]
    buffer_store_dwordx2 v[24:25], v4, s[12:15], s45 offen sc1
    s_mov_b64 exec, -1
L_s_nr_221:
    s_cmp_lg_u32 s44, 3
    s_cbranch_scc1 L_s_np_222
    ds_read_b128 v[20:23], v6
    s_lshl_b32 s45, s60, 17
    s_add_u32 s45, s45, s67
    s_waitcnt lgkmcnt(0)
    v_min_u32 v20, -2, v20
    v_min_u32 v21, -2, v21
    v_min_u32 v22, -2, v22
    v_min_u32 v23, -2, v23
    buffer_store_dwordx4 v[20:23], v2, s[12:15], s45 offen sc1
L_s_np_222:
    s_add_u32 s68, s60, 2
    s_min_u32 s68, s68, 63
    v_readlane_b32 s45, v0, 0
    v_readlane_b32 s46, v0, 1
    s_nop 0
    s_min_u32 s45, s45, s46
    s_max_u32 s69, s69, s45
    s_cmp_gt_u32 s69, s68
    s_cbranch_scc1 L_kv_ok_225
    s_mov_b32 s70, 0
L_kv_lp_224:
    v_and_b32 v22, 1, v1
    v_lshlrev_b32 v22, 9, v22
    buffer_load_dword v23, v22, s[12:15], s57 offen sc1
    s_waitcnt vmcnt(0)
    v_readlane_b32 s69, v23, 0
    v_readlane_b32 s45, v23, 1
    s_add_u32 s70, s70, 1
    s_nop 2
    s_min_u32 s69, s69, s45
    s_cmp_gt_u32 s69, s68
    s_cbranch_scc1 L_kv_ok_225
    s_sleep 4
    s_cmp_lt_u32 s70, 524288
    s_cbranch_scc1 L_kv_lp_224
    s_branch L_c_done_1
L_kv_ok_225:
    s_add_u32 s45, s60, 7
    s_min_u32 s45, s45, 63
    s_cmp_gt_u32 s69, s45
    s_cbranch_scc1 L_s_na_223
    v_and_b32 v22, 1, v1
    v_lshlrev_b32 v22, 9, v22
    buffer_load_dword v0, v22, s[12:15], s57 offen sc1
L_s_na_223:
    s_sub_u32 s45, s60, 4
    s_cmp_gt_u32 s45, 24
    s_cbranch_scc1 L_s_xe_226
    s_sleep 1
    s_setprio 0
    s_bitcmp1_b32 s45, 0
    s_cbranch_scc1 L_s_x1_227
    s_cmp_eq_u32 s45, 0
    s_cbranch_scc1 L_s_x0_228
    s_bitcmp1_b32 s44, 0
    s_cbranch_scc1 L_s_x0_228
    ds_read_b128 v[40:43], v31
    s_sub_u32 s46, s45, 2
    s_lshr_b32 s47, s46, 2
    s_mul_i32 s47, s47, 786432
    s_and_b32 s46, s46, 2
    s_lshl_b32 s46, s46, 11
    s_add_u32 s47, s47, s46
    s_waitcnt lgkmcnt(0)
    buffer_store_dwordx4 v[40:43], v13, s[12:15], s47 offen sc1
L_s_x0_228:
    s_cmp_eq_u32 s45, 24
    s_cbranch_scc1 L_s_xe_226
    ds_read_b128 v[64:67], v44 offset:0
    ds_read_b128 v[68:71], v44 offset:1024
    ds_read_b128 v[72:75], v44 offset:2048
    ds_read_b128 v[76:79], v44 offset:3072
    ds_read_b128 v[80:83], v44 offset:4096
    ds_read_b128 v[84:87], v44 offset:5120
    ds_read_b128 v[88:91], v44 offset:6144
    ds_read_b128 v[92:95], v44 offset:7168
    ds_read_b128 v[96:99], v44 offset:8192
    ds_read_b128 v[100:103], v44 offset:9216
    ds_read_b128 v[104:107], v44 offset:10240
    ds_read_b128 v[108:111], v44 offset:11264
    s_waitcnt lgkmcnt(11)
    v_mfma_f32_16x16x32_bf16 v[36:39], a[0:3], v[64:67], 0
    ds_read_b128 v[112:115], v44 offset:12288
    s_waitcnt lgkmcnt(11)
    v_mfma_f32_16x16x32_bf16 v[36:39], a[4:7], v[68:71], v[36:39]
    ds_read_b128 v[116:119], v44 offset:13312
    s_waitcnt lgkmcnt(11)
    v_mfma_f32_16x16x32_bf16 v[36:39], a[8:11], v[72:75], v[36:39]
    ds_read_b128 v[120:123], v44 offset:14336
    s_waitcnt lgkmcnt(11)
    v_mfma_f32_16x16x32_bf16 v[36:39], a[12:15], v[76:79], v[36:39]
    ds_read_b128 v[124:127], v44 offset:15360
    s_waitcnt lgkmcnt(11)
    v_mfma_f32_16x16x32_bf16 v[36:39], a[16:19], v[80:83], v[36:39]
    s_waitcnt lgkmcnt(10)
    v_mfma_f32_16x16x32_bf16 v[36:39], a[20:23], v[84:87], v[36:39]
    s_waitcnt lgkmcnt(9)
    v_mfma_f32_16x16x32_bf16 v[36:39], a[24:27], v[88:91], v[36:39]
    s_waitcnt lgkmcnt(8)
    v_mfma_f32_16x16x32_bf16 v[36:39], a[28:31], v[92:95], v[36:39]
    s_waitcnt lgkmcnt(7)
    v_mfma_f32_16x16x32_bf16 v[36:39], a[32:35], v[96:99], v[36:39]
    s_waitcnt lgkmcnt(6)
    v_mfma_f32_16x16x32_bf16 v[36:39], a[36:39], v[100:103], v[36:39]
    s_waitcnt lgkmcnt(5)
    v_mfma_f32_16x16x32_bf16 v[36:39], a[40:43], v[104:107], v[36:39]
    s_waitcnt lgkmcnt(4)
    v_mfma_f32_16x16x32_bf16 v[36:39], a[44:47], v[108:111], v[36:39]
    s_waitcnt lgkmcnt(3)
    v_mfma_f32_16x16x32_bf16 v[36:39], a[48:51], v[112:115], v[36:39]
    s_waitcnt lgkmcnt(2)
    v_mfma_f32_16x16x32_bf16 v[36:39], a[52:55], v[116:119], v[36:39]
    s_waitcnt lgkmcnt(1)
    v_mfma_f32_16x16x32_bf16 v[36:39], a[56:59], v[120:123], v[36:39]
    s_waitcnt lgkmcnt(0)
    v_mfma_f32_16x16x32_bf16 v[36:39], a[60:63], v[124:127], v[36:39]
    s_branch L_s_xe_226
L_s_x1_227:
    ds_read_b128 v[64:67], v44 offset:16384
    ds_read_b128 v[68:71], v44 offset:17408
    ds_read_b128 v[72:75], v44 offset:18432
    ds_read_b128 v[76:79], v44 offset:19456
    ds_read_b128 v[80:83], v44 offset:20480
    ds_read_b128 v[84:87], v44 offset:21504
    ds_read_b128 v[88:91], v44 offset:22528
    ds_read_b128 v[92:95], v44 offset:23552
    ds_read_b128 v[96:99], v44 offset:24576
    ds_read_b128 v[100:103], v44 offset:25600
    ds_read_b128 v[104:107], v44 offset:26624
    ds_read_b128 v[108:111], v44 offset:27648
    s_waitcnt lgkmcnt(11)
    v_mfma_f32_16x16x32_bf16 v[36:39], a[64:67], v[64:67], v[36:39]
    ds_read_b128 v[112:115], v44 offset:28672
    s_waitcnt lgkmcnt(11)
    v_mfma_f32_16x16x32_bf16 v[36:39], a[68:71], v[68:71], v[36:39]
    ds_read_b128 v[116:119], v44 offset:29696
    s_waitcnt lgkmcnt(11)
    v_mfma_f32_16x16x32_bf16 v[36:39], a[72:75], v[72:75], v[36:39]
    ds_read_b128 v[120:123], v44 offset:30720
    s_waitcnt lgkmcnt(11)
    v_mfma_f32_16x16x32_bf16 v[36:39], a[76:79], v[76:79], v[36:39]
    ds_read_b128 v[124:127], v44 offset:31744
    s_waitcnt lgkmcnt(11)
    v_mfma_f32_16x16x32_bf16 v[36:39], a[80:83], v[80:83], v[36:39]
    s_waitcnt lgkmcnt(10)
    v_mfma_f32_16x16x32_bf16 v[36:39], a[84:87], v[84:87], v[36:39]
    s_waitcnt lgkmcnt(9)
    v_mfma_f32_16x16x32_bf16 v[36:39], a[88:91], v[88:91], v[36:39]
    s_waitcnt lgkmcnt(8)
    v_mfma_f32_16x16x32_bf16 v[36:39], a[92:95], v[92:95], v[36:39]
    s_waitcnt lgkmcnt(7)
    v_mfma_f32_16x16x32_bf16 v[36:39], a[96:99], v[96:99], v[36:39]
    s_waitcnt lgkmcnt(6)
    v_mfma_f32_16x16x32_bf16 v[36:39], a[100:103], v[100:103], v[36:39]
    s_waitcnt lgkmcnt(5)
    v_mfma_f32_16x16x32_bf16 v[36:39], a[104:107], v[104:107], v[36:39]
    s_waitcnt lgkmcnt(4)
    v_mfma_f32_16x16x32_bf16 v[36:39], a[108:111], v[108:111], v[36:39]
    s_waitcnt lgkmcnt(3)
    v_mfma_f32_16x16x32_bf16 v[36:39], a[112:115], v[112:115], v[36:39]
    s_waitcnt lgkmcnt(2)
    v_mfma_f32_16x16x32_bf16 v[36:39], a[116:119], v[116:119], v[36:39]
    s_waitcnt lgkmcnt(1)
    v_mfma_f32_16x16x32_bf16 v[36:39], a[120:123], v[120:123], v[36:39]
    s_waitcnt lgkmcnt(0)
    v_mfma_f32_16x16x32_bf16 v[36:39], a[124:127], v[124:127], v[36:39]
    s_nop 7
    v_cvt_pk_bf16_f32 v40, v36, v37
    v_cvt_pk_bf16_f32 v41, v38, v39
    ds_write_b64 v45, v[40:41]
    s_waitcnt lgkmcnt(0)
L_s_xe_226:
    s_setprio 1
    s_add_u32 s60, s60, 1
    s_add_u32 s61, s61, 0x4000
    s_and_b32 s61, s61, 0xffff
    s_branch L_s_loop_211
L_s_last_212:
    s_waitcnt lgkmcnt(0)
    s_barrier
    s_cmp_lg_u32 s44, 3
    s_cbranch_scc1 L_s_np_229
    ds_read_b128 v[20:23], v6
    s_lshl_b32 s45, s60, 17
    s_add_u32 s45, s45, s67
    s_waitcnt lgkmcnt(0)
    v_min_u32 v20, -2, v20
    v_min_u32 v21, -2, v21
    v_min_u32 v22, -2, v22
    v_min_u32 v23, -2, v23
    buffer_store_dwordx4 v[20:23], v2, s[12:15], s45 offen sc1
L_s_np_229:
    s_branch L_replica
L_rt_216:
    s_add_u32 s70, s70, 1
    s_cmp_lt_u32 s70, 524288
    s_cbranch_scc1 L_s_xl_213
    s_branch L_c_done_1
L_s_w2_214:
    s_cmp_eq_u32 s44, 3
    s_cbranch_scc1 L_s_w3_215
    s_waitcnt lgkmcnt(0)
    v_mfma_f32_16x16x32_bf16 v[16:19], v[64:67], v[64:67], 0
    s_branch L_s_w2_214_b
L_s_w3_215:
    s_sleep 3
    s_branch L_s_w3_215_b
L_s_xf_218:
    v_or_b32 v72, 0xffff, v56
    v_or_b32 v73, 0xffff, v57
    v_or_b32 v74, 0xffff, v58
    v_or_b32 v75, 0xffff, v59
    v_max3_u32 v11, v64, v65, v66
    v_max3_u32 v11, v11, v67, v68
    v_max3_u32 v11, v11, v69, v70
    v_max3_u32 v11, v11, v71, v72
    v_max3_u32 v11, v11, v73, v74
    v_max_u32 v11, v11, v75
    v_cmp_eq_u32 vcc, -1, v11
    s_add_u32 s70, s70, 1
    s_cbranch_vccz L_s_xok_219
    s_cmp_lt_u32 s70, 524288
    s_cbranch_scc1 L_s_xp_217
    s_branch L_c_done_1
L_vf_190:
    s_cmp_eq_u32 s52, 0
    s_cbranch_scc1 L_vs_191
    s_mov_b32 s70, 1
    v_mov_b32 v16, 0
    v_mov_b32 v17, 0
    s_branch L_v_l1m_232
.p2align 6
L_v_loop_230:
    s_mov_b32 s70, 1
    buffer_load_dwordx4 v[64:67], v9, s[12:15], s61 offen offset:0 sc1
    buffer_load_dwordx4 v[68:71], v9, s[12:15], s61 offen offset:1024 sc1
    buffer_load_dwordx4 v[72:75], v9, s[12:15], s61 offen offset:2048 sc1
    buffer_load_dwordx4 v[76:79], v9, s[12:15], s61 offen offset:3072 sc1
    v_mov_b32 v16, 0
    v_mov_b32 v17, 0
    v_mov_b32 v18, 0
    v_mov_b32 v19, 0
    v_mov_b32 v20, 0
    v_mov_b32 v21, 0
    v_mov_b32 v22, 0
    v_mov_b32 v23, 0
L_v_l1m_232:
    s_waitcnt vmcnt(3)
    ds_write_b128 v10, v[64:67] offset:0
    v_max3_u32 v24, v64, v65, v66
    v_max_u32 v24, v24, v67
    v_cmp_eq_u32 s[48:49], -1, v24
    s_waitcnt vmcnt(2)
    ds_write_b128 v10, v[68:71] offset:1024
    v_max3_u32 v24, v68, v69, v70
    v_max_u32 v24, v24, v71
    v_cmp_eq_u32 s[50:51], -1, v24
    s_waitcnt vmcnt(1)
    ds_write_b128 v10, v[72:75] offset:2048
    v_max3_u32 v24, v72, v73, v74
    v_max_u32 v24, v24, v75
    v_cmp_eq_u32 s[52:53], -1, v24
    s_waitcnt vmcnt(0)
    ds_write_b128 v10, v[76:79] offset:3072
    v_max3_u32 v24, v76, v77, v78
    v_max_u32 v24, v24, v79
    v_cmp_eq_u32 s[54:55], -1, v24
    s_or_b64 s[46:47], s[48:49], s[50:51]
    s_or_b64 vcc, s[52:53], s[54:55]
    s_or_b64 vcc, vcc, s[46:47]
    s_cbranch_scc1 L_v_l1_231
L_v_l1ok_233:
    s_waitcnt lgkmcnt(0)
    s_barrier
    v_smfmac_f32_16x16x64_bf16 v[16:19], v[64:67], a[0:7], v3
    v_smfmac_f32_16x16x64_bf16 v[20:23], v[64:67], a[32:39], v3
    v_smfmac_f32_16x16x64_bf16 v[16:19], v[68:71], a[8:15], v3
    v_smfmac_f32_16x16x64_bf16 v[20:23], v[68:71], a[40:47], v3
    v_smfmac_f32_16x16x64_bf16 v[16:19], v[72:75], a[16:23], v3
    v_smfmac_f32_16x16x64_bf16 v[20:23], v[72:75], a[48:55], v3
    v_smfmac_f32_16x16x64_bf16 v[16:19], v[76:79], a[24:31], v3
    v_smfmac_f32_16x16x64_bf16 v[20:23], v[76:79], a[56:63], v3
    s_nop 6
    v_permlane32_swap_b32 v16, v18
    v_permlane32_swap_b32 v17, v19
    v_permlane32_swap_b32 v20, v22
    v_permlane32_swap_b32 v21, v23
    v_add_f32 v16, v16, v18
    v_add_f32 v17, v17, v19
    v_add_f32 v18, v20, v22
    v_add_f32 v19, v21, v23
    ds_write_b128 v14, v[16:19]
    s_mov_b64 exec, 1
    ds_add_u32 v29, v30
    s_mov_b64 exec, -1
    s_add_u32 s58, s58, 4
    s_bitcmp1_b32 s44, 0
    s_cbranch_scc1 L_v_k1_235_c
    s_mov_b32 s70, 0
L_v_rl_236:
    ds_read_b32 v24, v29
    ds_read_b64 v[16:17], v13 offset:0
    ds_read_b64 v[18:19], v13 offset:1024
    ds_read_b64 v[20:21], v13 offset:2048
    ds_read_b64 v[22:23], v13 offset:3072
    s_waitcnt lgkmcnt(2)
    v_cmp_ne_u32 vcc, s58, v24
    v_add_f32 v16, v16, v18
    v_add_f32 v17, v17, v19
    s_waitcnt lgkmcnt(0)
    s_cbranch_vccnz L_rt_237
    v_add_f32 v20, v20, v22
    v_add_f32 v21, v21, v23
    v_add_f32 v16, v16, v20
    v_add_f32 v17, v17, v21
    s_mov_b32 vcc_lo, 0x55555555
    s_mov_b32 vcc_hi, 0x55555555
    v_cndmask_b32_dpp v18, v17, v16, vcc quad_perm:[1,0,3,2] row_mask:0xf bank_mask:0xf
    s_not_b64 vcc, vcc
    v_cndmask_b32_dpp v19, v16, v17, vcc quad_perm:[1,0,3,2] row_mask:0xf bank_mask:0xf
    v_cvt_pk_bf16_f32 v18, v18, v19
    v_min_u32 v18, -2, v18
    buffer_store_dword v18, v4, s[12:15], s62 offen
    ds_write_b32 v5, v18
L_v_k1_235:
    s_cmp_eq_u32 s60, 63
    s_cbranch_scc1 L_v_last_234
    ds_read_b128 v[80:83], v27 offset:32768
    ds_read_b128 v[84:87], v27 offset:36864
    ds_read_b128 v[88:91], v27 offset:40960
    ds_read_b128 v[92:95], v27 offset:45056
    v_mov_b32 v96, 0
    v_mov_b32 v97, 0
    v_mov_b32 v98, 0
    v_mov_b32 v99, 0
    v_mov_b32 v100, 0
    v_mov_b32 v101, 0
    v_mov_b32 v102, 0
    v_mov_b32 v103, 0
    v_mov_b32 v104, 0
    v_mov_b32 v105, 0
    v_mov_b32 v106, 0
    v_mov_b32 v107, 0
    v_mov_b32 v108, 0
    v_mov_b32 v109, 0
    v_mov_b32 v110, 0
    v_mov_b32 v111, 0
    s_bitcmp1_b32 s44, 0
    s_cbranch_scc0 L_v_sv_238
    s_sleep 1
L_v_sv_238:
    s_sleep 3
    s_mov_b32 s70, 1
    buffer_load_dwordx4 v[64:67], v11, s[12:15], s62 offen offset:0 sc1
    buffer_load_dwordx4 v[68:71], v11, s[12:15], s62 offen offset:1024 sc1
L_v_vp_239_m:
    s_waitcnt vmcnt(0)
    v_max3_u32 v20, v64, v65, v66
    v_max3_u32 v20, v20, v67, v68
    v_max3_u32 v20, v20, v69, v70
    v_max_u32 v20, v20, v71
    v_cmp_eq_u32 vcc, -1, v20
    s_cbranch_vccnz L_rt_240
    v_smfmac_f32_16x16x64_bf16 v[96:99], v[64:67], a[64:71], v3
    v_smfmac_f32_16x16x64_bf16 v[96:99], v[68:71], a[72:79], v3
    v_smfmac_f32_16x16x64_bf16 v[100:103], v[64:67], a[80:87], v3
    v_smfmac_f32_16x16x64_bf16 v[100:103], v[68:71], a[88:95], v3
    v_smfmac_f32_16x16x64_bf16 v[104:107], v[64:67], a[96:103], v3
    v_smfmac_f32_16x16x64_bf16 v[104:107], v[68:71], a[104:111], v3
    v_smfmac_f32_16x16x64_bf16 v[108:111], v[64:67], a[112:119], v3
    v_smfmac_f32_16x16x64_bf16 v[108:111], v[68:71], a[120:127], v3
    s_nop 1
    v_cvt_pk_bf16_f32 v96, v96, v97
    v_cvt_pk_bf16_f32 v97, v98, v99
    ds_write_b64 v12, v[96:97] offset:0
    v_cvt_pk_bf16_f32 v100, v100, v101
    v_cvt_pk_bf16_f32 v101, v102, v103
    ds_write_b64 v12, v[100:101] offset:2048
    v_cvt_pk_bf16_f32 v104, v104, v105
    v_cvt_pk_bf16_f32 v105, v106, v107
    ds_write_b64 v12, v[104:105] offset:4096
    v_cvt_pk_bf16_f32 v108, v108, v109
    v_cvt_pk_bf16_f32 v109, v110, v111
    ds_write_b64 v12, v[108:109] offset:6144
    s_bitcmp1_b32 s44, 0
    s_cbranch_scc1 L_v_r8_241
    s_add_u32 s46, s65, 4096
    buffer_load_dwordx4 v[32:35], v15, s[12:15], s65 offen offset:0 sc1
    buffer_load_dwordx4 v[48:51], v15, s[12:15], s46 offen offset:0 sc1
    buffer_load_dwordx4 v[36:39], v15, s[12:15], s65 offen offset:1024 sc1
    buffer_load_dwordx4 v[52:55], v15, s[12:15], s46 offen offset:1024 sc1
    buffer_load_dwordx4 v[40:43], v15, s[12:15], s65 offen offset:2048 sc1
    buffer_load_dwordx4 v[56:59], v15, s[12:15], s46 offen offset:2048 sc1
    buffer_load_dwordx4 v[44:47], v15, s[12:15], s65 offen offset:3072 sc1
    buffer_load_dwordx4 v[60:63], v15, s[12:15], s46 offen offset:3072 sc1
    s_add_u32 s65, s65, 786432
L_v_r8_241:
    s_waitcnt lgkmcnt(0)
    s_barrier
    ds_read_b128 v[96:99], v2 offset:16384
    ds_read_b128 v[100:103], v2 offset:17408
    ds_read_b128 v[104:107], v2 offset:18432
    ds_read_b128 v[108:111], v2 offset:19456
    ds_read_b128 v[112:115], v31 offset:0
    ds_read_b128 v[116:119], v25 offset:0
    ds_read_b128 v[120:123], v31 offset:512
    ds_read_b128 v[124:127], v25 offset:1024
    s_waitcnt lgkmcnt(7)
    v_mfma_f32_16x16x32_bf16 v[16:19], v[80:83], v[96:99], 0
    s_waitcnt lgkmcnt(6)
    v_mfma_f32_16x16x32_bf16 v[16:19], v[84:87], v[100:103], v[16:19]
    s_waitcnt lgkmcnt(5)
    v_mfma_f32_16x16x32_bf16 v[16:19], v[88:91], v[104:107], v[16:19]
    s_waitcnt lgkmcnt(4)
    v_mfma_f32_16x16x32_bf16 v[16:19], v[92:95], v[108:111], v[16:19]
    s_waitcnt lgkmcnt(2)
    v_mfma_f32_16x16x32_bf16 v[16:19], v[116:119], v[112:115], v[16:19]
    s_waitcnt lgkmcnt(0)
    v_mfma_f32_16x16x32_bf16 v[16:19], v[124:127], v[120:123], v[16:19]
    s_mov_b32 exec_lo, 0x00ff00ff
    s_mov_b32 exec_hi, 0x00ff00ff
    s_nop 5
    v_cvt_pk_bf16_f32 v16, v16, v17
    v_cvt_pk_bf16_f32 v17, v18, v19
    v_min_u32 v16, -2, v16
    v_min_u32 v17, -2, v17
    buffer_store_dwordx2 v[16:17], v6, s[12:15], s63 offen sc1
    s_mov_b64 exec, -1
    s_waitcnt vmcnt(1)
    s_sub_u32 s45, s60, 3
    s_cmp_ge_u32 s45, 24
    s_cbranch_scc1 L_v_nx_242
    s_cmp_eq_u32 s45, 0
    s_cbranch_scc1 L_v_fl_243
L_v_fl_243_b:
    s_and_b32 s46, s45, 1
    s_lshl_b32 s47, s46, 14
    s_add_u32 s47, s47, s59
    s_lshl_b32 s46, s46, 15
    s_lshr_b32 s48, s45, 2
    s_lshl_b32 s48, s48, 16
    s_add_u32 s46, s46, s48
    s_and_b32 s48, s45, 2
    s_lshl_b32 s48, s48, 7
    s_add_u32 s46, s46, s48
    s_add_u32 m0, s47, 0
    s_add_u32 s48, s46, 0
    buffer_load_dwordx4 v28, s[12:15], s48 offen sc1 lds
    s_add_u32 m0, s47, 1024
    s_add_u32 s48, s46, 2048
    buffer_load_dwordx4 v28, s[12:15], s48 offen sc1 lds
    s_add_u32 m0, s47, 2048
    s_add_u32 s48, s46, 4096
    buffer_load_dwordx4 v28, s[12:15], s48 offen sc1 lds
    s_add_u32 m0, s47, 3072
    s_add_u32 s48, s46, 6144
    buffer_load_dwordx4 v28, s[12:15], s48 offen sc1 lds
L_v_nx_242:
    s_add_u32 s61, s61, 0x4000
    s_and_b32 s61, s61, 0xffff
    s_mov_b32 s70, 1
    s_sleep 8
    buffer_load_dword v96, v7, s[12:15], s63 offen offset:0 sc1
    buffer_load_dword v97, v7, s[12:15], s63 offen offset:256 sc1
    buffer_load_dword v98, v7, s[12:15], s63 offen offset:512 sc1
    buffer_load_dword v99, v7, s[12:15], s63 offen offset:768 sc1
    buffer_load_dword v100, v7, s[12:15], s63 offen offset:1024 sc1
    buffer_load_dword v101, v7, s[12:15], s63 offen offset:1280 sc1
    buffer_load_dword v102, v7, s[12:15], s63 offen offset:1536 sc1
    buffer_load_dword v103, v7, s[12:15], s63 offen offset:1792 sc1
    v_mfma_f32_16x16x32_bf16 v[64:67], v[32:35], a[64:67], 0
    v_mfma_f32_16x16x32_bf16 v[68:71], v[48:51], a[64:67], 0
    v_mfma_f32_16x16x32_bf16 v[64:67], v[36:39], a[68:71], v[64:67]
    v_mfma_f32_16x16x32_bf16 v[68:71], v[52:55], a[68:71], v[68:71]
    v_mfma_f32_16x16x32_bf16 v[64:67], v[40:43], a[72:75], v[64:67]
    v_mfma_f32_16x16x32_bf16 v[68:71], v[56:59], a[72:75], v[68:71]
    v_mfma_f32_16x16x32_bf16 v[64:67], v[44:47], a[76:79], v[64:67]
    v_mfma_f32_16x16x32_bf16 v[68:71], v[60:63], a[76:79], v[68:71]
    v_mfma_f32_16x16x32_bf16 v[72:75], v[32:35], a[80:83], 0
    v_mfma_f32_16x16x32_bf16 v[76:79], v[48:51], a[80:83], 0
    v_mfma_f32_16x16x32_bf16 v[72:75], v[36:39], a[84:87], v[72:75]
    v_mfma_f32_16x16x32_bf16 v[76:79], v[52:55], a[84:87], v[76:79]
    v_mfma_f32_16x16x32_bf16 v[72:75], v[40:43], a[88:91], v[72:75]
    v_mfma_f32_16x16x32_bf16 v[76:79], v[56:59], a[88:91], v[76:79]
    v_mfma_f32_16x16x32_bf16 v[72:75], v[44:47], a[92:95], v[72:75]
    v_mfma_f32_16x16x32_bf16 v[76:79], v[60:63], a[92:95], v[76:79]
    v_cvt_pk_bf16_f32 v64, v64, v65
    v_cvt_pk_bf16_f32 v65, v66, v67
    v_cvt_pk_bf16_f32 v66, v68, v69
    v_cvt_pk_bf16_f32 v67, v70, v71
    ds_write_b128 v10, v[64:67] offset:32768
    v_mfma_f32_16x16x32_bf16 v[80:83], v[32:35], a[96:99], 0
    v_mfma_f32_16x16x32_bf16 v[84:87], v[48:51], a[96:99], 0
    v_mfma_f32_16x16x32_bf16 v[80:83], v[36:39], a[100:103], v[80:83]
    v_mfma_f32_16x16x32_bf16 v[84:87], v[52:55], a[100:103], v[84:87]
    v_mfma_f32_16x16x32_bf16 v[80:83], v[40:43], a[104:107], v[80:83]
    v_mfma_f32_16x16x32_bf16 v[84:87], v[56:59], a[104:107], v[84:87]
    v_mfma_f32_16x16x32_bf16 v[80:83], v[44:47], a[108:111], v[80:83]
    v_mfma_f32_16x16x32_bf16 v[84:87], v[60:63], a[108:111], v[84:87]
    v_cvt_pk_bf16_f32 v72, v72, v73
    v_cvt_pk_bf16_f32 v73, v74, v75
    v_cvt_pk_bf16_f32 v74, v76, v77
    v_cvt_pk_bf16_f32 v75, v78, v79
    ds_write_b128 v10, v[72:75] offset:33792
L_v_gp_244:
    s_waitcnt vmcnt(7)
    v_lshlrev_b32 v20, 16, v96
    v_and_b32 v21, 0xffff0000, v96
    s_waitcnt vmcnt(6)
    v_lshlrev_b32 v22, 16, v97
    v_and_b32 v23, 0xffff0000, v97
    v_add_f32 v20, v20, v22
    v_add_f32 v21, v21, v23
    s_waitcnt vmcnt(5)
    v_lshlrev_b32 v22, 16, v98
    v_and_b32 v23, 0xffff0000, v98
    v_add_f32 v20, v20, v22
    v_add_f32 v21, v21, v23
    s_waitcnt vmcnt(4)
    v_lshlrev_b32 v22, 16, v99
    v_and_b32 v23, 0xffff0000, v99
    v_add_f32 v20, v20, v22
    v_add_f32 v21, v21, v23
    s_waitcnt vmcnt(3)
    v_lshlrev_b32 v22, 16, v100
    v_and_b32 v23, 0xffff0000, v100
    v_add_f32 v20, v20, v22
    v_add_f32 v21, v21, v23
    s_waitcnt vmcnt(2)
    v_lshlrev_b32 v22, 16, v101
    v_and_b32 v23, 0xffff0000, v101
    v_add_f32 v20, v20, v22
    v_add_f32 v21, v21, v23
    s_waitcnt vmcnt(1)
    v_lshlrev_b32 v22, 16, v102
    v_and_b32 v23, 0xffff0000, v102
    v_add_f32 v20, v20, v22
    v_add_f32 v21, v21, v23
    s_waitcnt vmcnt(0)
    v_lshlrev_b32 v22, 16, v103
    v_and_b32 v23, 0xffff0000, v103
    v_add_f32 v20, v20, v22
    v_add_f32 v21, v21, v23
    v_cmp_u_f32 vcc, v20, v21
    v_cvt_pk_bf16_f32 v20, v20, v21
    s_cbranch_vccnz L_v_gf_246
L_v_gok_245:
    buffer_store_dword v20, v8, s[12:15], s61 offen
    s_xor_b32 s45, s61, 0x8000
    buffer_store_dword v26, v8, s[12:15], s45 offen
    s_bitcmp1_b32 s44, 0
    s_cbranch_scc1 L_v_nr_247
    s_xor_b32 s45, s62, 0x4000
    buffer_store_dword v26, v4, s[12:15], s45 offen
L_v_nr_247:
    s_add_u32 s60, s60, 1
    s_add_u32 s62, s62, 0x2000
    s_and_b32 s62, s62, 0x7fff
    s_and_b32 s45, s60, 0x38
    s_bitcmp1_b64 s[66:67], s45
    s_cselect_b32 s45, 8192, 0
    s_lshl_b32 s63, s60, 18
    s_add_u32 s63, s63, s45
    v_mfma_f32_16x16x32_bf16 v[88:91], v[32:35], a[112:115], 0
    v_mfma_f32_16x16x32_bf16 v[92:95], v[48:51], a[112:115], 0
    v_mfma_f32_16x16x32_bf16 v[88:91], v[36:39], a[116:119], v[88:91]
    v_mfma_f32_16x16x32_bf16 v[92:95], v[52:55], a[116:119], v[92:95]
    v_mfma_f32_16x16x32_bf16 v[88:91], v[40:43], a[120:123], v[88:91]
    v_mfma_f32_16x16x32_bf16 v[92:95], v[56:59], a[120:123], v[92:95]
    v_mfma_f32_16x16x32_bf16 v[88:91], v[44:47], a[124:127], v[88:91]
    v_mfma_f32_16x16x32_bf16 v[92:95], v[60:63], a[124:127], v[92:95]
    v_cvt_pk_bf16_f32 v80, v80, v81
    v_cvt_pk_bf16_f32 v81, v82, v83
    v_cvt_pk_bf16_f32 v82, v84, v85
    v_cvt_pk_bf16_f32 v83, v86, v87
    ds_write_b128 v10, v[80:83] offset:34816
    s_nop 2
    v_cvt_pk_bf16_f32 v88, v88, v89
    v_cvt_pk_bf16_f32 v89, v90, v91
    v_cvt_pk_bf16_f32 v90, v92, v93
    v_cvt_pk_bf16_f32 v91, v94, v95
    ds_write_b128 v10, v[88:91] offset:35840
    s_sleep 3
    s_branch L_v_loop_230
L_v_last_234:
    s_waitcnt lgkmcnt(0)
    s_barrier
    s_branch L_replica
L_v_l1_231:
    s_mov_b64 exec, s[48:49]
    s_cbranch_execz L_v_ls_248
    buffer_load_dwordx4 v[64:67], v9, s[12:15], s61 offen offset:0 sc1
L_v_ls_248:
    s_mov_b64 exec, s[50:51]
    s_cbranch_execz L_v_ls_249
    buffer_load_dwordx4 v[68:71], v9, s[12:15], s61 offen offset:1024 sc1
L_v_ls_249:
    s_mov_b64 exec, s[52:53]
    s_cbranch_execz L_v_ls_250
    buffer_load_dwordx4 v[72:75], v9, s[12:15], s61 offen offset:2048 sc1
L_v_ls_250:
    s_mov_b64 exec, s[54:55]
    s_cbranch_execz L_v_ls_251
    buffer_load_dwordx4 v[76:79], v9, s[12:15], s61 offen offset:3072 sc1
L_v_ls_251:
    s_mov_b64 exec, -1
    s_add_u32 s70, s70, 1
    s_cmp_ge_u32 s70, 524288
    s_cbranch_scc1 L_c_done_1
    s_waitcnt vmcnt(0)
    s_cmp_eq_u64 s[48:49], 0
    s_cbranch_scc1 L_v_lc_252
    ds_write_b128 v10, v[64:67] offset:0
    v_max3_u32 v24, v64, v65, v66
    v_max_u32 v24, v24, v67
    v_cmp_eq_u32 s[48:49], -1, v24
L_v_lc_252:
    s_cmp_eq_u64 s[50:51], 0
    s_cbranch_scc1 L_v_lc_253
    ds_write_b128 v10, v[68:71] offset:1024
    v_max3_u32 v24, v68, v69, v70
    v_max_u32 v24, v24, v71
    v_cmp_eq_u32 s[50:51], -1, v24
L_v_lc_253:
    s_cmp_eq_u64 s[52:53], 0
    s_cbranch_scc1 L_v_lc_254
    ds_write_b128 v10, v[72:75] offset:2048
    v_max3_u32 v24, v72, v73, v74
    v_max_u32 v24, v24, v75
    v_cmp_eq_u32 s[52:53], -1, v24
L_v_lc_254:
    s_cmp_eq_u64 s[54:55], 0
    s_cbranch_scc1 L_v_lc_255
    ds_write_b128 v10, v[76:79] offset:3072
    v_max3_u32 v24, v76, v77, v78
    v_max_u32 v24, v24, v79
    v_cmp_eq_u32 s[54:55], -1, v24
L_v_lc_255:
    s_or_b64 s[46:47], s[48:49], s[50:51]
    s_or_b64 vcc, s[52:53], s[54:55]
    s_or_b64 vcc, vcc, s[46:47]
    s_cbranch_scc1 L_v_l1_231
    s_branch L_v_l1ok_233
L_v_k1_235_c:
    s_add_u32 s46, s65, 4096
    buffer_load_dwordx4 v[32:35], v15, s[12:15], s65 offen offset:0 sc1
    buffer_load_dwordx4 v[48:51], v15, s[12:15], s46 offen offset:0 sc1
    buffer_load_dwordx4 v[36:39], v15, s[12:15], s65 offen offset:1024 sc1
    buffer_load_dwordx4 v[52:55], v15, s[12:15], s46 offen offset:1024 sc1
    buffer_load_dwordx4 v[40:43], v15, s[12:15], s65 offen offset:2048 sc1
    buffer_load_dwordx4 v[56:59], v15, s[12:15], s46 offen offset:2048 sc1
    buffer_load_dwordx4 v[44:47], v15, s[12:15], s65 offen offset:3072 sc1
    buffer_load_dwordx4 v[60:63], v15, s[12:15], s46 offen offset:3072 sc1
    s_add_u32 s65, s65, 786432
    s_branch L_v_k1_235
L_rt_237:
    s_add_u32 s70, s70, 1
    s_cmp_lt_u32 s70, 524288
    s_cbranch_scc1 L_v_rl_236
    s_branch L_c_done_1
L_v_vp_239:
    buffer_load_dwordx4 v[64:67], v11, s[12:15], s62 offen offset:0 sc1
    buffer_load_dwordx4 v[68:71], v11, s[12:15], s62 offen offset:1024 sc1
    s_branch L_v_vp_239_m
L_rt_240:
    s_add_u32 s70, s70, 1
    s_cmp_lt_u32 s70, 524288
    s_cbranch_scc1 L_v_vp_239
    s_branch L_c_done_1
L_v_fl_243:
    v_and_b32 v22, 31, v1
    v_lshlrev_b32 v22, 7, v22
    s_mov_b32 s46, 0x109400
    s_mov_b32 s47, 56
    s_mov_b32 s70, 0
L_spin_256:
    buffer_load_dword v23, v22, s[12:15], s46 offen sc1
    s_waitcnt vmcnt(0)
    v_cmp_ge_u32 vcc, s47, v23
    s_add_u32 s70, s70, 1
    s_cbranch_vccz L_spok_257
    s_sleep 3
    s_cmp_lt_u32 s70, 524288
    s_cbranch_scc1 L_spin_256
    s_branch L_c_done_1
L_spok_257:
    s_branch L_v_fl_243_b
L_v_gf_246:
    v_max3_u32 v24, v96, v97, v98
    v_max3_u32 v24, v24, v99, v100
    v_max3_u32 v24, v24, v101, v102
    v_max_u32 v24, v24, v103
    v_cmp_eq_u32 vcc, -1, v24
    v_min_u32 v20, -2, v20
    s_add_u32 s70, s70, 1
    s_cbranch_vccz L_v_gok_245
    buffer_load_dword v96, v7, s[12:15], s63 offen offset:0 sc1
    buffer_load_dword v97, v7, s[12:15], s63 offen offset:256 sc1
    buffer_load_dword v98, v7, s[12:15], s63 offen offset:512 sc1
    buffer_load_dword v99, v7, s[12:15], s63 offen offset:768 sc1
    buffer_load_dword v100, v7, s[12:15], s63 offen offset:1024 sc1
    buffer_load_dword v101, v7, s[12:15], s63 offen offset:1280 sc1
    buffer_load_dword v102, v7, s[12:15], s63 offen offset:1536 sc1
    buffer_load_dword v103, v7, s[12:15], s63 offen offset:1792 sc1
    s_cmp_lt_u32 s70, 524288
    s_cbranch_scc1 L_v_gp_244
    s_branch L_c_done_1
L_vs_191:
    s_mov_b32 s70, 1
    v_mov_b32 v16, 0
    v_mov_b32 v17, 0
    s_branch L_v_l1m_260
.p2align 6
L_v_loop_258:
    s_mov_b32 s70, 1
    buffer_load_dwordx4 v[64:67], v9, s[12:15], s61 offen offset:0 sc1
    buffer_load_dwordx4 v[68:71], v9, s[12:15], s61 offen offset:1024 sc1
    buffer_load_dwordx4 v[72:75], v9, s[12:15], s61 offen offset:2048 sc1
    buffer_load_dwordx4 v[76:79], v9, s[12:15], s61 offen offset:3072 sc1
    v_mov_b32 v16, 0
    v_mov_b32 v17, 0
    v_mov_b32 v18, 0
    v_mov_b32 v19, 0
    v_mov_b32 v20, 0
    v_mov_b32 v21, 0
    v_mov_b32 v22, 0
    v_mov_b32 v23, 0
L_v_l1m_260:
    s_waitcnt vmcnt(3)
    ds_write_b128 v10, v[64:67] offset:0
    v_max3_u32 v24, v64, v65, v66
    v_max_u32 v24, v24, v67
    v_cmp_eq_u32 s[48:49], -1, v24
    s_waitcnt vmcnt(2)
    ds_write_b128 v10, v[68:71] offset:1024
    v_max3_u32 v24, v68, v69, v70
    v_max_u32 v24, v24, v71
    v_cmp_eq_u32 s[50:51], -1, v24
    s_waitcnt vmcnt(1)
    ds_write_b128 v10, v[72:75] offset:2048
    v_max3_u32 v24, v72, v73, v74
    v_max_u32 v24, v24, v75
    v_cmp_eq_u32 s[52:53], -1, v24
    s_waitcnt vmcnt(0)
    ds_write_b128 v10, v[76:79] offset:3072
    v_max3_u32 v24, v76, v77, v78
    v_max_u32 v24, v24, v79
    v_cmp_eq_u32 s[54:55], -1, v24
    s_or_b64 s[46:47], s[48:49], s[50:51]
    s_or_b64 vcc, s[52:53], s[54:55]
    s_or_b64 vcc, vcc, s[46:47]
    s_cbranch_scc1 L_v_l1_259
L_v_l1ok_261:
    s_waitcnt lgkmcnt(0)
    s_barrier
    v_smfmac_f32_16x16x64_bf16 v[16:19], v[64:67], a[0:7], v3
    v_smfmac_f32_16x16x64_bf16 v[20:23], v[64:67], a[32:39], v3
    v_smfmac_f32_16x16x64_bf16 v[16:19], v[68:71], a[8:15], v3
    v_smfmac_f32_16x16x64_bf16 v[20:23], v[68:71], a[40:47], v3
    v_smfmac_f32_16x16x64_bf16 v[16:19], v[72:75], a[16:23], v3
    v_smfmac_f32_16x16x64_bf16 v[20:23], v[72:75], a[48:55], v3
    v_smfmac_f32_16x16x64_bf16 v[16:19], v[76:79], a[24:31], v3
    v_smfmac_f32_16x16x64_bf16 v[20:23], v[76:79], a[56:63], v3
    s_nop 6
    v_permlane32_swap_b32 v16, v18
    v_permlane32_swap_b32 v17, v19
    v_permlane32_swap_b32 v20, v22
    v_permlane32_swap_b32 v21, v23
    v_add_f32 v16, v16, v18
    v_add_f32 v17, v17, v19
    v_add_f32 v18, v20, v22
    v_add_f32 v19, v21, v23
    ds_write_b128 v14, v[16:19]
    s_mov_b64 exec, 1
    ds_add_u32 v29, v30
    s_mov_b64 exec, -1
    s_add_u32 s58, s58, 4
    s_bitcmp1_b32 s44, 0
    s_cbranch_scc1 L_v_k1_263_c
    s_mov_b32 s70, 0
L_v_rl_264:
    ds_read_b32 v24, v29
    ds_read_b64 v[16:17], v13 offset:0
    ds_read_b64 v[18:19], v13 offset:1024
    ds_read_b64 v[20:21], v13 offset:2048
    ds_read_b64 v[22:23], v13 offset:3072
    s_waitcnt lgkmcnt(2)
    v_cmp_ne_u32 vcc, s58, v24
    v_add_f32 v16, v16, v18
    v_add_f32 v17, v17, v19
    s_waitcnt lgkmcnt(0)
    s_cbranch_vccnz L_rt_265
    v_add_f32 v20, v20, v22
    v_add_f32 v21, v21, v23
    v_add_f32 v16, v16, v20
    v_add_f32 v17, v17, v21
    s_mov_b32 vcc_lo, 0x55555555
    s_mov_b32 vcc_hi, 0x55555555
    v_cndmask_b32_dpp v18, v17, v16, vcc quad_perm:[1,0,3,2] row_mask:0xf bank_mask:0xf
    s_not_b64 vcc, vcc
    v_cndmask_b32_dpp v19, v16, v17, vcc quad_perm:[1,0,3,2] row_mask:0xf bank_mask:0xf
    v_cvt_pk_bf16_f32 v18, v18, v19
    v_min_u32 v18, -2, v18
    buffer_store_dword v18, v4, s[12:15], s62 offen sc1
    ds_write_b32 v5, v18
L_v_k1_263:
    s_cmp_eq_u32 s60, 63
    s_cbranch_scc1 L_v_last_262
    ds_read_b128 v[80:83], v27 offset:32768
    ds_read_b128 v[84:87], v27 offset:36864
    ds_read_b128 v[88:91], v27 offset:40960
    ds_read_b128 v[92:95], v27 offset:45056
    v_mov_b32 v96, 0
    v_mov_b32 v97, 0
    v_mov_b32 v98, 0
    v_mov_b32 v99, 0
    v_mov_b32 v100, 0
    v_mov_b32 v101, 0
    v_mov_b32 v102, 0
    v_mov_b32 v103, 0
    v_mov_b32 v104, 0
    v_mov_b32 v105, 0
    v_mov_b32 v106, 0
    v_mov_b32 v107, 0
    v_mov_b32 v108, 0
    v_mov_b32 v109, 0
    v_mov_b32 v110, 0
    v_mov_b32 v111, 0
    s_bitcmp1_b32 s44, 0
    s_cbranch_scc0 L_v_sv_266
    s_sleep 1
L_v_sv_266:
    s_sleep 3
    s_mov_b32 s70, 1
    buffer_load_dwordx4 v[64:67], v11, s[12:15], s62 offen offset:0 sc1
    buffer_load_dwordx4 v[68:71], v11, s[12:15], s62 offen offset:1024 sc1
L_v_vp_267_m:
    s_waitcnt vmcnt(0)
    v_max3_u32 v20, v64, v65, v66
    v_max3_u32 v20, v20, v67, v68
    v_max3_u32 v20, v20, v69, v70
    v_max_u32 v20, v20, v71
    v_cmp_eq_u32 vcc, -1, v20
    s_cbranch_vccnz L_rt_268
    v_smfmac_f32_16x16x64_bf16 v[96:99], v[64:67], a[64:71], v3
    v_smfmac_f32_16x16x64_bf16 v[96:99], v[68:71], a[72:79], v3
    v_smfmac_f32_16x16x64_bf16 v[100:103], v[64:67], a[80:87], v3
    v_smfmac_f32_16x16x64_bf16 v[100:103], v[68:71], a[88:95], v3
    v_smfmac_f32_16x16x64_bf16 v[104:107], v[64:67], a[96:103], v3
    v_smfmac_f32_16x16x64_bf16 v[104:107], v[68:71], a[104:111], v3
    v_smfmac_f32_16x16x64_bf16 v[108:111], v[64:67], a[112:119], v3
    v_smfmac_f32_16x16x64_bf16 v[108:111], v[68:71], a[120:127], v3
    s_nop 1
    v_cvt_pk_bf16_f32 v96, v96, v97
    v_cvt_pk_bf16_f32 v97, v98, v99
    ds_write_b64 v12, v[96:97] offset:0
    v_cvt_pk_bf16_f32 v100, v100, v101
    v_cvt_pk_bf16_f32 v101, v102, v103
    ds_write_b64 v12, v[100:101] offset:2048
    v_cvt_pk_bf16_f32 v104, v104, v105
    v_cvt_pk_bf16_f32 v105, v106, v107
    ds_write_b64 v12, v[104:105] offset:4096
    v_cvt_pk_bf16_f32 v108, v108, v109
    v_cvt_pk_bf16_f32 v109, v110, v111
    ds_write_b64 v12, v[108:109] offset:6144
    s_bitcmp1_b32 s44, 0
    s_cbranch_scc1 L_v_r8_269
    s_add_u32 s46, s65, 4096
    buffer_load_dwordx4 v[32:35], v15, s[12:15], s65 offen offset:0 sc1
    buffer_load_dwordx4 v[48:51], v15, s[12:15], s46 offen offset:0 sc1
    buffer_load_dwordx4 v[36:39], v15, s[12:15], s65 offen offset:1024 sc1
    buffer_load_dwordx4 v[52:55], v15, s[12:15], s46 offen offset:1024 sc1
    buffer_load_dwordx4 v[40:43], v15, s[12:15], s65 offen offset:2048 sc1
    buffer_load_dwordx4 v[56:59], v15, s[12:15], s46 offen offset:2048 sc1
    buffer_load_dwordx4 v[44:47], v15, s[12:15], s65 offen offset:3072 sc1
    buffer_load_dwordx4 v[60:63], v15, s[12:15], s46 offen offset:3072 sc1
    s_add_u32 s65, s65, 786432
L_v_r8_269:
    s_waitcnt lgkmcnt(0)
    s_barrier
    ds_read_b128 v[96:99], v2 offset:16384
    ds_read_b128 v[100:103], v2 offset:17408
    ds_read_b128 v[104:107], v2 offset:18432
    ds_read_b128 v[108:111], v2 offset:19456
    ds_read_b128 v[112:115], v31 offset:0
    ds_read_b128 v[116:119], v25 offset:0
    ds_read_b128 v[120:123], v31 offset:512
    ds_read_b128 v[124:127], v25 offset:1024
    s_waitcnt lgkmcnt(7)
    v_mfma_f32_16x16x32_bf16 v[16:19], v[80:83], v[96:99], 0
    s_waitcnt lgkmcnt(6)
    v_mfma_f32_16x16x32_bf16 v[16:19], v[84:87], v[100:103], v[16:19]
    s_waitcnt lgkmcnt(5)
    v_mfma_f32_16x16x32_bf16 v[16:19], v[88:91], v[104:107], v[16:19]
    s_waitcnt lgkmcnt(4)
    v_mfma_f32_16x16x32_bf16 v[16:19], v[92:95], v[108:111], v[16:19]
    s_waitcnt lgkmcnt(2)
    v_mfma_f32_16x16x32_bf16 v[16:19], v[116:119], v[112:115], v[16:19]
    s_waitcnt lgkmcnt(0)
    v_mfma_f32_16x16x32_bf16 v[16:19], v[124:127], v[120:123], v[16:19]
    s_mov_b32 exec_lo, 0x00ff00ff
    s_mov_b32 exec_hi, 0x00ff00ff
    s_nop 5
    v_cvt_pk_bf16_f32 v16, v16, v17
    v_cvt_pk_bf16_f32 v17, v18, v19
    v_min_u32 v16, -2, v16
    v_min_u32 v17, -2, v17
    buffer_store_dwordx2 v[16:17], v6, s[12:15], s63 offen sc1
    s_mov_b64 exec, -1
    s_waitcnt vmcnt(1)
    s_sub_u32 s45, s60, 3
    s_cmp_ge_u32 s45, 24
    s_cbranch_scc1 L_v_nx_270
    s_cmp_eq_u32 s45, 0
    s_cbranch_scc1 L_v_fl_271
L_v_fl_271_b:
    s_and_b32 s46, s45, 1
    s_lshl_b32 s47, s46, 14
    s_add_u32 s47, s47, s59
    s_lshl_b32 s46, s46, 15
    s_lshr_b32 s48, s45, 2
    s_lshl_b32 s48, s48, 16
    s_add_u32 s46, s46, s48
    s_and_b32 s48, s45, 2
    s_lshl_b32 s48, s48, 7
    s_add_u32 s46, s46, s48
    s_add_u32 m0, s47, 0
    s_add_u32 s48, s46, 0
    buffer_load_dwordx4 v28, s[12:15], s48 offen sc1 lds
    s_add_u32 m0, s47, 1024
    s_add_u32 s48, s46, 2048
    buffer_load_dwordx4 v28, s[12:15], s48 offen sc1 lds
    s_add_u32 m0, s47, 2048
    s_add_u32 s48, s46, 4096
    buffer_load_dwordx4 v28, s[12:15], s48 offen sc1 lds
    s_add_u32 m0, s47, 3072
    s_add_u32 s48, s46, 6144
    buffer_load_dwordx4 v28, s[12:15], s48 offen sc1 lds
L_v_nx_270:
    s_add_u32 s61, s61, 0x4000
    s_and_b32 s61, s61, 0xffff
    s_mov_b32 s70, 1
    s_sleep 8
    buffer_load_dword v96, v7, s[12:15], s63 offen offset:0 sc1
    buffer_load_dword v97, v7, s[12:15], s63 offen offset:256 sc1
    buffer_load_dword v98, v7, s[12:15], s63 offen offset:512 sc1
    buffer_load_dword v99, v7, s[12:15], s63 offen offset:768 sc1
    buffer_load_dword v100, v7, s[12:15], s63 offen offset:1024 sc1
    buffer_load_dword v101, v7, s[12:15], s63 offen offset:1280 sc1
    buffer_load_dword v102, v7, s[12:15], s63 offen offset:1536 sc1
    buffer_load_dword v103, v7, s[12:15], s63 offen offset:1792 sc1
    v_mfma_f32_16x16x32_bf16 v[64:67], v[32:35], a[64:67], 0
    v_mfma_f32_16x16x32_bf16 v[68:71], v[48:51], a[64:67], 0
    v_mfma_f32_16x16x32_bf16 v[64:67], v[36:39], a[68:71], v[64:67]
    v_mfma_f32_16x16x32_bf16 v[68:71], v[52:55], a[68:71], v[68:71]
    v_mfma_f32_16x16x32_bf16 v[64:67], v[40:43], a[72:75], v[64:67]
    v_mfma_f32_16x16x32_bf16 v[68:71], v[56:59], a[72:75], v[68:71]
    v_mfma_f32_16x16x32_bf16 v[64:67], v[44:47], a[76:79], v[64:67]
    v_mfma_f32_16x16x32_bf16 v[68:71], v[60:63], a[76:79], v[68:71]
    v_mfma_f32_16x16x32_bf16 v[72:75], v[32:35], a[80:83], 0
    v_mfma_f32_16x16x32_bf16 v[76:79], v[48:51], a[80:83], 0
    v_mfma_f32_16x16x32_bf16 v[72:75], v[36:39], a[84:87], v[72:75]
    v_mfma_f32_16x16x32_bf16 v[76:79], v[52:55], a[84:87], v[76:79]
    v_mfma_f32_16x16x32_bf16 v[72:75], v[40:43], a[88:91], v[72:75]
    v_mfma_f32_16x16x32_bf16 v[76:79], v[56:59], a[88:91], v[76:79]
    v_mfma_f32_16x16x32_bf16 v[72:75], v[44:47], a[92:95], v[72:75]
    v_mfma_f32_16x16x32_bf16 v[76:79], v[60:63], a[92:95], v[76:79]
    v_cvt_pk_bf16_f32 v64, v64, v65
    v_cvt_pk_bf16_f32 v65, v66, v67
    v_cvt_pk_bf16_f32 v66, v68, v69
    v_cvt_pk_bf16_f32 v67, v70, v71
    ds_write_b128 v10, v[64:67] offset:32768
    v_mfma_f32_16x16x32_bf16 v[80:83], v[32:35], a[96:99], 0
    v_mfma_f32_16x16x32_bf16 v[84:87], v[48:51], a[96:99], 0
    v_mfma_f32_16x16x32_bf16 v[80:83], v[36:39], a[100:103], v[80:83]
    v_mfma_f32_16x16x32_bf16 v[84:87], v[52:55], a[100:103], v[84:87]
    v_mfma_f32_16x16x32_bf16 v[80:83], v[40:43], a[104:107], v[80:83]
    v_mfma_f32_16x16x32_bf16 v[84:87], v[56:59], a[104:107], v[84:87]
    v_mfma_f32_16x16x32_bf16 v[80:83], v[44:47], a[108:111], v[80:83]
    v_mfma_f32_16x16x32_bf16 v[84:87], v[60:63], a[108:111], v[84:87]
    v_cvt_pk_bf16_f32 v72, v72, v73
    v_cvt_pk_bf16_f32 v73, v74, v75
    v_cvt_pk_bf16_f32 v74, v76, v77
    v_cvt_pk_bf16_f32 v75, v78, v79
    ds_write_b128 v10, v[72:75] offset:33792
L_v_gp_272:
    s_waitcnt vmcnt(7)
    v_lshlrev_b32 v20, 16, v96
    v_and_b32 v21, 0xffff0000, v96
    s_waitcnt vmcnt(6)
    v_lshlrev_b32 v22, 16, v97
    v_and_b32 v23, 0xffff0000, v97
    v_add_f32 v20, v20, v22
    v_add_f32 v21, v21, v23
    s_waitcnt vmcnt(5)
    v_lshlrev_b32 v22, 16, v98
    v_and_b32 v23, 0xffff0000, v98
    v_add_f32 v20, v20, v22
    v_add_f32 v21, v21, v23
    s_waitcnt vmcnt(4)
    v_lshlrev_b32 v22, 16, v99
    v_and_b32 v23, 0xffff0000, v99
    v_add_f32 v20, v20, v22
    v_add_f32 v21, v21, v23
    s_waitcnt vmcnt(3)
    v_lshlrev_b32 v22, 16, v100
    v_and_b32 v23, 0xffff0000, v100
    v_add_f32 v20, v20, v22
    v_add_f32 v21, v21, v23
    s_waitcnt vmcnt(2)
    v_lshlrev_b32 v22, 16, v101
    v_and_b32 v23, 0xffff0000, v101
    v_add_f32 v20, v20, v22
    v_add_f32 v21, v21, v23
    s_waitcnt vmcnt(1)
    v_lshlrev_b32 v22, 16, v102
    v_and_b32 v23, 0xffff0000, v102
    v_add_f32 v20, v20, v22
    v_add_f32 v21, v21, v23
    s_waitcnt vmcnt(0)
    v_lshlrev_b32 v22, 16, v103
    v_and_b32 v23, 0xffff0000, v103
    v_add_f32 v20, v20, v22
    v_add_f32 v21, v21, v23
    v_cmp_u_f32 vcc, v20, v21
    v_cvt_pk_bf16_f32 v20, v20, v21
    s_cbranch_vccnz L_v_gf_274
L_v_gok_273:
    buffer_store_dword v20, v8, s[12:15], s61 offen sc1
    s_xor_b32 s45, s61, 0x8000
    buffer_store_dword v26, v8, s[12:15], s45 offen sc1
    s_bitcmp1_b32 s44, 0
    s_cbranch_scc1 L_v_nr_275
    s_xor_b32 s45, s62, 0x4000
    buffer_store_dword v26, v4, s[12:15], s45 offen sc1
L_v_nr_275:
    s_add_u32 s60, s60, 1
    s_add_u32 s62, s62, 0x2000
    s_and_b32 s62, s62, 0x7fff
    s_and_b32 s45, s60, 0x38
    s_bitcmp1_b64 s[66:67], s45
    s_cselect_b32 s45, 8192, 0
    s_lshl_b32 s63, s60, 18
    s_add_u32 s63, s63, s45
    v_mfma_f32_16x16x32_bf16 v[88:91], v[32:35], a[112:115], 0
    v_mfma_f32_16x16x32_bf16 v[92:95], v[48:51], a[112:115], 0
    v_mfma_f32_16x16x32_bf16 v[88:91], v[36:39], a[116:119], v[88:91]
    v_mfma_f32_16x16x32_bf16 v[92:95], v[52:55], a[116:119], v[92:95]
    v_mfma_f32_16x16x32_bf16 v[88:91], v[40:43], a[120:123], v[88:91]
    v_mfma_f32_16x16x32_bf16 v[92:95], v[56:59], a[120:123], v[92:95]
    v_mfma_f32_16x16x32_bf16 v[88:91], v[44:47], a[124:127], v[88:91]
    v_mfma_f32_16x16x32_bf16 v[92:95], v[60:63], a[124:127], v[92:95]
    v_cvt_pk_bf16_f32 v80, v80, v81
    v_cvt_pk_bf16_f32 v81, v82, v83
    v_cvt_pk_bf16_f32 v82, v84, v85
    v_cvt_pk_bf16_f32 v83, v86, v87
    ds_write_b128 v10, v[80:83] offset:34816
    s_nop 2
    v_cvt_pk_bf16_f32 v88, v88, v89
    v_cvt_pk_bf16_f32 v89, v90, v91
    v_cvt_pk_bf16_f32 v90, v92, v93
    v_cvt_pk_bf16_f32 v91, v94, v95
    ds_write_b128 v10, v[88:91] offset:35840
    s_sleep 3
    s_branch L_v_loop_258
L_v_last_262:
    s_waitcnt lgkmcnt(0)
    s_barrier
    s_branch L_replica
L_v_l1_259:
    s_mov_b64 exec, s[48:49]
    s_cbranch_execz L_v_ls_276
    buffer_load_dwordx4 v[64:67], v9, s[12:15], s61 offen offset:0 sc1
L_v_ls_276:
    s_mov_b64 exec, s[50:51]
    s_cbranch_execz L_v_ls_277
    buffer_load_dwordx4 v[68:71], v9, s[12:15], s61 offen offset:1024 sc1
L_v_ls_277:
    s_mov_b64 exec, s[52:53]
    s_cbranch_execz L_v_ls_278
    buffer_load_dwordx4 v[72:75], v9, s[12:15], s61 offen offset:2048 sc1
L_v_ls_278:
    s_mov_b64 exec, s[54:55]
    s_cbranch_execz L_v_ls_279
    buffer_load_dwordx4 v[76:79], v9, s[12:15], s61 offen offset:3072 sc1
L_v_ls_279:
    s_mov_b64 exec, -1
    s_add_u32 s70, s70, 1
    s_cmp_ge_u32 s70, 524288
    s_cbranch_scc1 L_c_done_1
    s_waitcnt vmcnt(0)
    s_cmp_eq_u64 s[48:49], 0
    s_cbranch_scc1 L_v_lc_280
    ds_write_b128 v10, v[64:67] offset:0
    v_max3_u32 v24, v64, v65, v66
    v_max_u32 v24, v24, v67
    v_cmp_eq_u32 s[48:49], -1, v24
L_v_lc_280:
    s_cmp_eq_u64 s[50:51], 0
    s_cbranch_scc1 L_v_lc_281
    ds_write_b128 v10, v[68:71] offset:1024
    v_max3_u32 v24, v68, v69, v70
    v_max_u32 v24, v24, v71
    v_cmp_eq_u32 s[50:51], -1, v24
L_v_lc_281:
    s_cmp_eq_u64 s[52:53], 0
    s_cbranch_scc1 L_v_lc_282
    ds_write_b128 v10, v[72:75] offset:2048
    v_max3_u32 v24, v72, v73, v74
    v_max_u32 v24, v24, v75
    v_cmp_eq_u32 s[52:53], -1, v24
L_v_lc_282:
    s_cmp_eq_u64 s[54:55], 0
    s_cbranch_scc1 L_v_lc_283
    ds_write_b128 v10, v[76:79] offset:3072
    v_max3_u32 v24, v76, v77, v78
    v_max_u32 v24, v24, v79
    v_cmp_eq_u32 s[54:55], -1, v24
L_v_lc_283:
    s_or_b64 s[46:47], s[48:49], s[50:51]
    s_or_b64 vcc, s[52:53], s[54:55]
    s_or_b64 vcc, vcc, s[46:47]
    s_cbranch_scc1 L_v_l1_259
    s_branch L_v_l1ok_261
L_v_k1_263_c:
    s_add_u32 s46, s65, 4096
    buffer_load_dwordx4 v[32:35], v15, s[12:15], s65 offen offset:0 sc1
    buffer_load_dwordx4 v[48:51], v15, s[12:15], s46 offen offset:0 sc1
    buffer_load_dwordx4 v[36:39], v15, s[12:15], s65 offen offset:1024 sc1
    buffer_load_dwordx4 v[52:55], v15, s[12:15], s46 offen offset:1024 sc1
    buffer_load_dwordx4 v[40:43], v15, s[12:15], s65 offen offset:2048 sc1
    buffer_load_dwordx4 v[56:59], v15, s[12:15], s46 offen offset:2048 sc1
    buffer_load_dwordx4 v[44:47], v15, s[12:15], s65 offen offset:3072 sc1
    buffer_load_dwordx4 v[60:63], v15, s[12:15], s46 offen offset:3072 sc1
    s_add_u32 s65, s65, 786432
    s_branch L_v_k1_263
L_rt_265:
    s_add_u32 s70, s70, 1
    s_cmp_lt_u32 s70, 524288
    s_cbranch_scc1 L_v_rl_264
    s_branch L_c_done_1
L_v_vp_267:
    buffer_load_dwordx4 v[64:67], v11, s[12:15], s62 offen offset:0 sc1
    buffer_load_dwordx4 v[68:71], v11, s[12:15], s62 offen offset:1024 sc1
    s_branch L_v_vp_267_m
L_rt_268:
    s_add_u32 s70, s70, 1
    s_cmp_lt_u32 s70, 524288
    s_cbranch_scc1 L_v_vp_267
    s_branch L_c_done_1
L_v_fl_271:
    v_and_b32 v22, 31, v1
    v_lshlrev_b32 v22, 7, v22
    s_mov_b32 s46, 0x109400
    s_mov_b32 s47, 56
    s_mov_b32 s70, 0
L_spin_284:
    buffer_load_dword v23, v22, s[12:15], s46 offen sc1
    s_waitcnt vmcnt(0)
    v_cmp_ge_u32 vcc, s47, v23
    s_add_u32 s70, s70, 1
    s_cbranch_vccz L_spok_285
    s_sleep 3
    s_cmp_lt_u32 s70, 524288
    s_cbranch_scc1 L_spin_284
    s_branch L_c_done_1
L_spok_285:
    s_branch L_v_fl_271_b
L_v_gf_274:
    v_max3_u32 v24, v96, v97, v98
    v_max3_u32 v24, v24, v99, v100
    v_max3_u32 v24, v24, v101, v102
    v_max_u32 v24, v24, v103
    v_cmp_eq_u32 vcc, -1, v24
    v_min_u32 v20, -2, v20
    s_add_u32 s70, s70, 1
    s_cbranch_vccz L_v_gok_273
    buffer_load_dword v96, v7, s[12:15], s63 offen offset:0 sc1
    buffer_load_dword v97, v7, s[12:15], s63 offen offset:256 sc1
    buffer_load_dword v98, v7, s[12:15], s63 offen offset:512 sc1
    buffer_load_dword v99, v7, s[12:15], s63 offen offset:768 sc1
    buffer_load_dword v100, v7, s[12:15], s63 offen offset:1024 sc1
    buffer_load_dword v101, v7, s[12:15], s63 offen offset:1280 sc1
    buffer_load_dword v102, v7, s[12:15], s63 offen offset:1536 sc1
    buffer_load_dword v103, v7, s[12:15], s63 offen offset:1792 sc1
    s_cmp_lt_u32 s70, 524288
    s_cbranch_scc1 L_v_gp_272
    s_branch L_c_done_1
L_c_done_1:
    s_endpgm
.section .rodata,"a"
.p2align 6
.amdhsa_kernel k3_chain_kernel
  .amdhsa_next_free_vgpr 256
  .amdhsa_next_free_sgpr 102
  .amdhsa_accum_offset 128
  .amdhsa_group_segment_fixed_size 0
  .amdhsa_kernarg_size 136
  .amdhsa_user_sgpr_count 2
  .amdhsa_user_sgpr_kernarg_segment_ptr 1
  .amdhsa_system_sgpr_workgroup_id_x 1
.end_amdhsa_kernel
```

```asm
; @launch kernel=k3_chain_kernel grid=(256,1,1) block=(512,1,1) lds=147712
.amdgcn_target "amdgcn-amd-amdhsa--gfx950"
.text
.globl k3_chain_kernel
.p2align 8
.type k3_chain_kernel,@function
k3_chain_kernel:
    s_cmp_ge_u32 s2, 256
    s_cbranch_scc1 L_c_done_1
    s_load_dwordx4 s[20:23], s[0:1], 120
    v_and_b32 v1, 63, v0
    v_lshrrev_b32 v2, 6, v0
    s_nop 0
    v_readfirstlane_b32 s44, v2
    s_waitcnt lgkmcnt(0)
    s_mov_b32 s12, s22
    s_and_b32 s13, s23, 0xffff
    s_mov_b32 s14, 0x10000000
    s_mov_b32 s15, 0x00020000
    s_mov_b32 s16, s20
    s_and_b32 s17, s21, 0xffff
    s_mov_b32 s18, 0x100
    s_mov_b32 s19, 0x00020000
    s_getpc_b64 s[24:25]
L_c_here_2:
    v_lshlrev_b32 v3, 7, v0
    v_mov_b32 v5, s25
    v_add_co_u32 v4, vcc, s24, v3
    s_nop 1
    v_addc_co_u32 v5, vcc, 0, v5, vcc
    v_cmp_gt_u32 vcc, L_c_done_1 - L_c_here_2, v3
    s_and_saveexec_b64 s[26:27], vcc
    s_cbranch_execz L_c_ct_3
    global_load_dword v109, v[4:5], off
L_c_ct_3:
    s_mov_b64 exec, s[26:27]
    s_load_dwordx4 s[8:11], s[0:1], 96
    v_lshrrev_b32 v5, 3, v0
    v_mul_u32_u24 v6, 24576, v5
    v_and_b32 v7, 7, v0
    v_lshl_add_u32 v6, v7, 4, v6
    v_add_u32 v7, 12288, v6
    v_lshlrev_b32 v5, 2, v5
    s_lshr_b32 s50, s2, 5
    s_and_b32 s51, s2, 31
    s_mul_i32 s52, s50, 1572864
    s_lshl_b32 s53, s51, 7
    s_add_u32 s52, s52, s53
    s_lshl_b32 s53, s50, 8
    s_waitcnt lgkmcnt(0)
    s_mov_b32 s28, s10
    s_and_b32 s29, s11, 0xffff
    s_mov_b32 s30, 0xc00000
    s_mov_b32 s31, 0x00020000
    s_mov_b32 s32, s8
    s_and_b32 s33, s9, 0xffff
    s_mov_b32 s34, 0x800
    s_mov_b32 s35, 0x00020000
    buffer_load_dword v8, v5, s[32:35], s53 offen
    buffer_load_dwordx4 v[12:15], v6, s[28:31], s52 offen
    buffer_load_dwordx4 v[16:19], v7, s[28:31], s52 offen
    s_getreg_b32 s39, hwreg(HW_REG_XCC_ID)
    s_and_b32 s39, s39, 7
    s_cmp_lg_u32 s44, 1
    s_cbranch_scc1 L_nz_7
    v_mov_b32 v32, 0
    v_mov_b32 v33, 0
    v_mov_b32 v34, 0
    v_mov_b32 v35, 0
    v_lshlrev_b32 v4, 4, v1
    s_lshl_b32 s45, s2, 10
    s_add_u32 s45, s45, 0x100000
    buffer_store_dwordx4 v[32:35], v4, s[12:15], s45 offen sc1
L_nz_7:
    s_waitcnt vmcnt(0)
    v_lshlrev_b32 v9, 16, v8
    v_and_b32 v10, 0xffff0000, v8
    v_mul_f32 v20, 0xbfb8aa3b, v9
    v_mul_f32 v21, 0xbfb8aa3b, v10
    v_exp_f32 v20, v20
    v_exp_f32 v21, v21
    s_nop 0
    v_add_f32 v20, 1.0, v20
    v_add_f32 v21, 1.0, v21
    v_rcp_f32 v20, v20
    v_rcp_f32 v21, v21
    s_nop 0
    v_mul_f32 v9, v9, v20
    v_mul_f32 v10, v10, v21
    v_cvt_pk_bf16_f32 v9, 0, v9
    v_cvt_pk_bf16_f32 v10, 0, v10
    v_lshlrev_b32 v28, 16, v12
    v_and_b32 v29, 0xffff0000, v12
    v_lshlrev_b32 v30, 16, v16
    v_and_b32 v31, 0xffff0000, v16
    v_mul_f32 v20, v28, v9
    v_mul_f32 v21, v29, v9
    v_fmac_f32 v20, v30, v10
    v_fmac_f32 v21, v31, v10
    v_lshlrev_b32 v28, 16, v13
    v_and_b32 v29, 0xffff0000, v13
    v_lshlrev_b32 v30, 16, v17
    v_and_b32 v31, 0xffff0000, v17
    v_mul_f32 v22, v28, v9
    v_mul_f32 v23, v29, v9
    v_fmac_f32 v22, v30, v10
    v_fmac_f32 v23, v31, v10
    v_lshlrev_b32 v28, 16, v14
    v_and_b32 v29, 0xffff0000, v14
    v_lshlrev_b32 v30, 16, v18
    v_and_b32 v31, 0xffff0000, v18
    v_mul_f32 v24, v28, v9
    v_mul_f32 v25, v29, v9
    v_fmac_f32 v24, v30, v10
    v_fmac_f32 v25, v31, v10
    v_lshlrev_b32 v28, 16, v15
    v_and_b32 v29, 0xffff0000, v15
    v_lshlrev_b32 v30, 16, v19
    v_and_b32 v31, 0xffff0000, v19
    v_mul_f32 v26, v28, v9
    v_mul_f32 v27, v29, v9
    v_fmac_f32 v26, v30, v10
    v_fmac_f32 v27, v31, v10
    s_nop 1
    v_add_f32_dpp v20, v20, v20 row_ror:8 row_mask:0xf bank_mask:0xf
    v_add_f32_dpp v21, v21, v21 row_ror:8 row_mask:0xf bank_mask:0xf
    v_add_f32_dpp v22, v22, v22 row_ror:8 row_mask:0xf bank_mask:0xf
    v_add_f32_dpp v23, v23, v23 row_ror:8 row_mask:0xf bank_mask:0xf
    v_add_f32_dpp v24, v24, v24 row_ror:8 row_mask:0xf bank_mask:0xf
    v_add_f32_dpp v25, v25, v25 row_ror:8 row_mask:0xf bank_mask:0xf
    v_add_f32_dpp v26, v26, v26 row_ror:8 row_mask:0xf bank_mask:0xf
    v_add_f32_dpp v27, v27, v27 row_ror:8 row_mask:0xf bank_mask:0xf
    s_nop 1
    v_permlane16_swap_b32 v20, v24
    v_permlane16_swap_b32 v21, v25
    v_permlane16_swap_b32 v22, v26
    v_permlane16_swap_b32 v23, v27
    v_add_f32 v20, v20, v24
    v_add_f32 v21, v21, v25
    v_add_f32 v22, v22, v26
    v_add_f32 v23, v23, v27
    s_nop 1
    v_permlane32_swap_b32 v20, v22
    v_permlane32_swap_b32 v21, v23
    v_add_f32 v20, v20, v22
    v_add_f32 v21, v21, v23
    v_and_b32 v22, 7, v1
    v_lshlrev_b32 v22, 5, v22
    v_bfe_u32 v23, v1, 4, 1
    v_lshl_add_u32 v22, v23, 4, v22
    v_lshrrev_b32 v23, 5, v1
    v_lshl_add_u32 v22, v23, 3, v22
    s_lshl_b32 s52, s44, 8
    s_add_u32 s52, s52, 139776
    v_add_u32 v22, s52, v22
    ds_write_b64 v22, v[20:21]
    s_waitcnt lgkmcnt(0)
    s_barrier
    s_cmp_lg_u32 s44, 1
    s_cbranch_scc1 L_m1_8
    v_lshlrev_b32 v22, 2, v1
    v_add_u32 v23, 139776, v22
    ds_read_b32 v24, v23 offset:0
    ds_read_b32 v25, v23 offset:256
    ds_read_b32 v26, v23 offset:512
    ds_read_b32 v27, v23 offset:768
    ds_read_b32 v28, v23 offset:1024
    ds_read_b32 v29, v23 offset:1280
    ds_read_b32 v30, v23 offset:1536
    ds_read_b32 v31, v23 offset:1792
    s_waitcnt lgkmcnt(0)
    v_add_f32 v24, v24, v28
    v_add_f32 v25, v25, v29
    v_add_f32 v26, v26, v30
    v_add_f32 v27, v27, v31
    v_add_f32 v24, v24, v26
    v_add_f32 v25, v25, v27
    v_add_f32 v24, v24, v25
    s_lshl_b32 s52, s2, 8
    s_add_u32 s52, s52, 0x10000
    buffer_store_dword v24, v22, s[12:15], s52 offen sc1
L_m1_8:
    s_cmp_lg_u32 s44, 1
    s_cbranch_scc1 L_tk_4
    v_mov_b32 v3, 1
    s_mov_b32 s40, s39
    s_lshl_b32 s45, s40, 5
    v_mov_b32 v4, 0
    s_waitcnt vmcnt(0)
    s_mov_b64 exec, 1
    buffer_atomic_add v3, v4, s[16:19], s45 offen sc0
    s_waitcnt vmcnt(0)
    v_readfirstlane_b32 s41, v3
    s_nop 3
    s_cmp_lt_u32 s41, 32
    s_cbranch_scc1 L_got_5
    v_mov_b32 v3, 1
    buffer_atomic_add v3, v4, s[16:19], 0 offen offset:16 sc0
    s_waitcnt vmcnt(0)
    v_readfirstlane_b32 s46, v3
    s_mov_b64 exec, -1
    v_and_b32 v4, 7, v1
    v_lshlrev_b32 v4, 5, v4
    s_mov_b32 s70, 0
L_sp_6:
    s_sleep 8
    buffer_load_dword v3, v4, s[16:19], 0 offen sc1
    s_waitcnt vmcnt(0)
    s_mov_b32 s48, 0
    v_readlane_b32 s50, v3, 0
    v_readlane_b32 s51, v3, 1
    v_readlane_b32 s52, v3, 2
    v_readlane_b32 s53, v3, 3
    v_readlane_b32 s54, v3, 4
    v_readlane_b32 s55, v3, 5
    v_readlane_b32 s56, v3, 6
    v_readlane_b32 s57, v3, 7
    s_nop 3
    s_add_u32 s48, s48, s50
    s_add_u32 s48, s48, s51
    s_add_u32 s48, s48, s52
    s_add_u32 s48, s48, s53
    s_add_u32 s48, s48, s54
    s_add_u32 s48, s48, s55
    s_add_u32 s48, s48, s56
    s_add_u32 s48, s48, s57
    s_add_u32 s70, s70, 1
    s_cmp_ge_u32 s70, 524288
    s_cbranch_scc1 L_c_done_1
    s_cmp_lt_u32 s48, 256
    s_cbranch_scc1 L_sp_6
    s_min_u32 s48, s50, 32
    s_mov_b32 s40, 0
    s_add_u32 s41, s48, s46
    s_cmp_lt_u32 s41, 32
    s_cbranch_scc1 L_got_5
    s_sub_u32 s46, s41, 32
    s_min_u32 s48, s51, 32
    s_mov_b32 s40, 1
    s_add_u32 s41, s48, s46
    s_cmp_lt_u32 s41, 32
    s_cbranch_scc1 L_got_5
    s_sub_u32 s46, s41, 32
    s_min_u32 s48, s52, 32
    s_mov_b32 s40, 2
    s_add_u32 s41, s48, s46
    s_cmp_lt_u32 s41, 32
    s_cbranch_scc1 L_got_5
    s_sub_u32 s46, s41, 32
    s_min_u32 s48, s53, 32
    s_mov_b32 s40, 3
    s_add_u32 s41, s48, s46
    s_cmp_lt_u32 s41, 32
    s_cbranch_scc1 L_got_5
    s_sub_u32 s46, s41, 32
    s_min_u32 s48, s54, 32
    s_mov_b32 s40, 4
    s_add_u32 s41, s48, s46
    s_cmp_lt_u32 s41, 32
    s_cbranch_scc1 L_got_5
    s_sub_u32 s46, s41, 32
    s_min_u32 s48, s55, 32
    s_mov_b32 s40, 5
    s_add_u32 s41, s48, s46
    s_cmp_lt_u32 s41, 32
    s_cbranch_scc1 L_got_5
    s_sub_u32 s46, s41, 32
    s_min_u32 s48, s56, 32
    s_mov_b32 s40, 6
    s_add_u32 s41, s48, s46
    s_cmp_lt_u32 s41, 32
    s_cbranch_scc1 L_got_5
    s_sub_u32 s46, s41, 32
    s_min_u32 s48, s57, 32
    s_mov_b32 s40, 7
    s_add_u32 s41, s48, s46
    s_cmp_lt_u32 s41, 32
    s_cbranch_scc1 L_got_5
    s_sub_u32 s46, s41, 32
    s_branch L_c_done_1
L_got_5:
    s_mov_b64 exec, -1
    s_lshl_b32 s45, s40, 8
    s_or_b32 s45, s45, s41
    v_mov_b32 v3, s45
    v_mov_b32 v4, 147464
    ds_write_b32 v4, v3
    s_waitcnt lgkmcnt(0)
L_tk_4:
    s_barrier
    v_mov_b32 v4, 147464
    ds_read_b32 v3, v4
    s_waitcnt lgkmcnt(0)
    v_readfirstlane_b32 s45, v3
    s_nop 3
    s_lshr_b32 s40, s45, 8
    s_and_b32 s41, s45, 0xff
    s_lshr_b32 s45, s40, 2
    s_xor_b32 s45, s45, 1
    s_lshl_b32 s45, s45, 4
    s_and_b32 s40, s40, 3
    s_lshl_b32 s40, s40, 1
    s_lshr_b32 s46, s41, 4
    s_add_u32 s40, s40, s46
    s_and_b32 s41, s41, 15
    s_add_u32 s41, s41, s45
    s_cmp_lt_u32 s41, 16
    s_cbranch_scc1 L_c_chain_9
    s_sub_u32 s48, s41, 16
    s_cmp_lt_u32 s48, 12
    s_cbranch_scc1 L_w_g_10
    s_and_b32 s42, s48, 3
    s_mov_b32 s43, s40
    s_load_dwordx2 s[4:5], s[0:1], 0
    v_lshlrev_b32 v2, 4, v1
    v_lshlrev_b32 v3, 5, v1
    s_lshl_b32 s55, s43, 2
    s_add_u32 s55, s55, s42
    s_waitcnt lgkmcnt(0)
    s_mov_b32 s24, s4
    s_and_b32 s25, s5, 0xffff
    s_mov_b32 s26, 0x400000
    s_mov_b32 s27, 0x00020000
    s_lshl_b32 s46, s42, 3
    s_add_u32 s46, s46, s44
    s_lshl_b32 s46, s46, 11
    v_add_u32 v7, s46, v2
    s_lshl_b32 s63, s43, 16
    buffer_load_dwordx4 a[0:3], v7, s[24:27], s63 offen
    buffer_load_dwordx4 a[4:7], v7, s[24:27], s63 offen offset:1024
    s_cmp_lg_u32 s44, 0
    s_cbranch_scc1 L_zwok_19
    v_and_b32 v8, 7, v1
    v_lshlrev_b32 v8, 5, v8
    s_mov_b32 s70, 0
L_zw_18:
    buffer_load_dword v9, v8, s[16:19], 0 offen sc1
    s_waitcnt vmcnt(0)
    v_add_u32_dpp v9, v9, v9 row_ror:1 row_mask:0xf bank_mask:0xf
    s_nop 1
    v_add_u32_dpp v9, v9, v9 row_ror:2 row_mask:0xf bank_mask:0xf
    s_nop 1
    v_add_u32_dpp v9, v9, v9 row_ror:4 row_mask:0xf bank_mask:0xf
    v_cmp_ne_u32 vcc, 0x100, v9
    s_add_u32 s70, s70, 1
    s_cbranch_vccz L_zwok_19
    s_sleep 4
    s_cmp_lt_u32 s70, 524288
    s_cbranch_scc1 L_zw_18
    s_branch L_c_done_1
L_zwok_19:
    s_barrier
    v_lshlrev_b32 v4, 4, v0
    s_mov_b32 s46, 0x10000
    buffer_load_dwordx4 v[32:35], v4, s[12:15], s46 offen sc1
    s_mov_b32 s46, 0x12000
    buffer_load_dwordx4 v[36:39], v4, s[12:15], s46 offen sc1
    s_mov_b32 s46, 0x14000
    buffer_load_dwordx4 v[40:43], v4, s[12:15], s46 offen sc1
    s_mov_b32 s46, 0x16000
    buffer_load_dwordx4 v[44:47], v4, s[12:15], s46 offen sc1
    s_mov_b32 s46, 0x18000
    buffer_load_dwordx4 v[48:51], v4, s[12:15], s46 offen sc1
    s_mov_b32 s46, 0x1a000
    buffer_load_dwordx4 v[52:55], v4, s[12:15], s46 offen sc1
    s_mov_b32 s46, 0x1c000
    buffer_load_dwordx4 v[56:59], v4, s[12:15], s46 offen sc1
    s_mov_b32 s46, 0x1e000
    buffer_load_dwordx4 v[60:63], v4, s[12:15], s46 offen sc1
    s_cmp_lg_u32 s44, 0
    s_cbranch_scc1 L_l_nx_20
    s_cmp_ge_u32 s42, 2
    s_cbranch_scc1 L_l_nx_20
    s_or_b32 s47, s39, 0x100
    v_mov_b32 v8, s47
    v_mov_b32 v9, 0
    s_lshl_b32 s46, s40, 3
    s_lshl_b32 s47, s42, 2
    s_add_u32 s46, s46, s47
    s_add_u32 s46, s46, 0x101200
    s_mov_b64 exec, 1
    buffer_store_dword v8, v9, s[12:15], s46 offen sc1
    s_mov_b64 exec, -1
L_l_nx_20:
    s_mul_i32 s46, s44, 2064
    s_add_u32 s46, s46, 32768
    v_add_u32 v10, s46, v2
    v_and_b32 v11, 7, v1
    v_lshrrev_b32 v12, 3, v1
    v_mul_u32_u24 v13, 2064, v11
    v_lshl_add_u32 v13, v12, 4, v13
    s_lshl_b32 s46, s44, 8
    s_add_u32 s46, s46, 32768
    v_add_u32 v13, s46, v13
    v_lshlrev_b32 v11, 4, v11
    v_lshl_add_u32 v11, v12, 9, v11
    s_lshl_b32 s46, s44, 13
    s_lshl_b32 s47, s42, 7
    s_add_u32 s46, s46, s47
    s_add_u32 s46, s46, 0x400000
    v_add_u32 v11, s46, v11
    v_add_u32 v12, 4096, v11
    s_lshl_b32 s52, s43, 9
    s_lshl_b32 s47, s42, 7
    s_add_u32 s52, s52, s47
    s_add_u32 s52, s52, 0x109400
    s_mov_b32 s60, s43
    s_waitcnt vmcnt(0)
    v_add_f32 v32, v32, v48
    v_add_f32 v33, v33, v49
    v_add_f32 v34, v34, v50
    v_add_f32 v35, v35, v51
    v_add_f32 v36, v36, v52
    v_add_f32 v37, v37, v53
    v_add_f32 v38, v38, v54
    v_add_f32 v39, v39, v55
    v_add_f32 v40, v40, v56
    v_add_f32 v41, v41, v57
    v_add_f32 v42, v42, v58
    v_add_f32 v43, v43, v59
    v_add_f32 v44, v44, v60
    v_add_f32 v45, v45, v61
    v_add_f32 v46, v46, v62
    v_add_f32 v47, v47, v63
    v_add_f32 v32, v32, v40
    v_add_f32 v33, v33, v41
    v_add_f32 v34, v34, v42
    v_add_f32 v35, v35, v43
    v_add_f32 v36, v36, v44
    v_add_f32 v37, v37, v45
    v_add_f32 v38, v38, v46
    v_add_f32 v39, v39, v47
    v_add_f32 v32, v32, v36
    v_add_f32 v33, v33, v37
    v_add_f32 v34, v34, v38
    v_add_f32 v35, v35, v39
    v_cvt_pk_bf16_f32 v32, 0, v32
    v_cvt_pk_bf16_f32 v33, 0, v33
    v_cvt_pk_bf16_f32 v34, 0, v34
    v_cvt_pk_bf16_f32 v35, 0, v35
    ds_write_b128 v4, v[32:35]
    s_waitcnt lgkmcnt(0)
    s_barrier
    ds_read_b128 v[48:51], v3 offset:0
    ds_read_b128 v[52:55], v3 offset:16
    ds_read_b128 v[56:59], v3 offset:2048
    ds_read_b128 v[60:63], v3 offset:2064
    ds_read_b128 v[32:35], v3 offset:4096
    ds_read_b128 v[36:39], v3 offset:4112
    ds_read_b128 v[40:43], v3 offset:6144
    ds_read_b128 v[44:47], v3 offset:6160
    s_waitcnt lgkmcnt(0)
    v_add_f32 v32, 1.0, v32
    v_add_f32 v33, 1.0, v33
    v_add_f32 v34, 1.0, v34
    v_add_f32 v35, 1.0, v35
    v_add_f32 v36, 1.0, v36
    v_add_f32 v37, 1.0, v37
    v_add_f32 v38, 1.0, v38
    v_add_f32 v39, 1.0, v39
    v_add_f32 v40, 1.0, v40
    v_add_f32 v41, 1.0, v41
    v_add_f32 v42, 1.0, v42
    v_add_f32 v43, 1.0, v43
    v_add_f32 v44, 1.0, v44
    v_add_f32 v45, 1.0, v45
    v_add_f32 v46, 1.0, v46
    v_add_f32 v47, 1.0, v47
    v_cvt_pk_bf16_f32 v32, 0, v32
    v_cvt_pk_bf16_f32 v33, 0, v33
    v_cvt_pk_bf16_f32 v34, 0, v34
    v_cvt_pk_bf16_f32 v35, 0, v35
    v_cvt_pk_bf16_f32 v36, 0, v36
    v_cvt_pk_bf16_f32 v37, 0, v37
    v_cvt_pk_bf16_f32 v38, 0, v38
    v_cvt_pk_bf16_f32 v39, 0, v39
    v_cvt_pk_bf16_f32 v40, 0, v40
    v_cvt_pk_bf16_f32 v41, 0, v41
    v_cvt_pk_bf16_f32 v42, 0, v42
    v_cvt_pk_bf16_f32 v43, 0, v43
    v_cvt_pk_bf16_f32 v44, 0, v44
    v_cvt_pk_bf16_f32 v45, 0, v45
    v_cvt_pk_bf16_f32 v46, 0, v46
    v_cvt_pk_bf16_f32 v47, 0, v47
L_l_sub_21:
    s_lshl_b32 s63, s60, 16
    v_accvgpr_read_b32 v96, a0
    v_accvgpr_read_b32 v97, a1
    v_accvgpr_read_b32 v98, a2
    v_accvgpr_read_b32 v99, a3
    v_accvgpr_read_b32 v100, a4
    v_accvgpr_read_b32 v101, a5
    v_accvgpr_read_b32 v102, a6
    v_accvgpr_read_b32 v103, a7
    v_lshlrev_b32 v64, 16, v96
    v_and_b32 v65, 0xffff0000, v96
    v_lshlrev_b32 v66, 16, v97
    v_and_b32 v67, 0xffff0000, v97
    v_lshlrev_b32 v68, 16, v98
    v_and_b32 v69, 0xffff0000, v98
    v_lshlrev_b32 v70, 16, v99
    v_and_b32 v71, 0xffff0000, v99
    v_lshlrev_b32 v72, 16, v100
    v_and_b32 v73, 0xffff0000, v100
    v_lshlrev_b32 v74, 16, v101
    v_and_b32 v75, 0xffff0000, v101
    v_lshlrev_b32 v76, 16, v102
    v_and_b32 v77, 0xffff0000, v102
    v_lshlrev_b32 v78, 16, v103
    v_and_b32 v79, 0xffff0000, v103
    v_pk_add_f32 v[80:81], v[64:65], v[72:73]
    v_pk_add_f32 v[82:83], v[66:67], v[74:75]
    v_pk_add_f32 v[84:85], v[68:69], v[76:77]
    v_pk_add_f32 v[86:87], v[70:71], v[78:79]
    v_pk_add_f32 v[80:81], v[80:81], v[84:85]
    v_pk_add_f32 v[82:83], v[82:83], v[86:87]
    v_pk_add_f32 v[80:81], v[80:81], v[82:83]
    v_add_f32 v14, v80, v81
    s_nop 1
    v_add_f32_dpp v14, v14, v14 row_shr:1 row_mask:0xf bank_mask:0xf bound_ctrl:0
    s_nop 1
    v_add_f32_dpp v14, v14, v14 row_shr:2 row_mask:0xf bank_mask:0xf bound_ctrl:0
    s_nop 1
    v_add_f32_dpp v14, v14, v14 row_shr:4 row_mask:0xf bank_mask:0xf bound_ctrl:0
    s_nop 1
    v_add_f32_dpp v14, v14, v14 row_shr:8 row_mask:0xf bank_mask:0xf bound_ctrl:0
    s_nop 1
    v_add_f32_dpp v14, v14, v14 row_bcast:15 row_mask:0xa bank_mask:0xf
    s_nop 1
    v_add_f32_dpp v14, v14, v14 row_bcast:31 row_mask:0xc bank_mask:0xf
    s_nop 1
    v_readlane_b32 s46, v14, 63
    s_nop 1
    v_mov_b32 v15, s46
    v_mul_f32 v15, 0x3a800000, v15
    v_pk_add_f32 v[80:81], v[64:65], v[14:15] op_sel:[0,1] op_sel_hi:[1,1] neg_lo:[0,1] neg_hi:[0,1]
    v_pk_add_f32 v[82:83], v[66:67], v[14:15] op_sel:[0,1] op_sel_hi:[1,1] neg_lo:[0,1] neg_hi:[0,1]
    v_pk_add_f32 v[84:85], v[68:69], v[14:15] op_sel:[0,1] op_sel_hi:[1,1] neg_lo:[0,1] neg_hi:[0,1]
    v_pk_add_f32 v[86:87], v[70:71], v[14:15] op_sel:[0,1] op_sel_hi:[1,1] neg_lo:[0,1] neg_hi:[0,1]
    v_pk_add_f32 v[88:89], v[72:73], v[14:15] op_sel:[0,1] op_sel_hi:[1,1] neg_lo:[0,1] neg_hi:[0,1]
    v_pk_add_f32 v[90:91], v[74:75], v[14:15] op_sel:[0,1] op_sel_hi:[1,1] neg_lo:[0,1] neg_hi:[0,1]
    v_pk_add_f32 v[92:93], v[76:77], v[14:15] op_sel:[0,1] op_sel_hi:[1,1] neg_lo:[0,1] neg_hi:[0,1]
    v_pk_add_f32 v[94:95], v[78:79], v[14:15] op_sel:[0,1] op_sel_hi:[1,1] neg_lo:[0,1] neg_hi:[0,1]
    v_pk_mul_f32 v[104:105], v[80:81], v[80:81]
    v_pk_mul_f32 v[106:107], v[82:83], v[82:83]
    v_pk_fma_f32 v[104:105], v[84:85], v[84:85], v[104:105]
    v_pk_fma_f32 v[106:107], v[86:87], v[86:87], v[106:107]
    v_pk_fma_f32 v[104:105], v[88:89], v[88:89], v[104:105]
    v_pk_fma_f32 v[106:107], v[90:91], v[90:91], v[106:107]
    v_pk_fma_f32 v[104:105], v[92:93], v[92:93], v[104:105]
    v_pk_fma_f32 v[106:107], v[94:95], v[94:95], v[106:107]
    v_pk_add_f32 v[104:105], v[104:105], v[106:107]
    v_add_f32 v14, v104, v105
    v_cvt_pk_bf16_f32 v15, 0, v15
    s_nop 1
    v_add_f32_dpp v14, v14, v14 row_shr:1 row_mask:0xf bank_mask:0xf bound_ctrl:0
    s_nop 1
    v_add_f32_dpp v14, v14, v14 row_shr:2 row_mask:0xf bank_mask:0xf bound_ctrl:0
    s_nop 1
    v_add_f32_dpp v14, v14, v14 row_shr:4 row_mask:0xf bank_mask:0xf bound_ctrl:0
    s_nop 1
    v_add_f32_dpp v14, v14, v14 row_shr:8 row_mask:0xf bank_mask:0xf bound_ctrl:0
    s_nop 1
    v_add_f32_dpp v14, v14, v14 row_bcast:15 row_mask:0xa bank_mask:0xf
    s_nop 1
    v_add_f32_dpp v14, v14, v14 row_bcast:31 row_mask:0xc bank_mask:0xf
    s_nop 1
    v_readlane_b32 s47, v14, 63
    v_pk_add_f32 v[64:65], v[64:65], v[14:15] op_sel:[0,1] op_sel_hi:[1,1] neg_lo:[0,1] neg_hi:[0,1]
    v_pk_add_f32 v[66:67], v[66:67], v[14:15] op_sel:[0,1] op_sel_hi:[1,1] neg_lo:[0,1] neg_hi:[0,1]
    v_pk_add_f32 v[68:69], v[68:69], v[14:15] op_sel:[0,1] op_sel_hi:[1,1] neg_lo:[0,1] neg_hi:[0,1]
    v_pk_add_f32 v[70:71], v[70:71], v[14:15] op_sel:[0,1] op_sel_hi:[1,1] neg_lo:[0,1] neg_hi:[0,1]
    v_pk_add_f32 v[72:73], v[72:73], v[14:15] op_sel:[0,1] op_sel_hi:[1,1] neg_lo:[0,1] neg_hi:[0,1]
    v_pk_add_f32 v[74:75], v[74:75], v[14:15] op_sel:[0,1] op_sel_hi:[1,1] neg_lo:[0,1] neg_hi:[0,1]
    v_pk_add_f32 v[76:77], v[76:77], v[14:15] op_sel:[0,1] op_sel_hi:[1,1] neg_lo:[0,1] neg_hi:[0,1]
    v_pk_add_f32 v[78:79], v[78:79], v[14:15] op_sel:[0,1] op_sel_hi:[1,1] neg_lo:[0,1] neg_hi:[0,1]
    v_mov_b32 v14, s47
    v_mul_f32 v14, 0x3a800000, v14
    v_cvt_pk_bf16_f32 v14, 0, v14
    v_add_f32 v14, 0x3727c5ac, v14
    v_cvt_pk_bf16_f32 v14, 0, v14
    v_sqrt_f32 v14, v14
    s_nop 0
    v_cvt_pk_bf16_f32 v14, 0, v14
    v_rcp_f32 v14, v14
    v_cvt_pk_bf16_f32 v64, 0, v64
    v_cvt_pk_bf16_f32 v65, 0, v65
    v_cvt_pk_bf16_f32 v66, 0, v66
    v_cvt_pk_bf16_f32 v67, 0, v67
    v_cvt_pk_bf16_f32 v68, 0, v68
    v_cvt_pk_bf16_f32 v69, 0, v69
    v_cvt_pk_bf16_f32 v70, 0, v70
    v_cvt_pk_bf16_f32 v71, 0, v71
    v_cvt_pk_bf16_f32 v72, 0, v72
    v_cvt_pk_bf16_f32 v73, 0, v73
    v_cvt_pk_bf16_f32 v74, 0, v74
    v_cvt_pk_bf16_f32 v75, 0, v75
    v_cvt_pk_bf16_f32 v76, 0, v76
    v_cvt_pk_bf16_f32 v77, 0, v77
    v_cvt_pk_bf16_f32 v78, 0, v78
    v_cvt_pk_bf16_f32 v79, 0, v79
    v_pk_mul_f32 v[64:65], v[64:65], v[14:15] op_sel_hi:[1,0]
    v_pk_mul_f32 v[66:67], v[66:67], v[14:15] op_sel_hi:[1,0]
    v_pk_mul_f32 v[68:69], v[68:69], v[14:15] op_sel_hi:[1,0]
    v_pk_mul_f32 v[70:71], v[70:71], v[14:15] op_sel_hi:[1,0]
    v_pk_mul_f32 v[72:73], v[72:73], v[14:15] op_sel_hi:[1,0]
    v_pk_mul_f32 v[74:75], v[74:75], v[14:15] op_sel_hi:[1,0]
    v_pk_mul_f32 v[76:77], v[76:77], v[14:15] op_sel_hi:[1,0]
    v_pk_mul_f32 v[78:79], v[78:79], v[14:15] op_sel_hi:[1,0]
    v_cvt_pk_bf16_f32 v64, 0, v64
    v_cvt_pk_bf16_f32 v65, 0, v65
    v_cvt_pk_bf16_f32 v66, 0, v66
    v_cvt_pk_bf16_f32 v67, 0, v67
    v_cvt_pk_bf16_f32 v68, 0, v68
    v_cvt_pk_bf16_f32 v69, 0, v69
    v_cvt_pk_bf16_f32 v70, 0, v70
    v_cvt_pk_bf16_f32 v71, 0, v71
    v_cvt_pk_bf16_f32 v72, 0, v72
    v_cvt_pk_bf16_f32 v73, 0, v73
    v_cvt_pk_bf16_f32 v74, 0, v74
    v_cvt_pk_bf16_f32 v75, 0, v75
    v_cvt_pk_bf16_f32 v76, 0, v76
    v_cvt_pk_bf16_f32 v77, 0, v77
    v_cvt_pk_bf16_f32 v78, 0, v78
    v_cvt_pk_bf16_f32 v79, 0, v79
    v_pk_mul_f32 v[64:65], v[64:65], v[32:33]
    v_pk_mul_f32 v[66:67], v[66:67], v[34:35]
    v_pk_mul_f32 v[68:69], v[68:69], v[36:37]
    v_pk_mul_f32 v[70:71], v[70:71], v[38:39]
    v_pk_mul_f32 v[72:73], v[72:73], v[40:41]
    v_pk_mul_f32 v[74:75], v[74:75], v[42:43]
    v_pk_mul_f32 v[76:77], v[76:77], v[44:45]
    v_pk_mul_f32 v[78:79], v[78:79], v[46:47]
    v_cvt_pk_bf16_f32 v64, 0, v64
    v_cvt_pk_bf16_f32 v65, 0, v65
    v_cvt_pk_bf16_f32 v66, 0, v66
    v_cvt_pk_bf16_f32 v67, 0, v67
    v_cvt_pk_bf16_f32 v68, 0, v68
    v_cvt_pk_bf16_f32 v69, 0, v69
    v_cvt_pk_bf16_f32 v70, 0, v70
    v_cvt_pk_bf16_f32 v71, 0, v71
    v_cvt_pk_bf16_f32 v72, 0, v72
    v_cvt_pk_bf16_f32 v73, 0, v73
    v_cvt_pk_bf16_f32 v74, 0, v74
    v_cvt_pk_bf16_f32 v75, 0, v75
    v_cvt_pk_bf16_f32 v76, 0, v76
    v_cvt_pk_bf16_f32 v77, 0, v77
    v_cvt_pk_bf16_f32 v78, 0, v78
    v_cvt_pk_bf16_f32 v79, 0, v79
    v_pk_add_f32 v[64:65], v[64:65], v[48:49]
    v_pk_add_f32 v[66:67], v[66:67], v[50:51]
    v_pk_add_f32 v[68:69], v[68:69], v[52:53]
    v_pk_add_f32 v[70:71], v[70:71], v[54:55]
    v_pk_add_f32 v[72:73], v[72:73], v[56:57]
    v_pk_add_f32 v[74:75], v[74:75], v[58:59]
    v_pk_add_f32 v[76:77], v[76:77], v[60:61]
    v_pk_add_f32 v[78:79], v[78:79], v[62:63]
    v_cvt_pk_bf16_f32 v104, v64, v65
    v_cvt_pk_bf16_f32 v105, v66, v67
    v_cvt_pk_bf16_f32 v106, v68, v69
    v_cvt_pk_bf16_f32 v107, v70, v71
    v_cvt_pk_bf16_f32 v108, v72, v73
    v_cvt_pk_bf16_f32 v109, v74, v75
    v_cvt_pk_bf16_f32 v110, v76, v77
    v_cvt_pk_bf16_f32 v111, v78, v79
    ds_write_b128 v10, v[104:107]
    ds_write_b128 v10, v[108:111] offset:1024
    s_waitcnt lgkmcnt(0)
    s_barrier
    ds_read_b128 v[104:107], v13
    ds_read_b128 v[108:111], v13 offset:128
    s_waitcnt lgkmcnt(1)
    buffer_store_dwordx4 v[104:107], v11, s[12:15], s63 offen sc1
    s_waitcnt lgkmcnt(0)
    buffer_store_dwordx4 v[108:111], v12, s[12:15], s63 offen sc1
    s_waitcnt vmcnt(0)
    s_barrier
    s_cmp_lg_u32 s44, 0
    s_cbranch_scc1 L_sf_23
    v_mov_b32 v14, s60
    v_add_u32 v14, 1, v14
    v_mov_b32 v15, 0
    s_mov_b64 exec, 1
    buffer_store_dword v14, v15, s[12:15], s52 offen sc1
    s_mov_b64 exec, -1
L_sf_23:
    s_cmp_ge_u32 s60, 8
    s_cbranch_scc1 L_l_end_22
    s_add_u32 s63, s63, 524288
    buffer_load_dwordx4 a[8:11], v7, s[24:27], s63 offen
    buffer_load_dwordx4 a[12:15], v7, s[24:27], s63 offen offset:1024
    s_add_u32 s63, s63, 524288
    buffer_load_dwordx4 a[16:19], v7, s[24:27], s63 offen
    buffer_load_dwordx4 a[20:23], v7, s[24:27], s63 offen offset:1024
    s_add_u32 s63, s63, 524288
    buffer_load_dwordx4 a[24:27], v7, s[24:27], s63 offen
    buffer_load_dwordx4 a[28:31], v7, s[24:27], s63 offen offset:1024
    s_add_u32 s63, s63, 524288
    buffer_load_dwordx4 a[32:35], v7, s[24:27], s63 offen
    buffer_load_dwordx4 a[36:39], v7, s[24:27], s63 offen offset:1024
    s_add_u32 s63, s63, 524288
    buffer_load_dwordx4 a[40:43], v7, s[24:27], s63 offen
    buffer_load_dwordx4 a[44:47], v7, s[24:27], s63 offen offset:1024
    s_add_u32 s63, s63, 524288
    buffer_load_dwordx4 a[48:51], v7, s[24:27], s63 offen
    buffer_load_dwordx4 a[52:55], v7, s[24:27], s63 offen offset:1024
    s_add_u32 s63, s63, 524288
    buffer_load_dwordx4 a[56:59], v7, s[24:27], s63 offen
    buffer_load_dwordx4 a[60:63], v7, s[24:27], s63 offen offset:1024
    s_waitcnt vmcnt(0)
L_l_end_22:
    v_accvgpr_mov_b32 a0, a8
    v_accvgpr_mov_b32 a1, a9
    v_accvgpr_mov_b32 a2, a10
    v_accvgpr_mov_b32 a3, a11
    v_accvgpr_mov_b32 a4, a12
    v_accvgpr_mov_b32 a5, a13
    v_accvgpr_mov_b32 a6, a14
    v_accvgpr_mov_b32 a7, a15
    v_accvgpr_mov_b32 a8, a16
    v_accvgpr_mov_b32 a9, a17
    v_accvgpr_mov_b32 a10, a18
    v_accvgpr_mov_b32 a11, a19
    v_accvgpr_mov_b32 a12, a20
    v_accvgpr_mov_b32 a13, a21
    v_accvgpr_mov_b32 a14, a22
    v_accvgpr_mov_b32 a15, a23
    v_accvgpr_mov_b32 a16, a24
    v_accvgpr_mov_b32 a17, a25
    v_accvgpr_mov_b32 a18, a26
    v_accvgpr_mov_b32 a19, a27
    v_accvgpr_mov_b32 a20, a28
    v_accvgpr_mov_b32 a21, a29
    v_accvgpr_mov_b32 a22, a30
    v_accvgpr_mov_b32 a23, a31
    v_accvgpr_mov_b32 a24, a32
    v_accvgpr_mov_b32 a25, a33
    v_accvgpr_mov_b32 a26, a34
    v_accvgpr_mov_b32 a27, a35
    v_accvgpr_mov_b32 a28, a36
    v_accvgpr_mov_b32 a29, a37
    v_accvgpr_mov_b32 a30, a38
    v_accvgpr_mov_b32 a31, a39
    v_accvgpr_mov_b32 a32, a40
    v_accvgpr_mov_b32 a33, a41
    v_accvgpr_mov_b32 a34, a42
    v_accvgpr_mov_b32 a35, a43
    v_accvgpr_mov_b32 a36, a44
    v_accvgpr_mov_b32 a37, a45
    v_accvgpr_mov_b32 a38, a46
    v_accvgpr_mov_b32 a39, a47
    v_accvgpr_mov_b32 a40, a48
    v_accvgpr_mov_b32 a41, a49
    v_accvgpr_mov_b32 a42, a50
    v_accvgpr_mov_b32 a43, a51
    v_accvgpr_mov_b32 a44, a52
    v_accvgpr_mov_b32 a45, a53
    v_accvgpr_mov_b32 a46, a54
    v_accvgpr_mov_b32 a47, a55
    v_accvgpr_mov_b32 a48, a56
    v_accvgpr_mov_b32 a49, a57
    v_accvgpr_mov_b32 a50, a58
    v_accvgpr_mov_b32 a51, a59
    v_accvgpr_mov_b32 a52, a60
    v_accvgpr_mov_b32 a53, a61
    v_accvgpr_mov_b32 a54, a62
    v_accvgpr_mov_b32 a55, a63
    s_add_u32 s60, s60, 8
    s_cmp_lt_u32 s60, 64
    s_cbranch_scc1 L_l_sub_21
    s_cmp_lt_u32 s48, 14
    s_cbranch_scc1 L_w_h_17_s
    s_and_b32 s55, s48, 1
    s_lshl_b32 s55, s55, 3
    s_add_u32 s55, s55, s40
    s_load_dwordx4 s[8:11], s[0:1], 96
    v_lshrrev_b32 v5, 3, v0
    s_mov_b32 s46, 196608
    v_mul_lo_u32 v4, v5, s46
    v_and_b32 v6, 7, v0
    v_lshl_add_u32 v4, v6, 4, v4
    v_lshlrev_b32 v5, 5, v5
    s_waitcnt lgkmcnt(0)
    s_mov_b32 s28, s10
    s_and_b32 s29, s11, 0xffff
    s_mov_b32 s30, 0xc00000
    s_mov_b32 s31, 0x00020000
    s_mov_b32 s32, s8
    s_and_b32 s33, s9, 0xffff
    s_mov_b32 s34, 0x800
    s_mov_b32 s35, 0x00020000
    buffer_load_dwordx4 v[8:11], v5, s[32:35], 0 offen
    buffer_load_dwordx4 v[12:15], v5, s[32:35], 0 offen offset:16
    s_waitcnt vmcnt(0)
    v_lshlrev_b32 v16, 16, v8
    v_and_b32 v17, 0xffff0000, v8
    v_lshlrev_b32 v18, 16, v9
    v_and_b32 v19, 0xffff0000, v9
    v_lshlrev_b32 v20, 16, v10
    v_and_b32 v21, 0xffff0000, v10
    v_lshlrev_b32 v22, 16, v11
    v_and_b32 v23, 0xffff0000, v11
    v_lshlrev_b32 v24, 16, v12
    v_and_b32 v25, 0xffff0000, v12
    v_lshlrev_b32 v26, 16, v13
    v_and_b32 v27, 0xffff0000, v13
    v_lshlrev_b32 v28, 16, v14
    v_and_b32 v29, 0xffff0000, v14
    v_lshlrev_b32 v30, 16, v15
    v_and_b32 v31, 0xffff0000, v15
    v_mul_f32 v112, 0xbfb8aa3b, v16
    v_mul_f32 v113, 0xbfb8aa3b, v17
    v_mul_f32 v114, 0xbfb8aa3b, v18
    v_mul_f32 v115, 0xbfb8aa3b, v19
    v_mul_f32 v116, 0xbfb8aa3b, v20
    v_mul_f32 v117, 0xbfb8aa3b, v21
    v_mul_f32 v118, 0xbfb8aa3b, v22
    v_mul_f32 v119, 0xbfb8aa3b, v23
    v_mul_f32 v120, 0xbfb8aa3b, v24
    v_mul_f32 v121, 0xbfb8aa3b, v25
    v_mul_f32 v122, 0xbfb8aa3b, v26
    v_mul_f32 v123, 0xbfb8aa3b, v27
    v_mul_f32 v124, 0xbfb8aa3b, v28
    v_mul_f32 v125, 0xbfb8aa3b, v29
    v_mul_f32 v126, 0xbfb8aa3b, v30
    v_mul_f32 v127, 0xbfb8aa3b, v31
    v_exp_f32 v112, v112
    v_exp_f32 v113, v113
    v_exp_f32 v114, v114
    v_exp_f32 v115, v115
    v_exp_f32 v116, v116
    v_exp_f32 v117, v117
    v_exp_f32 v118, v118
    v_exp_f32 v119, v119
    v_exp_f32 v120, v120
    v_exp_f32 v121, v121
    v_exp_f32 v122, v122
    v_exp_f32 v123, v123
    v_exp_f32 v124, v124
    v_exp_f32 v125, v125
    v_exp_f32 v126, v126
    v_exp_f32 v127, v127
    v_add_f32 v112, 1.0, v112
    v_add_f32 v113, 1.0, v113
    v_add_f32 v114, 1.0, v114
    v_add_f32 v115, 1.0, v115
    v_add_f32 v116, 1.0, v116
    v_add_f32 v117, 1.0, v117
    v_add_f32 v118, 1.0, v118
    v_add_f32 v119, 1.0, v119
    v_add_f32 v120, 1.0, v120
    v_add_f32 v121, 1.0, v121
    v_add_f32 v122, 1.0, v122
    v_add_f32 v123, 1.0, v123
    v_add_f32 v124, 1.0, v124
    v_add_f32 v125, 1.0, v125
    v_add_f32 v126, 1.0, v126
    v_add_f32 v127, 1.0, v127
    v_rcp_f32 v112, v112
    v_rcp_f32 v113, v113
    v_rcp_f32 v114, v114
    v_rcp_f32 v115, v115
    v_rcp_f32 v116, v116
    v_rcp_f32 v117, v117
    v_rcp_f32 v118, v118
    v_rcp_f32 v119, v119
    v_rcp_f32 v120, v120
    v_rcp_f32 v121, v121
    v_rcp_f32 v122, v122
    v_rcp_f32 v123, v123
    v_rcp_f32 v124, v124
    v_rcp_f32 v125, v125
    v_rcp_f32 v126, v126
    v_rcp_f32 v127, v127
    v_mul_f32 v16, v16, v112
    v_mul_f32 v17, v17, v113
    v_mul_f32 v18, v18, v114
    v_mul_f32 v19, v19, v115
    v_mul_f32 v20, v20, v116
    v_mul_f32 v21, v21, v117
    v_mul_f32 v22, v22, v118
    v_mul_f32 v23, v23, v119
    v_mul_f32 v24, v24, v120
    v_mul_f32 v25, v25, v121
    v_mul_f32 v26, v26, v122
    v_mul_f32 v27, v27, v123
    v_mul_f32 v28, v28, v124
    v_mul_f32 v29, v29, v125
    v_mul_f32 v30, v30, v126
    v_mul_f32 v31, v31, v127
    v_cvt_pk_bf16_f32 v16, 0, v16
    v_cvt_pk_bf16_f32 v17, 0, v17
    v_cvt_pk_bf16_f32 v18, 0, v18
    v_cvt_pk_bf16_f32 v19, 0, v19
    v_cvt_pk_bf16_f32 v20, 0, v20
    v_cvt_pk_bf16_f32 v21, 0, v21
    v_cvt_pk_bf16_f32 v22, 0, v22
    v_cvt_pk_bf16_f32 v23, 0, v23
    v_cvt_pk_bf16_f32 v24, 0, v24
    v_cvt_pk_bf16_f32 v25, 0, v25
    v_cvt_pk_bf16_f32 v26, 0, v26
    v_cvt_pk_bf16_f32 v27, 0, v27
    v_cvt_pk_bf16_f32 v28, 0, v28
    v_cvt_pk_bf16_f32 v29, 0, v29
    v_cvt_pk_bf16_f32 v30, 0, v30
    v_cvt_pk_bf16_f32 v31, 0, v31
    s_lshl_b32 s53, s55, 9
    s_add_u32 s53, s53, 4096
L_m_loop_24:
    s_add_u32 s46, s53, 0
    buffer_load_dwordx4 v[32:35], v4, s[28:31], s46 offen
    s_add_u32 s46, s53, 12288
    buffer_load_dwordx4 v[36:39], v4, s[28:31], s46 offen
    s_add_u32 s46, s53, 24576
    buffer_load_dwordx4 v[40:43], v4, s[28:31], s46 offen
    s_add_u32 s46, s53, 36864
    buffer_load_dwordx4 v[44:47], v4, s[28:31], s46 offen
    s_add_u32 s46, s53, 49152
    buffer_load_dwordx4 v[48:51], v4, s[28:31], s46 offen
    s_add_u32 s46, s53, 61440
    buffer_load_dwordx4 v[52:55], v4, s[28:31], s46 offen
    s_add_u32 s46, s53, 73728
    buffer_load_dwordx4 v[56:59], v4, s[28:31], s46 offen
    s_add_u32 s46, s53, 86016
    buffer_load_dwordx4 v[60:63], v4, s[28:31], s46 offen
    s_add_u32 s46, s53, 98304
    buffer_load_dwordx4 v[64:67], v4, s[28:31], s46 offen
    s_add_u32 s46, s53, 110592
    buffer_load_dwordx4 v[68:71], v4, s[28:31], s46 offen
    s_add_u32 s46, s53, 122880
    buffer_load_dwordx4 v[72:75], v4, s[28:31], s46 offen
    s_add_u32 s46, s53, 135168
    buffer_load_dwordx4 v[76:79], v4, s[28:31], s46 offen
    s_add_u32 s46, s53, 147456
    buffer_load_dwordx4 v[80:83], v4, s[28:31], s46 offen
    s_add_u32 s46, s53, 159744
    buffer_load_dwordx4 v[84:87], v4, s[28:31], s46 offen
    s_add_u32 s46, s53, 172032
    buffer_load_dwordx4 v[88:91], v4, s[28:31], s46 offen
    s_add_u32 s46, s53, 184320
    buffer_load_dwordx4 v[92:95], v4, s[28:31], s46 offen
    s_waitcnt vmcnt(15)
    v_lshlrev_b32 v104, 16, v32
    v_and_b32 v105, 0xffff0000, v32
    v_mul_f32 v96, v104, v16
    v_mul_f32 v97, v105, v16
    v_lshlrev_b32 v104, 16, v33
    v_and_b32 v105, 0xffff0000, v33
    v_mul_f32 v98, v104, v16
    v_mul_f32 v99, v105, v16
    v_lshlrev_b32 v104, 16, v34
    v_and_b32 v105, 0xffff0000, v34
    v_mul_f32 v100, v104, v16
    v_mul_f32 v101, v105, v16
    v_lshlrev_b32 v104, 16, v35
    v_and_b32 v105, 0xffff0000, v35
    v_mul_f32 v102, v104, v16
    v_mul_f32 v103, v105, v16
    s_waitcnt vmcnt(14)
    v_lshlrev_b32 v104, 16, v36
    v_and_b32 v105, 0xffff0000, v36
    v_fmac_f32 v96, v104, v17
    v_fmac_f32 v97, v105, v17
    v_lshlrev_b32 v104, 16, v37
    v_and_b32 v105, 0xffff0000, v37
    v_fmac_f32 v98, v104, v17
    v_fmac_f32 v99, v105, v17
    v_lshlrev_b32 v104, 16, v38
    v_and_b32 v105, 0xffff0000, v38
    v_fmac_f32 v100, v104, v17
    v_fmac_f32 v101, v105, v17
    v_lshlrev_b32 v104, 16, v39
    v_and_b32 v105, 0xffff0000, v39
    v_fmac_f32 v102, v104, v17
    v_fmac_f32 v103, v105, v17
    s_waitcnt vmcnt(13)
    v_lshlrev_b32 v104, 16, v40
    v_and_b32 v105, 0xffff0000, v40
    v_fmac_f32 v96, v104, v18
    v_fmac_f32 v97, v105, v18
    v_lshlrev_b32 v104, 16, v41
    v_and_b32 v105, 0xffff0000, v41
    v_fmac_f32 v98, v104, v18
    v_fmac_f32 v99, v105, v18
    v_lshlrev_b32 v104, 16, v42
    v_and_b32 v105, 0xffff0000, v42
    v_fmac_f32 v100, v104, v18
    v_fmac_f32 v101, v105, v18
    v_lshlrev_b32 v104, 16, v43
    v_and_b32 v105, 0xffff0000, v43
    v_fmac_f32 v102, v104, v18
    v_fmac_f32 v103, v105, v18
    s_waitcnt vmcnt(12)
    v_lshlrev_b32 v104, 16, v44
    v_and_b32 v105, 0xffff0000, v44
    v_fmac_f32 v96, v104, v19
    v_fmac_f32 v97, v105, v19
    v_lshlrev_b32 v104, 16, v45
    v_and_b32 v105, 0xffff0000, v45
    v_fmac_f32 v98, v104, v19
    v_fmac_f32 v99, v105, v19
    v_lshlrev_b32 v104, 16, v46
    v_and_b32 v105, 0xffff0000, v46
    v_fmac_f32 v100, v104, v19
    v_fmac_f32 v101, v105, v19
    v_lshlrev_b32 v104, 16, v47
    v_and_b32 v105, 0xffff0000, v47
    v_fmac_f32 v102, v104, v19
    v_fmac_f32 v103, v105, v19
    s_waitcnt vmcnt(11)
    v_lshlrev_b32 v104, 16, v48
    v_and_b32 v105, 0xffff0000, v48
    v_fmac_f32 v96, v104, v20
    v_fmac_f32 v97, v105, v20
    v_lshlrev_b32 v104, 16, v49
    v_and_b32 v105, 0xffff0000, v49
    v_fmac_f32 v98, v104, v20
    v_fmac_f32 v99, v105, v20
    v_lshlrev_b32 v104, 16, v50
    v_and_b32 v105, 0xffff0000, v50
    v_fmac_f32 v100, v104, v20
    v_fmac_f32 v101, v105, v20
    v_lshlrev_b32 v104, 16, v51
    v_and_b32 v105, 0xffff0000, v51
    v_fmac_f32 v102, v104, v20
    v_fmac_f32 v103, v105, v20
    s_waitcnt vmcnt(10)
    v_lshlrev_b32 v104, 16, v52
    v_and_b32 v105, 0xffff0000, v52
    v_fmac_f32 v96, v104, v21
    v_fmac_f32 v97, v105, v21
    v_lshlrev_b32 v104, 16, v53
    v_and_b32 v105, 0xffff0000, v53
    v_fmac_f32 v98, v104, v21
    v_fmac_f32 v99, v105, v21
    v_lshlrev_b32 v104, 16, v54
    v_and_b32 v105, 0xffff0000, v54
    v_fmac_f32 v100, v104, v21
    v_fmac_f32 v101, v105, v21
    v_lshlrev_b32 v104, 16, v55
    v_and_b32 v105, 0xffff0000, v55
    v_fmac_f32 v102, v104, v21
    v_fmac_f32 v103, v105, v21
    s_waitcnt vmcnt(9)
    v_lshlrev_b32 v104, 16, v56
    v_and_b32 v105, 0xffff0000, v56
    v_fmac_f32 v96, v104, v22
    v_fmac_f32 v97, v105, v22
    v_lshlrev_b32 v104, 16, v57
    v_and_b32 v105, 0xffff0000, v57
    v_fmac_f32 v98, v104, v22
    v_fmac_f32 v99, v105, v22
    v_lshlrev_b32 v104, 16, v58
    v_and_b32 v105, 0xffff0000, v58
    v_fmac_f32 v100, v104, v22
    v_fmac_f32 v101, v105, v22
    v_lshlrev_b32 v104, 16, v59
    v_and_b32 v105, 0xffff0000, v59
    v_fmac_f32 v102, v104, v22
    v_fmac_f32 v103, v105, v22
    s_waitcnt vmcnt(8)
    v_lshlrev_b32 v104, 16, v60
    v_and_b32 v105, 0xffff0000, v60
    v_fmac_f32 v96, v104, v23
    v_fmac_f32 v97, v105, v23
    v_lshlrev_b32 v104, 16, v61
    v_and_b32 v105, 0xffff0000, v61
    v_fmac_f32 v98, v104, v23
    v_fmac_f32 v99, v105, v23
    v_lshlrev_b32 v104, 16, v62
    v_and_b32 v105, 0xffff0000, v62
    v_fmac_f32 v100, v104, v23
    v_fmac_f32 v101, v105, v23
    v_lshlrev_b32 v104, 16, v63
    v_and_b32 v105, 0xffff0000, v63
    v_fmac_f32 v102, v104, v23
    v_fmac_f32 v103, v105, v23
    s_waitcnt vmcnt(7)
    v_lshlrev_b32 v104, 16, v64
    v_and_b32 v105, 0xffff0000, v64
    v_fmac_f32 v96, v104, v24
    v_fmac_f32 v97, v105, v24
    v_lshlrev_b32 v104, 16, v65
    v_and_b32 v105, 0xffff0000, v65
    v_fmac_f32 v98, v104, v24
    v_fmac_f32 v99, v105, v24
    v_lshlrev_b32 v104, 16, v66
    v_and_b32 v105, 0xffff0000, v66
    v_fmac_f32 v100, v104, v24
    v_fmac_f32 v101, v105, v24
    v_lshlrev_b32 v104, 16, v67
    v_and_b32 v105, 0xffff0000, v67
    v_fmac_f32 v102, v104, v24
    v_fmac_f32 v103, v105, v24
    s_waitcnt vmcnt(6)
    v_lshlrev_b32 v104, 16, v68
    v_and_b32 v105, 0xffff0000, v68
    v_fmac_f32 v96, v104, v25
    v_fmac_f32 v97, v105, v25
    v_lshlrev_b32 v104, 16, v69
    v_and_b32 v105, 0xffff0000, v69
    v_fmac_f32 v98, v104, v25
    v_fmac_f32 v99, v105, v25
    v_lshlrev_b32 v104, 16, v70
    v_and_b32 v105, 0xffff0000, v70
    v_fmac_f32 v100, v104, v25
    v_fmac_f32 v101, v105, v25
    v_lshlrev_b32 v104, 16, v71
    v_and_b32 v105, 0xffff0000, v71
    v_fmac_f32 v102, v104, v25
    v_fmac_f32 v103, v105, v25
    s_waitcnt vmcnt(5)
    v_lshlrev_b32 v104, 16, v72
    v_and_b32 v105, 0xffff0000, v72
    v_fmac_f32 v96, v104, v26
    v_fmac_f32 v97, v105, v26
    v_lshlrev_b32 v104, 16, v73
    v_and_b32 v105, 0xffff0000, v73
    v_fmac_f32 v98, v104, v26
    v_fmac_f32 v99, v105, v26
    v_lshlrev_b32 v104, 16, v74
    v_and_b32 v105, 0xffff0000, v74
    v_fmac_f32 v100, v104, v26
    v_fmac_f32 v101, v105, v26
    v_lshlrev_b32 v104, 16, v75
    v_and_b32 v105, 0xffff0000, v75
    v_fmac_f32 v102, v104, v26
    v_fmac_f32 v103, v105, v26
    s_waitcnt vmcnt(4)
    v_lshlrev_b32 v104, 16, v76
    v_and_b32 v105, 0xffff0000, v76
    v_fmac_f32 v96, v104, v27
    v_fmac_f32 v97, v105, v27
    v_lshlrev_b32 v104, 16, v77
    v_and_b32 v105, 0xffff0000, v77
    v_fmac_f32 v98, v104, v27
    v_fmac_f32 v99, v105, v27
    v_lshlrev_b32 v104, 16, v78
    v_and_b32 v105, 0xffff0000, v78
    v_fmac_f32 v100, v104, v27
    v_fmac_f32 v101, v105, v27
    v_lshlrev_b32 v104, 16, v79
    v_and_b32 v105, 0xffff0000, v79
    v_fmac_f32 v102, v104, v27
    v_fmac_f32 v103, v105, v27
    s_waitcnt vmcnt(3)
    v_lshlrev_b32 v104, 16, v80
    v_and_b32 v105, 0xffff0000, v80
    v_fmac_f32 v96, v104, v28
    v_fmac_f32 v97, v105, v28
    v_lshlrev_b32 v104, 16, v81
    v_and_b32 v105, 0xffff0000, v81
    v_fmac_f32 v98, v104, v28
    v_fmac_f32 v99, v105, v28
    v_lshlrev_b32 v104, 16, v82
    v_and_b32 v105, 0xffff0000, v82
    v_fmac_f32 v100, v104, v28
    v_fmac_f32 v101, v105, v28
    v_lshlrev_b32 v104, 16, v83
    v_and_b32 v105, 0xffff0000, v83
    v_fmac_f32 v102, v104, v28
    v_fmac_f32 v103, v105, v28
    s_waitcnt vmcnt(2)
    v_lshlrev_b32 v104, 16, v84
    v_and_b32 v105, 0xffff0000, v84
    v_fmac_f32 v96, v104, v29
    v_fmac_f32 v97, v105, v29
    v_lshlrev_b32 v104, 16, v85
    v_and_b32 v105, 0xffff0000, v85
    v_fmac_f32 v98, v104, v29
    v_fmac_f32 v99, v105, v29
    v_lshlrev_b32 v104, 16, v86
    v_and_b32 v105, 0xffff0000, v86
    v_fmac_f32 v100, v104, v29
    v_fmac_f32 v101, v105, v29
    v_lshlrev_b32 v104, 16, v87
    v_and_b32 v105, 0xffff0000, v87
    v_fmac_f32 v102, v104, v29
    v_fmac_f32 v103, v105, v29
    s_waitcnt vmcnt(1)
    v_lshlrev_b32 v104, 16, v88
    v_and_b32 v105, 0xffff0000, v88
    v_fmac_f32 v96, v104, v30
    v_fmac_f32 v97, v105, v30
    v_lshlrev_b32 v104, 16, v89
    v_and_b32 v105, 0xffff0000, v89
    v_fmac_f32 v98, v104, v30
    v_fmac_f32 v99, v105, v30
    v_lshlrev_b32 v104, 16, v90
    v_and_b32 v105, 0xffff0000, v90
    v_fmac_f32 v100, v104, v30
    v_fmac_f32 v101, v105, v30
    v_lshlrev_b32 v104, 16, v91
    v_and_b32 v105, 0xffff0000, v91
    v_fmac_f32 v102, v104, v30
    v_fmac_f32 v103, v105, v30
    s_waitcnt vmcnt(0)
    v_lshlrev_b32 v104, 16, v92
    v_and_b32 v105, 0xffff0000, v92
    v_fmac_f32 v96, v104, v31
    v_fmac_f32 v97, v105, v31
    v_lshlrev_b32 v104, 16, v93
    v_and_b32 v105, 0xffff0000, v93
    v_fmac_f32 v98, v104, v31
    v_fmac_f32 v99, v105, v31
    v_lshlrev_b32 v104, 16, v94
    v_and_b32 v105, 0xffff0000, v94
    v_fmac_f32 v100, v104, v31
    v_fmac_f32 v101, v105, v31
    v_lshlrev_b32 v104, 16, v95
    v_and_b32 v105, 0xffff0000, v95
    v_fmac_f32 v102, v104, v31
    v_fmac_f32 v103, v105, v31
    v_lshlrev_b32 v104, 5, v0
    ds_write_b128 v104, v[96:99]
    ds_write_b128 v104, v[100:103] offset:16
    v_lshlrev_b32 v105, 2, v1
    s_lshl_b32 s46, s44, 11
    v_add_u32 v104, s46, v105
    s_waitcnt lgkmcnt(0)
    ds_read_b32 v96, v104 offset:0
    ds_read_b32 v97, v104 offset:256
    ds_read_b32 v98, v104 offset:512
    ds_read_b32 v99, v104 offset:768
    ds_read_b32 v100, v104 offset:1024
    ds_read_b32 v101, v104 offset:1280
    ds_read_b32 v102, v104 offset:1536
    ds_read_b32 v103, v104 offset:1792
    s_waitcnt lgkmcnt(0)
    v_add_f32 v96, v96, v100
    v_add_f32 v97, v97, v101
    v_add_f32 v98, v98, v102
    v_add_f32 v99, v99, v103
    v_add_f32 v96, v96, v98
    v_add_f32 v97, v97, v99
    v_add_f32 v96, v96, v97
    v_lshlrev_b32 v104, 2, v0
    ds_write_b32 v104, v96 offset:16384
    s_waitcnt lgkmcnt(0)
    s_barrier
    s_cmp_lg_u32 s44, 0
    s_cbranch_scc1 L_m_sk_25
    ds_read_b32 v96, v105 offset:16384
    ds_read_b32 v97, v105 offset:16640
    ds_read_b32 v98, v105 offset:16896
    ds_read_b32 v99, v105 offset:17152
    ds_read_b32 v100, v105 offset:17408
    ds_read_b32 v101, v105 offset:17664
    ds_read_b32 v102, v105 offset:17920
    ds_read_b32 v103, v105 offset:18176
    s_waitcnt lgkmcnt(0)
    v_add_f32 v96, v96, v100
    v_add_f32 v97, v97, v101
    v_add_f32 v98, v98, v102
    v_add_f32 v99, v99, v103
    v_add_f32 v96, v96, v98
    v_add_f32 v97, v97, v99
    v_add_f32 v96, v96, v97
    v_cvt_pk_bf16_f32 v96, 0, v96
    s_lshl_b32 s46, s53, 1
    buffer_store_dword v96, v105, s[12:15], s46 offen sc1
L_m_sk_25:
    s_barrier
    s_add_u32 s53, s53, 128
    s_and_b32 s46, s53, 511
    s_cmp_lg_u32 s46, 0
    s_cbranch_scc1 L_m_loop_24
    s_lshl_b32 s54, s55, 7
    s_add_u32 s54, s54, 0x10e400
    s_mov_b32 s60, 0
    s_waitcnt vmcnt(0)
    s_cmp_lg_u32 s44, 0
    s_cbranch_scc1 L_sf_26
    v_mov_b32 v8, s60
    v_add_u32 v8, 1, v8
    v_mov_b32 v9, 0
    s_mov_b64 exec, 1
    buffer_store_dword v8, v9, s[12:15], s54 offen sc1
    s_mov_b64 exec, -1
L_sf_26:
    s_barrier
L_w_h_17_s:
    s_mov_b32 s77, s48
    s_cmp_eq_u32 s48, 14
    s_cselect_b32 s53, 2, 1
    s_sub_u32 s48, s48, 12
    s_min_u32 s48, s48, 2
    s_mov_b32 s79, 0
L_w_h_17_n:
    s_cmp_eq_u32 s53, 1
    s_cselect_b32 s74, 41, 54
    s_cselect_b32 s75, 58, 64
    s_mov_b32 s76, 65536
    s_branch L_w_g_10_e
L_w_h_17:
    s_mov_b32 s48, s77
    s_cmp_lt_u32 s48, 14
    s_cbranch_scc1 L_w_att_15
    s_and_b32 s42, s40, 3
    s_lshr_b32 s43, s40, 2
    s_cmp_eq_u32 s48, 14
    s_cbranch_scc1 L_w_c_16
    s_mov_b32 s75, 60
    s_mov_b32 s76, 0
    s_mov_b32 s78, 2
L_w_h_17_f:
    s_load_dwordx2 s[4:5], s[0:1], 112
    s_load_dwordx2 s[6:7], s[0:1], 88
    v_lshlrev_b32 v2, 4, v1
    v_lshlrev_b32 v3, 5, v1
    s_waitcnt lgkmcnt(0)
    s_mov_b32 s24, s4
    s_and_b32 s25, s5, 0xffff
    s_mov_b32 s26, 0x400000
    s_mov_b32 s27, 0x00020000
    s_mov_b32 s28, s6
    s_and_b32 s29, s7, 0xffff
    s_mov_b32 s30, 0x800
    s_mov_b32 s31, 0x00020000
    s_cmp_lg_u32 s44, 0
    s_cbranch_scc1 L_mw_27
    v_and_b32 v8, 15, v1
    v_lshlrev_b32 v8, 7, v8
    s_mov_b32 s46, 0x10e400
    s_mov_b32 s47, 0
    s_mov_b32 s70, 0
L_spin_28:
    buffer_load_dword v9, v8, s[12:15], s46 offen sc1
    s_waitcnt vmcnt(0)
    v_cmp_ge_u32 vcc, s47, v9
    s_add_u32 s70, s70, 1
    s_cbranch_vccz L_spok_29
    s_sleep 2
    s_cmp_lt_u32 s70, 524288
    s_cbranch_scc1 L_spin_28
    s_branch L_c_done_1
L_spok_29:
L_mw_27:
    s_barrier
    s_mov_b32 s46, 20480
    buffer_load_dwordx4 v[16:19], v3, s[12:15], s46 offen offset:0 sc1
    buffer_load_dwordx4 v[20:23], v3, s[12:15], s46 offen offset:16 sc1
    buffer_load_dwordx4 v[24:27], v3, s[12:15], s46 offen offset:2048 sc1
    buffer_load_dwordx4 v[28:31], v3, s[12:15], s46 offen offset:2064 sc1
    buffer_load_dwordx4 v[48:51], v2, s[28:31], 0 offen
    buffer_load_dwordx4 v[52:55], v2, s[28:31], 0 offen offset:1024
    s_waitcnt vmcnt(0)
    v_lshlrev_b32 v32, 16, v48
    v_and_b32 v33, 0xffff0000, v48
    v_lshlrev_b32 v34, 16, v49
    v_and_b32 v35, 0xffff0000, v49
    v_lshlrev_b32 v36, 16, v50
    v_and_b32 v37, 0xffff0000, v50
    v_lshlrev_b32 v38, 16, v51
    v_and_b32 v39, 0xffff0000, v51
    v_lshlrev_b32 v40, 16, v52
    v_and_b32 v41, 0xffff0000, v52
    v_lshlrev_b32 v42, 16, v53
    v_and_b32 v43, 0xffff0000, v53
    v_lshlrev_b32 v44, 16, v54
    v_and_b32 v45, 0xffff0000, v54
    v_lshlrev_b32 v46, 16, v55
    v_and_b32 v47, 0xffff0000, v55
    s_lshl_b32 s46, s42, 14
    s_lshl_b32 s47, s44, 11
    s_add_u32 s46, s46, s47
    s_add_u32 s46, s46, 0xb000000
    v_add_u32 v4, s46, v2
    v_and_b32 v5, 31, v1
    v_lshlrev_b32 v5, 7, v5
    v_add_u32 v5, 0x108400, v5
    v_lshlrev_b32 v6, 2, v1
    s_lshl_b32 s46, s44, 9
    v_add_u32 v6, s46, v6
    s_lshl_b32 s46, s44, 12
    v_add_u32 v7, s46, v3
    s_lshl_b32 s46, s42, 3
    s_add_u32 s46, s46, s44
    s_lshl_b32 s46, s46, 11
    v_add_u32 v8, s46, v2
    v_add_u32 v9, 0x800000, v8
    s_mov_b32 s60, s43
L_r_loop_30:
    s_lshl_b32 s61, s60, 18
    s_lshl_b32 s63, s60, 16
    s_cmp_lg_u32 s44, 0
    s_cbranch_scc1 L_r_nsp_31
    s_mov_b32 s70, 0
L_spin_32:
    buffer_load_dword v14, v5, s[12:15], s76 offen sc1
    s_waitcnt vmcnt(0)
    v_cmp_ge_u32 vcc, s60, v14
    s_add_u32 s70, s70, 1
    s_cbranch_vccz L_spok_33
    s_sleep 3
    s_cmp_lt_u32 s70, 524288
    s_cbranch_scc1 L_spin_32
    s_branch L_c_done_1
L_spok_33:
L_r_nsp_31:
    s_barrier
    buffer_load_dwordx4 v[96:99], v4, s[12:15], s61 offen offset:0 sc1
    buffer_load_dwordx4 v[100:103], v4, s[12:15], s61 offen offset:1024 sc1
    s_add_u32 s61, s61, 65536
    buffer_load_dwordx4 v[104:107], v4, s[12:15], s61 offen offset:0 sc1
    buffer_load_dwordx4 v[108:111], v4, s[12:15], s61 offen offset:1024 sc1
    s_add_u32 s61, s61, 65536
    buffer_load_dwordx4 v[112:115], v4, s[12:15], s61 offen offset:0 sc1
    buffer_load_dwordx4 v[116:119], v4, s[12:15], s61 offen offset:1024 sc1
    s_add_u32 s61, s61, 65536
    buffer_load_dwordx4 v[120:123], v4, s[12:15], s61 offen offset:0 sc1
    buffer_load_dwordx4 v[124:127], v4, s[12:15], s61 offen offset:1024 sc1
    buffer_load_dwordx4 a[0:3], v9, s[12:15], s63 offen sc1
    buffer_load_dwordx4 a[4:7], v9, s[12:15], s63 offen offset:1024 sc1
    s_waitcnt vmcnt(8)
    v_lshlrev_b32 v64, 16, v96
    v_and_b32 v65, 0xffff0000, v96
    v_lshlrev_b32 v66, 16, v97
    v_and_b32 v67, 0xffff0000, v97
    v_lshlrev_b32 v68, 16, v98
    v_and_b32 v69, 0xffff0000, v98
    v_lshlrev_b32 v70, 16, v99
    v_and_b32 v71, 0xffff0000, v99
    v_lshlrev_b32 v72, 16, v100
    v_and_b32 v73, 0xffff0000, v100
    v_lshlrev_b32 v74, 16, v101
    v_and_b32 v75, 0xffff0000, v101
    v_lshlrev_b32 v76, 16, v102
    v_and_b32 v77, 0xffff0000, v102
    v_lshlrev_b32 v78, 16, v103
    v_and_b32 v79, 0xffff0000, v103
    s_waitcnt vmcnt(6)
    v_lshlrev_b32 v14, 16, v104
    v_and_b32 v15, 0xffff0000, v104
    v_pk_add_f32 v[64:65], v[64:65], v[14:15]
    v_lshlrev_b32 v14, 16, v105
    v_and_b32 v15, 0xffff0000, v105
    v_pk_add_f32 v[66:67], v[66:67], v[14:15]
    v_lshlrev_b32 v14, 16, v106
    v_and_b32 v15, 0xffff0000, v106
    v_pk_add_f32 v[68:69], v[68:69], v[14:15]
    v_lshlrev_b32 v14, 16, v107
    v_and_b32 v15, 0xffff0000, v107
    v_pk_add_f32 v[70:71], v[70:71], v[14:15]
    v_lshlrev_b32 v14, 16, v108
    v_and_b32 v15, 0xffff0000, v108
    v_pk_add_f32 v[72:73], v[72:73], v[14:15]
    v_lshlrev_b32 v14, 16, v109
    v_and_b32 v15, 0xffff0000, v109
    v_pk_add_f32 v[74:75], v[74:75], v[14:15]
    v_lshlrev_b32 v14, 16, v110
    v_and_b32 v15, 0xffff0000, v110
    v_pk_add_f32 v[76:77], v[76:77], v[14:15]
    v_lshlrev_b32 v14, 16, v111
    v_and_b32 v15, 0xffff0000, v111
    v_pk_add_f32 v[78:79], v[78:79], v[14:15]
    s_waitcnt vmcnt(4)
    v_lshlrev_b32 v14, 16, v112
    v_and_b32 v15, 0xffff0000, v112
    v_pk_add_f32 v[64:65], v[64:65], v[14:15]
    v_lshlrev_b32 v14, 16, v113
    v_and_b32 v15, 0xffff0000, v113
    v_pk_add_f32 v[66:67], v[66:67], v[14:15]
    v_lshlrev_b32 v14, 16, v114
    v_and_b32 v15, 0xffff0000, v114
    v_pk_add_f32 v[68:69], v[68:69], v[14:15]
    v_lshlrev_b32 v14, 16, v115
    v_and_b32 v15, 0xffff0000, v115
    v_pk_add_f32 v[70:71], v[70:71], v[14:15]
    v_lshlrev_b32 v14, 16, v116
    v_and_b32 v15, 0xffff0000, v116
    v_pk_add_f32 v[72:73], v[72:73], v[14:15]
    v_lshlrev_b32 v14, 16, v117
    v_and_b32 v15, 0xffff0000, v117
    v_pk_add_f32 v[74:75], v[74:75], v[14:15]
    v_lshlrev_b32 v14, 16, v118
    v_and_b32 v15, 0xffff0000, v118
    v_pk_add_f32 v[76:77], v[76:77], v[14:15]
    v_lshlrev_b32 v14, 16, v119
    v_and_b32 v15, 0xffff0000, v119
    v_pk_add_f32 v[78:79], v[78:79], v[14:15]
    s_waitcnt vmcnt(2)
    v_lshlrev_b32 v14, 16, v120
    v_and_b32 v15, 0xffff0000, v120
    v_pk_add_f32 v[64:65], v[64:65], v[14:15]
    v_lshlrev_b32 v14, 16, v121
    v_and_b32 v15, 0xffff0000, v121
    v_pk_add_f32 v[66:67], v[66:67], v[14:15]
    v_lshlrev_b32 v14, 16, v122
    v_and_b32 v15, 0xffff0000, v122
    v_pk_add_f32 v[68:69], v[68:69], v[14:15]
    v_lshlrev_b32 v14, 16, v123
    v_and_b32 v15, 0xffff0000, v123
    v_pk_add_f32 v[70:71], v[70:71], v[14:15]
    v_lshlrev_b32 v14, 16, v124
    v_and_b32 v15, 0xffff0000, v124
    v_pk_add_f32 v[72:73], v[72:73], v[14:15]
    v_lshlrev_b32 v14, 16, v125
    v_and_b32 v15, 0xffff0000, v125
    v_pk_add_f32 v[74:75], v[74:75], v[14:15]
    v_lshlrev_b32 v14, 16, v126
    v_and_b32 v15, 0xffff0000, v126
    v_pk_add_f32 v[76:77], v[76:77], v[14:15]
    v_lshlrev_b32 v14, 16, v127
    v_and_b32 v15, 0xffff0000, v127
    v_pk_add_f32 v[78:79], v[78:79], v[14:15]
    ds_write_b32 v6, v64 offset:0
    ds_write_b32 v6, v65 offset:4096
    ds_write_b32 v6, v66 offset:8192
    ds_write_b32 v6, v67 offset:12288
    ds_write_b32 v6, v68 offset:16384
    ds_write_b32 v6, v69 offset:20480
    ds_write_b32 v6, v70 offset:24576
    ds_write_b32 v6, v71 offset:28672
    ds_write_b32 v6, v72 offset:256
    ds_write_b32 v6, v73 offset:4352
    ds_write_b32 v6, v74 offset:8448
    ds_write_b32 v6, v75 offset:12544
    ds_write_b32 v6, v76 offset:16640
    ds_write_b32 v6, v77 offset:20736
    ds_write_b32 v6, v78 offset:24832
    ds_write_b32 v6, v79 offset:28928
    s_waitcnt lgkmcnt(0)
    s_barrier
    ds_read_b128 v[64:67], v7
    ds_read_b128 v[68:71], v7 offset:16
    ds_read_b128 v[72:75], v7 offset:2048
    ds_read_b128 v[76:79], v7 offset:2064
    s_waitcnt vmcnt(0)
    v_accvgpr_read_b32 v96, a0
    v_accvgpr_read_b32 v97, a1
    v_accvgpr_read_b32 v98, a2
    v_accvgpr_read_b32 v99, a3
    v_accvgpr_read_b32 v100, a4
    v_accvgpr_read_b32 v101, a5
    v_accvgpr_read_b32 v102, a6
    v_accvgpr_read_b32 v103, a7
    v_lshlrev_b32 v80, 16, v96
    v_and_b32 v81, 0xffff0000, v96
    v_lshlrev_b32 v82, 16, v97
    v_and_b32 v83, 0xffff0000, v97
    v_lshlrev_b32 v84, 16, v98
    v_and_b32 v85, 0xffff0000, v98
    v_lshlrev_b32 v86, 16, v99
    v_and_b32 v87, 0xffff0000, v99
    v_lshlrev_b32 v88, 16, v100
    v_and_b32 v89, 0xffff0000, v100
    v_lshlrev_b32 v90, 16, v101
    v_and_b32 v91, 0xffff0000, v101
    v_lshlrev_b32 v92, 16, v102
    v_and_b32 v93, 0xffff0000, v102
    v_lshlrev_b32 v94, 16, v103
    v_and_b32 v95, 0xffff0000, v103
    s_waitcnt lgkmcnt(0)
    v_cvt_pk_bf16_f32 v64, 0, v64
    v_cvt_pk_bf16_f32 v65, 0, v65
    v_cvt_pk_bf16_f32 v66, 0, v66
    v_cvt_pk_bf16_f32 v67, 0, v67
    v_cvt_pk_bf16_f32 v68, 0, v68
    v_cvt_pk_bf16_f32 v69, 0, v69
    v_cvt_pk_bf16_f32 v70, 0, v70
    v_cvt_pk_bf16_f32 v71, 0, v71
    v_cvt_pk_bf16_f32 v72, 0, v72
    v_cvt_pk_bf16_f32 v73, 0, v73
    v_cvt_pk_bf16_f32 v74, 0, v74
    v_cvt_pk_bf16_f32 v75, 0, v75
    v_cvt_pk_bf16_f32 v76, 0, v76
    v_cvt_pk_bf16_f32 v77, 0, v77
    v_cvt_pk_bf16_f32 v78, 0, v78
    v_cvt_pk_bf16_f32 v79, 0, v79
    v_pk_add_f32 v[64:65], v[64:65], v[32:33]
    v_pk_add_f32 v[66:67], v[66:67], v[34:35]
    v_pk_add_f32 v[68:69], v[68:69], v[36:37]
    v_pk_add_f32 v[70:71], v[70:71], v[38:39]
    v_pk_add_f32 v[72:73], v[72:73], v[40:41]
    v_pk_add_f32 v[74:75], v[74:75], v[42:43]
    v_pk_add_f32 v[76:77], v[76:77], v[44:45]
    v_pk_add_f32 v[78:79], v[78:79], v[46:47]
    v_cvt_pk_bf16_f32 v64, 0, v64
    v_cvt_pk_bf16_f32 v65, 0, v65
    v_cvt_pk_bf16_f32 v66, 0, v66
    v_cvt_pk_bf16_f32 v67, 0, v67
    v_cvt_pk_bf16_f32 v68, 0, v68
    v_cvt_pk_bf16_f32 v69, 0, v69
    v_cvt_pk_bf16_f32 v70, 0, v70
    v_cvt_pk_bf16_f32 v71, 0, v71
    v_cvt_pk_bf16_f32 v72, 0, v72
    v_cvt_pk_bf16_f32 v73, 0, v73
    v_cvt_pk_bf16_f32 v74, 0, v74
    v_cvt_pk_bf16_f32 v75, 0, v75
    v_cvt_pk_bf16_f32 v76, 0, v76
    v_cvt_pk_bf16_f32 v77, 0, v77
    v_cvt_pk_bf16_f32 v78, 0, v78
    v_cvt_pk_bf16_f32 v79, 0, v79
    v_pk_mul_f32 v[64:65], v[64:65], v[16:17]
    v_pk_mul_f32 v[66:67], v[66:67], v[18:19]
    v_pk_mul_f32 v[68:69], v[68:69], v[20:21]
    v_pk_mul_f32 v[70:71], v[70:71], v[22:23]
    v_pk_mul_f32 v[72:73], v[72:73], v[24:25]
    v_pk_mul_f32 v[74:75], v[74:75], v[26:27]
    v_pk_mul_f32 v[76:77], v[76:77], v[28:29]
    v_pk_mul_f32 v[78:79], v[78:79], v[30:31]
    v_cvt_pk_bf16_f32 v64, 0, v64
    v_cvt_pk_bf16_f32 v65, 0, v65
    v_cvt_pk_bf16_f32 v66, 0, v66
    v_cvt_pk_bf16_f32 v67, 0, v67
    v_cvt_pk_bf16_f32 v68, 0, v68
    v_cvt_pk_bf16_f32 v69, 0, v69
    v_cvt_pk_bf16_f32 v70, 0, v70
    v_cvt_pk_bf16_f32 v71, 0, v71
    v_cvt_pk_bf16_f32 v72, 0, v72
    v_cvt_pk_bf16_f32 v73, 0, v73
    v_cvt_pk_bf16_f32 v74, 0, v74
    v_cvt_pk_bf16_f32 v75, 0, v75
    v_cvt_pk_bf16_f32 v76, 0, v76
    v_cvt_pk_bf16_f32 v77, 0, v77
    v_cvt_pk_bf16_f32 v78, 0, v78
    v_cvt_pk_bf16_f32 v79, 0, v79
    v_pk_add_f32 v[64:65], v[64:65], v[80:81]
    v_pk_add_f32 v[66:67], v[66:67], v[82:83]
    v_pk_add_f32 v[68:69], v[68:69], v[84:85]
    v_pk_add_f32 v[70:71], v[70:71], v[86:87]
    v_pk_add_f32 v[72:73], v[72:73], v[88:89]
    v_pk_add_f32 v[74:75], v[74:75], v[90:91]
    v_pk_add_f32 v[76:77], v[76:77], v[92:93]
    v_pk_add_f32 v[78:79], v[78:79], v[94:95]
    v_cvt_pk_bf16_f32 v96, v64, v65
    v_cvt_pk_bf16_f32 v97, v66, v67
    v_cvt_pk_bf16_f32 v98, v68, v69
    v_cvt_pk_bf16_f32 v99, v70, v71
    v_cvt_pk_bf16_f32 v100, v72, v73
    v_cvt_pk_bf16_f32 v101, v74, v75
    v_cvt_pk_bf16_f32 v102, v76, v77
    v_cvt_pk_bf16_f32 v103, v78, v79
    buffer_store_dwordx4 v[96:99], v8, s[24:27], s63 offen
    buffer_store_dwordx4 v[100:103], v8, s[24:27], s63 offen offset:1024
    s_add_u32 s60, s60, s78
    s_cmp_lt_u32 s60, s75
    s_cbranch_scc1 L_r_loop_30
    s_branch L_c_done_1
L_w_c_16:
    s_load_dwordx2 s[4:5], s[0:1], 0
    s_load_dwordx2 s[6:7], s[0:1], 88
    v_lshlrev_b32 v2, 4, v1
    v_lshlrev_b32 v3, 5, v1
    s_waitcnt lgkmcnt(0)
    s_mov_b32 s24, s4
    s_and_b32 s25, s5, 0xffff
    s_mov_b32 s26, 0x400000
    s_mov_b32 s27, 0x00020000
    s_mov_b32 s28, s6
    s_and_b32 s29, s7, 0xffff
    s_mov_b32 s30, 0x800
    s_mov_b32 s31, 0x00020000
    s_cmp_lg_u32 s44, 0
    s_cbranch_scc1 L_mw_34
    v_and_b32 v8, 15, v1
    v_lshlrev_b32 v8, 7, v8
    s_mov_b32 s46, 0x10e400
    s_mov_b32 s47, 0
    s_mov_b32 s70, 0
L_spin_35:
    buffer_load_dword v9, v8, s[12:15], s46 offen sc1
    s_waitcnt vmcnt(0)
    v_cmp_ge_u32 vcc, s47, v9
    s_add_u32 s70, s70, 1
    s_cbranch_vccz L_spok_36
    s_sleep 2
    s_cmp_lt_u32 s70, 524288
    s_cbranch_scc1 L_spin_35
    s_branch L_c_done_1
L_spok_36:
L_mw_34:
    s_barrier
    s_mov_b32 s46, 8192
    buffer_load_dwordx4 v[16:19], v3, s[12:15], s46 offen offset:0 sc1
    buffer_load_dwordx4 v[20:23], v3, s[12:15], s46 offen offset:16 sc1
    buffer_load_dwordx4 v[24:27], v3, s[12:15], s46 offen offset:2048 sc1
    buffer_load_dwordx4 v[28:31], v3, s[12:15], s46 offen offset:2064 sc1
    s_mov_b32 s46, 16384
    buffer_load_dwordx4 v[32:35], v3, s[12:15], s46 offen offset:0 sc1
    buffer_load_dwordx4 v[36:39], v3, s[12:15], s46 offen offset:16 sc1
    buffer_load_dwordx4 v[40:43], v3, s[12:15], s46 offen offset:2048 sc1
    buffer_load_dwordx4 v[44:47], v3, s[12:15], s46 offen offset:2064 sc1
    s_mov_b32 s46, 12288
    buffer_load_dwordx4 v[48:51], v3, s[12:15], s46 offen offset:0 sc1
    buffer_load_dwordx4 v[52:55], v3, s[12:15], s46 offen offset:16 sc1
    buffer_load_dwordx4 v[56:59], v3, s[12:15], s46 offen offset:2048 sc1
    buffer_load_dwordx4 v[60:63], v3, s[12:15], s46 offen offset:2064 sc1
    s_waitcnt vmcnt(0)
    v_add_f32 v32, 1.0, v32
    v_add_f32 v33, 1.0, v33
    v_add_f32 v34, 1.0, v34
    v_add_f32 v35, 1.0, v35
    v_add_f32 v36, 1.0, v36
    v_add_f32 v37, 1.0, v37
    v_add_f32 v38, 1.0, v38
    v_add_f32 v39, 1.0, v39
    v_add_f32 v40, 1.0, v40
    v_add_f32 v41, 1.0, v41
    v_add_f32 v42, 1.0, v42
    v_add_f32 v43, 1.0, v43
    v_add_f32 v44, 1.0, v44
    v_add_f32 v45, 1.0, v45
    v_add_f32 v46, 1.0, v46
    v_add_f32 v47, 1.0, v47
    v_cvt_pk_bf16_f32 v32, 0, v32
    v_cvt_pk_bf16_f32 v33, 0, v33
    v_cvt_pk_bf16_f32 v34, 0, v34
    v_cvt_pk_bf16_f32 v35, 0, v35
    v_cvt_pk_bf16_f32 v36, 0, v36
    v_cvt_pk_bf16_f32 v37, 0, v37
    v_cvt_pk_bf16_f32 v38, 0, v38
    v_cvt_pk_bf16_f32 v39, 0, v39
    v_cvt_pk_bf16_f32 v40, 0, v40
    v_cvt_pk_bf16_f32 v41, 0, v41
    v_cvt_pk_bf16_f32 v42, 0, v42
    v_cvt_pk_bf16_f32 v43, 0, v43
    v_cvt_pk_bf16_f32 v44, 0, v44
    v_cvt_pk_bf16_f32 v45, 0, v45
    v_cvt_pk_bf16_f32 v46, 0, v46
    v_cvt_pk_bf16_f32 v47, 0, v47
    s_lshl_b32 s46, s42, 14
    s_lshl_b32 s47, s44, 11
    s_add_u32 s46, s46, s47
    s_add_u32 s46, s46, 0x9000000
    v_add_u32 v4, s46, v2
    v_and_b32 v5, 31, v1
    v_lshlrev_b32 v5, 7, v5
    v_add_u32 v5, 0x107400, v5
    v_lshlrev_b32 v6, 2, v1
    s_lshl_b32 s46, s44, 9
    v_add_u32 v6, s46, v6
    s_lshl_b32 s46, s44, 12
    v_add_u32 v7, s46, v3
    s_lshl_b32 s46, s42, 3
    s_add_u32 s46, s46, s44
    s_lshl_b32 s46, s46, 11
    v_add_u32 v8, s46, v2
    v_add_u32 v9, 0x800000, v8
    s_mul_i32 s46, s44, 2064
    s_add_u32 s46, s46, 32768
    v_add_u32 v10, s46, v2
    v_and_b32 v11, 7, v1
    v_lshrrev_b32 v12, 3, v1
    v_mul_u32_u24 v13, 2064, v11
    v_lshl_add_u32 v13, v12, 4, v13
    s_lshl_b32 s46, s44, 8
    s_add_u32 s46, s46, 32768
    v_add_u32 v13, s46, v13
    v_lshlrev_b32 v11, 4, v11
    v_lshl_add_u32 v11, v12, 9, v11
    s_lshl_b32 s46, s44, 13
    s_lshl_b32 s47, s42, 7
    s_add_u32 s46, s46, s47
    s_add_u32 s46, s46, 0xc00000
    v_add_u32 v11, s46, v11
    v_add_u32 v12, 4096, v11
    s_lshl_b32 s52, s43, 9
    s_lshl_b32 s47, s42, 7
    s_add_u32 s52, s52, s47
    s_add_u32 s52, s52, 0x10ec00
    s_mov_b32 s60, s43
L_r_loop_37:
    s_lshl_b32 s61, s60, 18
    s_lshl_b32 s63, s60, 16
    buffer_load_dwordx4 a[0:3], v8, s[24:27], s63 offen
    buffer_load_dwordx4 a[4:7], v8, s[24:27], s63 offen offset:1024
    s_cmp_lg_u32 s44, 0
    s_cbranch_scc1 L_r_nsp_38
    s_mov_b32 s70, 0
L_spin_39:
    buffer_load_dword v14, v5, s[12:15], 0 offen sc1
    s_waitcnt vmcnt(0)
    v_cmp_ge_u32 vcc, s60, v14
    s_add_u32 s70, s70, 1
    s_cbranch_vccz L_spok_40
    s_sleep 3
    s_cmp_lt_u32 s70, 524288
    s_cbranch_scc1 L_spin_39
    s_branch L_c_done_1
L_spok_40:
L_r_nsp_38:
    s_barrier
    buffer_load_dwordx4 v[96:99], v4, s[12:15], s61 offen offset:0 sc1
    buffer_load_dwordx4 v[100:103], v4, s[12:15], s61 offen offset:1024 sc1
    s_add_u32 s61, s61, 65536
    buffer_load_dwordx4 v[104:107], v4, s[12:15], s61 offen offset:0 sc1
    buffer_load_dwordx4 v[108:111], v4, s[12:15], s61 offen offset:1024 sc1
    s_add_u32 s61, s61, 65536
    buffer_load_dwordx4 v[112:115], v4, s[12:15], s61 offen offset:0 sc1
    buffer_load_dwordx4 v[116:119], v4, s[12:15], s61 offen offset:1024 sc1
    s_add_u32 s61, s61, 65536
    buffer_load_dwordx4 v[120:123], v4, s[12:15], s61 offen offset:0 sc1
    buffer_load_dwordx4 v[124:127], v4, s[12:15], s61 offen offset:1024 sc1
    s_waitcnt vmcnt(8)
    v_accvgpr_read_b32 v64, a0
    v_accvgpr_read_b32 v65, a1
    v_accvgpr_read_b32 v66, a2
    v_accvgpr_read_b32 v67, a3
    v_accvgpr_read_b32 v68, a4
    v_accvgpr_read_b32 v69, a5
    v_accvgpr_read_b32 v70, a6
    v_accvgpr_read_b32 v71, a7
    v_lshlrev_b32 v80, 16, v64
    v_and_b32 v81, 0xffff0000, v64
    v_lshlrev_b32 v82, 16, v65
    v_and_b32 v83, 0xffff0000, v65
    v_lshlrev_b32 v84, 16, v66
    v_and_b32 v85, 0xffff0000, v66
    v_lshlrev_b32 v86, 16, v67
    v_and_b32 v87, 0xffff0000, v67
    v_lshlrev_b32 v88, 16, v68
    v_and_b32 v89, 0xffff0000, v68
    v_lshlrev_b32 v90, 16, v69
    v_and_b32 v91, 0xffff0000, v69
    v_lshlrev_b32 v92, 16, v70
    v_and_b32 v93, 0xffff0000, v70
    v_lshlrev_b32 v94, 16, v71
    v_and_b32 v95, 0xffff0000, v71
    s_waitcnt vmcnt(6)
    v_lshlrev_b32 v64, 16, v96
    v_and_b32 v65, 0xffff0000, v96
    v_lshlrev_b32 v66, 16, v97
    v_and_b32 v67, 0xffff0000, v97
    v_lshlrev_b32 v68, 16, v98
    v_and_b32 v69, 0xffff0000, v98
    v_lshlrev_b32 v70, 16, v99
    v_and_b32 v71, 0xffff0000, v99
    v_lshlrev_b32 v72, 16, v100
    v_and_b32 v73, 0xffff0000, v100
    v_lshlrev_b32 v74, 16, v101
    v_and_b32 v75, 0xffff0000, v101
    v_lshlrev_b32 v76, 16, v102
    v_and_b32 v77, 0xffff0000, v102
    v_lshlrev_b32 v78, 16, v103
    v_and_b32 v79, 0xffff0000, v103
    s_waitcnt vmcnt(4)
    v_lshlrev_b32 v14, 16, v104
    v_and_b32 v15, 0xffff0000, v104
    v_pk_add_f32 v[64:65], v[64:65], v[14:15]
    v_lshlrev_b32 v14, 16, v105
    v_and_b32 v15, 0xffff0000, v105
    v_pk_add_f32 v[66:67], v[66:67], v[14:15]
    v_lshlrev_b32 v14, 16, v106
    v_and_b32 v15, 0xffff0000, v106
    v_pk_add_f32 v[68:69], v[68:69], v[14:15]
    v_lshlrev_b32 v14, 16, v107
    v_and_b32 v15, 0xffff0000, v107
    v_pk_add_f32 v[70:71], v[70:71], v[14:15]
    v_lshlrev_b32 v14, 16, v108
    v_and_b32 v15, 0xffff0000, v108
    v_pk_add_f32 v[72:73], v[72:73], v[14:15]
    v_lshlrev_b32 v14, 16, v109
    v_and_b32 v15, 0xffff0000, v109
    v_pk_add_f32 v[74:75], v[74:75], v[14:15]
    v_lshlrev_b32 v14, 16, v110
    v_and_b32 v15, 0xffff0000, v110
    v_pk_add_f32 v[76:77], v[76:77], v[14:15]
    v_lshlrev_b32 v14, 16, v111
    v_and_b32 v15, 0xffff0000, v111
    v_pk_add_f32 v[78:79], v[78:79], v[14:15]
    s_waitcnt vmcnt(2)
    v_lshlrev_b32 v14, 16, v112
    v_and_b32 v15, 0xffff0000, v112
    v_pk_add_f32 v[64:65], v[64:65], v[14:15]
    v_lshlrev_b32 v14, 16, v113
    v_and_b32 v15, 0xffff0000, v113
    v_pk_add_f32 v[66:67], v[66:67], v[14:15]
    v_lshlrev_b32 v14, 16, v114
    v_and_b32 v15, 0xffff0000, v114
    v_pk_add_f32 v[68:69], v[68:69], v[14:15]
    v_lshlrev_b32 v14, 16, v115
    v_and_b32 v15, 0xffff0000, v115
    v_pk_add_f32 v[70:71], v[70:71], v[14:15]
    v_lshlrev_b32 v14, 16, v116
    v_and_b32 v15, 0xffff0000, v116
    v_pk_add_f32 v[72:73], v[72:73], v[14:15]
    v_lshlrev_b32 v14, 16, v117
    v_and_b32 v15, 0xffff0000, v117
    v_pk_add_f32 v[74:75], v[74:75], v[14:15]
    v_lshlrev_b32 v14, 16, v118
    v_and_b32 v15, 0xffff0000, v118
    v_pk_add_f32 v[76:77], v[76:77], v[14:15]
    v_lshlrev_b32 v14, 16, v119
    v_and_b32 v15, 0xffff0000, v119
    v_pk_add_f32 v[78:79], v[78:79], v[14:15]
    s_waitcnt vmcnt(0)
    v_lshlrev_b32 v14, 16, v120
    v_and_b32 v15, 0xffff0000, v120
    v_pk_add_f32 v[64:65], v[64:65], v[14:15]
    v_lshlrev_b32 v14, 16, v121
    v_and_b32 v15, 0xffff0000, v121
    v_pk_add_f32 v[66:67], v[66:67], v[14:15]
    v_lshlrev_b32 v14, 16, v122
    v_and_b32 v15, 0xffff0000, v122
    v_pk_add_f32 v[68:69], v[68:69], v[14:15]
    v_lshlrev_b32 v14, 16, v123
    v_and_b32 v15, 0xffff0000, v123
    v_pk_add_f32 v[70:71], v[70:71], v[14:15]
    v_lshlrev_b32 v14, 16, v124
    v_and_b32 v15, 0xffff0000, v124
    v_pk_add_f32 v[72:73], v[72:73], v[14:15]
    v_lshlrev_b32 v14, 16, v125
    v_and_b32 v15, 0xffff0000, v125
    v_pk_add_f32 v[74:75], v[74:75], v[14:15]
    v_lshlrev_b32 v14, 16, v126
    v_and_b32 v15, 0xffff0000, v126
    v_pk_add_f32 v[76:77], v[76:77], v[14:15]
    v_lshlrev_b32 v14, 16, v127
    v_and_b32 v15, 0xffff0000, v127
    v_pk_add_f32 v[78:79], v[78:79], v[14:15]
    ds_write_b32 v6, v64 offset:0
    ds_write_b32 v6, v65 offset:4096
    ds_write_b32 v6, v66 offset:8192
    ds_write_b32 v6, v67 offset:12288
    ds_write_b32 v6, v68 offset:16384
    ds_write_b32 v6, v69 offset:20480
    ds_write_b32 v6, v70 offset:24576
    ds_write_b32 v6, v71 offset:28672
    ds_write_b32 v6, v72 offset:256
    ds_write_b32 v6, v73 offset:4352
    ds_write_b32 v6, v74 offset:8448
    ds_write_b32 v6, v75 offset:12544
    ds_write_b32 v6, v76 offset:16640
    ds_write_b32 v6, v77 offset:20736
    ds_write_b32 v6, v78 offset:24832
    ds_write_b32 v6, v79 offset:28928
    s_waitcnt lgkmcnt(0)
    s_barrier
    ds_read_b128 v[64:67], v7
    ds_read_b128 v[68:71], v7 offset:16
    ds_read_b128 v[72:75], v7 offset:2048
    ds_read_b128 v[76:79], v7 offset:2064
    s_waitcnt vmcnt(0)
    s_waitcnt lgkmcnt(0)
    v_cvt_pk_bf16_f32 v64, 0, v64
    v_cvt_pk_bf16_f32 v65, 0, v65
    v_cvt_pk_bf16_f32 v66, 0, v66
    v_cvt_pk_bf16_f32 v67, 0, v67
    v_cvt_pk_bf16_f32 v68, 0, v68
    v_cvt_pk_bf16_f32 v69, 0, v69
    v_cvt_pk_bf16_f32 v70, 0, v70
    v_cvt_pk_bf16_f32 v71, 0, v71
    v_cvt_pk_bf16_f32 v72, 0, v72
    v_cvt_pk_bf16_f32 v73, 0, v73
    v_cvt_pk_bf16_f32 v74, 0, v74
    v_cvt_pk_bf16_f32 v75, 0, v75
    v_cvt_pk_bf16_f32 v76, 0, v76
    v_cvt_pk_bf16_f32 v77, 0, v77
    v_cvt_pk_bf16_f32 v78, 0, v78
    v_cvt_pk_bf16_f32 v79, 0, v79
    v_pk_mul_f32 v[64:65], v[64:65], v[16:17]
    v_pk_mul_f32 v[66:67], v[66:67], v[18:19]
    v_pk_mul_f32 v[68:69], v[68:69], v[20:21]
    v_pk_mul_f32 v[70:71], v[70:71], v[22:23]
    v_pk_mul_f32 v[72:73], v[72:73], v[24:25]
    v_pk_mul_f32 v[74:75], v[74:75], v[26:27]
    v_pk_mul_f32 v[76:77], v[76:77], v[28:29]
    v_pk_mul_f32 v[78:79], v[78:79], v[30:31]
    v_cvt_pk_bf16_f32 v64, 0, v64
    v_cvt_pk_bf16_f32 v65, 0, v65
    v_cvt_pk_bf16_f32 v66, 0, v66
    v_cvt_pk_bf16_f32 v67, 0, v67
    v_cvt_pk_bf16_f32 v68, 0, v68
    v_cvt_pk_bf16_f32 v69, 0, v69
    v_cvt_pk_bf16_f32 v70, 0, v70
    v_cvt_pk_bf16_f32 v71, 0, v71
    v_cvt_pk_bf16_f32 v72, 0, v72
    v_cvt_pk_bf16_f32 v73, 0, v73
    v_cvt_pk_bf16_f32 v74, 0, v74
    v_cvt_pk_bf16_f32 v75, 0, v75
    v_cvt_pk_bf16_f32 v76, 0, v76
    v_cvt_pk_bf16_f32 v77, 0, v77
    v_cvt_pk_bf16_f32 v78, 0, v78
    v_cvt_pk_bf16_f32 v79, 0, v79
    v_pk_add_f32 v[64:65], v[64:65], v[80:81]
    v_pk_add_f32 v[66:67], v[66:67], v[82:83]
    v_pk_add_f32 v[68:69], v[68:69], v[84:85]
    v_pk_add_f32 v[70:71], v[70:71], v[86:87]
    v_pk_add_f32 v[72:73], v[72:73], v[88:89]
    v_pk_add_f32 v[74:75], v[74:75], v[90:91]
    v_pk_add_f32 v[76:77], v[76:77], v[92:93]
    v_pk_add_f32 v[78:79], v[78:79], v[94:95]
    v_cvt_pk_bf16_f32 v96, v64, v65
    v_cvt_pk_bf16_f32 v97, v66, v67
    v_cvt_pk_bf16_f32 v98, v68, v69
    v_cvt_pk_bf16_f32 v99, v70, v71
    v_cvt_pk_bf16_f32 v100, v72, v73
    v_cvt_pk_bf16_f32 v101, v74, v75
    v_cvt_pk_bf16_f32 v102, v76, v77
    v_cvt_pk_bf16_f32 v103, v78, v79
    buffer_store_dwordx4 v[96:99], v9, s[12:15], s63 offen sc1
    buffer_store_dwordx4 v[100:103], v9, s[12:15], s63 offen offset:1024 sc1
    v_lshlrev_b32 v64, 16, v96
    v_and_b32 v65, 0xffff0000, v96
    v_lshlrev_b32 v66, 16, v97
    v_and_b32 v67, 0xffff0000, v97
    v_lshlrev_b32 v68, 16, v98
    v_and_b32 v69, 0xffff0000, v98
    v_lshlrev_b32 v70, 16, v99
    v_and_b32 v71, 0xffff0000, v99
    v_lshlrev_b32 v72, 16, v100
    v_and_b32 v73, 0xffff0000, v100
    v_lshlrev_b32 v74, 16, v101
    v_and_b32 v75, 0xffff0000, v101
    v_lshlrev_b32 v76, 16, v102
    v_and_b32 v77, 0xffff0000, v102
    v_lshlrev_b32 v78, 16, v103
    v_and_b32 v79, 0xffff0000, v103
    v_pk_add_f32 v[80:81], v[64:65], v[72:73]
    v_pk_add_f32 v[82:83], v[66:67], v[74:75]
    v_pk_add_f32 v[84:85], v[68:69], v[76:77]
    v_pk_add_f32 v[86:87], v[70:71], v[78:79]
    v_pk_add_f32 v[80:81], v[80:81], v[84:85]
    v_pk_add_f32 v[82:83], v[82:83], v[86:87]
    v_pk_add_f32 v[80:81], v[80:81], v[82:83]
    v_add_f32 v14, v80, v81
    s_nop 1
    v_add_f32_dpp v14, v14, v14 row_shr:1 row_mask:0xf bank_mask:0xf bound_ctrl:0
    s_nop 1
    v_add_f32_dpp v14, v14, v14 row_shr:2 row_mask:0xf bank_mask:0xf bound_ctrl:0
    s_nop 1
    v_add_f32_dpp v14, v14, v14 row_shr:4 row_mask:0xf bank_mask:0xf bound_ctrl:0
    s_nop 1
    v_add_f32_dpp v14, v14, v14 row_shr:8 row_mask:0xf bank_mask:0xf bound_ctrl:0
    s_nop 1
    v_add_f32_dpp v14, v14, v14 row_bcast:15 row_mask:0xa bank_mask:0xf
    s_nop 1
    v_add_f32_dpp v14, v14, v14 row_bcast:31 row_mask:0xc bank_mask:0xf
    s_nop 1
    v_readlane_b32 s46, v14, 63
    s_nop 1
    v_mov_b32 v15, s46
    v_mul_f32 v15, 0x3a800000, v15
    v_pk_add_f32 v[80:81], v[64:65], v[14:15] op_sel:[0,1] op_sel_hi:[1,1] neg_lo:[0,1] neg_hi:[0,1]
    v_pk_add_f32 v[82:83], v[66:67], v[14:15] op_sel:[0,1] op_sel_hi:[1,1] neg_lo:[0,1] neg_hi:[0,1]
    v_pk_add_f32 v[84:85], v[68:69], v[14:15] op_sel:[0,1] op_sel_hi:[1,1] neg_lo:[0,1] neg_hi:[0,1]
    v_pk_add_f32 v[86:87], v[70:71], v[14:15] op_sel:[0,1] op_sel_hi:[1,1] neg_lo:[0,1] neg_hi:[0,1]
    v_pk_add_f32 v[88:89], v[72:73], v[14:15] op_sel:[0,1] op_sel_hi:[1,1] neg_lo:[0,1] neg_hi:[0,1]
    v_pk_add_f32 v[90:91], v[74:75], v[14:15] op_sel:[0,1] op_sel_hi:[1,1] neg_lo:[0,1] neg_hi:[0,1]
    v_pk_add_f32 v[92:93], v[76:77], v[14:15] op_sel:[0,1] op_sel_hi:[1,1] neg_lo:[0,1] neg_hi:[0,1]
    v_pk_add_f32 v[94:95], v[78:79], v[14:15] op_sel:[0,1] op_sel_hi:[1,1] neg_lo:[0,1] neg_hi:[0,1]
    v_pk_mul_f32 v[104:105], v[80:81], v[80:81]
    v_pk_mul_f32 v[106:107], v[82:83], v[82:83]
    v_pk_fma_f32 v[104:105], v[84:85], v[84:85], v[104:105]
    v_pk_fma_f32 v[106:107], v[86:87], v[86:87], v[106:107]
    v_pk_fma_f32 v[104:105], v[88:89], v[88:89], v[104:105]
    v_pk_fma_f32 v[106:107], v[90:91], v[90:91], v[106:107]
    v_pk_fma_f32 v[104:105], v[92:93], v[92:93], v[104:105]
    v_pk_fma_f32 v[106:107], v[94:95], v[94:95], v[106:107]
    v_pk_add_f32 v[104:105], v[104:105], v[106:107]
    v_add_f32 v14, v104, v105
    v_cvt_pk_bf16_f32 v15, 0, v15
    s_nop 1
    v_add_f32_dpp v14, v14, v14 row_shr:1 row_mask:0xf bank_mask:0xf bound_ctrl:0
    s_nop 1
    v_add_f32_dpp v14, v14, v14 row_shr:2 row_mask:0xf bank_mask:0xf bound_ctrl:0
    s_nop 1
    v_add_f32_dpp v14, v14, v14 row_shr:4 row_mask:0xf bank_mask:0xf bound_ctrl:0
    s_nop 1
    v_add_f32_dpp v14, v14, v14 row_shr:8 row_mask:0xf bank_mask:0xf bound_ctrl:0
    s_nop 1
    v_add_f32_dpp v14, v14, v14 row_bcast:15 row_mask:0xa bank_mask:0xf
    s_nop 1
    v_add_f32_dpp v14, v14, v14 row_bcast:31 row_mask:0xc bank_mask:0xf
    s_nop 1
    v_readlane_b32 s47, v14, 63
    v_pk_add_f32 v[64:65], v[64:65], v[14:15] op_sel:[0,1] op_sel_hi:[1,1] neg_lo:[0,1] neg_hi:[0,1]
    v_pk_add_f32 v[66:67], v[66:67], v[14:15] op_sel:[0,1] op_sel_hi:[1,1] neg_lo:[0,1] neg_hi:[0,1]
    v_pk_add_f32 v[68:69], v[68:69], v[14:15] op_sel:[0,1] op_sel_hi:[1,1] neg_lo:[0,1] neg_hi:[0,1]
    v_pk_add_f32 v[70:71], v[70:71], v[14:15] op_sel:[0,1] op_sel_hi:[1,1] neg_lo:[0,1] neg_hi:[0,1]
    v_pk_add_f32 v[72:73], v[72:73], v[14:15] op_sel:[0,1] op_sel_hi:[1,1] neg_lo:[0,1] neg_hi:[0,1]
    v_pk_add_f32 v[74:75], v[74:75], v[14:15] op_sel:[0,1] op_sel_hi:[1,1] neg_lo:[0,1] neg_hi:[0,1]
    v_pk_add_f32 v[76:77], v[76:77], v[14:15] op_sel:[0,1] op_sel_hi:[1,1] neg_lo:[0,1] neg_hi:[0,1]
    v_pk_add_f32 v[78:79], v[78:79], v[14:15] op_sel:[0,1] op_sel_hi:[1,1] neg_lo:[0,1] neg_hi:[0,1]
    v_mov_b32 v14, s47
    v_mul_f32 v14, 0x3a800000, v14
    v_cvt_pk_bf16_f32 v14, 0, v14
    v_add_f32 v14, 0x3727c5ac, v14
    v_cvt_pk_bf16_f32 v14, 0, v14
    v_sqrt_f32 v14, v14
    s_nop 0
    v_cvt_pk_bf16_f32 v14, 0, v14
    v_rcp_f32 v14, v14
    v_cvt_pk_bf16_f32 v64, 0, v64
    v_cvt_pk_bf16_f32 v65, 0, v65
    v_cvt_pk_bf16_f32 v66, 0, v66
    v_cvt_pk_bf16_f32 v67, 0, v67
    v_cvt_pk_bf16_f32 v68, 0, v68
    v_cvt_pk_bf16_f32 v69, 0, v69
    v_cvt_pk_bf16_f32 v70, 0, v70
    v_cvt_pk_bf16_f32 v71, 0, v71
    v_cvt_pk_bf16_f32 v72, 0, v72
    v_cvt_pk_bf16_f32 v73, 0, v73
    v_cvt_pk_bf16_f32 v74, 0, v74
    v_cvt_pk_bf16_f32 v75, 0, v75
    v_cvt_pk_bf16_f32 v76, 0, v76
    v_cvt_pk_bf16_f32 v77, 0, v77
    v_cvt_pk_bf16_f32 v78, 0, v78
    v_cvt_pk_bf16_f32 v79, 0, v79
    v_pk_mul_f32 v[64:65], v[64:65], v[14:15] op_sel_hi:[1,0]
    v_pk_mul_f32 v[66:67], v[66:67], v[14:15] op_sel_hi:[1,0]
    v_pk_mul_f32 v[68:69], v[68:69], v[14:15] op_sel_hi:[1,0]
    v_pk_mul_f32 v[70:71], v[70:71], v[14:15] op_sel_hi:[1,0]
    v_pk_mul_f32 v[72:73], v[72:73], v[14:15] op_sel_hi:[1,0]
    v_pk_mul_f32 v[74:75], v[74:75], v[14:15] op_sel_hi:[1,0]
    v_pk_mul_f32 v[76:77], v[76:77], v[14:15] op_sel_hi:[1,0]
    v_pk_mul_f32 v[78:79], v[78:79], v[14:15] op_sel_hi:[1,0]
    v_cvt_pk_bf16_f32 v64, 0, v64
    v_cvt_pk_bf16_f32 v65, 0, v65
    v_cvt_pk_bf16_f32 v66, 0, v66
    v_cvt_pk_bf16_f32 v67, 0, v67
    v_cvt_pk_bf16_f32 v68, 0, v68
    v_cvt_pk_bf16_f32 v69, 0, v69
    v_cvt_pk_bf16_f32 v70, 0, v70
    v_cvt_pk_bf16_f32 v71, 0, v71
    v_cvt_pk_bf16_f32 v72, 0, v72
    v_cvt_pk_bf16_f32 v73, 0, v73
    v_cvt_pk_bf16_f32 v74, 0, v74
    v_cvt_pk_bf16_f32 v75, 0, v75
    v_cvt_pk_bf16_f32 v76, 0, v76
    v_cvt_pk_bf16_f32 v77, 0, v77
    v_cvt_pk_bf16_f32 v78, 0, v78
    v_cvt_pk_bf16_f32 v79, 0, v79
    v_pk_mul_f32 v[64:65], v[64:65], v[32:33]
    v_pk_mul_f32 v[66:67], v[66:67], v[34:35]
    v_pk_mul_f32 v[68:69], v[68:69], v[36:37]
    v_pk_mul_f32 v[70:71], v[70:71], v[38:39]
    v_pk_mul_f32 v[72:73], v[72:73], v[40:41]
    v_pk_mul_f32 v[74:75], v[74:75], v[42:43]
    v_pk_mul_f32 v[76:77], v[76:77], v[44:45]
    v_pk_mul_f32 v[78:79], v[78:79], v[46:47]
    v_cvt_pk_bf16_f32 v64, 0, v64
    v_cvt_pk_bf16_f32 v65, 0, v65
    v_cvt_pk_bf16_f32 v66, 0, v66
    v_cvt_pk_bf16_f32 v67, 0, v67
    v_cvt_pk_bf16_f32 v68, 0, v68
    v_cvt_pk_bf16_f32 v69, 0, v69
    v_cvt_pk_bf16_f32 v70, 0, v70
    v_cvt_pk_bf16_f32 v71, 0, v71
    v_cvt_pk_bf16_f32 v72, 0, v72
    v_cvt_pk_bf16_f32 v73, 0, v73
    v_cvt_pk_bf16_f32 v74, 0, v74
    v_cvt_pk_bf16_f32 v75, 0, v75
    v_cvt_pk_bf16_f32 v76, 0, v76
    v_cvt_pk_bf16_f32 v77, 0, v77
    v_cvt_pk_bf16_f32 v78, 0, v78
    v_cvt_pk_bf16_f32 v79, 0, v79
    v_pk_add_f32 v[64:65], v[64:65], v[48:49]
    v_pk_add_f32 v[66:67], v[66:67], v[50:51]
    v_pk_add_f32 v[68:69], v[68:69], v[52:53]
    v_pk_add_f32 v[70:71], v[70:71], v[54:55]
    v_pk_add_f32 v[72:73], v[72:73], v[56:57]
    v_pk_add_f32 v[74:75], v[74:75], v[58:59]
    v_pk_add_f32 v[76:77], v[76:77], v[60:61]
    v_pk_add_f32 v[78:79], v[78:79], v[62:63]
    v_cvt_pk_bf16_f32 v104, v64, v65
    v_cvt_pk_bf16_f32 v105, v66, v67
    v_cvt_pk_bf16_f32 v106, v68, v69
    v_cvt_pk_bf16_f32 v107, v70, v71
    v_cvt_pk_bf16_f32 v108, v72, v73
    v_cvt_pk_bf16_f32 v109, v74, v75
    v_cvt_pk_bf16_f32 v110, v76, v77
    v_cvt_pk_bf16_f32 v111, v78, v79
    ds_write_b128 v10, v[104:107]
    ds_write_b128 v10, v[108:111] offset:1024
    s_waitcnt lgkmcnt(0)
    s_barrier
    ds_read_b128 v[104:107], v13
    ds_read_b128 v[108:111], v13 offset:128
    s_waitcnt lgkmcnt(1)
    buffer_store_dwordx4 v[104:107], v11, s[12:15], s63 offen sc1
    s_waitcnt lgkmcnt(0)
    buffer_store_dwordx4 v[108:111], v12, s[12:15], s63 offen sc1
    s_waitcnt vmcnt(0)
    s_barrier
    s_cmp_lg_u32 s44, 0
    s_cbranch_scc1 L_sf_41
    v_mov_b32 v14, s60
    v_add_u32 v14, 1, v14
    v_mov_b32 v15, 0
    s_mov_b64 exec, 1
    buffer_store_dword v14, v15, s[12:15], s52 offen sc1
    s_mov_b64 exec, -1
L_sf_41:
    s_add_u32 s60, s60, 3
    s_cmp_lt_u32 s60, 64
    s_cbranch_scc1 L_r_loop_37
    s_branch L_c_done_1
L_w_att_15:
    s_lshl_b32 s42, s40, 2
    s_and_b32 s46, s44, 3
    s_add_u32 s42, s42, s46
    s_and_b32 s43, s48, 1
    s_lshl_b32 s43, s43, 1
    s_lshr_b32 s46, s44, 2
    s_add_u32 s43, s43, s46
    s_mul_i32 s46, s42, 24576
    s_add_u32 s46, s46, 0x2000000
    v_lshlrev_b32 v2, 4, v1
    v_add_u32 v3, s46, v2
    v_add_u32 v5, 4096, v3
    v_lshrrev_b32 v4, 4, v1
    v_and_b32 v9, 15, v1
    s_lshl_b32 s46, s42, 12
    s_add_u32 s46, s46, 0x1000000
    v_and_b32 v6, 7, v1
    v_lshlrev_b32 v6, 4, v6
    v_lshl_add_u32 v6, v4, 7, v6
    v_add_u32 v6, s46, v6
    v_and_b32 v7, 31, v1
    v_lshlrev_b32 v7, 4, v7
    v_lshrrev_b32 v10, 5, v1
    v_lshl_add_u32 v7, v10, 10, v7
    v_add_u32 v7, s46, v7
    s_mul_i32 s50, s44, 13056
    v_mul_u32_u24 v8, 272, v9
    v_lshl_add_u32 v8, v4, 4, v8
    v_add_u32 v8, s50, v8
    v_bfe_u32 v11, v1, 2, 3
    v_mul_u32_u24 v11, 272, v11
    v_lshl_add_u32 v11, v10, 6, v11
    v_and_b32 v12, 3, v1
    v_lshl_add_u32 v11, v12, 4, v11
    v_add_u32 v11, s50, v11
    v_mul_u32_u24 v14, 272, v4
    v_lshl_add_u32 v14, v9, 4, v14
    v_add_u32 v14, s50, v14
    v_mov_b32 v16, 0
    v_mov_b32 v17, 0
    v_mov_b32 v18, 0
    v_mov_b32 v19, 0
    ds_write_b128 v14, v[16:19] offset:10880
    ds_write_b128 v14, v[16:19] offset:11968
    v_lshlrev_b32 v12, 2, v4
    v_bfe_u32 v13, v1, 2, 2
    v_add_u32 v12, v12, v13
    v_mul_u32_u24 v12, 272, v12
    v_and_b32 v13, 3, v1
    v_lshl_add_u32 v12, v13, 3, v12
    v_add_u32 v12, s50, v12
    v_lshlrev_b32 v13, 10, v13
    s_lshl_b32 s46, s42, 12
    s_add_u32 s46, s46, 0x1000000
    v_add_u32 v13, s46, v13
    v_lshlrev_b32 v10, 9, v4
    v_lshl_add_u32 v10, v9, 4, v10
    s_lshl_b32 s46, s42, 13
    s_add_u32 s46, s46, 0x5000000
    v_add_u32 v10, s46, v10
    s_lshl_b32 s52, s42, 9
    s_lshl_b32 s47, s43, 7
    s_add_u32 s52, s52, s47
    s_add_u32 s52, s52, 0x102000
    v_min_u32 v42, 2, v1
    v_lshlrev_b32 v42, 9, v42
    s_lshl_b32 s46, s40, 11
    s_and_b32 s47, s42, 3
    s_lshl_b32 s47, s47, 7
    s_add_u32 s46, s46, s47
    s_add_u32 s46, s46, 0x10a400
    v_add_u32 v48, s46, v42
    s_mul_i32 s46, s42, 24576
    s_add_u32 s46, s46, 0x2000000
    v_lshlrev_b32 v49, 7, v1
    v_add_u32 v49, s46, v49
    v_cmp_le_u32 s[56:57], 32, v1
    v_lshlrev_b32 v14, 2, v4
    s_mov_b32 s54, 0x3e0293ee
    s_mov_b32 s60, s43
    v_add_u32 v15, 0, v14
    v_cmp_gt_u32 s[84:85], v15, v9
    v_add_u32 v15, 1, v14
    v_cmp_gt_u32 s[86:87], v15, v9
    v_add_u32 v15, 2, v14
    v_cmp_gt_u32 s[88:89], v15, v9
    v_add_u32 v15, 3, v14
    v_cmp_gt_u32 s[90:91], v15, v9
L_a_loop_42:
    s_mul_i32 s45, s60, 786432
    s_add_u32 s48, s45, 8192
    s_add_u32 s49, s45, 16384
    s_lshl_b32 s61, s60, 17
    s_lshl_b32 s63, s60, 18
    s_mov_b32 s70, 0
L_spin_43:
    buffer_load_dword v40, v48, s[12:15], 0 offen sc1
    s_waitcnt vmcnt(0)
    v_cmp_ge_u32 vcc, s60, v40
    s_add_u32 s70, s70, 1
    s_cbranch_vccz L_spok_44
    s_sleep 3
    s_cmp_lt_u32 s70, 524288
    s_cbranch_scc1 L_spin_43
    s_branch L_c_done_1
L_spok_44:
    buffer_load_dwordx4 a[0:3], v3, s[12:15], s45 offen offset:0 sc1
    buffer_load_dwordx4 a[4:7], v3, s[12:15], s45 offen offset:1024 sc1
    buffer_load_dwordx4 a[8:11], v3, s[12:15], s45 offen offset:2048 sc1
    buffer_load_dwordx4 a[12:15], v3, s[12:15], s45 offen offset:3072 sc1
    buffer_load_dwordx4 a[16:19], v5, s[12:15], s45 offen offset:0 sc1
    buffer_load_dwordx4 a[20:23], v5, s[12:15], s45 offen offset:1024 sc1
    buffer_load_dwordx4 a[24:27], v5, s[12:15], s45 offen offset:2048 sc1
    buffer_load_dwordx4 a[28:31], v5, s[12:15], s45 offen offset:3072 sc1
    buffer_load_dwordx4 a[32:35], v3, s[12:15], s48 offen offset:0 sc1
    buffer_load_dwordx4 a[36:39], v3, s[12:15], s48 offen offset:1024 sc1
    buffer_load_dwordx4 a[40:43], v3, s[12:15], s48 offen offset:2048 sc1
    buffer_load_dwordx4 a[44:47], v3, s[12:15], s48 offen offset:3072 sc1
    buffer_load_dwordx4 a[48:51], v5, s[12:15], s48 offen offset:0 sc1
    buffer_load_dwordx4 a[52:55], v5, s[12:15], s48 offen offset:1024 sc1
    buffer_load_dwordx4 a[56:59], v5, s[12:15], s48 offen offset:2048 sc1
    buffer_load_dwordx4 a[60:63], v5, s[12:15], s48 offen offset:3072 sc1
    buffer_load_dwordx4 v[16:19], v3, s[12:15], s49 offen offset:0 sc1
    buffer_load_dwordx4 v[20:23], v3, s[12:15], s49 offen offset:1024 sc1
    buffer_load_dwordx4 v[24:27], v3, s[12:15], s49 offen offset:2048 sc1
    buffer_load_dwordx4 v[28:31], v3, s[12:15], s49 offen offset:3072 sc1
    buffer_load_dwordx4 v[32:35], v5, s[12:15], s49 offen offset:0 sc1
    buffer_load_dwordx4 v[36:39], v5, s[12:15], s49 offen offset:1024 sc1
    buffer_load_dwordx4 v[40:43], v5, s[12:15], s49 offen offset:2048 sc1
    buffer_load_dwordx4 v[44:47], v5, s[12:15], s49 offen offset:3072 sc1
    s_waitcnt vmcnt(0)
    ds_write_b128 v8, v[16:19] offset:0
    ds_write_b128 v8, v[20:23] offset:64
    ds_write_b128 v8, v[24:27] offset:128
    ds_write_b128 v8, v[28:31] offset:192
    ds_write_b128 v8, v[32:35] offset:4352
    ds_write_b128 v8, v[36:39] offset:4416
    ds_write_b128 v8, v[40:43] offset:4480
    ds_write_b128 v8, v[44:47] offset:4544
    v_mfma_f32_16x16x32_bf16 v[56:59], a[32:35], a[0:3], 0
    v_mfma_f32_16x16x32_bf16 v[60:63], a[32:35], a[16:19], 0
    v_mfma_f32_16x16x32_bf16 v[68:71], a[48:51], a[16:19], 0
    v_mfma_f32_16x16x32_bf16 v[56:59], a[36:39], a[4:7], v[56:59]
    v_mfma_f32_16x16x32_bf16 v[60:63], a[36:39], a[20:23], v[60:63]
    v_mfma_f32_16x16x32_bf16 v[68:71], a[52:55], a[20:23], v[68:71]
    v_mfma_f32_16x16x32_bf16 v[56:59], a[40:43], a[8:11], v[56:59]
    v_mfma_f32_16x16x32_bf16 v[60:63], a[40:43], a[24:27], v[60:63]
    v_mfma_f32_16x16x32_bf16 v[68:71], a[56:59], a[24:27], v[68:71]
    v_mfma_f32_16x16x32_bf16 v[56:59], a[44:47], a[12:15], v[56:59]
    v_mfma_f32_16x16x32_bf16 v[60:63], a[44:47], a[28:31], v[60:63]
    v_mfma_f32_16x16x32_bf16 v[68:71], a[60:63], a[28:31], v[68:71]
    s_waitcnt lgkmcnt(0)
    ds_read_b64_tr_b16 a[80:81], v12 offset:0
    ds_read_b64_tr_b16 a[82:83], v12 offset:4352
    ds_read_b64_tr_b16 a[86:87], v12 offset:32
    ds_read_b64_tr_b16 a[88:89], v12 offset:4384
    ds_read_b64_tr_b16 a[92:93], v12 offset:64
    ds_read_b64_tr_b16 a[94:95], v12 offset:4416
    ds_read_b64_tr_b16 a[98:99], v12 offset:96
    ds_read_b64_tr_b16 a[100:101], v12 offset:4448
    s_waitcnt lgkmcnt(0)
    ds_read_b64_tr_b16 a[104:105], v12 offset:128
    ds_read_b64_tr_b16 a[106:107], v12 offset:4480
    ds_read_b64_tr_b16 a[110:111], v12 offset:160
    ds_read_b64_tr_b16 a[112:113], v12 offset:4512
    ds_read_b64_tr_b16 a[116:117], v12 offset:192
    ds_read_b64_tr_b16 a[118:119], v12 offset:4544
    ds_read_b64_tr_b16 a[122:123], v12 offset:224
    ds_read_b64_tr_b16 a[124:125], v12 offset:4576
    v_mov_b32 v15, 0xff800000
    v_cndmask_b32 v56, v56, v15, s[84:85]
    v_cndmask_b32 v68, v68, v15, s[84:85]
    v_cndmask_b32 v57, v57, v15, s[86:87]
    v_cndmask_b32 v69, v69, v15, s[86:87]
    v_cndmask_b32 v58, v58, v15, s[88:89]
    v_cndmask_b32 v70, v70, v15, s[88:89]
    v_cndmask_b32 v59, v59, v15, s[90:91]
    v_cndmask_b32 v71, v71, v15, s[90:91]
    s_mov_b32 s70, 0
L_a_cp_45:
    s_add_u32 s70, s70, 1
    s_cmp_ge_u32 s60, 63
    s_cbranch_scc1 L_a_fl_46
    buffer_load_dword v40, v13, s[12:15], s61 offen sc1
    s_waitcnt vmcnt(0)
    v_cmp_eq_u32 vcc, -1, v40
    s_add_u32 s70, s70, 1
    s_cbranch_vccz L_a_fl_46
L_a_cp_45_s:
    s_sleep 4
    s_cmp_lt_u32 s70, 524288
    s_cbranch_scc1 L_a_cp_45
    s_branch L_c_done_1
L_a_fl_46:
    buffer_load_dwordx4 v[24:27], v6, s[12:15], s61 offen offset:0 sc1
    buffer_load_dwordx4 v[28:31], v6, s[12:15], s61 offen offset:1024 sc1
    buffer_load_dwordx4 v[32:35], v6, s[12:15], s61 offen offset:2048 sc1
    buffer_load_dwordx4 v[36:39], v6, s[12:15], s61 offen offset:3072 sc1
    buffer_load_dwordx4 v[16:19], v7, s[12:15], s61 offen offset:512 sc1
    buffer_load_dwordx4 v[20:23], v7, s[12:15], s61 offen offset:2560 sc1
    s_waitcnt vmcnt(0)
    v_max_u32 v40, v16, v17
    v_max3_u32 v40, v40, v18, v19
    v_max3_u32 v40, v40, v20, v21
    v_max3_u32 v40, v40, v22, v23
    v_max3_u32 v40, v40, v24, v25
    v_max3_u32 v40, v40, v26, v27
    v_max3_u32 v40, v40, v28, v29
    v_max3_u32 v40, v40, v30, v31
    v_max3_u32 v40, v40, v32, v33
    v_max3_u32 v40, v40, v34, v35
    v_max3_u32 v40, v40, v36, v37
    v_max3_u32 v40, v40, v38, v39
    v_cmp_eq_u32 vcc, -1, v40
    s_nop 0
    s_cbranch_vccnz L_a_cp_45_s
    v_mfma_f32_16x16x32_bf16 v[72:75], v[24:27], a[0:3], 0
    v_mfma_f32_16x16x32_bf16 v[76:79], v[24:27], a[16:19], 0
    v_mfma_f32_16x16x32_bf16 v[72:75], v[28:31], a[4:7], v[72:75]
    v_mfma_f32_16x16x32_bf16 v[76:79], v[28:31], a[20:23], v[76:79]
    v_mfma_f32_16x16x32_bf16 v[72:75], v[32:35], a[8:11], v[72:75]
    v_mfma_f32_16x16x32_bf16 v[76:79], v[32:35], a[24:27], v[76:79]
    v_mfma_f32_16x16x32_bf16 v[72:75], v[36:39], a[12:15], v[72:75]
    v_mfma_f32_16x16x32_bf16 v[76:79], v[36:39], a[28:31], v[76:79]
    ds_write_b128 v11, v[16:19] offset:8704
    ds_write_b128 v11, v[20:23] offset:8832
    s_waitcnt lgkmcnt(0)
    ds_read_b64_tr_b16 a[84:85], v12 offset:8704
    ds_read_b64_tr_b16 a[90:91], v12 offset:8736
    ds_read_b64_tr_b16 a[96:97], v12 offset:8768
    ds_read_b64_tr_b16 a[102:103], v12 offset:8800
    ds_read_b64_tr_b16 a[108:109], v12 offset:8832
    ds_read_b64_tr_b16 a[114:115], v12 offset:8864
    ds_read_b64_tr_b16 a[120:121], v12 offset:8896
    ds_read_b64_tr_b16 a[126:127], v12 offset:8928
    v_cndmask_b32 v72, v72, v15, s[56:57]
    v_cndmask_b32 v73, v73, v15, s[56:57]
    v_cndmask_b32 v74, v74, v15, s[56:57]
    v_cndmask_b32 v75, v75, v15, s[56:57]
    v_cndmask_b32 v76, v76, v15, s[56:57]
    v_cndmask_b32 v77, v77, v15, s[56:57]
    v_cndmask_b32 v78, v78, v15, s[56:57]
    v_cndmask_b32 v79, v79, v15, s[56:57]
    v_max_f32 v40, v56, v57
    v_max3_f32 v40, v40, v58, v59
    v_max3_f32 v40, v40, v72, v73
    v_max3_f32 v40, v40, v74, v75
    v_mov_b32 v41, v40
    s_nop 1
    v_permlane16_swap_b32 v40, v41
    v_max_f32 v40, v40, v41
    v_mov_b32 v41, v40
    s_nop 1
    v_permlane32_swap_b32 v40, v41
    v_max_f32 v40, v40, v41
    v_mul_f32 v40, s54, v40
    v_fma_f32 v56, v56, s54, -v40
    v_fma_f32 v57, v57, s54, -v40
    v_fma_f32 v58, v58, s54, -v40
    v_fma_f32 v59, v59, s54, -v40
    v_fma_f32 v72, v72, s54, -v40
    v_fma_f32 v73, v73, s54, -v40
    v_fma_f32 v74, v74, s54, -v40
    v_fma_f32 v75, v75, s54, -v40
    v_exp_f32 v56, v56
    v_exp_f32 v57, v57
    v_exp_f32 v58, v58
    v_exp_f32 v59, v59
    v_exp_f32 v72, v72
    v_exp_f32 v73, v73
    v_exp_f32 v74, v74
    v_exp_f32 v75, v75
    v_add_f32 v40, v56, v57
    v_add_f32 v40, v40, v58
    v_add_f32 v40, v40, v59
    v_add_f32 v40, v40, v72
    v_add_f32 v40, v40, v73
    v_add_f32 v40, v40, v74
    v_add_f32 v40, v40, v75
    v_mov_b32 v41, v40
    s_nop 1
    v_permlane16_swap_b32 v40, v41
    v_add_f32 v40, v40, v41
    v_mov_b32 v41, v40
    s_nop 1
    v_permlane32_swap_b32 v40, v41
    v_add_f32 v40, v40, v41
    v_rcp_f32 v40, v40
    s_nop 0
    v_mul_f32 v56, v56, v40
    v_mul_f32 v57, v57, v40
    v_mul_f32 v58, v58, v40
    v_mul_f32 v59, v59, v40
    v_mul_f32 v72, v72, v40
    v_mul_f32 v73, v73, v40
    v_mul_f32 v74, v74, v40
    v_mul_f32 v75, v75, v40
    v_cvt_pk_bf16_f32 v24, v56, v57
    v_cvt_pk_bf16_f32 v25, v58, v59
    v_cvt_pk_bf16_f32 v28, v72, v73
    v_cvt_pk_bf16_f32 v29, v74, v75
    v_max_f32 v40, v60, v61
    v_max3_f32 v40, v40, v62, v63
    v_max3_f32 v40, v40, v68, v69
    v_max3_f32 v40, v40, v70, v71
    v_max3_f32 v40, v40, v76, v77
    v_max3_f32 v40, v40, v78, v79
    v_mov_b32 v41, v40
    s_nop 1
    v_permlane16_swap_b32 v40, v41
    v_max_f32 v40, v40, v41
    v_mov_b32 v41, v40
    s_nop 1
    v_permlane32_swap_b32 v40, v41
    v_max_f32 v40, v40, v41
    v_mul_f32 v40, s54, v40
    v_fma_f32 v60, v60, s54, -v40
    v_fma_f32 v61, v61, s54, -v40
    v_fma_f32 v62, v62, s54, -v40
    v_fma_f32 v63, v63, s54, -v40
    v_fma_f32 v68, v68, s54, -v40
    v_fma_f32 v69, v69, s54, -v40
    v_fma_f32 v70, v70, s54, -v40
    v_fma_f32 v71, v71, s54, -v40
    v_fma_f32 v76, v76, s54, -v40
    v_fma_f32 v77, v77, s54, -v40
    v_fma_f32 v78, v78, s54, -v40
    v_fma_f32 v79, v79, s54, -v40
    v_exp_f32 v60, v60
    v_exp_f32 v61, v61
    v_exp_f32 v62, v62
    v_exp_f32 v63, v63
    v_exp_f32 v68, v68
    v_exp_f32 v69, v69
    v_exp_f32 v70, v70
    v_exp_f32 v71, v71
    v_exp_f32 v76, v76
    v_exp_f32 v77, v77
    v_exp_f32 v78, v78
    v_exp_f32 v79, v79
    v_add_f32 v40, v60, v61
    v_add_f32 v40, v40, v62
    v_add_f32 v40, v40, v63
    v_add_f32 v40, v40, v68
    v_add_f32 v40, v40, v69
    v_add_f32 v40, v40, v70
    v_add_f32 v40, v40, v71
    v_add_f32 v40, v40, v76
    v_add_f32 v40, v40, v77
    v_add_f32 v40, v40, v78
    v_add_f32 v40, v40, v79
    v_mov_b32 v41, v40
    s_nop 1
    v_permlane16_swap_b32 v40, v41
    v_add_f32 v40, v40, v41
    v_mov_b32 v41, v40
    s_nop 1
    v_permlane32_swap_b32 v40, v41
    v_add_f32 v40, v40, v41
    v_rcp_f32 v40, v40
    s_nop 0
    v_mul_f32 v60, v60, v40
    v_mul_f32 v61, v61, v40
    v_mul_f32 v62, v62, v40
    v_mul_f32 v63, v63, v40
    v_mul_f32 v68, v68, v40
    v_mul_f32 v69, v69, v40
    v_mul_f32 v70, v70, v40
    v_mul_f32 v71, v71, v40
    v_mul_f32 v76, v76, v40
    v_mul_f32 v77, v77, v40
    v_mul_f32 v78, v78, v40
    v_mul_f32 v79, v79, v40
    v_cvt_pk_bf16_f32 v30, v60, v61
    v_cvt_pk_bf16_f32 v31, v62, v63
    v_cvt_pk_bf16_f32 v32, v68, v69
    v_cvt_pk_bf16_f32 v33, v70, v71
    v_cvt_pk_bf16_f32 v34, v76, v77
    v_cvt_pk_bf16_f32 v35, v78, v79
    s_waitcnt lgkmcnt(0)
    s_nop 0
    v_mfma_f32_16x16x16_bf16 v[64:67], a[80:81], v[24:25], 0
    v_mfma_f32_16x16x16_bf16 v[68:71], a[86:87], v[24:25], 0
    v_mfma_f32_16x16x16_bf16 v[72:75], a[92:93], v[24:25], 0
    v_mfma_f32_16x16x16_bf16 v[76:79], a[98:99], v[24:25], 0
    v_mfma_f32_16x16x16_bf16 v[80:83], a[104:105], v[24:25], 0
    v_mfma_f32_16x16x16_bf16 v[84:87], a[110:111], v[24:25], 0
    v_mfma_f32_16x16x16_bf16 v[88:91], a[116:117], v[24:25], 0
    v_mfma_f32_16x16x16_bf16 v[92:95], a[122:123], v[24:25], 0
    v_mfma_f32_16x16x16_bf16 v[64:67], a[84:85], v[28:29], v[64:67]
    v_mfma_f32_16x16x16_bf16 v[68:71], a[90:91], v[28:29], v[68:71]
    v_mfma_f32_16x16x16_bf16 v[72:75], a[96:97], v[28:29], v[72:75]
    v_mfma_f32_16x16x16_bf16 v[76:79], a[102:103], v[28:29], v[76:79]
    v_mfma_f32_16x16x16_bf16 v[80:83], a[108:109], v[28:29], v[80:83]
    v_mfma_f32_16x16x16_bf16 v[84:87], a[114:115], v[28:29], v[84:87]
    v_mfma_f32_16x16x16_bf16 v[88:91], a[120:121], v[28:29], v[88:91]
    v_mfma_f32_16x16x16_bf16 v[92:95], a[126:127], v[28:29], v[92:95]
    v_mfma_f32_16x16x16_bf16 v[96:99], a[80:81], v[30:31], 0
    v_mfma_f32_16x16x16_bf16 v[100:103], a[86:87], v[30:31], 0
    v_mfma_f32_16x16x16_bf16 v[104:107], a[92:93], v[30:31], 0
    v_mfma_f32_16x16x16_bf16 v[108:111], a[98:99], v[30:31], 0
    v_mfma_f32_16x16x16_bf16 v[112:115], a[104:105], v[30:31], 0
    v_mfma_f32_16x16x16_bf16 v[116:119], a[110:111], v[30:31], 0
    v_mfma_f32_16x16x16_bf16 v[120:123], a[116:117], v[30:31], 0
    v_mfma_f32_16x16x16_bf16 v[124:127], a[122:123], v[30:31], 0
    v_mfma_f32_16x16x16_bf16 v[96:99], a[82:83], v[32:33], v[96:99]
    v_mfma_f32_16x16x16_bf16 v[100:103], a[88:89], v[32:33], v[100:103]
    v_mfma_f32_16x16x16_bf16 v[104:107], a[94:95], v[32:33], v[104:107]
    v_mfma_f32_16x16x16_bf16 v[108:111], a[100:101], v[32:33], v[108:111]
    v_mfma_f32_16x16x16_bf16 v[112:115], a[106:107], v[32:33], v[112:115]
    v_mfma_f32_16x16x16_bf16 v[116:119], a[112:113], v[32:33], v[116:119]
    v_mfma_f32_16x16x16_bf16 v[120:123], a[118:119], v[32:33], v[120:123]
    v_mfma_f32_16x16x16_bf16 v[124:127], a[124:125], v[32:33], v[124:127]
    v_mfma_f32_16x16x16_bf16 v[96:99], a[84:85], v[34:35], v[96:99]
    v_mfma_f32_16x16x16_bf16 v[100:103], a[90:91], v[34:35], v[100:103]
    v_mfma_f32_16x16x16_bf16 v[104:107], a[96:97], v[34:35], v[104:107]
    v_mfma_f32_16x16x16_bf16 v[108:111], a[102:103], v[34:35], v[108:111]
    v_mfma_f32_16x16x16_bf16 v[112:115], a[108:109], v[34:35], v[112:115]
    v_mfma_f32_16x16x16_bf16 v[116:119], a[114:115], v[34:35], v[116:119]
    v_mfma_f32_16x16x16_bf16 v[120:123], a[120:121], v[34:35], v[120:123]
    v_mfma_f32_16x16x16_bf16 v[124:127], a[126:127], v[34:35], v[124:127]
    s_add_u32 s46, s63, 4096
    v_cvt_pk_bf16_f32 v64, v64, v65
    v_cvt_pk_bf16_f32 v65, v66, v67
    v_cvt_pk_bf16_f32 v66, v68, v69
    v_cvt_pk_bf16_f32 v67, v70, v71
    buffer_store_dwordx4 v[64:67], v10, s[12:15], s63 offen offset:0 sc1
    v_cvt_pk_bf16_f32 v72, v72, v73
    v_cvt_pk_bf16_f32 v73, v74, v75
    v_cvt_pk_bf16_f32 v74, v76, v77
    v_cvt_pk_bf16_f32 v75, v78, v79
    buffer_store_dwordx4 v[72:75], v10, s[12:15], s63 offen offset:2048 sc1
    v_cvt_pk_bf16_f32 v80, v80, v81
    v_cvt_pk_bf16_f32 v81, v82, v83
    v_cvt_pk_bf16_f32 v82, v84, v85
    v_cvt_pk_bf16_f32 v83, v86, v87
    buffer_store_dwordx4 v[80:83], v10, s[12:15], s46 offen offset:0 sc1
    v_cvt_pk_bf16_f32 v88, v88, v89
    v_cvt_pk_bf16_f32 v89, v90, v91
    v_cvt_pk_bf16_f32 v90, v92, v93
    v_cvt_pk_bf16_f32 v91, v94, v95
    buffer_store_dwordx4 v[88:91], v10, s[12:15], s46 offen offset:2048 sc1
    v_cvt_pk_bf16_f32 v96, v96, v97
    v_cvt_pk_bf16_f32 v97, v98, v99
    v_cvt_pk_bf16_f32 v98, v100, v101
    v_cvt_pk_bf16_f32 v99, v102, v103
    buffer_store_dwordx4 v[96:99], v10, s[12:15], s63 offen offset:256 sc1
    v_cvt_pk_bf16_f32 v104, v104, v105
    v_cvt_pk_bf16_f32 v105, v106, v107
    v_cvt_pk_bf16_f32 v106, v108, v109
    v_cvt_pk_bf16_f32 v107, v110, v111
    buffer_store_dwordx4 v[104:107], v10, s[12:15], s63 offen offset:2304 sc1
    v_cvt_pk_bf16_f32 v112, v112, v113
    v_cvt_pk_bf16_f32 v113, v114, v115
    v_cvt_pk_bf16_f32 v114, v116, v117
    v_cvt_pk_bf16_f32 v115, v118, v119
    buffer_store_dwordx4 v[112:115], v10, s[12:15], s46 offen offset:256 sc1
    v_cvt_pk_bf16_f32 v120, v120, v121
    v_cvt_pk_bf16_f32 v121, v122, v123
    v_cvt_pk_bf16_f32 v122, v124, v125
    v_cvt_pk_bf16_f32 v123, v126, v127
    buffer_store_dwordx4 v[120:123], v10, s[12:15], s46 offen offset:2304 sc1
    s_waitcnt vmcnt(0)
    v_mov_b32 v16, s60
    v_add_u32 v16, 1, v16
    v_mov_b32 v17, 0
    s_mov_b64 exec, 1
    buffer_store_dword v16, v17, s[12:15], s52 offen sc1
    s_mov_b64 exec, -1
L_sf_48:
    s_add_u32 s60, s60, 4
    s_cmp_lt_u32 s60, 64
    s_cbranch_scc1 L_a_loop_42
    s_branch L_c_done_1
L_w_g_10:
    s_lshr_b32 s53, s48, 2
    s_cmp_lt_u32 s53, 2
    s_cselect_b32 s46, 1, 0
    s_xor_b32 s53, s53, s46
    s_mov_b32 s74, 0
    s_mov_b32 s76, 0
    s_cmp_eq_u32 s53, 1
    s_cselect_b32 s75, 41, 58
    s_cmp_eq_u32 s53, 2
    s_cselect_b32 s75, 54, s75
L_w_g_10_e:
    s_lshl_b32 s46, s53, 3
    s_add_u32 s46, s46, 16
    s_load_dwordx2 s[4:5], s[0:1], s46
    s_lshl_b32 s49, s40, 2
    s_and_b32 s46, s48, 3
    s_add_u32 s49, s49, s46
    s_load_dwordx2 s[6:7], s[0:1], 72
    s_and_b32 s50, s44, 3
    s_lshr_b32 s51, s44, 2
    s_waitcnt lgkmcnt(0)
    s_mov_b32 s24, s4
    s_and_b32 s25, s5, 0xffff
    s_mov_b32 s26, 0x800000
    s_mov_b32 s27, 0x00020000
    s_cmp_lg_u32 s53, 0
    s_cbranch_scc1 L_g_nq_49
    s_load_dwordx4 s[8:11], s[0:1], 24
    v_and_b32 v10, 255, v0
    v_lshlrev_b32 v10, 13, v10
    s_and_b32 s46, s48, 3
    s_lshl_b32 s46, s46, 21
    s_lshl_b32 s47, s40, 10
    s_add_u32 s46, s46, s47
    s_add_u32 s46, s46, 384
    s_waitcnt lgkmcnt(0)
    s_cmp_eq_u32 s51, 1
    s_cselect_b32 s8, s10, s8
    s_cselect_b32 s9, s11, s9
    s_mov_b32 s28, s8
    s_and_b32 s29, s9, 0xffff
    s_mov_b32 s30, 0x800000
    s_mov_b32 s31, 0x00020000
    buffer_load_dword v11, v10, s[28:31], s46 offen
    s_cmp_eq_u32 s51, 1
    s_cbranch_scc1 L_g_nq_49
    buffer_load_dword v12, v10, s[24:27], s46 offen
L_g_nq_49:
    v_lshrrev_b32 v3, 4, v1
    v_and_b32 v4, 15, v1
    v_lshlrev_b32 v5, 2, v3
    v_xor_b32 v4, v4, v5
    v_mul_u32_u24 v3, 8192, v3
    v_lshl_add_u32 v3, v4, 4, v3
    s_mul_i32 s46, s51, 512
    s_mul_i32 s47, s50, 16
    s_add_u32 s46, s46, s47
    s_mul_i32 s46, s46, 8192
    s_lshl_b32 s47, s49, 8
    s_add_u32 s46, s46, s47
    s_lshl_b32 s45, s51, 16
    s_mul_i32 s47, s50, 4096
    s_add_u32 s45, s45, s47
    v_bfe_u32 v4, v1, 2, 2
    v_bfe_u32 v5, v1, 4, 1
    v_lshlrev_b32 v5, 1, v5
    v_bfe_u32 v6, v1, 0, 1
    v_add_u32 v5, v5, v6
    s_lshl_b32 s47, s50, 2
    v_add_u32 v5, s47, v5
    v_lshlrev_b32 v6, 2, v4
    v_xor_b32 v5, v5, v6
    v_lshlrev_b32 v5, 4, v5
    v_lshl_add_u32 v5, v4, 8, v5
    v_bfe_u32 v6, v1, 1, 1
    v_lshl_add_u32 v5, v6, 3, v5
    v_lshrrev_b32 v6, 5, v1
    v_mul_u32_u24 v6, 2048, v6
    v_add_u32 v5, v5, v6
    s_lshl_b32 s47, s51, 16
    v_add_u32 v5, s47, v5
    v_bfe_u32 v4, v1, 2, 2
    v_xor_b32 v5, s50, v4
    v_lshlrev_b32 v5, 6, v5
    v_lshl_add_u32 v5, v4, 8, v5
    v_and_b32 v6, 3, v1
    v_lshl_add_u32 v5, v6, 4, v5
    v_lshrrev_b32 v6, 4, v1
    v_lshl_add_u32 v5, v6, 11, v5
    v_lshrrev_b32 v6, 5, v1
    s_lshl_b32 s47, s51, 16
    v_add_u32 v5, s47, v5
    s_add_u32 m0, s45, 0
    s_add_u32 s47, s46, 0x0
    buffer_load_dwordx4 v3, s[24:27], s47 offen lds
    s_add_u32 m0, s45, 1024
    s_add_u32 s47, s46, 0x8000
    buffer_load_dwordx4 v3, s[24:27], s47 offen lds
    s_add_u32 m0, s45, 2048
    s_add_u32 s47, s46, 0x10000
    buffer_load_dwordx4 v3, s[24:27], s47 offen lds
    s_add_u32 m0, s45, 3072
    s_add_u32 s47, s46, 0x18000
    buffer_load_dwordx4 v3, s[24:27], s47 offen lds
    s_add_u32 m0, s45, 16384
    s_add_u32 s47, s46, 0x80000
    buffer_load_dwordx4 v3, s[24:27], s47 offen lds
    s_add_u32 m0, s45, 17408
    s_add_u32 s47, s46, 0x88000
    buffer_load_dwordx4 v3, s[24:27], s47 offen lds
    s_add_u32 m0, s45, 18432
    s_add_u32 s47, s46, 0x90000
    buffer_load_dwordx4 v3, s[24:27], s47 offen lds
    s_add_u32 m0, s45, 19456
    s_add_u32 s47, s46, 0x98000
    buffer_load_dwordx4 v3, s[24:27], s47 offen lds
    s_add_u32 m0, s45, 32768
    s_add_u32 s47, s46, 0x100000
    buffer_load_dwordx4 v3, s[24:27], s47 offen lds
    s_add_u32 m0, s45, 33792
    s_add_u32 s47, s46, 0x108000
    buffer_load_dwordx4 v3, s[24:27], s47 offen lds
    s_add_u32 m0, s45, 34816
    s_add_u32 s47, s46, 0x110000
    buffer_load_dwordx4 v3, s[24:27], s47 offen lds
    s_add_u32 m0, s45, 35840
    s_add_u32 s47, s46, 0x118000
    buffer_load_dwordx4 v3, s[24:27], s47 offen lds
    s_add_u32 m0, s45, 49152
    s_add_u32 s47, s46, 0x180000
    buffer_load_dwordx4 v3, s[24:27], s47 offen lds
    s_add_u32 m0, s45, 50176
    s_add_u32 s47, s46, 0x188000
    buffer_load_dwordx4 v3, s[24:27], s47 offen lds
    s_add_u32 m0, s45, 51200
    s_add_u32 s47, s46, 0x190000
    buffer_load_dwordx4 v3, s[24:27], s47 offen lds
    s_add_u32 m0, s45, 52224
    s_add_u32 s47, s46, 0x198000
    buffer_load_dwordx4 v3, s[24:27], s47 offen lds
    s_waitcnt vmcnt(12) lgkmcnt(0)
    s_barrier
    ds_read_b64_tr_b16 a[0:1], v5 offset:0
    ds_read_b64_tr_b16 a[2:3], v5 offset:1024
    ds_read_b64_tr_b16 a[4:5], v5 offset:8
    ds_read_b64_tr_b16 a[6:7], v5 offset:1032
    ds_read_b64_tr_b16 a[8:9], v5 offset:8192
    ds_read_b64_tr_b16 a[10:11], v5 offset:9216
    ds_read_b64_tr_b16 a[12:13], v5 offset:8200
    ds_read_b64_tr_b16 a[14:15], v5 offset:9224
    s_waitcnt vmcnt(8) lgkmcnt(0)
    s_barrier
    s_add_u32 m0, s45, 0
    s_add_u32 s47, s46, 0x200000
    buffer_load_dwordx4 v3, s[24:27], s47 offen lds
    s_add_u32 m0, s45, 1024
    s_add_u32 s47, s46, 0x208000
    buffer_load_dwordx4 v3, s[24:27], s47 offen lds
    s_add_u32 m0, s45, 2048
    s_add_u32 s47, s46, 0x210000
    buffer_load_dwordx4 v3, s[24:27], s47 offen lds
    s_add_u32 m0, s45, 3072
    s_add_u32 s47, s46, 0x218000
    buffer_load_dwordx4 v3, s[24:27], s47 offen lds
    ds_read_b64_tr_b16 a[16:17], v5 offset:16384
    ds_read_b64_tr_b16 a[18:19], v5 offset:17408
    ds_read_b64_tr_b16 a[20:21], v5 offset:16392
    ds_read_b64_tr_b16 a[22:23], v5 offset:17416
    ds_read_b64_tr_b16 a[24:25], v5 offset:24576
    ds_read_b64_tr_b16 a[26:27], v5 offset:25600
    ds_read_b64_tr_b16 a[28:29], v5 offset:24584
    ds_read_b64_tr_b16 a[30:31], v5 offset:25608
    s_waitcnt vmcnt(8) lgkmcnt(0)
    s_barrier
    s_add_u32 m0, s45, 16384
    s_add_u32 s47, s46, 0x280000
    buffer_load_dwordx4 v3, s[24:27], s47 offen lds
    s_add_u32 m0, s45, 17408
    s_add_u32 s47, s46, 0x288000
    buffer_load_dwordx4 v3, s[24:27], s47 offen lds
    s_add_u32 m0, s45, 18432
    s_add_u32 s47, s46, 0x290000
    buffer_load_dwordx4 v3, s[24:27], s47 offen lds
    s_add_u32 m0, s45, 19456
    s_add_u32 s47, s46, 0x298000
    buffer_load_dwordx4 v3, s[24:27], s47 offen lds
    ds_read_b64_tr_b16 a[32:33], v5 offset:32768
    ds_read_b64_tr_b16 a[34:35], v5 offset:33792
    ds_read_b64_tr_b16 a[36:37], v5 offset:32776
    ds_read_b64_tr_b16 a[38:39], v5 offset:33800
    ds_read_b64_tr_b16 a[40:41], v5 offset:40960
    ds_read_b64_tr_b16 a[42:43], v5 offset:41984
    ds_read_b64_tr_b16 a[44:45], v5 offset:40968
    ds_read_b64_tr_b16 a[46:47], v5 offset:41992
    s_waitcnt vmcnt(8) lgkmcnt(0)
    s_barrier
    s_add_u32 m0, s45, 32768
    s_add_u32 s47, s46, 0x300000
    buffer_load_dwordx4 v3, s[24:27], s47 offen lds
    s_add_u32 m0, s45, 33792
    s_add_u32 s47, s46, 0x308000
    buffer_load_dwordx4 v3, s[24:27], s47 offen lds
    s_add_u32 m0, s45, 34816
    s_add_u32 s47, s46, 0x310000
    buffer_load_dwordx4 v3, s[24:27], s47 offen lds
    s_add_u32 m0, s45, 35840
    s_add_u32 s47, s46, 0x318000
    buffer_load_dwordx4 v3, s[24:27], s47 offen lds
    ds_read_b64_tr_b16 a[48:49], v5 offset:49152
    ds_read_b64_tr_b16 a[50:51], v5 offset:50176
    ds_read_b64_tr_b16 a[52:53], v5 offset:49160
    ds_read_b64_tr_b16 a[54:55], v5 offset:50184
    ds_read_b64_tr_b16 a[56:57], v5 offset:57344
    ds_read_b64_tr_b16 a[58:59], v5 offset:58368
    ds_read_b64_tr_b16 a[60:61], v5 offset:57352
    ds_read_b64_tr_b16 a[62:63], v5 offset:58376
    s_waitcnt vmcnt(8) lgkmcnt(0)
    s_barrier
    s_add_u32 m0, s45, 49152
    s_add_u32 s47, s46, 0x380000
    buffer_load_dwordx4 v3, s[24:27], s47 offen lds
    s_add_u32 m0, s45, 50176
    s_add_u32 s47, s46, 0x388000
    buffer_load_dwordx4 v3, s[24:27], s47 offen lds
    s_add_u32 m0, s45, 51200
    s_add_u32 s47, s46, 0x390000
    buffer_load_dwordx4 v3, s[24:27], s47 offen lds
    s_add_u32 m0, s45, 52224
    s_add_u32 s47, s46, 0x398000
    buffer_load_dwordx4 v3, s[24:27], s47 offen lds
    ds_read_b64_tr_b16 a[64:65], v5 offset:0
    ds_read_b64_tr_b16 a[66:67], v5 offset:1024
    ds_read_b64_tr_b16 a[68:69], v5 offset:8
    ds_read_b64_tr_b16 a[70:71], v5 offset:1032
    ds_read_b64_tr_b16 a[72:73], v5 offset:8192
    ds_read_b64_tr_b16 a[74:75], v5 offset:9216
    ds_read_b64_tr_b16 a[76:77], v5 offset:8200
    ds_read_b64_tr_b16 a[78:79], v5 offset:9224
    s_waitcnt vmcnt(8) lgkmcnt(0)
    s_barrier
    ds_read_b64_tr_b16 a[80:81], v5 offset:16384
    ds_read_b64_tr_b16 a[82:83], v5 offset:17408
    ds_read_b64_tr_b16 a[84:85], v5 offset:16392
    ds_read_b64_tr_b16 a[86:87], v5 offset:17416
    ds_read_b64_tr_b16 a[88:89], v5 offset:24576
    ds_read_b64_tr_b16 a[90:91], v5 offset:25600
    ds_read_b64_tr_b16 a[92:93], v5 offset:24584
    ds_read_b64_tr_b16 a[94:95], v5 offset:25608
    s_waitcnt vmcnt(4) lgkmcnt(0)
    s_barrier
    ds_read_b64_tr_b16 a[96:97], v5 offset:32768
    ds_read_b64_tr_b16 a[98:99], v5 offset:33792
    ds_read_b64_tr_b16 a[100:101], v5 offset:32776
    ds_read_b64_tr_b16 a[102:103], v5 offset:33800
    ds_read_b64_tr_b16 a[104:105], v5 offset:40960
    ds_read_b64_tr_b16 a[106:107], v5 offset:41984
    ds_read_b64_tr_b16 a[108:109], v5 offset:40968
    ds_read_b64_tr_b16 a[110:111], v5 offset:41992
    s_waitcnt vmcnt(0) lgkmcnt(0)
    s_barrier
    ds_read_b64_tr_b16 a[112:113], v5 offset:49152
    ds_read_b64_tr_b16 a[114:115], v5 offset:50176
    ds_read_b64_tr_b16 a[116:117], v5 offset:49160
    ds_read_b64_tr_b16 a[118:119], v5 offset:50184
    ds_read_b64_tr_b16 a[120:121], v5 offset:57344
    ds_read_b64_tr_b16 a[122:123], v5 offset:58368
    ds_read_b64_tr_b16 a[124:125], v5 offset:57352
    ds_read_b64_tr_b16 a[126:127], v5 offset:58376
    s_waitcnt lgkmcnt(0)
    s_barrier
    v_lshlrev_b32 v2, 4, v1
    s_mul_i32 s64, s44, 8192
    s_add_u32 s46, s64, 0x400000
    v_add_u32 v3, s46, v2
    s_mul_i32 s46, s51, 32768
    v_add_u32 v4, s46, v2
    v_and_b32 v6, 15, v1
    v_lshlrev_b32 v6, 4, v6
    v_lshrrev_b32 v7, 4, v1
    v_lshl_add_u32 v6, v7, 9, v6
    v_add_u32 v4, s46, v6
    s_lshl_b32 s46, s50, 12
    s_add_u32 s46, s46, 131072
    v_add_u32 v5, s46, v2
    v_and_b32 v7, 3, v1
    v_lshlrev_b32 v7, 7, v7
    v_add_u32 v7, 0x109400, v7
    s_mul_i32 s46, s49, 24576
    s_lshl_b32 s47, s53, 13
    s_add_u32 s46, s46, s47
    s_lshl_b32 s47, s50, 10
    s_add_u32 s46, s46, s47
    s_add_u32 s46, s46, 0x2000000
    v_and_b32 v8, 15, v1
    v_lshlrev_b32 v8, 4, v8
    v_bfe_u32 v9, v1, 4, 1
    v_lshl_add_u32 v8, v9, 12, v8
    v_lshrrev_b32 v9, 5, v1
    v_lshl_add_u32 v8, v9, 8, v8
    v_add_u32 v8, s46, v2
    v_add_u32 v9, 4096, v8
    s_lshl_b32 s52, s40, 2
    s_add_u32 s52, s52, s53
    s_lshl_b32 s52, s52, 2
    s_and_b32 s47, s48, 3
    s_add_u32 s52, s52, s47
    s_lshl_b32 s52, s52, 7
    s_add_u32 s52, s52, 0x10a400
    s_add_u32 s52, s52, s76
    v_mov_b32 v120, -1
    v_mov_b32 v121, -1
    v_mov_b32 v122, -1
    v_mov_b32 v123, -1
    s_lshl_b32 s46, s49, 12
    s_lshl_b32 s47, s50, 10
    s_add_u32 s46, s46, s47
    s_add_u32 s46, s46, 0x1000000
    v_add_u32 v64, s46, v2
    s_and_b32 s46, s48, 3
    s_lshl_b32 s46, s46, 16
    s_lshl_b32 s47, s50, 14
    s_add_u32 s46, s46, s47
    s_lshl_b32 s47, s40, 8
    s_add_u32 s46, s46, s47
    s_add_u32 s46, s46, 0x7800000
    v_and_b32 v65, 15, v1
    v_lshlrev_b32 v65, 4, v65
    v_lshrrev_b32 v66, 4, v1
    v_lshl_add_u32 v65, v66, 11, v65
    v_add_u32 v65, s46, v65
    v_add_u32 v68, 8192, v65
    s_lshl_b32 s58, s74, 17
    s_lshl_b32 s46, s53, 3
    s_sub_u32 s46, 80, s46
    s_load_dwordx2 s[8:9], s[0:1], s46
    v_lshlrev_b32 v66, 7, v1
    s_mul_i32 s57, s49, 229376
    s_waitcnt lgkmcnt(0)
    s_mov_b32 s32, s8
    s_and_b32 s33, s9, 0xffff
    s_mov_b32 s34, 0x700000
    s_mov_b32 s35, 0x00020000
    s_mov_b32 s60, s74
    s_mul_i32 s61, s74, 65536
    s_mov_b32 s62, s74
    s_mul_i32 s63, s74, 786432
    s_mov_b32 s67, 0
    s_mov_b32 s68, 3
    s_mov_b32 s71, 0
    v_mov_b32 v15, 147456
    v_mov_b32 v14, 0
    ds_write_b32 v15, v14 offset:4
    ds_write_b32 v15, v14 offset:12
    ds_write_b32 v15, v14 offset:16
    v_mov_b32 v114, 1
    v_mov_b32 v115, 0
    s_mov_b32 s81, 0
    s_lshl_b32 s46, s44, 5
    v_add_u32 v119, s46, v15
    v_lshrrev_b32 v113, 4, v1
    s_mov_b32 s72, 0
    s_cmp_lg_u32 s44, 0
    s_cbranch_scc1 L_zwok_59
    v_and_b32 v10, 7, v1
    v_lshlrev_b32 v10, 5, v10
    s_mov_b32 s70, 0
L_zw_58:
    buffer_load_dword v11, v10, s[16:19], 0 offen sc1
    s_waitcnt vmcnt(0)
    v_add_u32_dpp v11, v11, v11 row_ror:1 row_mask:0xf bank_mask:0xf
    s_nop 1
    v_add_u32_dpp v11, v11, v11 row_ror:2 row_mask:0xf bank_mask:0xf
    s_nop 1
    v_add_u32_dpp v11, v11, v11 row_ror:4 row_mask:0xf bank_mask:0xf
    v_cmp_ne_u32 vcc, 0x100, v11
    s_add_u32 s70, s70, 1
    s_cbranch_vccz L_zwok_59
    s_sleep 4
    s_cmp_lt_u32 s70, 524288
    s_cbranch_scc1 L_zw_58
    s_branch L_c_done_1
L_zwok_59:
L_g_restart_50:
    s_cmp_lg_u32 s44, 0
    s_cbranch_scc1 L_g_nsp_51
    s_mov_b32 s70, 0
L_g_sp_57:
    s_add_u32 s54, s60, 0
    v_add_u32 v12, s54, v113
    v_and_b32 v13, 7, v12
    v_lshl_add_u32 v13, v13, 9, v7
    buffer_load_dword v11, v13, s[12:15], 0 offen sc1
    s_waitcnt vmcnt(0)
    v_cmp_ge_u32 vcc, v12, v11
    s_add_u32 s70, s70, 1
    s_and_b32 s46, vcc_lo, 0xffff
    s_cbranch_scc0 L_g_sp_57_ok
    s_sleep 3
    s_cmp_lt_u32 s70, 524288
    s_cbranch_scc1 L_g_sp_57
    s_branch L_c_done_1
L_g_sp_57_ok:
    v_cmp_ge_u32 vcc, v12, v11
    s_nop 0
    s_ff1_i32_b64 s46, vcc
    s_lshr_b32 s46, s46, 4
    s_min_u32 s46, s46, 4
    s_add_u32 s46, s46, s54
    s_min_u32 s46, s46, s75
    v_mov_b32 v118, s46
    ds_write_b32 v15, v118 offset:20
L_g_nsp_51:
    s_waitcnt lgkmcnt(0)
    s_barrier
    ds_read_b32 v14, v15 offset:20
    s_waitcnt lgkmcnt(0)
    v_readfirstlane_b32 s66, v14
    s_nop 3
L_g_restart_50_go:
    s_mov_b32 s69, 0
    s_cmp_gt_u32 s62, s60
    s_cbranch_scc1 L_g_nd_60
    s_cmp_ge_u32 s62, s66
    s_cbranch_scc1 L_g_nd_60
    s_add_u32 s47, s61, 4096
    s_add_u32 m0, s64, 0
    s_nop 0
    buffer_load_dwordx4 v3, s[12:15], s61 offen offset:0 sc1 lds
    buffer_load_dwordx4 v3, s[12:15], s61 offen offset:1024 sc1 lds
    buffer_load_dwordx4 v3, s[12:15], s61 offen offset:2048 sc1 lds
    buffer_load_dwordx4 v3, s[12:15], s61 offen offset:3072 sc1 lds
    s_add_u32 m0, s64, 4096
    s_nop 0
    buffer_load_dwordx4 v3, s[12:15], s47 offen offset:0 sc1 lds
    buffer_load_dwordx4 v3, s[12:15], s47 offen offset:1024 sc1 lds
    buffer_load_dwordx4 v3, s[12:15], s47 offen offset:2048 sc1 lds
    buffer_load_dwordx4 v3, s[12:15], s47 offen offset:3072 sc1 lds
    s_add_u32 s61, s61, 65536
    s_add_u32 s62, s62, 1
    s_xor_b32 s64, s64, 0x10000
    s_mov_b32 s69, 1
L_g_nd_60:
    s_cmp_eq_u32 s51, 1
    s_cbranch_scc1 L_g_g1r_52
    s_add_u32 s59, s60, 1
    s_mov_b32 s69, 0
    s_cmp_gt_u32 s62, s59
    s_cbranch_scc1 L_g_nd_61
    s_cmp_ge_u32 s62, s66
    s_cbranch_scc1 L_g_nd_61
    s_add_u32 s47, s61, 4096
    s_add_u32 m0, s64, 0
    s_nop 0
    buffer_load_dwordx4 v3, s[12:15], s61 offen offset:0 sc1 lds
    buffer_load_dwordx4 v3, s[12:15], s61 offen offset:1024 sc1 lds
    buffer_load_dwordx4 v3, s[12:15], s61 offen offset:2048 sc1 lds
    buffer_load_dwordx4 v3, s[12:15], s61 offen offset:3072 sc1 lds
    s_add_u32 m0, s64, 4096
    s_nop 0
    buffer_load_dwordx4 v3, s[12:15], s47 offen offset:0 sc1 lds
    buffer_load_dwordx4 v3, s[12:15], s47 offen offset:1024 sc1 lds
    buffer_load_dwordx4 v3, s[12:15], s47 offen offset:2048 sc1 lds
    buffer_load_dwordx4 v3, s[12:15], s47 offen offset:3072 sc1 lds
    s_add_u32 s61, s61, 65536
    s_add_u32 s62, s62, 1
    s_xor_b32 s64, s64, 0x10000
    s_mov_b32 s69, 1
L_g_nd_61:
    s_cmp_eq_u32 s69, 1
    s_cbranch_scc1 L_g_w0_62
    s_waitcnt vmcnt(0)
L_g_w0_62:
    s_waitcnt vmcnt(8)
    s_cmp_lg_u32 s44, 0
    s_cbranch_scc1 L_g_nl_63
    s_cmp_lt_u32 s66, s75
    s_cselect_b32 s81, 1, 2
L_g_nl_63:
L_g_loop0_53_l:
    s_barrier
    ds_read_b128 v[32:35], v4 offset:0
    ds_read_b128 v[36:39], v4 offset:256
    ds_read_b128 v[40:43], v4 offset:2048
    ds_read_b128 v[44:47], v4 offset:2304
    ds_read_b128 v[48:51], v4 offset:4096
    ds_read_b128 v[52:55], v4 offset:4352
    ds_read_b128 v[56:59], v4 offset:6144
    ds_read_b128 v[60:63], v4 offset:6400
    s_branch L_g_loop0_53_m
.p2align 6
L_g_loop0_53:
    s_barrier
L_g_loop0_53_m:
    s_setprio 2
    s_waitcnt lgkmcnt(6)
    v_mfma_f32_16x16x32_bf16 v[16:19], a[0:3], v[32:35], 0
    v_mfma_f32_16x16x32_bf16 v[20:23], a[4:7], v[32:35], 0
    ds_read_b128 v[32:35], v4 offset:8192
    v_mfma_f32_16x16x32_bf16 v[28:31], a[4:7], v[36:39], 0
    v_mfma_f32_16x16x32_bf16 v[24:27], a[0:3], v[36:39], 0
    ds_read_b128 v[36:39], v4 offset:8448
    s_cmp_eq_u32 s81, 1
    s_cbranch_scc1 L_g_h1_67
L_g_h1_67_b:
    s_waitcnt lgkmcnt(6)
    v_mfma_f32_16x16x32_bf16 v[16:19], a[8:11], v[40:43], v[16:19]
    v_mfma_f32_16x16x32_bf16 v[20:23], a[12:15], v[40:43], v[20:23]
    ds_read_b128 v[40:43], v4 offset:10240
    v_mfma_f32_16x16x32_bf16 v[28:31], a[12:15], v[44:47], v[28:31]
    v_mfma_f32_16x16x32_bf16 v[24:27], a[8:11], v[44:47], v[24:27]
    ds_read_b128 v[44:47], v4 offset:10496
    s_waitcnt lgkmcnt(6)
    v_mfma_f32_16x16x32_bf16 v[16:19], a[16:19], v[48:51], v[16:19]
    v_mfma_f32_16x16x32_bf16 v[20:23], a[20:23], v[48:51], v[20:23]
    ds_read_b128 v[48:51], v4 offset:12288
    v_mfma_f32_16x16x32_bf16 v[28:31], a[20:23], v[52:55], v[28:31]
    v_mfma_f32_16x16x32_bf16 v[24:27], a[16:19], v[52:55], v[24:27]
    ds_read_b128 v[52:55], v4 offset:12544
    s_waitcnt lgkmcnt(6)
    v_mfma_f32_16x16x32_bf16 v[16:19], a[24:27], v[56:59], v[16:19]
    v_mfma_f32_16x16x32_bf16 v[20:23], a[28:31], v[56:59], v[20:23]
    ds_read_b128 v[56:59], v4 offset:14336
    v_mfma_f32_16x16x32_bf16 v[28:31], a[28:31], v[60:63], v[28:31]
    v_mfma_f32_16x16x32_bf16 v[24:27], a[24:27], v[60:63], v[24:27]
    ds_read_b128 v[60:63], v4 offset:14592
    s_waitcnt lgkmcnt(6)
    v_mfma_f32_16x16x32_bf16 v[16:19], a[32:35], v[32:35], v[16:19]
    v_mfma_f32_16x16x32_bf16 v[20:23], a[36:39], v[32:35], v[20:23]
    ds_read_b128 v[32:35], v4 offset:16384
    v_mfma_f32_16x16x32_bf16 v[28:31], a[36:39], v[36:39], v[28:31]
    v_mfma_f32_16x16x32_bf16 v[24:27], a[32:35], v[36:39], v[24:27]
    ds_read_b128 v[36:39], v4 offset:16640
    s_waitcnt lgkmcnt(6)
    v_mfma_f32_16x16x32_bf16 v[16:19], a[40:43], v[40:43], v[16:19]
    v_mfma_f32_16x16x32_bf16 v[20:23], a[44:47], v[40:43], v[20:23]
    ds_read_b128 v[40:43], v4 offset:18432
    v_mfma_f32_16x16x32_bf16 v[28:31], a[44:47], v[44:47], v[28:31]
    v_mfma_f32_16x16x32_bf16 v[24:27], a[40:43], v[44:47], v[24:27]
    ds_read_b128 v[44:47], v4 offset:18688
    s_waitcnt lgkmcnt(6)
    v_mfma_f32_16x16x32_bf16 v[16:19], a[48:51], v[48:51], v[16:19]
    v_mfma_f32_16x16x32_bf16 v[20:23], a[52:55], v[48:51], v[20:23]
    ds_read_b128 v[48:51], v4 offset:20480
    v_mfma_f32_16x16x32_bf16 v[28:31], a[52:55], v[52:55], v[28:31]
    v_mfma_f32_16x16x32_bf16 v[24:27], a[48:51], v[52:55], v[24:27]
    ds_read_b128 v[52:55], v4 offset:20736
    s_waitcnt lgkmcnt(6)
    v_mfma_f32_16x16x32_bf16 v[16:19], a[56:59], v[56:59], v[16:19]
    v_mfma_f32_16x16x32_bf16 v[20:23], a[60:63], v[56:59], v[20:23]
    ds_read_b128 v[56:59], v4 offset:22528
    v_mfma_f32_16x16x32_bf16 v[28:31], a[60:63], v[60:63], v[28:31]
    v_mfma_f32_16x16x32_bf16 v[24:27], a[56:59], v[60:63], v[24:27]
    ds_read_b128 v[60:63], v4 offset:22784
    s_waitcnt lgkmcnt(6)
    v_mfma_f32_16x16x32_bf16 v[16:19], a[64:67], v[32:35], v[16:19]
    v_mfma_f32_16x16x32_bf16 v[20:23], a[68:71], v[32:35], v[20:23]
    ds_read_b128 v[32:35], v4 offset:24576
    v_mfma_f32_16x16x32_bf16 v[28:31], a[68:71], v[36:39], v[28:31]
    v_mfma_f32_16x16x32_bf16 v[24:27], a[64:67], v[36:39], v[24:27]
    ds_read_b128 v[36:39], v4 offset:24832
    s_waitcnt lgkmcnt(6)
    v_mfma_f32_16x16x32_bf16 v[16:19], a[72:75], v[40:43], v[16:19]
    v_mfma_f32_16x16x32_bf16 v[20:23], a[76:79], v[40:43], v[20:23]
    ds_read_b128 v[40:43], v4 offset:26624
    v_mfma_f32_16x16x32_bf16 v[28:31], a[76:79], v[44:47], v[28:31]
    v_mfma_f32_16x16x32_bf16 v[24:27], a[72:75], v[44:47], v[24:27]
    ds_read_b128 v[44:47], v4 offset:26880
    s_waitcnt lgkmcnt(6)
    v_mfma_f32_16x16x32_bf16 v[16:19], a[80:83], v[48:51], v[16:19]
    v_mfma_f32_16x16x32_bf16 v[20:23], a[84:87], v[48:51], v[20:23]
    ds_read_b128 v[48:51], v4 offset:28672
    v_mfma_f32_16x16x32_bf16 v[28:31], a[84:87], v[52:55], v[28:31]
    v_mfma_f32_16x16x32_bf16 v[24:27], a[80:83], v[52:55], v[24:27]
    ds_read_b128 v[52:55], v4 offset:28928
    s_waitcnt lgkmcnt(6)
    v_mfma_f32_16x16x32_bf16 v[16:19], a[88:91], v[56:59], v[16:19]
    v_mfma_f32_16x16x32_bf16 v[20:23], a[92:95], v[56:59], v[20:23]
    ds_read_b128 v[56:59], v4 offset:30720
    v_mfma_f32_16x16x32_bf16 v[28:31], a[92:95], v[60:63], v[28:31]
    v_mfma_f32_16x16x32_bf16 v[24:27], a[88:91], v[60:63], v[24:27]
    ds_read_b128 v[60:63], v4 offset:30976
    s_waitcnt lgkmcnt(6)
    v_mfma_f32_16x16x32_bf16 v[16:19], a[96:99], v[32:35], v[16:19]
    v_mfma_f32_16x16x32_bf16 v[20:23], a[100:103], v[32:35], v[20:23]
    v_mfma_f32_16x16x32_bf16 v[28:31], a[100:103], v[36:39], v[28:31]
    v_mfma_f32_16x16x32_bf16 v[24:27], a[96:99], v[36:39], v[24:27]
    s_waitcnt lgkmcnt(4)
    v_mfma_f32_16x16x32_bf16 v[16:19], a[104:107], v[40:43], v[16:19]
    v_mfma_f32_16x16x32_bf16 v[20:23], a[108:111], v[40:43], v[20:23]
    v_mfma_f32_16x16x32_bf16 v[28:31], a[108:111], v[44:47], v[28:31]
    v_mfma_f32_16x16x32_bf16 v[24:27], a[104:107], v[44:47], v[24:27]
    s_waitcnt lgkmcnt(2)
    v_mfma_f32_16x16x32_bf16 v[16:19], a[112:115], v[48:51], v[16:19]
    v_mfma_f32_16x16x32_bf16 v[20:23], a[116:119], v[48:51], v[20:23]
    s_cmp_eq_u32 s81, 1
    s_cbranch_scc1 L_g_h2_68
L_g_h2_68_b:
    ds_write_b32 v119, v118
    v_mfma_f32_16x16x32_bf16 v[28:31], a[116:119], v[52:55], v[28:31]
    v_mfma_f32_16x16x32_bf16 v[24:27], a[112:115], v[52:55], v[24:27]
    s_waitcnt lgkmcnt(0)
    v_mfma_f32_16x16x32_bf16 v[16:19], a[120:123], v[56:59], v[16:19]
    v_mfma_f32_16x16x32_bf16 v[20:23], a[124:127], v[56:59], v[20:23]
    v_mfma_f32_16x16x32_bf16 v[28:31], a[124:127], v[60:63], v[28:31]
    v_mfma_f32_16x16x32_bf16 v[24:27], a[120:123], v[60:63], v[24:27]
    v_xor_b32 v4, 0x10000, v4
    s_setprio 0
    s_waitcnt vmcnt(0)
    s_waitcnt lgkmcnt(0)
    s_barrier
    ds_read_b32 v14, v15
    s_nop 6
    ds_write_b128 v5, v[16:19] offset:0
    ds_write_b128 v5, v[20:23] offset:1024
    ds_write_b128 v5, v[24:27] offset:2048
    ds_write_b128 v5, v[28:31] offset:3072
    s_waitcnt lgkmcnt(4)
    v_readfirstlane_b32 s66, v14
    s_add_u32 s60, s60, 1
    s_mov_b32 s65, 0
    s_cmp_le_u32 s62, s60
    s_cbranch_scc1 L_g_dp_69_l
L_g_dp_69_a:
    s_cmp_ge_u32 s62, s66
    s_cbranch_scc1 L_g_dp_69_d
    s_add_u32 s47, s61, 4096
    s_mov_b32 m0, s64
    s_add_u32 s62, s62, 1
    buffer_load_dwordx4 v3, s[12:15], s61 offen offset:0 sc1 lds
    buffer_load_dwordx4 v3, s[12:15], s61 offen offset:1024 sc1 lds
    buffer_load_dwordx4 v3, s[12:15], s61 offen offset:2048 sc1 lds
    buffer_load_dwordx4 v3, s[12:15], s61 offen offset:3072 sc1 lds
    s_add_u32 m0, s64, 4096
    s_add_u32 s61, s61, 65536
    buffer_load_dwordx4 v3, s[12:15], s47 offen offset:0 sc1 lds
    buffer_load_dwordx4 v3, s[12:15], s47 offen offset:1024 sc1 lds
    buffer_load_dwordx4 v3, s[12:15], s47 offen offset:2048 sc1 lds
    buffer_load_dwordx4 v3, s[12:15], s47 offen offset:3072 sc1 lds
    s_xor_b32 s64, s64, 0x10000
L_g_dp_69_d:
    s_cmp_le_u32 s66, s60
    s_cbranch_scc1 L_g_ex0_66
    s_cmp_lg_u32 s65, 0
    s_cbranch_scc1 L_g_nw_65
    ds_read_b128 v[32:35], v4 offset:0
    ds_read_b128 v[36:39], v4 offset:256
    ds_read_b128 v[40:43], v4 offset:2048
    ds_read_b128 v[44:47], v4 offset:2304
    ds_read_b128 v[48:51], v4 offset:4096
    ds_read_b128 v[52:55], v4 offset:4352
    ds_read_b128 v[56:59], v4 offset:6144
    ds_read_b128 v[60:63], v4 offset:6400
    s_cmp_lg_u32 s44, 0
    s_cbranch_scc1 L_g_nl_70
    s_mov_b32 s46, s66
    s_cmp_lg_u32 s81, 0
    s_cbranch_scc1 L_g_nl_70_e
    v_cmp_ge_u32 vcc, v12, v11
    s_nop 0
    s_ff1_i32_b64 s46, vcc
    s_lshr_b32 s46, s46, 4
    s_min_u32 s46, s46, 4
    s_add_u32 s46, s46, s54
    s_min_u32 s46, s46, s75
    v_mov_b32 v118, s46
L_g_nl_70_e:
    s_add_u32 s47, s60, 3
    s_min_u32 s47, s47, s75
    s_cmp_lt_u32 s46, s47
    s_cselect_b32 s81, 1, 0
    s_cbranch_scc1 L_g_nl_70
    s_add_u32 s54, s60, 2
    v_add_u32 v12, s54, v113
    v_and_b32 v13, 7, v12
    v_lshl_add_u32 v13, v13, 9, v7
    buffer_load_dword v11, v13, s[12:15], 0 offen sc1
L_g_nl_70:
    s_waitcnt lgkmcnt(8)
    s_branch L_g_loop0_53
L_g_ex0_66:
    s_cmp_lg_u32 s44, 0
    s_cbranch_scc1 L_g_ex0_66_n
    ds_write_b32 v15, v118 offset:20
    s_cmp_ge_u32 s60, s75
    s_cbranch_scc1 L_g_ex0_66_n
    s_sleep 6
    s_add_u32 s54, s60, 0
    v_add_u32 v12, s54, v113
    v_and_b32 v13, 7, v12
    v_lshl_add_u32 v13, v13, 9, v7
    buffer_load_dword v11, v13, s[12:15], 0 offen sc1
    s_waitcnt vmcnt(0)
    v_cmp_ge_u32 vcc, v12, v11
    s_nop 0
    s_ff1_i32_b64 s46, vcc
    s_lshr_b32 s46, s46, 4
    s_min_u32 s46, s46, 4
    s_add_u32 s46, s46, s54
    s_min_u32 s46, s46, s75
    v_mov_b32 v118, s46
    ds_write_b32 v15, v118 offset:20
L_g_ex0_66_n:
    s_waitcnt lgkmcnt(0)
    s_barrier
    ds_read_b32 v14, v15 offset:20
    s_waitcnt lgkmcnt(0)
    v_readfirstlane_b32 s66, v14
    s_barrier
    s_cmp_gt_u32 s66, s60
    s_cbranch_scc1 L_g_restart_50_go
    s_branch L_g_tail_55
L_g_g1r_52:
    s_mov_b32 s65, 1
    s_branch L_g_loop1_54_e
.p2align 6
L_g_loop1_54:
    s_mov_b32 s65, 0
L_g_loop1_54_e:
    s_barrier
    s_bitcmp1_b32 s67, 1
    s_cbranch_scc0 L_g_nfl_71
    s_cmp_lg_u32 s44, 4
    s_cbranch_scc1 L_g_nfl_71_d
    s_sub_u32 s59, s60, 1
    v_mov_b32 v10, s59
    buffer_store_dword v10, v115, s[12:15], s52 offen sc1
L_g_nfl_71_d:
    ds_read_b128 v[80:83], v5 offset:0
    ds_read_b128 v[84:87], v5 offset:1024
    ds_read_b128 v[88:91], v5 offset:2048
    ds_read_b128 v[92:95], v5 offset:3072
    s_cmp_le_u32 s62, s60
    s_cbranch_scc1 L_g_dp_76_l
L_g_dp_76_a:
    s_cmp_ge_u32 s62, s66
    s_cbranch_scc1 L_g_dp_76_d
    s_add_u32 s47, s61, 4096
    s_mov_b32 m0, s64
    s_add_u32 s62, s62, 1
    buffer_load_dwordx4 v3, s[12:15], s61 offen offset:0 sc1 lds
    buffer_load_dwordx4 v3, s[12:15], s61 offen offset:1024 sc1 lds
    buffer_load_dwordx4 v3, s[12:15], s61 offen offset:2048 sc1 lds
    buffer_load_dwordx4 v3, s[12:15], s61 offen offset:3072 sc1 lds
    s_add_u32 m0, s64, 4096
    s_add_u32 s61, s61, 65536
    buffer_load_dwordx4 v3, s[12:15], s47 offen offset:0 sc1 lds
    buffer_load_dwordx4 v3, s[12:15], s47 offen offset:1024 sc1 lds
    buffer_load_dwordx4 v3, s[12:15], s47 offen offset:2048 sc1 lds
    buffer_load_dwordx4 v3, s[12:15], s47 offen offset:3072 sc1 lds
    s_xor_b32 s64, s64, 0x10000
L_g_dp_76_d:
    s_bitcmp1_b32 s67, 0
    s_cbranch_scc0 L_g_nep_72
    s_waitcnt lgkmcnt(0)
    v_add_f32 v80, v80, v16
    v_add_f32 v81, v81, v17
    v_add_f32 v82, v82, v18
    v_add_f32 v83, v83, v19
    v_add_f32 v84, v84, v20
    v_add_f32 v85, v85, v21
    v_add_f32 v86, v86, v22
    v_add_f32 v87, v87, v23
    v_add_f32 v88, v88, v24
    v_add_f32 v89, v89, v25
    v_add_f32 v90, v90, v26
    v_add_f32 v91, v91, v27
    v_add_f32 v92, v92, v28
    v_add_f32 v93, v93, v29
    v_add_f32 v94, v94, v30
    v_add_f32 v95, v95, v31
    v_cvt_pk_bf16_f32 v104, v80, v81
    v_cvt_pk_bf16_f32 v105, v82, v83
    v_cvt_pk_bf16_f32 v106, v84, v85
    v_cvt_pk_bf16_f32 v107, v86, v87
    buffer_store_dwordx4 v[104:107], v8, s[12:15], s63 offen sc1
    v_cvt_pk_bf16_f32 v108, v88, v89
    v_cvt_pk_bf16_f32 v109, v90, v91
    v_cvt_pk_bf16_f32 v110, v92, v93
    v_cvt_pk_bf16_f32 v111, v94, v95
    buffer_store_dwordx4 v[108:111], v9, s[12:15], s63 offen sc1
    s_add_u32 s63, s63, 786432
    s_cmp_lg_u32 s53, 2
    s_cbranch_scc1 L_g_pf_77
    s_lshl_b32 s73, s58, 1
    buffer_store_dwordx4 v[120:123], v64, s[12:15], s58 offen sc1
    buffer_store_dwordx4 v[120:123], v65, s[12:15], s73 offen sc1
    buffer_store_dwordx4 v[120:123], v68, s[12:15], s73 offen sc1
    s_add_u32 s58, s58, 131072
L_g_pf_77:
    s_cmp_le_u32 s60, 2
    s_cbranch_scc1 L_g_nep_72_e
L_g_nep_72:
    s_cmp_lg_u32 s65, 0
    s_cbranch_scc1 L_g_nw1_73
    ds_read_b128 v[32:35], v4 offset:0
    ds_read_b128 v[36:39], v4 offset:256
    ds_read_b128 v[40:43], v4 offset:2048
    ds_read_b128 v[44:47], v4 offset:2304
    ds_read_b128 v[48:51], v4 offset:4096
    ds_read_b128 v[52:55], v4 offset:4352
    ds_read_b128 v[56:59], v4 offset:6144
    ds_read_b128 v[60:63], v4 offset:6400
    s_barrier
L_g_jn_75:
    s_setprio 1
    s_waitcnt lgkmcnt(6)
    v_mfma_f32_16x16x32_bf16 v[16:19], a[0:3], v[32:35], 0
    ds_read_b32 v14, v15
    v_mfma_f32_16x16x32_bf16 v[20:23], a[4:7], v[32:35], 0
    ds_read_b128 v[32:35], v4 offset:8192
    v_mfma_f32_16x16x32_bf16 v[28:31], a[4:7], v[36:39], 0
    v_mfma_f32_16x16x32_bf16 v[24:27], a[0:3], v[36:39], 0
    ds_read_b128 v[36:39], v4 offset:8448
    s_waitcnt lgkmcnt(6)
    v_mfma_f32_16x16x32_bf16 v[16:19], a[8:11], v[40:43], v[16:19]
    v_mfma_f32_16x16x32_bf16 v[20:23], a[12:15], v[40:43], v[20:23]
    ds_read_b128 v[40:43], v4 offset:10240
    v_mfma_f32_16x16x32_bf16 v[28:31], a[12:15], v[44:47], v[28:31]
    v_mfma_f32_16x16x32_bf16 v[24:27], a[8:11], v[44:47], v[24:27]
    ds_read_b128 v[44:47], v4 offset:10496
    s_waitcnt lgkmcnt(6)
    v_mfma_f32_16x16x32_bf16 v[16:19], a[16:19], v[48:51], v[16:19]
    v_mfma_f32_16x16x32_bf16 v[20:23], a[20:23], v[48:51], v[20:23]
    ds_read_b128 v[48:51], v4 offset:12288
    v_mfma_f32_16x16x32_bf16 v[28:31], a[20:23], v[52:55], v[28:31]
    v_mfma_f32_16x16x32_bf16 v[24:27], a[16:19], v[52:55], v[24:27]
    ds_read_b128 v[52:55], v4 offset:12544
    s_waitcnt lgkmcnt(6)
    v_mfma_f32_16x16x32_bf16 v[16:19], a[24:27], v[56:59], v[16:19]
    v_mfma_f32_16x16x32_bf16 v[20:23], a[28:31], v[56:59], v[20:23]
    ds_read_b128 v[56:59], v4 offset:14336
    v_mfma_f32_16x16x32_bf16 v[28:31], a[28:31], v[60:63], v[28:31]
    v_mfma_f32_16x16x32_bf16 v[24:27], a[24:27], v[60:63], v[24:27]
    ds_read_b128 v[60:63], v4 offset:14592
    s_waitcnt lgkmcnt(6)
    v_mfma_f32_16x16x32_bf16 v[16:19], a[32:35], v[32:35], v[16:19]
    v_mfma_f32_16x16x32_bf16 v[20:23], a[36:39], v[32:35], v[20:23]
    ds_read_b128 v[32:35], v4 offset:16384
    v_mfma_f32_16x16x32_bf16 v[28:31], a[36:39], v[36:39], v[28:31]
    v_mfma_f32_16x16x32_bf16 v[24:27], a[32:35], v[36:39], v[24:27]
    ds_read_b128 v[36:39], v4 offset:16640
    s_waitcnt lgkmcnt(6)
    v_mfma_f32_16x16x32_bf16 v[16:19], a[40:43], v[40:43], v[16:19]
    v_mfma_f32_16x16x32_bf16 v[20:23], a[44:47], v[40:43], v[20:23]
    ds_read_b128 v[40:43], v4 offset:18432
    v_mfma_f32_16x16x32_bf16 v[28:31], a[44:47], v[44:47], v[28:31]
    v_mfma_f32_16x16x32_bf16 v[24:27], a[40:43], v[44:47], v[24:27]
    ds_read_b128 v[44:47], v4 offset:18688
    s_waitcnt lgkmcnt(6)
    v_mfma_f32_16x16x32_bf16 v[16:19], a[48:51], v[48:51], v[16:19]
    v_mfma_f32_16x16x32_bf16 v[20:23], a[52:55], v[48:51], v[20:23]
    ds_read_b128 v[48:51], v4 offset:20480
    v_mfma_f32_16x16x32_bf16 v[28:31], a[52:55], v[52:55], v[28:31]
    v_mfma_f32_16x16x32_bf16 v[24:27], a[48:51], v[52:55], v[24:27]
    ds_read_b128 v[52:55], v4 offset:20736
    s_waitcnt lgkmcnt(6)
    v_mfma_f32_16x16x32_bf16 v[16:19], a[56:59], v[56:59], v[16:19]
    v_mfma_f32_16x16x32_bf16 v[20:23], a[60:63], v[56:59], v[20:23]
    ds_read_b128 v[56:59], v4 offset:22528
    v_mfma_f32_16x16x32_bf16 v[28:31], a[60:63], v[60:63], v[28:31]
    v_mfma_f32_16x16x32_bf16 v[24:27], a[56:59], v[60:63], v[24:27]
    ds_read_b128 v[60:63], v4 offset:22784
    s_waitcnt lgkmcnt(6)
    v_mfma_f32_16x16x32_bf16 v[16:19], a[64:67], v[32:35], v[16:19]
    v_mfma_f32_16x16x32_bf16 v[20:23], a[68:71], v[32:35], v[20:23]
    ds_read_b128 v[32:35], v4 offset:24576
    v_mfma_f32_16x16x32_bf16 v[28:31], a[68:71], v[36:39], v[28:31]
    v_mfma_f32_16x16x32_bf16 v[24:27], a[64:67], v[36:39], v[24:27]
    ds_read_b128 v[36:39], v4 offset:24832
    s_waitcnt lgkmcnt(6)
    v_mfma_f32_16x16x32_bf16 v[16:19], a[72:75], v[40:43], v[16:19]
    v_mfma_f32_16x16x32_bf16 v[20:23], a[76:79], v[40:43], v[20:23]
    ds_read_b128 v[40:43], v4 offset:26624
    v_mfma_f32_16x16x32_bf16 v[28:31], a[76:79], v[44:47], v[28:31]
    v_mfma_f32_16x16x32_bf16 v[24:27], a[72:75], v[44:47], v[24:27]
    ds_read_b128 v[44:47], v4 offset:26880
    s_waitcnt lgkmcnt(6)
    v_mfma_f32_16x16x32_bf16 v[16:19], a[80:83], v[48:51], v[16:19]
    v_mfma_f32_16x16x32_bf16 v[20:23], a[84:87], v[48:51], v[20:23]
    ds_read_b128 v[48:51], v4 offset:28672
    v_mfma_f32_16x16x32_bf16 v[28:31], a[84:87], v[52:55], v[28:31]
    v_mfma_f32_16x16x32_bf16 v[24:27], a[80:83], v[52:55], v[24:27]
    ds_read_b128 v[52:55], v4 offset:28928
    s_waitcnt lgkmcnt(6)
    v_mfma_f32_16x16x32_bf16 v[16:19], a[88:91], v[56:59], v[16:19]
    v_mfma_f32_16x16x32_bf16 v[20:23], a[92:95], v[56:59], v[20:23]
    ds_read_b128 v[56:59], v4 offset:30720
    v_mfma_f32_16x16x32_bf16 v[28:31], a[92:95], v[60:63], v[28:31]
    v_mfma_f32_16x16x32_bf16 v[24:27], a[88:91], v[60:63], v[24:27]
    ds_read_b128 v[60:63], v4 offset:30976
    s_waitcnt lgkmcnt(6)
    v_mfma_f32_16x16x32_bf16 v[16:19], a[96:99], v[32:35], v[16:19]
    v_mfma_f32_16x16x32_bf16 v[20:23], a[100:103], v[32:35], v[20:23]
    v_mfma_f32_16x16x32_bf16 v[28:31], a[100:103], v[36:39], v[28:31]
    v_mfma_f32_16x16x32_bf16 v[24:27], a[96:99], v[36:39], v[24:27]
    s_waitcnt lgkmcnt(4)
    v_mfma_f32_16x16x32_bf16 v[16:19], a[104:107], v[40:43], v[16:19]
    v_mfma_f32_16x16x32_bf16 v[20:23], a[108:111], v[40:43], v[20:23]
    v_mfma_f32_16x16x32_bf16 v[28:31], a[108:111], v[44:47], v[28:31]
    v_mfma_f32_16x16x32_bf16 v[24:27], a[104:107], v[44:47], v[24:27]
    s_waitcnt lgkmcnt(2)
    v_mfma_f32_16x16x32_bf16 v[16:19], a[112:115], v[48:51], v[16:19]
    v_mfma_f32_16x16x32_bf16 v[20:23], a[116:119], v[48:51], v[20:23]
    v_mfma_f32_16x16x32_bf16 v[28:31], a[116:119], v[52:55], v[28:31]
    v_mfma_f32_16x16x32_bf16 v[24:27], a[112:115], v[52:55], v[24:27]
    s_waitcnt lgkmcnt(0)
    v_mfma_f32_16x16x32_bf16 v[16:19], a[120:123], v[56:59], v[16:19]
    v_mfma_f32_16x16x32_bf16 v[20:23], a[124:127], v[56:59], v[20:23]
    v_mfma_f32_16x16x32_bf16 v[28:31], a[124:127], v[60:63], v[28:31]
    v_mfma_f32_16x16x32_bf16 v[24:27], a[120:123], v[60:63], v[24:27]
    v_xor_b32 v4, 0x10000, v4
    s_setprio 0
    s_waitcnt vmcnt(0)
    v_readfirstlane_b32 s66, v14
    s_lshl_b32 s67, s67, 1
    s_or_b32 s67, s67, 1
    s_add_u32 s60, s60, 1
    s_cmp_gt_u32 s66, s60
    s_cbranch_scc1 L_g_loop1_54
    s_barrier
    ds_read_b32 v14, v15 offset:20
    ds_read_b128 v[80:83], v5 offset:0
    ds_read_b128 v[84:87], v5 offset:1024
    ds_read_b128 v[88:91], v5 offset:2048
    ds_read_b128 v[92:95], v5 offset:3072
    s_waitcnt lgkmcnt(4)
    v_readfirstlane_b32 s66, v14
    s_barrier
    s_mov_b32 s69, 0
    s_cmp_gt_u32 s62, s60
    s_cbranch_scc1 L_g_nd_78
    s_cmp_ge_u32 s62, s66
    s_cbranch_scc1 L_g_nd_78
    s_add_u32 s47, s61, 4096
    s_add_u32 m0, s64, 0
    s_nop 0
    buffer_load_dwordx4 v3, s[12:15], s61 offen offset:0 sc1 lds
    buffer_load_dwordx4 v3, s[12:15], s61 offen offset:1024 sc1 lds
    buffer_load_dwordx4 v3, s[12:15], s61 offen offset:2048 sc1 lds
    buffer_load_dwordx4 v3, s[12:15], s61 offen offset:3072 sc1 lds
    s_add_u32 m0, s64, 4096
    s_nop 0
    buffer_load_dwordx4 v3, s[12:15], s47 offen offset:0 sc1 lds
    buffer_load_dwordx4 v3, s[12:15], s47 offen offset:1024 sc1 lds
    buffer_load_dwordx4 v3, s[12:15], s47 offen offset:2048 sc1 lds
    buffer_load_dwordx4 v3, s[12:15], s47 offen offset:3072 sc1 lds
    s_add_u32 s61, s61, 65536
    s_add_u32 s62, s62, 1
    s_xor_b32 s64, s64, 0x10000
    s_mov_b32 s69, 1
L_g_nd_78:
    s_sub_u32 s59, s60, 1
    s_waitcnt lgkmcnt(3)
    v_add_f32 v80, v80, v16
    v_add_f32 v81, v81, v17
    v_add_f32 v82, v82, v18
    v_add_f32 v83, v83, v19
    s_waitcnt lgkmcnt(2)
    v_add_f32 v84, v84, v20
    v_add_f32 v85, v85, v21
    v_add_f32 v86, v86, v22
    v_add_f32 v87, v87, v23
    s_waitcnt lgkmcnt(1)
    v_add_f32 v88, v88, v24
    v_add_f32 v89, v89, v25
    v_add_f32 v90, v90, v26
    v_add_f32 v91, v91, v27
    s_waitcnt lgkmcnt(0)
    v_add_f32 v92, v92, v28
    v_add_f32 v93, v93, v29
    v_add_f32 v94, v94, v30
    v_add_f32 v95, v95, v31
    v_cvt_pk_bf16_f32 v104, v80, v81
    v_cvt_pk_bf16_f32 v105, v82, v83
    v_cvt_pk_bf16_f32 v106, v84, v85
    v_cvt_pk_bf16_f32 v107, v86, v87
    buffer_store_dwordx4 v[104:107], v8, s[12:15], s63 offen sc1
    v_cvt_pk_bf16_f32 v108, v88, v89
    v_cvt_pk_bf16_f32 v109, v90, v91
    v_cvt_pk_bf16_f32 v110, v92, v93
    v_cvt_pk_bf16_f32 v111, v94, v95
    buffer_store_dwordx4 v[108:111], v9, s[12:15], s63 offen sc1
    s_add_u32 s63, s63, 786432
    s_cmp_lg_u32 s53, 2
    s_cbranch_scc1 L_g_pf_79
    s_lshl_b32 s73, s58, 1
    buffer_store_dwordx4 v[120:123], v64, s[12:15], s58 offen sc1
    buffer_store_dwordx4 v[120:123], v65, s[12:15], s73 offen sc1
    buffer_store_dwordx4 v[120:123], v68, s[12:15], s73 offen sc1
    s_add_u32 s58, s58, 131072
L_g_pf_79:
    s_mov_b32 s67, 0
    s_mov_b32 s71, 1
    s_cmp_gt_u32 s66, s60
    s_cbranch_scc1 L_g_g1r_52
    v_mov_b32 v10, 1
    s_mov_b64 exec, 1
    s_waitcnt vmcnt(0)
    ds_add_rtn_u32 v10, v15, v10 offset:4
    s_waitcnt lgkmcnt(0)
    v_readfirstlane_b32 s46, v10
    s_mov_b64 exec, -1
    s_mov_b32 s71, 0
    s_sub_u32 s59, s60, 1
    s_cmp_lg_u32 s46, s68
    s_cbranch_scc1 L_g_df_80
    v_mov_b32 v10, s59
    v_add_u32 v10, 1, v10
    v_mov_b32 v11, 0
    s_mov_b64 exec, 1
    buffer_store_dword v10, v11, s[12:15], s52 offen sc1
    s_mov_b64 exec, -1
L_sf_81:
L_g_df_80:
    s_add_u32 s68, s68, 4
    s_cmp_gt_u32 s66, s60
    s_cbranch_scc1 L_g_g1r_52
L_g_tail_55:
    s_cmp_lt_u32 s60, s75
    s_cbranch_scc1 L_g_restart_50
    s_waitcnt vmcnt(0)
    s_barrier
    s_branch L_w_p2_11
L_g_h1_67:
    s_add_u32 s54, s60, 1
    v_add_u32 v12, s54, v113
    v_and_b32 v13, 7, v12
    v_lshl_add_u32 v13, v13, 9, v7
    buffer_load_dword v11, v13, s[12:15], 0 offen sc1
    s_branch L_g_h1_67_b
L_g_h2_68:
    s_waitcnt vmcnt(0)
    v_cmp_ge_u32 vcc, v12, v11
    s_nop 0
    s_ff1_i32_b64 s46, vcc
    s_lshr_b32 s46, s46, 4
    s_min_u32 s46, s46, 4
    s_add_u32 s46, s46, s54
    s_min_u32 s46, s46, s75
    v_mov_b32 v118, s46
    s_branch L_g_h2_68_b
L_g_dp_69_l:
    s_cmp_ge_u32 s62, s66
    s_cbranch_scc1 L_g_dp_69_d
    s_mov_b32 s65, 1
    s_add_u32 s47, s61, 4096
    s_mov_b32 m0, s64
    s_add_u32 s62, s62, 1
    buffer_load_dwordx4 v3, s[12:15], s61 offen offset:0 sc1 lds
    buffer_load_dwordx4 v3, s[12:15], s61 offen offset:1024 sc1 lds
    buffer_load_dwordx4 v3, s[12:15], s61 offen offset:2048 sc1 lds
    buffer_load_dwordx4 v3, s[12:15], s61 offen offset:3072 sc1 lds
    s_add_u32 m0, s64, 4096
    s_add_u32 s61, s61, 65536
    buffer_load_dwordx4 v3, s[12:15], s47 offen offset:0 sc1 lds
    buffer_load_dwordx4 v3, s[12:15], s47 offen offset:1024 sc1 lds
    buffer_load_dwordx4 v3, s[12:15], s47 offen offset:2048 sc1 lds
    buffer_load_dwordx4 v3, s[12:15], s47 offen offset:3072 sc1 lds
    s_xor_b32 s64, s64, 0x10000
    s_branch L_g_dp_69_a
L_g_nw_65:
    s_waitcnt vmcnt(0) lgkmcnt(0)
    s_cmp_lg_u32 s44, 0
    s_cbranch_scc1 L_g_nl_82
    s_cmp_lt_u32 s66, s75
    s_cselect_b32 s81, 1, 2
L_g_nl_82:
    s_branch L_g_loop0_53_l
L_g_nfl_71:
    s_cmp_eq_u32 s71, 0
    s_cbranch_scc1 L_g_nfl_71_d
    v_mov_b32 v10, 1
    s_mov_b64 exec, 1
    s_waitcnt vmcnt(0)
    ds_add_rtn_u32 v10, v15, v10 offset:4
    s_waitcnt lgkmcnt(0)
    v_readfirstlane_b32 s46, v10
    s_mov_b64 exec, -1
    s_mov_b32 s71, 0
    s_sub_u32 s59, s60, 1
    s_cmp_lg_u32 s46, s68
    s_cbranch_scc1 L_g_df_83
    v_mov_b32 v10, s59
    v_add_u32 v10, 1, v10
    v_mov_b32 v11, 0
    s_mov_b64 exec, 1
    buffer_store_dword v10, v11, s[12:15], s52 offen sc1
    s_mov_b64 exec, -1
L_sf_84:
L_g_df_83:
    s_add_u32 s68, s68, 4
    s_mov_b32 s65, 2
    s_branch L_g_nfl_71_d
L_g_dp_76_l:
    s_cmp_ge_u32 s62, s66
    s_cbranch_scc1 L_g_dp_76_d
    s_or_b32 s65, s65, 1
    s_add_u32 s47, s61, 4096
    s_mov_b32 m0, s64
    s_add_u32 s62, s62, 1
    buffer_load_dwordx4 v3, s[12:15], s61 offen offset:0 sc1 lds
    buffer_load_dwordx4 v3, s[12:15], s61 offen offset:1024 sc1 lds
    buffer_load_dwordx4 v3, s[12:15], s61 offen offset:2048 sc1 lds
    buffer_load_dwordx4 v3, s[12:15], s61 offen offset:3072 sc1 lds
    s_add_u32 m0, s64, 4096
    s_add_u32 s61, s61, 65536
    buffer_load_dwordx4 v3, s[12:15], s47 offen offset:0 sc1 lds
    buffer_load_dwordx4 v3, s[12:15], s47 offen offset:1024 sc1 lds
    buffer_load_dwordx4 v3, s[12:15], s47 offen offset:2048 sc1 lds
    buffer_load_dwordx4 v3, s[12:15], s47 offen offset:3072 sc1 lds
    s_xor_b32 s64, s64, 0x10000
    s_branch L_g_dp_76_a
L_g_nep_72_e:
    v_mov_b32 v10, 1
    s_mov_b64 exec, 1
    s_waitcnt vmcnt(0)
    ds_add_rtn_u32 v10, v15, v10 offset:4
    s_waitcnt lgkmcnt(0)
    v_readfirstlane_b32 s46, v10
    s_mov_b64 exec, -1
    s_mov_b32 s71, 0
    s_sub_u32 s59, s60, 1
    s_cmp_lg_u32 s46, s68
    s_cbranch_scc1 L_g_df_85
    v_mov_b32 v10, s59
    v_add_u32 v10, 1, v10
    v_mov_b32 v11, 0
    s_mov_b64 exec, 1
    buffer_store_dword v10, v11, s[12:15], s52 offen sc1
    s_mov_b64 exec, -1
L_sf_86:
L_g_df_85:
    s_add_u32 s68, s68, 4
    s_branch L_g_nep_72
L_g_nw1_73:
    s_cmp_eq_u32 s65, 2
    s_cbranch_scc1 L_g_nw1_73_w
    s_waitcnt vmcnt(0)
L_g_nw1_73_w:
    s_barrier
    ds_read_b128 v[32:35], v4 offset:0
    ds_read_b128 v[36:39], v4 offset:256
    ds_read_b128 v[40:43], v4 offset:2048
    ds_read_b128 v[44:47], v4 offset:2304
    ds_read_b128 v[48:51], v4 offset:4096
    ds_read_b128 v[52:55], v4 offset:4352
    ds_read_b128 v[56:59], v4 offset:6144
    ds_read_b128 v[60:63], v4 offset:6400
    s_branch L_g_jn_75
L_w_p2_11:
    s_cmp_lg_u32 s44, 0
    s_cbranch_scc1 L_w_p2_11_h
    s_mov_b32 s47, 63
    s_cmp_eq_u32 s53, 0
    s_cbranch_scc1 L_w_p2_11_q
    s_sub_u32 s52, s52, s76
    v_mov_b32 v10, 1
    v_mov_b32 v11, 131072
    s_mov_b64 exec, 1
    buffer_atomic_add v10, v11, s[12:15], s52 offen sc0
    s_waitcnt vmcnt(0)
    v_readfirstlane_b32 s46, v10
    s_mov_b64 exec, -1
    s_mov_b32 s47, 63
    s_nop 1
    s_cmp_eq_u32 s46, 0
    s_cbranch_scc1 L_w_p2_11_h
L_w_p2_11_q:
    v_mov_b32 v10, s47
    v_add_u32 v10, 1, v10
    v_mov_b32 v11, 0
    s_mov_b64 exec, 1
    buffer_store_dword v10, v11, s[12:15], s52 offen sc1
    s_mov_b64 exec, -1
L_sf_87:
L_w_p2_11_h:
    s_cmp_eq_u32 s76, 0
    s_cbranch_scc1 L_w_p2_11_m
    s_cmp_eq_u32 s79, 1
    s_cbranch_scc1 L_w_h_17
    s_mov_b32 s79, 1
    s_cmp_lt_u32 s77, 14
    s_cselect_b32 s53, 2, s53
    s_cselect_b32 s48, s48, 3
    s_branch L_w_h_17_n
L_w_p2_11_m:
    s_cmp_lt_u32 s48, 8
    s_cselect_b32 s75, 60, 60
    s_cmp_lt_u32 s48, 4
    s_cselect_b32 s75, 64, s75
L_w_p2_11_r:
    s_lshr_b32 s42, s40, 1
    s_and_b32 s43, s40, 1
    s_lshl_b32 s43, s43, 2
    s_and_b32 s46, s48, 3
    s_add_u32 s43, s43, s46
    s_cmp_lt_u32 s48, 4
    s_cbranch_scc1 L_w_wo_12
    s_cmp_lt_u32 s48, 8
    s_cbranch_scc1 L_w_f2_13
    s_cmp_lg_u32 s43, 7
    s_cbranch_scc1 L_w_f1_14
    s_mov_b32 s43, 2
    s_cmp_eq_u32 s76, 0
    s_cbranch_scc1 L_w_c_16
    s_mov_b32 s43, 7
    s_mov_b32 s78, 1
L_w_f1_14_t:
    s_cmp_lt_u32 s41, 8
    s_cselect_b32 s74, 60, 63
    s_cselect_b32 s75, 63, 64
    s_add_u32 s43, s43, s74
    s_cmp_lt_u32 s43, s75
    s_cbranch_scc1 L_w_h_17_f
    s_branch L_c_done_1
L_w_f1_14_d:
    s_cmp_eq_u32 s76, 0
    s_cbranch_scc1 L_c_done_1
    s_and_b32 s42, s49, 3
    s_lshr_b32 s43, s49, 2
    s_mov_b32 s78, 64
    s_branch L_w_f1_14_t
L_replica:
    s_setprio 0
    s_barrier
    s_and_b32 s48, s41, 7
    s_add_u32 s48, s48, 4
    s_cmp_lt_u32 s41, 8
    s_cselect_b32 s74, 60, 63
    s_cselect_b32 s75, 63, 64
    s_cselect_b32 s76, 1, 2
    s_cselect_b32 s46, 60, 63
    s_cselect_b32 s47, 63, 64
    s_mul_i32 s76, s76, 65536
    s_cmp_lt_u32 s48, 8
    s_cselect_b32 s74, s46, s74
    s_cselect_b32 s75, s47, s75
    s_branch L_w_p2_11_r
L_w_f1_14:
    s_load_dwordx2 s[4:5], s[0:1], 64
    s_load_dwordx2 s[6:7], s[0:1], 72
    s_and_b32 s50, s44, 3
    s_lshr_b32 s51, s44, 2
    s_waitcnt lgkmcnt(0)
    s_mov_b32 s24, s4
    s_and_b32 s25, s5, 0xffff
    s_mov_b32 s26, 0x700000
    s_mov_b32 s27, 0x00020000
    s_mul_i32 s49, s42, 7
    s_add_u32 s49, s49, s43
    v_lshrrev_b32 v3, 4, v1
    v_and_b32 v4, 15, v1
    v_lshlrev_b32 v5, 2, v3
    v_xor_b32 v4, v4, v5
    v_mul_u32_u24 v3, 7168, v3
    v_lshl_add_u32 v3, v4, 4, v3
    s_mul_i32 s46, s51, 512
    s_mul_i32 s47, s50, 16
    s_add_u32 s46, s46, s47
    s_mul_i32 s46, s46, 7168
    s_lshl_b32 s47, s49, 8
    s_add_u32 s46, s46, s47
    s_lshl_b32 s45, s51, 16
    s_mul_i32 s47, s50, 4096
    s_add_u32 s45, s45, s47
    v_bfe_u32 v4, v1, 2, 2
    v_bfe_u32 v5, v1, 4, 1
    v_lshlrev_b32 v5, 1, v5
    v_bfe_u32 v6, v1, 1, 1
    v_add_u32 v5, v5, v6
    s_lshl_b32 s47, s50, 2
    v_add_u32 v5, s47, v5
    v_lshlrev_b32 v6, 2, v4
    v_xor_b32 v5, v5, v6
    v_lshlrev_b32 v5, 4, v5
    v_lshl_add_u32 v5, v4, 8, v5
    v_bfe_u32 v6, v1, 0, 1
    v_lshl_add_u32 v5, v6, 3, v5
    v_lshrrev_b32 v6, 5, v1
    v_mul_u32_u24 v6, 2048, v6
    v_add_u32 v5, v5, v6
    s_lshl_b32 s47, s51, 16
    v_add_u32 v5, s47, v5
    s_add_u32 m0, s45, 0
    s_add_u32 s47, s46, 0x0
    buffer_load_dwordx4 v3, s[24:27], s47 offen lds
    s_add_u32 m0, s45, 1024
    s_add_u32 s47, s46, 0x7000
    buffer_load_dwordx4 v3, s[24:27], s47 offen lds
    s_add_u32 m0, s45, 2048
    s_add_u32 s47, s46, 0xe000
    buffer_load_dwordx4 v3, s[24:27], s47 offen lds
    s_add_u32 m0, s45, 3072
    s_add_u32 s47, s46, 0x15000
    buffer_load_dwordx4 v3, s[24:27], s47 offen lds
    s_add_u32 m0, s45, 16384
    s_add_u32 s47, s46, 0x70000
    buffer_load_dwordx4 v3, s[24:27], s47 offen lds
    s_add_u32 m0, s45, 17408
    s_add_u32 s47, s46, 0x77000
    buffer_load_dwordx4 v3, s[24:27], s47 offen lds
    s_add_u32 m0, s45, 18432
    s_add_u32 s47, s46, 0x7e000
    buffer_load_dwordx4 v3, s[24:27], s47 offen lds
    s_add_u32 m0, s45, 19456
    s_add_u32 s47, s46, 0x85000
    buffer_load_dwordx4 v3, s[24:27], s47 offen lds
    s_add_u32 m0, s45, 32768
    s_add_u32 s47, s46, 0xe0000
    buffer_load_dwordx4 v3, s[24:27], s47 offen lds
    s_add_u32 m0, s45, 33792
    s_add_u32 s47, s46, 0xe7000
    buffer_load_dwordx4 v3, s[24:27], s47 offen lds
    s_add_u32 m0, s45, 34816
    s_add_u32 s47, s46, 0xee000
    buffer_load_dwordx4 v3, s[24:27], s47 offen lds
    s_add_u32 m0, s45, 35840
    s_add_u32 s47, s46, 0xf5000
    buffer_load_dwordx4 v3, s[24:27], s47 offen lds
    s_add_u32 m0, s45, 49152
    s_add_u32 s47, s46, 0x150000
    buffer_load_dwordx4 v3, s[24:27], s47 offen lds
    s_add_u32 m0, s45, 50176
    s_add_u32 s47, s46, 0x157000
    buffer_load_dwordx4 v3, s[24:27], s47 offen lds
    s_add_u32 m0, s45, 51200
    s_add_u32 s47, s46, 0x15e000
    buffer_load_dwordx4 v3, s[24:27], s47 offen lds
    s_add_u32 m0, s45, 52224
    s_add_u32 s47, s46, 0x165000
    buffer_load_dwordx4 v3, s[24:27], s47 offen lds
    s_waitcnt vmcnt(12) lgkmcnt(0)
    s_barrier
    ds_read_b64_tr_b16 a[0:1], v5 offset:0
    ds_read_b64_tr_b16 a[2:3], v5 offset:1024
    ds_read_b64_tr_b16 a[4:5], v5 offset:4096
    ds_read_b64_tr_b16 a[6:7], v5 offset:5120
    ds_read_b64_tr_b16 a[8:9], v5 offset:8192
    ds_read_b64_tr_b16 a[10:11], v5 offset:9216
    ds_read_b64_tr_b16 a[12:13], v5 offset:12288
    ds_read_b64_tr_b16 a[14:15], v5 offset:13312
    s_waitcnt vmcnt(8) lgkmcnt(0)
    s_barrier
    s_add_u32 m0, s45, 0
    s_add_u32 s47, s46, 0x1c0000
    buffer_load_dwordx4 v3, s[24:27], s47 offen lds
    s_add_u32 m0, s45, 1024
    s_add_u32 s47, s46, 0x1c7000
    buffer_load_dwordx4 v3, s[24:27], s47 offen lds
    s_add_u32 m0, s45, 2048
    s_add_u32 s47, s46, 0x1ce000
    buffer_load_dwordx4 v3, s[24:27], s47 offen lds
    s_add_u32 m0, s45, 3072
    s_add_u32 s47, s46, 0x1d5000
    buffer_load_dwordx4 v3, s[24:27], s47 offen lds
    ds_read_b64_tr_b16 a[16:17], v5 offset:16384
    ds_read_b64_tr_b16 a[18:19], v5 offset:17408
    ds_read_b64_tr_b16 a[20:21], v5 offset:20480
    ds_read_b64_tr_b16 a[22:23], v5 offset:21504
    ds_read_b64_tr_b16 a[24:25], v5 offset:24576
    ds_read_b64_tr_b16 a[26:27], v5 offset:25600
    ds_read_b64_tr_b16 a[28:29], v5 offset:28672
    ds_read_b64_tr_b16 a[30:31], v5 offset:29696
    s_waitcnt vmcnt(8) lgkmcnt(0)
    s_barrier
    s_add_u32 m0, s45, 16384
    s_add_u32 s47, s46, 0x230000
    buffer_load_dwordx4 v3, s[24:27], s47 offen lds
    s_add_u32 m0, s45, 17408
    s_add_u32 s47, s46, 0x237000
    buffer_load_dwordx4 v3, s[24:27], s47 offen lds
    s_add_u32 m0, s45, 18432
    s_add_u32 s47, s46, 0x23e000
    buffer_load_dwordx4 v3, s[24:27], s47 offen lds
    s_add_u32 m0, s45, 19456
    s_add_u32 s47, s46, 0x245000
    buffer_load_dwordx4 v3, s[24:27], s47 offen lds
    ds_read_b64_tr_b16 a[32:33], v5 offset:32768
    ds_read_b64_tr_b16 a[34:35], v5 offset:33792
    ds_read_b64_tr_b16 a[36:37], v5 offset:36864
    ds_read_b64_tr_b16 a[38:39], v5 offset:37888
    ds_read_b64_tr_b16 a[40:41], v5 offset:40960
    ds_read_b64_tr_b16 a[42:43], v5 offset:41984
    ds_read_b64_tr_b16 a[44:45], v5 offset:45056
    ds_read_b64_tr_b16 a[46:47], v5 offset:46080
    s_waitcnt vmcnt(8) lgkmcnt(0)
    s_barrier
    s_add_u32 m0, s45, 32768
    s_add_u32 s47, s46, 0x2a0000
    buffer_load_dwordx4 v3, s[24:27], s47 offen lds
    s_add_u32 m0, s45, 33792
    s_add_u32 s47, s46, 0x2a7000
    buffer_load_dwordx4 v3, s[24:27], s47 offen lds
    s_add_u32 m0, s45, 34816
    s_add_u32 s47, s46, 0x2ae000
    buffer_load_dwordx4 v3, s[24:27], s47 offen lds
    s_add_u32 m0, s45, 35840
    s_add_u32 s47, s46, 0x2b5000
    buffer_load_dwordx4 v3, s[24:27], s47 offen lds
    ds_read_b64_tr_b16 a[48:49], v5 offset:49152
    ds_read_b64_tr_b16 a[50:51], v5 offset:50176
    ds_read_b64_tr_b16 a[52:53], v5 offset:53248
    ds_read_b64_tr_b16 a[54:55], v5 offset:54272
    ds_read_b64_tr_b16 a[56:57], v5 offset:57344
    ds_read_b64_tr_b16 a[58:59], v5 offset:58368
    ds_read_b64_tr_b16 a[60:61], v5 offset:61440
    ds_read_b64_tr_b16 a[62:63], v5 offset:62464
    s_waitcnt vmcnt(8) lgkmcnt(0)
    s_barrier
    s_add_u32 m0, s45, 49152
    s_add_u32 s47, s46, 0x310000
    buffer_load_dwordx4 v3, s[24:27], s47 offen lds
    s_add_u32 m0, s45, 50176
    s_add_u32 s47, s46, 0x317000
    buffer_load_dwordx4 v3, s[24:27], s47 offen lds
    s_add_u32 m0, s45, 51200
    s_add_u32 s47, s46, 0x31e000
    buffer_load_dwordx4 v3, s[24:27], s47 offen lds
    s_add_u32 m0, s45, 52224
    s_add_u32 s47, s46, 0x325000
    buffer_load_dwordx4 v3, s[24:27], s47 offen lds
    ds_read_b64_tr_b16 a[64:65], v5 offset:0
    ds_read_b64_tr_b16 a[66:67], v5 offset:1024
    ds_read_b64_tr_b16 a[68:69], v5 offset:4096
    ds_read_b64_tr_b16 a[70:71], v5 offset:5120
    ds_read_b64_tr_b16 a[72:73], v5 offset:8192
    ds_read_b64_tr_b16 a[74:75], v5 offset:9216
    ds_read_b64_tr_b16 a[76:77], v5 offset:12288
    ds_read_b64_tr_b16 a[78:79], v5 offset:13312
    s_waitcnt vmcnt(8) lgkmcnt(0)
    s_barrier
    ds_read_b64_tr_b16 a[80:81], v5 offset:16384
    ds_read_b64_tr_b16 a[82:83], v5 offset:17408
    ds_read_b64_tr_b16 a[84:85], v5 offset:20480
    ds_read_b64_tr_b16 a[86:87], v5 offset:21504
    ds_read_b64_tr_b16 a[88:89], v5 offset:24576
    ds_read_b64_tr_b16 a[90:91], v5 offset:25600
    ds_read_b64_tr_b16 a[92:93], v5 offset:28672
    ds_read_b64_tr_b16 a[94:95], v5 offset:29696
    s_waitcnt vmcnt(4) lgkmcnt(0)
    s_barrier
    ds_read_b64_tr_b16 a[96:97], v5 offset:32768
    ds_read_b64_tr_b16 a[98:99], v5 offset:33792
    ds_read_b64_tr_b16 a[100:101], v5 offset:36864
    ds_read_b64_tr_b16 a[102:103], v5 offset:37888
    ds_read_b64_tr_b16 a[104:105], v5 offset:40960
    ds_read_b64_tr_b16 a[106:107], v5 offset:41984
    ds_read_b64_tr_b16 a[108:109], v5 offset:45056
    ds_read_b64_tr_b16 a[110:111], v5 offset:46080
    s_waitcnt vmcnt(0) lgkmcnt(0)
    s_barrier
    ds_read_b64_tr_b16 a[112:113], v5 offset:49152
    ds_read_b64_tr_b16 a[114:115], v5 offset:50176
    ds_read_b64_tr_b16 a[116:117], v5 offset:53248
    ds_read_b64_tr_b16 a[118:119], v5 offset:54272
    ds_read_b64_tr_b16 a[120:121], v5 offset:57344
    ds_read_b64_tr_b16 a[122:123], v5 offset:58368
    ds_read_b64_tr_b16 a[124:125], v5 offset:61440
    ds_read_b64_tr_b16 a[126:127], v5 offset:62464
    s_waitcnt lgkmcnt(0)
    s_barrier
    v_lshlrev_b32 v2, 4, v1
    s_mul_i32 s64, s44, 8192
    s_add_u32 s46, s64, 0xc00000
    v_add_u32 v3, s46, v2
    s_mul_i32 s46, s51, 32768
    v_add_u32 v4, s46, v2
    v_and_b32 v6, 15, v1
    v_lshlrev_b32 v6, 4, v6
    v_lshrrev_b32 v7, 4, v1
    v_lshl_add_u32 v6, v7, 9, v6
    s_lshl_b32 s46, s50, 12
    s_add_u32 s46, s46, 131072
    v_add_u32 v5, s46, v2
    v_and_b32 v7, 3, v1
    v_lshlrev_b32 v7, 7, v7
    v_add_u32 v7, 0x10ec00, v7
    s_lshl_b32 s46, s49, 13
    s_lshl_b32 s47, s50, 11
    s_add_u32 s46, s46, s47
    s_add_u32 s46, s46, 0x6000000
    v_add_u32 v8, s46, v2
    s_lshl_b32 s52, s49, 7
    s_add_u32 s52, s52, 0x106400
    s_add_u32 s52, s52, s76
    s_mov_b32 s28, s6
    s_and_b32 s29, s7, 0xffff
    s_mov_b32 s30, 0x1c00
    s_mov_b32 s31, 0x00020000
    s_lshl_b32 s46, s49, 8
    s_lshl_b32 s47, s50, 6
    s_add_u32 s46, s46, s47
    v_lshrrev_b32 v9, 5, v1
    v_lshlrev_b32 v9, 3, v9
    buffer_load_dwordx2 v[32:33], v9, s[28:31], s46 offen offset:0
    buffer_load_dwordx2 v[34:35], v9, s[28:31], s46 offen offset:16
    buffer_load_dwordx2 v[36:37], v9, s[28:31], s46 offen offset:32
    buffer_load_dwordx2 v[38:39], v9, s[28:31], s46 offen offset:48
    v_add_u32 v9, 1024, v8
    s_mov_b32 s56, 0xbdd2d3e8
    s_mov_b32 s57, 0xbdd2d3e8
    v_mov_b32 v112, 0xc0135761
    s_waitcnt vmcnt(0)
    v_lshlrev_b32 v64, 16, v32
    v_and_b32 v65, 0xffff0000, v32
    v_lshlrev_b32 v66, 16, v33
    v_and_b32 v67, 0xffff0000, v33
    v_lshlrev_b32 v68, 16, v34
    v_and_b32 v69, 0xffff0000, v34
    v_lshlrev_b32 v70, 16, v35
    v_and_b32 v71, 0xffff0000, v35
    v_lshlrev_b32 v72, 16, v36
    v_and_b32 v73, 0xffff0000, v36
    v_lshlrev_b32 v74, 16, v37
    v_and_b32 v75, 0xffff0000, v37
    v_lshlrev_b32 v76, 16, v38
    v_and_b32 v77, 0xffff0000, v38
    v_lshlrev_b32 v78, 16, v39
    v_and_b32 v79, 0xffff0000, v39
    s_mul_i32 s46, s43, 8192
    s_add_u32 s46, s46, 0xc00000
    s_mul_i32 s47, s42, 0
    s_add_u32 s46, s46, s47
    v_min_u32 v116, 63, v1
    v_lshlrev_b32 v116, 7, v116
    v_add_u32 v116, s46, v116
    s_mov_b32 s60, s74
    s_mul_i32 s61, s74, 65536
    s_mov_b32 s62, s74
    s_mul_i32 s63, s74, 229376
    s_mov_b32 s67, 0
    s_mov_b32 s68, 3
    s_mov_b32 s71, 0
    v_mov_b32 v15, 147456
    v_mov_b32 v14, 0
    ds_write_b32 v15, v14 offset:4
    ds_write_b32 v15, v14 offset:12
    ds_write_b32 v15, v14 offset:16
    v_mov_b32 v114, 1
    v_mov_b32 v115, 0
    s_mov_b32 s81, 0
    s_lshl_b32 s46, s44, 5
    v_add_u32 v119, s46, v15
    v_lshrrev_b32 v113, 4, v1
    s_mov_b32 s72, 0
L_g_restart_88:
    s_cmp_lg_u32 s44, 0
    s_cbranch_scc1 L_g_nsp_89
    s_mov_b32 s70, 0
L_g_sp_95:
    s_add_u32 s54, s60, 0
    v_add_u32 v12, s54, v113
    v_mul_u32_u24 v13, 171, v12
    v_lshrrev_b32 v13, 9, v13
    v_mad_i32_i24 v13, v13, -3, v12
    v_lshl_add_u32 v13, v13, 9, v7
    buffer_load_dword v11, v13, s[12:15], 0 offen sc1
    s_waitcnt vmcnt(0)
    v_cmp_ge_u32 vcc, v12, v11
    s_add_u32 s70, s70, 1
    s_and_b32 s46, vcc_lo, 0xffff
    s_cbranch_scc0 L_g_sp_95_ok
    s_sleep 3
    s_cmp_lt_u32 s70, 524288
    s_cbranch_scc1 L_g_sp_95
    s_branch L_c_done_1
L_g_sp_95_ok:
    v_cmp_ge_u32 vcc, v12, v11
    s_nop 0
    s_ff1_i32_b64 s46, vcc
    s_lshr_b32 s46, s46, 4
    s_min_u32 s46, s46, 4
    s_add_u32 s46, s46, s54
    s_min_u32 s46, s46, s75
    v_mov_b32 v118, s46
    ds_write_b32 v15, v118 offset:20
L_g_nsp_89:
    s_waitcnt lgkmcnt(0)
    s_barrier
    ds_read_b32 v14, v15 offset:20
    s_waitcnt lgkmcnt(0)
    v_readfirstlane_b32 s66, v14
    s_nop 3
L_g_restart_88_go:
    s_mov_b32 s69, 0
    s_cmp_gt_u32 s62, s60
    s_cbranch_scc1 L_g_nd_96
    s_cmp_ge_u32 s62, s66
    s_cbranch_scc1 L_g_nd_96
    s_add_u32 s47, s61, 4096
    s_add_u32 m0, s64, 0
    s_nop 0
    buffer_load_dwordx4 v3, s[12:15], s61 offen offset:0 sc1 lds
    buffer_load_dwordx4 v3, s[12:15], s61 offen offset:1024 sc1 lds
    buffer_load_dwordx4 v3, s[12:15], s61 offen offset:2048 sc1 lds
    buffer_load_dwordx4 v3, s[12:15], s61 offen offset:3072 sc1 lds
    s_add_u32 m0, s64, 4096
    s_nop 0
    buffer_load_dwordx4 v3, s[12:15], s47 offen offset:0 sc1 lds
    buffer_load_dwordx4 v3, s[12:15], s47 offen offset:1024 sc1 lds
    buffer_load_dwordx4 v3, s[12:15], s47 offen offset:2048 sc1 lds
    buffer_load_dwordx4 v3, s[12:15], s47 offen offset:3072 sc1 lds
    s_add_u32 s61, s61, 65536
    s_add_u32 s62, s62, 1
    s_xor_b32 s64, s64, 0x10000
    s_mov_b32 s69, 1
L_g_nd_96:
    s_cmp_eq_u32 s51, 1
    s_cbranch_scc1 L_g_g1r_90
    s_add_u32 s59, s60, 1
    s_mov_b32 s69, 0
    s_cmp_gt_u32 s62, s59
    s_cbranch_scc1 L_g_nd_97
    s_cmp_ge_u32 s62, s66
    s_cbranch_scc1 L_g_nd_97
    s_add_u32 s47, s61, 4096
    s_add_u32 m0, s64, 0
    s_nop 0
    buffer_load_dwordx4 v3, s[12:15], s61 offen offset:0 sc1 lds
    buffer_load_dwordx4 v3, s[12:15], s61 offen offset:1024 sc1 lds
    buffer_load_dwordx4 v3, s[12:15], s61 offen offset:2048 sc1 lds
    buffer_load_dwordx4 v3, s[12:15], s61 offen offset:3072 sc1 lds
    s_add_u32 m0, s64, 4096
    s_nop 0
    buffer_load_dwordx4 v3, s[12:15], s47 offen offset:0 sc1 lds
    buffer_load_dwordx4 v3, s[12:15], s47 offen offset:1024 sc1 lds
    buffer_load_dwordx4 v3, s[12:15], s47 offen offset:2048 sc1 lds
    buffer_load_dwordx4 v3, s[12:15], s47 offen offset:3072 sc1 lds
    s_add_u32 s61, s61, 65536
    s_add_u32 s62, s62, 1
    s_xor_b32 s64, s64, 0x10000
    s_mov_b32 s69, 1
L_g_nd_97:
    s_cmp_eq_u32 s69, 1
    s_cbranch_scc1 L_g_w0_98
    s_waitcnt vmcnt(0)
L_g_w0_98:
    s_waitcnt vmcnt(8)
    s_cmp_lg_u32 s44, 0
    s_cbranch_scc1 L_g_nl_99
    s_cmp_lt_u32 s66, s75
    s_cselect_b32 s81, 1, 2
L_g_nl_99:
L_g_loop0_91_l:
    s_barrier
    ds_read_b128 v[32:35], v4 offset:0
    ds_read_b128 v[36:39], v4 offset:1024
    ds_read_b128 v[40:43], v4 offset:2048
    ds_read_b128 v[44:47], v4 offset:3072
    ds_read_b128 v[48:51], v4 offset:4096
    ds_read_b128 v[52:55], v4 offset:5120
    ds_read_b128 v[56:59], v4 offset:6144
    ds_read_b128 v[60:63], v4 offset:7168
    s_branch L_g_loop0_91_m
.p2align 6
L_g_loop0_91:
    s_barrier
L_g_loop0_91_m:
    s_setprio 2
    s_waitcnt lgkmcnt(6)
    v_mfma_f32_32x32x16_bf16 v[16:31], a[0:3], v[32:35], v[64:79]
    ds_read_b128 v[32:35], v4 offset:8192
    v_mfma_f32_32x32x16_bf16 v[16:31], a[4:7], v[36:39], v[16:31]
    ds_read_b128 v[36:39], v4 offset:9216
    s_cmp_eq_u32 s81, 1
    s_cbranch_scc1 L_g_h1_103
L_g_h1_103_b:
    s_waitcnt lgkmcnt(6)
    v_mfma_f32_32x32x16_bf16 v[16:31], a[8:11], v[40:43], v[16:31]
    ds_read_b128 v[40:43], v4 offset:10240
    v_mfma_f32_32x32x16_bf16 v[16:31], a[12:15], v[44:47], v[16:31]
    ds_read_b128 v[44:47], v4 offset:11264
    s_waitcnt lgkmcnt(6)
    v_mfma_f32_32x32x16_bf16 v[16:31], a[16:19], v[48:51], v[16:31]
    ds_read_b128 v[48:51], v4 offset:12288
    v_mfma_f32_32x32x16_bf16 v[16:31], a[20:23], v[52:55], v[16:31]
    ds_read_b128 v[52:55], v4 offset:13312
    s_waitcnt lgkmcnt(6)
    v_mfma_f32_32x32x16_bf16 v[16:31], a[24:27], v[56:59], v[16:31]
    ds_read_b128 v[56:59], v4 offset:14336
    v_mfma_f32_32x32x16_bf16 v[16:31], a[28:31], v[60:63], v[16:31]
    ds_read_b128 v[60:63], v4 offset:15360
    s_waitcnt lgkmcnt(6)
    v_mfma_f32_32x32x16_bf16 v[16:31], a[32:35], v[32:35], v[16:31]
    ds_read_b128 v[32:35], v4 offset:16384
    v_mfma_f32_32x32x16_bf16 v[16:31], a[36:39], v[36:39], v[16:31]
    ds_read_b128 v[36:39], v4 offset:17408
    s_waitcnt lgkmcnt(6)
    v_mfma_f32_32x32x16_bf16 v[16:31], a[40:43], v[40:43], v[16:31]
    ds_read_b128 v[40:43], v4 offset:18432
    v_mfma_f32_32x32x16_bf16 v[16:31], a[44:47], v[44:47], v[16:31]
    ds_read_b128 v[44:47], v4 offset:19456
    s_waitcnt lgkmcnt(6)
    v_mfma_f32_32x32x16_bf16 v[16:31], a[48:51], v[48:51], v[16:31]
    ds_read_b128 v[48:51], v4 offset:20480
    v_mfma_f32_32x32x16_bf16 v[16:31], a[52:55], v[52:55], v[16:31]
    ds_read_b128 v[52:55], v4 offset:21504
    s_waitcnt lgkmcnt(6)
    v_mfma_f32_32x32x16_bf16 v[16:31], a[56:59], v[56:59], v[16:31]
    ds_read_b128 v[56:59], v4 offset:22528
    v_mfma_f32_32x32x16_bf16 v[16:31], a[60:63], v[60:63], v[16:31]
    ds_read_b128 v[60:63], v4 offset:23552
    s_waitcnt lgkmcnt(6)
    v_mfma_f32_32x32x16_bf16 v[16:31], a[64:67], v[32:35], v[16:31]
    ds_read_b128 v[32:35], v4 offset:24576
    v_mfma_f32_32x32x16_bf16 v[16:31], a[68:71], v[36:39], v[16:31]
    ds_read_b128 v[36:39], v4 offset:25600
    s_waitcnt lgkmcnt(6)
    v_mfma_f32_32x32x16_bf16 v[16:31], a[72:75], v[40:43], v[16:31]
    ds_read_b128 v[40:43], v4 offset:26624
    v_mfma_f32_32x32x16_bf16 v[16:31], a[76:79], v[44:47], v[16:31]
    ds_read_b128 v[44:47], v4 offset:27648
    s_waitcnt lgkmcnt(6)
    v_mfma_f32_32x32x16_bf16 v[16:31], a[80:83], v[48:51], v[16:31]
    ds_read_b128 v[48:51], v4 offset:28672
    v_mfma_f32_32x32x16_bf16 v[16:31], a[84:87], v[52:55], v[16:31]
    ds_read_b128 v[52:55], v4 offset:29696
    s_waitcnt lgkmcnt(6)
    v_mfma_f32_32x32x16_bf16 v[16:31], a[88:91], v[56:59], v[16:31]
    ds_read_b128 v[56:59], v4 offset:30720
    v_mfma_f32_32x32x16_bf16 v[16:31], a[92:95], v[60:63], v[16:31]
    ds_read_b128 v[60:63], v4 offset:31744
    s_waitcnt lgkmcnt(6)
    v_mfma_f32_32x32x16_bf16 v[16:31], a[96:99], v[32:35], v[16:31]
    v_mfma_f32_32x32x16_bf16 v[16:31], a[100:103], v[36:39], v[16:31]
    s_waitcnt lgkmcnt(4)
    v_mfma_f32_32x32x16_bf16 v[16:31], a[104:107], v[40:43], v[16:31]
    v_mfma_f32_32x32x16_bf16 v[16:31], a[108:111], v[44:47], v[16:31]
    s_waitcnt lgkmcnt(2)
    v_mfma_f32_32x32x16_bf16 v[16:31], a[112:115], v[48:51], v[16:31]
    s_cmp_eq_u32 s81, 1
    s_cbranch_scc1 L_g_h2_104
L_g_h2_104_b:
    ds_write_b32 v119, v118
    v_mfma_f32_32x32x16_bf16 v[16:31], a[116:119], v[52:55], v[16:31]
    s_waitcnt lgkmcnt(0)
    v_mfma_f32_32x32x16_bf16 v[16:31], a[120:123], v[56:59], v[16:31]
    v_mfma_f32_32x32x16_bf16 v[16:31], a[124:127], v[60:63], v[16:31]
    v_xor_b32 v4, 0x10000, v4
    s_setprio 0
    s_waitcnt vmcnt(0)
    s_waitcnt lgkmcnt(0)
    s_barrier
    ds_read_b32 v14, v15
    s_nop 6
    ds_write_b128 v5, v[16:19] offset:0
    ds_write_b128 v5, v[20:23] offset:1024
    ds_write_b128 v5, v[24:27] offset:2048
    ds_write_b128 v5, v[28:31] offset:3072
    s_waitcnt lgkmcnt(4)
    v_readfirstlane_b32 s66, v14
    s_add_u32 s60, s60, 1
    s_mov_b32 s65, 0
    s_cmp_le_u32 s62, s60
    s_cbranch_scc1 L_g_dp_105_l
L_g_dp_105_a:
    s_cmp_ge_u32 s62, s66
    s_cbranch_scc1 L_g_dp_105_d
    s_add_u32 s47, s61, 4096
    s_mov_b32 m0, s64
    s_add_u32 s62, s62, 1
    buffer_load_dwordx4 v3, s[12:15], s61 offen offset:0 sc1 lds
    buffer_load_dwordx4 v3, s[12:15], s61 offen offset:1024 sc1 lds
    buffer_load_dwordx4 v3, s[12:15], s61 offen offset:2048 sc1 lds
    buffer_load_dwordx4 v3, s[12:15], s61 offen offset:3072 sc1 lds
    s_add_u32 m0, s64, 4096
    s_add_u32 s61, s61, 65536
    buffer_load_dwordx4 v3, s[12:15], s47 offen offset:0 sc1 lds
    buffer_load_dwordx4 v3, s[12:15], s47 offen offset:1024 sc1 lds
    buffer_load_dwordx4 v3, s[12:15], s47 offen offset:2048 sc1 lds
    buffer_load_dwordx4 v3, s[12:15], s47 offen offset:3072 sc1 lds
    s_xor_b32 s64, s64, 0x10000
L_g_dp_105_d:
    s_cmp_lg_u32 s44, 2
    s_cbranch_scc1 L_g_pf_106
    s_cmp_ge_u32 s62, s66
    s_cbranch_scc1 L_g_pf_106
    buffer_load_dword v117, v116, s[12:15], s61 offen sc1
L_g_pf_106:
    s_cmp_le_u32 s66, s60
    s_cbranch_scc1 L_g_ex0_102
    s_cmp_lg_u32 s65, 0
    s_cbranch_scc1 L_g_nw_101
    ds_read_b128 v[32:35], v4 offset:0
    ds_read_b128 v[36:39], v4 offset:1024
    ds_read_b128 v[40:43], v4 offset:2048
    ds_read_b128 v[44:47], v4 offset:3072
    ds_read_b128 v[48:51], v4 offset:4096
    ds_read_b128 v[52:55], v4 offset:5120
    ds_read_b128 v[56:59], v4 offset:6144
    ds_read_b128 v[60:63], v4 offset:7168
    s_cmp_lg_u32 s44, 0
    s_cbranch_scc1 L_g_nl_107
    s_mov_b32 s46, s66
    s_cmp_lg_u32 s81, 0
    s_cbranch_scc1 L_g_nl_107_e
    v_cmp_ge_u32 vcc, v12, v11
    s_nop 0
    s_ff1_i32_b64 s46, vcc
    s_lshr_b32 s46, s46, 4
    s_min_u32 s46, s46, 4
    s_add_u32 s46, s46, s54
    s_min_u32 s46, s46, s75
    v_mov_b32 v118, s46
L_g_nl_107_e:
    s_add_u32 s47, s60, 3
    s_min_u32 s47, s47, s75
    s_cmp_lt_u32 s46, s47
    s_cselect_b32 s81, 1, 0
    s_cbranch_scc1 L_g_nl_107
    s_add_u32 s54, s60, 2
    v_add_u32 v12, s54, v113
    v_mul_u32_u24 v13, 171, v12
    v_lshrrev_b32 v13, 9, v13
    v_mad_i32_i24 v13, v13, -3, v12
    v_lshl_add_u32 v13, v13, 9, v7
    buffer_load_dword v11, v13, s[12:15], 0 offen sc1
L_g_nl_107:
    s_waitcnt lgkmcnt(8)
    s_branch L_g_loop0_91
L_g_ex0_102:
    s_cmp_lg_u32 s44, 0
    s_cbranch_scc1 L_g_ex0_102_n
    ds_write_b32 v15, v118 offset:20
    s_cmp_ge_u32 s60, s75
    s_cbranch_scc1 L_g_ex0_102_n
    s_sleep 6
    s_add_u32 s54, s60, 0
    v_add_u32 v12, s54, v113
    v_mul_u32_u24 v13, 171, v12
    v_lshrrev_b32 v13, 9, v13
    v_mad_i32_i24 v13, v13, -3, v12
    v_lshl_add_u32 v13, v13, 9, v7
    buffer_load_dword v11, v13, s[12:15], 0 offen sc1
    s_waitcnt vmcnt(0)
    v_cmp_ge_u32 vcc, v12, v11
    s_nop 0
    s_ff1_i32_b64 s46, vcc
    s_lshr_b32 s46, s46, 4
    s_min_u32 s46, s46, 4
    s_add_u32 s46, s46, s54
    s_min_u32 s46, s46, s75
    v_mov_b32 v118, s46
    ds_write_b32 v15, v118 offset:20
L_g_ex0_102_n:
    s_waitcnt lgkmcnt(0)
    s_barrier
    ds_read_b32 v14, v15 offset:20
    s_waitcnt lgkmcnt(0)
    v_readfirstlane_b32 s66, v14
    s_barrier
    s_cmp_gt_u32 s66, s60
    s_cbranch_scc1 L_g_restart_88_go
    s_branch L_g_tail_93
L_g_g1r_90:
    s_mov_b32 s65, 1
    s_branch L_g_loop1_92_e
.p2align 6
L_g_loop1_92:
    s_mov_b32 s65, 0
L_g_loop1_92_e:
    s_barrier
    s_bitcmp1_b32 s67, 2
    s_cbranch_scc0 L_g_nfl_108
    s_cmp_lg_u32 s44, 4
    s_cbranch_scc1 L_g_nfl_108_d
    s_sub_u32 s59, s60, 2
    v_mov_b32 v10, s59
    buffer_store_dword v10, v115, s[12:15], s52 offen sc1
L_g_nfl_108_d:
    ds_read_b128 v[80:83], v5 offset:0
    ds_read_b128 v[84:87], v5 offset:1024
    ds_read_b128 v[88:91], v5 offset:2048
    ds_read_b128 v[92:95], v5 offset:3072
    s_cmp_le_u32 s62, s60
    s_cbranch_scc1 L_g_dp_113_l
L_g_dp_113_a:
    s_cmp_ge_u32 s62, s66
    s_cbranch_scc1 L_g_dp_113_d
    s_add_u32 s47, s61, 4096
    s_mov_b32 m0, s64
    s_add_u32 s62, s62, 1
    buffer_load_dwordx4 v3, s[12:15], s61 offen offset:0 sc1 lds
    buffer_load_dwordx4 v3, s[12:15], s61 offen offset:1024 sc1 lds
    buffer_load_dwordx4 v3, s[12:15], s61 offen offset:2048 sc1 lds
    buffer_load_dwordx4 v3, s[12:15], s61 offen offset:3072 sc1 lds
    s_add_u32 m0, s64, 4096
    s_add_u32 s61, s61, 65536
    buffer_load_dwordx4 v3, s[12:15], s47 offen offset:0 sc1 lds
    buffer_load_dwordx4 v3, s[12:15], s47 offen offset:1024 sc1 lds
    buffer_load_dwordx4 v3, s[12:15], s47 offen offset:2048 sc1 lds
    buffer_load_dwordx4 v3, s[12:15], s47 offen offset:3072 sc1 lds
    s_xor_b32 s64, s64, 0x10000
L_g_dp_113_d:
    s_bitcmp1_b32 s67, 0
    s_cbranch_scc0 L_g_nep_109
    s_waitcnt lgkmcnt(0)
    v_add_f32 v80, v80, v16
    v_add_f32 v81, v81, v17
    v_add_f32 v82, v82, v18
    v_add_f32 v83, v83, v19
    v_add_f32 v84, v84, v20
    v_add_f32 v85, v85, v21
    v_add_f32 v86, v86, v22
    v_add_f32 v87, v87, v23
    v_add_f32 v88, v88, v24
    v_add_f32 v89, v89, v25
    v_add_f32 v90, v90, v26
    v_add_f32 v91, v91, v27
    v_add_f32 v92, v92, v28
    v_add_f32 v93, v93, v29
    v_add_f32 v94, v94, v30
    v_add_f32 v95, v95, v31
L_g_nep_109:
    v_mul_f32 v96, v80, v80
    v_mul_f32 v97, v81, v81
    v_mul_f32 v98, v82, v82
    v_mul_f32 v99, v83, v83
    v_mul_f32 v100, v84, v84
    v_mul_f32 v101, v85, v85
    v_mul_f32 v102, v86, v86
    v_mul_f32 v103, v87, v87
    v_fma_f32 v96, v96, s56, v112
    v_fma_f32 v97, v97, s56, v112
    v_fma_f32 v98, v98, s56, v112
    v_fma_f32 v99, v99, s56, v112
    v_fma_f32 v100, v100, s56, v112
    v_fma_f32 v101, v101, s56, v112
    v_fma_f32 v102, v102, s56, v112
    v_fma_f32 v103, v103, s56, v112
    v_mul_f32 v96, v96, v80
    v_mul_f32 v97, v97, v81
    v_mul_f32 v98, v98, v82
    v_mul_f32 v99, v99, v83
    v_mul_f32 v100, v100, v84
    v_mul_f32 v101, v101, v85
    v_mul_f32 v102, v102, v86
    v_mul_f32 v103, v103, v87
    v_exp_f32 v96, v96
    v_exp_f32 v97, v97
    v_exp_f32 v98, v98
    v_exp_f32 v99, v99
    v_exp_f32 v100, v100
    v_exp_f32 v101, v101
    v_exp_f32 v102, v102
    v_exp_f32 v103, v103
    v_add_f32 v96, 1.0, v96
    v_add_f32 v97, 1.0, v97
    v_add_f32 v98, 1.0, v98
    v_add_f32 v99, 1.0, v99
    v_add_f32 v100, 1.0, v100
    v_add_f32 v101, 1.0, v101
    v_add_f32 v102, 1.0, v102
    v_add_f32 v103, 1.0, v103
    v_rcp_f32 v96, v96
    v_rcp_f32 v97, v97
    v_rcp_f32 v98, v98
    v_rcp_f32 v99, v99
    v_rcp_f32 v100, v100
    v_rcp_f32 v101, v101
    v_rcp_f32 v102, v102
    v_rcp_f32 v103, v103
    v_mul_f32 v80, v80, v96
    v_mul_f32 v81, v81, v97
    s_cmp_lg_u32 s65, 0
    s_cbranch_scc1 L_g_nw1_110
    ds_read_b128 v[32:35], v4 offset:0
    ds_read_b128 v[36:39], v4 offset:1024
    ds_read_b128 v[40:43], v4 offset:2048
    ds_read_b128 v[44:47], v4 offset:3072
    ds_read_b128 v[48:51], v4 offset:4096
    ds_read_b128 v[52:55], v4 offset:5120
    ds_read_b128 v[56:59], v4 offset:6144
    ds_read_b128 v[60:63], v4 offset:7168
    s_barrier
L_g_jn_112:
    s_bitcmp1_b32 s67, 0
    s_cbranch_scc0 L_g_mm2_111
    s_setprio 1
    s_waitcnt lgkmcnt(6)
    v_mfma_f32_32x32x16_bf16 v[16:31], a[0:3], v[32:35], 0
    ds_read_b128 v[32:35], v4 offset:8192
    ds_read_b32 v14, v15
    v_mul_f32 v82, v82, v98
    v_mul_f32 v83, v83, v99
    v_mul_f32 v84, v84, v100
    v_mfma_f32_32x32x16_bf16 v[16:31], a[4:7], v[36:39], v[16:31]
    ds_read_b128 v[36:39], v4 offset:9216
    v_mul_f32 v85, v85, v101
    v_mul_f32 v86, v86, v102
    v_mul_f32 v87, v87, v103
    v_cvt_pk_bf16_f32 v104, v80, v81
    s_waitcnt lgkmcnt(6)
    v_mfma_f32_32x32x16_bf16 v[16:31], a[8:11], v[40:43], v[16:31]
    ds_read_b128 v[40:43], v4 offset:10240
    v_cvt_pk_bf16_f32 v105, v82, v83
    v_cvt_pk_bf16_f32 v106, v84, v85
    v_cvt_pk_bf16_f32 v107, v86, v87
    buffer_store_dwordx4 v[104:107], v8, s[12:15], s63 offen sc1
    v_mfma_f32_32x32x16_bf16 v[16:31], a[12:15], v[44:47], v[16:31]
    ds_read_b128 v[44:47], v4 offset:11264
    v_mul_f32 v96, v88, v88
    v_mul_f32 v97, v89, v89
    v_mul_f32 v98, v90, v90
    v_mul_f32 v99, v91, v91
    s_waitcnt lgkmcnt(6)
    v_mfma_f32_32x32x16_bf16 v[16:31], a[16:19], v[48:51], v[16:31]
    ds_read_b128 v[48:51], v4 offset:12288
    v_mul_f32 v100, v92, v92
    v_mul_f32 v101, v93, v93
    v_mul_f32 v102, v94, v94
    v_mul_f32 v103, v95, v95
    v_mfma_f32_32x32x16_bf16 v[16:31], a[20:23], v[52:55], v[16:31]
    ds_read_b128 v[52:55], v4 offset:13312
    v_fma_f32 v96, v96, s56, v112
    v_fma_f32 v97, v97, s56, v112
    v_fma_f32 v98, v98, s56, v112
    v_fma_f32 v99, v99, s56, v112
    s_waitcnt lgkmcnt(6)
    v_mfma_f32_32x32x16_bf16 v[16:31], a[24:27], v[56:59], v[16:31]
    ds_read_b128 v[56:59], v4 offset:14336
    v_fma_f32 v100, v100, s56, v112
    v_fma_f32 v101, v101, s56, v112
    v_fma_f32 v102, v102, s56, v112
    v_fma_f32 v103, v103, s56, v112
    v_mfma_f32_32x32x16_bf16 v[16:31], a[28:31], v[60:63], v[16:31]
    ds_read_b128 v[60:63], v4 offset:15360
    v_mul_f32 v96, v96, v88
    v_mul_f32 v97, v97, v89
    v_mul_f32 v98, v98, v90
    v_mul_f32 v99, v99, v91
    s_waitcnt lgkmcnt(6)
    v_mfma_f32_32x32x16_bf16 v[16:31], a[32:35], v[32:35], v[16:31]
    ds_read_b128 v[32:35], v4 offset:16384
    v_mul_f32 v100, v100, v92
    v_mul_f32 v101, v101, v93
    v_mul_f32 v102, v102, v94
    v_mul_f32 v103, v103, v95
    v_mfma_f32_32x32x16_bf16 v[16:31], a[36:39], v[36:39], v[16:31]
    ds_read_b128 v[36:39], v4 offset:17408
    v_exp_f32 v96, v96
    v_exp_f32 v97, v97
    s_waitcnt lgkmcnt(6)
    v_mfma_f32_32x32x16_bf16 v[16:31], a[40:43], v[40:43], v[16:31]
    ds_read_b128 v[40:43], v4 offset:18432
    v_exp_f32 v98, v98
    v_exp_f32 v99, v99
    v_mfma_f32_32x32x16_bf16 v[16:31], a[44:47], v[44:47], v[16:31]
    ds_read_b128 v[44:47], v4 offset:19456
    v_exp_f32 v100, v100
    v_exp_f32 v101, v101
    s_waitcnt lgkmcnt(6)
    v_mfma_f32_32x32x16_bf16 v[16:31], a[48:51], v[48:51], v[16:31]
    ds_read_b128 v[48:51], v4 offset:20480
    v_exp_f32 v102, v102
    v_exp_f32 v103, v103
    v_mfma_f32_32x32x16_bf16 v[16:31], a[52:55], v[52:55], v[16:31]
    ds_read_b128 v[52:55], v4 offset:21504
    v_add_f32 v96, 1.0, v96
    v_add_f32 v97, 1.0, v97
    v_add_f32 v98, 1.0, v98
    v_add_f32 v99, 1.0, v99
    s_waitcnt lgkmcnt(6)
    v_mfma_f32_32x32x16_bf16 v[16:31], a[56:59], v[56:59], v[16:31]
    ds_read_b128 v[56:59], v4 offset:22528
    v_add_f32 v100, 1.0, v100
    v_add_f32 v101, 1.0, v101
    v_add_f32 v102, 1.0, v102
    v_add_f32 v103, 1.0, v103
    v_mfma_f32_32x32x16_bf16 v[16:31], a[60:63], v[60:63], v[16:31]
    ds_read_b128 v[60:63], v4 offset:23552
    v_rcp_f32 v96, v96
    v_rcp_f32 v97, v97
    s_waitcnt lgkmcnt(6)
    v_mfma_f32_32x32x16_bf16 v[16:31], a[64:67], v[32:35], v[16:31]
    ds_read_b128 v[32:35], v4 offset:24576
    v_rcp_f32 v98, v98
    v_rcp_f32 v99, v99
    v_mfma_f32_32x32x16_bf16 v[16:31], a[68:71], v[36:39], v[16:31]
    ds_read_b128 v[36:39], v4 offset:25600
    v_rcp_f32 v100, v100
    v_rcp_f32 v101, v101
    s_waitcnt lgkmcnt(6)
    v_mfma_f32_32x32x16_bf16 v[16:31], a[72:75], v[40:43], v[16:31]
    ds_read_b128 v[40:43], v4 offset:26624
    v_rcp_f32 v102, v102
    v_rcp_f32 v103, v103
    v_mfma_f32_32x32x16_bf16 v[16:31], a[76:79], v[44:47], v[16:31]
    ds_read_b128 v[44:47], v4 offset:27648
    v_mul_f32 v88, v88, v96
    v_mul_f32 v89, v89, v97
    v_mul_f32 v90, v90, v98
    v_mul_f32 v91, v91, v99
    s_waitcnt lgkmcnt(6)
    v_mfma_f32_32x32x16_bf16 v[16:31], a[80:83], v[48:51], v[16:31]
    ds_read_b128 v[48:51], v4 offset:28672
    v_mul_f32 v92, v92, v100
    v_mul_f32 v93, v93, v101
    v_mul_f32 v94, v94, v102
    v_mul_f32 v95, v95, v103
    v_mfma_f32_32x32x16_bf16 v[16:31], a[84:87], v[52:55], v[16:31]
    ds_read_b128 v[52:55], v4 offset:29696
    v_cvt_pk_bf16_f32 v108, v88, v89
    v_cvt_pk_bf16_f32 v109, v90, v91
    v_cvt_pk_bf16_f32 v110, v92, v93
    v_cvt_pk_bf16_f32 v111, v94, v95
    s_waitcnt lgkmcnt(6)
    v_mfma_f32_32x32x16_bf16 v[16:31], a[88:91], v[56:59], v[16:31]
    ds_read_b128 v[56:59], v4 offset:30720
    buffer_store_dwordx4 v[108:111], v9, s[12:15], s63 offen sc1
    s_add_u32 s63, s63, 229376
    v_mfma_f32_32x32x16_bf16 v[16:31], a[92:95], v[60:63], v[16:31]
    ds_read_b128 v[60:63], v4 offset:31744
    s_waitcnt lgkmcnt(6)
    v_mfma_f32_32x32x16_bf16 v[16:31], a[96:99], v[32:35], v[16:31]
    v_mfma_f32_32x32x16_bf16 v[16:31], a[100:103], v[36:39], v[16:31]
    s_waitcnt lgkmcnt(4)
    v_mfma_f32_32x32x16_bf16 v[16:31], a[104:107], v[40:43], v[16:31]
    v_mfma_f32_32x32x16_bf16 v[16:31], a[108:111], v[44:47], v[16:31]
    s_waitcnt lgkmcnt(2)
    v_mfma_f32_32x32x16_bf16 v[16:31], a[112:115], v[48:51], v[16:31]
    v_mfma_f32_32x32x16_bf16 v[16:31], a[116:119], v[52:55], v[16:31]
    s_waitcnt lgkmcnt(0)
    v_mfma_f32_32x32x16_bf16 v[16:31], a[120:123], v[56:59], v[16:31]
    v_mfma_f32_32x32x16_bf16 v[16:31], a[124:127], v[60:63], v[16:31]
    v_xor_b32 v4, 0x10000, v4
    s_setprio 0
    s_waitcnt vmcnt(2)
L_g_mm2_111_d:
    v_readfirstlane_b32 s66, v14
    s_lshl_b32 s67, s67, 1
    s_or_b32 s67, s67, 1
    s_add_u32 s60, s60, 1
    s_cmp_gt_u32 s66, s60
    s_cbranch_scc1 L_g_loop1_92
    s_barrier
    ds_read_b32 v14, v15 offset:20
    ds_read_b128 v[80:83], v5 offset:0
    ds_read_b128 v[84:87], v5 offset:1024
    ds_read_b128 v[88:91], v5 offset:2048
    ds_read_b128 v[92:95], v5 offset:3072
    s_waitcnt lgkmcnt(4)
    v_readfirstlane_b32 s66, v14
    s_barrier
    s_mov_b32 s69, 0
    s_cmp_gt_u32 s62, s60
    s_cbranch_scc1 L_g_nd_114
    s_cmp_ge_u32 s62, s66
    s_cbranch_scc1 L_g_nd_114
    s_add_u32 s47, s61, 4096
    s_add_u32 m0, s64, 0
    s_nop 0
    buffer_load_dwordx4 v3, s[12:15], s61 offen offset:0 sc1 lds
    buffer_load_dwordx4 v3, s[12:15], s61 offen offset:1024 sc1 lds
    buffer_load_dwordx4 v3, s[12:15], s61 offen offset:2048 sc1 lds
    buffer_load_dwordx4 v3, s[12:15], s61 offen offset:3072 sc1 lds
    s_add_u32 m0, s64, 4096
    s_nop 0
    buffer_load_dwordx4 v3, s[12:15], s47 offen offset:0 sc1 lds
    buffer_load_dwordx4 v3, s[12:15], s47 offen offset:1024 sc1 lds
    buffer_load_dwordx4 v3, s[12:15], s47 offen offset:2048 sc1 lds
    buffer_load_dwordx4 v3, s[12:15], s47 offen offset:3072 sc1 lds
    s_add_u32 s61, s61, 65536
    s_add_u32 s62, s62, 1
    s_xor_b32 s64, s64, 0x10000
    s_mov_b32 s69, 1
L_g_nd_114:
    s_sub_u32 s59, s60, 1
    s_waitcnt lgkmcnt(3)
    v_add_f32 v80, v80, v16
    v_add_f32 v81, v81, v17
    v_add_f32 v82, v82, v18
    v_add_f32 v83, v83, v19
    s_waitcnt lgkmcnt(2)
    v_add_f32 v84, v84, v20
    v_add_f32 v85, v85, v21
    v_add_f32 v86, v86, v22
    v_add_f32 v87, v87, v23
    s_waitcnt lgkmcnt(1)
    v_add_f32 v88, v88, v24
    v_add_f32 v89, v89, v25
    v_add_f32 v90, v90, v26
    v_add_f32 v91, v91, v27
    s_waitcnt lgkmcnt(0)
    v_add_f32 v92, v92, v28
    v_add_f32 v93, v93, v29
    v_add_f32 v94, v94, v30
    v_add_f32 v95, v95, v31
    v_mul_f32 v96, v80, v80
    v_mul_f32 v97, v81, v81
    v_mul_f32 v98, v82, v82
    v_mul_f32 v99, v83, v83
    v_mul_f32 v100, v84, v84
    v_mul_f32 v101, v85, v85
    v_mul_f32 v102, v86, v86
    v_mul_f32 v103, v87, v87
    v_fma_f32 v96, v96, s56, v112
    v_fma_f32 v97, v97, s56, v112
    v_fma_f32 v98, v98, s56, v112
    v_fma_f32 v99, v99, s56, v112
    v_fma_f32 v100, v100, s56, v112
    v_fma_f32 v101, v101, s56, v112
    v_fma_f32 v102, v102, s56, v112
    v_fma_f32 v103, v103, s56, v112
    v_mul_f32 v96, v96, v80
    v_mul_f32 v97, v97, v81
    v_mul_f32 v98, v98, v82
    v_mul_f32 v99, v99, v83
    v_mul_f32 v100, v100, v84
    v_mul_f32 v101, v101, v85
    v_mul_f32 v102, v102, v86
    v_mul_f32 v103, v103, v87
    v_exp_f32 v96, v96
    v_exp_f32 v97, v97
    v_exp_f32 v98, v98
    v_exp_f32 v99, v99
    v_exp_f32 v100, v100
    v_exp_f32 v101, v101
    v_exp_f32 v102, v102
    v_exp_f32 v103, v103
    v_add_f32 v96, 1.0, v96
    v_add_f32 v97, 1.0, v97
    v_add_f32 v98, 1.0, v98
    v_add_f32 v99, 1.0, v99
    v_add_f32 v100, 1.0, v100
    v_add_f32 v101, 1.0, v101
    v_add_f32 v102, 1.0, v102
    v_add_f32 v103, 1.0, v103
    v_rcp_f32 v96, v96
    v_rcp_f32 v97, v97
    v_rcp_f32 v98, v98
    v_rcp_f32 v99, v99
    v_rcp_f32 v100, v100
    v_rcp_f32 v101, v101
    v_rcp_f32 v102, v102
    v_rcp_f32 v103, v103
    v_mul_f32 v80, v80, v96
    v_mul_f32 v81, v81, v97
    v_mul_f32 v82, v82, v98
    v_mul_f32 v83, v83, v99
    v_mul_f32 v84, v84, v100
    v_mul_f32 v85, v85, v101
    v_mul_f32 v86, v86, v102
    v_mul_f32 v87, v87, v103
    v_cvt_pk_bf16_f32 v104, v80, v81
    v_cvt_pk_bf16_f32 v105, v82, v83
    v_cvt_pk_bf16_f32 v106, v84, v85
    v_cvt_pk_bf16_f32 v107, v86, v87
    buffer_store_dwordx4 v[104:107], v8, s[12:15], s63 offen sc1
    v_mul_f32 v96, v88, v88
    v_mul_f32 v97, v89, v89
    v_mul_f32 v98, v90, v90
    v_mul_f32 v99, v91, v91
    v_mul_f32 v100, v92, v92
    v_mul_f32 v101, v93, v93
    v_mul_f32 v102, v94, v94
    v_mul_f32 v103, v95, v95
    v_fma_f32 v96, v96, s56, v112
    v_fma_f32 v97, v97, s56, v112
    v_fma_f32 v98, v98, s56, v112
    v_fma_f32 v99, v99, s56, v112
    v_fma_f32 v100, v100, s56, v112
    v_fma_f32 v101, v101, s56, v112
    v_fma_f32 v102, v102, s56, v112
    v_fma_f32 v103, v103, s56, v112
    v_mul_f32 v96, v96, v88
    v_mul_f32 v97, v97, v89
    v_mul_f32 v98, v98, v90
    v_mul_f32 v99, v99, v91
    v_mul_f32 v100, v100, v92
    v_mul_f32 v101, v101, v93
    v_mul_f32 v102, v102, v94
    v_mul_f32 v103, v103, v95
    v_exp_f32 v96, v96
    v_exp_f32 v97, v97
    v_exp_f32 v98, v98
    v_exp_f32 v99, v99
    v_exp_f32 v100, v100
    v_exp_f32 v101, v101
    v_exp_f32 v102, v102
    v_exp_f32 v103, v103
    v_add_f32 v96, 1.0, v96
    v_add_f32 v97, 1.0, v97
    v_add_f32 v98, 1.0, v98
    v_add_f32 v99, 1.0, v99
    v_add_f32 v100, 1.0, v100
    v_add_f32 v101, 1.0, v101
    v_add_f32 v102, 1.0, v102
    v_add_f32 v103, 1.0, v103
    v_rcp_f32 v96, v96
    v_rcp_f32 v97, v97
    v_rcp_f32 v98, v98
    v_rcp_f32 v99, v99
    v_rcp_f32 v100, v100
    v_rcp_f32 v101, v101
    v_rcp_f32 v102, v102
    v_rcp_f32 v103, v103
    v_mul_f32 v88, v88, v96
    v_mul_f32 v89, v89, v97
    v_mul_f32 v90, v90, v98
    v_mul_f32 v91, v91, v99
    v_mul_f32 v92, v92, v100
    v_mul_f32 v93, v93, v101
    v_mul_f32 v94, v94, v102
    v_mul_f32 v95, v95, v103
    v_cvt_pk_bf16_f32 v108, v88, v89
    v_cvt_pk_bf16_f32 v109, v90, v91
    v_cvt_pk_bf16_f32 v110, v92, v93
    v_cvt_pk_bf16_f32 v111, v94, v95
    buffer_store_dwordx4 v[108:111], v9, s[12:15], s63 offen sc1
    s_add_u32 s63, s63, 229376
    s_mov_b32 s67, 0
    s_mov_b32 s71, 1
    s_cmp_gt_u32 s66, s60
    s_cbranch_scc1 L_g_g1r_90
    v_mov_b32 v10, 1
    s_mov_b64 exec, 1
    s_waitcnt vmcnt(0)
    ds_add_rtn_u32 v10, v15, v10 offset:4
    s_waitcnt lgkmcnt(0)
    v_readfirstlane_b32 s46, v10
    s_mov_b64 exec, -1
    s_mov_b32 s71, 0
    s_sub_u32 s59, s60, 1
    s_cmp_lg_u32 s46, s68
    s_cbranch_scc1 L_g_df_115
    v_mov_b32 v10, s59
    v_add_u32 v10, 1, v10
    v_mov_b32 v11, 0
    s_mov_b64 exec, 1
    buffer_store_dword v10, v11, s[12:15], s52 offen sc1
    s_mov_b64 exec, -1
L_sf_116:
L_g_df_115:
    s_add_u32 s68, s68, 4
    s_cmp_gt_u32 s66, s60
    s_cbranch_scc1 L_g_g1r_90
L_g_tail_93:
    s_cmp_lt_u32 s60, s75
    s_cbranch_scc1 L_g_restart_88
    s_waitcnt vmcnt(0)
    s_barrier
    s_branch L_w_f1_14_d
L_g_h1_103:
    s_add_u32 s54, s60, 1
    v_add_u32 v12, s54, v113
    v_mul_u32_u24 v13, 171, v12
    v_lshrrev_b32 v13, 9, v13
    v_mad_i32_i24 v13, v13, -3, v12
    v_lshl_add_u32 v13, v13, 9, v7
    buffer_load_dword v11, v13, s[12:15], 0 offen sc1
    s_branch L_g_h1_103_b
L_g_h2_104:
    s_waitcnt vmcnt(0)
    v_cmp_ge_u32 vcc, v12, v11
    s_nop 0
    s_ff1_i32_b64 s46, vcc
    s_lshr_b32 s46, s46, 4
    s_min_u32 s46, s46, 4
    s_add_u32 s46, s46, s54
    s_min_u32 s46, s46, s75
    v_mov_b32 v118, s46
    s_branch L_g_h2_104_b
L_g_dp_105_l:
    s_cmp_ge_u32 s62, s66
    s_cbranch_scc1 L_g_dp_105_d
    s_mov_b32 s65, 1
    s_add_u32 s47, s61, 4096
    s_mov_b32 m0, s64
    s_add_u32 s62, s62, 1
    buffer_load_dwordx4 v3, s[12:15], s61 offen offset:0 sc1 lds
    buffer_load_dwordx4 v3, s[12:15], s61 offen offset:1024 sc1 lds
    buffer_load_dwordx4 v3, s[12:15], s61 offen offset:2048 sc1 lds
    buffer_load_dwordx4 v3, s[12:15], s61 offen offset:3072 sc1 lds
    s_add_u32 m0, s64, 4096
    s_add_u32 s61, s61, 65536
    buffer_load_dwordx4 v3, s[12:15], s47 offen offset:0 sc1 lds
    buffer_load_dwordx4 v3, s[12:15], s47 offen offset:1024 sc1 lds
    buffer_load_dwordx4 v3, s[12:15], s47 offen offset:2048 sc1 lds
    buffer_load_dwordx4 v3, s[12:15], s47 offen offset:3072 sc1 lds
    s_xor_b32 s64, s64, 0x10000
    s_branch L_g_dp_105_a
L_g_nw_101:
    s_waitcnt vmcnt(0) lgkmcnt(0)
    s_cmp_lg_u32 s44, 0
    s_cbranch_scc1 L_g_nl_117
    s_cmp_lt_u32 s66, s75
    s_cselect_b32 s81, 1, 2
L_g_nl_117:
    s_branch L_g_loop0_91_l
L_g_nfl_108:
    s_cmp_eq_u32 s71, 0
    s_cbranch_scc1 L_g_nfl_108_d
    v_mov_b32 v10, 1
    s_mov_b64 exec, 1
    s_waitcnt vmcnt(0)
    ds_add_rtn_u32 v10, v15, v10 offset:4
    s_waitcnt lgkmcnt(0)
    v_readfirstlane_b32 s46, v10
    s_mov_b64 exec, -1
    s_mov_b32 s71, 0
    s_sub_u32 s59, s60, 1
    s_cmp_lg_u32 s46, s68
    s_cbranch_scc1 L_g_df_118
    v_mov_b32 v10, s59
    v_add_u32 v10, 1, v10
    v_mov_b32 v11, 0
    s_mov_b64 exec, 1
    buffer_store_dword v10, v11, s[12:15], s52 offen sc1
    s_mov_b64 exec, -1
L_sf_119:
L_g_df_118:
    s_add_u32 s68, s68, 4
    s_mov_b32 s65, 2
    s_branch L_g_nfl_108_d
L_g_dp_113_l:
    s_cmp_ge_u32 s62, s66
    s_cbranch_scc1 L_g_dp_113_d
    s_or_b32 s65, s65, 1
    s_add_u32 s47, s61, 4096
    s_mov_b32 m0, s64
    s_add_u32 s62, s62, 1
    buffer_load_dwordx4 v3, s[12:15], s61 offen offset:0 sc1 lds
    buffer_load_dwordx4 v3, s[12:15], s61 offen offset:1024 sc1 lds
    buffer_load_dwordx4 v3, s[12:15], s61 offen offset:2048 sc1 lds
    buffer_load_dwordx4 v3, s[12:15], s61 offen offset:3072 sc1 lds
    s_add_u32 m0, s64, 4096
    s_add_u32 s61, s61, 65536
    buffer_load_dwordx4 v3, s[12:15], s47 offen offset:0 sc1 lds
    buffer_load_dwordx4 v3, s[12:15], s47 offen offset:1024 sc1 lds
    buffer_load_dwordx4 v3, s[12:15], s47 offen offset:2048 sc1 lds
    buffer_load_dwordx4 v3, s[12:15], s47 offen offset:3072 sc1 lds
    s_xor_b32 s64, s64, 0x10000
    s_branch L_g_dp_113_a
L_g_nw1_110:
    s_cmp_eq_u32 s65, 2
    s_cbranch_scc1 L_g_nw1_110_w
    s_waitcnt vmcnt(0)
L_g_nw1_110_w:
    s_barrier
    ds_read_b128 v[32:35], v4 offset:0
    ds_read_b128 v[36:39], v4 offset:1024
    ds_read_b128 v[40:43], v4 offset:2048
    ds_read_b128 v[44:47], v4 offset:3072
    ds_read_b128 v[48:51], v4 offset:4096
    ds_read_b128 v[52:55], v4 offset:5120
    ds_read_b128 v[56:59], v4 offset:6144
    ds_read_b128 v[60:63], v4 offset:7168
    s_branch L_g_jn_112
L_g_mm2_111:
    s_setprio 1
    s_waitcnt lgkmcnt(6)
    v_mfma_f32_32x32x16_bf16 v[16:31], a[0:3], v[32:35], 0
    ds_read_b128 v[32:35], v4 offset:8192
    ds_read_b32 v14, v15
    v_mfma_f32_32x32x16_bf16 v[16:31], a[4:7], v[36:39], v[16:31]
    ds_read_b128 v[36:39], v4 offset:9216
    s_waitcnt lgkmcnt(6)
    v_mfma_f32_32x32x16_bf16 v[16:31], a[8:11], v[40:43], v[16:31]
    ds_read_b128 v[40:43], v4 offset:10240
    v_mfma_f32_32x32x16_bf16 v[16:31], a[12:15], v[44:47], v[16:31]
    ds_read_b128 v[44:47], v4 offset:11264
    s_waitcnt lgkmcnt(6)
    v_mfma_f32_32x32x16_bf16 v[16:31], a[16:19], v[48:51], v[16:31]
    ds_read_b128 v[48:51], v4 offset:12288
    v_mfma_f32_32x32x16_bf16 v[16:31], a[20:23], v[52:55], v[16:31]
    ds_read_b128 v[52:55], v4 offset:13312
    s_waitcnt lgkmcnt(6)
    v_mfma_f32_32x32x16_bf16 v[16:31], a[24:27], v[56:59], v[16:31]
    ds_read_b128 v[56:59], v4 offset:14336
    v_mfma_f32_32x32x16_bf16 v[16:31], a[28:31], v[60:63], v[16:31]
    ds_read_b128 v[60:63], v4 offset:15360
    s_waitcnt lgkmcnt(6)
    v_mfma_f32_32x32x16_bf16 v[16:31], a[32:35], v[32:35], v[16:31]
    ds_read_b128 v[32:35], v4 offset:16384
    v_mfma_f32_32x32x16_bf16 v[16:31], a[36:39], v[36:39], v[16:31]
    ds_read_b128 v[36:39], v4 offset:17408
    s_waitcnt lgkmcnt(6)
    v_mfma_f32_32x32x16_bf16 v[16:31], a[40:43], v[40:43], v[16:31]
    ds_read_b128 v[40:43], v4 offset:18432
    v_mfma_f32_32x32x16_bf16 v[16:31], a[44:47], v[44:47], v[16:31]
    ds_read_b128 v[44:47], v4 offset:19456
    s_waitcnt lgkmcnt(6)
    v_mfma_f32_32x32x16_bf16 v[16:31], a[48:51], v[48:51], v[16:31]
    ds_read_b128 v[48:51], v4 offset:20480
    v_mfma_f32_32x32x16_bf16 v[16:31], a[52:55], v[52:55], v[16:31]
    ds_read_b128 v[52:55], v4 offset:21504
    s_waitcnt lgkmcnt(6)
    v_mfma_f32_32x32x16_bf16 v[16:31], a[56:59], v[56:59], v[16:31]
    ds_read_b128 v[56:59], v4 offset:22528
    v_mfma_f32_32x32x16_bf16 v[16:31], a[60:63], v[60:63], v[16:31]
    ds_read_b128 v[60:63], v4 offset:23552
    s_waitcnt lgkmcnt(6)
    v_mfma_f32_32x32x16_bf16 v[16:31], a[64:67], v[32:35], v[16:31]
    ds_read_b128 v[32:35], v4 offset:24576
    v_mfma_f32_32x32x16_bf16 v[16:31], a[68:71], v[36:39], v[16:31]
    ds_read_b128 v[36:39], v4 offset:25600
    s_waitcnt lgkmcnt(6)
    v_mfma_f32_32x32x16_bf16 v[16:31], a[72:75], v[40:43], v[16:31]
    ds_read_b128 v[40:43], v4 offset:26624
    v_mfma_f32_32x32x16_bf16 v[16:31], a[76:79], v[44:47], v[16:31]
    ds_read_b128 v[44:47], v4 offset:27648
    s_waitcnt lgkmcnt(6)
    v_mfma_f32_32x32x16_bf16 v[16:31], a[80:83], v[48:51], v[16:31]
    ds_read_b128 v[48:51], v4 offset:28672
    v_mfma_f32_32x32x16_bf16 v[16:31], a[84:87], v[52:55], v[16:31]
    ds_read_b128 v[52:55], v4 offset:29696
    s_waitcnt lgkmcnt(6)
    v_mfma_f32_32x32x16_bf16 v[16:31], a[88:91], v[56:59], v[16:31]
    ds_read_b128 v[56:59], v4 offset:30720
    v_mfma_f32_32x32x16_bf16 v[16:31], a[92:95], v[60:63], v[16:31]
    ds_read_b128 v[60:63], v4 offset:31744
    s_waitcnt lgkmcnt(6)
    v_mfma_f32_32x32x16_bf16 v[16:31], a[96:99], v[32:35], v[16:31]
    v_mfma_f32_32x32x16_bf16 v[16:31], a[100:103], v[36:39], v[16:31]
    s_waitcnt lgkmcnt(4)
    v_mfma_f32_32x32x16_bf16 v[16:31], a[104:107], v[40:43], v[16:31]
    v_mfma_f32_32x32x16_bf16 v[16:31], a[108:111], v[44:47], v[16:31]
    s_waitcnt lgkmcnt(2)
    v_mfma_f32_32x32x16_bf16 v[16:31], a[112:115], v[48:51], v[16:31]
    v_mfma_f32_32x32x16_bf16 v[16:31], a[116:119], v[52:55], v[16:31]
    s_waitcnt lgkmcnt(0)
    v_mfma_f32_32x32x16_bf16 v[16:31], a[120:123], v[56:59], v[16:31]
    v_mfma_f32_32x32x16_bf16 v[16:31], a[124:127], v[60:63], v[16:31]
    v_xor_b32 v4, 0x10000, v4
    s_setprio 0
    s_waitcnt vmcnt(0)
    s_branch L_g_mm2_111_d
L_w_f2_13:
    s_load_dwordx2 s[4:5], s[0:1], 80
    s_load_dwordx2 s[6:7], s[0:1], 72
    s_and_b32 s50, s44, 3
    s_lshr_b32 s51, s44, 2
    s_waitcnt lgkmcnt(0)
    s_mov_b32 s24, s4
    s_and_b32 s25, s5, 0xffff
    s_mov_b32 s26, 0x700000
    s_mov_b32 s27, 0x00020000
    v_lshrrev_b32 v3, 4, v1
    v_and_b32 v4, 15, v1
    v_lshlrev_b32 v5, 2, v3
    v_xor_b32 v4, v4, v5
    v_mul_u32_u24 v3, 2048, v3
    v_lshl_add_u32 v3, v4, 4, v3
    s_mul_i32 s46, s51, 448
    s_mul_i32 s47, s50, 16
    s_add_u32 s46, s46, s47
    s_mul_i32 s47, s42, 896
    s_add_u32 s46, s46, s47
    s_mul_i32 s46, s46, 2048
    s_lshl_b32 s47, s43, 8
    s_add_u32 s46, s46, s47
    s_lshl_b32 s45, s51, 16
    s_mul_i32 s47, s50, 4096
    s_add_u32 s45, s45, s47
    v_bfe_u32 v4, v1, 2, 2
    v_bfe_u32 v5, v1, 4, 1
    v_lshlrev_b32 v5, 1, v5
    v_bfe_u32 v6, v1, 1, 1
    v_add_u32 v5, v5, v6
    s_lshl_b32 s47, s50, 2
    v_add_u32 v5, s47, v5
    v_lshlrev_b32 v6, 2, v4
    v_xor_b32 v5, v5, v6
    v_lshlrev_b32 v5, 4, v5
    v_lshl_add_u32 v5, v4, 8, v5
    v_bfe_u32 v6, v1, 0, 1
    v_lshl_add_u32 v5, v6, 3, v5
    v_lshrrev_b32 v6, 5, v1
    v_mul_u32_u24 v6, 1024, v6
    v_add_u32 v5, v5, v6
    s_lshl_b32 s47, s51, 16
    v_add_u32 v5, s47, v5
    v_bfe_u32 v4, v1, 2, 2
    v_xor_b32 v5, s50, v4
    v_lshlrev_b32 v5, 6, v5
    v_lshl_add_u32 v5, v4, 8, v5
    v_and_b32 v6, 3, v1
    v_lshl_add_u32 v5, v6, 3, v5
    v_lshrrev_b32 v6, 4, v1
    v_lshl_add_u32 v5, v6, 10, v5
    v_lshrrev_b32 v6, 5, v1
    v_lshl_add_u32 v5, v6, 11, v5
    s_lshl_b32 s47, s51, 16
    v_add_u32 v5, s47, v5
    s_add_u32 m0, s45, 0
    s_add_u32 s47, s46, 0x0
    buffer_load_dwordx4 v3, s[24:27], s47 offen lds
    s_add_u32 m0, s45, 1024
    s_add_u32 s47, s46, 0x2000
    buffer_load_dwordx4 v3, s[24:27], s47 offen lds
    s_add_u32 m0, s45, 2048
    s_add_u32 s47, s46, 0x4000
    buffer_load_dwordx4 v3, s[24:27], s47 offen lds
    s_add_u32 m0, s45, 3072
    s_add_u32 s47, s46, 0x6000
    buffer_load_dwordx4 v3, s[24:27], s47 offen lds
    s_add_u32 m0, s45, 16384
    s_add_u32 s47, s46, 0x20000
    buffer_load_dwordx4 v3, s[24:27], s47 offen lds
    s_add_u32 m0, s45, 17408
    s_add_u32 s47, s46, 0x22000
    buffer_load_dwordx4 v3, s[24:27], s47 offen lds
    s_add_u32 m0, s45, 18432
    s_add_u32 s47, s46, 0x24000
    buffer_load_dwordx4 v3, s[24:27], s47 offen lds
    s_add_u32 m0, s45, 19456
    s_add_u32 s47, s46, 0x26000
    buffer_load_dwordx4 v3, s[24:27], s47 offen lds
    s_add_u32 m0, s45, 32768
    s_add_u32 s47, s46, 0x40000
    buffer_load_dwordx4 v3, s[24:27], s47 offen lds
    s_add_u32 m0, s45, 33792
    s_add_u32 s47, s46, 0x42000
    buffer_load_dwordx4 v3, s[24:27], s47 offen lds
    s_add_u32 m0, s45, 34816
    s_add_u32 s47, s46, 0x44000
    buffer_load_dwordx4 v3, s[24:27], s47 offen lds
    s_add_u32 m0, s45, 35840
    s_add_u32 s47, s46, 0x46000
    buffer_load_dwordx4 v3, s[24:27], s47 offen lds
    s_add_u32 m0, s45, 49152
    s_add_u32 s47, s46, 0x60000
    buffer_load_dwordx4 v3, s[24:27], s47 offen lds
    s_add_u32 m0, s45, 50176
    s_add_u32 s47, s46, 0x62000
    buffer_load_dwordx4 v3, s[24:27], s47 offen lds
    s_add_u32 m0, s45, 51200
    s_add_u32 s47, s46, 0x64000
    buffer_load_dwordx4 v3, s[24:27], s47 offen lds
    s_add_u32 m0, s45, 52224
    s_add_u32 s47, s46, 0x66000
    buffer_load_dwordx4 v3, s[24:27], s47 offen lds
    s_waitcnt vmcnt(12) lgkmcnt(0)
    s_barrier
    ds_read_b64_tr_b16 a[0:1], v5 offset:0
    ds_read_b64_tr_b16 a[2:3], v5 offset:2048
    ds_read_b64_tr_b16 a[4:5], v5 offset:32
    ds_read_b64_tr_b16 a[6:7], v5 offset:2080
    ds_read_b64_tr_b16 a[8:9], v5 offset:8192
    ds_read_b64_tr_b16 a[10:11], v5 offset:10240
    ds_read_b64_tr_b16 a[12:13], v5 offset:8224
    ds_read_b64_tr_b16 a[14:15], v5 offset:10272
    s_waitcnt vmcnt(8) lgkmcnt(0)
    s_barrier
    s_add_u32 m0, s45, 0
    s_add_u32 s47, s46, 0x80000
    buffer_load_dwordx4 v3, s[24:27], s47 offen lds
    s_add_u32 m0, s45, 1024
    s_add_u32 s47, s46, 0x82000
    buffer_load_dwordx4 v3, s[24:27], s47 offen lds
    s_add_u32 m0, s45, 2048
    s_add_u32 s47, s46, 0x84000
    buffer_load_dwordx4 v3, s[24:27], s47 offen lds
    s_add_u32 m0, s45, 3072
    s_add_u32 s47, s46, 0x86000
    buffer_load_dwordx4 v3, s[24:27], s47 offen lds
    ds_read_b64_tr_b16 a[16:17], v5 offset:16384
    ds_read_b64_tr_b16 a[18:19], v5 offset:18432
    ds_read_b64_tr_b16 a[20:21], v5 offset:16416
    ds_read_b64_tr_b16 a[22:23], v5 offset:18464
    ds_read_b64_tr_b16 a[24:25], v5 offset:24576
    ds_read_b64_tr_b16 a[26:27], v5 offset:26624
    ds_read_b64_tr_b16 a[28:29], v5 offset:24608
    ds_read_b64_tr_b16 a[30:31], v5 offset:26656
    s_waitcnt vmcnt(8) lgkmcnt(0)
    s_barrier
    s_add_u32 m0, s45, 16384
    s_add_u32 s47, s46, 0xa0000
    buffer_load_dwordx4 v3, s[24:27], s47 offen lds
    s_add_u32 m0, s45, 17408
    s_add_u32 s47, s46, 0xa2000
    buffer_load_dwordx4 v3, s[24:27], s47 offen lds
    s_add_u32 m0, s45, 18432
    s_add_u32 s47, s46, 0xa4000
    buffer_load_dwordx4 v3, s[24:27], s47 offen lds
    s_add_u32 m0, s45, 19456
    s_add_u32 s47, s46, 0xa6000
    buffer_load_dwordx4 v3, s[24:27], s47 offen lds
    ds_read_b64_tr_b16 a[32:33], v5 offset:32768
    ds_read_b64_tr_b16 a[34:35], v5 offset:34816
    ds_read_b64_tr_b16 a[36:37], v5 offset:32800
    ds_read_b64_tr_b16 a[38:39], v5 offset:34848
    ds_read_b64_tr_b16 a[40:41], v5 offset:40960
    ds_read_b64_tr_b16 a[42:43], v5 offset:43008
    ds_read_b64_tr_b16 a[44:45], v5 offset:40992
    ds_read_b64_tr_b16 a[46:47], v5 offset:43040
    s_waitcnt vmcnt(8) lgkmcnt(0)
    s_barrier
    s_add_u32 m0, s45, 32768
    s_add_u32 s47, s46, 0xc0000
    buffer_load_dwordx4 v3, s[24:27], s47 offen lds
    s_add_u32 m0, s45, 33792
    s_add_u32 s47, s46, 0xc2000
    buffer_load_dwordx4 v3, s[24:27], s47 offen lds
    s_add_u32 m0, s45, 34816
    s_add_u32 s47, s46, 0xc4000
    buffer_load_dwordx4 v3, s[24:27], s47 offen lds
    s_add_u32 m0, s45, 35840
    s_add_u32 s47, s46, 0xc6000
    buffer_load_dwordx4 v3, s[24:27], s47 offen lds
    ds_read_b64_tr_b16 a[48:49], v5 offset:49152
    ds_read_b64_tr_b16 a[50:51], v5 offset:51200
    ds_read_b64_tr_b16 a[52:53], v5 offset:49184
    ds_read_b64_tr_b16 a[54:55], v5 offset:51232
    ds_read_b64_tr_b16 a[56:57], v5 offset:57344
    ds_read_b64_tr_b16 a[58:59], v5 offset:59392
    ds_read_b64_tr_b16 a[60:61], v5 offset:57376
    ds_read_b64_tr_b16 a[62:63], v5 offset:59424
    s_waitcnt vmcnt(8) lgkmcnt(0)
    s_barrier
    ds_read_b64_tr_b16 a[64:65], v5 offset:0
    ds_read_b64_tr_b16 a[66:67], v5 offset:2048
    ds_read_b64_tr_b16 a[68:69], v5 offset:32
    ds_read_b64_tr_b16 a[70:71], v5 offset:2080
    ds_read_b64_tr_b16 a[72:73], v5 offset:8192
    ds_read_b64_tr_b16 a[74:75], v5 offset:10240
    ds_read_b64_tr_b16 a[76:77], v5 offset:8224
    ds_read_b64_tr_b16 a[78:79], v5 offset:10272
    s_waitcnt vmcnt(4) lgkmcnt(0)
    s_barrier
    ds_read_b64_tr_b16 a[80:81], v5 offset:16384
    ds_read_b64_tr_b16 a[82:83], v5 offset:18432
    ds_read_b64_tr_b16 a[84:85], v5 offset:16416
    ds_read_b64_tr_b16 a[86:87], v5 offset:18464
    ds_read_b64_tr_b16 a[88:89], v5 offset:24576
    ds_read_b64_tr_b16 a[90:91], v5 offset:26624
    ds_read_b64_tr_b16 a[92:93], v5 offset:24608
    ds_read_b64_tr_b16 a[94:95], v5 offset:26656
    s_waitcnt vmcnt(0) lgkmcnt(0)
    s_barrier
    ds_read_b64_tr_b16 a[96:97], v5 offset:32768
    ds_read_b64_tr_b16 a[98:99], v5 offset:34816
    ds_read_b64_tr_b16 a[100:101], v5 offset:32800
    ds_read_b64_tr_b16 a[102:103], v5 offset:34848
    ds_read_b64_tr_b16 a[104:105], v5 offset:40960
    ds_read_b64_tr_b16 a[106:107], v5 offset:43008
    ds_read_b64_tr_b16 a[108:109], v5 offset:40992
    ds_read_b64_tr_b16 a[110:111], v5 offset:43040
    s_waitcnt lgkmcnt(0)
    s_barrier
    v_lshlrev_b32 v2, 4, v1
    s_mul_i32 s64, s44, 7168
    s_add_u32 s46, s64, 0x6000000
    s_mul_i32 s47, s42, 57344
    s_add_u32 s46, s46, s47
    v_add_u32 v3, s46, v2
    s_mul_i32 s46, s51, 28672
    v_add_u32 v4, s46, v2
    v_and_b32 v6, 15, v1
    v_lshlrev_b32 v6, 4, v6
    v_lshrrev_b32 v7, 4, v1
    v_lshl_add_u32 v6, v7, 9, v6
    v_add_u32 v4, s46, v6
    s_lshl_b32 s46, s50, 12
    s_add_u32 s46, s46, 131072
    v_add_u32 v5, s46, v2
    v_and_b32 v7, 15, v1
    v_min_u32 v7, 6, v7
    v_lshlrev_b32 v7, 7, v7
    s_mul_i32 s46, s42, 896
    s_add_u32 s46, s46, 0x106400
    v_add_u32 v7, s46, v7
    s_lshl_b32 s46, s42, 16
    s_lshl_b32 s47, s43, 11
    s_add_u32 s46, s46, s47
    s_lshl_b32 s47, s50, 9
    s_add_u32 s46, s46, s47
    s_add_u32 s46, s46, 0xb000000
    v_and_b32 v8, 31, v1
    v_lshlrev_b32 v8, 4, v8
    v_lshrrev_b32 v9, 5, v1
    v_lshl_add_u32 v8, v9, 14, v8
    v_add_u32 v8, s46, v8
    v_add_u32 v9, 0x8000, v8
    s_lshl_b32 s52, s43, 9
    s_lshl_b32 s47, s42, 7
    s_add_u32 s52, s52, s47
    s_add_u32 s52, s52, 0x108400
    s_add_u32 s52, s52, s76
    s_mul_i32 s46, s43, 7168
    s_add_u32 s46, s46, 0x6000000
    s_mul_i32 s47, s42, 57344
    s_add_u32 s46, s46, s47
    v_min_u32 v116, 55, v1
    v_lshlrev_b32 v116, 7, v116
    v_add_u32 v116, s46, v116
    s_mov_b32 s60, s74
    s_mul_i32 s61, s74, 229376
    s_mov_b32 s62, s74
    s_mul_i32 s63, s74, 262144
    s_mov_b32 s67, 0
    s_mov_b32 s68, 3
    s_mov_b32 s71, 0
    v_mov_b32 v15, 147456
    v_mov_b32 v14, 0
    ds_write_b32 v15, v14 offset:4
    ds_write_b32 v15, v14 offset:12
    ds_write_b32 v15, v14 offset:16
    v_mov_b32 v114, 1
    v_mov_b32 v115, 0
    s_mov_b32 s81, 0
    s_lshl_b32 s46, s44, 5
    v_add_u32 v119, s46, v15
    v_lshrrev_b32 v113, 4, v1
    s_mov_b32 s72, 0
L_g_restart_120:
    s_cmp_lg_u32 s44, 0
    s_cbranch_scc1 L_g_nsp_121
    s_mov_b32 s70, 0
L_g_sp_127:
    s_add_u32 s54, s60, 0
    v_add_u32 v12, s54, v113
    v_subrev_u32 v13, 60, v12
    v_subrev_u32 v11, 63, v12
    v_ashrrev_i32 v13, 31, v13
    v_ashrrev_i32 v11, 31, v11
    v_add3_u32 v13, v13, v11, 2
    v_lshl_add_u32 v13, v13, 16, v7
    buffer_load_dword v11, v13, s[12:15], 0 offen sc1
    s_waitcnt vmcnt(0)
    v_cmp_ge_u32 vcc, v12, v11
    s_add_u32 s70, s70, 1
    s_and_b32 s46, vcc_lo, 0xffff
    s_cbranch_scc0 L_g_sp_127_ok
    s_sleep 3
    s_cmp_lt_u32 s70, 524288
    s_cbranch_scc1 L_g_sp_127
    s_branch L_c_done_1
L_g_sp_127_ok:
    v_cmp_ge_u32 vcc, v12, v11
    s_nop 0
    s_ff1_i32_b64 s46, vcc
    s_lshr_b32 s46, s46, 4
    s_min_u32 s46, s46, 4
    s_add_u32 s46, s46, s54
    s_min_u32 s46, s46, s75
    v_mov_b32 v118, s46
    ds_write_b32 v15, v118 offset:20
L_g_nsp_121:
    s_waitcnt lgkmcnt(0)
    s_barrier
    ds_read_b32 v14, v15 offset:20
    s_waitcnt lgkmcnt(0)
    v_readfirstlane_b32 s66, v14
    s_nop 3
L_g_restart_120_go:
    s_mov_b32 s69, 0
    s_cmp_gt_u32 s62, s60
    s_cbranch_scc1 L_g_nd_128
    s_cmp_ge_u32 s62, s66
    s_cbranch_scc1 L_g_nd_128
    s_add_u32 s47, s61, 4096
    s_add_u32 m0, s64, 0
    s_nop 0
    buffer_load_dwordx4 v3, s[12:15], s61 offen offset:0 sc1 lds
    buffer_load_dwordx4 v3, s[12:15], s61 offen offset:1024 sc1 lds
    buffer_load_dwordx4 v3, s[12:15], s61 offen offset:2048 sc1 lds
    buffer_load_dwordx4 v3, s[12:15], s61 offen offset:3072 sc1 lds
    s_add_u32 m0, s64, 4096
    s_nop 0
    buffer_load_dwordx4 v3, s[12:15], s47 offen offset:0 sc1 lds
    buffer_load_dwordx4 v3, s[12:15], s47 offen offset:1024 sc1 lds
    buffer_load_dwordx4 v3, s[12:15], s47 offen offset:2048 sc1 lds
    s_add_u32 s61, s61, 229376
    s_add_u32 s62, s62, 1
    s_xor_b32 s64, s64, 0x10000
    s_mov_b32 s69, 1
L_g_nd_128:
    s_cmp_eq_u32 s51, 1
    s_cbranch_scc1 L_g_g1r_122
    s_add_u32 s59, s60, 1
    s_mov_b32 s69, 0
    s_cmp_gt_u32 s62, s59
    s_cbranch_scc1 L_g_nd_129
    s_cmp_ge_u32 s62, s66
    s_cbranch_scc1 L_g_nd_129
    s_add_u32 s47, s61, 4096
    s_add_u32 m0, s64, 0
    s_nop 0
    buffer_load_dwordx4 v3, s[12:15], s61 offen offset:0 sc1 lds
    buffer_load_dwordx4 v3, s[12:15], s61 offen offset:1024 sc1 lds
    buffer_load_dwordx4 v3, s[12:15], s61 offen offset:2048 sc1 lds
    buffer_load_dwordx4 v3, s[12:15], s61 offen offset:3072 sc1 lds
    s_add_u32 m0, s64, 4096
    s_nop 0
    buffer_load_dwordx4 v3, s[12:15], s47 offen offset:0 sc1 lds
    buffer_load_dwordx4 v3, s[12:15], s47 offen offset:1024 sc1 lds
    buffer_load_dwordx4 v3, s[12:15], s47 offen offset:2048 sc1 lds
    s_add_u32 s61, s61, 229376
    s_add_u32 s62, s62, 1
    s_xor_b32 s64, s64, 0x10000
    s_mov_b32 s69, 1
L_g_nd_129:
    s_cmp_eq_u32 s69, 1
    s_cbranch_scc1 L_g_w0_130
    s_waitcnt vmcnt(0)
L_g_w0_130:
    s_waitcnt vmcnt(7)
    s_cmp_lg_u32 s44, 0
    s_cbranch_scc1 L_g_nl_131
    s_cmp_lt_u32 s66, s75
    s_cselect_b32 s81, 1, 2
L_g_nl_131:
L_g_loop0_123_l:
    s_barrier
    ds_read_b128 v[32:35], v4 offset:0
    ds_read_b128 v[36:39], v4 offset:256
    ds_read_b128 v[40:43], v4 offset:2048
    ds_read_b128 v[44:47], v4 offset:2304
    ds_read_b128 v[48:51], v4 offset:4096
    ds_read_b128 v[52:55], v4 offset:4352
    ds_read_b128 v[56:59], v4 offset:6144
    ds_read_b128 v[60:63], v4 offset:6400
    s_branch L_g_loop0_123_m
.p2align 6
L_g_loop0_123:
    s_barrier
L_g_loop0_123_m:
    s_setprio 2
    s_waitcnt lgkmcnt(6)
    v_mfma_f32_16x16x32_bf16 v[16:19], v[32:35], a[0:3], 0
    v_mfma_f32_16x16x32_bf16 v[20:23], v[32:35], a[4:7], 0
    ds_read_b128 v[32:35], v4 offset:8192
    v_mfma_f32_16x16x32_bf16 v[28:31], v[36:39], a[4:7], 0
    v_mfma_f32_16x16x32_bf16 v[24:27], v[36:39], a[0:3], 0
    ds_read_b128 v[36:39], v4 offset:8448
    s_cmp_eq_u32 s81, 1
    s_cbranch_scc1 L_g_h1_135
L_g_h1_135_b:
    s_waitcnt lgkmcnt(6)
    v_mfma_f32_16x16x32_bf16 v[16:19], v[40:43], a[8:11], v[16:19]
    v_mfma_f32_16x16x32_bf16 v[20:23], v[40:43], a[12:15], v[20:23]
    ds_read_b128 v[40:43], v4 offset:10240
    v_mfma_f32_16x16x32_bf16 v[28:31], v[44:47], a[12:15], v[28:31]
    v_mfma_f32_16x16x32_bf16 v[24:27], v[44:47], a[8:11], v[24:27]
    ds_read_b128 v[44:47], v4 offset:10496
    s_waitcnt lgkmcnt(6)
    v_mfma_f32_16x16x32_bf16 v[16:19], v[48:51], a[16:19], v[16:19]
    v_mfma_f32_16x16x32_bf16 v[20:23], v[48:51], a[20:23], v[20:23]
    ds_read_b128 v[48:51], v4 offset:12288
    v_mfma_f32_16x16x32_bf16 v[28:31], v[52:55], a[20:23], v[28:31]
    v_mfma_f32_16x16x32_bf16 v[24:27], v[52:55], a[16:19], v[24:27]
    ds_read_b128 v[52:55], v4 offset:12544
    s_waitcnt lgkmcnt(6)
    v_mfma_f32_16x16x32_bf16 v[16:19], v[56:59], a[24:27], v[16:19]
    v_mfma_f32_16x16x32_bf16 v[20:23], v[56:59], a[28:31], v[20:23]
    ds_read_b128 v[56:59], v4 offset:14336
    v_mfma_f32_16x16x32_bf16 v[28:31], v[60:63], a[28:31], v[28:31]
    v_mfma_f32_16x16x32_bf16 v[24:27], v[60:63], a[24:27], v[24:27]
    ds_read_b128 v[60:63], v4 offset:14592
    s_waitcnt lgkmcnt(6)
    v_mfma_f32_16x16x32_bf16 v[16:19], v[32:35], a[32:35], v[16:19]
    v_mfma_f32_16x16x32_bf16 v[20:23], v[32:35], a[36:39], v[20:23]
    ds_read_b128 v[32:35], v4 offset:16384
    v_mfma_f32_16x16x32_bf16 v[28:31], v[36:39], a[36:39], v[28:31]
    v_mfma_f32_16x16x32_bf16 v[24:27], v[36:39], a[32:35], v[24:27]
    ds_read_b128 v[36:39], v4 offset:16640
    s_waitcnt lgkmcnt(6)
    v_mfma_f32_16x16x32_bf16 v[16:19], v[40:43], a[40:43], v[16:19]
    v_mfma_f32_16x16x32_bf16 v[20:23], v[40:43], a[44:47], v[20:23]
    ds_read_b128 v[40:43], v4 offset:18432
    v_mfma_f32_16x16x32_bf16 v[28:31], v[44:47], a[44:47], v[28:31]
    v_mfma_f32_16x16x32_bf16 v[24:27], v[44:47], a[40:43], v[24:27]
    ds_read_b128 v[44:47], v4 offset:18688
    s_waitcnt lgkmcnt(6)
    v_mfma_f32_16x16x32_bf16 v[16:19], v[48:51], a[48:51], v[16:19]
    v_mfma_f32_16x16x32_bf16 v[20:23], v[48:51], a[52:55], v[20:23]
    ds_read_b128 v[48:51], v4 offset:20480
    v_mfma_f32_16x16x32_bf16 v[28:31], v[52:55], a[52:55], v[28:31]
    v_mfma_f32_16x16x32_bf16 v[24:27], v[52:55], a[48:51], v[24:27]
    ds_read_b128 v[52:55], v4 offset:20736
    s_waitcnt lgkmcnt(6)
    v_mfma_f32_16x16x32_bf16 v[16:19], v[56:59], a[56:59], v[16:19]
    v_mfma_f32_16x16x32_bf16 v[20:23], v[56:59], a[60:63], v[20:23]
    ds_read_b128 v[56:59], v4 offset:22528
    v_mfma_f32_16x16x32_bf16 v[28:31], v[60:63], a[60:63], v[28:31]
    v_mfma_f32_16x16x32_bf16 v[24:27], v[60:63], a[56:59], v[24:27]
    ds_read_b128 v[60:63], v4 offset:22784
    s_waitcnt lgkmcnt(6)
    v_mfma_f32_16x16x32_bf16 v[16:19], v[32:35], a[64:67], v[16:19]
    v_mfma_f32_16x16x32_bf16 v[20:23], v[32:35], a[68:71], v[20:23]
    ds_read_b128 v[32:35], v4 offset:24576
    v_mfma_f32_16x16x32_bf16 v[28:31], v[36:39], a[68:71], v[28:31]
    v_mfma_f32_16x16x32_bf16 v[24:27], v[36:39], a[64:67], v[24:27]
    ds_read_b128 v[36:39], v4 offset:24832
    s_waitcnt lgkmcnt(6)
    v_mfma_f32_16x16x32_bf16 v[16:19], v[40:43], a[72:75], v[16:19]
    v_mfma_f32_16x16x32_bf16 v[20:23], v[40:43], a[76:79], v[20:23]
    ds_read_b128 v[40:43], v4 offset:26624
    v_mfma_f32_16x16x32_bf16 v[28:31], v[44:47], a[76:79], v[28:31]
    v_mfma_f32_16x16x32_bf16 v[24:27], v[44:47], a[72:75], v[24:27]
    ds_read_b128 v[44:47], v4 offset:26880
    s_waitcnt lgkmcnt(6)
    v_mfma_f32_16x16x32_bf16 v[16:19], v[48:51], a[80:83], v[16:19]
    v_mfma_f32_16x16x32_bf16 v[20:23], v[48:51], a[84:87], v[20:23]
    v_mfma_f32_16x16x32_bf16 v[28:31], v[52:55], a[84:87], v[28:31]
    v_mfma_f32_16x16x32_bf16 v[24:27], v[52:55], a[80:83], v[24:27]
    s_waitcnt lgkmcnt(4)
    v_mfma_f32_16x16x32_bf16 v[16:19], v[56:59], a[88:91], v[16:19]
    v_mfma_f32_16x16x32_bf16 v[20:23], v[56:59], a[92:95], v[20:23]
    v_mfma_f32_16x16x32_bf16 v[28:31], v[60:63], a[92:95], v[28:31]
    v_mfma_f32_16x16x32_bf16 v[24:27], v[60:63], a[88:91], v[24:27]
    s_waitcnt lgkmcnt(2)
    v_mfma_f32_16x16x32_bf16 v[16:19], v[32:35], a[96:99], v[16:19]
    v_mfma_f32_16x16x32_bf16 v[20:23], v[32:35], a[100:103], v[20:23]
    s_cmp_eq_u32 s81, 1
    s_cbranch_scc1 L_g_h2_136
L_g_h2_136_b:
    ds_write_b32 v119, v118
    v_mfma_f32_16x16x32_bf16 v[28:31], v[36:39], a[100:103], v[28:31]
    v_mfma_f32_16x16x32_bf16 v[24:27], v[36:39], a[96:99], v[24:27]
    s_waitcnt lgkmcnt(0)
    v_mfma_f32_16x16x32_bf16 v[16:19], v[40:43], a[104:107], v[16:19]
    v_mfma_f32_16x16x32_bf16 v[20:23], v[40:43], a[108:111], v[20:23]
    v_mfma_f32_16x16x32_bf16 v[28:31], v[44:47], a[108:111], v[28:31]
    v_mfma_f32_16x16x32_bf16 v[24:27], v[44:47], a[104:107], v[24:27]
    v_xor_b32 v4, 0x10000, v4
    s_setprio 0
    s_waitcnt vmcnt(0)
    s_waitcnt lgkmcnt(0)
    s_barrier
    ds_read_b32 v14, v15
    s_nop 6
    ds_write_b128 v5, v[16:19] offset:0
    ds_write_b128 v5, v[20:23] offset:1024
    ds_write_b128 v5, v[24:27] offset:2048
    ds_write_b128 v5, v[28:31] offset:3072
    s_waitcnt lgkmcnt(4)
    v_readfirstlane_b32 s66, v14
    s_add_u32 s60, s60, 1
    s_mov_b32 s65, 0
    s_cmp_le_u32 s62, s60
    s_cbranch_scc1 L_g_dp_137_l
L_g_dp_137_a:
    s_cmp_ge_u32 s62, s66
    s_cbranch_scc1 L_g_dp_137_d
    s_add_u32 s47, s61, 4096
    s_mov_b32 m0, s64
    s_add_u32 s62, s62, 1
    buffer_load_dwordx4 v3, s[12:15], s61 offen offset:0 sc1 lds
    buffer_load_dwordx4 v3, s[12:15], s61 offen offset:1024 sc1 lds
    buffer_load_dwordx4 v3, s[12:15], s61 offen offset:2048 sc1 lds
    buffer_load_dwordx4 v3, s[12:15], s61 offen offset:3072 sc1 lds
    s_add_u32 m0, s64, 4096
    s_add_u32 s61, s61, 229376
    buffer_load_dwordx4 v3, s[12:15], s47 offen offset:0 sc1 lds
    buffer_load_dwordx4 v3, s[12:15], s47 offen offset:1024 sc1 lds
    buffer_load_dwordx4 v3, s[12:15], s47 offen offset:2048 sc1 lds
    s_xor_b32 s64, s64, 0x10000
L_g_dp_137_d:
    s_cmp_lg_u32 s44, 2
    s_cbranch_scc1 L_g_pf_138
    s_cmp_ge_u32 s62, s66
    s_cbranch_scc1 L_g_pf_138
    buffer_load_dword v117, v116, s[12:15], s61 offen sc1
L_g_pf_138:
    s_cmp_le_u32 s66, s60
    s_cbranch_scc1 L_g_ex0_134
    s_cmp_lg_u32 s65, 0
    s_cbranch_scc1 L_g_nw_133
    ds_read_b128 v[32:35], v4 offset:0
    ds_read_b128 v[36:39], v4 offset:256
    ds_read_b128 v[40:43], v4 offset:2048
    ds_read_b128 v[44:47], v4 offset:2304
    ds_read_b128 v[48:51], v4 offset:4096
    ds_read_b128 v[52:55], v4 offset:4352
    ds_read_b128 v[56:59], v4 offset:6144
    ds_read_b128 v[60:63], v4 offset:6400
    s_cmp_lg_u32 s44, 0
    s_cbranch_scc1 L_g_nl_139
    s_mov_b32 s46, s66
    s_cmp_lg_u32 s81, 0
    s_cbranch_scc1 L_g_nl_139_e
    v_cmp_ge_u32 vcc, v12, v11
    s_nop 0
    s_ff1_i32_b64 s46, vcc
    s_lshr_b32 s46, s46, 4
    s_min_u32 s46, s46, 4
    s_add_u32 s46, s46, s54
    s_min_u32 s46, s46, s75
    v_mov_b32 v118, s46
L_g_nl_139_e:
    s_add_u32 s47, s60, 3
    s_min_u32 s47, s47, s75
    s_cmp_lt_u32 s46, s47
    s_cselect_b32 s81, 1, 0
    s_cbranch_scc1 L_g_nl_139
    s_add_u32 s54, s60, 2
    v_add_u32 v12, s54, v113
    v_subrev_u32 v13, 60, v12
    v_subrev_u32 v11, 63, v12
    v_ashrrev_i32 v13, 31, v13
    v_ashrrev_i32 v11, 31, v11
    v_add3_u32 v13, v13, v11, 2
    v_lshl_add_u32 v13, v13, 16, v7
    buffer_load_dword v11, v13, s[12:15], 0 offen sc1
L_g_nl_139:
    s_waitcnt lgkmcnt(8)
    s_branch L_g_loop0_123
L_g_ex0_134:
    s_cmp_lg_u32 s44, 0
    s_cbranch_scc1 L_g_ex0_134_n
    ds_write_b32 v15, v118 offset:20
    s_cmp_ge_u32 s60, s75
    s_cbranch_scc1 L_g_ex0_134_n
    s_sleep 6
    s_add_u32 s54, s60, 0
    v_add_u32 v12, s54, v113
    v_subrev_u32 v13, 60, v12
    v_subrev_u32 v11, 63, v12
    v_ashrrev_i32 v13, 31, v13
    v_ashrrev_i32 v11, 31, v11
    v_add3_u32 v13, v13, v11, 2
    v_lshl_add_u32 v13, v13, 16, v7
    buffer_load_dword v11, v13, s[12:15], 0 offen sc1
    s_waitcnt vmcnt(0)
    v_cmp_ge_u32 vcc, v12, v11
    s_nop 0
    s_ff1_i32_b64 s46, vcc
    s_lshr_b32 s46, s46, 4
    s_min_u32 s46, s46, 4
    s_add_u32 s46, s46, s54
    s_min_u32 s46, s46, s75
    v_mov_b32 v118, s46
    ds_write_b32 v15, v118 offset:20
L_g_ex0_134_n:
    s_waitcnt lgkmcnt(0)
    s_barrier
    ds_read_b32 v14, v15 offset:20
    s_waitcnt lgkmcnt(0)
    v_readfirstlane_b32 s66, v14
    s_barrier
    s_cmp_gt_u32 s66, s60
    s_cbranch_scc1 L_g_restart_120_go
    s_branch L_g_tail_125
L_g_g1r_122:
    s_mov_b32 s65, 1
    s_branch L_g_loop1_124_e
.p2align 6
L_g_loop1_124:
    s_mov_b32 s65, 0
L_g_loop1_124_e:
    s_barrier
    s_bitcmp1_b32 s67, 1
    s_cbranch_scc0 L_g_nfl_140
    s_cmp_lg_u32 s44, 4
    s_cbranch_scc1 L_g_nfl_140_d
    s_sub_u32 s59, s60, 1
    v_mov_b32 v10, s59
    buffer_store_dword v10, v115, s[12:15], s52 offen sc1
L_g_nfl_140_d:
    ds_read_b128 v[80:83], v5 offset:0
    ds_read_b128 v[84:87], v5 offset:1024
    ds_read_b128 v[88:91], v5 offset:2048
    ds_read_b128 v[92:95], v5 offset:3072
    s_cmp_le_u32 s62, s60
    s_cbranch_scc1 L_g_dp_145_l
L_g_dp_145_a:
    s_cmp_ge_u32 s62, s66
    s_cbranch_scc1 L_g_dp_145_d
    s_add_u32 s47, s61, 4096
    s_mov_b32 m0, s64
    s_add_u32 s62, s62, 1
    buffer_load_dwordx4 v3, s[12:15], s61 offen offset:0 sc1 lds
    buffer_load_dwordx4 v3, s[12:15], s61 offen offset:1024 sc1 lds
    buffer_load_dwordx4 v3, s[12:15], s61 offen offset:2048 sc1 lds
    buffer_load_dwordx4 v3, s[12:15], s61 offen offset:3072 sc1 lds
    s_add_u32 m0, s64, 4096
    s_add_u32 s61, s61, 229376
    buffer_load_dwordx4 v3, s[12:15], s47 offen offset:0 sc1 lds
    buffer_load_dwordx4 v3, s[12:15], s47 offen offset:1024 sc1 lds
    buffer_load_dwordx4 v3, s[12:15], s47 offen offset:2048 sc1 lds
    s_xor_b32 s64, s64, 0x10000
L_g_dp_145_d:
    s_bitcmp1_b32 s67, 0
    s_cbranch_scc0 L_g_nep_141
    s_waitcnt lgkmcnt(0)
    v_add_f32 v80, v80, v16
    v_add_f32 v81, v81, v17
    v_add_f32 v82, v82, v18
    v_add_f32 v83, v83, v19
    v_add_f32 v84, v84, v20
    v_add_f32 v85, v85, v21
    v_add_f32 v86, v86, v22
    v_add_f32 v87, v87, v23
    v_add_f32 v88, v88, v24
    v_add_f32 v89, v89, v25
    v_add_f32 v90, v90, v26
    v_add_f32 v91, v91, v27
    v_add_f32 v92, v92, v28
    v_add_f32 v93, v93, v29
    v_add_f32 v94, v94, v30
    v_add_f32 v95, v95, v31
    v_cvt_pk_bf16_f32 v104, v80, v81
    v_cvt_pk_bf16_f32 v105, v82, v83
    v_cvt_pk_bf16_f32 v106, v84, v85
    v_cvt_pk_bf16_f32 v107, v86, v87
    s_nop 1
    v_permlane16_swap_b32 v104, v106
    v_permlane16_swap_b32 v105, v107
    buffer_store_dwordx4 v[104:107], v8, s[12:15], s63 offen sc1
    v_cvt_pk_bf16_f32 v108, v88, v89
    v_cvt_pk_bf16_f32 v109, v90, v91
    v_cvt_pk_bf16_f32 v110, v92, v93
    v_cvt_pk_bf16_f32 v111, v94, v95
    s_nop 1
    v_permlane16_swap_b32 v108, v110
    v_permlane16_swap_b32 v109, v111
    buffer_store_dwordx4 v[108:111], v9, s[12:15], s63 offen sc1
    s_add_u32 s63, s63, 262144
L_g_nep_141:
    s_cmp_lg_u32 s65, 0
    s_cbranch_scc1 L_g_nw1_142
    ds_read_b128 v[32:35], v4 offset:0
    ds_read_b128 v[36:39], v4 offset:256
    ds_read_b128 v[40:43], v4 offset:2048
    ds_read_b128 v[44:47], v4 offset:2304
    ds_read_b128 v[48:51], v4 offset:4096
    ds_read_b128 v[52:55], v4 offset:4352
    ds_read_b128 v[56:59], v4 offset:6144
    ds_read_b128 v[60:63], v4 offset:6400
    s_barrier
L_g_jn_144:
    s_setprio 1
    s_waitcnt lgkmcnt(6)
    v_mfma_f32_16x16x32_bf16 v[16:19], v[32:35], a[0:3], 0
    ds_read_b32 v14, v15
    v_mfma_f32_16x16x32_bf16 v[20:23], v[32:35], a[4:7], 0
    ds_read_b128 v[32:35], v4 offset:8192
    v_mfma_f32_16x16x32_bf16 v[28:31], v[36:39], a[4:7], 0
    v_mfma_f32_16x16x32_bf16 v[24:27], v[36:39], a[0:3], 0
    ds_read_b128 v[36:39], v4 offset:8448
    s_waitcnt lgkmcnt(6)
    v_mfma_f32_16x16x32_bf16 v[16:19], v[40:43], a[8:11], v[16:19]
    v_mfma_f32_16x16x32_bf16 v[20:23], v[40:43], a[12:15], v[20:23]
    ds_read_b128 v[40:43], v4 offset:10240
    v_mfma_f32_16x16x32_bf16 v[28:31], v[44:47], a[12:15], v[28:31]
    v_mfma_f32_16x16x32_bf16 v[24:27], v[44:47], a[8:11], v[24:27]
    ds_read_b128 v[44:47], v4 offset:10496
    s_waitcnt lgkmcnt(6)
    v_mfma_f32_16x16x32_bf16 v[16:19], v[48:51], a[16:19], v[16:19]
    v_mfma_f32_16x16x32_bf16 v[20:23], v[48:51], a[20:23], v[20:23]
    ds_read_b128 v[48:51], v4 offset:12288
    v_mfma_f32_16x16x32_bf16 v[28:31], v[52:55], a[20:23], v[28:31]
    v_mfma_f32_16x16x32_bf16 v[24:27], v[52:55], a[16:19], v[24:27]
    ds_read_b128 v[52:55], v4 offset:12544
    s_waitcnt lgkmcnt(6)
    v_mfma_f32_16x16x32_bf16 v[16:19], v[56:59], a[24:27], v[16:19]
    v_mfma_f32_16x16x32_bf16 v[20:23], v[56:59], a[28:31], v[20:23]
    ds_read_b128 v[56:59], v4 offset:14336
    v_mfma_f32_16x16x32_bf16 v[28:31], v[60:63], a[28:31], v[28:31]
    v_mfma_f32_16x16x32_bf16 v[24:27], v[60:63], a[24:27], v[24:27]
    ds_read_b128 v[60:63], v4 offset:14592
    s_waitcnt lgkmcnt(6)
    v_mfma_f32_16x16x32_bf16 v[16:19], v[32:35], a[32:35], v[16:19]
    v_mfma_f32_16x16x32_bf16 v[20:23], v[32:35], a[36:39], v[20:23]
    ds_read_b128 v[32:35], v4 offset:16384
    v_mfma_f32_16x16x32_bf16 v[28:31], v[36:39], a[36:39], v[28:31]
    v_mfma_f32_16x16x32_bf16 v[24:27], v[36:39], a[32:35], v[24:27]
    ds_read_b128 v[36:39], v4 offset:16640
    s_waitcnt lgkmcnt(6)
    v_mfma_f32_16x16x32_bf16 v[16:19], v[40:43], a[40:43], v[16:19]
    v_mfma_f32_16x16x32_bf16 v[20:23], v[40:43], a[44:47], v[20:23]
    ds_read_b128 v[40:43], v4 offset:18432
    v_mfma_f32_16x16x32_bf16 v[28:31], v[44:47], a[44:47], v[28:31]
    v_mfma_f32_16x16x32_bf16 v[24:27], v[44:47], a[40:43], v[24:27]
    ds_read_b128 v[44:47], v4 offset:18688
    s_waitcnt lgkmcnt(6)
    v_mfma_f32_16x16x32_bf16 v[16:19], v[48:51], a[48:51], v[16:19]
    v_mfma_f32_16x16x32_bf16 v[20:23], v[48:51], a[52:55], v[20:23]
    ds_read_b128 v[48:51], v4 offset:20480
    v_mfma_f32_16x16x32_bf16 v[28:31], v[52:55], a[52:55], v[28:31]
    v_mfma_f32_16x16x32_bf16 v[24:27], v[52:55], a[48:51], v[24:27]
    ds_read_b128 v[52:55], v4 offset:20736
    s_waitcnt lgkmcnt(6)
    v_mfma_f32_16x16x32_bf16 v[16:19], v[56:59], a[56:59], v[16:19]
    v_mfma_f32_16x16x32_bf16 v[20:23], v[56:59], a[60:63], v[20:23]
    ds_read_b128 v[56:59], v4 offset:22528
    v_mfma_f32_16x16x32_bf16 v[28:31], v[60:63], a[60:63], v[28:31]
    v_mfma_f32_16x16x32_bf16 v[24:27], v[60:63], a[56:59], v[24:27]
    ds_read_b128 v[60:63], v4 offset:22784
    s_waitcnt lgkmcnt(6)
    v_mfma_f32_16x16x32_bf16 v[16:19], v[32:35], a[64:67], v[16:19]
    v_mfma_f32_16x16x32_bf16 v[20:23], v[32:35], a[68:71], v[20:23]
    ds_read_b128 v[32:35], v4 offset:24576
    v_mfma_f32_16x16x32_bf16 v[28:31], v[36:39], a[68:71], v[28:31]
    v_mfma_f32_16x16x32_bf16 v[24:27], v[36:39], a[64:67], v[24:27]
    ds_read_b128 v[36:39], v4 offset:24832
    s_waitcnt lgkmcnt(6)
    v_mfma_f32_16x16x32_bf16 v[16:19], v[40:43], a[72:75], v[16:19]
    v_mfma_f32_16x16x32_bf16 v[20:23], v[40:43], a[76:79], v[20:23]
    ds_read_b128 v[40:43], v4 offset:26624
    v_mfma_f32_16x16x32_bf16 v[28:31], v[44:47], a[76:79], v[28:31]
    v_mfma_f32_16x16x32_bf16 v[24:27], v[44:47], a[72:75], v[24:27]
    ds_read_b128 v[44:47], v4 offset:26880
    s_waitcnt lgkmcnt(6)
    v_mfma_f32_16x16x32_bf16 v[16:19], v[48:51], a[80:83], v[16:19]
    v_mfma_f32_16x16x32_bf16 v[20:23], v[48:51], a[84:87], v[20:23]
    v_mfma_f32_16x16x32_bf16 v[28:31], v[52:55], a[84:87], v[28:31]
    v_mfma_f32_16x16x32_bf16 v[24:27], v[52:55], a[80:83], v[24:27]
    s_waitcnt lgkmcnt(4)
    v_mfma_f32_16x16x32_bf16 v[16:19], v[56:59], a[88:91], v[16:19]
    v_mfma_f32_16x16x32_bf16 v[20:23], v[56:59], a[92:95], v[20:23]
    v_mfma_f32_16x16x32_bf16 v[28:31], v[60:63], a[92:95], v[28:31]
    v_mfma_f32_16x16x32_bf16 v[24:27], v[60:63], a[88:91], v[24:27]
    s_waitcnt lgkmcnt(2)
    v_mfma_f32_16x16x32_bf16 v[16:19], v[32:35], a[96:99], v[16:19]
    v_mfma_f32_16x16x32_bf16 v[20:23], v[32:35], a[100:103], v[20:23]
    v_mfma_f32_16x16x32_bf16 v[28:31], v[36:39], a[100:103], v[28:31]
    v_mfma_f32_16x16x32_bf16 v[24:27], v[36:39], a[96:99], v[24:27]
    s_waitcnt lgkmcnt(0)
    v_mfma_f32_16x16x32_bf16 v[16:19], v[40:43], a[104:107], v[16:19]
    v_mfma_f32_16x16x32_bf16 v[20:23], v[40:43], a[108:111], v[20:23]
    v_mfma_f32_16x16x32_bf16 v[28:31], v[44:47], a[108:111], v[28:31]
    v_mfma_f32_16x16x32_bf16 v[24:27], v[44:47], a[104:107], v[24:27]
    v_xor_b32 v4, 0x10000, v4
    s_setprio 0
    s_waitcnt vmcnt(0)
    v_readfirstlane_b32 s66, v14
    s_lshl_b32 s67, s67, 1
    s_or_b32 s67, s67, 1
    s_add_u32 s60, s60, 1
    s_cmp_gt_u32 s66, s60
    s_cbranch_scc1 L_g_loop1_124
    s_barrier
    ds_read_b32 v14, v15 offset:20
    ds_read_b128 v[80:83], v5 offset:0
    ds_read_b128 v[84:87], v5 offset:1024
    ds_read_b128 v[88:91], v5 offset:2048
    ds_read_b128 v[92:95], v5 offset:3072
    s_waitcnt lgkmcnt(4)
    v_readfirstlane_b32 s66, v14
    s_barrier
    s_mov_b32 s69, 0
    s_cmp_gt_u32 s62, s60
    s_cbranch_scc1 L_g_nd_146
    s_cmp_ge_u32 s62, s66
    s_cbranch_scc1 L_g_nd_146
    s_add_u32 s47, s61, 4096
    s_add_u32 m0, s64, 0
    s_nop 0
    buffer_load_dwordx4 v3, s[12:15], s61 offen offset:0 sc1 lds
    buffer_load_dwordx4 v3, s[12:15], s61 offen offset:1024 sc1 lds
    buffer_load_dwordx4 v3, s[12:15], s61 offen offset:2048 sc1 lds
    buffer_load_dwordx4 v3, s[12:15], s61 offen offset:3072 sc1 lds
    s_add_u32 m0, s64, 4096
    s_nop 0
    buffer_load_dwordx4 v3, s[12:15], s47 offen offset:0 sc1 lds
    buffer_load_dwordx4 v3, s[12:15], s47 offen offset:1024 sc1 lds
    buffer_load_dwordx4 v3, s[12:15], s47 offen offset:2048 sc1 lds
    s_add_u32 s61, s61, 229376
    s_add_u32 s62, s62, 1
    s_xor_b32 s64, s64, 0x10000
    s_mov_b32 s69, 1
L_g_nd_146:
    s_sub_u32 s59, s60, 1
    s_waitcnt lgkmcnt(3)
    v_add_f32 v80, v80, v16
    v_add_f32 v81, v81, v17
    v_add_f32 v82, v82, v18
    v_add_f32 v83, v83, v19
    s_waitcnt lgkmcnt(2)
    v_add_f32 v84, v84, v20
    v_add_f32 v85, v85, v21
    v_add_f32 v86, v86, v22
    v_add_f32 v87, v87, v23
    s_waitcnt lgkmcnt(1)
    v_add_f32 v88, v88, v24
    v_add_f32 v89, v89, v25
    v_add_f32 v90, v90, v26
    v_add_f32 v91, v91, v27
    s_waitcnt lgkmcnt(0)
    v_add_f32 v92, v92, v28
    v_add_f32 v93, v93, v29
    v_add_f32 v94, v94, v30
    v_add_f32 v95, v95, v31
    v_cvt_pk_bf16_f32 v104, v80, v81
    v_cvt_pk_bf16_f32 v105, v82, v83
    v_cvt_pk_bf16_f32 v106, v84, v85
    v_cvt_pk_bf16_f32 v107, v86, v87
    s_nop 1
    v_permlane16_swap_b32 v104, v106
    v_permlane16_swap_b32 v105, v107
    buffer_store_dwordx4 v[104:107], v8, s[12:15], s63 offen sc1
    v_cvt_pk_bf16_f32 v108, v88, v89
    v_cvt_pk_bf16_f32 v109, v90, v91
    v_cvt_pk_bf16_f32 v110, v92, v93
    v_cvt_pk_bf16_f32 v111, v94, v95
    s_nop 1
    v_permlane16_swap_b32 v108, v110
    v_permlane16_swap_b32 v109, v111
    buffer_store_dwordx4 v[108:111], v9, s[12:15], s63 offen sc1
    s_add_u32 s63, s63, 262144
    s_mov_b32 s67, 0
    s_mov_b32 s71, 1
    s_cmp_gt_u32 s66, s60
    s_cbranch_scc1 L_g_g1r_122
    v_mov_b32 v10, 1
    s_mov_b64 exec, 1
    s_waitcnt vmcnt(0)
    ds_add_rtn_u32 v10, v15, v10 offset:4
    s_waitcnt lgkmcnt(0)
    v_readfirstlane_b32 s46, v10
    s_mov_b64 exec, -1
    s_mov_b32 s71, 0
    s_sub_u32 s59, s60, 1
    s_cmp_lg_u32 s46, s68
    s_cbranch_scc1 L_g_df_147
    v_mov_b32 v10, s59
    v_add_u32 v10, 1, v10
    v_mov_b32 v11, 0
    s_mov_b64 exec, 1
    buffer_store_dword v10, v11, s[12:15], s52 offen sc1
    s_mov_b64 exec, -1
L_sf_148:
L_g_df_147:
    s_add_u32 s68, s68, 4
    s_cmp_gt_u32 s66, s60
    s_cbranch_scc1 L_g_g1r_122
L_g_tail_125:
    s_cmp_lt_u32 s60, s75
    s_cbranch_scc1 L_g_restart_120
    s_waitcnt vmcnt(0)
    s_barrier
    s_branch L_c_done_1
L_g_h1_135:
    s_add_u32 s54, s60, 1
    v_add_u32 v12, s54, v113
    v_subrev_u32 v13, 60, v12
    v_subrev_u32 v11, 63, v12
    v_ashrrev_i32 v13, 31, v13
    v_ashrrev_i32 v11, 31, v11
    v_add3_u32 v13, v13, v11, 2
    v_lshl_add_u32 v13, v13, 16, v7
    buffer_load_dword v11, v13, s[12:15], 0 offen sc1
    s_branch L_g_h1_135_b
L_g_h2_136:
    s_waitcnt vmcnt(0)
    v_cmp_ge_u32 vcc, v12, v11
    s_nop 0
    s_ff1_i32_b64 s46, vcc
    s_lshr_b32 s46, s46, 4
    s_min_u32 s46, s46, 4
    s_add_u32 s46, s46, s54
    s_min_u32 s46, s46, s75
    v_mov_b32 v118, s46
    s_branch L_g_h2_136_b
L_g_dp_137_l:
    s_cmp_ge_u32 s62, s66
    s_cbranch_scc1 L_g_dp_137_d
    s_mov_b32 s65, 1
    s_add_u32 s47, s61, 4096
    s_mov_b32 m0, s64
    s_add_u32 s62, s62, 1
    buffer_load_dwordx4 v3, s[12:15], s61 offen offset:0 sc1 lds
    buffer_load_dwordx4 v3, s[12:15], s61 offen offset:1024 sc1 lds
    buffer_load_dwordx4 v3, s[12:15], s61 offen offset:2048 sc1 lds
    buffer_load_dwordx4 v3, s[12:15], s61 offen offset:3072 sc1 lds
    s_add_u32 m0, s64, 4096
    s_add_u32 s61, s61, 229376
    buffer_load_dwordx4 v3, s[12:15], s47 offen offset:0 sc1 lds
    buffer_load_dwordx4 v3, s[12:15], s47 offen offset:1024 sc1 lds
    buffer_load_dwordx4 v3, s[12:15], s47 offen offset:2048 sc1 lds
    s_xor_b32 s64, s64, 0x10000
    s_branch L_g_dp_137_a
L_g_nw_133:
    s_waitcnt vmcnt(0) lgkmcnt(0)
    s_cmp_lg_u32 s44, 0
    s_cbranch_scc1 L_g_nl_149
    s_cmp_lt_u32 s66, s75
    s_cselect_b32 s81, 1, 2
L_g_nl_149:
    s_branch L_g_loop0_123_l
L_g_nfl_140:
    s_cmp_eq_u32 s71, 0
    s_cbranch_scc1 L_g_nfl_140_d
    v_mov_b32 v10, 1
    s_mov_b64 exec, 1
    s_waitcnt vmcnt(0)
    ds_add_rtn_u32 v10, v15, v10 offset:4
    s_waitcnt lgkmcnt(0)
    v_readfirstlane_b32 s46, v10
    s_mov_b64 exec, -1
    s_mov_b32 s71, 0
    s_sub_u32 s59, s60, 1
    s_cmp_lg_u32 s46, s68
    s_cbranch_scc1 L_g_df_150
    v_mov_b32 v10, s59
    v_add_u32 v10, 1, v10
    v_mov_b32 v11, 0
    s_mov_b64 exec, 1
    buffer_store_dword v10, v11, s[12:15], s52 offen sc1
    s_mov_b64 exec, -1
L_sf_151:
L_g_df_150:
    s_add_u32 s68, s68, 4
    s_mov_b32 s65, 2
    s_branch L_g_nfl_140_d
L_g_dp_145_l:
    s_cmp_ge_u32 s62, s66
    s_cbranch_scc1 L_g_dp_145_d
    s_or_b32 s65, s65, 1
    s_add_u32 s47, s61, 4096
    s_mov_b32 m0, s64
    s_add_u32 s62, s62, 1
    buffer_load_dwordx4 v3, s[12:15], s61 offen offset:0 sc1 lds
    buffer_load_dwordx4 v3, s[12:15], s61 offen offset:1024 sc1 lds
    buffer_load_dwordx4 v3, s[12:15], s61 offen offset:2048 sc1 lds
    buffer_load_dwordx4 v3, s[12:15], s61 offen offset:3072 sc1 lds
    s_add_u32 m0, s64, 4096
    s_add_u32 s61, s61, 229376
    buffer_load_dwordx4 v3, s[12:15], s47 offen offset:0 sc1 lds
    buffer_load_dwordx4 v3, s[12:15], s47 offen offset:1024 sc1 lds
    buffer_load_dwordx4 v3, s[12:15], s47 offen offset:2048 sc1 lds
    s_xor_b32 s64, s64, 0x10000
    s_branch L_g_dp_145_a
L_g_nw1_142:
    s_cmp_eq_u32 s65, 2
    s_cbranch_scc1 L_g_nw1_142_w
    s_waitcnt vmcnt(0)
L_g_nw1_142_w:
    s_barrier
    ds_read_b128 v[32:35], v4 offset:0
    ds_read_b128 v[36:39], v4 offset:256
    ds_read_b128 v[40:43], v4 offset:2048
    ds_read_b128 v[44:47], v4 offset:2304
    ds_read_b128 v[48:51], v4 offset:4096
    ds_read_b128 v[52:55], v4 offset:4352
    ds_read_b128 v[56:59], v4 offset:6144
    ds_read_b128 v[60:63], v4 offset:6400
    s_branch L_g_jn_144
L_w_wo_12:
    s_load_dwordx2 s[4:5], s[0:1], 40
    s_load_dwordx2 s[6:7], s[0:1], 72
    s_and_b32 s50, s44, 3
    s_lshr_b32 s51, s44, 2
    s_waitcnt lgkmcnt(0)
    s_mov_b32 s24, s4
    s_and_b32 s25, s5, 0xffff
    s_mov_b32 s26, 0x800000
    s_mov_b32 s27, 0x00020000
    v_lshrrev_b32 v3, 4, v1
    v_and_b32 v4, 15, v1
    v_lshlrev_b32 v5, 2, v3
    v_xor_b32 v4, v4, v5
    v_mul_u32_u24 v3, 2048, v3
    v_lshl_add_u32 v3, v4, 4, v3
    s_mul_i32 s46, s51, 512
    s_mul_i32 s47, s50, 16
    s_add_u32 s46, s46, s47
    s_mul_i32 s47, s42, 1024
    s_add_u32 s46, s46, s47
    s_mul_i32 s46, s46, 2048
    s_lshl_b32 s47, s43, 8
    s_add_u32 s46, s46, s47
    s_lshl_b32 s45, s51, 16
    s_mul_i32 s47, s50, 4096
    s_add_u32 s45, s45, s47
    v_bfe_u32 v4, v1, 2, 2
    v_bfe_u32 v5, v1, 4, 1
    v_lshlrev_b32 v5, 1, v5
    v_bfe_u32 v6, v1, 1, 1
    v_add_u32 v5, v5, v6
    s_lshl_b32 s47, s50, 2
    v_add_u32 v5, s47, v5
    v_lshlrev_b32 v6, 2, v4
    v_xor_b32 v5, v5, v6
    v_lshlrev_b32 v5, 4, v5
    v_lshl_add_u32 v5, v4, 8, v5
    v_bfe_u32 v6, v1, 0, 1
    v_lshl_add_u32 v5, v6, 3, v5
    v_lshrrev_b32 v6, 5, v1
    v_mul_u32_u24 v6, 1024, v6
    v_add_u32 v5, v5, v6
    s_lshl_b32 s47, s51, 16
    v_add_u32 v5, s47, v5
    v_bfe_u32 v4, v1, 2, 2
    v_xor_b32 v5, s50, v4
    v_lshlrev_b32 v5, 6, v5
    v_lshl_add_u32 v5, v4, 8, v5
    v_and_b32 v6, 3, v1
    v_lshl_add_u32 v5, v6, 3, v5
    v_lshrrev_b32 v6, 4, v1
    v_lshl_add_u32 v5, v6, 10, v5
    v_lshrrev_b32 v6, 5, v1
    s_lshl_b32 s47, s51, 16
    v_add_u32 v5, s47, v5
    s_add_u32 m0, s45, 0
    s_add_u32 s47, s46, 0x0
    buffer_load_dwordx4 v3, s[24:27], s47 offen lds
    s_add_u32 m0, s45, 1024
    s_add_u32 s47, s46, 0x2000
    buffer_load_dwordx4 v3, s[24:27], s47 offen lds
    s_add_u32 m0, s45, 2048
    s_add_u32 s47, s46, 0x4000
    buffer_load_dwordx4 v3, s[24:27], s47 offen lds
    s_add_u32 m0, s45, 3072
    s_add_u32 s47, s46, 0x6000
    buffer_load_dwordx4 v3, s[24:27], s47 offen lds
    s_add_u32 m0, s45, 16384
    s_add_u32 s47, s46, 0x20000
    buffer_load_dwordx4 v3, s[24:27], s47 offen lds
    s_add_u32 m0, s45, 17408
    s_add_u32 s47, s46, 0x22000
    buffer_load_dwordx4 v3, s[24:27], s47 offen lds
    s_add_u32 m0, s45, 18432
    s_add_u32 s47, s46, 0x24000
    buffer_load_dwordx4 v3, s[24:27], s47 offen lds
    s_add_u32 m0, s45, 19456
    s_add_u32 s47, s46, 0x26000
    buffer_load_dwordx4 v3, s[24:27], s47 offen lds
    s_add_u32 m0, s45, 32768
    s_add_u32 s47, s46, 0x40000
    buffer_load_dwordx4 v3, s[24:27], s47 offen lds
    s_add_u32 m0, s45, 33792
    s_add_u32 s47, s46, 0x42000
    buffer_load_dwordx4 v3, s[24:27], s47 offen lds
    s_add_u32 m0, s45, 34816
    s_add_u32 s47, s46, 0x44000
    buffer_load_dwordx4 v3, s[24:27], s47 offen lds
    s_add_u32 m0, s45, 35840
    s_add_u32 s47, s46, 0x46000
    buffer_load_dwordx4 v3, s[24:27], s47 offen lds
    s_add_u32 m0, s45, 49152
    s_add_u32 s47, s46, 0x60000
    buffer_load_dwordx4 v3, s[24:27], s47 offen lds
    s_add_u32 m0, s45, 50176
    s_add_u32 s47, s46, 0x62000
    buffer_load_dwordx4 v3, s[24:27], s47 offen lds
    s_add_u32 m0, s45, 51200
    s_add_u32 s47, s46, 0x64000
    buffer_load_dwordx4 v3, s[24:27], s47 offen lds
    s_add_u32 m0, s45, 52224
    s_add_u32 s47, s46, 0x66000
    buffer_load_dwordx4 v3, s[24:27], s47 offen lds
    s_waitcnt vmcnt(12) lgkmcnt(0)
    s_barrier
    ds_read_b64_tr_b16 a[0:1], v5 offset:0
    ds_read_b64_tr_b16 a[2:3], v5 offset:4096
    ds_read_b64_tr_b16 a[4:5], v5 offset:32
    ds_read_b64_tr_b16 a[6:7], v5 offset:4128
    ds_read_b64_tr_b16 a[8:9], v5 offset:8192
    ds_read_b64_tr_b16 a[10:11], v5 offset:12288
    ds_read_b64_tr_b16 a[12:13], v5 offset:8224
    ds_read_b64_tr_b16 a[14:15], v5 offset:12320
    s_waitcnt vmcnt(8) lgkmcnt(0)
    s_barrier
    s_add_u32 m0, s45, 0
    s_add_u32 s47, s46, 0x80000
    buffer_load_dwordx4 v3, s[24:27], s47 offen lds
    s_add_u32 m0, s45, 1024
    s_add_u32 s47, s46, 0x82000
    buffer_load_dwordx4 v3, s[24:27], s47 offen lds
    s_add_u32 m0, s45, 2048
    s_add_u32 s47, s46, 0x84000
    buffer_load_dwordx4 v3, s[24:27], s47 offen lds
    s_add_u32 m0, s45, 3072
    s_add_u32 s47, s46, 0x86000
    buffer_load_dwordx4 v3, s[24:27], s47 offen lds
    ds_read_b64_tr_b16 a[16:17], v5 offset:16384
    ds_read_b64_tr_b16 a[18:19], v5 offset:20480
    ds_read_b64_tr_b16 a[20:21], v5 offset:16416
    ds_read_b64_tr_b16 a[22:23], v5 offset:20512
    ds_read_b64_tr_b16 a[24:25], v5 offset:24576
    ds_read_b64_tr_b16 a[26:27], v5 offset:28672
    ds_read_b64_tr_b16 a[28:29], v5 offset:24608
    ds_read_b64_tr_b16 a[30:31], v5 offset:28704
    s_waitcnt vmcnt(8) lgkmcnt(0)
    s_barrier
    s_add_u32 m0, s45, 16384
    s_add_u32 s47, s46, 0xa0000
    buffer_load_dwordx4 v3, s[24:27], s47 offen lds
    s_add_u32 m0, s45, 17408
    s_add_u32 s47, s46, 0xa2000
    buffer_load_dwordx4 v3, s[24:27], s47 offen lds
    s_add_u32 m0, s45, 18432
    s_add_u32 s47, s46, 0xa4000
    buffer_load_dwordx4 v3, s[24:27], s47 offen lds
    s_add_u32 m0, s45, 19456
    s_add_u32 s47, s46, 0xa6000
    buffer_load_dwordx4 v3, s[24:27], s47 offen lds
    ds_read_b64_tr_b16 a[32:33], v5 offset:32768
    ds_read_b64_tr_b16 a[34:35], v5 offset:36864
    ds_read_b64_tr_b16 a[36:37], v5 offset:32800
    ds_read_b64_tr_b16 a[38:39], v5 offset:36896
    ds_read_b64_tr_b16 a[40:41], v5 offset:40960
    ds_read_b64_tr_b16 a[42:43], v5 offset:45056
    ds_read_b64_tr_b16 a[44:45], v5 offset:40992
    ds_read_b64_tr_b16 a[46:47], v5 offset:45088
    s_waitcnt vmcnt(8) lgkmcnt(0)
    s_barrier
    s_add_u32 m0, s45, 32768
    s_add_u32 s47, s46, 0xc0000
    buffer_load_dwordx4 v3, s[24:27], s47 offen lds
    s_add_u32 m0, s45, 33792
    s_add_u32 s47, s46, 0xc2000
    buffer_load_dwordx4 v3, s[24:27], s47 offen lds
    s_add_u32 m0, s45, 34816
    s_add_u32 s47, s46, 0xc4000
    buffer_load_dwordx4 v3, s[24:27], s47 offen lds
    s_add_u32 m0, s45, 35840
    s_add_u32 s47, s46, 0xc6000
    buffer_load_dwordx4 v3, s[24:27], s47 offen lds
    ds_read_b64_tr_b16 a[48:49], v5 offset:49152
    ds_read_b64_tr_b16 a[50:51], v5 offset:53248
    ds_read_b64_tr_b16 a[52:53], v5 offset:49184
    ds_read_b64_tr_b16 a[54:55], v5 offset:53280
    ds_read_b64_tr_b16 a[56:57], v5 offset:57344
    ds_read_b64_tr_b16 a[58:59], v5 offset:61440
    ds_read_b64_tr_b16 a[60:61], v5 offset:57376
    ds_read_b64_tr_b16 a[62:63], v5 offset:61472
    s_waitcnt vmcnt(8) lgkmcnt(0)
    s_barrier
    s_add_u32 m0, s45, 49152
    s_add_u32 s47, s46, 0xe0000
    buffer_load_dwordx4 v3, s[24:27], s47 offen lds
    s_add_u32 m0, s45, 50176
    s_add_u32 s47, s46, 0xe2000
    buffer_load_dwordx4 v3, s[24:27], s47 offen lds
    s_add_u32 m0, s45, 51200
    s_add_u32 s47, s46, 0xe4000
    buffer_load_dwordx4 v3, s[24:27], s47 offen lds
    s_add_u32 m0, s45, 52224
    s_add_u32 s47, s46, 0xe6000
    buffer_load_dwordx4 v3, s[24:27], s47 offen lds
    ds_read_b64_tr_b16 a[64:65], v5 offset:0
    ds_read_b64_tr_b16 a[66:67], v5 offset:4096
    ds_read_b64_tr_b16 a[68:69], v5 offset:32
    ds_read_b64_tr_b16 a[70:71], v5 offset:4128
    ds_read_b64_tr_b16 a[72:73], v5 offset:8192
    ds_read_b64_tr_b16 a[74:75], v5 offset:12288
    ds_read_b64_tr_b16 a[76:77], v5 offset:8224
    ds_read_b64_tr_b16 a[78:79], v5 offset:12320
    s_waitcnt vmcnt(8) lgkmcnt(0)
    s_barrier
    ds_read_b64_tr_b16 a[80:81], v5 offset:16384
    ds_read_b64_tr_b16 a[82:83], v5 offset:20480
    ds_read_b64_tr_b16 a[84:85], v5 offset:16416
    ds_read_b64_tr_b16 a[86:87], v5 offset:20512
    ds_read_b64_tr_b16 a[88:89], v5 offset:24576
    ds_read_b64_tr_b16 a[90:91], v5 offset:28672
    ds_read_b64_tr_b16 a[92:93], v5 offset:24608
    ds_read_b64_tr_b16 a[94:95], v5 offset:28704
    s_waitcnt vmcnt(4) lgkmcnt(0)
    s_barrier
    ds_read_b64_tr_b16 a[96:97], v5 offset:32768
    ds_read_b64_tr_b16 a[98:99], v5 offset:36864
    ds_read_b64_tr_b16 a[100:101], v5 offset:32800
    ds_read_b64_tr_b16 a[102:103], v5 offset:36896
    ds_read_b64_tr_b16 a[104:105], v5 offset:40960
    ds_read_b64_tr_b16 a[106:107], v5 offset:45056
    ds_read_b64_tr_b16 a[108:109], v5 offset:40992
    ds_read_b64_tr_b16 a[110:111], v5 offset:45088
    s_waitcnt vmcnt(0) lgkmcnt(0)
    s_barrier
    ds_read_b64_tr_b16 a[112:113], v5 offset:49152
    ds_read_b64_tr_b16 a[114:115], v5 offset:53248
    ds_read_b64_tr_b16 a[116:117], v5 offset:49184
    ds_read_b64_tr_b16 a[118:119], v5 offset:53280
    ds_read_b64_tr_b16 a[120:121], v5 offset:57344
    ds_read_b64_tr_b16 a[122:123], v5 offset:61440
    ds_read_b64_tr_b16 a[124:125], v5 offset:57376
    ds_read_b64_tr_b16 a[126:127], v5 offset:61472
    s_waitcnt lgkmcnt(0)
    s_barrier
    s_load_dwordx2 s[8:9], s[0:1], 64
    s_load_dwordx2 s[10:11], s[0:1], 80
    s_lshl_b32 s46, s42, 3
    s_add_u32 s46, s46, s43
    s_mul_i32 s46, s46, 229376
    s_mul_i32 s47, s44, 28672
    s_add_u32 s46, s46, s47
    v_lshlrev_b32 v10, 7, v1
    s_waitcnt lgkmcnt(0)
    s_mov_b32 s28, s8
    s_and_b32 s29, s9, 0xffff
    s_mov_b32 s30, 0x700000
    s_mov_b32 s31, 0x00020000
    s_mov_b32 s32, s10
    s_and_b32 s33, s11, 0xffff
    s_mov_b32 s34, 0x700000
    s_mov_b32 s35, 0x00020000
    s_add_u32 s47, s46, 0
    buffer_load_dword v120, v10, s[28:31], s47 offen
    s_add_u32 s47, s46, 8192
    buffer_load_dword v121, v10, s[28:31], s47 offen
    s_add_u32 s47, s46, 16384
    buffer_load_dword v122, v10, s[28:31], s47 offen
    s_add_u32 s47, s46, 20480
    buffer_load_dword v123, v10, s[28:31], s47 offen
    v_lshlrev_b32 v2, 4, v1
    s_mul_i32 s64, s44, 8192
    s_add_u32 s46, s64, 0x5000000
    s_mul_i32 s47, s42, 65536
    s_add_u32 s46, s46, s47
    v_add_u32 v3, s46, v2
    s_mul_i32 s46, s51, 32768
    v_add_u32 v4, s46, v2
    v_and_b32 v6, 15, v1
    v_lshlrev_b32 v6, 4, v6
    v_lshrrev_b32 v7, 4, v1
    v_lshl_add_u32 v6, v7, 9, v6
    v_add_u32 v4, s46, v6
    s_lshl_b32 s46, s50, 12
    s_add_u32 s46, s46, 131072
    v_add_u32 v5, s46, v2
    v_and_b32 v7, 7, v1
    v_lshlrev_b32 v7, 9, v7
    s_lshl_b32 s46, s42, 12
    s_add_u32 s46, s46, 0x102000
    v_add_u32 v7, s46, v7
    s_lshl_b32 s46, s42, 16
    s_lshl_b32 s47, s43, 11
    s_add_u32 s46, s46, s47
    s_lshl_b32 s47, s50, 9
    s_add_u32 s46, s46, s47
    s_add_u32 s46, s46, 0x9000000
    v_and_b32 v8, 31, v1
    v_lshlrev_b32 v8, 4, v8
    v_lshrrev_b32 v9, 5, v1
    v_lshl_add_u32 v8, v9, 14, v8
    v_add_u32 v8, s46, v8
    v_add_u32 v9, 0x8000, v8
    s_lshl_b32 s52, s43, 9
    s_lshl_b32 s47, s42, 7
    s_add_u32 s52, s52, s47
    s_add_u32 s52, s52, 0x107400
    s_add_u32 s52, s52, s76
    s_mul_i32 s46, s43, 8192
    s_add_u32 s46, s46, 0x5000000
    s_mul_i32 s47, s42, 65536
    s_add_u32 s46, s46, s47
    v_min_u32 v116, 63, v1
    v_lshlrev_b32 v116, 7, v116
    v_add_u32 v116, s46, v116
    s_mov_b32 s60, s74
    s_mul_i32 s61, s74, 262144
    s_mov_b32 s62, s74
    s_mul_i32 s63, s74, 262144
    s_mov_b32 s67, 0
    s_mov_b32 s68, 3
    s_mov_b32 s71, 0
    v_mov_b32 v15, 147456
    v_mov_b32 v14, 0
    ds_write_b32 v15, v14 offset:4
    ds_write_b32 v15, v14 offset:12
    ds_write_b32 v15, v14 offset:16
    v_mov_b32 v114, 1
    v_mov_b32 v115, 0
    s_mov_b32 s81, 0
    s_lshl_b32 s46, s44, 5
    v_add_u32 v119, s46, v15
    v_lshrrev_b32 v113, 4, v1
    s_mov_b32 s72, 0
L_g_restart_152:
    s_cmp_lg_u32 s44, 0
    s_cbranch_scc1 L_g_nsp_153
    s_mov_b32 s70, 0
L_g_sp_159:
    s_add_u32 s54, s60, 0
    v_add_u32 v12, s54, v113
    v_and_b32 v13, 3, v12
    v_lshl_add_u32 v13, v13, 7, v7
    buffer_load_dword v11, v13, s[12:15], 0 offen sc1
    s_waitcnt vmcnt(0)
    v_cmp_ge_u32 vcc, v12, v11
    s_add_u32 s70, s70, 1
    s_and_b32 s46, vcc_lo, 0xffff
    s_cbranch_scc0 L_g_sp_159_ok
    s_sleep 3
    s_cmp_lt_u32 s70, 524288
    s_cbranch_scc1 L_g_sp_159
    s_branch L_c_done_1
L_g_sp_159_ok:
    v_cmp_ge_u32 vcc, v12, v11
    s_nop 0
    s_ff1_i32_b64 s46, vcc
    s_lshr_b32 s46, s46, 4
    s_min_u32 s46, s46, 4
    s_add_u32 s46, s46, s54
    s_min_u32 s46, s46, s75
    v_mov_b32 v118, s46
    ds_write_b32 v15, v118 offset:20
L_g_nsp_153:
    s_waitcnt lgkmcnt(0)
    s_barrier
    ds_read_b32 v14, v15 offset:20
    s_waitcnt lgkmcnt(0)
    v_readfirstlane_b32 s66, v14
    s_nop 3
L_g_restart_152_go:
    s_mov_b32 s69, 0
    s_cmp_gt_u32 s62, s60
    s_cbranch_scc1 L_g_nd_160
    s_cmp_ge_u32 s62, s66
    s_cbranch_scc1 L_g_nd_160
    s_add_u32 s47, s61, 4096
    s_add_u32 m0, s64, 0
    s_nop 0
    buffer_load_dwordx4 v3, s[12:15], s61 offen offset:0 sc1 lds
    buffer_load_dwordx4 v3, s[12:15], s61 offen offset:1024 sc1 lds
    buffer_load_dwordx4 v3, s[12:15], s61 offen offset:2048 sc1 lds
    buffer_load_dwordx4 v3, s[12:15], s61 offen offset:3072 sc1 lds
    s_add_u32 m0, s64, 4096
    s_nop 0
    buffer_load_dwordx4 v3, s[12:15], s47 offen offset:0 sc1 lds
    buffer_load_dwordx4 v3, s[12:15], s47 offen offset:1024 sc1 lds
    buffer_load_dwordx4 v3, s[12:15], s47 offen offset:2048 sc1 lds
    buffer_load_dwordx4 v3, s[12:15], s47 offen offset:3072 sc1 lds
    s_add_u32 s61, s61, 262144
    s_add_u32 s62, s62, 1
    s_xor_b32 s64, s64, 0x10000
    s_mov_b32 s69, 1
L_g_nd_160:
    s_cmp_eq_u32 s51, 1
    s_cbranch_scc1 L_g_g1r_154
    s_add_u32 s59, s60, 1
    s_mov_b32 s69, 0
    s_cmp_gt_u32 s62, s59
    s_cbranch_scc1 L_g_nd_161
    s_cmp_ge_u32 s62, s66
    s_cbranch_scc1 L_g_nd_161
    s_add_u32 s47, s61, 4096
    s_add_u32 m0, s64, 0
    s_nop 0
    buffer_load_dwordx4 v3, s[12:15], s61 offen offset:0 sc1 lds
    buffer_load_dwordx4 v3, s[12:15], s61 offen offset:1024 sc1 lds
    buffer_load_dwordx4 v3, s[12:15], s61 offen offset:2048 sc1 lds
    buffer_load_dwordx4 v3, s[12:15], s61 offen offset:3072 sc1 lds
    s_add_u32 m0, s64, 4096
    s_nop 0
    buffer_load_dwordx4 v3, s[12:15], s47 offen offset:0 sc1 lds
    buffer_load_dwordx4 v3, s[12:15], s47 offen offset:1024 sc1 lds
    buffer_load_dwordx4 v3, s[12:15], s47 offen offset:2048 sc1 lds
    buffer_load_dwordx4 v3, s[12:15], s47 offen offset:3072 sc1 lds
    s_add_u32 s61, s61, 262144
    s_add_u32 s62, s62, 1
    s_xor_b32 s64, s64, 0x10000
    s_mov_b32 s69, 1
L_g_nd_161:
    s_cmp_eq_u32 s69, 1
    s_cbranch_scc1 L_g_w0_162
    s_waitcnt vmcnt(0)
L_g_w0_162:
    s_waitcnt vmcnt(8)
    s_cmp_lg_u32 s44, 0
    s_cbranch_scc1 L_g_nl_163
    s_cmp_lt_u32 s66, s75
    s_cselect_b32 s81, 1, 2
L_g_nl_163:
L_g_loop0_155_l:
    s_barrier
    ds_read_b128 v[32:35], v4 offset:0
    ds_read_b128 v[36:39], v4 offset:256
    ds_read_b128 v[40:43], v4 offset:2048
    ds_read_b128 v[44:47], v4 offset:2304
    ds_read_b128 v[48:51], v4 offset:4096
    ds_read_b128 v[52:55], v4 offset:4352
    ds_read_b128 v[56:59], v4 offset:6144
    ds_read_b128 v[60:63], v4 offset:6400
    s_branch L_g_loop0_155_m
.p2align 6
L_g_loop0_155:
    s_barrier
L_g_loop0_155_m:
    s_setprio 2
    s_waitcnt lgkmcnt(6)
    v_mfma_f32_16x16x32_bf16 v[16:19], v[32:35], a[0:3], 0
    v_mfma_f32_16x16x32_bf16 v[20:23], v[32:35], a[4:7], 0
    ds_read_b128 v[32:35], v4 offset:8192
    v_mfma_f32_16x16x32_bf16 v[28:31], v[36:39], a[4:7], 0
    v_mfma_f32_16x16x32_bf16 v[24:27], v[36:39], a[0:3], 0
    ds_read_b128 v[36:39], v4 offset:8448
    s_cmp_eq_u32 s81, 1
    s_cbranch_scc1 L_g_h1_167
L_g_h1_167_b:
    s_waitcnt lgkmcnt(6)
    v_mfma_f32_16x16x32_bf16 v[16:19], v[40:43], a[8:11], v[16:19]
    v_mfma_f32_16x16x32_bf16 v[20:23], v[40:43], a[12:15], v[20:23]
    ds_read_b128 v[40:43], v4 offset:10240
    v_mfma_f32_16x16x32_bf16 v[28:31], v[44:47], a[12:15], v[28:31]
    v_mfma_f32_16x16x32_bf16 v[24:27], v[44:47], a[8:11], v[24:27]
    ds_read_b128 v[44:47], v4 offset:10496
    s_waitcnt lgkmcnt(6)
    v_mfma_f32_16x16x32_bf16 v[16:19], v[48:51], a[16:19], v[16:19]
    v_mfma_f32_16x16x32_bf16 v[20:23], v[48:51], a[20:23], v[20:23]
    ds_read_b128 v[48:51], v4 offset:12288
    v_mfma_f32_16x16x32_bf16 v[28:31], v[52:55], a[20:23], v[28:31]
    v_mfma_f32_16x16x32_bf16 v[24:27], v[52:55], a[16:19], v[24:27]
    ds_read_b128 v[52:55], v4 offset:12544
    s_waitcnt lgkmcnt(6)
    v_mfma_f32_16x16x32_bf16 v[16:19], v[56:59], a[24:27], v[16:19]
    v_mfma_f32_16x16x32_bf16 v[20:23], v[56:59], a[28:31], v[20:23]
    ds_read_b128 v[56:59], v4 offset:14336
    v_mfma_f32_16x16x32_bf16 v[28:31], v[60:63], a[28:31], v[28:31]
    v_mfma_f32_16x16x32_bf16 v[24:27], v[60:63], a[24:27], v[24:27]
    ds_read_b128 v[60:63], v4 offset:14592
    s_waitcnt lgkmcnt(6)
    v_mfma_f32_16x16x32_bf16 v[16:19], v[32:35], a[32:35], v[16:19]
    v_mfma_f32_16x16x32_bf16 v[20:23], v[32:35], a[36:39], v[20:23]
    ds_read_b128 v[32:35], v4 offset:16384
    v_mfma_f32_16x16x32_bf16 v[28:31], v[36:39], a[36:39], v[28:31]
    v_mfma_f32_16x16x32_bf16 v[24:27], v[36:39], a[32:35], v[24:27]
    ds_read_b128 v[36:39], v4 offset:16640
    s_waitcnt lgkmcnt(6)
    v_mfma_f32_16x16x32_bf16 v[16:19], v[40:43], a[40:43], v[16:19]
    v_mfma_f32_16x16x32_bf16 v[20:23], v[40:43], a[44:47], v[20:23]
    ds_read_b128 v[40:43], v4 offset:18432
    v_mfma_f32_16x16x32_bf16 v[28:31], v[44:47], a[44:47], v[28:31]
    v_mfma_f32_16x16x32_bf16 v[24:27], v[44:47], a[40:43], v[24:27]
    ds_read_b128 v[44:47], v4 offset:18688
    s_waitcnt lgkmcnt(6)
    v_mfma_f32_16x16x32_bf16 v[16:19], v[48:51], a[48:51], v[16:19]
    v_mfma_f32_16x16x32_bf16 v[20:23], v[48:51], a[52:55], v[20:23]
    ds_read_b128 v[48:51], v4 offset:20480
    v_mfma_f32_16x16x32_bf16 v[28:31], v[52:55], a[52:55], v[28:31]
    v_mfma_f32_16x16x32_bf16 v[24:27], v[52:55], a[48:51], v[24:27]
    ds_read_b128 v[52:55], v4 offset:20736
    s_waitcnt lgkmcnt(6)
    v_mfma_f32_16x16x32_bf16 v[16:19], v[56:59], a[56:59], v[16:19]
    v_mfma_f32_16x16x32_bf16 v[20:23], v[56:59], a[60:63], v[20:23]
    ds_read_b128 v[56:59], v4 offset:22528
    v_mfma_f32_16x16x32_bf16 v[28:31], v[60:63], a[60:63], v[28:31]
    v_mfma_f32_16x16x32_bf16 v[24:27], v[60:63], a[56:59], v[24:27]
    ds_read_b128 v[60:63], v4 offset:22784
    s_waitcnt lgkmcnt(6)
    v_mfma_f32_16x16x32_bf16 v[16:19], v[32:35], a[64:67], v[16:19]
    v_mfma_f32_16x16x32_bf16 v[20:23], v[32:35], a[68:71], v[20:23]
    ds_read_b128 v[32:35], v4 offset:24576
    v_mfma_f32_16x16x32_bf16 v[28:31], v[36:39], a[68:71], v[28:31]
    v_mfma_f32_16x16x32_bf16 v[24:27], v[36:39], a[64:67], v[24:27]
    ds_read_b128 v[36:39], v4 offset:24832
    s_waitcnt lgkmcnt(6)
    v_mfma_f32_16x16x32_bf16 v[16:19], v[40:43], a[72:75], v[16:19]
    v_mfma_f32_16x16x32_bf16 v[20:23], v[40:43], a[76:79], v[20:23]
    ds_read_b128 v[40:43], v4 offset:26624
    v_mfma_f32_16x16x32_bf16 v[28:31], v[44:47], a[76:79], v[28:31]
    v_mfma_f32_16x16x32_bf16 v[24:27], v[44:47], a[72:75], v[24:27]
    ds_read_b128 v[44:47], v4 offset:26880
    s_waitcnt lgkmcnt(6)
    v_mfma_f32_16x16x32_bf16 v[16:19], v[48:51], a[80:83], v[16:19]
    v_mfma_f32_16x16x32_bf16 v[20:23], v[48:51], a[84:87], v[20:23]
    ds_read_b128 v[48:51], v4 offset:28672
    v_mfma_f32_16x16x32_bf16 v[28:31], v[52:55], a[84:87], v[28:31]
    v_mfma_f32_16x16x32_bf16 v[24:27], v[52:55], a[80:83], v[24:27]
    ds_read_b128 v[52:55], v4 offset:28928
    s_waitcnt lgkmcnt(6)
    v_mfma_f32_16x16x32_bf16 v[16:19], v[56:59], a[88:91], v[16:19]
    v_mfma_f32_16x16x32_bf16 v[20:23], v[56:59], a[92:95], v[20:23]
    ds_read_b128 v[56:59], v4 offset:30720
    v_mfma_f32_16x16x32_bf16 v[28:31], v[60:63], a[92:95], v[28:31]
    v_mfma_f32_16x16x32_bf16 v[24:27], v[60:63], a[88:91], v[24:27]
    ds_read_b128 v[60:63], v4 offset:30976
    s_waitcnt lgkmcnt(6)
    v_mfma_f32_16x16x32_bf16 v[16:19], v[32:35], a[96:99], v[16:19]
    v_mfma_f32_16x16x32_bf16 v[20:23], v[32:35], a[100:103], v[20:23]
    v_mfma_f32_16x16x32_bf16 v[28:31], v[36:39], a[100:103], v[28:31]
    v_mfma_f32_16x16x32_bf16 v[24:27], v[36:39], a[96:99], v[24:27]
    s_waitcnt lgkmcnt(4)
    v_mfma_f32_16x16x32_bf16 v[16:19], v[40:43], a[104:107], v[16:19]
    v_mfma_f32_16x16x32_bf16 v[20:23], v[40:43], a[108:111], v[20:23]
    v_mfma_f32_16x16x32_bf16 v[28:31], v[44:47], a[108:111], v[28:31]
    v_mfma_f32_16x16x32_bf16 v[24:27], v[44:47], a[104:107], v[24:27]
    s_waitcnt lgkmcnt(2)
    v_mfma_f32_16x16x32_bf16 v[16:19], v[48:51], a[112:115], v[16:19]
    v_mfma_f32_16x16x32_bf16 v[20:23], v[48:51], a[116:119], v[20:23]
    s_cmp_eq_u32 s81, 1
    s_cbranch_scc1 L_g_h2_168
L_g_h2_168_b:
    ds_write_b32 v119, v118
    v_mfma_f32_16x16x32_bf16 v[28:31], v[52:55], a[116:119], v[28:31]
    v_mfma_f32_16x16x32_bf16 v[24:27], v[52:55], a[112:115], v[24:27]
    s_waitcnt lgkmcnt(0)
    v_mfma_f32_16x16x32_bf16 v[16:19], v[56:59], a[120:123], v[16:19]
    v_mfma_f32_16x16x32_bf16 v[20:23], v[56:59], a[124:127], v[20:23]
    v_mfma_f32_16x16x32_bf16 v[28:31], v[60:63], a[124:127], v[28:31]
    v_mfma_f32_16x16x32_bf16 v[24:27], v[60:63], a[120:123], v[24:27]
    v_xor_b32 v4, 0x10000, v4
    s_setprio 0
    s_waitcnt vmcnt(0)
    s_waitcnt lgkmcnt(0)
    s_barrier
    ds_read_b32 v14, v15
    s_nop 6
    ds_write_b128 v5, v[16:19] offset:0
    ds_write_b128 v5, v[20:23] offset:1024
    ds_write_b128 v5, v[24:27] offset:2048
    ds_write_b128 v5, v[28:31] offset:3072
    s_waitcnt lgkmcnt(4)
    v_readfirstlane_b32 s66, v14
    s_add_u32 s60, s60, 1
    s_mov_b32 s65, 0
    s_cmp_le_u32 s62, s60
    s_cbranch_scc1 L_g_dp_169_l
L_g_dp_169_a:
    s_cmp_ge_u32 s62, s66
    s_cbranch_scc1 L_g_dp_169_d
    s_add_u32 s47, s61, 4096
    s_mov_b32 m0, s64
    s_add_u32 s62, s62, 1
    buffer_load_dwordx4 v3, s[12:15], s61 offen offset:0 sc1 lds
    buffer_load_dwordx4 v3, s[12:15], s61 offen offset:1024 sc1 lds
    buffer_load_dwordx4 v3, s[12:15], s61 offen offset:2048 sc1 lds
    buffer_load_dwordx4 v3, s[12:15], s61 offen offset:3072 sc1 lds
    s_add_u32 m0, s64, 4096
    s_add_u32 s61, s61, 262144
    buffer_load_dwordx4 v3, s[12:15], s47 offen offset:0 sc1 lds
    buffer_load_dwordx4 v3, s[12:15], s47 offen offset:1024 sc1 lds
    buffer_load_dwordx4 v3, s[12:15], s47 offen offset:2048 sc1 lds
    buffer_load_dwordx4 v3, s[12:15], s47 offen offset:3072 sc1 lds
    s_xor_b32 s64, s64, 0x10000
L_g_dp_169_d:
    s_cmp_lg_u32 s44, 2
    s_cbranch_scc1 L_g_pf_170
    s_cmp_ge_u32 s62, s66
    s_cbranch_scc1 L_g_pf_170
    buffer_load_dword v117, v116, s[12:15], s61 offen sc1
L_g_pf_170:
    s_cmp_le_u32 s66, s60
    s_cbranch_scc1 L_g_ex0_166
    s_cmp_lg_u32 s65, 0
    s_cbranch_scc1 L_g_nw_165
    ds_read_b128 v[32:35], v4 offset:0
    ds_read_b128 v[36:39], v4 offset:256
    ds_read_b128 v[40:43], v4 offset:2048
    ds_read_b128 v[44:47], v4 offset:2304
    ds_read_b128 v[48:51], v4 offset:4096
    ds_read_b128 v[52:55], v4 offset:4352
    ds_read_b128 v[56:59], v4 offset:6144
    ds_read_b128 v[60:63], v4 offset:6400
    s_cmp_lg_u32 s44, 0
    s_cbranch_scc1 L_g_nl_171
    s_mov_b32 s46, s66
    s_cmp_lg_u32 s81, 0
    s_cbranch_scc1 L_g_nl_171_e
    v_cmp_ge_u32 vcc, v12, v11
    s_nop 0
    s_ff1_i32_b64 s46, vcc
    s_lshr_b32 s46, s46, 4
    s_min_u32 s46, s46, 4
    s_add_u32 s46, s46, s54
    s_min_u32 s46, s46, s75
    v_mov_b32 v118, s46
L_g_nl_171_e:
    s_add_u32 s47, s60, 3
    s_min_u32 s47, s47, s75
    s_cmp_lt_u32 s46, s47
    s_cselect_b32 s81, 1, 0
    s_cbranch_scc1 L_g_nl_171
    s_add_u32 s54, s60, 2
    v_add_u32 v12, s54, v113
    v_and_b32 v13, 3, v12
    v_lshl_add_u32 v13, v13, 7, v7
    buffer_load_dword v11, v13, s[12:15], 0 offen sc1
L_g_nl_171:
    s_waitcnt lgkmcnt(8)
    s_branch L_g_loop0_155
L_g_ex0_166:
    s_cmp_lg_u32 s44, 0
    s_cbranch_scc1 L_g_ex0_166_n
    ds_write_b32 v15, v118 offset:20
    s_cmp_ge_u32 s60, s75
    s_cbranch_scc1 L_g_ex0_166_n
    s_sleep 6
    s_add_u32 s54, s60, 0
    v_add_u32 v12, s54, v113
    v_and_b32 v13, 3, v12
    v_lshl_add_u32 v13, v13, 7, v7
    buffer_load_dword v11, v13, s[12:15], 0 offen sc1
    s_waitcnt vmcnt(0)
    v_cmp_ge_u32 vcc, v12, v11
    s_nop 0
    s_ff1_i32_b64 s46, vcc
    s_lshr_b32 s46, s46, 4
    s_min_u32 s46, s46, 4
    s_add_u32 s46, s46, s54
    s_min_u32 s46, s46, s75
    v_mov_b32 v118, s46
    ds_write_b32 v15, v118 offset:20
L_g_ex0_166_n:
    s_waitcnt lgkmcnt(0)
    s_barrier
    ds_read_b32 v14, v15 offset:20
    s_waitcnt lgkmcnt(0)
    v_readfirstlane_b32 s66, v14
    s_barrier
    s_cmp_gt_u32 s66, s60
    s_cbranch_scc1 L_g_restart_152_go
    s_branch L_g_tail_157
L_g_g1r_154:
    s_mov_b32 s65, 1
    s_branch L_g_loop1_156_e
.p2align 6
L_g_loop1_156:
    s_mov_b32 s65, 0
L_g_loop1_156_e:
    s_barrier
    s_bitcmp1_b32 s67, 1
    s_cbranch_scc0 L_g_nfl_172
    s_cmp_lg_u32 s44, 4
    s_cbranch_scc1 L_g_nfl_172_d
    s_sub_u32 s59, s60, 1
    v_mov_b32 v10, s59
    buffer_store_dword v10, v115, s[12:15], s52 offen sc1
L_g_nfl_172_d:
    ds_read_b128 v[80:83], v5 offset:0
    ds_read_b128 v[84:87], v5 offset:1024
    ds_read_b128 v[88:91], v5 offset:2048
    ds_read_b128 v[92:95], v5 offset:3072
    s_cmp_le_u32 s62, s60
    s_cbranch_scc1 L_g_dp_177_l
L_g_dp_177_a:
    s_cmp_ge_u32 s62, s66
    s_cbranch_scc1 L_g_dp_177_d
    s_add_u32 s47, s61, 4096
    s_mov_b32 m0, s64
    s_add_u32 s62, s62, 1
    buffer_load_dwordx4 v3, s[12:15], s61 offen offset:0 sc1 lds
    buffer_load_dwordx4 v3, s[12:15], s61 offen offset:1024 sc1 lds
    buffer_load_dwordx4 v3, s[12:15], s61 offen offset:2048 sc1 lds
    buffer_load_dwordx4 v3, s[12:15], s61 offen offset:3072 sc1 lds
    s_add_u32 m0, s64, 4096
    s_add_u32 s61, s61, 262144
    buffer_load_dwordx4 v3, s[12:15], s47 offen offset:0 sc1 lds
    buffer_load_dwordx4 v3, s[12:15], s47 offen offset:1024 sc1 lds
    buffer_load_dwordx4 v3, s[12:15], s47 offen offset:2048 sc1 lds
    buffer_load_dwordx4 v3, s[12:15], s47 offen offset:3072 sc1 lds
    s_xor_b32 s64, s64, 0x10000
L_g_dp_177_d:
    s_bitcmp1_b32 s67, 0
    s_cbranch_scc0 L_g_nep_173
    s_waitcnt lgkmcnt(0)
    v_add_f32 v80, v80, v16
    v_add_f32 v81, v81, v17
    v_add_f32 v82, v82, v18
    v_add_f32 v83, v83, v19
    v_add_f32 v84, v84, v20
    v_add_f32 v85, v85, v21
    v_add_f32 v86, v86, v22
    v_add_f32 v87, v87, v23
    v_add_f32 v88, v88, v24
    v_add_f32 v89, v89, v25
    v_add_f32 v90, v90, v26
    v_add_f32 v91, v91, v27
    v_add_f32 v92, v92, v28
    v_add_f32 v93, v93, v29
    v_add_f32 v94, v94, v30
    v_add_f32 v95, v95, v31
    v_cvt_pk_bf16_f32 v104, v80, v81
    v_cvt_pk_bf16_f32 v105, v82, v83
    v_cvt_pk_bf16_f32 v106, v84, v85
    v_cvt_pk_bf16_f32 v107, v86, v87
    s_nop 1
    v_permlane16_swap_b32 v104, v106
    v_permlane16_swap_b32 v105, v107
    buffer_store_dwordx4 v[104:107], v8, s[12:15], s63 offen sc1
    v_cvt_pk_bf16_f32 v108, v88, v89
    v_cvt_pk_bf16_f32 v109, v90, v91
    v_cvt_pk_bf16_f32 v110, v92, v93
    v_cvt_pk_bf16_f32 v111, v94, v95
    s_nop 1
    v_permlane16_swap_b32 v108, v110
    v_permlane16_swap_b32 v109, v111
    buffer_store_dwordx4 v[108:111], v9, s[12:15], s63 offen sc1
    s_add_u32 s63, s63, 262144
L_g_nep_173:
    s_cmp_lg_u32 s65, 0
    s_cbranch_scc1 L_g_nw1_174
    ds_read_b128 v[32:35], v4 offset:0
    ds_read_b128 v[36:39], v4 offset:256
    ds_read_b128 v[40:43], v4 offset:2048
    ds_read_b128 v[44:47], v4 offset:2304
    ds_read_b128 v[48:51], v4 offset:4096
    ds_read_b128 v[52:55], v4 offset:4352
    ds_read_b128 v[56:59], v4 offset:6144
    ds_read_b128 v[60:63], v4 offset:6400
    s_barrier
L_g_jn_176:
    s_setprio 1
    s_waitcnt lgkmcnt(6)
    v_mfma_f32_16x16x32_bf16 v[16:19], v[32:35], a[0:3], 0
    ds_read_b32 v14, v15
    v_mfma_f32_16x16x32_bf16 v[20:23], v[32:35], a[4:7], 0
    ds_read_b128 v[32:35], v4 offset:8192
    v_mfma_f32_16x16x32_bf16 v[28:31], v[36:39], a[4:7], 0
    v_mfma_f32_16x16x32_bf16 v[24:27], v[36:39], a[0:3], 0
    ds_read_b128 v[36:39], v4 offset:8448
    s_waitcnt lgkmcnt(6)
    v_mfma_f32_16x16x32_bf16 v[16:19], v[40:43], a[8:11], v[16:19]
    v_mfma_f32_16x16x32_bf16 v[20:23], v[40:43], a[12:15], v[20:23]
    ds_read_b128 v[40:43], v4 offset:10240
    v_mfma_f32_16x16x32_bf16 v[28:31], v[44:47], a[12:15], v[28:31]
    v_mfma_f32_16x16x32_bf16 v[24:27], v[44:47], a[8:11], v[24:27]
    ds_read_b128 v[44:47], v4 offset:10496
    s_waitcnt lgkmcnt(6)
    v_mfma_f32_16x16x32_bf16 v[16:19], v[48:51], a[16:19], v[16:19]
    v_mfma_f32_16x16x32_bf16 v[20:23], v[48:51], a[20:23], v[20:23]
    ds_read_b128 v[48:51], v4 offset:12288
    v_mfma_f32_16x16x32_bf16 v[28:31], v[52:55], a[20:23], v[28:31]
    v_mfma_f32_16x16x32_bf16 v[24:27], v[52:55], a[16:19], v[24:27]
    ds_read_b128 v[52:55], v4 offset:12544
    s_waitcnt lgkmcnt(6)
    v_mfma_f32_16x16x32_bf16 v[16:19], v[56:59], a[24:27], v[16:19]
    v_mfma_f32_16x16x32_bf16 v[20:23], v[56:59], a[28:31], v[20:23]
    ds_read_b128 v[56:59], v4 offset:14336
    v_mfma_f32_16x16x32_bf16 v[28:31], v[60:63], a[28:31], v[28:31]
    v_mfma_f32_16x16x32_bf16 v[24:27], v[60:63], a[24:27], v[24:27]
    ds_read_b128 v[60:63], v4 offset:14592
    s_waitcnt lgkmcnt(6)
    v_mfma_f32_16x16x32_bf16 v[16:19], v[32:35], a[32:35], v[16:19]
    v_mfma_f32_16x16x32_bf16 v[20:23], v[32:35], a[36:39], v[20:23]
    ds_read_b128 v[32:35], v4 offset:16384
    v_mfma_f32_16x16x32_bf16 v[28:31], v[36:39], a[36:39], v[28:31]
    v_mfma_f32_16x16x32_bf16 v[24:27], v[36:39], a[32:35], v[24:27]
    ds_read_b128 v[36:39], v4 offset:16640
    s_waitcnt lgkmcnt(6)
    v_mfma_f32_16x16x32_bf16 v[16:19], v[40:43], a[40:43], v[16:19]
    v_mfma_f32_16x16x32_bf16 v[20:23], v[40:43], a[44:47], v[20:23]
    ds_read_b128 v[40:43], v4 offset:18432
    v_mfma_f32_16x16x32_bf16 v[28:31], v[44:47], a[44:47], v[28:31]
    v_mfma_f32_16x16x32_bf16 v[24:27], v[44:47], a[40:43], v[24:27]
    ds_read_b128 v[44:47], v4 offset:18688
    s_waitcnt lgkmcnt(6)
    v_mfma_f32_16x16x32_bf16 v[16:19], v[48:51], a[48:51], v[16:19]
    v_mfma_f32_16x16x32_bf16 v[20:23], v[48:51], a[52:55], v[20:23]
    ds_read_b128 v[48:51], v4 offset:20480
    v_mfma_f32_16x16x32_bf16 v[28:31], v[52:55], a[52:55], v[28:31]
    v_mfma_f32_16x16x32_bf16 v[24:27], v[52:55], a[48:51], v[24:27]
    ds_read_b128 v[52:55], v4 offset:20736
    s_waitcnt lgkmcnt(6)
    v_mfma_f32_16x16x32_bf16 v[16:19], v[56:59], a[56:59], v[16:19]
    v_mfma_f32_16x16x32_bf16 v[20:23], v[56:59], a[60:63], v[20:23]
    ds_read_b128 v[56:59], v4 offset:22528
    v_mfma_f32_16x16x32_bf16 v[28:31], v[60:63], a[60:63], v[28:31]
    v_mfma_f32_16x16x32_bf16 v[24:27], v[60:63], a[56:59], v[24:27]
    ds_read_b128 v[60:63], v4 offset:22784
    s_waitcnt lgkmcnt(6)
    v_mfma_f32_16x16x32_bf16 v[16:19], v[32:35], a[64:67], v[16:19]
    v_mfma_f32_16x16x32_bf16 v[20:23], v[32:35], a[68:71], v[20:23]
    ds_read_b128 v[32:35], v4 offset:24576
    v_mfma_f32_16x16x32_bf16 v[28:31], v[36:39], a[68:71], v[28:31]
    v_mfma_f32_16x16x32_bf16 v[24:27], v[36:39], a[64:67], v[24:27]
    ds_read_b128 v[36:39], v4 offset:24832
    s_waitcnt lgkmcnt(6)
    v_mfma_f32_16x16x32_bf16 v[16:19], v[40:43], a[72:75], v[16:19]
    v_mfma_f32_16x16x32_bf16 v[20:23], v[40:43], a[76:79], v[20:23]
    ds_read_b128 v[40:43], v4 offset:26624
    v_mfma_f32_16x16x32_bf16 v[28:31], v[44:47], a[76:79], v[28:31]
    v_mfma_f32_16x16x32_bf16 v[24:27], v[44:47], a[72:75], v[24:27]
    ds_read_b128 v[44:47], v4 offset:26880
    s_waitcnt lgkmcnt(6)
    v_mfma_f32_16x16x32_bf16 v[16:19], v[48:51], a[80:83], v[16:19]
    v_mfma_f32_16x16x32_bf16 v[20:23], v[48:51], a[84:87], v[20:23]
    ds_read_b128 v[48:51], v4 offset:28672
    v_mfma_f32_16x16x32_bf16 v[28:31], v[52:55], a[84:87], v[28:31]
    v_mfma_f32_16x16x32_bf16 v[24:27], v[52:55], a[80:83], v[24:27]
    ds_read_b128 v[52:55], v4 offset:28928
    s_waitcnt lgkmcnt(6)
    v_mfma_f32_16x16x32_bf16 v[16:19], v[56:59], a[88:91], v[16:19]
    v_mfma_f32_16x16x32_bf16 v[20:23], v[56:59], a[92:95], v[20:23]
    ds_read_b128 v[56:59], v4 offset:30720
    v_mfma_f32_16x16x32_bf16 v[28:31], v[60:63], a[92:95], v[28:31]
    v_mfma_f32_16x16x32_bf16 v[24:27], v[60:63], a[88:91], v[24:27]
    ds_read_b128 v[60:63], v4 offset:30976
    s_waitcnt lgkmcnt(6)
    v_mfma_f32_16x16x32_bf16 v[16:19], v[32:35], a[96:99], v[16:19]
    v_mfma_f32_16x16x32_bf16 v[20:23], v[32:35], a[100:103], v[20:23]
    v_mfma_f32_16x16x32_bf16 v[28:31], v[36:39], a[100:103], v[28:31]
    v_mfma_f32_16x16x32_bf16 v[24:27], v[36:39], a[96:99], v[24:27]
    s_waitcnt lgkmcnt(4)
    v_mfma_f32_16x16x32_bf16 v[16:19], v[40:43], a[104:107], v[16:19]
    v_mfma_f32_16x16x32_bf16 v[20:23], v[40:43], a[108:111], v[20:23]
    v_mfma_f32_16x16x32_bf16 v[28:31], v[44:47], a[108:111], v[28:31]
    v_mfma_f32_16x16x32_bf16 v[24:27], v[44:47], a[104:107], v[24:27]
    s_waitcnt lgkmcnt(2)
    v_mfma_f32_16x16x32_bf16 v[16:19], v[48:51], a[112:115], v[16:19]
    v_mfma_f32_16x16x32_bf16 v[20:23], v[48:51], a[116:119], v[20:23]
    v_mfma_f32_16x16x32_bf16 v[28:31], v[52:55], a[116:119], v[28:31]
    v_mfma_f32_16x16x32_bf16 v[24:27], v[52:55], a[112:115], v[24:27]
    s_waitcnt lgkmcnt(0)
    v_mfma_f32_16x16x32_bf16 v[16:19], v[56:59], a[120:123], v[16:19]
    v_mfma_f32_16x16x32_bf16 v[20:23], v[56:59], a[124:127], v[20:23]
    v_mfma_f32_16x16x32_bf16 v[28:31], v[60:63], a[124:127], v[28:31]
    v_mfma_f32_16x16x32_bf16 v[24:27], v[60:63], a[120:123], v[24:27]
    v_xor_b32 v4, 0x10000, v4
    s_setprio 0
    s_waitcnt vmcnt(0)
    v_readfirstlane_b32 s66, v14
    s_lshl_b32 s67, s67, 1
    s_or_b32 s67, s67, 1
    s_add_u32 s60, s60, 1
    s_cmp_gt_u32 s66, s60
    s_cbranch_scc1 L_g_loop1_156
    s_barrier
    ds_read_b32 v14, v15 offset:20
    ds_read_b128 v[80:83], v5 offset:0
    ds_read_b128 v[84:87], v5 offset:1024
    ds_read_b128 v[88:91], v5 offset:2048
    ds_read_b128 v[92:95], v5 offset:3072
    s_waitcnt lgkmcnt(4)
    v_readfirstlane_b32 s66, v14
    s_barrier
    s_mov_b32 s69, 0
    s_cmp_gt_u32 s62, s60
    s_cbranch_scc1 L_g_nd_178
    s_cmp_ge_u32 s62, s66
    s_cbranch_scc1 L_g_nd_178
    s_add_u32 s47, s61, 4096
    s_add_u32 m0, s64, 0
    s_nop 0
    buffer_load_dwordx4 v3, s[12:15], s61 offen offset:0 sc1 lds
    buffer_load_dwordx4 v3, s[12:15], s61 offen offset:1024 sc1 lds
    buffer_load_dwordx4 v3, s[12:15], s61 offen offset:2048 sc1 lds
    buffer_load_dwordx4 v3, s[12:15], s61 offen offset:3072 sc1 lds
    s_add_u32 m0, s64, 4096
    s_nop 0
    buffer_load_dwordx4 v3, s[12:15], s47 offen offset:0 sc1 lds
    buffer_load_dwordx4 v3, s[12:15], s47 offen offset:1024 sc1 lds
    buffer_load_dwordx4 v3, s[12:15], s47 offen offset:2048 sc1 lds
    buffer_load_dwordx4 v3, s[12:15], s47 offen offset:3072 sc1 lds
    s_add_u32 s61, s61, 262144
    s_add_u32 s62, s62, 1
    s_xor_b32 s64, s64, 0x10000
    s_mov_b32 s69, 1
L_g_nd_178:
    s_sub_u32 s59, s60, 1
    s_waitcnt lgkmcnt(3)
    v_add_f32 v80, v80, v16
    v_add_f32 v81, v81, v17
    v_add_f32 v82, v82, v18
    v_add_f32 v83, v83, v19
    s_waitcnt lgkmcnt(2)
    v_add_f32 v84, v84, v20
    v_add_f32 v85, v85, v21
    v_add_f32 v86, v86, v22
    v_add_f32 v87, v87, v23
    s_waitcnt lgkmcnt(1)
    v_add_f32 v88, v88, v24
    v_add_f32 v89, v89, v25
    v_add_f32 v90, v90, v26
    v_add_f32 v91, v91, v27
    s_waitcnt lgkmcnt(0)
    v_add_f32 v92, v92, v28
    v_add_f32 v93, v93, v29
    v_add_f32 v94, v94, v30
    v_add_f32 v95, v95, v31
    v_cvt_pk_bf16_f32 v104, v80, v81
    v_cvt_pk_bf16_f32 v105, v82, v83
    v_cvt_pk_bf16_f32 v106, v84, v85
    v_cvt_pk_bf16_f32 v107, v86, v87
    s_nop 1
    v_permlane16_swap_b32 v104, v106
    v_permlane16_swap_b32 v105, v107
    buffer_store_dwordx4 v[104:107], v8, s[12:15], s63 offen sc1
    v_cvt_pk_bf16_f32 v108, v88, v89
    v_cvt_pk_bf16_f32 v109, v90, v91
    v_cvt_pk_bf16_f32 v110, v92, v93
    v_cvt_pk_bf16_f32 v111, v94, v95
    s_nop 1
    v_permlane16_swap_b32 v108, v110
    v_permlane16_swap_b32 v109, v111
    buffer_store_dwordx4 v[108:111], v9, s[12:15], s63 offen sc1
    s_add_u32 s63, s63, 262144
    s_mov_b32 s67, 0
    s_mov_b32 s71, 1
    s_cmp_gt_u32 s66, s60
    s_cbranch_scc1 L_g_g1r_154
    v_mov_b32 v10, 1
    s_mov_b64 exec, 1
    s_waitcnt vmcnt(0)
    ds_add_rtn_u32 v10, v15, v10 offset:4
    s_waitcnt lgkmcnt(0)
    v_readfirstlane_b32 s46, v10
    s_mov_b64 exec, -1
    s_mov_b32 s71, 0
    s_sub_u32 s59, s60, 1
    s_cmp_lg_u32 s46, s68
    s_cbranch_scc1 L_g_df_179
    v_mov_b32 v10, s59
    v_add_u32 v10, 1, v10
    v_mov_b32 v11, 0
    s_mov_b64 exec, 1
    buffer_store_dword v10, v11, s[12:15], s52 offen sc1
    s_mov_b64 exec, -1
L_sf_180:
L_g_df_179:
    s_add_u32 s68, s68, 4
    s_cmp_gt_u32 s66, s60
    s_cbranch_scc1 L_g_g1r_154
L_g_tail_157:
    s_cmp_lt_u32 s60, s75
    s_cbranch_scc1 L_g_restart_152
    s_waitcnt vmcnt(0)
    s_barrier
    s_branch L_c_done_1
L_g_h1_167:
    s_add_u32 s54, s60, 1
    v_add_u32 v12, s54, v113
    v_and_b32 v13, 3, v12
    v_lshl_add_u32 v13, v13, 7, v7
    buffer_load_dword v11, v13, s[12:15], 0 offen sc1
    s_branch L_g_h1_167_b
L_g_h2_168:
    s_waitcnt vmcnt(0)
    v_cmp_ge_u32 vcc, v12, v11
    s_nop 0
    s_ff1_i32_b64 s46, vcc
    s_lshr_b32 s46, s46, 4
    s_min_u32 s46, s46, 4
    s_add_u32 s46, s46, s54
    s_min_u32 s46, s46, s75
    v_mov_b32 v118, s46
    s_branch L_g_h2_168_b
L_g_dp_169_l:
    s_cmp_ge_u32 s62, s66
    s_cbranch_scc1 L_g_dp_169_d
    s_mov_b32 s65, 1
    s_add_u32 s47, s61, 4096
    s_mov_b32 m0, s64
    s_add_u32 s62, s62, 1
    buffer_load_dwordx4 v3, s[12:15], s61 offen offset:0 sc1 lds
    buffer_load_dwordx4 v3, s[12:15], s61 offen offset:1024 sc1 lds
    buffer_load_dwordx4 v3, s[12:15], s61 offen offset:2048 sc1 lds
    buffer_load_dwordx4 v3, s[12:15], s61 offen offset:3072 sc1 lds
    s_add_u32 m0, s64, 4096
    s_add_u32 s61, s61, 262144
    buffer_load_dwordx4 v3, s[12:15], s47 offen offset:0 sc1 lds
    buffer_load_dwordx4 v3, s[12:15], s47 offen offset:1024 sc1 lds
    buffer_load_dwordx4 v3, s[12:15], s47 offen offset:2048 sc1 lds
    buffer_load_dwordx4 v3, s[12:15], s47 offen offset:3072 sc1 lds
    s_xor_b32 s64, s64, 0x10000
    s_branch L_g_dp_169_a
L_g_nw_165:
    s_waitcnt vmcnt(0) lgkmcnt(0)
    s_cmp_lg_u32 s44, 0
    s_cbranch_scc1 L_g_nl_181
    s_cmp_lt_u32 s66, s75
    s_cselect_b32 s81, 1, 2
L_g_nl_181:
    s_branch L_g_loop0_155_l
L_g_nfl_172:
    s_cmp_eq_u32 s71, 0
    s_cbranch_scc1 L_g_nfl_172_d
    v_mov_b32 v10, 1
    s_mov_b64 exec, 1
    s_waitcnt vmcnt(0)
    ds_add_rtn_u32 v10, v15, v10 offset:4
    s_waitcnt lgkmcnt(0)
    v_readfirstlane_b32 s46, v10
    s_mov_b64 exec, -1
    s_mov_b32 s71, 0
    s_sub_u32 s59, s60, 1
    s_cmp_lg_u32 s46, s68
    s_cbranch_scc1 L_g_df_182
    v_mov_b32 v10, s59
    v_add_u32 v10, 1, v10
    v_mov_b32 v11, 0
    s_mov_b64 exec, 1
    buffer_store_dword v10, v11, s[12:15], s52 offen sc1
    s_mov_b64 exec, -1
L_sf_183:
L_g_df_182:
    s_add_u32 s68, s68, 4
    s_mov_b32 s65, 2
    s_branch L_g_nfl_172_d
L_g_dp_177_l:
    s_cmp_ge_u32 s62, s66
    s_cbranch_scc1 L_g_dp_177_d
    s_or_b32 s65, s65, 1
    s_add_u32 s47, s61, 4096
    s_mov_b32 m0, s64
    s_add_u32 s62, s62, 1
    buffer_load_dwordx4 v3, s[12:15], s61 offen offset:0 sc1 lds
    buffer_load_dwordx4 v3, s[12:15], s61 offen offset:1024 sc1 lds
    buffer_load_dwordx4 v3, s[12:15], s61 offen offset:2048 sc1 lds
    buffer_load_dwordx4 v3, s[12:15], s61 offen offset:3072 sc1 lds
    s_add_u32 m0, s64, 4096
    s_add_u32 s61, s61, 262144
    buffer_load_dwordx4 v3, s[12:15], s47 offen offset:0 sc1 lds
    buffer_load_dwordx4 v3, s[12:15], s47 offen offset:1024 sc1 lds
    buffer_load_dwordx4 v3, s[12:15], s47 offen offset:2048 sc1 lds
    buffer_load_dwordx4 v3, s[12:15], s47 offen offset:3072 sc1 lds
    s_xor_b32 s64, s64, 0x10000
    s_branch L_g_dp_177_a
L_g_nw1_174:
    s_cmp_eq_u32 s65, 2
    s_cbranch_scc1 L_g_nw1_174_w
    s_waitcnt vmcnt(0)
L_g_nw1_174_w:
    s_barrier
    ds_read_b128 v[32:35], v4 offset:0
    ds_read_b128 v[36:39], v4 offset:256
    ds_read_b128 v[40:43], v4 offset:2048
    ds_read_b128 v[44:47], v4 offset:2304
    ds_read_b128 v[48:51], v4 offset:4096
    ds_read_b128 v[52:55], v4 offset:4352
    ds_read_b128 v[56:59], v4 offset:6144
    ds_read_b128 v[60:63], v4 offset:6400
    s_branch L_g_jn_176
L_c_chain_9:
    v_mov_b32 v4, 0
    v_mov_b32 v5, 0
    v_mov_b32 v6, 0
    v_mov_b32 v7, 0
    v_mov_b32 v8, 0
    v_mov_b32 v9, 0
    v_mov_b32 v10, 0
    v_mov_b32 v11, 0
    v_mov_b32 v12, 0
    v_mov_b32 v13, 0
    v_mov_b32 v14, 0
    v_mov_b32 v15, 0
    v_mov_b32 v32, -1
    v_mov_b32 v33, -1
    v_mov_b32 v34, -1
    v_mov_b32 v35, -1
    v_lshlrev_b32 v2, 4, v1
    s_lshl_b32 s45, s40, 16
    s_lshl_b32 s46, s41, 12
    s_add_u32 s45, s45, s46
    s_and_b32 s46, s44, 3
    s_lshl_b32 s46, s46, 10
    s_add_u32 s45, s45, s46
    s_lshr_b32 s46, s44, 2
    s_lshl_b32 s46, s46, 19
    s_add_u32 s45, s45, s46
    s_add_u32 s45, s45, 0x7000000
    buffer_store_dwordx4 v[32:35], v2, s[12:15], s45 offen sc1
    s_lshl_b32 s45, s40, 15
    s_lshl_b32 s46, s41, 11
    s_add_u32 s45, s45, s46
    s_lshl_b32 s46, s44, 8
    s_add_u32 s45, s45, s46
    s_add_u32 s45, s45, 0x7100000
    s_mov_b64 exec, 0xffff
    buffer_store_dwordx4 v[32:35], v2, s[12:15], s45 offen sc1
    s_lshl_b32 s45, s40, 16
    s_lshl_b32 s46, s41, 8
    s_add_u32 s45, s45, s46
    s_and_b32 s46, s44, 3
    s_lshl_b32 s46, s46, 14
    s_add_u32 s45, s45, s46
    s_add_u32 s45, s45, 0x7180000
    buffer_store_dwordx4 v[32:35], v2, s[12:15], s45 offen sc1
    s_mov_b64 exec, -1
    v_lshlrev_b32 v2, 4, v1
    v_and_b32 v3, 8, v1
    v_cmp_eq_u32 vcc, 0, v3
    v_mov_b32 v3, 0xeeeeeeee
    v_mov_b32 v4, 0x44444444
    v_cndmask_b32 v3, v3, v4, vcc
    v_and_b32 v100, 15, v1
    v_lshrrev_b32 v101, 4, v1
    v_and_b32 v102, 1, v101
    v_lshrrev_b32 v103, 1, v101
    v_lshlrev_b32 v104, 2, v102
    v_lshl_add_u32 v104, v103, 1, v104
    v_and_b32 v105, 1, v1
    v_add_u32 v104, v104, v105
    v_and_b32 v106, 7, v1
    v_bfe_u32 v107, v1, 3, 1
    s_lshr_b32 s42, s41, 2
    s_and_b32 s43, s41, 3
    s_lshl_b32 s49, s40, 2
    s_add_u32 s49, s49, s42
    s_lshl_b32 s45, s44, 14
    v_lshlrev_b32 v22, 3, v101
    v_bfe_u32 v23, v1, 2, 2
    v_add_u32 v22, v22, v23
    v_and_b32 v23, 3, v1
    v_lshlrev_b32 v24, 3, v23
    v_lshl_add_u32 v20, v22, 6, v24
    v_lshl_add_u32 v21, v22, 7, v24
    v_lshrrev_b32 v22, 2, v1
    v_lshlrev_b32 v23, 4, v23
    v_lshl_add_u32 v24, v22, 13, v23
    v_lshrrev_b32 v22, 3, v1
    v_lshlrev_b32 v23, 4, v106
    v_lshl_add_u32 v25, v22, 11, v23
    s_cmp_ge_u32 s44, 4
    s_cbranch_scc1 L_v_init_184
    s_lshr_b32 s50, s44, 1
    s_and_b32 s51, s44, 1
    s_load_dwordx4 s[4:7], s[0:1], 16
    s_lshl_b32 s46, s49, 8
    s_lshl_b32 s48, s43, 6
    s_add_u32 s46, s46, s48
    s_lshl_b32 s48, s44, 21
    s_add_u32 s46, s46, s48
    s_lshl_b32 s52, s51, 5
    s_xor_b32 s53, s50, 1
    s_lshl_b32 s53, s53, 16
    s_add_u32 s52, s52, s53
    v_add_u32 v20, s52, v20
    s_waitcnt lgkmcnt(0)
    s_mov_b32 s24, s6
    s_and_b32 s25, s7, 0xffff
    s_mov_b32 s26, 0x800000
    s_mov_b32 s27, 0x00020000
    s_mov_b32 s28, s4
    s_and_b32 s29, s5, 0xffff
    s_mov_b32 s30, 0x800000
    s_mov_b32 s31, 0x00020000
    s_lshl_b32 s52, s51, 9
    s_lshl_b32 s53, s50, 7
    s_add_u32 s52, s52, s53
    s_add_u32 s52, s52, 61440
    v_lshlrev_b32 v5, 1, v106
    v_lshl_add_u32 v5, v107, 8, v5
    v_lshl_add_u32 v5, v102, 6, v5
    v_lshl_add_u32 v5, v103, 5, v5
    v_add_u32 v5, s52, v5
    s_lshl_b32 s67, s49, 12
    s_lshl_b32 s53, s43, 10
    s_add_u32 s67, s67, s53
    s_add_u32 s67, s67, 0x1000000
    s_lshl_b32 s52, s40, 16
    s_lshl_b32 s53, s44, 11
    s_add_u32 s53, s52, s53
    s_add_u32 s53, s53, 0x7080000
    v_lshlrev_b32 v7, 3, v1
    v_add_u32 v7, s53, v7
    s_lshl_b32 s53, s44, 9
    s_add_u32 s53, s52, s53
    s_add_u32 s53, s53, 0x7180000
    v_lshlrev_b32 v28, 6, v103
    v_lshl_add_u32 v28, v106, 3, v28
    v_lshl_add_u32 v28, v102, 2, v28
    v_lshl_add_u32 v28, v107, 1, v28
    v_add_u32 v28, s53, v28
    s_lshl_b32 s52, s44, 10
    s_add_u32 s52, s52, 16384
    v_lshlrev_b32 v8, 8, v101
    v_lshl_add_u32 v8, v106, 4, v8
    v_lshl_add_u32 v8, v107, 3, v8
    v_add_u32 v8, s52, v8
    s_lshl_b32 s52, s44, 8
    s_add_u32 s52, s52, 20480
    v_lshlrev_b32 v9, 4, v106
    v_lshl_add_u32 v9, v101, 2, v9
    v_lshl_add_u32 v9, v107, 1, v9
    v_add_u32 v9, s52, v9
    s_mov_b32 s66, 0x3e0293ee
    s_add_u32 m0, s45, 0
    s_add_u32 s48, s46, 0x0
    buffer_load_dwordx4 v24, s[24:27], s48 offen lds
    s_add_u32 m0, s45, 1024
    s_add_u32 s48, s46, 0x20000
    buffer_load_dwordx4 v24, s[24:27], s48 offen lds
    s_add_u32 m0, s45, 2048
    s_add_u32 s48, s46, 0x40000
    buffer_load_dwordx4 v24, s[24:27], s48 offen lds
    s_add_u32 m0, s45, 3072
    s_add_u32 s48, s46, 0x60000
    buffer_load_dwordx4 v24, s[24:27], s48 offen lds
    s_add_u32 m0, s45, 4096
    s_add_u32 s48, s46, 0x80000
    buffer_load_dwordx4 v24, s[24:27], s48 offen lds
    s_add_u32 m0, s45, 5120
    s_add_u32 s48, s46, 0xa0000
    buffer_load_dwordx4 v24, s[24:27], s48 offen lds
    s_add_u32 m0, s45, 6144
    s_add_u32 s48, s46, 0xc0000
    buffer_load_dwordx4 v24, s[24:27], s48 offen lds
    s_add_u32 m0, s45, 7168
    s_add_u32 s48, s46, 0xe0000
    buffer_load_dwordx4 v24, s[24:27], s48 offen lds
    s_add_u32 m0, s45, 8192
    s_add_u32 s48, s46, 0x100000
    buffer_load_dwordx4 v24, s[24:27], s48 offen lds
    s_add_u32 m0, s45, 9216
    s_add_u32 s48, s46, 0x120000
    buffer_load_dwordx4 v24, s[24:27], s48 offen lds
    s_add_u32 m0, s45, 10240
    s_add_u32 s48, s46, 0x140000
    buffer_load_dwordx4 v24, s[24:27], s48 offen lds
    s_add_u32 m0, s45, 11264
    s_add_u32 s48, s46, 0x160000
    buffer_load_dwordx4 v24, s[24:27], s48 offen lds
    s_add_u32 m0, s45, 12288
    s_add_u32 s48, s46, 0x180000
    buffer_load_dwordx4 v24, s[24:27], s48 offen lds
    s_add_u32 m0, s45, 13312
    s_add_u32 s48, s46, 0x1a0000
    buffer_load_dwordx4 v24, s[24:27], s48 offen lds
    s_add_u32 m0, s45, 14336
    s_add_u32 s48, s46, 0x1c0000
    buffer_load_dwordx4 v24, s[24:27], s48 offen lds
    s_add_u32 m0, s45, 15360
    s_add_u32 s48, s46, 0x1e0000
    buffer_load_dwordx4 v24, s[24:27], s48 offen lds
    s_add_u32 s45, s45, 0x10000
    s_add_u32 m0, s45, 0
    s_add_u32 s48, s46, 0x0
    buffer_load_dwordx4 v24, s[28:31], s48 offen lds
    s_add_u32 m0, s45, 1024
    s_add_u32 s48, s46, 0x20000
    buffer_load_dwordx4 v24, s[28:31], s48 offen lds
    s_add_u32 m0, s45, 2048
    s_add_u32 s48, s46, 0x40000
    buffer_load_dwordx4 v24, s[28:31], s48 offen lds
    s_add_u32 m0, s45, 3072
    s_add_u32 s48, s46, 0x60000
    buffer_load_dwordx4 v24, s[28:31], s48 offen lds
    s_add_u32 m0, s45, 4096
    s_add_u32 s48, s46, 0x80000
    buffer_load_dwordx4 v24, s[28:31], s48 offen lds
    s_add_u32 m0, s45, 5120
    s_add_u32 s48, s46, 0xa0000
    buffer_load_dwordx4 v24, s[28:31], s48 offen lds
    s_add_u32 m0, s45, 6144
    s_add_u32 s48, s46, 0xc0000
    buffer_load_dwordx4 v24, s[28:31], s48 offen lds
    s_add_u32 m0, s45, 7168
    s_add_u32 s48, s46, 0xe0000
    buffer_load_dwordx4 v24, s[28:31], s48 offen lds
    s_add_u32 m0, s45, 8192
    s_add_u32 s48, s46, 0x100000
    buffer_load_dwordx4 v24, s[28:31], s48 offen lds
    s_add_u32 m0, s45, 9216
    s_add_u32 s48, s46, 0x120000
    buffer_load_dwordx4 v24, s[28:31], s48 offen lds
    s_add_u32 m0, s45, 10240
    s_add_u32 s48, s46, 0x140000
    buffer_load_dwordx4 v24, s[28:31], s48 offen lds
    s_add_u32 m0, s45, 11264
    s_add_u32 s48, s46, 0x160000
    buffer_load_dwordx4 v24, s[28:31], s48 offen lds
    s_add_u32 m0, s45, 12288
    s_add_u32 s48, s46, 0x180000
    buffer_load_dwordx4 v24, s[28:31], s48 offen lds
    s_add_u32 m0, s45, 13312
    s_add_u32 s48, s46, 0x1a0000
    buffer_load_dwordx4 v24, s[28:31], s48 offen lds
    s_add_u32 m0, s45, 14336
    s_add_u32 s48, s46, 0x1c0000
    buffer_load_dwordx4 v24, s[28:31], s48 offen lds
    s_add_u32 m0, s45, 15360
    s_add_u32 s48, s46, 0x1e0000
    buffer_load_dwordx4 v24, s[28:31], s48 offen lds
    s_add_u32 s45, s45, 0x10000
    s_waitcnt vmcnt(0)
    s_barrier
    s_cmp_lg_u32 s44, 0
    s_cbranch_scc1 L_zwok_187
    v_and_b32 v16, 7, v1
    v_lshlrev_b32 v16, 5, v16
    s_mov_b32 s70, 0
L_zw_186:
    buffer_load_dword v17, v16, s[16:19], 0 offen sc1
    s_waitcnt vmcnt(0)
    v_add_u32_dpp v17, v17, v17 row_ror:1 row_mask:0xf bank_mask:0xf
    s_nop 1
    v_add_u32_dpp v17, v17, v17 row_ror:2 row_mask:0xf bank_mask:0xf
    s_nop 1
    v_add_u32_dpp v17, v17, v17 row_ror:4 row_mask:0xf bank_mask:0xf
    v_cmp_ne_u32 vcc, 0x100, v17
    s_add_u32 s70, s70, 1
    s_cbranch_vccz L_zwok_187
    s_sleep 4
    s_cmp_lt_u32 s70, 524288
    s_cbranch_scc1 L_zw_186
    s_branch L_c_done_1
L_zwok_187:
    s_cmp_lg_u32 s44, 0
    s_cbranch_scc1 L_c_nr_188
    s_or_b32 s47, s39, 0x100
    v_mov_b32 v16, s47
    s_lshl_b32 s52, s40, 6
    s_lshl_b32 s53, s41, 2
    s_add_u32 s52, s52, s53
    s_add_u32 s52, s52, 0x101000
    v_mov_b32 v17, 0
    s_mov_b64 exec, 1
    buffer_store_dword v16, v17, s[12:15], s52 offen sc1
    s_mov_b64 exec, -1
L_c_nr_188:
    ds_read_b64_tr_b16 a[0:1], v20 offset:0
    ds_read_b64_tr_b16 a[2:3], v20 offset:256
    ds_read_b64_tr_b16 a[4:5], v20 offset:2048
    ds_read_b64_tr_b16 a[6:7], v20 offset:2304
    ds_read_b64_tr_b16 a[8:9], v20 offset:4096
    ds_read_b64_tr_b16 a[10:11], v20 offset:4352
    ds_read_b64_tr_b16 a[12:13], v20 offset:6144
    ds_read_b64_tr_b16 a[14:15], v20 offset:6400
    s_waitcnt lgkmcnt(0)
    ds_read_b64_tr_b16 a[16:17], v20 offset:8192
    ds_read_b64_tr_b16 a[18:19], v20 offset:8448
    ds_read_b64_tr_b16 a[20:21], v20 offset:10240
    ds_read_b64_tr_b16 a[22:23], v20 offset:10496
    ds_read_b64_tr_b16 a[24:25], v20 offset:12288
    ds_read_b64_tr_b16 a[26:27], v20 offset:12544
    ds_read_b64_tr_b16 a[28:29], v20 offset:14336
    ds_read_b64_tr_b16 a[30:31], v20 offset:14592
    s_waitcnt lgkmcnt(0)
    ds_read_b64_tr_b16 a[32:33], v20 offset:16384
    ds_read_b64_tr_b16 a[34:35], v20 offset:16640
    ds_read_b64_tr_b16 a[36:37], v20 offset:18432
    ds_read_b64_tr_b16 a[38:39], v20 offset:18688
    ds_read_b64_tr_b16 a[40:41], v20 offset:20480
    ds_read_b64_tr_b16 a[42:43], v20 offset:20736
    ds_read_b64_tr_b16 a[44:45], v20 offset:22528
    ds_read_b64_tr_b16 a[46:47], v20 offset:22784
    s_waitcnt lgkmcnt(0)
    ds_read_b64_tr_b16 a[48:49], v20 offset:24576
    ds_read_b64_tr_b16 a[50:51], v20 offset:24832
    ds_read_b64_tr_b16 a[52:53], v20 offset:26624
    ds_read_b64_tr_b16 a[54:55], v20 offset:26880
    ds_read_b64_tr_b16 a[56:57], v20 offset:28672
    ds_read_b64_tr_b16 a[58:59], v20 offset:28928
    ds_read_b64_tr_b16 a[60:61], v20 offset:30720
    ds_read_b64_tr_b16 a[62:63], v20 offset:30976
    s_waitcnt lgkmcnt(0)
    ds_read_b64_tr_b16 a[64:65], v20 offset:32768
    ds_read_b64_tr_b16 a[66:67], v20 offset:33024
    ds_read_b64_tr_b16 a[68:69], v20 offset:34816
    ds_read_b64_tr_b16 a[70:71], v20 offset:35072
    ds_read_b64_tr_b16 a[72:73], v20 offset:36864
    ds_read_b64_tr_b16 a[74:75], v20 offset:37120
    ds_read_b64_tr_b16 a[76:77], v20 offset:38912
    ds_read_b64_tr_b16 a[78:79], v20 offset:39168
    s_waitcnt lgkmcnt(0)
    ds_read_b64_tr_b16 a[80:81], v20 offset:40960
    ds_read_b64_tr_b16 a[82:83], v20 offset:41216
    ds_read_b64_tr_b16 a[84:85], v20 offset:43008
    ds_read_b64_tr_b16 a[86:87], v20 offset:43264
    ds_read_b64_tr_b16 a[88:89], v20 offset:45056
    ds_read_b64_tr_b16 a[90:91], v20 offset:45312
    ds_read_b64_tr_b16 a[92:93], v20 offset:47104
    ds_read_b64_tr_b16 a[94:95], v20 offset:47360
    s_waitcnt lgkmcnt(0)
    ds_read_b64_tr_b16 a[96:97], v20 offset:49152
    ds_read_b64_tr_b16 a[98:99], v20 offset:49408
    ds_read_b64_tr_b16 a[100:101], v20 offset:51200
    ds_read_b64_tr_b16 a[102:103], v20 offset:51456
    ds_read_b64_tr_b16 a[104:105], v20 offset:53248
    ds_read_b64_tr_b16 a[106:107], v20 offset:53504
    ds_read_b64_tr_b16 a[108:109], v20 offset:55296
    ds_read_b64_tr_b16 a[110:111], v20 offset:55552
    s_waitcnt lgkmcnt(0)
    ds_read_b64_tr_b16 a[112:113], v20 offset:57344
    ds_read_b64_tr_b16 a[114:115], v20 offset:57600
    ds_read_b64_tr_b16 a[116:117], v20 offset:59392
    ds_read_b64_tr_b16 a[118:119], v20 offset:59648
    ds_read_b64_tr_b16 a[120:121], v20 offset:61440
    ds_read_b64_tr_b16 a[122:123], v20 offset:61696
    ds_read_b64_tr_b16 a[124:125], v20 offset:63488
    ds_read_b64_tr_b16 a[126:127], v20 offset:63744
    s_waitcnt lgkmcnt(0)
    s_mov_b32 s63, 0
    s_barrier
    s_lshl_b32 s52, s40, 2
    s_add_u32 s52, s52, s44
    s_mul_i32 s52, s52, 24576
    s_lshl_b32 s53, s41, 9
    s_add_u32 s52, s52, s53
    s_add_u32 s52, s52, 0x2004000
    v_and_b32 v14, 3, v1
    v_lshlrev_b32 v14, 7, v14
    v_add_u32 v14, s52, v14
    s_lshl_b32 s52, s40, 16
    s_lshl_b32 s53, s41, 9
    s_add_u32 s53, s53, s52
    s_lshl_b32 s54, s44, 6
    s_add_u32 s53, s53, s54
    s_add_u32 s53, s53, 0x7080000
    v_lshlrev_b32 v4, 3, v106
    v_lshl_add_u32 v10, v102, 6, v4
    v_lshl_add_u32 v4, v101, 7, v4
    v_add_u32 v4, s53, v4
    v_mov_b32 v54, 0xfffefffe
    v_mov_b32 v56, 0
    v_mov_b32 v57, 0
    v_mov_b32 v58, 0
    v_mov_b32 v59, 0
    s_lshl_b32 s53, s41, 7
    s_add_u32 s53, s53, s52
    s_add_u32 s53, s53, 0x7180000
    v_add_u32 v10, s53, v10
    s_cmp_ge_u32 s44, 2
    s_cselect_b64 vcc, -1, 0
    v_cndmask_b32 v4, v4, v10, vcc
    s_mul_i32 s52, s49, 24576
    s_lshl_b32 s53, s44, 12
    s_add_u32 s52, s52, s53
    s_lshl_b32 s53, s43, 10
    s_add_u32 s52, s52, s53
    s_add_u32 s52, s52, 0x2002000
    v_add_u32 v6, s52, v2
    v_lshrrev_b32 v10, 3, v1
    v_lshlrev_b32 v10, 8, v10
    v_lshl_add_u32 v10, v106, 4, v10
    v_add_u32 v10, 61568, v10
    v_add_u32 v11, 27648, v2
    v_cmp_gt_u32 s[52:53], 32, v1
    s_nop 1
    v_cndmask_b32 v10, v11, v10, s[52:53]
    v_cndmask_b32 v6, v6, v10, vcc
    v_mov_b32 v24, -1
    v_mov_b32 v25, -1
    v_mov_b32 v26, -1
    v_mov_b32 v27, -1
    s_and_b32 s52, s40, 1
    s_lshl_b32 s52, s52, 14
    s_lshl_b32 s53, s41, 10
    s_add_u32 s52, s52, s53
    s_lshl_b32 s53, s50, 9
    s_add_u32 s52, s52, s53
    s_lshl_b32 s53, s51, 7
    s_add_u32 s52, s52, s53
    s_add_u32 s52, s52, 0x7a0000
    v_mov_b32 v46, s52
    v_add_u32 v44, 65536, v2
    s_lshl_b32 s52, s50, 10
    s_add_u32 s52, s52, 62464
    v_add_u32 v31, s52, v2
    s_lshl_b32 s53, s51, 9
    s_add_u32 s52, s52, s53
    v_lshlrev_b32 v45, 4, v100
    v_lshl_add_u32 v45, v103, 8, v45
    v_lshl_add_u32 v45, v102, 3, v45
    v_add_u32 v45, s52, v45
    s_mul_i32 s52, s49, 24576
    s_lshl_b32 s53, s50, 13
    s_add_u32 s52, s52, s53
    s_lshl_b32 s53, s43, 10
    s_add_u32 s52, s52, s53
    s_add_u32 s52, s52, 0x4b80000
    v_add_u32 v13, s52, v2
    v_mov_b32 v29, 26644
    v_mov_b32 v30, 0
    ds_write_b32 v29, v30
    v_mov_b32 v30, 1
    s_lshl_b32 s58, s40, 11
    s_lshl_b32 s53, s44, 7
    s_add_u32 s58, s58, s53
    s_add_u32 s58, s58, 0x10a600
    s_mov_b32 s69, 0
    v_mov_b32 v0, 0
    s_cmp_ge_u32 s44, 2
    s_cselect_b32 s50, 0, 0x00ff00ff
    s_mov_b32 s51, 0x00ff00ff
    s_xor_b32 s45, s44, 2
    s_or_b32 s45, s45, s41
    s_cbranch_scc1 L_c_join_185_p
    s_lshl_b32 s45, s40, 21
    s_add_u32 s45, s45, 0x79c0000
    v_and_b32 v10, 31, v1
    v_lshlrev_b32 v10, 4, v10
    v_lshl_add_u32 v10, v103, 13, v10
    buffer_store_dwordx4 v[24:27], v10, s[12:15], s45 offen sc1
    s_add_u32 s46, s45, 0x1000
    s_load_dword s47, s[22:23], s46
    s_mov_b32 s60, -1
    s_mov_b32 s61, -1
    s_waitcnt vmcnt(0) lgkmcnt(0)
    s_add_u32 s46, s45, 0
    s_memtime s[84:85]
    s_waitcnt lgkmcnt(0)
    s_load_dword s47, s[22:23], s46
    s_waitcnt lgkmcnt(0)
    s_memtime s[86:87]
    s_waitcnt lgkmcnt(0)
    s_sub_u32 s86, s86, s84
    s_min_u32 s60, s60, s86
    s_add_u32 s46, s45, 8192
    s_memtime s[84:85]
    s_waitcnt lgkmcnt(0)
    s_load_dword s47, s[22:23], s46
    s_waitcnt lgkmcnt(0)
    s_memtime s[86:87]
    s_waitcnt lgkmcnt(0)
    s_sub_u32 s86, s86, s84
    s_min_u32 s61, s61, s86
    s_add_u32 s46, s45, 128
    s_memtime s[84:85]
    s_waitcnt lgkmcnt(0)
    s_load_dword s47, s[22:23], s46
    s_waitcnt lgkmcnt(0)
    s_memtime s[86:87]
    s_waitcnt lgkmcnt(0)
    s_sub_u32 s86, s86, s84
    s_min_u32 s60, s60, s86
    s_add_u32 s46, s45, 8320
    s_memtime s[84:85]
    s_waitcnt lgkmcnt(0)
    s_load_dword s47, s[22:23], s46
    s_waitcnt lgkmcnt(0)
    s_memtime s[86:87]
    s_waitcnt lgkmcnt(0)
    s_sub_u32 s86, s86, s84
    s_min_u32 s61, s61, s86
    s_add_u32 s46, s45, 256
    s_memtime s[84:85]
    s_waitcnt lgkmcnt(0)
    s_load_dword s47, s[22:23], s46
    s_waitcnt lgkmcnt(0)
    s_memtime s[86:87]
    s_waitcnt lgkmcnt(0)
    s_sub_u32 s86, s86, s84
    s_min_u32 s60, s60, s86
    s_add_u32 s46, s45, 8448
    s_memtime s[84:85]
    s_waitcnt lgkmcnt(0)
    s_load_dword s47, s[22:23], s46
    s_waitcnt lgkmcnt(0)
    s_memtime s[86:87]
    s_waitcnt lgkmcnt(0)
    s_sub_u32 s86, s86, s84
    s_min_u32 s61, s61, s86
    s_add_u32 s46, s45, 384
    s_memtime s[84:85]
    s_waitcnt lgkmcnt(0)
    s_load_dword s47, s[22:23], s46
    s_waitcnt lgkmcnt(0)
    s_memtime s[86:87]
    s_waitcnt lgkmcnt(0)
    s_sub_u32 s86, s86, s84
    s_min_u32 s60, s60, s86
    s_add_u32 s46, s45, 8576
    s_memtime s[84:85]
    s_waitcnt lgkmcnt(0)
    s_load_dword s47, s[22:23], s46
    s_waitcnt lgkmcnt(0)
    s_memtime s[86:87]
    s_waitcnt lgkmcnt(0)
    s_sub_u32 s86, s86, s84
    s_min_u32 s61, s61, s86
    s_cmp_gt_u32 s60, s61
    s_cselect_b32 s45, 3, 2
    v_mov_b32 v10, s45
    v_mov_b32 v11, 0
    s_lshl_b32 s45, s40, 7
    s_add_u32 s45, s45, 0x101800
    s_mov_b64 exec, 1
    buffer_store_dword v10, v11, s[12:15], s45 offen sc1
    s_mov_b64 exec, -1
L_c_join_185_p:
    s_setprio 1
    s_branch L_c_join_185
L_v_init_184:
    s_sub_u32 s54, s44, 4
    s_lshr_b32 s51, s54, 1
    s_and_b32 s50, s54, 1
    s_load_dwordx4 s[4:7], s[0:1], 32
    s_load_dwordx2 s[8:9], s[0:1], 8
    s_waitcnt lgkmcnt(0)
    s_mov_b32 s24, s4
    s_and_b32 s25, s5, 0xffff
    s_mov_b32 s26, 0x800000
    s_mov_b32 s27, 0x00020000
    s_mov_b32 s28, s6
    s_and_b32 s29, s7, 0xffff
    s_mov_b32 s30, 0x800000
    s_mov_b32 s31, 0x00020000
    s_mov_b32 s32, s8
    s_and_b32 s33, s9, 0xffff
    s_mov_b32 s34, 0x4000
    s_mov_b32 s35, 0x00020000
    s_lshl_b32 s45, s54, 12
    s_add_u32 s45, s45, 0x20000
    v_add_u32 v20, s45, v20
    v_add_u32 v21, s45, v21
    v_add_u32 v22, s45, v2
    s_lshl_b32 s46, s49, 8
    s_lshl_b32 s48, s43, 6
    s_add_u32 s46, s46, s48
    s_lshl_b32 s48, s54, 21
    s_add_u32 s46, s46, s48
    s_add_u32 s48, s46, 0x0
    buffer_load_dwordx4 a[0:3], v24, s[24:27], s48 offen
    s_add_u32 s48, s46, 0x20000
    buffer_load_dwordx4 a[32:35], v24, s[24:27], s48 offen
    s_add_u32 s48, s46, 0x40000
    buffer_load_dwordx4 a[4:7], v24, s[24:27], s48 offen
    s_add_u32 s48, s46, 0x60000
    buffer_load_dwordx4 a[36:39], v24, s[24:27], s48 offen
    s_add_u32 s48, s46, 0x80000
    buffer_load_dwordx4 a[8:11], v24, s[24:27], s48 offen
    s_add_u32 s48, s46, 0xa0000
    buffer_load_dwordx4 a[40:43], v24, s[24:27], s48 offen
    s_add_u32 s48, s46, 0xc0000
    buffer_load_dwordx4 a[12:15], v24, s[24:27], s48 offen
    s_add_u32 s48, s46, 0xe0000
    buffer_load_dwordx4 a[44:47], v24, s[24:27], s48 offen
    s_add_u32 s48, s46, 0x100000
    buffer_load_dwordx4 a[16:19], v24, s[24:27], s48 offen
    s_add_u32 s48, s46, 0x120000
    buffer_load_dwordx4 a[48:51], v24, s[24:27], s48 offen
    s_add_u32 s48, s46, 0x140000
    buffer_load_dwordx4 a[20:23], v24, s[24:27], s48 offen
    s_add_u32 s48, s46, 0x160000
    buffer_load_dwordx4 a[52:55], v24, s[24:27], s48 offen
    s_add_u32 s48, s46, 0x180000
    buffer_load_dwordx4 a[24:27], v24, s[24:27], s48 offen
    s_add_u32 s48, s46, 0x1a0000
    buffer_load_dwordx4 a[56:59], v24, s[24:27], s48 offen
    s_add_u32 s48, s46, 0x1c0000
    buffer_load_dwordx4 a[28:31], v24, s[24:27], s48 offen
    s_add_u32 s48, s46, 0x1e0000
    buffer_load_dwordx4 a[60:63], v24, s[24:27], s48 offen
    s_lshl_b32 s52, s40, 15
    s_lshl_b32 s53, s42, 11
    s_add_u32 s52, s52, s53
    s_lshl_b32 s53, s43, 9
    s_add_u32 s52, s52, s53
    s_lshl_b32 s53, s51, 8
    s_add_u32 s52, s52, s53
    s_add_u32 s52, s52, 0x7100000
    v_bfe_u32 v4, v1, 1, 1
    v_lshlrev_b32 v4, 7, v4
    v_lshl_add_u32 v4, v104, 4, v4
    v_and_b32 v5, 12, v100
    v_add_u32 v4, v4, v5
    v_add_u32 v4, s52, v4
    v_mov_b32 v26, -1
    s_lshl_b32 s52, s51, 5
    s_add_u32 s52, s52, 28160
    v_and_b32 v5, 14, v100
    v_lshlrev_b32 v5, 1, v5
    v_lshl_add_u32 v5, v104, 6, v5
    v_add_u32 v5, s52, v5
    s_lshl_b32 s52, s41, 14
    s_lshl_b32 s53, s54, 11
    s_add_u32 s52, s52, s53
    s_add_u32 s52, s52, 0x7800000
    v_lshlrev_b32 v6, 3, v101
    v_lshl_add_u32 v6, v106, 5, v6
    v_and_b32 v7, 3, v1
    v_lshlrev_b32 v7, 3, v7
    v_bfe_u32 v30, v1, 2, 3
    v_lshl_add_u32 v7, v30, 5, v7
    v_lshl_add_u32 v7, v103, 2, v7
    v_add_u32 v7, s52, v7
    s_lshl_b32 s53, s40, 8
    s_add_u32 s52, s52, s53
    v_add_u32 v6, s52, v6
    v_lshlrev_b32 v30, 4, v100
    v_lshl_add_u32 v30, v101, 18, v30
    v_add_u32 v30, s52, v30
    v_mov_b32 v32, -1
    v_mov_b32 v33, -1
    v_mov_b32 v34, -1
    v_mov_b32 v35, -1
    buffer_store_dwordx4 v[32:35], v30, s[12:15], 0 offen sc1
    s_mov_b32 s53, 8192
    buffer_store_dwordx4 v[32:35], v30, s[12:15], s53 offen sc1
    s_lshl_b32 s55, s40, 16
    s_add_u32 s55, s55, 0x7000000
    s_lshl_b32 s52, s41, 10
    s_lshl_b32 s53, s54, 8
    s_add_u32 s52, s52, s53
    s_add_u32 s52, s52, s55
    v_lshlrev_b32 v8, 2, v1
    v_add_u32 v8, s52, v8
    s_lshl_b32 s53, s54, 12
    v_add_u32 v10, s53, v2
    v_add_u32 v9, s55, v10
    s_lshl_b32 s52, s40, 15
    s_lshl_b32 s53, s54, 11
    s_add_u32 s52, s52, s53
    s_add_u32 s52, s52, 0x7100000
    v_add_u32 v11, s52, v2
    s_lshl_b32 s52, s54, 9
    s_add_u32 s52, s52, 53248
    v_lshlrev_b32 v12, 4, v100
    v_lshl_add_u32 v12, v102, 3, v12
    v_lshl_add_u32 v12, v103, 8, v12
    v_add_u32 v12, s52, v12
    s_lshl_b32 s52, s51, 3
    s_add_u32 s52, s52, 49152
    v_add_u32 v13, s52, v2
    s_lshl_b32 s52, s54, 10
    s_add_u32 s52, s52, 49152
    v_add_u32 v14, s52, v2
    s_lshl_b32 s52, s40, 2
    s_add_u32 s52, s52, s54
    s_mul_i32 s52, s52, 24576
    s_add_u32 s52, s52, 0x2004000
    v_add_u32 v15, s52, v2
    s_lshl_b32 s52, s54, 10
    v_add_u32 v27, s52, v2
    v_lshlrev_b32 v30, 11, v106
    v_lshl_add_u32 v30, v101, 5, v30
    v_lshl_add_u32 v30, v107, 2, v30
    s_lshl_b32 s52, s54, 9
    buffer_load_dword v112, v30, s[32:35], s52 offen offset:0
    buffer_load_dword v113, v30, s[32:35], s52 offen offset:8
    buffer_load_dword v114, v30, s[32:35], s52 offen offset:16
    buffer_load_dword v115, v30, s[32:35], s52 offen offset:24
    buffer_load_dword v116, v30, s[32:35], s52 offen offset:128
    buffer_load_dword v117, v30, s[32:35], s52 offen offset:136
    buffer_load_dword v118, v30, s[32:35], s52 offen offset:144
    buffer_load_dword v119, v30, s[32:35], s52 offen offset:152
    buffer_load_dword v120, v30, s[32:35], s52 offen offset:256
    buffer_load_dword v121, v30, s[32:35], s52 offen offset:264
    buffer_load_dword v122, v30, s[32:35], s52 offen offset:272
    buffer_load_dword v123, v30, s[32:35], s52 offen offset:280
    buffer_load_dword v124, v30, s[32:35], s52 offen offset:384
    buffer_load_dword v125, v30, s[32:35], s52 offen offset:392
    buffer_load_dword v126, v30, s[32:35], s52 offen offset:400
    buffer_load_dword v127, v30, s[32:35], s52 offen offset:408
    s_lshl_b32 s46, s40, 2
    s_add_u32 s46, s46, s54
    s_lshl_b32 s46, s46, 18
    s_lshl_b32 s48, s41, 7
    s_add_u32 s46, s46, s48
    s_add_u32 s48, s46, 0x0
    buffer_load_dwordx4 a[64:67], v25, s[28:31], s48 offen
    s_add_u32 s48, s46, 0x4000
    buffer_load_dwordx4 a[80:83], v25, s[28:31], s48 offen
    s_add_u32 s48, s46, 0x8000
    buffer_load_dwordx4 a[96:99], v25, s[28:31], s48 offen
    s_add_u32 s48, s46, 0xc000
    buffer_load_dwordx4 a[112:115], v25, s[28:31], s48 offen
    s_add_u32 s48, s46, 0x10000
    buffer_load_dwordx4 a[68:71], v25, s[28:31], s48 offen
    s_add_u32 s48, s46, 0x14000
    buffer_load_dwordx4 a[84:87], v25, s[28:31], s48 offen
    s_add_u32 s48, s46, 0x18000
    buffer_load_dwordx4 a[100:103], v25, s[28:31], s48 offen
    s_add_u32 s48, s46, 0x1c000
    buffer_load_dwordx4 a[116:119], v25, s[28:31], s48 offen
    s_add_u32 s48, s46, 0x20000
    buffer_load_dwordx4 a[72:75], v25, s[28:31], s48 offen
    s_add_u32 s48, s46, 0x24000
    buffer_load_dwordx4 a[88:91], v25, s[28:31], s48 offen
    s_add_u32 s48, s46, 0x28000
    buffer_load_dwordx4 a[104:107], v25, s[28:31], s48 offen
    s_add_u32 s48, s46, 0x2c000
    buffer_load_dwordx4 a[120:123], v25, s[28:31], s48 offen
    s_add_u32 s48, s46, 0x30000
    buffer_load_dwordx4 a[76:79], v25, s[28:31], s48 offen
    s_add_u32 s48, s46, 0x34000
    buffer_load_dwordx4 a[92:95], v25, s[28:31], s48 offen
    s_add_u32 s48, s46, 0x38000
    buffer_load_dwordx4 a[108:111], v25, s[28:31], s48 offen
    s_add_u32 s48, s46, 0x3c000
    buffer_load_dwordx4 a[124:127], v25, s[28:31], s48 offen
    s_waitcnt vmcnt(16)
    ds_write_b128 v22, a[0:3] offset:0
    ds_write_b128 v22, a[32:35] offset:1024
    ds_write_b128 v22, a[4:7] offset:2048
    ds_write_b128 v22, a[36:39] offset:3072
    s_waitcnt lgkmcnt(0)
    ds_read_b64_tr_b16 a[0:1], v20 offset:0
    ds_read_b64_tr_b16 a[2:3], v20 offset:256
    ds_read_b64_tr_b16 a[32:33], v20 offset:32
    ds_read_b64_tr_b16 a[34:35], v20 offset:288
    ds_read_b64_tr_b16 a[4:5], v20 offset:2048
    ds_read_b64_tr_b16 a[6:7], v20 offset:2304
    ds_read_b64_tr_b16 a[36:37], v20 offset:2080
    ds_read_b64_tr_b16 a[38:39], v20 offset:2336
    s_waitcnt lgkmcnt(0)
    ds_write_b128 v22, a[8:11] offset:0
    ds_write_b128 v22, a[40:43] offset:1024
    ds_write_b128 v22, a[12:15] offset:2048
    ds_write_b128 v22, a[44:47] offset:3072
    s_waitcnt lgkmcnt(0)
    ds_read_b64_tr_b16 a[8:9], v20 offset:0
    ds_read_b64_tr_b16 a[10:11], v20 offset:256
    ds_read_b64_tr_b16 a[40:41], v20 offset:32
    ds_read_b64_tr_b16 a[42:43], v20 offset:288
    ds_read_b64_tr_b16 a[12:13], v20 offset:2048
    ds_read_b64_tr_b16 a[14:15], v20 offset:2304
    ds_read_b64_tr_b16 a[44:45], v20 offset:2080
    ds_read_b64_tr_b16 a[46:47], v20 offset:2336
    s_waitcnt lgkmcnt(0)
    ds_write_b128 v22, a[16:19] offset:0
    ds_write_b128 v22, a[48:51] offset:1024
    ds_write_b128 v22, a[20:23] offset:2048
    ds_write_b128 v22, a[52:55] offset:3072
    s_waitcnt lgkmcnt(0)
    ds_read_b64_tr_b16 a[16:17], v20 offset:0
    ds_read_b64_tr_b16 a[18:19], v20 offset:256
    ds_read_b64_tr_b16 a[48:49], v20 offset:32
    ds_read_b64_tr_b16 a[50:51], v20 offset:288
    ds_read_b64_tr_b16 a[20:21], v20 offset:2048
    ds_read_b64_tr_b16 a[22:23], v20 offset:2304
    ds_read_b64_tr_b16 a[52:53], v20 offset:2080
    ds_read_b64_tr_b16 a[54:55], v20 offset:2336
    s_waitcnt lgkmcnt(0)
    ds_write_b128 v22, a[24:27] offset:0
    ds_write_b128 v22, a[56:59] offset:1024
    ds_write_b128 v22, a[28:31] offset:2048
    ds_write_b128 v22, a[60:63] offset:3072
    s_waitcnt lgkmcnt(0)
    ds_read_b64_tr_b16 a[24:25], v20 offset:0
    ds_read_b64_tr_b16 a[26:27], v20 offset:256
    ds_read_b64_tr_b16 a[56:57], v20 offset:32
    ds_read_b64_tr_b16 a[58:59], v20 offset:288
    ds_read_b64_tr_b16 a[28:29], v20 offset:2048
    ds_read_b64_tr_b16 a[30:31], v20 offset:2304
    ds_read_b64_tr_b16 a[60:61], v20 offset:2080
    ds_read_b64_tr_b16 a[62:63], v20 offset:2336
    s_waitcnt lgkmcnt(0)
    s_barrier
    s_waitcnt vmcnt(0)
    ds_write_b128 v22, a[64:67] offset:0
    ds_write_b128 v22, a[80:83] offset:1024
    ds_write_b128 v22, a[96:99] offset:2048
    ds_write_b128 v22, a[112:115] offset:3072
    s_waitcnt lgkmcnt(0)
    ds_read_b64_tr_b16 a[64:65], v21 offset:0
    ds_read_b64_tr_b16 a[66:67], v21 offset:512
    ds_read_b64_tr_b16 a[80:81], v21 offset:32
    ds_read_b64_tr_b16 a[82:83], v21 offset:544
    ds_read_b64_tr_b16 a[96:97], v21 offset:64
    ds_read_b64_tr_b16 a[98:99], v21 offset:576
    ds_read_b64_tr_b16 a[112:113], v21 offset:96
    ds_read_b64_tr_b16 a[114:115], v21 offset:608
    s_waitcnt lgkmcnt(0)
    ds_write_b128 v22, a[68:71] offset:0
    ds_write_b128 v22, a[84:87] offset:1024
    ds_write_b128 v22, a[100:103] offset:2048
    ds_write_b128 v22, a[116:119] offset:3072
    s_waitcnt lgkmcnt(0)
    ds_read_b64_tr_b16 a[68:69], v21 offset:0
    ds_read_b64_tr_b16 a[70:71], v21 offset:512
    ds_read_b64_tr_b16 a[84:85], v21 offset:32
    ds_read_b64_tr_b16 a[86:87], v21 offset:544
    ds_read_b64_tr_b16 a[100:101], v21 offset:64
    ds_read_b64_tr_b16 a[102:103], v21 offset:576
    ds_read_b64_tr_b16 a[116:117], v21 offset:96
    ds_read_b64_tr_b16 a[118:119], v21 offset:608
    s_waitcnt lgkmcnt(0)
    ds_write_b128 v22, a[72:75] offset:0
    ds_write_b128 v22, a[88:91] offset:1024
    ds_write_b128 v22, a[104:107] offset:2048
    ds_write_b128 v22, a[120:123] offset:3072
    s_waitcnt lgkmcnt(0)
    ds_read_b64_tr_b16 a[72:73], v21 offset:0
    ds_read_b64_tr_b16 a[74:75], v21 offset:512
    ds_read_b64_tr_b16 a[88:89], v21 offset:32
    ds_read_b64_tr_b16 a[90:91], v21 offset:544
    ds_read_b64_tr_b16 a[104:105], v21 offset:64
    ds_read_b64_tr_b16 a[106:107], v21 offset:576
    ds_read_b64_tr_b16 a[120:121], v21 offset:96
    ds_read_b64_tr_b16 a[122:123], v21 offset:608
    s_waitcnt lgkmcnt(0)
    ds_write_b128 v22, a[76:79] offset:0
    ds_write_b128 v22, a[92:95] offset:1024
    ds_write_b128 v22, a[108:111] offset:2048
    ds_write_b128 v22, a[124:127] offset:3072
    s_waitcnt lgkmcnt(0)
    ds_read_b64_tr_b16 a[76:77], v21 offset:0
    ds_read_b64_tr_b16 a[78:79], v21 offset:512
    ds_read_b64_tr_b16 a[92:93], v21 offset:32
    ds_read_b64_tr_b16 a[94:95], v21 offset:544
    ds_read_b64_tr_b16 a[108:109], v21 offset:64
    ds_read_b64_tr_b16 a[110:111], v21 offset:576
    ds_read_b64_tr_b16 a[124:125], v21 offset:96
    ds_read_b64_tr_b16 a[126:127], v21 offset:608
    s_waitcnt lgkmcnt(0)
    s_mov_b32 s65, 0
    s_waitcnt vmcnt(0)
    s_barrier
    s_lshl_b32 s57, s40, 11
    s_lshl_b32 s53, s54, 7
    s_add_u32 s57, s57, s53
    s_add_u32 s57, s57, 0x10a600
    s_mov_b32 s69, 0
    s_mov_b32 s68, 0
    s_cmp_gt_u32 s69, s68
    s_cbranch_scc1 L_kv_ok_190
    s_mov_b32 s70, 0
L_kv_lp_189:
    v_and_b32 v22, 1, v1
    v_lshlrev_b32 v22, 9, v22
    buffer_load_dword v23, v22, s[12:15], s57 offen sc1
    s_waitcnt vmcnt(0)
    v_readlane_b32 s69, v23, 0
    v_readlane_b32 s45, v23, 1
    s_add_u32 s70, s70, 1
    s_nop 2
    s_min_u32 s69, s69, s45
    s_cmp_gt_u32 s69, s68
    s_cbranch_scc1 L_kv_ok_190
    s_sleep 4
    s_cmp_lt_u32 s70, 524288
    s_cbranch_scc1 L_kv_lp_189
    s_branch L_c_done_1
L_kv_ok_190:
    v_lshlrev_b32 v28, 9, v101
    v_lshl_add_u32 v28, v100, 4, v28
    s_lshl_b32 s52, s54, 13
    s_add_u32 s52, s52, 0x7a0000
    v_add_u32 v28, s52, v28
    s_lshl_b32 s59, s54, 12
    s_add_u32 s59, s59, 65536
    v_lshlrev_b32 v31, 4, v100
    v_lshl_add_u32 v31, v103, 8, v31
    v_add_u32 v31, 20480, v31
    s_lshl_b32 s52, s54, 11
    s_add_u32 s52, s52, 53248
    v_add_u32 v25, s52, v2
    v_mov_b32 v29, 26640
    v_mov_b32 v30, 0
    ds_write_b32 v29, v30
    v_mov_b32 v30, 1
    s_mov_b32 s58, 0
    s_mov_b32 s64, 0
    s_add_u32 s46, s65, 4096
    buffer_load_dwordx4 v[32:35], v15, s[12:15], s65 offen offset:0 sc1
    buffer_load_dwordx4 v[48:51], v15, s[12:15], s46 offen offset:0 sc1
    buffer_load_dwordx4 v[36:39], v15, s[12:15], s65 offen offset:1024 sc1
    buffer_load_dwordx4 v[52:55], v15, s[12:15], s46 offen offset:1024 sc1
    buffer_load_dwordx4 v[40:43], v15, s[12:15], s65 offen offset:2048 sc1
    buffer_load_dwordx4 v[56:59], v15, s[12:15], s46 offen offset:2048 sc1
    buffer_load_dwordx4 v[44:47], v15, s[12:15], s65 offen offset:3072 sc1
    buffer_load_dwordx4 v[60:63], v15, s[12:15], s46 offen offset:3072 sc1
    s_add_u32 s65, s65, 786432
    s_waitcnt vmcnt(0)
    v_mfma_f32_16x16x32_bf16 v[64:67], v[32:35], a[64:67], 0
    v_mfma_f32_16x16x32_bf16 v[68:71], v[48:51], a[64:67], 0
    v_mfma_f32_16x16x32_bf16 v[64:67], v[36:39], a[68:71], v[64:67]
    v_mfma_f32_16x16x32_bf16 v[68:71], v[52:55], a[68:71], v[68:71]
    v_mfma_f32_16x16x32_bf16 v[64:67], v[40:43], a[72:75], v[64:67]
    v_mfma_f32_16x16x32_bf16 v[68:71], v[56:59], a[72:75], v[68:71]
    v_mfma_f32_16x16x32_bf16 v[64:67], v[44:47], a[76:79], v[64:67]
    v_mfma_f32_16x16x32_bf16 v[68:71], v[60:63], a[76:79], v[68:71]
    v_mfma_f32_16x16x32_bf16 v[72:75], v[32:35], a[80:83], 0
    v_mfma_f32_16x16x32_bf16 v[76:79], v[48:51], a[80:83], 0
    v_mfma_f32_16x16x32_bf16 v[72:75], v[36:39], a[84:87], v[72:75]
    v_mfma_f32_16x16x32_bf16 v[76:79], v[52:55], a[84:87], v[76:79]
    v_mfma_f32_16x16x32_bf16 v[72:75], v[40:43], a[88:91], v[72:75]
    v_mfma_f32_16x16x32_bf16 v[76:79], v[56:59], a[88:91], v[76:79]
    v_mfma_f32_16x16x32_bf16 v[72:75], v[44:47], a[92:95], v[72:75]
    v_mfma_f32_16x16x32_bf16 v[76:79], v[60:63], a[92:95], v[76:79]
    v_cvt_pk_bf16_f32 v64, v64, v65
    v_cvt_pk_bf16_f32 v65, v66, v67
    v_cvt_pk_bf16_f32 v66, v68, v69
    v_cvt_pk_bf16_f32 v67, v70, v71
    ds_write_b128 v10, v[64:67] offset:32768
    v_mfma_f32_16x16x32_bf16 v[80:83], v[32:35], a[96:99], 0
    v_mfma_f32_16x16x32_bf16 v[84:87], v[48:51], a[96:99], 0
    v_mfma_f32_16x16x32_bf16 v[80:83], v[36:39], a[100:103], v[80:83]
    v_mfma_f32_16x16x32_bf16 v[84:87], v[52:55], a[100:103], v[84:87]
    v_mfma_f32_16x16x32_bf16 v[80:83], v[40:43], a[104:107], v[80:83]
    v_mfma_f32_16x16x32_bf16 v[84:87], v[56:59], a[104:107], v[84:87]
    v_mfma_f32_16x16x32_bf16 v[80:83], v[44:47], a[108:111], v[80:83]
    v_mfma_f32_16x16x32_bf16 v[84:87], v[60:63], a[108:111], v[84:87]
    v_cvt_pk_bf16_f32 v72, v72, v73
    v_cvt_pk_bf16_f32 v73, v74, v75
    v_cvt_pk_bf16_f32 v74, v76, v77
    v_cvt_pk_bf16_f32 v75, v78, v79
    ds_write_b128 v10, v[72:75] offset:33792
    v_mfma_f32_16x16x32_bf16 v[88:91], v[32:35], a[112:115], 0
    v_mfma_f32_16x16x32_bf16 v[92:95], v[48:51], a[112:115], 0
    v_mfma_f32_16x16x32_bf16 v[88:91], v[36:39], a[116:119], v[88:91]
    v_mfma_f32_16x16x32_bf16 v[92:95], v[52:55], a[116:119], v[92:95]
    v_mfma_f32_16x16x32_bf16 v[88:91], v[40:43], a[120:123], v[88:91]
    v_mfma_f32_16x16x32_bf16 v[92:95], v[56:59], a[120:123], v[92:95]
    v_mfma_f32_16x16x32_bf16 v[88:91], v[44:47], a[124:127], v[88:91]
    v_mfma_f32_16x16x32_bf16 v[92:95], v[60:63], a[124:127], v[92:95]
    v_cvt_pk_bf16_f32 v80, v80, v81
    v_cvt_pk_bf16_f32 v81, v82, v83
    v_cvt_pk_bf16_f32 v82, v84, v85
    v_cvt_pk_bf16_f32 v83, v86, v87
    ds_write_b128 v10, v[80:83] offset:34816
    s_nop 2
    v_cvt_pk_bf16_f32 v88, v88, v89
    v_cvt_pk_bf16_f32 v89, v90, v91
    v_cvt_pk_bf16_f32 v90, v92, v93
    v_cvt_pk_bf16_f32 v91, v94, v95
    ds_write_b128 v10, v[88:91] offset:35840
    s_mov_b64 s[66:67], 0
    s_mov_b32 s63, 0
    s_mov_b32 s68, 1
    s_cmp_gt_u32 s69, s68
    s_cbranch_scc1 L_kv_ok_192
    s_mov_b32 s70, 0
L_kv_lp_191:
    v_and_b32 v22, 1, v1
    v_lshlrev_b32 v22, 9, v22
    buffer_load_dword v23, v22, s[12:15], s57 offen sc1
    s_waitcnt vmcnt(0)
    v_readlane_b32 s69, v23, 0
    v_readlane_b32 s45, v23, 1
    s_add_u32 s70, s70, 1
    s_nop 2
    s_min_u32 s69, s69, s45
    s_cmp_gt_u32 s69, s68
    s_cbranch_scc1 L_kv_ok_192
    s_sleep 4
    s_cmp_lt_u32 s70, 524288
    s_cbranch_scc1 L_kv_lp_191
    s_branch L_c_done_1
L_kv_ok_192:
    v_lshrrev_b32 v22, 3, v1
    v_lshlrev_b32 v22, 7, v22
    s_mov_b32 s45, 0x101800
    s_mov_b32 s46, 0
    s_mov_b32 s70, 0
L_spin_193:
    buffer_load_dword v23, v22, s[12:15], s45 offen sc1
    s_waitcnt vmcnt(0)
    v_cmp_ge_u32 vcc, s46, v23
    s_add_u32 s70, s70, 1
    s_cbranch_vccz L_spok_194
    s_sleep 3
    s_cmp_lt_u32 s70, 524288
    s_cbranch_scc1 L_spin_193
    s_branch L_c_done_1
L_spok_194:
    v_cmp_eq_u32 s[66:67], 3, v23
    s_nop 3
    s_bitcmp1_b32 s66, 0
    s_cselect_b32 s63, 8192, 0
    s_waitcnt lgkmcnt(0)
    v_min_u32 v64, -2, v112
    v_min_u32 v65, -2, v113
    v_min_u32 v66, -2, v114
    v_min_u32 v67, -2, v115
    v_min_u32 v68, -2, v116
    v_min_u32 v69, -2, v117
    v_min_u32 v70, -2, v118
    v_min_u32 v71, -2, v119
    v_min_u32 v72, -2, v120
    v_min_u32 v73, -2, v121
    v_min_u32 v74, -2, v122
    v_min_u32 v75, -2, v123
    v_min_u32 v76, -2, v124
    v_min_u32 v77, -2, v125
    v_min_u32 v78, -2, v126
    v_min_u32 v79, -2, v127
    v_mov_b32 v16, 0
    v_mov_b32 v17, 0
    v_mov_b32 v18, 0
    v_mov_b32 v19, 0
    v_mov_b32 v20, 0
    v_mov_b32 v21, 0
    v_mov_b32 v22, 0
    v_mov_b32 v23, 0
L_c_join_185:
    s_mov_b32 s60, 0
    s_mov_b32 s61, 0
    s_mov_b32 s62, 0
    s_cmp_lg_u32 s44, 0
    s_cbranch_scc1 L_c_nh_195
    v_lshlrev_b32 v17, 3, v1
    s_lshl_b32 s46, s40, 3
    v_mov_b32 v21, s46
    s_mov_b32 s45, 0x101000
    s_mov_b32 s70, 0
L_c_rp_196:
    buffer_load_dwordx2 v[18:19], v17, s[12:15], s45 offen sc1
    buffer_load_dwordx2 v[22:23], v21, s[12:15], s45 offen offset:512 sc1
    s_waitcnt vmcnt(0)
    v_min3_u32 v20, v18, v19, v22
    v_min_u32 v20, v20, v23
    v_cmp_eq_u32 vcc, 0, v20
    s_cbranch_vccnz L_rt_197
    v_cmp_eq_u32 s[52:53], v18, v16
    v_cmp_eq_u32 vcc, v19, v16
    v_cmp_eq_u32 s[54:55], v22, v16
    v_cmp_eq_u32 s[56:57], v23, v16
    s_lshl_b32 s46, s40, 3
    s_nop 3
    s_and_b64 s[52:53], s[52:53], vcc
    s_lshr_b64 s[52:53], s[52:53], s46
    s_and_b32 s52, s52, 0xff
    s_cmp_eq_u32 s52, 0xff
    s_cselect_b32 s52, 1, 0
    v_mov_b32 v16, s52
    v_mov_b32 v17, 26624
    ds_write_b32 v17, v16
L_c_nh_195:
    s_waitcnt lgkmcnt(0)
    s_barrier
    v_mov_b32 v17, 26624
    ds_read_b32 v16, v17
    s_waitcnt lgkmcnt(0)
    v_readfirstlane_b32 s52, v16
    s_nop 3
    s_cmp_ge_u32 s44, 4
    s_cbranch_scc1 L_vf_200
    s_mov_b32 s57, s58
    s_mov_b32 s58, 0
    s_cmp_ge_u32 s44, 2
    s_cbranch_scc1 L_sf_198
    buffer_load_dwordx4 v[32:35], v6, s[12:15], 0 offen sc1
L_sf_198:
    s_mov_b32 s54, s52
    v_add_u32 v52, 786432, v6
    s_mul_i32 s53, s49, 24576
    s_lshl_b32 s55, s43, 11
    s_add_u32 s53, s53, s55
    s_and_b32 s55, s44, 1
    s_lshl_b32 s55, s55, 10
    s_add_u32 s53, s53, s55
    s_add_u32 s53, s53, 0x2184000
    v_and_b32 v53, 7, v1
    v_lshlrev_b32 v53, 7, v53
    v_add_u32 v53, s53, v53
    s_cmp_ge_u32 s44, 2
    s_cselect_b64 vcc, -1, 0
    s_cselect_b64 s[52:53], 0xff, -1
    v_cndmask_b32 v52, v52, v53, vcc
    s_cselect_b32 s55, 786432, 0
    v_readfirstlane_b32 s56, v52
    s_nop 3
    s_sub_u32 s56, s56, s55
    s_cmp_eq_u32 s54, 0
    s_cbranch_scc1 L_ss_199
.p2align 6
L_s_loop_202:
    v_mov_b32 v16, 0
    v_mov_b32 v17, 0
    v_mov_b32 v18, 0
    v_mov_b32 v19, 0
    s_add_u32 s58, s58, 4
    s_mov_b32 s70, 1
    s_waitcnt vmcnt(0) lgkmcnt(0)
    s_barrier
    ds_read_b128 v[64:67], v2 offset:0
    ds_read_b128 v[68:71], v2 offset:1024
    ds_read_b128 v[72:75], v2 offset:2048
    ds_read_b128 v[76:79], v2 offset:3072
    ds_read_b128 v[80:83], v2 offset:4096
    ds_read_b128 v[84:87], v2 offset:5120
    ds_read_b128 v[88:91], v2 offset:6144
    ds_read_b128 v[92:95], v2 offset:7168
    ds_read_b128 v[96:99], v2 offset:8192
    ds_read_b128 v[100:103], v2 offset:9216
    ds_read_b128 v[104:107], v2 offset:10240
    ds_read_b128 v[108:111], v2 offset:11264
    s_waitcnt lgkmcnt(11)
    v_smfmac_f32_16x16x64_bf16 v[16:19], v[64:67], a[0:7], v3
    ds_read_b128 v[112:115], v2 offset:12288
    s_waitcnt lgkmcnt(11)
    v_smfmac_f32_16x16x64_bf16 v[16:19], v[68:71], a[8:15], v3
    ds_read_b128 v[116:119], v2 offset:13312
    s_waitcnt lgkmcnt(11)
    v_smfmac_f32_16x16x64_bf16 v[16:19], v[72:75], a[16:23], v3
    ds_read_b128 v[120:123], v2 offset:14336
    s_waitcnt lgkmcnt(11)
    v_smfmac_f32_16x16x64_bf16 v[16:19], v[76:79], a[24:31], v3
    ds_read_b128 v[124:127], v2 offset:15360
    s_waitcnt lgkmcnt(11)
    v_smfmac_f32_16x16x64_bf16 v[16:19], v[80:83], a[32:39], v3
    s_waitcnt lgkmcnt(10)
    v_smfmac_f32_16x16x64_bf16 v[16:19], v[84:87], a[40:47], v3
    s_waitcnt lgkmcnt(9)
    v_smfmac_f32_16x16x64_bf16 v[16:19], v[88:91], a[48:55], v3
    s_waitcnt lgkmcnt(8)
    v_smfmac_f32_16x16x64_bf16 v[16:19], v[92:95], a[56:63], v3
    s_waitcnt lgkmcnt(7)
    v_smfmac_f32_16x16x64_bf16 v[16:19], v[96:99], a[64:71], v3
    s_waitcnt lgkmcnt(6)
    v_smfmac_f32_16x16x64_bf16 v[16:19], v[100:103], a[72:79], v3
    s_waitcnt lgkmcnt(5)
    v_smfmac_f32_16x16x64_bf16 v[16:19], v[104:107], a[80:87], v3
    s_waitcnt lgkmcnt(4)
    v_smfmac_f32_16x16x64_bf16 v[16:19], v[108:111], a[88:95], v3
    s_waitcnt lgkmcnt(3)
    v_smfmac_f32_16x16x64_bf16 v[16:19], v[112:115], a[96:103], v3
    s_waitcnt lgkmcnt(2)
    v_smfmac_f32_16x16x64_bf16 v[16:19], v[116:119], a[104:111], v3
    s_waitcnt lgkmcnt(1)
    v_smfmac_f32_16x16x64_bf16 v[16:19], v[120:123], a[112:119], v3
    s_waitcnt lgkmcnt(0)
    v_smfmac_f32_16x16x64_bf16 v[16:19], v[124:127], a[120:127], v3
    s_nop 7
    v_permlane32_swap_b32 v16, v18
    v_permlane32_swap_b32 v17, v19
    v_add_f32 v16, v16, v18
    v_add_f32 v17, v17, v19
    v_cvt_pk_bf16_f32 v16, v16, v17
    ds_write_b16 v5, v16
    ds_write_b16_d16_hi v5, v16 offset:16
    s_mov_b64 exec, 1
    ds_add_u32 v29, v30
    s_mov_b64 exec, -1
L_s_xl_204:
    ds_read_b32 v10, v29
    ds_read_b128 v[64:67], v2 offset:61440
    s_cmp_eq_u32 s60, 63
    s_cbranch_scc1 L_s_last_203
    s_cmp_ge_u32 s44, 2
    s_cbranch_scc1 L_s_w2_205
    s_waitcnt lgkmcnt(0)
    v_mfma_f32_16x16x32_bf16 v[16:19], v[32:35], v[64:67], 0
L_s_w2_205_b:
    v_cmp_ne_u32 vcc, s58, v10
    s_nop 0
    s_cbranch_vccnz L_rt_207
    s_mov_b64 exec, s[50:51]
    s_nop 3
    v_cvt_pk_bf16_f32 v16, v16, v17
    v_cvt_pk_bf16_f32 v17, v18, v19
    v_pk_min_u16 v16, v16, v54
    v_pk_min_u16 v17, v17, v54
    buffer_store_dwordx2 v[16:17], v4, s[12:15], s61 offen
    s_mov_b64 exec, -1
L_s_w3_206_b:
    s_sleep 5
    s_mov_b32 s70, 1
L_s_xp_208:
    buffer_load_dwordx2 v[64:65], v7, s[12:15], s61 offen offset:0 sc1
    buffer_load_short_d16_hi v56, v28, s[12:15], s61 offen offset:0 sc1
    buffer_load_dwordx2 v[66:67], v7, s[12:15], s61 offen offset:512 sc1
    buffer_load_short_d16_hi v57, v28, s[12:15], s61 offen offset:128 sc1
    buffer_load_dwordx2 v[68:69], v7, s[12:15], s61 offen offset:1024 sc1
    buffer_load_short_d16_hi v58, v28, s[12:15], s61 offen offset:256 sc1
    buffer_load_dwordx2 v[70:71], v7, s[12:15], s61 offen offset:1536 sc1
    buffer_load_short_d16_hi v59, v28, s[12:15], s61 offen offset:384 sc1
    s_mov_b32 s46, 0x00003f80
    s_mov_b32 s47, 0x3f800000
    s_waitcnt vmcnt(6)
    v_dot2_f32_bf16 v16, v64, s46, 0
    v_dot2_f32_bf16 v17, v64, s47, 0
    v_dot2_f32_bf16 v18, v65, s46, 0
    v_dot2_f32_bf16 v19, v65, s47, 0
    s_waitcnt vmcnt(4)
    v_dot2_f32_bf16 v16, v66, s46, v16
    v_dot2_f32_bf16 v17, v66, s47, v17
    v_dot2_f32_bf16 v18, v67, s46, v18
    v_dot2_f32_bf16 v19, v67, s47, v19
    v_add_f32 v20, v56, v57
    s_waitcnt vmcnt(2)
    v_dot2_f32_bf16 v16, v68, s46, v16
    v_dot2_f32_bf16 v17, v68, s47, v17
    v_dot2_f32_bf16 v18, v69, s46, v18
    v_dot2_f32_bf16 v19, v69, s47, v19
    v_add_f32 v20, v20, v58
    s_waitcnt vmcnt(0)
    v_dot2_f32_bf16 v16, v70, s46, v16
    v_dot2_f32_bf16 v17, v70, s47, v17
    v_dot2_f32_bf16 v18, v71, s46, v18
    v_dot2_f32_bf16 v19, v71, s47, v19
    v_add_f32 v20, v20, v59
    s_nop 0
    v_cmp_u_f32 s[46:47], v16, v17
    v_cmp_u_f32 s[48:49], v18, v19
    v_cmp_u_f32 vcc, v20, v20
    v_max3_f32 v10, v16, v17, v18
    s_or_b64 s[46:47], s[46:47], s[48:49]
    v_max3_f32 v10, v10, v19, v20
    s_or_b64 vcc, vcc, s[46:47]
    s_cbranch_scc1 L_s_xf_209
L_s_xok_210:
    v_max_f32_dpp v11, v10, v10 row_ror:8 row_mask:0xf bank_mask:0xf
    v_max_f32_dpp v10, v10, v10 row_ror:8 row_mask:0xf bank_mask:0xf
    s_nop 1
    v_permlane16_swap_b32 v10, v11
    v_max_f32 v12, v10, v11
    v_max_f32 v10, v10, v11
    s_nop 1
    v_permlane32_swap_b32 v10, v12
    v_max_f32 v10, v10, v12
    v_mul_f32 v10, s66, v10
    v_fma_f32 v16, v16, s66, -v10
    v_fma_f32 v17, v17, s66, -v10
    v_fma_f32 v18, v18, s66, -v10
    v_fma_f32 v19, v19, s66, -v10
    v_fma_f32 v20, v20, s66, -v10
    v_exp_f32 v16, v16
    v_exp_f32 v17, v17
    v_exp_f32 v18, v18
    v_exp_f32 v19, v19
    v_exp_f32 v20, v20
    v_add_f32 v10, v16, v17
    v_add_f32 v11, v18, v19
    v_add_f32 v10, v10, v20
    v_add_f32 v10, v10, v11
    s_nop 1
    v_add_f32_dpp v11, v10, v10 row_ror:8 row_mask:0xf bank_mask:0xf
    v_add_f32_dpp v10, v10, v10 row_ror:8 row_mask:0xf bank_mask:0xf
    s_nop 1
    v_permlane16_swap_b32 v10, v11
    v_add_f32 v12, v10, v11
    v_add_f32 v10, v10, v11
    s_nop 1
    v_permlane32_swap_b32 v10, v12
    v_add_f32 v10, v10, v12
    v_rcp_f32 v10, v10
    s_nop 0
    v_mul_f32 v16, v16, v10
    v_mul_f32 v17, v17, v10
    v_mul_f32 v18, v18, v10
    v_mul_f32 v19, v19, v10
    v_mul_f32 v20, v20, v10
    v_cvt_pk_bf16_f32 v16, v16, v17
    v_cvt_pk_bf16_f32 v17, v18, v19
    v_cvt_pk_bf16_f32 v18, v20, v20
    ds_write_b64 v8, v[16:17]
    ds_write_b16 v9, v18
    s_waitcnt lgkmcnt(0)
    s_barrier
    s_add_u32 s63, s63, 786432
    s_cmp_ge_u32 s44, 2
    s_cbranch_scc1 L_s_nk_211
    buffer_load_dwordx4 v[32:35], v6, s[12:15], s63 offen sc1
L_s_nk_211:
    s_add_u32 s45, s60, 2
    s_cmp_le_u32 s69, s45
    s_cbranch_scc1 L_s_nk_211_w
    s_add_u32 s45, s63, 786432
    s_mov_b64 exec, 0xf
    buffer_load_dword v15, v14, s[12:15], s45 offen sc1
    s_mov_b64 exec, -1
L_s_nk_211_w:
    s_cmp_eq_u32 s44, 3
    s_cbranch_scc1 L_s_nr_212
    s_xor_b32 s45, s61, 0x8000
    s_mov_b64 exec, s[50:51]
    buffer_store_dwordx2 v[24:25], v4, s[12:15], s45 offen
    s_mov_b64 exec, -1
L_s_nr_212:
    s_cmp_lg_u32 s44, 3
    s_cbranch_scc1 L_s_np_213
    ds_read_b128 v[20:23], v6
    s_lshl_b32 s45, s60, 17
    s_add_u32 s45, s45, s67
    s_waitcnt lgkmcnt(0)
    v_min_u32 v20, -2, v20
    v_min_u32 v21, -2, v21
    v_min_u32 v22, -2, v22
    v_min_u32 v23, -2, v23
    buffer_store_dwordx4 v[20:23], v2, s[12:15], s45 offen sc1
L_s_np_213:
    s_add_u32 s68, s60, 2
    s_min_u32 s68, s68, 63
    v_readlane_b32 s45, v0, 0
    v_readlane_b32 s46, v0, 1
    s_nop 0
    s_min_u32 s45, s45, s46
    s_max_u32 s69, s69, s45
    s_cmp_gt_u32 s69, s68
    s_cbranch_scc1 L_kv_ok_216
    s_mov_b32 s70, 0
L_kv_lp_215:
    v_and_b32 v22, 1, v1
    v_lshlrev_b32 v22, 9, v22
    buffer_load_dword v23, v22, s[12:15], s57 offen sc1
    s_waitcnt vmcnt(0)
    v_readlane_b32 s69, v23, 0
    v_readlane_b32 s45, v23, 1
    s_add_u32 s70, s70, 1
    s_nop 2
    s_min_u32 s69, s69, s45
    s_cmp_gt_u32 s69, s68
    s_cbranch_scc1 L_kv_ok_216
    s_sleep 4
    s_cmp_lt_u32 s70, 524288
    s_cbranch_scc1 L_kv_lp_215
    s_branch L_c_done_1
L_kv_ok_216:
    s_add_u32 s45, s60, 7
    s_min_u32 s45, s45, 63
    s_cmp_gt_u32 s69, s45
    s_cbranch_scc1 L_s_na_214
    v_and_b32 v22, 1, v1
    v_lshlrev_b32 v22, 9, v22
    buffer_load_dword v0, v22, s[12:15], s57 offen sc1
L_s_na_214:
    s_sub_u32 s45, s60, 4
    s_cmp_gt_u32 s45, 24
    s_cbranch_scc1 L_s_xe_217
    s_sleep 1
    s_setprio 0
    s_bitcmp1_b32 s45, 0
    s_cbranch_scc1 L_s_x1_218
    s_cmp_eq_u32 s45, 0
    s_cbranch_scc1 L_s_x0_219
    s_bitcmp1_b32 s44, 0
    s_cbranch_scc1 L_s_x0_219
    ds_read_b128 v[40:43], v31
    s_sub_u32 s46, s45, 2
    s_lshr_b32 s47, s46, 2
    s_mul_i32 s47, s47, 786432
    s_and_b32 s46, s46, 2
    s_lshl_b32 s46, s46, 11
    s_add_u32 s47, s47, s46
    s_waitcnt lgkmcnt(0)
    buffer_store_dwordx4 v[40:43], v13, s[12:15], s47 offen sc1
L_s_x0_219:
    s_cmp_eq_u32 s45, 24
    s_cbranch_scc1 L_s_xe_217
    ds_read_b128 v[64:67], v44 offset:0
    ds_read_b128 v[68:71], v44 offset:1024
    ds_read_b128 v[72:75], v44 offset:2048
    ds_read_b128 v[76:79], v44 offset:3072
    ds_read_b128 v[80:83], v44 offset:4096
    ds_read_b128 v[84:87], v44 offset:5120
    ds_read_b128 v[88:91], v44 offset:6144
    ds_read_b128 v[92:95], v44 offset:7168
    ds_read_b128 v[96:99], v44 offset:8192
    ds_read_b128 v[100:103], v44 offset:9216
    ds_read_b128 v[104:107], v44 offset:10240
    ds_read_b128 v[108:111], v44 offset:11264
    s_waitcnt lgkmcnt(11)
    v_mfma_f32_16x16x32_bf16 v[36:39], a[0:3], v[64:67], 0
    ds_read_b128 v[112:115], v44 offset:12288
    s_waitcnt lgkmcnt(11)
    v_mfma_f32_16x16x32_bf16 v[36:39], a[4:7], v[68:71], v[36:39]
    ds_read_b128 v[116:119], v44 offset:13312
    s_waitcnt lgkmcnt(11)
    v_mfma_f32_16x16x32_bf16 v[36:39], a[8:11], v[72:75], v[36:39]
    ds_read_b128 v[120:123], v44 offset:14336
    s_waitcnt lgkmcnt(11)
    v_mfma_f32_16x16x32_bf16 v[36:39], a[12:15], v[76:79], v[36:39]
    ds_read_b128 v[124:127], v44 offset:15360
    s_waitcnt lgkmcnt(11)
    v_mfma_f32_16x16x32_bf16 v[36:39], a[16:19], v[80:83], v[36:39]
    s_waitcnt lgkmcnt(10)
    v_mfma_f32_16x16x32_bf16 v[36:39], a[20:23], v[84:87], v[36:39]
    s_waitcnt lgkmcnt(9)
    v_mfma_f32_16x16x32_bf16 v[36:39], a[24:27], v[88:91], v[36:39]
    s_waitcnt lgkmcnt(8)
    v_mfma_f32_16x16x32_bf16 v[36:39], a[28:31], v[92:95], v[36:39]
    s_waitcnt lgkmcnt(7)
    v_mfma_f32_16x16x32_bf16 v[36:39], a[32:35], v[96:99], v[36:39]
    s_waitcnt lgkmcnt(6)
    v_mfma_f32_16x16x32_bf16 v[36:39], a[36:39], v[100:103], v[36:39]
    s_waitcnt lgkmcnt(5)
    v_mfma_f32_16x16x32_bf16 v[36:39], a[40:43], v[104:107], v[36:39]
    s_waitcnt lgkmcnt(4)
    v_mfma_f32_16x16x32_bf16 v[36:39], a[44:47], v[108:111], v[36:39]
    s_waitcnt lgkmcnt(3)
    v_mfma_f32_16x16x32_bf16 v[36:39], a[48:51], v[112:115], v[36:39]
    s_waitcnt lgkmcnt(2)
    v_mfma_f32_16x16x32_bf16 v[36:39], a[52:55], v[116:119], v[36:39]
    s_waitcnt lgkmcnt(1)
    v_mfma_f32_16x16x32_bf16 v[36:39], a[56:59], v[120:123], v[36:39]
    s_waitcnt lgkmcnt(0)
    v_mfma_f32_16x16x32_bf16 v[36:39], a[60:63], v[124:127], v[36:39]
    s_branch L_s_xe_217
L_s_x1_218:
    ds_read_b128 v[64:67], v44 offset:16384
    ds_read_b128 v[68:71], v44 offset:17408
    ds_read_b128 v[72:75], v44 offset:18432
    ds_read_b128 v[76:79], v44 offset:19456
    ds_read_b128 v[80:83], v44 offset:20480
    ds_read_b128 v[84:87], v44 offset:21504
    ds_read_b128 v[88:91], v44 offset:22528
    ds_read_b128 v[92:95], v44 offset:23552
    ds_read_b128 v[96:99], v44 offset:24576
    ds_read_b128 v[100:103], v44 offset:25600
    ds_read_b128 v[104:107], v44 offset:26624
    ds_read_b128 v[108:111], v44 offset:27648
    s_waitcnt lgkmcnt(11)
    v_mfma_f32_16x16x32_bf16 v[36:39], a[64:67], v[64:67], v[36:39]
    ds_read_b128 v[112:115], v44 offset:28672
    s_waitcnt lgkmcnt(11)
    v_mfma_f32_16x16x32_bf16 v[36:39], a[68:71], v[68:71], v[36:39]
    ds_read_b128 v[116:119], v44 offset:29696
    s_waitcnt lgkmcnt(11)
    v_mfma_f32_16x16x32_bf16 v[36:39], a[72:75], v[72:75], v[36:39]
    ds_read_b128 v[120:123], v44 offset:30720
    s_waitcnt lgkmcnt(11)
    v_mfma_f32_16x16x32_bf16 v[36:39], a[76:79], v[76:79], v[36:39]
    ds_read_b128 v[124:127], v44 offset:31744
    s_waitcnt lgkmcnt(11)
    v_mfma_f32_16x16x32_bf16 v[36:39], a[80:83], v[80:83], v[36:39]
    s_waitcnt lgkmcnt(10)
    v_mfma_f32_16x16x32_bf16 v[36:39], a[84:87], v[84:87], v[36:39]
    s_waitcnt lgkmcnt(9)
    v_mfma_f32_16x16x32_bf16 v[36:39], a[88:91], v[88:91], v[36:39]
    s_waitcnt lgkmcnt(8)
    v_mfma_f32_16x16x32_bf16 v[36:39], a[92:95], v[92:95], v[36:39]
    s_waitcnt lgkmcnt(7)
    v_mfma_f32_16x16x32_bf16 v[36:39], a[96:99], v[96:99], v[36:39]
    s_waitcnt lgkmcnt(6)
    v_mfma_f32_16x16x32_bf16 v[36:39], a[100:103], v[100:103], v[36:39]
    s_waitcnt lgkmcnt(5)
    v_mfma_f32_16x16x32_bf16 v[36:39], a[104:107], v[104:107], v[36:39]
    s_waitcnt lgkmcnt(4)
    v_mfma_f32_16x16x32_bf16 v[36:39], a[108:111], v[108:111], v[36:39]
    s_waitcnt lgkmcnt(3)
    v_mfma_f32_16x16x32_bf16 v[36:39], a[112:115], v[112:115], v[36:39]
    s_waitcnt lgkmcnt(2)
    v_mfma_f32_16x16x32_bf16 v[36:39], a[116:119], v[116:119], v[36:39]
    s_waitcnt lgkmcnt(1)
    v_mfma_f32_16x16x32_bf16 v[36:39], a[120:123], v[120:123], v[36:39]
    s_waitcnt lgkmcnt(0)
    v_mfma_f32_16x16x32_bf16 v[36:39], a[124:127], v[124:127], v[36:39]
    s_nop 7
    v_cvt_pk_bf16_f32 v40, v36, v37
    v_cvt_pk_bf16_f32 v41, v38, v39
    ds_write_b64 v45, v[40:41]
    s_waitcnt lgkmcnt(0)
L_s_xe_217:
    s_setprio 1
    s_add_u32 s60, s60, 1
    s_add_u32 s61, s61, 0x4000
    s_and_b32 s61, s61, 0xffff
    s_branch L_s_loop_202
L_s_last_203:
    s_waitcnt lgkmcnt(0)
    s_barrier
    s_cmp_lg_u32 s44, 3
    s_cbranch_scc1 L_s_np_220
    ds_read_b128 v[20:23], v6
    s_lshl_b32 s45, s60, 17
    s_add_u32 s45, s45, s67
    s_waitcnt lgkmcnt(0)
    v_min_u32 v20, -2, v20
    v_min_u32 v21, -2, v21
    v_min_u32 v22, -2, v22
    v_min_u32 v23, -2, v23
    buffer_store_dwordx4 v[20:23], v2, s[12:15], s45 offen sc1
L_s_np_220:
    s_branch L_replica
L_rt_197:
    s_add_u32 s70, s70, 1
    s_cmp_lt_u32 s70, 524288
    s_cbranch_scc1 L_c_rp_196
    s_branch L_c_done_1
L_rt_207:
    s_add_u32 s70, s70, 1
    s_cmp_lt_u32 s70, 524288
    s_cbranch_scc1 L_s_xl_204
    s_branch L_c_done_1
L_s_w2_205:
    s_cmp_eq_u32 s44, 3
    s_cbranch_scc1 L_s_w3_206
    s_waitcnt lgkmcnt(0)
    v_mfma_f32_16x16x32_bf16 v[16:19], v[64:67], v[64:67], 0
    s_branch L_s_w2_205_b
L_s_w3_206:
    s_sleep 3
    s_branch L_s_w3_206_b
L_s_xf_209:
    v_or_b32 v72, 0xffff, v56
    v_or_b32 v73, 0xffff, v57
    v_or_b32 v74, 0xffff, v58
    v_or_b32 v75, 0xffff, v59
    v_max3_u32 v11, v64, v65, v66
    v_max3_u32 v11, v11, v67, v68
    v_max3_u32 v11, v11, v69, v70
    v_max3_u32 v11, v11, v71, v72
    v_max3_u32 v11, v11, v73, v74
    v_max_u32 v11, v11, v75
    v_cmp_eq_u32 vcc, -1, v11
    s_add_u32 s70, s70, 1
    s_cbranch_vccz L_s_xok_210
    s_cmp_lt_u32 s70, 524288
    s_cbranch_scc1 L_s_xp_208
    s_branch L_c_done_1
L_ss_199:
.p2align 6
L_s_loop_221:
    v_mov_b32 v16, 0
    v_mov_b32 v17, 0
    v_mov_b32 v18, 0
    v_mov_b32 v19, 0
    s_add_u32 s58, s58, 4
    s_mov_b32 s70, 1
    s_waitcnt vmcnt(0) lgkmcnt(0)
    s_barrier
    ds_read_b128 v[64:67], v2 offset:0
    ds_read_b128 v[68:71], v2 offset:1024
    ds_read_b128 v[72:75], v2 offset:2048
    ds_read_b128 v[76:79], v2 offset:3072
    ds_read_b128 v[80:83], v2 offset:4096
    ds_read_b128 v[84:87], v2 offset:5120
    ds_read_b128 v[88:91], v2 offset:6144
    ds_read_b128 v[92:95], v2 offset:7168
    ds_read_b128 v[96:99], v2 offset:8192
    ds_read_b128 v[100:103], v2 offset:9216
    ds_read_b128 v[104:107], v2 offset:10240
    ds_read_b128 v[108:111], v2 offset:11264
    s_waitcnt lgkmcnt(11)
    v_smfmac_f32_16x16x64_bf16 v[16:19], v[64:67], a[0:7], v3
    ds_read_b128 v[112:115], v2 offset:12288
    s_waitcnt lgkmcnt(11)
    v_smfmac_f32_16x16x64_bf16 v[16:19], v[68:71], a[8:15], v3
    ds_read_b128 v[116:119], v2 offset:13312
    s_waitcnt lgkmcnt(11)
    v_smfmac_f32_16x16x64_bf16 v[16:19], v[72:75], a[16:23], v3
    ds_read_b128 v[120:123], v2 offset:14336
    s_waitcnt lgkmcnt(11)
    v_smfmac_f32_16x16x64_bf16 v[16:19], v[76:79], a[24:31], v3
    ds_read_b128 v[124:127], v2 offset:15360
    s_waitcnt lgkmcnt(11)
    v_smfmac_f32_16x16x64_bf16 v[16:19], v[80:83], a[32:39], v3
    s_waitcnt lgkmcnt(10)
    v_smfmac_f32_16x16x64_bf16 v[16:19], v[84:87], a[40:47], v3
    s_waitcnt lgkmcnt(9)
    v_smfmac_f32_16x16x64_bf16 v[16:19], v[88:91], a[48:55], v3
    s_waitcnt lgkmcnt(8)
    v_smfmac_f32_16x16x64_bf16 v[16:19], v[92:95], a[56:63], v3
    s_waitcnt lgkmcnt(7)
    v_smfmac_f32_16x16x64_bf16 v[16:19], v[96:99], a[64:71], v3
    s_waitcnt lgkmcnt(6)
    v_smfmac_f32_16x16x64_bf16 v[16:19], v[100:103], a[72:79], v3
    s_waitcnt lgkmcnt(5)
    v_smfmac_f32_16x16x64_bf16 v[16:19], v[104:107], a[80:87], v3
    s_waitcnt lgkmcnt(4)
    v_smfmac_f32_16x16x64_bf16 v[16:19], v[108:111], a[88:95], v3
    s_waitcnt lgkmcnt(3)
    v_smfmac_f32_16x16x64_bf16 v[16:19], v[112:115], a[96:103], v3
    s_waitcnt lgkmcnt(2)
    v_smfmac_f32_16x16x64_bf16 v[16:19], v[116:119], a[104:111], v3
    s_waitcnt lgkmcnt(1)
    v_smfmac_f32_16x16x64_bf16 v[16:19], v[120:123], a[112:119], v3
    s_waitcnt lgkmcnt(0)
    v_smfmac_f32_16x16x64_bf16 v[16:19], v[124:127], a[120:127], v3
    s_nop 7
    v_permlane32_swap_b32 v16, v18
    v_permlane32_swap_b32 v17, v19
    v_add_f32 v16, v16, v18
    v_add_f32 v17, v17, v19
    v_cvt_pk_bf16_f32 v16, v16, v17
    ds_write_b16 v5, v16
    ds_write_b16_d16_hi v5, v16 offset:16
    s_mov_b64 exec, 1
    ds_add_u32 v29, v30
    s_mov_b64 exec, -1
L_s_xl_223:
    ds_read_b32 v10, v29
    ds_read_b128 v[64:67], v2 offset:61440
    s_cmp_eq_u32 s60, 63
    s_cbranch_scc1 L_s_last_222
    s_cmp_ge_u32 s44, 2
    s_cbranch_scc1 L_s_w2_224
    s_waitcnt lgkmcnt(0)
    v_mfma_f32_16x16x32_bf16 v[16:19], v[32:35], v[64:67], 0
L_s_w2_224_b:
    v_cmp_ne_u32 vcc, s58, v10
    s_nop 0
    s_cbranch_vccnz L_rt_226
    s_mov_b64 exec, s[50:51]
    s_nop 3
    v_cvt_pk_bf16_f32 v16, v16, v17
    v_cvt_pk_bf16_f32 v17, v18, v19
    v_pk_min_u16 v16, v16, v54
    v_pk_min_u16 v17, v17, v54
    buffer_store_dwordx2 v[16:17], v4, s[12:15], s61 offen sc1
    s_mov_b64 exec, -1
L_s_w3_225_b:
    s_sleep 5
    s_mov_b32 s70, 1
L_s_xp_227:
    buffer_load_dwordx2 v[64:65], v7, s[12:15], s61 offen offset:0 sc1
    buffer_load_short_d16_hi v56, v28, s[12:15], s61 offen offset:0 sc1
    buffer_load_dwordx2 v[66:67], v7, s[12:15], s61 offen offset:512 sc1
    buffer_load_short_d16_hi v57, v28, s[12:15], s61 offen offset:128 sc1
    buffer_load_dwordx2 v[68:69], v7, s[12:15], s61 offen offset:1024 sc1
    buffer_load_short_d16_hi v58, v28, s[12:15], s61 offen offset:256 sc1
    buffer_load_dwordx2 v[70:71], v7, s[12:15], s61 offen offset:1536 sc1
    buffer_load_short_d16_hi v59, v28, s[12:15], s61 offen offset:384 sc1
    s_mov_b32 s46, 0x00003f80
    s_mov_b32 s47, 0x3f800000
    s_waitcnt vmcnt(6)
    v_dot2_f32_bf16 v16, v64, s46, 0
    v_dot2_f32_bf16 v17, v64, s47, 0
    v_dot2_f32_bf16 v18, v65, s46, 0
    v_dot2_f32_bf16 v19, v65, s47, 0
    s_waitcnt vmcnt(4)
    v_dot2_f32_bf16 v16, v66, s46, v16
    v_dot2_f32_bf16 v17, v66, s47, v17
    v_dot2_f32_bf16 v18, v67, s46, v18
    v_dot2_f32_bf16 v19, v67, s47, v19
    v_add_f32 v20, v56, v57
    s_waitcnt vmcnt(2)
    v_dot2_f32_bf16 v16, v68, s46, v16
    v_dot2_f32_bf16 v17, v68, s47, v17
    v_dot2_f32_bf16 v18, v69, s46, v18
    v_dot2_f32_bf16 v19, v69, s47, v19
    v_add_f32 v20, v20, v58
    s_waitcnt vmcnt(0)
    v_dot2_f32_bf16 v16, v70, s46, v16
    v_dot2_f32_bf16 v17, v70, s47, v17
    v_dot2_f32_bf16 v18, v71, s46, v18
    v_dot2_f32_bf16 v19, v71, s47, v19
    v_add_f32 v20, v20, v59
    s_nop 0
    v_cmp_u_f32 s[46:47], v16, v17
    v_cmp_u_f32 s[48:49], v18, v19
    v_cmp_u_f32 vcc, v20, v20
    v_max3_f32 v10, v16, v17, v18
    s_or_b64 s[46:47], s[46:47], s[48:49]
    v_max3_f32 v10, v10, v19, v20
    s_or_b64 vcc, vcc, s[46:47]
    s_cbranch_scc1 L_s_xf_228
L_s_xok_229:
    v_max_f32_dpp v11, v10, v10 row_ror:8 row_mask:0xf bank_mask:0xf
    v_max_f32_dpp v10, v10, v10 row_ror:8 row_mask:0xf bank_mask:0xf
    s_nop 1
    v_permlane16_swap_b32 v10, v11
    v_max_f32 v12, v10, v11
    v_max_f32 v10, v10, v11
    s_nop 1
    v_permlane32_swap_b32 v10, v12
    v_max_f32 v10, v10, v12
    v_mul_f32 v10, s66, v10
    v_fma_f32 v16, v16, s66, -v10
    v_fma_f32 v17, v17, s66, -v10
    v_fma_f32 v18, v18, s66, -v10
    v_fma_f32 v19, v19, s66, -v10
    v_fma_f32 v20, v20, s66, -v10
    v_exp_f32 v16, v16
    v_exp_f32 v17, v17
    v_exp_f32 v18, v18
    v_exp_f32 v19, v19
    v_exp_f32 v20, v20
    v_add_f32 v10, v16, v17
    v_add_f32 v11, v18, v19
    v_add_f32 v10, v10, v20
    v_add_f32 v10, v10, v11
    s_nop 1
    v_add_f32_dpp v11, v10, v10 row_ror:8 row_mask:0xf bank_mask:0xf
    v_add_f32_dpp v10, v10, v10 row_ror:8 row_mask:0xf bank_mask:0xf
    s_nop 1
    v_permlane16_swap_b32 v10, v11
    v_add_f32 v12, v10, v11
    v_add_f32 v10, v10, v11
    s_nop 1
    v_permlane32_swap_b32 v10, v12
    v_add_f32 v10, v10, v12
    v_rcp_f32 v10, v10
    s_nop 0
    v_mul_f32 v16, v16, v10
    v_mul_f32 v17, v17, v10
    v_mul_f32 v18, v18, v10
    v_mul_f32 v19, v19, v10
    v_mul_f32 v20, v20, v10
    v_cvt_pk_bf16_f32 v16, v16, v17
    v_cvt_pk_bf16_f32 v17, v18, v19
    v_cvt_pk_bf16_f32 v18, v20, v20
    ds_write_b64 v8, v[16:17]
    ds_write_b16 v9, v18
    s_waitcnt lgkmcnt(0)
    s_barrier
    s_add_u32 s63, s63, 786432
    s_cmp_ge_u32 s44, 2
    s_cbranch_scc1 L_s_nk_230
    buffer_load_dwordx4 v[32:35], v6, s[12:15], s63 offen sc1
L_s_nk_230:
    s_add_u32 s45, s60, 2
    s_cmp_le_u32 s69, s45
    s_cbranch_scc1 L_s_nk_230_w
    s_add_u32 s45, s63, 786432
    s_mov_b64 exec, 0xf
    buffer_load_dword v15, v14, s[12:15], s45 offen sc1
    s_mov_b64 exec, -1
L_s_nk_230_w:
    s_cmp_eq_u32 s44, 3
    s_cbranch_scc1 L_s_nr_231
    s_xor_b32 s45, s61, 0x8000
    s_mov_b64 exec, s[50:51]
    buffer_store_dwordx2 v[24:25], v4, s[12:15], s45 offen sc1
    s_mov_b64 exec, -1
L_s_nr_231:
    s_cmp_lg_u32 s44, 3
    s_cbranch_scc1 L_s_np_232
    ds_read_b128 v[20:23], v6
    s_lshl_b32 s45, s60, 17
    s_add_u32 s45, s45, s67
    s_waitcnt lgkmcnt(0)
    v_min_u32 v20, -2, v20
    v_min_u32 v21, -2, v21
    v_min_u32 v22, -2, v22
    v_min_u32 v23, -2, v23
    buffer_store_dwordx4 v[20:23], v2, s[12:15], s45 offen sc1
L_s_np_232:
    s_add_u32 s68, s60, 2
    s_min_u32 s68, s68, 63
    v_readlane_b32 s45, v0, 0
    v_readlane_b32 s46, v0, 1
    s_nop 0
    s_min_u32 s45, s45, s46
    s_max_u32 s69, s69, s45
    s_cmp_gt_u32 s69, s68
    s_cbranch_scc1 L_kv_ok_235
    s_mov_b32 s70, 0
L_kv_lp_234:
    v_and_b32 v22, 1, v1
    v_lshlrev_b32 v22, 9, v22
    buffer_load_dword v23, v22, s[12:15], s57 offen sc1
    s_waitcnt vmcnt(0)
    v_readlane_b32 s69, v23, 0
    v_readlane_b32 s45, v23, 1
    s_add_u32 s70, s70, 1
    s_nop 2
    s_min_u32 s69, s69, s45
    s_cmp_gt_u32 s69, s68
    s_cbranch_scc1 L_kv_ok_235
    s_sleep 4
    s_cmp_lt_u32 s70, 524288
    s_cbranch_scc1 L_kv_lp_234
    s_branch L_c_done_1
L_kv_ok_235:
    s_add_u32 s45, s60, 7
    s_min_u32 s45, s45, 63
    s_cmp_gt_u32 s69, s45
    s_cbranch_scc1 L_s_na_233
    v_and_b32 v22, 1, v1
    v_lshlrev_b32 v22, 9, v22
    buffer_load_dword v0, v22, s[12:15], s57 offen sc1
L_s_na_233:
    s_sub_u32 s45, s60, 4
    s_cmp_gt_u32 s45, 24
    s_cbranch_scc1 L_s_xe_236
    s_sleep 1
    s_setprio 0
    s_bitcmp1_b32 s45, 0
    s_cbranch_scc1 L_s_x1_237
    s_cmp_eq_u32 s45, 0
    s_cbranch_scc1 L_s_x0_238
    s_bitcmp1_b32 s44, 0
    s_cbranch_scc1 L_s_x0_238
    ds_read_b128 v[40:43], v31
    s_sub_u32 s46, s45, 2
    s_lshr_b32 s47, s46, 2
    s_mul_i32 s47, s47, 786432
    s_and_b32 s46, s46, 2
    s_lshl_b32 s46, s46, 11
    s_add_u32 s47, s47, s46
    s_waitcnt lgkmcnt(0)
    buffer_store_dwordx4 v[40:43], v13, s[12:15], s47 offen sc1
L_s_x0_238:
    s_cmp_eq_u32 s45, 24
    s_cbranch_scc1 L_s_xe_236
    ds_read_b128 v[64:67], v44 offset:0
    ds_read_b128 v[68:71], v44 offset:1024
    ds_read_b128 v[72:75], v44 offset:2048
    ds_read_b128 v[76:79], v44 offset:3072
    ds_read_b128 v[80:83], v44 offset:4096
    ds_read_b128 v[84:87], v44 offset:5120
    ds_read_b128 v[88:91], v44 offset:6144
    ds_read_b128 v[92:95], v44 offset:7168
    ds_read_b128 v[96:99], v44 offset:8192
    ds_read_b128 v[100:103], v44 offset:9216
    ds_read_b128 v[104:107], v44 offset:10240
    ds_read_b128 v[108:111], v44 offset:11264
    s_waitcnt lgkmcnt(11)
    v_mfma_f32_16x16x32_bf16 v[36:39], a[0:3], v[64:67], 0
    ds_read_b128 v[112:115], v44 offset:12288
    s_waitcnt lgkmcnt(11)
    v_mfma_f32_16x16x32_bf16 v[36:39], a[4:7], v[68:71], v[36:39]
    ds_read_b128 v[116:119], v44 offset:13312
    s_waitcnt lgkmcnt(11)
    v_mfma_f32_16x16x32_bf16 v[36:39], a[8:11], v[72:75], v[36:39]
    ds_read_b128 v[120:123], v44 offset:14336
    s_waitcnt lgkmcnt(11)
    v_mfma_f32_16x16x32_bf16 v[36:39], a[12:15], v[76:79], v[36:39]
    ds_read_b128 v[124:127], v44 offset:15360
    s_waitcnt lgkmcnt(11)
    v_mfma_f32_16x16x32_bf16 v[36:39], a[16:19], v[80:83], v[36:39]
    s_waitcnt lgkmcnt(10)
    v_mfma_f32_16x16x32_bf16 v[36:39], a[20:23], v[84:87], v[36:39]
    s_waitcnt lgkmcnt(9)
    v_mfma_f32_16x16x32_bf16 v[36:39], a[24:27], v[88:91], v[36:39]
    s_waitcnt lgkmcnt(8)
    v_mfma_f32_16x16x32_bf16 v[36:39], a[28:31], v[92:95], v[36:39]
    s_waitcnt lgkmcnt(7)
    v_mfma_f32_16x16x32_bf16 v[36:39], a[32:35], v[96:99], v[36:39]
    s_waitcnt lgkmcnt(6)
    v_mfma_f32_16x16x32_bf16 v[36:39], a[36:39], v[100:103], v[36:39]
    s_waitcnt lgkmcnt(5)
    v_mfma_f32_16x16x32_bf16 v[36:39], a[40:43], v[104:107], v[36:39]
    s_waitcnt lgkmcnt(4)
    v_mfma_f32_16x16x32_bf16 v[36:39], a[44:47], v[108:111], v[36:39]
    s_waitcnt lgkmcnt(3)
    v_mfma_f32_16x16x32_bf16 v[36:39], a[48:51], v[112:115], v[36:39]
    s_waitcnt lgkmcnt(2)
    v_mfma_f32_16x16x32_bf16 v[36:39], a[52:55], v[116:119], v[36:39]
    s_waitcnt lgkmcnt(1)
    v_mfma_f32_16x16x32_bf16 v[36:39], a[56:59], v[120:123], v[36:39]
    s_waitcnt lgkmcnt(0)
    v_mfma_f32_16x16x32_bf16 v[36:39], a[60:63], v[124:127], v[36:39]
    s_branch L_s_xe_236
L_s_x1_237:
    ds_read_b128 v[64:67], v44 offset:16384
    ds_read_b128 v[68:71], v44 offset:17408
    ds_read_b128 v[72:75], v44 offset:18432
    ds_read_b128 v[76:79], v44 offset:19456
    ds_read_b128 v[80:83], v44 offset:20480
    ds_read_b128 v[84:87], v44 offset:21504
    ds_read_b128 v[88:91], v44 offset:22528
    ds_read_b128 v[92:95], v44 offset:23552
    ds_read_b128 v[96:99], v44 offset:24576
    ds_read_b128 v[100:103], v44 offset:25600
    ds_read_b128 v[104:107], v44 offset:26624
    ds_read_b128 v[108:111], v44 offset:27648
    s_waitcnt lgkmcnt(11)
    v_mfma_f32_16x16x32_bf16 v[36:39], a[64:67], v[64:67], v[36:39]
    ds_read_b128 v[112:115], v44 offset:28672
    s_waitcnt lgkmcnt(11)
    v_mfma_f32_16x16x32_bf16 v[36:39], a[68:71], v[68:71], v[36:39]
    ds_read_b128 v[116:119], v44 offset:29696
    s_waitcnt lgkmcnt(11)
    v_mfma_f32_16x16x32_bf16 v[36:39], a[72:75], v[72:75], v[36:39]
    ds_read_b128 v[120:123], v44 offset:30720
    s_waitcnt lgkmcnt(11)
    v_mfma_f32_16x16x32_bf16 v[36:39], a[76:79], v[76:79], v[36:39]
    ds_read_b128 v[124:127], v44 offset:31744
    s_waitcnt lgkmcnt(11)
    v_mfma_f32_16x16x32_bf16 v[36:39], a[80:83], v[80:83], v[36:39]
    s_waitcnt lgkmcnt(10)
    v_mfma_f32_16x16x32_bf16 v[36:39], a[84:87], v[84:87], v[36:39]
    s_waitcnt lgkmcnt(9)
    v_mfma_f32_16x16x32_bf16 v[36:39], a[88:91], v[88:91], v[36:39]
    s_waitcnt lgkmcnt(8)
    v_mfma_f32_16x16x32_bf16 v[36:39], a[92:95], v[92:95], v[36:39]
    s_waitcnt lgkmcnt(7)
    v_mfma_f32_16x16x32_bf16 v[36:39], a[96:99], v[96:99], v[36:39]
    s_waitcnt lgkmcnt(6)
    v_mfma_f32_16x16x32_bf16 v[36:39], a[100:103], v[100:103], v[36:39]
    s_waitcnt lgkmcnt(5)
    v_mfma_f32_16x16x32_bf16 v[36:39], a[104:107], v[104:107], v[36:39]
    s_waitcnt lgkmcnt(4)
    v_mfma_f32_16x16x32_bf16 v[36:39], a[108:111], v[108:111], v[36:39]
    s_waitcnt lgkmcnt(3)
    v_mfma_f32_16x16x32_bf16 v[36:39], a[112:115], v[112:115], v[36:39]
    s_waitcnt lgkmcnt(2)
    v_mfma_f32_16x16x32_bf16 v[36:39], a[116:119], v[116:119], v[36:39]
    s_waitcnt lgkmcnt(1)
    v_mfma_f32_16x16x32_bf16 v[36:39], a[120:123], v[120:123], v[36:39]
    s_waitcnt lgkmcnt(0)
    v_mfma_f32_16x16x32_bf16 v[36:39], a[124:127], v[124:127], v[36:39]
    s_nop 7
    v_cvt_pk_bf16_f32 v40, v36, v37
    v_cvt_pk_bf16_f32 v41, v38, v39
    ds_write_b64 v45, v[40:41]
    s_waitcnt lgkmcnt(0)
L_s_xe_236:
    s_setprio 1
    s_add_u32 s60, s60, 1
    s_add_u32 s61, s61, 0x4000
    s_and_b32 s61, s61, 0xffff
    s_branch L_s_loop_221
L_s_last_222:
    s_waitcnt lgkmcnt(0)
    s_barrier
    s_cmp_lg_u32 s44, 3
    s_cbranch_scc1 L_s_np_239
    ds_read_b128 v[20:23], v6
    s_lshl_b32 s45, s60, 17
    s_add_u32 s45, s45, s67
    s_waitcnt lgkmcnt(0)
    v_min_u32 v20, -2, v20
    v_min_u32 v21, -2, v21
    v_min_u32 v22, -2, v22
    v_min_u32 v23, -2, v23
    buffer_store_dwordx4 v[20:23], v2, s[12:15], s45 offen sc1
L_s_np_239:
    s_branch L_replica
L_rt_226:
    s_add_u32 s70, s70, 1
    s_cmp_lt_u32 s70, 524288
    s_cbranch_scc1 L_s_xl_223
    s_branch L_c_done_1
L_s_w2_224:
    s_cmp_eq_u32 s44, 3
    s_cbranch_scc1 L_s_w3_225
    s_waitcnt lgkmcnt(0)
    v_mfma_f32_16x16x32_bf16 v[16:19], v[64:67], v[64:67], 0
    s_branch L_s_w2_224_b
L_s_w3_225:
    s_sleep 3
    s_branch L_s_w3_225_b
L_s_xf_228:
    v_or_b32 v72, 0xffff, v56
    v_or_b32 v73, 0xffff, v57
    v_or_b32 v74, 0xffff, v58
    v_or_b32 v75, 0xffff, v59
    v_max3_u32 v11, v64, v65, v66
    v_max3_u32 v11, v11, v67, v68
    v_max3_u32 v11, v11, v69, v70
    v_max3_u32 v11, v11, v71, v72
    v_max3_u32 v11, v11, v73, v74
    v_max_u32 v11, v11, v75
    v_cmp_eq_u32 vcc, -1, v11
    s_add_u32 s70, s70, 1
    s_cbranch_vccz L_s_xok_229
    s_cmp_lt_u32 s70, 524288
    s_cbranch_scc1 L_s_xp_227
    s_branch L_c_done_1
L_vf_200:
    s_cmp_eq_u32 s52, 0
    s_cbranch_scc1 L_vs_201
    s_mov_b32 s70, 1
    v_mov_b32 v16, 0
    v_mov_b32 v17, 0
    s_branch L_v_l1m_242
.p2align 6
L_v_loop_240:
    s_mov_b32 s70, 1
    buffer_load_dwordx4 v[64:67], v9, s[12:15], s61 offen offset:0 sc1
    buffer_load_dwordx4 v[68:71], v9, s[12:15], s61 offen offset:1024 sc1
    buffer_load_dwordx4 v[72:75], v9, s[12:15], s61 offen offset:2048 sc1
    buffer_load_dwordx4 v[76:79], v9, s[12:15], s61 offen offset:3072 sc1
    v_mov_b32 v16, 0
    v_mov_b32 v17, 0
    v_mov_b32 v18, 0
    v_mov_b32 v19, 0
    v_mov_b32 v20, 0
    v_mov_b32 v21, 0
    v_mov_b32 v22, 0
    v_mov_b32 v23, 0
L_v_l1m_242:
    s_waitcnt vmcnt(3)
    ds_write_b128 v10, v[64:67] offset:0
    v_max3_u32 v24, v64, v65, v66
    v_max_u32 v24, v24, v67
    v_cmp_eq_u32 s[48:49], -1, v24
    s_waitcnt vmcnt(2)
    ds_write_b128 v10, v[68:71] offset:1024
    v_max3_u32 v24, v68, v69, v70
    v_max_u32 v24, v24, v71
    v_cmp_eq_u32 s[50:51], -1, v24
    s_waitcnt vmcnt(1)
    ds_write_b128 v10, v[72:75] offset:2048
    v_max3_u32 v24, v72, v73, v74
    v_max_u32 v24, v24, v75
    v_cmp_eq_u32 s[52:53], -1, v24
    s_waitcnt vmcnt(0)
    ds_write_b128 v10, v[76:79] offset:3072
    v_max3_u32 v24, v76, v77, v78
    v_max_u32 v24, v24, v79
    v_cmp_eq_u32 s[54:55], -1, v24
    s_or_b64 s[46:47], s[48:49], s[50:51]
    s_or_b64 vcc, s[52:53], s[54:55]
    s_or_b64 vcc, vcc, s[46:47]
    s_cbranch_scc1 L_v_l1_241
L_v_l1ok_243:
    s_waitcnt lgkmcnt(0)
    s_barrier
    v_smfmac_f32_16x16x64_bf16 v[16:19], v[64:67], a[0:7], v3
    v_smfmac_f32_16x16x64_bf16 v[20:23], v[64:67], a[32:39], v3
    v_smfmac_f32_16x16x64_bf16 v[16:19], v[68:71], a[8:15], v3
    v_smfmac_f32_16x16x64_bf16 v[20:23], v[68:71], a[40:47], v3
    v_smfmac_f32_16x16x64_bf16 v[16:19], v[72:75], a[16:23], v3
    v_smfmac_f32_16x16x64_bf16 v[20:23], v[72:75], a[48:55], v3
    v_smfmac_f32_16x16x64_bf16 v[16:19], v[76:79], a[24:31], v3
    v_smfmac_f32_16x16x64_bf16 v[20:23], v[76:79], a[56:63], v3
    s_nop 6
    v_permlane32_swap_b32 v16, v18
    v_permlane32_swap_b32 v17, v19
    v_permlane32_swap_b32 v20, v22
    v_permlane32_swap_b32 v21, v23
    v_add_f32 v16, v16, v18
    v_add_f32 v17, v17, v19
    v_add_f32 v18, v20, v22
    v_add_f32 v19, v21, v23
    ds_write_b128 v14, v[16:19]
    s_mov_b64 exec, 1
    ds_add_u32 v29, v30
    s_mov_b64 exec, -1
    s_add_u32 s58, s58, 4
    s_bitcmp1_b32 s44, 0
    s_cbranch_scc1 L_v_k1_245_c
    s_mov_b32 s70, 0
L_v_rl_246:
    ds_read_b32 v24, v29
    ds_read_b64 v[16:17], v13 offset:0
    ds_read_b64 v[18:19], v13 offset:1024
    ds_read_b64 v[20:21], v13 offset:2048
    ds_read_b64 v[22:23], v13 offset:3072
    s_waitcnt lgkmcnt(2)
    v_cmp_ne_u32 vcc, s58, v24
    v_add_f32 v16, v16, v18
    v_add_f32 v17, v17, v19
    s_waitcnt lgkmcnt(0)
    s_cbranch_vccnz L_rt_247
    v_add_f32 v20, v20, v22
    v_add_f32 v21, v21, v23
    v_add_f32 v16, v16, v20
    v_add_f32 v17, v17, v21
    s_mov_b32 vcc_lo, 0x55555555
    s_mov_b32 vcc_hi, 0x55555555
    v_cndmask_b32_dpp v18, v17, v16, vcc quad_perm:[1,0,3,2] row_mask:0xf bank_mask:0xf
    s_not_b64 vcc, vcc
    v_cndmask_b32_dpp v19, v16, v17, vcc quad_perm:[1,0,3,2] row_mask:0xf bank_mask:0xf
    v_cvt_pk_bf16_f32 v18, v18, v19
    v_min_u32 v18, -2, v18
    buffer_store_dword v18, v4, s[12:15], s62 offen
    ds_write_b32 v5, v18
L_v_k1_245:
    s_cmp_eq_u32 s60, 63
    s_cbranch_scc1 L_v_last_244
    ds_read_b128 v[80:83], v27 offset:32768
    ds_read_b128 v[84:87], v27 offset:36864
    ds_read_b128 v[88:91], v27 offset:40960
    ds_read_b128 v[92:95], v27 offset:45056
    v_mov_b32 v96, 0
    v_mov_b32 v97, 0
    v_mov_b32 v98, 0
    v_mov_b32 v99, 0
    v_mov_b32 v100, 0
    v_mov_b32 v101, 0
    v_mov_b32 v102, 0
    v_mov_b32 v103, 0
    v_mov_b32 v104, 0
    v_mov_b32 v105, 0
    v_mov_b32 v106, 0
    v_mov_b32 v107, 0
    v_mov_b32 v108, 0
    v_mov_b32 v109, 0
    v_mov_b32 v110, 0
    v_mov_b32 v111, 0
    s_bitcmp1_b32 s44, 0
    s_cbranch_scc0 L_v_sv_248
    s_sleep 1
L_v_sv_248:
    s_sleep 3
    s_mov_b32 s70, 1
    buffer_load_dwordx4 v[64:67], v11, s[12:15], s62 offen offset:0 sc1
    buffer_load_dwordx4 v[68:71], v11, s[12:15], s62 offen offset:1024 sc1
L_v_vp_249_m:
    s_waitcnt vmcnt(0)
    v_max3_u32 v20, v64, v65, v66
    v_max3_u32 v20, v20, v67, v68
    v_max3_u32 v20, v20, v69, v70
    v_max_u32 v20, v20, v71
    v_cmp_eq_u32 vcc, -1, v20
    s_cbranch_vccnz L_rt_250
    v_smfmac_f32_16x16x64_bf16 v[96:99], v[64:67], a[64:71], v3
    v_smfmac_f32_16x16x64_bf16 v[96:99], v[68:71], a[72:79], v3
    v_smfmac_f32_16x16x64_bf16 v[100:103], v[64:67], a[80:87], v3
    v_smfmac_f32_16x16x64_bf16 v[100:103], v[68:71], a[88:95], v3
    v_smfmac_f32_16x16x64_bf16 v[104:107], v[64:67], a[96:103], v3
    v_smfmac_f32_16x16x64_bf16 v[104:107], v[68:71], a[104:111], v3
    v_smfmac_f32_16x16x64_bf16 v[108:111], v[64:67], a[112:119], v3
    v_smfmac_f32_16x16x64_bf16 v[108:111], v[68:71], a[120:127], v3
    s_nop 1
    v_cvt_pk_bf16_f32 v96, v96, v97
    v_cvt_pk_bf16_f32 v97, v98, v99
    ds_write_b64 v12, v[96:97] offset:0
    v_cvt_pk_bf16_f32 v100, v100, v101
    v_cvt_pk_bf16_f32 v101, v102, v103
    ds_write_b64 v12, v[100:101] offset:2048
    v_cvt_pk_bf16_f32 v104, v104, v105
    v_cvt_pk_bf16_f32 v105, v106, v107
    ds_write_b64 v12, v[104:105] offset:4096
    v_cvt_pk_bf16_f32 v108, v108, v109
    v_cvt_pk_bf16_f32 v109, v110, v111
    ds_write_b64 v12, v[108:109] offset:6144
    s_bitcmp1_b32 s44, 0
    s_cbranch_scc1 L_v_r8_251
    s_add_u32 s46, s65, 4096
    buffer_load_dwordx4 v[32:35], v15, s[12:15], s65 offen offset:0 sc1
    buffer_load_dwordx4 v[48:51], v15, s[12:15], s46 offen offset:0 sc1
    buffer_load_dwordx4 v[36:39], v15, s[12:15], s65 offen offset:1024 sc1
    buffer_load_dwordx4 v[52:55], v15, s[12:15], s46 offen offset:1024 sc1
    buffer_load_dwordx4 v[40:43], v15, s[12:15], s65 offen offset:2048 sc1
    buffer_load_dwordx4 v[56:59], v15, s[12:15], s46 offen offset:2048 sc1
    buffer_load_dwordx4 v[44:47], v15, s[12:15], s65 offen offset:3072 sc1
    buffer_load_dwordx4 v[60:63], v15, s[12:15], s46 offen offset:3072 sc1
    s_add_u32 s65, s65, 786432
L_v_r8_251:
    s_waitcnt lgkmcnt(0)
    s_barrier
    ds_read_b128 v[96:99], v2 offset:16384
    ds_read_b128 v[100:103], v2 offset:17408
    ds_read_b128 v[104:107], v2 offset:18432
    ds_read_b128 v[108:111], v2 offset:19456
    ds_read_b128 v[112:115], v31 offset:0
    ds_read_b128 v[116:119], v25 offset:0
    ds_read_b128 v[120:123], v31 offset:512
    ds_read_b128 v[124:127], v25 offset:1024
    s_waitcnt lgkmcnt(7)
    v_mfma_f32_16x16x32_bf16 v[16:19], v[80:83], v[96:99], 0
    s_waitcnt lgkmcnt(6)
    v_mfma_f32_16x16x32_bf16 v[16:19], v[84:87], v[100:103], v[16:19]
    s_waitcnt lgkmcnt(5)
    v_mfma_f32_16x16x32_bf16 v[16:19], v[88:91], v[104:107], v[16:19]
    s_waitcnt lgkmcnt(4)
    v_mfma_f32_16x16x32_bf16 v[16:19], v[92:95], v[108:111], v[16:19]
    s_waitcnt lgkmcnt(2)
    v_mfma_f32_16x16x32_bf16 v[16:19], v[116:119], v[112:115], v[16:19]
    s_waitcnt lgkmcnt(0)
    v_mfma_f32_16x16x32_bf16 v[16:19], v[124:127], v[120:123], v[16:19]
    s_mov_b32 exec_lo, 0x00ff00ff
    s_mov_b32 exec_hi, 0x00ff00ff
    s_nop 5
    v_cvt_pk_bf16_f32 v16, v16, v17
    v_cvt_pk_bf16_f32 v17, v18, v19
    v_min_u32 v16, -2, v16
    v_min_u32 v17, -2, v17
    buffer_store_dwordx2 v[16:17], v6, s[12:15], s63 offen sc1
    s_mov_b64 exec, -1
    s_waitcnt vmcnt(1)
    s_sub_u32 s45, s60, 3
    s_cmp_ge_u32 s45, 24
    s_cbranch_scc1 L_v_nx_252_s
    s_cmp_eq_u32 s45, 0
    s_cbranch_scc1 L_v_fl_253
L_v_fl_253_b:
    s_and_b32 s46, s45, 1
    s_lshl_b32 s47, s46, 14
    s_add_u32 s47, s47, s59
    s_lshl_b32 s46, s46, 15
    s_lshr_b32 s48, s45, 2
    s_lshl_b32 s48, s48, 16
    s_add_u32 s46, s46, s48
    s_and_b32 s48, s45, 2
    s_lshl_b32 s48, s48, 7
    s_add_u32 s46, s46, s48
    s_add_u32 m0, s47, 0
    s_add_u32 s48, s46, 0
    buffer_load_dwordx4 v28, s[12:15], s48 offen sc1 lds
    s_add_u32 m0, s47, 1024
    s_add_u32 s48, s46, 2048
    buffer_load_dwordx4 v28, s[12:15], s48 offen sc1 lds
    s_add_u32 m0, s47, 2048
    s_add_u32 s48, s46, 4096
    buffer_load_dwordx4 v28, s[12:15], s48 offen sc1 lds
    s_add_u32 m0, s47, 3072
    s_add_u32 s48, s46, 6144
    buffer_load_dwordx4 v28, s[12:15], s48 offen sc1 lds
L_v_nx_252:
    s_add_u32 s61, s61, 0x4000
    s_and_b32 s61, s61, 0xffff
    s_mov_b32 s70, 1
    s_sleep 5
    buffer_load_dword v96, v7, s[12:15], s63 offen offset:0 sc1
    buffer_load_dword v97, v7, s[12:15], s63 offen offset:256 sc1
    buffer_load_dword v98, v7, s[12:15], s63 offen offset:512 sc1
    buffer_load_dword v99, v7, s[12:15], s63 offen offset:768 sc1
    buffer_load_dword v100, v7, s[12:15], s63 offen offset:1024 sc1
    buffer_load_dword v101, v7, s[12:15], s63 offen offset:1280 sc1
    buffer_load_dword v102, v7, s[12:15], s63 offen offset:1536 sc1
    buffer_load_dword v103, v7, s[12:15], s63 offen offset:1792 sc1
    v_mfma_f32_16x16x32_bf16 v[64:67], v[32:35], a[64:67], 0
    v_mfma_f32_16x16x32_bf16 v[68:71], v[48:51], a[64:67], 0
    v_mfma_f32_16x16x32_bf16 v[64:67], v[36:39], a[68:71], v[64:67]
    v_mfma_f32_16x16x32_bf16 v[68:71], v[52:55], a[68:71], v[68:71]
    v_mfma_f32_16x16x32_bf16 v[64:67], v[40:43], a[72:75], v[64:67]
    v_mfma_f32_16x16x32_bf16 v[68:71], v[56:59], a[72:75], v[68:71]
    v_mfma_f32_16x16x32_bf16 v[64:67], v[44:47], a[76:79], v[64:67]
    v_mfma_f32_16x16x32_bf16 v[68:71], v[60:63], a[76:79], v[68:71]
    v_mfma_f32_16x16x32_bf16 v[72:75], v[32:35], a[80:83], 0
    v_mfma_f32_16x16x32_bf16 v[76:79], v[48:51], a[80:83], 0
    v_mfma_f32_16x16x32_bf16 v[72:75], v[36:39], a[84:87], v[72:75]
    v_mfma_f32_16x16x32_bf16 v[76:79], v[52:55], a[84:87], v[76:79]
    v_mfma_f32_16x16x32_bf16 v[72:75], v[40:43], a[88:91], v[72:75]
    v_mfma_f32_16x16x32_bf16 v[76:79], v[56:59], a[88:91], v[76:79]
    v_mfma_f32_16x16x32_bf16 v[72:75], v[44:47], a[92:95], v[72:75]
    v_mfma_f32_16x16x32_bf16 v[76:79], v[60:63], a[92:95], v[76:79]
    v_cvt_pk_bf16_f32 v64, v64, v65
    v_cvt_pk_bf16_f32 v65, v66, v67
    v_cvt_pk_bf16_f32 v66, v68, v69
    v_cvt_pk_bf16_f32 v67, v70, v71
    ds_write_b128 v10, v[64:67] offset:32768
    v_mfma_f32_16x16x32_bf16 v[80:83], v[32:35], a[96:99], 0
    v_mfma_f32_16x16x32_bf16 v[84:87], v[48:51], a[96:99], 0
    v_mfma_f32_16x16x32_bf16 v[80:83], v[36:39], a[100:103], v[80:83]
    v_mfma_f32_16x16x32_bf16 v[84:87], v[52:55], a[100:103], v[84:87]
    v_mfma_f32_16x16x32_bf16 v[80:83], v[40:43], a[104:107], v[80:83]
    v_mfma_f32_16x16x32_bf16 v[84:87], v[56:59], a[104:107], v[84:87]
    v_mfma_f32_16x16x32_bf16 v[80:83], v[44:47], a[108:111], v[80:83]
    v_mfma_f32_16x16x32_bf16 v[84:87], v[60:63], a[108:111], v[84:87]
    v_cvt_pk_bf16_f32 v72, v72, v73
    v_cvt_pk_bf16_f32 v73, v74, v75
    v_cvt_pk_bf16_f32 v74, v76, v77
    v_cvt_pk_bf16_f32 v75, v78, v79
    ds_write_b128 v10, v[72:75] offset:33792
L_v_gp_254:
    s_waitcnt vmcnt(7)
    v_lshlrev_b32 v20, 16, v96
    v_and_b32 v21, 0xffff0000, v96
    s_waitcnt vmcnt(6)
    v_lshlrev_b32 v22, 16, v97
    v_and_b32 v23, 0xffff0000, v97
    v_add_f32 v20, v20, v22
    v_add_f32 v21, v21, v23
    s_waitcnt vmcnt(5)
    v_lshlrev_b32 v22, 16, v98
    v_and_b32 v23, 0xffff0000, v98
    v_add_f32 v20, v20, v22
    v_add_f32 v21, v21, v23
    s_waitcnt vmcnt(4)
    v_lshlrev_b32 v22, 16, v99
    v_and_b32 v23, 0xffff0000, v99
    v_add_f32 v20, v20, v22
    v_add_f32 v21, v21, v23
    s_waitcnt vmcnt(3)
    v_lshlrev_b32 v22, 16, v100
    v_and_b32 v23, 0xffff0000, v100
    v_add_f32 v20, v20, v22
    v_add_f32 v21, v21, v23
    s_waitcnt vmcnt(2)
    v_lshlrev_b32 v22, 16, v101
    v_and_b32 v23, 0xffff0000, v101
    v_add_f32 v20, v20, v22
    v_add_f32 v21, v21, v23
    s_waitcnt vmcnt(1)
    v_lshlrev_b32 v22, 16, v102
    v_and_b32 v23, 0xffff0000, v102
    v_add_f32 v20, v20, v22
    v_add_f32 v21, v21, v23
    s_waitcnt vmcnt(0)
    v_lshlrev_b32 v22, 16, v103
    v_and_b32 v23, 0xffff0000, v103
    v_add_f32 v20, v20, v22
    v_add_f32 v21, v21, v23
    v_cmp_u_f32 vcc, v20, v21
    v_cvt_pk_bf16_f32 v20, v20, v21
    s_cbranch_vccnz L_v_gf_256
L_v_gok_255:
    buffer_store_dword v20, v8, s[12:15], s61 offen
    s_xor_b32 s45, s61, 0x8000
    buffer_store_dword v26, v8, s[12:15], s45 offen
    s_bitcmp1_b32 s44, 0
    s_cbranch_scc1 L_v_nr_257
    s_xor_b32 s45, s62, 0x4000
    buffer_store_dword v26, v4, s[12:15], s45 offen
L_v_nr_257:
    s_add_u32 s60, s60, 1
    s_add_u32 s62, s62, 0x2000
    s_and_b32 s62, s62, 0x7fff
    s_and_b32 s45, s60, 0x38
    s_bitcmp1_b64 s[66:67], s45
    s_cselect_b32 s45, 8192, 0
    s_lshl_b32 s63, s60, 18
    s_add_u32 s63, s63, s45
    v_mfma_f32_16x16x32_bf16 v[88:91], v[32:35], a[112:115], 0
    v_mfma_f32_16x16x32_bf16 v[92:95], v[48:51], a[112:115], 0
    v_mfma_f32_16x16x32_bf16 v[88:91], v[36:39], a[116:119], v[88:91]
    v_mfma_f32_16x16x32_bf16 v[92:95], v[52:55], a[116:119], v[92:95]
    v_mfma_f32_16x16x32_bf16 v[88:91], v[40:43], a[120:123], v[88:91]
    v_mfma_f32_16x16x32_bf16 v[92:95], v[56:59], a[120:123], v[92:95]
    v_mfma_f32_16x16x32_bf16 v[88:91], v[44:47], a[124:127], v[88:91]
    v_mfma_f32_16x16x32_bf16 v[92:95], v[60:63], a[124:127], v[92:95]
    v_cvt_pk_bf16_f32 v80, v80, v81
    v_cvt_pk_bf16_f32 v81, v82, v83
    v_cvt_pk_bf16_f32 v82, v84, v85
    v_cvt_pk_bf16_f32 v83, v86, v87
    ds_write_b128 v10, v[80:83] offset:34816
    s_nop 2
    v_cvt_pk_bf16_f32 v88, v88, v89
    v_cvt_pk_bf16_f32 v89, v90, v91
    v_cvt_pk_bf16_f32 v90, v92, v93
    v_cvt_pk_bf16_f32 v91, v94, v95
    ds_write_b128 v10, v[88:91] offset:35840
    s_sleep 3
    s_branch L_v_loop_240
L_v_last_244:
    s_waitcnt lgkmcnt(0)
    s_barrier
    s_branch L_replica
L_v_l1_241:
    s_mov_b64 exec, s[48:49]
    s_cbranch_execz L_v_ls_258
    buffer_load_dwordx4 v[64:67], v9, s[12:15], s61 offen offset:0 sc1
L_v_ls_258:
    s_mov_b64 exec, s[50:51]
    s_cbranch_execz L_v_ls_259
    buffer_load_dwordx4 v[68:71], v9, s[12:15], s61 offen offset:1024 sc1
L_v_ls_259:
    s_mov_b64 exec, s[52:53]
    s_cbranch_execz L_v_ls_260
    buffer_load_dwordx4 v[72:75], v9, s[12:15], s61 offen offset:2048 sc1
L_v_ls_260:
    s_mov_b64 exec, s[54:55]
    s_cbranch_execz L_v_ls_261
    buffer_load_dwordx4 v[76:79], v9, s[12:15], s61 offen offset:3072 sc1
L_v_ls_261:
    s_mov_b64 exec, -1
    s_add_u32 s70, s70, 1
    s_cmp_ge_u32 s70, 524288
    s_cbranch_scc1 L_c_done_1
    s_waitcnt vmcnt(0)
    s_cmp_eq_u64 s[48:49], 0
    s_cbranch_scc1 L_v_lc_262
    ds_write_b128 v10, v[64:67] offset:0
    v_max3_u32 v24, v64, v65, v66
    v_max_u32 v24, v24, v67
    v_cmp_eq_u32 s[48:49], -1, v24
L_v_lc_262:
    s_cmp_eq_u64 s[50:51], 0
    s_cbranch_scc1 L_v_lc_263
    ds_write_b128 v10, v[68:71] offset:1024
    v_max3_u32 v24, v68, v69, v70
    v_max_u32 v24, v24, v71
    v_cmp_eq_u32 s[50:51], -1, v24
L_v_lc_263:
    s_cmp_eq_u64 s[52:53], 0
    s_cbranch_scc1 L_v_lc_264
    ds_write_b128 v10, v[72:75] offset:2048
    v_max3_u32 v24, v72, v73, v74
    v_max_u32 v24, v24, v75
    v_cmp_eq_u32 s[52:53], -1, v24
L_v_lc_264:
    s_cmp_eq_u64 s[54:55], 0
    s_cbranch_scc1 L_v_lc_265
    ds_write_b128 v10, v[76:79] offset:3072
    v_max3_u32 v24, v76, v77, v78
    v_max_u32 v24, v24, v79
    v_cmp_eq_u32 s[54:55], -1, v24
L_v_lc_265:
    s_or_b64 s[46:47], s[48:49], s[50:51]
    s_or_b64 vcc, s[52:53], s[54:55]
    s_or_b64 vcc, vcc, s[46:47]
    s_cbranch_scc1 L_v_l1_241
    s_branch L_v_l1ok_243
L_v_k1_245_c:
    s_add_u32 s46, s65, 4096
    buffer_load_dwordx4 v[32:35], v15, s[12:15], s65 offen offset:0 sc1
    buffer_load_dwordx4 v[48:51], v15, s[12:15], s46 offen offset:0 sc1
    buffer_load_dwordx4 v[36:39], v15, s[12:15], s65 offen offset:1024 sc1
    buffer_load_dwordx4 v[52:55], v15, s[12:15], s46 offen offset:1024 sc1
    buffer_load_dwordx4 v[40:43], v15, s[12:15], s65 offen offset:2048 sc1
    buffer_load_dwordx4 v[56:59], v15, s[12:15], s46 offen offset:2048 sc1
    buffer_load_dwordx4 v[44:47], v15, s[12:15], s65 offen offset:3072 sc1
    buffer_load_dwordx4 v[60:63], v15, s[12:15], s46 offen offset:3072 sc1
    s_add_u32 s65, s65, 786432
    s_branch L_v_k1_245
L_rt_247:
    s_add_u32 s70, s70, 1
    s_cmp_lt_u32 s70, 524288
    s_cbranch_scc1 L_v_rl_246
    s_branch L_c_done_1
L_v_vp_249:
    buffer_load_dwordx4 v[64:67], v11, s[12:15], s62 offen offset:0 sc1
    buffer_load_dwordx4 v[68:71], v11, s[12:15], s62 offen offset:1024 sc1
    s_branch L_v_vp_249_m
L_rt_250:
    s_add_u32 s70, s70, 1
    s_cmp_lt_u32 s70, 524288
    s_cbranch_scc1 L_v_vp_249
    s_branch L_c_done_1
L_v_fl_253:
    v_and_b32 v22, 31, v1
    v_lshlrev_b32 v22, 7, v22
    s_mov_b32 s46, 0x109400
    s_mov_b32 s47, 56
    s_mov_b32 s70, 0
L_spin_266:
    buffer_load_dword v23, v22, s[12:15], s46 offen sc1
    s_waitcnt vmcnt(0)
    v_cmp_ge_u32 vcc, s47, v23
    s_add_u32 s70, s70, 1
    s_cbranch_vccz L_spok_267
    s_sleep 3
    s_cmp_lt_u32 s70, 524288
    s_cbranch_scc1 L_spin_266
    s_branch L_c_done_1
L_spok_267:
    s_branch L_v_fl_253_b
L_v_nx_252_s:
    s_sleep 2
    s_branch L_v_nx_252
L_v_gf_256:
    v_max3_u32 v24, v96, v97, v98
    v_max3_u32 v24, v24, v99, v100
    v_max3_u32 v24, v24, v101, v102
    v_max_u32 v24, v24, v103
    v_cmp_eq_u32 vcc, -1, v24
    v_min_u32 v20, -2, v20
    s_add_u32 s70, s70, 1
    s_cbranch_vccz L_v_gok_255
    buffer_load_dword v96, v7, s[12:15], s63 offen offset:0 sc1
    buffer_load_dword v97, v7, s[12:15], s63 offen offset:256 sc1
    buffer_load_dword v98, v7, s[12:15], s63 offen offset:512 sc1
    buffer_load_dword v99, v7, s[12:15], s63 offen offset:768 sc1
    buffer_load_dword v100, v7, s[12:15], s63 offen offset:1024 sc1
    buffer_load_dword v101, v7, s[12:15], s63 offen offset:1280 sc1
    buffer_load_dword v102, v7, s[12:15], s63 offen offset:1536 sc1
    buffer_load_dword v103, v7, s[12:15], s63 offen offset:1792 sc1
    s_cmp_lt_u32 s70, 524288
    s_cbranch_scc1 L_v_gp_254
    s_branch L_c_done_1
L_vs_201:
    s_mov_b32 s70, 1
    v_mov_b32 v16, 0
    v_mov_b32 v17, 0
    s_branch L_v_l1m_270
.p2align 6
L_v_loop_268:
    s_mov_b32 s70, 1
    buffer_load_dwordx4 v[64:67], v9, s[12:15], s61 offen offset:0 sc1
    buffer_load_dwordx4 v[68:71], v9, s[12:15], s61 offen offset:1024 sc1
    buffer_load_dwordx4 v[72:75], v9, s[12:15], s61 offen offset:2048 sc1
    buffer_load_dwordx4 v[76:79], v9, s[12:15], s61 offen offset:3072 sc1
    v_mov_b32 v16, 0
    v_mov_b32 v17, 0
    v_mov_b32 v18, 0
    v_mov_b32 v19, 0
    v_mov_b32 v20, 0
    v_mov_b32 v21, 0
    v_mov_b32 v22, 0
    v_mov_b32 v23, 0
L_v_l1m_270:
    s_waitcnt vmcnt(3)
    ds_write_b128 v10, v[64:67] offset:0
    v_max3_u32 v24, v64, v65, v66
    v_max_u32 v24, v24, v67
    v_cmp_eq_u32 s[48:49], -1, v24
    s_waitcnt vmcnt(2)
    ds_write_b128 v10, v[68:71] offset:1024
    v_max3_u32 v24, v68, v69, v70
    v_max_u32 v24, v24, v71
    v_cmp_eq_u32 s[50:51], -1, v24
    s_waitcnt vmcnt(1)
    ds_write_b128 v10, v[72:75] offset:2048
    v_max3_u32 v24, v72, v73, v74
    v_max_u32 v24, v24, v75
    v_cmp_eq_u32 s[52:53], -1, v24
    s_waitcnt vmcnt(0)
    ds_write_b128 v10, v[76:79] offset:3072
    v_max3_u32 v24, v76, v77, v78
    v_max_u32 v24, v24, v79
    v_cmp_eq_u32 s[54:55], -1, v24
    s_or_b64 s[46:47], s[48:49], s[50:51]
    s_or_b64 vcc, s[52:53], s[54:55]
    s_or_b64 vcc, vcc, s[46:47]
    s_cbranch_scc1 L_v_l1_269
L_v_l1ok_271:
    s_waitcnt lgkmcnt(0)
    s_barrier
    v_smfmac_f32_16x16x64_bf16 v[16:19], v[64:67], a[0:7], v3
    v_smfmac_f32_16x16x64_bf16 v[20:23], v[64:67], a[32:39], v3
    v_smfmac_f32_16x16x64_bf16 v[16:19], v[68:71], a[8:15], v3
    v_smfmac_f32_16x16x64_bf16 v[20:23], v[68:71], a[40:47], v3
    v_smfmac_f32_16x16x64_bf16 v[16:19], v[72:75], a[16:23], v3
    v_smfmac_f32_16x16x64_bf16 v[20:23], v[72:75], a[48:55], v3
    v_smfmac_f32_16x16x64_bf16 v[16:19], v[76:79], a[24:31], v3
    v_smfmac_f32_16x16x64_bf16 v[20:23], v[76:79], a[56:63], v3
    s_nop 6
    v_permlane32_swap_b32 v16, v18
    v_permlane32_swap_b32 v17, v19
    v_permlane32_swap_b32 v20, v22
    v_permlane32_swap_b32 v21, v23
    v_add_f32 v16, v16, v18
    v_add_f32 v17, v17, v19
    v_add_f32 v18, v20, v22
    v_add_f32 v19, v21, v23
    ds_write_b128 v14, v[16:19]
    s_mov_b64 exec, 1
    ds_add_u32 v29, v30
    s_mov_b64 exec, -1
    s_add_u32 s58, s58, 4
    s_bitcmp1_b32 s44, 0
    s_cbranch_scc1 L_v_k1_273_c
    s_mov_b32 s70, 0
L_v_rl_274:
    ds_read_b32 v24, v29
    ds_read_b64 v[16:17], v13 offset:0
    ds_read_b64 v[18:19], v13 offset:1024
    ds_read_b64 v[20:21], v13 offset:2048
    ds_read_b64 v[22:23], v13 offset:3072
    s_waitcnt lgkmcnt(2)
    v_cmp_ne_u32 vcc, s58, v24
    v_add_f32 v16, v16, v18
    v_add_f32 v17, v17, v19
    s_waitcnt lgkmcnt(0)
    s_cbranch_vccnz L_rt_275
    v_add_f32 v20, v20, v22
    v_add_f32 v21, v21, v23
    v_add_f32 v16, v16, v20
    v_add_f32 v17, v17, v21
    s_mov_b32 vcc_lo, 0x55555555
    s_mov_b32 vcc_hi, 0x55555555
    v_cndmask_b32_dpp v18, v17, v16, vcc quad_perm:[1,0,3,2] row_mask:0xf bank_mask:0xf
    s_not_b64 vcc, vcc
    v_cndmask_b32_dpp v19, v16, v17, vcc quad_perm:[1,0,3,2] row_mask:0xf bank_mask:0xf
    v_cvt_pk_bf16_f32 v18, v18, v19
    v_min_u32 v18, -2, v18
    buffer_store_dword v18, v4, s[12:15], s62 offen sc1
    ds_write_b32 v5, v18
L_v_k1_273:
    s_cmp_eq_u32 s60, 63
    s_cbranch_scc1 L_v_last_272
    ds_read_b128 v[80:83], v27 offset:32768
    ds_read_b128 v[84:87], v27 offset:36864
    ds_read_b128 v[88:91], v27 offset:40960
    ds_read_b128 v[92:95], v27 offset:45056
    v_mov_b32 v96, 0
    v_mov_b32 v97, 0
    v_mov_b32 v98, 0
    v_mov_b32 v99, 0
    v_mov_b32 v100, 0
    v_mov_b32 v101, 0
    v_mov_b32 v102, 0
    v_mov_b32 v103, 0
    v_mov_b32 v104, 0
    v_mov_b32 v105, 0
    v_mov_b32 v106, 0
    v_mov_b32 v107, 0
    v_mov_b32 v108, 0
    v_mov_b32 v109, 0
    v_mov_b32 v110, 0
    v_mov_b32 v111, 0
    s_bitcmp1_b32 s44, 0
    s_cbranch_scc0 L_v_sv_276
    s_sleep 1
L_v_sv_276:
    s_sleep 3
    s_mov_b32 s70, 1
    buffer_load_dwordx4 v[64:67], v11, s[12:15], s62 offen offset:0 sc1
    buffer_load_dwordx4 v[68:71], v11, s[12:15], s62 offen offset:1024 sc1
L_v_vp_277_m:
    s_waitcnt vmcnt(0)
    v_max3_u32 v20, v64, v65, v66
    v_max3_u32 v20, v20, v67, v68
    v_max3_u32 v20, v20, v69, v70
    v_max_u32 v20, v20, v71
    v_cmp_eq_u32 vcc, -1, v20
    s_cbranch_vccnz L_rt_278
    v_smfmac_f32_16x16x64_bf16 v[96:99], v[64:67], a[64:71], v3
    v_smfmac_f32_16x16x64_bf16 v[96:99], v[68:71], a[72:79], v3
    v_smfmac_f32_16x16x64_bf16 v[100:103], v[64:67], a[80:87], v3
    v_smfmac_f32_16x16x64_bf16 v[100:103], v[68:71], a[88:95], v3
    v_smfmac_f32_16x16x64_bf16 v[104:107], v[64:67], a[96:103], v3
    v_smfmac_f32_16x16x64_bf16 v[104:107], v[68:71], a[104:111], v3
    v_smfmac_f32_16x16x64_bf16 v[108:111], v[64:67], a[112:119], v3
    v_smfmac_f32_16x16x64_bf16 v[108:111], v[68:71], a[120:127], v3
    s_nop 1
    v_cvt_pk_bf16_f32 v96, v96, v97
    v_cvt_pk_bf16_f32 v97, v98, v99
    ds_write_b64 v12, v[96:97] offset:0
    v_cvt_pk_bf16_f32 v100, v100, v101
    v_cvt_pk_bf16_f32 v101, v102, v103
    ds_write_b64 v12, v[100:101] offset:2048
    v_cvt_pk_bf16_f32 v104, v104, v105
    v_cvt_pk_bf16_f32 v105, v106, v107
    ds_write_b64 v12, v[104:105] offset:4096
    v_cvt_pk_bf16_f32 v108, v108, v109
    v_cvt_pk_bf16_f32 v109, v110, v111
    ds_write_b64 v12, v[108:109] offset:6144
    s_bitcmp1_b32 s44, 0
    s_cbranch_scc1 L_v_r8_279
    s_add_u32 s46, s65, 4096
    buffer_load_dwordx4 v[32:35], v15, s[12:15], s65 offen offset:0 sc1
    buffer_load_dwordx4 v[48:51], v15, s[12:15], s46 offen offset:0 sc1
    buffer_load_dwordx4 v[36:39], v15, s[12:15], s65 offen offset:1024 sc1
    buffer_load_dwordx4 v[52:55], v15, s[12:15], s46 offen offset:1024 sc1
    buffer_load_dwordx4 v[40:43], v15, s[12:15], s65 offen offset:2048 sc1
    buffer_load_dwordx4 v[56:59], v15, s[12:15], s46 offen offset:2048 sc1
    buffer_load_dwordx4 v[44:47], v15, s[12:15], s65 offen offset:3072 sc1
    buffer_load_dwordx4 v[60:63], v15, s[12:15], s46 offen offset:3072 sc1
    s_add_u32 s65, s65, 786432
L_v_r8_279:
    s_waitcnt lgkmcnt(0)
    s_barrier
    ds_read_b128 v[96:99], v2 offset:16384
    ds_read_b128 v[100:103], v2 offset:17408
    ds_read_b128 v[104:107], v2 offset:18432
    ds_read_b128 v[108:111], v2 offset:19456
    ds_read_b128 v[112:115], v31 offset:0
    ds_read_b128 v[116:119], v25 offset:0
    ds_read_b128 v[120:123], v31 offset:512
    ds_read_b128 v[124:127], v25 offset:1024
    s_waitcnt lgkmcnt(7)
    v_mfma_f32_16x16x32_bf16 v[16:19], v[80:83], v[96:99], 0
    s_waitcnt lgkmcnt(6)
    v_mfma_f32_16x16x32_bf16 v[16:19], v[84:87], v[100:103], v[16:19]
    s_waitcnt lgkmcnt(5)
    v_mfma_f32_16x16x32_bf16 v[16:19], v[88:91], v[104:107], v[16:19]
    s_waitcnt lgkmcnt(4)
    v_mfma_f32_16x16x32_bf16 v[16:19], v[92:95], v[108:111], v[16:19]
    s_waitcnt lgkmcnt(2)
    v_mfma_f32_16x16x32_bf16 v[16:19], v[116:119], v[112:115], v[16:19]
    s_waitcnt lgkmcnt(0)
    v_mfma_f32_16x16x32_bf16 v[16:19], v[124:127], v[120:123], v[16:19]
    s_mov_b32 exec_lo, 0x00ff00ff
    s_mov_b32 exec_hi, 0x00ff00ff
    s_nop 5
    v_cvt_pk_bf16_f32 v16, v16, v17
    v_cvt_pk_bf16_f32 v17, v18, v19
    v_min_u32 v16, -2, v16
    v_min_u32 v17, -2, v17
    buffer_store_dwordx2 v[16:17], v6, s[12:15], s63 offen sc1
    s_mov_b64 exec, -1
    s_waitcnt vmcnt(1)
    s_sub_u32 s45, s60, 3
    s_cmp_ge_u32 s45, 24
    s_cbranch_scc1 L_v_nx_280_s
    s_cmp_eq_u32 s45, 0
    s_cbranch_scc1 L_v_fl_281
L_v_fl_281_b:
    s_and_b32 s46, s45, 1
    s_lshl_b32 s47, s46, 14
    s_add_u32 s47, s47, s59
    s_lshl_b32 s46, s46, 15
    s_lshr_b32 s48, s45, 2
    s_lshl_b32 s48, s48, 16
    s_add_u32 s46, s46, s48
    s_and_b32 s48, s45, 2
    s_lshl_b32 s48, s48, 7
    s_add_u32 s46, s46, s48
    s_add_u32 m0, s47, 0
    s_add_u32 s48, s46, 0
    buffer_load_dwordx4 v28, s[12:15], s48 offen sc1 lds
    s_add_u32 m0, s47, 1024
    s_add_u32 s48, s46, 2048
    buffer_load_dwordx4 v28, s[12:15], s48 offen sc1 lds
    s_add_u32 m0, s47, 2048
    s_add_u32 s48, s46, 4096
    buffer_load_dwordx4 v28, s[12:15], s48 offen sc1 lds
    s_add_u32 m0, s47, 3072
    s_add_u32 s48, s46, 6144
    buffer_load_dwordx4 v28, s[12:15], s48 offen sc1 lds
L_v_nx_280:
    s_add_u32 s61, s61, 0x4000
    s_and_b32 s61, s61, 0xffff
    s_mov_b32 s70, 1
    s_sleep 5
    buffer_load_dword v96, v7, s[12:15], s63 offen offset:0 sc1
    buffer_load_dword v97, v7, s[12:15], s63 offen offset:256 sc1
    buffer_load_dword v98, v7, s[12:15], s63 offen offset:512 sc1
    buffer_load_dword v99, v7, s[12:15], s63 offen offset:768 sc1
    buffer_load_dword v100, v7, s[12:15], s63 offen offset:1024 sc1
    buffer_load_dword v101, v7, s[12:15], s63 offen offset:1280 sc1
    buffer_load_dword v102, v7, s[12:15], s63 offen offset:1536 sc1
    buffer_load_dword v103, v7, s[12:15], s63 offen offset:1792 sc1
    v_mfma_f32_16x16x32_bf16 v[64:67], v[32:35], a[64:67], 0
    v_mfma_f32_16x16x32_bf16 v[68:71], v[48:51], a[64:67], 0
    v_mfma_f32_16x16x32_bf16 v[64:67], v[36:39], a[68:71], v[64:67]
    v_mfma_f32_16x16x32_bf16 v[68:71], v[52:55], a[68:71], v[68:71]
    v_mfma_f32_16x16x32_bf16 v[64:67], v[40:43], a[72:75], v[64:67]
    v_mfma_f32_16x16x32_bf16 v[68:71], v[56:59], a[72:75], v[68:71]
    v_mfma_f32_16x16x32_bf16 v[64:67], v[44:47], a[76:79], v[64:67]
    v_mfma_f32_16x16x32_bf16 v[68:71], v[60:63], a[76:79], v[68:71]
    v_mfma_f32_16x16x32_bf16 v[72:75], v[32:35], a[80:83], 0
    v_mfma_f32_16x16x32_bf16 v[76:79], v[48:51], a[80:83], 0
    v_mfma_f32_16x16x32_bf16 v[72:75], v[36:39], a[84:87], v[72:75]
    v_mfma_f32_16x16x32_bf16 v[76:79], v[52:55], a[84:87], v[76:79]
    v_mfma_f32_16x16x32_bf16 v[72:75], v[40:43], a[88:91], v[72:75]
    v_mfma_f32_16x16x32_bf16 v[76:79], v[56:59], a[88:91], v[76:79]
    v_mfma_f32_16x16x32_bf16 v[72:75], v[44:47], a[92:95], v[72:75]
    v_mfma_f32_16x16x32_bf16 v[76:79], v[60:63], a[92:95], v[76:79]
    v_cvt_pk_bf16_f32 v64, v64, v65
    v_cvt_pk_bf16_f32 v65, v66, v67
    v_cvt_pk_bf16_f32 v66, v68, v69
    v_cvt_pk_bf16_f32 v67, v70, v71
    ds_write_b128 v10, v[64:67] offset:32768
    v_mfma_f32_16x16x32_bf16 v[80:83], v[32:35], a[96:99], 0
    v_mfma_f32_16x16x32_bf16 v[84:87], v[48:51], a[96:99], 0
    v_mfma_f32_16x16x32_bf16 v[80:83], v[36:39], a[100:103], v[80:83]
    v_mfma_f32_16x16x32_bf16 v[84:87], v[52:55], a[100:103], v[84:87]
    v_mfma_f32_16x16x32_bf16 v[80:83], v[40:43], a[104:107], v[80:83]
    v_mfma_f32_16x16x32_bf16 v[84:87], v[56:59], a[104:107], v[84:87]
    v_mfma_f32_16x16x32_bf16 v[80:83], v[44:47], a[108:111], v[80:83]
    v_mfma_f32_16x16x32_bf16 v[84:87], v[60:63], a[108:111], v[84:87]
    v_cvt_pk_bf16_f32 v72, v72, v73
    v_cvt_pk_bf16_f32 v73, v74, v75
    v_cvt_pk_bf16_f32 v74, v76, v77
    v_cvt_pk_bf16_f32 v75, v78, v79
    ds_write_b128 v10, v[72:75] offset:33792
L_v_gp_282:
    s_waitcnt vmcnt(7)
    v_lshlrev_b32 v20, 16, v96
    v_and_b32 v21, 0xffff0000, v96
    s_waitcnt vmcnt(6)
    v_lshlrev_b32 v22, 16, v97
    v_and_b32 v23, 0xffff0000, v97
    v_add_f32 v20, v20, v22
    v_add_f32 v21, v21, v23
    s_waitcnt vmcnt(5)
    v_lshlrev_b32 v22, 16, v98
    v_and_b32 v23, 0xffff0000, v98
    v_add_f32 v20, v20, v22
    v_add_f32 v21, v21, v23
    s_waitcnt vmcnt(4)
    v_lshlrev_b32 v22, 16, v99
    v_and_b32 v23, 0xffff0000, v99
    v_add_f32 v20, v20, v22
    v_add_f32 v21, v21, v23
    s_waitcnt vmcnt(3)
    v_lshlrev_b32 v22, 16, v100
    v_and_b32 v23, 0xffff0000, v100
    v_add_f32 v20, v20, v22
    v_add_f32 v21, v21, v23
    s_waitcnt vmcnt(2)
    v_lshlrev_b32 v22, 16, v101
    v_and_b32 v23, 0xffff0000, v101
    v_add_f32 v20, v20, v22
    v_add_f32 v21, v21, v23
    s_waitcnt vmcnt(1)
    v_lshlrev_b32 v22, 16, v102
    v_and_b32 v23, 0xffff0000, v102
    v_add_f32 v20, v20, v22
    v_add_f32 v21, v21, v23
    s_waitcnt vmcnt(0)
    v_lshlrev_b32 v22, 16, v103
    v_and_b32 v23, 0xffff0000, v103
    v_add_f32 v20, v20, v22
    v_add_f32 v21, v21, v23
    v_cmp_u_f32 vcc, v20, v21
    v_cvt_pk_bf16_f32 v20, v20, v21
    s_cbranch_vccnz L_v_gf_284
L_v_gok_283:
    buffer_store_dword v20, v8, s[12:15], s61 offen sc1
    s_xor_b32 s45, s61, 0x8000
    buffer_store_dword v26, v8, s[12:15], s45 offen sc1
    s_bitcmp1_b32 s44, 0
    s_cbranch_scc1 L_v_nr_285
    s_xor_b32 s45, s62, 0x4000
    buffer_store_dword v26, v4, s[12:15], s45 offen sc1
L_v_nr_285:
    s_add_u32 s60, s60, 1
    s_add_u32 s62, s62, 0x2000
    s_and_b32 s62, s62, 0x7fff
    s_and_b32 s45, s60, 0x38
    s_bitcmp1_b64 s[66:67], s45
    s_cselect_b32 s45, 8192, 0
    s_lshl_b32 s63, s60, 18
    s_add_u32 s63, s63, s45
    v_mfma_f32_16x16x32_bf16 v[88:91], v[32:35], a[112:115], 0
    v_mfma_f32_16x16x32_bf16 v[92:95], v[48:51], a[112:115], 0
    v_mfma_f32_16x16x32_bf16 v[88:91], v[36:39], a[116:119], v[88:91]
    v_mfma_f32_16x16x32_bf16 v[92:95], v[52:55], a[116:119], v[92:95]
    v_mfma_f32_16x16x32_bf16 v[88:91], v[40:43], a[120:123], v[88:91]
    v_mfma_f32_16x16x32_bf16 v[92:95], v[56:59], a[120:123], v[92:95]
    v_mfma_f32_16x16x32_bf16 v[88:91], v[44:47], a[124:127], v[88:91]
    v_mfma_f32_16x16x32_bf16 v[92:95], v[60:63], a[124:127], v[92:95]
    v_cvt_pk_bf16_f32 v80, v80, v81
    v_cvt_pk_bf16_f32 v81, v82, v83
    v_cvt_pk_bf16_f32 v82, v84, v85
    v_cvt_pk_bf16_f32 v83, v86, v87
    ds_write_b128 v10, v[80:83] offset:34816
    s_nop 2
    v_cvt_pk_bf16_f32 v88, v88, v89
    v_cvt_pk_bf16_f32 v89, v90, v91
    v_cvt_pk_bf16_f32 v90, v92, v93
    v_cvt_pk_bf16_f32 v91, v94, v95
    ds_write_b128 v10, v[88:91] offset:35840
    s_sleep 3
    s_branch L_v_loop_268
L_v_last_272:
    s_waitcnt lgkmcnt(0)
    s_barrier
    s_branch L_replica
L_v_l1_269:
    s_mov_b64 exec, s[48:49]
    s_cbranch_execz L_v_ls_286
    buffer_load_dwordx4 v[64:67], v9, s[12:15], s61 offen offset:0 sc1
L_v_ls_286:
    s_mov_b64 exec, s[50:51]
    s_cbranch_execz L_v_ls_287
    buffer_load_dwordx4 v[68:71], v9, s[12:15], s61 offen offset:1024 sc1
L_v_ls_287:
    s_mov_b64 exec, s[52:53]
    s_cbranch_execz L_v_ls_288
    buffer_load_dwordx4 v[72:75], v9, s[12:15], s61 offen offset:2048 sc1
L_v_ls_288:
    s_mov_b64 exec, s[54:55]
    s_cbranch_execz L_v_ls_289
    buffer_load_dwordx4 v[76:79], v9, s[12:15], s61 offen offset:3072 sc1
L_v_ls_289:
    s_mov_b64 exec, -1
    s_add_u32 s70, s70, 1
    s_cmp_ge_u32 s70, 524288
    s_cbranch_scc1 L_c_done_1
    s_waitcnt vmcnt(0)
    s_cmp_eq_u64 s[48:49], 0
    s_cbranch_scc1 L_v_lc_290
    ds_write_b128 v10, v[64:67] offset:0
    v_max3_u32 v24, v64, v65, v66
    v_max_u32 v24, v24, v67
    v_cmp_eq_u32 s[48:49], -1, v24
L_v_lc_290:
    s_cmp_eq_u64 s[50:51], 0
    s_cbranch_scc1 L_v_lc_291
    ds_write_b128 v10, v[68:71] offset:1024
    v_max3_u32 v24, v68, v69, v70
    v_max_u32 v24, v24, v71
    v_cmp_eq_u32 s[50:51], -1, v24
L_v_lc_291:
    s_cmp_eq_u64 s[52:53], 0
    s_cbranch_scc1 L_v_lc_292
    ds_write_b128 v10, v[72:75] offset:2048
    v_max3_u32 v24, v72, v73, v74
    v_max_u32 v24, v24, v75
    v_cmp_eq_u32 s[52:53], -1, v24
L_v_lc_292:
    s_cmp_eq_u64 s[54:55], 0
    s_cbranch_scc1 L_v_lc_293
    ds_write_b128 v10, v[76:79] offset:3072
    v_max3_u32 v24, v76, v77, v78
    v_max_u32 v24, v24, v79
    v_cmp_eq_u32 s[54:55], -1, v24
L_v_lc_293:
    s_or_b64 s[46:47], s[48:49], s[50:51]
    s_or_b64 vcc, s[52:53], s[54:55]
    s_or_b64 vcc, vcc, s[46:47]
    s_cbranch_scc1 L_v_l1_269
    s_branch L_v_l1ok_271
L_v_k1_273_c:
    s_add_u32 s46, s65, 4096
    buffer_load_dwordx4 v[32:35], v15, s[12:15], s65 offen offset:0 sc1
    buffer_load_dwordx4 v[48:51], v15, s[12:15], s46 offen offset:0 sc1
    buffer_load_dwordx4 v[36:39], v15, s[12:15], s65 offen offset:1024 sc1
    buffer_load_dwordx4 v[52:55], v15, s[12:15], s46 offen offset:1024 sc1
    buffer_load_dwordx4 v[40:43], v15, s[12:15], s65 offen offset:2048 sc1
    buffer_load_dwordx4 v[56:59], v15, s[12:15], s46 offen offset:2048 sc1
    buffer_load_dwordx4 v[44:47], v15, s[12:15], s65 offen offset:3072 sc1
    buffer_load_dwordx4 v[60:63], v15, s[12:15], s46 offen offset:3072 sc1
    s_add_u32 s65, s65, 786432
    s_branch L_v_k1_273
L_rt_275:
    s_add_u32 s70, s70, 1
    s_cmp_lt_u32 s70, 524288
    s_cbranch_scc1 L_v_rl_274
    s_branch L_c_done_1
L_v_vp_277:
    buffer_load_dwordx4 v[64:67], v11, s[12:15], s62 offen offset:0 sc1
    buffer_load_dwordx4 v[68:71], v11, s[12:15], s62 offen offset:1024 sc1
    s_branch L_v_vp_277_m
L_rt_278:
    s_add_u32 s70, s70, 1
    s_cmp_lt_u32 s70, 524288
    s_cbranch_scc1 L_v_vp_277
    s_branch L_c_done_1
L_v_fl_281:
    v_and_b32 v22, 31, v1
    v_lshlrev_b32 v22, 7, v22
    s_mov_b32 s46, 0x109400
    s_mov_b32 s47, 56
    s_mov_b32 s70, 0
L_spin_294:
    buffer_load_dword v23, v22, s[12:15], s46 offen sc1
    s_waitcnt vmcnt(0)
    v_cmp_ge_u32 vcc, s47, v23
    s_add_u32 s70, s70, 1
    s_cbranch_vccz L_spok_295
    s_sleep 3
    s_cmp_lt_u32 s70, 524288
    s_cbranch_scc1 L_spin_294
    s_branch L_c_done_1
L_spok_295:
    s_branch L_v_fl_281_b
L_v_nx_280_s:
    s_sleep 2
    s_branch L_v_nx_280
L_v_gf_284:
    v_max3_u32 v24, v96, v97, v98
    v_max3_u32 v24, v24, v99, v100
    v_max3_u32 v24, v24, v101, v102
    v_max_u32 v24, v24, v103
    v_cmp_eq_u32 vcc, -1, v24
    v_min_u32 v20, -2, v20
    s_add_u32 s70, s70, 1
    s_cbranch_vccz L_v_gok_283
    buffer_load_dword v96, v7, s[12:15], s63 offen offset:0 sc1
    buffer_load_dword v97, v7, s[12:15], s63 offen offset:256 sc1
    buffer_load_dword v98, v7, s[12:15], s63 offen offset:512 sc1
    buffer_load_dword v99, v7, s[12:15], s63 offen offset:768 sc1
    buffer_load_dword v100, v7, s[12:15], s63 offen offset:1024 sc1
    buffer_load_dword v101, v7, s[12:15], s63 offen offset:1280 sc1
    buffer_load_dword v102, v7, s[12:15], s63 offen offset:1536 sc1
    buffer_load_dword v103, v7, s[12:15], s63 offen offset:1792 sc1
    s_cmp_lt_u32 s70, 524288
    s_cbranch_scc1 L_v_gp_282
    s_branch L_c_done_1
L_c_done_1:
    s_endpgm
.section .rodata,"a"
.p2align 6
.amdhsa_kernel k3_chain_kernel
  .amdhsa_next_free_vgpr 256
  .amdhsa_next_free_sgpr 102
  .amdhsa_accum_offset 128
  .amdhsa_group_segment_fixed_size 0
  .amdhsa_kernarg_size 136
  .amdhsa_user_sgpr_count 2
  .amdhsa_user_sgpr_kernarg_segment_ptr 1
  .amdhsa_system_sgpr_workgroup_id_x 1
.end_amdhsa_kernel
```

```asm
; @launch kernel=k3_chain_kernel grid=(256,1,1) block=(512,1,1) lds=147712
.amdgcn_target "amdgcn-amd-amdhsa--gfx950"
.text
.globl k3_chain_kernel
.p2align 8
.type k3_chain_kernel,@function
k3_chain_kernel:
    s_cmp_ge_u32 s2, 256
    s_cbranch_scc1 L_c_done_1
    s_load_dwordx4 s[20:23], s[0:1], 120
    v_and_b32 v1, 63, v0
    v_lshrrev_b32 v2, 6, v0
    s_nop 0
    v_readfirstlane_b32 s44, v2
    s_waitcnt lgkmcnt(0)
    s_mov_b32 s12, s22
    s_and_b32 s13, s23, 0xffff
    s_mov_b32 s14, 0x10000000
    s_mov_b32 s15, 0x00020000
    s_mov_b32 s16, s20
    s_and_b32 s17, s21, 0xffff
    s_mov_b32 s18, 0x100
    s_mov_b32 s19, 0x00020000
    s_getpc_b64 s[24:25]
L_c_here_2:
    v_lshlrev_b32 v3, 7, v0
    v_mov_b32 v5, s25
    v_add_co_u32 v4, vcc, s24, v3
    s_nop 1
    v_addc_co_u32 v5, vcc, 0, v5, vcc
    v_cmp_gt_u32 vcc, L_c_done_1 - L_c_here_2, v3
    s_and_saveexec_b64 s[26:27], vcc
    s_cbranch_execz L_c_ct_3
    global_load_dword v109, v[4:5], off
L_c_ct_3:
    s_mov_b64 exec, s[26:27]
    s_load_dwordx4 s[8:11], s[0:1], 96
    v_lshrrev_b32 v5, 3, v0
    v_mul_u32_u24 v6, 24576, v5
    v_and_b32 v7, 7, v0
    v_lshl_add_u32 v6, v7, 4, v6
    v_add_u32 v7, 12288, v6
    v_lshlrev_b32 v5, 2, v5
    s_lshr_b32 s50, s2, 5
    s_and_b32 s51, s2, 31
    s_mul_i32 s52, s50, 1572864
    s_lshl_b32 s53, s51, 7
    s_add_u32 s52, s52, s53
    s_lshl_b32 s53, s50, 8
    s_waitcnt lgkmcnt(0)
    s_mov_b32 s28, s10
    s_and_b32 s29, s11, 0xffff
    s_mov_b32 s30, 0xc00000
    s_mov_b32 s31, 0x00020000
    s_mov_b32 s32, s8
    s_and_b32 s33, s9, 0xffff
    s_mov_b32 s34, 0x800
    s_mov_b32 s35, 0x00020000
    buffer_load_dword v8, v5, s[32:35], s53 offen
    buffer_load_dwordx4 v[12:15], v6, s[28:31], s52 offen nt
    buffer_load_dwordx4 v[16:19], v7, s[28:31], s52 offen nt
    s_getreg_b32 s39, hwreg(HW_REG_XCC_ID)
    s_and_b32 s39, s39, 7
    s_cmp_lg_u32 s44, 1
    s_cbranch_scc1 L_nz_7
    v_mov_b32 v32, 0
    v_mov_b32 v33, 0
    v_mov_b32 v34, 0
    v_mov_b32 v35, 0
    v_lshlrev_b32 v4, 4, v1
    s_lshl_b32 s45, s2, 10
    s_add_u32 s45, s45, 0x100000
    buffer_store_dwordx4 v[32:35], v4, s[12:15], s45 offen sc1
L_nz_7:
    s_waitcnt vmcnt(0)
    v_lshlrev_b32 v9, 16, v8
    v_and_b32 v10, 0xffff0000, v8
    v_mul_f32 v20, 0xbfb8aa3b, v9
    v_mul_f32 v21, 0xbfb8aa3b, v10
    v_exp_f32 v20, v20
    v_exp_f32 v21, v21
    s_nop 0
    v_add_f32 v20, 1.0, v20
    v_add_f32 v21, 1.0, v21
    v_rcp_f32 v20, v20
    v_rcp_f32 v21, v21
    s_nop 0
    v_mul_f32 v9, v9, v20
    v_mul_f32 v10, v10, v21
    v_cvt_pk_bf16_f32 v9, 0, v9
    v_cvt_pk_bf16_f32 v10, 0, v10
    v_lshlrev_b32 v28, 16, v12
    v_and_b32 v29, 0xffff0000, v12
    v_lshlrev_b32 v30, 16, v16
    v_and_b32 v31, 0xffff0000, v16
    v_mul_f32 v20, v28, v9
    v_mul_f32 v21, v29, v9
    v_fmac_f32 v20, v30, v10
    v_fmac_f32 v21, v31, v10
    v_lshlrev_b32 v28, 16, v13
    v_and_b32 v29, 0xffff0000, v13
    v_lshlrev_b32 v30, 16, v17
    v_and_b32 v31, 0xffff0000, v17
    v_mul_f32 v22, v28, v9
    v_mul_f32 v23, v29, v9
    v_fmac_f32 v22, v30, v10
    v_fmac_f32 v23, v31, v10
    v_lshlrev_b32 v28, 16, v14
    v_and_b32 v29, 0xffff0000, v14
    v_lshlrev_b32 v30, 16, v18
    v_and_b32 v31, 0xffff0000, v18
    v_mul_f32 v24, v28, v9
    v_mul_f32 v25, v29, v9
    v_fmac_f32 v24, v30, v10
    v_fmac_f32 v25, v31, v10
    v_lshlrev_b32 v28, 16, v15
    v_and_b32 v29, 0xffff0000, v15
    v_lshlrev_b32 v30, 16, v19
    v_and_b32 v31, 0xffff0000, v19
    v_mul_f32 v26, v28, v9
    v_mul_f32 v27, v29, v9
    v_fmac_f32 v26, v30, v10
    v_fmac_f32 v27, v31, v10
    s_nop 1
    v_add_f32_dpp v20, v20, v20 row_ror:8 row_mask:0xf bank_mask:0xf
    v_add_f32_dpp v21, v21, v21 row_ror:8 row_mask:0xf bank_mask:0xf
    v_add_f32_dpp v22, v22, v22 row_ror:8 row_mask:0xf bank_mask:0xf
    v_add_f32_dpp v23, v23, v23 row_ror:8 row_mask:0xf bank_mask:0xf
    v_add_f32_dpp v24, v24, v24 row_ror:8 row_mask:0xf bank_mask:0xf
    v_add_f32_dpp v25, v25, v25 row_ror:8 row_mask:0xf bank_mask:0xf
    v_add_f32_dpp v26, v26, v26 row_ror:8 row_mask:0xf bank_mask:0xf
    v_add_f32_dpp v27, v27, v27 row_ror:8 row_mask:0xf bank_mask:0xf
    s_nop 1
    v_permlane16_swap_b32 v20, v24
    v_permlane16_swap_b32 v21, v25
    v_permlane16_swap_b32 v22, v26
    v_permlane16_swap_b32 v23, v27
    v_add_f32 v20, v20, v24
    v_add_f32 v21, v21, v25
    v_add_f32 v22, v22, v26
    v_add_f32 v23, v23, v27
    s_nop 1
    v_permlane32_swap_b32 v20, v22
    v_permlane32_swap_b32 v21, v23
    v_add_f32 v20, v20, v22
    v_add_f32 v21, v21, v23
    v_and_b32 v22, 7, v1
    v_lshlrev_b32 v22, 5, v22
    v_bfe_u32 v23, v1, 4, 1
    v_lshl_add_u32 v22, v23, 4, v22
    v_lshrrev_b32 v23, 5, v1
    v_lshl_add_u32 v22, v23, 3, v22
    s_lshl_b32 s52, s44, 8
    s_add_u32 s52, s52, 139776
    v_add_u32 v22, s52, v22
    ds_write_b64 v22, v[20:21]
    s_waitcnt lgkmcnt(0)
    s_barrier
    s_cmp_lg_u32 s44, 1
    s_cbranch_scc1 L_m1_8
    v_lshlrev_b32 v22, 2, v1
    v_add_u32 v23, 139776, v22
    ds_read_b32 v24, v23 offset:0
    ds_read_b32 v25, v23 offset:256
    ds_read_b32 v26, v23 offset:512
    ds_read_b32 v27, v23 offset:768
    ds_read_b32 v28, v23 offset:1024
    ds_read_b32 v29, v23 offset:1280
    ds_read_b32 v30, v23 offset:1536
    ds_read_b32 v31, v23 offset:1792
    s_waitcnt lgkmcnt(0)
    v_add_f32 v24, v24, v28
    v_add_f32 v25, v25, v29
    v_add_f32 v26, v26, v30
    v_add_f32 v27, v27, v31
    v_add_f32 v24, v24, v26
    v_add_f32 v25, v25, v27
    v_add_f32 v24, v24, v25
    s_lshl_b32 s52, s2, 8
    s_add_u32 s52, s52, 0x10000
    buffer_store_dword v24, v22, s[12:15], s52 offen sc1
L_m1_8:
    s_cmp_lg_u32 s44, 1
    s_cbranch_scc1 L_tk_4
    v_mov_b32 v3, 1
    s_mov_b32 s40, s39
    s_lshl_b32 s45, s40, 5
    v_mov_b32 v4, 0
    s_waitcnt vmcnt(0)
    s_mov_b64 exec, 1
    buffer_atomic_add v3, v4, s[16:19], s45 offen sc0
    s_waitcnt vmcnt(0)
    v_readfirstlane_b32 s41, v3
    s_nop 3
    s_cmp_lt_u32 s41, 32
    s_cbranch_scc1 L_got_5
    v_mov_b32 v3, 1
    buffer_atomic_add v3, v4, s[16:19], 0 offen offset:16 sc0
    s_waitcnt vmcnt(0)
    v_readfirstlane_b32 s46, v3
    s_mov_b64 exec, -1
    v_and_b32 v4, 7, v1
    v_lshlrev_b32 v4, 5, v4
    s_mov_b32 s70, 0
L_sp_6:
    s_sleep 8
    buffer_load_dword v3, v4, s[16:19], 0 offen sc1
    s_waitcnt vmcnt(0)
    s_mov_b32 s48, 0
    v_readlane_b32 s50, v3, 0
    v_readlane_b32 s51, v3, 1
    v_readlane_b32 s52, v3, 2
    v_readlane_b32 s53, v3, 3
    v_readlane_b32 s54, v3, 4
    v_readlane_b32 s55, v3, 5
    v_readlane_b32 s56, v3, 6
    v_readlane_b32 s57, v3, 7
    s_nop 3
    s_add_u32 s48, s48, s50
    s_add_u32 s48, s48, s51
    s_add_u32 s48, s48, s52
    s_add_u32 s48, s48, s53
    s_add_u32 s48, s48, s54
    s_add_u32 s48, s48, s55
    s_add_u32 s48, s48, s56
    s_add_u32 s48, s48, s57
    s_add_u32 s70, s70, 1
    s_cmp_ge_u32 s70, 524288
    s_cbranch_scc1 L_c_done_1
    s_cmp_lt_u32 s48, 256
    s_cbranch_scc1 L_sp_6
    s_min_u32 s48, s50, 32
    s_mov_b32 s40, 0
    s_add_u32 s41, s48, s46
    s_cmp_lt_u32 s41, 32
    s_cbranch_scc1 L_got_5
    s_sub_u32 s46, s41, 32
    s_min_u32 s48, s51, 32
    s_mov_b32 s40, 1
    s_add_u32 s41, s48, s46
    s_cmp_lt_u32 s41, 32
    s_cbranch_scc1 L_got_5
    s_sub_u32 s46, s41, 32
    s_min_u32 s48, s52, 32
    s_mov_b32 s40, 2
    s_add_u32 s41, s48, s46
    s_cmp_lt_u32 s41, 32
    s_cbranch_scc1 L_got_5
    s_sub_u32 s46, s41, 32
    s_min_u32 s48, s53, 32
    s_mov_b32 s40, 3
    s_add_u32 s41, s48, s46
    s_cmp_lt_u32 s41, 32
    s_cbranch_scc1 L_got_5
    s_sub_u32 s46, s41, 32
    s_min_u32 s48, s54, 32
    s_mov_b32 s40, 4
    s_add_u32 s41, s48, s46
    s_cmp_lt_u32 s41, 32
    s_cbranch_scc1 L_got_5
    s_sub_u32 s46, s41, 32
    s_min_u32 s48, s55, 32
    s_mov_b32 s40, 5
    s_add_u32 s41, s48, s46
    s_cmp_lt_u32 s41, 32
    s_cbranch_scc1 L_got_5
    s_sub_u32 s46, s41, 32
    s_min_u32 s48, s56, 32
    s_mov_b32 s40, 6
    s_add_u32 s41, s48, s46
    s_cmp_lt_u32 s41, 32
    s_cbranch_scc1 L_got_5
    s_sub_u32 s46, s41, 32
    s_min_u32 s48, s57, 32
    s_mov_b32 s40, 7
    s_add_u32 s41, s48, s46
    s_cmp_lt_u32 s41, 32
    s_cbranch_scc1 L_got_5
    s_sub_u32 s46, s41, 32
    s_branch L_c_done_1
L_got_5:
    s_mov_b64 exec, -1
    s_lshl_b32 s45, s40, 8
    s_or_b32 s45, s45, s41
    v_mov_b32 v3, s45
    v_mov_b32 v4, 147464
    ds_write_b32 v4, v3
    s_waitcnt lgkmcnt(0)
L_tk_4:
    s_barrier
    v_mov_b32 v4, 147464
    ds_read_b32 v3, v4
    s_waitcnt lgkmcnt(0)
    v_readfirstlane_b32 s45, v3
    s_nop 3
    s_lshr_b32 s40, s45, 8
    s_and_b32 s41, s45, 0xff
    s_lshr_b32 s45, s40, 2
    s_xor_b32 s45, s45, 1
    s_lshl_b32 s45, s45, 4
    s_and_b32 s40, s40, 3
    s_lshl_b32 s40, s40, 1
    s_lshr_b32 s46, s41, 4
    s_add_u32 s40, s40, s46
    s_and_b32 s41, s41, 15
    s_add_u32 s41, s41, s45
    s_cmp_lt_u32 s41, 16
    s_cbranch_scc1 L_c_chain_9
    s_sub_u32 s48, s41, 16
    s_cmp_lt_u32 s48, 12
    s_cbranch_scc1 L_w_g_10
    s_and_b32 s42, s48, 3
    s_mov_b32 s43, s40
    s_load_dwordx2 s[4:5], s[0:1], 0
    v_lshlrev_b32 v2, 4, v1
    v_lshlrev_b32 v3, 5, v1
    s_lshl_b32 s55, s43, 2
    s_add_u32 s55, s55, s42
    s_waitcnt lgkmcnt(0)
    s_mov_b32 s24, s4
    s_and_b32 s25, s5, 0xffff
    s_mov_b32 s26, 0x400000
    s_mov_b32 s27, 0x00020000
    s_lshl_b32 s46, s42, 3
    s_add_u32 s46, s46, s44
    s_lshl_b32 s46, s46, 11
    v_add_u32 v7, s46, v2
    s_lshl_b32 s63, s43, 16
    buffer_load_dwordx4 a[0:3], v7, s[24:27], s63 offen
    buffer_load_dwordx4 a[4:7], v7, s[24:27], s63 offen offset:1024
    s_cmp_lg_u32 s44, 0
    s_cbranch_scc1 L_zwok_19
    v_and_b32 v8, 7, v1
    v_lshlrev_b32 v8, 5, v8
    s_mov_b32 s70, 0
L_zw_18:
    buffer_load_dword v9, v8, s[16:19], 0 offen sc1
    s_waitcnt vmcnt(0)
    v_add_u32_dpp v9, v9, v9 row_ror:1 row_mask:0xf bank_mask:0xf
    s_nop 1
    v_add_u32_dpp v9, v9, v9 row_ror:2 row_mask:0xf bank_mask:0xf
    s_nop 1
    v_add_u32_dpp v9, v9, v9 row_ror:4 row_mask:0xf bank_mask:0xf
    v_cmp_ne_u32 vcc, 0x100, v9
    s_add_u32 s70, s70, 1
    s_cbranch_vccz L_zwok_19
    s_sleep 4
    s_cmp_lt_u32 s70, 524288
    s_cbranch_scc1 L_zw_18
    s_branch L_c_done_1
L_zwok_19:
    s_barrier
    v_lshlrev_b32 v4, 4, v0
    s_mov_b32 s46, 0x10000
    buffer_load_dwordx4 v[32:35], v4, s[12:15], s46 offen sc1
    s_mov_b32 s46, 0x12000
    buffer_load_dwordx4 v[36:39], v4, s[12:15], s46 offen sc1
    s_mov_b32 s46, 0x14000
    buffer_load_dwordx4 v[40:43], v4, s[12:15], s46 offen sc1
    s_mov_b32 s46, 0x16000
    buffer_load_dwordx4 v[44:47], v4, s[12:15], s46 offen sc1
    s_mov_b32 s46, 0x18000
    buffer_load_dwordx4 v[48:51], v4, s[12:15], s46 offen sc1
    s_mov_b32 s46, 0x1a000
    buffer_load_dwordx4 v[52:55], v4, s[12:15], s46 offen sc1
    s_mov_b32 s46, 0x1c000
    buffer_load_dwordx4 v[56:59], v4, s[12:15], s46 offen sc1
    s_mov_b32 s46, 0x1e000
    buffer_load_dwordx4 v[60:63], v4, s[12:15], s46 offen sc1
    s_cmp_lg_u32 s44, 0
    s_cbranch_scc1 L_l_nx_20
    s_cmp_ge_u32 s42, 2
    s_cbranch_scc1 L_l_nx_20
    s_or_b32 s47, s39, 0x100
    v_mov_b32 v8, s47
    v_mov_b32 v9, 0
    s_lshl_b32 s46, s40, 3
    s_lshl_b32 s47, s42, 2
    s_add_u32 s46, s46, s47
    s_add_u32 s46, s46, 0x101200
    s_mov_b64 exec, 1
    buffer_store_dword v8, v9, s[12:15], s46 offen sc1
    s_mov_b64 exec, -1
L_l_nx_20:
    s_mul_i32 s46, s44, 2064
    s_add_u32 s46, s46, 32768
    v_add_u32 v10, s46, v2
    v_and_b32 v11, 7, v1
    v_lshrrev_b32 v12, 3, v1
    v_mul_u32_u24 v13, 2064, v11
    v_lshl_add_u32 v13, v12, 4, v13
    s_lshl_b32 s46, s44, 8
    s_add_u32 s46, s46, 32768
    v_add_u32 v13, s46, v13
    v_lshlrev_b32 v11, 4, v11
    v_lshl_add_u32 v11, v12, 9, v11
    s_lshl_b32 s46, s44, 13
    s_lshl_b32 s47, s42, 7
    s_add_u32 s46, s46, s47
    s_add_u32 s46, s46, 0x400000
    v_add_u32 v11, s46, v11
    v_add_u32 v12, 4096, v11
    s_lshl_b32 s52, s43, 9
    s_lshl_b32 s47, s42, 7
    s_add_u32 s52, s52, s47
    s_add_u32 s52, s52, 0x109400
    s_mov_b32 s60, s43
    s_waitcnt vmcnt(0)
    v_add_f32 v32, v32, v48
    v_add_f32 v33, v33, v49
    v_add_f32 v34, v34, v50
    v_add_f32 v35, v35, v51
    v_add_f32 v36, v36, v52
    v_add_f32 v37, v37, v53
    v_add_f32 v38, v38, v54
    v_add_f32 v39, v39, v55
    v_add_f32 v40, v40, v56
    v_add_f32 v41, v41, v57
    v_add_f32 v42, v42, v58
    v_add_f32 v43, v43, v59
    v_add_f32 v44, v44, v60
    v_add_f32 v45, v45, v61
    v_add_f32 v46, v46, v62
    v_add_f32 v47, v47, v63
    v_add_f32 v32, v32, v40
    v_add_f32 v33, v33, v41
    v_add_f32 v34, v34, v42
    v_add_f32 v35, v35, v43
    v_add_f32 v36, v36, v44
    v_add_f32 v37, v37, v45
    v_add_f32 v38, v38, v46
    v_add_f32 v39, v39, v47
    v_add_f32 v32, v32, v36
    v_add_f32 v33, v33, v37
    v_add_f32 v34, v34, v38
    v_add_f32 v35, v35, v39
    v_cvt_pk_bf16_f32 v32, 0, v32
    v_cvt_pk_bf16_f32 v33, 0, v33
    v_cvt_pk_bf16_f32 v34, 0, v34
    v_cvt_pk_bf16_f32 v35, 0, v35
    ds_write_b128 v4, v[32:35]
    s_waitcnt lgkmcnt(0)
    s_barrier
    ds_read_b128 v[48:51], v3 offset:0
    ds_read_b128 v[52:55], v3 offset:16
    ds_read_b128 v[56:59], v3 offset:2048
    ds_read_b128 v[60:63], v3 offset:2064
    ds_read_b128 v[32:35], v3 offset:4096
    ds_read_b128 v[36:39], v3 offset:4112
    ds_read_b128 v[40:43], v3 offset:6144
    ds_read_b128 v[44:47], v3 offset:6160
    s_waitcnt lgkmcnt(0)
    v_add_f32 v32, 1.0, v32
    v_add_f32 v33, 1.0, v33
    v_add_f32 v34, 1.0, v34
    v_add_f32 v35, 1.0, v35
    v_add_f32 v36, 1.0, v36
    v_add_f32 v37, 1.0, v37
    v_add_f32 v38, 1.0, v38
    v_add_f32 v39, 1.0, v39
    v_add_f32 v40, 1.0, v40
    v_add_f32 v41, 1.0, v41
    v_add_f32 v42, 1.0, v42
    v_add_f32 v43, 1.0, v43
    v_add_f32 v44, 1.0, v44
    v_add_f32 v45, 1.0, v45
    v_add_f32 v46, 1.0, v46
    v_add_f32 v47, 1.0, v47
    v_cvt_pk_bf16_f32 v32, 0, v32
    v_cvt_pk_bf16_f32 v33, 0, v33
    v_cvt_pk_bf16_f32 v34, 0, v34
    v_cvt_pk_bf16_f32 v35, 0, v35
    v_cvt_pk_bf16_f32 v36, 0, v36
    v_cvt_pk_bf16_f32 v37, 0, v37
    v_cvt_pk_bf16_f32 v38, 0, v38
    v_cvt_pk_bf16_f32 v39, 0, v39
    v_cvt_pk_bf16_f32 v40, 0, v40
    v_cvt_pk_bf16_f32 v41, 0, v41
    v_cvt_pk_bf16_f32 v42, 0, v42
    v_cvt_pk_bf16_f32 v43, 0, v43
    v_cvt_pk_bf16_f32 v44, 0, v44
    v_cvt_pk_bf16_f32 v45, 0, v45
    v_cvt_pk_bf16_f32 v46, 0, v46
    v_cvt_pk_bf16_f32 v47, 0, v47
L_l_sub_21:
    s_lshl_b32 s63, s60, 16
    v_accvgpr_read_b32 v96, a0
    v_accvgpr_read_b32 v97, a1
    v_accvgpr_read_b32 v98, a2
    v_accvgpr_read_b32 v99, a3
    v_accvgpr_read_b32 v100, a4
    v_accvgpr_read_b32 v101, a5
    v_accvgpr_read_b32 v102, a6
    v_accvgpr_read_b32 v103, a7
    v_lshlrev_b32 v64, 16, v96
    v_and_b32 v65, 0xffff0000, v96
    v_lshlrev_b32 v66, 16, v97
    v_and_b32 v67, 0xffff0000, v97
    v_lshlrev_b32 v68, 16, v98
    v_and_b32 v69, 0xffff0000, v98
    v_lshlrev_b32 v70, 16, v99
    v_and_b32 v71, 0xffff0000, v99
    v_lshlrev_b32 v72, 16, v100
    v_and_b32 v73, 0xffff0000, v100
    v_lshlrev_b32 v74, 16, v101
    v_and_b32 v75, 0xffff0000, v101
    v_lshlrev_b32 v76, 16, v102
    v_and_b32 v77, 0xffff0000, v102
    v_lshlrev_b32 v78, 16, v103
    v_and_b32 v79, 0xffff0000, v103
    v_pk_add_f32 v[80:81], v[64:65], v[72:73]
    v_pk_add_f32 v[82:83], v[66:67], v[74:75]
    v_pk_add_f32 v[84:85], v[68:69], v[76:77]
    v_pk_add_f32 v[86:87], v[70:71], v[78:79]
    v_pk_add_f32 v[80:81], v[80:81], v[84:85]
    v_pk_add_f32 v[82:83], v[82:83], v[86:87]
    v_pk_add_f32 v[80:81], v[80:81], v[82:83]
    v_add_f32 v14, v80, v81
    s_nop 1
    v_add_f32_dpp v14, v14, v14 row_shr:1 row_mask:0xf bank_mask:0xf bound_ctrl:0
    s_nop 1
    v_add_f32_dpp v14, v14, v14 row_shr:2 row_mask:0xf bank_mask:0xf bound_ctrl:0
    s_nop 1
    v_add_f32_dpp v14, v14, v14 row_shr:4 row_mask:0xf bank_mask:0xf bound_ctrl:0
    s_nop 1
    v_add_f32_dpp v14, v14, v14 row_shr:8 row_mask:0xf bank_mask:0xf bound_ctrl:0
    s_nop 1
    v_add_f32_dpp v14, v14, v14 row_bcast:15 row_mask:0xa bank_mask:0xf
    s_nop 1
    v_add_f32_dpp v14, v14, v14 row_bcast:31 row_mask:0xc bank_mask:0xf
    s_nop 1
    v_readlane_b32 s46, v14, 63
    s_nop 1
    v_mov_b32 v15, s46
    v_mul_f32 v15, 0x3a800000, v15
    v_pk_add_f32 v[80:81], v[64:65], v[14:15] op_sel:[0,1] op_sel_hi:[1,1] neg_lo:[0,1] neg_hi:[0,1]
    v_pk_add_f32 v[82:83], v[66:67], v[14:15] op_sel:[0,1] op_sel_hi:[1,1] neg_lo:[0,1] neg_hi:[0,1]
    v_pk_add_f32 v[84:85], v[68:69], v[14:15] op_sel:[0,1] op_sel_hi:[1,1] neg_lo:[0,1] neg_hi:[0,1]
    v_pk_add_f32 v[86:87], v[70:71], v[14:15] op_sel:[0,1] op_sel_hi:[1,1] neg_lo:[0,1] neg_hi:[0,1]
    v_pk_add_f32 v[88:89], v[72:73], v[14:15] op_sel:[0,1] op_sel_hi:[1,1] neg_lo:[0,1] neg_hi:[0,1]
    v_pk_add_f32 v[90:91], v[74:75], v[14:15] op_sel:[0,1] op_sel_hi:[1,1] neg_lo:[0,1] neg_hi:[0,1]
    v_pk_add_f32 v[92:93], v[76:77], v[14:15] op_sel:[0,1] op_sel_hi:[1,1] neg_lo:[0,1] neg_hi:[0,1]
    v_pk_add_f32 v[94:95], v[78:79], v[14:15] op_sel:[0,1] op_sel_hi:[1,1] neg_lo:[0,1] neg_hi:[0,1]
    v_pk_mul_f32 v[104:105], v[80:81], v[80:81]
    v_pk_mul_f32 v[106:107], v[82:83], v[82:83]
    v_pk_fma_f32 v[104:105], v[84:85], v[84:85], v[104:105]
    v_pk_fma_f32 v[106:107], v[86:87], v[86:87], v[106:107]
    v_pk_fma_f32 v[104:105], v[88:89], v[88:89], v[104:105]
    v_pk_fma_f32 v[106:107], v[90:91], v[90:91], v[106:107]
    v_pk_fma_f32 v[104:105], v[92:93], v[92:93], v[104:105]
    v_pk_fma_f32 v[106:107], v[94:95], v[94:95], v[106:107]
    v_pk_add_f32 v[104:105], v[104:105], v[106:107]
    v_add_f32 v14, v104, v105
    v_cvt_pk_bf16_f32 v15, 0, v15
    s_nop 1
    v_add_f32_dpp v14, v14, v14 row_shr:1 row_mask:0xf bank_mask:0xf bound_ctrl:0
    s_nop 1
    v_add_f32_dpp v14, v14, v14 row_shr:2 row_mask:0xf bank_mask:0xf bound_ctrl:0
    s_nop 1
    v_add_f32_dpp v14, v14, v14 row_shr:4 row_mask:0xf bank_mask:0xf bound_ctrl:0
    s_nop 1
    v_add_f32_dpp v14, v14, v14 row_shr:8 row_mask:0xf bank_mask:0xf bound_ctrl:0
    s_nop 1
    v_add_f32_dpp v14, v14, v14 row_bcast:15 row_mask:0xa bank_mask:0xf
    s_nop 1
    v_add_f32_dpp v14, v14, v14 row_bcast:31 row_mask:0xc bank_mask:0xf
    s_nop 1
    v_readlane_b32 s47, v14, 63
    v_pk_add_f32 v[64:65], v[64:65], v[14:15] op_sel:[0,1] op_sel_hi:[1,1] neg_lo:[0,1] neg_hi:[0,1]
    v_pk_add_f32 v[66:67], v[66:67], v[14:15] op_sel:[0,1] op_sel_hi:[1,1] neg_lo:[0,1] neg_hi:[0,1]
    v_pk_add_f32 v[68:69], v[68:69], v[14:15] op_sel:[0,1] op_sel_hi:[1,1] neg_lo:[0,1] neg_hi:[0,1]
    v_pk_add_f32 v[70:71], v[70:71], v[14:15] op_sel:[0,1] op_sel_hi:[1,1] neg_lo:[0,1] neg_hi:[0,1]
    v_pk_add_f32 v[72:73], v[72:73], v[14:15] op_sel:[0,1] op_sel_hi:[1,1] neg_lo:[0,1] neg_hi:[0,1]
    v_pk_add_f32 v[74:75], v[74:75], v[14:15] op_sel:[0,1] op_sel_hi:[1,1] neg_lo:[0,1] neg_hi:[0,1]
    v_pk_add_f32 v[76:77], v[76:77], v[14:15] op_sel:[0,1] op_sel_hi:[1,1] neg_lo:[0,1] neg_hi:[0,1]
    v_pk_add_f32 v[78:79], v[78:79], v[14:15] op_sel:[0,1] op_sel_hi:[1,1] neg_lo:[0,1] neg_hi:[0,1]
    v_mov_b32 v14, s47
    v_mul_f32 v14, 0x3a800000, v14
    v_cvt_pk_bf16_f32 v14, 0, v14
    v_add_f32 v14, 0x3727c5ac, v14
    v_cvt_pk_bf16_f32 v14, 0, v14
    v_sqrt_f32 v14, v14
    s_nop 0
    v_cvt_pk_bf16_f32 v14, 0, v14
    v_rcp_f32 v14, v14
    v_cvt_pk_bf16_f32 v64, 0, v64
    v_cvt_pk_bf16_f32 v65, 0, v65
    v_cvt_pk_bf16_f32 v66, 0, v66
    v_cvt_pk_bf16_f32 v67, 0, v67
    v_cvt_pk_bf16_f32 v68, 0, v68
    v_cvt_pk_bf16_f32 v69, 0, v69
    v_cvt_pk_bf16_f32 v70, 0, v70
    v_cvt_pk_bf16_f32 v71, 0, v71
    v_cvt_pk_bf16_f32 v72, 0, v72
    v_cvt_pk_bf16_f32 v73, 0, v73
    v_cvt_pk_bf16_f32 v74, 0, v74
    v_cvt_pk_bf16_f32 v75, 0, v75
    v_cvt_pk_bf16_f32 v76, 0, v76
    v_cvt_pk_bf16_f32 v77, 0, v77
    v_cvt_pk_bf16_f32 v78, 0, v78
    v_cvt_pk_bf16_f32 v79, 0, v79
    v_pk_mul_f32 v[64:65], v[64:65], v[14:15] op_sel_hi:[1,0]
    v_pk_mul_f32 v[66:67], v[66:67], v[14:15] op_sel_hi:[1,0]
    v_pk_mul_f32 v[68:69], v[68:69], v[14:15] op_sel_hi:[1,0]
    v_pk_mul_f32 v[70:71], v[70:71], v[14:15] op_sel_hi:[1,0]
    v_pk_mul_f32 v[72:73], v[72:73], v[14:15] op_sel_hi:[1,0]
    v_pk_mul_f32 v[74:75], v[74:75], v[14:15] op_sel_hi:[1,0]
    v_pk_mul_f32 v[76:77], v[76:77], v[14:15] op_sel_hi:[1,0]
    v_pk_mul_f32 v[78:79], v[78:79], v[14:15] op_sel_hi:[1,0]
    v_cvt_pk_bf16_f32 v64, 0, v64
    v_cvt_pk_bf16_f32 v65, 0, v65
    v_cvt_pk_bf16_f32 v66, 0, v66
    v_cvt_pk_bf16_f32 v67, 0, v67
    v_cvt_pk_bf16_f32 v68, 0, v68
    v_cvt_pk_bf16_f32 v69, 0, v69
    v_cvt_pk_bf16_f32 v70, 0, v70
    v_cvt_pk_bf16_f32 v71, 0, v71
    v_cvt_pk_bf16_f32 v72, 0, v72
    v_cvt_pk_bf16_f32 v73, 0, v73
    v_cvt_pk_bf16_f32 v74, 0, v74
    v_cvt_pk_bf16_f32 v75, 0, v75
    v_cvt_pk_bf16_f32 v76, 0, v76
    v_cvt_pk_bf16_f32 v77, 0, v77
    v_cvt_pk_bf16_f32 v78, 0, v78
    v_cvt_pk_bf16_f32 v79, 0, v79
    v_pk_mul_f32 v[64:65], v[64:65], v[32:33]
    v_pk_mul_f32 v[66:67], v[66:67], v[34:35]
    v_pk_mul_f32 v[68:69], v[68:69], v[36:37]
    v_pk_mul_f32 v[70:71], v[70:71], v[38:39]
    v_pk_mul_f32 v[72:73], v[72:73], v[40:41]
    v_pk_mul_f32 v[74:75], v[74:75], v[42:43]
    v_pk_mul_f32 v[76:77], v[76:77], v[44:45]
    v_pk_mul_f32 v[78:79], v[78:79], v[46:47]
    v_cvt_pk_bf16_f32 v64, 0, v64
    v_cvt_pk_bf16_f32 v65, 0, v65
    v_cvt_pk_bf16_f32 v66, 0, v66
    v_cvt_pk_bf16_f32 v67, 0, v67
    v_cvt_pk_bf16_f32 v68, 0, v68
    v_cvt_pk_bf16_f32 v69, 0, v69
    v_cvt_pk_bf16_f32 v70, 0, v70
    v_cvt_pk_bf16_f32 v71, 0, v71
    v_cvt_pk_bf16_f32 v72, 0, v72
    v_cvt_pk_bf16_f32 v73, 0, v73
    v_cvt_pk_bf16_f32 v74, 0, v74
    v_cvt_pk_bf16_f32 v75, 0, v75
    v_cvt_pk_bf16_f32 v76, 0, v76
    v_cvt_pk_bf16_f32 v77, 0, v77
    v_cvt_pk_bf16_f32 v78, 0, v78
    v_cvt_pk_bf16_f32 v79, 0, v79
    v_pk_add_f32 v[64:65], v[64:65], v[48:49]
    v_pk_add_f32 v[66:67], v[66:67], v[50:51]
    v_pk_add_f32 v[68:69], v[68:69], v[52:53]
    v_pk_add_f32 v[70:71], v[70:71], v[54:55]
    v_pk_add_f32 v[72:73], v[72:73], v[56:57]
    v_pk_add_f32 v[74:75], v[74:75], v[58:59]
    v_pk_add_f32 v[76:77], v[76:77], v[60:61]
    v_pk_add_f32 v[78:79], v[78:79], v[62:63]
    v_cvt_pk_bf16_f32 v104, v64, v65
    v_cvt_pk_bf16_f32 v105, v66, v67
    v_cvt_pk_bf16_f32 v106, v68, v69
    v_cvt_pk_bf16_f32 v107, v70, v71
    v_cvt_pk_bf16_f32 v108, v72, v73
    v_cvt_pk_bf16_f32 v109, v74, v75
    v_cvt_pk_bf16_f32 v110, v76, v77
    v_cvt_pk_bf16_f32 v111, v78, v79
    ds_write_b128 v10, v[104:107]
    ds_write_b128 v10, v[108:111] offset:1024
    s_waitcnt lgkmcnt(0)
    s_barrier
    ds_read_b128 v[104:107], v13
    ds_read_b128 v[108:111], v13 offset:128
    s_waitcnt lgkmcnt(1)
    buffer_store_dwordx4 v[104:107], v11, s[12:15], s63 offen sc1
    s_waitcnt lgkmcnt(0)
    buffer_store_dwordx4 v[108:111], v12, s[12:15], s63 offen sc1
    s_waitcnt vmcnt(0)
    s_barrier
    s_cmp_lg_u32 s44, 0
    s_cbranch_scc1 L_sf_23
    v_mov_b32 v14, s60
    v_add_u32 v14, 1, v14
    v_mov_b32 v15, 0
    s_mov_b64 exec, 1
    buffer_store_dword v14, v15, s[12:15], s52 offen sc1
    s_mov_b64 exec, -1
L_sf_23:
    s_cmp_ge_u32 s60, 8
    s_cbranch_scc1 L_l_end_22
    s_add_u32 s63, s63, 524288
    buffer_load_dwordx4 a[8:11], v7, s[24:27], s63 offen
    buffer_load_dwordx4 a[12:15], v7, s[24:27], s63 offen offset:1024
    s_add_u32 s63, s63, 524288
    buffer_load_dwordx4 a[16:19], v7, s[24:27], s63 offen
    buffer_load_dwordx4 a[20:23], v7, s[24:27], s63 offen offset:1024
    s_add_u32 s63, s63, 524288
    buffer_load_dwordx4 a[24:27], v7, s[24:27], s63 offen
    buffer_load_dwordx4 a[28:31], v7, s[24:27], s63 offen offset:1024
    s_add_u32 s63, s63, 524288
    buffer_load_dwordx4 a[32:35], v7, s[24:27], s63 offen
    buffer_load_dwordx4 a[36:39], v7, s[24:27], s63 offen offset:1024
    s_add_u32 s63, s63, 524288
    buffer_load_dwordx4 a[40:43], v7, s[24:27], s63 offen
    buffer_load_dwordx4 a[44:47], v7, s[24:27], s63 offen offset:1024
    s_add_u32 s63, s63, 524288
    buffer_load_dwordx4 a[48:51], v7, s[24:27], s63 offen
    buffer_load_dwordx4 a[52:55], v7, s[24:27], s63 offen offset:1024
    s_add_u32 s63, s63, 524288
    buffer_load_dwordx4 a[56:59], v7, s[24:27], s63 offen
    buffer_load_dwordx4 a[60:63], v7, s[24:27], s63 offen offset:1024
    s_waitcnt vmcnt(0)
L_l_end_22:
    v_accvgpr_mov_b32 a0, a8
    v_accvgpr_mov_b32 a1, a9
    v_accvgpr_mov_b32 a2, a10
    v_accvgpr_mov_b32 a3, a11
    v_accvgpr_mov_b32 a4, a12
    v_accvgpr_mov_b32 a5, a13
    v_accvgpr_mov_b32 a6, a14
    v_accvgpr_mov_b32 a7, a15
    v_accvgpr_mov_b32 a8, a16
    v_accvgpr_mov_b32 a9, a17
    v_accvgpr_mov_b32 a10, a18
    v_accvgpr_mov_b32 a11, a19
    v_accvgpr_mov_b32 a12, a20
    v_accvgpr_mov_b32 a13, a21
    v_accvgpr_mov_b32 a14, a22
    v_accvgpr_mov_b32 a15, a23
    v_accvgpr_mov_b32 a16, a24
    v_accvgpr_mov_b32 a17, a25
    v_accvgpr_mov_b32 a18, a26
    v_accvgpr_mov_b32 a19, a27
    v_accvgpr_mov_b32 a20, a28
    v_accvgpr_mov_b32 a21, a29
    v_accvgpr_mov_b32 a22, a30
    v_accvgpr_mov_b32 a23, a31
    v_accvgpr_mov_b32 a24, a32
    v_accvgpr_mov_b32 a25, a33
    v_accvgpr_mov_b32 a26, a34
    v_accvgpr_mov_b32 a27, a35
    v_accvgpr_mov_b32 a28, a36
    v_accvgpr_mov_b32 a29, a37
    v_accvgpr_mov_b32 a30, a38
    v_accvgpr_mov_b32 a31, a39
    v_accvgpr_mov_b32 a32, a40
    v_accvgpr_mov_b32 a33, a41
    v_accvgpr_mov_b32 a34, a42
    v_accvgpr_mov_b32 a35, a43
    v_accvgpr_mov_b32 a36, a44
    v_accvgpr_mov_b32 a37, a45
    v_accvgpr_mov_b32 a38, a46
    v_accvgpr_mov_b32 a39, a47
    v_accvgpr_mov_b32 a40, a48
    v_accvgpr_mov_b32 a41, a49
    v_accvgpr_mov_b32 a42, a50
    v_accvgpr_mov_b32 a43, a51
    v_accvgpr_mov_b32 a44, a52
    v_accvgpr_mov_b32 a45, a53
    v_accvgpr_mov_b32 a46, a54
    v_accvgpr_mov_b32 a47, a55
    v_accvgpr_mov_b32 a48, a56
    v_accvgpr_mov_b32 a49, a57
    v_accvgpr_mov_b32 a50, a58
    v_accvgpr_mov_b32 a51, a59
    v_accvgpr_mov_b32 a52, a60
    v_accvgpr_mov_b32 a53, a61
    v_accvgpr_mov_b32 a54, a62
    v_accvgpr_mov_b32 a55, a63
    s_add_u32 s60, s60, 8
    s_cmp_lt_u32 s60, 64
    s_cbranch_scc1 L_l_sub_21
    s_cmp_lt_u32 s48, 14
    s_cbranch_scc1 L_w_h_17_s
    s_and_b32 s55, s48, 1
    s_lshl_b32 s55, s55, 3
    s_add_u32 s55, s55, s40
    s_load_dwordx4 s[8:11], s[0:1], 96
    v_lshrrev_b32 v5, 3, v0
    s_mov_b32 s46, 196608
    v_mul_lo_u32 v4, v5, s46
    v_and_b32 v6, 7, v0
    v_lshl_add_u32 v4, v6, 4, v4
    v_lshlrev_b32 v5, 5, v5
    s_waitcnt lgkmcnt(0)
    s_mov_b32 s28, s10
    s_and_b32 s29, s11, 0xffff
    s_mov_b32 s30, 0xc00000
    s_mov_b32 s31, 0x00020000
    s_mov_b32 s32, s8
    s_and_b32 s33, s9, 0xffff
    s_mov_b32 s34, 0x800
    s_mov_b32 s35, 0x00020000
    buffer_load_dwordx4 v[8:11], v5, s[32:35], 0 offen
    buffer_load_dwordx4 v[12:15], v5, s[32:35], 0 offen offset:16
    s_waitcnt vmcnt(0)
    v_lshlrev_b32 v16, 16, v8
    v_and_b32 v17, 0xffff0000, v8
    v_lshlrev_b32 v18, 16, v9
    v_and_b32 v19, 0xffff0000, v9
    v_lshlrev_b32 v20, 16, v10
    v_and_b32 v21, 0xffff0000, v10
    v_lshlrev_b32 v22, 16, v11
    v_and_b32 v23, 0xffff0000, v11
    v_lshlrev_b32 v24, 16, v12
    v_and_b32 v25, 0xffff0000, v12
    v_lshlrev_b32 v26, 16, v13
    v_and_b32 v27, 0xffff0000, v13
    v_lshlrev_b32 v28, 16, v14
    v_and_b32 v29, 0xffff0000, v14
    v_lshlrev_b32 v30, 16, v15
    v_and_b32 v31, 0xffff0000, v15
    v_mul_f32 v112, 0xbfb8aa3b, v16
    v_mul_f32 v113, 0xbfb8aa3b, v17
    v_mul_f32 v114, 0xbfb8aa3b, v18
    v_mul_f32 v115, 0xbfb8aa3b, v19
    v_mul_f32 v116, 0xbfb8aa3b, v20
    v_mul_f32 v117, 0xbfb8aa3b, v21
    v_mul_f32 v118, 0xbfb8aa3b, v22
    v_mul_f32 v119, 0xbfb8aa3b, v23
    v_mul_f32 v120, 0xbfb8aa3b, v24
    v_mul_f32 v121, 0xbfb8aa3b, v25
    v_mul_f32 v122, 0xbfb8aa3b, v26
    v_mul_f32 v123, 0xbfb8aa3b, v27
    v_mul_f32 v124, 0xbfb8aa3b, v28
    v_mul_f32 v125, 0xbfb8aa3b, v29
    v_mul_f32 v126, 0xbfb8aa3b, v30
    v_mul_f32 v127, 0xbfb8aa3b, v31
    v_exp_f32 v112, v112
    v_exp_f32 v113, v113
    v_exp_f32 v114, v114
    v_exp_f32 v115, v115
    v_exp_f32 v116, v116
    v_exp_f32 v117, v117
    v_exp_f32 v118, v118
    v_exp_f32 v119, v119
    v_exp_f32 v120, v120
    v_exp_f32 v121, v121
    v_exp_f32 v122, v122
    v_exp_f32 v123, v123
    v_exp_f32 v124, v124
    v_exp_f32 v125, v125
    v_exp_f32 v126, v126
    v_exp_f32 v127, v127
    v_add_f32 v112, 1.0, v112
    v_add_f32 v113, 1.0, v113
    v_add_f32 v114, 1.0, v114
    v_add_f32 v115, 1.0, v115
    v_add_f32 v116, 1.0, v116
    v_add_f32 v117, 1.0, v117
    v_add_f32 v118, 1.0, v118
    v_add_f32 v119, 1.0, v119
    v_add_f32 v120, 1.0, v120
    v_add_f32 v121, 1.0, v121
    v_add_f32 v122, 1.0, v122
    v_add_f32 v123, 1.0, v123
    v_add_f32 v124, 1.0, v124
    v_add_f32 v125, 1.0, v125
    v_add_f32 v126, 1.0, v126
    v_add_f32 v127, 1.0, v127
    v_rcp_f32 v112, v112
    v_rcp_f32 v113, v113
    v_rcp_f32 v114, v114
    v_rcp_f32 v115, v115
    v_rcp_f32 v116, v116
    v_rcp_f32 v117, v117
    v_rcp_f32 v118, v118
    v_rcp_f32 v119, v119
    v_rcp_f32 v120, v120
    v_rcp_f32 v121, v121
    v_rcp_f32 v122, v122
    v_rcp_f32 v123, v123
    v_rcp_f32 v124, v124
    v_rcp_f32 v125, v125
    v_rcp_f32 v126, v126
    v_rcp_f32 v127, v127
    v_mul_f32 v16, v16, v112
    v_mul_f32 v17, v17, v113
    v_mul_f32 v18, v18, v114
    v_mul_f32 v19, v19, v115
    v_mul_f32 v20, v20, v116
    v_mul_f32 v21, v21, v117
    v_mul_f32 v22, v22, v118
    v_mul_f32 v23, v23, v119
    v_mul_f32 v24, v24, v120
    v_mul_f32 v25, v25, v121
    v_mul_f32 v26, v26, v122
    v_mul_f32 v27, v27, v123
    v_mul_f32 v28, v28, v124
    v_mul_f32 v29, v29, v125
    v_mul_f32 v30, v30, v126
    v_mul_f32 v31, v31, v127
    v_cvt_pk_bf16_f32 v16, 0, v16
    v_cvt_pk_bf16_f32 v17, 0, v17
    v_cvt_pk_bf16_f32 v18, 0, v18
    v_cvt_pk_bf16_f32 v19, 0, v19
    v_cvt_pk_bf16_f32 v20, 0, v20
    v_cvt_pk_bf16_f32 v21, 0, v21
    v_cvt_pk_bf16_f32 v22, 0, v22
    v_cvt_pk_bf16_f32 v23, 0, v23
    v_cvt_pk_bf16_f32 v24, 0, v24
    v_cvt_pk_bf16_f32 v25, 0, v25
    v_cvt_pk_bf16_f32 v26, 0, v26
    v_cvt_pk_bf16_f32 v27, 0, v27
    v_cvt_pk_bf16_f32 v28, 0, v28
    v_cvt_pk_bf16_f32 v29, 0, v29
    v_cvt_pk_bf16_f32 v30, 0, v30
    v_cvt_pk_bf16_f32 v31, 0, v31
    s_lshl_b32 s53, s55, 9
    s_add_u32 s53, s53, 4096
L_m_loop_24:
    s_add_u32 s46, s53, 0
    buffer_load_dwordx4 v[32:35], v4, s[28:31], s46 offen nt
    s_add_u32 s46, s53, 12288
    buffer_load_dwordx4 v[36:39], v4, s[28:31], s46 offen nt
    s_add_u32 s46, s53, 24576
    buffer_load_dwordx4 v[40:43], v4, s[28:31], s46 offen nt
    s_add_u32 s46, s53, 36864
    buffer_load_dwordx4 v[44:47], v4, s[28:31], s46 offen nt
    s_add_u32 s46, s53, 49152
    buffer_load_dwordx4 v[48:51], v4, s[28:31], s46 offen nt
    s_add_u32 s46, s53, 61440
    buffer_load_dwordx4 v[52:55], v4, s[28:31], s46 offen nt
    s_add_u32 s46, s53, 73728
    buffer_load_dwordx4 v[56:59], v4, s[28:31], s46 offen nt
    s_add_u32 s46, s53, 86016
    buffer_load_dwordx4 v[60:63], v4, s[28:31], s46 offen nt
    s_add_u32 s46, s53, 98304
    buffer_load_dwordx4 v[64:67], v4, s[28:31], s46 offen nt
    s_add_u32 s46, s53, 110592
    buffer_load_dwordx4 v[68:71], v4, s[28:31], s46 offen nt
    s_add_u32 s46, s53, 122880
    buffer_load_dwordx4 v[72:75], v4, s[28:31], s46 offen nt
    s_add_u32 s46, s53, 135168
    buffer_load_dwordx4 v[76:79], v4, s[28:31], s46 offen nt
    s_add_u32 s46, s53, 147456
    buffer_load_dwordx4 v[80:83], v4, s[28:31], s46 offen nt
    s_add_u32 s46, s53, 159744
    buffer_load_dwordx4 v[84:87], v4, s[28:31], s46 offen nt
    s_add_u32 s46, s53, 172032
    buffer_load_dwordx4 v[88:91], v4, s[28:31], s46 offen nt
    s_add_u32 s46, s53, 184320
    buffer_load_dwordx4 v[92:95], v4, s[28:31], s46 offen nt
    s_waitcnt vmcnt(15)
    v_lshlrev_b32 v104, 16, v32
    v_and_b32 v105, 0xffff0000, v32
    v_mul_f32 v96, v104, v16
    v_mul_f32 v97, v105, v16
    v_lshlrev_b32 v104, 16, v33
    v_and_b32 v105, 0xffff0000, v33
    v_mul_f32 v98, v104, v16
    v_mul_f32 v99, v105, v16
    v_lshlrev_b32 v104, 16, v34
    v_and_b32 v105, 0xffff0000, v34
    v_mul_f32 v100, v104, v16
    v_mul_f32 v101, v105, v16
    v_lshlrev_b32 v104, 16, v35
    v_and_b32 v105, 0xffff0000, v35
    v_mul_f32 v102, v104, v16
    v_mul_f32 v103, v105, v16
    s_waitcnt vmcnt(14)
    v_lshlrev_b32 v104, 16, v36
    v_and_b32 v105, 0xffff0000, v36
    v_fmac_f32 v96, v104, v17
    v_fmac_f32 v97, v105, v17
    v_lshlrev_b32 v104, 16, v37
    v_and_b32 v105, 0xffff0000, v37
    v_fmac_f32 v98, v104, v17
    v_fmac_f32 v99, v105, v17
    v_lshlrev_b32 v104, 16, v38
    v_and_b32 v105, 0xffff0000, v38
    v_fmac_f32 v100, v104, v17
    v_fmac_f32 v101, v105, v17
    v_lshlrev_b32 v104, 16, v39
    v_and_b32 v105, 0xffff0000, v39
    v_fmac_f32 v102, v104, v17
    v_fmac_f32 v103, v105, v17
    s_waitcnt vmcnt(13)
    v_lshlrev_b32 v104, 16, v40
    v_and_b32 v105, 0xffff0000, v40
    v_fmac_f32 v96, v104, v18
    v_fmac_f32 v97, v105, v18
    v_lshlrev_b32 v104, 16, v41
    v_and_b32 v105, 0xffff0000, v41
    v_fmac_f32 v98, v104, v18
    v_fmac_f32 v99, v105, v18
    v_lshlrev_b32 v104, 16, v42
    v_and_b32 v105, 0xffff0000, v42
    v_fmac_f32 v100, v104, v18
    v_fmac_f32 v101, v105, v18
    v_lshlrev_b32 v104, 16, v43
    v_and_b32 v105, 0xffff0000, v43
    v_fmac_f32 v102, v104, v18
    v_fmac_f32 v103, v105, v18
    s_waitcnt vmcnt(12)
    v_lshlrev_b32 v104, 16, v44
    v_and_b32 v105, 0xffff0000, v44
    v_fmac_f32 v96, v104, v19
    v_fmac_f32 v97, v105, v19
    v_lshlrev_b32 v104, 16, v45
    v_and_b32 v105, 0xffff0000, v45
    v_fmac_f32 v98, v104, v19
    v_fmac_f32 v99, v105, v19
    v_lshlrev_b32 v104, 16, v46
    v_and_b32 v105, 0xffff0000, v46
    v_fmac_f32 v100, v104, v19
    v_fmac_f32 v101, v105, v19
    v_lshlrev_b32 v104, 16, v47
    v_and_b32 v105, 0xffff0000, v47
    v_fmac_f32 v102, v104, v19
    v_fmac_f32 v103, v105, v19
    s_waitcnt vmcnt(11)
    v_lshlrev_b32 v104, 16, v48
    v_and_b32 v105, 0xffff0000, v48
    v_fmac_f32 v96, v104, v20
    v_fmac_f32 v97, v105, v20
    v_lshlrev_b32 v104, 16, v49
    v_and_b32 v105, 0xffff0000, v49
    v_fmac_f32 v98, v104, v20
    v_fmac_f32 v99, v105, v20
    v_lshlrev_b32 v104, 16, v50
    v_and_b32 v105, 0xffff0000, v50
    v_fmac_f32 v100, v104, v20
    v_fmac_f32 v101, v105, v20
    v_lshlrev_b32 v104, 16, v51
    v_and_b32 v105, 0xffff0000, v51
    v_fmac_f32 v102, v104, v20
    v_fmac_f32 v103, v105, v20
    s_waitcnt vmcnt(10)
    v_lshlrev_b32 v104, 16, v52
    v_and_b32 v105, 0xffff0000, v52
    v_fmac_f32 v96, v104, v21
    v_fmac_f32 v97, v105, v21
    v_lshlrev_b32 v104, 16, v53
    v_and_b32 v105, 0xffff0000, v53
    v_fmac_f32 v98, v104, v21
    v_fmac_f32 v99, v105, v21
    v_lshlrev_b32 v104, 16, v54
    v_and_b32 v105, 0xffff0000, v54
    v_fmac_f32 v100, v104, v21
    v_fmac_f32 v101, v105, v21
    v_lshlrev_b32 v104, 16, v55
    v_and_b32 v105, 0xffff0000, v55
    v_fmac_f32 v102, v104, v21
    v_fmac_f32 v103, v105, v21
    s_waitcnt vmcnt(9)
    v_lshlrev_b32 v104, 16, v56
    v_and_b32 v105, 0xffff0000, v56
    v_fmac_f32 v96, v104, v22
    v_fmac_f32 v97, v105, v22
    v_lshlrev_b32 v104, 16, v57
    v_and_b32 v105, 0xffff0000, v57
    v_fmac_f32 v98, v104, v22
    v_fmac_f32 v99, v105, v22
    v_lshlrev_b32 v104, 16, v58
    v_and_b32 v105, 0xffff0000, v58
    v_fmac_f32 v100, v104, v22
    v_fmac_f32 v101, v105, v22
    v_lshlrev_b32 v104, 16, v59
    v_and_b32 v105, 0xffff0000, v59
    v_fmac_f32 v102, v104, v22
    v_fmac_f32 v103, v105, v22
    s_waitcnt vmcnt(8)
    v_lshlrev_b32 v104, 16, v60
    v_and_b32 v105, 0xffff0000, v60
    v_fmac_f32 v96, v104, v23
    v_fmac_f32 v97, v105, v23
    v_lshlrev_b32 v104, 16, v61
    v_and_b32 v105, 0xffff0000, v61
    v_fmac_f32 v98, v104, v23
    v_fmac_f32 v99, v105, v23
    v_lshlrev_b32 v104, 16, v62
    v_and_b32 v105, 0xffff0000, v62
    v_fmac_f32 v100, v104, v23
    v_fmac_f32 v101, v105, v23
    v_lshlrev_b32 v104, 16, v63
    v_and_b32 v105, 0xffff0000, v63
    v_fmac_f32 v102, v104, v23
    v_fmac_f32 v103, v105, v23
    s_waitcnt vmcnt(7)
    v_lshlrev_b32 v104, 16, v64
    v_and_b32 v105, 0xffff0000, v64
    v_fmac_f32 v96, v104, v24
    v_fmac_f32 v97, v105, v24
    v_lshlrev_b32 v104, 16, v65
    v_and_b32 v105, 0xffff0000, v65
    v_fmac_f32 v98, v104, v24
    v_fmac_f32 v99, v105, v24
    v_lshlrev_b32 v104, 16, v66
    v_and_b32 v105, 0xffff0000, v66
    v_fmac_f32 v100, v104, v24
    v_fmac_f32 v101, v105, v24
    v_lshlrev_b32 v104, 16, v67
    v_and_b32 v105, 0xffff0000, v67
    v_fmac_f32 v102, v104, v24
    v_fmac_f32 v103, v105, v24
    s_waitcnt vmcnt(6)
    v_lshlrev_b32 v104, 16, v68
    v_and_b32 v105, 0xffff0000, v68
    v_fmac_f32 v96, v104, v25
    v_fmac_f32 v97, v105, v25
    v_lshlrev_b32 v104, 16, v69
    v_and_b32 v105, 0xffff0000, v69
    v_fmac_f32 v98, v104, v25
    v_fmac_f32 v99, v105, v25
    v_lshlrev_b32 v104, 16, v70
    v_and_b32 v105, 0xffff0000, v70
    v_fmac_f32 v100, v104, v25
    v_fmac_f32 v101, v105, v25
    v_lshlrev_b32 v104, 16, v71
    v_and_b32 v105, 0xffff0000, v71
    v_fmac_f32 v102, v104, v25
    v_fmac_f32 v103, v105, v25
    s_waitcnt vmcnt(5)
    v_lshlrev_b32 v104, 16, v72
    v_and_b32 v105, 0xffff0000, v72
    v_fmac_f32 v96, v104, v26
    v_fmac_f32 v97, v105, v26
    v_lshlrev_b32 v104, 16, v73
    v_and_b32 v105, 0xffff0000, v73
    v_fmac_f32 v98, v104, v26
    v_fmac_f32 v99, v105, v26
    v_lshlrev_b32 v104, 16, v74
    v_and_b32 v105, 0xffff0000, v74
    v_fmac_f32 v100, v104, v26
    v_fmac_f32 v101, v105, v26
    v_lshlrev_b32 v104, 16, v75
    v_and_b32 v105, 0xffff0000, v75
    v_fmac_f32 v102, v104, v26
    v_fmac_f32 v103, v105, v26
    s_waitcnt vmcnt(4)
    v_lshlrev_b32 v104, 16, v76
    v_and_b32 v105, 0xffff0000, v76
    v_fmac_f32 v96, v104, v27
    v_fmac_f32 v97, v105, v27
    v_lshlrev_b32 v104, 16, v77
    v_and_b32 v105, 0xffff0000, v77
    v_fmac_f32 v98, v104, v27
    v_fmac_f32 v99, v105, v27
    v_lshlrev_b32 v104, 16, v78
    v_and_b32 v105, 0xffff0000, v78
    v_fmac_f32 v100, v104, v27
    v_fmac_f32 v101, v105, v27
    v_lshlrev_b32 v104, 16, v79
    v_and_b32 v105, 0xffff0000, v79
    v_fmac_f32 v102, v104, v27
    v_fmac_f32 v103, v105, v27
    s_waitcnt vmcnt(3)
    v_lshlrev_b32 v104, 16, v80
    v_and_b32 v105, 0xffff0000, v80
    v_fmac_f32 v96, v104, v28
    v_fmac_f32 v97, v105, v28
    v_lshlrev_b32 v104, 16, v81
    v_and_b32 v105, 0xffff0000, v81
    v_fmac_f32 v98, v104, v28
    v_fmac_f32 v99, v105, v28
    v_lshlrev_b32 v104, 16, v82
    v_and_b32 v105, 0xffff0000, v82
    v_fmac_f32 v100, v104, v28
    v_fmac_f32 v101, v105, v28
    v_lshlrev_b32 v104, 16, v83
    v_and_b32 v105, 0xffff0000, v83
    v_fmac_f32 v102, v104, v28
    v_fmac_f32 v103, v105, v28
    s_waitcnt vmcnt(2)
    v_lshlrev_b32 v104, 16, v84
    v_and_b32 v105, 0xffff0000, v84
    v_fmac_f32 v96, v104, v29
    v_fmac_f32 v97, v105, v29
    v_lshlrev_b32 v104, 16, v85
    v_and_b32 v105, 0xffff0000, v85
    v_fmac_f32 v98, v104, v29
    v_fmac_f32 v99, v105, v29
    v_lshlrev_b32 v104, 16, v86
    v_and_b32 v105, 0xffff0000, v86
    v_fmac_f32 v100, v104, v29
    v_fmac_f32 v101, v105, v29
    v_lshlrev_b32 v104, 16, v87
    v_and_b32 v105, 0xffff0000, v87
    v_fmac_f32 v102, v104, v29
    v_fmac_f32 v103, v105, v29
    s_waitcnt vmcnt(1)
    v_lshlrev_b32 v104, 16, v88
    v_and_b32 v105, 0xffff0000, v88
    v_fmac_f32 v96, v104, v30
    v_fmac_f32 v97, v105, v30
    v_lshlrev_b32 v104, 16, v89
    v_and_b32 v105, 0xffff0000, v89
    v_fmac_f32 v98, v104, v30
    v_fmac_f32 v99, v105, v30
    v_lshlrev_b32 v104, 16, v90
    v_and_b32 v105, 0xffff0000, v90
    v_fmac_f32 v100, v104, v30
    v_fmac_f32 v101, v105, v30
    v_lshlrev_b32 v104, 16, v91
    v_and_b32 v105, 0xffff0000, v91
    v_fmac_f32 v102, v104, v30
    v_fmac_f32 v103, v105, v30
    s_waitcnt vmcnt(0)
    v_lshlrev_b32 v104, 16, v92
    v_and_b32 v105, 0xffff0000, v92
    v_fmac_f32 v96, v104, v31
    v_fmac_f32 v97, v105, v31
    v_lshlrev_b32 v104, 16, v93
    v_and_b32 v105, 0xffff0000, v93
    v_fmac_f32 v98, v104, v31
    v_fmac_f32 v99, v105, v31
    v_lshlrev_b32 v104, 16, v94
    v_and_b32 v105, 0xffff0000, v94
    v_fmac_f32 v100, v104, v31
    v_fmac_f32 v101, v105, v31
    v_lshlrev_b32 v104, 16, v95
    v_and_b32 v105, 0xffff0000, v95
    v_fmac_f32 v102, v104, v31
    v_fmac_f32 v103, v105, v31
    v_lshlrev_b32 v104, 5, v0
    ds_write_b128 v104, v[96:99]
    ds_write_b128 v104, v[100:103] offset:16
    v_lshlrev_b32 v105, 2, v1
    s_lshl_b32 s46, s44, 11
    v_add_u32 v104, s46, v105
    s_waitcnt lgkmcnt(0)
    ds_read_b32 v96, v104 offset:0
    ds_read_b32 v97, v104 offset:256
    ds_read_b32 v98, v104 offset:512
    ds_read_b32 v99, v104 offset:768
    ds_read_b32 v100, v104 offset:1024
    ds_read_b32 v101, v104 offset:1280
    ds_read_b32 v102, v104 offset:1536
    ds_read_b32 v103, v104 offset:1792
    s_waitcnt lgkmcnt(0)
    v_add_f32 v96, v96, v100
    v_add_f32 v97, v97, v101
    v_add_f32 v98, v98, v102
    v_add_f32 v99, v99, v103
    v_add_f32 v96, v96, v98
    v_add_f32 v97, v97, v99
    v_add_f32 v96, v96, v97
    v_lshlrev_b32 v104, 2, v0
    ds_write_b32 v104, v96 offset:16384
    s_waitcnt lgkmcnt(0)
    s_barrier
    s_cmp_lg_u32 s44, 0
    s_cbranch_scc1 L_m_sk_25
    ds_read_b32 v96, v105 offset:16384
    ds_read_b32 v97, v105 offset:16640
    ds_read_b32 v98, v105 offset:16896
    ds_read_b32 v99, v105 offset:17152
    ds_read_b32 v100, v105 offset:17408
    ds_read_b32 v101, v105 offset:17664
    ds_read_b32 v102, v105 offset:17920
    ds_read_b32 v103, v105 offset:18176
    s_waitcnt lgkmcnt(0)
    v_add_f32 v96, v96, v100
    v_add_f32 v97, v97, v101
    v_add_f32 v98, v98, v102
    v_add_f32 v99, v99, v103
    v_add_f32 v96, v96, v98
    v_add_f32 v97, v97, v99
    v_add_f32 v96, v96, v97
    v_cvt_pk_bf16_f32 v96, 0, v96
    s_lshl_b32 s46, s53, 1
    buffer_store_dword v96, v105, s[12:15], s46 offen sc1
L_m_sk_25:
    s_barrier
    s_add_u32 s53, s53, 128
    s_and_b32 s46, s53, 511
    s_cmp_lg_u32 s46, 0
    s_cbranch_scc1 L_m_loop_24
    s_lshl_b32 s54, s55, 7
    s_add_u32 s54, s54, 0x10e400
    s_mov_b32 s60, 0
    s_waitcnt vmcnt(0)
    s_cmp_lg_u32 s44, 0
    s_cbranch_scc1 L_sf_26
    v_mov_b32 v8, s60
    v_add_u32 v8, 1, v8
    v_mov_b32 v9, 0
    s_mov_b64 exec, 1
    buffer_store_dword v8, v9, s[12:15], s54 offen sc1
    s_mov_b64 exec, -1
L_sf_26:
    s_barrier
L_w_h_17_s:
    s_mov_b32 s77, s48
    s_cmp_eq_u32 s48, 14
    s_cselect_b32 s53, 2, 1
    s_sub_u32 s48, s48, 12
    s_min_u32 s48, s48, 2
    s_mov_b32 s79, 0
L_w_h_17_n:
    s_cmp_eq_u32 s53, 1
    s_cselect_b32 s74, 41, 54
    s_cselect_b32 s75, 58, 64
    s_mov_b32 s76, 65536
    s_branch L_w_g_10_e
L_w_h_17:
    s_mov_b32 s48, s77
    s_cmp_lt_u32 s48, 14
    s_cbranch_scc1 L_w_att_15
    s_and_b32 s42, s40, 3
    s_lshr_b32 s43, s40, 2
    s_cmp_eq_u32 s48, 14
    s_cbranch_scc1 L_w_c_16
    s_mov_b32 s75, 60
    s_mov_b32 s76, 0
    s_mov_b32 s78, 2
L_w_h_17_f:
    s_load_dwordx2 s[4:5], s[0:1], 112
    s_load_dwordx2 s[6:7], s[0:1], 88
    v_lshlrev_b32 v2, 4, v1
    v_lshlrev_b32 v3, 5, v1
    s_waitcnt lgkmcnt(0)
    s_mov_b32 s24, s4
    s_and_b32 s25, s5, 0xffff
    s_mov_b32 s26, 0x400000
    s_mov_b32 s27, 0x00020000
    s_mov_b32 s28, s6
    s_and_b32 s29, s7, 0xffff
    s_mov_b32 s30, 0x800
    s_mov_b32 s31, 0x00020000
    s_cmp_lg_u32 s44, 0
    s_cbranch_scc1 L_mw_27
    v_and_b32 v8, 15, v1
    v_lshlrev_b32 v8, 7, v8
    s_mov_b32 s46, 0x10e400
    s_mov_b32 s47, 0
    s_mov_b32 s70, 0
L_spin_28:
    buffer_load_dword v9, v8, s[12:15], s46 offen sc1
    s_waitcnt vmcnt(0)
    v_cmp_ge_u32 vcc, s47, v9
    s_add_u32 s70, s70, 1
    s_cbranch_vccz L_spok_29
    s_sleep 2
    s_cmp_lt_u32 s70, 524288
    s_cbranch_scc1 L_spin_28
    s_branch L_c_done_1
L_spok_29:
L_mw_27:
    s_barrier
    s_mov_b32 s46, 20480
    buffer_load_dwordx4 v[16:19], v3, s[12:15], s46 offen offset:0 sc1
    buffer_load_dwordx4 v[20:23], v3, s[12:15], s46 offen offset:16 sc1
    buffer_load_dwordx4 v[24:27], v3, s[12:15], s46 offen offset:2048 sc1
    buffer_load_dwordx4 v[28:31], v3, s[12:15], s46 offen offset:2064 sc1
    buffer_load_dwordx4 v[48:51], v2, s[28:31], 0 offen
    buffer_load_dwordx4 v[52:55], v2, s[28:31], 0 offen offset:1024
    s_waitcnt vmcnt(0)
    v_lshlrev_b32 v32, 16, v48
    v_and_b32 v33, 0xffff0000, v48
    v_lshlrev_b32 v34, 16, v49
    v_and_b32 v35, 0xffff0000, v49
    v_lshlrev_b32 v36, 16, v50
    v_and_b32 v37, 0xffff0000, v50
    v_lshlrev_b32 v38, 16, v51
    v_and_b32 v39, 0xffff0000, v51
    v_lshlrev_b32 v40, 16, v52
    v_and_b32 v41, 0xffff0000, v52
    v_lshlrev_b32 v42, 16, v53
    v_and_b32 v43, 0xffff0000, v53
    v_lshlrev_b32 v44, 16, v54
    v_and_b32 v45, 0xffff0000, v54
    v_lshlrev_b32 v46, 16, v55
    v_and_b32 v47, 0xffff0000, v55
    s_lshl_b32 s46, s42, 14
    s_lshl_b32 s47, s44, 11
    s_add_u32 s46, s46, s47
    s_add_u32 s46, s46, 0xb000000
    v_add_u32 v4, s46, v2
    v_and_b32 v5, 31, v1
    v_lshlrev_b32 v5, 7, v5
    v_add_u32 v5, 0x108400, v5
    v_lshlrev_b32 v6, 2, v1
    s_lshl_b32 s46, s44, 9
    v_add_u32 v6, s46, v6
    s_lshl_b32 s46, s44, 12
    v_add_u32 v7, s46, v3
    s_lshl_b32 s46, s42, 3
    s_add_u32 s46, s46, s44
    s_lshl_b32 s46, s46, 11
    v_add_u32 v8, s46, v2
    v_add_u32 v9, 0x800000, v8
    s_mov_b32 s60, s43
L_r_loop_30:
    s_lshl_b32 s61, s60, 18
    s_lshl_b32 s63, s60, 16
    s_cmp_lg_u32 s44, 0
    s_cbranch_scc1 L_r_nsp_31
    s_mov_b32 s70, 0
L_spin_32:
    buffer_load_dword v14, v5, s[12:15], s76 offen sc1
    s_waitcnt vmcnt(0)
    v_cmp_ge_u32 vcc, s60, v14
    s_add_u32 s70, s70, 1
    s_cbranch_vccz L_spok_33
    s_sleep 3
    s_cmp_lt_u32 s70, 524288
    s_cbranch_scc1 L_spin_32
    s_branch L_c_done_1
L_spok_33:
L_r_nsp_31:
    s_barrier
    buffer_load_dwordx4 v[96:99], v4, s[12:15], s61 offen offset:0 sc1
    buffer_load_dwordx4 v[100:103], v4, s[12:15], s61 offen offset:1024 sc1
    s_add_u32 s61, s61, 65536
    buffer_load_dwordx4 v[104:107], v4, s[12:15], s61 offen offset:0 sc1
    buffer_load_dwordx4 v[108:111], v4, s[12:15], s61 offen offset:1024 sc1
    s_add_u32 s61, s61, 65536
    buffer_load_dwordx4 v[112:115], v4, s[12:15], s61 offen offset:0 sc1
    buffer_load_dwordx4 v[116:119], v4, s[12:15], s61 offen offset:1024 sc1
    s_add_u32 s61, s61, 65536
    buffer_load_dwordx4 v[120:123], v4, s[12:15], s61 offen offset:0 sc1
    buffer_load_dwordx4 v[124:127], v4, s[12:15], s61 offen offset:1024 sc1
    buffer_load_dwordx4 a[0:3], v9, s[12:15], s63 offen sc1
    buffer_load_dwordx4 a[4:7], v9, s[12:15], s63 offen offset:1024 sc1
    s_waitcnt vmcnt(8)
    v_lshlrev_b32 v64, 16, v96
    v_and_b32 v65, 0xffff0000, v96
    v_lshlrev_b32 v66, 16, v97
    v_and_b32 v67, 0xffff0000, v97
    v_lshlrev_b32 v68, 16, v98
    v_and_b32 v69, 0xffff0000, v98
    v_lshlrev_b32 v70, 16, v99
    v_and_b32 v71, 0xffff0000, v99
    v_lshlrev_b32 v72, 16, v100
    v_and_b32 v73, 0xffff0000, v100
    v_lshlrev_b32 v74, 16, v101
    v_and_b32 v75, 0xffff0000, v101
    v_lshlrev_b32 v76, 16, v102
    v_and_b32 v77, 0xffff0000, v102
    v_lshlrev_b32 v78, 16, v103
    v_and_b32 v79, 0xffff0000, v103
    s_waitcnt vmcnt(6)
    v_lshlrev_b32 v14, 16, v104
    v_and_b32 v15, 0xffff0000, v104
    v_pk_add_f32 v[64:65], v[64:65], v[14:15]
    v_lshlrev_b32 v14, 16, v105
    v_and_b32 v15, 0xffff0000, v105
    v_pk_add_f32 v[66:67], v[66:67], v[14:15]
    v_lshlrev_b32 v14, 16, v106
    v_and_b32 v15, 0xffff0000, v106
    v_pk_add_f32 v[68:69], v[68:69], v[14:15]
    v_lshlrev_b32 v14, 16, v107
    v_and_b32 v15, 0xffff0000, v107
    v_pk_add_f32 v[70:71], v[70:71], v[14:15]
    v_lshlrev_b32 v14, 16, v108
    v_and_b32 v15, 0xffff0000, v108
    v_pk_add_f32 v[72:73], v[72:73], v[14:15]
    v_lshlrev_b32 v14, 16, v109
    v_and_b32 v15, 0xffff0000, v109
    v_pk_add_f32 v[74:75], v[74:75], v[14:15]
    v_lshlrev_b32 v14, 16, v110
    v_and_b32 v15, 0xffff0000, v110
    v_pk_add_f32 v[76:77], v[76:77], v[14:15]
    v_lshlrev_b32 v14, 16, v111
    v_and_b32 v15, 0xffff0000, v111
    v_pk_add_f32 v[78:79], v[78:79], v[14:15]
    s_waitcnt vmcnt(4)
    v_lshlrev_b32 v14, 16, v112
    v_and_b32 v15, 0xffff0000, v112
    v_pk_add_f32 v[64:65], v[64:65], v[14:15]
    v_lshlrev_b32 v14, 16, v113
    v_and_b32 v15, 0xffff0000, v113
    v_pk_add_f32 v[66:67], v[66:67], v[14:15]
    v_lshlrev_b32 v14, 16, v114
    v_and_b32 v15, 0xffff0000, v114
    v_pk_add_f32 v[68:69], v[68:69], v[14:15]
    v_lshlrev_b32 v14, 16, v115
    v_and_b32 v15, 0xffff0000, v115
    v_pk_add_f32 v[70:71], v[70:71], v[14:15]
    v_lshlrev_b32 v14, 16, v116
    v_and_b32 v15, 0xffff0000, v116
    v_pk_add_f32 v[72:73], v[72:73], v[14:15]
    v_lshlrev_b32 v14, 16, v117
    v_and_b32 v15, 0xffff0000, v117
    v_pk_add_f32 v[74:75], v[74:75], v[14:15]
    v_lshlrev_b32 v14, 16, v118
    v_and_b32 v15, 0xffff0000, v118
    v_pk_add_f32 v[76:77], v[76:77], v[14:15]
    v_lshlrev_b32 v14, 16, v119
    v_and_b32 v15, 0xffff0000, v119
    v_pk_add_f32 v[78:79], v[78:79], v[14:15]
    s_waitcnt vmcnt(2)
    v_lshlrev_b32 v14, 16, v120
    v_and_b32 v15, 0xffff0000, v120
    v_pk_add_f32 v[64:65], v[64:65], v[14:15]
    v_lshlrev_b32 v14, 16, v121
    v_and_b32 v15, 0xffff0000, v121
    v_pk_add_f32 v[66:67], v[66:67], v[14:15]
    v_lshlrev_b32 v14, 16, v122
    v_and_b32 v15, 0xffff0000, v122
    v_pk_add_f32 v[68:69], v[68:69], v[14:15]
    v_lshlrev_b32 v14, 16, v123
    v_and_b32 v15, 0xffff0000, v123
    v_pk_add_f32 v[70:71], v[70:71], v[14:15]
    v_lshlrev_b32 v14, 16, v124
    v_and_b32 v15, 0xffff0000, v124
    v_pk_add_f32 v[72:73], v[72:73], v[14:15]
    v_lshlrev_b32 v14, 16, v125
    v_and_b32 v15, 0xffff0000, v125
    v_pk_add_f32 v[74:75], v[74:75], v[14:15]
    v_lshlrev_b32 v14, 16, v126
    v_and_b32 v15, 0xffff0000, v126
    v_pk_add_f32 v[76:77], v[76:77], v[14:15]
    v_lshlrev_b32 v14, 16, v127
    v_and_b32 v15, 0xffff0000, v127
    v_pk_add_f32 v[78:79], v[78:79], v[14:15]
    ds_write_b32 v6, v64 offset:0
    ds_write_b32 v6, v65 offset:4096
    ds_write_b32 v6, v66 offset:8192
    ds_write_b32 v6, v67 offset:12288
    ds_write_b32 v6, v68 offset:16384
    ds_write_b32 v6, v69 offset:20480
    ds_write_b32 v6, v70 offset:24576
    ds_write_b32 v6, v71 offset:28672
    ds_write_b32 v6, v72 offset:256
    ds_write_b32 v6, v73 offset:4352
    ds_write_b32 v6, v74 offset:8448
    ds_write_b32 v6, v75 offset:12544
    ds_write_b32 v6, v76 offset:16640
    ds_write_b32 v6, v77 offset:20736
    ds_write_b32 v6, v78 offset:24832
    ds_write_b32 v6, v79 offset:28928
    s_waitcnt lgkmcnt(0)
    s_barrier
    ds_read_b128 v[64:67], v7
    ds_read_b128 v[68:71], v7 offset:16
    ds_read_b128 v[72:75], v7 offset:2048
    ds_read_b128 v[76:79], v7 offset:2064
    s_waitcnt vmcnt(0)
    v_accvgpr_read_b32 v96, a0
    v_accvgpr_read_b32 v97, a1
    v_accvgpr_read_b32 v98, a2
    v_accvgpr_read_b32 v99, a3
    v_accvgpr_read_b32 v100, a4
    v_accvgpr_read_b32 v101, a5
    v_accvgpr_read_b32 v102, a6
    v_accvgpr_read_b32 v103, a7
    v_lshlrev_b32 v80, 16, v96
    v_and_b32 v81, 0xffff0000, v96
    v_lshlrev_b32 v82, 16, v97
    v_and_b32 v83, 0xffff0000, v97
    v_lshlrev_b32 v84, 16, v98
    v_and_b32 v85, 0xffff0000, v98
    v_lshlrev_b32 v86, 16, v99
    v_and_b32 v87, 0xffff0000, v99
    v_lshlrev_b32 v88, 16, v100
    v_and_b32 v89, 0xffff0000, v100
    v_lshlrev_b32 v90, 16, v101
    v_and_b32 v91, 0xffff0000, v101
    v_lshlrev_b32 v92, 16, v102
    v_and_b32 v93, 0xffff0000, v102
    v_lshlrev_b32 v94, 16, v103
    v_and_b32 v95, 0xffff0000, v103
    s_waitcnt lgkmcnt(0)
    v_cvt_pk_bf16_f32 v64, 0, v64
    v_cvt_pk_bf16_f32 v65, 0, v65
    v_cvt_pk_bf16_f32 v66, 0, v66
    v_cvt_pk_bf16_f32 v67, 0, v67
    v_cvt_pk_bf16_f32 v68, 0, v68
    v_cvt_pk_bf16_f32 v69, 0, v69
    v_cvt_pk_bf16_f32 v70, 0, v70
    v_cvt_pk_bf16_f32 v71, 0, v71
    v_cvt_pk_bf16_f32 v72, 0, v72
    v_cvt_pk_bf16_f32 v73, 0, v73
    v_cvt_pk_bf16_f32 v74, 0, v74
    v_cvt_pk_bf16_f32 v75, 0, v75
    v_cvt_pk_bf16_f32 v76, 0, v76
    v_cvt_pk_bf16_f32 v77, 0, v77
    v_cvt_pk_bf16_f32 v78, 0, v78
    v_cvt_pk_bf16_f32 v79, 0, v79
    v_pk_add_f32 v[64:65], v[64:65], v[32:33]
    v_pk_add_f32 v[66:67], v[66:67], v[34:35]
    v_pk_add_f32 v[68:69], v[68:69], v[36:37]
    v_pk_add_f32 v[70:71], v[70:71], v[38:39]
    v_pk_add_f32 v[72:73], v[72:73], v[40:41]
    v_pk_add_f32 v[74:75], v[74:75], v[42:43]
    v_pk_add_f32 v[76:77], v[76:77], v[44:45]
    v_pk_add_f32 v[78:79], v[78:79], v[46:47]
    v_cvt_pk_bf16_f32 v64, 0, v64
    v_cvt_pk_bf16_f32 v65, 0, v65
    v_cvt_pk_bf16_f32 v66, 0, v66
    v_cvt_pk_bf16_f32 v67, 0, v67
    v_cvt_pk_bf16_f32 v68, 0, v68
    v_cvt_pk_bf16_f32 v69, 0, v69
    v_cvt_pk_bf16_f32 v70, 0, v70
    v_cvt_pk_bf16_f32 v71, 0, v71
    v_cvt_pk_bf16_f32 v72, 0, v72
    v_cvt_pk_bf16_f32 v73, 0, v73
    v_cvt_pk_bf16_f32 v74, 0, v74
    v_cvt_pk_bf16_f32 v75, 0, v75
    v_cvt_pk_bf16_f32 v76, 0, v76
    v_cvt_pk_bf16_f32 v77, 0, v77
    v_cvt_pk_bf16_f32 v78, 0, v78
    v_cvt_pk_bf16_f32 v79, 0, v79
    v_pk_mul_f32 v[64:65], v[64:65], v[16:17]
    v_pk_mul_f32 v[66:67], v[66:67], v[18:19]
    v_pk_mul_f32 v[68:69], v[68:69], v[20:21]
    v_pk_mul_f32 v[70:71], v[70:71], v[22:23]
    v_pk_mul_f32 v[72:73], v[72:73], v[24:25]
    v_pk_mul_f32 v[74:75], v[74:75], v[26:27]
    v_pk_mul_f32 v[76:77], v[76:77], v[28:29]
    v_pk_mul_f32 v[78:79], v[78:79], v[30:31]
    v_cvt_pk_bf16_f32 v64, 0, v64
    v_cvt_pk_bf16_f32 v65, 0, v65
    v_cvt_pk_bf16_f32 v66, 0, v66
    v_cvt_pk_bf16_f32 v67, 0, v67
    v_cvt_pk_bf16_f32 v68, 0, v68
    v_cvt_pk_bf16_f32 v69, 0, v69
    v_cvt_pk_bf16_f32 v70, 0, v70
    v_cvt_pk_bf16_f32 v71, 0, v71
    v_cvt_pk_bf16_f32 v72, 0, v72
    v_cvt_pk_bf16_f32 v73, 0, v73
    v_cvt_pk_bf16_f32 v74, 0, v74
    v_cvt_pk_bf16_f32 v75, 0, v75
    v_cvt_pk_bf16_f32 v76, 0, v76
    v_cvt_pk_bf16_f32 v77, 0, v77
    v_cvt_pk_bf16_f32 v78, 0, v78
    v_cvt_pk_bf16_f32 v79, 0, v79
    v_pk_add_f32 v[64:65], v[64:65], v[80:81]
    v_pk_add_f32 v[66:67], v[66:67], v[82:83]
    v_pk_add_f32 v[68:69], v[68:69], v[84:85]
    v_pk_add_f32 v[70:71], v[70:71], v[86:87]
    v_pk_add_f32 v[72:73], v[72:73], v[88:89]
    v_pk_add_f32 v[74:75], v[74:75], v[90:91]
    v_pk_add_f32 v[76:77], v[76:77], v[92:93]
    v_pk_add_f32 v[78:79], v[78:79], v[94:95]
    v_cvt_pk_bf16_f32 v96, v64, v65
    v_cvt_pk_bf16_f32 v97, v66, v67
    v_cvt_pk_bf16_f32 v98, v68, v69
    v_cvt_pk_bf16_f32 v99, v70, v71
    v_cvt_pk_bf16_f32 v100, v72, v73
    v_cvt_pk_bf16_f32 v101, v74, v75
    v_cvt_pk_bf16_f32 v102, v76, v77
    v_cvt_pk_bf16_f32 v103, v78, v79
    buffer_store_dwordx4 v[96:99], v8, s[24:27], s63 offen
    buffer_store_dwordx4 v[100:103], v8, s[24:27], s63 offen offset:1024
    s_add_u32 s60, s60, s78
    s_cmp_lt_u32 s60, s75
    s_cbranch_scc1 L_r_loop_30
    s_branch L_c_done_1
L_w_c_16:
    s_load_dwordx2 s[4:5], s[0:1], 0
    s_load_dwordx2 s[6:7], s[0:1], 88
    v_lshlrev_b32 v2, 4, v1
    v_lshlrev_b32 v3, 5, v1
    s_waitcnt lgkmcnt(0)
    s_mov_b32 s24, s4
    s_and_b32 s25, s5, 0xffff
    s_mov_b32 s26, 0x400000
    s_mov_b32 s27, 0x00020000
    s_mov_b32 s28, s6
    s_and_b32 s29, s7, 0xffff
    s_mov_b32 s30, 0x800
    s_mov_b32 s31, 0x00020000
    s_cmp_lg_u32 s44, 0
    s_cbranch_scc1 L_mw_34
    v_and_b32 v8, 15, v1
    v_lshlrev_b32 v8, 7, v8
    s_mov_b32 s46, 0x10e400
    s_mov_b32 s47, 0
    s_mov_b32 s70, 0
L_spin_35:
    buffer_load_dword v9, v8, s[12:15], s46 offen sc1
    s_waitcnt vmcnt(0)
    v_cmp_ge_u32 vcc, s47, v9
    s_add_u32 s70, s70, 1
    s_cbranch_vccz L_spok_36
    s_sleep 2
    s_cmp_lt_u32 s70, 524288
    s_cbranch_scc1 L_spin_35
    s_branch L_c_done_1
L_spok_36:
L_mw_34:
    s_barrier
    s_mov_b32 s46, 8192
    buffer_load_dwordx4 v[16:19], v3, s[12:15], s46 offen offset:0 sc1
    buffer_load_dwordx4 v[20:23], v3, s[12:15], s46 offen offset:16 sc1
    buffer_load_dwordx4 v[24:27], v3, s[12:15], s46 offen offset:2048 sc1
    buffer_load_dwordx4 v[28:31], v3, s[12:15], s46 offen offset:2064 sc1
    s_mov_b32 s46, 16384
    buffer_load_dwordx4 v[32:35], v3, s[12:15], s46 offen offset:0 sc1
    buffer_load_dwordx4 v[36:39], v3, s[12:15], s46 offen offset:16 sc1
    buffer_load_dwordx4 v[40:43], v3, s[12:15], s46 offen offset:2048 sc1
    buffer_load_dwordx4 v[44:47], v3, s[12:15], s46 offen offset:2064 sc1
    s_mov_b32 s46, 12288
    buffer_load_dwordx4 v[48:51], v3, s[12:15], s46 offen offset:0 sc1
    buffer_load_dwordx4 v[52:55], v3, s[12:15], s46 offen offset:16 sc1
    buffer_load_dwordx4 v[56:59], v3, s[12:15], s46 offen offset:2048 sc1
    buffer_load_dwordx4 v[60:63], v3, s[12:15], s46 offen offset:2064 sc1
    s_waitcnt vmcnt(0)
    v_add_f32 v32, 1.0, v32
    v_add_f32 v33, 1.0, v33
    v_add_f32 v34, 1.0, v34
    v_add_f32 v35, 1.0, v35
    v_add_f32 v36, 1.0, v36
    v_add_f32 v37, 1.0, v37
    v_add_f32 v38, 1.0, v38
    v_add_f32 v39, 1.0, v39
    v_add_f32 v40, 1.0, v40
    v_add_f32 v41, 1.0, v41
    v_add_f32 v42, 1.0, v42
    v_add_f32 v43, 1.0, v43
    v_add_f32 v44, 1.0, v44
    v_add_f32 v45, 1.0, v45
    v_add_f32 v46, 1.0, v46
    v_add_f32 v47, 1.0, v47
    v_cvt_pk_bf16_f32 v32, 0, v32
    v_cvt_pk_bf16_f32 v33, 0, v33
    v_cvt_pk_bf16_f32 v34, 0, v34
    v_cvt_pk_bf16_f32 v35, 0, v35
    v_cvt_pk_bf16_f32 v36, 0, v36
    v_cvt_pk_bf16_f32 v37, 0, v37
    v_cvt_pk_bf16_f32 v38, 0, v38
    v_cvt_pk_bf16_f32 v39, 0, v39
    v_cvt_pk_bf16_f32 v40, 0, v40
    v_cvt_pk_bf16_f32 v41, 0, v41
    v_cvt_pk_bf16_f32 v42, 0, v42
    v_cvt_pk_bf16_f32 v43, 0, v43
    v_cvt_pk_bf16_f32 v44, 0, v44
    v_cvt_pk_bf16_f32 v45, 0, v45
    v_cvt_pk_bf16_f32 v46, 0, v46
    v_cvt_pk_bf16_f32 v47, 0, v47
    s_lshl_b32 s46, s42, 14
    s_lshl_b32 s47, s44, 11
    s_add_u32 s46, s46, s47
    s_add_u32 s46, s46, 0x9000000
    v_add_u32 v4, s46, v2
    v_and_b32 v5, 31, v1
    v_lshlrev_b32 v5, 7, v5
    v_add_u32 v5, 0x107400, v5
    v_lshlrev_b32 v6, 2, v1
    s_lshl_b32 s46, s44, 9
    v_add_u32 v6, s46, v6
    s_lshl_b32 s46, s44, 12
    v_add_u32 v7, s46, v3
    s_lshl_b32 s46, s42, 3
    s_add_u32 s46, s46, s44
    s_lshl_b32 s46, s46, 11
    v_add_u32 v8, s46, v2
    v_add_u32 v9, 0x800000, v8
    s_mul_i32 s46, s44, 2064
    s_add_u32 s46, s46, 32768
    v_add_u32 v10, s46, v2
    v_and_b32 v11, 7, v1
    v_lshrrev_b32 v12, 3, v1
    v_mul_u32_u24 v13, 2064, v11
    v_lshl_add_u32 v13, v12, 4, v13
    s_lshl_b32 s46, s44, 8
    s_add_u32 s46, s46, 32768
    v_add_u32 v13, s46, v13
    v_lshlrev_b32 v11, 4, v11
    v_lshl_add_u32 v11, v12, 9, v11
    s_lshl_b32 s46, s44, 13
    s_lshl_b32 s47, s42, 7
    s_add_u32 s46, s46, s47
    s_add_u32 s46, s46, 0xc00000
    v_add_u32 v11, s46, v11
    v_add_u32 v12, 4096, v11
    s_lshl_b32 s52, s43, 9
    s_lshl_b32 s47, s42, 7
    s_add_u32 s52, s52, s47
    s_add_u32 s52, s52, 0x10ec00
    s_mov_b32 s60, s43
L_r_loop_37:
    s_lshl_b32 s61, s60, 18
    s_lshl_b32 s63, s60, 16
    buffer_load_dwordx4 a[0:3], v8, s[24:27], s63 offen
    buffer_load_dwordx4 a[4:7], v8, s[24:27], s63 offen offset:1024
    s_cmp_lg_u32 s44, 0
    s_cbranch_scc1 L_r_nsp_38
    s_mov_b32 s70, 0
L_spin_39:
    buffer_load_dword v14, v5, s[12:15], 0 offen sc1
    s_waitcnt vmcnt(0)
    v_cmp_ge_u32 vcc, s60, v14
    s_add_u32 s70, s70, 1
    s_cbranch_vccz L_spok_40
    s_sleep 3
    s_cmp_lt_u32 s70, 524288
    s_cbranch_scc1 L_spin_39
    s_branch L_c_done_1
L_spok_40:
L_r_nsp_38:
    s_barrier
    buffer_load_dwordx4 v[96:99], v4, s[12:15], s61 offen offset:0 sc1
    buffer_load_dwordx4 v[100:103], v4, s[12:15], s61 offen offset:1024 sc1
    s_add_u32 s61, s61, 65536
    buffer_load_dwordx4 v[104:107], v4, s[12:15], s61 offen offset:0 sc1
    buffer_load_dwordx4 v[108:111], v4, s[12:15], s61 offen offset:1024 sc1
    s_add_u32 s61, s61, 65536
    buffer_load_dwordx4 v[112:115], v4, s[12:15], s61 offen offset:0 sc1
    buffer_load_dwordx4 v[116:119], v4, s[12:15], s61 offen offset:1024 sc1
    s_add_u32 s61, s61, 65536
    buffer_load_dwordx4 v[120:123], v4, s[12:15], s61 offen offset:0 sc1
    buffer_load_dwordx4 v[124:127], v4, s[12:15], s61 offen offset:1024 sc1
    s_waitcnt vmcnt(8)
    v_accvgpr_read_b32 v64, a0
    v_accvgpr_read_b32 v65, a1
    v_accvgpr_read_b32 v66, a2
    v_accvgpr_read_b32 v67, a3
    v_accvgpr_read_b32 v68, a4
    v_accvgpr_read_b32 v69, a5
    v_accvgpr_read_b32 v70, a6
    v_accvgpr_read_b32 v71, a7
    v_lshlrev_b32 v80, 16, v64
    v_and_b32 v81, 0xffff0000, v64
    v_lshlrev_b32 v82, 16, v65
    v_and_b32 v83, 0xffff0000, v65
    v_lshlrev_b32 v84, 16, v66
    v_and_b32 v85, 0xffff0000, v66
    v_lshlrev_b32 v86, 16, v67
    v_and_b32 v87, 0xffff0000, v67
    v_lshlrev_b32 v88, 16, v68
    v_and_b32 v89, 0xffff0000, v68
    v_lshlrev_b32 v90, 16, v69
    v_and_b32 v91, 0xffff0000, v69
    v_lshlrev_b32 v92, 16, v70
    v_and_b32 v93, 0xffff0000, v70
    v_lshlrev_b32 v94, 16, v71
    v_and_b32 v95, 0xffff0000, v71
    s_waitcnt vmcnt(6)
    v_lshlrev_b32 v64, 16, v96
    v_and_b32 v65, 0xffff0000, v96
    v_lshlrev_b32 v66, 16, v97
    v_and_b32 v67, 0xffff0000, v97
    v_lshlrev_b32 v68, 16, v98
    v_and_b32 v69, 0xffff0000, v98
    v_lshlrev_b32 v70, 16, v99
    v_and_b32 v71, 0xffff0000, v99
    v_lshlrev_b32 v72, 16, v100
    v_and_b32 v73, 0xffff0000, v100
    v_lshlrev_b32 v74, 16, v101
    v_and_b32 v75, 0xffff0000, v101
    v_lshlrev_b32 v76, 16, v102
    v_and_b32 v77, 0xffff0000, v102
    v_lshlrev_b32 v78, 16, v103
    v_and_b32 v79, 0xffff0000, v103
    s_waitcnt vmcnt(4)
    v_lshlrev_b32 v14, 16, v104
    v_and_b32 v15, 0xffff0000, v104
    v_pk_add_f32 v[64:65], v[64:65], v[14:15]
    v_lshlrev_b32 v14, 16, v105
    v_and_b32 v15, 0xffff0000, v105
    v_pk_add_f32 v[66:67], v[66:67], v[14:15]
    v_lshlrev_b32 v14, 16, v106
    v_and_b32 v15, 0xffff0000, v106
    v_pk_add_f32 v[68:69], v[68:69], v[14:15]
    v_lshlrev_b32 v14, 16, v107
    v_and_b32 v15, 0xffff0000, v107
    v_pk_add_f32 v[70:71], v[70:71], v[14:15]
    v_lshlrev_b32 v14, 16, v108
    v_and_b32 v15, 0xffff0000, v108
    v_pk_add_f32 v[72:73], v[72:73], v[14:15]
    v_lshlrev_b32 v14, 16, v109
    v_and_b32 v15, 0xffff0000, v109
    v_pk_add_f32 v[74:75], v[74:75], v[14:15]
    v_lshlrev_b32 v14, 16, v110
    v_and_b32 v15, 0xffff0000, v110
    v_pk_add_f32 v[76:77], v[76:77], v[14:15]
    v_lshlrev_b32 v14, 16, v111
    v_and_b32 v15, 0xffff0000, v111
    v_pk_add_f32 v[78:79], v[78:79], v[14:15]
    s_waitcnt vmcnt(2)
    v_lshlrev_b32 v14, 16, v112
    v_and_b32 v15, 0xffff0000, v112
    v_pk_add_f32 v[64:65], v[64:65], v[14:15]
    v_lshlrev_b32 v14, 16, v113
    v_and_b32 v15, 0xffff0000, v113
    v_pk_add_f32 v[66:67], v[66:67], v[14:15]
    v_lshlrev_b32 v14, 16, v114
    v_and_b32 v15, 0xffff0000, v114
    v_pk_add_f32 v[68:69], v[68:69], v[14:15]
    v_lshlrev_b32 v14, 16, v115
    v_and_b32 v15, 0xffff0000, v115
    v_pk_add_f32 v[70:71], v[70:71], v[14:15]
    v_lshlrev_b32 v14, 16, v116
    v_and_b32 v15, 0xffff0000, v116
    v_pk_add_f32 v[72:73], v[72:73], v[14:15]
    v_lshlrev_b32 v14, 16, v117
    v_and_b32 v15, 0xffff0000, v117
    v_pk_add_f32 v[74:75], v[74:75], v[14:15]
    v_lshlrev_b32 v14, 16, v118
    v_and_b32 v15, 0xffff0000, v118
    v_pk_add_f32 v[76:77], v[76:77], v[14:15]
    v_lshlrev_b32 v14, 16, v119
    v_and_b32 v15, 0xffff0000, v119
    v_pk_add_f32 v[78:79], v[78:79], v[14:15]
    s_waitcnt vmcnt(0)
    v_lshlrev_b32 v14, 16, v120
    v_and_b32 v15, 0xffff0000, v120
    v_pk_add_f32 v[64:65], v[64:65], v[14:15]
    v_lshlrev_b32 v14, 16, v121
    v_and_b32 v15, 0xffff0000, v121
    v_pk_add_f32 v[66:67], v[66:67], v[14:15]
    v_lshlrev_b32 v14, 16, v122
    v_and_b32 v15, 0xffff0000, v122
    v_pk_add_f32 v[68:69], v[68:69], v[14:15]
    v_lshlrev_b32 v14, 16, v123
    v_and_b32 v15, 0xffff0000, v123
    v_pk_add_f32 v[70:71], v[70:71], v[14:15]
    v_lshlrev_b32 v14, 16, v124
    v_and_b32 v15, 0xffff0000, v124
    v_pk_add_f32 v[72:73], v[72:73], v[14:15]
    v_lshlrev_b32 v14, 16, v125
    v_and_b32 v15, 0xffff0000, v125
    v_pk_add_f32 v[74:75], v[74:75], v[14:15]
    v_lshlrev_b32 v14, 16, v126
    v_and_b32 v15, 0xffff0000, v126
    v_pk_add_f32 v[76:77], v[76:77], v[14:15]
    v_lshlrev_b32 v14, 16, v127
    v_and_b32 v15, 0xffff0000, v127
    v_pk_add_f32 v[78:79], v[78:79], v[14:15]
    ds_write_b32 v6, v64 offset:0
    ds_write_b32 v6, v65 offset:4096
    ds_write_b32 v6, v66 offset:8192
    ds_write_b32 v6, v67 offset:12288
    ds_write_b32 v6, v68 offset:16384
    ds_write_b32 v6, v69 offset:20480
    ds_write_b32 v6, v70 offset:24576
    ds_write_b32 v6, v71 offset:28672
    ds_write_b32 v6, v72 offset:256
    ds_write_b32 v6, v73 offset:4352
    ds_write_b32 v6, v74 offset:8448
    ds_write_b32 v6, v75 offset:12544
    ds_write_b32 v6, v76 offset:16640
    ds_write_b32 v6, v77 offset:20736
    ds_write_b32 v6, v78 offset:24832
    ds_write_b32 v6, v79 offset:28928
    s_waitcnt lgkmcnt(0)
    s_barrier
    ds_read_b128 v[64:67], v7
    ds_read_b128 v[68:71], v7 offset:16
    ds_read_b128 v[72:75], v7 offset:2048
    ds_read_b128 v[76:79], v7 offset:2064
    s_waitcnt vmcnt(0)
    s_waitcnt lgkmcnt(0)
    v_cvt_pk_bf16_f32 v64, 0, v64
    v_cvt_pk_bf16_f32 v65, 0, v65
    v_cvt_pk_bf16_f32 v66, 0, v66
    v_cvt_pk_bf16_f32 v67, 0, v67
    v_cvt_pk_bf16_f32 v68, 0, v68
    v_cvt_pk_bf16_f32 v69, 0, v69
    v_cvt_pk_bf16_f32 v70, 0, v70
    v_cvt_pk_bf16_f32 v71, 0, v71
    v_cvt_pk_bf16_f32 v72, 0, v72
    v_cvt_pk_bf16_f32 v73, 0, v73
    v_cvt_pk_bf16_f32 v74, 0, v74
    v_cvt_pk_bf16_f32 v75, 0, v75
    v_cvt_pk_bf16_f32 v76, 0, v76
    v_cvt_pk_bf16_f32 v77, 0, v77
    v_cvt_pk_bf16_f32 v78, 0, v78
    v_cvt_pk_bf16_f32 v79, 0, v79
    v_pk_mul_f32 v[64:65], v[64:65], v[16:17]
    v_pk_mul_f32 v[66:67], v[66:67], v[18:19]
    v_pk_mul_f32 v[68:69], v[68:69], v[20:21]
    v_pk_mul_f32 v[70:71], v[70:71], v[22:23]
    v_pk_mul_f32 v[72:73], v[72:73], v[24:25]
    v_pk_mul_f32 v[74:75], v[74:75], v[26:27]
    v_pk_mul_f32 v[76:77], v[76:77], v[28:29]
    v_pk_mul_f32 v[78:79], v[78:79], v[30:31]
    v_cvt_pk_bf16_f32 v64, 0, v64
    v_cvt_pk_bf16_f32 v65, 0, v65
    v_cvt_pk_bf16_f32 v66, 0, v66
    v_cvt_pk_bf16_f32 v67, 0, v67
    v_cvt_pk_bf16_f32 v68, 0, v68
    v_cvt_pk_bf16_f32 v69, 0, v69
    v_cvt_pk_bf16_f32 v70, 0, v70
    v_cvt_pk_bf16_f32 v71, 0, v71
    v_cvt_pk_bf16_f32 v72, 0, v72
    v_cvt_pk_bf16_f32 v73, 0, v73
    v_cvt_pk_bf16_f32 v74, 0, v74
    v_cvt_pk_bf16_f32 v75, 0, v75
    v_cvt_pk_bf16_f32 v76, 0, v76
    v_cvt_pk_bf16_f32 v77, 0, v77
    v_cvt_pk_bf16_f32 v78, 0, v78
    v_cvt_pk_bf16_f32 v79, 0, v79
    v_pk_add_f32 v[64:65], v[64:65], v[80:81]
    v_pk_add_f32 v[66:67], v[66:67], v[82:83]
    v_pk_add_f32 v[68:69], v[68:69], v[84:85]
    v_pk_add_f32 v[70:71], v[70:71], v[86:87]
    v_pk_add_f32 v[72:73], v[72:73], v[88:89]
    v_pk_add_f32 v[74:75], v[74:75], v[90:91]
    v_pk_add_f32 v[76:77], v[76:77], v[92:93]
    v_pk_add_f32 v[78:79], v[78:79], v[94:95]
    v_cvt_pk_bf16_f32 v96, v64, v65
    v_cvt_pk_bf16_f32 v97, v66, v67
    v_cvt_pk_bf16_f32 v98, v68, v69
    v_cvt_pk_bf16_f32 v99, v70, v71
    v_cvt_pk_bf16_f32 v100, v72, v73
    v_cvt_pk_bf16_f32 v101, v74, v75
    v_cvt_pk_bf16_f32 v102, v76, v77
    v_cvt_pk_bf16_f32 v103, v78, v79
    buffer_store_dwordx4 v[96:99], v9, s[12:15], s63 offen sc1
    buffer_store_dwordx4 v[100:103], v9, s[12:15], s63 offen offset:1024 sc1
    v_lshlrev_b32 v64, 16, v96
    v_and_b32 v65, 0xffff0000, v96
    v_lshlrev_b32 v66, 16, v97
    v_and_b32 v67, 0xffff0000, v97
    v_lshlrev_b32 v68, 16, v98
    v_and_b32 v69, 0xffff0000, v98
    v_lshlrev_b32 v70, 16, v99
    v_and_b32 v71, 0xffff0000, v99
    v_lshlrev_b32 v72, 16, v100
    v_and_b32 v73, 0xffff0000, v100
    v_lshlrev_b32 v74, 16, v101
    v_and_b32 v75, 0xffff0000, v101
    v_lshlrev_b32 v76, 16, v102
    v_and_b32 v77, 0xffff0000, v102
    v_lshlrev_b32 v78, 16, v103
    v_and_b32 v79, 0xffff0000, v103
    v_pk_add_f32 v[80:81], v[64:65], v[72:73]
    v_pk_add_f32 v[82:83], v[66:67], v[74:75]
    v_pk_add_f32 v[84:85], v[68:69], v[76:77]
    v_pk_add_f32 v[86:87], v[70:71], v[78:79]
    v_pk_add_f32 v[80:81], v[80:81], v[84:85]
    v_pk_add_f32 v[82:83], v[82:83], v[86:87]
    v_pk_add_f32 v[80:81], v[80:81], v[82:83]
    v_add_f32 v14, v80, v81
    s_nop 1
    v_add_f32_dpp v14, v14, v14 row_shr:1 row_mask:0xf bank_mask:0xf bound_ctrl:0
    s_nop 1
    v_add_f32_dpp v14, v14, v14 row_shr:2 row_mask:0xf bank_mask:0xf bound_ctrl:0
    s_nop 1
    v_add_f32_dpp v14, v14, v14 row_shr:4 row_mask:0xf bank_mask:0xf bound_ctrl:0
    s_nop 1
    v_add_f32_dpp v14, v14, v14 row_shr:8 row_mask:0xf bank_mask:0xf bound_ctrl:0
    s_nop 1
    v_add_f32_dpp v14, v14, v14 row_bcast:15 row_mask:0xa bank_mask:0xf
    s_nop 1
    v_add_f32_dpp v14, v14, v14 row_bcast:31 row_mask:0xc bank_mask:0xf
    s_nop 1
    v_readlane_b32 s46, v14, 63
    s_nop 1
    v_mov_b32 v15, s46
    v_mul_f32 v15, 0x3a800000, v15
    v_pk_add_f32 v[80:81], v[64:65], v[14:15] op_sel:[0,1] op_sel_hi:[1,1] neg_lo:[0,1] neg_hi:[0,1]
    v_pk_add_f32 v[82:83], v[66:67], v[14:15] op_sel:[0,1] op_sel_hi:[1,1] neg_lo:[0,1] neg_hi:[0,1]
    v_pk_add_f32 v[84:85], v[68:69], v[14:15] op_sel:[0,1] op_sel_hi:[1,1] neg_lo:[0,1] neg_hi:[0,1]
    v_pk_add_f32 v[86:87], v[70:71], v[14:15] op_sel:[0,1] op_sel_hi:[1,1] neg_lo:[0,1] neg_hi:[0,1]
    v_pk_add_f32 v[88:89], v[72:73], v[14:15] op_sel:[0,1] op_sel_hi:[1,1] neg_lo:[0,1] neg_hi:[0,1]
    v_pk_add_f32 v[90:91], v[74:75], v[14:15] op_sel:[0,1] op_sel_hi:[1,1] neg_lo:[0,1] neg_hi:[0,1]
    v_pk_add_f32 v[92:93], v[76:77], v[14:15] op_sel:[0,1] op_sel_hi:[1,1] neg_lo:[0,1] neg_hi:[0,1]
    v_pk_add_f32 v[94:95], v[78:79], v[14:15] op_sel:[0,1] op_sel_hi:[1,1] neg_lo:[0,1] neg_hi:[0,1]
    v_pk_mul_f32 v[104:105], v[80:81], v[80:81]
    v_pk_mul_f32 v[106:107], v[82:83], v[82:83]
    v_pk_fma_f32 v[104:105], v[84:85], v[84:85], v[104:105]
    v_pk_fma_f32 v[106:107], v[86:87], v[86:87], v[106:107]
    v_pk_fma_f32 v[104:105], v[88:89], v[88:89], v[104:105]
    v_pk_fma_f32 v[106:107], v[90:91], v[90:91], v[106:107]
    v_pk_fma_f32 v[104:105], v[92:93], v[92:93], v[104:105]
    v_pk_fma_f32 v[106:107], v[94:95], v[94:95], v[106:107]
    v_pk_add_f32 v[104:105], v[104:105], v[106:107]
    v_add_f32 v14, v104, v105
    v_cvt_pk_bf16_f32 v15, 0, v15
    s_nop 1
    v_add_f32_dpp v14, v14, v14 row_shr:1 row_mask:0xf bank_mask:0xf bound_ctrl:0
    s_nop 1
    v_add_f32_dpp v14, v14, v14 row_shr:2 row_mask:0xf bank_mask:0xf bound_ctrl:0
    s_nop 1
    v_add_f32_dpp v14, v14, v14 row_shr:4 row_mask:0xf bank_mask:0xf bound_ctrl:0
    s_nop 1
    v_add_f32_dpp v14, v14, v14 row_shr:8 row_mask:0xf bank_mask:0xf bound_ctrl:0
    s_nop 1
    v_add_f32_dpp v14, v14, v14 row_bcast:15 row_mask:0xa bank_mask:0xf
    s_nop 1
    v_add_f32_dpp v14, v14, v14 row_bcast:31 row_mask:0xc bank_mask:0xf
    s_nop 1
    v_readlane_b32 s47, v14, 63
    v_pk_add_f32 v[64:65], v[64:65], v[14:15] op_sel:[0,1] op_sel_hi:[1,1] neg_lo:[0,1] neg_hi:[0,1]
    v_pk_add_f32 v[66:67], v[66:67], v[14:15] op_sel:[0,1] op_sel_hi:[1,1] neg_lo:[0,1] neg_hi:[0,1]
    v_pk_add_f32 v[68:69], v[68:69], v[14:15] op_sel:[0,1] op_sel_hi:[1,1] neg_lo:[0,1] neg_hi:[0,1]
    v_pk_add_f32 v[70:71], v[70:71], v[14:15] op_sel:[0,1] op_sel_hi:[1,1] neg_lo:[0,1] neg_hi:[0,1]
    v_pk_add_f32 v[72:73], v[72:73], v[14:15] op_sel:[0,1] op_sel_hi:[1,1] neg_lo:[0,1] neg_hi:[0,1]
    v_pk_add_f32 v[74:75], v[74:75], v[14:15] op_sel:[0,1] op_sel_hi:[1,1] neg_lo:[0,1] neg_hi:[0,1]
    v_pk_add_f32 v[76:77], v[76:77], v[14:15] op_sel:[0,1] op_sel_hi:[1,1] neg_lo:[0,1] neg_hi:[0,1]
    v_pk_add_f32 v[78:79], v[78:79], v[14:15] op_sel:[0,1] op_sel_hi:[1,1] neg_lo:[0,1] neg_hi:[0,1]
    v_mov_b32 v14, s47
    v_mul_f32 v14, 0x3a800000, v14
    v_cvt_pk_bf16_f32 v14, 0, v14
    v_add_f32 v14, 0x3727c5ac, v14
    v_cvt_pk_bf16_f32 v14, 0, v14
    v_sqrt_f32 v14, v14
    s_nop 0
    v_cvt_pk_bf16_f32 v14, 0, v14
    v_rcp_f32 v14, v14
    v_cvt_pk_bf16_f32 v64, 0, v64
    v_cvt_pk_bf16_f32 v65, 0, v65
    v_cvt_pk_bf16_f32 v66, 0, v66
    v_cvt_pk_bf16_f32 v67, 0, v67
    v_cvt_pk_bf16_f32 v68, 0, v68
    v_cvt_pk_bf16_f32 v69, 0, v69
    v_cvt_pk_bf16_f32 v70, 0, v70
    v_cvt_pk_bf16_f32 v71, 0, v71
    v_cvt_pk_bf16_f32 v72, 0, v72
    v_cvt_pk_bf16_f32 v73, 0, v73
    v_cvt_pk_bf16_f32 v74, 0, v74
    v_cvt_pk_bf16_f32 v75, 0, v75
    v_cvt_pk_bf16_f32 v76, 0, v76
    v_cvt_pk_bf16_f32 v77, 0, v77
    v_cvt_pk_bf16_f32 v78, 0, v78
    v_cvt_pk_bf16_f32 v79, 0, v79
    v_pk_mul_f32 v[64:65], v[64:65], v[14:15] op_sel_hi:[1,0]
    v_pk_mul_f32 v[66:67], v[66:67], v[14:15] op_sel_hi:[1,0]
    v_pk_mul_f32 v[68:69], v[68:69], v[14:15] op_sel_hi:[1,0]
    v_pk_mul_f32 v[70:71], v[70:71], v[14:15] op_sel_hi:[1,0]
    v_pk_mul_f32 v[72:73], v[72:73], v[14:15] op_sel_hi:[1,0]
    v_pk_mul_f32 v[74:75], v[74:75], v[14:15] op_sel_hi:[1,0]
    v_pk_mul_f32 v[76:77], v[76:77], v[14:15] op_sel_hi:[1,0]
    v_pk_mul_f32 v[78:79], v[78:79], v[14:15] op_sel_hi:[1,0]
    v_cvt_pk_bf16_f32 v64, 0, v64
    v_cvt_pk_bf16_f32 v65, 0, v65
    v_cvt_pk_bf16_f32 v66, 0, v66
    v_cvt_pk_bf16_f32 v67, 0, v67
    v_cvt_pk_bf16_f32 v68, 0, v68
    v_cvt_pk_bf16_f32 v69, 0, v69
    v_cvt_pk_bf16_f32 v70, 0, v70
    v_cvt_pk_bf16_f32 v71, 0, v71
    v_cvt_pk_bf16_f32 v72, 0, v72
    v_cvt_pk_bf16_f32 v73, 0, v73
    v_cvt_pk_bf16_f32 v74, 0, v74
    v_cvt_pk_bf16_f32 v75, 0, v75
    v_cvt_pk_bf16_f32 v76, 0, v76
    v_cvt_pk_bf16_f32 v77, 0, v77
    v_cvt_pk_bf16_f32 v78, 0, v78
    v_cvt_pk_bf16_f32 v79, 0, v79
    v_pk_mul_f32 v[64:65], v[64:65], v[32:33]
    v_pk_mul_f32 v[66:67], v[66:67], v[34:35]
    v_pk_mul_f32 v[68:69], v[68:69], v[36:37]
    v_pk_mul_f32 v[70:71], v[70:71], v[38:39]
    v_pk_mul_f32 v[72:73], v[72:73], v[40:41]
    v_pk_mul_f32 v[74:75], v[74:75], v[42:43]
    v_pk_mul_f32 v[76:77], v[76:77], v[44:45]
    v_pk_mul_f32 v[78:79], v[78:79], v[46:47]
    v_cvt_pk_bf16_f32 v64, 0, v64
    v_cvt_pk_bf16_f32 v65, 0, v65
    v_cvt_pk_bf16_f32 v66, 0, v66
    v_cvt_pk_bf16_f32 v67, 0, v67
    v_cvt_pk_bf16_f32 v68, 0, v68
    v_cvt_pk_bf16_f32 v69, 0, v69
    v_cvt_pk_bf16_f32 v70, 0, v70
    v_cvt_pk_bf16_f32 v71, 0, v71
    v_cvt_pk_bf16_f32 v72, 0, v72
    v_cvt_pk_bf16_f32 v73, 0, v73
    v_cvt_pk_bf16_f32 v74, 0, v74
    v_cvt_pk_bf16_f32 v75, 0, v75
    v_cvt_pk_bf16_f32 v76, 0, v76
    v_cvt_pk_bf16_f32 v77, 0, v77
    v_cvt_pk_bf16_f32 v78, 0, v78
    v_cvt_pk_bf16_f32 v79, 0, v79
    v_pk_add_f32 v[64:65], v[64:65], v[48:49]
    v_pk_add_f32 v[66:67], v[66:67], v[50:51]
    v_pk_add_f32 v[68:69], v[68:69], v[52:53]
    v_pk_add_f32 v[70:71], v[70:71], v[54:55]
    v_pk_add_f32 v[72:73], v[72:73], v[56:57]
    v_pk_add_f32 v[74:75], v[74:75], v[58:59]
    v_pk_add_f32 v[76:77], v[76:77], v[60:61]
    v_pk_add_f32 v[78:79], v[78:79], v[62:63]
    v_cvt_pk_bf16_f32 v104, v64, v65
    v_cvt_pk_bf16_f32 v105, v66, v67
    v_cvt_pk_bf16_f32 v106, v68, v69
    v_cvt_pk_bf16_f32 v107, v70, v71
    v_cvt_pk_bf16_f32 v108, v72, v73
    v_cvt_pk_bf16_f32 v109, v74, v75
    v_cvt_pk_bf16_f32 v110, v76, v77
    v_cvt_pk_bf16_f32 v111, v78, v79
    ds_write_b128 v10, v[104:107]
    ds_write_b128 v10, v[108:111] offset:1024
    s_waitcnt lgkmcnt(0)
    s_barrier
    ds_read_b128 v[104:107], v13
    ds_read_b128 v[108:111], v13 offset:128
    s_waitcnt lgkmcnt(1)
    buffer_store_dwordx4 v[104:107], v11, s[12:15], s63 offen sc1
    s_waitcnt lgkmcnt(0)
    buffer_store_dwordx4 v[108:111], v12, s[12:15], s63 offen sc1
    s_waitcnt vmcnt(0)
    s_barrier
    s_cmp_lg_u32 s44, 0
    s_cbranch_scc1 L_sf_41
    v_mov_b32 v14, s60
    v_add_u32 v14, 1, v14
    v_mov_b32 v15, 0
    s_mov_b64 exec, 1
    buffer_store_dword v14, v15, s[12:15], s52 offen sc1
    s_mov_b64 exec, -1
L_sf_41:
    s_add_u32 s60, s60, 3
    s_cmp_lt_u32 s60, 64
    s_cbranch_scc1 L_r_loop_37
    s_branch L_c_done_1
L_w_att_15:
    s_lshl_b32 s42, s40, 2
    s_and_b32 s46, s44, 3
    s_add_u32 s42, s42, s46
    s_and_b32 s43, s48, 1
    s_lshl_b32 s43, s43, 1
    s_lshr_b32 s46, s44, 2
    s_add_u32 s43, s43, s46
    s_mul_i32 s46, s42, 24576
    s_add_u32 s46, s46, 0x2000000
    v_lshlrev_b32 v2, 4, v1
    v_add_u32 v3, s46, v2
    v_add_u32 v5, 4096, v3
    v_lshrrev_b32 v4, 4, v1
    v_and_b32 v9, 15, v1
    s_lshl_b32 s46, s42, 12
    s_add_u32 s46, s46, 0x1000000
    v_and_b32 v6, 7, v1
    v_lshlrev_b32 v6, 4, v6
    v_lshl_add_u32 v6, v4, 7, v6
    v_add_u32 v6, s46, v6
    v_and_b32 v7, 31, v1
    v_lshlrev_b32 v7, 4, v7
    v_lshrrev_b32 v10, 5, v1
    v_lshl_add_u32 v7, v10, 10, v7
    v_add_u32 v7, s46, v7
    s_mul_i32 s50, s44, 13056
    v_mul_u32_u24 v8, 272, v9
    v_lshl_add_u32 v8, v4, 4, v8
    v_add_u32 v8, s50, v8
    v_bfe_u32 v11, v1, 2, 3
    v_mul_u32_u24 v11, 272, v11
    v_lshl_add_u32 v11, v10, 6, v11
    v_and_b32 v12, 3, v1
    v_lshl_add_u32 v11, v12, 4, v11
    v_add_u32 v11, s50, v11
    v_mul_u32_u24 v14, 272, v4
    v_lshl_add_u32 v14, v9, 4, v14
    v_add_u32 v14, s50, v14
    v_mov_b32 v16, 0
    v_mov_b32 v17, 0
    v_mov_b32 v18, 0
    v_mov_b32 v19, 0
    ds_write_b128 v14, v[16:19] offset:10880
    ds_write_b128 v14, v[16:19] offset:11968
    v_lshlrev_b32 v12, 2, v4
    v_bfe_u32 v13, v1, 2, 2
    v_add_u32 v12, v12, v13
    v_mul_u32_u24 v12, 272, v12
    v_and_b32 v13, 3, v1
    v_lshl_add_u32 v12, v13, 3, v12
    v_add_u32 v12, s50, v12
    v_lshlrev_b32 v13, 10, v13
    s_lshl_b32 s46, s42, 12
    s_add_u32 s46, s46, 0x1000000
    v_add_u32 v13, s46, v13
    v_lshlrev_b32 v10, 9, v4
    v_lshl_add_u32 v10, v9, 4, v10
    s_lshl_b32 s46, s42, 13
    s_add_u32 s46, s46, 0x5000000
    v_add_u32 v10, s46, v10
    s_lshl_b32 s52, s42, 9
    s_lshl_b32 s47, s43, 7
    s_add_u32 s52, s52, s47
    s_add_u32 s52, s52, 0x102000
    v_min_u32 v42, 2, v1
    v_lshlrev_b32 v42, 9, v42
    s_lshl_b32 s46, s40, 11
    s_and_b32 s47, s42, 3
    s_lshl_b32 s47, s47, 7
    s_add_u32 s46, s46, s47
    s_add_u32 s46, s46, 0x10a400
    v_add_u32 v48, s46, v42
    s_mul_i32 s46, s42, 24576
    s_add_u32 s46, s46, 0x2000000
    v_lshlrev_b32 v49, 7, v1
    v_add_u32 v49, s46, v49
    v_cmp_le_u32 s[56:57], 32, v1
    v_lshlrev_b32 v14, 2, v4
    s_mov_b32 s54, 0x3e0293ee
    s_mov_b32 s60, s43
    v_add_u32 v15, 0, v14
    v_cmp_gt_u32 s[84:85], v15, v9
    v_add_u32 v15, 1, v14
    v_cmp_gt_u32 s[86:87], v15, v9
    v_add_u32 v15, 2, v14
    v_cmp_gt_u32 s[88:89], v15, v9
    v_add_u32 v15, 3, v14
    v_cmp_gt_u32 s[90:91], v15, v9
L_a_loop_42:
    s_mul_i32 s45, s60, 786432
    s_add_u32 s48, s45, 8192
    s_add_u32 s49, s45, 16384
    s_lshl_b32 s61, s60, 17
    s_lshl_b32 s63, s60, 18
    s_mov_b32 s70, 0
L_spin_43:
    buffer_load_dword v40, v48, s[12:15], 0 offen sc1
    s_waitcnt vmcnt(0)
    v_cmp_ge_u32 vcc, s60, v40
    s_add_u32 s70, s70, 1
    s_cbranch_vccz L_spok_44
    s_sleep 3
    s_cmp_lt_u32 s70, 524288
    s_cbranch_scc1 L_spin_43
    s_branch L_c_done_1
L_spok_44:
    buffer_load_dwordx4 a[0:3], v3, s[12:15], s45 offen offset:0 sc1
    buffer_load_dwordx4 a[4:7], v3, s[12:15], s45 offen offset:1024 sc1
    buffer_load_dwordx4 a[8:11], v3, s[12:15], s45 offen offset:2048 sc1
    buffer_load_dwordx4 a[12:15], v3, s[12:15], s45 offen offset:3072 sc1
    buffer_load_dwordx4 a[16:19], v5, s[12:15], s45 offen offset:0 sc1
    buffer_load_dwordx4 a[20:23], v5, s[12:15], s45 offen offset:1024 sc1
    buffer_load_dwordx4 a[24:27], v5, s[12:15], s45 offen offset:2048 sc1
    buffer_load_dwordx4 a[28:31], v5, s[12:15], s45 offen offset:3072 sc1
    buffer_load_dwordx4 a[32:35], v3, s[12:15], s48 offen offset:0 sc1
    buffer_load_dwordx4 a[36:39], v3, s[12:15], s48 offen offset:1024 sc1
    buffer_load_dwordx4 a[40:43], v3, s[12:15], s48 offen offset:2048 sc1
    buffer_load_dwordx4 a[44:47], v3, s[12:15], s48 offen offset:3072 sc1
    buffer_load_dwordx4 a[48:51], v5, s[12:15], s48 offen offset:0 sc1
    buffer_load_dwordx4 a[52:55], v5, s[12:15], s48 offen offset:1024 sc1
    buffer_load_dwordx4 a[56:59], v5, s[12:15], s48 offen offset:2048 sc1
    buffer_load_dwordx4 a[60:63], v5, s[12:15], s48 offen offset:3072 sc1
    buffer_load_dwordx4 v[16:19], v3, s[12:15], s49 offen offset:0 sc1
    buffer_load_dwordx4 v[20:23], v3, s[12:15], s49 offen offset:1024 sc1
    buffer_load_dwordx4 v[24:27], v3, s[12:15], s49 offen offset:2048 sc1
    buffer_load_dwordx4 v[28:31], v3, s[12:15], s49 offen offset:3072 sc1
    buffer_load_dwordx4 v[32:35], v5, s[12:15], s49 offen offset:0 sc1
    buffer_load_dwordx4 v[36:39], v5, s[12:15], s49 offen offset:1024 sc1
    buffer_load_dwordx4 v[40:43], v5, s[12:15], s49 offen offset:2048 sc1
    buffer_load_dwordx4 v[44:47], v5, s[12:15], s49 offen offset:3072 sc1
    s_waitcnt vmcnt(0)
    ds_write_b128 v8, v[16:19] offset:0
    ds_write_b128 v8, v[20:23] offset:64
    ds_write_b128 v8, v[24:27] offset:128
    ds_write_b128 v8, v[28:31] offset:192
    ds_write_b128 v8, v[32:35] offset:4352
    ds_write_b128 v8, v[36:39] offset:4416
    ds_write_b128 v8, v[40:43] offset:4480
    ds_write_b128 v8, v[44:47] offset:4544
    v_mfma_f32_16x16x32_bf16 v[56:59], a[32:35], a[0:3], 0
    v_mfma_f32_16x16x32_bf16 v[60:63], a[32:35], a[16:19], 0
    v_mfma_f32_16x16x32_bf16 v[68:71], a[48:51], a[16:19], 0
    v_mfma_f32_16x16x32_bf16 v[56:59], a[36:39], a[4:7], v[56:59]
    v_mfma_f32_16x16x32_bf16 v[60:63], a[36:39], a[20:23], v[60:63]
    v_mfma_f32_16x16x32_bf16 v[68:71], a[52:55], a[20:23], v[68:71]
    v_mfma_f32_16x16x32_bf16 v[56:59], a[40:43], a[8:11], v[56:59]
    v_mfma_f32_16x16x32_bf16 v[60:63], a[40:43], a[24:27], v[60:63]
    v_mfma_f32_16x16x32_bf16 v[68:71], a[56:59], a[24:27], v[68:71]
    v_mfma_f32_16x16x32_bf16 v[56:59], a[44:47], a[12:15], v[56:59]
    v_mfma_f32_16x16x32_bf16 v[60:63], a[44:47], a[28:31], v[60:63]
    v_mfma_f32_16x16x32_bf16 v[68:71], a[60:63], a[28:31], v[68:71]
    s_waitcnt lgkmcnt(0)
    ds_read_b64_tr_b16 a[80:81], v12 offset:0
    ds_read_b64_tr_b16 a[82:83], v12 offset:4352
    ds_read_b64_tr_b16 a[86:87], v12 offset:32
    ds_read_b64_tr_b16 a[88:89], v12 offset:4384
    ds_read_b64_tr_b16 a[92:93], v12 offset:64
    ds_read_b64_tr_b16 a[94:95], v12 offset:4416
    ds_read_b64_tr_b16 a[98:99], v12 offset:96
    ds_read_b64_tr_b16 a[100:101], v12 offset:4448
    s_waitcnt lgkmcnt(0)
    ds_read_b64_tr_b16 a[104:105], v12 offset:128
    ds_read_b64_tr_b16 a[106:107], v12 offset:4480
    ds_read_b64_tr_b16 a[110:111], v12 offset:160
    ds_read_b64_tr_b16 a[112:113], v12 offset:4512
    ds_read_b64_tr_b16 a[116:117], v12 offset:192
    ds_read_b64_tr_b16 a[118:119], v12 offset:4544
    ds_read_b64_tr_b16 a[122:123], v12 offset:224
    ds_read_b64_tr_b16 a[124:125], v12 offset:4576
    v_mov_b32 v15, 0xff800000
    v_cndmask_b32 v56, v56, v15, s[84:85]
    v_cndmask_b32 v68, v68, v15, s[84:85]
    v_cndmask_b32 v57, v57, v15, s[86:87]
    v_cndmask_b32 v69, v69, v15, s[86:87]
    v_cndmask_b32 v58, v58, v15, s[88:89]
    v_cndmask_b32 v70, v70, v15, s[88:89]
    v_cndmask_b32 v59, v59, v15, s[90:91]
    v_cndmask_b32 v71, v71, v15, s[90:91]
    s_mov_b32 s70, 0
L_a_cp_45:
    s_add_u32 s70, s70, 1
    s_cmp_ge_u32 s60, 63
    s_cbranch_scc1 L_a_fl_46
    buffer_load_dword v40, v13, s[12:15], s61 offen sc1
    s_waitcnt vmcnt(0)
    v_cmp_eq_u32 vcc, -1, v40
    s_add_u32 s70, s70, 1
    s_cbranch_vccz L_a_fl_46
L_a_cp_45_s:
    s_sleep 4
    s_cmp_lt_u32 s70, 524288
    s_cbranch_scc1 L_a_cp_45
    s_branch L_c_done_1
L_a_fl_46:
    buffer_load_dwordx4 v[24:27], v6, s[12:15], s61 offen offset:0 sc1
    buffer_load_dwordx4 v[28:31], v6, s[12:15], s61 offen offset:1024 sc1
    buffer_load_dwordx4 v[32:35], v6, s[12:15], s61 offen offset:2048 sc1
    buffer_load_dwordx4 v[36:39], v6, s[12:15], s61 offen offset:3072 sc1
    buffer_load_dwordx4 v[16:19], v7, s[12:15], s61 offen offset:512 sc1
    buffer_load_dwordx4 v[20:23], v7, s[12:15], s61 offen offset:2560 sc1
    s_waitcnt vmcnt(0)
    v_max_u32 v40, v16, v17
    v_max3_u32 v40, v40, v18, v19
    v_max3_u32 v40, v40, v20, v21
    v_max3_u32 v40, v40, v22, v23
    v_max3_u32 v40, v40, v24, v25
    v_max3_u32 v40, v40, v26, v27
    v_max3_u32 v40, v40, v28, v29
    v_max3_u32 v40, v40, v30, v31
    v_max3_u32 v40, v40, v32, v33
    v_max3_u32 v40, v40, v34, v35
    v_max3_u32 v40, v40, v36, v37
    v_max3_u32 v40, v40, v38, v39
    v_cmp_eq_u32 vcc, -1, v40
    s_nop 0
    s_cbranch_vccnz L_a_cp_45_s
    v_mfma_f32_16x16x32_bf16 v[72:75], v[24:27], a[0:3], 0
    v_mfma_f32_16x16x32_bf16 v[76:79], v[24:27], a[16:19], 0
    v_mfma_f32_16x16x32_bf16 v[72:75], v[28:31], a[4:7], v[72:75]
    v_mfma_f32_16x16x32_bf16 v[76:79], v[28:31], a[20:23], v[76:79]
    v_mfma_f32_16x16x32_bf16 v[72:75], v[32:35], a[8:11], v[72:75]
    v_mfma_f32_16x16x32_bf16 v[76:79], v[32:35], a[24:27], v[76:79]
    v_mfma_f32_16x16x32_bf16 v[72:75], v[36:39], a[12:15], v[72:75]
    v_mfma_f32_16x16x32_bf16 v[76:79], v[36:39], a[28:31], v[76:79]
    ds_write_b128 v11, v[16:19] offset:8704
    ds_write_b128 v11, v[20:23] offset:8832
    s_waitcnt lgkmcnt(0)
    ds_read_b64_tr_b16 a[84:85], v12 offset:8704
    ds_read_b64_tr_b16 a[90:91], v12 offset:8736
    ds_read_b64_tr_b16 a[96:97], v12 offset:8768
    ds_read_b64_tr_b16 a[102:103], v12 offset:8800
    ds_read_b64_tr_b16 a[108:109], v12 offset:8832
    ds_read_b64_tr_b16 a[114:115], v12 offset:8864
    ds_read_b64_tr_b16 a[120:121], v12 offset:8896
    ds_read_b64_tr_b16 a[126:127], v12 offset:8928
    v_cndmask_b32 v72, v72, v15, s[56:57]
    v_cndmask_b32 v73, v73, v15, s[56:57]
    v_cndmask_b32 v74, v74, v15, s[56:57]
    v_cndmask_b32 v75, v75, v15, s[56:57]
    v_cndmask_b32 v76, v76, v15, s[56:57]
    v_cndmask_b32 v77, v77, v15, s[56:57]
    v_cndmask_b32 v78, v78, v15, s[56:57]
    v_cndmask_b32 v79, v79, v15, s[56:57]
    v_max_f32 v40, v56, v57
    v_max3_f32 v40, v40, v58, v59
    v_max3_f32 v40, v40, v72, v73
    v_max3_f32 v40, v40, v74, v75
    v_mov_b32 v41, v40
    s_nop 1
    v_permlane16_swap_b32 v40, v41
    v_max_f32 v40, v40, v41
    v_mov_b32 v41, v40
    s_nop 1
    v_permlane32_swap_b32 v40, v41
    v_max_f32 v40, v40, v41
    v_mul_f32 v40, s54, v40
    v_fma_f32 v56, v56, s54, -v40
    v_fma_f32 v57, v57, s54, -v40
    v_fma_f32 v58, v58, s54, -v40
    v_fma_f32 v59, v59, s54, -v40
    v_fma_f32 v72, v72, s54, -v40
    v_fma_f32 v73, v73, s54, -v40
    v_fma_f32 v74, v74, s54, -v40
    v_fma_f32 v75, v75, s54, -v40
    v_exp_f32 v56, v56
    v_exp_f32 v57, v57
    v_exp_f32 v58, v58
    v_exp_f32 v59, v59
    v_exp_f32 v72, v72
    v_exp_f32 v73, v73
    v_exp_f32 v74, v74
    v_exp_f32 v75, v75
    v_add_f32 v40, v56, v57
    v_add_f32 v40, v40, v58
    v_add_f32 v40, v40, v59
    v_add_f32 v40, v40, v72
    v_add_f32 v40, v40, v73
    v_add_f32 v40, v40, v74
    v_add_f32 v40, v40, v75
    v_mov_b32 v41, v40
    s_nop 1
    v_permlane16_swap_b32 v40, v41
    v_add_f32 v40, v40, v41
    v_mov_b32 v41, v40
    s_nop 1
    v_permlane32_swap_b32 v40, v41
    v_add_f32 v40, v40, v41
    v_rcp_f32 v40, v40
    s_nop 0
    v_mul_f32 v56, v56, v40
    v_mul_f32 v57, v57, v40
    v_mul_f32 v58, v58, v40
    v_mul_f32 v59, v59, v40
    v_mul_f32 v72, v72, v40
    v_mul_f32 v73, v73, v40
    v_mul_f32 v74, v74, v40
    v_mul_f32 v75, v75, v40
    v_cvt_pk_bf16_f32 v24, v56, v57
    v_cvt_pk_bf16_f32 v25, v58, v59
    v_cvt_pk_bf16_f32 v28, v72, v73
    v_cvt_pk_bf16_f32 v29, v74, v75
    v_max_f32 v40, v60, v61
    v_max3_f32 v40, v40, v62, v63
    v_max3_f32 v40, v40, v68, v69
    v_max3_f32 v40, v40, v70, v71
    v_max3_f32 v40, v40, v76, v77
    v_max3_f32 v40, v40, v78, v79
    v_mov_b32 v41, v40
    s_nop 1
    v_permlane16_swap_b32 v40, v41
    v_max_f32 v40, v40, v41
    v_mov_b32 v41, v40
    s_nop 1
    v_permlane32_swap_b32 v40, v41
    v_max_f32 v40, v40, v41
    v_mul_f32 v40, s54, v40
    v_fma_f32 v60, v60, s54, -v40
    v_fma_f32 v61, v61, s54, -v40
    v_fma_f32 v62, v62, s54, -v40
    v_fma_f32 v63, v63, s54, -v40
    v_fma_f32 v68, v68, s54, -v40
    v_fma_f32 v69, v69, s54, -v40
    v_fma_f32 v70, v70, s54, -v40
    v_fma_f32 v71, v71, s54, -v40
    v_fma_f32 v76, v76, s54, -v40
    v_fma_f32 v77, v77, s54, -v40
    v_fma_f32 v78, v78, s54, -v40
    v_fma_f32 v79, v79, s54, -v40
    v_exp_f32 v60, v60
    v_exp_f32 v61, v61
    v_exp_f32 v62, v62
    v_exp_f32 v63, v63
    v_exp_f32 v68, v68
    v_exp_f32 v69, v69
    v_exp_f32 v70, v70
    v_exp_f32 v71, v71
    v_exp_f32 v76, v76
    v_exp_f32 v77, v77
    v_exp_f32 v78, v78
    v_exp_f32 v79, v79
    v_add_f32 v40, v60, v61
    v_add_f32 v40, v40, v62
    v_add_f32 v40, v40, v63
    v_add_f32 v40, v40, v68
    v_add_f32 v40, v40, v69
    v_add_f32 v40, v40, v70
    v_add_f32 v40, v40, v71
    v_add_f32 v40, v40, v76
    v_add_f32 v40, v40, v77
    v_add_f32 v40, v40, v78
    v_add_f32 v40, v40, v79
    v_mov_b32 v41, v40
    s_nop 1
    v_permlane16_swap_b32 v40, v41
    v_add_f32 v40, v40, v41
    v_mov_b32 v41, v40
    s_nop 1
    v_permlane32_swap_b32 v40, v41
    v_add_f32 v40, v40, v41
    v_rcp_f32 v40, v40
    s_nop 0
    v_mul_f32 v60, v60, v40
    v_mul_f32 v61, v61, v40
    v_mul_f32 v62, v62, v40
    v_mul_f32 v63, v63, v40
    v_mul_f32 v68, v68, v40
    v_mul_f32 v69, v69, v40
    v_mul_f32 v70, v70, v40
    v_mul_f32 v71, v71, v40
    v_mul_f32 v76, v76, v40
    v_mul_f32 v77, v77, v40
    v_mul_f32 v78, v78, v40
    v_mul_f32 v79, v79, v40
    v_cvt_pk_bf16_f32 v30, v60, v61
    v_cvt_pk_bf16_f32 v31, v62, v63
    v_cvt_pk_bf16_f32 v32, v68, v69
    v_cvt_pk_bf16_f32 v33, v70, v71
    v_cvt_pk_bf16_f32 v34, v76, v77
    v_cvt_pk_bf16_f32 v35, v78, v79
    s_waitcnt lgkmcnt(0)
    s_nop 0
    v_mfma_f32_16x16x16_bf16 v[64:67], a[80:81], v[24:25], 0
    v_mfma_f32_16x16x16_bf16 v[68:71], a[86:87], v[24:25], 0
    v_mfma_f32_16x16x16_bf16 v[72:75], a[92:93], v[24:25], 0
    v_mfma_f32_16x16x16_bf16 v[76:79], a[98:99], v[24:25], 0
    v_mfma_f32_16x16x16_bf16 v[80:83], a[104:105], v[24:25], 0
    v_mfma_f32_16x16x16_bf16 v[84:87], a[110:111], v[24:25], 0
    v_mfma_f32_16x16x16_bf16 v[88:91], a[116:117], v[24:25], 0
    v_mfma_f32_16x16x16_bf16 v[92:95], a[122:123], v[24:25], 0
    v_mfma_f32_16x16x16_bf16 v[64:67], a[84:85], v[28:29], v[64:67]
    v_mfma_f32_16x16x16_bf16 v[68:71], a[90:91], v[28:29], v[68:71]
    v_mfma_f32_16x16x16_bf16 v[72:75], a[96:97], v[28:29], v[72:75]
    v_mfma_f32_16x16x16_bf16 v[76:79], a[102:103], v[28:29], v[76:79]
    v_mfma_f32_16x16x16_bf16 v[80:83], a[108:109], v[28:29], v[80:83]
    v_mfma_f32_16x16x16_bf16 v[84:87], a[114:115], v[28:29], v[84:87]
    v_mfma_f32_16x16x16_bf16 v[88:91], a[120:121], v[28:29], v[88:91]
    v_mfma_f32_16x16x16_bf16 v[92:95], a[126:127], v[28:29], v[92:95]
    v_mfma_f32_16x16x16_bf16 v[96:99], a[80:81], v[30:31], 0
    v_mfma_f32_16x16x16_bf16 v[100:103], a[86:87], v[30:31], 0
    v_mfma_f32_16x16x16_bf16 v[104:107], a[92:93], v[30:31], 0
    v_mfma_f32_16x16x16_bf16 v[108:111], a[98:99], v[30:31], 0
    v_mfma_f32_16x16x16_bf16 v[112:115], a[104:105], v[30:31], 0
    v_mfma_f32_16x16x16_bf16 v[116:119], a[110:111], v[30:31], 0
    v_mfma_f32_16x16x16_bf16 v[120:123], a[116:117], v[30:31], 0
    v_mfma_f32_16x16x16_bf16 v[124:127], a[122:123], v[30:31], 0
    v_mfma_f32_16x16x16_bf16 v[96:99], a[82:83], v[32:33], v[96:99]
    v_mfma_f32_16x16x16_bf16 v[100:103], a[88:89], v[32:33], v[100:103]
    v_mfma_f32_16x16x16_bf16 v[104:107], a[94:95], v[32:33], v[104:107]
    v_mfma_f32_16x16x16_bf16 v[108:111], a[100:101], v[32:33], v[108:111]
    v_mfma_f32_16x16x16_bf16 v[112:115], a[106:107], v[32:33], v[112:115]
    v_mfma_f32_16x16x16_bf16 v[116:119], a[112:113], v[32:33], v[116:119]
    v_mfma_f32_16x16x16_bf16 v[120:123], a[118:119], v[32:33], v[120:123]
    v_mfma_f32_16x16x16_bf16 v[124:127], a[124:125], v[32:33], v[124:127]
    v_mfma_f32_16x16x16_bf16 v[96:99], a[84:85], v[34:35], v[96:99]
    v_mfma_f32_16x16x16_bf16 v[100:103], a[90:91], v[34:35], v[100:103]
    v_mfma_f32_16x16x16_bf16 v[104:107], a[96:97], v[34:35], v[104:107]
    v_mfma_f32_16x16x16_bf16 v[108:111], a[102:103], v[34:35], v[108:111]
    v_mfma_f32_16x16x16_bf16 v[112:115], a[108:109], v[34:35], v[112:115]
    v_mfma_f32_16x16x16_bf16 v[116:119], a[114:115], v[34:35], v[116:119]
    v_mfma_f32_16x16x16_bf16 v[120:123], a[120:121], v[34:35], v[120:123]
    v_mfma_f32_16x16x16_bf16 v[124:127], a[126:127], v[34:35], v[124:127]
    s_add_u32 s46, s63, 4096
    v_cvt_pk_bf16_f32 v64, v64, v65
    v_cvt_pk_bf16_f32 v65, v66, v67
    v_cvt_pk_bf16_f32 v66, v68, v69
    v_cvt_pk_bf16_f32 v67, v70, v71
    buffer_store_dwordx4 v[64:67], v10, s[12:15], s63 offen offset:0 sc1
    v_cvt_pk_bf16_f32 v72, v72, v73
    v_cvt_pk_bf16_f32 v73, v74, v75
    v_cvt_pk_bf16_f32 v74, v76, v77
    v_cvt_pk_bf16_f32 v75, v78, v79
    buffer_store_dwordx4 v[72:75], v10, s[12:15], s63 offen offset:2048 sc1
    v_cvt_pk_bf16_f32 v80, v80, v81
    v_cvt_pk_bf16_f32 v81, v82, v83
    v_cvt_pk_bf16_f32 v82, v84, v85
    v_cvt_pk_bf16_f32 v83, v86, v87
    buffer_store_dwordx4 v[80:83], v10, s[12:15], s46 offen offset:0 sc1
    v_cvt_pk_bf16_f32 v88, v88, v89
    v_cvt_pk_bf16_f32 v89, v90, v91
    v_cvt_pk_bf16_f32 v90, v92, v93
    v_cvt_pk_bf16_f32 v91, v94, v95
    buffer_store_dwordx4 v[88:91], v10, s[12:15], s46 offen offset:2048 sc1
    v_cvt_pk_bf16_f32 v96, v96, v97
    v_cvt_pk_bf16_f32 v97, v98, v99
    v_cvt_pk_bf16_f32 v98, v100, v101
    v_cvt_pk_bf16_f32 v99, v102, v103
    buffer_store_dwordx4 v[96:99], v10, s[12:15], s63 offen offset:256 sc1
    v_cvt_pk_bf16_f32 v104, v104, v105
    v_cvt_pk_bf16_f32 v105, v106, v107
    v_cvt_pk_bf16_f32 v106, v108, v109
    v_cvt_pk_bf16_f32 v107, v110, v111
    buffer_store_dwordx4 v[104:107], v10, s[12:15], s63 offen offset:2304 sc1
    v_cvt_pk_bf16_f32 v112, v112, v113
    v_cvt_pk_bf16_f32 v113, v114, v115
    v_cvt_pk_bf16_f32 v114, v116, v117
    v_cvt_pk_bf16_f32 v115, v118, v119
    buffer_store_dwordx4 v[112:115], v10, s[12:15], s46 offen offset:256 sc1
    v_cvt_pk_bf16_f32 v120, v120, v121
    v_cvt_pk_bf16_f32 v121, v122, v123
    v_cvt_pk_bf16_f32 v122, v124, v125
    v_cvt_pk_bf16_f32 v123, v126, v127
    buffer_store_dwordx4 v[120:123], v10, s[12:15], s46 offen offset:2304 sc1
    s_waitcnt vmcnt(0)
    v_mov_b32 v16, s60
    v_add_u32 v16, 1, v16
    v_mov_b32 v17, 0
    s_mov_b64 exec, 1
    buffer_store_dword v16, v17, s[12:15], s52 offen sc1
    s_mov_b64 exec, -1
L_sf_48:
    s_add_u32 s60, s60, 4
    s_cmp_lt_u32 s60, 64
    s_cbranch_scc1 L_a_loop_42
    s_branch L_c_done_1
L_w_g_10:
    s_lshr_b32 s53, s48, 2
    s_cmp_lt_u32 s53, 2
    s_cselect_b32 s46, 1, 0
    s_xor_b32 s53, s53, s46
    s_mov_b32 s74, 0
    s_mov_b32 s76, 0
    s_cmp_eq_u32 s53, 1
    s_cselect_b32 s75, 41, 58
    s_cmp_eq_u32 s53, 2
    s_cselect_b32 s75, 54, s75
L_w_g_10_e:
    s_lshl_b32 s46, s53, 3
    s_add_u32 s46, s46, 16
    s_load_dwordx2 s[4:5], s[0:1], s46
    s_lshl_b32 s49, s40, 2
    s_and_b32 s46, s48, 3
    s_add_u32 s49, s49, s46
    s_load_dwordx2 s[6:7], s[0:1], 72
    s_and_b32 s50, s44, 3
    s_lshr_b32 s51, s44, 2
    s_waitcnt lgkmcnt(0)
    s_mov_b32 s24, s4
    s_and_b32 s25, s5, 0xffff
    s_mov_b32 s26, 0x800000
    s_mov_b32 s27, 0x00020000
    s_cmp_lg_u32 s76, 0
    s_cbranch_scc1 L_g_n3_49
    s_cmp_ge_u32 s44, 3
    s_cbranch_scc1 L_g_n3_49
    s_mul_i32 s46, s48, 3
    s_add_u32 s46, s46, s44
    s_cmp_ge_u32 s46, 32
    s_cbranch_scc1 L_g_n3_49
    s_lshr_b32 s47, s46, 4
    s_add_u32 s47, s47, 1
    s_cmp_eq_u32 s47, 3
    s_cselect_b32 s47, 0, s47
    s_lshl_b32 s47, s47, 3
    s_add_u32 s47, s47, 16
    s_load_dwordx2 s[8:9], s[0:1], s47
    s_and_b32 s46, s46, 15
    s_lshl_b32 s46, s46, 19
    s_lshl_b32 s47, s40, 10
    s_add_u32 s46, s46, s47
    s_add_u32 s46, s46, 384
    v_lshlrev_b32 v10, 13, v1
    s_waitcnt lgkmcnt(0)
    s_mov_b32 s28, s8
    s_and_b32 s29, s9, 0xffff
    s_mov_b32 s30, 0x800000
    s_mov_b32 s31, 0x00020000
    buffer_load_dword v16, v10, s[28:31], s46 offen
L_g_n3_49:
    s_cmp_lg_u32 s53, 0
    s_cbranch_scc1 L_g_nq_50
    s_load_dwordx4 s[8:11], s[0:1], 24
    v_bfe_u32 v10, v0, 1, 6
    v_lshlrev_b32 v10, 13, v10
    v_and_b32 v11, 1, v0
    v_lshl_add_u32 v10, v11, 7, v10
    v_bfe_u32 v11, v0, 7, 1
    v_lshl_add_u32 v10, v11, 22, v10
    s_lshl_b32 s46, s49, 8
    s_waitcnt lgkmcnt(0)
    s_mov_b32 s28, s10
    s_and_b32 s29, s11, 0xffff
    s_mov_b32 s30, 0x800000
    s_mov_b32 s31, 0x00020000
    s_mov_b32 s32, s8
    s_and_b32 s33, s9, 0xffff
    s_mov_b32 s34, 0x800000
    s_mov_b32 s35, 0x00020000
    s_lshl_b32 s47, s51, 19
    s_add_u32 s46, s46, s47
    s_add_u32 s47, s46, 0x200000
    buffer_load_dword v11, v10, s[28:31], s47 offen
    s_add_u32 s47, s46, 0x300000
    buffer_load_dword v12, v10, s[28:31], s47 offen
L_g_nq_50:
    v_lshrrev_b32 v3, 4, v1
    v_and_b32 v4, 15, v1
    v_lshlrev_b32 v5, 2, v3
    v_xor_b32 v4, v4, v5
    v_mul_u32_u24 v3, 8192, v3
    v_lshl_add_u32 v3, v4, 4, v3
    s_mul_i32 s46, s51, 512
    s_mul_i32 s47, s50, 16
    s_add_u32 s46, s46, s47
    s_mul_i32 s46, s46, 8192
    s_lshl_b32 s47, s49, 8
    s_add_u32 s46, s46, s47
    s_lshl_b32 s45, s51, 16
    s_mul_i32 s47, s50, 4096
    s_add_u32 s45, s45, s47
    v_bfe_u32 v4, v1, 2, 2
    v_bfe_u32 v5, v1, 4, 1
    v_lshlrev_b32 v5, 1, v5
    v_bfe_u32 v6, v1, 0, 1
    v_add_u32 v5, v5, v6
    s_lshl_b32 s47, s50, 2
    v_add_u32 v5, s47, v5
    v_lshlrev_b32 v6, 2, v4
    v_xor_b32 v5, v5, v6
    v_lshlrev_b32 v5, 4, v5
    v_lshl_add_u32 v5, v4, 8, v5
    v_bfe_u32 v6, v1, 1, 1
    v_lshl_add_u32 v5, v6, 3, v5
    v_lshrrev_b32 v6, 5, v1
    v_mul_u32_u24 v6, 2048, v6
    v_add_u32 v5, v5, v6
    s_lshl_b32 s47, s51, 16
    v_add_u32 v5, s47, v5
    v_bfe_u32 v4, v1, 2, 2
    v_xor_b32 v5, s50, v4
    v_lshlrev_b32 v5, 6, v5
    v_lshl_add_u32 v5, v4, 8, v5
    v_and_b32 v6, 3, v1
    v_lshl_add_u32 v5, v6, 4, v5
    v_lshrrev_b32 v6, 4, v1
    v_lshl_add_u32 v5, v6, 11, v5
    v_lshrrev_b32 v6, 5, v1
    s_lshl_b32 s47, s51, 16
    v_add_u32 v5, s47, v5
    s_add_u32 m0, s45, 0
    s_add_u32 s47, s46, 0x0
    buffer_load_dwordx4 v3, s[24:27], s47 offen  lds
    s_add_u32 m0, s45, 1024
    s_add_u32 s47, s46, 0x8000
    buffer_load_dwordx4 v3, s[24:27], s47 offen  lds
    s_add_u32 m0, s45, 2048
    s_add_u32 s47, s46, 0x10000
    buffer_load_dwordx4 v3, s[24:27], s47 offen  lds
    s_add_u32 m0, s45, 3072
    s_add_u32 s47, s46, 0x18000
    buffer_load_dwordx4 v3, s[24:27], s47 offen  lds
    s_add_u32 m0, s45, 16384
    s_add_u32 s47, s46, 0x80000
    buffer_load_dwordx4 v3, s[24:27], s47 offen  lds
    s_add_u32 m0, s45, 17408
    s_add_u32 s47, s46, 0x88000
    buffer_load_dwordx4 v3, s[24:27], s47 offen  lds
    s_add_u32 m0, s45, 18432
    s_add_u32 s47, s46, 0x90000
    buffer_load_dwordx4 v3, s[24:27], s47 offen  lds
    s_add_u32 m0, s45, 19456
    s_add_u32 s47, s46, 0x98000
    buffer_load_dwordx4 v3, s[24:27], s47 offen  lds
    s_add_u32 m0, s45, 32768
    s_add_u32 s47, s46, 0x100000
    buffer_load_dwordx4 v3, s[24:27], s47 offen  lds
    s_add_u32 m0, s45, 33792
    s_add_u32 s47, s46, 0x108000
    buffer_load_dwordx4 v3, s[24:27], s47 offen  lds
    s_add_u32 m0, s45, 34816
    s_add_u32 s47, s46, 0x110000
    buffer_load_dwordx4 v3, s[24:27], s47 offen  lds
    s_add_u32 m0, s45, 35840
    s_add_u32 s47, s46, 0x118000
    buffer_load_dwordx4 v3, s[24:27], s47 offen  lds
    s_add_u32 m0, s45, 49152
    s_add_u32 s47, s46, 0x180000
    buffer_load_dwordx4 v3, s[24:27], s47 offen  lds
    s_add_u32 m0, s45, 50176
    s_add_u32 s47, s46, 0x188000
    buffer_load_dwordx4 v3, s[24:27], s47 offen  lds
    s_add_u32 m0, s45, 51200
    s_add_u32 s47, s46, 0x190000
    buffer_load_dwordx4 v3, s[24:27], s47 offen  lds
    s_add_u32 m0, s45, 52224
    s_add_u32 s47, s46, 0x198000
    buffer_load_dwordx4 v3, s[24:27], s47 offen  lds
    s_waitcnt vmcnt(12) lgkmcnt(0)
    s_barrier
    ds_read_b64_tr_b16 a[0:1], v5 offset:0
    ds_read_b64_tr_b16 a[2:3], v5 offset:1024
    ds_read_b64_tr_b16 a[4:5], v5 offset:8
    ds_read_b64_tr_b16 a[6:7], v5 offset:1032
    ds_read_b64_tr_b16 a[8:9], v5 offset:8192
    ds_read_b64_tr_b16 a[10:11], v5 offset:9216
    ds_read_b64_tr_b16 a[12:13], v5 offset:8200
    ds_read_b64_tr_b16 a[14:15], v5 offset:9224
    s_waitcnt vmcnt(8) lgkmcnt(0)
    s_barrier
    s_add_u32 m0, s45, 0
    s_add_u32 s47, s46, 0x200000
    buffer_load_dwordx4 v3, s[24:27], s47 offen  lds
    s_add_u32 m0, s45, 1024
    s_add_u32 s47, s46, 0x208000
    buffer_load_dwordx4 v3, s[24:27], s47 offen  lds
    s_add_u32 m0, s45, 2048
    s_add_u32 s47, s46, 0x210000
    buffer_load_dwordx4 v3, s[24:27], s47 offen  lds
    s_add_u32 m0, s45, 3072
    s_add_u32 s47, s46, 0x218000
    buffer_load_dwordx4 v3, s[24:27], s47 offen  lds
    ds_read_b64_tr_b16 a[16:17], v5 offset:16384
    ds_read_b64_tr_b16 a[18:19], v5 offset:17408
    ds_read_b64_tr_b16 a[20:21], v5 offset:16392
    ds_read_b64_tr_b16 a[22:23], v5 offset:17416
    ds_read_b64_tr_b16 a[24:25], v5 offset:24576
    ds_read_b64_tr_b16 a[26:27], v5 offset:25600
    ds_read_b64_tr_b16 a[28:29], v5 offset:24584
    ds_read_b64_tr_b16 a[30:31], v5 offset:25608
    s_waitcnt vmcnt(8) lgkmcnt(0)
    s_barrier
    s_add_u32 m0, s45, 16384
    s_add_u32 s47, s46, 0x280000
    buffer_load_dwordx4 v3, s[24:27], s47 offen  lds
    s_add_u32 m0, s45, 17408
    s_add_u32 s47, s46, 0x288000
    buffer_load_dwordx4 v3, s[24:27], s47 offen  lds
    s_add_u32 m0, s45, 18432
    s_add_u32 s47, s46, 0x290000
    buffer_load_dwordx4 v3, s[24:27], s47 offen  lds
    s_add_u32 m0, s45, 19456
    s_add_u32 s47, s46, 0x298000
    buffer_load_dwordx4 v3, s[24:27], s47 offen  lds
    ds_read_b64_tr_b16 a[32:33], v5 offset:32768
    ds_read_b64_tr_b16 a[34:35], v5 offset:33792
    ds_read_b64_tr_b16 a[36:37], v5 offset:32776
    ds_read_b64_tr_b16 a[38:39], v5 offset:33800
    ds_read_b64_tr_b16 a[40:41], v5 offset:40960
    ds_read_b64_tr_b16 a[42:43], v5 offset:41984
    ds_read_b64_tr_b16 a[44:45], v5 offset:40968
    ds_read_b64_tr_b16 a[46:47], v5 offset:41992
    s_waitcnt vmcnt(8) lgkmcnt(0)
    s_barrier
    s_add_u32 m0, s45, 32768
    s_add_u32 s47, s46, 0x300000
    buffer_load_dwordx4 v3, s[24:27], s47 offen  lds
    s_add_u32 m0, s45, 33792
    s_add_u32 s47, s46, 0x308000
    buffer_load_dwordx4 v3, s[24:27], s47 offen  lds
    s_add_u32 m0, s45, 34816
    s_add_u32 s47, s46, 0x310000
    buffer_load_dwordx4 v3, s[24:27], s47 offen  lds
    s_add_u32 m0, s45, 35840
    s_add_u32 s47, s46, 0x318000
    buffer_load_dwordx4 v3, s[24:27], s47 offen  lds
    ds_read_b64_tr_b16 a[48:49], v5 offset:49152
    ds_read_b64_tr_b16 a[50:51], v5 offset:50176
    ds_read_b64_tr_b16 a[52:53], v5 offset:49160
    ds_read_b64_tr_b16 a[54:55], v5 offset:50184
    ds_read_b64_tr_b16 a[56:57], v5 offset:57344
    ds_read_b64_tr_b16 a[58:59], v5 offset:58368
    ds_read_b64_tr_b16 a[60:61], v5 offset:57352
    ds_read_b64_tr_b16 a[62:63], v5 offset:58376
    s_waitcnt vmcnt(8) lgkmcnt(0)
    s_barrier
    s_add_u32 m0, s45, 49152
    s_add_u32 s47, s46, 0x380000
    buffer_load_dwordx4 v3, s[24:27], s47 offen  lds
    s_add_u32 m0, s45, 50176
    s_add_u32 s47, s46, 0x388000
    buffer_load_dwordx4 v3, s[24:27], s47 offen  lds
    s_add_u32 m0, s45, 51200
    s_add_u32 s47, s46, 0x390000
    buffer_load_dwordx4 v3, s[24:27], s47 offen  lds
    s_add_u32 m0, s45, 52224
    s_add_u32 s47, s46, 0x398000
    buffer_load_dwordx4 v3, s[24:27], s47 offen  lds
    ds_read_b64_tr_b16 a[64:65], v5 offset:0
    ds_read_b64_tr_b16 a[66:67], v5 offset:1024
    ds_read_b64_tr_b16 a[68:69], v5 offset:8
    ds_read_b64_tr_b16 a[70:71], v5 offset:1032
    ds_read_b64_tr_b16 a[72:73], v5 offset:8192
    ds_read_b64_tr_b16 a[74:75], v5 offset:9216
    ds_read_b64_tr_b16 a[76:77], v5 offset:8200
    ds_read_b64_tr_b16 a[78:79], v5 offset:9224
    s_waitcnt vmcnt(8) lgkmcnt(0)
    s_barrier
    ds_read_b64_tr_b16 a[80:81], v5 offset:16384
    ds_read_b64_tr_b16 a[82:83], v5 offset:17408
    ds_read_b64_tr_b16 a[84:85], v5 offset:16392
    ds_read_b64_tr_b16 a[86:87], v5 offset:17416
    ds_read_b64_tr_b16 a[88:89], v5 offset:24576
    ds_read_b64_tr_b16 a[90:91], v5 offset:25600
    ds_read_b64_tr_b16 a[92:93], v5 offset:24584
    ds_read_b64_tr_b16 a[94:95], v5 offset:25608
    s_waitcnt vmcnt(4) lgkmcnt(0)
    s_barrier
    ds_read_b64_tr_b16 a[96:97], v5 offset:32768
    ds_read_b64_tr_b16 a[98:99], v5 offset:33792
    ds_read_b64_tr_b16 a[100:101], v5 offset:32776
    ds_read_b64_tr_b16 a[102:103], v5 offset:33800
    ds_read_b64_tr_b16 a[104:105], v5 offset:40960
    ds_read_b64_tr_b16 a[106:107], v5 offset:41984
    ds_read_b64_tr_b16 a[108:109], v5 offset:40968
    ds_read_b64_tr_b16 a[110:111], v5 offset:41992
    s_waitcnt vmcnt(0) lgkmcnt(0)
    s_barrier
    ds_read_b64_tr_b16 a[112:113], v5 offset:49152
    ds_read_b64_tr_b16 a[114:115], v5 offset:50176
    ds_read_b64_tr_b16 a[116:117], v5 offset:49160
    ds_read_b64_tr_b16 a[118:119], v5 offset:50184
    ds_read_b64_tr_b16 a[120:121], v5 offset:57344
    ds_read_b64_tr_b16 a[122:123], v5 offset:58368
    ds_read_b64_tr_b16 a[124:125], v5 offset:57352
    ds_read_b64_tr_b16 a[126:127], v5 offset:58376
    s_waitcnt lgkmcnt(0)
    s_barrier
    v_lshlrev_b32 v2, 4, v1
    s_mul_i32 s64, s44, 8192
    s_add_u32 s46, s64, 0x400000
    v_add_u32 v3, s46, v2
    s_mul_i32 s46, s51, 32768
    v_add_u32 v4, s46, v2
    v_and_b32 v6, 15, v1
    v_lshlrev_b32 v6, 4, v6
    v_lshrrev_b32 v7, 4, v1
    v_lshl_add_u32 v6, v7, 9, v6
    v_add_u32 v4, s46, v6
    s_lshl_b32 s46, s50, 12
    s_add_u32 s46, s46, 131072
    v_add_u32 v5, s46, v2
    v_and_b32 v7, 3, v1
    v_lshlrev_b32 v7, 7, v7
    v_add_u32 v7, 0x109400, v7
    s_mul_i32 s46, s49, 24576
    s_lshl_b32 s47, s53, 13
    s_add_u32 s46, s46, s47
    s_lshl_b32 s47, s50, 10
    s_add_u32 s46, s46, s47
    s_add_u32 s46, s46, 0x2000000
    v_and_b32 v8, 15, v1
    v_lshlrev_b32 v8, 4, v8
    v_bfe_u32 v9, v1, 4, 1
    v_lshl_add_u32 v8, v9, 12, v8
    v_lshrrev_b32 v9, 5, v1
    v_lshl_add_u32 v8, v9, 8, v8
    v_add_u32 v8, s46, v2
    v_add_u32 v9, 4096, v8
    s_lshl_b32 s52, s40, 2
    s_add_u32 s52, s52, s53
    s_lshl_b32 s52, s52, 2
    s_and_b32 s47, s48, 3
    s_add_u32 s52, s52, s47
    s_lshl_b32 s52, s52, 7
    s_add_u32 s52, s52, 0x10a400
    s_add_u32 s52, s52, s76
    v_mov_b32 v120, -1
    v_mov_b32 v121, -1
    v_mov_b32 v122, -1
    v_mov_b32 v123, -1
    s_lshl_b32 s46, s49, 12
    s_lshl_b32 s47, s50, 10
    s_add_u32 s46, s46, s47
    s_add_u32 s46, s46, 0x1000000
    v_add_u32 v64, s46, v2
    s_and_b32 s46, s48, 3
    s_lshl_b32 s46, s46, 16
    s_lshl_b32 s47, s50, 14
    s_add_u32 s46, s46, s47
    s_lshl_b32 s47, s40, 8
    s_add_u32 s46, s46, s47
    s_add_u32 s46, s46, 0x7800000
    v_and_b32 v65, 15, v1
    v_lshlrev_b32 v65, 4, v65
    v_lshrrev_b32 v66, 4, v1
    v_lshl_add_u32 v65, v66, 11, v65
    v_add_u32 v65, s46, v65
    v_add_u32 v68, 8192, v65
    s_lshl_b32 s58, s74, 17
    s_lshl_b32 s46, s53, 3
    s_sub_u32 s46, 80, s46
    s_load_dwordx2 s[8:9], s[0:1], s46
    v_lshlrev_b32 v66, 7, v1
    s_mul_i32 s57, s49, 229376
    s_waitcnt lgkmcnt(0)
    s_mov_b32 s32, s8
    s_and_b32 s33, s9, 0xffff
    s_mov_b32 s34, 0x700000
    s_mov_b32 s35, 0x00020000
    s_mov_b32 s60, s74
    s_mul_i32 s61, s74, 65536
    s_mov_b32 s62, s74
    s_mul_i32 s63, s74, 786432
    s_mov_b32 s67, 0
    s_mov_b32 s68, 3
    s_mov_b32 s71, 0
    v_mov_b32 v15, 147456
    v_mov_b32 v14, 0
    ds_write_b32 v15, v14 offset:4
    ds_write_b32 v15, v14 offset:12
    ds_write_b32 v15, v14 offset:16
    v_mov_b32 v114, 1
    v_mov_b32 v115, 0
    s_mov_b32 s81, 0
    s_lshl_b32 s46, s44, 5
    v_add_u32 v119, s46, v15
    v_lshrrev_b32 v113, 4, v1
    s_mov_b32 s72, 0
    s_cmp_lg_u32 s44, 0
    s_cbranch_scc1 L_zwok_60
    v_and_b32 v10, 7, v1
    v_lshlrev_b32 v10, 5, v10
    s_mov_b32 s70, 0
L_zw_59:
    buffer_load_dword v11, v10, s[16:19], 0 offen sc1
    s_waitcnt vmcnt(0)
    v_add_u32_dpp v11, v11, v11 row_ror:1 row_mask:0xf bank_mask:0xf
    s_nop 1
    v_add_u32_dpp v11, v11, v11 row_ror:2 row_mask:0xf bank_mask:0xf
    s_nop 1
    v_add_u32_dpp v11, v11, v11 row_ror:4 row_mask:0xf bank_mask:0xf
    v_cmp_ne_u32 vcc, 0x100, v11
    s_add_u32 s70, s70, 1
    s_cbranch_vccz L_zwok_60
    s_sleep 4
    s_cmp_lt_u32 s70, 524288
    s_cbranch_scc1 L_zw_59
    s_branch L_c_done_1
L_zwok_60:
L_g_restart_51:
    s_cmp_lg_u32 s44, 0
    s_cbranch_scc1 L_g_nsp_52
    s_mov_b32 s70, 0
L_g_sp_58:
    s_add_u32 s54, s60, 0
    v_add_u32 v12, s54, v113
    v_and_b32 v13, 7, v12
    v_lshl_add_u32 v13, v13, 9, v7
    buffer_load_dword v11, v13, s[12:15], 0 offen sc1
    s_waitcnt vmcnt(0)
    v_cmp_ge_u32 vcc, v12, v11
    s_add_u32 s70, s70, 1
    s_and_b32 s46, vcc_lo, 0xffff
    s_cbranch_scc0 L_g_sp_58_ok
    s_sleep 3
    s_cmp_lt_u32 s70, 524288
    s_cbranch_scc1 L_g_sp_58
    s_branch L_c_done_1
L_g_sp_58_ok:
    v_cmp_ge_u32 vcc, v12, v11
    s_nop 0
    s_ff1_i32_b64 s46, vcc
    s_lshr_b32 s46, s46, 4
    s_min_u32 s46, s46, 4
    s_add_u32 s46, s46, s54
    s_min_u32 s46, s46, s75
    v_mov_b32 v118, s46
    ds_write_b32 v15, v118 offset:20
L_g_nsp_52:
    s_waitcnt lgkmcnt(0)
    s_barrier
    ds_read_b32 v14, v15 offset:20
    s_waitcnt lgkmcnt(0)
    v_readfirstlane_b32 s66, v14
    s_nop 3
L_g_restart_51_go:
    s_mov_b32 s69, 0
    s_cmp_gt_u32 s62, s60
    s_cbranch_scc1 L_g_nd_61
    s_cmp_ge_u32 s62, s66
    s_cbranch_scc1 L_g_nd_61
    s_add_u32 s47, s61, 4096
    s_add_u32 m0, s64, 0
    s_nop 0
    buffer_load_dwordx4 v3, s[12:15], s61 offen offset:0 sc1 lds
    buffer_load_dwordx4 v3, s[12:15], s61 offen offset:1024 sc1 lds
    buffer_load_dwordx4 v3, s[12:15], s61 offen offset:2048 sc1 lds
    buffer_load_dwordx4 v3, s[12:15], s61 offen offset:3072 sc1 lds
    s_add_u32 m0, s64, 4096
    s_nop 0
    buffer_load_dwordx4 v3, s[12:15], s47 offen offset:0 sc1 lds
    buffer_load_dwordx4 v3, s[12:15], s47 offen offset:1024 sc1 lds
    buffer_load_dwordx4 v3, s[12:15], s47 offen offset:2048 sc1 lds
    buffer_load_dwordx4 v3, s[12:15], s47 offen offset:3072 sc1 lds
    s_add_u32 s61, s61, 65536
    s_add_u32 s62, s62, 1
    s_xor_b32 s64, s64, 0x10000
    s_mov_b32 s69, 1
L_g_nd_61:
    s_cmp_eq_u32 s51, 1
    s_cbranch_scc1 L_g_g1r_53
    s_add_u32 s59, s60, 1
    s_mov_b32 s69, 0
    s_cmp_gt_u32 s62, s59
    s_cbranch_scc1 L_g_nd_62
    s_cmp_ge_u32 s62, s66
    s_cbranch_scc1 L_g_nd_62
    s_add_u32 s47, s61, 4096
    s_add_u32 m0, s64, 0
    s_nop 0
    buffer_load_dwordx4 v3, s[12:15], s61 offen offset:0 sc1 lds
    buffer_load_dwordx4 v3, s[12:15], s61 offen offset:1024 sc1 lds
    buffer_load_dwordx4 v3, s[12:15], s61 offen offset:2048 sc1 lds
    buffer_load_dwordx4 v3, s[12:15], s61 offen offset:3072 sc1 lds
    s_add_u32 m0, s64, 4096
    s_nop 0
    buffer_load_dwordx4 v3, s[12:15], s47 offen offset:0 sc1 lds
    buffer_load_dwordx4 v3, s[12:15], s47 offen offset:1024 sc1 lds
    buffer_load_dwordx4 v3, s[12:15], s47 offen offset:2048 sc1 lds
    buffer_load_dwordx4 v3, s[12:15], s47 offen offset:3072 sc1 lds
    s_add_u32 s61, s61, 65536
    s_add_u32 s62, s62, 1
    s_xor_b32 s64, s64, 0x10000
    s_mov_b32 s69, 1
L_g_nd_62:
    s_cmp_eq_u32 s69, 1
    s_cbranch_scc1 L_g_w0_63
    s_waitcnt vmcnt(0)
L_g_w0_63:
    s_waitcnt vmcnt(8)
    s_cmp_lg_u32 s44, 0
    s_cbranch_scc1 L_g_nl_64
    s_cmp_lt_u32 s66, s75
    s_cselect_b32 s81, 1, 2
L_g_nl_64:
L_g_loop0_54_l:
    s_barrier
    ds_read_b128 v[32:35], v4 offset:0
    ds_read_b128 v[36:39], v4 offset:256
    ds_read_b128 v[40:43], v4 offset:2048
    ds_read_b128 v[44:47], v4 offset:2304
    ds_read_b128 v[48:51], v4 offset:4096
    ds_read_b128 v[52:55], v4 offset:4352
    ds_read_b128 v[56:59], v4 offset:6144
    ds_read_b128 v[60:63], v4 offset:6400
    s_branch L_g_loop0_54_m
.p2align 6
L_g_loop0_54:
    s_barrier
L_g_loop0_54_m:
    s_setprio 2
    s_waitcnt lgkmcnt(6)
    v_mfma_f32_16x16x32_bf16 v[16:19], a[0:3], v[32:35], 0
    v_mfma_f32_16x16x32_bf16 v[20:23], a[4:7], v[32:35], 0
    ds_read_b128 v[32:35], v4 offset:8192
    v_mfma_f32_16x16x32_bf16 v[28:31], a[4:7], v[36:39], 0
    v_mfma_f32_16x16x32_bf16 v[24:27], a[0:3], v[36:39], 0
    ds_read_b128 v[36:39], v4 offset:8448
    s_cmp_eq_u32 s81, 1
    s_cbranch_scc1 L_g_h1_68
L_g_h1_68_b:
    s_waitcnt lgkmcnt(6)
    v_mfma_f32_16x16x32_bf16 v[16:19], a[8:11], v[40:43], v[16:19]
    v_mfma_f32_16x16x32_bf16 v[20:23], a[12:15], v[40:43], v[20:23]
    ds_read_b128 v[40:43], v4 offset:10240
    v_mfma_f32_16x16x32_bf16 v[28:31], a[12:15], v[44:47], v[28:31]
    v_mfma_f32_16x16x32_bf16 v[24:27], a[8:11], v[44:47], v[24:27]
    ds_read_b128 v[44:47], v4 offset:10496
    s_waitcnt lgkmcnt(6)
    v_mfma_f32_16x16x32_bf16 v[16:19], a[16:19], v[48:51], v[16:19]
    v_mfma_f32_16x16x32_bf16 v[20:23], a[20:23], v[48:51], v[20:23]
    ds_read_b128 v[48:51], v4 offset:12288
    v_mfma_f32_16x16x32_bf16 v[28:31], a[20:23], v[52:55], v[28:31]
    v_mfma_f32_16x16x32_bf16 v[24:27], a[16:19], v[52:55], v[24:27]
    ds_read_b128 v[52:55], v4 offset:12544
    s_waitcnt lgkmcnt(6)
    v_mfma_f32_16x16x32_bf16 v[16:19], a[24:27], v[56:59], v[16:19]
    v_mfma_f32_16x16x32_bf16 v[20:23], a[28:31], v[56:59], v[20:23]
    ds_read_b128 v[56:59], v4 offset:14336
    v_mfma_f32_16x16x32_bf16 v[28:31], a[28:31], v[60:63], v[28:31]
    v_mfma_f32_16x16x32_bf16 v[24:27], a[24:27], v[60:63], v[24:27]
    ds_read_b128 v[60:63], v4 offset:14592
    s_waitcnt lgkmcnt(6)
    v_mfma_f32_16x16x32_bf16 v[16:19], a[32:35], v[32:35], v[16:19]
    v_mfma_f32_16x16x32_bf16 v[20:23], a[36:39], v[32:35], v[20:23]
    ds_read_b128 v[32:35], v4 offset:16384
    v_mfma_f32_16x16x32_bf16 v[28:31], a[36:39], v[36:39], v[28:31]
    v_mfma_f32_16x16x32_bf16 v[24:27], a[32:35], v[36:39], v[24:27]
    ds_read_b128 v[36:39], v4 offset:16640
    s_waitcnt lgkmcnt(6)
    v_mfma_f32_16x16x32_bf16 v[16:19], a[40:43], v[40:43], v[16:19]
    v_mfma_f32_16x16x32_bf16 v[20:23], a[44:47], v[40:43], v[20:23]
    ds_read_b128 v[40:43], v4 offset:18432
    v_mfma_f32_16x16x32_bf16 v[28:31], a[44:47], v[44:47], v[28:31]
    v_mfma_f32_16x16x32_bf16 v[24:27], a[40:43], v[44:47], v[24:27]
    ds_read_b128 v[44:47], v4 offset:18688
    s_waitcnt lgkmcnt(6)
    v_mfma_f32_16x16x32_bf16 v[16:19], a[48:51], v[48:51], v[16:19]
    v_mfma_f32_16x16x32_bf16 v[20:23], a[52:55], v[48:51], v[20:23]
    ds_read_b128 v[48:51], v4 offset:20480
    v_mfma_f32_16x16x32_bf16 v[28:31], a[52:55], v[52:55], v[28:31]
    v_mfma_f32_16x16x32_bf16 v[24:27], a[48:51], v[52:55], v[24:27]
    ds_read_b128 v[52:55], v4 offset:20736
    s_waitcnt lgkmcnt(6)
    v_mfma_f32_16x16x32_bf16 v[16:19], a[56:59], v[56:59], v[16:19]
    v_mfma_f32_16x16x32_bf16 v[20:23], a[60:63], v[56:59], v[20:23]
    ds_read_b128 v[56:59], v4 offset:22528
    v_mfma_f32_16x16x32_bf16 v[28:31], a[60:63], v[60:63], v[28:31]
    v_mfma_f32_16x16x32_bf16 v[24:27], a[56:59], v[60:63], v[24:27]
    ds_read_b128 v[60:63], v4 offset:22784
    s_waitcnt lgkmcnt(6)
    v_mfma_f32_16x16x32_bf16 v[16:19], a[64:67], v[32:35], v[16:19]
    v_mfma_f32_16x16x32_bf16 v[20:23], a[68:71], v[32:35], v[20:23]
    ds_read_b128 v[32:35], v4 offset:24576
    v_mfma_f32_16x16x32_bf16 v[28:31], a[68:71], v[36:39], v[28:31]
    v_mfma_f32_16x16x32_bf16 v[24:27], a[64:67], v[36:39], v[24:27]
    ds_read_b128 v[36:39], v4 offset:24832
    s_waitcnt lgkmcnt(6)
    v_mfma_f32_16x16x32_bf16 v[16:19], a[72:75], v[40:43], v[16:19]
    v_mfma_f32_16x16x32_bf16 v[20:23], a[76:79], v[40:43], v[20:23]
    ds_read_b128 v[40:43], v4 offset:26624
    v_mfma_f32_16x16x32_bf16 v[28:31], a[76:79], v[44:47], v[28:31]
    v_mfma_f32_16x16x32_bf16 v[24:27], a[72:75], v[44:47], v[24:27]
    ds_read_b128 v[44:47], v4 offset:26880
    s_waitcnt lgkmcnt(6)
    v_mfma_f32_16x16x32_bf16 v[16:19], a[80:83], v[48:51], v[16:19]
    v_mfma_f32_16x16x32_bf16 v[20:23], a[84:87], v[48:51], v[20:23]
    ds_read_b128 v[48:51], v4 offset:28672
    v_mfma_f32_16x16x32_bf16 v[28:31], a[84:87], v[52:55], v[28:31]
    v_mfma_f32_16x16x32_bf16 v[24:27], a[80:83], v[52:55], v[24:27]
    ds_read_b128 v[52:55], v4 offset:28928
    s_waitcnt lgkmcnt(6)
    v_mfma_f32_16x16x32_bf16 v[16:19], a[88:91], v[56:59], v[16:19]
    v_mfma_f32_16x16x32_bf16 v[20:23], a[92:95], v[56:59], v[20:23]
    ds_read_b128 v[56:59], v4 offset:30720
    v_mfma_f32_16x16x32_bf16 v[28:31], a[92:95], v[60:63], v[28:31]
    v_mfma_f32_16x16x32_bf16 v[24:27], a[88:91], v[60:63], v[24:27]
    ds_read_b128 v[60:63], v4 offset:30976
    s_waitcnt lgkmcnt(6)
    v_mfma_f32_16x16x32_bf16 v[16:19], a[96:99], v[32:35], v[16:19]
    v_mfma_f32_16x16x32_bf16 v[20:23], a[100:103], v[32:35], v[20:23]
    v_mfma_f32_16x16x32_bf16 v[28:31], a[100:103], v[36:39], v[28:31]
    v_mfma_f32_16x16x32_bf16 v[24:27], a[96:99], v[36:39], v[24:27]
    s_waitcnt lgkmcnt(4)
    v_mfma_f32_16x16x32_bf16 v[16:19], a[104:107], v[40:43], v[16:19]
    v_mfma_f32_16x16x32_bf16 v[20:23], a[108:111], v[40:43], v[20:23]
    v_mfma_f32_16x16x32_bf16 v[28:31], a[108:111], v[44:47], v[28:31]
    v_mfma_f32_16x16x32_bf16 v[24:27], a[104:107], v[44:47], v[24:27]
    s_waitcnt lgkmcnt(2)
    v_mfma_f32_16x16x32_bf16 v[16:19], a[112:115], v[48:51], v[16:19]
    v_mfma_f32_16x16x32_bf16 v[20:23], a[116:119], v[48:51], v[20:23]
    s_cmp_eq_u32 s81, 1
    s_cbranch_scc1 L_g_h2_69
L_g_h2_69_b:
    ds_write_b32 v119, v118
    v_mfma_f32_16x16x32_bf16 v[28:31], a[116:119], v[52:55], v[28:31]
    v_mfma_f32_16x16x32_bf16 v[24:27], a[112:115], v[52:55], v[24:27]
    s_waitcnt lgkmcnt(0)
    v_mfma_f32_16x16x32_bf16 v[16:19], a[120:123], v[56:59], v[16:19]
    v_mfma_f32_16x16x32_bf16 v[20:23], a[124:127], v[56:59], v[20:23]
    v_mfma_f32_16x16x32_bf16 v[28:31], a[124:127], v[60:63], v[28:31]
    v_mfma_f32_16x16x32_bf16 v[24:27], a[120:123], v[60:63], v[24:27]
    v_xor_b32 v4, 0x10000, v4
    s_setprio 0
    s_waitcnt vmcnt(0)
    s_waitcnt lgkmcnt(0)
    s_barrier
    ds_read_b32 v14, v15
    s_nop 6
    ds_write_b128 v5, v[16:19] offset:0
    ds_write_b128 v5, v[20:23] offset:1024
    ds_write_b128 v5, v[24:27] offset:2048
    ds_write_b128 v5, v[28:31] offset:3072
    s_waitcnt lgkmcnt(4)
    v_readfirstlane_b32 s66, v14
    s_add_u32 s60, s60, 1
    s_mov_b32 s65, 0
    s_cmp_le_u32 s62, s60
    s_cbranch_scc1 L_g_dp_70_l
L_g_dp_70_a:
    s_cmp_ge_u32 s62, s66
    s_cbranch_scc1 L_g_dp_70_d
    s_add_u32 s47, s61, 4096
    s_mov_b32 m0, s64
    s_add_u32 s62, s62, 1
    buffer_load_dwordx4 v3, s[12:15], s61 offen offset:0 sc1 lds
    buffer_load_dwordx4 v3, s[12:15], s61 offen offset:1024 sc1 lds
    buffer_load_dwordx4 v3, s[12:15], s61 offen offset:2048 sc1 lds
    buffer_load_dwordx4 v3, s[12:15], s61 offen offset:3072 sc1 lds
    s_add_u32 m0, s64, 4096
    s_add_u32 s61, s61, 65536
    buffer_load_dwordx4 v3, s[12:15], s47 offen offset:0 sc1 lds
    buffer_load_dwordx4 v3, s[12:15], s47 offen offset:1024 sc1 lds
    buffer_load_dwordx4 v3, s[12:15], s47 offen offset:2048 sc1 lds
    buffer_load_dwordx4 v3, s[12:15], s47 offen offset:3072 sc1 lds
    s_xor_b32 s64, s64, 0x10000
L_g_dp_70_d:
    s_cmp_le_u32 s66, s60
    s_cbranch_scc1 L_g_ex0_67
    s_cmp_lg_u32 s65, 0
    s_cbranch_scc1 L_g_nw_66
    ds_read_b128 v[32:35], v4 offset:0
    ds_read_b128 v[36:39], v4 offset:256
    ds_read_b128 v[40:43], v4 offset:2048
    ds_read_b128 v[44:47], v4 offset:2304
    ds_read_b128 v[48:51], v4 offset:4096
    ds_read_b128 v[52:55], v4 offset:4352
    ds_read_b128 v[56:59], v4 offset:6144
    ds_read_b128 v[60:63], v4 offset:6400
    s_cmp_lg_u32 s44, 0
    s_cbranch_scc1 L_g_nl_71
    s_mov_b32 s46, s66
    s_cmp_lg_u32 s81, 0
    s_cbranch_scc1 L_g_nl_71_e
    v_cmp_ge_u32 vcc, v12, v11
    s_nop 0
    s_ff1_i32_b64 s46, vcc
    s_lshr_b32 s46, s46, 4
    s_min_u32 s46, s46, 4
    s_add_u32 s46, s46, s54
    s_min_u32 s46, s46, s75
    v_mov_b32 v118, s46
L_g_nl_71_e:
    s_add_u32 s47, s60, 3
    s_min_u32 s47, s47, s75
    s_cmp_lt_u32 s46, s47
    s_cselect_b32 s81, 1, 0
    s_cbranch_scc1 L_g_nl_71
    s_add_u32 s54, s60, 2
    v_add_u32 v12, s54, v113
    v_and_b32 v13, 7, v12
    v_lshl_add_u32 v13, v13, 9, v7
    buffer_load_dword v11, v13, s[12:15], 0 offen sc1
L_g_nl_71:
    s_waitcnt lgkmcnt(8)
    s_branch L_g_loop0_54
L_g_ex0_67:
    s_cmp_lg_u32 s44, 0
    s_cbranch_scc1 L_g_ex0_67_n
    ds_write_b32 v15, v118 offset:20
    s_cmp_ge_u32 s60, s75
    s_cbranch_scc1 L_g_ex0_67_n
    s_sleep 6
    s_add_u32 s54, s60, 0
    v_add_u32 v12, s54, v113
    v_and_b32 v13, 7, v12
    v_lshl_add_u32 v13, v13, 9, v7
    buffer_load_dword v11, v13, s[12:15], 0 offen sc1
    s_waitcnt vmcnt(0)
    v_cmp_ge_u32 vcc, v12, v11
    s_nop 0
    s_ff1_i32_b64 s46, vcc
    s_lshr_b32 s46, s46, 4
    s_min_u32 s46, s46, 4
    s_add_u32 s46, s46, s54
    s_min_u32 s46, s46, s75
    v_mov_b32 v118, s46
    ds_write_b32 v15, v118 offset:20
L_g_ex0_67_n:
    s_waitcnt lgkmcnt(0)
    s_barrier
    ds_read_b32 v14, v15 offset:20
    s_waitcnt lgkmcnt(0)
    v_readfirstlane_b32 s66, v14
    s_barrier
    s_cmp_gt_u32 s66, s60
    s_cbranch_scc1 L_g_restart_51_go
    s_branch L_g_tail_56
L_g_g1r_53:
    s_mov_b32 s65, 1
    s_branch L_g_loop1_55_e
.p2align 6
L_g_loop1_55:
    s_mov_b32 s65, 0
L_g_loop1_55_e:
    s_barrier
    s_bitcmp1_b32 s67, 1
    s_cbranch_scc0 L_g_nfl_72
    s_cmp_lg_u32 s44, 4
    s_cbranch_scc1 L_g_nfl_72_d
    s_sub_u32 s59, s60, 1
    v_mov_b32 v10, s59
    buffer_store_dword v10, v115, s[12:15], s52 offen sc1
L_g_nfl_72_d:
    ds_read_b128 v[80:83], v5 offset:0
    ds_read_b128 v[84:87], v5 offset:1024
    ds_read_b128 v[88:91], v5 offset:2048
    ds_read_b128 v[92:95], v5 offset:3072
    s_cmp_le_u32 s62, s60
    s_cbranch_scc1 L_g_dp_77_l
L_g_dp_77_a:
    s_cmp_ge_u32 s62, s66
    s_cbranch_scc1 L_g_dp_77_d
    s_add_u32 s47, s61, 4096
    s_mov_b32 m0, s64
    s_add_u32 s62, s62, 1
    buffer_load_dwordx4 v3, s[12:15], s61 offen offset:0 sc1 lds
    buffer_load_dwordx4 v3, s[12:15], s61 offen offset:1024 sc1 lds
    buffer_load_dwordx4 v3, s[12:15], s61 offen offset:2048 sc1 lds
    buffer_load_dwordx4 v3, s[12:15], s61 offen offset:3072 sc1 lds
    s_add_u32 m0, s64, 4096
    s_add_u32 s61, s61, 65536
    buffer_load_dwordx4 v3, s[12:15], s47 offen offset:0 sc1 lds
    buffer_load_dwordx4 v3, s[12:15], s47 offen offset:1024 sc1 lds
    buffer_load_dwordx4 v3, s[12:15], s47 offen offset:2048 sc1 lds
    buffer_load_dwordx4 v3, s[12:15], s47 offen offset:3072 sc1 lds
    s_xor_b32 s64, s64, 0x10000
L_g_dp_77_d:
    s_bitcmp1_b32 s67, 0
    s_cbranch_scc0 L_g_nep_73
    s_waitcnt lgkmcnt(0)
    v_add_f32 v80, v80, v16
    v_add_f32 v81, v81, v17
    v_add_f32 v82, v82, v18
    v_add_f32 v83, v83, v19
    v_add_f32 v84, v84, v20
    v_add_f32 v85, v85, v21
    v_add_f32 v86, v86, v22
    v_add_f32 v87, v87, v23
    v_add_f32 v88, v88, v24
    v_add_f32 v89, v89, v25
    v_add_f32 v90, v90, v26
    v_add_f32 v91, v91, v27
    v_add_f32 v92, v92, v28
    v_add_f32 v93, v93, v29
    v_add_f32 v94, v94, v30
    v_add_f32 v95, v95, v31
    v_cvt_pk_bf16_f32 v104, v80, v81
    v_cvt_pk_bf16_f32 v105, v82, v83
    v_cvt_pk_bf16_f32 v106, v84, v85
    v_cvt_pk_bf16_f32 v107, v86, v87
    buffer_store_dwordx4 v[104:107], v8, s[12:15], s63 offen sc1
    v_cvt_pk_bf16_f32 v108, v88, v89
    v_cvt_pk_bf16_f32 v109, v90, v91
    v_cvt_pk_bf16_f32 v110, v92, v93
    v_cvt_pk_bf16_f32 v111, v94, v95
    buffer_store_dwordx4 v[108:111], v9, s[12:15], s63 offen sc1
    s_add_u32 s63, s63, 786432
    s_cmp_lg_u32 s53, 2
    s_cbranch_scc1 L_g_pf_78
    s_lshl_b32 s73, s58, 1
    buffer_store_dwordx4 v[120:123], v64, s[12:15], s58 offen sc1
    buffer_store_dwordx4 v[120:123], v65, s[12:15], s73 offen sc1
    buffer_store_dwordx4 v[120:123], v68, s[12:15], s73 offen sc1
    s_add_u32 s58, s58, 131072
L_g_pf_78:
    s_cmp_le_u32 s60, 2
    s_cbranch_scc1 L_g_nep_73_e
L_g_nep_73:
    s_cmp_lg_u32 s65, 0
    s_cbranch_scc1 L_g_nw1_74
    ds_read_b128 v[32:35], v4 offset:0
    ds_read_b128 v[36:39], v4 offset:256
    ds_read_b128 v[40:43], v4 offset:2048
    ds_read_b128 v[44:47], v4 offset:2304
    ds_read_b128 v[48:51], v4 offset:4096
    ds_read_b128 v[52:55], v4 offset:4352
    ds_read_b128 v[56:59], v4 offset:6144
    ds_read_b128 v[60:63], v4 offset:6400
    s_barrier
L_g_jn_76:
    s_setprio 1
    s_waitcnt lgkmcnt(6)
    v_mfma_f32_16x16x32_bf16 v[16:19], a[0:3], v[32:35], 0
    ds_read_b32 v14, v15
    v_mfma_f32_16x16x32_bf16 v[20:23], a[4:7], v[32:35], 0
    ds_read_b128 v[32:35], v4 offset:8192
    v_mfma_f32_16x16x32_bf16 v[28:31], a[4:7], v[36:39], 0
    v_mfma_f32_16x16x32_bf16 v[24:27], a[0:3], v[36:39], 0
    ds_read_b128 v[36:39], v4 offset:8448
    s_waitcnt lgkmcnt(6)
    v_mfma_f32_16x16x32_bf16 v[16:19], a[8:11], v[40:43], v[16:19]
    v_mfma_f32_16x16x32_bf16 v[20:23], a[12:15], v[40:43], v[20:23]
    ds_read_b128 v[40:43], v4 offset:10240
    v_mfma_f32_16x16x32_bf16 v[28:31], a[12:15], v[44:47], v[28:31]
    v_mfma_f32_16x16x32_bf16 v[24:27], a[8:11], v[44:47], v[24:27]
    ds_read_b128 v[44:47], v4 offset:10496
    s_waitcnt lgkmcnt(6)
    v_mfma_f32_16x16x32_bf16 v[16:19], a[16:19], v[48:51], v[16:19]
    v_mfma_f32_16x16x32_bf16 v[20:23], a[20:23], v[48:51], v[20:23]
    ds_read_b128 v[48:51], v4 offset:12288
    v_mfma_f32_16x16x32_bf16 v[28:31], a[20:23], v[52:55], v[28:31]
    v_mfma_f32_16x16x32_bf16 v[24:27], a[16:19], v[52:55], v[24:27]
    ds_read_b128 v[52:55], v4 offset:12544
    s_waitcnt lgkmcnt(6)
    v_mfma_f32_16x16x32_bf16 v[16:19], a[24:27], v[56:59], v[16:19]
    v_mfma_f32_16x16x32_bf16 v[20:23], a[28:31], v[56:59], v[20:23]
    ds_read_b128 v[56:59], v4 offset:14336
    v_mfma_f32_16x16x32_bf16 v[28:31], a[28:31], v[60:63], v[28:31]
    v_mfma_f32_16x16x32_bf16 v[24:27], a[24:27], v[60:63], v[24:27]
    ds_read_b128 v[60:63], v4 offset:14592
    s_waitcnt lgkmcnt(6)
    v_mfma_f32_16x16x32_bf16 v[16:19], a[32:35], v[32:35], v[16:19]
    v_mfma_f32_16x16x32_bf16 v[20:23], a[36:39], v[32:35], v[20:23]
    ds_read_b128 v[32:35], v4 offset:16384
    v_mfma_f32_16x16x32_bf16 v[28:31], a[36:39], v[36:39], v[28:31]
    v_mfma_f32_16x16x32_bf16 v[24:27], a[32:35], v[36:39], v[24:27]
    ds_read_b128 v[36:39], v4 offset:16640
    s_waitcnt lgkmcnt(6)
    v_mfma_f32_16x16x32_bf16 v[16:19], a[40:43], v[40:43], v[16:19]
    v_mfma_f32_16x16x32_bf16 v[20:23], a[44:47], v[40:43], v[20:23]
    ds_read_b128 v[40:43], v4 offset:18432
    v_mfma_f32_16x16x32_bf16 v[28:31], a[44:47], v[44:47], v[28:31]
    v_mfma_f32_16x16x32_bf16 v[24:27], a[40:43], v[44:47], v[24:27]
    ds_read_b128 v[44:47], v4 offset:18688
    s_waitcnt lgkmcnt(6)
    v_mfma_f32_16x16x32_bf16 v[16:19], a[48:51], v[48:51], v[16:19]
    v_mfma_f32_16x16x32_bf16 v[20:23], a[52:55], v[48:51], v[20:23]
    ds_read_b128 v[48:51], v4 offset:20480
    v_mfma_f32_16x16x32_bf16 v[28:31], a[52:55], v[52:55], v[28:31]
    v_mfma_f32_16x16x32_bf16 v[24:27], a[48:51], v[52:55], v[24:27]
    ds_read_b128 v[52:55], v4 offset:20736
    s_waitcnt lgkmcnt(6)
    v_mfma_f32_16x16x32_bf16 v[16:19], a[56:59], v[56:59], v[16:19]
    v_mfma_f32_16x16x32_bf16 v[20:23], a[60:63], v[56:59], v[20:23]
    ds_read_b128 v[56:59], v4 offset:22528
    v_mfma_f32_16x16x32_bf16 v[28:31], a[60:63], v[60:63], v[28:31]
    v_mfma_f32_16x16x32_bf16 v[24:27], a[56:59], v[60:63], v[24:27]
    ds_read_b128 v[60:63], v4 offset:22784
    s_waitcnt lgkmcnt(6)
    v_mfma_f32_16x16x32_bf16 v[16:19], a[64:67], v[32:35], v[16:19]
    v_mfma_f32_16x16x32_bf16 v[20:23], a[68:71], v[32:35], v[20:23]
    ds_read_b128 v[32:35], v4 offset:24576
    v_mfma_f32_16x16x32_bf16 v[28:31], a[68:71], v[36:39], v[28:31]
    v_mfma_f32_16x16x32_bf16 v[24:27], a[64:67], v[36:39], v[24:27]
    ds_read_b128 v[36:39], v4 offset:24832
    s_waitcnt lgkmcnt(6)
    v_mfma_f32_16x16x32_bf16 v[16:19], a[72:75], v[40:43], v[16:19]
    v_mfma_f32_16x16x32_bf16 v[20:23], a[76:79], v[40:43], v[20:23]
    ds_read_b128 v[40:43], v4 offset:26624
    v_mfma_f32_16x16x32_bf16 v[28:31], a[76:79], v[44:47], v[28:31]
    v_mfma_f32_16x16x32_bf16 v[24:27], a[72:75], v[44:47], v[24:27]
    ds_read_b128 v[44:47], v4 offset:26880
    s_waitcnt lgkmcnt(6)
    v_mfma_f32_16x16x32_bf16 v[16:19], a[80:83], v[48:51], v[16:19]
    v_mfma_f32_16x16x32_bf16 v[20:23], a[84:87], v[48:51], v[20:23]
    ds_read_b128 v[48:51], v4 offset:28672
    v_mfma_f32_16x16x32_bf16 v[28:31], a[84:87], v[52:55], v[28:31]
    v_mfma_f32_16x16x32_bf16 v[24:27], a[80:83], v[52:55], v[24:27]
    ds_read_b128 v[52:55], v4 offset:28928
    s_waitcnt lgkmcnt(6)
    v_mfma_f32_16x16x32_bf16 v[16:19], a[88:91], v[56:59], v[16:19]
    v_mfma_f32_16x16x32_bf16 v[20:23], a[92:95], v[56:59], v[20:23]
    ds_read_b128 v[56:59], v4 offset:30720
    v_mfma_f32_16x16x32_bf16 v[28:31], a[92:95], v[60:63], v[28:31]
    v_mfma_f32_16x16x32_bf16 v[24:27], a[88:91], v[60:63], v[24:27]
    ds_read_b128 v[60:63], v4 offset:30976
    s_waitcnt lgkmcnt(6)
    v_mfma_f32_16x16x32_bf16 v[16:19], a[96:99], v[32:35], v[16:19]
    v_mfma_f32_16x16x32_bf16 v[20:23], a[100:103], v[32:35], v[20:23]
    v_mfma_f32_16x16x32_bf16 v[28:31], a[100:103], v[36:39], v[28:31]
    v_mfma_f32_16x16x32_bf16 v[24:27], a[96:99], v[36:39], v[24:27]
    s_waitcnt lgkmcnt(4)
    v_mfma_f32_16x16x32_bf16 v[16:19], a[104:107], v[40:43], v[16:19]
    v_mfma_f32_16x16x32_bf16 v[20:23], a[108:111], v[40:43], v[20:23]
    v_mfma_f32_16x16x32_bf16 v[28:31], a[108:111], v[44:47], v[28:31]
    v_mfma_f32_16x16x32_bf16 v[24:27], a[104:107], v[44:47], v[24:27]
    s_waitcnt lgkmcnt(2)
    v_mfma_f32_16x16x32_bf16 v[16:19], a[112:115], v[48:51], v[16:19]
    v_mfma_f32_16x16x32_bf16 v[20:23], a[116:119], v[48:51], v[20:23]
    v_mfma_f32_16x16x32_bf16 v[28:31], a[116:119], v[52:55], v[28:31]
    v_mfma_f32_16x16x32_bf16 v[24:27], a[112:115], v[52:55], v[24:27]
    s_waitcnt lgkmcnt(0)
    v_mfma_f32_16x16x32_bf16 v[16:19], a[120:123], v[56:59], v[16:19]
    v_mfma_f32_16x16x32_bf16 v[20:23], a[124:127], v[56:59], v[20:23]
    v_mfma_f32_16x16x32_bf16 v[28:31], a[124:127], v[60:63], v[28:31]
    v_mfma_f32_16x16x32_bf16 v[24:27], a[120:123], v[60:63], v[24:27]
    v_xor_b32 v4, 0x10000, v4
    s_setprio 0
    s_waitcnt vmcnt(0)
    v_readfirstlane_b32 s66, v14
    s_lshl_b32 s67, s67, 1
    s_or_b32 s67, s67, 1
    s_add_u32 s60, s60, 1
    s_cmp_gt_u32 s66, s60
    s_cbranch_scc1 L_g_loop1_55
    s_barrier
    ds_read_b32 v14, v15 offset:20
    ds_read_b128 v[80:83], v5 offset:0
    ds_read_b128 v[84:87], v5 offset:1024
    ds_read_b128 v[88:91], v5 offset:2048
    ds_read_b128 v[92:95], v5 offset:3072
    s_waitcnt lgkmcnt(4)
    v_readfirstlane_b32 s66, v14
    s_barrier
    s_mov_b32 s69, 0
    s_cmp_gt_u32 s62, s60
    s_cbranch_scc1 L_g_nd_79
    s_cmp_ge_u32 s62, s66
    s_cbranch_scc1 L_g_nd_79
    s_add_u32 s47, s61, 4096
    s_add_u32 m0, s64, 0
    s_nop 0
    buffer_load_dwordx4 v3, s[12:15], s61 offen offset:0 sc1 lds
    buffer_load_dwordx4 v3, s[12:15], s61 offen offset:1024 sc1 lds
    buffer_load_dwordx4 v3, s[12:15], s61 offen offset:2048 sc1 lds
    buffer_load_dwordx4 v3, s[12:15], s61 offen offset:3072 sc1 lds
    s_add_u32 m0, s64, 4096
    s_nop 0
    buffer_load_dwordx4 v3, s[12:15], s47 offen offset:0 sc1 lds
    buffer_load_dwordx4 v3, s[12:15], s47 offen offset:1024 sc1 lds
    buffer_load_dwordx4 v3, s[12:15], s47 offen offset:2048 sc1 lds
    buffer_load_dwordx4 v3, s[12:15], s47 offen offset:3072 sc1 lds
    s_add_u32 s61, s61, 65536
    s_add_u32 s62, s62, 1
    s_xor_b32 s64, s64, 0x10000
    s_mov_b32 s69, 1
L_g_nd_79:
    s_sub_u32 s59, s60, 1
    s_waitcnt lgkmcnt(3)
    v_add_f32 v80, v80, v16
    v_add_f32 v81, v81, v17
    v_add_f32 v82, v82, v18
    v_add_f32 v83, v83, v19
    s_waitcnt lgkmcnt(2)
    v_add_f32 v84, v84, v20
    v_add_f32 v85, v85, v21
    v_add_f32 v86, v86, v22
    v_add_f32 v87, v87, v23
    s_waitcnt lgkmcnt(1)
    v_add_f32 v88, v88, v24
    v_add_f32 v89, v89, v25
    v_add_f32 v90, v90, v26
    v_add_f32 v91, v91, v27
    s_waitcnt lgkmcnt(0)
    v_add_f32 v92, v92, v28
    v_add_f32 v93, v93, v29
    v_add_f32 v94, v94, v30
    v_add_f32 v95, v95, v31
    v_cvt_pk_bf16_f32 v104, v80, v81
    v_cvt_pk_bf16_f32 v105, v82, v83
    v_cvt_pk_bf16_f32 v106, v84, v85
    v_cvt_pk_bf16_f32 v107, v86, v87
    buffer_store_dwordx4 v[104:107], v8, s[12:15], s63 offen sc1
    v_cvt_pk_bf16_f32 v108, v88, v89
    v_cvt_pk_bf16_f32 v109, v90, v91
    v_cvt_pk_bf16_f32 v110, v92, v93
    v_cvt_pk_bf16_f32 v111, v94, v95
    buffer_store_dwordx4 v[108:111], v9, s[12:15], s63 offen sc1
    s_add_u32 s63, s63, 786432
    s_cmp_lg_u32 s53, 2
    s_cbranch_scc1 L_g_pf_80
    s_lshl_b32 s73, s58, 1
    buffer_store_dwordx4 v[120:123], v64, s[12:15], s58 offen sc1
    buffer_store_dwordx4 v[120:123], v65, s[12:15], s73 offen sc1
    buffer_store_dwordx4 v[120:123], v68, s[12:15], s73 offen sc1
    s_add_u32 s58, s58, 131072
L_g_pf_80:
    s_mov_b32 s67, 0
    s_mov_b32 s71, 1
    s_cmp_gt_u32 s66, s60
    s_cbranch_scc1 L_g_g1r_53
    v_mov_b32 v10, 1
    s_mov_b64 exec, 1
    s_waitcnt vmcnt(0)
    ds_add_rtn_u32 v10, v15, v10 offset:4
    s_waitcnt lgkmcnt(0)
    v_readfirstlane_b32 s46, v10
    s_mov_b64 exec, -1
    s_mov_b32 s71, 0
    s_sub_u32 s59, s60, 1
    s_cmp_lg_u32 s46, s68
    s_cbranch_scc1 L_g_df_81
    v_mov_b32 v10, s59
    v_add_u32 v10, 1, v10
    v_mov_b32 v11, 0
    s_mov_b64 exec, 1
    buffer_store_dword v10, v11, s[12:15], s52 offen sc1
    s_mov_b64 exec, -1
L_sf_82:
L_g_df_81:
    s_add_u32 s68, s68, 4
    s_cmp_gt_u32 s66, s60
    s_cbranch_scc1 L_g_g1r_53
L_g_tail_56:
    s_cmp_lt_u32 s60, s75
    s_cbranch_scc1 L_g_restart_51
    s_waitcnt vmcnt(0)
    s_barrier
    s_branch L_w_p2_11
L_g_h1_68:
    s_add_u32 s54, s60, 1
    v_add_u32 v12, s54, v113
    v_and_b32 v13, 7, v12
    v_lshl_add_u32 v13, v13, 9, v7
    buffer_load_dword v11, v13, s[12:15], 0 offen sc1
    s_branch L_g_h1_68_b
L_g_h2_69:
    s_waitcnt vmcnt(0)
    v_cmp_ge_u32 vcc, v12, v11
    s_nop 0
    s_ff1_i32_b64 s46, vcc
    s_lshr_b32 s46, s46, 4
    s_min_u32 s46, s46, 4
    s_add_u32 s46, s46, s54
    s_min_u32 s46, s46, s75
    v_mov_b32 v118, s46
    s_branch L_g_h2_69_b
L_g_dp_70_l:
    s_cmp_ge_u32 s62, s66
    s_cbranch_scc1 L_g_dp_70_d
    s_mov_b32 s65, 1
    s_add_u32 s47, s61, 4096
    s_mov_b32 m0, s64
    s_add_u32 s62, s62, 1
    buffer_load_dwordx4 v3, s[12:15], s61 offen offset:0 sc1 lds
    buffer_load_dwordx4 v3, s[12:15], s61 offen offset:1024 sc1 lds
    buffer_load_dwordx4 v3, s[12:15], s61 offen offset:2048 sc1 lds
    buffer_load_dwordx4 v3, s[12:15], s61 offen offset:3072 sc1 lds
    s_add_u32 m0, s64, 4096
    s_add_u32 s61, s61, 65536
    buffer_load_dwordx4 v3, s[12:15], s47 offen offset:0 sc1 lds
    buffer_load_dwordx4 v3, s[12:15], s47 offen offset:1024 sc1 lds
    buffer_load_dwordx4 v3, s[12:15], s47 offen offset:2048 sc1 lds
    buffer_load_dwordx4 v3, s[12:15], s47 offen offset:3072 sc1 lds
    s_xor_b32 s64, s64, 0x10000
    s_branch L_g_dp_70_a
L_g_nw_66:
    s_waitcnt vmcnt(0) lgkmcnt(0)
    s_cmp_lg_u32 s44, 0
    s_cbranch_scc1 L_g_nl_83
    s_cmp_lt_u32 s66, s75
    s_cselect_b32 s81, 1, 2
L_g_nl_83:
    s_branch L_g_loop0_54_l
L_g_nfl_72:
    s_cmp_eq_u32 s71, 0
    s_cbranch_scc1 L_g_nfl_72_d
    v_mov_b32 v10, 1
    s_mov_b64 exec, 1
    s_waitcnt vmcnt(0)
    ds_add_rtn_u32 v10, v15, v10 offset:4
    s_waitcnt lgkmcnt(0)
    v_readfirstlane_b32 s46, v10
    s_mov_b64 exec, -1
    s_mov_b32 s71, 0
    s_sub_u32 s59, s60, 1
    s_cmp_lg_u32 s46, s68
    s_cbranch_scc1 L_g_df_84
    v_mov_b32 v10, s59
    v_add_u32 v10, 1, v10
    v_mov_b32 v11, 0
    s_mov_b64 exec, 1
    buffer_store_dword v10, v11, s[12:15], s52 offen sc1
    s_mov_b64 exec, -1
L_sf_85:
L_g_df_84:
    s_add_u32 s68, s68, 4
    s_mov_b32 s65, 2
    s_branch L_g_nfl_72_d
L_g_dp_77_l:
    s_cmp_ge_u32 s62, s66
    s_cbranch_scc1 L_g_dp_77_d
    s_or_b32 s65, s65, 1
    s_add_u32 s47, s61, 4096
    s_mov_b32 m0, s64
    s_add_u32 s62, s62, 1
    buffer_load_dwordx4 v3, s[12:15], s61 offen offset:0 sc1 lds
    buffer_load_dwordx4 v3, s[12:15], s61 offen offset:1024 sc1 lds
    buffer_load_dwordx4 v3, s[12:15], s61 offen offset:2048 sc1 lds
    buffer_load_dwordx4 v3, s[12:15], s61 offen offset:3072 sc1 lds
    s_add_u32 m0, s64, 4096
    s_add_u32 s61, s61, 65536
    buffer_load_dwordx4 v3, s[12:15], s47 offen offset:0 sc1 lds
    buffer_load_dwordx4 v3, s[12:15], s47 offen offset:1024 sc1 lds
    buffer_load_dwordx4 v3, s[12:15], s47 offen offset:2048 sc1 lds
    buffer_load_dwordx4 v3, s[12:15], s47 offen offset:3072 sc1 lds
    s_xor_b32 s64, s64, 0x10000
    s_branch L_g_dp_77_a
L_g_nep_73_e:
    v_mov_b32 v10, 1
    s_mov_b64 exec, 1
    s_waitcnt vmcnt(0)
    ds_add_rtn_u32 v10, v15, v10 offset:4
    s_waitcnt lgkmcnt(0)
    v_readfirstlane_b32 s46, v10
    s_mov_b64 exec, -1
    s_mov_b32 s71, 0
    s_sub_u32 s59, s60, 1
    s_cmp_lg_u32 s46, s68
    s_cbranch_scc1 L_g_df_86
    v_mov_b32 v10, s59
    v_add_u32 v10, 1, v10
    v_mov_b32 v11, 0
    s_mov_b64 exec, 1
    buffer_store_dword v10, v11, s[12:15], s52 offen sc1
    s_mov_b64 exec, -1
L_sf_87:
L_g_df_86:
    s_add_u32 s68, s68, 4
    s_branch L_g_nep_73
L_g_nw1_74:
    s_cmp_eq_u32 s65, 2
    s_cbranch_scc1 L_g_nw1_74_w
    s_waitcnt vmcnt(0)
L_g_nw1_74_w:
    s_barrier
    ds_read_b128 v[32:35], v4 offset:0
    ds_read_b128 v[36:39], v4 offset:256
    ds_read_b128 v[40:43], v4 offset:2048
    ds_read_b128 v[44:47], v4 offset:2304
    ds_read_b128 v[48:51], v4 offset:4096
    ds_read_b128 v[52:55], v4 offset:4352
    ds_read_b128 v[56:59], v4 offset:6144
    ds_read_b128 v[60:63], v4 offset:6400
    s_branch L_g_jn_76
L_w_p2_11:
    s_cmp_lg_u32 s44, 0
    s_cbranch_scc1 L_w_p2_11_h
    s_mov_b32 s47, 63
    s_cmp_eq_u32 s53, 0
    s_cbranch_scc1 L_w_p2_11_q
    s_sub_u32 s52, s52, s76
    v_mov_b32 v10, 1
    v_mov_b32 v11, 131072
    s_mov_b64 exec, 1
    buffer_atomic_add v10, v11, s[12:15], s52 offen sc0
    s_waitcnt vmcnt(0)
    v_readfirstlane_b32 s46, v10
    s_mov_b64 exec, -1
    s_mov_b32 s47, 63
    s_nop 1
    s_cmp_eq_u32 s46, 0
    s_cbranch_scc1 L_w_p2_11_h
L_w_p2_11_q:
    v_mov_b32 v10, s47
    v_add_u32 v10, 1, v10
    v_mov_b32 v11, 0
    s_mov_b64 exec, 1
    buffer_store_dword v10, v11, s[12:15], s52 offen sc1
    s_mov_b64 exec, -1
L_sf_88:
L_w_p2_11_h:
    s_cmp_eq_u32 s76, 0
    s_cbranch_scc1 L_w_p2_11_m
    s_cmp_eq_u32 s79, 1
    s_cbranch_scc1 L_w_h_17
    s_mov_b32 s79, 1
    s_cmp_lt_u32 s77, 14
    s_cselect_b32 s53, 2, s53
    s_cselect_b32 s48, s48, 3
    s_branch L_w_h_17_n
L_w_p2_11_m:
    s_cmp_lt_u32 s48, 8
    s_cselect_b32 s75, 60, 60
    s_cmp_lt_u32 s48, 4
    s_cselect_b32 s75, 64, s75
L_w_p2_11_r:
    s_lshr_b32 s42, s40, 1
    s_and_b32 s43, s40, 1
    s_lshl_b32 s43, s43, 2
    s_and_b32 s46, s48, 3
    s_add_u32 s43, s43, s46
    s_cmp_lt_u32 s48, 4
    s_cbranch_scc1 L_w_wo_12
    s_cmp_lt_u32 s48, 8
    s_cbranch_scc1 L_w_f2_13
    s_cmp_lg_u32 s43, 7
    s_cbranch_scc1 L_w_f1_14
    s_mov_b32 s43, 2
    s_cmp_eq_u32 s76, 0
    s_cbranch_scc1 L_w_c_16
    s_mov_b32 s43, 7
    s_mov_b32 s78, 1
L_w_f1_14_t:
    s_cmp_lt_u32 s41, 8
    s_cselect_b32 s74, 60, 63
    s_cselect_b32 s75, 63, 64
    s_add_u32 s43, s43, s74
    s_cmp_lt_u32 s43, s75
    s_cbranch_scc1 L_w_h_17_f
    s_branch L_c_done_1
L_w_f1_14_d:
    s_cmp_eq_u32 s76, 0
    s_cbranch_scc1 L_c_done_1
    s_and_b32 s42, s49, 3
    s_lshr_b32 s43, s49, 2
    s_mov_b32 s78, 64
    s_branch L_w_f1_14_t
L_replica:
    s_setprio 0
    s_barrier
    s_and_b32 s48, s41, 7
    s_add_u32 s48, s48, 4
    s_cmp_lt_u32 s41, 8
    s_cselect_b32 s74, 60, 63
    s_cselect_b32 s75, 63, 64
    s_cselect_b32 s76, 1, 2
    s_cselect_b32 s46, 60, 63
    s_cselect_b32 s47, 63, 64
    s_mul_i32 s76, s76, 65536
    s_cmp_lt_u32 s48, 8
    s_cselect_b32 s74, s46, s74
    s_cselect_b32 s75, s47, s75
    s_branch L_w_p2_11_r
L_w_f1_14:
    s_load_dwordx2 s[4:5], s[0:1], 64
    s_load_dwordx2 s[6:7], s[0:1], 72
    s_and_b32 s50, s44, 3
    s_lshr_b32 s51, s44, 2
    s_waitcnt lgkmcnt(0)
    s_mov_b32 s24, s4
    s_and_b32 s25, s5, 0xffff
    s_mov_b32 s26, 0x700000
    s_mov_b32 s27, 0x00020000
    s_mul_i32 s49, s42, 7
    s_add_u32 s49, s49, s43
    v_lshrrev_b32 v3, 4, v1
    v_and_b32 v4, 15, v1
    v_lshlrev_b32 v5, 2, v3
    v_xor_b32 v4, v4, v5
    v_mul_u32_u24 v3, 7168, v3
    v_lshl_add_u32 v3, v4, 4, v3
    s_mul_i32 s46, s51, 512
    s_mul_i32 s47, s50, 16
    s_add_u32 s46, s46, s47
    s_mul_i32 s46, s46, 7168
    s_lshl_b32 s47, s49, 8
    s_add_u32 s46, s46, s47
    s_lshl_b32 s45, s51, 16
    s_mul_i32 s47, s50, 4096
    s_add_u32 s45, s45, s47
    v_bfe_u32 v4, v1, 2, 2
    v_bfe_u32 v5, v1, 4, 1
    v_lshlrev_b32 v5, 1, v5
    v_bfe_u32 v6, v1, 1, 1
    v_add_u32 v5, v5, v6
    s_lshl_b32 s47, s50, 2
    v_add_u32 v5, s47, v5
    v_lshlrev_b32 v6, 2, v4
    v_xor_b32 v5, v5, v6
    v_lshlrev_b32 v5, 4, v5
    v_lshl_add_u32 v5, v4, 8, v5
    v_bfe_u32 v6, v1, 0, 1
    v_lshl_add_u32 v5, v6, 3, v5
    v_lshrrev_b32 v6, 5, v1
    v_mul_u32_u24 v6, 2048, v6
    v_add_u32 v5, v5, v6
    s_lshl_b32 s47, s51, 16
    v_add_u32 v5, s47, v5
    s_add_u32 m0, s45, 0
    s_add_u32 s47, s46, 0x0
    buffer_load_dwordx4 v3, s[24:27], s47 offen  lds
    s_add_u32 m0, s45, 1024
    s_add_u32 s47, s46, 0x7000
    buffer_load_dwordx4 v3, s[24:27], s47 offen  lds
    s_add_u32 m0, s45, 2048
    s_add_u32 s47, s46, 0xe000
    buffer_load_dwordx4 v3, s[24:27], s47 offen  lds
    s_add_u32 m0, s45, 3072
    s_add_u32 s47, s46, 0x15000
    buffer_load_dwordx4 v3, s[24:27], s47 offen  lds
    s_add_u32 m0, s45, 16384
    s_add_u32 s47, s46, 0x70000
    buffer_load_dwordx4 v3, s[24:27], s47 offen  lds
    s_add_u32 m0, s45, 17408
    s_add_u32 s47, s46, 0x77000
    buffer_load_dwordx4 v3, s[24:27], s47 offen  lds
    s_add_u32 m0, s45, 18432
    s_add_u32 s47, s46, 0x7e000
    buffer_load_dwordx4 v3, s[24:27], s47 offen  lds
    s_add_u32 m0, s45, 19456
    s_add_u32 s47, s46, 0x85000
    buffer_load_dwordx4 v3, s[24:27], s47 offen  lds
    s_add_u32 m0, s45, 32768
    s_add_u32 s47, s46, 0xe0000
    buffer_load_dwordx4 v3, s[24:27], s47 offen  lds
    s_add_u32 m0, s45, 33792
    s_add_u32 s47, s46, 0xe7000
    buffer_load_dwordx4 v3, s[24:27], s47 offen  lds
    s_add_u32 m0, s45, 34816
    s_add_u32 s47, s46, 0xee000
    buffer_load_dwordx4 v3, s[24:27], s47 offen  lds
    s_add_u32 m0, s45, 35840
    s_add_u32 s47, s46, 0xf5000
    buffer_load_dwordx4 v3, s[24:27], s47 offen  lds
    s_add_u32 m0, s45, 49152
    s_add_u32 s47, s46, 0x150000
    buffer_load_dwordx4 v3, s[24:27], s47 offen  lds
    s_add_u32 m0, s45, 50176
    s_add_u32 s47, s46, 0x157000
    buffer_load_dwordx4 v3, s[24:27], s47 offen  lds
    s_add_u32 m0, s45, 51200
    s_add_u32 s47, s46, 0x15e000
    buffer_load_dwordx4 v3, s[24:27], s47 offen  lds
    s_add_u32 m0, s45, 52224
    s_add_u32 s47, s46, 0x165000
    buffer_load_dwordx4 v3, s[24:27], s47 offen  lds
    s_waitcnt vmcnt(12) lgkmcnt(0)
    s_barrier
    ds_read_b64_tr_b16 a[0:1], v5 offset:0
    ds_read_b64_tr_b16 a[2:3], v5 offset:1024
    ds_read_b64_tr_b16 a[4:5], v5 offset:4096
    ds_read_b64_tr_b16 a[6:7], v5 offset:5120
    ds_read_b64_tr_b16 a[8:9], v5 offset:8192
    ds_read_b64_tr_b16 a[10:11], v5 offset:9216
    ds_read_b64_tr_b16 a[12:13], v5 offset:12288
    ds_read_b64_tr_b16 a[14:15], v5 offset:13312
    s_waitcnt vmcnt(8) lgkmcnt(0)
    s_barrier
    s_add_u32 m0, s45, 0
    s_add_u32 s47, s46, 0x1c0000
    buffer_load_dwordx4 v3, s[24:27], s47 offen  lds
    s_add_u32 m0, s45, 1024
    s_add_u32 s47, s46, 0x1c7000
    buffer_load_dwordx4 v3, s[24:27], s47 offen  lds
    s_add_u32 m0, s45, 2048
    s_add_u32 s47, s46, 0x1ce000
    buffer_load_dwordx4 v3, s[24:27], s47 offen  lds
    s_add_u32 m0, s45, 3072
    s_add_u32 s47, s46, 0x1d5000
    buffer_load_dwordx4 v3, s[24:27], s47 offen  lds
    ds_read_b64_tr_b16 a[16:17], v5 offset:16384
    ds_read_b64_tr_b16 a[18:19], v5 offset:17408
    ds_read_b64_tr_b16 a[20:21], v5 offset:20480
    ds_read_b64_tr_b16 a[22:23], v5 offset:21504
    ds_read_b64_tr_b16 a[24:25], v5 offset:24576
    ds_read_b64_tr_b16 a[26:27], v5 offset:25600
    ds_read_b64_tr_b16 a[28:29], v5 offset:28672
    ds_read_b64_tr_b16 a[30:31], v5 offset:29696
    s_waitcnt vmcnt(8) lgkmcnt(0)
    s_barrier
    s_add_u32 m0, s45, 16384
    s_add_u32 s47, s46, 0x230000
    buffer_load_dwordx4 v3, s[24:27], s47 offen  lds
    s_add_u32 m0, s45, 17408
    s_add_u32 s47, s46, 0x237000
    buffer_load_dwordx4 v3, s[24:27], s47 offen  lds
    s_add_u32 m0, s45, 18432
    s_add_u32 s47, s46, 0x23e000
    buffer_load_dwordx4 v3, s[24:27], s47 offen  lds
    s_add_u32 m0, s45, 19456
    s_add_u32 s47, s46, 0x245000
    buffer_load_dwordx4 v3, s[24:27], s47 offen  lds
    ds_read_b64_tr_b16 a[32:33], v5 offset:32768
    ds_read_b64_tr_b16 a[34:35], v5 offset:33792
    ds_read_b64_tr_b16 a[36:37], v5 offset:36864
    ds_read_b64_tr_b16 a[38:39], v5 offset:37888
    ds_read_b64_tr_b16 a[40:41], v5 offset:40960
    ds_read_b64_tr_b16 a[42:43], v5 offset:41984
    ds_read_b64_tr_b16 a[44:45], v5 offset:45056
    ds_read_b64_tr_b16 a[46:47], v5 offset:46080
    s_waitcnt vmcnt(8) lgkmcnt(0)
    s_barrier
    s_add_u32 m0, s45, 32768
    s_add_u32 s47, s46, 0x2a0000
    buffer_load_dwordx4 v3, s[24:27], s47 offen  lds
    s_add_u32 m0, s45, 33792
    s_add_u32 s47, s46, 0x2a7000
    buffer_load_dwordx4 v3, s[24:27], s47 offen  lds
    s_add_u32 m0, s45, 34816
    s_add_u32 s47, s46, 0x2ae000
    buffer_load_dwordx4 v3, s[24:27], s47 offen  lds
    s_add_u32 m0, s45, 35840
    s_add_u32 s47, s46, 0x2b5000
    buffer_load_dwordx4 v3, s[24:27], s47 offen  lds
    ds_read_b64_tr_b16 a[48:49], v5 offset:49152
    ds_read_b64_tr_b16 a[50:51], v5 offset:50176
    ds_read_b64_tr_b16 a[52:53], v5 offset:53248
    ds_read_b64_tr_b16 a[54:55], v5 offset:54272
    ds_read_b64_tr_b16 a[56:57], v5 offset:57344
    ds_read_b64_tr_b16 a[58:59], v5 offset:58368
    ds_read_b64_tr_b16 a[60:61], v5 offset:61440
    ds_read_b64_tr_b16 a[62:63], v5 offset:62464
    s_waitcnt vmcnt(8) lgkmcnt(0)
    s_barrier
    s_add_u32 m0, s45, 49152
    s_add_u32 s47, s46, 0x310000
    buffer_load_dwordx4 v3, s[24:27], s47 offen  lds
    s_add_u32 m0, s45, 50176
    s_add_u32 s47, s46, 0x317000
    buffer_load_dwordx4 v3, s[24:27], s47 offen  lds
    s_add_u32 m0, s45, 51200
    s_add_u32 s47, s46, 0x31e000
    buffer_load_dwordx4 v3, s[24:27], s47 offen  lds
    s_add_u32 m0, s45, 52224
    s_add_u32 s47, s46, 0x325000
    buffer_load_dwordx4 v3, s[24:27], s47 offen  lds
    ds_read_b64_tr_b16 a[64:65], v5 offset:0
    ds_read_b64_tr_b16 a[66:67], v5 offset:1024
    ds_read_b64_tr_b16 a[68:69], v5 offset:4096
    ds_read_b64_tr_b16 a[70:71], v5 offset:5120
    ds_read_b64_tr_b16 a[72:73], v5 offset:8192
    ds_read_b64_tr_b16 a[74:75], v5 offset:9216
    ds_read_b64_tr_b16 a[76:77], v5 offset:12288
    ds_read_b64_tr_b16 a[78:79], v5 offset:13312
    s_waitcnt vmcnt(8) lgkmcnt(0)
    s_barrier
    ds_read_b64_tr_b16 a[80:81], v5 offset:16384
    ds_read_b64_tr_b16 a[82:83], v5 offset:17408
    ds_read_b64_tr_b16 a[84:85], v5 offset:20480
    ds_read_b64_tr_b16 a[86:87], v5 offset:21504
    ds_read_b64_tr_b16 a[88:89], v5 offset:24576
    ds_read_b64_tr_b16 a[90:91], v5 offset:25600
    ds_read_b64_tr_b16 a[92:93], v5 offset:28672
    ds_read_b64_tr_b16 a[94:95], v5 offset:29696
    s_waitcnt vmcnt(4) lgkmcnt(0)
    s_barrier
    ds_read_b64_tr_b16 a[96:97], v5 offset:32768
    ds_read_b64_tr_b16 a[98:99], v5 offset:33792
    ds_read_b64_tr_b16 a[100:101], v5 offset:36864
    ds_read_b64_tr_b16 a[102:103], v5 offset:37888
    ds_read_b64_tr_b16 a[104:105], v5 offset:40960
    ds_read_b64_tr_b16 a[106:107], v5 offset:41984
    ds_read_b64_tr_b16 a[108:109], v5 offset:45056
    ds_read_b64_tr_b16 a[110:111], v5 offset:46080
    s_waitcnt vmcnt(0) lgkmcnt(0)
    s_barrier
    ds_read_b64_tr_b16 a[112:113], v5 offset:49152
    ds_read_b64_tr_b16 a[114:115], v5 offset:50176
    ds_read_b64_tr_b16 a[116:117], v5 offset:53248
    ds_read_b64_tr_b16 a[118:119], v5 offset:54272
    ds_read_b64_tr_b16 a[120:121], v5 offset:57344
    ds_read_b64_tr_b16 a[122:123], v5 offset:58368
    ds_read_b64_tr_b16 a[124:125], v5 offset:61440
    ds_read_b64_tr_b16 a[126:127], v5 offset:62464
    s_waitcnt lgkmcnt(0)
    s_barrier
    v_lshlrev_b32 v2, 4, v1
    s_mul_i32 s64, s44, 8192
    s_add_u32 s46, s64, 0xc00000
    v_add_u32 v3, s46, v2
    s_mul_i32 s46, s51, 32768
    v_add_u32 v4, s46, v2
    v_and_b32 v6, 15, v1
    v_lshlrev_b32 v6, 4, v6
    v_lshrrev_b32 v7, 4, v1
    v_lshl_add_u32 v6, v7, 9, v6
    s_lshl_b32 s46, s50, 12
    s_add_u32 s46, s46, 131072
    v_add_u32 v5, s46, v2
    v_and_b32 v7, 3, v1
    v_lshlrev_b32 v7, 7, v7
    v_add_u32 v7, 0x10ec00, v7
    s_lshl_b32 s46, s49, 13
    s_lshl_b32 s47, s50, 11
    s_add_u32 s46, s46, s47
    s_add_u32 s46, s46, 0x6000000
    v_add_u32 v8, s46, v2
    s_lshl_b32 s52, s49, 7
    s_add_u32 s52, s52, 0x106400
    s_add_u32 s52, s52, s76
    s_mov_b32 s28, s6
    s_and_b32 s29, s7, 0xffff
    s_mov_b32 s30, 0x1c00
    s_mov_b32 s31, 0x00020000
    s_lshl_b32 s46, s49, 8
    s_lshl_b32 s47, s50, 6
    s_add_u32 s46, s46, s47
    v_lshrrev_b32 v9, 5, v1
    v_lshlrev_b32 v9, 3, v9
    buffer_load_dwordx2 v[32:33], v9, s[28:31], s46 offen offset:0
    buffer_load_dwordx2 v[34:35], v9, s[28:31], s46 offen offset:16
    buffer_load_dwordx2 v[36:37], v9, s[28:31], s46 offen offset:32
    buffer_load_dwordx2 v[38:39], v9, s[28:31], s46 offen offset:48
    v_add_u32 v9, 1024, v8
    s_mov_b32 s56, 0xbdd2d3e8
    s_mov_b32 s57, 0xbdd2d3e8
    v_mov_b32 v112, 0xc0135761
    s_waitcnt vmcnt(0)
    v_lshlrev_b32 v64, 16, v32
    v_and_b32 v65, 0xffff0000, v32
    v_lshlrev_b32 v66, 16, v33
    v_and_b32 v67, 0xffff0000, v33
    v_lshlrev_b32 v68, 16, v34
    v_and_b32 v69, 0xffff0000, v34
    v_lshlrev_b32 v70, 16, v35
    v_and_b32 v71, 0xffff0000, v35
    v_lshlrev_b32 v72, 16, v36
    v_and_b32 v73, 0xffff0000, v36
    v_lshlrev_b32 v74, 16, v37
    v_and_b32 v75, 0xffff0000, v37
    v_lshlrev_b32 v76, 16, v38
    v_and_b32 v77, 0xffff0000, v38
    v_lshlrev_b32 v78, 16, v39
    v_and_b32 v79, 0xffff0000, v39
    s_mul_i32 s46, s43, 8192
    s_add_u32 s46, s46, 0xc00000
    s_mul_i32 s47, s42, 0
    s_add_u32 s46, s46, s47
    v_min_u32 v116, 63, v1
    v_lshlrev_b32 v116, 7, v116
    v_add_u32 v116, s46, v116
    s_mov_b32 s60, s74
    s_mul_i32 s61, s74, 65536
    s_mov_b32 s62, s74
    s_mul_i32 s63, s74, 229376
    s_mov_b32 s67, 0
    s_mov_b32 s68, 3
    s_mov_b32 s71, 0
    v_mov_b32 v15, 147456
    v_mov_b32 v14, 0
    ds_write_b32 v15, v14 offset:4
    ds_write_b32 v15, v14 offset:12
    ds_write_b32 v15, v14 offset:16
    v_mov_b32 v114, 1
    v_mov_b32 v115, 0
    s_mov_b32 s81, 0
    s_lshl_b32 s46, s44, 5
    v_add_u32 v119, s46, v15
    v_lshrrev_b32 v113, 4, v1
    s_mov_b32 s72, 0
L_g_restart_89:
    s_cmp_lg_u32 s44, 0
    s_cbranch_scc1 L_g_nsp_90
    s_mov_b32 s70, 0
L_g_sp_96:
    s_add_u32 s54, s60, 0
    v_add_u32 v12, s54, v113
    v_mul_u32_u24 v13, 171, v12
    v_lshrrev_b32 v13, 9, v13
    v_mad_i32_i24 v13, v13, -3, v12
    v_lshl_add_u32 v13, v13, 9, v7
    buffer_load_dword v11, v13, s[12:15], 0 offen sc1
    s_waitcnt vmcnt(0)
    v_cmp_ge_u32 vcc, v12, v11
    s_add_u32 s70, s70, 1
    s_and_b32 s46, vcc_lo, 0xffff
    s_cbranch_scc0 L_g_sp_96_ok
    s_sleep 3
    s_cmp_lt_u32 s70, 524288
    s_cbranch_scc1 L_g_sp_96
    s_branch L_c_done_1
L_g_sp_96_ok:
    v_cmp_ge_u32 vcc, v12, v11
    s_nop 0
    s_ff1_i32_b64 s46, vcc
    s_lshr_b32 s46, s46, 4
    s_min_u32 s46, s46, 4
    s_add_u32 s46, s46, s54
    s_min_u32 s46, s46, s75
    v_mov_b32 v118, s46
    ds_write_b32 v15, v118 offset:20
L_g_nsp_90:
    s_waitcnt lgkmcnt(0)
    s_barrier
    ds_read_b32 v14, v15 offset:20
    s_waitcnt lgkmcnt(0)
    v_readfirstlane_b32 s66, v14
    s_nop 3
L_g_restart_89_go:
    s_mov_b32 s69, 0
    s_cmp_gt_u32 s62, s60
    s_cbranch_scc1 L_g_nd_97
    s_cmp_ge_u32 s62, s66
    s_cbranch_scc1 L_g_nd_97
    s_add_u32 s47, s61, 4096
    s_add_u32 m0, s64, 0
    s_nop 0
    buffer_load_dwordx4 v3, s[12:15], s61 offen offset:0 sc1 lds
    buffer_load_dwordx4 v3, s[12:15], s61 offen offset:1024 sc1 lds
    buffer_load_dwordx4 v3, s[12:15], s61 offen offset:2048 sc1 lds
    buffer_load_dwordx4 v3, s[12:15], s61 offen offset:3072 sc1 lds
    s_add_u32 m0, s64, 4096
    s_nop 0
    buffer_load_dwordx4 v3, s[12:15], s47 offen offset:0 sc1 lds
    buffer_load_dwordx4 v3, s[12:15], s47 offen offset:1024 sc1 lds
    buffer_load_dwordx4 v3, s[12:15], s47 offen offset:2048 sc1 lds
    buffer_load_dwordx4 v3, s[12:15], s47 offen offset:3072 sc1 lds
    s_add_u32 s61, s61, 65536
    s_add_u32 s62, s62, 1
    s_xor_b32 s64, s64, 0x10000
    s_mov_b32 s69, 1
L_g_nd_97:
    s_cmp_eq_u32 s51, 1
    s_cbranch_scc1 L_g_g1r_91
    s_add_u32 s59, s60, 1
    s_mov_b32 s69, 0
    s_cmp_gt_u32 s62, s59
    s_cbranch_scc1 L_g_nd_98
    s_cmp_ge_u32 s62, s66
    s_cbranch_scc1 L_g_nd_98
    s_add_u32 s47, s61, 4096
    s_add_u32 m0, s64, 0
    s_nop 0
    buffer_load_dwordx4 v3, s[12:15], s61 offen offset:0 sc1 lds
    buffer_load_dwordx4 v3, s[12:15], s61 offen offset:1024 sc1 lds
    buffer_load_dwordx4 v3, s[12:15], s61 offen offset:2048 sc1 lds
    buffer_load_dwordx4 v3, s[12:15], s61 offen offset:3072 sc1 lds
    s_add_u32 m0, s64, 4096
    s_nop 0
    buffer_load_dwordx4 v3, s[12:15], s47 offen offset:0 sc1 lds
    buffer_load_dwordx4 v3, s[12:15], s47 offen offset:1024 sc1 lds
    buffer_load_dwordx4 v3, s[12:15], s47 offen offset:2048 sc1 lds
    buffer_load_dwordx4 v3, s[12:15], s47 offen offset:3072 sc1 lds
    s_add_u32 s61, s61, 65536
    s_add_u32 s62, s62, 1
    s_xor_b32 s64, s64, 0x10000
    s_mov_b32 s69, 1
L_g_nd_98:
    s_cmp_eq_u32 s69, 1
    s_cbranch_scc1 L_g_w0_99
    s_waitcnt vmcnt(0)
L_g_w0_99:
    s_waitcnt vmcnt(8)
    s_cmp_lg_u32 s44, 0
    s_cbranch_scc1 L_g_nl_100
    s_cmp_lt_u32 s66, s75
    s_cselect_b32 s81, 1, 2
L_g_nl_100:
L_g_loop0_92_l:
    s_barrier
    ds_read_b128 v[32:35], v4 offset:0
    ds_read_b128 v[36:39], v4 offset:1024
    ds_read_b128 v[40:43], v4 offset:2048
    ds_read_b128 v[44:47], v4 offset:3072
    ds_read_b128 v[48:51], v4 offset:4096
    ds_read_b128 v[52:55], v4 offset:5120
    ds_read_b128 v[56:59], v4 offset:6144
    ds_read_b128 v[60:63], v4 offset:7168
    s_branch L_g_loop0_92_m
.p2align 6
L_g_loop0_92:
    s_barrier
L_g_loop0_92_m:
    s_setprio 2
    s_waitcnt lgkmcnt(6)
    v_mfma_f32_32x32x16_bf16 v[16:31], a[0:3], v[32:35], v[64:79]
    ds_read_b128 v[32:35], v4 offset:8192
    v_mfma_f32_32x32x16_bf16 v[16:31], a[4:7], v[36:39], v[16:31]
    ds_read_b128 v[36:39], v4 offset:9216
    s_cmp_eq_u32 s81, 1
    s_cbranch_scc1 L_g_h1_104
L_g_h1_104_b:
    s_waitcnt lgkmcnt(6)
    v_mfma_f32_32x32x16_bf16 v[16:31], a[8:11], v[40:43], v[16:31]
    ds_read_b128 v[40:43], v4 offset:10240
    v_mfma_f32_32x32x16_bf16 v[16:31], a[12:15], v[44:47], v[16:31]
    ds_read_b128 v[44:47], v4 offset:11264
    s_waitcnt lgkmcnt(6)
    v_mfma_f32_32x32x16_bf16 v[16:31], a[16:19], v[48:51], v[16:31]
    ds_read_b128 v[48:51], v4 offset:12288
    v_mfma_f32_32x32x16_bf16 v[16:31], a[20:23], v[52:55], v[16:31]
    ds_read_b128 v[52:55], v4 offset:13312
    s_waitcnt lgkmcnt(6)
    v_mfma_f32_32x32x16_bf16 v[16:31], a[24:27], v[56:59], v[16:31]
    ds_read_b128 v[56:59], v4 offset:14336
    v_mfma_f32_32x32x16_bf16 v[16:31], a[28:31], v[60:63], v[16:31]
    ds_read_b128 v[60:63], v4 offset:15360
    s_waitcnt lgkmcnt(6)
    v_mfma_f32_32x32x16_bf16 v[16:31], a[32:35], v[32:35], v[16:31]
    ds_read_b128 v[32:35], v4 offset:16384
    v_mfma_f32_32x32x16_bf16 v[16:31], a[36:39], v[36:39], v[16:31]
    ds_read_b128 v[36:39], v4 offset:17408
    s_waitcnt lgkmcnt(6)
    v_mfma_f32_32x32x16_bf16 v[16:31], a[40:43], v[40:43], v[16:31]
    ds_read_b128 v[40:43], v4 offset:18432
    v_mfma_f32_32x32x16_bf16 v[16:31], a[44:47], v[44:47], v[16:31]
    ds_read_b128 v[44:47], v4 offset:19456
    s_waitcnt lgkmcnt(6)
    v_mfma_f32_32x32x16_bf16 v[16:31], a[48:51], v[48:51], v[16:31]
    ds_read_b128 v[48:51], v4 offset:20480
    v_mfma_f32_32x32x16_bf16 v[16:31], a[52:55], v[52:55], v[16:31]
    ds_read_b128 v[52:55], v4 offset:21504
    s_waitcnt lgkmcnt(6)
    v_mfma_f32_32x32x16_bf16 v[16:31], a[56:59], v[56:59], v[16:31]
    ds_read_b128 v[56:59], v4 offset:22528
    v_mfma_f32_32x32x16_bf16 v[16:31], a[60:63], v[60:63], v[16:31]
    ds_read_b128 v[60:63], v4 offset:23552
    s_waitcnt lgkmcnt(6)
    v_mfma_f32_32x32x16_bf16 v[16:31], a[64:67], v[32:35], v[16:31]
    ds_read_b128 v[32:35], v4 offset:24576
    v_mfma_f32_32x32x16_bf16 v[16:31], a[68:71], v[36:39], v[16:31]
    ds_read_b128 v[36:39], v4 offset:25600
    s_waitcnt lgkmcnt(6)
    v_mfma_f32_32x32x16_bf16 v[16:31], a[72:75], v[40:43], v[16:31]
    ds_read_b128 v[40:43], v4 offset:26624
    v_mfma_f32_32x32x16_bf16 v[16:31], a[76:79], v[44:47], v[16:31]
    ds_read_b128 v[44:47], v4 offset:27648
    s_waitcnt lgkmcnt(6)
    v_mfma_f32_32x32x16_bf16 v[16:31], a[80:83], v[48:51], v[16:31]
    ds_read_b128 v[48:51], v4 offset:28672
    v_mfma_f32_32x32x16_bf16 v[16:31], a[84:87], v[52:55], v[16:31]
    ds_read_b128 v[52:55], v4 offset:29696
    s_waitcnt lgkmcnt(6)
    v_mfma_f32_32x32x16_bf16 v[16:31], a[88:91], v[56:59], v[16:31]
    ds_read_b128 v[56:59], v4 offset:30720
    v_mfma_f32_32x32x16_bf16 v[16:31], a[92:95], v[60:63], v[16:31]
    ds_read_b128 v[60:63], v4 offset:31744
    s_waitcnt lgkmcnt(6)
    v_mfma_f32_32x32x16_bf16 v[16:31], a[96:99], v[32:35], v[16:31]
    v_mfma_f32_32x32x16_bf16 v[16:31], a[100:103], v[36:39], v[16:31]
    s_waitcnt lgkmcnt(4)
    v_mfma_f32_32x32x16_bf16 v[16:31], a[104:107], v[40:43], v[16:31]
    v_mfma_f32_32x32x16_bf16 v[16:31], a[108:111], v[44:47], v[16:31]
    s_waitcnt lgkmcnt(2)
    v_mfma_f32_32x32x16_bf16 v[16:31], a[112:115], v[48:51], v[16:31]
    s_cmp_eq_u32 s81, 1
    s_cbranch_scc1 L_g_h2_105
L_g_h2_105_b:
    ds_write_b32 v119, v118
    v_mfma_f32_32x32x16_bf16 v[16:31], a[116:119], v[52:55], v[16:31]
    s_waitcnt lgkmcnt(0)
    v_mfma_f32_32x32x16_bf16 v[16:31], a[120:123], v[56:59], v[16:31]
    v_mfma_f32_32x32x16_bf16 v[16:31], a[124:127], v[60:63], v[16:31]
    v_xor_b32 v4, 0x10000, v4
    s_setprio 0
    s_waitcnt vmcnt(0)
    s_waitcnt lgkmcnt(0)
    s_barrier
    ds_read_b32 v14, v15
    s_nop 6
    ds_write_b128 v5, v[16:19] offset:0
    ds_write_b128 v5, v[20:23] offset:1024
    ds_write_b128 v5, v[24:27] offset:2048
    ds_write_b128 v5, v[28:31] offset:3072
    s_waitcnt lgkmcnt(4)
    v_readfirstlane_b32 s66, v14
    s_add_u32 s60, s60, 1
    s_mov_b32 s65, 0
    s_cmp_le_u32 s62, s60
    s_cbranch_scc1 L_g_dp_106_l
L_g_dp_106_a:
    s_cmp_ge_u32 s62, s66
    s_cbranch_scc1 L_g_dp_106_d
    s_add_u32 s47, s61, 4096
    s_mov_b32 m0, s64
    s_add_u32 s62, s62, 1
    buffer_load_dwordx4 v3, s[12:15], s61 offen offset:0 sc1 lds
    buffer_load_dwordx4 v3, s[12:15], s61 offen offset:1024 sc1 lds
    buffer_load_dwordx4 v3, s[12:15], s61 offen offset:2048 sc1 lds
    buffer_load_dwordx4 v3, s[12:15], s61 offen offset:3072 sc1 lds
    s_add_u32 m0, s64, 4096
    s_add_u32 s61, s61, 65536
    buffer_load_dwordx4 v3, s[12:15], s47 offen offset:0 sc1 lds
    buffer_load_dwordx4 v3, s[12:15], s47 offen offset:1024 sc1 lds
    buffer_load_dwordx4 v3, s[12:15], s47 offen offset:2048 sc1 lds
    buffer_load_dwordx4 v3, s[12:15], s47 offen offset:3072 sc1 lds
    s_xor_b32 s64, s64, 0x10000
L_g_dp_106_d:
    s_cmp_lg_u32 s44, 2
    s_cbranch_scc1 L_g_pf_107
    s_cmp_ge_u32 s62, s66
    s_cbranch_scc1 L_g_pf_107
    buffer_load_dword v117, v116, s[12:15], s61 offen sc1
L_g_pf_107:
    s_cmp_le_u32 s66, s60
    s_cbranch_scc1 L_g_ex0_103
    s_cmp_lg_u32 s65, 0
    s_cbranch_scc1 L_g_nw_102
    ds_read_b128 v[32:35], v4 offset:0
    ds_read_b128 v[36:39], v4 offset:1024
    ds_read_b128 v[40:43], v4 offset:2048
    ds_read_b128 v[44:47], v4 offset:3072
    ds_read_b128 v[48:51], v4 offset:4096
    ds_read_b128 v[52:55], v4 offset:5120
    ds_read_b128 v[56:59], v4 offset:6144
    ds_read_b128 v[60:63], v4 offset:7168
    s_cmp_lg_u32 s44, 0
    s_cbranch_scc1 L_g_nl_108
    s_mov_b32 s46, s66
    s_cmp_lg_u32 s81, 0
    s_cbranch_scc1 L_g_nl_108_e
    v_cmp_ge_u32 vcc, v12, v11
    s_nop 0
    s_ff1_i32_b64 s46, vcc
    s_lshr_b32 s46, s46, 4
    s_min_u32 s46, s46, 4
    s_add_u32 s46, s46, s54
    s_min_u32 s46, s46, s75
    v_mov_b32 v118, s46
L_g_nl_108_e:
    s_add_u32 s47, s60, 3
    s_min_u32 s47, s47, s75
    s_cmp_lt_u32 s46, s47
    s_cselect_b32 s81, 1, 0
    s_cbranch_scc1 L_g_nl_108
    s_add_u32 s54, s60, 2
    v_add_u32 v12, s54, v113
    v_mul_u32_u24 v13, 171, v12
    v_lshrrev_b32 v13, 9, v13
    v_mad_i32_i24 v13, v13, -3, v12
    v_lshl_add_u32 v13, v13, 9, v7
    buffer_load_dword v11, v13, s[12:15], 0 offen sc1
L_g_nl_108:
    s_waitcnt lgkmcnt(8)
    s_branch L_g_loop0_92
L_g_ex0_103:
    s_cmp_lg_u32 s44, 0
    s_cbranch_scc1 L_g_ex0_103_n
    ds_write_b32 v15, v118 offset:20
    s_cmp_ge_u32 s60, s75
    s_cbranch_scc1 L_g_ex0_103_n
    s_sleep 6
    s_add_u32 s54, s60, 0
    v_add_u32 v12, s54, v113
    v_mul_u32_u24 v13, 171, v12
    v_lshrrev_b32 v13, 9, v13
    v_mad_i32_i24 v13, v13, -3, v12
    v_lshl_add_u32 v13, v13, 9, v7
    buffer_load_dword v11, v13, s[12:15], 0 offen sc1
    s_waitcnt vmcnt(0)
    v_cmp_ge_u32 vcc, v12, v11
    s_nop 0
    s_ff1_i32_b64 s46, vcc
    s_lshr_b32 s46, s46, 4
    s_min_u32 s46, s46, 4
    s_add_u32 s46, s46, s54
    s_min_u32 s46, s46, s75
    v_mov_b32 v118, s46
    ds_write_b32 v15, v118 offset:20
L_g_ex0_103_n:
    s_waitcnt lgkmcnt(0)
    s_barrier
    ds_read_b32 v14, v15 offset:20
    s_waitcnt lgkmcnt(0)
    v_readfirstlane_b32 s66, v14
    s_barrier
    s_cmp_gt_u32 s66, s60
    s_cbranch_scc1 L_g_restart_89_go
    s_branch L_g_tail_94
L_g_g1r_91:
    s_mov_b32 s65, 1
    s_branch L_g_loop1_93_e
.p2align 6
L_g_loop1_93:
    s_mov_b32 s65, 0
L_g_loop1_93_e:
    s_barrier
    s_bitcmp1_b32 s67, 2
    s_cbranch_scc0 L_g_nfl_109
    s_cmp_lg_u32 s44, 4
    s_cbranch_scc1 L_g_nfl_109_d
    s_sub_u32 s59, s60, 2
    v_mov_b32 v10, s59
    buffer_store_dword v10, v115, s[12:15], s52 offen sc1
L_g_nfl_109_d:
    ds_read_b128 v[80:83], v5 offset:0
    ds_read_b128 v[84:87], v5 offset:1024
    ds_read_b128 v[88:91], v5 offset:2048
    ds_read_b128 v[92:95], v5 offset:3072
    s_cmp_le_u32 s62, s60
    s_cbranch_scc1 L_g_dp_114_l
L_g_dp_114_a:
    s_cmp_ge_u32 s62, s66
    s_cbranch_scc1 L_g_dp_114_d
    s_add_u32 s47, s61, 4096
    s_mov_b32 m0, s64
    s_add_u32 s62, s62, 1
    buffer_load_dwordx4 v3, s[12:15], s61 offen offset:0 sc1 lds
    buffer_load_dwordx4 v3, s[12:15], s61 offen offset:1024 sc1 lds
    buffer_load_dwordx4 v3, s[12:15], s61 offen offset:2048 sc1 lds
    buffer_load_dwordx4 v3, s[12:15], s61 offen offset:3072 sc1 lds
    s_add_u32 m0, s64, 4096
    s_add_u32 s61, s61, 65536
    buffer_load_dwordx4 v3, s[12:15], s47 offen offset:0 sc1 lds
    buffer_load_dwordx4 v3, s[12:15], s47 offen offset:1024 sc1 lds
    buffer_load_dwordx4 v3, s[12:15], s47 offen offset:2048 sc1 lds
    buffer_load_dwordx4 v3, s[12:15], s47 offen offset:3072 sc1 lds
    s_xor_b32 s64, s64, 0x10000
L_g_dp_114_d:
    s_bitcmp1_b32 s67, 0
    s_cbranch_scc0 L_g_nep_110
    s_waitcnt lgkmcnt(0)
    v_add_f32 v80, v80, v16
    v_add_f32 v81, v81, v17
    v_add_f32 v82, v82, v18
    v_add_f32 v83, v83, v19
    v_add_f32 v84, v84, v20
    v_add_f32 v85, v85, v21
    v_add_f32 v86, v86, v22
    v_add_f32 v87, v87, v23
    v_add_f32 v88, v88, v24
    v_add_f32 v89, v89, v25
    v_add_f32 v90, v90, v26
    v_add_f32 v91, v91, v27
    v_add_f32 v92, v92, v28
    v_add_f32 v93, v93, v29
    v_add_f32 v94, v94, v30
    v_add_f32 v95, v95, v31
L_g_nep_110:
    v_mul_f32 v96, v80, v80
    v_mul_f32 v97, v81, v81
    v_mul_f32 v98, v82, v82
    v_mul_f32 v99, v83, v83
    v_mul_f32 v100, v84, v84
    v_mul_f32 v101, v85, v85
    v_mul_f32 v102, v86, v86
    v_mul_f32 v103, v87, v87
    v_fma_f32 v96, v96, s56, v112
    v_fma_f32 v97, v97, s56, v112
    v_fma_f32 v98, v98, s56, v112
    v_fma_f32 v99, v99, s56, v112
    v_fma_f32 v100, v100, s56, v112
    v_fma_f32 v101, v101, s56, v112
    v_fma_f32 v102, v102, s56, v112
    v_fma_f32 v103, v103, s56, v112
    v_mul_f32 v96, v96, v80
    v_mul_f32 v97, v97, v81
    v_mul_f32 v98, v98, v82
    v_mul_f32 v99, v99, v83
    v_mul_f32 v100, v100, v84
    v_mul_f32 v101, v101, v85
    v_mul_f32 v102, v102, v86
    v_mul_f32 v103, v103, v87
    v_exp_f32 v96, v96
    v_exp_f32 v97, v97
    v_exp_f32 v98, v98
    v_exp_f32 v99, v99
    v_exp_f32 v100, v100
    v_exp_f32 v101, v101
    v_exp_f32 v102, v102
    v_exp_f32 v103, v103
    v_add_f32 v96, 1.0, v96
    v_add_f32 v97, 1.0, v97
    v_add_f32 v98, 1.0, v98
    v_add_f32 v99, 1.0, v99
    v_add_f32 v100, 1.0, v100
    v_add_f32 v101, 1.0, v101
    v_add_f32 v102, 1.0, v102
    v_add_f32 v103, 1.0, v103
    v_rcp_f32 v96, v96
    v_rcp_f32 v97, v97
    v_rcp_f32 v98, v98
    v_rcp_f32 v99, v99
    v_rcp_f32 v100, v100
    v_rcp_f32 v101, v101
    v_rcp_f32 v102, v102
    v_rcp_f32 v103, v103
    v_mul_f32 v80, v80, v96
    v_mul_f32 v81, v81, v97
    s_cmp_lg_u32 s65, 0
    s_cbranch_scc1 L_g_nw1_111
    ds_read_b128 v[32:35], v4 offset:0
    ds_read_b128 v[36:39], v4 offset:1024
    ds_read_b128 v[40:43], v4 offset:2048
    ds_read_b128 v[44:47], v4 offset:3072
    ds_read_b128 v[48:51], v4 offset:4096
    ds_read_b128 v[52:55], v4 offset:5120
    ds_read_b128 v[56:59], v4 offset:6144
    ds_read_b128 v[60:63], v4 offset:7168
    s_barrier
L_g_jn_113:
    s_bitcmp1_b32 s67, 0
    s_cbranch_scc0 L_g_mm2_112
    s_setprio 1
    s_waitcnt lgkmcnt(6)
    v_mfma_f32_32x32x16_bf16 v[16:31], a[0:3], v[32:35], 0
    ds_read_b128 v[32:35], v4 offset:8192
    ds_read_b32 v14, v15
    v_mul_f32 v82, v82, v98
    v_mul_f32 v83, v83, v99
    v_mul_f32 v84, v84, v100
    v_mfma_f32_32x32x16_bf16 v[16:31], a[4:7], v[36:39], v[16:31]
    ds_read_b128 v[36:39], v4 offset:9216
    v_mul_f32 v85, v85, v101
    v_mul_f32 v86, v86, v102
    v_mul_f32 v87, v87, v103
    v_cvt_pk_bf16_f32 v104, v80, v81
    s_waitcnt lgkmcnt(6)
    v_mfma_f32_32x32x16_bf16 v[16:31], a[8:11], v[40:43], v[16:31]
    ds_read_b128 v[40:43], v4 offset:10240
    v_cvt_pk_bf16_f32 v105, v82, v83
    v_cvt_pk_bf16_f32 v106, v84, v85
    v_cvt_pk_bf16_f32 v107, v86, v87
    buffer_store_dwordx4 v[104:107], v8, s[12:15], s63 offen sc1
    v_mfma_f32_32x32x16_bf16 v[16:31], a[12:15], v[44:47], v[16:31]
    ds_read_b128 v[44:47], v4 offset:11264
    v_mul_f32 v96, v88, v88
    v_mul_f32 v97, v89, v89
    v_mul_f32 v98, v90, v90
    v_mul_f32 v99, v91, v91
    s_waitcnt lgkmcnt(6)
    v_mfma_f32_32x32x16_bf16 v[16:31], a[16:19], v[48:51], v[16:31]
    ds_read_b128 v[48:51], v4 offset:12288
    v_mul_f32 v100, v92, v92
    v_mul_f32 v101, v93, v93
    v_mul_f32 v102, v94, v94
    v_mul_f32 v103, v95, v95
    v_mfma_f32_32x32x16_bf16 v[16:31], a[20:23], v[52:55], v[16:31]
    ds_read_b128 v[52:55], v4 offset:13312
    v_fma_f32 v96, v96, s56, v112
    v_fma_f32 v97, v97, s56, v112
    v_fma_f32 v98, v98, s56, v112
    v_fma_f32 v99, v99, s56, v112
    s_waitcnt lgkmcnt(6)
    v_mfma_f32_32x32x16_bf16 v[16:31], a[24:27], v[56:59], v[16:31]
    ds_read_b128 v[56:59], v4 offset:14336
    v_fma_f32 v100, v100, s56, v112
    v_fma_f32 v101, v101, s56, v112
    v_fma_f32 v102, v102, s56, v112
    v_fma_f32 v103, v103, s56, v112
    v_mfma_f32_32x32x16_bf16 v[16:31], a[28:31], v[60:63], v[16:31]
    ds_read_b128 v[60:63], v4 offset:15360
    v_mul_f32 v96, v96, v88
    v_mul_f32 v97, v97, v89
    v_mul_f32 v98, v98, v90
    v_mul_f32 v99, v99, v91
    s_waitcnt lgkmcnt(6)
    v_mfma_f32_32x32x16_bf16 v[16:31], a[32:35], v[32:35], v[16:31]
    ds_read_b128 v[32:35], v4 offset:16384
    v_mul_f32 v100, v100, v92
    v_mul_f32 v101, v101, v93
    v_mul_f32 v102, v102, v94
    v_mul_f32 v103, v103, v95
    v_mfma_f32_32x32x16_bf16 v[16:31], a[36:39], v[36:39], v[16:31]
    ds_read_b128 v[36:39], v4 offset:17408
    v_exp_f32 v96, v96
    v_exp_f32 v97, v97
    s_waitcnt lgkmcnt(6)
    v_mfma_f32_32x32x16_bf16 v[16:31], a[40:43], v[40:43], v[16:31]
    ds_read_b128 v[40:43], v4 offset:18432
    v_exp_f32 v98, v98
    v_exp_f32 v99, v99
    v_mfma_f32_32x32x16_bf16 v[16:31], a[44:47], v[44:47], v[16:31]
    ds_read_b128 v[44:47], v4 offset:19456
    v_exp_f32 v100, v100
    v_exp_f32 v101, v101
    s_waitcnt lgkmcnt(6)
    v_mfma_f32_32x32x16_bf16 v[16:31], a[48:51], v[48:51], v[16:31]
    ds_read_b128 v[48:51], v4 offset:20480
    v_exp_f32 v102, v102
    v_exp_f32 v103, v103
    v_mfma_f32_32x32x16_bf16 v[16:31], a[52:55], v[52:55], v[16:31]
    ds_read_b128 v[52:55], v4 offset:21504
    v_add_f32 v96, 1.0, v96
    v_add_f32 v97, 1.0, v97
    v_add_f32 v98, 1.0, v98
    v_add_f32 v99, 1.0, v99
    s_waitcnt lgkmcnt(6)
    v_mfma_f32_32x32x16_bf16 v[16:31], a[56:59], v[56:59], v[16:31]
    ds_read_b128 v[56:59], v4 offset:22528
    v_add_f32 v100, 1.0, v100
    v_add_f32 v101, 1.0, v101
    v_add_f32 v102, 1.0, v102
    v_add_f32 v103, 1.0, v103
    v_mfma_f32_32x32x16_bf16 v[16:31], a[60:63], v[60:63], v[16:31]
    ds_read_b128 v[60:63], v4 offset:23552
    v_rcp_f32 v96, v96
    v_rcp_f32 v97, v97
    s_waitcnt lgkmcnt(6)
    v_mfma_f32_32x32x16_bf16 v[16:31], a[64:67], v[32:35], v[16:31]
    ds_read_b128 v[32:35], v4 offset:24576
    v_rcp_f32 v98, v98
    v_rcp_f32 v99, v99
    v_mfma_f32_32x32x16_bf16 v[16:31], a[68:71], v[36:39], v[16:31]
    ds_read_b128 v[36:39], v4 offset:25600
    v_rcp_f32 v100, v100
    v_rcp_f32 v101, v101
    s_waitcnt lgkmcnt(6)
    v_mfma_f32_32x32x16_bf16 v[16:31], a[72:75], v[40:43], v[16:31]
    ds_read_b128 v[40:43], v4 offset:26624
    v_rcp_f32 v102, v102
    v_rcp_f32 v103, v103
    v_mfma_f32_32x32x16_bf16 v[16:31], a[76:79], v[44:47], v[16:31]
    ds_read_b128 v[44:47], v4 offset:27648
    v_mul_f32 v88, v88, v96
    v_mul_f32 v89, v89, v97
    v_mul_f32 v90, v90, v98
    v_mul_f32 v91, v91, v99
    s_waitcnt lgkmcnt(6)
    v_mfma_f32_32x32x16_bf16 v[16:31], a[80:83], v[48:51], v[16:31]
    ds_read_b128 v[48:51], v4 offset:28672
    v_mul_f32 v92, v92, v100
    v_mul_f32 v93, v93, v101
    v_mul_f32 v94, v94, v102
    v_mul_f32 v95, v95, v103
    v_mfma_f32_32x32x16_bf16 v[16:31], a[84:87], v[52:55], v[16:31]
    ds_read_b128 v[52:55], v4 offset:29696
    v_cvt_pk_bf16_f32 v108, v88, v89
    v_cvt_pk_bf16_f32 v109, v90, v91
    v_cvt_pk_bf16_f32 v110, v92, v93
    v_cvt_pk_bf16_f32 v111, v94, v95
    s_waitcnt lgkmcnt(6)
    v_mfma_f32_32x32x16_bf16 v[16:31], a[88:91], v[56:59], v[16:31]
    ds_read_b128 v[56:59], v4 offset:30720
    buffer_store_dwordx4 v[108:111], v9, s[12:15], s63 offen sc1
    s_add_u32 s63, s63, 229376
    v_mfma_f32_32x32x16_bf16 v[16:31], a[92:95], v[60:63], v[16:31]
    ds_read_b128 v[60:63], v4 offset:31744
    s_waitcnt lgkmcnt(6)
    v_mfma_f32_32x32x16_bf16 v[16:31], a[96:99], v[32:35], v[16:31]
    v_mfma_f32_32x32x16_bf16 v[16:31], a[100:103], v[36:39], v[16:31]
    s_waitcnt lgkmcnt(4)
    v_mfma_f32_32x32x16_bf16 v[16:31], a[104:107], v[40:43], v[16:31]
    v_mfma_f32_32x32x16_bf16 v[16:31], a[108:111], v[44:47], v[16:31]
    s_waitcnt lgkmcnt(2)
    v_mfma_f32_32x32x16_bf16 v[16:31], a[112:115], v[48:51], v[16:31]
    v_mfma_f32_32x32x16_bf16 v[16:31], a[116:119], v[52:55], v[16:31]
    s_waitcnt lgkmcnt(0)
    v_mfma_f32_32x32x16_bf16 v[16:31], a[120:123], v[56:59], v[16:31]
    v_mfma_f32_32x32x16_bf16 v[16:31], a[124:127], v[60:63], v[16:31]
    v_xor_b32 v4, 0x10000, v4
    s_setprio 0
    s_waitcnt vmcnt(2)
L_g_mm2_112_d:
    v_readfirstlane_b32 s66, v14
    s_lshl_b32 s67, s67, 1
    s_or_b32 s67, s67, 1
    s_add_u32 s60, s60, 1
    s_cmp_gt_u32 s66, s60
    s_cbranch_scc1 L_g_loop1_93
    s_barrier
    ds_read_b32 v14, v15 offset:20
    ds_read_b128 v[80:83], v5 offset:0
    ds_read_b128 v[84:87], v5 offset:1024
    ds_read_b128 v[88:91], v5 offset:2048
    ds_read_b128 v[92:95], v5 offset:3072
    s_waitcnt lgkmcnt(4)
    v_readfirstlane_b32 s66, v14
    s_barrier
    s_mov_b32 s69, 0
    s_cmp_gt_u32 s62, s60
    s_cbranch_scc1 L_g_nd_115
    s_cmp_ge_u32 s62, s66
    s_cbranch_scc1 L_g_nd_115
    s_add_u32 s47, s61, 4096
    s_add_u32 m0, s64, 0
    s_nop 0
    buffer_load_dwordx4 v3, s[12:15], s61 offen offset:0 sc1 lds
    buffer_load_dwordx4 v3, s[12:15], s61 offen offset:1024 sc1 lds
    buffer_load_dwordx4 v3, s[12:15], s61 offen offset:2048 sc1 lds
    buffer_load_dwordx4 v3, s[12:15], s61 offen offset:3072 sc1 lds
    s_add_u32 m0, s64, 4096
    s_nop 0
    buffer_load_dwordx4 v3, s[12:15], s47 offen offset:0 sc1 lds
    buffer_load_dwordx4 v3, s[12:15], s47 offen offset:1024 sc1 lds
    buffer_load_dwordx4 v3, s[12:15], s47 offen offset:2048 sc1 lds
    buffer_load_dwordx4 v3, s[12:15], s47 offen offset:3072 sc1 lds
    s_add_u32 s61, s61, 65536
    s_add_u32 s62, s62, 1
    s_xor_b32 s64, s64, 0x10000
    s_mov_b32 s69, 1
L_g_nd_115:
    s_sub_u32 s59, s60, 1
    s_waitcnt lgkmcnt(3)
    v_add_f32 v80, v80, v16
    v_add_f32 v81, v81, v17
    v_add_f32 v82, v82, v18
    v_add_f32 v83, v83, v19
    s_waitcnt lgkmcnt(2)
    v_add_f32 v84, v84, v20
    v_add_f32 v85, v85, v21
    v_add_f32 v86, v86, v22
    v_add_f32 v87, v87, v23
    s_waitcnt lgkmcnt(1)
    v_add_f32 v88, v88, v24
    v_add_f32 v89, v89, v25
    v_add_f32 v90, v90, v26
    v_add_f32 v91, v91, v27
    s_waitcnt lgkmcnt(0)
    v_add_f32 v92, v92, v28
    v_add_f32 v93, v93, v29
    v_add_f32 v94, v94, v30
    v_add_f32 v95, v95, v31
    v_mul_f32 v96, v80, v80
    v_mul_f32 v97, v81, v81
    v_mul_f32 v98, v82, v82
    v_mul_f32 v99, v83, v83
    v_mul_f32 v100, v84, v84
    v_mul_f32 v101, v85, v85
    v_mul_f32 v102, v86, v86
    v_mul_f32 v103, v87, v87
    v_fma_f32 v96, v96, s56, v112
    v_fma_f32 v97, v97, s56, v112
    v_fma_f32 v98, v98, s56, v112
    v_fma_f32 v99, v99, s56, v112
    v_fma_f32 v100, v100, s56, v112
    v_fma_f32 v101, v101, s56, v112
    v_fma_f32 v102, v102, s56, v112
    v_fma_f32 v103, v103, s56, v112
    v_mul_f32 v96, v96, v80
    v_mul_f32 v97, v97, v81
    v_mul_f32 v98, v98, v82
    v_mul_f32 v99, v99, v83
    v_mul_f32 v100, v100, v84
    v_mul_f32 v101, v101, v85
    v_mul_f32 v102, v102, v86
    v_mul_f32 v103, v103, v87
    v_exp_f32 v96, v96
    v_exp_f32 v97, v97
    v_exp_f32 v98, v98
    v_exp_f32 v99, v99
    v_exp_f32 v100, v100
    v_exp_f32 v101, v101
    v_exp_f32 v102, v102
    v_exp_f32 v103, v103
    v_add_f32 v96, 1.0, v96
    v_add_f32 v97, 1.0, v97
    v_add_f32 v98, 1.0, v98
    v_add_f32 v99, 1.0, v99
    v_add_f32 v100, 1.0, v100
    v_add_f32 v101, 1.0, v101
    v_add_f32 v102, 1.0, v102
    v_add_f32 v103, 1.0, v103
    v_rcp_f32 v96, v96
    v_rcp_f32 v97, v97
    v_rcp_f32 v98, v98
    v_rcp_f32 v99, v99
    v_rcp_f32 v100, v100
    v_rcp_f32 v101, v101
    v_rcp_f32 v102, v102
    v_rcp_f32 v103, v103
    v_mul_f32 v80, v80, v96
    v_mul_f32 v81, v81, v97
    v_mul_f32 v82, v82, v98
    v_mul_f32 v83, v83, v99
    v_mul_f32 v84, v84, v100
    v_mul_f32 v85, v85, v101
    v_mul_f32 v86, v86, v102
    v_mul_f32 v87, v87, v103
    v_cvt_pk_bf16_f32 v104, v80, v81
    v_cvt_pk_bf16_f32 v105, v82, v83
    v_cvt_pk_bf16_f32 v106, v84, v85
    v_cvt_pk_bf16_f32 v107, v86, v87
    buffer_store_dwordx4 v[104:107], v8, s[12:15], s63 offen sc1
    v_mul_f32 v96, v88, v88
    v_mul_f32 v97, v89, v89
    v_mul_f32 v98, v90, v90
    v_mul_f32 v99, v91, v91
    v_mul_f32 v100, v92, v92
    v_mul_f32 v101, v93, v93
    v_mul_f32 v102, v94, v94
    v_mul_f32 v103, v95, v95
    v_fma_f32 v96, v96, s56, v112
    v_fma_f32 v97, v97, s56, v112
    v_fma_f32 v98, v98, s56, v112
    v_fma_f32 v99, v99, s56, v112
    v_fma_f32 v100, v100, s56, v112
    v_fma_f32 v101, v101, s56, v112
    v_fma_f32 v102, v102, s56, v112
    v_fma_f32 v103, v103, s56, v112
    v_mul_f32 v96, v96, v88
    v_mul_f32 v97, v97, v89
    v_mul_f32 v98, v98, v90
    v_mul_f32 v99, v99, v91
    v_mul_f32 v100, v100, v92
    v_mul_f32 v101, v101, v93
    v_mul_f32 v102, v102, v94
    v_mul_f32 v103, v103, v95
    v_exp_f32 v96, v96
    v_exp_f32 v97, v97
    v_exp_f32 v98, v98
    v_exp_f32 v99, v99
    v_exp_f32 v100, v100
    v_exp_f32 v101, v101
    v_exp_f32 v102, v102
    v_exp_f32 v103, v103
    v_add_f32 v96, 1.0, v96
    v_add_f32 v97, 1.0, v97
    v_add_f32 v98, 1.0, v98
    v_add_f32 v99, 1.0, v99
    v_add_f32 v100, 1.0, v100
    v_add_f32 v101, 1.0, v101
    v_add_f32 v102, 1.0, v102
    v_add_f32 v103, 1.0, v103
    v_rcp_f32 v96, v96
    v_rcp_f32 v97, v97
    v_rcp_f32 v98, v98
    v_rcp_f32 v99, v99
    v_rcp_f32 v100, v100
    v_rcp_f32 v101, v101
    v_rcp_f32 v102, v102
    v_rcp_f32 v103, v103
    v_mul_f32 v88, v88, v96
    v_mul_f32 v89, v89, v97
    v_mul_f32 v90, v90, v98
    v_mul_f32 v91, v91, v99
    v_mul_f32 v92, v92, v100
    v_mul_f32 v93, v93, v101
    v_mul_f32 v94, v94, v102
    v_mul_f32 v95, v95, v103
    v_cvt_pk_bf16_f32 v108, v88, v89
    v_cvt_pk_bf16_f32 v109, v90, v91
    v_cvt_pk_bf16_f32 v110, v92, v93
    v_cvt_pk_bf16_f32 v111, v94, v95
    buffer_store_dwordx4 v[108:111], v9, s[12:15], s63 offen sc1
    s_add_u32 s63, s63, 229376
    s_mov_b32 s67, 0
    s_mov_b32 s71, 1
    s_cmp_gt_u32 s66, s60
    s_cbranch_scc1 L_g_g1r_91
    v_mov_b32 v10, 1
    s_mov_b64 exec, 1
    s_waitcnt vmcnt(0)
    ds_add_rtn_u32 v10, v15, v10 offset:4
    s_waitcnt lgkmcnt(0)
    v_readfirstlane_b32 s46, v10
    s_mov_b64 exec, -1
    s_mov_b32 s71, 0
    s_sub_u32 s59, s60, 1
    s_cmp_lg_u32 s46, s68
    s_cbranch_scc1 L_g_df_116
    v_mov_b32 v10, s59
    v_add_u32 v10, 1, v10
    v_mov_b32 v11, 0
    s_mov_b64 exec, 1
    buffer_store_dword v10, v11, s[12:15], s52 offen sc1
    s_mov_b64 exec, -1
L_sf_117:
L_g_df_116:
    s_add_u32 s68, s68, 4
    s_cmp_gt_u32 s66, s60
    s_cbranch_scc1 L_g_g1r_91
L_g_tail_94:
    s_cmp_lt_u32 s60, s75
    s_cbranch_scc1 L_g_restart_89
    s_waitcnt vmcnt(0)
    s_barrier
    s_branch L_w_f1_14_d
L_g_h1_104:
    s_add_u32 s54, s60, 1
    v_add_u32 v12, s54, v113
    v_mul_u32_u24 v13, 171, v12
    v_lshrrev_b32 v13, 9, v13
    v_mad_i32_i24 v13, v13, -3, v12
    v_lshl_add_u32 v13, v13, 9, v7
    buffer_load_dword v11, v13, s[12:15], 0 offen sc1
    s_branch L_g_h1_104_b
L_g_h2_105:
    s_waitcnt vmcnt(0)
    v_cmp_ge_u32 vcc, v12, v11
    s_nop 0
    s_ff1_i32_b64 s46, vcc
    s_lshr_b32 s46, s46, 4
    s_min_u32 s46, s46, 4
    s_add_u32 s46, s46, s54
    s_min_u32 s46, s46, s75
    v_mov_b32 v118, s46
    s_branch L_g_h2_105_b
L_g_dp_106_l:
    s_cmp_ge_u32 s62, s66
    s_cbranch_scc1 L_g_dp_106_d
    s_mov_b32 s65, 1
    s_add_u32 s47, s61, 4096
    s_mov_b32 m0, s64
    s_add_u32 s62, s62, 1
    buffer_load_dwordx4 v3, s[12:15], s61 offen offset:0 sc1 lds
    buffer_load_dwordx4 v3, s[12:15], s61 offen offset:1024 sc1 lds
    buffer_load_dwordx4 v3, s[12:15], s61 offen offset:2048 sc1 lds
    buffer_load_dwordx4 v3, s[12:15], s61 offen offset:3072 sc1 lds
    s_add_u32 m0, s64, 4096
    s_add_u32 s61, s61, 65536
    buffer_load_dwordx4 v3, s[12:15], s47 offen offset:0 sc1 lds
    buffer_load_dwordx4 v3, s[12:15], s47 offen offset:1024 sc1 lds
    buffer_load_dwordx4 v3, s[12:15], s47 offen offset:2048 sc1 lds
    buffer_load_dwordx4 v3, s[12:15], s47 offen offset:3072 sc1 lds
    s_xor_b32 s64, s64, 0x10000
    s_branch L_g_dp_106_a
L_g_nw_102:
    s_waitcnt vmcnt(0) lgkmcnt(0)
    s_cmp_lg_u32 s44, 0
    s_cbranch_scc1 L_g_nl_118
    s_cmp_lt_u32 s66, s75
    s_cselect_b32 s81, 1, 2
L_g_nl_118:
    s_branch L_g_loop0_92_l
L_g_nfl_109:
    s_cmp_eq_u32 s71, 0
    s_cbranch_scc1 L_g_nfl_109_d
    v_mov_b32 v10, 1
    s_mov_b64 exec, 1
    s_waitcnt vmcnt(0)
    ds_add_rtn_u32 v10, v15, v10 offset:4
    s_waitcnt lgkmcnt(0)
    v_readfirstlane_b32 s46, v10
    s_mov_b64 exec, -1
    s_mov_b32 s71, 0
    s_sub_u32 s59, s60, 1
    s_cmp_lg_u32 s46, s68
    s_cbranch_scc1 L_g_df_119
    v_mov_b32 v10, s59
    v_add_u32 v10, 1, v10
    v_mov_b32 v11, 0
    s_mov_b64 exec, 1
    buffer_store_dword v10, v11, s[12:15], s52 offen sc1
    s_mov_b64 exec, -1
L_sf_120:
L_g_df_119:
    s_add_u32 s68, s68, 4
    s_mov_b32 s65, 2
    s_branch L_g_nfl_109_d
L_g_dp_114_l:
    s_cmp_ge_u32 s62, s66
    s_cbranch_scc1 L_g_dp_114_d
    s_or_b32 s65, s65, 1
    s_add_u32 s47, s61, 4096
    s_mov_b32 m0, s64
    s_add_u32 s62, s62, 1
    buffer_load_dwordx4 v3, s[12:15], s61 offen offset:0 sc1 lds
    buffer_load_dwordx4 v3, s[12:15], s61 offen offset:1024 sc1 lds
    buffer_load_dwordx4 v3, s[12:15], s61 offen offset:2048 sc1 lds
    buffer_load_dwordx4 v3, s[12:15], s61 offen offset:3072 sc1 lds
    s_add_u32 m0, s64, 4096
    s_add_u32 s61, s61, 65536
    buffer_load_dwordx4 v3, s[12:15], s47 offen offset:0 sc1 lds
    buffer_load_dwordx4 v3, s[12:15], s47 offen offset:1024 sc1 lds
    buffer_load_dwordx4 v3, s[12:15], s47 offen offset:2048 sc1 lds
    buffer_load_dwordx4 v3, s[12:15], s47 offen offset:3072 sc1 lds
    s_xor_b32 s64, s64, 0x10000
    s_branch L_g_dp_114_a
L_g_nw1_111:
    s_cmp_eq_u32 s65, 2
    s_cbranch_scc1 L_g_nw1_111_w
    s_waitcnt vmcnt(0)
L_g_nw1_111_w:
    s_barrier
    ds_read_b128 v[32:35], v4 offset:0
    ds_read_b128 v[36:39], v4 offset:1024
    ds_read_b128 v[40:43], v4 offset:2048
    ds_read_b128 v[44:47], v4 offset:3072
    ds_read_b128 v[48:51], v4 offset:4096
    ds_read_b128 v[52:55], v4 offset:5120
    ds_read_b128 v[56:59], v4 offset:6144
    ds_read_b128 v[60:63], v4 offset:7168
    s_branch L_g_jn_113
L_g_mm2_112:
    s_setprio 1
    s_waitcnt lgkmcnt(6)
    v_mfma_f32_32x32x16_bf16 v[16:31], a[0:3], v[32:35], 0
    ds_read_b128 v[32:35], v4 offset:8192
    ds_read_b32 v14, v15
    v_mfma_f32_32x32x16_bf16 v[16:31], a[4:7], v[36:39], v[16:31]
    ds_read_b128 v[36:39], v4 offset:9216
    s_waitcnt lgkmcnt(6)
    v_mfma_f32_32x32x16_bf16 v[16:31], a[8:11], v[40:43], v[16:31]
    ds_read_b128 v[40:43], v4 offset:10240
    v_mfma_f32_32x32x16_bf16 v[16:31], a[12:15], v[44:47], v[16:31]
    ds_read_b128 v[44:47], v4 offset:11264
    s_waitcnt lgkmcnt(6)
    v_mfma_f32_32x32x16_bf16 v[16:31], a[16:19], v[48:51], v[16:31]
    ds_read_b128 v[48:51], v4 offset:12288
    v_mfma_f32_32x32x16_bf16 v[16:31], a[20:23], v[52:55], v[16:31]
    ds_read_b128 v[52:55], v4 offset:13312
    s_waitcnt lgkmcnt(6)
    v_mfma_f32_32x32x16_bf16 v[16:31], a[24:27], v[56:59], v[16:31]
    ds_read_b128 v[56:59], v4 offset:14336
    v_mfma_f32_32x32x16_bf16 v[16:31], a[28:31], v[60:63], v[16:31]
    ds_read_b128 v[60:63], v4 offset:15360
    s_waitcnt lgkmcnt(6)
    v_mfma_f32_32x32x16_bf16 v[16:31], a[32:35], v[32:35], v[16:31]
    ds_read_b128 v[32:35], v4 offset:16384
    v_mfma_f32_32x32x16_bf16 v[16:31], a[36:39], v[36:39], v[16:31]
    ds_read_b128 v[36:39], v4 offset:17408
    s_waitcnt lgkmcnt(6)
    v_mfma_f32_32x32x16_bf16 v[16:31], a[40:43], v[40:43], v[16:31]
    ds_read_b128 v[40:43], v4 offset:18432
    v_mfma_f32_32x32x16_bf16 v[16:31], a[44:47], v[44:47], v[16:31]
    ds_read_b128 v[44:47], v4 offset:19456
    s_waitcnt lgkmcnt(6)
    v_mfma_f32_32x32x16_bf16 v[16:31], a[48:51], v[48:51], v[16:31]
    ds_read_b128 v[48:51], v4 offset:20480
    v_mfma_f32_32x32x16_bf16 v[16:31], a[52:55], v[52:55], v[16:31]
    ds_read_b128 v[52:55], v4 offset:21504
    s_waitcnt lgkmcnt(6)
    v_mfma_f32_32x32x16_bf16 v[16:31], a[56:59], v[56:59], v[16:31]
    ds_read_b128 v[56:59], v4 offset:22528
    v_mfma_f32_32x32x16_bf16 v[16:31], a[60:63], v[60:63], v[16:31]
    ds_read_b128 v[60:63], v4 offset:23552
    s_waitcnt lgkmcnt(6)
    v_mfma_f32_32x32x16_bf16 v[16:31], a[64:67], v[32:35], v[16:31]
    ds_read_b128 v[32:35], v4 offset:24576
    v_mfma_f32_32x32x16_bf16 v[16:31], a[68:71], v[36:39], v[16:31]
    ds_read_b128 v[36:39], v4 offset:25600
    s_waitcnt lgkmcnt(6)
    v_mfma_f32_32x32x16_bf16 v[16:31], a[72:75], v[40:43], v[16:31]
    ds_read_b128 v[40:43], v4 offset:26624
    v_mfma_f32_32x32x16_bf16 v[16:31], a[76:79], v[44:47], v[16:31]
    ds_read_b128 v[44:47], v4 offset:27648
    s_waitcnt lgkmcnt(6)
    v_mfma_f32_32x32x16_bf16 v[16:31], a[80:83], v[48:51], v[16:31]
    ds_read_b128 v[48:51], v4 offset:28672
    v_mfma_f32_32x32x16_bf16 v[16:31], a[84:87], v[52:55], v[16:31]
    ds_read_b128 v[52:55], v4 offset:29696
    s_waitcnt lgkmcnt(6)
    v_mfma_f32_32x32x16_bf16 v[16:31], a[88:91], v[56:59], v[16:31]
    ds_read_b128 v[56:59], v4 offset:30720
    v_mfma_f32_32x32x16_bf16 v[16:31], a[92:95], v[60:63], v[16:31]
    ds_read_b128 v[60:63], v4 offset:31744
    s_waitcnt lgkmcnt(6)
    v_mfma_f32_32x32x16_bf16 v[16:31], a[96:99], v[32:35], v[16:31]
    v_mfma_f32_32x32x16_bf16 v[16:31], a[100:103], v[36:39], v[16:31]
    s_waitcnt lgkmcnt(4)
    v_mfma_f32_32x32x16_bf16 v[16:31], a[104:107], v[40:43], v[16:31]
    v_mfma_f32_32x32x16_bf16 v[16:31], a[108:111], v[44:47], v[16:31]
    s_waitcnt lgkmcnt(2)
    v_mfma_f32_32x32x16_bf16 v[16:31], a[112:115], v[48:51], v[16:31]
    v_mfma_f32_32x32x16_bf16 v[16:31], a[116:119], v[52:55], v[16:31]
    s_waitcnt lgkmcnt(0)
    v_mfma_f32_32x32x16_bf16 v[16:31], a[120:123], v[56:59], v[16:31]
    v_mfma_f32_32x32x16_bf16 v[16:31], a[124:127], v[60:63], v[16:31]
    v_xor_b32 v4, 0x10000, v4
    s_setprio 0
    s_waitcnt vmcnt(0)
    s_branch L_g_mm2_112_d
L_w_f2_13:
    s_load_dwordx2 s[4:5], s[0:1], 80
    s_load_dwordx2 s[6:7], s[0:1], 72
    s_and_b32 s50, s44, 3
    s_lshr_b32 s51, s44, 2
    s_waitcnt lgkmcnt(0)
    s_mov_b32 s24, s4
    s_and_b32 s25, s5, 0xffff
    s_mov_b32 s26, 0x700000
    s_mov_b32 s27, 0x00020000
    v_lshrrev_b32 v3, 4, v1
    v_and_b32 v4, 15, v1
    v_lshlrev_b32 v5, 2, v3
    v_xor_b32 v4, v4, v5
    v_mul_u32_u24 v3, 2048, v3
    v_lshl_add_u32 v3, v4, 4, v3
    s_mul_i32 s46, s51, 448
    s_mul_i32 s47, s50, 16
    s_add_u32 s46, s46, s47
    s_mul_i32 s47, s42, 896
    s_add_u32 s46, s46, s47
    s_mul_i32 s46, s46, 2048
    s_lshl_b32 s47, s43, 8
    s_add_u32 s46, s46, s47
    s_lshl_b32 s45, s51, 16
    s_mul_i32 s47, s50, 4096
    s_add_u32 s45, s45, s47
    v_bfe_u32 v4, v1, 2, 2
    v_bfe_u32 v5, v1, 4, 1
    v_lshlrev_b32 v5, 1, v5
    v_bfe_u32 v6, v1, 1, 1
    v_add_u32 v5, v5, v6
    s_lshl_b32 s47, s50, 2
    v_add_u32 v5, s47, v5
    v_lshlrev_b32 v6, 2, v4
    v_xor_b32 v5, v5, v6
    v_lshlrev_b32 v5, 4, v5
    v_lshl_add_u32 v5, v4, 8, v5
    v_bfe_u32 v6, v1, 0, 1
    v_lshl_add_u32 v5, v6, 3, v5
    v_lshrrev_b32 v6, 5, v1
    v_mul_u32_u24 v6, 1024, v6
    v_add_u32 v5, v5, v6
    s_lshl_b32 s47, s51, 16
    v_add_u32 v5, s47, v5
    v_bfe_u32 v4, v1, 2, 2
    v_xor_b32 v5, s50, v4
    v_lshlrev_b32 v5, 6, v5
    v_lshl_add_u32 v5, v4, 8, v5
    v_and_b32 v6, 3, v1
    v_lshl_add_u32 v5, v6, 3, v5
    v_lshrrev_b32 v6, 4, v1
    v_lshl_add_u32 v5, v6, 10, v5
    v_lshrrev_b32 v6, 5, v1
    v_lshl_add_u32 v5, v6, 11, v5
    s_lshl_b32 s47, s51, 16
    v_add_u32 v5, s47, v5
    s_add_u32 m0, s45, 0
    s_add_u32 s47, s46, 0x0
    buffer_load_dwordx4 v3, s[24:27], s47 offen nt lds
    s_add_u32 m0, s45, 1024
    s_add_u32 s47, s46, 0x2000
    buffer_load_dwordx4 v3, s[24:27], s47 offen nt lds
    s_add_u32 m0, s45, 2048
    s_add_u32 s47, s46, 0x4000
    buffer_load_dwordx4 v3, s[24:27], s47 offen nt lds
    s_add_u32 m0, s45, 3072
    s_add_u32 s47, s46, 0x6000
    buffer_load_dwordx4 v3, s[24:27], s47 offen nt lds
    s_add_u32 m0, s45, 16384
    s_add_u32 s47, s46, 0x20000
    buffer_load_dwordx4 v3, s[24:27], s47 offen nt lds
    s_add_u32 m0, s45, 17408
    s_add_u32 s47, s46, 0x22000
    buffer_load_dwordx4 v3, s[24:27], s47 offen nt lds
    s_add_u32 m0, s45, 18432
    s_add_u32 s47, s46, 0x24000
    buffer_load_dwordx4 v3, s[24:27], s47 offen nt lds
    s_add_u32 m0, s45, 19456
    s_add_u32 s47, s46, 0x26000
    buffer_load_dwordx4 v3, s[24:27], s47 offen nt lds
    s_add_u32 m0, s45, 32768
    s_add_u32 s47, s46, 0x40000
    buffer_load_dwordx4 v3, s[24:27], s47 offen nt lds
    s_add_u32 m0, s45, 33792
    s_add_u32 s47, s46, 0x42000
    buffer_load_dwordx4 v3, s[24:27], s47 offen nt lds
    s_add_u32 m0, s45, 34816
    s_add_u32 s47, s46, 0x44000
    buffer_load_dwordx4 v3, s[24:27], s47 offen nt lds
    s_add_u32 m0, s45, 35840
    s_add_u32 s47, s46, 0x46000
    buffer_load_dwordx4 v3, s[24:27], s47 offen nt lds
    s_add_u32 m0, s45, 49152
    s_add_u32 s47, s46, 0x60000
    buffer_load_dwordx4 v3, s[24:27], s47 offen nt lds
    s_add_u32 m0, s45, 50176
    s_add_u32 s47, s46, 0x62000
    buffer_load_dwordx4 v3, s[24:27], s47 offen nt lds
    s_add_u32 m0, s45, 51200
    s_add_u32 s47, s46, 0x64000
    buffer_load_dwordx4 v3, s[24:27], s47 offen nt lds
    s_add_u32 m0, s45, 52224
    s_add_u32 s47, s46, 0x66000
    buffer_load_dwordx4 v3, s[24:27], s47 offen nt lds
    s_waitcnt vmcnt(12) lgkmcnt(0)
    s_barrier
    ds_read_b64_tr_b16 a[0:1], v5 offset:0
    ds_read_b64_tr_b16 a[2:3], v5 offset:2048
    ds_read_b64_tr_b16 a[4:5], v5 offset:32
    ds_read_b64_tr_b16 a[6:7], v5 offset:2080
    ds_read_b64_tr_b16 a[8:9], v5 offset:8192
    ds_read_b64_tr_b16 a[10:11], v5 offset:10240
    ds_read_b64_tr_b16 a[12:13], v5 offset:8224
    ds_read_b64_tr_b16 a[14:15], v5 offset:10272
    s_waitcnt vmcnt(8) lgkmcnt(0)
    s_barrier
    s_add_u32 m0, s45, 0
    s_add_u32 s47, s46, 0x80000
    buffer_load_dwordx4 v3, s[24:27], s47 offen nt lds
    s_add_u32 m0, s45, 1024
    s_add_u32 s47, s46, 0x82000
    buffer_load_dwordx4 v3, s[24:27], s47 offen nt lds
    s_add_u32 m0, s45, 2048
    s_add_u32 s47, s46, 0x84000
    buffer_load_dwordx4 v3, s[24:27], s47 offen nt lds
    s_add_u32 m0, s45, 3072
    s_add_u32 s47, s46, 0x86000
    buffer_load_dwordx4 v3, s[24:27], s47 offen nt lds
    ds_read_b64_tr_b16 a[16:17], v5 offset:16384
    ds_read_b64_tr_b16 a[18:19], v5 offset:18432
    ds_read_b64_tr_b16 a[20:21], v5 offset:16416
    ds_read_b64_tr_b16 a[22:23], v5 offset:18464
    ds_read_b64_tr_b16 a[24:25], v5 offset:24576
    ds_read_b64_tr_b16 a[26:27], v5 offset:26624
    ds_read_b64_tr_b16 a[28:29], v5 offset:24608
    ds_read_b64_tr_b16 a[30:31], v5 offset:26656
    s_waitcnt vmcnt(8) lgkmcnt(0)
    s_barrier
    s_add_u32 m0, s45, 16384
    s_add_u32 s47, s46, 0xa0000
    buffer_load_dwordx4 v3, s[24:27], s47 offen nt lds
    s_add_u32 m0, s45, 17408
    s_add_u32 s47, s46, 0xa2000
    buffer_load_dwordx4 v3, s[24:27], s47 offen nt lds
    s_add_u32 m0, s45, 18432
    s_add_u32 s47, s46, 0xa4000
    buffer_load_dwordx4 v3, s[24:27], s47 offen nt lds
    s_add_u32 m0, s45, 19456
    s_add_u32 s47, s46, 0xa6000
    buffer_load_dwordx4 v3, s[24:27], s47 offen nt lds
    ds_read_b64_tr_b16 a[32:33], v5 offset:32768
    ds_read_b64_tr_b16 a[34:35], v5 offset:34816
    ds_read_b64_tr_b16 a[36:37], v5 offset:32800
    ds_read_b64_tr_b16 a[38:39], v5 offset:34848
    ds_read_b64_tr_b16 a[40:41], v5 offset:40960
    ds_read_b64_tr_b16 a[42:43], v5 offset:43008
    ds_read_b64_tr_b16 a[44:45], v5 offset:40992
    ds_read_b64_tr_b16 a[46:47], v5 offset:43040
    s_waitcnt vmcnt(8) lgkmcnt(0)
    s_barrier
    s_add_u32 m0, s45, 32768
    s_add_u32 s47, s46, 0xc0000
    buffer_load_dwordx4 v3, s[24:27], s47 offen nt lds
    s_add_u32 m0, s45, 33792
    s_add_u32 s47, s46, 0xc2000
    buffer_load_dwordx4 v3, s[24:27], s47 offen nt lds
    s_add_u32 m0, s45, 34816
    s_add_u32 s47, s46, 0xc4000
    buffer_load_dwordx4 v3, s[24:27], s47 offen nt lds
    s_add_u32 m0, s45, 35840
    s_add_u32 s47, s46, 0xc6000
    buffer_load_dwordx4 v3, s[24:27], s47 offen nt lds
    ds_read_b64_tr_b16 a[48:49], v5 offset:49152
    ds_read_b64_tr_b16 a[50:51], v5 offset:51200
    ds_read_b64_tr_b16 a[52:53], v5 offset:49184
    ds_read_b64_tr_b16 a[54:55], v5 offset:51232
    ds_read_b64_tr_b16 a[56:57], v5 offset:57344
    ds_read_b64_tr_b16 a[58:59], v5 offset:59392
    ds_read_b64_tr_b16 a[60:61], v5 offset:57376
    ds_read_b64_tr_b16 a[62:63], v5 offset:59424
    s_waitcnt vmcnt(8) lgkmcnt(0)
    s_barrier
    ds_read_b64_tr_b16 a[64:65], v5 offset:0
    ds_read_b64_tr_b16 a[66:67], v5 offset:2048
    ds_read_b64_tr_b16 a[68:69], v5 offset:32
    ds_read_b64_tr_b16 a[70:71], v5 offset:2080
    ds_read_b64_tr_b16 a[72:73], v5 offset:8192
    ds_read_b64_tr_b16 a[74:75], v5 offset:10240
    ds_read_b64_tr_b16 a[76:77], v5 offset:8224
    ds_read_b64_tr_b16 a[78:79], v5 offset:10272
    s_waitcnt vmcnt(4) lgkmcnt(0)
    s_barrier
    ds_read_b64_tr_b16 a[80:81], v5 offset:16384
    ds_read_b64_tr_b16 a[82:83], v5 offset:18432
    ds_read_b64_tr_b16 a[84:85], v5 offset:16416
    ds_read_b64_tr_b16 a[86:87], v5 offset:18464
    ds_read_b64_tr_b16 a[88:89], v5 offset:24576
    ds_read_b64_tr_b16 a[90:91], v5 offset:26624
    ds_read_b64_tr_b16 a[92:93], v5 offset:24608
    ds_read_b64_tr_b16 a[94:95], v5 offset:26656
    s_waitcnt vmcnt(0) lgkmcnt(0)
    s_barrier
    ds_read_b64_tr_b16 a[96:97], v5 offset:32768
    ds_read_b64_tr_b16 a[98:99], v5 offset:34816
    ds_read_b64_tr_b16 a[100:101], v5 offset:32800
    ds_read_b64_tr_b16 a[102:103], v5 offset:34848
    ds_read_b64_tr_b16 a[104:105], v5 offset:40960
    ds_read_b64_tr_b16 a[106:107], v5 offset:43008
    ds_read_b64_tr_b16 a[108:109], v5 offset:40992
    ds_read_b64_tr_b16 a[110:111], v5 offset:43040
    s_waitcnt lgkmcnt(0)
    s_barrier
    v_lshlrev_b32 v2, 4, v1
    s_mul_i32 s64, s44, 7168
    s_add_u32 s46, s64, 0x6000000
    s_mul_i32 s47, s42, 57344
    s_add_u32 s46, s46, s47
    v_add_u32 v3, s46, v2
    s_mul_i32 s46, s51, 28672
    v_add_u32 v4, s46, v2
    v_and_b32 v6, 15, v1
    v_lshlrev_b32 v6, 4, v6
    v_lshrrev_b32 v7, 4, v1
    v_lshl_add_u32 v6, v7, 9, v6
    v_add_u32 v4, s46, v6
    s_lshl_b32 s46, s50, 12
    s_add_u32 s46, s46, 131072
    v_add_u32 v5, s46, v2
    v_and_b32 v7, 15, v1
    v_min_u32 v7, 6, v7
    v_lshlrev_b32 v7, 7, v7
    s_mul_i32 s46, s42, 896
    s_add_u32 s46, s46, 0x106400
    v_add_u32 v7, s46, v7
    s_lshl_b32 s46, s42, 16
    s_lshl_b32 s47, s43, 11
    s_add_u32 s46, s46, s47
    s_lshl_b32 s47, s50, 9
    s_add_u32 s46, s46, s47
    s_add_u32 s46, s46, 0xb000000
    v_and_b32 v8, 31, v1
    v_lshlrev_b32 v8, 4, v8
    v_lshrrev_b32 v9, 5, v1
    v_lshl_add_u32 v8, v9, 14, v8
    v_add_u32 v8, s46, v8
    v_add_u32 v9, 0x8000, v8
    s_lshl_b32 s52, s43, 9
    s_lshl_b32 s47, s42, 7
    s_add_u32 s52, s52, s47
    s_add_u32 s52, s52, 0x108400
    s_add_u32 s52, s52, s76
    s_mul_i32 s46, s43, 7168
    s_add_u32 s46, s46, 0x6000000
    s_mul_i32 s47, s42, 57344
    s_add_u32 s46, s46, s47
    v_min_u32 v116, 55, v1
    v_lshlrev_b32 v116, 7, v116
    v_add_u32 v116, s46, v116
    s_mov_b32 s60, s74
    s_mul_i32 s61, s74, 229376
    s_mov_b32 s62, s74
    s_mul_i32 s63, s74, 262144
    s_mov_b32 s67, 0
    s_mov_b32 s68, 3
    s_mov_b32 s71, 0
    v_mov_b32 v15, 147456
    v_mov_b32 v14, 0
    ds_write_b32 v15, v14 offset:4
    ds_write_b32 v15, v14 offset:12
    ds_write_b32 v15, v14 offset:16
    v_mov_b32 v114, 1
    v_mov_b32 v115, 0
    s_mov_b32 s81, 0
    s_lshl_b32 s46, s44, 5
    v_add_u32 v119, s46, v15
    v_lshrrev_b32 v113, 4, v1
    s_mov_b32 s72, 0
L_g_restart_121:
    s_cmp_lg_u32 s44, 0
    s_cbranch_scc1 L_g_nsp_122
    s_mov_b32 s70, 0
L_g_sp_128:
    s_add_u32 s54, s60, 0
    v_add_u32 v12, s54, v113
    v_subrev_u32 v13, 60, v12
    v_subrev_u32 v11, 63, v12
    v_ashrrev_i32 v13, 31, v13
    v_ashrrev_i32 v11, 31, v11
    v_add3_u32 v13, v13, v11, 2
    v_lshl_add_u32 v13, v13, 16, v7
    buffer_load_dword v11, v13, s[12:15], 0 offen sc1
    s_waitcnt vmcnt(0)
    v_cmp_ge_u32 vcc, v12, v11
    s_add_u32 s70, s70, 1
    s_and_b32 s46, vcc_lo, 0xffff
    s_cbranch_scc0 L_g_sp_128_ok
    s_sleep 3
    s_cmp_lt_u32 s70, 524288
    s_cbranch_scc1 L_g_sp_128
    s_branch L_c_done_1
L_g_sp_128_ok:
    v_cmp_ge_u32 vcc, v12, v11
    s_nop 0
    s_ff1_i32_b64 s46, vcc
    s_lshr_b32 s46, s46, 4
    s_min_u32 s46, s46, 4
    s_add_u32 s46, s46, s54
    s_min_u32 s46, s46, s75
    v_mov_b32 v118, s46
    ds_write_b32 v15, v118 offset:20
L_g_nsp_122:
    s_waitcnt lgkmcnt(0)
    s_barrier
    ds_read_b32 v14, v15 offset:20
    s_waitcnt lgkmcnt(0)
    v_readfirstlane_b32 s66, v14
    s_nop 3
L_g_restart_121_go:
    s_mov_b32 s69, 0
    s_cmp_gt_u32 s62, s60
    s_cbranch_scc1 L_g_nd_129
    s_cmp_ge_u32 s62, s66
    s_cbranch_scc1 L_g_nd_129
    s_add_u32 s47, s61, 4096
    s_add_u32 m0, s64, 0
    s_nop 0
    buffer_load_dwordx4 v3, s[12:15], s61 offen offset:0 sc1 lds
    buffer_load_dwordx4 v3, s[12:15], s61 offen offset:1024 sc1 lds
    buffer_load_dwordx4 v3, s[12:15], s61 offen offset:2048 sc1 lds
    buffer_load_dwordx4 v3, s[12:15], s61 offen offset:3072 sc1 lds
    s_add_u32 m0, s64, 4096
    s_nop 0
    buffer_load_dwordx4 v3, s[12:15], s47 offen offset:0 sc1 lds
    buffer_load_dwordx4 v3, s[12:15], s47 offen offset:1024 sc1 lds
    buffer_load_dwordx4 v3, s[12:15], s47 offen offset:2048 sc1 lds
    s_add_u32 s61, s61, 229376
    s_add_u32 s62, s62, 1
    s_xor_b32 s64, s64, 0x10000
    s_mov_b32 s69, 1
L_g_nd_129:
    s_cmp_eq_u32 s51, 1
    s_cbranch_scc1 L_g_g1r_123
    s_add_u32 s59, s60, 1
    s_mov_b32 s69, 0
    s_cmp_gt_u32 s62, s59
    s_cbranch_scc1 L_g_nd_130
    s_cmp_ge_u32 s62, s66
    s_cbranch_scc1 L_g_nd_130
    s_add_u32 s47, s61, 4096
    s_add_u32 m0, s64, 0
    s_nop 0
    buffer_load_dwordx4 v3, s[12:15], s61 offen offset:0 sc1 lds
    buffer_load_dwordx4 v3, s[12:15], s61 offen offset:1024 sc1 lds
    buffer_load_dwordx4 v3, s[12:15], s61 offen offset:2048 sc1 lds
    buffer_load_dwordx4 v3, s[12:15], s61 offen offset:3072 sc1 lds
    s_add_u32 m0, s64, 4096
    s_nop 0
    buffer_load_dwordx4 v3, s[12:15], s47 offen offset:0 sc1 lds
    buffer_load_dwordx4 v3, s[12:15], s47 offen offset:1024 sc1 lds
    buffer_load_dwordx4 v3, s[12:15], s47 offen offset:2048 sc1 lds
    s_add_u32 s61, s61, 229376
    s_add_u32 s62, s62, 1
    s_xor_b32 s64, s64, 0x10000
    s_mov_b32 s69, 1
L_g_nd_130:
    s_cmp_eq_u32 s69, 1
    s_cbranch_scc1 L_g_w0_131
    s_waitcnt vmcnt(0)
L_g_w0_131:
    s_waitcnt vmcnt(7)
    s_cmp_lg_u32 s44, 0
    s_cbranch_scc1 L_g_nl_132
    s_cmp_lt_u32 s66, s75
    s_cselect_b32 s81, 1, 2
L_g_nl_132:
L_g_loop0_124_l:
    s_barrier
    ds_read_b128 v[32:35], v4 offset:0
    ds_read_b128 v[36:39], v4 offset:256
    ds_read_b128 v[40:43], v4 offset:2048
    ds_read_b128 v[44:47], v4 offset:2304
    ds_read_b128 v[48:51], v4 offset:4096
    ds_read_b128 v[52:55], v4 offset:4352
    ds_read_b128 v[56:59], v4 offset:6144
    ds_read_b128 v[60:63], v4 offset:6400
    s_branch L_g_loop0_124_m
.p2align 6
L_g_loop0_124:
    s_barrier
L_g_loop0_124_m:
    s_setprio 2
    s_waitcnt lgkmcnt(6)
    v_mfma_f32_16x16x32_bf16 v[16:19], v[32:35], a[0:3], 0
    v_mfma_f32_16x16x32_bf16 v[20:23], v[32:35], a[4:7], 0
    ds_read_b128 v[32:35], v4 offset:8192
    v_mfma_f32_16x16x32_bf16 v[28:31], v[36:39], a[4:7], 0
    v_mfma_f32_16x16x32_bf16 v[24:27], v[36:39], a[0:3], 0
    ds_read_b128 v[36:39], v4 offset:8448
    s_cmp_eq_u32 s81, 1
    s_cbranch_scc1 L_g_h1_136
L_g_h1_136_b:
    s_waitcnt lgkmcnt(6)
    v_mfma_f32_16x16x32_bf16 v[16:19], v[40:43], a[8:11], v[16:19]
    v_mfma_f32_16x16x32_bf16 v[20:23], v[40:43], a[12:15], v[20:23]
    ds_read_b128 v[40:43], v4 offset:10240
    v_mfma_f32_16x16x32_bf16 v[28:31], v[44:47], a[12:15], v[28:31]
    v_mfma_f32_16x16x32_bf16 v[24:27], v[44:47], a[8:11], v[24:27]
    ds_read_b128 v[44:47], v4 offset:10496
    s_waitcnt lgkmcnt(6)
    v_mfma_f32_16x16x32_bf16 v[16:19], v[48:51], a[16:19], v[16:19]
    v_mfma_f32_16x16x32_bf16 v[20:23], v[48:51], a[20:23], v[20:23]
    ds_read_b128 v[48:51], v4 offset:12288
    v_mfma_f32_16x16x32_bf16 v[28:31], v[52:55], a[20:23], v[28:31]
    v_mfma_f32_16x16x32_bf16 v[24:27], v[52:55], a[16:19], v[24:27]
    ds_read_b128 v[52:55], v4 offset:12544
    s_waitcnt lgkmcnt(6)
    v_mfma_f32_16x16x32_bf16 v[16:19], v[56:59], a[24:27], v[16:19]
    v_mfma_f32_16x16x32_bf16 v[20:23], v[56:59], a[28:31], v[20:23]
    ds_read_b128 v[56:59], v4 offset:14336
    v_mfma_f32_16x16x32_bf16 v[28:31], v[60:63], a[28:31], v[28:31]
    v_mfma_f32_16x16x32_bf16 v[24:27], v[60:63], a[24:27], v[24:27]
    ds_read_b128 v[60:63], v4 offset:14592
    s_waitcnt lgkmcnt(6)
    v_mfma_f32_16x16x32_bf16 v[16:19], v[32:35], a[32:35], v[16:19]
    v_mfma_f32_16x16x32_bf16 v[20:23], v[32:35], a[36:39], v[20:23]
    ds_read_b128 v[32:35], v4 offset:16384
    v_mfma_f32_16x16x32_bf16 v[28:31], v[36:39], a[36:39], v[28:31]
    v_mfma_f32_16x16x32_bf16 v[24:27], v[36:39], a[32:35], v[24:27]
    ds_read_b128 v[36:39], v4 offset:16640
    s_waitcnt lgkmcnt(6)
    v_mfma_f32_16x16x32_bf16 v[16:19], v[40:43], a[40:43], v[16:19]
    v_mfma_f32_16x16x32_bf16 v[20:23], v[40:43], a[44:47], v[20:23]
    ds_read_b128 v[40:43], v4 offset:18432
    v_mfma_f32_16x16x32_bf16 v[28:31], v[44:47], a[44:47], v[28:31]
    v_mfma_f32_16x16x32_bf16 v[24:27], v[44:47], a[40:43], v[24:27]
    ds_read_b128 v[44:47], v4 offset:18688
    s_waitcnt lgkmcnt(6)
    v_mfma_f32_16x16x32_bf16 v[16:19], v[48:51], a[48:51], v[16:19]
    v_mfma_f32_16x16x32_bf16 v[20:23], v[48:51], a[52:55], v[20:23]
    ds_read_b128 v[48:51], v4 offset:20480
    v_mfma_f32_16x16x32_bf16 v[28:31], v[52:55], a[52:55], v[28:31]
    v_mfma_f32_16x16x32_bf16 v[24:27], v[52:55], a[48:51], v[24:27]
    ds_read_b128 v[52:55], v4 offset:20736
    s_waitcnt lgkmcnt(6)
    v_mfma_f32_16x16x32_bf16 v[16:19], v[56:59], a[56:59], v[16:19]
    v_mfma_f32_16x16x32_bf16 v[20:23], v[56:59], a[60:63], v[20:23]
    ds_read_b128 v[56:59], v4 offset:22528
    v_mfma_f32_16x16x32_bf16 v[28:31], v[60:63], a[60:63], v[28:31]
    v_mfma_f32_16x16x32_bf16 v[24:27], v[60:63], a[56:59], v[24:27]
    ds_read_b128 v[60:63], v4 offset:22784
    s_waitcnt lgkmcnt(6)
    v_mfma_f32_16x16x32_bf16 v[16:19], v[32:35], a[64:67], v[16:19]
    v_mfma_f32_16x16x32_bf16 v[20:23], v[32:35], a[68:71], v[20:23]
    ds_read_b128 v[32:35], v4 offset:24576
    v_mfma_f32_16x16x32_bf16 v[28:31], v[36:39], a[68:71], v[28:31]
    v_mfma_f32_16x16x32_bf16 v[24:27], v[36:39], a[64:67], v[24:27]
    ds_read_b128 v[36:39], v4 offset:24832
    s_waitcnt lgkmcnt(6)
    v_mfma_f32_16x16x32_bf16 v[16:19], v[40:43], a[72:75], v[16:19]
    v_mfma_f32_16x16x32_bf16 v[20:23], v[40:43], a[76:79], v[20:23]
    ds_read_b128 v[40:43], v4 offset:26624
    v_mfma_f32_16x16x32_bf16 v[28:31], v[44:47], a[76:79], v[28:31]
    v_mfma_f32_16x16x32_bf16 v[24:27], v[44:47], a[72:75], v[24:27]
    ds_read_b128 v[44:47], v4 offset:26880
    s_waitcnt lgkmcnt(6)
    v_mfma_f32_16x16x32_bf16 v[16:19], v[48:51], a[80:83], v[16:19]
    v_mfma_f32_16x16x32_bf16 v[20:23], v[48:51], a[84:87], v[20:23]
    v_mfma_f32_16x16x32_bf16 v[28:31], v[52:55], a[84:87], v[28:31]
    v_mfma_f32_16x16x32_bf16 v[24:27], v[52:55], a[80:83], v[24:27]
    s_waitcnt lgkmcnt(4)
    v_mfma_f32_16x16x32_bf16 v[16:19], v[56:59], a[88:91], v[16:19]
    v_mfma_f32_16x16x32_bf16 v[20:23], v[56:59], a[92:95], v[20:23]
    v_mfma_f32_16x16x32_bf16 v[28:31], v[60:63], a[92:95], v[28:31]
    v_mfma_f32_16x16x32_bf16 v[24:27], v[60:63], a[88:91], v[24:27]
    s_waitcnt lgkmcnt(2)
    v_mfma_f32_16x16x32_bf16 v[16:19], v[32:35], a[96:99], v[16:19]
    v_mfma_f32_16x16x32_bf16 v[20:23], v[32:35], a[100:103], v[20:23]
    s_cmp_eq_u32 s81, 1
    s_cbranch_scc1 L_g_h2_137
L_g_h2_137_b:
    ds_write_b32 v119, v118
    v_mfma_f32_16x16x32_bf16 v[28:31], v[36:39], a[100:103], v[28:31]
    v_mfma_f32_16x16x32_bf16 v[24:27], v[36:39], a[96:99], v[24:27]
    s_waitcnt lgkmcnt(0)
    v_mfma_f32_16x16x32_bf16 v[16:19], v[40:43], a[104:107], v[16:19]
    v_mfma_f32_16x16x32_bf16 v[20:23], v[40:43], a[108:111], v[20:23]
    v_mfma_f32_16x16x32_bf16 v[28:31], v[44:47], a[108:111], v[28:31]
    v_mfma_f32_16x16x32_bf16 v[24:27], v[44:47], a[104:107], v[24:27]
    v_xor_b32 v4, 0x10000, v4
    s_setprio 0
    s_waitcnt vmcnt(0)
    s_waitcnt lgkmcnt(0)
    s_barrier
    ds_read_b32 v14, v15
    s_nop 6
    ds_write_b128 v5, v[16:19] offset:0
    ds_write_b128 v5, v[20:23] offset:1024
    ds_write_b128 v5, v[24:27] offset:2048
    ds_write_b128 v5, v[28:31] offset:3072
    s_waitcnt lgkmcnt(4)
    v_readfirstlane_b32 s66, v14
    s_add_u32 s60, s60, 1
    s_mov_b32 s65, 0
    s_cmp_le_u32 s62, s60
    s_cbranch_scc1 L_g_dp_138_l
L_g_dp_138_a:
    s_cmp_ge_u32 s62, s66
    s_cbranch_scc1 L_g_dp_138_d
    s_add_u32 s47, s61, 4096
    s_mov_b32 m0, s64
    s_add_u32 s62, s62, 1
    buffer_load_dwordx4 v3, s[12:15], s61 offen offset:0 sc1 lds
    buffer_load_dwordx4 v3, s[12:15], s61 offen offset:1024 sc1 lds
    buffer_load_dwordx4 v3, s[12:15], s61 offen offset:2048 sc1 lds
    buffer_load_dwordx4 v3, s[12:15], s61 offen offset:3072 sc1 lds
    s_add_u32 m0, s64, 4096
    s_add_u32 s61, s61, 229376
    buffer_load_dwordx4 v3, s[12:15], s47 offen offset:0 sc1 lds
    buffer_load_dwordx4 v3, s[12:15], s47 offen offset:1024 sc1 lds
    buffer_load_dwordx4 v3, s[12:15], s47 offen offset:2048 sc1 lds
    s_xor_b32 s64, s64, 0x10000
L_g_dp_138_d:
    s_cmp_lg_u32 s44, 2
    s_cbranch_scc1 L_g_pf_139
    s_cmp_ge_u32 s62, s66
    s_cbranch_scc1 L_g_pf_139
    buffer_load_dword v117, v116, s[12:15], s61 offen sc1
L_g_pf_139:
    s_cmp_le_u32 s66, s60
    s_cbranch_scc1 L_g_ex0_135
    s_cmp_lg_u32 s65, 0
    s_cbranch_scc1 L_g_nw_134
    ds_read_b128 v[32:35], v4 offset:0
    ds_read_b128 v[36:39], v4 offset:256
    ds_read_b128 v[40:43], v4 offset:2048
    ds_read_b128 v[44:47], v4 offset:2304
    ds_read_b128 v[48:51], v4 offset:4096
    ds_read_b128 v[52:55], v4 offset:4352
    ds_read_b128 v[56:59], v4 offset:6144
    ds_read_b128 v[60:63], v4 offset:6400
    s_cmp_lg_u32 s44, 0
    s_cbranch_scc1 L_g_nl_140
    s_mov_b32 s46, s66
    s_cmp_lg_u32 s81, 0
    s_cbranch_scc1 L_g_nl_140_e
    v_cmp_ge_u32 vcc, v12, v11
    s_nop 0
    s_ff1_i32_b64 s46, vcc
    s_lshr_b32 s46, s46, 4
    s_min_u32 s46, s46, 4
    s_add_u32 s46, s46, s54
    s_min_u32 s46, s46, s75
    v_mov_b32 v118, s46
L_g_nl_140_e:
    s_add_u32 s47, s60, 3
    s_min_u32 s47, s47, s75
    s_cmp_lt_u32 s46, s47
    s_cselect_b32 s81, 1, 0
    s_cbranch_scc1 L_g_nl_140
    s_add_u32 s54, s60, 2
    v_add_u32 v12, s54, v113
    v_subrev_u32 v13, 60, v12
    v_subrev_u32 v11, 63, v12
    v_ashrrev_i32 v13, 31, v13
    v_ashrrev_i32 v11, 31, v11
    v_add3_u32 v13, v13, v11, 2
    v_lshl_add_u32 v13, v13, 16, v7
    buffer_load_dword v11, v13, s[12:15], 0 offen sc1
L_g_nl_140:
    s_waitcnt lgkmcnt(8)
    s_branch L_g_loop0_124
L_g_ex0_135:
    s_cmp_lg_u32 s44, 0
    s_cbranch_scc1 L_g_ex0_135_n
    ds_write_b32 v15, v118 offset:20
    s_cmp_ge_u32 s60, s75
    s_cbranch_scc1 L_g_ex0_135_n
    s_sleep 6
    s_add_u32 s54, s60, 0
    v_add_u32 v12, s54, v113
    v_subrev_u32 v13, 60, v12
    v_subrev_u32 v11, 63, v12
    v_ashrrev_i32 v13, 31, v13
    v_ashrrev_i32 v11, 31, v11
    v_add3_u32 v13, v13, v11, 2
    v_lshl_add_u32 v13, v13, 16, v7
    buffer_load_dword v11, v13, s[12:15], 0 offen sc1
    s_waitcnt vmcnt(0)
    v_cmp_ge_u32 vcc, v12, v11
    s_nop 0
    s_ff1_i32_b64 s46, vcc
    s_lshr_b32 s46, s46, 4
    s_min_u32 s46, s46, 4
    s_add_u32 s46, s46, s54
    s_min_u32 s46, s46, s75
    v_mov_b32 v118, s46
    ds_write_b32 v15, v118 offset:20
L_g_ex0_135_n:
    s_waitcnt lgkmcnt(0)
    s_barrier
    ds_read_b32 v14, v15 offset:20
    s_waitcnt lgkmcnt(0)
    v_readfirstlane_b32 s66, v14
    s_barrier
    s_cmp_gt_u32 s66, s60
    s_cbranch_scc1 L_g_restart_121_go
    s_branch L_g_tail_126
L_g_g1r_123:
    s_mov_b32 s65, 1
    s_branch L_g_loop1_125_e
.p2align 6
L_g_loop1_125:
    s_mov_b32 s65, 0
L_g_loop1_125_e:
    s_barrier
    s_bitcmp1_b32 s67, 1
    s_cbranch_scc0 L_g_nfl_141
    s_cmp_lg_u32 s44, 4
    s_cbranch_scc1 L_g_nfl_141_d
    s_sub_u32 s59, s60, 1
    v_mov_b32 v10, s59
    buffer_store_dword v10, v115, s[12:15], s52 offen sc1
L_g_nfl_141_d:
    ds_read_b128 v[80:83], v5 offset:0
    ds_read_b128 v[84:87], v5 offset:1024
    ds_read_b128 v[88:91], v5 offset:2048
    ds_read_b128 v[92:95], v5 offset:3072
    s_cmp_le_u32 s62, s60
    s_cbranch_scc1 L_g_dp_146_l
L_g_dp_146_a:
    s_cmp_ge_u32 s62, s66
    s_cbranch_scc1 L_g_dp_146_d
    s_add_u32 s47, s61, 4096
    s_mov_b32 m0, s64
    s_add_u32 s62, s62, 1
    buffer_load_dwordx4 v3, s[12:15], s61 offen offset:0 sc1 lds
    buffer_load_dwordx4 v3, s[12:15], s61 offen offset:1024 sc1 lds
    buffer_load_dwordx4 v3, s[12:15], s61 offen offset:2048 sc1 lds
    buffer_load_dwordx4 v3, s[12:15], s61 offen offset:3072 sc1 lds
    s_add_u32 m0, s64, 4096
    s_add_u32 s61, s61, 229376
    buffer_load_dwordx4 v3, s[12:15], s47 offen offset:0 sc1 lds
    buffer_load_dwordx4 v3, s[12:15], s47 offen offset:1024 sc1 lds
    buffer_load_dwordx4 v3, s[12:15], s47 offen offset:2048 sc1 lds
    s_xor_b32 s64, s64, 0x10000
L_g_dp_146_d:
    s_bitcmp1_b32 s67, 0
    s_cbranch_scc0 L_g_nep_142
    s_waitcnt lgkmcnt(0)
    v_add_f32 v80, v80, v16
    v_add_f32 v81, v81, v17
    v_add_f32 v82, v82, v18
    v_add_f32 v83, v83, v19
    v_add_f32 v84, v84, v20
    v_add_f32 v85, v85, v21
    v_add_f32 v86, v86, v22
    v_add_f32 v87, v87, v23
    v_add_f32 v88, v88, v24
    v_add_f32 v89, v89, v25
    v_add_f32 v90, v90, v26
    v_add_f32 v91, v91, v27
    v_add_f32 v92, v92, v28
    v_add_f32 v93, v93, v29
    v_add_f32 v94, v94, v30
    v_add_f32 v95, v95, v31
    v_cvt_pk_bf16_f32 v104, v80, v81
    v_cvt_pk_bf16_f32 v105, v82, v83
    v_cvt_pk_bf16_f32 v106, v84, v85
    v_cvt_pk_bf16_f32 v107, v86, v87
    s_nop 1
    v_permlane16_swap_b32 v104, v106
    v_permlane16_swap_b32 v105, v107
    buffer_store_dwordx4 v[104:107], v8, s[12:15], s63 offen sc1
    v_cvt_pk_bf16_f32 v108, v88, v89
    v_cvt_pk_bf16_f32 v109, v90, v91
    v_cvt_pk_bf16_f32 v110, v92, v93
    v_cvt_pk_bf16_f32 v111, v94, v95
    s_nop 1
    v_permlane16_swap_b32 v108, v110
    v_permlane16_swap_b32 v109, v111
    buffer_store_dwordx4 v[108:111], v9, s[12:15], s63 offen sc1
    s_add_u32 s63, s63, 262144
L_g_nep_142:
    s_cmp_lg_u32 s65, 0
    s_cbranch_scc1 L_g_nw1_143
    ds_read_b128 v[32:35], v4 offset:0
    ds_read_b128 v[36:39], v4 offset:256
    ds_read_b128 v[40:43], v4 offset:2048
    ds_read_b128 v[44:47], v4 offset:2304
    ds_read_b128 v[48:51], v4 offset:4096
    ds_read_b128 v[52:55], v4 offset:4352
    ds_read_b128 v[56:59], v4 offset:6144
    ds_read_b128 v[60:63], v4 offset:6400
    s_barrier
L_g_jn_145:
    s_setprio 1
    s_waitcnt lgkmcnt(6)
    v_mfma_f32_16x16x32_bf16 v[16:19], v[32:35], a[0:3], 0
    ds_read_b32 v14, v15
    v_mfma_f32_16x16x32_bf16 v[20:23], v[32:35], a[4:7], 0
    ds_read_b128 v[32:35], v4 offset:8192
    v_mfma_f32_16x16x32_bf16 v[28:31], v[36:39], a[4:7], 0
    v_mfma_f32_16x16x32_bf16 v[24:27], v[36:39], a[0:3], 0
    ds_read_b128 v[36:39], v4 offset:8448
    s_waitcnt lgkmcnt(6)
    v_mfma_f32_16x16x32_bf16 v[16:19], v[40:43], a[8:11], v[16:19]
    v_mfma_f32_16x16x32_bf16 v[20:23], v[40:43], a[12:15], v[20:23]
    ds_read_b128 v[40:43], v4 offset:10240
    v_mfma_f32_16x16x32_bf16 v[28:31], v[44:47], a[12:15], v[28:31]
    v_mfma_f32_16x16x32_bf16 v[24:27], v[44:47], a[8:11], v[24:27]
    ds_read_b128 v[44:47], v4 offset:10496
    s_waitcnt lgkmcnt(6)
    v_mfma_f32_16x16x32_bf16 v[16:19], v[48:51], a[16:19], v[16:19]
    v_mfma_f32_16x16x32_bf16 v[20:23], v[48:51], a[20:23], v[20:23]
    ds_read_b128 v[48:51], v4 offset:12288
    v_mfma_f32_16x16x32_bf16 v[28:31], v[52:55], a[20:23], v[28:31]
    v_mfma_f32_16x16x32_bf16 v[24:27], v[52:55], a[16:19], v[24:27]
    ds_read_b128 v[52:55], v4 offset:12544
    s_waitcnt lgkmcnt(6)
    v_mfma_f32_16x16x32_bf16 v[16:19], v[56:59], a[24:27], v[16:19]
    v_mfma_f32_16x16x32_bf16 v[20:23], v[56:59], a[28:31], v[20:23]
    ds_read_b128 v[56:59], v4 offset:14336
    v_mfma_f32_16x16x32_bf16 v[28:31], v[60:63], a[28:31], v[28:31]
    v_mfma_f32_16x16x32_bf16 v[24:27], v[60:63], a[24:27], v[24:27]
    ds_read_b128 v[60:63], v4 offset:14592
    s_waitcnt lgkmcnt(6)
    v_mfma_f32_16x16x32_bf16 v[16:19], v[32:35], a[32:35], v[16:19]
    v_mfma_f32_16x16x32_bf16 v[20:23], v[32:35], a[36:39], v[20:23]
    ds_read_b128 v[32:35], v4 offset:16384
    v_mfma_f32_16x16x32_bf16 v[28:31], v[36:39], a[36:39], v[28:31]
    v_mfma_f32_16x16x32_bf16 v[24:27], v[36:39], a[32:35], v[24:27]
    ds_read_b128 v[36:39], v4 offset:16640
    s_waitcnt lgkmcnt(6)
    v_mfma_f32_16x16x32_bf16 v[16:19], v[40:43], a[40:43], v[16:19]
    v_mfma_f32_16x16x32_bf16 v[20:23], v[40:43], a[44:47], v[20:23]
    ds_read_b128 v[40:43], v4 offset:18432
    v_mfma_f32_16x16x32_bf16 v[28:31], v[44:47], a[44:47], v[28:31]
    v_mfma_f32_16x16x32_bf16 v[24:27], v[44:47], a[40:43], v[24:27]
    ds_read_b128 v[44:47], v4 offset:18688
    s_waitcnt lgkmcnt(6)
    v_mfma_f32_16x16x32_bf16 v[16:19], v[48:51], a[48:51], v[16:19]
    v_mfma_f32_16x16x32_bf16 v[20:23], v[48:51], a[52:55], v[20:23]
    ds_read_b128 v[48:51], v4 offset:20480
    v_mfma_f32_16x16x32_bf16 v[28:31], v[52:55], a[52:55], v[28:31]
    v_mfma_f32_16x16x32_bf16 v[24:27], v[52:55], a[48:51], v[24:27]
    ds_read_b128 v[52:55], v4 offset:20736
    s_waitcnt lgkmcnt(6)
    v_mfma_f32_16x16x32_bf16 v[16:19], v[56:59], a[56:59], v[16:19]
    v_mfma_f32_16x16x32_bf16 v[20:23], v[56:59], a[60:63], v[20:23]
    ds_read_b128 v[56:59], v4 offset:22528
    v_mfma_f32_16x16x32_bf16 v[28:31], v[60:63], a[60:63], v[28:31]
    v_mfma_f32_16x16x32_bf16 v[24:27], v[60:63], a[56:59], v[24:27]
    ds_read_b128 v[60:63], v4 offset:22784
    s_waitcnt lgkmcnt(6)
    v_mfma_f32_16x16x32_bf16 v[16:19], v[32:35], a[64:67], v[16:19]
    v_mfma_f32_16x16x32_bf16 v[20:23], v[32:35], a[68:71], v[20:23]
    ds_read_b128 v[32:35], v4 offset:24576
    v_mfma_f32_16x16x32_bf16 v[28:31], v[36:39], a[68:71], v[28:31]
    v_mfma_f32_16x16x32_bf16 v[24:27], v[36:39], a[64:67], v[24:27]
    ds_read_b128 v[36:39], v4 offset:24832
    s_waitcnt lgkmcnt(6)
    v_mfma_f32_16x16x32_bf16 v[16:19], v[40:43], a[72:75], v[16:19]
    v_mfma_f32_16x16x32_bf16 v[20:23], v[40:43], a[76:79], v[20:23]
    ds_read_b128 v[40:43], v4 offset:26624
    v_mfma_f32_16x16x32_bf16 v[28:31], v[44:47], a[76:79], v[28:31]
    v_mfma_f32_16x16x32_bf16 v[24:27], v[44:47], a[72:75], v[24:27]
    ds_read_b128 v[44:47], v4 offset:26880
    s_waitcnt lgkmcnt(6)
    v_mfma_f32_16x16x32_bf16 v[16:19], v[48:51], a[80:83], v[16:19]
    v_mfma_f32_16x16x32_bf16 v[20:23], v[48:51], a[84:87], v[20:23]
    v_mfma_f32_16x16x32_bf16 v[28:31], v[52:55], a[84:87], v[28:31]
    v_mfma_f32_16x16x32_bf16 v[24:27], v[52:55], a[80:83], v[24:27]
    s_waitcnt lgkmcnt(4)
    v_mfma_f32_16x16x32_bf16 v[16:19], v[56:59], a[88:91], v[16:19]
    v_mfma_f32_16x16x32_bf16 v[20:23], v[56:59], a[92:95], v[20:23]
    v_mfma_f32_16x16x32_bf16 v[28:31], v[60:63], a[92:95], v[28:31]
    v_mfma_f32_16x16x32_bf16 v[24:27], v[60:63], a[88:91], v[24:27]
    s_waitcnt lgkmcnt(2)
    v_mfma_f32_16x16x32_bf16 v[16:19], v[32:35], a[96:99], v[16:19]
    v_mfma_f32_16x16x32_bf16 v[20:23], v[32:35], a[100:103], v[20:23]
    v_mfma_f32_16x16x32_bf16 v[28:31], v[36:39], a[100:103], v[28:31]
    v_mfma_f32_16x16x32_bf16 v[24:27], v[36:39], a[96:99], v[24:27]
    s_waitcnt lgkmcnt(0)
    v_mfma_f32_16x16x32_bf16 v[16:19], v[40:43], a[104:107], v[16:19]
    v_mfma_f32_16x16x32_bf16 v[20:23], v[40:43], a[108:111], v[20:23]
    v_mfma_f32_16x16x32_bf16 v[28:31], v[44:47], a[108:111], v[28:31]
    v_mfma_f32_16x16x32_bf16 v[24:27], v[44:47], a[104:107], v[24:27]
    v_xor_b32 v4, 0x10000, v4
    s_setprio 0
    s_waitcnt vmcnt(0)
    v_readfirstlane_b32 s66, v14
    s_lshl_b32 s67, s67, 1
    s_or_b32 s67, s67, 1
    s_add_u32 s60, s60, 1
    s_cmp_gt_u32 s66, s60
    s_cbranch_scc1 L_g_loop1_125
    s_barrier
    ds_read_b32 v14, v15 offset:20
    ds_read_b128 v[80:83], v5 offset:0
    ds_read_b128 v[84:87], v5 offset:1024
    ds_read_b128 v[88:91], v5 offset:2048
    ds_read_b128 v[92:95], v5 offset:3072
    s_waitcnt lgkmcnt(4)
    v_readfirstlane_b32 s66, v14
    s_barrier
    s_mov_b32 s69, 0
    s_cmp_gt_u32 s62, s60
    s_cbranch_scc1 L_g_nd_147
    s_cmp_ge_u32 s62, s66
    s_cbranch_scc1 L_g_nd_147
    s_add_u32 s47, s61, 4096
    s_add_u32 m0, s64, 0
    s_nop 0
    buffer_load_dwordx4 v3, s[12:15], s61 offen offset:0 sc1 lds
    buffer_load_dwordx4 v3, s[12:15], s61 offen offset:1024 sc1 lds
    buffer_load_dwordx4 v3, s[12:15], s61 offen offset:2048 sc1 lds
    buffer_load_dwordx4 v3, s[12:15], s61 offen offset:3072 sc1 lds
    s_add_u32 m0, s64, 4096
    s_nop 0
    buffer_load_dwordx4 v3, s[12:15], s47 offen offset:0 sc1 lds
    buffer_load_dwordx4 v3, s[12:15], s47 offen offset:1024 sc1 lds
    buffer_load_dwordx4 v3, s[12:15], s47 offen offset:2048 sc1 lds
    s_add_u32 s61, s61, 229376
    s_add_u32 s62, s62, 1
    s_xor_b32 s64, s64, 0x10000
    s_mov_b32 s69, 1
L_g_nd_147:
    s_sub_u32 s59, s60, 1
    s_waitcnt lgkmcnt(3)
    v_add_f32 v80, v80, v16
    v_add_f32 v81, v81, v17
    v_add_f32 v82, v82, v18
    v_add_f32 v83, v83, v19
    s_waitcnt lgkmcnt(2)
    v_add_f32 v84, v84, v20
    v_add_f32 v85, v85, v21
    v_add_f32 v86, v86, v22
    v_add_f32 v87, v87, v23
    s_waitcnt lgkmcnt(1)
    v_add_f32 v88, v88, v24
    v_add_f32 v89, v89, v25
    v_add_f32 v90, v90, v26
    v_add_f32 v91, v91, v27
    s_waitcnt lgkmcnt(0)
    v_add_f32 v92, v92, v28
    v_add_f32 v93, v93, v29
    v_add_f32 v94, v94, v30
    v_add_f32 v95, v95, v31
    v_cvt_pk_bf16_f32 v104, v80, v81
    v_cvt_pk_bf16_f32 v105, v82, v83
    v_cvt_pk_bf16_f32 v106, v84, v85
    v_cvt_pk_bf16_f32 v107, v86, v87
    s_nop 1
    v_permlane16_swap_b32 v104, v106
    v_permlane16_swap_b32 v105, v107
    buffer_store_dwordx4 v[104:107], v8, s[12:15], s63 offen sc1
    v_cvt_pk_bf16_f32 v108, v88, v89
    v_cvt_pk_bf16_f32 v109, v90, v91
    v_cvt_pk_bf16_f32 v110, v92, v93
    v_cvt_pk_bf16_f32 v111, v94, v95
    s_nop 1
    v_permlane16_swap_b32 v108, v110
    v_permlane16_swap_b32 v109, v111
    buffer_store_dwordx4 v[108:111], v9, s[12:15], s63 offen sc1
    s_add_u32 s63, s63, 262144
    s_mov_b32 s67, 0
    s_mov_b32 s71, 1
    s_cmp_gt_u32 s66, s60
    s_cbranch_scc1 L_g_g1r_123
    v_mov_b32 v10, 1
    s_mov_b64 exec, 1
    s_waitcnt vmcnt(0)
    ds_add_rtn_u32 v10, v15, v10 offset:4
    s_waitcnt lgkmcnt(0)
    v_readfirstlane_b32 s46, v10
    s_mov_b64 exec, -1
    s_mov_b32 s71, 0
    s_sub_u32 s59, s60, 1
    s_cmp_lg_u32 s46, s68
    s_cbranch_scc1 L_g_df_148
    v_mov_b32 v10, s59
    v_add_u32 v10, 1, v10
    v_mov_b32 v11, 0
    s_mov_b64 exec, 1
    buffer_store_dword v10, v11, s[12:15], s52 offen sc1
    s_mov_b64 exec, -1
L_sf_149:
L_g_df_148:
    s_add_u32 s68, s68, 4
    s_cmp_gt_u32 s66, s60
    s_cbranch_scc1 L_g_g1r_123
L_g_tail_126:
    s_cmp_lt_u32 s60, s75
    s_cbranch_scc1 L_g_restart_121
    s_waitcnt vmcnt(0)
    s_barrier
    s_branch L_c_done_1
L_g_h1_136:
    s_add_u32 s54, s60, 1
    v_add_u32 v12, s54, v113
    v_subrev_u32 v13, 60, v12
    v_subrev_u32 v11, 63, v12
    v_ashrrev_i32 v13, 31, v13
    v_ashrrev_i32 v11, 31, v11
    v_add3_u32 v13, v13, v11, 2
    v_lshl_add_u32 v13, v13, 16, v7
    buffer_load_dword v11, v13, s[12:15], 0 offen sc1
    s_branch L_g_h1_136_b
L_g_h2_137:
    s_waitcnt vmcnt(0)
    v_cmp_ge_u32 vcc, v12, v11
    s_nop 0
    s_ff1_i32_b64 s46, vcc
    s_lshr_b32 s46, s46, 4
    s_min_u32 s46, s46, 4
    s_add_u32 s46, s46, s54
    s_min_u32 s46, s46, s75
    v_mov_b32 v118, s46
    s_branch L_g_h2_137_b
L_g_dp_138_l:
    s_cmp_ge_u32 s62, s66
    s_cbranch_scc1 L_g_dp_138_d
    s_mov_b32 s65, 1
    s_add_u32 s47, s61, 4096
    s_mov_b32 m0, s64
    s_add_u32 s62, s62, 1
    buffer_load_dwordx4 v3, s[12:15], s61 offen offset:0 sc1 lds
    buffer_load_dwordx4 v3, s[12:15], s61 offen offset:1024 sc1 lds
    buffer_load_dwordx4 v3, s[12:15], s61 offen offset:2048 sc1 lds
    buffer_load_dwordx4 v3, s[12:15], s61 offen offset:3072 sc1 lds
    s_add_u32 m0, s64, 4096
    s_add_u32 s61, s61, 229376
    buffer_load_dwordx4 v3, s[12:15], s47 offen offset:0 sc1 lds
    buffer_load_dwordx4 v3, s[12:15], s47 offen offset:1024 sc1 lds
    buffer_load_dwordx4 v3, s[12:15], s47 offen offset:2048 sc1 lds
    s_xor_b32 s64, s64, 0x10000
    s_branch L_g_dp_138_a
L_g_nw_134:
    s_waitcnt vmcnt(0) lgkmcnt(0)
    s_cmp_lg_u32 s44, 0
    s_cbranch_scc1 L_g_nl_150
    s_cmp_lt_u32 s66, s75
    s_cselect_b32 s81, 1, 2
L_g_nl_150:
    s_branch L_g_loop0_124_l
L_g_nfl_141:
    s_cmp_eq_u32 s71, 0
    s_cbranch_scc1 L_g_nfl_141_d
    v_mov_b32 v10, 1
    s_mov_b64 exec, 1
    s_waitcnt vmcnt(0)
    ds_add_rtn_u32 v10, v15, v10 offset:4
    s_waitcnt lgkmcnt(0)
    v_readfirstlane_b32 s46, v10
    s_mov_b64 exec, -1
    s_mov_b32 s71, 0
    s_sub_u32 s59, s60, 1
    s_cmp_lg_u32 s46, s68
    s_cbranch_scc1 L_g_df_151
    v_mov_b32 v10, s59
    v_add_u32 v10, 1, v10
    v_mov_b32 v11, 0
    s_mov_b64 exec, 1
    buffer_store_dword v10, v11, s[12:15], s52 offen sc1
    s_mov_b64 exec, -1
L_sf_152:
L_g_df_151:
    s_add_u32 s68, s68, 4
    s_mov_b32 s65, 2
    s_branch L_g_nfl_141_d
L_g_dp_146_l:
    s_cmp_ge_u32 s62, s66
    s_cbranch_scc1 L_g_dp_146_d
    s_or_b32 s65, s65, 1
    s_add_u32 s47, s61, 4096
    s_mov_b32 m0, s64
    s_add_u32 s62, s62, 1
    buffer_load_dwordx4 v3, s[12:15], s61 offen offset:0 sc1 lds
    buffer_load_dwordx4 v3, s[12:15], s61 offen offset:1024 sc1 lds
    buffer_load_dwordx4 v3, s[12:15], s61 offen offset:2048 sc1 lds
    buffer_load_dwordx4 v3, s[12:15], s61 offen offset:3072 sc1 lds
    s_add_u32 m0, s64, 4096
    s_add_u32 s61, s61, 229376
    buffer_load_dwordx4 v3, s[12:15], s47 offen offset:0 sc1 lds
    buffer_load_dwordx4 v3, s[12:15], s47 offen offset:1024 sc1 lds
    buffer_load_dwordx4 v3, s[12:15], s47 offen offset:2048 sc1 lds
    s_xor_b32 s64, s64, 0x10000
    s_branch L_g_dp_146_a
L_g_nw1_143:
    s_cmp_eq_u32 s65, 2
    s_cbranch_scc1 L_g_nw1_143_w
    s_waitcnt vmcnt(0)
L_g_nw1_143_w:
    s_barrier
    ds_read_b128 v[32:35], v4 offset:0
    ds_read_b128 v[36:39], v4 offset:256
    ds_read_b128 v[40:43], v4 offset:2048
    ds_read_b128 v[44:47], v4 offset:2304
    ds_read_b128 v[48:51], v4 offset:4096
    ds_read_b128 v[52:55], v4 offset:4352
    ds_read_b128 v[56:59], v4 offset:6144
    ds_read_b128 v[60:63], v4 offset:6400
    s_branch L_g_jn_145
L_w_wo_12:
    s_load_dwordx2 s[4:5], s[0:1], 40
    s_load_dwordx2 s[6:7], s[0:1], 72
    s_and_b32 s50, s44, 3
    s_lshr_b32 s51, s44, 2
    s_waitcnt lgkmcnt(0)
    s_mov_b32 s24, s4
    s_and_b32 s25, s5, 0xffff
    s_mov_b32 s26, 0x800000
    s_mov_b32 s27, 0x00020000
    v_lshrrev_b32 v3, 4, v1
    v_and_b32 v4, 15, v1
    v_lshlrev_b32 v5, 2, v3
    v_xor_b32 v4, v4, v5
    v_mul_u32_u24 v3, 2048, v3
    v_lshl_add_u32 v3, v4, 4, v3
    s_mul_i32 s46, s51, 512
    s_mul_i32 s47, s50, 16
    s_add_u32 s46, s46, s47
    s_mul_i32 s47, s42, 1024
    s_add_u32 s46, s46, s47
    s_mul_i32 s46, s46, 2048
    s_lshl_b32 s47, s43, 8
    s_add_u32 s46, s46, s47
    s_lshl_b32 s45, s51, 16
    s_mul_i32 s47, s50, 4096
    s_add_u32 s45, s45, s47
    v_bfe_u32 v4, v1, 2, 2
    v_bfe_u32 v5, v1, 4, 1
    v_lshlrev_b32 v5, 1, v5
    v_bfe_u32 v6, v1, 1, 1
    v_add_u32 v5, v5, v6
    s_lshl_b32 s47, s50, 2
    v_add_u32 v5, s47, v5
    v_lshlrev_b32 v6, 2, v4
    v_xor_b32 v5, v5, v6
    v_lshlrev_b32 v5, 4, v5
    v_lshl_add_u32 v5, v4, 8, v5
    v_bfe_u32 v6, v1, 0, 1
    v_lshl_add_u32 v5, v6, 3, v5
    v_lshrrev_b32 v6, 5, v1
    v_mul_u32_u24 v6, 1024, v6
    v_add_u32 v5, v5, v6
    s_lshl_b32 s47, s51, 16
    v_add_u32 v5, s47, v5
    v_bfe_u32 v4, v1, 2, 2
    v_xor_b32 v5, s50, v4
    v_lshlrev_b32 v5, 6, v5
    v_lshl_add_u32 v5, v4, 8, v5
    v_and_b32 v6, 3, v1
    v_lshl_add_u32 v5, v6, 3, v5
    v_lshrrev_b32 v6, 4, v1
    v_lshl_add_u32 v5, v6, 10, v5
    v_lshrrev_b32 v6, 5, v1
    s_lshl_b32 s47, s51, 16
    v_add_u32 v5, s47, v5
    s_add_u32 m0, s45, 0
    s_add_u32 s47, s46, 0x0
    buffer_load_dwordx4 v3, s[24:27], s47 offen  lds
    s_add_u32 m0, s45, 1024
    s_add_u32 s47, s46, 0x2000
    buffer_load_dwordx4 v3, s[24:27], s47 offen  lds
    s_add_u32 m0, s45, 2048
    s_add_u32 s47, s46, 0x4000
    buffer_load_dwordx4 v3, s[24:27], s47 offen  lds
    s_add_u32 m0, s45, 3072
    s_add_u32 s47, s46, 0x6000
    buffer_load_dwordx4 v3, s[24:27], s47 offen  lds
    s_add_u32 m0, s45, 16384
    s_add_u32 s47, s46, 0x20000
    buffer_load_dwordx4 v3, s[24:27], s47 offen  lds
    s_add_u32 m0, s45, 17408
    s_add_u32 s47, s46, 0x22000
    buffer_load_dwordx4 v3, s[24:27], s47 offen  lds
    s_add_u32 m0, s45, 18432
    s_add_u32 s47, s46, 0x24000
    buffer_load_dwordx4 v3, s[24:27], s47 offen  lds
    s_add_u32 m0, s45, 19456
    s_add_u32 s47, s46, 0x26000
    buffer_load_dwordx4 v3, s[24:27], s47 offen  lds
    s_add_u32 m0, s45, 32768
    s_add_u32 s47, s46, 0x40000
    buffer_load_dwordx4 v3, s[24:27], s47 offen  lds
    s_add_u32 m0, s45, 33792
    s_add_u32 s47, s46, 0x42000
    buffer_load_dwordx4 v3, s[24:27], s47 offen  lds
    s_add_u32 m0, s45, 34816
    s_add_u32 s47, s46, 0x44000
    buffer_load_dwordx4 v3, s[24:27], s47 offen  lds
    s_add_u32 m0, s45, 35840
    s_add_u32 s47, s46, 0x46000
    buffer_load_dwordx4 v3, s[24:27], s47 offen  lds
    s_add_u32 m0, s45, 49152
    s_add_u32 s47, s46, 0x60000
    buffer_load_dwordx4 v3, s[24:27], s47 offen  lds
    s_add_u32 m0, s45, 50176
    s_add_u32 s47, s46, 0x62000
    buffer_load_dwordx4 v3, s[24:27], s47 offen  lds
    s_add_u32 m0, s45, 51200
    s_add_u32 s47, s46, 0x64000
    buffer_load_dwordx4 v3, s[24:27], s47 offen  lds
    s_add_u32 m0, s45, 52224
    s_add_u32 s47, s46, 0x66000
    buffer_load_dwordx4 v3, s[24:27], s47 offen  lds
    s_waitcnt vmcnt(12) lgkmcnt(0)
    s_barrier
    ds_read_b64_tr_b16 a[0:1], v5 offset:0
    ds_read_b64_tr_b16 a[2:3], v5 offset:4096
    ds_read_b64_tr_b16 a[4:5], v5 offset:32
    ds_read_b64_tr_b16 a[6:7], v5 offset:4128
    ds_read_b64_tr_b16 a[8:9], v5 offset:8192
    ds_read_b64_tr_b16 a[10:11], v5 offset:12288
    ds_read_b64_tr_b16 a[12:13], v5 offset:8224
    ds_read_b64_tr_b16 a[14:15], v5 offset:12320
    s_waitcnt vmcnt(8) lgkmcnt(0)
    s_barrier
    s_add_u32 m0, s45, 0
    s_add_u32 s47, s46, 0x80000
    buffer_load_dwordx4 v3, s[24:27], s47 offen  lds
    s_add_u32 m0, s45, 1024
    s_add_u32 s47, s46, 0x82000
    buffer_load_dwordx4 v3, s[24:27], s47 offen  lds
    s_add_u32 m0, s45, 2048
    s_add_u32 s47, s46, 0x84000
    buffer_load_dwordx4 v3, s[24:27], s47 offen  lds
    s_add_u32 m0, s45, 3072
    s_add_u32 s47, s46, 0x86000
    buffer_load_dwordx4 v3, s[24:27], s47 offen  lds
    ds_read_b64_tr_b16 a[16:17], v5 offset:16384
    ds_read_b64_tr_b16 a[18:19], v5 offset:20480
    ds_read_b64_tr_b16 a[20:21], v5 offset:16416
    ds_read_b64_tr_b16 a[22:23], v5 offset:20512
    ds_read_b64_tr_b16 a[24:25], v5 offset:24576
    ds_read_b64_tr_b16 a[26:27], v5 offset:28672
    ds_read_b64_tr_b16 a[28:29], v5 offset:24608
    ds_read_b64_tr_b16 a[30:31], v5 offset:28704
    s_waitcnt vmcnt(8) lgkmcnt(0)
    s_barrier
    s_add_u32 m0, s45, 16384
    s_add_u32 s47, s46, 0xa0000
    buffer_load_dwordx4 v3, s[24:27], s47 offen  lds
    s_add_u32 m0, s45, 17408
    s_add_u32 s47, s46, 0xa2000
    buffer_load_dwordx4 v3, s[24:27], s47 offen  lds
    s_add_u32 m0, s45, 18432
    s_add_u32 s47, s46, 0xa4000
    buffer_load_dwordx4 v3, s[24:27], s47 offen  lds
    s_add_u32 m0, s45, 19456
    s_add_u32 s47, s46, 0xa6000
    buffer_load_dwordx4 v3, s[24:27], s47 offen  lds
    ds_read_b64_tr_b16 a[32:33], v5 offset:32768
    ds_read_b64_tr_b16 a[34:35], v5 offset:36864
    ds_read_b64_tr_b16 a[36:37], v5 offset:32800
    ds_read_b64_tr_b16 a[38:39], v5 offset:36896
    ds_read_b64_tr_b16 a[40:41], v5 offset:40960
    ds_read_b64_tr_b16 a[42:43], v5 offset:45056
    ds_read_b64_tr_b16 a[44:45], v5 offset:40992
    ds_read_b64_tr_b16 a[46:47], v5 offset:45088
    s_waitcnt vmcnt(8) lgkmcnt(0)
    s_barrier
    s_add_u32 m0, s45, 32768
    s_add_u32 s47, s46, 0xc0000
    buffer_load_dwordx4 v3, s[24:27], s47 offen  lds
    s_add_u32 m0, s45, 33792
    s_add_u32 s47, s46, 0xc2000
    buffer_load_dwordx4 v3, s[24:27], s47 offen  lds
    s_add_u32 m0, s45, 34816
    s_add_u32 s47, s46, 0xc4000
    buffer_load_dwordx4 v3, s[24:27], s47 offen  lds
    s_add_u32 m0, s45, 35840
    s_add_u32 s47, s46, 0xc6000
    buffer_load_dwordx4 v3, s[24:27], s47 offen  lds
    ds_read_b64_tr_b16 a[48:49], v5 offset:49152
    ds_read_b64_tr_b16 a[50:51], v5 offset:53248
    ds_read_b64_tr_b16 a[52:53], v5 offset:49184
    ds_read_b64_tr_b16 a[54:55], v5 offset:53280
    ds_read_b64_tr_b16 a[56:57], v5 offset:57344
    ds_read_b64_tr_b16 a[58:59], v5 offset:61440
    ds_read_b64_tr_b16 a[60:61], v5 offset:57376
    ds_read_b64_tr_b16 a[62:63], v5 offset:61472
    s_waitcnt vmcnt(8) lgkmcnt(0)
    s_barrier
    s_add_u32 m0, s45, 49152
    s_add_u32 s47, s46, 0xe0000
    buffer_load_dwordx4 v3, s[24:27], s47 offen  lds
    s_add_u32 m0, s45, 50176
    s_add_u32 s47, s46, 0xe2000
    buffer_load_dwordx4 v3, s[24:27], s47 offen  lds
    s_add_u32 m0, s45, 51200
    s_add_u32 s47, s46, 0xe4000
    buffer_load_dwordx4 v3, s[24:27], s47 offen  lds
    s_add_u32 m0, s45, 52224
    s_add_u32 s47, s46, 0xe6000
    buffer_load_dwordx4 v3, s[24:27], s47 offen  lds
    ds_read_b64_tr_b16 a[64:65], v5 offset:0
    ds_read_b64_tr_b16 a[66:67], v5 offset:4096
    ds_read_b64_tr_b16 a[68:69], v5 offset:32
    ds_read_b64_tr_b16 a[70:71], v5 offset:4128
    ds_read_b64_tr_b16 a[72:73], v5 offset:8192
    ds_read_b64_tr_b16 a[74:75], v5 offset:12288
    ds_read_b64_tr_b16 a[76:77], v5 offset:8224
    ds_read_b64_tr_b16 a[78:79], v5 offset:12320
    s_waitcnt vmcnt(8) lgkmcnt(0)
    s_barrier
    ds_read_b64_tr_b16 a[80:81], v5 offset:16384
    ds_read_b64_tr_b16 a[82:83], v5 offset:20480
    ds_read_b64_tr_b16 a[84:85], v5 offset:16416
    ds_read_b64_tr_b16 a[86:87], v5 offset:20512
    ds_read_b64_tr_b16 a[88:89], v5 offset:24576
    ds_read_b64_tr_b16 a[90:91], v5 offset:28672
    ds_read_b64_tr_b16 a[92:93], v5 offset:24608
    ds_read_b64_tr_b16 a[94:95], v5 offset:28704
    s_waitcnt vmcnt(4) lgkmcnt(0)
    s_barrier
    ds_read_b64_tr_b16 a[96:97], v5 offset:32768
    ds_read_b64_tr_b16 a[98:99], v5 offset:36864
    ds_read_b64_tr_b16 a[100:101], v5 offset:32800
    ds_read_b64_tr_b16 a[102:103], v5 offset:36896
    ds_read_b64_tr_b16 a[104:105], v5 offset:40960
    ds_read_b64_tr_b16 a[106:107], v5 offset:45056
    ds_read_b64_tr_b16 a[108:109], v5 offset:40992
    ds_read_b64_tr_b16 a[110:111], v5 offset:45088
    s_waitcnt vmcnt(0) lgkmcnt(0)
    s_barrier
    ds_read_b64_tr_b16 a[112:113], v5 offset:49152
    ds_read_b64_tr_b16 a[114:115], v5 offset:53248
    ds_read_b64_tr_b16 a[116:117], v5 offset:49184
    ds_read_b64_tr_b16 a[118:119], v5 offset:53280
    ds_read_b64_tr_b16 a[120:121], v5 offset:57344
    ds_read_b64_tr_b16 a[122:123], v5 offset:61440
    ds_read_b64_tr_b16 a[124:125], v5 offset:57376
    ds_read_b64_tr_b16 a[126:127], v5 offset:61472
    s_waitcnt lgkmcnt(0)
    s_barrier
    s_load_dwordx2 s[8:9], s[0:1], 64
    s_load_dwordx2 s[10:11], s[0:1], 80
    s_lshl_b32 s46, s42, 3
    s_add_u32 s46, s46, s43
    s_mul_i32 s46, s46, 229376
    s_mul_i32 s47, s44, 28672
    s_add_u32 s46, s46, s47
    v_lshlrev_b32 v10, 7, v1
    s_waitcnt lgkmcnt(0)
    s_mov_b32 s28, s8
    s_and_b32 s29, s9, 0xffff
    s_mov_b32 s30, 0x700000
    s_mov_b32 s31, 0x00020000
    s_mov_b32 s32, s10
    s_and_b32 s33, s11, 0xffff
    s_mov_b32 s34, 0x700000
    s_mov_b32 s35, 0x00020000
    s_add_u32 s47, s46, 0
    buffer_load_dword v120, v10, s[28:31], s47 offen
    s_add_u32 s47, s46, 8192
    buffer_load_dword v121, v10, s[28:31], s47 offen
    s_add_u32 s47, s46, 16384
    buffer_load_dword v122, v10, s[28:31], s47 offen
    s_add_u32 s47, s46, 20480
    buffer_load_dword v123, v10, s[28:31], s47 offen
    v_lshlrev_b32 v2, 4, v1
    s_mul_i32 s64, s44, 8192
    s_add_u32 s46, s64, 0x5000000
    s_mul_i32 s47, s42, 65536
    s_add_u32 s46, s46, s47
    v_add_u32 v3, s46, v2
    s_mul_i32 s46, s51, 32768
    v_add_u32 v4, s46, v2
    v_and_b32 v6, 15, v1
    v_lshlrev_b32 v6, 4, v6
    v_lshrrev_b32 v7, 4, v1
    v_lshl_add_u32 v6, v7, 9, v6
    v_add_u32 v4, s46, v6
    s_lshl_b32 s46, s50, 12
    s_add_u32 s46, s46, 131072
    v_add_u32 v5, s46, v2
    v_and_b32 v7, 7, v1
    v_lshlrev_b32 v7, 9, v7
    s_lshl_b32 s46, s42, 12
    s_add_u32 s46, s46, 0x102000
    v_add_u32 v7, s46, v7
    s_lshl_b32 s46, s42, 16
    s_lshl_b32 s47, s43, 11
    s_add_u32 s46, s46, s47
    s_lshl_b32 s47, s50, 9
    s_add_u32 s46, s46, s47
    s_add_u32 s46, s46, 0x9000000
    v_and_b32 v8, 31, v1
    v_lshlrev_b32 v8, 4, v8
    v_lshrrev_b32 v9, 5, v1
    v_lshl_add_u32 v8, v9, 14, v8
    v_add_u32 v8, s46, v8
    v_add_u32 v9, 0x8000, v8
    s_lshl_b32 s52, s43, 9
    s_lshl_b32 s47, s42, 7
    s_add_u32 s52, s52, s47
    s_add_u32 s52, s52, 0x107400
    s_add_u32 s52, s52, s76
    s_mul_i32 s46, s43, 8192
    s_add_u32 s46, s46, 0x5000000
    s_mul_i32 s47, s42, 65536
    s_add_u32 s46, s46, s47
    v_min_u32 v116, 63, v1
    v_lshlrev_b32 v116, 7, v116
    v_add_u32 v116, s46, v116
    s_mov_b32 s60, s74
    s_mul_i32 s61, s74, 262144
    s_mov_b32 s62, s74
    s_mul_i32 s63, s74, 262144
    s_mov_b32 s67, 0
    s_mov_b32 s68, 3
    s_mov_b32 s71, 0
    v_mov_b32 v15, 147456
    v_mov_b32 v14, 0
    ds_write_b32 v15, v14 offset:4
    ds_write_b32 v15, v14 offset:12
    ds_write_b32 v15, v14 offset:16
    v_mov_b32 v114, 1
    v_mov_b32 v115, 0
    s_mov_b32 s81, 0
    s_lshl_b32 s46, s44, 5
    v_add_u32 v119, s46, v15
    v_lshrrev_b32 v113, 4, v1
    s_mov_b32 s72, 0
L_g_restart_153:
    s_cmp_lg_u32 s44, 0
    s_cbranch_scc1 L_g_nsp_154
    s_mov_b32 s70, 0
L_g_sp_160:
    s_add_u32 s54, s60, 0
    v_add_u32 v12, s54, v113
    v_and_b32 v13, 3, v12
    v_lshl_add_u32 v13, v13, 7, v7
    buffer_load_dword v11, v13, s[12:15], 0 offen sc1
    s_waitcnt vmcnt(0)
    v_cmp_ge_u32 vcc, v12, v11
    s_add_u32 s70, s70, 1
    s_and_b32 s46, vcc_lo, 0xffff
    s_cbranch_scc0 L_g_sp_160_ok
    s_sleep 3
    s_cmp_lt_u32 s70, 524288
    s_cbranch_scc1 L_g_sp_160
    s_branch L_c_done_1
L_g_sp_160_ok:
    v_cmp_ge_u32 vcc, v12, v11
    s_nop 0
    s_ff1_i32_b64 s46, vcc
    s_lshr_b32 s46, s46, 4
    s_min_u32 s46, s46, 4
    s_add_u32 s46, s46, s54
    s_min_u32 s46, s46, s75
    v_mov_b32 v118, s46
    ds_write_b32 v15, v118 offset:20
L_g_nsp_154:
    s_waitcnt lgkmcnt(0)
    s_barrier
    ds_read_b32 v14, v15 offset:20
    s_waitcnt lgkmcnt(0)
    v_readfirstlane_b32 s66, v14
    s_nop 3
L_g_restart_153_go:
    s_mov_b32 s69, 0
    s_cmp_gt_u32 s62, s60
    s_cbranch_scc1 L_g_nd_161
    s_cmp_ge_u32 s62, s66
    s_cbranch_scc1 L_g_nd_161
    s_add_u32 s47, s61, 4096
    s_add_u32 m0, s64, 0
    s_nop 0
    buffer_load_dwordx4 v3, s[12:15], s61 offen offset:0 sc1 lds
    buffer_load_dwordx4 v3, s[12:15], s61 offen offset:1024 sc1 lds
    buffer_load_dwordx4 v3, s[12:15], s61 offen offset:2048 sc1 lds
    buffer_load_dwordx4 v3, s[12:15], s61 offen offset:3072 sc1 lds
    s_add_u32 m0, s64, 4096
    s_nop 0
    buffer_load_dwordx4 v3, s[12:15], s47 offen offset:0 sc1 lds
    buffer_load_dwordx4 v3, s[12:15], s47 offen offset:1024 sc1 lds
    buffer_load_dwordx4 v3, s[12:15], s47 offen offset:2048 sc1 lds
    buffer_load_dwordx4 v3, s[12:15], s47 offen offset:3072 sc1 lds
    s_add_u32 s61, s61, 262144
    s_add_u32 s62, s62, 1
    s_xor_b32 s64, s64, 0x10000
    s_mov_b32 s69, 1
L_g_nd_161:
    s_cmp_eq_u32 s51, 1
    s_cbranch_scc1 L_g_g1r_155
    s_add_u32 s59, s60, 1
    s_mov_b32 s69, 0
    s_cmp_gt_u32 s62, s59
    s_cbranch_scc1 L_g_nd_162
    s_cmp_ge_u32 s62, s66
    s_cbranch_scc1 L_g_nd_162
    s_add_u32 s47, s61, 4096
    s_add_u32 m0, s64, 0
    s_nop 0
    buffer_load_dwordx4 v3, s[12:15], s61 offen offset:0 sc1 lds
    buffer_load_dwordx4 v3, s[12:15], s61 offen offset:1024 sc1 lds
    buffer_load_dwordx4 v3, s[12:15], s61 offen offset:2048 sc1 lds
    buffer_load_dwordx4 v3, s[12:15], s61 offen offset:3072 sc1 lds
    s_add_u32 m0, s64, 4096
    s_nop 0
    buffer_load_dwordx4 v3, s[12:15], s47 offen offset:0 sc1 lds
    buffer_load_dwordx4 v3, s[12:15], s47 offen offset:1024 sc1 lds
    buffer_load_dwordx4 v3, s[12:15], s47 offen offset:2048 sc1 lds
    buffer_load_dwordx4 v3, s[12:15], s47 offen offset:3072 sc1 lds
    s_add_u32 s61, s61, 262144
    s_add_u32 s62, s62, 1
    s_xor_b32 s64, s64, 0x10000
    s_mov_b32 s69, 1
L_g_nd_162:
    s_cmp_eq_u32 s69, 1
    s_cbranch_scc1 L_g_w0_163
    s_waitcnt vmcnt(0)
L_g_w0_163:
    s_waitcnt vmcnt(8)
    s_cmp_lg_u32 s44, 0
    s_cbranch_scc1 L_g_nl_164
    s_cmp_lt_u32 s66, s75
    s_cselect_b32 s81, 1, 2
L_g_nl_164:
L_g_loop0_156_l:
    s_barrier
    ds_read_b128 v[32:35], v4 offset:0
    ds_read_b128 v[36:39], v4 offset:256
    ds_read_b128 v[40:43], v4 offset:2048
    ds_read_b128 v[44:47], v4 offset:2304
    ds_read_b128 v[48:51], v4 offset:4096
    ds_read_b128 v[52:55], v4 offset:4352
    ds_read_b128 v[56:59], v4 offset:6144
    ds_read_b128 v[60:63], v4 offset:6400
    s_branch L_g_loop0_156_m
.p2align 6
L_g_loop0_156:
    s_barrier
L_g_loop0_156_m:
    s_setprio 2
    s_waitcnt lgkmcnt(6)
    v_mfma_f32_16x16x32_bf16 v[16:19], v[32:35], a[0:3], 0
    v_mfma_f32_16x16x32_bf16 v[20:23], v[32:35], a[4:7], 0
    ds_read_b128 v[32:35], v4 offset:8192
    v_mfma_f32_16x16x32_bf16 v[28:31], v[36:39], a[4:7], 0
    v_mfma_f32_16x16x32_bf16 v[24:27], v[36:39], a[0:3], 0
    ds_read_b128 v[36:39], v4 offset:8448
    s_cmp_eq_u32 s81, 1
    s_cbranch_scc1 L_g_h1_168
L_g_h1_168_b:
    s_waitcnt lgkmcnt(6)
    v_mfma_f32_16x16x32_bf16 v[16:19], v[40:43], a[8:11], v[16:19]
    v_mfma_f32_16x16x32_bf16 v[20:23], v[40:43], a[12:15], v[20:23]
    ds_read_b128 v[40:43], v4 offset:10240
    v_mfma_f32_16x16x32_bf16 v[28:31], v[44:47], a[12:15], v[28:31]
    v_mfma_f32_16x16x32_bf16 v[24:27], v[44:47], a[8:11], v[24:27]
    ds_read_b128 v[44:47], v4 offset:10496
    s_waitcnt lgkmcnt(6)
    v_mfma_f32_16x16x32_bf16 v[16:19], v[48:51], a[16:19], v[16:19]
    v_mfma_f32_16x16x32_bf16 v[20:23], v[48:51], a[20:23], v[20:23]
    ds_read_b128 v[48:51], v4 offset:12288
    v_mfma_f32_16x16x32_bf16 v[28:31], v[52:55], a[20:23], v[28:31]
    v_mfma_f32_16x16x32_bf16 v[24:27], v[52:55], a[16:19], v[24:27]
    ds_read_b128 v[52:55], v4 offset:12544
    s_waitcnt lgkmcnt(6)
    v_mfma_f32_16x16x32_bf16 v[16:19], v[56:59], a[24:27], v[16:19]
    v_mfma_f32_16x16x32_bf16 v[20:23], v[56:59], a[28:31], v[20:23]
    ds_read_b128 v[56:59], v4 offset:14336
    v_mfma_f32_16x16x32_bf16 v[28:31], v[60:63], a[28:31], v[28:31]
    v_mfma_f32_16x16x32_bf16 v[24:27], v[60:63], a[24:27], v[24:27]
    ds_read_b128 v[60:63], v4 offset:14592
    s_waitcnt lgkmcnt(6)
    v_mfma_f32_16x16x32_bf16 v[16:19], v[32:35], a[32:35], v[16:19]
    v_mfma_f32_16x16x32_bf16 v[20:23], v[32:35], a[36:39], v[20:23]
    ds_read_b128 v[32:35], v4 offset:16384
    v_mfma_f32_16x16x32_bf16 v[28:31], v[36:39], a[36:39], v[28:31]
    v_mfma_f32_16x16x32_bf16 v[24:27], v[36:39], a[32:35], v[24:27]
    ds_read_b128 v[36:39], v4 offset:16640
    s_waitcnt lgkmcnt(6)
    v_mfma_f32_16x16x32_bf16 v[16:19], v[40:43], a[40:43], v[16:19]
    v_mfma_f32_16x16x32_bf16 v[20:23], v[40:43], a[44:47], v[20:23]
    ds_read_b128 v[40:43], v4 offset:18432
    v_mfma_f32_16x16x32_bf16 v[28:31], v[44:47], a[44:47], v[28:31]
    v_mfma_f32_16x16x32_bf16 v[24:27], v[44:47], a[40:43], v[24:27]
    ds_read_b128 v[44:47], v4 offset:18688
    s_waitcnt lgkmcnt(6)
    v_mfma_f32_16x16x32_bf16 v[16:19], v[48:51], a[48:51], v[16:19]
    v_mfma_f32_16x16x32_bf16 v[20:23], v[48:51], a[52:55], v[20:23]
    ds_read_b128 v[48:51], v4 offset:20480
    v_mfma_f32_16x16x32_bf16 v[28:31], v[52:55], a[52:55], v[28:31]
    v_mfma_f32_16x16x32_bf16 v[24:27], v[52:55], a[48:51], v[24:27]
    ds_read_b128 v[52:55], v4 offset:20736
    s_waitcnt lgkmcnt(6)
    v_mfma_f32_16x16x32_bf16 v[16:19], v[56:59], a[56:59], v[16:19]
    v_mfma_f32_16x16x32_bf16 v[20:23], v[56:59], a[60:63], v[20:23]
    ds_read_b128 v[56:59], v4 offset:22528
    v_mfma_f32_16x16x32_bf16 v[28:31], v[60:63], a[60:63], v[28:31]
    v_mfma_f32_16x16x32_bf16 v[24:27], v[60:63], a[56:59], v[24:27]
    ds_read_b128 v[60:63], v4 offset:22784
    s_waitcnt lgkmcnt(6)
    v_mfma_f32_16x16x32_bf16 v[16:19], v[32:35], a[64:67], v[16:19]
    v_mfma_f32_16x16x32_bf16 v[20:23], v[32:35], a[68:71], v[20:23]
    ds_read_b128 v[32:35], v4 offset:24576
    v_mfma_f32_16x16x32_bf16 v[28:31], v[36:39], a[68:71], v[28:31]
    v_mfma_f32_16x16x32_bf16 v[24:27], v[36:39], a[64:67], v[24:27]
    ds_read_b128 v[36:39], v4 offset:24832
    s_waitcnt lgkmcnt(6)
    v_mfma_f32_16x16x32_bf16 v[16:19], v[40:43], a[72:75], v[16:19]
    v_mfma_f32_16x16x32_bf16 v[20:23], v[40:43], a[76:79], v[20:23]
    ds_read_b128 v[40:43], v4 offset:26624
    v_mfma_f32_16x16x32_bf16 v[28:31], v[44:47], a[76:79], v[28:31]
    v_mfma_f32_16x16x32_bf16 v[24:27], v[44:47], a[72:75], v[24:27]
    ds_read_b128 v[44:47], v4 offset:26880
    s_waitcnt lgkmcnt(6)
    v_mfma_f32_16x16x32_bf16 v[16:19], v[48:51], a[80:83], v[16:19]
    v_mfma_f32_16x16x32_bf16 v[20:23], v[48:51], a[84:87], v[20:23]
    ds_read_b128 v[48:51], v4 offset:28672
    v_mfma_f32_16x16x32_bf16 v[28:31], v[52:55], a[84:87], v[28:31]
    v_mfma_f32_16x16x32_bf16 v[24:27], v[52:55], a[80:83], v[24:27]
    ds_read_b128 v[52:55], v4 offset:28928
    s_waitcnt lgkmcnt(6)
    v_mfma_f32_16x16x32_bf16 v[16:19], v[56:59], a[88:91], v[16:19]
    v_mfma_f32_16x16x32_bf16 v[20:23], v[56:59], a[92:95], v[20:23]
    ds_read_b128 v[56:59], v4 offset:30720
    v_mfma_f32_16x16x32_bf16 v[28:31], v[60:63], a[92:95], v[28:31]
    v_mfma_f32_16x16x32_bf16 v[24:27], v[60:63], a[88:91], v[24:27]
    ds_read_b128 v[60:63], v4 offset:30976
    s_waitcnt lgkmcnt(6)
    v_mfma_f32_16x16x32_bf16 v[16:19], v[32:35], a[96:99], v[16:19]
    v_mfma_f32_16x16x32_bf16 v[20:23], v[32:35], a[100:103], v[20:23]
    v_mfma_f32_16x16x32_bf16 v[28:31], v[36:39], a[100:103], v[28:31]
    v_mfma_f32_16x16x32_bf16 v[24:27], v[36:39], a[96:99], v[24:27]
    s_waitcnt lgkmcnt(4)
    v_mfma_f32_16x16x32_bf16 v[16:19], v[40:43], a[104:107], v[16:19]
    v_mfma_f32_16x16x32_bf16 v[20:23], v[40:43], a[108:111], v[20:23]
    v_mfma_f32_16x16x32_bf16 v[28:31], v[44:47], a[108:111], v[28:31]
    v_mfma_f32_16x16x32_bf16 v[24:27], v[44:47], a[104:107], v[24:27]
    s_waitcnt lgkmcnt(2)
    v_mfma_f32_16x16x32_bf16 v[16:19], v[48:51], a[112:115], v[16:19]
    v_mfma_f32_16x16x32_bf16 v[20:23], v[48:51], a[116:119], v[20:23]
    s_cmp_eq_u32 s81, 1
    s_cbranch_scc1 L_g_h2_169
L_g_h2_169_b:
    ds_write_b32 v119, v118
    v_mfma_f32_16x16x32_bf16 v[28:31], v[52:55], a[116:119], v[28:31]
    v_mfma_f32_16x16x32_bf16 v[24:27], v[52:55], a[112:115], v[24:27]
    s_waitcnt lgkmcnt(0)
    v_mfma_f32_16x16x32_bf16 v[16:19], v[56:59], a[120:123], v[16:19]
    v_mfma_f32_16x16x32_bf16 v[20:23], v[56:59], a[124:127], v[20:23]
    v_mfma_f32_16x16x32_bf16 v[28:31], v[60:63], a[124:127], v[28:31]
    v_mfma_f32_16x16x32_bf16 v[24:27], v[60:63], a[120:123], v[24:27]
    v_xor_b32 v4, 0x10000, v4
    s_setprio 0
    s_waitcnt vmcnt(0)
    s_waitcnt lgkmcnt(0)
    s_barrier
    ds_read_b32 v14, v15
    s_nop 6
    ds_write_b128 v5, v[16:19] offset:0
    ds_write_b128 v5, v[20:23] offset:1024
    ds_write_b128 v5, v[24:27] offset:2048
    ds_write_b128 v5, v[28:31] offset:3072
    s_waitcnt lgkmcnt(4)
    v_readfirstlane_b32 s66, v14
    s_add_u32 s60, s60, 1
    s_mov_b32 s65, 0
    s_cmp_le_u32 s62, s60
    s_cbranch_scc1 L_g_dp_170_l
L_g_dp_170_a:
    s_cmp_ge_u32 s62, s66
    s_cbranch_scc1 L_g_dp_170_d
    s_add_u32 s47, s61, 4096
    s_mov_b32 m0, s64
    s_add_u32 s62, s62, 1
    buffer_load_dwordx4 v3, s[12:15], s61 offen offset:0 sc1 lds
    buffer_load_dwordx4 v3, s[12:15], s61 offen offset:1024 sc1 lds
    buffer_load_dwordx4 v3, s[12:15], s61 offen offset:2048 sc1 lds
    buffer_load_dwordx4 v3, s[12:15], s61 offen offset:3072 sc1 lds
    s_add_u32 m0, s64, 4096
    s_add_u32 s61, s61, 262144
    buffer_load_dwordx4 v3, s[12:15], s47 offen offset:0 sc1 lds
    buffer_load_dwordx4 v3, s[12:15], s47 offen offset:1024 sc1 lds
    buffer_load_dwordx4 v3, s[12:15], s47 offen offset:2048 sc1 lds
    buffer_load_dwordx4 v3, s[12:15], s47 offen offset:3072 sc1 lds
    s_xor_b32 s64, s64, 0x10000
L_g_dp_170_d:
    s_cmp_lg_u32 s44, 2
    s_cbranch_scc1 L_g_pf_171
    s_cmp_ge_u32 s62, s66
    s_cbranch_scc1 L_g_pf_171
    buffer_load_dword v117, v116, s[12:15], s61 offen sc1
L_g_pf_171:
    s_cmp_le_u32 s66, s60
    s_cbranch_scc1 L_g_ex0_167
    s_cmp_lg_u32 s65, 0
    s_cbranch_scc1 L_g_nw_166
    ds_read_b128 v[32:35], v4 offset:0
    ds_read_b128 v[36:39], v4 offset:256
    ds_read_b128 v[40:43], v4 offset:2048
    ds_read_b128 v[44:47], v4 offset:2304
    ds_read_b128 v[48:51], v4 offset:4096
    ds_read_b128 v[52:55], v4 offset:4352
    ds_read_b128 v[56:59], v4 offset:6144
    ds_read_b128 v[60:63], v4 offset:6400
    s_cmp_lg_u32 s44, 0
    s_cbranch_scc1 L_g_nl_172
    s_mov_b32 s46, s66
    s_cmp_lg_u32 s81, 0
    s_cbranch_scc1 L_g_nl_172_e
    v_cmp_ge_u32 vcc, v12, v11
    s_nop 0
    s_ff1_i32_b64 s46, vcc
    s_lshr_b32 s46, s46, 4
    s_min_u32 s46, s46, 4
    s_add_u32 s46, s46, s54
    s_min_u32 s46, s46, s75
    v_mov_b32 v118, s46
L_g_nl_172_e:
    s_add_u32 s47, s60, 3
    s_min_u32 s47, s47, s75
    s_cmp_lt_u32 s46, s47
    s_cselect_b32 s81, 1, 0
    s_cbranch_scc1 L_g_nl_172
    s_add_u32 s54, s60, 2
    v_add_u32 v12, s54, v113
    v_and_b32 v13, 3, v12
    v_lshl_add_u32 v13, v13, 7, v7
    buffer_load_dword v11, v13, s[12:15], 0 offen sc1
L_g_nl_172:
    s_waitcnt lgkmcnt(8)
    s_branch L_g_loop0_156
L_g_ex0_167:
    s_cmp_lg_u32 s44, 0
    s_cbranch_scc1 L_g_ex0_167_n
    ds_write_b32 v15, v118 offset:20
    s_cmp_ge_u32 s60, s75
    s_cbranch_scc1 L_g_ex0_167_n
    s_sleep 6
    s_add_u32 s54, s60, 0
    v_add_u32 v12, s54, v113
    v_and_b32 v13, 3, v12
    v_lshl_add_u32 v13, v13, 7, v7
    buffer_load_dword v11, v13, s[12:15], 0 offen sc1
    s_waitcnt vmcnt(0)
    v_cmp_ge_u32 vcc, v12, v11
    s_nop 0
    s_ff1_i32_b64 s46, vcc
    s_lshr_b32 s46, s46, 4
    s_min_u32 s46, s46, 4
    s_add_u32 s46, s46, s54
    s_min_u32 s46, s46, s75
    v_mov_b32 v118, s46
    ds_write_b32 v15, v118 offset:20
L_g_ex0_167_n:
    s_waitcnt lgkmcnt(0)
    s_barrier
    ds_read_b32 v14, v15 offset:20
    s_waitcnt lgkmcnt(0)
    v_readfirstlane_b32 s66, v14
    s_barrier
    s_cmp_gt_u32 s66, s60
    s_cbranch_scc1 L_g_restart_153_go
    s_branch L_g_tail_158
L_g_g1r_155:
    s_mov_b32 s65, 1
    s_branch L_g_loop1_157_e
.p2align 6
L_g_loop1_157:
    s_mov_b32 s65, 0
L_g_loop1_157_e:
    s_barrier
    s_bitcmp1_b32 s67, 1
    s_cbranch_scc0 L_g_nfl_173
    s_cmp_lg_u32 s44, 4
    s_cbranch_scc1 L_g_nfl_173_d
    s_sub_u32 s59, s60, 1
    v_mov_b32 v10, s59
    buffer_store_dword v10, v115, s[12:15], s52 offen sc1
L_g_nfl_173_d:
    ds_read_b128 v[80:83], v5 offset:0
    ds_read_b128 v[84:87], v5 offset:1024
    ds_read_b128 v[88:91], v5 offset:2048
    ds_read_b128 v[92:95], v5 offset:3072
    s_cmp_le_u32 s62, s60
    s_cbranch_scc1 L_g_dp_178_l
L_g_dp_178_a:
    s_cmp_ge_u32 s62, s66
    s_cbranch_scc1 L_g_dp_178_d
    s_add_u32 s47, s61, 4096
    s_mov_b32 m0, s64
    s_add_u32 s62, s62, 1
    buffer_load_dwordx4 v3, s[12:15], s61 offen offset:0 sc1 lds
    buffer_load_dwordx4 v3, s[12:15], s61 offen offset:1024 sc1 lds
    buffer_load_dwordx4 v3, s[12:15], s61 offen offset:2048 sc1 lds
    buffer_load_dwordx4 v3, s[12:15], s61 offen offset:3072 sc1 lds
    s_add_u32 m0, s64, 4096
    s_add_u32 s61, s61, 262144
    buffer_load_dwordx4 v3, s[12:15], s47 offen offset:0 sc1 lds
    buffer_load_dwordx4 v3, s[12:15], s47 offen offset:1024 sc1 lds
    buffer_load_dwordx4 v3, s[12:15], s47 offen offset:2048 sc1 lds
    buffer_load_dwordx4 v3, s[12:15], s47 offen offset:3072 sc1 lds
    s_xor_b32 s64, s64, 0x10000
L_g_dp_178_d:
    s_bitcmp1_b32 s67, 0
    s_cbranch_scc0 L_g_nep_174
    s_waitcnt lgkmcnt(0)
    v_add_f32 v80, v80, v16
    v_add_f32 v81, v81, v17
    v_add_f32 v82, v82, v18
    v_add_f32 v83, v83, v19
    v_add_f32 v84, v84, v20
    v_add_f32 v85, v85, v21
    v_add_f32 v86, v86, v22
    v_add_f32 v87, v87, v23
    v_add_f32 v88, v88, v24
    v_add_f32 v89, v89, v25
    v_add_f32 v90, v90, v26
    v_add_f32 v91, v91, v27
    v_add_f32 v92, v92, v28
    v_add_f32 v93, v93, v29
    v_add_f32 v94, v94, v30
    v_add_f32 v95, v95, v31
    v_cvt_pk_bf16_f32 v104, v80, v81
    v_cvt_pk_bf16_f32 v105, v82, v83
    v_cvt_pk_bf16_f32 v106, v84, v85
    v_cvt_pk_bf16_f32 v107, v86, v87
    s_nop 1
    v_permlane16_swap_b32 v104, v106
    v_permlane16_swap_b32 v105, v107
    buffer_store_dwordx4 v[104:107], v8, s[12:15], s63 offen sc1
    v_cvt_pk_bf16_f32 v108, v88, v89
    v_cvt_pk_bf16_f32 v109, v90, v91
    v_cvt_pk_bf16_f32 v110, v92, v93
    v_cvt_pk_bf16_f32 v111, v94, v95
    s_nop 1
    v_permlane16_swap_b32 v108, v110
    v_permlane16_swap_b32 v109, v111
    buffer_store_dwordx4 v[108:111], v9, s[12:15], s63 offen sc1
    s_add_u32 s63, s63, 262144
L_g_nep_174:
    s_cmp_lg_u32 s65, 0
    s_cbranch_scc1 L_g_nw1_175
    ds_read_b128 v[32:35], v4 offset:0
    ds_read_b128 v[36:39], v4 offset:256
    ds_read_b128 v[40:43], v4 offset:2048
    ds_read_b128 v[44:47], v4 offset:2304
    ds_read_b128 v[48:51], v4 offset:4096
    ds_read_b128 v[52:55], v4 offset:4352
    ds_read_b128 v[56:59], v4 offset:6144
    ds_read_b128 v[60:63], v4 offset:6400
    s_barrier
L_g_jn_177:
    s_setprio 1
    s_waitcnt lgkmcnt(6)
    v_mfma_f32_16x16x32_bf16 v[16:19], v[32:35], a[0:3], 0
    ds_read_b32 v14, v15
    v_mfma_f32_16x16x32_bf16 v[20:23], v[32:35], a[4:7], 0
    ds_read_b128 v[32:35], v4 offset:8192
    v_mfma_f32_16x16x32_bf16 v[28:31], v[36:39], a[4:7], 0
    v_mfma_f32_16x16x32_bf16 v[24:27], v[36:39], a[0:3], 0
    ds_read_b128 v[36:39], v4 offset:8448
    s_waitcnt lgkmcnt(6)
    v_mfma_f32_16x16x32_bf16 v[16:19], v[40:43], a[8:11], v[16:19]
    v_mfma_f32_16x16x32_bf16 v[20:23], v[40:43], a[12:15], v[20:23]
    ds_read_b128 v[40:43], v4 offset:10240
    v_mfma_f32_16x16x32_bf16 v[28:31], v[44:47], a[12:15], v[28:31]
    v_mfma_f32_16x16x32_bf16 v[24:27], v[44:47], a[8:11], v[24:27]
    ds_read_b128 v[44:47], v4 offset:10496
    s_waitcnt lgkmcnt(6)
    v_mfma_f32_16x16x32_bf16 v[16:19], v[48:51], a[16:19], v[16:19]
    v_mfma_f32_16x16x32_bf16 v[20:23], v[48:51], a[20:23], v[20:23]
    ds_read_b128 v[48:51], v4 offset:12288
    v_mfma_f32_16x16x32_bf16 v[28:31], v[52:55], a[20:23], v[28:31]
    v_mfma_f32_16x16x32_bf16 v[24:27], v[52:55], a[16:19], v[24:27]
    ds_read_b128 v[52:55], v4 offset:12544
    s_waitcnt lgkmcnt(6)
    v_mfma_f32_16x16x32_bf16 v[16:19], v[56:59], a[24:27], v[16:19]
    v_mfma_f32_16x16x32_bf16 v[20:23], v[56:59], a[28:31], v[20:23]
    ds_read_b128 v[56:59], v4 offset:14336
    v_mfma_f32_16x16x32_bf16 v[28:31], v[60:63], a[28:31], v[28:31]
    v_mfma_f32_16x16x32_bf16 v[24:27], v[60:63], a[24:27], v[24:27]
    ds_read_b128 v[60:63], v4 offset:14592
    s_waitcnt lgkmcnt(6)
    v_mfma_f32_16x16x32_bf16 v[16:19], v[32:35], a[32:35], v[16:19]
    v_mfma_f32_16x16x32_bf16 v[20:23], v[32:35], a[36:39], v[20:23]
    ds_read_b128 v[32:35], v4 offset:16384
    v_mfma_f32_16x16x32_bf16 v[28:31], v[36:39], a[36:39], v[28:31]
    v_mfma_f32_16x16x32_bf16 v[24:27], v[36:39], a[32:35], v[24:27]
    ds_read_b128 v[36:39], v4 offset:16640
    s_waitcnt lgkmcnt(6)
    v_mfma_f32_16x16x32_bf16 v[16:19], v[40:43], a[40:43], v[16:19]
    v_mfma_f32_16x16x32_bf16 v[20:23], v[40:43], a[44:47], v[20:23]
    ds_read_b128 v[40:43], v4 offset:18432
    v_mfma_f32_16x16x32_bf16 v[28:31], v[44:47], a[44:47], v[28:31]
    v_mfma_f32_16x16x32_bf16 v[24:27], v[44:47], a[40:43], v[24:27]
    ds_read_b128 v[44:47], v4 offset:18688
    s_waitcnt lgkmcnt(6)
    v_mfma_f32_16x16x32_bf16 v[16:19], v[48:51], a[48:51], v[16:19]
    v_mfma_f32_16x16x32_bf16 v[20:23], v[48:51], a[52:55], v[20:23]
    ds_read_b128 v[48:51], v4 offset:20480
    v_mfma_f32_16x16x32_bf16 v[28:31], v[52:55], a[52:55], v[28:31]
    v_mfma_f32_16x16x32_bf16 v[24:27], v[52:55], a[48:51], v[24:27]
    ds_read_b128 v[52:55], v4 offset:20736
    s_waitcnt lgkmcnt(6)
    v_mfma_f32_16x16x32_bf16 v[16:19], v[56:59], a[56:59], v[16:19]
    v_mfma_f32_16x16x32_bf16 v[20:23], v[56:59], a[60:63], v[20:23]
    ds_read_b128 v[56:59], v4 offset:22528
    v_mfma_f32_16x16x32_bf16 v[28:31], v[60:63], a[60:63], v[28:31]
    v_mfma_f32_16x16x32_bf16 v[24:27], v[60:63], a[56:59], v[24:27]
    ds_read_b128 v[60:63], v4 offset:22784
    s_waitcnt lgkmcnt(6)
    v_mfma_f32_16x16x32_bf16 v[16:19], v[32:35], a[64:67], v[16:19]
    v_mfma_f32_16x16x32_bf16 v[20:23], v[32:35], a[68:71], v[20:23]
    ds_read_b128 v[32:35], v4 offset:24576
    v_mfma_f32_16x16x32_bf16 v[28:31], v[36:39], a[68:71], v[28:31]
    v_mfma_f32_16x16x32_bf16 v[24:27], v[36:39], a[64:67], v[24:27]
    ds_read_b128 v[36:39], v4 offset:24832
    s_waitcnt lgkmcnt(6)
    v_mfma_f32_16x16x32_bf16 v[16:19], v[40:43], a[72:75], v[16:19]
    v_mfma_f32_16x16x32_bf16 v[20:23], v[40:43], a[76:79], v[20:23]
    ds_read_b128 v[40:43], v4 offset:26624
    v_mfma_f32_16x16x32_bf16 v[28:31], v[44:47], a[76:79], v[28:31]
    v_mfma_f32_16x16x32_bf16 v[24:27], v[44:47], a[72:75], v[24:27]
    ds_read_b128 v[44:47], v4 offset:26880
    s_waitcnt lgkmcnt(6)
    v_mfma_f32_16x16x32_bf16 v[16:19], v[48:51], a[80:83], v[16:19]
    v_mfma_f32_16x16x32_bf16 v[20:23], v[48:51], a[84:87], v[20:23]
    ds_read_b128 v[48:51], v4 offset:28672
    v_mfma_f32_16x16x32_bf16 v[28:31], v[52:55], a[84:87], v[28:31]
    v_mfma_f32_16x16x32_bf16 v[24:27], v[52:55], a[80:83], v[24:27]
    ds_read_b128 v[52:55], v4 offset:28928
    s_waitcnt lgkmcnt(6)
    v_mfma_f32_16x16x32_bf16 v[16:19], v[56:59], a[88:91], v[16:19]
    v_mfma_f32_16x16x32_bf16 v[20:23], v[56:59], a[92:95], v[20:23]
    ds_read_b128 v[56:59], v4 offset:30720
    v_mfma_f32_16x16x32_bf16 v[28:31], v[60:63], a[92:95], v[28:31]
    v_mfma_f32_16x16x32_bf16 v[24:27], v[60:63], a[88:91], v[24:27]
    ds_read_b128 v[60:63], v4 offset:30976
    s_waitcnt lgkmcnt(6)
    v_mfma_f32_16x16x32_bf16 v[16:19], v[32:35], a[96:99], v[16:19]
    v_mfma_f32_16x16x32_bf16 v[20:23], v[32:35], a[100:103], v[20:23]
    v_mfma_f32_16x16x32_bf16 v[28:31], v[36:39], a[100:103], v[28:31]
    v_mfma_f32_16x16x32_bf16 v[24:27], v[36:39], a[96:99], v[24:27]
    s_waitcnt lgkmcnt(4)
    v_mfma_f32_16x16x32_bf16 v[16:19], v[40:43], a[104:107], v[16:19]
    v_mfma_f32_16x16x32_bf16 v[20:23], v[40:43], a[108:111], v[20:23]
    v_mfma_f32_16x16x32_bf16 v[28:31], v[44:47], a[108:111], v[28:31]
    v_mfma_f32_16x16x32_bf16 v[24:27], v[44:47], a[104:107], v[24:27]
    s_waitcnt lgkmcnt(2)
    v_mfma_f32_16x16x32_bf16 v[16:19], v[48:51], a[112:115], v[16:19]
    v_mfma_f32_16x16x32_bf16 v[20:23], v[48:51], a[116:119], v[20:23]
    v_mfma_f32_16x16x32_bf16 v[28:31], v[52:55], a[116:119], v[28:31]
    v_mfma_f32_16x16x32_bf16 v[24:27], v[52:55], a[112:115], v[24:27]
    s_waitcnt lgkmcnt(0)
    v_mfma_f32_16x16x32_bf16 v[16:19], v[56:59], a[120:123], v[16:19]
    v_mfma_f32_16x16x32_bf16 v[20:23], v[56:59], a[124:127], v[20:23]
    v_mfma_f32_16x16x32_bf16 v[28:31], v[60:63], a[124:127], v[28:31]
    v_mfma_f32_16x16x32_bf16 v[24:27], v[60:63], a[120:123], v[24:27]
    v_xor_b32 v4, 0x10000, v4
    s_setprio 0
    s_waitcnt vmcnt(0)
    v_readfirstlane_b32 s66, v14
    s_lshl_b32 s67, s67, 1
    s_or_b32 s67, s67, 1
    s_add_u32 s60, s60, 1
    s_cmp_gt_u32 s66, s60
    s_cbranch_scc1 L_g_loop1_157
    s_barrier
    ds_read_b32 v14, v15 offset:20
    ds_read_b128 v[80:83], v5 offset:0
    ds_read_b128 v[84:87], v5 offset:1024
    ds_read_b128 v[88:91], v5 offset:2048
    ds_read_b128 v[92:95], v5 offset:3072
    s_waitcnt lgkmcnt(4)
    v_readfirstlane_b32 s66, v14
    s_barrier
    s_mov_b32 s69, 0
    s_cmp_gt_u32 s62, s60
    s_cbranch_scc1 L_g_nd_179
    s_cmp_ge_u32 s62, s66
    s_cbranch_scc1 L_g_nd_179
    s_add_u32 s47, s61, 4096
    s_add_u32 m0, s64, 0
    s_nop 0
    buffer_load_dwordx4 v3, s[12:15], s61 offen offset:0 sc1 lds
    buffer_load_dwordx4 v3, s[12:15], s61 offen offset:1024 sc1 lds
    buffer_load_dwordx4 v3, s[12:15], s61 offen offset:2048 sc1 lds
    buffer_load_dwordx4 v3, s[12:15], s61 offen offset:3072 sc1 lds
    s_add_u32 m0, s64, 4096
    s_nop 0
    buffer_load_dwordx4 v3, s[12:15], s47 offen offset:0 sc1 lds
    buffer_load_dwordx4 v3, s[12:15], s47 offen offset:1024 sc1 lds
    buffer_load_dwordx4 v3, s[12:15], s47 offen offset:2048 sc1 lds
    buffer_load_dwordx4 v3, s[12:15], s47 offen offset:3072 sc1 lds
    s_add_u32 s61, s61, 262144
    s_add_u32 s62, s62, 1
    s_xor_b32 s64, s64, 0x10000
    s_mov_b32 s69, 1
L_g_nd_179:
    s_sub_u32 s59, s60, 1
    s_waitcnt lgkmcnt(3)
    v_add_f32 v80, v80, v16
    v_add_f32 v81, v81, v17
    v_add_f32 v82, v82, v18
    v_add_f32 v83, v83, v19
    s_waitcnt lgkmcnt(2)
    v_add_f32 v84, v84, v20
    v_add_f32 v85, v85, v21
    v_add_f32 v86, v86, v22
    v_add_f32 v87, v87, v23
    s_waitcnt lgkmcnt(1)
    v_add_f32 v88, v88, v24
    v_add_f32 v89, v89, v25
    v_add_f32 v90, v90, v26
    v_add_f32 v91, v91, v27
    s_waitcnt lgkmcnt(0)
    v_add_f32 v92, v92, v28
    v_add_f32 v93, v93, v29
    v_add_f32 v94, v94, v30
    v_add_f32 v95, v95, v31
    v_cvt_pk_bf16_f32 v104, v80, v81
    v_cvt_pk_bf16_f32 v105, v82, v83
    v_cvt_pk_bf16_f32 v106, v84, v85
    v_cvt_pk_bf16_f32 v107, v86, v87
    s_nop 1
    v_permlane16_swap_b32 v104, v106
    v_permlane16_swap_b32 v105, v107
    buffer_store_dwordx4 v[104:107], v8, s[12:15], s63 offen sc1
    v_cvt_pk_bf16_f32 v108, v88, v89
    v_cvt_pk_bf16_f32 v109, v90, v91
    v_cvt_pk_bf16_f32 v110, v92, v93
    v_cvt_pk_bf16_f32 v111, v94, v95
    s_nop 1
    v_permlane16_swap_b32 v108, v110
    v_permlane16_swap_b32 v109, v111
    buffer_store_dwordx4 v[108:111], v9, s[12:15], s63 offen sc1
    s_add_u32 s63, s63, 262144
    s_mov_b32 s67, 0
    s_mov_b32 s71, 1
    s_cmp_gt_u32 s66, s60
    s_cbranch_scc1 L_g_g1r_155
    v_mov_b32 v10, 1
    s_mov_b64 exec, 1
    s_waitcnt vmcnt(0)
    ds_add_rtn_u32 v10, v15, v10 offset:4
    s_waitcnt lgkmcnt(0)
    v_readfirstlane_b32 s46, v10
    s_mov_b64 exec, -1
    s_mov_b32 s71, 0
    s_sub_u32 s59, s60, 1
    s_cmp_lg_u32 s46, s68
    s_cbranch_scc1 L_g_df_180
    v_mov_b32 v10, s59
    v_add_u32 v10, 1, v10
    v_mov_b32 v11, 0
    s_mov_b64 exec, 1
    buffer_store_dword v10, v11, s[12:15], s52 offen sc1
    s_mov_b64 exec, -1
L_sf_181:
L_g_df_180:
    s_add_u32 s68, s68, 4
    s_cmp_gt_u32 s66, s60
    s_cbranch_scc1 L_g_g1r_155
L_g_tail_158:
    s_cmp_lt_u32 s60, s75
    s_cbranch_scc1 L_g_restart_153
    s_waitcnt vmcnt(0)
    s_barrier
    s_branch L_c_done_1
L_g_h1_168:
    s_add_u32 s54, s60, 1
    v_add_u32 v12, s54, v113
    v_and_b32 v13, 3, v12
    v_lshl_add_u32 v13, v13, 7, v7
    buffer_load_dword v11, v13, s[12:15], 0 offen sc1
    s_branch L_g_h1_168_b
L_g_h2_169:
    s_waitcnt vmcnt(0)
    v_cmp_ge_u32 vcc, v12, v11
    s_nop 0
    s_ff1_i32_b64 s46, vcc
    s_lshr_b32 s46, s46, 4
    s_min_u32 s46, s46, 4
    s_add_u32 s46, s46, s54
    s_min_u32 s46, s46, s75
    v_mov_b32 v118, s46
    s_branch L_g_h2_169_b
L_g_dp_170_l:
    s_cmp_ge_u32 s62, s66
    s_cbranch_scc1 L_g_dp_170_d
    s_mov_b32 s65, 1
    s_add_u32 s47, s61, 4096
    s_mov_b32 m0, s64
    s_add_u32 s62, s62, 1
    buffer_load_dwordx4 v3, s[12:15], s61 offen offset:0 sc1 lds
    buffer_load_dwordx4 v3, s[12:15], s61 offen offset:1024 sc1 lds
    buffer_load_dwordx4 v3, s[12:15], s61 offen offset:2048 sc1 lds
    buffer_load_dwordx4 v3, s[12:15], s61 offen offset:3072 sc1 lds
    s_add_u32 m0, s64, 4096
    s_add_u32 s61, s61, 262144
    buffer_load_dwordx4 v3, s[12:15], s47 offen offset:0 sc1 lds
    buffer_load_dwordx4 v3, s[12:15], s47 offen offset:1024 sc1 lds
    buffer_load_dwordx4 v3, s[12:15], s47 offen offset:2048 sc1 lds
    buffer_load_dwordx4 v3, s[12:15], s47 offen offset:3072 sc1 lds
    s_xor_b32 s64, s64, 0x10000
    s_branch L_g_dp_170_a
L_g_nw_166:
    s_waitcnt vmcnt(0) lgkmcnt(0)
    s_cmp_lg_u32 s44, 0
    s_cbranch_scc1 L_g_nl_182
    s_cmp_lt_u32 s66, s75
    s_cselect_b32 s81, 1, 2
L_g_nl_182:
    s_branch L_g_loop0_156_l
L_g_nfl_173:
    s_cmp_eq_u32 s71, 0
    s_cbranch_scc1 L_g_nfl_173_d
    v_mov_b32 v10, 1
    s_mov_b64 exec, 1
    s_waitcnt vmcnt(0)
    ds_add_rtn_u32 v10, v15, v10 offset:4
    s_waitcnt lgkmcnt(0)
    v_readfirstlane_b32 s46, v10
    s_mov_b64 exec, -1
    s_mov_b32 s71, 0
    s_sub_u32 s59, s60, 1
    s_cmp_lg_u32 s46, s68
    s_cbranch_scc1 L_g_df_183
    v_mov_b32 v10, s59
    v_add_u32 v10, 1, v10
    v_mov_b32 v11, 0
    s_mov_b64 exec, 1
    buffer_store_dword v10, v11, s[12:15], s52 offen sc1
    s_mov_b64 exec, -1
L_sf_184:
L_g_df_183:
    s_add_u32 s68, s68, 4
    s_mov_b32 s65, 2
    s_branch L_g_nfl_173_d
L_g_dp_178_l:
    s_cmp_ge_u32 s62, s66
    s_cbranch_scc1 L_g_dp_178_d
    s_or_b32 s65, s65, 1
    s_add_u32 s47, s61, 4096
    s_mov_b32 m0, s64
    s_add_u32 s62, s62, 1
    buffer_load_dwordx4 v3, s[12:15], s61 offen offset:0 sc1 lds
    buffer_load_dwordx4 v3, s[12:15], s61 offen offset:1024 sc1 lds
    buffer_load_dwordx4 v3, s[12:15], s61 offen offset:2048 sc1 lds
    buffer_load_dwordx4 v3, s[12:15], s61 offen offset:3072 sc1 lds
    s_add_u32 m0, s64, 4096
    s_add_u32 s61, s61, 262144
    buffer_load_dwordx4 v3, s[12:15], s47 offen offset:0 sc1 lds
    buffer_load_dwordx4 v3, s[12:15], s47 offen offset:1024 sc1 lds
    buffer_load_dwordx4 v3, s[12:15], s47 offen offset:2048 sc1 lds
    buffer_load_dwordx4 v3, s[12:15], s47 offen offset:3072 sc1 lds
    s_xor_b32 s64, s64, 0x10000
    s_branch L_g_dp_178_a
L_g_nw1_175:
    s_cmp_eq_u32 s65, 2
    s_cbranch_scc1 L_g_nw1_175_w
    s_waitcnt vmcnt(0)
L_g_nw1_175_w:
    s_barrier
    ds_read_b128 v[32:35], v4 offset:0
    ds_read_b128 v[36:39], v4 offset:256
    ds_read_b128 v[40:43], v4 offset:2048
    ds_read_b128 v[44:47], v4 offset:2304
    ds_read_b128 v[48:51], v4 offset:4096
    ds_read_b128 v[52:55], v4 offset:4352
    ds_read_b128 v[56:59], v4 offset:6144
    ds_read_b128 v[60:63], v4 offset:6400
    s_branch L_g_jn_177
L_c_chain_9:
    v_mov_b32 v4, 0
    v_mov_b32 v5, 0
    v_mov_b32 v6, 0
    v_mov_b32 v7, 0
    v_mov_b32 v8, 0
    v_mov_b32 v9, 0
    v_mov_b32 v10, 0
    v_mov_b32 v11, 0
    v_mov_b32 v12, 0
    v_mov_b32 v13, 0
    v_mov_b32 v14, 0
    v_mov_b32 v15, 0
    v_mov_b32 v32, -1
    v_mov_b32 v33, -1
    v_mov_b32 v34, -1
    v_mov_b32 v35, -1
    v_lshlrev_b32 v2, 4, v1
    s_lshl_b32 s45, s40, 16
    s_lshl_b32 s46, s41, 12
    s_add_u32 s45, s45, s46
    s_and_b32 s46, s44, 3
    s_lshl_b32 s46, s46, 10
    s_add_u32 s45, s45, s46
    s_lshr_b32 s46, s44, 2
    s_lshl_b32 s46, s46, 19
    s_add_u32 s45, s45, s46
    s_add_u32 s45, s45, 0x7000000
    buffer_store_dwordx4 v[32:35], v2, s[12:15], s45 offen sc1
    s_lshl_b32 s45, s40, 15
    s_lshl_b32 s46, s41, 11
    s_add_u32 s45, s45, s46
    s_lshl_b32 s46, s44, 8
    s_add_u32 s45, s45, s46
    s_add_u32 s45, s45, 0x7100000
    s_mov_b64 exec, 0xffff
    buffer_store_dwordx4 v[32:35], v2, s[12:15], s45 offen sc1
    s_lshl_b32 s45, s40, 16
    s_lshl_b32 s46, s41, 8
    s_add_u32 s45, s45, s46
    s_and_b32 s46, s44, 3
    s_lshl_b32 s46, s46, 14
    s_add_u32 s45, s45, s46
    s_add_u32 s45, s45, 0x7180000
    buffer_store_dwordx4 v[32:35], v2, s[12:15], s45 offen sc1
    s_mov_b64 exec, -1
    s_and_b32 s47, s44, 3
    s_cmp_eq_u32 s47, 3
    s_cbranch_scc1 L_c_t3_185
    s_cmp_eq_u32 s40, 7
    s_cselect_b32 s46, 8, 4
    s_cmp_ge_u32 s44, s46
    s_cbranch_scc1 L_c_t3_185
    s_lshl_b32 s46, s47, 3
    s_add_u32 s46, s46, 16
    s_load_dwordx2 s[4:5], s[0:1], s46
    v_lshlrev_b32 v2, 13, v1
    s_lshl_b32 s45, s41, 19
    s_lshl_b32 s46, s40, 10
    s_add_u32 s45, s45, s46
    s_add_u32 s45, s45, 384
    s_lshr_b32 s46, s44, 2
    s_lshl_b32 s46, s46, 9
    s_add_u32 s45, s45, s46
    s_waitcnt lgkmcnt(0)
    s_mov_b32 s24, s4
    s_and_b32 s25, s5, 0xffff
    s_mov_b32 s26, 0x800000
    s_mov_b32 s27, 0x00020000
    buffer_load_dword v110, v2, s[24:27], s45 offen
L_c_t3_185:
    s_cmp_lg_u32 s44, 3
    s_cbranch_scc1 L_c_t3_185_o
    s_load_dwordx2 s[4:5], s[0:1], 40
    v_lshlrev_b32 v2, 10, v1
    s_lshl_b32 s45, s40, 20
    s_lshl_b32 s46, s41, 16
    s_add_u32 s45, s45, s46
    s_add_u32 s45, s45, 384
    s_waitcnt lgkmcnt(0)
    s_mov_b32 s24, s4
    s_and_b32 s25, s5, 0xffff
    s_mov_b32 s26, 0x800000
    s_mov_b32 s27, 0x00020000
    buffer_load_dword v110, v2, s[24:27], s45 offen
L_c_t3_185_o:
    v_lshlrev_b32 v2, 4, v1
    v_and_b32 v3, 8, v1
    v_cmp_eq_u32 vcc, 0, v3
    v_mov_b32 v3, 0xeeeeeeee
    v_mov_b32 v4, 0x44444444
    v_cndmask_b32 v3, v3, v4, vcc
    v_and_b32 v100, 15, v1
    v_lshrrev_b32 v101, 4, v1
    v_and_b32 v102, 1, v101
    v_lshrrev_b32 v103, 1, v101
    v_lshlrev_b32 v104, 2, v102
    v_lshl_add_u32 v104, v103, 1, v104
    v_and_b32 v105, 1, v1
    v_add_u32 v104, v104, v105
    v_and_b32 v106, 7, v1
    v_bfe_u32 v107, v1, 3, 1
    s_lshr_b32 s42, s41, 2
    s_and_b32 s43, s41, 3
    s_lshl_b32 s49, s40, 2
    s_add_u32 s49, s49, s42
    s_lshl_b32 s45, s44, 14
    v_lshlrev_b32 v22, 3, v101
    v_bfe_u32 v23, v1, 2, 2
    v_add_u32 v22, v22, v23
    v_and_b32 v23, 3, v1
    v_lshlrev_b32 v24, 3, v23
    v_lshl_add_u32 v20, v22, 6, v24
    v_lshl_add_u32 v21, v22, 7, v24
    v_lshrrev_b32 v22, 2, v1
    v_lshlrev_b32 v23, 4, v23
    v_lshl_add_u32 v24, v22, 13, v23
    v_lshrrev_b32 v22, 3, v1
    v_lshlrev_b32 v23, 4, v106
    v_lshl_add_u32 v25, v22, 11, v23
    s_cmp_ge_u32 s44, 4
    s_cbranch_scc1 L_v_init_186
    s_lshr_b32 s50, s44, 1
    s_and_b32 s51, s44, 1
    s_load_dwordx4 s[4:7], s[0:1], 16
    s_lshl_b32 s46, s49, 8
    s_lshl_b32 s48, s43, 6
    s_add_u32 s46, s46, s48
    s_lshl_b32 s48, s44, 21
    s_add_u32 s46, s46, s48
    s_lshl_b32 s52, s51, 5
    s_xor_b32 s53, s50, 1
    s_lshl_b32 s53, s53, 16
    s_add_u32 s52, s52, s53
    v_add_u32 v20, s52, v20
    s_waitcnt lgkmcnt(0)
    s_mov_b32 s24, s6
    s_and_b32 s25, s7, 0xffff
    s_mov_b32 s26, 0x800000
    s_mov_b32 s27, 0x00020000
    s_mov_b32 s28, s4
    s_and_b32 s29, s5, 0xffff
    s_mov_b32 s30, 0x800000
    s_mov_b32 s31, 0x00020000
    s_lshl_b32 s52, s51, 9
    s_lshl_b32 s53, s50, 7
    s_add_u32 s52, s52, s53
    s_add_u32 s52, s52, 61440
    v_lshlrev_b32 v5, 1, v106
    v_lshl_add_u32 v5, v107, 8, v5
    v_lshl_add_u32 v5, v102, 6, v5
    v_lshl_add_u32 v5, v103, 5, v5
    v_add_u32 v5, s52, v5
    s_lshl_b32 s67, s49, 12
    s_lshl_b32 s53, s43, 10
    s_add_u32 s67, s67, s53
    s_add_u32 s67, s67, 0x1000000
    s_lshl_b32 s52, s40, 16
    s_lshl_b32 s53, s44, 11
    s_add_u32 s53, s52, s53
    s_add_u32 s53, s53, 0x7080000
    v_lshlrev_b32 v7, 3, v1
    v_add_u32 v7, s53, v7
    s_lshl_b32 s53, s44, 9
    s_add_u32 s53, s52, s53
    s_add_u32 s53, s53, 0x7180000
    v_lshlrev_b32 v28, 6, v103
    v_lshl_add_u32 v28, v106, 3, v28
    v_lshl_add_u32 v28, v102, 2, v28
    v_lshl_add_u32 v28, v107, 1, v28
    v_add_u32 v28, s53, v28
    s_lshl_b32 s52, s44, 10
    s_add_u32 s52, s52, 16384
    v_lshlrev_b32 v8, 8, v101
    v_lshl_add_u32 v8, v106, 4, v8
    v_lshl_add_u32 v8, v107, 3, v8
    v_add_u32 v8, s52, v8
    s_lshl_b32 s52, s44, 8
    s_add_u32 s52, s52, 20480
    v_lshlrev_b32 v9, 4, v106
    v_lshl_add_u32 v9, v101, 2, v9
    v_lshl_add_u32 v9, v107, 1, v9
    v_add_u32 v9, s52, v9
    s_mov_b32 s66, 0x3e0293ee
    s_add_u32 m0, s45, 0
    s_add_u32 s48, s46, 0x0
    buffer_load_dwordx4 v24, s[24:27], s48 offen  lds
    s_add_u32 m0, s45, 1024
    s_add_u32 s48, s46, 0x20000
    buffer_load_dwordx4 v24, s[24:27], s48 offen  lds
    s_add_u32 m0, s45, 2048
    s_add_u32 s48, s46, 0x40000
    buffer_load_dwordx4 v24, s[24:27], s48 offen  lds
    s_add_u32 m0, s45, 3072
    s_add_u32 s48, s46, 0x60000
    buffer_load_dwordx4 v24, s[24:27], s48 offen  lds
    s_add_u32 m0, s45, 4096
    s_add_u32 s48, s46, 0x80000
    buffer_load_dwordx4 v24, s[24:27], s48 offen  lds
    s_add_u32 m0, s45, 5120
    s_add_u32 s48, s46, 0xa0000
    buffer_load_dwordx4 v24, s[24:27], s48 offen  lds
    s_add_u32 m0, s45, 6144
    s_add_u32 s48, s46, 0xc0000
    buffer_load_dwordx4 v24, s[24:27], s48 offen  lds
    s_add_u32 m0, s45, 7168
    s_add_u32 s48, s46, 0xe0000
    buffer_load_dwordx4 v24, s[24:27], s48 offen  lds
    s_add_u32 m0, s45, 8192
    s_add_u32 s48, s46, 0x100000
    buffer_load_dwordx4 v24, s[24:27], s48 offen  lds
    s_add_u32 m0, s45, 9216
    s_add_u32 s48, s46, 0x120000
    buffer_load_dwordx4 v24, s[24:27], s48 offen  lds
    s_add_u32 m0, s45, 10240
    s_add_u32 s48, s46, 0x140000
    buffer_load_dwordx4 v24, s[24:27], s48 offen  lds
    s_add_u32 m0, s45, 11264
    s_add_u32 s48, s46, 0x160000
    buffer_load_dwordx4 v24, s[24:27], s48 offen  lds
    s_add_u32 m0, s45, 12288
    s_add_u32 s48, s46, 0x180000
    buffer_load_dwordx4 v24, s[24:27], s48 offen  lds
    s_add_u32 m0, s45, 13312
    s_add_u32 s48, s46, 0x1a0000
    buffer_load_dwordx4 v24, s[24:27], s48 offen  lds
    s_add_u32 m0, s45, 14336
    s_add_u32 s48, s46, 0x1c0000
    buffer_load_dwordx4 v24, s[24:27], s48 offen  lds
    s_add_u32 m0, s45, 15360
    s_add_u32 s48, s46, 0x1e0000
    buffer_load_dwordx4 v24, s[24:27], s48 offen  lds
    s_add_u32 s45, s45, 0x10000
    s_add_u32 m0, s45, 0
    s_add_u32 s48, s46, 0x0
    buffer_load_dwordx4 v24, s[28:31], s48 offen  lds
    s_add_u32 m0, s45, 1024
    s_add_u32 s48, s46, 0x20000
    buffer_load_dwordx4 v24, s[28:31], s48 offen  lds
    s_add_u32 m0, s45, 2048
    s_add_u32 s48, s46, 0x40000
    buffer_load_dwordx4 v24, s[28:31], s48 offen  lds
    s_add_u32 m0, s45, 3072
    s_add_u32 s48, s46, 0x60000
    buffer_load_dwordx4 v24, s[28:31], s48 offen  lds
    s_add_u32 m0, s45, 4096
    s_add_u32 s48, s46, 0x80000
    buffer_load_dwordx4 v24, s[28:31], s48 offen  lds
    s_add_u32 m0, s45, 5120
    s_add_u32 s48, s46, 0xa0000
    buffer_load_dwordx4 v24, s[28:31], s48 offen  lds
    s_add_u32 m0, s45, 6144
    s_add_u32 s48, s46, 0xc0000
    buffer_load_dwordx4 v24, s[28:31], s48 offen  lds
    s_add_u32 m0, s45, 7168
    s_add_u32 s48, s46, 0xe0000
    buffer_load_dwordx4 v24, s[28:31], s48 offen  lds
    s_add_u32 m0, s45, 8192
    s_add_u32 s48, s46, 0x100000
    buffer_load_dwordx4 v24, s[28:31], s48 offen  lds
    s_add_u32 m0, s45, 9216
    s_add_u32 s48, s46, 0x120000
    buffer_load_dwordx4 v24, s[28:31], s48 offen  lds
    s_add_u32 m0, s45, 10240
    s_add_u32 s48, s46, 0x140000
    buffer_load_dwordx4 v24, s[28:31], s48 offen  lds
    s_add_u32 m0, s45, 11264
    s_add_u32 s48, s46, 0x160000
    buffer_load_dwordx4 v24, s[28:31], s48 offen  lds
    s_add_u32 m0, s45, 12288
    s_add_u32 s48, s46, 0x180000
    buffer_load_dwordx4 v24, s[28:31], s48 offen  lds
    s_add_u32 m0, s45, 13312
    s_add_u32 s48, s46, 0x1a0000
    buffer_load_dwordx4 v24, s[28:31], s48 offen  lds
    s_add_u32 m0, s45, 14336
    s_add_u32 s48, s46, 0x1c0000
    buffer_load_dwordx4 v24, s[28:31], s48 offen  lds
    s_add_u32 m0, s45, 15360
    s_add_u32 s48, s46, 0x1e0000
    buffer_load_dwordx4 v24, s[28:31], s48 offen  lds
    s_add_u32 s45, s45, 0x10000
    s_waitcnt vmcnt(0)
    s_barrier
    s_cmp_lg_u32 s44, 0
    s_cbranch_scc1 L_zwok_189
    v_and_b32 v16, 7, v1
    v_lshlrev_b32 v16, 5, v16
    s_mov_b32 s70, 0
L_zw_188:
    buffer_load_dword v17, v16, s[16:19], 0 offen sc1
    s_waitcnt vmcnt(0)
    v_add_u32_dpp v17, v17, v17 row_ror:1 row_mask:0xf bank_mask:0xf
    s_nop 1
    v_add_u32_dpp v17, v17, v17 row_ror:2 row_mask:0xf bank_mask:0xf
    s_nop 1
    v_add_u32_dpp v17, v17, v17 row_ror:4 row_mask:0xf bank_mask:0xf
    v_cmp_ne_u32 vcc, 0x100, v17
    s_add_u32 s70, s70, 1
    s_cbranch_vccz L_zwok_189
    s_sleep 4
    s_cmp_lt_u32 s70, 524288
    s_cbranch_scc1 L_zw_188
    s_branch L_c_done_1
L_zwok_189:
    s_cmp_lg_u32 s44, 0
    s_cbranch_scc1 L_c_nr_190
    s_or_b32 s47, s39, 0x100
    v_mov_b32 v16, s47
    s_lshl_b32 s52, s40, 6
    s_lshl_b32 s53, s41, 2
    s_add_u32 s52, s52, s53
    s_add_u32 s52, s52, 0x101000
    v_mov_b32 v17, 0
    s_mov_b64 exec, 1
    buffer_store_dword v16, v17, s[12:15], s52 offen sc1
    s_mov_b64 exec, -1
L_c_nr_190:
    ds_read_b64_tr_b16 a[0:1], v20 offset:0
    ds_read_b64_tr_b16 a[2:3], v20 offset:256
    ds_read_b64_tr_b16 a[4:5], v20 offset:2048
    ds_read_b64_tr_b16 a[6:7], v20 offset:2304
    ds_read_b64_tr_b16 a[8:9], v20 offset:4096
    ds_read_b64_tr_b16 a[10:11], v20 offset:4352
    ds_read_b64_tr_b16 a[12:13], v20 offset:6144
    ds_read_b64_tr_b16 a[14:15], v20 offset:6400
    s_waitcnt lgkmcnt(0)
    ds_read_b64_tr_b16 a[16:17], v20 offset:8192
    ds_read_b64_tr_b16 a[18:19], v20 offset:8448
    ds_read_b64_tr_b16 a[20:21], v20 offset:10240
    ds_read_b64_tr_b16 a[22:23], v20 offset:10496
    ds_read_b64_tr_b16 a[24:25], v20 offset:12288
    ds_read_b64_tr_b16 a[26:27], v20 offset:12544
    ds_read_b64_tr_b16 a[28:29], v20 offset:14336
    ds_read_b64_tr_b16 a[30:31], v20 offset:14592
    s_waitcnt lgkmcnt(0)
    ds_read_b64_tr_b16 a[32:33], v20 offset:16384
    ds_read_b64_tr_b16 a[34:35], v20 offset:16640
    ds_read_b64_tr_b16 a[36:37], v20 offset:18432
    ds_read_b64_tr_b16 a[38:39], v20 offset:18688
    ds_read_b64_tr_b16 a[40:41], v20 offset:20480
    ds_read_b64_tr_b16 a[42:43], v20 offset:20736
    ds_read_b64_tr_b16 a[44:45], v20 offset:22528
    ds_read_b64_tr_b16 a[46:47], v20 offset:22784
    s_waitcnt lgkmcnt(0)
    ds_read_b64_tr_b16 a[48:49], v20 offset:24576
    ds_read_b64_tr_b16 a[50:51], v20 offset:24832
    ds_read_b64_tr_b16 a[52:53], v20 offset:26624
    ds_read_b64_tr_b16 a[54:55], v20 offset:26880
    ds_read_b64_tr_b16 a[56:57], v20 offset:28672
    ds_read_b64_tr_b16 a[58:59], v20 offset:28928
    ds_read_b64_tr_b16 a[60:61], v20 offset:30720
    ds_read_b64_tr_b16 a[62:63], v20 offset:30976
    s_waitcnt lgkmcnt(0)
    ds_read_b64_tr_b16 a[64:65], v20 offset:32768
    ds_read_b64_tr_b16 a[66:67], v20 offset:33024
    ds_read_b64_tr_b16 a[68:69], v20 offset:34816
    ds_read_b64_tr_b16 a[70:71], v20 offset:35072
    ds_read_b64_tr_b16 a[72:73], v20 offset:36864
    ds_read_b64_tr_b16 a[74:75], v20 offset:37120
    ds_read_b64_tr_b16 a[76:77], v20 offset:38912
    ds_read_b64_tr_b16 a[78:79], v20 offset:39168
    s_waitcnt lgkmcnt(0)
    ds_read_b64_tr_b16 a[80:81], v20 offset:40960
    ds_read_b64_tr_b16 a[82:83], v20 offset:41216
    ds_read_b64_tr_b16 a[84:85], v20 offset:43008
    ds_read_b64_tr_b16 a[86:87], v20 offset:43264
    ds_read_b64_tr_b16 a[88:89], v20 offset:45056
    ds_read_b64_tr_b16 a[90:91], v20 offset:45312
    ds_read_b64_tr_b16 a[92:93], v20 offset:47104
    ds_read_b64_tr_b16 a[94:95], v20 offset:47360
    s_waitcnt lgkmcnt(0)
    ds_read_b64_tr_b16 a[96:97], v20 offset:49152
    ds_read_b64_tr_b16 a[98:99], v20 offset:49408
    ds_read_b64_tr_b16 a[100:101], v20 offset:51200
    ds_read_b64_tr_b16 a[102:103], v20 offset:51456
    ds_read_b64_tr_b16 a[104:105], v20 offset:53248
    ds_read_b64_tr_b16 a[106:107], v20 offset:53504
    ds_read_b64_tr_b16 a[108:109], v20 offset:55296
    ds_read_b64_tr_b16 a[110:111], v20 offset:55552
    s_waitcnt lgkmcnt(0)
    ds_read_b64_tr_b16 a[112:113], v20 offset:57344
    ds_read_b64_tr_b16 a[114:115], v20 offset:57600
    ds_read_b64_tr_b16 a[116:117], v20 offset:59392
    ds_read_b64_tr_b16 a[118:119], v20 offset:59648
    ds_read_b64_tr_b16 a[120:121], v20 offset:61440
    ds_read_b64_tr_b16 a[122:123], v20 offset:61696
    ds_read_b64_tr_b16 a[124:125], v20 offset:63488
    ds_read_b64_tr_b16 a[126:127], v20 offset:63744
    s_waitcnt lgkmcnt(0)
    s_mov_b32 s63, 0
    s_barrier
    s_lshl_b32 s52, s40, 2
    s_add_u32 s52, s52, s44
    s_mul_i32 s52, s52, 24576
    s_lshl_b32 s53, s41, 9
    s_add_u32 s52, s52, s53
    s_add_u32 s52, s52, 0x2004000
    v_and_b32 v14, 3, v1
    v_lshlrev_b32 v14, 7, v14
    v_add_u32 v14, s52, v14
    s_lshl_b32 s52, s40, 16
    s_lshl_b32 s53, s41, 9
    s_add_u32 s53, s53, s52
    s_lshl_b32 s54, s44, 6
    s_add_u32 s53, s53, s54
    s_add_u32 s53, s53, 0x7080000
    v_lshlrev_b32 v4, 3, v106
    v_lshl_add_u32 v10, v102, 6, v4
    v_lshl_add_u32 v4, v101, 7, v4
    v_add_u32 v4, s53, v4
    v_mov_b32 v54, 0xfffefffe
    v_mov_b32 v56, 0
    v_mov_b32 v57, 0
    v_mov_b32 v58, 0
    v_mov_b32 v59, 0
    s_lshl_b32 s53, s41, 7
    s_add_u32 s53, s53, s52
    s_add_u32 s53, s53, 0x7180000
    v_add_u32 v10, s53, v10
    s_cmp_ge_u32 s44, 2
    s_cselect_b64 vcc, -1, 0
    v_cndmask_b32 v4, v4, v10, vcc
    s_mul_i32 s52, s49, 24576
    s_lshl_b32 s53, s44, 12
    s_add_u32 s52, s52, s53
    s_lshl_b32 s53, s43, 10
    s_add_u32 s52, s52, s53
    s_add_u32 s52, s52, 0x2002000
    v_add_u32 v6, s52, v2
    v_lshrrev_b32 v10, 3, v1
    v_lshlrev_b32 v10, 8, v10
    v_lshl_add_u32 v10, v106, 4, v10
    v_add_u32 v10, 61568, v10
    v_add_u32 v11, 27648, v2
    v_cmp_gt_u32 s[52:53], 32, v1
    s_nop 1
    v_cndmask_b32 v10, v11, v10, s[52:53]
    v_cndmask_b32 v6, v6, v10, vcc
    v_mov_b32 v24, -1
    v_mov_b32 v25, -1
    v_mov_b32 v26, -1
    v_mov_b32 v27, -1
    s_and_b32 s52, s40, 1
    s_lshl_b32 s52, s52, 14
    s_lshl_b32 s53, s41, 10
    s_add_u32 s52, s52, s53
    s_lshl_b32 s53, s50, 9
    s_add_u32 s52, s52, s53
    s_lshl_b32 s53, s51, 7
    s_add_u32 s52, s52, s53
    s_add_u32 s52, s52, 0x7a0000
    v_mov_b32 v46, s52
    v_add_u32 v44, 65536, v2
    s_lshl_b32 s52, s50, 10
    s_add_u32 s52, s52, 62464
    v_add_u32 v31, s52, v2
    s_lshl_b32 s53, s51, 9
    s_add_u32 s52, s52, s53
    v_lshlrev_b32 v45, 4, v100
    v_lshl_add_u32 v45, v103, 8, v45
    v_lshl_add_u32 v45, v102, 3, v45
    v_add_u32 v45, s52, v45
    s_mul_i32 s52, s49, 24576
    s_lshl_b32 s53, s50, 13
    s_add_u32 s52, s52, s53
    s_lshl_b32 s53, s43, 10
    s_add_u32 s52, s52, s53
    s_add_u32 s52, s52, 0x4b80000
    v_add_u32 v13, s52, v2
    v_mov_b32 v29, 26644
    v_mov_b32 v30, 0
    ds_write_b32 v29, v30
    v_mov_b32 v30, 1
    s_lshl_b32 s58, s40, 11
    s_lshl_b32 s53, s44, 7
    s_add_u32 s58, s58, s53
    s_add_u32 s58, s58, 0x10a600
    s_mov_b32 s69, 0
    v_mov_b32 v0, 0
    s_cmp_ge_u32 s44, 2
    s_cselect_b32 s50, 0, 0x00ff00ff
    s_mov_b32 s51, 0x00ff00ff
    s_xor_b32 s45, s44, 2
    s_xor_b32 s46, s41, 6
    s_or_b32 s45, s45, s46
    s_cbranch_scc1 L_c_join_187_p
    s_lshl_b32 s45, s40, 21
    s_add_u32 s45, s45, 0x79c0000
    v_and_b32 v10, 31, v1
    v_lshlrev_b32 v10, 4, v10
    v_lshl_add_u32 v10, v103, 13, v10
    buffer_store_dwordx4 v[24:27], v10, s[12:15], s45 offen sc1
    s_add_u32 s46, s45, 0x1000
    s_load_dword s47, s[22:23], s46
    s_mov_b32 s60, -1
    s_mov_b32 s61, -1
    s_waitcnt vmcnt(0) lgkmcnt(0)
    s_add_u32 s46, s45, 0
    s_memtime s[84:85]
    s_waitcnt lgkmcnt(0)
    s_load_dword s47, s[22:23], s46
    s_waitcnt lgkmcnt(0)
    s_memtime s[86:87]
    s_waitcnt lgkmcnt(0)
    s_sub_u32 s86, s86, s84
    s_min_u32 s60, s60, s86
    s_add_u32 s46, s45, 8192
    s_memtime s[84:85]
    s_waitcnt lgkmcnt(0)
    s_load_dword s47, s[22:23], s46
    s_waitcnt lgkmcnt(0)
    s_memtime s[86:87]
    s_waitcnt lgkmcnt(0)
    s_sub_u32 s86, s86, s84
    s_min_u32 s61, s61, s86
    s_add_u32 s46, s45, 128
    s_memtime s[84:85]
    s_waitcnt lgkmcnt(0)
    s_load_dword s47, s[22:23], s46
    s_waitcnt lgkmcnt(0)
    s_memtime s[86:87]
    s_waitcnt lgkmcnt(0)
    s_sub_u32 s86, s86, s84
    s_min_u32 s60, s60, s86
    s_add_u32 s46, s45, 8320
    s_memtime s[84:85]
    s_waitcnt lgkmcnt(0)
    s_load_dword s47, s[22:23], s46
    s_waitcnt lgkmcnt(0)
    s_memtime s[86:87]
    s_waitcnt lgkmcnt(0)
    s_sub_u32 s86, s86, s84
    s_min_u32 s61, s61, s86
    s_add_u32 s46, s45, 256
    s_memtime s[84:85]
    s_waitcnt lgkmcnt(0)
    s_load_dword s47, s[22:23], s46
    s_waitcnt lgkmcnt(0)
    s_memtime s[86:87]
    s_waitcnt lgkmcnt(0)
    s_sub_u32 s86, s86, s84
    s_min_u32 s60, s60, s86
    s_add_u32 s46, s45, 8448
    s_memtime s[84:85]
    s_waitcnt lgkmcnt(0)
    s_load_dword s47, s[22:23], s46
    s_waitcnt lgkmcnt(0)
    s_memtime s[86:87]
    s_waitcnt lgkmcnt(0)
    s_sub_u32 s86, s86, s84
    s_min_u32 s61, s61, s86
    s_add_u32 s46, s45, 384
    s_memtime s[84:85]
    s_waitcnt lgkmcnt(0)
    s_load_dword s47, s[22:23], s46
    s_waitcnt lgkmcnt(0)
    s_memtime s[86:87]
    s_waitcnt lgkmcnt(0)
    s_sub_u32 s86, s86, s84
    s_min_u32 s60, s60, s86
    s_add_u32 s46, s45, 8576
    s_memtime s[84:85]
    s_waitcnt lgkmcnt(0)
    s_load_dword s47, s[22:23], s46
    s_waitcnt lgkmcnt(0)
    s_memtime s[86:87]
    s_waitcnt lgkmcnt(0)
    s_sub_u32 s86, s86, s84
    s_min_u32 s61, s61, s86
    s_cmp_gt_u32 s60, s61
    s_cselect_b32 s45, 3, 2
    v_mov_b32 v10, s45
    v_mov_b32 v11, 0
    s_lshl_b32 s45, s40, 7
    s_add_u32 s45, s45, 0x101800
    s_mov_b64 exec, 1
    buffer_store_dword v10, v11, s[12:15], s45 offen sc1
    s_mov_b64 exec, -1
L_c_join_187_p:
    s_setprio 1
    s_branch L_c_join_187
L_v_init_186:
    s_sub_u32 s54, s44, 4
    s_lshr_b32 s51, s54, 1
    s_and_b32 s50, s54, 1
    s_load_dwordx4 s[4:7], s[0:1], 32
    s_load_dwordx2 s[8:9], s[0:1], 8
    s_waitcnt lgkmcnt(0)
    s_mov_b32 s24, s4
    s_and_b32 s25, s5, 0xffff
    s_mov_b32 s26, 0x800000
    s_mov_b32 s27, 0x00020000
    s_mov_b32 s28, s6
    s_and_b32 s29, s7, 0xffff
    s_mov_b32 s30, 0x800000
    s_mov_b32 s31, 0x00020000
    s_mov_b32 s32, s8
    s_and_b32 s33, s9, 0xffff
    s_mov_b32 s34, 0x4000
    s_mov_b32 s35, 0x00020000
    s_lshl_b32 s45, s54, 12
    s_add_u32 s45, s45, 0x20000
    v_add_u32 v20, s45, v20
    v_add_u32 v21, s45, v21
    v_add_u32 v22, s45, v2
    s_lshl_b32 s46, s49, 8
    s_lshl_b32 s48, s43, 6
    s_add_u32 s46, s46, s48
    s_lshl_b32 s48, s54, 21
    s_add_u32 s46, s46, s48
    s_add_u32 s48, s46, 0x0
    buffer_load_dwordx4 a[0:3], v24, s[24:27], s48 offen
    s_add_u32 s48, s46, 0x20000
    buffer_load_dwordx4 a[32:35], v24, s[24:27], s48 offen
    s_add_u32 s48, s46, 0x40000
    buffer_load_dwordx4 a[4:7], v24, s[24:27], s48 offen
    s_add_u32 s48, s46, 0x60000
    buffer_load_dwordx4 a[36:39], v24, s[24:27], s48 offen
    s_add_u32 s48, s46, 0x80000
    buffer_load_dwordx4 a[8:11], v24, s[24:27], s48 offen
    s_add_u32 s48, s46, 0xa0000
    buffer_load_dwordx4 a[40:43], v24, s[24:27], s48 offen
    s_add_u32 s48, s46, 0xc0000
    buffer_load_dwordx4 a[12:15], v24, s[24:27], s48 offen
    s_add_u32 s48, s46, 0xe0000
    buffer_load_dwordx4 a[44:47], v24, s[24:27], s48 offen
    s_add_u32 s48, s46, 0x100000
    buffer_load_dwordx4 a[16:19], v24, s[24:27], s48 offen
    s_add_u32 s48, s46, 0x120000
    buffer_load_dwordx4 a[48:51], v24, s[24:27], s48 offen
    s_add_u32 s48, s46, 0x140000
    buffer_load_dwordx4 a[20:23], v24, s[24:27], s48 offen
    s_add_u32 s48, s46, 0x160000
    buffer_load_dwordx4 a[52:55], v24, s[24:27], s48 offen
    s_add_u32 s48, s46, 0x180000
    buffer_load_dwordx4 a[24:27], v24, s[24:27], s48 offen
    s_add_u32 s48, s46, 0x1a0000
    buffer_load_dwordx4 a[56:59], v24, s[24:27], s48 offen
    s_add_u32 s48, s46, 0x1c0000
    buffer_load_dwordx4 a[28:31], v24, s[24:27], s48 offen
    s_add_u32 s48, s46, 0x1e0000
    buffer_load_dwordx4 a[60:63], v24, s[24:27], s48 offen
    s_lshl_b32 s52, s40, 15
    s_lshl_b32 s53, s42, 11
    s_add_u32 s52, s52, s53
    s_lshl_b32 s53, s43, 9
    s_add_u32 s52, s52, s53
    s_lshl_b32 s53, s51, 8
    s_add_u32 s52, s52, s53
    s_add_u32 s52, s52, 0x7100000
    v_bfe_u32 v4, v1, 1, 1
    v_lshlrev_b32 v4, 7, v4
    v_lshl_add_u32 v4, v104, 4, v4
    v_and_b32 v5, 12, v100
    v_add_u32 v4, v4, v5
    v_add_u32 v4, s52, v4
    v_mov_b32 v26, -1
    s_lshl_b32 s52, s51, 5
    s_add_u32 s52, s52, 28160
    v_and_b32 v5, 14, v100
    v_lshlrev_b32 v5, 1, v5
    v_lshl_add_u32 v5, v104, 6, v5
    v_add_u32 v5, s52, v5
    s_lshl_b32 s52, s41, 14
    s_lshl_b32 s53, s54, 11
    s_add_u32 s52, s52, s53
    s_add_u32 s52, s52, 0x7800000
    v_lshlrev_b32 v6, 3, v101
    v_lshl_add_u32 v6, v106, 5, v6
    v_and_b32 v7, 3, v1
    v_lshlrev_b32 v7, 3, v7
    v_bfe_u32 v30, v1, 2, 3
    v_lshl_add_u32 v7, v30, 5, v7
    v_lshl_add_u32 v7, v103, 2, v7
    v_add_u32 v7, s52, v7
    s_lshl_b32 s53, s40, 8
    s_add_u32 s52, s52, s53
    v_add_u32 v6, s52, v6
    v_lshlrev_b32 v30, 4, v100
    v_lshl_add_u32 v30, v101, 18, v30
    v_add_u32 v30, s52, v30
    v_mov_b32 v32, -1
    v_mov_b32 v33, -1
    v_mov_b32 v34, -1
    v_mov_b32 v35, -1
    buffer_store_dwordx4 v[32:35], v30, s[12:15], 0 offen sc1
    s_mov_b32 s53, 8192
    buffer_store_dwordx4 v[32:35], v30, s[12:15], s53 offen sc1
    s_lshl_b32 s55, s40, 16
    s_add_u32 s55, s55, 0x7000000
    s_lshl_b32 s52, s41, 10
    s_lshl_b32 s53, s54, 8
    s_add_u32 s52, s52, s53
    s_add_u32 s52, s52, s55
    v_lshlrev_b32 v8, 2, v1
    v_add_u32 v8, s52, v8
    s_lshl_b32 s53, s54, 12
    v_add_u32 v10, s53, v2
    v_add_u32 v9, s55, v10
    s_lshl_b32 s52, s40, 15
    s_lshl_b32 s53, s54, 11
    s_add_u32 s52, s52, s53
    s_add_u32 s52, s52, 0x7100000
    v_add_u32 v11, s52, v2
    s_lshl_b32 s52, s54, 9
    s_add_u32 s52, s52, 53248
    v_lshlrev_b32 v12, 4, v100
    v_lshl_add_u32 v12, v102, 3, v12
    v_lshl_add_u32 v12, v103, 8, v12
    v_add_u32 v12, s52, v12
    s_lshl_b32 s52, s51, 3
    s_add_u32 s52, s52, 49152
    v_add_u32 v13, s52, v2
    s_lshl_b32 s52, s54, 10
    s_add_u32 s52, s52, 49152
    v_add_u32 v14, s52, v2
    s_lshl_b32 s52, s40, 2
    s_add_u32 s52, s52, s54
    s_mul_i32 s52, s52, 24576
    s_add_u32 s52, s52, 0x2004000
    v_add_u32 v15, s52, v2
    s_lshl_b32 s52, s54, 10
    v_add_u32 v27, s52, v2
    v_lshlrev_b32 v30, 11, v106
    v_lshl_add_u32 v30, v101, 5, v30
    v_lshl_add_u32 v30, v107, 2, v30
    s_lshl_b32 s52, s54, 9
    buffer_load_dword v112, v30, s[32:35], s52 offen offset:0
    buffer_load_dword v113, v30, s[32:35], s52 offen offset:8
    buffer_load_dword v114, v30, s[32:35], s52 offen offset:16
    buffer_load_dword v115, v30, s[32:35], s52 offen offset:24
    buffer_load_dword v116, v30, s[32:35], s52 offen offset:128
    buffer_load_dword v117, v30, s[32:35], s52 offen offset:136
    buffer_load_dword v118, v30, s[32:35], s52 offen offset:144
    buffer_load_dword v119, v30, s[32:35], s52 offen offset:152
    buffer_load_dword v120, v30, s[32:35], s52 offen offset:256
    buffer_load_dword v121, v30, s[32:35], s52 offen offset:264
    buffer_load_dword v122, v30, s[32:35], s52 offen offset:272
    buffer_load_dword v123, v30, s[32:35], s52 offen offset:280
    buffer_load_dword v124, v30, s[32:35], s52 offen offset:384
    buffer_load_dword v125, v30, s[32:35], s52 offen offset:392
    buffer_load_dword v126, v30, s[32:35], s52 offen offset:400
    buffer_load_dword v127, v30, s[32:35], s52 offen offset:408
    s_lshl_b32 s46, s40, 2
    s_add_u32 s46, s46, s54
    s_lshl_b32 s46, s46, 18
    s_lshl_b32 s48, s41, 7
    s_add_u32 s46, s46, s48
    s_add_u32 s48, s46, 0x0
    buffer_load_dwordx4 a[64:67], v25, s[28:31], s48 offen
    s_add_u32 s48, s46, 0x4000
    buffer_load_dwordx4 a[80:83], v25, s[28:31], s48 offen
    s_add_u32 s48, s46, 0x8000
    buffer_load_dwordx4 a[96:99], v25, s[28:31], s48 offen
    s_add_u32 s48, s46, 0xc000
    buffer_load_dwordx4 a[112:115], v25, s[28:31], s48 offen
    s_add_u32 s48, s46, 0x10000
    buffer_load_dwordx4 a[68:71], v25, s[28:31], s48 offen
    s_add_u32 s48, s46, 0x14000
    buffer_load_dwordx4 a[84:87], v25, s[28:31], s48 offen
    s_add_u32 s48, s46, 0x18000
    buffer_load_dwordx4 a[100:103], v25, s[28:31], s48 offen
    s_add_u32 s48, s46, 0x1c000
    buffer_load_dwordx4 a[116:119], v25, s[28:31], s48 offen
    s_add_u32 s48, s46, 0x20000
    buffer_load_dwordx4 a[72:75], v25, s[28:31], s48 offen
    s_add_u32 s48, s46, 0x24000
    buffer_load_dwordx4 a[88:91], v25, s[28:31], s48 offen
    s_add_u32 s48, s46, 0x28000
    buffer_load_dwordx4 a[104:107], v25, s[28:31], s48 offen
    s_add_u32 s48, s46, 0x2c000
    buffer_load_dwordx4 a[120:123], v25, s[28:31], s48 offen
    s_add_u32 s48, s46, 0x30000
    buffer_load_dwordx4 a[76:79], v25, s[28:31], s48 offen
    s_add_u32 s48, s46, 0x34000
    buffer_load_dwordx4 a[92:95], v25, s[28:31], s48 offen
    s_add_u32 s48, s46, 0x38000
    buffer_load_dwordx4 a[108:111], v25, s[28:31], s48 offen
    s_add_u32 s48, s46, 0x3c000
    buffer_load_dwordx4 a[124:127], v25, s[28:31], s48 offen
    s_waitcnt vmcnt(16)
    ds_write_b128 v22, a[0:3] offset:0
    ds_write_b128 v22, a[32:35] offset:1024
    ds_write_b128 v22, a[4:7] offset:2048
    ds_write_b128 v22, a[36:39] offset:3072
    s_waitcnt lgkmcnt(0)
    ds_read_b64_tr_b16 a[0:1], v20 offset:0
    ds_read_b64_tr_b16 a[2:3], v20 offset:256
    ds_read_b64_tr_b16 a[32:33], v20 offset:32
    ds_read_b64_tr_b16 a[34:35], v20 offset:288
    ds_read_b64_tr_b16 a[4:5], v20 offset:2048
    ds_read_b64_tr_b16 a[6:7], v20 offset:2304
    ds_read_b64_tr_b16 a[36:37], v20 offset:2080
    ds_read_b64_tr_b16 a[38:39], v20 offset:2336
    s_waitcnt lgkmcnt(0)
    ds_write_b128 v22, a[8:11] offset:0
    ds_write_b128 v22, a[40:43] offset:1024
    ds_write_b128 v22, a[12:15] offset:2048
    ds_write_b128 v22, a[44:47] offset:3072
    s_waitcnt lgkmcnt(0)
    ds_read_b64_tr_b16 a[8:9], v20 offset:0
    ds_read_b64_tr_b16 a[10:11], v20 offset:256
    ds_read_b64_tr_b16 a[40:41], v20 offset:32
    ds_read_b64_tr_b16 a[42:43], v20 offset:288
    ds_read_b64_tr_b16 a[12:13], v20 offset:2048
    ds_read_b64_tr_b16 a[14:15], v20 offset:2304
    ds_read_b64_tr_b16 a[44:45], v20 offset:2080
    ds_read_b64_tr_b16 a[46:47], v20 offset:2336
    s_waitcnt lgkmcnt(0)
    ds_write_b128 v22, a[16:19] offset:0
    ds_write_b128 v22, a[48:51] offset:1024
    ds_write_b128 v22, a[20:23] offset:2048
    ds_write_b128 v22, a[52:55] offset:3072
    s_waitcnt lgkmcnt(0)
    ds_read_b64_tr_b16 a[16:17], v20 offset:0
    ds_read_b64_tr_b16 a[18:19], v20 offset:256
    ds_read_b64_tr_b16 a[48:49], v20 offset:32
    ds_read_b64_tr_b16 a[50:51], v20 offset:288
    ds_read_b64_tr_b16 a[20:21], v20 offset:2048
    ds_read_b64_tr_b16 a[22:23], v20 offset:2304
    ds_read_b64_tr_b16 a[52:53], v20 offset:2080
    ds_read_b64_tr_b16 a[54:55], v20 offset:2336
    s_waitcnt lgkmcnt(0)
    ds_write_b128 v22, a[24:27] offset:0
    ds_write_b128 v22, a[56:59] offset:1024
    ds_write_b128 v22, a[28:31] offset:2048
    ds_write_b128 v22, a[60:63] offset:3072
    s_waitcnt lgkmcnt(0)
    ds_read_b64_tr_b16 a[24:25], v20 offset:0
    ds_read_b64_tr_b16 a[26:27], v20 offset:256
    ds_read_b64_tr_b16 a[56:57], v20 offset:32
    ds_read_b64_tr_b16 a[58:59], v20 offset:288
    ds_read_b64_tr_b16 a[28:29], v20 offset:2048
    ds_read_b64_tr_b16 a[30:31], v20 offset:2304
    ds_read_b64_tr_b16 a[60:61], v20 offset:2080
    ds_read_b64_tr_b16 a[62:63], v20 offset:2336
    s_waitcnt lgkmcnt(0)
    s_barrier
    s_waitcnt vmcnt(0)
    ds_write_b128 v22, a[64:67] offset:0
    ds_write_b128 v22, a[80:83] offset:1024
    ds_write_b128 v22, a[96:99] offset:2048
    ds_write_b128 v22, a[112:115] offset:3072
    s_waitcnt lgkmcnt(0)
    ds_read_b64_tr_b16 a[64:65], v21 offset:0
    ds_read_b64_tr_b16 a[66:67], v21 offset:512
    ds_read_b64_tr_b16 a[80:81], v21 offset:32
    ds_read_b64_tr_b16 a[82:83], v21 offset:544
    ds_read_b64_tr_b16 a[96:97], v21 offset:64
    ds_read_b64_tr_b16 a[98:99], v21 offset:576
    ds_read_b64_tr_b16 a[112:113], v21 offset:96
    ds_read_b64_tr_b16 a[114:115], v21 offset:608
    s_waitcnt lgkmcnt(0)
    ds_write_b128 v22, a[68:71] offset:0
    ds_write_b128 v22, a[84:87] offset:1024
    ds_write_b128 v22, a[100:103] offset:2048
    ds_write_b128 v22, a[116:119] offset:3072
    s_waitcnt lgkmcnt(0)
    ds_read_b64_tr_b16 a[68:69], v21 offset:0
    ds_read_b64_tr_b16 a[70:71], v21 offset:512
    ds_read_b64_tr_b16 a[84:85], v21 offset:32
    ds_read_b64_tr_b16 a[86:87], v21 offset:544
    ds_read_b64_tr_b16 a[100:101], v21 offset:64
    ds_read_b64_tr_b16 a[102:103], v21 offset:576
    ds_read_b64_tr_b16 a[116:117], v21 offset:96
    ds_read_b64_tr_b16 a[118:119], v21 offset:608
    s_waitcnt lgkmcnt(0)
    ds_write_b128 v22, a[72:75] offset:0
    ds_write_b128 v22, a[88:91] offset:1024
    ds_write_b128 v22, a[104:107] offset:2048
    ds_write_b128 v22, a[120:123] offset:3072
    s_waitcnt lgkmcnt(0)
    ds_read_b64_tr_b16 a[72:73], v21 offset:0
    ds_read_b64_tr_b16 a[74:75], v21 offset:512
    ds_read_b64_tr_b16 a[88:89], v21 offset:32
    ds_read_b64_tr_b16 a[90:91], v21 offset:544
    ds_read_b64_tr_b16 a[104:105], v21 offset:64
    ds_read_b64_tr_b16 a[106:107], v21 offset:576
    ds_read_b64_tr_b16 a[120:121], v21 offset:96
    ds_read_b64_tr_b16 a[122:123], v21 offset:608
    s_waitcnt lgkmcnt(0)
    ds_write_b128 v22, a[76:79] offset:0
    ds_write_b128 v22, a[92:95] offset:1024
    ds_write_b128 v22, a[108:111] offset:2048
    ds_write_b128 v22, a[124:127] offset:3072
    s_waitcnt lgkmcnt(0)
    ds_read_b64_tr_b16 a[76:77], v21 offset:0
    ds_read_b64_tr_b16 a[78:79], v21 offset:512
    ds_read_b64_tr_b16 a[92:93], v21 offset:32
    ds_read_b64_tr_b16 a[94:95], v21 offset:544
    ds_read_b64_tr_b16 a[108:109], v21 offset:64
    ds_read_b64_tr_b16 a[110:111], v21 offset:576
    ds_read_b64_tr_b16 a[124:125], v21 offset:96
    ds_read_b64_tr_b16 a[126:127], v21 offset:608
    s_waitcnt lgkmcnt(0)
    s_mov_b32 s65, 0
    s_waitcnt vmcnt(0)
    s_barrier
    s_lshl_b32 s57, s40, 11
    s_lshl_b32 s53, s54, 7
    s_add_u32 s57, s57, s53
    s_add_u32 s57, s57, 0x10a600
    s_mov_b32 s69, 0
    s_mov_b32 s68, 0
    s_cmp_gt_u32 s69, s68
    s_cbranch_scc1 L_kv_ok_192
    s_mov_b32 s70, 0
L_kv_lp_191:
    v_and_b32 v22, 1, v1
    v_lshlrev_b32 v22, 9, v22
    buffer_load_dword v23, v22, s[12:15], s57 offen sc1
    s_waitcnt vmcnt(0)
    v_readlane_b32 s69, v23, 0
    v_readlane_b32 s45, v23, 1
    s_add_u32 s70, s70, 1
    s_nop 2
    s_min_u32 s69, s69, s45
    s_cmp_gt_u32 s69, s68
    s_cbranch_scc1 L_kv_ok_192
    s_sleep 4
    s_cmp_lt_u32 s70, 524288
    s_cbranch_scc1 L_kv_lp_191
    s_branch L_c_done_1
L_kv_ok_192:
    v_lshlrev_b32 v28, 9, v101
    v_lshl_add_u32 v28, v100, 4, v28
    s_lshl_b32 s52, s54, 13
    s_add_u32 s52, s52, 0x7a0000
    v_add_u32 v28, s52, v28
    s_lshl_b32 s59, s54, 12
    s_add_u32 s59, s59, 65536
    v_lshlrev_b32 v31, 4, v100
    v_lshl_add_u32 v31, v103, 8, v31
    v_add_u32 v31, 20480, v31
    s_lshl_b32 s52, s54, 11
    s_add_u32 s52, s52, 53248
    v_add_u32 v25, s52, v2
    v_mov_b32 v29, 26640
    v_mov_b32 v30, 0
    ds_write_b32 v29, v30
    v_mov_b32 v30, 1
    s_mov_b32 s58, 0
    s_mov_b32 s64, 0
    s_add_u32 s46, s65, 4096
    buffer_load_dwordx4 v[32:35], v15, s[12:15], s65 offen offset:0 sc1
    buffer_load_dwordx4 v[48:51], v15, s[12:15], s46 offen offset:0 sc1
    buffer_load_dwordx4 v[36:39], v15, s[12:15], s65 offen offset:1024 sc1
    buffer_load_dwordx4 v[52:55], v15, s[12:15], s46 offen offset:1024 sc1
    buffer_load_dwordx4 v[40:43], v15, s[12:15], s65 offen offset:2048 sc1
    buffer_load_dwordx4 v[56:59], v15, s[12:15], s46 offen offset:2048 sc1
    buffer_load_dwordx4 v[44:47], v15, s[12:15], s65 offen offset:3072 sc1
    buffer_load_dwordx4 v[60:63], v15, s[12:15], s46 offen offset:3072 sc1
    s_add_u32 s65, s65, 786432
    s_waitcnt vmcnt(0)
    v_mfma_f32_16x16x32_bf16 v[64:67], v[32:35], a[64:67], 0
    v_mfma_f32_16x16x32_bf16 v[68:71], v[48:51], a[64:67], 0
    v_mfma_f32_16x16x32_bf16 v[64:67], v[36:39], a[68:71], v[64:67]
    v_mfma_f32_16x16x32_bf16 v[68:71], v[52:55], a[68:71], v[68:71]
    v_mfma_f32_16x16x32_bf16 v[64:67], v[40:43], a[72:75], v[64:67]
    v_mfma_f32_16x16x32_bf16 v[68:71], v[56:59], a[72:75], v[68:71]
    v_mfma_f32_16x16x32_bf16 v[64:67], v[44:47], a[76:79], v[64:67]
    v_mfma_f32_16x16x32_bf16 v[68:71], v[60:63], a[76:79], v[68:71]
    v_mfma_f32_16x16x32_bf16 v[72:75], v[32:35], a[80:83], 0
    v_mfma_f32_16x16x32_bf16 v[76:79], v[48:51], a[80:83], 0
    v_mfma_f32_16x16x32_bf16 v[72:75], v[36:39], a[84:87], v[72:75]
    v_mfma_f32_16x16x32_bf16 v[76:79], v[52:55], a[84:87], v[76:79]
    v_mfma_f32_16x16x32_bf16 v[72:75], v[40:43], a[88:91], v[72:75]
    v_mfma_f32_16x16x32_bf16 v[76:79], v[56:59], a[88:91], v[76:79]
    v_mfma_f32_16x16x32_bf16 v[72:75], v[44:47], a[92:95], v[72:75]
    v_mfma_f32_16x16x32_bf16 v[76:79], v[60:63], a[92:95], v[76:79]
    v_cvt_pk_bf16_f32 v64, v64, v65
    v_cvt_pk_bf16_f32 v65, v66, v67
    v_cvt_pk_bf16_f32 v66, v68, v69
    v_cvt_pk_bf16_f32 v67, v70, v71
    ds_write_b128 v10, v[64:67] offset:32768
    v_mfma_f32_16x16x32_bf16 v[80:83], v[32:35], a[96:99], 0
    v_mfma_f32_16x16x32_bf16 v[84:87], v[48:51], a[96:99], 0
    v_mfma_f32_16x16x32_bf16 v[80:83], v[36:39], a[100:103], v[80:83]
    v_mfma_f32_16x16x32_bf16 v[84:87], v[52:55], a[100:103], v[84:87]
    v_mfma_f32_16x16x32_bf16 v[80:83], v[40:43], a[104:107], v[80:83]
    v_mfma_f32_16x16x32_bf16 v[84:87], v[56:59], a[104:107], v[84:87]
    v_mfma_f32_16x16x32_bf16 v[80:83], v[44:47], a[108:111], v[80:83]
    v_mfma_f32_16x16x32_bf16 v[84:87], v[60:63], a[108:111], v[84:87]
    v_cvt_pk_bf16_f32 v72, v72, v73
    v_cvt_pk_bf16_f32 v73, v74, v75
    v_cvt_pk_bf16_f32 v74, v76, v77
    v_cvt_pk_bf16_f32 v75, v78, v79
    ds_write_b128 v10, v[72:75] offset:33792
    v_mfma_f32_16x16x32_bf16 v[88:91], v[32:35], a[112:115], 0
    v_mfma_f32_16x16x32_bf16 v[92:95], v[48:51], a[112:115], 0
    v_mfma_f32_16x16x32_bf16 v[88:91], v[36:39], a[116:119], v[88:91]
    v_mfma_f32_16x16x32_bf16 v[92:95], v[52:55], a[116:119], v[92:95]
    v_mfma_f32_16x16x32_bf16 v[88:91], v[40:43], a[120:123], v[88:91]
    v_mfma_f32_16x16x32_bf16 v[92:95], v[56:59], a[120:123], v[92:95]
    v_mfma_f32_16x16x32_bf16 v[88:91], v[44:47], a[124:127], v[88:91]
    v_mfma_f32_16x16x32_bf16 v[92:95], v[60:63], a[124:127], v[92:95]
    v_cvt_pk_bf16_f32 v80, v80, v81
    v_cvt_pk_bf16_f32 v81, v82, v83
    v_cvt_pk_bf16_f32 v82, v84, v85
    v_cvt_pk_bf16_f32 v83, v86, v87
    ds_write_b128 v10, v[80:83] offset:34816
    s_nop 2
    v_cvt_pk_bf16_f32 v88, v88, v89
    v_cvt_pk_bf16_f32 v89, v90, v91
    v_cvt_pk_bf16_f32 v90, v92, v93
    v_cvt_pk_bf16_f32 v91, v94, v95
    ds_write_b128 v10, v[88:91] offset:35840
    s_mov_b64 s[66:67], 0
    s_mov_b32 s63, 0
    s_mov_b32 s68, 1
    s_cmp_gt_u32 s69, s68
    s_cbranch_scc1 L_kv_ok_194
    s_mov_b32 s70, 0
L_kv_lp_193:
    v_and_b32 v22, 1, v1
    v_lshlrev_b32 v22, 9, v22
    buffer_load_dword v23, v22, s[12:15], s57 offen sc1
    s_waitcnt vmcnt(0)
    v_readlane_b32 s69, v23, 0
    v_readlane_b32 s45, v23, 1
    s_add_u32 s70, s70, 1
    s_nop 2
    s_min_u32 s69, s69, s45
    s_cmp_gt_u32 s69, s68
    s_cbranch_scc1 L_kv_ok_194
    s_sleep 4
    s_cmp_lt_u32 s70, 524288
    s_cbranch_scc1 L_kv_lp_193
    s_branch L_c_done_1
L_kv_ok_194:
    v_lshrrev_b32 v22, 3, v1
    v_lshlrev_b32 v22, 7, v22
    s_mov_b32 s45, 0x101800
    s_mov_b32 s46, 0
    s_mov_b32 s70, 0
L_spin_195:
    buffer_load_dword v23, v22, s[12:15], s45 offen sc1
    s_waitcnt vmcnt(0)
    v_cmp_ge_u32 vcc, s46, v23
    s_add_u32 s70, s70, 1
    s_cbranch_vccz L_spok_196
    s_sleep 3
    s_cmp_lt_u32 s70, 524288
    s_cbranch_scc1 L_spin_195
    s_branch L_c_done_1
L_spok_196:
    v_cmp_eq_u32 s[66:67], 3, v23
    s_nop 3
    s_bitcmp1_b32 s66, 0
    s_cselect_b32 s63, 8192, 0
    s_waitcnt lgkmcnt(0)
    v_min_u32 v64, -2, v112
    v_min_u32 v65, -2, v113
    v_min_u32 v66, -2, v114
    v_min_u32 v67, -2, v115
    v_min_u32 v68, -2, v116
    v_min_u32 v69, -2, v117
    v_min_u32 v70, -2, v118
    v_min_u32 v71, -2, v119
    v_min_u32 v72, -2, v120
    v_min_u32 v73, -2, v121
    v_min_u32 v74, -2, v122
    v_min_u32 v75, -2, v123
    v_min_u32 v76, -2, v124
    v_min_u32 v77, -2, v125
    v_min_u32 v78, -2, v126
    v_min_u32 v79, -2, v127
    v_mov_b32 v16, 0
    v_mov_b32 v17, 0
    v_mov_b32 v18, 0
    v_mov_b32 v19, 0
    v_mov_b32 v20, 0
    v_mov_b32 v21, 0
    v_mov_b32 v22, 0
    v_mov_b32 v23, 0
L_c_join_187:
    s_mov_b32 s60, 0
    s_mov_b32 s61, 0
    s_mov_b32 s62, 0
    s_cmp_lg_u32 s44, 0
    s_cbranch_scc1 L_c_nh_197
    v_lshlrev_b32 v17, 3, v1
    s_lshl_b32 s46, s40, 3
    v_mov_b32 v21, s46
    s_mov_b32 s45, 0x101000
    s_mov_b32 s70, 0
L_c_rp_198:
    buffer_load_dwordx2 v[18:19], v17, s[12:15], s45 offen sc1
    buffer_load_dwordx2 v[22:23], v21, s[12:15], s45 offen offset:512 sc1
    s_waitcnt vmcnt(0)
    v_min3_u32 v20, v18, v19, v22
    v_min_u32 v20, v20, v23
    v_cmp_eq_u32 vcc, 0, v20
    s_cbranch_vccnz L_rt_199
    v_cmp_eq_u32 s[52:53], v18, v16
    v_cmp_eq_u32 vcc, v19, v16
    v_cmp_eq_u32 s[54:55], v22, v16
    v_cmp_eq_u32 s[56:57], v23, v16
    s_lshl_b32 s46, s40, 3
    s_nop 3
    s_and_b64 s[52:53], s[52:53], vcc
    s_lshr_b64 s[52:53], s[52:53], s46
    s_and_b32 s52, s52, 0xff
    s_cmp_eq_u32 s52, 0xff
    s_cselect_b32 s52, 1, 0
    v_mov_b32 v16, s52
    v_mov_b32 v17, 26624
    ds_write_b32 v17, v16
L_c_nh_197:
    s_waitcnt lgkmcnt(0)
    s_barrier
    v_mov_b32 v17, 26624
    ds_read_b32 v16, v17
    s_waitcnt lgkmcnt(0)
    v_readfirstlane_b32 s52, v16
    s_nop 3
    s_cmp_ge_u32 s44, 4
    s_cbranch_scc1 L_vf_202
    s_mov_b32 s57, s58
    s_mov_b32 s58, 0
    s_cmp_ge_u32 s44, 2
    s_cbranch_scc1 L_sf_200
    buffer_load_dwordx4 v[32:35], v6, s[12:15], 0 offen sc1
L_sf_200:
    s_mov_b32 s54, s52
    v_add_u32 v52, 786432, v6
    s_mul_i32 s53, s49, 24576
    s_lshl_b32 s55, s43, 11
    s_add_u32 s53, s53, s55
    s_and_b32 s55, s44, 1
    s_lshl_b32 s55, s55, 10
    s_add_u32 s53, s53, s55
    s_add_u32 s53, s53, 0x2184000
    v_and_b32 v53, 7, v1
    v_lshlrev_b32 v53, 7, v53
    v_add_u32 v53, s53, v53
    s_cmp_ge_u32 s44, 2
    s_cselect_b64 vcc, -1, 0
    s_cselect_b64 s[52:53], 0xff, -1
    v_cndmask_b32 v52, v52, v53, vcc
    s_cselect_b32 s55, 786432, 0
    v_readfirstlane_b32 s56, v52
    s_nop 3
    s_sub_u32 s56, s56, s55
    s_cmp_eq_u32 s54, 0
    s_cbranch_scc1 L_ss_201
.p2align 6
L_s_loop_204:
    v_mov_b32 v16, 0
    v_mov_b32 v17, 0
    v_mov_b32 v18, 0
    v_mov_b32 v19, 0
    s_add_u32 s58, s58, 4
    s_mov_b32 s70, 1
    s_waitcnt vmcnt(0) lgkmcnt(0)
    s_barrier
    ds_read_b128 v[64:67], v2 offset:0
    ds_read_b128 v[68:71], v2 offset:1024
    ds_read_b128 v[72:75], v2 offset:2048
    ds_read_b128 v[76:79], v2 offset:3072
    ds_read_b128 v[80:83], v2 offset:4096
    ds_read_b128 v[84:87], v2 offset:5120
    ds_read_b128 v[88:91], v2 offset:6144
    ds_read_b128 v[92:95], v2 offset:7168
    ds_read_b128 v[96:99], v2 offset:8192
    ds_read_b128 v[100:103], v2 offset:9216
    ds_read_b128 v[104:107], v2 offset:10240
    ds_read_b128 v[108:111], v2 offset:11264
    s_waitcnt lgkmcnt(11)
    v_smfmac_f32_16x16x64_bf16 v[16:19], v[64:67], a[0:7], v3
    ds_read_b128 v[112:115], v2 offset:12288
    s_waitcnt lgkmcnt(11)
    v_smfmac_f32_16x16x64_bf16 v[16:19], v[68:71], a[8:15], v3
    ds_read_b128 v[116:119], v2 offset:13312
    s_waitcnt lgkmcnt(11)
    v_smfmac_f32_16x16x64_bf16 v[16:19], v[72:75], a[16:23], v3
    ds_read_b128 v[120:123], v2 offset:14336
    s_waitcnt lgkmcnt(11)
    v_smfmac_f32_16x16x64_bf16 v[16:19], v[76:79], a[24:31], v3
    ds_read_b128 v[124:127], v2 offset:15360
    s_waitcnt lgkmcnt(11)
    v_smfmac_f32_16x16x64_bf16 v[16:19], v[80:83], a[32:39], v3
    s_waitcnt lgkmcnt(10)
    v_smfmac_f32_16x16x64_bf16 v[16:19], v[84:87], a[40:47], v3
    s_waitcnt lgkmcnt(9)
    v_smfmac_f32_16x16x64_bf16 v[16:19], v[88:91], a[48:55], v3
    s_waitcnt lgkmcnt(8)
    v_smfmac_f32_16x16x64_bf16 v[16:19], v[92:95], a[56:63], v3
    s_waitcnt lgkmcnt(7)
    v_smfmac_f32_16x16x64_bf16 v[16:19], v[96:99], a[64:71], v3
    s_waitcnt lgkmcnt(6)
    v_smfmac_f32_16x16x64_bf16 v[16:19], v[100:103], a[72:79], v3
    s_waitcnt lgkmcnt(5)
    v_smfmac_f32_16x16x64_bf16 v[16:19], v[104:107], a[80:87], v3
    s_waitcnt lgkmcnt(4)
    v_smfmac_f32_16x16x64_bf16 v[16:19], v[108:111], a[88:95], v3
    s_waitcnt lgkmcnt(3)
    v_smfmac_f32_16x16x64_bf16 v[16:19], v[112:115], a[96:103], v3
    s_waitcnt lgkmcnt(2)
    v_smfmac_f32_16x16x64_bf16 v[16:19], v[116:119], a[104:111], v3
    s_waitcnt lgkmcnt(1)
    v_smfmac_f32_16x16x64_bf16 v[16:19], v[120:123], a[112:119], v3
    s_waitcnt lgkmcnt(0)
    v_smfmac_f32_16x16x64_bf16 v[16:19], v[124:127], a[120:127], v3
    s_nop 7
    v_permlane32_swap_b32 v16, v18
    v_permlane32_swap_b32 v17, v19
    v_add_f32 v16, v16, v18
    v_add_f32 v17, v17, v19
    v_cvt_pk_bf16_f32 v16, v16, v17
    ds_write_b16 v5, v16
    ds_write_b16_d16_hi v5, v16 offset:16
    s_mov_b64 exec, 1
    ds_add_u32 v29, v30
    s_mov_b64 exec, -1
L_s_xl_206:
    ds_read_b32 v10, v29
    ds_read_b128 v[64:67], v2 offset:61440
    s_cmp_eq_u32 s60, 63
    s_cbranch_scc1 L_s_last_205
    s_cmp_ge_u32 s44, 2
    s_cbranch_scc1 L_s_w2_207
    s_waitcnt lgkmcnt(0)
    v_mfma_f32_16x16x32_bf16 v[16:19], v[32:35], v[64:67], 0
L_s_w2_207_b:
    v_cmp_ne_u32 vcc, s58, v10
    s_nop 0
    s_cbranch_vccnz L_rt_209
    s_mov_b64 exec, s[50:51]
    s_nop 3
    v_cvt_pk_bf16_f32 v16, v16, v17
    v_cvt_pk_bf16_f32 v17, v18, v19
    v_pk_min_u16 v16, v16, v54
    v_pk_min_u16 v17, v17, v54
    buffer_store_dwordx2 v[16:17], v4, s[12:15], s61 offen
    s_mov_b64 exec, -1
L_s_w3_208_b:
    s_sleep 5
    s_mov_b32 s70, 1
L_s_xp_210:
    buffer_load_dwordx2 v[64:65], v7, s[12:15], s61 offen offset:0 sc1
    buffer_load_short_d16_hi v56, v28, s[12:15], s61 offen offset:0 sc1
    buffer_load_dwordx2 v[66:67], v7, s[12:15], s61 offen offset:512 sc1
    buffer_load_short_d16_hi v57, v28, s[12:15], s61 offen offset:128 sc1
    buffer_load_dwordx2 v[68:69], v7, s[12:15], s61 offen offset:1024 sc1
    buffer_load_short_d16_hi v58, v28, s[12:15], s61 offen offset:256 sc1
    buffer_load_dwordx2 v[70:71], v7, s[12:15], s61 offen offset:1536 sc1
    buffer_load_short_d16_hi v59, v28, s[12:15], s61 offen offset:384 sc1
    s_mov_b32 s46, 0x00003f80
    s_mov_b32 s47, 0x3f800000
    s_waitcnt vmcnt(6)
    v_dot2_f32_bf16 v16, v64, s46, 0
    v_dot2_f32_bf16 v17, v64, s47, 0
    v_dot2_f32_bf16 v18, v65, s46, 0
    v_dot2_f32_bf16 v19, v65, s47, 0
    s_waitcnt vmcnt(4)
    v_dot2_f32_bf16 v16, v66, s46, v16
    v_dot2_f32_bf16 v17, v66, s47, v17
    v_dot2_f32_bf16 v18, v67, s46, v18
    v_dot2_f32_bf16 v19, v67, s47, v19
    v_add_f32 v20, v56, v57
    s_waitcnt vmcnt(2)
    v_dot2_f32_bf16 v16, v68, s46, v16
    v_dot2_f32_bf16 v17, v68, s47, v17
    v_dot2_f32_bf16 v18, v69, s46, v18
    v_dot2_f32_bf16 v19, v69, s47, v19
    v_add_f32 v20, v20, v58
    s_waitcnt vmcnt(0)
    v_dot2_f32_bf16 v16, v70, s46, v16
    v_dot2_f32_bf16 v17, v70, s47, v17
    v_dot2_f32_bf16 v18, v71, s46, v18
    v_dot2_f32_bf16 v19, v71, s47, v19
    v_add_f32 v20, v20, v59
    s_nop 0
    v_cmp_u_f32 s[46:47], v16, v17
    v_cmp_u_f32 s[48:49], v18, v19
    v_cmp_u_f32 vcc, v20, v20
    v_max3_f32 v10, v16, v17, v18
    s_or_b64 s[46:47], s[46:47], s[48:49]
    v_max3_f32 v10, v10, v19, v20
    s_or_b64 vcc, vcc, s[46:47]
    s_cbranch_scc1 L_s_xf_211
L_s_xok_212:
    v_max_f32_dpp v11, v10, v10 row_ror:8 row_mask:0xf bank_mask:0xf
    v_max_f32_dpp v10, v10, v10 row_ror:8 row_mask:0xf bank_mask:0xf
    s_nop 1
    v_permlane16_swap_b32 v10, v11
    v_max_f32 v12, v10, v11
    v_max_f32 v10, v10, v11
    s_nop 1
    v_permlane32_swap_b32 v10, v12
    v_max_f32 v10, v10, v12
    v_mul_f32 v10, s66, v10
    v_fma_f32 v16, v16, s66, -v10
    v_fma_f32 v17, v17, s66, -v10
    v_fma_f32 v18, v18, s66, -v10
    v_fma_f32 v19, v19, s66, -v10
    v_fma_f32 v20, v20, s66, -v10
    v_exp_f32 v16, v16
    v_exp_f32 v17, v17
    v_exp_f32 v18, v18
    v_exp_f32 v19, v19
    v_exp_f32 v20, v20
    v_add_f32 v10, v16, v17
    v_add_f32 v11, v18, v19
    v_add_f32 v10, v10, v20
    v_add_f32 v10, v10, v11
    s_nop 1
    v_add_f32_dpp v11, v10, v10 row_ror:8 row_mask:0xf bank_mask:0xf
    v_add_f32_dpp v10, v10, v10 row_ror:8 row_mask:0xf bank_mask:0xf
    s_nop 1
    v_permlane16_swap_b32 v10, v11
    v_add_f32 v12, v10, v11
    v_add_f32 v10, v10, v11
    s_nop 1
    v_permlane32_swap_b32 v10, v12
    v_add_f32 v10, v10, v12
    v_rcp_f32 v10, v10
    s_nop 0
    v_mul_f32 v16, v16, v10
    v_mul_f32 v17, v17, v10
    v_mul_f32 v18, v18, v10
    v_mul_f32 v19, v19, v10
    v_mul_f32 v20, v20, v10
    v_cvt_pk_bf16_f32 v16, v16, v17
    v_cvt_pk_bf16_f32 v17, v18, v19
    v_cvt_pk_bf16_f32 v18, v20, v20
    ds_write_b64 v8, v[16:17]
    ds_write_b16 v9, v18
    s_waitcnt lgkmcnt(0)
    s_barrier
    s_add_u32 s63, s63, 786432
    s_cmp_ge_u32 s44, 2
    s_cbranch_scc1 L_s_nk_213
    buffer_load_dwordx4 v[32:35], v6, s[12:15], s63 offen sc1
L_s_nk_213:
    s_add_u32 s45, s60, 2
    s_cmp_le_u32 s69, s45
    s_cbranch_scc1 L_s_nk_213_w
    s_add_u32 s45, s63, 786432
    s_mov_b64 exec, 0xf
    buffer_load_dword v15, v14, s[12:15], s45 offen sc1
    s_mov_b64 exec, -1
L_s_nk_213_w:
    s_cmp_eq_u32 s44, 3
    s_cbranch_scc1 L_s_nr_214
    s_xor_b32 s45, s61, 0x8000
    s_mov_b64 exec, s[50:51]
    buffer_store_dwordx2 v[24:25], v4, s[12:15], s45 offen
    s_mov_b64 exec, -1
L_s_nr_214:
    s_cmp_lg_u32 s44, 3
    s_cbranch_scc1 L_s_np_215
    ds_read_b128 v[20:23], v6
    s_lshl_b32 s45, s60, 17
    s_add_u32 s45, s45, s67
    s_waitcnt lgkmcnt(0)
    v_min_u32 v20, -2, v20
    v_min_u32 v21, -2, v21
    v_min_u32 v22, -2, v22
    v_min_u32 v23, -2, v23
    buffer_store_dwordx4 v[20:23], v2, s[12:15], s45 offen sc1
L_s_np_215:
    s_add_u32 s68, s60, 2
    s_min_u32 s68, s68, 63
    v_readlane_b32 s45, v0, 0
    v_readlane_b32 s46, v0, 1
    s_nop 0
    s_min_u32 s45, s45, s46
    s_max_u32 s69, s69, s45
    s_cmp_gt_u32 s69, s68
    s_cbranch_scc1 L_kv_ok_218
    s_mov_b32 s70, 0
L_kv_lp_217:
    v_and_b32 v22, 1, v1
    v_lshlrev_b32 v22, 9, v22
    buffer_load_dword v23, v22, s[12:15], s57 offen sc1
    s_waitcnt vmcnt(0)
    v_readlane_b32 s69, v23, 0
    v_readlane_b32 s45, v23, 1
    s_add_u32 s70, s70, 1
    s_nop 2
    s_min_u32 s69, s69, s45
    s_cmp_gt_u32 s69, s68
    s_cbranch_scc1 L_kv_ok_218
    s_sleep 4
    s_cmp_lt_u32 s70, 524288
    s_cbranch_scc1 L_kv_lp_217
    s_branch L_c_done_1
L_kv_ok_218:
    s_add_u32 s45, s60, 7
    s_min_u32 s45, s45, 63
    s_cmp_gt_u32 s69, s45
    s_cbranch_scc1 L_s_na_216
    v_and_b32 v22, 1, v1
    v_lshlrev_b32 v22, 9, v22
    buffer_load_dword v0, v22, s[12:15], s57 offen sc1
L_s_na_216:
    s_sub_u32 s45, s60, 4
    s_cmp_gt_u32 s45, 24
    s_cbranch_scc1 L_s_xe_219
    s_sleep 1
    s_setprio 0
    s_bitcmp1_b32 s45, 0
    s_cbranch_scc1 L_s_x1_220
    s_cmp_eq_u32 s45, 0
    s_cbranch_scc1 L_s_x0_221
    s_bitcmp1_b32 s44, 0
    s_cbranch_scc1 L_s_x0_221
    ds_read_b128 v[40:43], v31
    s_sub_u32 s46, s45, 2
    s_lshr_b32 s47, s46, 2
    s_mul_i32 s47, s47, 786432
    s_and_b32 s46, s46, 2
    s_lshl_b32 s46, s46, 11
    s_add_u32 s47, s47, s46
    s_waitcnt lgkmcnt(0)
    buffer_store_dwordx4 v[40:43], v13, s[12:15], s47 offen sc1
L_s_x0_221:
    s_cmp_eq_u32 s45, 24
    s_cbranch_scc1 L_s_xe_219
    ds_read_b128 v[64:67], v44 offset:0
    ds_read_b128 v[68:71], v44 offset:1024
    ds_read_b128 v[72:75], v44 offset:2048
    ds_read_b128 v[76:79], v44 offset:3072
    ds_read_b128 v[80:83], v44 offset:4096
    ds_read_b128 v[84:87], v44 offset:5120
    ds_read_b128 v[88:91], v44 offset:6144
    ds_read_b128 v[92:95], v44 offset:7168
    ds_read_b128 v[96:99], v44 offset:8192
    ds_read_b128 v[100:103], v44 offset:9216
    ds_read_b128 v[104:107], v44 offset:10240
    ds_read_b128 v[108:111], v44 offset:11264
    s_waitcnt lgkmcnt(11)
    v_mfma_f32_16x16x32_bf16 v[36:39], a[0:3], v[64:67], 0
    ds_read_b128 v[112:115], v44 offset:12288
    s_waitcnt lgkmcnt(11)
    v_mfma_f32_16x16x32_bf16 v[36:39], a[4:7], v[68:71], v[36:39]
    ds_read_b128 v[116:119], v44 offset:13312
    s_waitcnt lgkmcnt(11)
    v_mfma_f32_16x16x32_bf16 v[36:39], a[8:11], v[72:75], v[36:39]
    ds_read_b128 v[120:123], v44 offset:14336
    s_waitcnt lgkmcnt(11)
    v_mfma_f32_16x16x32_bf16 v[36:39], a[12:15], v[76:79], v[36:39]
    ds_read_b128 v[124:127], v44 offset:15360
    s_waitcnt lgkmcnt(11)
    v_mfma_f32_16x16x32_bf16 v[36:39], a[16:19], v[80:83], v[36:39]
    s_waitcnt lgkmcnt(10)
    v_mfma_f32_16x16x32_bf16 v[36:39], a[20:23], v[84:87], v[36:39]
    s_waitcnt lgkmcnt(9)
    v_mfma_f32_16x16x32_bf16 v[36:39], a[24:27], v[88:91], v[36:39]
    s_waitcnt lgkmcnt(8)
    v_mfma_f32_16x16x32_bf16 v[36:39], a[28:31], v[92:95], v[36:39]
    s_waitcnt lgkmcnt(7)
    v_mfma_f32_16x16x32_bf16 v[36:39], a[32:35], v[96:99], v[36:39]
    s_waitcnt lgkmcnt(6)
    v_mfma_f32_16x16x32_bf16 v[36:39], a[36:39], v[100:103], v[36:39]
    s_waitcnt lgkmcnt(5)
    v_mfma_f32_16x16x32_bf16 v[36:39], a[40:43], v[104:107], v[36:39]
    s_waitcnt lgkmcnt(4)
    v_mfma_f32_16x16x32_bf16 v[36:39], a[44:47], v[108:111], v[36:39]
    s_waitcnt lgkmcnt(3)
    v_mfma_f32_16x16x32_bf16 v[36:39], a[48:51], v[112:115], v[36:39]
    s_waitcnt lgkmcnt(2)
    v_mfma_f32_16x16x32_bf16 v[36:39], a[52:55], v[116:119], v[36:39]
    s_waitcnt lgkmcnt(1)
    v_mfma_f32_16x16x32_bf16 v[36:39], a[56:59], v[120:123], v[36:39]
    s_waitcnt lgkmcnt(0)
    v_mfma_f32_16x16x32_bf16 v[36:39], a[60:63], v[124:127], v[36:39]
    s_branch L_s_xe_219
L_s_x1_220:
    ds_read_b128 v[64:67], v44 offset:16384
    ds_read_b128 v[68:71], v44 offset:17408
    ds_read_b128 v[72:75], v44 offset:18432
    ds_read_b128 v[76:79], v44 offset:19456
    ds_read_b128 v[80:83], v44 offset:20480
    ds_read_b128 v[84:87], v44 offset:21504
    ds_read_b128 v[88:91], v44 offset:22528
    ds_read_b128 v[92:95], v44 offset:23552
    ds_read_b128 v[96:99], v44 offset:24576
    ds_read_b128 v[100:103], v44 offset:25600
    ds_read_b128 v[104:107], v44 offset:26624
    ds_read_b128 v[108:111], v44 offset:27648
    s_waitcnt lgkmcnt(11)
    v_mfma_f32_16x16x32_bf16 v[36:39], a[64:67], v[64:67], v[36:39]
    ds_read_b128 v[112:115], v44 offset:28672
    s_waitcnt lgkmcnt(11)
    v_mfma_f32_16x16x32_bf16 v[36:39], a[68:71], v[68:71], v[36:39]
    ds_read_b128 v[116:119], v44 offset:29696
    s_waitcnt lgkmcnt(11)
    v_mfma_f32_16x16x32_bf16 v[36:39], a[72:75], v[72:75], v[36:39]
    ds_read_b128 v[120:123], v44 offset:30720
    s_waitcnt lgkmcnt(11)
    v_mfma_f32_16x16x32_bf16 v[36:39], a[76:79], v[76:79], v[36:39]
    ds_read_b128 v[124:127], v44 offset:31744
    s_waitcnt lgkmcnt(11)
    v_mfma_f32_16x16x32_bf16 v[36:39], a[80:83], v[80:83], v[36:39]
    s_waitcnt lgkmcnt(10)
    v_mfma_f32_16x16x32_bf16 v[36:39], a[84:87], v[84:87], v[36:39]
    s_waitcnt lgkmcnt(9)
    v_mfma_f32_16x16x32_bf16 v[36:39], a[88:91], v[88:91], v[36:39]
    s_waitcnt lgkmcnt(8)
    v_mfma_f32_16x16x32_bf16 v[36:39], a[92:95], v[92:95], v[36:39]
    s_waitcnt lgkmcnt(7)
    v_mfma_f32_16x16x32_bf16 v[36:39], a[96:99], v[96:99], v[36:39]
    s_waitcnt lgkmcnt(6)
    v_mfma_f32_16x16x32_bf16 v[36:39], a[100:103], v[100:103], v[36:39]
    s_waitcnt lgkmcnt(5)
    v_mfma_f32_16x16x32_bf16 v[36:39], a[104:107], v[104:107], v[36:39]
    s_waitcnt lgkmcnt(4)
    v_mfma_f32_16x16x32_bf16 v[36:39], a[108:111], v[108:111], v[36:39]
    s_waitcnt lgkmcnt(3)
    v_mfma_f32_16x16x32_bf16 v[36:39], a[112:115], v[112:115], v[36:39]
    s_waitcnt lgkmcnt(2)
    v_mfma_f32_16x16x32_bf16 v[36:39], a[116:119], v[116:119], v[36:39]
    s_waitcnt lgkmcnt(1)
    v_mfma_f32_16x16x32_bf16 v[36:39], a[120:123], v[120:123], v[36:39]
    s_waitcnt lgkmcnt(0)
    v_mfma_f32_16x16x32_bf16 v[36:39], a[124:127], v[124:127], v[36:39]
    s_nop 7
    v_cvt_pk_bf16_f32 v40, v36, v37
    v_cvt_pk_bf16_f32 v41, v38, v39
    ds_write_b64 v45, v[40:41]
    s_waitcnt lgkmcnt(0)
L_s_xe_219:
    s_setprio 1
    s_add_u32 s60, s60, 1
    s_add_u32 s61, s61, 0x4000
    s_and_b32 s61, s61, 0xffff
    s_branch L_s_loop_204
L_s_last_205:
    s_waitcnt lgkmcnt(0)
    s_barrier
    s_cmp_lg_u32 s44, 3
    s_cbranch_scc1 L_s_np_222
    ds_read_b128 v[20:23], v6
    s_lshl_b32 s45, s60, 17
    s_add_u32 s45, s45, s67
    s_waitcnt lgkmcnt(0)
    v_min_u32 v20, -2, v20
    v_min_u32 v21, -2, v21
    v_min_u32 v22, -2, v22
    v_min_u32 v23, -2, v23
    buffer_store_dwordx4 v[20:23], v2, s[12:15], s45 offen sc1
L_s_np_222:
    s_branch L_replica
L_rt_199:
    s_add_u32 s70, s70, 1
    s_cmp_lt_u32 s70, 524288
    s_cbranch_scc1 L_c_rp_198
    s_branch L_c_done_1
L_rt_209:
    s_add_u32 s70, s70, 1
    s_cmp_lt_u32 s70, 524288
    s_cbranch_scc1 L_s_xl_206
    s_branch L_c_done_1
L_s_w2_207:
    s_cmp_eq_u32 s44, 3
    s_cbranch_scc1 L_s_w3_208
    s_waitcnt lgkmcnt(0)
    v_mfma_f32_16x16x32_bf16 v[16:19], v[64:67], v[64:67], 0
    s_branch L_s_w2_207_b
L_s_w3_208:
    s_sleep 3
    s_branch L_s_w3_208_b
L_s_xf_211:
    v_or_b32 v72, 0xffff, v56
    v_or_b32 v73, 0xffff, v57
    v_or_b32 v74, 0xffff, v58
    v_or_b32 v75, 0xffff, v59
    v_max3_u32 v11, v64, v65, v66
    v_max3_u32 v11, v11, v67, v68
    v_max3_u32 v11, v11, v69, v70
    v_max3_u32 v11, v11, v71, v72
    v_max3_u32 v11, v11, v73, v74
    v_max_u32 v11, v11, v75
    v_cmp_eq_u32 vcc, -1, v11
    s_add_u32 s70, s70, 1
    s_cbranch_vccz L_s_xok_212
    s_cmp_lt_u32 s70, 524288
    s_cbranch_scc1 L_s_xp_210
    s_branch L_c_done_1
L_ss_201:
.p2align 6
L_s_loop_223:
    v_mov_b32 v16, 0
    v_mov_b32 v17, 0
    v_mov_b32 v18, 0
    v_mov_b32 v19, 0
    s_add_u32 s58, s58, 4
    s_mov_b32 s70, 1
    s_waitcnt vmcnt(0) lgkmcnt(0)
    s_barrier
    ds_read_b128 v[64:67], v2 offset:0
    ds_read_b128 v[68:71], v2 offset:1024
    ds_read_b128 v[72:75], v2 offset:2048
    ds_read_b128 v[76:79], v2 offset:3072
    ds_read_b128 v[80:83], v2 offset:4096
    ds_read_b128 v[84:87], v2 offset:5120
    ds_read_b128 v[88:91], v2 offset:6144
    ds_read_b128 v[92:95], v2 offset:7168
    ds_read_b128 v[96:99], v2 offset:8192
    ds_read_b128 v[100:103], v2 offset:9216
    ds_read_b128 v[104:107], v2 offset:10240
    ds_read_b128 v[108:111], v2 offset:11264
    s_waitcnt lgkmcnt(11)
    v_smfmac_f32_16x16x64_bf16 v[16:19], v[64:67], a[0:7], v3
    ds_read_b128 v[112:115], v2 offset:12288
    s_waitcnt lgkmcnt(11)
    v_smfmac_f32_16x16x64_bf16 v[16:19], v[68:71], a[8:15], v3
    ds_read_b128 v[116:119], v2 offset:13312
    s_waitcnt lgkmcnt(11)
    v_smfmac_f32_16x16x64_bf16 v[16:19], v[72:75], a[16:23], v3
    ds_read_b128 v[120:123], v2 offset:14336
    s_waitcnt lgkmcnt(11)
    v_smfmac_f32_16x16x64_bf16 v[16:19], v[76:79], a[24:31], v3
    ds_read_b128 v[124:127], v2 offset:15360
    s_waitcnt lgkmcnt(11)
    v_smfmac_f32_16x16x64_bf16 v[16:19], v[80:83], a[32:39], v3
    s_waitcnt lgkmcnt(10)
    v_smfmac_f32_16x16x64_bf16 v[16:19], v[84:87], a[40:47], v3
    s_waitcnt lgkmcnt(9)
    v_smfmac_f32_16x16x64_bf16 v[16:19], v[88:91], a[48:55], v3
    s_waitcnt lgkmcnt(8)
    v_smfmac_f32_16x16x64_bf16 v[16:19], v[92:95], a[56:63], v3
    s_waitcnt lgkmcnt(7)
    v_smfmac_f32_16x16x64_bf16 v[16:19], v[96:99], a[64:71], v3
    s_waitcnt lgkmcnt(6)
    v_smfmac_f32_16x16x64_bf16 v[16:19], v[100:103], a[72:79], v3
    s_waitcnt lgkmcnt(5)
    v_smfmac_f32_16x16x64_bf16 v[16:19], v[104:107], a[80:87], v3
    s_waitcnt lgkmcnt(4)
    v_smfmac_f32_16x16x64_bf16 v[16:19], v[108:111], a[88:95], v3
    s_waitcnt lgkmcnt(3)
    v_smfmac_f32_16x16x64_bf16 v[16:19], v[112:115], a[96:103], v3
    s_waitcnt lgkmcnt(2)
    v_smfmac_f32_16x16x64_bf16 v[16:19], v[116:119], a[104:111], v3
    s_waitcnt lgkmcnt(1)
    v_smfmac_f32_16x16x64_bf16 v[16:19], v[120:123], a[112:119], v3
    s_waitcnt lgkmcnt(0)
    v_smfmac_f32_16x16x64_bf16 v[16:19], v[124:127], a[120:127], v3
    s_nop 7
    v_permlane32_swap_b32 v16, v18
    v_permlane32_swap_b32 v17, v19
    v_add_f32 v16, v16, v18
    v_add_f32 v17, v17, v19
    v_cvt_pk_bf16_f32 v16, v16, v17
    ds_write_b16 v5, v16
    ds_write_b16_d16_hi v5, v16 offset:16
    s_mov_b64 exec, 1
    ds_add_u32 v29, v30
    s_mov_b64 exec, -1
L_s_xl_225:
    ds_read_b32 v10, v29
    ds_read_b128 v[64:67], v2 offset:61440
    s_cmp_eq_u32 s60, 63
    s_cbranch_scc1 L_s_last_224
    s_cmp_ge_u32 s44, 2
    s_cbranch_scc1 L_s_w2_226
    s_waitcnt lgkmcnt(0)
    v_mfma_f32_16x16x32_bf16 v[16:19], v[32:35], v[64:67], 0
L_s_w2_226_b:
    v_cmp_ne_u32 vcc, s58, v10
    s_nop 0
    s_cbranch_vccnz L_rt_228
    s_mov_b64 exec, s[50:51]
    s_nop 3
    v_cvt_pk_bf16_f32 v16, v16, v17
    v_cvt_pk_bf16_f32 v17, v18, v19
    v_pk_min_u16 v16, v16, v54
    v_pk_min_u16 v17, v17, v54
    buffer_store_dwordx2 v[16:17], v4, s[12:15], s61 offen sc1
    s_mov_b64 exec, -1
L_s_w3_227_b:
    s_sleep 5
    s_mov_b32 s70, 1
L_s_xp_229:
    buffer_load_dwordx2 v[64:65], v7, s[12:15], s61 offen offset:0 sc1
    buffer_load_short_d16_hi v56, v28, s[12:15], s61 offen offset:0 sc1
    buffer_load_dwordx2 v[66:67], v7, s[12:15], s61 offen offset:512 sc1
    buffer_load_short_d16_hi v57, v28, s[12:15], s61 offen offset:128 sc1
    buffer_load_dwordx2 v[68:69], v7, s[12:15], s61 offen offset:1024 sc1
    buffer_load_short_d16_hi v58, v28, s[12:15], s61 offen offset:256 sc1
    buffer_load_dwordx2 v[70:71], v7, s[12:15], s61 offen offset:1536 sc1
    buffer_load_short_d16_hi v59, v28, s[12:15], s61 offen offset:384 sc1
    s_mov_b32 s46, 0x00003f80
    s_mov_b32 s47, 0x3f800000
    s_waitcnt vmcnt(6)
    v_dot2_f32_bf16 v16, v64, s46, 0
    v_dot2_f32_bf16 v17, v64, s47, 0
    v_dot2_f32_bf16 v18, v65, s46, 0
    v_dot2_f32_bf16 v19, v65, s47, 0
    s_waitcnt vmcnt(4)
    v_dot2_f32_bf16 v16, v66, s46, v16
    v_dot2_f32_bf16 v17, v66, s47, v17
    v_dot2_f32_bf16 v18, v67, s46, v18
    v_dot2_f32_bf16 v19, v67, s47, v19
    v_add_f32 v20, v56, v57
    s_waitcnt vmcnt(2)
    v_dot2_f32_bf16 v16, v68, s46, v16
    v_dot2_f32_bf16 v17, v68, s47, v17
    v_dot2_f32_bf16 v18, v69, s46, v18
    v_dot2_f32_bf16 v19, v69, s47, v19
    v_add_f32 v20, v20, v58
    s_waitcnt vmcnt(0)
    v_dot2_f32_bf16 v16, v70, s46, v16
    v_dot2_f32_bf16 v17, v70, s47, v17
    v_dot2_f32_bf16 v18, v71, s46, v18
    v_dot2_f32_bf16 v19, v71, s47, v19
    v_add_f32 v20, v20, v59
    s_nop 0
    v_cmp_u_f32 s[46:47], v16, v17
    v_cmp_u_f32 s[48:49], v18, v19
    v_cmp_u_f32 vcc, v20, v20
    v_max3_f32 v10, v16, v17, v18
    s_or_b64 s[46:47], s[46:47], s[48:49]
    v_max3_f32 v10, v10, v19, v20
    s_or_b64 vcc, vcc, s[46:47]
    s_cbranch_scc1 L_s_xf_230
L_s_xok_231:
    v_max_f32_dpp v11, v10, v10 row_ror:8 row_mask:0xf bank_mask:0xf
    v_max_f32_dpp v10, v10, v10 row_ror:8 row_mask:0xf bank_mask:0xf
    s_nop 1
    v_permlane16_swap_b32 v10, v11
    v_max_f32 v12, v10, v11
    v_max_f32 v10, v10, v11
    s_nop 1
    v_permlane32_swap_b32 v10, v12
    v_max_f32 v10, v10, v12
    v_mul_f32 v10, s66, v10
    v_fma_f32 v16, v16, s66, -v10
    v_fma_f32 v17, v17, s66, -v10
    v_fma_f32 v18, v18, s66, -v10
    v_fma_f32 v19, v19, s66, -v10
    v_fma_f32 v20, v20, s66, -v10
    v_exp_f32 v16, v16
    v_exp_f32 v17, v17
    v_exp_f32 v18, v18
    v_exp_f32 v19, v19
    v_exp_f32 v20, v20
    v_add_f32 v10, v16, v17
    v_add_f32 v11, v18, v19
    v_add_f32 v10, v10, v20
    v_add_f32 v10, v10, v11
    s_nop 1
    v_add_f32_dpp v11, v10, v10 row_ror:8 row_mask:0xf bank_mask:0xf
    v_add_f32_dpp v10, v10, v10 row_ror:8 row_mask:0xf bank_mask:0xf
    s_nop 1
    v_permlane16_swap_b32 v10, v11
    v_add_f32 v12, v10, v11
    v_add_f32 v10, v10, v11
    s_nop 1
    v_permlane32_swap_b32 v10, v12
    v_add_f32 v10, v10, v12
    v_rcp_f32 v10, v10
    s_nop 0
    v_mul_f32 v16, v16, v10
    v_mul_f32 v17, v17, v10
    v_mul_f32 v18, v18, v10
    v_mul_f32 v19, v19, v10
    v_mul_f32 v20, v20, v10
    v_cvt_pk_bf16_f32 v16, v16, v17
    v_cvt_pk_bf16_f32 v17, v18, v19
    v_cvt_pk_bf16_f32 v18, v20, v20
    ds_write_b64 v8, v[16:17]
    ds_write_b16 v9, v18
    s_waitcnt lgkmcnt(0)
    s_barrier
    s_add_u32 s63, s63, 786432
    s_cmp_ge_u32 s44, 2
    s_cbranch_scc1 L_s_nk_232
    buffer_load_dwordx4 v[32:35], v6, s[12:15], s63 offen sc1
L_s_nk_232:
    s_add_u32 s45, s60, 2
    s_cmp_le_u32 s69, s45
    s_cbranch_scc1 L_s_nk_232_w
    s_add_u32 s45, s63, 786432
    s_mov_b64 exec, 0xf
    buffer_load_dword v15, v14, s[12:15], s45 offen sc1
    s_mov_b64 exec, -1
L_s_nk_232_w:
    s_cmp_eq_u32 s44, 3
    s_cbranch_scc1 L_s_nr_233
    s_xor_b32 s45, s61, 0x8000
    s_mov_b64 exec, s[50:51]
    buffer_store_dwordx2 v[24:25], v4, s[12:15], s45 offen sc1
    s_mov_b64 exec, -1
L_s_nr_233:
    s_cmp_lg_u32 s44, 3
    s_cbranch_scc1 L_s_np_234
    ds_read_b128 v[20:23], v6
    s_lshl_b32 s45, s60, 17
    s_add_u32 s45, s45, s67
    s_waitcnt lgkmcnt(0)
    v_min_u32 v20, -2, v20
    v_min_u32 v21, -2, v21
    v_min_u32 v22, -2, v22
    v_min_u32 v23, -2, v23
    buffer_store_dwordx4 v[20:23], v2, s[12:15], s45 offen sc1
L_s_np_234:
    s_add_u32 s68, s60, 2
    s_min_u32 s68, s68, 63
    v_readlane_b32 s45, v0, 0
    v_readlane_b32 s46, v0, 1
    s_nop 0
    s_min_u32 s45, s45, s46
    s_max_u32 s69, s69, s45
    s_cmp_gt_u32 s69, s68
    s_cbranch_scc1 L_kv_ok_237
    s_mov_b32 s70, 0
L_kv_lp_236:
    v_and_b32 v22, 1, v1
    v_lshlrev_b32 v22, 9, v22
    buffer_load_dword v23, v22, s[12:15], s57 offen sc1
    s_waitcnt vmcnt(0)
    v_readlane_b32 s69, v23, 0
    v_readlane_b32 s45, v23, 1
    s_add_u32 s70, s70, 1
    s_nop 2
    s_min_u32 s69, s69, s45
    s_cmp_gt_u32 s69, s68
    s_cbranch_scc1 L_kv_ok_237
    s_sleep 4
    s_cmp_lt_u32 s70, 524288
    s_cbranch_scc1 L_kv_lp_236
    s_branch L_c_done_1
L_kv_ok_237:
    s_add_u32 s45, s60, 7
    s_min_u32 s45, s45, 63
    s_cmp_gt_u32 s69, s45
    s_cbranch_scc1 L_s_na_235
    v_and_b32 v22, 1, v1
    v_lshlrev_b32 v22, 9, v22
    buffer_load_dword v0, v22, s[12:15], s57 offen sc1
L_s_na_235:
    s_sub_u32 s45, s60, 4
    s_cmp_gt_u32 s45, 24
    s_cbranch_scc1 L_s_xe_238
    s_sleep 1
    s_setprio 0
    s_bitcmp1_b32 s45, 0
    s_cbranch_scc1 L_s_x1_239
    s_cmp_eq_u32 s45, 0
    s_cbranch_scc1 L_s_x0_240
    s_bitcmp1_b32 s44, 0
    s_cbranch_scc1 L_s_x0_240
    ds_read_b128 v[40:43], v31
    s_sub_u32 s46, s45, 2
    s_lshr_b32 s47, s46, 2
    s_mul_i32 s47, s47, 786432
    s_and_b32 s46, s46, 2
    s_lshl_b32 s46, s46, 11
    s_add_u32 s47, s47, s46
    s_waitcnt lgkmcnt(0)
    buffer_store_dwordx4 v[40:43], v13, s[12:15], s47 offen sc1
L_s_x0_240:
    s_cmp_eq_u32 s45, 24
    s_cbranch_scc1 L_s_xe_238
    ds_read_b128 v[64:67], v44 offset:0
    ds_read_b128 v[68:71], v44 offset:1024
    ds_read_b128 v[72:75], v44 offset:2048
    ds_read_b128 v[76:79], v44 offset:3072
    ds_read_b128 v[80:83], v44 offset:4096
    ds_read_b128 v[84:87], v44 offset:5120
    ds_read_b128 v[88:91], v44 offset:6144
    ds_read_b128 v[92:95], v44 offset:7168
    ds_read_b128 v[96:99], v44 offset:8192
    ds_read_b128 v[100:103], v44 offset:9216
    ds_read_b128 v[104:107], v44 offset:10240
    ds_read_b128 v[108:111], v44 offset:11264
    s_waitcnt lgkmcnt(11)
    v_mfma_f32_16x16x32_bf16 v[36:39], a[0:3], v[64:67], 0
    ds_read_b128 v[112:115], v44 offset:12288
    s_waitcnt lgkmcnt(11)
    v_mfma_f32_16x16x32_bf16 v[36:39], a[4:7], v[68:71], v[36:39]
    ds_read_b128 v[116:119], v44 offset:13312
    s_waitcnt lgkmcnt(11)
    v_mfma_f32_16x16x32_bf16 v[36:39], a[8:11], v[72:75], v[36:39]
    ds_read_b128 v[120:123], v44 offset:14336
    s_waitcnt lgkmcnt(11)
    v_mfma_f32_16x16x32_bf16 v[36:39], a[12:15], v[76:79], v[36:39]
    ds_read_b128 v[124:127], v44 offset:15360
    s_waitcnt lgkmcnt(11)
    v_mfma_f32_16x16x32_bf16 v[36:39], a[16:19], v[80:83], v[36:39]
    s_waitcnt lgkmcnt(10)
    v_mfma_f32_16x16x32_bf16 v[36:39], a[20:23], v[84:87], v[36:39]
    s_waitcnt lgkmcnt(9)
    v_mfma_f32_16x16x32_bf16 v[36:39], a[24:27], v[88:91], v[36:39]
    s_waitcnt lgkmcnt(8)
    v_mfma_f32_16x16x32_bf16 v[36:39], a[28:31], v[92:95], v[36:39]
    s_waitcnt lgkmcnt(7)
    v_mfma_f32_16x16x32_bf16 v[36:39], a[32:35], v[96:99], v[36:39]
    s_waitcnt lgkmcnt(6)
    v_mfma_f32_16x16x32_bf16 v[36:39], a[36:39], v[100:103], v[36:39]
    s_waitcnt lgkmcnt(5)
    v_mfma_f32_16x16x32_bf16 v[36:39], a[40:43], v[104:107], v[36:39]
    s_waitcnt lgkmcnt(4)
    v_mfma_f32_16x16x32_bf16 v[36:39], a[44:47], v[108:111], v[36:39]
    s_waitcnt lgkmcnt(3)
    v_mfma_f32_16x16x32_bf16 v[36:39], a[48:51], v[112:115], v[36:39]
    s_waitcnt lgkmcnt(2)
    v_mfma_f32_16x16x32_bf16 v[36:39], a[52:55], v[116:119], v[36:39]
    s_waitcnt lgkmcnt(1)
    v_mfma_f32_16x16x32_bf16 v[36:39], a[56:59], v[120:123], v[36:39]
    s_waitcnt lgkmcnt(0)
    v_mfma_f32_16x16x32_bf16 v[36:39], a[60:63], v[124:127], v[36:39]
    s_branch L_s_xe_238
L_s_x1_239:
    ds_read_b128 v[64:67], v44 offset:16384
    ds_read_b128 v[68:71], v44 offset:17408
    ds_read_b128 v[72:75], v44 offset:18432
    ds_read_b128 v[76:79], v44 offset:19456
    ds_read_b128 v[80:83], v44 offset:20480
    ds_read_b128 v[84:87], v44 offset:21504
    ds_read_b128 v[88:91], v44 offset:22528
    ds_read_b128 v[92:95], v44 offset:23552
    ds_read_b128 v[96:99], v44 offset:24576
    ds_read_b128 v[100:103], v44 offset:25600
    ds_read_b128 v[104:107], v44 offset:26624
    ds_read_b128 v[108:111], v44 offset:27648
    s_waitcnt lgkmcnt(11)
    v_mfma_f32_16x16x32_bf16 v[36:39], a[64:67], v[64:67], v[36:39]
    ds_read_b128 v[112:115], v44 offset:28672
    s_waitcnt lgkmcnt(11)
    v_mfma_f32_16x16x32_bf16 v[36:39], a[68:71], v[68:71], v[36:39]
    ds_read_b128 v[116:119], v44 offset:29696
    s_waitcnt lgkmcnt(11)
    v_mfma_f32_16x16x32_bf16 v[36:39], a[72:75], v[72:75], v[36:39]
    ds_read_b128 v[120:123], v44 offset:30720
    s_waitcnt lgkmcnt(11)
    v_mfma_f32_16x16x32_bf16 v[36:39], a[76:79], v[76:79], v[36:39]
    ds_read_b128 v[124:127], v44 offset:31744
    s_waitcnt lgkmcnt(11)
    v_mfma_f32_16x16x32_bf16 v[36:39], a[80:83], v[80:83], v[36:39]
    s_waitcnt lgkmcnt(10)
    v_mfma_f32_16x16x32_bf16 v[36:39], a[84:87], v[84:87], v[36:39]
    s_waitcnt lgkmcnt(9)
    v_mfma_f32_16x16x32_bf16 v[36:39], a[88:91], v[88:91], v[36:39]
    s_waitcnt lgkmcnt(8)
    v_mfma_f32_16x16x32_bf16 v[36:39], a[92:95], v[92:95], v[36:39]
    s_waitcnt lgkmcnt(7)
    v_mfma_f32_16x16x32_bf16 v[36:39], a[96:99], v[96:99], v[36:39]
    s_waitcnt lgkmcnt(6)
    v_mfma_f32_16x16x32_bf16 v[36:39], a[100:103], v[100:103], v[36:39]
    s_waitcnt lgkmcnt(5)
    v_mfma_f32_16x16x32_bf16 v[36:39], a[104:107], v[104:107], v[36:39]
    s_waitcnt lgkmcnt(4)
    v_mfma_f32_16x16x32_bf16 v[36:39], a[108:111], v[108:111], v[36:39]
    s_waitcnt lgkmcnt(3)
    v_mfma_f32_16x16x32_bf16 v[36:39], a[112:115], v[112:115], v[36:39]
    s_waitcnt lgkmcnt(2)
    v_mfma_f32_16x16x32_bf16 v[36:39], a[116:119], v[116:119], v[36:39]
    s_waitcnt lgkmcnt(1)
    v_mfma_f32_16x16x32_bf16 v[36:39], a[120:123], v[120:123], v[36:39]
    s_waitcnt lgkmcnt(0)
    v_mfma_f32_16x16x32_bf16 v[36:39], a[124:127], v[124:127], v[36:39]
    s_nop 7
    v_cvt_pk_bf16_f32 v40, v36, v37
    v_cvt_pk_bf16_f32 v41, v38, v39
    ds_write_b64 v45, v[40:41]
    s_waitcnt lgkmcnt(0)
L_s_xe_238:
    s_setprio 1
    s_add_u32 s60, s60, 1
    s_add_u32 s61, s61, 0x4000
    s_and_b32 s61, s61, 0xffff
    s_branch L_s_loop_223
L_s_last_224:
    s_waitcnt lgkmcnt(0)
    s_barrier
    s_cmp_lg_u32 s44, 3
    s_cbranch_scc1 L_s_np_241
    ds_read_b128 v[20:23], v6
    s_lshl_b32 s45, s60, 17
    s_add_u32 s45, s45, s67
    s_waitcnt lgkmcnt(0)
    v_min_u32 v20, -2, v20
    v_min_u32 v21, -2, v21
    v_min_u32 v22, -2, v22
    v_min_u32 v23, -2, v23
    buffer_store_dwordx4 v[20:23], v2, s[12:15], s45 offen sc1
L_s_np_241:
    s_branch L_replica
L_rt_228:
    s_add_u32 s70, s70, 1
    s_cmp_lt_u32 s70, 524288
    s_cbranch_scc1 L_s_xl_225
    s_branch L_c_done_1
L_s_w2_226:
    s_cmp_eq_u32 s44, 3
    s_cbranch_scc1 L_s_w3_227
    s_waitcnt lgkmcnt(0)
    v_mfma_f32_16x16x32_bf16 v[16:19], v[64:67], v[64:67], 0
    s_branch L_s_w2_226_b
L_s_w3_227:
    s_sleep 3
    s_branch L_s_w3_227_b
L_s_xf_230:
    v_or_b32 v72, 0xffff, v56
    v_or_b32 v73, 0xffff, v57
    v_or_b32 v74, 0xffff, v58
    v_or_b32 v75, 0xffff, v59
    v_max3_u32 v11, v64, v65, v66
    v_max3_u32 v11, v11, v67, v68
    v_max3_u32 v11, v11, v69, v70
    v_max3_u32 v11, v11, v71, v72
    v_max3_u32 v11, v11, v73, v74
    v_max_u32 v11, v11, v75
    v_cmp_eq_u32 vcc, -1, v11
    s_add_u32 s70, s70, 1
    s_cbranch_vccz L_s_xok_231
    s_cmp_lt_u32 s70, 524288
    s_cbranch_scc1 L_s_xp_229
    s_branch L_c_done_1
L_vf_202:
    s_cmp_eq_u32 s52, 0
    s_cbranch_scc1 L_vs_203
    s_mov_b32 s70, 1
    v_mov_b32 v16, 0
    v_mov_b32 v17, 0
    s_branch L_v_l1m_244
.p2align 6
L_v_loop_242:
    s_mov_b32 s70, 1
    buffer_load_dwordx4 v[64:67], v9, s[12:15], s61 offen offset:0 sc1
    buffer_load_dwordx4 v[68:71], v9, s[12:15], s61 offen offset:1024 sc1
    buffer_load_dwordx4 v[72:75], v9, s[12:15], s61 offen offset:2048 sc1
    buffer_load_dwordx4 v[76:79], v9, s[12:15], s61 offen offset:3072 sc1
    v_mov_b32 v16, 0
    v_mov_b32 v17, 0
    v_mov_b32 v18, 0
    v_mov_b32 v19, 0
    v_mov_b32 v20, 0
    v_mov_b32 v21, 0
    v_mov_b32 v22, 0
    v_mov_b32 v23, 0
L_v_l1m_244:
    s_waitcnt vmcnt(3)
    ds_write_b128 v10, v[64:67] offset:0
    v_max3_u32 v24, v64, v65, v66
    v_max_u32 v24, v24, v67
    v_cmp_eq_u32 s[48:49], -1, v24
    s_waitcnt vmcnt(2)
    ds_write_b128 v10, v[68:71] offset:1024
    v_max3_u32 v24, v68, v69, v70
    v_max_u32 v24, v24, v71
    v_cmp_eq_u32 s[50:51], -1, v24
    s_waitcnt vmcnt(1)
    ds_write_b128 v10, v[72:75] offset:2048
    v_max3_u32 v24, v72, v73, v74
    v_max_u32 v24, v24, v75
    v_cmp_eq_u32 s[52:53], -1, v24
    s_waitcnt vmcnt(0)
    ds_write_b128 v10, v[76:79] offset:3072
    v_max3_u32 v24, v76, v77, v78
    v_max_u32 v24, v24, v79
    v_cmp_eq_u32 s[54:55], -1, v24
    s_or_b64 s[46:47], s[48:49], s[50:51]
    s_or_b64 vcc, s[52:53], s[54:55]
    s_or_b64 vcc, vcc, s[46:47]
    s_cbranch_scc1 L_v_l1_243
L_v_l1ok_245:
    s_waitcnt lgkmcnt(0)
    s_barrier
    v_smfmac_f32_16x16x64_bf16 v[16:19], v[64:67], a[0:7], v3
    v_smfmac_f32_16x16x64_bf16 v[20:23], v[64:67], a[32:39], v3
    v_smfmac_f32_16x16x64_bf16 v[16:19], v[68:71], a[8:15], v3
    v_smfmac_f32_16x16x64_bf16 v[20:23], v[68:71], a[40:47], v3
    v_smfmac_f32_16x16x64_bf16 v[16:19], v[72:75], a[16:23], v3
    v_smfmac_f32_16x16x64_bf16 v[20:23], v[72:75], a[48:55], v3
    v_smfmac_f32_16x16x64_bf16 v[16:19], v[76:79], a[24:31], v3
    v_smfmac_f32_16x16x64_bf16 v[20:23], v[76:79], a[56:63], v3
    s_nop 6
    v_permlane32_swap_b32 v16, v18
    v_permlane32_swap_b32 v17, v19
    v_permlane32_swap_b32 v20, v22
    v_permlane32_swap_b32 v21, v23
    v_add_f32 v16, v16, v18
    v_add_f32 v17, v17, v19
    v_add_f32 v18, v20, v22
    v_add_f32 v19, v21, v23
    ds_write_b128 v14, v[16:19]
    s_mov_b64 exec, 1
    ds_add_u32 v29, v30
    s_mov_b64 exec, -1
    s_add_u32 s58, s58, 4
    s_bitcmp1_b32 s44, 0
    s_cbranch_scc1 L_v_k1_247_c
    s_mov_b32 s70, 0
L_v_rl_248:
    ds_read_b32 v24, v29
    ds_read_b64 v[16:17], v13 offset:0
    ds_read_b64 v[18:19], v13 offset:1024
    ds_read_b64 v[20:21], v13 offset:2048
    ds_read_b64 v[22:23], v13 offset:3072
    s_waitcnt lgkmcnt(2)
    v_cmp_ne_u32 vcc, s58, v24
    v_add_f32 v16, v16, v18
    v_add_f32 v17, v17, v19
    s_waitcnt lgkmcnt(0)
    s_cbranch_vccnz L_rt_249
    v_add_f32 v20, v20, v22
    v_add_f32 v21, v21, v23
    v_add_f32 v16, v16, v20
    v_add_f32 v17, v17, v21
    s_mov_b32 vcc_lo, 0x55555555
    s_mov_b32 vcc_hi, 0x55555555
    v_cndmask_b32_dpp v18, v17, v16, vcc quad_perm:[1,0,3,2] row_mask:0xf bank_mask:0xf
    s_not_b64 vcc, vcc
    v_cndmask_b32_dpp v19, v16, v17, vcc quad_perm:[1,0,3,2] row_mask:0xf bank_mask:0xf
    v_cvt_pk_bf16_f32 v18, v18, v19
    v_min_u32 v18, -2, v18
    buffer_store_dword v18, v4, s[12:15], s62 offen
    ds_write_b32 v5, v18
L_v_k1_247:
    s_cmp_eq_u32 s60, 63
    s_cbranch_scc1 L_v_last_246
    ds_read_b128 v[80:83], v27 offset:32768
    ds_read_b128 v[84:87], v27 offset:36864
    ds_read_b128 v[88:91], v27 offset:40960
    ds_read_b128 v[92:95], v27 offset:45056
    v_mov_b32 v96, 0
    v_mov_b32 v97, 0
    v_mov_b32 v98, 0
    v_mov_b32 v99, 0
    v_mov_b32 v100, 0
    v_mov_b32 v101, 0
    v_mov_b32 v102, 0
    v_mov_b32 v103, 0
    v_mov_b32 v104, 0
    v_mov_b32 v105, 0
    v_mov_b32 v106, 0
    v_mov_b32 v107, 0
    v_mov_b32 v108, 0
    v_mov_b32 v109, 0
    v_mov_b32 v110, 0
    v_mov_b32 v111, 0
    s_bitcmp1_b32 s44, 0
    s_cbranch_scc0 L_v_sv_250
    s_sleep 1
L_v_sv_250:
    s_sleep 3
    s_mov_b32 s70, 1
    buffer_load_dwordx4 v[64:67], v11, s[12:15], s62 offen offset:0 sc1
    buffer_load_dwordx4 v[68:71], v11, s[12:15], s62 offen offset:1024 sc1
L_v_vp_251_m:
    s_waitcnt vmcnt(0)
    v_max3_u32 v20, v64, v65, v66
    v_max3_u32 v20, v20, v67, v68
    v_max3_u32 v20, v20, v69, v70
    v_max_u32 v20, v20, v71
    v_cmp_eq_u32 vcc, -1, v20
    s_cbranch_vccnz L_rt_252
    v_smfmac_f32_16x16x64_bf16 v[96:99], v[64:67], a[64:71], v3
    v_smfmac_f32_16x16x64_bf16 v[96:99], v[68:71], a[72:79], v3
    v_smfmac_f32_16x16x64_bf16 v[100:103], v[64:67], a[80:87], v3
    v_smfmac_f32_16x16x64_bf16 v[100:103], v[68:71], a[88:95], v3
    v_smfmac_f32_16x16x64_bf16 v[104:107], v[64:67], a[96:103], v3
    v_smfmac_f32_16x16x64_bf16 v[104:107], v[68:71], a[104:111], v3
    v_smfmac_f32_16x16x64_bf16 v[108:111], v[64:67], a[112:119], v3
    v_smfmac_f32_16x16x64_bf16 v[108:111], v[68:71], a[120:127], v3
    s_nop 1
    v_cvt_pk_bf16_f32 v96, v96, v97
    v_cvt_pk_bf16_f32 v97, v98, v99
    ds_write_b64 v12, v[96:97] offset:0
    v_cvt_pk_bf16_f32 v100, v100, v101
    v_cvt_pk_bf16_f32 v101, v102, v103
    ds_write_b64 v12, v[100:101] offset:2048
    v_cvt_pk_bf16_f32 v104, v104, v105
    v_cvt_pk_bf16_f32 v105, v106, v107
    ds_write_b64 v12, v[104:105] offset:4096
    v_cvt_pk_bf16_f32 v108, v108, v109
    v_cvt_pk_bf16_f32 v109, v110, v111
    ds_write_b64 v12, v[108:109] offset:6144
    s_bitcmp1_b32 s44, 0
    s_cbranch_scc1 L_v_r8_253
L_v_r8_253_l:
    s_add_u32 s46, s65, 4096
    buffer_load_dwordx4 v[32:35], v15, s[12:15], s65 offen offset:0 sc1
    buffer_load_dwordx4 v[48:51], v15, s[12:15], s46 offen offset:0 sc1
    buffer_load_dwordx4 v[36:39], v15, s[12:15], s65 offen offset:1024 sc1
    buffer_load_dwordx4 v[52:55], v15, s[12:15], s46 offen offset:1024 sc1
    buffer_load_dwordx4 v[40:43], v15, s[12:15], s65 offen offset:2048 sc1
    buffer_load_dwordx4 v[56:59], v15, s[12:15], s46 offen offset:2048 sc1
    buffer_load_dwordx4 v[44:47], v15, s[12:15], s65 offen offset:3072 sc1
    buffer_load_dwordx4 v[60:63], v15, s[12:15], s46 offen offset:3072 sc1
    s_add_u32 s65, s65, 786432
L_v_r8_253:
    s_waitcnt lgkmcnt(0)
    s_barrier
    ds_read_b128 v[96:99], v2 offset:16384
    ds_read_b128 v[100:103], v2 offset:17408
    ds_read_b128 v[104:107], v2 offset:18432
    ds_read_b128 v[108:111], v2 offset:19456
    ds_read_b128 v[112:115], v31 offset:0
    ds_read_b128 v[116:119], v25 offset:0
    ds_read_b128 v[120:123], v31 offset:512
    ds_read_b128 v[124:127], v25 offset:1024
    s_waitcnt lgkmcnt(7)
    v_mfma_f32_16x16x32_bf16 v[16:19], v[80:83], v[96:99], 0
    s_waitcnt lgkmcnt(6)
    v_mfma_f32_16x16x32_bf16 v[16:19], v[84:87], v[100:103], v[16:19]
    s_waitcnt lgkmcnt(5)
    v_mfma_f32_16x16x32_bf16 v[16:19], v[88:91], v[104:107], v[16:19]
    s_waitcnt lgkmcnt(4)
    v_mfma_f32_16x16x32_bf16 v[16:19], v[92:95], v[108:111], v[16:19]
    s_waitcnt lgkmcnt(2)
    v_mfma_f32_16x16x32_bf16 v[16:19], v[116:119], v[112:115], v[16:19]
    s_waitcnt lgkmcnt(0)
    v_mfma_f32_16x16x32_bf16 v[16:19], v[124:127], v[120:123], v[16:19]
    s_mov_b32 exec_lo, 0x00ff00ff
    s_mov_b32 exec_hi, 0x00ff00ff
    s_nop 5
    v_cvt_pk_bf16_f32 v16, v16, v17
    v_cvt_pk_bf16_f32 v17, v18, v19
    v_min_u32 v16, -2, v16
    v_min_u32 v17, -2, v17
    buffer_store_dwordx2 v[16:17], v6, s[12:15], s63 offen sc1
    s_mov_b64 exec, -1
    s_waitcnt vmcnt(1)
    s_sub_u32 s45, s60, 3
    s_cmp_ge_u32 s45, 24
    s_cbranch_scc1 L_v_nx_254_s
    s_cmp_eq_u32 s45, 0
    s_cbranch_scc1 L_v_fl_255
L_v_fl_255_b:
    s_and_b32 s46, s45, 1
    s_lshl_b32 s47, s46, 14
    s_add_u32 s47, s47, s59
    s_lshl_b32 s46, s46, 15
    s_lshr_b32 s48, s45, 2
    s_lshl_b32 s48, s48, 16
    s_add_u32 s46, s46, s48
    s_and_b32 s48, s45, 2
    s_lshl_b32 s48, s48, 7
    s_add_u32 s46, s46, s48
    s_add_u32 m0, s47, 0
    s_add_u32 s48, s46, 0
    buffer_load_dwordx4 v28, s[12:15], s48 offen sc1 lds
    s_add_u32 m0, s47, 1024
    s_add_u32 s48, s46, 2048
    buffer_load_dwordx4 v28, s[12:15], s48 offen sc1 lds
    s_add_u32 m0, s47, 2048
    s_add_u32 s48, s46, 4096
    buffer_load_dwordx4 v28, s[12:15], s48 offen sc1 lds
    s_add_u32 m0, s47, 3072
    s_add_u32 s48, s46, 6144
    buffer_load_dwordx4 v28, s[12:15], s48 offen sc1 lds
L_v_nx_254:
    s_add_u32 s61, s61, 0x4000
    s_and_b32 s61, s61, 0xffff
    s_mov_b32 s70, 1
    s_sleep 5
    buffer_load_dword v96, v7, s[12:15], s63 offen offset:0 sc1
    buffer_load_dword v97, v7, s[12:15], s63 offen offset:256 sc1
    buffer_load_dword v98, v7, s[12:15], s63 offen offset:512 sc1
    buffer_load_dword v99, v7, s[12:15], s63 offen offset:768 sc1
    buffer_load_dword v100, v7, s[12:15], s63 offen offset:1024 sc1
    buffer_load_dword v101, v7, s[12:15], s63 offen offset:1280 sc1
    buffer_load_dword v102, v7, s[12:15], s63 offen offset:1536 sc1
    buffer_load_dword v103, v7, s[12:15], s63 offen offset:1792 sc1
    v_mfma_f32_16x16x32_bf16 v[64:67], v[32:35], a[64:67], 0
    v_mfma_f32_16x16x32_bf16 v[68:71], v[48:51], a[64:67], 0
    v_mfma_f32_16x16x32_bf16 v[64:67], v[36:39], a[68:71], v[64:67]
    v_mfma_f32_16x16x32_bf16 v[68:71], v[52:55], a[68:71], v[68:71]
    v_mfma_f32_16x16x32_bf16 v[64:67], v[40:43], a[72:75], v[64:67]
    v_mfma_f32_16x16x32_bf16 v[68:71], v[56:59], a[72:75], v[68:71]
    v_mfma_f32_16x16x32_bf16 v[64:67], v[44:47], a[76:79], v[64:67]
    v_mfma_f32_16x16x32_bf16 v[68:71], v[60:63], a[76:79], v[68:71]
    v_mfma_f32_16x16x32_bf16 v[72:75], v[32:35], a[80:83], 0
    v_mfma_f32_16x16x32_bf16 v[76:79], v[48:51], a[80:83], 0
    v_mfma_f32_16x16x32_bf16 v[72:75], v[36:39], a[84:87], v[72:75]
    v_mfma_f32_16x16x32_bf16 v[76:79], v[52:55], a[84:87], v[76:79]
    v_mfma_f32_16x16x32_bf16 v[72:75], v[40:43], a[88:91], v[72:75]
    v_mfma_f32_16x16x32_bf16 v[76:79], v[56:59], a[88:91], v[76:79]
    v_mfma_f32_16x16x32_bf16 v[72:75], v[44:47], a[92:95], v[72:75]
    v_mfma_f32_16x16x32_bf16 v[76:79], v[60:63], a[92:95], v[76:79]
    v_cvt_pk_bf16_f32 v64, v64, v65
    v_cvt_pk_bf16_f32 v65, v66, v67
    v_cvt_pk_bf16_f32 v66, v68, v69
    v_cvt_pk_bf16_f32 v67, v70, v71
    ds_write_b128 v10, v[64:67] offset:32768
    v_mfma_f32_16x16x32_bf16 v[80:83], v[32:35], a[96:99], 0
    v_mfma_f32_16x16x32_bf16 v[84:87], v[48:51], a[96:99], 0
    v_mfma_f32_16x16x32_bf16 v[80:83], v[36:39], a[100:103], v[80:83]
    v_mfma_f32_16x16x32_bf16 v[84:87], v[52:55], a[100:103], v[84:87]
    v_mfma_f32_16x16x32_bf16 v[80:83], v[40:43], a[104:107], v[80:83]
    v_mfma_f32_16x16x32_bf16 v[84:87], v[56:59], a[104:107], v[84:87]
    v_mfma_f32_16x16x32_bf16 v[80:83], v[44:47], a[108:111], v[80:83]
    v_mfma_f32_16x16x32_bf16 v[84:87], v[60:63], a[108:111], v[84:87]
    v_cvt_pk_bf16_f32 v72, v72, v73
    v_cvt_pk_bf16_f32 v73, v74, v75
    v_cvt_pk_bf16_f32 v74, v76, v77
    v_cvt_pk_bf16_f32 v75, v78, v79
    ds_write_b128 v10, v[72:75] offset:33792
L_v_gp_256:
    s_waitcnt vmcnt(7)
    v_lshlrev_b32 v20, 16, v96
    v_and_b32 v21, 0xffff0000, v96
    s_waitcnt vmcnt(6)
    v_lshlrev_b32 v22, 16, v97
    v_and_b32 v23, 0xffff0000, v97
    v_add_f32 v20, v20, v22
    v_add_f32 v21, v21, v23
    s_waitcnt vmcnt(5)
    v_lshlrev_b32 v22, 16, v98
    v_and_b32 v23, 0xffff0000, v98
    v_add_f32 v20, v20, v22
    v_add_f32 v21, v21, v23
    s_waitcnt vmcnt(4)
    v_lshlrev_b32 v22, 16, v99
    v_and_b32 v23, 0xffff0000, v99
    v_add_f32 v20, v20, v22
    v_add_f32 v21, v21, v23
    s_waitcnt vmcnt(3)
    v_lshlrev_b32 v22, 16, v100
    v_and_b32 v23, 0xffff0000, v100
    v_add_f32 v20, v20, v22
    v_add_f32 v21, v21, v23
    s_waitcnt vmcnt(2)
    v_lshlrev_b32 v22, 16, v101
    v_and_b32 v23, 0xffff0000, v101
    v_add_f32 v20, v20, v22
    v_add_f32 v21, v21, v23
    s_waitcnt vmcnt(1)
    v_lshlrev_b32 v22, 16, v102
    v_and_b32 v23, 0xffff0000, v102
    v_add_f32 v20, v20, v22
    v_add_f32 v21, v21, v23
    s_waitcnt vmcnt(0)
    v_lshlrev_b32 v22, 16, v103
    v_and_b32 v23, 0xffff0000, v103
    v_add_f32 v20, v20, v22
    v_add_f32 v21, v21, v23
    v_cmp_u_f32 vcc, v20, v21
    v_cvt_pk_bf16_f32 v20, v20, v21
    s_cbranch_vccnz L_v_gf_258
L_v_gok_257:
    buffer_store_dword v20, v8, s[12:15], s61 offen
    s_xor_b32 s45, s61, 0x8000
    buffer_store_dword v26, v8, s[12:15], s45 offen
    s_bitcmp1_b32 s44, 0
    s_cbranch_scc1 L_v_nr_259
    s_xor_b32 s45, s62, 0x4000
    buffer_store_dword v26, v4, s[12:15], s45 offen
L_v_nr_259:
    s_add_u32 s60, s60, 1
    s_add_u32 s62, s62, 0x2000
    s_and_b32 s62, s62, 0x7fff
    s_and_b32 s45, s60, 0x38
    s_bitcmp1_b64 s[66:67], s45
    s_cselect_b32 s45, 8192, 0
    s_lshl_b32 s63, s60, 18
    s_add_u32 s63, s63, s45
    v_mfma_f32_16x16x32_bf16 v[88:91], v[32:35], a[112:115], 0
    v_mfma_f32_16x16x32_bf16 v[92:95], v[48:51], a[112:115], 0
    v_mfma_f32_16x16x32_bf16 v[88:91], v[36:39], a[116:119], v[88:91]
    v_mfma_f32_16x16x32_bf16 v[92:95], v[52:55], a[116:119], v[92:95]
    v_mfma_f32_16x16x32_bf16 v[88:91], v[40:43], a[120:123], v[88:91]
    v_mfma_f32_16x16x32_bf16 v[92:95], v[56:59], a[120:123], v[92:95]
    v_mfma_f32_16x16x32_bf16 v[88:91], v[44:47], a[124:127], v[88:91]
    v_mfma_f32_16x16x32_bf16 v[92:95], v[60:63], a[124:127], v[92:95]
    v_cvt_pk_bf16_f32 v80, v80, v81
    v_cvt_pk_bf16_f32 v81, v82, v83
    v_cvt_pk_bf16_f32 v82, v84, v85
    v_cvt_pk_bf16_f32 v83, v86, v87
    ds_write_b128 v10, v[80:83] offset:34816
    s_nop 2
    v_cvt_pk_bf16_f32 v88, v88, v89
    v_cvt_pk_bf16_f32 v89, v90, v91
    v_cvt_pk_bf16_f32 v90, v92, v93
    v_cvt_pk_bf16_f32 v91, v94, v95
    ds_write_b128 v10, v[88:91] offset:35840
    s_sleep 3
    s_branch L_v_loop_242
L_v_last_246:
    s_waitcnt lgkmcnt(0)
    s_barrier
    s_branch L_replica
L_v_l1_243:
    s_mov_b64 exec, s[48:49]
    s_cbranch_execz L_v_ls_260
    buffer_load_dwordx4 v[64:67], v9, s[12:15], s61 offen offset:0 sc1
L_v_ls_260:
    s_mov_b64 exec, s[50:51]
    s_cbranch_execz L_v_ls_261
    buffer_load_dwordx4 v[68:71], v9, s[12:15], s61 offen offset:1024 sc1
L_v_ls_261:
    s_mov_b64 exec, s[52:53]
    s_cbranch_execz L_v_ls_262
    buffer_load_dwordx4 v[72:75], v9, s[12:15], s61 offen offset:2048 sc1
L_v_ls_262:
    s_mov_b64 exec, s[54:55]
    s_cbranch_execz L_v_ls_263
    buffer_load_dwordx4 v[76:79], v9, s[12:15], s61 offen offset:3072 sc1
L_v_ls_263:
    s_mov_b64 exec, -1
    s_add_u32 s70, s70, 1
    s_cmp_ge_u32 s70, 524288
    s_cbranch_scc1 L_c_done_1
    s_waitcnt vmcnt(0)
    s_cmp_eq_u64 s[48:49], 0
    s_cbranch_scc1 L_v_lc_264
    ds_write_b128 v10, v[64:67] offset:0
    v_max3_u32 v24, v64, v65, v66
    v_max_u32 v24, v24, v67
    v_cmp_eq_u32 s[48:49], -1, v24
L_v_lc_264:
    s_cmp_eq_u64 s[50:51], 0
    s_cbranch_scc1 L_v_lc_265
    ds_write_b128 v10, v[68:71] offset:1024
    v_max3_u32 v24, v68, v69, v70
    v_max_u32 v24, v24, v71
    v_cmp_eq_u32 s[50:51], -1, v24
L_v_lc_265:
    s_cmp_eq_u64 s[52:53], 0
    s_cbranch_scc1 L_v_lc_266
    ds_write_b128 v10, v[72:75] offset:2048
    v_max3_u32 v24, v72, v73, v74
    v_max_u32 v24, v24, v75
    v_cmp_eq_u32 s[52:53], -1, v24
L_v_lc_266:
    s_cmp_eq_u64 s[54:55], 0
    s_cbranch_scc1 L_v_lc_267
    ds_write_b128 v10, v[76:79] offset:3072
    v_max3_u32 v24, v76, v77, v78
    v_max_u32 v24, v24, v79
    v_cmp_eq_u32 s[54:55], -1, v24
L_v_lc_267:
    s_or_b64 s[46:47], s[48:49], s[50:51]
    s_or_b64 vcc, s[52:53], s[54:55]
    s_or_b64 vcc, vcc, s[46:47]
    s_cbranch_scc1 L_v_l1_243
    s_branch L_v_l1ok_245
L_v_k1_247_c:
    s_add_u32 s46, s65, 4096
    buffer_load_dwordx4 v[32:35], v15, s[12:15], s65 offen offset:0 sc1
    buffer_load_dwordx4 v[48:51], v15, s[12:15], s46 offen offset:0 sc1
    buffer_load_dwordx4 v[36:39], v15, s[12:15], s65 offen offset:1024 sc1
    buffer_load_dwordx4 v[52:55], v15, s[12:15], s46 offen offset:1024 sc1
    buffer_load_dwordx4 v[40:43], v15, s[12:15], s65 offen offset:2048 sc1
    buffer_load_dwordx4 v[56:59], v15, s[12:15], s46 offen offset:2048 sc1
    buffer_load_dwordx4 v[44:47], v15, s[12:15], s65 offen offset:3072 sc1
    buffer_load_dwordx4 v[60:63], v15, s[12:15], s46 offen offset:3072 sc1
    s_add_u32 s65, s65, 786432
    s_branch L_v_k1_247
L_rt_249:
    s_add_u32 s70, s70, 1
    s_cmp_lt_u32 s70, 524288
    s_cbranch_scc1 L_v_rl_248
    s_branch L_c_done_1
L_v_vp_251:
    buffer_load_dwordx4 v[64:67], v11, s[12:15], s62 offen offset:0 sc1
    buffer_load_dwordx4 v[68:71], v11, s[12:15], s62 offen offset:1024 sc1
    s_branch L_v_vp_251_m
L_rt_252:
    s_add_u32 s70, s70, 1
    s_cmp_lt_u32 s70, 524288
    s_cbranch_scc1 L_v_vp_251
    s_branch L_c_done_1
L_v_fl_255:
    v_and_b32 v22, 31, v1
    v_lshlrev_b32 v22, 7, v22
    s_mov_b32 s46, 0x109400
    s_mov_b32 s47, 56
    s_mov_b32 s70, 0
L_spin_268:
    buffer_load_dword v23, v22, s[12:15], s46 offen sc1
    s_waitcnt vmcnt(0)
    v_cmp_ge_u32 vcc, s47, v23
    s_add_u32 s70, s70, 1
    s_cbranch_vccz L_spok_269
    s_sleep 3
    s_cmp_lt_u32 s70, 524288
    s_cbranch_scc1 L_spin_268
    s_branch L_c_done_1
L_spok_269:
    s_branch L_v_fl_255_b
L_v_nx_254_s:
    s_sleep 2
    s_branch L_v_nx_254
L_v_gf_258:
    v_max3_u32 v24, v96, v97, v98
    v_max3_u32 v24, v24, v99, v100
    v_max3_u32 v24, v24, v101, v102
    v_max_u32 v24, v24, v103
    v_cmp_eq_u32 vcc, -1, v24
    v_min_u32 v20, -2, v20
    s_add_u32 s70, s70, 1
    s_cbranch_vccz L_v_gok_257
    buffer_load_dword v96, v7, s[12:15], s63 offen offset:0 sc1
    buffer_load_dword v97, v7, s[12:15], s63 offen offset:256 sc1
    buffer_load_dword v98, v7, s[12:15], s63 offen offset:512 sc1
    buffer_load_dword v99, v7, s[12:15], s63 offen offset:768 sc1
    buffer_load_dword v100, v7, s[12:15], s63 offen offset:1024 sc1
    buffer_load_dword v101, v7, s[12:15], s63 offen offset:1280 sc1
    buffer_load_dword v102, v7, s[12:15], s63 offen offset:1536 sc1
    buffer_load_dword v103, v7, s[12:15], s63 offen offset:1792 sc1
    s_cmp_lt_u32 s70, 524288
    s_cbranch_scc1 L_v_gp_256
    s_branch L_c_done_1
L_vs_203:
    s_mov_b32 s70, 1
    v_mov_b32 v16, 0
    v_mov_b32 v17, 0
    s_branch L_v_l1m_272
.p2align 6
L_v_loop_270:
    s_mov_b32 s70, 1
    buffer_load_dwordx4 v[64:67], v9, s[12:15], s61 offen offset:0 sc1
    buffer_load_dwordx4 v[68:71], v9, s[12:15], s61 offen offset:1024 sc1
    buffer_load_dwordx4 v[72:75], v9, s[12:15], s61 offen offset:2048 sc1
    buffer_load_dwordx4 v[76:79], v9, s[12:15], s61 offen offset:3072 sc1
    v_mov_b32 v16, 0
    v_mov_b32 v17, 0
    v_mov_b32 v18, 0
    v_mov_b32 v19, 0
    v_mov_b32 v20, 0
    v_mov_b32 v21, 0
    v_mov_b32 v22, 0
    v_mov_b32 v23, 0
L_v_l1m_272:
    s_waitcnt vmcnt(3)
    ds_write_b128 v10, v[64:67] offset:0
    v_max3_u32 v24, v64, v65, v66
    v_max_u32 v24, v24, v67
    v_cmp_eq_u32 s[48:49], -1, v24
    s_waitcnt vmcnt(2)
    ds_write_b128 v10, v[68:71] offset:1024
    v_max3_u32 v24, v68, v69, v70
    v_max_u32 v24, v24, v71
    v_cmp_eq_u32 s[50:51], -1, v24
    s_waitcnt vmcnt(1)
    ds_write_b128 v10, v[72:75] offset:2048
    v_max3_u32 v24, v72, v73, v74
    v_max_u32 v24, v24, v75
    v_cmp_eq_u32 s[52:53], -1, v24
    s_waitcnt vmcnt(0)
    ds_write_b128 v10, v[76:79] offset:3072
    v_max3_u32 v24, v76, v77, v78
    v_max_u32 v24, v24, v79
    v_cmp_eq_u32 s[54:55], -1, v24
    s_or_b64 s[46:47], s[48:49], s[50:51]
    s_or_b64 vcc, s[52:53], s[54:55]
    s_or_b64 vcc, vcc, s[46:47]
    s_cbranch_scc1 L_v_l1_271
L_v_l1ok_273:
    s_waitcnt lgkmcnt(0)
    s_barrier
    v_smfmac_f32_16x16x64_bf16 v[16:19], v[64:67], a[0:7], v3
    v_smfmac_f32_16x16x64_bf16 v[20:23], v[64:67], a[32:39], v3
    v_smfmac_f32_16x16x64_bf16 v[16:19], v[68:71], a[8:15], v3
    v_smfmac_f32_16x16x64_bf16 v[20:23], v[68:71], a[40:47], v3
    v_smfmac_f32_16x16x64_bf16 v[16:19], v[72:75], a[16:23], v3
    v_smfmac_f32_16x16x64_bf16 v[20:23], v[72:75], a[48:55], v3
    v_smfmac_f32_16x16x64_bf16 v[16:19], v[76:79], a[24:31], v3
    v_smfmac_f32_16x16x64_bf16 v[20:23], v[76:79], a[56:63], v3
    s_nop 6
    v_permlane32_swap_b32 v16, v18
    v_permlane32_swap_b32 v17, v19
    v_permlane32_swap_b32 v20, v22
    v_permlane32_swap_b32 v21, v23
    v_add_f32 v16, v16, v18
    v_add_f32 v17, v17, v19
    v_add_f32 v18, v20, v22
    v_add_f32 v19, v21, v23
    ds_write_b128 v14, v[16:19]
    s_mov_b64 exec, 1
    ds_add_u32 v29, v30
    s_mov_b64 exec, -1
    s_add_u32 s58, s58, 4
    s_bitcmp1_b32 s44, 0
    s_cbranch_scc1 L_v_k1_275_c
    s_mov_b32 s70, 0
L_v_rl_276:
    ds_read_b32 v24, v29
    ds_read_b64 v[16:17], v13 offset:0
    ds_read_b64 v[18:19], v13 offset:1024
    ds_read_b64 v[20:21], v13 offset:2048
    ds_read_b64 v[22:23], v13 offset:3072
    s_waitcnt lgkmcnt(2)
    v_cmp_ne_u32 vcc, s58, v24
    v_add_f32 v16, v16, v18
    v_add_f32 v17, v17, v19
    s_waitcnt lgkmcnt(0)
    s_cbranch_vccnz L_rt_277
    v_add_f32 v20, v20, v22
    v_add_f32 v21, v21, v23
    v_add_f32 v16, v16, v20
    v_add_f32 v17, v17, v21
    s_mov_b32 vcc_lo, 0x55555555
    s_mov_b32 vcc_hi, 0x55555555
    v_cndmask_b32_dpp v18, v17, v16, vcc quad_perm:[1,0,3,2] row_mask:0xf bank_mask:0xf
    s_not_b64 vcc, vcc
    v_cndmask_b32_dpp v19, v16, v17, vcc quad_perm:[1,0,3,2] row_mask:0xf bank_mask:0xf
    v_cvt_pk_bf16_f32 v18, v18, v19
    v_min_u32 v18, -2, v18
    buffer_store_dword v18, v4, s[12:15], s62 offen sc1
    ds_write_b32 v5, v18
L_v_k1_275:
    s_cmp_eq_u32 s60, 63
    s_cbranch_scc1 L_v_last_274
    ds_read_b128 v[80:83], v27 offset:32768
    ds_read_b128 v[84:87], v27 offset:36864
    ds_read_b128 v[88:91], v27 offset:40960
    ds_read_b128 v[92:95], v27 offset:45056
    v_mov_b32 v96, 0
    v_mov_b32 v97, 0
    v_mov_b32 v98, 0
    v_mov_b32 v99, 0
    v_mov_b32 v100, 0
    v_mov_b32 v101, 0
    v_mov_b32 v102, 0
    v_mov_b32 v103, 0
    v_mov_b32 v104, 0
    v_mov_b32 v105, 0
    v_mov_b32 v106, 0
    v_mov_b32 v107, 0
    v_mov_b32 v108, 0
    v_mov_b32 v109, 0
    v_mov_b32 v110, 0
    v_mov_b32 v111, 0
    s_bitcmp1_b32 s44, 0
    s_cbranch_scc0 L_v_sv_278
    s_sleep 1
L_v_sv_278:
    s_sleep 3
    s_mov_b32 s70, 1
    buffer_load_dwordx4 v[64:67], v11, s[12:15], s62 offen offset:0 sc1
    buffer_load_dwordx4 v[68:71], v11, s[12:15], s62 offen offset:1024 sc1
L_v_vp_279_m:
    s_waitcnt vmcnt(0)
    v_max3_u32 v20, v64, v65, v66
    v_max3_u32 v20, v20, v67, v68
    v_max3_u32 v20, v20, v69, v70
    v_max_u32 v20, v20, v71
    v_cmp_eq_u32 vcc, -1, v20
    s_cbranch_vccnz L_rt_280
    v_smfmac_f32_16x16x64_bf16 v[96:99], v[64:67], a[64:71], v3
    v_smfmac_f32_16x16x64_bf16 v[96:99], v[68:71], a[72:79], v3
    v_smfmac_f32_16x16x64_bf16 v[100:103], v[64:67], a[80:87], v3
    v_smfmac_f32_16x16x64_bf16 v[100:103], v[68:71], a[88:95], v3
    v_smfmac_f32_16x16x64_bf16 v[104:107], v[64:67], a[96:103], v3
    v_smfmac_f32_16x16x64_bf16 v[104:107], v[68:71], a[104:111], v3
    v_smfmac_f32_16x16x64_bf16 v[108:111], v[64:67], a[112:119], v3
    v_smfmac_f32_16x16x64_bf16 v[108:111], v[68:71], a[120:127], v3
    s_nop 1
    v_cvt_pk_bf16_f32 v96, v96, v97
    v_cvt_pk_bf16_f32 v97, v98, v99
    ds_write_b64 v12, v[96:97] offset:0
    v_cvt_pk_bf16_f32 v100, v100, v101
    v_cvt_pk_bf16_f32 v101, v102, v103
    ds_write_b64 v12, v[100:101] offset:2048
    v_cvt_pk_bf16_f32 v104, v104, v105
    v_cvt_pk_bf16_f32 v105, v106, v107
    ds_write_b64 v12, v[104:105] offset:4096
    v_cvt_pk_bf16_f32 v108, v108, v109
    v_cvt_pk_bf16_f32 v109, v110, v111
    ds_write_b64 v12, v[108:109] offset:6144
    s_bitcmp1_b32 s44, 0
    s_cbranch_scc1 L_v_r8_281
L_v_r8_281_l:
    s_add_u32 s46, s65, 4096
    buffer_load_dwordx4 v[32:35], v15, s[12:15], s65 offen offset:0 sc1
    buffer_load_dwordx4 v[48:51], v15, s[12:15], s46 offen offset:0 sc1
    buffer_load_dwordx4 v[36:39], v15, s[12:15], s65 offen offset:1024 sc1
    buffer_load_dwordx4 v[52:55], v15, s[12:15], s46 offen offset:1024 sc1
    buffer_load_dwordx4 v[40:43], v15, s[12:15], s65 offen offset:2048 sc1
    buffer_load_dwordx4 v[56:59], v15, s[12:15], s46 offen offset:2048 sc1
    buffer_load_dwordx4 v[44:47], v15, s[12:15], s65 offen offset:3072 sc1
    buffer_load_dwordx4 v[60:63], v15, s[12:15], s46 offen offset:3072 sc1
    s_add_u32 s65, s65, 786432
L_v_r8_281:
    s_waitcnt lgkmcnt(0)
    s_barrier
    ds_read_b128 v[96:99], v2 offset:16384
    ds_read_b128 v[100:103], v2 offset:17408
    ds_read_b128 v[104:107], v2 offset:18432
    ds_read_b128 v[108:111], v2 offset:19456
    ds_read_b128 v[112:115], v31 offset:0
    ds_read_b128 v[116:119], v25 offset:0
    ds_read_b128 v[120:123], v31 offset:512
    ds_read_b128 v[124:127], v25 offset:1024
    s_waitcnt lgkmcnt(7)
    v_mfma_f32_16x16x32_bf16 v[16:19], v[80:83], v[96:99], 0
    s_waitcnt lgkmcnt(6)
    v_mfma_f32_16x16x32_bf16 v[16:19], v[84:87], v[100:103], v[16:19]
    s_waitcnt lgkmcnt(5)
    v_mfma_f32_16x16x32_bf16 v[16:19], v[88:91], v[104:107], v[16:19]
    s_waitcnt lgkmcnt(4)
    v_mfma_f32_16x16x32_bf16 v[16:19], v[92:95], v[108:111], v[16:19]
    s_waitcnt lgkmcnt(2)
    v_mfma_f32_16x16x32_bf16 v[16:19], v[116:119], v[112:115], v[16:19]
    s_waitcnt lgkmcnt(0)
    v_mfma_f32_16x16x32_bf16 v[16:19], v[124:127], v[120:123], v[16:19]
    s_mov_b32 exec_lo, 0x00ff00ff
    s_mov_b32 exec_hi, 0x00ff00ff
    s_nop 5
    v_cvt_pk_bf16_f32 v16, v16, v17
    v_cvt_pk_bf16_f32 v17, v18, v19
    v_min_u32 v16, -2, v16
    v_min_u32 v17, -2, v17
    buffer_store_dwordx2 v[16:17], v6, s[12:15], s63 offen sc1
    s_mov_b64 exec, -1
    s_waitcnt vmcnt(1)
    s_sub_u32 s45, s60, 3
    s_cmp_ge_u32 s45, 24
    s_cbranch_scc1 L_v_nx_282_s
    s_cmp_eq_u32 s45, 0
    s_cbranch_scc1 L_v_fl_283
L_v_fl_283_b:
    s_and_b32 s46, s45, 1
    s_lshl_b32 s47, s46, 14
    s_add_u32 s47, s47, s59
    s_lshl_b32 s46, s46, 15
    s_lshr_b32 s48, s45, 2
    s_lshl_b32 s48, s48, 16
    s_add_u32 s46, s46, s48
    s_and_b32 s48, s45, 2
    s_lshl_b32 s48, s48, 7
    s_add_u32 s46, s46, s48
    s_add_u32 m0, s47, 0
    s_add_u32 s48, s46, 0
    buffer_load_dwordx4 v28, s[12:15], s48 offen sc1 lds
    s_add_u32 m0, s47, 1024
    s_add_u32 s48, s46, 2048
    buffer_load_dwordx4 v28, s[12:15], s48 offen sc1 lds
    s_add_u32 m0, s47, 2048
    s_add_u32 s48, s46, 4096
    buffer_load_dwordx4 v28, s[12:15], s48 offen sc1 lds
    s_add_u32 m0, s47, 3072
    s_add_u32 s48, s46, 6144
    buffer_load_dwordx4 v28, s[12:15], s48 offen sc1 lds
L_v_nx_282:
    s_add_u32 s61, s61, 0x4000
    s_and_b32 s61, s61, 0xffff
    s_mov_b32 s70, 1
    s_sleep 5
    buffer_load_dword v96, v7, s[12:15], s63 offen offset:0 sc1
    buffer_load_dword v97, v7, s[12:15], s63 offen offset:256 sc1
    buffer_load_dword v98, v7, s[12:15], s63 offen offset:512 sc1
    buffer_load_dword v99, v7, s[12:15], s63 offen offset:768 sc1
    buffer_load_dword v100, v7, s[12:15], s63 offen offset:1024 sc1
    buffer_load_dword v101, v7, s[12:15], s63 offen offset:1280 sc1
    buffer_load_dword v102, v7, s[12:15], s63 offen offset:1536 sc1
    buffer_load_dword v103, v7, s[12:15], s63 offen offset:1792 sc1
    v_mfma_f32_16x16x32_bf16 v[64:67], v[32:35], a[64:67], 0
    v_mfma_f32_16x16x32_bf16 v[68:71], v[48:51], a[64:67], 0
    v_mfma_f32_16x16x32_bf16 v[64:67], v[36:39], a[68:71], v[64:67]
    v_mfma_f32_16x16x32_bf16 v[68:71], v[52:55], a[68:71], v[68:71]
    v_mfma_f32_16x16x32_bf16 v[64:67], v[40:43], a[72:75], v[64:67]
    v_mfma_f32_16x16x32_bf16 v[68:71], v[56:59], a[72:75], v[68:71]
    v_mfma_f32_16x16x32_bf16 v[64:67], v[44:47], a[76:79], v[64:67]
    v_mfma_f32_16x16x32_bf16 v[68:71], v[60:63], a[76:79], v[68:71]
    v_mfma_f32_16x16x32_bf16 v[72:75], v[32:35], a[80:83], 0
    v_mfma_f32_16x16x32_bf16 v[76:79], v[48:51], a[80:83], 0
    v_mfma_f32_16x16x32_bf16 v[72:75], v[36:39], a[84:87], v[72:75]
    v_mfma_f32_16x16x32_bf16 v[76:79], v[52:55], a[84:87], v[76:79]
    v_mfma_f32_16x16x32_bf16 v[72:75], v[40:43], a[88:91], v[72:75]
    v_mfma_f32_16x16x32_bf16 v[76:79], v[56:59], a[88:91], v[76:79]
    v_mfma_f32_16x16x32_bf16 v[72:75], v[44:47], a[92:95], v[72:75]
    v_mfma_f32_16x16x32_bf16 v[76:79], v[60:63], a[92:95], v[76:79]
    v_cvt_pk_bf16_f32 v64, v64, v65
    v_cvt_pk_bf16_f32 v65, v66, v67
    v_cvt_pk_bf16_f32 v66, v68, v69
    v_cvt_pk_bf16_f32 v67, v70, v71
    ds_write_b128 v10, v[64:67] offset:32768
    v_mfma_f32_16x16x32_bf16 v[80:83], v[32:35], a[96:99], 0
    v_mfma_f32_16x16x32_bf16 v[84:87], v[48:51], a[96:99], 0
    v_mfma_f32_16x16x32_bf16 v[80:83], v[36:39], a[100:103], v[80:83]
    v_mfma_f32_16x16x32_bf16 v[84:87], v[52:55], a[100:103], v[84:87]
    v_mfma_f32_16x16x32_bf16 v[80:83], v[40:43], a[104:107], v[80:83]
    v_mfma_f32_16x16x32_bf16 v[84:87], v[56:59], a[104:107], v[84:87]
    v_mfma_f32_16x16x32_bf16 v[80:83], v[44:47], a[108:111], v[80:83]
    v_mfma_f32_16x16x32_bf16 v[84:87], v[60:63], a[108:111], v[84:87]
    v_cvt_pk_bf16_f32 v72, v72, v73
    v_cvt_pk_bf16_f32 v73, v74, v75
    v_cvt_pk_bf16_f32 v74, v76, v77
    v_cvt_pk_bf16_f32 v75, v78, v79
    ds_write_b128 v10, v[72:75] offset:33792
L_v_gp_284:
    s_waitcnt vmcnt(7)
    v_lshlrev_b32 v20, 16, v96
    v_and_b32 v21, 0xffff0000, v96
    s_waitcnt vmcnt(6)
    v_lshlrev_b32 v22, 16, v97
    v_and_b32 v23, 0xffff0000, v97
    v_add_f32 v20, v20, v22
    v_add_f32 v21, v21, v23
    s_waitcnt vmcnt(5)
    v_lshlrev_b32 v22, 16, v98
    v_and_b32 v23, 0xffff0000, v98
    v_add_f32 v20, v20, v22
    v_add_f32 v21, v21, v23
    s_waitcnt vmcnt(4)
    v_lshlrev_b32 v22, 16, v99
    v_and_b32 v23, 0xffff0000, v99
    v_add_f32 v20, v20, v22
    v_add_f32 v21, v21, v23
    s_waitcnt vmcnt(3)
    v_lshlrev_b32 v22, 16, v100
    v_and_b32 v23, 0xffff0000, v100
    v_add_f32 v20, v20, v22
    v_add_f32 v21, v21, v23
    s_waitcnt vmcnt(2)
    v_lshlrev_b32 v22, 16, v101
    v_and_b32 v23, 0xffff0000, v101
    v_add_f32 v20, v20, v22
    v_add_f32 v21, v21, v23
    s_waitcnt vmcnt(1)
    v_lshlrev_b32 v22, 16, v102
    v_and_b32 v23, 0xffff0000, v102
    v_add_f32 v20, v20, v22
    v_add_f32 v21, v21, v23
    s_waitcnt vmcnt(0)
    v_lshlrev_b32 v22, 16, v103
    v_and_b32 v23, 0xffff0000, v103
    v_add_f32 v20, v20, v22
    v_add_f32 v21, v21, v23
    v_cmp_u_f32 vcc, v20, v21
    v_cvt_pk_bf16_f32 v20, v20, v21
    s_cbranch_vccnz L_v_gf_286
L_v_gok_285:
    buffer_store_dword v20, v8, s[12:15], s61 offen sc1
    s_xor_b32 s45, s61, 0x8000
    buffer_store_dword v26, v8, s[12:15], s45 offen sc1
    s_bitcmp1_b32 s44, 0
    s_cbranch_scc1 L_v_nr_287
    s_xor_b32 s45, s62, 0x4000
    buffer_store_dword v26, v4, s[12:15], s45 offen sc1
L_v_nr_287:
    s_add_u32 s60, s60, 1
    s_add_u32 s62, s62, 0x2000
    s_and_b32 s62, s62, 0x7fff
    s_and_b32 s45, s60, 0x38
    s_bitcmp1_b64 s[66:67], s45
    s_cselect_b32 s45, 8192, 0
    s_lshl_b32 s63, s60, 18
    s_add_u32 s63, s63, s45
    v_mfma_f32_16x16x32_bf16 v[88:91], v[32:35], a[112:115], 0
    v_mfma_f32_16x16x32_bf16 v[92:95], v[48:51], a[112:115], 0
    v_mfma_f32_16x16x32_bf16 v[88:91], v[36:39], a[116:119], v[88:91]
    v_mfma_f32_16x16x32_bf16 v[92:95], v[52:55], a[116:119], v[92:95]
    v_mfma_f32_16x16x32_bf16 v[88:91], v[40:43], a[120:123], v[88:91]
    v_mfma_f32_16x16x32_bf16 v[92:95], v[56:59], a[120:123], v[92:95]
    v_mfma_f32_16x16x32_bf16 v[88:91], v[44:47], a[124:127], v[88:91]
    v_mfma_f32_16x16x32_bf16 v[92:95], v[60:63], a[124:127], v[92:95]
    v_cvt_pk_bf16_f32 v80, v80, v81
    v_cvt_pk_bf16_f32 v81, v82, v83
    v_cvt_pk_bf16_f32 v82, v84, v85
    v_cvt_pk_bf16_f32 v83, v86, v87
    ds_write_b128 v10, v[80:83] offset:34816
    s_nop 2
    v_cvt_pk_bf16_f32 v88, v88, v89
    v_cvt_pk_bf16_f32 v89, v90, v91
    v_cvt_pk_bf16_f32 v90, v92, v93
    v_cvt_pk_bf16_f32 v91, v94, v95
    ds_write_b128 v10, v[88:91] offset:35840
    s_sleep 3
    s_branch L_v_loop_270
L_v_last_274:
    s_waitcnt lgkmcnt(0)
    s_barrier
    s_branch L_replica
L_v_l1_271:
    s_mov_b64 exec, s[48:49]
    s_cbranch_execz L_v_ls_288
    buffer_load_dwordx4 v[64:67], v9, s[12:15], s61 offen offset:0 sc1
L_v_ls_288:
    s_mov_b64 exec, s[50:51]
    s_cbranch_execz L_v_ls_289
    buffer_load_dwordx4 v[68:71], v9, s[12:15], s61 offen offset:1024 sc1
L_v_ls_289:
    s_mov_b64 exec, s[52:53]
    s_cbranch_execz L_v_ls_290
    buffer_load_dwordx4 v[72:75], v9, s[12:15], s61 offen offset:2048 sc1
L_v_ls_290:
    s_mov_b64 exec, s[54:55]
    s_cbranch_execz L_v_ls_291
    buffer_load_dwordx4 v[76:79], v9, s[12:15], s61 offen offset:3072 sc1
L_v_ls_291:
    s_mov_b64 exec, -1
    s_add_u32 s70, s70, 1
    s_cmp_ge_u32 s70, 524288
    s_cbranch_scc1 L_c_done_1
    s_waitcnt vmcnt(0)
    s_cmp_eq_u64 s[48:49], 0
    s_cbranch_scc1 L_v_lc_292
    ds_write_b128 v10, v[64:67] offset:0
    v_max3_u32 v24, v64, v65, v66
    v_max_u32 v24, v24, v67
    v_cmp_eq_u32 s[48:49], -1, v24
L_v_lc_292:
    s_cmp_eq_u64 s[50:51], 0
    s_cbranch_scc1 L_v_lc_293
    ds_write_b128 v10, v[68:71] offset:1024
    v_max3_u32 v24, v68, v69, v70
    v_max_u32 v24, v24, v71
    v_cmp_eq_u32 s[50:51], -1, v24
L_v_lc_293:
    s_cmp_eq_u64 s[52:53], 0
    s_cbranch_scc1 L_v_lc_294
    ds_write_b128 v10, v[72:75] offset:2048
    v_max3_u32 v24, v72, v73, v74
    v_max_u32 v24, v24, v75
    v_cmp_eq_u32 s[52:53], -1, v24
L_v_lc_294:
    s_cmp_eq_u64 s[54:55], 0
    s_cbranch_scc1 L_v_lc_295
    ds_write_b128 v10, v[76:79] offset:3072
    v_max3_u32 v24, v76, v77, v78
    v_max_u32 v24, v24, v79
    v_cmp_eq_u32 s[54:55], -1, v24
L_v_lc_295:
    s_or_b64 s[46:47], s[48:49], s[50:51]
    s_or_b64 vcc, s[52:53], s[54:55]
    s_or_b64 vcc, vcc, s[46:47]
    s_cbranch_scc1 L_v_l1_271
    s_branch L_v_l1ok_273
L_v_k1_275_c:
    s_add_u32 s46, s65, 4096
    buffer_load_dwordx4 v[32:35], v15, s[12:15], s65 offen offset:0 sc1
    buffer_load_dwordx4 v[48:51], v15, s[12:15], s46 offen offset:0 sc1
    buffer_load_dwordx4 v[36:39], v15, s[12:15], s65 offen offset:1024 sc1
    buffer_load_dwordx4 v[52:55], v15, s[12:15], s46 offen offset:1024 sc1
    buffer_load_dwordx4 v[40:43], v15, s[12:15], s65 offen offset:2048 sc1
    buffer_load_dwordx4 v[56:59], v15, s[12:15], s46 offen offset:2048 sc1
    buffer_load_dwordx4 v[44:47], v15, s[12:15], s65 offen offset:3072 sc1
    buffer_load_dwordx4 v[60:63], v15, s[12:15], s46 offen offset:3072 sc1
    s_add_u32 s65, s65, 786432
    s_branch L_v_k1_275
L_rt_277:
    s_add_u32 s70, s70, 1
    s_cmp_lt_u32 s70, 524288
    s_cbranch_scc1 L_v_rl_276
    s_branch L_c_done_1
L_v_vp_279:
    buffer_load_dwordx4 v[64:67], v11, s[12:15], s62 offen offset:0 sc1
    buffer_load_dwordx4 v[68:71], v11, s[12:15], s62 offen offset:1024 sc1
    s_branch L_v_vp_279_m
L_rt_280:
    s_add_u32 s70, s70, 1
    s_cmp_lt_u32 s70, 524288
    s_cbranch_scc1 L_v_vp_279
    s_branch L_c_done_1
L_v_fl_283:
    v_and_b32 v22, 31, v1
    v_lshlrev_b32 v22, 7, v22
    s_mov_b32 s46, 0x109400
    s_mov_b32 s47, 56
    s_mov_b32 s70, 0
L_spin_296:
    buffer_load_dword v23, v22, s[12:15], s46 offen sc1
    s_waitcnt vmcnt(0)
    v_cmp_ge_u32 vcc, s47, v23
    s_add_u32 s70, s70, 1
    s_cbranch_vccz L_spok_297
    s_sleep 3
    s_cmp_lt_u32 s70, 524288
    s_cbranch_scc1 L_spin_296
    s_branch L_c_done_1
L_spok_297:
    s_branch L_v_fl_283_b
L_v_nx_282_s:
    s_sleep 2
    s_branch L_v_nx_282
L_v_gf_286:
    v_max3_u32 v24, v96, v97, v98
    v_max3_u32 v24, v24, v99, v100
    v_max3_u32 v24, v24, v101, v102
    v_max_u32 v24, v24, v103
    v_cmp_eq_u32 vcc, -1, v24
    v_min_u32 v20, -2, v20
    s_add_u32 s70, s70, 1
    s_cbranch_vccz L_v_gok_285
    buffer_load_dword v96, v7, s[12:15], s63 offen offset:0 sc1
    buffer_load_dword v97, v7, s[12:15], s63 offen offset:256 sc1
    buffer_load_dword v98, v7, s[12:15], s63 offen offset:512 sc1
    buffer_load_dword v99, v7, s[12:15], s63 offen offset:768 sc1
    buffer_load_dword v100, v7, s[12:15], s63 offen offset:1024 sc1
    buffer_load_dword v101, v7, s[12:15], s63 offen offset:1280 sc1
    buffer_load_dword v102, v7, s[12:15], s63 offen offset:1536 sc1
    buffer_load_dword v103, v7, s[12:15], s63 offen offset:1792 sc1
    s_cmp_lt_u32 s70, 524288
    s_cbranch_scc1 L_v_gp_284
    s_branch L_c_done_1
L_c_done_1:
    s_endpgm
.section .rodata,"a"
.p2align 6
.amdhsa_kernel k3_chain_kernel
  .amdhsa_next_free_vgpr 256
  .amdhsa_next_free_sgpr 102
  .amdhsa_accum_offset 128
  .amdhsa_group_segment_fixed_size 0
  .amdhsa_kernarg_size 136
  .amdhsa_user_sgpr_count 2
  .amdhsa_user_sgpr_kernarg_segment_ptr 1
  .amdhsa_system_sgpr_workgroup_id_x 1
.end_amdhsa_kernel
```

```asm
; @launch kernel=k3_chain_kernel grid=(256,1,1) block=(512,1,1) lds=147712
.amdgcn_target "amdgcn-amd-amdhsa--gfx950"
.text
.globl k3_chain_kernel
.p2align 8
.type k3_chain_kernel,@function
k3_chain_kernel:
    s_cmp_ge_u32 s2, 256
    s_cbranch_scc1 L_c_done_1
    s_load_dwordx4 s[20:23], s[0:1], 120
    v_and_b32 v1, 63, v0
    v_lshrrev_b32 v2, 6, v0
    s_nop 0
    v_readfirstlane_b32 s44, v2
    s_waitcnt lgkmcnt(0)
    s_mov_b32 s12, s22
    s_and_b32 s13, s23, 0xffff
    s_mov_b32 s14, 0x10000000
    s_mov_b32 s15, 0x00020000
    s_mov_b32 s16, s20
    s_and_b32 s17, s21, 0xffff
    s_mov_b32 s18, 0x100
    s_mov_b32 s19, 0x00020000
    s_getpc_b64 s[24:25]
L_c_here_2:
    v_lshlrev_b32 v3, 7, v0
    v_mov_b32 v5, s25
    v_add_co_u32 v4, vcc, s24, v3
    s_nop 1
    v_addc_co_u32 v5, vcc, 0, v5, vcc
    v_cmp_gt_u32 vcc, L_c_done_1 - L_c_here_2, v3
    s_and_saveexec_b64 s[26:27], vcc
    s_cbranch_execz L_c_ct_3
    global_load_dword v109, v[4:5], off
L_c_ct_3:
    s_mov_b64 exec, s[26:27]
    s_load_dwordx4 s[8:11], s[0:1], 96
    v_lshrrev_b32 v5, 3, v0
    v_mul_u32_u24 v6, 24576, v5
    v_and_b32 v7, 7, v0
    v_lshl_add_u32 v6, v7, 4, v6
    v_add_u32 v7, 12288, v6
    v_lshlrev_b32 v5, 2, v5
    s_lshr_b32 s50, s2, 5
    s_and_b32 s51, s2, 31
    s_mul_i32 s52, s50, 1572864
    s_lshl_b32 s53, s51, 7
    s_add_u32 s52, s52, s53
    s_lshl_b32 s53, s50, 8
    s_waitcnt lgkmcnt(0)
    s_mov_b32 s28, s10
    s_and_b32 s29, s11, 0xffff
    s_mov_b32 s30, 0xc00000
    s_mov_b32 s31, 0x00020000
    s_mov_b32 s32, s8
    s_and_b32 s33, s9, 0xffff
    s_mov_b32 s34, 0x800
    s_mov_b32 s35, 0x00020000
    buffer_load_dword v8, v5, s[32:35], s53 offen
    buffer_load_dwordx4 v[12:15], v6, s[28:31], s52 offen nt
    buffer_load_dwordx4 v[16:19], v7, s[28:31], s52 offen nt
    s_getreg_b32 s39, hwreg(HW_REG_XCC_ID)
    s_and_b32 s39, s39, 7
    s_cmp_lg_u32 s44, 1
    s_cbranch_scc1 L_nz_7
    v_mov_b32 v32, 0
    v_mov_b32 v33, 0
    v_mov_b32 v34, 0
    v_mov_b32 v35, 0
    v_lshlrev_b32 v4, 4, v1
    s_lshl_b32 s45, s2, 10
    s_add_u32 s45, s45, 0x100000
    buffer_store_dwordx4 v[32:35], v4, s[12:15], s45 offen sc1
L_nz_7:
    s_waitcnt vmcnt(0)
    v_lshlrev_b32 v9, 16, v8
    v_and_b32 v10, 0xffff0000, v8
    v_mul_f32 v20, 0xbfb8aa3b, v9
    v_mul_f32 v21, 0xbfb8aa3b, v10
    v_exp_f32 v20, v20
    v_exp_f32 v21, v21
    s_nop 0
    v_add_f32 v20, 1.0, v20
    v_add_f32 v21, 1.0, v21
    v_rcp_f32 v20, v20
    v_rcp_f32 v21, v21
    s_nop 0
    v_mul_f32 v9, v9, v20
    v_mul_f32 v10, v10, v21
    v_cvt_pk_bf16_f32 v9, 0, v9
    v_cvt_pk_bf16_f32 v10, 0, v10
    v_lshlrev_b32 v28, 16, v12
    v_and_b32 v29, 0xffff0000, v12
    v_lshlrev_b32 v30, 16, v16
    v_and_b32 v31, 0xffff0000, v16
    v_mul_f32 v20, v28, v9
    v_mul_f32 v21, v29, v9
    v_fmac_f32 v20, v30, v10
    v_fmac_f32 v21, v31, v10
    v_lshlrev_b32 v28, 16, v13
    v_and_b32 v29, 0xffff0000, v13
    v_lshlrev_b32 v30, 16, v17
    v_and_b32 v31, 0xffff0000, v17
    v_mul_f32 v22, v28, v9
    v_mul_f32 v23, v29, v9
    v_fmac_f32 v22, v30, v10
    v_fmac_f32 v23, v31, v10
    v_lshlrev_b32 v28, 16, v14
    v_and_b32 v29, 0xffff0000, v14
    v_lshlrev_b32 v30, 16, v18
    v_and_b32 v31, 0xffff0000, v18
    v_mul_f32 v24, v28, v9
    v_mul_f32 v25, v29, v9
    v_fmac_f32 v24, v30, v10
    v_fmac_f32 v25, v31, v10
    v_lshlrev_b32 v28, 16, v15
    v_and_b32 v29, 0xffff0000, v15
    v_lshlrev_b32 v30, 16, v19
    v_and_b32 v31, 0xffff0000, v19
    v_mul_f32 v26, v28, v9
    v_mul_f32 v27, v29, v9
    v_fmac_f32 v26, v30, v10
    v_fmac_f32 v27, v31, v10
    s_nop 1
    v_add_f32_dpp v20, v20, v20 row_ror:8 row_mask:0xf bank_mask:0xf
    v_add_f32_dpp v21, v21, v21 row_ror:8 row_mask:0xf bank_mask:0xf
    v_add_f32_dpp v22, v22, v22 row_ror:8 row_mask:0xf bank_mask:0xf
    v_add_f32_dpp v23, v23, v23 row_ror:8 row_mask:0xf bank_mask:0xf
    v_add_f32_dpp v24, v24, v24 row_ror:8 row_mask:0xf bank_mask:0xf
    v_add_f32_dpp v25, v25, v25 row_ror:8 row_mask:0xf bank_mask:0xf
    v_add_f32_dpp v26, v26, v26 row_ror:8 row_mask:0xf bank_mask:0xf
    v_add_f32_dpp v27, v27, v27 row_ror:8 row_mask:0xf bank_mask:0xf
    s_nop 1
    v_permlane16_swap_b32 v20, v24
    v_permlane16_swap_b32 v21, v25
    v_permlane16_swap_b32 v22, v26
    v_permlane16_swap_b32 v23, v27
    v_add_f32 v20, v20, v24
    v_add_f32 v21, v21, v25
    v_add_f32 v22, v22, v26
    v_add_f32 v23, v23, v27
    s_nop 1
    v_permlane32_swap_b32 v20, v22
    v_permlane32_swap_b32 v21, v23
    v_add_f32 v20, v20, v22
    v_add_f32 v21, v21, v23
    v_and_b32 v22, 7, v1
    v_lshlrev_b32 v22, 5, v22
    v_bfe_u32 v23, v1, 4, 1
    v_lshl_add_u32 v22, v23, 4, v22
    v_lshrrev_b32 v23, 5, v1
    v_lshl_add_u32 v22, v23, 3, v22
    s_lshl_b32 s52, s44, 8
    s_add_u32 s52, s52, 139776
    v_add_u32 v22, s52, v22
    ds_write_b64 v22, v[20:21]
    s_waitcnt lgkmcnt(0)
    s_barrier
    s_cmp_lg_u32 s44, 1
    s_cbranch_scc1 L_m1_8
    v_lshlrev_b32 v22, 2, v1
    v_add_u32 v23, 139776, v22
    ds_read_b32 v24, v23 offset:0
    ds_read_b32 v25, v23 offset:256
    ds_read_b32 v26, v23 offset:512
    ds_read_b32 v27, v23 offset:768
    ds_read_b32 v28, v23 offset:1024
    ds_read_b32 v29, v23 offset:1280
    ds_read_b32 v30, v23 offset:1536
    ds_read_b32 v31, v23 offset:1792
    s_waitcnt lgkmcnt(0)
    v_add_f32 v24, v24, v28
    v_add_f32 v25, v25, v29
    v_add_f32 v26, v26, v30
    v_add_f32 v27, v27, v31
    v_add_f32 v24, v24, v26
    v_add_f32 v25, v25, v27
    v_add_f32 v24, v24, v25
    s_lshl_b32 s52, s2, 8
    s_add_u32 s52, s52, 0x10000
    buffer_store_dword v24, v22, s[12:15], s52 offen sc1
L_m1_8:
    s_cmp_lg_u32 s44, 1
    s_cbranch_scc1 L_tk_4
    v_mov_b32 v3, 1
    s_mov_b32 s40, s39
    s_lshl_b32 s45, s40, 5
    v_mov_b32 v4, 0
    s_waitcnt vmcnt(0)
    s_mov_b64 exec, 1
    buffer_atomic_add v3, v4, s[16:19], s45 offen sc0
    s_waitcnt vmcnt(0)
    v_readfirstlane_b32 s41, v3
    s_nop 3
    s_cmp_lt_u32 s41, 32
    s_cbranch_scc1 L_got_5
    v_mov_b32 v3, 1
    buffer_atomic_add v3, v4, s[16:19], 0 offen offset:16 sc0
    s_waitcnt vmcnt(0)
    v_readfirstlane_b32 s46, v3
    s_mov_b64 exec, -1
    v_and_b32 v4, 7, v1
    v_lshlrev_b32 v4, 5, v4
    s_mov_b32 s70, 0
L_sp_6:
    s_sleep 8
    buffer_load_dword v3, v4, s[16:19], 0 offen sc1
    s_waitcnt vmcnt(0)
    s_mov_b32 s48, 0
    v_readlane_b32 s50, v3, 0
    v_readlane_b32 s51, v3, 1
    v_readlane_b32 s52, v3, 2
    v_readlane_b32 s53, v3, 3
    v_readlane_b32 s54, v3, 4
    v_readlane_b32 s55, v3, 5
    v_readlane_b32 s56, v3, 6
    v_readlane_b32 s57, v3, 7
    s_nop 3
    s_add_u32 s48, s48, s50
    s_add_u32 s48, s48, s51
    s_add_u32 s48, s48, s52
    s_add_u32 s48, s48, s53
    s_add_u32 s48, s48, s54
    s_add_u32 s48, s48, s55
    s_add_u32 s48, s48, s56
    s_add_u32 s48, s48, s57
    s_add_u32 s70, s70, 1
    s_cmp_ge_u32 s70, 524288
    s_cbranch_scc1 L_c_done_1
    s_cmp_lt_u32 s48, 256
    s_cbranch_scc1 L_sp_6
    s_min_u32 s48, s50, 32
    s_mov_b32 s40, 0
    s_add_u32 s41, s48, s46
    s_cmp_lt_u32 s41, 32
    s_cbranch_scc1 L_got_5
    s_sub_u32 s46, s41, 32
    s_min_u32 s48, s51, 32
    s_mov_b32 s40, 1
    s_add_u32 s41, s48, s46
    s_cmp_lt_u32 s41, 32
    s_cbranch_scc1 L_got_5
    s_sub_u32 s46, s41, 32
    s_min_u32 s48, s52, 32
    s_mov_b32 s40, 2
    s_add_u32 s41, s48, s46
    s_cmp_lt_u32 s41, 32
    s_cbranch_scc1 L_got_5
    s_sub_u32 s46, s41, 32
    s_min_u32 s48, s53, 32
    s_mov_b32 s40, 3
    s_add_u32 s41, s48, s46
    s_cmp_lt_u32 s41, 32
    s_cbranch_scc1 L_got_5
    s_sub_u32 s46, s41, 32
    s_min_u32 s48, s54, 32
    s_mov_b32 s40, 4
    s_add_u32 s41, s48, s46
    s_cmp_lt_u32 s41, 32
    s_cbranch_scc1 L_got_5
    s_sub_u32 s46, s41, 32
    s_min_u32 s48, s55, 32
    s_mov_b32 s40, 5
    s_add_u32 s41, s48, s46
    s_cmp_lt_u32 s41, 32
    s_cbranch_scc1 L_got_5
    s_sub_u32 s46, s41, 32
    s_min_u32 s48, s56, 32
    s_mov_b32 s40, 6
    s_add_u32 s41, s48, s46
    s_cmp_lt_u32 s41, 32
    s_cbranch_scc1 L_got_5
    s_sub_u32 s46, s41, 32
    s_min_u32 s48, s57, 32
    s_mov_b32 s40, 7
    s_add_u32 s41, s48, s46
    s_cmp_lt_u32 s41, 32
    s_cbranch_scc1 L_got_5
    s_sub_u32 s46, s41, 32
    s_branch L_c_done_1
L_got_5:
    s_mov_b64 exec, -1
    s_lshl_b32 s45, s40, 8
    s_or_b32 s45, s45, s41
    v_mov_b32 v3, s45
    v_mov_b32 v4, 147464
    ds_write_b32 v4, v3
    s_waitcnt lgkmcnt(0)
L_tk_4:
    s_barrier
    v_mov_b32 v4, 147464
    ds_read_b32 v3, v4
    s_waitcnt lgkmcnt(0)
    v_readfirstlane_b32 s45, v3
    s_nop 3
    s_lshr_b32 s40, s45, 8
    s_and_b32 s41, s45, 0xff
    s_lshr_b32 s45, s40, 2
    s_xor_b32 s45, s45, 1
    s_lshl_b32 s45, s45, 4
    s_and_b32 s40, s40, 3
    s_lshl_b32 s40, s40, 1
    s_lshr_b32 s46, s41, 4
    s_add_u32 s40, s40, s46
    s_and_b32 s41, s41, 15
    s_add_u32 s41, s41, s45
    s_cmp_lt_u32 s41, 16
    s_cbranch_scc1 L_c_chain_9
    s_sub_u32 s48, s41, 16
    s_mov_b32 s78, 1
    s_cmp_lt_u32 s48, 12
    s_cbranch_scc1 L_w_g_10
    s_and_b32 s42, s48, 3
    s_mov_b32 s43, s40
    s_load_dwordx2 s[4:5], s[0:1], 0
    v_lshlrev_b32 v2, 4, v1
    v_lshlrev_b32 v3, 5, v1
    s_lshl_b32 s55, s43, 2
    s_add_u32 s55, s55, s42
    s_waitcnt lgkmcnt(0)
    s_mov_b32 s24, s4
    s_and_b32 s25, s5, 0xffff
    s_mov_b32 s26, 0x400000
    s_mov_b32 s27, 0x00020000
    s_lshl_b32 s46, s42, 3
    s_add_u32 s46, s46, s44
    s_lshl_b32 s46, s46, 11
    v_add_u32 v7, s46, v2
    s_lshl_b32 s63, s43, 16
    buffer_load_dwordx4 a[0:3], v7, s[24:27], s63 offen
    buffer_load_dwordx4 a[4:7], v7, s[24:27], s63 offen offset:1024
    s_cmp_lg_u32 s44, 0
    s_cbranch_scc1 L_zwok_19
    v_and_b32 v8, 7, v1
    v_lshlrev_b32 v8, 5, v8
    s_mov_b32 s70, 0
L_zw_18:
    buffer_load_dword v9, v8, s[16:19], 0 offen sc1
    s_waitcnt vmcnt(0)
    v_add_u32_dpp v9, v9, v9 row_ror:1 row_mask:0xf bank_mask:0xf
    s_nop 1
    v_add_u32_dpp v9, v9, v9 row_ror:2 row_mask:0xf bank_mask:0xf
    s_nop 1
    v_add_u32_dpp v9, v9, v9 row_ror:4 row_mask:0xf bank_mask:0xf
    v_cmp_ne_u32 vcc, 0x100, v9
    s_add_u32 s70, s70, 1
    s_cbranch_vccz L_zwok_19
    s_sleep 4
    s_cmp_lt_u32 s70, 524288
    s_cbranch_scc1 L_zw_18
    s_branch L_c_done_1
L_zwok_19:
    s_barrier
    v_lshlrev_b32 v4, 4, v0
    s_mov_b32 s46, 0x10000
    buffer_load_dwordx4 v[32:35], v4, s[12:15], s46 offen sc1
    s_mov_b32 s46, 0x12000
    buffer_load_dwordx4 v[36:39], v4, s[12:15], s46 offen sc1
    s_mov_b32 s46, 0x14000
    buffer_load_dwordx4 v[40:43], v4, s[12:15], s46 offen sc1
    s_mov_b32 s46, 0x16000
    buffer_load_dwordx4 v[44:47], v4, s[12:15], s46 offen sc1
    s_mov_b32 s46, 0x18000
    buffer_load_dwordx4 v[48:51], v4, s[12:15], s46 offen sc1
    s_mov_b32 s46, 0x1a000
    buffer_load_dwordx4 v[52:55], v4, s[12:15], s46 offen sc1
    s_mov_b32 s46, 0x1c000
    buffer_load_dwordx4 v[56:59], v4, s[12:15], s46 offen sc1
    s_mov_b32 s46, 0x1e000
    buffer_load_dwordx4 v[60:63], v4, s[12:15], s46 offen sc1
    s_cmp_lg_u32 s44, 0
    s_cbranch_scc1 L_l_nx_20
    s_cmp_ge_u32 s42, 2
    s_cbranch_scc1 L_l_nx_20
    s_or_b32 s47, s39, 0x100
    v_mov_b32 v8, s47
    v_mov_b32 v9, 0
    s_lshl_b32 s46, s40, 3
    s_lshl_b32 s47, s42, 2
    s_add_u32 s46, s46, s47
    s_add_u32 s46, s46, 0x101200
    s_mov_b64 exec, 1
    buffer_store_dword v8, v9, s[12:15], s46 offen sc1
    s_mov_b64 exec, -1
L_l_nx_20:
    s_mul_i32 s46, s44, 2064
    s_add_u32 s46, s46, 32768
    v_add_u32 v10, s46, v2
    v_and_b32 v11, 7, v1
    v_lshrrev_b32 v12, 3, v1
    v_mul_u32_u24 v13, 2064, v11
    v_lshl_add_u32 v13, v12, 4, v13
    s_lshl_b32 s46, s44, 8
    s_add_u32 s46, s46, 32768
    v_add_u32 v13, s46, v13
    v_lshlrev_b32 v11, 4, v11
    v_lshl_add_u32 v11, v12, 9, v11
    s_lshl_b32 s46, s44, 13
    s_lshl_b32 s47, s42, 7
    s_add_u32 s46, s46, s47
    s_add_u32 s46, s46, 0x400000
    v_add_u32 v11, s46, v11
    v_add_u32 v12, 4096, v11
    s_lshl_b32 s52, s43, 9
    s_lshl_b32 s47, s42, 7
    s_add_u32 s52, s52, s47
    s_add_u32 s52, s52, 0x109400
    s_mov_b32 s60, s43
    s_waitcnt vmcnt(0)
    v_add_f32 v32, v32, v48
    v_add_f32 v33, v33, v49
    v_add_f32 v34, v34, v50
    v_add_f32 v35, v35, v51
    v_add_f32 v36, v36, v52
    v_add_f32 v37, v37, v53
    v_add_f32 v38, v38, v54
    v_add_f32 v39, v39, v55
    v_add_f32 v40, v40, v56
    v_add_f32 v41, v41, v57
    v_add_f32 v42, v42, v58
    v_add_f32 v43, v43, v59
    v_add_f32 v44, v44, v60
    v_add_f32 v45, v45, v61
    v_add_f32 v46, v46, v62
    v_add_f32 v47, v47, v63
    v_add_f32 v32, v32, v40
    v_add_f32 v33, v33, v41
    v_add_f32 v34, v34, v42
    v_add_f32 v35, v35, v43
    v_add_f32 v36, v36, v44
    v_add_f32 v37, v37, v45
    v_add_f32 v38, v38, v46
    v_add_f32 v39, v39, v47
    v_add_f32 v32, v32, v36
    v_add_f32 v33, v33, v37
    v_add_f32 v34, v34, v38
    v_add_f32 v35, v35, v39
    v_cvt_pk_bf16_f32 v32, 0, v32
    v_cvt_pk_bf16_f32 v33, 0, v33
    v_cvt_pk_bf16_f32 v34, 0, v34
    v_cvt_pk_bf16_f32 v35, 0, v35
    ds_write_b128 v4, v[32:35]
    s_waitcnt lgkmcnt(0)
    s_barrier
    ds_read_b128 v[48:51], v3 offset:0
    ds_read_b128 v[52:55], v3 offset:16
    ds_read_b128 v[56:59], v3 offset:2048
    ds_read_b128 v[60:63], v3 offset:2064
    ds_read_b128 v[32:35], v3 offset:4096
    ds_read_b128 v[36:39], v3 offset:4112
    ds_read_b128 v[40:43], v3 offset:6144
    ds_read_b128 v[44:47], v3 offset:6160
    s_waitcnt lgkmcnt(0)
    v_add_f32 v32, 1.0, v32
    v_add_f32 v33, 1.0, v33
    v_add_f32 v34, 1.0, v34
    v_add_f32 v35, 1.0, v35
    v_add_f32 v36, 1.0, v36
    v_add_f32 v37, 1.0, v37
    v_add_f32 v38, 1.0, v38
    v_add_f32 v39, 1.0, v39
    v_add_f32 v40, 1.0, v40
    v_add_f32 v41, 1.0, v41
    v_add_f32 v42, 1.0, v42
    v_add_f32 v43, 1.0, v43
    v_add_f32 v44, 1.0, v44
    v_add_f32 v45, 1.0, v45
    v_add_f32 v46, 1.0, v46
    v_add_f32 v47, 1.0, v47
    v_cvt_pk_bf16_f32 v32, 0, v32
    v_cvt_pk_bf16_f32 v33, 0, v33
    v_cvt_pk_bf16_f32 v34, 0, v34
    v_cvt_pk_bf16_f32 v35, 0, v35
    v_cvt_pk_bf16_f32 v36, 0, v36
    v_cvt_pk_bf16_f32 v37, 0, v37
    v_cvt_pk_bf16_f32 v38, 0, v38
    v_cvt_pk_bf16_f32 v39, 0, v39
    v_cvt_pk_bf16_f32 v40, 0, v40
    v_cvt_pk_bf16_f32 v41, 0, v41
    v_cvt_pk_bf16_f32 v42, 0, v42
    v_cvt_pk_bf16_f32 v43, 0, v43
    v_cvt_pk_bf16_f32 v44, 0, v44
    v_cvt_pk_bf16_f32 v45, 0, v45
    v_cvt_pk_bf16_f32 v46, 0, v46
    v_cvt_pk_bf16_f32 v47, 0, v47
L_l_sub_21:
    s_lshl_b32 s63, s60, 16
    v_accvgpr_read_b32 v96, a0
    v_accvgpr_read_b32 v97, a1
    v_accvgpr_read_b32 v98, a2
    v_accvgpr_read_b32 v99, a3
    v_accvgpr_read_b32 v100, a4
    v_accvgpr_read_b32 v101, a5
    v_accvgpr_read_b32 v102, a6
    v_accvgpr_read_b32 v103, a7
    v_lshlrev_b32 v64, 16, v96
    v_and_b32 v65, 0xffff0000, v96
    v_lshlrev_b32 v66, 16, v97
    v_and_b32 v67, 0xffff0000, v97
    v_lshlrev_b32 v68, 16, v98
    v_and_b32 v69, 0xffff0000, v98
    v_lshlrev_b32 v70, 16, v99
    v_and_b32 v71, 0xffff0000, v99
    v_lshlrev_b32 v72, 16, v100
    v_and_b32 v73, 0xffff0000, v100
    v_lshlrev_b32 v74, 16, v101
    v_and_b32 v75, 0xffff0000, v101
    v_lshlrev_b32 v76, 16, v102
    v_and_b32 v77, 0xffff0000, v102
    v_lshlrev_b32 v78, 16, v103
    v_and_b32 v79, 0xffff0000, v103
    v_pk_add_f32 v[80:81], v[64:65], v[72:73]
    v_pk_add_f32 v[82:83], v[66:67], v[74:75]
    v_pk_add_f32 v[84:85], v[68:69], v[76:77]
    v_pk_add_f32 v[86:87], v[70:71], v[78:79]
    v_pk_add_f32 v[80:81], v[80:81], v[84:85]
    v_pk_add_f32 v[82:83], v[82:83], v[86:87]
    v_pk_add_f32 v[80:81], v[80:81], v[82:83]
    v_add_f32 v14, v80, v81
    s_nop 1
    v_add_f32_dpp v14, v14, v14 row_shr:1 row_mask:0xf bank_mask:0xf bound_ctrl:0
    s_nop 1
    v_add_f32_dpp v14, v14, v14 row_shr:2 row_mask:0xf bank_mask:0xf bound_ctrl:0
    s_nop 1
    v_add_f32_dpp v14, v14, v14 row_shr:4 row_mask:0xf bank_mask:0xf bound_ctrl:0
    s_nop 1
    v_add_f32_dpp v14, v14, v14 row_shr:8 row_mask:0xf bank_mask:0xf bound_ctrl:0
    s_nop 1
    v_add_f32_dpp v14, v14, v14 row_bcast:15 row_mask:0xa bank_mask:0xf
    s_nop 1
    v_add_f32_dpp v14, v14, v14 row_bcast:31 row_mask:0xc bank_mask:0xf
    s_nop 1
    v_readlane_b32 s46, v14, 63
    s_nop 1
    v_mov_b32 v15, s46
    v_mul_f32 v15, 0x3a800000, v15
    v_pk_add_f32 v[80:81], v[64:65], v[14:15] op_sel:[0,1] op_sel_hi:[1,1] neg_lo:[0,1] neg_hi:[0,1]
    v_pk_add_f32 v[82:83], v[66:67], v[14:15] op_sel:[0,1] op_sel_hi:[1,1] neg_lo:[0,1] neg_hi:[0,1]
    v_pk_add_f32 v[84:85], v[68:69], v[14:15] op_sel:[0,1] op_sel_hi:[1,1] neg_lo:[0,1] neg_hi:[0,1]
    v_pk_add_f32 v[86:87], v[70:71], v[14:15] op_sel:[0,1] op_sel_hi:[1,1] neg_lo:[0,1] neg_hi:[0,1]
    v_pk_add_f32 v[88:89], v[72:73], v[14:15] op_sel:[0,1] op_sel_hi:[1,1] neg_lo:[0,1] neg_hi:[0,1]
    v_pk_add_f32 v[90:91], v[74:75], v[14:15] op_sel:[0,1] op_sel_hi:[1,1] neg_lo:[0,1] neg_hi:[0,1]
    v_pk_add_f32 v[92:93], v[76:77], v[14:15] op_sel:[0,1] op_sel_hi:[1,1] neg_lo:[0,1] neg_hi:[0,1]
    v_pk_add_f32 v[94:95], v[78:79], v[14:15] op_sel:[0,1] op_sel_hi:[1,1] neg_lo:[0,1] neg_hi:[0,1]
    v_pk_mul_f32 v[104:105], v[80:81], v[80:81]
    v_pk_mul_f32 v[106:107], v[82:83], v[82:83]
    v_pk_fma_f32 v[104:105], v[84:85], v[84:85], v[104:105]
    v_pk_fma_f32 v[106:107], v[86:87], v[86:87], v[106:107]
    v_pk_fma_f32 v[104:105], v[88:89], v[88:89], v[104:105]
    v_pk_fma_f32 v[106:107], v[90:91], v[90:91], v[106:107]
    v_pk_fma_f32 v[104:105], v[92:93], v[92:93], v[104:105]
    v_pk_fma_f32 v[106:107], v[94:95], v[94:95], v[106:107]
    v_pk_add_f32 v[104:105], v[104:105], v[106:107]
    v_add_f32 v14, v104, v105
    v_cvt_pk_bf16_f32 v15, 0, v15
    s_nop 1
    v_add_f32_dpp v14, v14, v14 row_shr:1 row_mask:0xf bank_mask:0xf bound_ctrl:0
    s_nop 1
    v_add_f32_dpp v14, v14, v14 row_shr:2 row_mask:0xf bank_mask:0xf bound_ctrl:0
    s_nop 1
    v_add_f32_dpp v14, v14, v14 row_shr:4 row_mask:0xf bank_mask:0xf bound_ctrl:0
    s_nop 1
    v_add_f32_dpp v14, v14, v14 row_shr:8 row_mask:0xf bank_mask:0xf bound_ctrl:0
    s_nop 1
    v_add_f32_dpp v14, v14, v14 row_bcast:15 row_mask:0xa bank_mask:0xf
    s_nop 1
    v_add_f32_dpp v14, v14, v14 row_bcast:31 row_mask:0xc bank_mask:0xf
    s_nop 1
    v_readlane_b32 s47, v14, 63
    v_pk_add_f32 v[64:65], v[64:65], v[14:15] op_sel:[0,1] op_sel_hi:[1,1] neg_lo:[0,1] neg_hi:[0,1]
    v_pk_add_f32 v[66:67], v[66:67], v[14:15] op_sel:[0,1] op_sel_hi:[1,1] neg_lo:[0,1] neg_hi:[0,1]
    v_pk_add_f32 v[68:69], v[68:69], v[14:15] op_sel:[0,1] op_sel_hi:[1,1] neg_lo:[0,1] neg_hi:[0,1]
    v_pk_add_f32 v[70:71], v[70:71], v[14:15] op_sel:[0,1] op_sel_hi:[1,1] neg_lo:[0,1] neg_hi:[0,1]
    v_pk_add_f32 v[72:73], v[72:73], v[14:15] op_sel:[0,1] op_sel_hi:[1,1] neg_lo:[0,1] neg_hi:[0,1]
    v_pk_add_f32 v[74:75], v[74:75], v[14:15] op_sel:[0,1] op_sel_hi:[1,1] neg_lo:[0,1] neg_hi:[0,1]
    v_pk_add_f32 v[76:77], v[76:77], v[14:15] op_sel:[0,1] op_sel_hi:[1,1] neg_lo:[0,1] neg_hi:[0,1]
    v_pk_add_f32 v[78:79], v[78:79], v[14:15] op_sel:[0,1] op_sel_hi:[1,1] neg_lo:[0,1] neg_hi:[0,1]
    v_mov_b32 v14, s47
    v_mul_f32 v14, 0x3a800000, v14
    v_cvt_pk_bf16_f32 v14, 0, v14
    v_add_f32 v14, 0x3727c5ac, v14
    v_cvt_pk_bf16_f32 v14, 0, v14
    v_sqrt_f32 v14, v14
    s_nop 0
    v_cvt_pk_bf16_f32 v14, 0, v14
    v_rcp_f32 v14, v14
    v_cvt_pk_bf16_f32 v64, 0, v64
    v_cvt_pk_bf16_f32 v65, 0, v65
    v_cvt_pk_bf16_f32 v66, 0, v66
    v_cvt_pk_bf16_f32 v67, 0, v67
    v_cvt_pk_bf16_f32 v68, 0, v68
    v_cvt_pk_bf16_f32 v69, 0, v69
    v_cvt_pk_bf16_f32 v70, 0, v70
    v_cvt_pk_bf16_f32 v71, 0, v71
    v_cvt_pk_bf16_f32 v72, 0, v72
    v_cvt_pk_bf16_f32 v73, 0, v73
    v_cvt_pk_bf16_f32 v74, 0, v74
    v_cvt_pk_bf16_f32 v75, 0, v75
    v_cvt_pk_bf16_f32 v76, 0, v76
    v_cvt_pk_bf16_f32 v77, 0, v77
    v_cvt_pk_bf16_f32 v78, 0, v78
    v_cvt_pk_bf16_f32 v79, 0, v79
    v_pk_mul_f32 v[64:65], v[64:65], v[14:15] op_sel_hi:[1,0]
    v_pk_mul_f32 v[66:67], v[66:67], v[14:15] op_sel_hi:[1,0]
    v_pk_mul_f32 v[68:69], v[68:69], v[14:15] op_sel_hi:[1,0]
    v_pk_mul_f32 v[70:71], v[70:71], v[14:15] op_sel_hi:[1,0]
    v_pk_mul_f32 v[72:73], v[72:73], v[14:15] op_sel_hi:[1,0]
    v_pk_mul_f32 v[74:75], v[74:75], v[14:15] op_sel_hi:[1,0]
    v_pk_mul_f32 v[76:77], v[76:77], v[14:15] op_sel_hi:[1,0]
    v_pk_mul_f32 v[78:79], v[78:79], v[14:15] op_sel_hi:[1,0]
    v_cvt_pk_bf16_f32 v64, 0, v64
    v_cvt_pk_bf16_f32 v65, 0, v65
    v_cvt_pk_bf16_f32 v66, 0, v66
    v_cvt_pk_bf16_f32 v67, 0, v67
    v_cvt_pk_bf16_f32 v68, 0, v68
    v_cvt_pk_bf16_f32 v69, 0, v69
    v_cvt_pk_bf16_f32 v70, 0, v70
    v_cvt_pk_bf16_f32 v71, 0, v71
    v_cvt_pk_bf16_f32 v72, 0, v72
    v_cvt_pk_bf16_f32 v73, 0, v73
    v_cvt_pk_bf16_f32 v74, 0, v74
    v_cvt_pk_bf16_f32 v75, 0, v75
    v_cvt_pk_bf16_f32 v76, 0, v76
    v_cvt_pk_bf16_f32 v77, 0, v77
    v_cvt_pk_bf16_f32 v78, 0, v78
    v_cvt_pk_bf16_f32 v79, 0, v79
    v_pk_mul_f32 v[64:65], v[64:65], v[32:33]
    v_pk_mul_f32 v[66:67], v[66:67], v[34:35]
    v_pk_mul_f32 v[68:69], v[68:69], v[36:37]
    v_pk_mul_f32 v[70:71], v[70:71], v[38:39]
    v_pk_mul_f32 v[72:73], v[72:73], v[40:41]
    v_pk_mul_f32 v[74:75], v[74:75], v[42:43]
    v_pk_mul_f32 v[76:77], v[76:77], v[44:45]
    v_pk_mul_f32 v[78:79], v[78:79], v[46:47]
    v_cvt_pk_bf16_f32 v64, 0, v64
    v_cvt_pk_bf16_f32 v65, 0, v65
    v_cvt_pk_bf16_f32 v66, 0, v66
    v_cvt_pk_bf16_f32 v67, 0, v67
    v_cvt_pk_bf16_f32 v68, 0, v68
    v_cvt_pk_bf16_f32 v69, 0, v69
    v_cvt_pk_bf16_f32 v70, 0, v70
    v_cvt_pk_bf16_f32 v71, 0, v71
    v_cvt_pk_bf16_f32 v72, 0, v72
    v_cvt_pk_bf16_f32 v73, 0, v73
    v_cvt_pk_bf16_f32 v74, 0, v74
    v_cvt_pk_bf16_f32 v75, 0, v75
    v_cvt_pk_bf16_f32 v76, 0, v76
    v_cvt_pk_bf16_f32 v77, 0, v77
    v_cvt_pk_bf16_f32 v78, 0, v78
    v_cvt_pk_bf16_f32 v79, 0, v79
    v_pk_add_f32 v[64:65], v[64:65], v[48:49]
    v_pk_add_f32 v[66:67], v[66:67], v[50:51]
    v_pk_add_f32 v[68:69], v[68:69], v[52:53]
    v_pk_add_f32 v[70:71], v[70:71], v[54:55]
    v_pk_add_f32 v[72:73], v[72:73], v[56:57]
    v_pk_add_f32 v[74:75], v[74:75], v[58:59]
    v_pk_add_f32 v[76:77], v[76:77], v[60:61]
    v_pk_add_f32 v[78:79], v[78:79], v[62:63]
    v_cvt_pk_bf16_f32 v104, v64, v65
    v_cvt_pk_bf16_f32 v105, v66, v67
    v_cvt_pk_bf16_f32 v106, v68, v69
    v_cvt_pk_bf16_f32 v107, v70, v71
    v_cvt_pk_bf16_f32 v108, v72, v73
    v_cvt_pk_bf16_f32 v109, v74, v75
    v_cvt_pk_bf16_f32 v110, v76, v77
    v_cvt_pk_bf16_f32 v111, v78, v79
    ds_write_b128 v10, v[104:107]
    ds_write_b128 v10, v[108:111] offset:1024
    s_waitcnt lgkmcnt(0)
    s_barrier
    ds_read_b128 v[104:107], v13
    ds_read_b128 v[108:111], v13 offset:128
    s_waitcnt lgkmcnt(1)
    buffer_store_dwordx4 v[104:107], v11, s[12:15], s63 offen sc1
    s_waitcnt lgkmcnt(0)
    buffer_store_dwordx4 v[108:111], v12, s[12:15], s63 offen sc1
    s_waitcnt vmcnt(0)
    s_barrier
    s_cmp_lg_u32 s44, 0
    s_cbranch_scc1 L_sf_23
    v_mov_b32 v14, s60
    v_add_u32 v14, 1, v14
    v_mov_b32 v15, 0
    s_mov_b64 exec, 1
    buffer_store_dword v14, v15, s[12:15], s52 offen sc1
    s_mov_b64 exec, -1
L_sf_23:
    s_cmp_ge_u32 s60, 8
    s_cbranch_scc1 L_l_end_22
    s_add_u32 s63, s63, 524288
    buffer_load_dwordx4 a[8:11], v7, s[24:27], s63 offen
    buffer_load_dwordx4 a[12:15], v7, s[24:27], s63 offen offset:1024
    s_add_u32 s63, s63, 524288
    buffer_load_dwordx4 a[16:19], v7, s[24:27], s63 offen
    buffer_load_dwordx4 a[20:23], v7, s[24:27], s63 offen offset:1024
    s_add_u32 s63, s63, 524288
    buffer_load_dwordx4 a[24:27], v7, s[24:27], s63 offen
    buffer_load_dwordx4 a[28:31], v7, s[24:27], s63 offen offset:1024
    s_add_u32 s63, s63, 524288
    buffer_load_dwordx4 a[32:35], v7, s[24:27], s63 offen
    buffer_load_dwordx4 a[36:39], v7, s[24:27], s63 offen offset:1024
    s_add_u32 s63, s63, 524288
    buffer_load_dwordx4 a[40:43], v7, s[24:27], s63 offen
    buffer_load_dwordx4 a[44:47], v7, s[24:27], s63 offen offset:1024
    s_add_u32 s63, s63, 524288
    buffer_load_dwordx4 a[48:51], v7, s[24:27], s63 offen
    buffer_load_dwordx4 a[52:55], v7, s[24:27], s63 offen offset:1024
    s_add_u32 s63, s63, 524288
    buffer_load_dwordx4 a[56:59], v7, s[24:27], s63 offen
    buffer_load_dwordx4 a[60:63], v7, s[24:27], s63 offen offset:1024
    s_waitcnt vmcnt(0)
L_l_end_22:
    v_accvgpr_mov_b32 a0, a8
    v_accvgpr_mov_b32 a1, a9
    v_accvgpr_mov_b32 a2, a10
    v_accvgpr_mov_b32 a3, a11
    v_accvgpr_mov_b32 a4, a12
    v_accvgpr_mov_b32 a5, a13
    v_accvgpr_mov_b32 a6, a14
    v_accvgpr_mov_b32 a7, a15
    v_accvgpr_mov_b32 a8, a16
    v_accvgpr_mov_b32 a9, a17
    v_accvgpr_mov_b32 a10, a18
    v_accvgpr_mov_b32 a11, a19
    v_accvgpr_mov_b32 a12, a20
    v_accvgpr_mov_b32 a13, a21
    v_accvgpr_mov_b32 a14, a22
    v_accvgpr_mov_b32 a15, a23
    v_accvgpr_mov_b32 a16, a24
    v_accvgpr_mov_b32 a17, a25
    v_accvgpr_mov_b32 a18, a26
    v_accvgpr_mov_b32 a19, a27
    v_accvgpr_mov_b32 a20, a28
    v_accvgpr_mov_b32 a21, a29
    v_accvgpr_mov_b32 a22, a30
    v_accvgpr_mov_b32 a23, a31
    v_accvgpr_mov_b32 a24, a32
    v_accvgpr_mov_b32 a25, a33
    v_accvgpr_mov_b32 a26, a34
    v_accvgpr_mov_b32 a27, a35
    v_accvgpr_mov_b32 a28, a36
    v_accvgpr_mov_b32 a29, a37
    v_accvgpr_mov_b32 a30, a38
    v_accvgpr_mov_b32 a31, a39
    v_accvgpr_mov_b32 a32, a40
    v_accvgpr_mov_b32 a33, a41
    v_accvgpr_mov_b32 a34, a42
    v_accvgpr_mov_b32 a35, a43
    v_accvgpr_mov_b32 a36, a44
    v_accvgpr_mov_b32 a37, a45
    v_accvgpr_mov_b32 a38, a46
    v_accvgpr_mov_b32 a39, a47
    v_accvgpr_mov_b32 a40, a48
    v_accvgpr_mov_b32 a41, a49
    v_accvgpr_mov_b32 a42, a50
    v_accvgpr_mov_b32 a43, a51
    v_accvgpr_mov_b32 a44, a52
    v_accvgpr_mov_b32 a45, a53
    v_accvgpr_mov_b32 a46, a54
    v_accvgpr_mov_b32 a47, a55
    v_accvgpr_mov_b32 a48, a56
    v_accvgpr_mov_b32 a49, a57
    v_accvgpr_mov_b32 a50, a58
    v_accvgpr_mov_b32 a51, a59
    v_accvgpr_mov_b32 a52, a60
    v_accvgpr_mov_b32 a53, a61
    v_accvgpr_mov_b32 a54, a62
    v_accvgpr_mov_b32 a55, a63
    s_add_u32 s60, s60, 8
    s_cmp_lt_u32 s60, 64
    s_cbranch_scc1 L_l_sub_21
    s_cmp_lt_u32 s48, 14
    s_cbranch_scc1 L_w_h_17_s
    s_and_b32 s55, s48, 1
    s_lshl_b32 s55, s55, 3
    s_add_u32 s55, s55, s40
    s_load_dwordx4 s[8:11], s[0:1], 96
    v_lshrrev_b32 v5, 3, v0
    s_mov_b32 s46, 196608
    v_mul_lo_u32 v4, v5, s46
    v_and_b32 v6, 7, v0
    v_lshl_add_u32 v4, v6, 4, v4
    v_lshlrev_b32 v5, 5, v5
    s_waitcnt lgkmcnt(0)
    s_mov_b32 s28, s10
    s_and_b32 s29, s11, 0xffff
    s_mov_b32 s30, 0xc00000
    s_mov_b32 s31, 0x00020000
    s_mov_b32 s32, s8
    s_and_b32 s33, s9, 0xffff
    s_mov_b32 s34, 0x800
    s_mov_b32 s35, 0x00020000
    buffer_load_dwordx4 v[8:11], v5, s[32:35], 0 offen
    buffer_load_dwordx4 v[12:15], v5, s[32:35], 0 offen offset:16
    s_waitcnt vmcnt(0)
    v_lshlrev_b32 v16, 16, v8
    v_and_b32 v17, 0xffff0000, v8
    v_lshlrev_b32 v18, 16, v9
    v_and_b32 v19, 0xffff0000, v9
    v_lshlrev_b32 v20, 16, v10
    v_and_b32 v21, 0xffff0000, v10
    v_lshlrev_b32 v22, 16, v11
    v_and_b32 v23, 0xffff0000, v11
    v_lshlrev_b32 v24, 16, v12
    v_and_b32 v25, 0xffff0000, v12
    v_lshlrev_b32 v26, 16, v13
    v_and_b32 v27, 0xffff0000, v13
    v_lshlrev_b32 v28, 16, v14
    v_and_b32 v29, 0xffff0000, v14
    v_lshlrev_b32 v30, 16, v15
    v_and_b32 v31, 0xffff0000, v15
    v_mul_f32 v112, 0xbfb8aa3b, v16
    v_mul_f32 v113, 0xbfb8aa3b, v17
    v_mul_f32 v114, 0xbfb8aa3b, v18
    v_mul_f32 v115, 0xbfb8aa3b, v19
    v_mul_f32 v116, 0xbfb8aa3b, v20
    v_mul_f32 v117, 0xbfb8aa3b, v21
    v_mul_f32 v118, 0xbfb8aa3b, v22
    v_mul_f32 v119, 0xbfb8aa3b, v23
    v_mul_f32 v120, 0xbfb8aa3b, v24
    v_mul_f32 v121, 0xbfb8aa3b, v25
    v_mul_f32 v122, 0xbfb8aa3b, v26
    v_mul_f32 v123, 0xbfb8aa3b, v27
    v_mul_f32 v124, 0xbfb8aa3b, v28
    v_mul_f32 v125, 0xbfb8aa3b, v29
    v_mul_f32 v126, 0xbfb8aa3b, v30
    v_mul_f32 v127, 0xbfb8aa3b, v31
    v_exp_f32 v112, v112
    v_exp_f32 v113, v113
    v_exp_f32 v114, v114
    v_exp_f32 v115, v115
    v_exp_f32 v116, v116
    v_exp_f32 v117, v117
    v_exp_f32 v118, v118
    v_exp_f32 v119, v119
    v_exp_f32 v120, v120
    v_exp_f32 v121, v121
    v_exp_f32 v122, v122
    v_exp_f32 v123, v123
    v_exp_f32 v124, v124
    v_exp_f32 v125, v125
    v_exp_f32 v126, v126
    v_exp_f32 v127, v127
    v_add_f32 v112, 1.0, v112
    v_add_f32 v113, 1.0, v113
    v_add_f32 v114, 1.0, v114
    v_add_f32 v115, 1.0, v115
    v_add_f32 v116, 1.0, v116
    v_add_f32 v117, 1.0, v117
    v_add_f32 v118, 1.0, v118
    v_add_f32 v119, 1.0, v119
    v_add_f32 v120, 1.0, v120
    v_add_f32 v121, 1.0, v121
    v_add_f32 v122, 1.0, v122
    v_add_f32 v123, 1.0, v123
    v_add_f32 v124, 1.0, v124
    v_add_f32 v125, 1.0, v125
    v_add_f32 v126, 1.0, v126
    v_add_f32 v127, 1.0, v127
    v_rcp_f32 v112, v112
    v_rcp_f32 v113, v113
    v_rcp_f32 v114, v114
    v_rcp_f32 v115, v115
    v_rcp_f32 v116, v116
    v_rcp_f32 v117, v117
    v_rcp_f32 v118, v118
    v_rcp_f32 v119, v119
    v_rcp_f32 v120, v120
    v_rcp_f32 v121, v121
    v_rcp_f32 v122, v122
    v_rcp_f32 v123, v123
    v_rcp_f32 v124, v124
    v_rcp_f32 v125, v125
    v_rcp_f32 v126, v126
    v_rcp_f32 v127, v127
    v_mul_f32 v16, v16, v112
    v_mul_f32 v17, v17, v113
    v_mul_f32 v18, v18, v114
    v_mul_f32 v19, v19, v115
    v_mul_f32 v20, v20, v116
    v_mul_f32 v21, v21, v117
    v_mul_f32 v22, v22, v118
    v_mul_f32 v23, v23, v119
    v_mul_f32 v24, v24, v120
    v_mul_f32 v25, v25, v121
    v_mul_f32 v26, v26, v122
    v_mul_f32 v27, v27, v123
    v_mul_f32 v28, v28, v124
    v_mul_f32 v29, v29, v125
    v_mul_f32 v30, v30, v126
    v_mul_f32 v31, v31, v127
    v_cvt_pk_bf16_f32 v16, 0, v16
    v_cvt_pk_bf16_f32 v17, 0, v17
    v_cvt_pk_bf16_f32 v18, 0, v18
    v_cvt_pk_bf16_f32 v19, 0, v19
    v_cvt_pk_bf16_f32 v20, 0, v20
    v_cvt_pk_bf16_f32 v21, 0, v21
    v_cvt_pk_bf16_f32 v22, 0, v22
    v_cvt_pk_bf16_f32 v23, 0, v23
    v_cvt_pk_bf16_f32 v24, 0, v24
    v_cvt_pk_bf16_f32 v25, 0, v25
    v_cvt_pk_bf16_f32 v26, 0, v26
    v_cvt_pk_bf16_f32 v27, 0, v27
    v_cvt_pk_bf16_f32 v28, 0, v28
    v_cvt_pk_bf16_f32 v29, 0, v29
    v_cvt_pk_bf16_f32 v30, 0, v30
    v_cvt_pk_bf16_f32 v31, 0, v31
    s_lshl_b32 s53, s55, 9
    s_add_u32 s53, s53, 4096
L_m_loop_24:
    s_add_u32 s46, s53, 0
    buffer_load_dwordx4 v[32:35], v4, s[28:31], s46 offen nt
    s_add_u32 s46, s53, 12288
    buffer_load_dwordx4 v[36:39], v4, s[28:31], s46 offen nt
    s_add_u32 s46, s53, 24576
    buffer_load_dwordx4 v[40:43], v4, s[28:31], s46 offen nt
    s_add_u32 s46, s53, 36864
    buffer_load_dwordx4 v[44:47], v4, s[28:31], s46 offen nt
    s_add_u32 s46, s53, 49152
    buffer_load_dwordx4 v[48:51], v4, s[28:31], s46 offen nt
    s_add_u32 s46, s53, 61440
    buffer_load_dwordx4 v[52:55], v4, s[28:31], s46 offen nt
    s_add_u32 s46, s53, 73728
    buffer_load_dwordx4 v[56:59], v4, s[28:31], s46 offen nt
    s_add_u32 s46, s53, 86016
    buffer_load_dwordx4 v[60:63], v4, s[28:31], s46 offen nt
    s_add_u32 s46, s53, 98304
    buffer_load_dwordx4 v[64:67], v4, s[28:31], s46 offen nt
    s_add_u32 s46, s53, 110592
    buffer_load_dwordx4 v[68:71], v4, s[28:31], s46 offen nt
    s_add_u32 s46, s53, 122880
    buffer_load_dwordx4 v[72:75], v4, s[28:31], s46 offen nt
    s_add_u32 s46, s53, 135168
    buffer_load_dwordx4 v[76:79], v4, s[28:31], s46 offen nt
    s_add_u32 s46, s53, 147456
    buffer_load_dwordx4 v[80:83], v4, s[28:31], s46 offen nt
    s_add_u32 s46, s53, 159744
    buffer_load_dwordx4 v[84:87], v4, s[28:31], s46 offen nt
    s_add_u32 s46, s53, 172032
    buffer_load_dwordx4 v[88:91], v4, s[28:31], s46 offen nt
    s_add_u32 s46, s53, 184320
    buffer_load_dwordx4 v[92:95], v4, s[28:31], s46 offen nt
    s_waitcnt vmcnt(15)
    v_lshlrev_b32 v104, 16, v32
    v_and_b32 v105, 0xffff0000, v32
    v_mul_f32 v96, v104, v16
    v_mul_f32 v97, v105, v16
    v_lshlrev_b32 v104, 16, v33
    v_and_b32 v105, 0xffff0000, v33
    v_mul_f32 v98, v104, v16
    v_mul_f32 v99, v105, v16
    v_lshlrev_b32 v104, 16, v34
    v_and_b32 v105, 0xffff0000, v34
    v_mul_f32 v100, v104, v16
    v_mul_f32 v101, v105, v16
    v_lshlrev_b32 v104, 16, v35
    v_and_b32 v105, 0xffff0000, v35
    v_mul_f32 v102, v104, v16
    v_mul_f32 v103, v105, v16
    s_waitcnt vmcnt(14)
    v_lshlrev_b32 v104, 16, v36
    v_and_b32 v105, 0xffff0000, v36
    v_fmac_f32 v96, v104, v17
    v_fmac_f32 v97, v105, v17
    v_lshlrev_b32 v104, 16, v37
    v_and_b32 v105, 0xffff0000, v37
    v_fmac_f32 v98, v104, v17
    v_fmac_f32 v99, v105, v17
    v_lshlrev_b32 v104, 16, v38
    v_and_b32 v105, 0xffff0000, v38
    v_fmac_f32 v100, v104, v17
    v_fmac_f32 v101, v105, v17
    v_lshlrev_b32 v104, 16, v39
    v_and_b32 v105, 0xffff0000, v39
    v_fmac_f32 v102, v104, v17
    v_fmac_f32 v103, v105, v17
    s_waitcnt vmcnt(13)
    v_lshlrev_b32 v104, 16, v40
    v_and_b32 v105, 0xffff0000, v40
    v_fmac_f32 v96, v104, v18
    v_fmac_f32 v97, v105, v18
    v_lshlrev_b32 v104, 16, v41
    v_and_b32 v105, 0xffff0000, v41
    v_fmac_f32 v98, v104, v18
    v_fmac_f32 v99, v105, v18
    v_lshlrev_b32 v104, 16, v42
    v_and_b32 v105, 0xffff0000, v42
    v_fmac_f32 v100, v104, v18
    v_fmac_f32 v101, v105, v18
    v_lshlrev_b32 v104, 16, v43
    v_and_b32 v105, 0xffff0000, v43
    v_fmac_f32 v102, v104, v18
    v_fmac_f32 v103, v105, v18
    s_waitcnt vmcnt(12)
    v_lshlrev_b32 v104, 16, v44
    v_and_b32 v105, 0xffff0000, v44
    v_fmac_f32 v96, v104, v19
    v_fmac_f32 v97, v105, v19
    v_lshlrev_b32 v104, 16, v45
    v_and_b32 v105, 0xffff0000, v45
    v_fmac_f32 v98, v104, v19
    v_fmac_f32 v99, v105, v19
    v_lshlrev_b32 v104, 16, v46
    v_and_b32 v105, 0xffff0000, v46
    v_fmac_f32 v100, v104, v19
    v_fmac_f32 v101, v105, v19
    v_lshlrev_b32 v104, 16, v47
    v_and_b32 v105, 0xffff0000, v47
    v_fmac_f32 v102, v104, v19
    v_fmac_f32 v103, v105, v19
    s_waitcnt vmcnt(11)
    v_lshlrev_b32 v104, 16, v48
    v_and_b32 v105, 0xffff0000, v48
    v_fmac_f32 v96, v104, v20
    v_fmac_f32 v97, v105, v20
    v_lshlrev_b32 v104, 16, v49
    v_and_b32 v105, 0xffff0000, v49
    v_fmac_f32 v98, v104, v20
    v_fmac_f32 v99, v105, v20
    v_lshlrev_b32 v104, 16, v50
    v_and_b32 v105, 0xffff0000, v50
    v_fmac_f32 v100, v104, v20
    v_fmac_f32 v101, v105, v20
    v_lshlrev_b32 v104, 16, v51
    v_and_b32 v105, 0xffff0000, v51
    v_fmac_f32 v102, v104, v20
    v_fmac_f32 v103, v105, v20
    s_waitcnt vmcnt(10)
    v_lshlrev_b32 v104, 16, v52
    v_and_b32 v105, 0xffff0000, v52
    v_fmac_f32 v96, v104, v21
    v_fmac_f32 v97, v105, v21
    v_lshlrev_b32 v104, 16, v53
    v_and_b32 v105, 0xffff0000, v53
    v_fmac_f32 v98, v104, v21
    v_fmac_f32 v99, v105, v21
    v_lshlrev_b32 v104, 16, v54
    v_and_b32 v105, 0xffff0000, v54
    v_fmac_f32 v100, v104, v21
    v_fmac_f32 v101, v105, v21
    v_lshlrev_b32 v104, 16, v55
    v_and_b32 v105, 0xffff0000, v55
    v_fmac_f32 v102, v104, v21
    v_fmac_f32 v103, v105, v21
    s_waitcnt vmcnt(9)
    v_lshlrev_b32 v104, 16, v56
    v_and_b32 v105, 0xffff0000, v56
    v_fmac_f32 v96, v104, v22
    v_fmac_f32 v97, v105, v22
    v_lshlrev_b32 v104, 16, v57
    v_and_b32 v105, 0xffff0000, v57
    v_fmac_f32 v98, v104, v22
    v_fmac_f32 v99, v105, v22
    v_lshlrev_b32 v104, 16, v58
    v_and_b32 v105, 0xffff0000, v58
    v_fmac_f32 v100, v104, v22
    v_fmac_f32 v101, v105, v22
    v_lshlrev_b32 v104, 16, v59
    v_and_b32 v105, 0xffff0000, v59
    v_fmac_f32 v102, v104, v22
    v_fmac_f32 v103, v105, v22
    s_waitcnt vmcnt(8)
    v_lshlrev_b32 v104, 16, v60
    v_and_b32 v105, 0xffff0000, v60
    v_fmac_f32 v96, v104, v23
    v_fmac_f32 v97, v105, v23
    v_lshlrev_b32 v104, 16, v61
    v_and_b32 v105, 0xffff0000, v61
    v_fmac_f32 v98, v104, v23
    v_fmac_f32 v99, v105, v23
    v_lshlrev_b32 v104, 16, v62
    v_and_b32 v105, 0xffff0000, v62
    v_fmac_f32 v100, v104, v23
    v_fmac_f32 v101, v105, v23
    v_lshlrev_b32 v104, 16, v63
    v_and_b32 v105, 0xffff0000, v63
    v_fmac_f32 v102, v104, v23
    v_fmac_f32 v103, v105, v23
    s_waitcnt vmcnt(7)
    v_lshlrev_b32 v104, 16, v64
    v_and_b32 v105, 0xffff0000, v64
    v_fmac_f32 v96, v104, v24
    v_fmac_f32 v97, v105, v24
    v_lshlrev_b32 v104, 16, v65
    v_and_b32 v105, 0xffff0000, v65
    v_fmac_f32 v98, v104, v24
    v_fmac_f32 v99, v105, v24
    v_lshlrev_b32 v104, 16, v66
    v_and_b32 v105, 0xffff0000, v66
    v_fmac_f32 v100, v104, v24
    v_fmac_f32 v101, v105, v24
    v_lshlrev_b32 v104, 16, v67
    v_and_b32 v105, 0xffff0000, v67
    v_fmac_f32 v102, v104, v24
    v_fmac_f32 v103, v105, v24
    s_waitcnt vmcnt(6)
    v_lshlrev_b32 v104, 16, v68
    v_and_b32 v105, 0xffff0000, v68
    v_fmac_f32 v96, v104, v25
    v_fmac_f32 v97, v105, v25
    v_lshlrev_b32 v104, 16, v69
    v_and_b32 v105, 0xffff0000, v69
    v_fmac_f32 v98, v104, v25
    v_fmac_f32 v99, v105, v25
    v_lshlrev_b32 v104, 16, v70
    v_and_b32 v105, 0xffff0000, v70
    v_fmac_f32 v100, v104, v25
    v_fmac_f32 v101, v105, v25
    v_lshlrev_b32 v104, 16, v71
    v_and_b32 v105, 0xffff0000, v71
    v_fmac_f32 v102, v104, v25
    v_fmac_f32 v103, v105, v25
    s_waitcnt vmcnt(5)
    v_lshlrev_b32 v104, 16, v72
    v_and_b32 v105, 0xffff0000, v72
    v_fmac_f32 v96, v104, v26
    v_fmac_f32 v97, v105, v26
    v_lshlrev_b32 v104, 16, v73
    v_and_b32 v105, 0xffff0000, v73
    v_fmac_f32 v98, v104, v26
    v_fmac_f32 v99, v105, v26
    v_lshlrev_b32 v104, 16, v74
    v_and_b32 v105, 0xffff0000, v74
    v_fmac_f32 v100, v104, v26
    v_fmac_f32 v101, v105, v26
    v_lshlrev_b32 v104, 16, v75
    v_and_b32 v105, 0xffff0000, v75
    v_fmac_f32 v102, v104, v26
    v_fmac_f32 v103, v105, v26
    s_waitcnt vmcnt(4)
    v_lshlrev_b32 v104, 16, v76
    v_and_b32 v105, 0xffff0000, v76
    v_fmac_f32 v96, v104, v27
    v_fmac_f32 v97, v105, v27
    v_lshlrev_b32 v104, 16, v77
    v_and_b32 v105, 0xffff0000, v77
    v_fmac_f32 v98, v104, v27
    v_fmac_f32 v99, v105, v27
    v_lshlrev_b32 v104, 16, v78
    v_and_b32 v105, 0xffff0000, v78
    v_fmac_f32 v100, v104, v27
    v_fmac_f32 v101, v105, v27
    v_lshlrev_b32 v104, 16, v79
    v_and_b32 v105, 0xffff0000, v79
    v_fmac_f32 v102, v104, v27
    v_fmac_f32 v103, v105, v27
    s_waitcnt vmcnt(3)
    v_lshlrev_b32 v104, 16, v80
    v_and_b32 v105, 0xffff0000, v80
    v_fmac_f32 v96, v104, v28
    v_fmac_f32 v97, v105, v28
    v_lshlrev_b32 v104, 16, v81
    v_and_b32 v105, 0xffff0000, v81
    v_fmac_f32 v98, v104, v28
    v_fmac_f32 v99, v105, v28
    v_lshlrev_b32 v104, 16, v82
    v_and_b32 v105, 0xffff0000, v82
    v_fmac_f32 v100, v104, v28
    v_fmac_f32 v101, v105, v28
    v_lshlrev_b32 v104, 16, v83
    v_and_b32 v105, 0xffff0000, v83
    v_fmac_f32 v102, v104, v28
    v_fmac_f32 v103, v105, v28
    s_waitcnt vmcnt(2)
    v_lshlrev_b32 v104, 16, v84
    v_and_b32 v105, 0xffff0000, v84
    v_fmac_f32 v96, v104, v29
    v_fmac_f32 v97, v105, v29
    v_lshlrev_b32 v104, 16, v85
    v_and_b32 v105, 0xffff0000, v85
    v_fmac_f32 v98, v104, v29
    v_fmac_f32 v99, v105, v29
    v_lshlrev_b32 v104, 16, v86
    v_and_b32 v105, 0xffff0000, v86
    v_fmac_f32 v100, v104, v29
    v_fmac_f32 v101, v105, v29
    v_lshlrev_b32 v104, 16, v87
    v_and_b32 v105, 0xffff0000, v87
    v_fmac_f32 v102, v104, v29
    v_fmac_f32 v103, v105, v29
    s_waitcnt vmcnt(1)
    v_lshlrev_b32 v104, 16, v88
    v_and_b32 v105, 0xffff0000, v88
    v_fmac_f32 v96, v104, v30
    v_fmac_f32 v97, v105, v30
    v_lshlrev_b32 v104, 16, v89
    v_and_b32 v105, 0xffff0000, v89
    v_fmac_f32 v98, v104, v30
    v_fmac_f32 v99, v105, v30
    v_lshlrev_b32 v104, 16, v90
    v_and_b32 v105, 0xffff0000, v90
    v_fmac_f32 v100, v104, v30
    v_fmac_f32 v101, v105, v30
    v_lshlrev_b32 v104, 16, v91
    v_and_b32 v105, 0xffff0000, v91
    v_fmac_f32 v102, v104, v30
    v_fmac_f32 v103, v105, v30
    s_waitcnt vmcnt(0)
    v_lshlrev_b32 v104, 16, v92
    v_and_b32 v105, 0xffff0000, v92
    v_fmac_f32 v96, v104, v31
    v_fmac_f32 v97, v105, v31
    v_lshlrev_b32 v104, 16, v93
    v_and_b32 v105, 0xffff0000, v93
    v_fmac_f32 v98, v104, v31
    v_fmac_f32 v99, v105, v31
    v_lshlrev_b32 v104, 16, v94
    v_and_b32 v105, 0xffff0000, v94
    v_fmac_f32 v100, v104, v31
    v_fmac_f32 v101, v105, v31
    v_lshlrev_b32 v104, 16, v95
    v_and_b32 v105, 0xffff0000, v95
    v_fmac_f32 v102, v104, v31
    v_fmac_f32 v103, v105, v31
    v_lshlrev_b32 v104, 5, v0
    ds_write_b128 v104, v[96:99]
    ds_write_b128 v104, v[100:103] offset:16
    v_lshlrev_b32 v105, 2, v1
    s_lshl_b32 s46, s44, 11
    v_add_u32 v104, s46, v105
    s_waitcnt lgkmcnt(0)
    ds_read_b32 v96, v104 offset:0
    ds_read_b32 v97, v104 offset:256
    ds_read_b32 v98, v104 offset:512
    ds_read_b32 v99, v104 offset:768
    ds_read_b32 v100, v104 offset:1024
    ds_read_b32 v101, v104 offset:1280
    ds_read_b32 v102, v104 offset:1536
    ds_read_b32 v103, v104 offset:1792
    s_waitcnt lgkmcnt(0)
    v_add_f32 v96, v96, v100
    v_add_f32 v97, v97, v101
    v_add_f32 v98, v98, v102
    v_add_f32 v99, v99, v103
    v_add_f32 v96, v96, v98
    v_add_f32 v97, v97, v99
    v_add_f32 v96, v96, v97
    v_lshlrev_b32 v104, 2, v0
    ds_write_b32 v104, v96 offset:16384
    s_waitcnt lgkmcnt(0)
    s_barrier
    s_cmp_lg_u32 s44, 0
    s_cbranch_scc1 L_m_sk_25
    ds_read_b32 v96, v105 offset:16384
    ds_read_b32 v97, v105 offset:16640
    ds_read_b32 v98, v105 offset:16896
    ds_read_b32 v99, v105 offset:17152
    ds_read_b32 v100, v105 offset:17408
    ds_read_b32 v101, v105 offset:17664
    ds_read_b32 v102, v105 offset:17920
    ds_read_b32 v103, v105 offset:18176
    s_waitcnt lgkmcnt(0)
    v_add_f32 v96, v96, v100
    v_add_f32 v97, v97, v101
    v_add_f32 v98, v98, v102
    v_add_f32 v99, v99, v103
    v_add_f32 v96, v96, v98
    v_add_f32 v97, v97, v99
    v_add_f32 v96, v96, v97
    v_cvt_pk_bf16_f32 v96, 0, v96
    s_lshl_b32 s46, s53, 1
    buffer_store_dword v96, v105, s[12:15], s46 offen sc1
L_m_sk_25:
    s_barrier
    s_add_u32 s53, s53, 128
    s_and_b32 s46, s53, 511
    s_cmp_lg_u32 s46, 0
    s_cbranch_scc1 L_m_loop_24
    s_lshl_b32 s54, s55, 7
    s_add_u32 s54, s54, 0x10e400
    s_mov_b32 s60, 0
    s_waitcnt vmcnt(0)
    s_cmp_lg_u32 s44, 0
    s_cbranch_scc1 L_sf_26
    v_mov_b32 v8, s60
    v_add_u32 v8, 1, v8
    v_mov_b32 v9, 0
    s_mov_b64 exec, 1
    buffer_store_dword v8, v9, s[12:15], s54 offen sc1
    s_mov_b64 exec, -1
L_sf_26:
    s_barrier
L_w_h_17_s:
    s_mov_b32 s77, s48
    s_cmp_eq_u32 s48, 14
    s_cselect_b32 s53, 2, 1
    s_sub_u32 s48, s48, 12
    s_min_u32 s48, s48, 2
    s_mov_b32 s79, 0
L_w_h_17_n:
    s_cmp_eq_u32 s53, 1
    s_cselect_b32 s74, 41, 54
    s_cselect_b32 s75, 58, 64
    s_mov_b32 s76, 65536
    s_branch L_w_g_10_e
L_w_h_17:
    s_mov_b32 s48, s77
    s_cmp_lt_u32 s48, 14
    s_cbranch_scc1 L_w_att_15
    s_and_b32 s42, s40, 3
    s_lshr_b32 s43, s40, 2
    s_cmp_eq_u32 s48, 14
    s_cbranch_scc1 L_w_c_16
    s_mov_b32 s75, 58
    s_mov_b32 s76, 0
    s_mov_b32 s78, 2
L_w_h_17_f:
    s_load_dwordx2 s[4:5], s[0:1], 112
    s_load_dwordx2 s[6:7], s[0:1], 88
    v_lshlrev_b32 v2, 4, v1
    v_lshlrev_b32 v3, 5, v1
    s_waitcnt lgkmcnt(0)
    s_mov_b32 s24, s4
    s_and_b32 s25, s5, 0xffff
    s_mov_b32 s26, 0x400000
    s_mov_b32 s27, 0x00020000
    s_mov_b32 s28, s6
    s_and_b32 s29, s7, 0xffff
    s_mov_b32 s30, 0x800
    s_mov_b32 s31, 0x00020000
    s_cmp_lg_u32 s44, 0
    s_cbranch_scc1 L_mw_27
    v_and_b32 v8, 15, v1
    v_lshlrev_b32 v8, 7, v8
    s_mov_b32 s46, 0x10e400
    s_mov_b32 s47, 0
    s_mov_b32 s70, 0
L_spin_28:
    buffer_load_dword v9, v8, s[12:15], s46 offen sc1
    s_waitcnt vmcnt(0)
    v_cmp_ge_u32 vcc, s47, v9
    s_add_u32 s70, s70, 1
    s_cbranch_vccz L_spok_29
    s_sleep 2
    s_cmp_lt_u32 s70, 524288
    s_cbranch_scc1 L_spin_28
    s_branch L_c_done_1
L_spok_29:
L_mw_27:
    s_barrier
    s_mov_b32 s46, 20480
    buffer_load_dwordx4 v[16:19], v3, s[12:15], s46 offen offset:0 sc1
    buffer_load_dwordx4 v[20:23], v3, s[12:15], s46 offen offset:16 sc1
    buffer_load_dwordx4 v[24:27], v3, s[12:15], s46 offen offset:2048 sc1
    buffer_load_dwordx4 v[28:31], v3, s[12:15], s46 offen offset:2064 sc1
    buffer_load_dwordx4 v[48:51], v2, s[28:31], 0 offen
    buffer_load_dwordx4 v[52:55], v2, s[28:31], 0 offen offset:1024
    s_waitcnt vmcnt(0)
    v_lshlrev_b32 v32, 16, v48
    v_and_b32 v33, 0xffff0000, v48
    v_lshlrev_b32 v34, 16, v49
    v_and_b32 v35, 0xffff0000, v49
    v_lshlrev_b32 v36, 16, v50
    v_and_b32 v37, 0xffff0000, v50
    v_lshlrev_b32 v38, 16, v51
    v_and_b32 v39, 0xffff0000, v51
    v_lshlrev_b32 v40, 16, v52
    v_and_b32 v41, 0xffff0000, v52
    v_lshlrev_b32 v42, 16, v53
    v_and_b32 v43, 0xffff0000, v53
    v_lshlrev_b32 v44, 16, v54
    v_and_b32 v45, 0xffff0000, v54
    v_lshlrev_b32 v46, 16, v55
    v_and_b32 v47, 0xffff0000, v55
    s_lshl_b32 s46, s42, 14
    s_lshl_b32 s47, s44, 11
    s_add_u32 s46, s46, s47
    s_add_u32 s46, s46, 0xb000000
    v_add_u32 v4, s46, v2
    v_and_b32 v5, 31, v1
    v_lshlrev_b32 v5, 7, v5
    v_add_u32 v5, 0x108400, v5
    v_lshlrev_b32 v6, 2, v1
    s_lshl_b32 s46, s44, 9
    v_add_u32 v6, s46, v6
    s_lshl_b32 s46, s44, 12
    v_add_u32 v7, s46, v3
    s_lshl_b32 s46, s42, 3
    s_add_u32 s46, s46, s44
    s_lshl_b32 s46, s46, 11
    v_add_u32 v8, s46, v2
    v_add_u32 v9, 0x800000, v8
    s_mov_b32 s60, s43
L_r_loop_30:
    s_lshl_b32 s61, s60, 18
    s_lshl_b32 s63, s60, 16
    s_cmp_lg_u32 s44, 0
    s_cbranch_scc1 L_r_nsp_31
    s_mov_b32 s70, 0
L_spin_32:
    buffer_load_dword v14, v5, s[12:15], s76 offen sc1
    s_waitcnt vmcnt(0)
    v_cmp_ge_u32 vcc, s60, v14
    s_add_u32 s70, s70, 1
    s_cbranch_vccz L_spok_33
    s_sleep 3
    s_cmp_lt_u32 s70, 524288
    s_cbranch_scc1 L_spin_32
    s_branch L_c_done_1
L_spok_33:
L_r_nsp_31:
    s_barrier
    buffer_load_dwordx4 v[96:99], v4, s[12:15], s61 offen offset:0 sc1
    buffer_load_dwordx4 v[100:103], v4, s[12:15], s61 offen offset:1024 sc1
    s_add_u32 s61, s61, 65536
    buffer_load_dwordx4 v[104:107], v4, s[12:15], s61 offen offset:0 sc1
    buffer_load_dwordx4 v[108:111], v4, s[12:15], s61 offen offset:1024 sc1
    s_add_u32 s61, s61, 65536
    buffer_load_dwordx4 v[112:115], v4, s[12:15], s61 offen offset:0 sc1
    buffer_load_dwordx4 v[116:119], v4, s[12:15], s61 offen offset:1024 sc1
    s_add_u32 s61, s61, 65536
    buffer_load_dwordx4 v[120:123], v4, s[12:15], s61 offen offset:0 sc1
    buffer_load_dwordx4 v[124:127], v4, s[12:15], s61 offen offset:1024 sc1
    buffer_load_dwordx4 a[0:3], v9, s[12:15], s63 offen sc1
    buffer_load_dwordx4 a[4:7], v9, s[12:15], s63 offen offset:1024 sc1
    s_waitcnt vmcnt(8)
    v_lshlrev_b32 v64, 16, v96
    v_and_b32 v65, 0xffff0000, v96
    v_lshlrev_b32 v66, 16, v97
    v_and_b32 v67, 0xffff0000, v97
    v_lshlrev_b32 v68, 16, v98
    v_and_b32 v69, 0xffff0000, v98
    v_lshlrev_b32 v70, 16, v99
    v_and_b32 v71, 0xffff0000, v99
    v_lshlrev_b32 v72, 16, v100
    v_and_b32 v73, 0xffff0000, v100
    v_lshlrev_b32 v74, 16, v101
    v_and_b32 v75, 0xffff0000, v101
    v_lshlrev_b32 v76, 16, v102
    v_and_b32 v77, 0xffff0000, v102
    v_lshlrev_b32 v78, 16, v103
    v_and_b32 v79, 0xffff0000, v103
    s_waitcnt vmcnt(6)
    v_lshlrev_b32 v14, 16, v104
    v_and_b32 v15, 0xffff0000, v104
    v_pk_add_f32 v[64:65], v[64:65], v[14:15]
    v_lshlrev_b32 v14, 16, v105
    v_and_b32 v15, 0xffff0000, v105
    v_pk_add_f32 v[66:67], v[66:67], v[14:15]
    v_lshlrev_b32 v14, 16, v106
    v_and_b32 v15, 0xffff0000, v106
    v_pk_add_f32 v[68:69], v[68:69], v[14:15]
    v_lshlrev_b32 v14, 16, v107
    v_and_b32 v15, 0xffff0000, v107
    v_pk_add_f32 v[70:71], v[70:71], v[14:15]
    v_lshlrev_b32 v14, 16, v108
    v_and_b32 v15, 0xffff0000, v108
    v_pk_add_f32 v[72:73], v[72:73], v[14:15]
    v_lshlrev_b32 v14, 16, v109
    v_and_b32 v15, 0xffff0000, v109
    v_pk_add_f32 v[74:75], v[74:75], v[14:15]
    v_lshlrev_b32 v14, 16, v110
    v_and_b32 v15, 0xffff0000, v110
    v_pk_add_f32 v[76:77], v[76:77], v[14:15]
    v_lshlrev_b32 v14, 16, v111
    v_and_b32 v15, 0xffff0000, v111
    v_pk_add_f32 v[78:79], v[78:79], v[14:15]
    s_waitcnt vmcnt(4)
    v_lshlrev_b32 v14, 16, v112
    v_and_b32 v15, 0xffff0000, v112
    v_pk_add_f32 v[64:65], v[64:65], v[14:15]
    v_lshlrev_b32 v14, 16, v113
    v_and_b32 v15, 0xffff0000, v113
    v_pk_add_f32 v[66:67], v[66:67], v[14:15]
    v_lshlrev_b32 v14, 16, v114
    v_and_b32 v15, 0xffff0000, v114
    v_pk_add_f32 v[68:69], v[68:69], v[14:15]
    v_lshlrev_b32 v14, 16, v115
    v_and_b32 v15, 0xffff0000, v115
    v_pk_add_f32 v[70:71], v[70:71], v[14:15]
    v_lshlrev_b32 v14, 16, v116
    v_and_b32 v15, 0xffff0000, v116
    v_pk_add_f32 v[72:73], v[72:73], v[14:15]
    v_lshlrev_b32 v14, 16, v117
    v_and_b32 v15, 0xffff0000, v117
    v_pk_add_f32 v[74:75], v[74:75], v[14:15]
    v_lshlrev_b32 v14, 16, v118
    v_and_b32 v15, 0xffff0000, v118
    v_pk_add_f32 v[76:77], v[76:77], v[14:15]
    v_lshlrev_b32 v14, 16, v119
    v_and_b32 v15, 0xffff0000, v119
    v_pk_add_f32 v[78:79], v[78:79], v[14:15]
    s_waitcnt vmcnt(2)
    v_lshlrev_b32 v14, 16, v120
    v_and_b32 v15, 0xffff0000, v120
    v_pk_add_f32 v[64:65], v[64:65], v[14:15]
    v_lshlrev_b32 v14, 16, v121
    v_and_b32 v15, 0xffff0000, v121
    v_pk_add_f32 v[66:67], v[66:67], v[14:15]
    v_lshlrev_b32 v14, 16, v122
    v_and_b32 v15, 0xffff0000, v122
    v_pk_add_f32 v[68:69], v[68:69], v[14:15]
    v_lshlrev_b32 v14, 16, v123
    v_and_b32 v15, 0xffff0000, v123
    v_pk_add_f32 v[70:71], v[70:71], v[14:15]
    v_lshlrev_b32 v14, 16, v124
    v_and_b32 v15, 0xffff0000, v124
    v_pk_add_f32 v[72:73], v[72:73], v[14:15]
    v_lshlrev_b32 v14, 16, v125
    v_and_b32 v15, 0xffff0000, v125
    v_pk_add_f32 v[74:75], v[74:75], v[14:15]
    v_lshlrev_b32 v14, 16, v126
    v_and_b32 v15, 0xffff0000, v126
    v_pk_add_f32 v[76:77], v[76:77], v[14:15]
    v_lshlrev_b32 v14, 16, v127
    v_and_b32 v15, 0xffff0000, v127
    v_pk_add_f32 v[78:79], v[78:79], v[14:15]
    ds_write_b32 v6, v64 offset:0
    ds_write_b32 v6, v65 offset:4096
    ds_write_b32 v6, v66 offset:8192
    ds_write_b32 v6, v67 offset:12288
    ds_write_b32 v6, v68 offset:16384
    ds_write_b32 v6, v69 offset:20480
    ds_write_b32 v6, v70 offset:24576
    ds_write_b32 v6, v71 offset:28672
    ds_write_b32 v6, v72 offset:256
    ds_write_b32 v6, v73 offset:4352
    ds_write_b32 v6, v74 offset:8448
    ds_write_b32 v6, v75 offset:12544
    ds_write_b32 v6, v76 offset:16640
    ds_write_b32 v6, v77 offset:20736
    ds_write_b32 v6, v78 offset:24832
    ds_write_b32 v6, v79 offset:28928
    s_waitcnt lgkmcnt(0)
    s_barrier
    ds_read_b128 v[64:67], v7
    ds_read_b128 v[68:71], v7 offset:16
    ds_read_b128 v[72:75], v7 offset:2048
    ds_read_b128 v[76:79], v7 offset:2064
    s_waitcnt vmcnt(0)
    v_accvgpr_read_b32 v96, a0
    v_accvgpr_read_b32 v97, a1
    v_accvgpr_read_b32 v98, a2
    v_accvgpr_read_b32 v99, a3
    v_accvgpr_read_b32 v100, a4
    v_accvgpr_read_b32 v101, a5
    v_accvgpr_read_b32 v102, a6
    v_accvgpr_read_b32 v103, a7
    v_lshlrev_b32 v80, 16, v96
    v_and_b32 v81, 0xffff0000, v96
    v_lshlrev_b32 v82, 16, v97
    v_and_b32 v83, 0xffff0000, v97
    v_lshlrev_b32 v84, 16, v98
    v_and_b32 v85, 0xffff0000, v98
    v_lshlrev_b32 v86, 16, v99
    v_and_b32 v87, 0xffff0000, v99
    v_lshlrev_b32 v88, 16, v100
    v_and_b32 v89, 0xffff0000, v100
    v_lshlrev_b32 v90, 16, v101
    v_and_b32 v91, 0xffff0000, v101
    v_lshlrev_b32 v92, 16, v102
    v_and_b32 v93, 0xffff0000, v102
    v_lshlrev_b32 v94, 16, v103
    v_and_b32 v95, 0xffff0000, v103
    s_waitcnt lgkmcnt(0)
    v_cvt_pk_bf16_f32 v64, 0, v64
    v_cvt_pk_bf16_f32 v65, 0, v65
    v_cvt_pk_bf16_f32 v66, 0, v66
    v_cvt_pk_bf16_f32 v67, 0, v67
    v_cvt_pk_bf16_f32 v68, 0, v68
    v_cvt_pk_bf16_f32 v69, 0, v69
    v_cvt_pk_bf16_f32 v70, 0, v70
    v_cvt_pk_bf16_f32 v71, 0, v71
    v_cvt_pk_bf16_f32 v72, 0, v72
    v_cvt_pk_bf16_f32 v73, 0, v73
    v_cvt_pk_bf16_f32 v74, 0, v74
    v_cvt_pk_bf16_f32 v75, 0, v75
    v_cvt_pk_bf16_f32 v76, 0, v76
    v_cvt_pk_bf16_f32 v77, 0, v77
    v_cvt_pk_bf16_f32 v78, 0, v78
    v_cvt_pk_bf16_f32 v79, 0, v79
    v_pk_add_f32 v[64:65], v[64:65], v[32:33]
    v_pk_add_f32 v[66:67], v[66:67], v[34:35]
    v_pk_add_f32 v[68:69], v[68:69], v[36:37]
    v_pk_add_f32 v[70:71], v[70:71], v[38:39]
    v_pk_add_f32 v[72:73], v[72:73], v[40:41]
    v_pk_add_f32 v[74:75], v[74:75], v[42:43]
    v_pk_add_f32 v[76:77], v[76:77], v[44:45]
    v_pk_add_f32 v[78:79], v[78:79], v[46:47]
    v_cvt_pk_bf16_f32 v64, 0, v64
    v_cvt_pk_bf16_f32 v65, 0, v65
    v_cvt_pk_bf16_f32 v66, 0, v66
    v_cvt_pk_bf16_f32 v67, 0, v67
    v_cvt_pk_bf16_f32 v68, 0, v68
    v_cvt_pk_bf16_f32 v69, 0, v69
    v_cvt_pk_bf16_f32 v70, 0, v70
    v_cvt_pk_bf16_f32 v71, 0, v71
    v_cvt_pk_bf16_f32 v72, 0, v72
    v_cvt_pk_bf16_f32 v73, 0, v73
    v_cvt_pk_bf16_f32 v74, 0, v74
    v_cvt_pk_bf16_f32 v75, 0, v75
    v_cvt_pk_bf16_f32 v76, 0, v76
    v_cvt_pk_bf16_f32 v77, 0, v77
    v_cvt_pk_bf16_f32 v78, 0, v78
    v_cvt_pk_bf16_f32 v79, 0, v79
    v_pk_mul_f32 v[64:65], v[64:65], v[16:17]
    v_pk_mul_f32 v[66:67], v[66:67], v[18:19]
    v_pk_mul_f32 v[68:69], v[68:69], v[20:21]
    v_pk_mul_f32 v[70:71], v[70:71], v[22:23]
    v_pk_mul_f32 v[72:73], v[72:73], v[24:25]
    v_pk_mul_f32 v[74:75], v[74:75], v[26:27]
    v_pk_mul_f32 v[76:77], v[76:77], v[28:29]
    v_pk_mul_f32 v[78:79], v[78:79], v[30:31]
    v_cvt_pk_bf16_f32 v64, 0, v64
    v_cvt_pk_bf16_f32 v65, 0, v65
    v_cvt_pk_bf16_f32 v66, 0, v66
    v_cvt_pk_bf16_f32 v67, 0, v67
    v_cvt_pk_bf16_f32 v68, 0, v68
    v_cvt_pk_bf16_f32 v69, 0, v69
    v_cvt_pk_bf16_f32 v70, 0, v70
    v_cvt_pk_bf16_f32 v71, 0, v71
    v_cvt_pk_bf16_f32 v72, 0, v72
    v_cvt_pk_bf16_f32 v73, 0, v73
    v_cvt_pk_bf16_f32 v74, 0, v74
    v_cvt_pk_bf16_f32 v75, 0, v75
    v_cvt_pk_bf16_f32 v76, 0, v76
    v_cvt_pk_bf16_f32 v77, 0, v77
    v_cvt_pk_bf16_f32 v78, 0, v78
    v_cvt_pk_bf16_f32 v79, 0, v79
    v_pk_add_f32 v[64:65], v[64:65], v[80:81]
    v_pk_add_f32 v[66:67], v[66:67], v[82:83]
    v_pk_add_f32 v[68:69], v[68:69], v[84:85]
    v_pk_add_f32 v[70:71], v[70:71], v[86:87]
    v_pk_add_f32 v[72:73], v[72:73], v[88:89]
    v_pk_add_f32 v[74:75], v[74:75], v[90:91]
    v_pk_add_f32 v[76:77], v[76:77], v[92:93]
    v_pk_add_f32 v[78:79], v[78:79], v[94:95]
    v_cvt_pk_bf16_f32 v96, v64, v65
    v_cvt_pk_bf16_f32 v97, v66, v67
    v_cvt_pk_bf16_f32 v98, v68, v69
    v_cvt_pk_bf16_f32 v99, v70, v71
    v_cvt_pk_bf16_f32 v100, v72, v73
    v_cvt_pk_bf16_f32 v101, v74, v75
    v_cvt_pk_bf16_f32 v102, v76, v77
    v_cvt_pk_bf16_f32 v103, v78, v79
    buffer_store_dwordx4 v[96:99], v8, s[24:27], s63 offen
    buffer_store_dwordx4 v[100:103], v8, s[24:27], s63 offen offset:1024
    s_add_u32 s60, s60, s78
    s_cmp_lt_u32 s60, s75
    s_cbranch_scc1 L_r_loop_30
    s_branch L_c_done_1
L_w_c_16:
    s_load_dwordx2 s[4:5], s[0:1], 0
    s_load_dwordx2 s[6:7], s[0:1], 88
    v_lshlrev_b32 v2, 4, v1
    v_lshlrev_b32 v3, 5, v1
    s_waitcnt lgkmcnt(0)
    s_mov_b32 s24, s4
    s_and_b32 s25, s5, 0xffff
    s_mov_b32 s26, 0x400000
    s_mov_b32 s27, 0x00020000
    s_mov_b32 s28, s6
    s_and_b32 s29, s7, 0xffff
    s_mov_b32 s30, 0x800
    s_mov_b32 s31, 0x00020000
    s_cmp_lg_u32 s44, 0
    s_cbranch_scc1 L_mw_34
    v_and_b32 v8, 15, v1
    v_lshlrev_b32 v8, 7, v8
    s_mov_b32 s46, 0x10e400
    s_mov_b32 s47, 0
    s_mov_b32 s70, 0
L_spin_35:
    buffer_load_dword v9, v8, s[12:15], s46 offen sc1
    s_waitcnt vmcnt(0)
    v_cmp_ge_u32 vcc, s47, v9
    s_add_u32 s70, s70, 1
    s_cbranch_vccz L_spok_36
    s_sleep 2
    s_cmp_lt_u32 s70, 524288
    s_cbranch_scc1 L_spin_35
    s_branch L_c_done_1
L_spok_36:
L_mw_34:
    s_barrier
    s_mov_b32 s46, 8192
    buffer_load_dwordx4 v[16:19], v3, s[12:15], s46 offen offset:0 sc1
    buffer_load_dwordx4 v[20:23], v3, s[12:15], s46 offen offset:16 sc1
    buffer_load_dwordx4 v[24:27], v3, s[12:15], s46 offen offset:2048 sc1
    buffer_load_dwordx4 v[28:31], v3, s[12:15], s46 offen offset:2064 sc1
    s_mov_b32 s46, 16384
    buffer_load_dwordx4 v[32:35], v3, s[12:15], s46 offen offset:0 sc1
    buffer_load_dwordx4 v[36:39], v3, s[12:15], s46 offen offset:16 sc1
    buffer_load_dwordx4 v[40:43], v3, s[12:15], s46 offen offset:2048 sc1
    buffer_load_dwordx4 v[44:47], v3, s[12:15], s46 offen offset:2064 sc1
    s_mov_b32 s46, 12288
    buffer_load_dwordx4 v[48:51], v3, s[12:15], s46 offen offset:0 sc1
    buffer_load_dwordx4 v[52:55], v3, s[12:15], s46 offen offset:16 sc1
    buffer_load_dwordx4 v[56:59], v3, s[12:15], s46 offen offset:2048 sc1
    buffer_load_dwordx4 v[60:63], v3, s[12:15], s46 offen offset:2064 sc1
    s_waitcnt vmcnt(0)
    v_add_f32 v32, 1.0, v32
    v_add_f32 v33, 1.0, v33
    v_add_f32 v34, 1.0, v34
    v_add_f32 v35, 1.0, v35
    v_add_f32 v36, 1.0, v36
    v_add_f32 v37, 1.0, v37
    v_add_f32 v38, 1.0, v38
    v_add_f32 v39, 1.0, v39
    v_add_f32 v40, 1.0, v40
    v_add_f32 v41, 1.0, v41
    v_add_f32 v42, 1.0, v42
    v_add_f32 v43, 1.0, v43
    v_add_f32 v44, 1.0, v44
    v_add_f32 v45, 1.0, v45
    v_add_f32 v46, 1.0, v46
    v_add_f32 v47, 1.0, v47
    v_cvt_pk_bf16_f32 v32, 0, v32
    v_cvt_pk_bf16_f32 v33, 0, v33
    v_cvt_pk_bf16_f32 v34, 0, v34
    v_cvt_pk_bf16_f32 v35, 0, v35
    v_cvt_pk_bf16_f32 v36, 0, v36
    v_cvt_pk_bf16_f32 v37, 0, v37
    v_cvt_pk_bf16_f32 v38, 0, v38
    v_cvt_pk_bf16_f32 v39, 0, v39
    v_cvt_pk_bf16_f32 v40, 0, v40
    v_cvt_pk_bf16_f32 v41, 0, v41
    v_cvt_pk_bf16_f32 v42, 0, v42
    v_cvt_pk_bf16_f32 v43, 0, v43
    v_cvt_pk_bf16_f32 v44, 0, v44
    v_cvt_pk_bf16_f32 v45, 0, v45
    v_cvt_pk_bf16_f32 v46, 0, v46
    v_cvt_pk_bf16_f32 v47, 0, v47
    s_lshl_b32 s46, s42, 14
    s_lshl_b32 s47, s44, 11
    s_add_u32 s46, s46, s47
    s_add_u32 s46, s46, 0x9000000
    v_add_u32 v4, s46, v2
    v_and_b32 v5, 31, v1
    v_lshlrev_b32 v5, 7, v5
    v_add_u32 v5, 0x107400, v5
    v_lshlrev_b32 v6, 2, v1
    s_lshl_b32 s46, s44, 9
    v_add_u32 v6, s46, v6
    s_lshl_b32 s46, s44, 12
    v_add_u32 v7, s46, v3
    s_lshl_b32 s46, s42, 3
    s_add_u32 s46, s46, s44
    s_lshl_b32 s46, s46, 11
    v_add_u32 v8, s46, v2
    v_add_u32 v9, 0x800000, v8
    s_mul_i32 s46, s44, 2064
    s_add_u32 s46, s46, 32768
    v_add_u32 v10, s46, v2
    v_and_b32 v11, 7, v1
    v_lshrrev_b32 v12, 3, v1
    v_mul_u32_u24 v13, 2064, v11
    v_lshl_add_u32 v13, v12, 4, v13
    s_lshl_b32 s46, s44, 8
    s_add_u32 s46, s46, 32768
    v_add_u32 v13, s46, v13
    v_lshlrev_b32 v11, 4, v11
    v_lshl_add_u32 v11, v12, 9, v11
    s_lshl_b32 s46, s44, 13
    s_lshl_b32 s47, s42, 7
    s_add_u32 s46, s46, s47
    s_add_u32 s46, s46, 0xc00000
    v_add_u32 v11, s46, v11
    v_add_u32 v12, 4096, v11
    s_lshl_b32 s52, s43, 9
    s_lshl_b32 s47, s42, 7
    s_add_u32 s52, s52, s47
    s_add_u32 s52, s52, 0x10ec00
    s_mov_b32 s60, s43
L_r_loop_37:
    s_lshl_b32 s61, s60, 18
    s_lshl_b32 s63, s60, 16
    buffer_load_dwordx4 a[0:3], v8, s[24:27], s63 offen
    buffer_load_dwordx4 a[4:7], v8, s[24:27], s63 offen offset:1024
    s_cmp_lg_u32 s44, 0
    s_cbranch_scc1 L_r_nsp_38
    s_mov_b32 s70, 0
L_spin_39:
    buffer_load_dword v14, v5, s[12:15], 0 offen sc1
    s_waitcnt vmcnt(0)
    v_cmp_ge_u32 vcc, s60, v14
    s_add_u32 s70, s70, 1
    s_cbranch_vccz L_spok_40
    s_sleep 3
    s_cmp_lt_u32 s70, 524288
    s_cbranch_scc1 L_spin_39
    s_branch L_c_done_1
L_spok_40:
L_r_nsp_38:
    s_barrier
    buffer_load_dwordx4 v[96:99], v4, s[12:15], s61 offen offset:0 sc1
    buffer_load_dwordx4 v[100:103], v4, s[12:15], s61 offen offset:1024 sc1
    s_add_u32 s61, s61, 65536
    buffer_load_dwordx4 v[104:107], v4, s[12:15], s61 offen offset:0 sc1
    buffer_load_dwordx4 v[108:111], v4, s[12:15], s61 offen offset:1024 sc1
    s_add_u32 s61, s61, 65536
    buffer_load_dwordx4 v[112:115], v4, s[12:15], s61 offen offset:0 sc1
    buffer_load_dwordx4 v[116:119], v4, s[12:15], s61 offen offset:1024 sc1
    s_add_u32 s61, s61, 65536
    buffer_load_dwordx4 v[120:123], v4, s[12:15], s61 offen offset:0 sc1
    buffer_load_dwordx4 v[124:127], v4, s[12:15], s61 offen offset:1024 sc1
    s_waitcnt vmcnt(8)
    v_accvgpr_read_b32 v64, a0
    v_accvgpr_read_b32 v65, a1
    v_accvgpr_read_b32 v66, a2
    v_accvgpr_read_b32 v67, a3
    v_accvgpr_read_b32 v68, a4
    v_accvgpr_read_b32 v69, a5
    v_accvgpr_read_b32 v70, a6
    v_accvgpr_read_b32 v71, a7
    v_lshlrev_b32 v80, 16, v64
    v_and_b32 v81, 0xffff0000, v64
    v_lshlrev_b32 v82, 16, v65
    v_and_b32 v83, 0xffff0000, v65
    v_lshlrev_b32 v84, 16, v66
    v_and_b32 v85, 0xffff0000, v66
    v_lshlrev_b32 v86, 16, v67
    v_and_b32 v87, 0xffff0000, v67
    v_lshlrev_b32 v88, 16, v68
    v_and_b32 v89, 0xffff0000, v68
    v_lshlrev_b32 v90, 16, v69
    v_and_b32 v91, 0xffff0000, v69
    v_lshlrev_b32 v92, 16, v70
    v_and_b32 v93, 0xffff0000, v70
    v_lshlrev_b32 v94, 16, v71
    v_and_b32 v95, 0xffff0000, v71
    s_waitcnt vmcnt(6)
    v_lshlrev_b32 v64, 16, v96
    v_and_b32 v65, 0xffff0000, v96
    v_lshlrev_b32 v66, 16, v97
    v_and_b32 v67, 0xffff0000, v97
    v_lshlrev_b32 v68, 16, v98
    v_and_b32 v69, 0xffff0000, v98
    v_lshlrev_b32 v70, 16, v99
    v_and_b32 v71, 0xffff0000, v99
    v_lshlrev_b32 v72, 16, v100
    v_and_b32 v73, 0xffff0000, v100
    v_lshlrev_b32 v74, 16, v101
    v_and_b32 v75, 0xffff0000, v101
    v_lshlrev_b32 v76, 16, v102
    v_and_b32 v77, 0xffff0000, v102
    v_lshlrev_b32 v78, 16, v103
    v_and_b32 v79, 0xffff0000, v103
    s_waitcnt vmcnt(4)
    v_lshlrev_b32 v14, 16, v104
    v_and_b32 v15, 0xffff0000, v104
    v_pk_add_f32 v[64:65], v[64:65], v[14:15]
    v_lshlrev_b32 v14, 16, v105
    v_and_b32 v15, 0xffff0000, v105
    v_pk_add_f32 v[66:67], v[66:67], v[14:15]
    v_lshlrev_b32 v14, 16, v106
    v_and_b32 v15, 0xffff0000, v106
    v_pk_add_f32 v[68:69], v[68:69], v[14:15]
    v_lshlrev_b32 v14, 16, v107
    v_and_b32 v15, 0xffff0000, v107
    v_pk_add_f32 v[70:71], v[70:71], v[14:15]
    v_lshlrev_b32 v14, 16, v108
    v_and_b32 v15, 0xffff0000, v108
    v_pk_add_f32 v[72:73], v[72:73], v[14:15]
    v_lshlrev_b32 v14, 16, v109
    v_and_b32 v15, 0xffff0000, v109
    v_pk_add_f32 v[74:75], v[74:75], v[14:15]
    v_lshlrev_b32 v14, 16, v110
    v_and_b32 v15, 0xffff0000, v110
    v_pk_add_f32 v[76:77], v[76:77], v[14:15]
    v_lshlrev_b32 v14, 16, v111
    v_and_b32 v15, 0xffff0000, v111
    v_pk_add_f32 v[78:79], v[78:79], v[14:15]
    s_waitcnt vmcnt(2)
    v_lshlrev_b32 v14, 16, v112
    v_and_b32 v15, 0xffff0000, v112
    v_pk_add_f32 v[64:65], v[64:65], v[14:15]
    v_lshlrev_b32 v14, 16, v113
    v_and_b32 v15, 0xffff0000, v113
    v_pk_add_f32 v[66:67], v[66:67], v[14:15]
    v_lshlrev_b32 v14, 16, v114
    v_and_b32 v15, 0xffff0000, v114
    v_pk_add_f32 v[68:69], v[68:69], v[14:15]
    v_lshlrev_b32 v14, 16, v115
    v_and_b32 v15, 0xffff0000, v115
    v_pk_add_f32 v[70:71], v[70:71], v[14:15]
    v_lshlrev_b32 v14, 16, v116
    v_and_b32 v15, 0xffff0000, v116
    v_pk_add_f32 v[72:73], v[72:73], v[14:15]
    v_lshlrev_b32 v14, 16, v117
    v_and_b32 v15, 0xffff0000, v117
    v_pk_add_f32 v[74:75], v[74:75], v[14:15]
    v_lshlrev_b32 v14, 16, v118
    v_and_b32 v15, 0xffff0000, v118
    v_pk_add_f32 v[76:77], v[76:77], v[14:15]
    v_lshlrev_b32 v14, 16, v119
    v_and_b32 v15, 0xffff0000, v119
    v_pk_add_f32 v[78:79], v[78:79], v[14:15]
    s_waitcnt vmcnt(0)
    v_lshlrev_b32 v14, 16, v120
    v_and_b32 v15, 0xffff0000, v120
    v_pk_add_f32 v[64:65], v[64:65], v[14:15]
    v_lshlrev_b32 v14, 16, v121
    v_and_b32 v15, 0xffff0000, v121
    v_pk_add_f32 v[66:67], v[66:67], v[14:15]
    v_lshlrev_b32 v14, 16, v122
    v_and_b32 v15, 0xffff0000, v122
    v_pk_add_f32 v[68:69], v[68:69], v[14:15]
    v_lshlrev_b32 v14, 16, v123
    v_and_b32 v15, 0xffff0000, v123
    v_pk_add_f32 v[70:71], v[70:71], v[14:15]
    v_lshlrev_b32 v14, 16, v124
    v_and_b32 v15, 0xffff0000, v124
    v_pk_add_f32 v[72:73], v[72:73], v[14:15]
    v_lshlrev_b32 v14, 16, v125
    v_and_b32 v15, 0xffff0000, v125
    v_pk_add_f32 v[74:75], v[74:75], v[14:15]
    v_lshlrev_b32 v14, 16, v126
    v_and_b32 v15, 0xffff0000, v126
    v_pk_add_f32 v[76:77], v[76:77], v[14:15]
    v_lshlrev_b32 v14, 16, v127
    v_and_b32 v15, 0xffff0000, v127
    v_pk_add_f32 v[78:79], v[78:79], v[14:15]
    ds_write_b32 v6, v64 offset:0
    ds_write_b32 v6, v65 offset:4096
    ds_write_b32 v6, v66 offset:8192
    ds_write_b32 v6, v67 offset:12288
    ds_write_b32 v6, v68 offset:16384
    ds_write_b32 v6, v69 offset:20480
    ds_write_b32 v6, v70 offset:24576
    ds_write_b32 v6, v71 offset:28672
    ds_write_b32 v6, v72 offset:256
    ds_write_b32 v6, v73 offset:4352
    ds_write_b32 v6, v74 offset:8448
    ds_write_b32 v6, v75 offset:12544
    ds_write_b32 v6, v76 offset:16640
    ds_write_b32 v6, v77 offset:20736
    ds_write_b32 v6, v78 offset:24832
    ds_write_b32 v6, v79 offset:28928
    s_waitcnt lgkmcnt(0)
    s_barrier
    ds_read_b128 v[64:67], v7
    ds_read_b128 v[68:71], v7 offset:16
    ds_read_b128 v[72:75], v7 offset:2048
    ds_read_b128 v[76:79], v7 offset:2064
    s_waitcnt vmcnt(0)
    s_waitcnt lgkmcnt(0)
    v_cvt_pk_bf16_f32 v64, 0, v64
    v_cvt_pk_bf16_f32 v65, 0, v65
    v_cvt_pk_bf16_f32 v66, 0, v66
    v_cvt_pk_bf16_f32 v67, 0, v67
    v_cvt_pk_bf16_f32 v68, 0, v68
    v_cvt_pk_bf16_f32 v69, 0, v69
    v_cvt_pk_bf16_f32 v70, 0, v70
    v_cvt_pk_bf16_f32 v71, 0, v71
    v_cvt_pk_bf16_f32 v72, 0, v72
    v_cvt_pk_bf16_f32 v73, 0, v73
    v_cvt_pk_bf16_f32 v74, 0, v74
    v_cvt_pk_bf16_f32 v75, 0, v75
    v_cvt_pk_bf16_f32 v76, 0, v76
    v_cvt_pk_bf16_f32 v77, 0, v77
    v_cvt_pk_bf16_f32 v78, 0, v78
    v_cvt_pk_bf16_f32 v79, 0, v79
    v_pk_mul_f32 v[64:65], v[64:65], v[16:17]
    v_pk_mul_f32 v[66:67], v[66:67], v[18:19]
    v_pk_mul_f32 v[68:69], v[68:69], v[20:21]
    v_pk_mul_f32 v[70:71], v[70:71], v[22:23]
    v_pk_mul_f32 v[72:73], v[72:73], v[24:25]
    v_pk_mul_f32 v[74:75], v[74:75], v[26:27]
    v_pk_mul_f32 v[76:77], v[76:77], v[28:29]
    v_pk_mul_f32 v[78:79], v[78:79], v[30:31]
    v_cvt_pk_bf16_f32 v64, 0, v64
    v_cvt_pk_bf16_f32 v65, 0, v65
    v_cvt_pk_bf16_f32 v66, 0, v66
    v_cvt_pk_bf16_f32 v67, 0, v67
    v_cvt_pk_bf16_f32 v68, 0, v68
    v_cvt_pk_bf16_f32 v69, 0, v69
    v_cvt_pk_bf16_f32 v70, 0, v70
    v_cvt_pk_bf16_f32 v71, 0, v71
    v_cvt_pk_bf16_f32 v72, 0, v72
    v_cvt_pk_bf16_f32 v73, 0, v73
    v_cvt_pk_bf16_f32 v74, 0, v74
    v_cvt_pk_bf16_f32 v75, 0, v75
    v_cvt_pk_bf16_f32 v76, 0, v76
    v_cvt_pk_bf16_f32 v77, 0, v77
    v_cvt_pk_bf16_f32 v78, 0, v78
    v_cvt_pk_bf16_f32 v79, 0, v79
    v_pk_add_f32 v[64:65], v[64:65], v[80:81]
    v_pk_add_f32 v[66:67], v[66:67], v[82:83]
    v_pk_add_f32 v[68:69], v[68:69], v[84:85]
    v_pk_add_f32 v[70:71], v[70:71], v[86:87]
    v_pk_add_f32 v[72:73], v[72:73], v[88:89]
    v_pk_add_f32 v[74:75], v[74:75], v[90:91]
    v_pk_add_f32 v[76:77], v[76:77], v[92:93]
    v_pk_add_f32 v[78:79], v[78:79], v[94:95]
    v_cvt_pk_bf16_f32 v96, v64, v65
    v_cvt_pk_bf16_f32 v97, v66, v67
    v_cvt_pk_bf16_f32 v98, v68, v69
    v_cvt_pk_bf16_f32 v99, v70, v71
    v_cvt_pk_bf16_f32 v100, v72, v73
    v_cvt_pk_bf16_f32 v101, v74, v75
    v_cvt_pk_bf16_f32 v102, v76, v77
    v_cvt_pk_bf16_f32 v103, v78, v79
    buffer_store_dwordx4 v[96:99], v9, s[12:15], s63 offen sc1
    buffer_store_dwordx4 v[100:103], v9, s[12:15], s63 offen offset:1024 sc1
    v_lshlrev_b32 v64, 16, v96
    v_and_b32 v65, 0xffff0000, v96
    v_lshlrev_b32 v66, 16, v97
    v_and_b32 v67, 0xffff0000, v97
    v_lshlrev_b32 v68, 16, v98
    v_and_b32 v69, 0xffff0000, v98
    v_lshlrev_b32 v70, 16, v99
    v_and_b32 v71, 0xffff0000, v99
    v_lshlrev_b32 v72, 16, v100
    v_and_b32 v73, 0xffff0000, v100
    v_lshlrev_b32 v74, 16, v101
    v_and_b32 v75, 0xffff0000, v101
    v_lshlrev_b32 v76, 16, v102
    v_and_b32 v77, 0xffff0000, v102
    v_lshlrev_b32 v78, 16, v103
    v_and_b32 v79, 0xffff0000, v103
    v_pk_add_f32 v[80:81], v[64:65], v[72:73]
    v_pk_add_f32 v[82:83], v[66:67], v[74:75]
    v_pk_add_f32 v[84:85], v[68:69], v[76:77]
    v_pk_add_f32 v[86:87], v[70:71], v[78:79]
    v_pk_add_f32 v[80:81], v[80:81], v[84:85]
    v_pk_add_f32 v[82:83], v[82:83], v[86:87]
    v_pk_add_f32 v[80:81], v[80:81], v[82:83]
    v_add_f32 v14, v80, v81
    s_nop 1
    v_add_f32_dpp v14, v14, v14 row_shr:1 row_mask:0xf bank_mask:0xf bound_ctrl:0
    s_nop 1
    v_add_f32_dpp v14, v14, v14 row_shr:2 row_mask:0xf bank_mask:0xf bound_ctrl:0
    s_nop 1
    v_add_f32_dpp v14, v14, v14 row_shr:4 row_mask:0xf bank_mask:0xf bound_ctrl:0
    s_nop 1
    v_add_f32_dpp v14, v14, v14 row_shr:8 row_mask:0xf bank_mask:0xf bound_ctrl:0
    s_nop 1
    v_add_f32_dpp v14, v14, v14 row_bcast:15 row_mask:0xa bank_mask:0xf
    s_nop 1
    v_add_f32_dpp v14, v14, v14 row_bcast:31 row_mask:0xc bank_mask:0xf
    s_nop 1
    v_readlane_b32 s46, v14, 63
    s_nop 1
    v_mov_b32 v15, s46
    v_mul_f32 v15, 0x3a800000, v15
    v_pk_add_f32 v[80:81], v[64:65], v[14:15] op_sel:[0,1] op_sel_hi:[1,1] neg_lo:[0,1] neg_hi:[0,1]
    v_pk_add_f32 v[82:83], v[66:67], v[14:15] op_sel:[0,1] op_sel_hi:[1,1] neg_lo:[0,1] neg_hi:[0,1]
    v_pk_add_f32 v[84:85], v[68:69], v[14:15] op_sel:[0,1] op_sel_hi:[1,1] neg_lo:[0,1] neg_hi:[0,1]
    v_pk_add_f32 v[86:87], v[70:71], v[14:15] op_sel:[0,1] op_sel_hi:[1,1] neg_lo:[0,1] neg_hi:[0,1]
    v_pk_add_f32 v[88:89], v[72:73], v[14:15] op_sel:[0,1] op_sel_hi:[1,1] neg_lo:[0,1] neg_hi:[0,1]
    v_pk_add_f32 v[90:91], v[74:75], v[14:15] op_sel:[0,1] op_sel_hi:[1,1] neg_lo:[0,1] neg_hi:[0,1]
    v_pk_add_f32 v[92:93], v[76:77], v[14:15] op_sel:[0,1] op_sel_hi:[1,1] neg_lo:[0,1] neg_hi:[0,1]
    v_pk_add_f32 v[94:95], v[78:79], v[14:15] op_sel:[0,1] op_sel_hi:[1,1] neg_lo:[0,1] neg_hi:[0,1]
    v_pk_mul_f32 v[104:105], v[80:81], v[80:81]
    v_pk_mul_f32 v[106:107], v[82:83], v[82:83]
    v_pk_fma_f32 v[104:105], v[84:85], v[84:85], v[104:105]
    v_pk_fma_f32 v[106:107], v[86:87], v[86:87], v[106:107]
    v_pk_fma_f32 v[104:105], v[88:89], v[88:89], v[104:105]
    v_pk_fma_f32 v[106:107], v[90:91], v[90:91], v[106:107]
    v_pk_fma_f32 v[104:105], v[92:93], v[92:93], v[104:105]
    v_pk_fma_f32 v[106:107], v[94:95], v[94:95], v[106:107]
    v_pk_add_f32 v[104:105], v[104:105], v[106:107]
    v_add_f32 v14, v104, v105
    v_cvt_pk_bf16_f32 v15, 0, v15
    s_nop 1
    v_add_f32_dpp v14, v14, v14 row_shr:1 row_mask:0xf bank_mask:0xf bound_ctrl:0
    s_nop 1
    v_add_f32_dpp v14, v14, v14 row_shr:2 row_mask:0xf bank_mask:0xf bound_ctrl:0
    s_nop 1
    v_add_f32_dpp v14, v14, v14 row_shr:4 row_mask:0xf bank_mask:0xf bound_ctrl:0
    s_nop 1
    v_add_f32_dpp v14, v14, v14 row_shr:8 row_mask:0xf bank_mask:0xf bound_ctrl:0
    s_nop 1
    v_add_f32_dpp v14, v14, v14 row_bcast:15 row_mask:0xa bank_mask:0xf
    s_nop 1
    v_add_f32_dpp v14, v14, v14 row_bcast:31 row_mask:0xc bank_mask:0xf
    s_nop 1
    v_readlane_b32 s47, v14, 63
    v_pk_add_f32 v[64:65], v[64:65], v[14:15] op_sel:[0,1] op_sel_hi:[1,1] neg_lo:[0,1] neg_hi:[0,1]
    v_pk_add_f32 v[66:67], v[66:67], v[14:15] op_sel:[0,1] op_sel_hi:[1,1] neg_lo:[0,1] neg_hi:[0,1]
    v_pk_add_f32 v[68:69], v[68:69], v[14:15] op_sel:[0,1] op_sel_hi:[1,1] neg_lo:[0,1] neg_hi:[0,1]
    v_pk_add_f32 v[70:71], v[70:71], v[14:15] op_sel:[0,1] op_sel_hi:[1,1] neg_lo:[0,1] neg_hi:[0,1]
    v_pk_add_f32 v[72:73], v[72:73], v[14:15] op_sel:[0,1] op_sel_hi:[1,1] neg_lo:[0,1] neg_hi:[0,1]
    v_pk_add_f32 v[74:75], v[74:75], v[14:15] op_sel:[0,1] op_sel_hi:[1,1] neg_lo:[0,1] neg_hi:[0,1]
    v_pk_add_f32 v[76:77], v[76:77], v[14:15] op_sel:[0,1] op_sel_hi:[1,1] neg_lo:[0,1] neg_hi:[0,1]
    v_pk_add_f32 v[78:79], v[78:79], v[14:15] op_sel:[0,1] op_sel_hi:[1,1] neg_lo:[0,1] neg_hi:[0,1]
    v_mov_b32 v14, s47
    v_mul_f32 v14, 0x3a800000, v14
    v_cvt_pk_bf16_f32 v14, 0, v14
    v_add_f32 v14, 0x3727c5ac, v14
    v_cvt_pk_bf16_f32 v14, 0, v14
    v_sqrt_f32 v14, v14
    s_nop 0
    v_cvt_pk_bf16_f32 v14, 0, v14
    v_rcp_f32 v14, v14
    v_cvt_pk_bf16_f32 v64, 0, v64
    v_cvt_pk_bf16_f32 v65, 0, v65
    v_cvt_pk_bf16_f32 v66, 0, v66
    v_cvt_pk_bf16_f32 v67, 0, v67
    v_cvt_pk_bf16_f32 v68, 0, v68
    v_cvt_pk_bf16_f32 v69, 0, v69
    v_cvt_pk_bf16_f32 v70, 0, v70
    v_cvt_pk_bf16_f32 v71, 0, v71
    v_cvt_pk_bf16_f32 v72, 0, v72
    v_cvt_pk_bf16_f32 v73, 0, v73
    v_cvt_pk_bf16_f32 v74, 0, v74
    v_cvt_pk_bf16_f32 v75, 0, v75
    v_cvt_pk_bf16_f32 v76, 0, v76
    v_cvt_pk_bf16_f32 v77, 0, v77
    v_cvt_pk_bf16_f32 v78, 0, v78
    v_cvt_pk_bf16_f32 v79, 0, v79
    v_pk_mul_f32 v[64:65], v[64:65], v[14:15] op_sel_hi:[1,0]
    v_pk_mul_f32 v[66:67], v[66:67], v[14:15] op_sel_hi:[1,0]
    v_pk_mul_f32 v[68:69], v[68:69], v[14:15] op_sel_hi:[1,0]
    v_pk_mul_f32 v[70:71], v[70:71], v[14:15] op_sel_hi:[1,0]
    v_pk_mul_f32 v[72:73], v[72:73], v[14:15] op_sel_hi:[1,0]
    v_pk_mul_f32 v[74:75], v[74:75], v[14:15] op_sel_hi:[1,0]
    v_pk_mul_f32 v[76:77], v[76:77], v[14:15] op_sel_hi:[1,0]
    v_pk_mul_f32 v[78:79], v[78:79], v[14:15] op_sel_hi:[1,0]
    v_cvt_pk_bf16_f32 v64, 0, v64
    v_cvt_pk_bf16_f32 v65, 0, v65
    v_cvt_pk_bf16_f32 v66, 0, v66
    v_cvt_pk_bf16_f32 v67, 0, v67
    v_cvt_pk_bf16_f32 v68, 0, v68
    v_cvt_pk_bf16_f32 v69, 0, v69
    v_cvt_pk_bf16_f32 v70, 0, v70
    v_cvt_pk_bf16_f32 v71, 0, v71
    v_cvt_pk_bf16_f32 v72, 0, v72
    v_cvt_pk_bf16_f32 v73, 0, v73
    v_cvt_pk_bf16_f32 v74, 0, v74
    v_cvt_pk_bf16_f32 v75, 0, v75
    v_cvt_pk_bf16_f32 v76, 0, v76
    v_cvt_pk_bf16_f32 v77, 0, v77
    v_cvt_pk_bf16_f32 v78, 0, v78
    v_cvt_pk_bf16_f32 v79, 0, v79
    v_pk_mul_f32 v[64:65], v[64:65], v[32:33]
    v_pk_mul_f32 v[66:67], v[66:67], v[34:35]
    v_pk_mul_f32 v[68:69], v[68:69], v[36:37]
    v_pk_mul_f32 v[70:71], v[70:71], v[38:39]
    v_pk_mul_f32 v[72:73], v[72:73], v[40:41]
    v_pk_mul_f32 v[74:75], v[74:75], v[42:43]
    v_pk_mul_f32 v[76:77], v[76:77], v[44:45]
    v_pk_mul_f32 v[78:79], v[78:79], v[46:47]
    v_cvt_pk_bf16_f32 v64, 0, v64
    v_cvt_pk_bf16_f32 v65, 0, v65
    v_cvt_pk_bf16_f32 v66, 0, v66
    v_cvt_pk_bf16_f32 v67, 0, v67
    v_cvt_pk_bf16_f32 v68, 0, v68
    v_cvt_pk_bf16_f32 v69, 0, v69
    v_cvt_pk_bf16_f32 v70, 0, v70
    v_cvt_pk_bf16_f32 v71, 0, v71
    v_cvt_pk_bf16_f32 v72, 0, v72
    v_cvt_pk_bf16_f32 v73, 0, v73
    v_cvt_pk_bf16_f32 v74, 0, v74
    v_cvt_pk_bf16_f32 v75, 0, v75
    v_cvt_pk_bf16_f32 v76, 0, v76
    v_cvt_pk_bf16_f32 v77, 0, v77
    v_cvt_pk_bf16_f32 v78, 0, v78
    v_cvt_pk_bf16_f32 v79, 0, v79
    v_pk_add_f32 v[64:65], v[64:65], v[48:49]
    v_pk_add_f32 v[66:67], v[66:67], v[50:51]
    v_pk_add_f32 v[68:69], v[68:69], v[52:53]
    v_pk_add_f32 v[70:71], v[70:71], v[54:55]
    v_pk_add_f32 v[72:73], v[72:73], v[56:57]
    v_pk_add_f32 v[74:75], v[74:75], v[58:59]
    v_pk_add_f32 v[76:77], v[76:77], v[60:61]
    v_pk_add_f32 v[78:79], v[78:79], v[62:63]
    v_cvt_pk_bf16_f32 v104, v64, v65
    v_cvt_pk_bf16_f32 v105, v66, v67
    v_cvt_pk_bf16_f32 v106, v68, v69
    v_cvt_pk_bf16_f32 v107, v70, v71
    v_cvt_pk_bf16_f32 v108, v72, v73
    v_cvt_pk_bf16_f32 v109, v74, v75
    v_cvt_pk_bf16_f32 v110, v76, v77
    v_cvt_pk_bf16_f32 v111, v78, v79
    ds_write_b128 v10, v[104:107]
    ds_write_b128 v10, v[108:111] offset:1024
    s_waitcnt lgkmcnt(0)
    s_barrier
    ds_read_b128 v[104:107], v13
    ds_read_b128 v[108:111], v13 offset:128
    s_waitcnt lgkmcnt(1)
    buffer_store_dwordx4 v[104:107], v11, s[12:15], s63 offen sc1
    s_waitcnt lgkmcnt(0)
    buffer_store_dwordx4 v[108:111], v12, s[12:15], s63 offen sc1
    s_waitcnt vmcnt(0)
    s_barrier
    s_cmp_lg_u32 s44, 0
    s_cbranch_scc1 L_sf_41
    v_mov_b32 v14, s60
    v_add_u32 v14, 1, v14
    v_mov_b32 v15, 0
    s_mov_b64 exec, 1
    buffer_store_dword v14, v15, s[12:15], s52 offen sc1
    s_mov_b64 exec, -1
L_sf_41:
    s_add_u32 s60, s60, 3
    s_cmp_lt_u32 s60, 64
    s_cbranch_scc1 L_r_loop_37
    s_branch L_c_done_1
L_w_att_15:
    s_lshl_b32 s42, s40, 2
    s_and_b32 s46, s44, 3
    s_add_u32 s42, s42, s46
    s_and_b32 s43, s48, 1
    s_lshl_b32 s43, s43, 1
    s_lshr_b32 s46, s44, 2
    s_add_u32 s43, s43, s46
    s_mul_i32 s46, s42, 24576
    s_add_u32 s46, s46, 0x2000000
    v_lshlrev_b32 v2, 4, v1
    v_add_u32 v3, s46, v2
    v_add_u32 v5, 4096, v3
    v_lshrrev_b32 v4, 4, v1
    v_and_b32 v9, 15, v1
    s_lshl_b32 s46, s42, 12
    s_add_u32 s46, s46, 0x1000000
    v_and_b32 v6, 7, v1
    v_lshlrev_b32 v6, 4, v6
    v_lshl_add_u32 v6, v4, 7, v6
    v_add_u32 v6, s46, v6
    v_and_b32 v7, 31, v1
    v_lshlrev_b32 v7, 4, v7
    v_lshrrev_b32 v10, 5, v1
    v_lshl_add_u32 v7, v10, 10, v7
    v_add_u32 v7, s46, v7
    s_mul_i32 s50, s44, 13056
    v_mul_u32_u24 v8, 272, v9
    v_lshl_add_u32 v8, v4, 4, v8
    v_add_u32 v8, s50, v8
    v_bfe_u32 v11, v1, 2, 3
    v_mul_u32_u24 v11, 272, v11
    v_lshl_add_u32 v11, v10, 6, v11
    v_and_b32 v12, 3, v1
    v_lshl_add_u32 v11, v12, 4, v11
    v_add_u32 v11, s50, v11
    v_mul_u32_u24 v14, 272, v4
    v_lshl_add_u32 v14, v9, 4, v14
    v_add_u32 v14, s50, v14
    v_mov_b32 v16, 0
    v_mov_b32 v17, 0
    v_mov_b32 v18, 0
    v_mov_b32 v19, 0
    ds_write_b128 v14, v[16:19] offset:10880
    ds_write_b128 v14, v[16:19] offset:11968
    v_lshlrev_b32 v12, 2, v4
    v_bfe_u32 v13, v1, 2, 2
    v_add_u32 v12, v12, v13
    v_mul_u32_u24 v12, 272, v12
    v_and_b32 v13, 3, v1
    v_lshl_add_u32 v12, v13, 3, v12
    v_add_u32 v12, s50, v12
    v_lshlrev_b32 v13, 10, v13
    s_lshl_b32 s46, s42, 12
    s_add_u32 s46, s46, 0x1000000
    v_add_u32 v13, s46, v13
    v_lshlrev_b32 v10, 9, v4
    v_lshl_add_u32 v10, v9, 4, v10
    s_lshl_b32 s46, s42, 13
    s_add_u32 s46, s46, 0x5000000
    v_add_u32 v10, s46, v10
    s_lshl_b32 s52, s42, 9
    s_lshl_b32 s47, s43, 7
    s_add_u32 s52, s52, s47
    s_add_u32 s52, s52, 0x102000
    v_min_u32 v42, 2, v1
    v_lshlrev_b32 v42, 9, v42
    s_lshl_b32 s46, s40, 11
    s_and_b32 s47, s42, 3
    s_lshl_b32 s47, s47, 7
    s_add_u32 s46, s46, s47
    s_add_u32 s46, s46, 0x10a400
    v_add_u32 v48, s46, v42
    s_mul_i32 s46, s42, 24576
    s_add_u32 s46, s46, 0x2000000
    v_lshlrev_b32 v49, 7, v1
    v_add_u32 v49, s46, v49
    v_cmp_le_u32 s[56:57], 32, v1
    v_lshlrev_b32 v14, 2, v4
    s_mov_b32 s54, 0x3e0293ee
    s_mov_b32 s60, s43
    v_add_u32 v15, 0, v14
    v_cmp_gt_u32 s[84:85], v15, v9
    v_add_u32 v15, 1, v14
    v_cmp_gt_u32 s[86:87], v15, v9
    v_add_u32 v15, 2, v14
    v_cmp_gt_u32 s[88:89], v15, v9
    v_add_u32 v15, 3, v14
    v_cmp_gt_u32 s[90:91], v15, v9
L_a_loop_42:
    s_mul_i32 s45, s60, 786432
    s_add_u32 s48, s45, 8192
    s_add_u32 s49, s45, 16384
    s_lshl_b32 s61, s60, 17
    s_lshl_b32 s63, s60, 18
    s_mov_b32 s70, 0
L_spin_43:
    buffer_load_dword v40, v48, s[12:15], 0 offen sc1
    s_waitcnt vmcnt(0)
    v_cmp_ge_u32 vcc, s60, v40
    s_add_u32 s70, s70, 1
    s_cbranch_vccz L_spok_44
    s_sleep 3
    s_cmp_lt_u32 s70, 524288
    s_cbranch_scc1 L_spin_43
    s_branch L_c_done_1
L_spok_44:
    buffer_load_dwordx4 a[0:3], v3, s[12:15], s45 offen offset:0 sc1
    buffer_load_dwordx4 a[4:7], v3, s[12:15], s45 offen offset:1024 sc1
    buffer_load_dwordx4 a[8:11], v3, s[12:15], s45 offen offset:2048 sc1
    buffer_load_dwordx4 a[12:15], v3, s[12:15], s45 offen offset:3072 sc1
    buffer_load_dwordx4 a[16:19], v5, s[12:15], s45 offen offset:0 sc1
    buffer_load_dwordx4 a[20:23], v5, s[12:15], s45 offen offset:1024 sc1
    buffer_load_dwordx4 a[24:27], v5, s[12:15], s45 offen offset:2048 sc1
    buffer_load_dwordx4 a[28:31], v5, s[12:15], s45 offen offset:3072 sc1
    buffer_load_dwordx4 a[32:35], v3, s[12:15], s48 offen offset:0 sc1
    buffer_load_dwordx4 a[36:39], v3, s[12:15], s48 offen offset:1024 sc1
    buffer_load_dwordx4 a[40:43], v3, s[12:15], s48 offen offset:2048 sc1
    buffer_load_dwordx4 a[44:47], v3, s[12:15], s48 offen offset:3072 sc1
    buffer_load_dwordx4 a[48:51], v5, s[12:15], s48 offen offset:0 sc1
    buffer_load_dwordx4 a[52:55], v5, s[12:15], s48 offen offset:1024 sc1
    buffer_load_dwordx4 a[56:59], v5, s[12:15], s48 offen offset:2048 sc1
    buffer_load_dwordx4 a[60:63], v5, s[12:15], s48 offen offset:3072 sc1
    buffer_load_dwordx4 v[16:19], v3, s[12:15], s49 offen offset:0 sc1
    buffer_load_dwordx4 v[20:23], v3, s[12:15], s49 offen offset:1024 sc1
    buffer_load_dwordx4 v[24:27], v3, s[12:15], s49 offen offset:2048 sc1
    buffer_load_dwordx4 v[28:31], v3, s[12:15], s49 offen offset:3072 sc1
    buffer_load_dwordx4 v[32:35], v5, s[12:15], s49 offen offset:0 sc1
    buffer_load_dwordx4 v[36:39], v5, s[12:15], s49 offen offset:1024 sc1
    buffer_load_dwordx4 v[40:43], v5, s[12:15], s49 offen offset:2048 sc1
    buffer_load_dwordx4 v[44:47], v5, s[12:15], s49 offen offset:3072 sc1
    s_waitcnt vmcnt(0)
    ds_write_b128 v8, v[16:19] offset:0
    ds_write_b128 v8, v[20:23] offset:64
    ds_write_b128 v8, v[24:27] offset:128
    ds_write_b128 v8, v[28:31] offset:192
    ds_write_b128 v8, v[32:35] offset:4352
    ds_write_b128 v8, v[36:39] offset:4416
    ds_write_b128 v8, v[40:43] offset:4480
    ds_write_b128 v8, v[44:47] offset:4544
    v_mfma_f32_16x16x32_bf16 v[56:59], a[32:35], a[0:3], 0
    v_mfma_f32_16x16x32_bf16 v[60:63], a[32:35], a[16:19], 0
    v_mfma_f32_16x16x32_bf16 v[68:71], a[48:51], a[16:19], 0
    v_mfma_f32_16x16x32_bf16 v[56:59], a[36:39], a[4:7], v[56:59]
    v_mfma_f32_16x16x32_bf16 v[60:63], a[36:39], a[20:23], v[60:63]
    v_mfma_f32_16x16x32_bf16 v[68:71], a[52:55], a[20:23], v[68:71]
    v_mfma_f32_16x16x32_bf16 v[56:59], a[40:43], a[8:11], v[56:59]
    v_mfma_f32_16x16x32_bf16 v[60:63], a[40:43], a[24:27], v[60:63]
    v_mfma_f32_16x16x32_bf16 v[68:71], a[56:59], a[24:27], v[68:71]
    v_mfma_f32_16x16x32_bf16 v[56:59], a[44:47], a[12:15], v[56:59]
    v_mfma_f32_16x16x32_bf16 v[60:63], a[44:47], a[28:31], v[60:63]
    v_mfma_f32_16x16x32_bf16 v[68:71], a[60:63], a[28:31], v[68:71]
    s_waitcnt lgkmcnt(0)
    ds_read_b64_tr_b16 a[80:81], v12 offset:0
    ds_read_b64_tr_b16 a[82:83], v12 offset:4352
    ds_read_b64_tr_b16 a[86:87], v12 offset:32
    ds_read_b64_tr_b16 a[88:89], v12 offset:4384
    ds_read_b64_tr_b16 a[92:93], v12 offset:64
    ds_read_b64_tr_b16 a[94:95], v12 offset:4416
    ds_read_b64_tr_b16 a[98:99], v12 offset:96
    ds_read_b64_tr_b16 a[100:101], v12 offset:4448
    s_waitcnt lgkmcnt(0)
    ds_read_b64_tr_b16 a[104:105], v12 offset:128
    ds_read_b64_tr_b16 a[106:107], v12 offset:4480
    ds_read_b64_tr_b16 a[110:111], v12 offset:160
    ds_read_b64_tr_b16 a[112:113], v12 offset:4512
    ds_read_b64_tr_b16 a[116:117], v12 offset:192
    ds_read_b64_tr_b16 a[118:119], v12 offset:4544
    ds_read_b64_tr_b16 a[122:123], v12 offset:224
    ds_read_b64_tr_b16 a[124:125], v12 offset:4576
    v_mov_b32 v15, 0xff800000
    v_cndmask_b32 v56, v56, v15, s[84:85]
    v_cndmask_b32 v68, v68, v15, s[84:85]
    v_cndmask_b32 v57, v57, v15, s[86:87]
    v_cndmask_b32 v69, v69, v15, s[86:87]
    v_cndmask_b32 v58, v58, v15, s[88:89]
    v_cndmask_b32 v70, v70, v15, s[88:89]
    v_cndmask_b32 v59, v59, v15, s[90:91]
    v_cndmask_b32 v71, v71, v15, s[90:91]
    s_mov_b32 s70, 0
L_a_cp_45:
    s_add_u32 s70, s70, 1
    s_cmp_ge_u32 s60, 63
    s_cbranch_scc1 L_a_fl_46
    buffer_load_dword v40, v13, s[12:15], s61 offen sc1
    s_waitcnt vmcnt(0)
    v_cmp_eq_u32 vcc, -1, v40
    s_add_u32 s70, s70, 1
    s_cbranch_vccz L_a_fl_46
L_a_cp_45_s:
    s_sleep 4
    s_cmp_lt_u32 s70, 524288
    s_cbranch_scc1 L_a_cp_45
    s_branch L_c_done_1
L_a_fl_46:
    buffer_load_dwordx4 v[24:27], v6, s[12:15], s61 offen offset:0 sc1
    buffer_load_dwordx4 v[28:31], v6, s[12:15], s61 offen offset:1024 sc1
    buffer_load_dwordx4 v[32:35], v6, s[12:15], s61 offen offset:2048 sc1
    buffer_load_dwordx4 v[36:39], v6, s[12:15], s61 offen offset:3072 sc1
    buffer_load_dwordx4 v[16:19], v7, s[12:15], s61 offen offset:512 sc1
    buffer_load_dwordx4 v[20:23], v7, s[12:15], s61 offen offset:2560 sc1
    s_waitcnt vmcnt(0)
    v_max_u32 v40, v16, v17
    v_max3_u32 v40, v40, v18, v19
    v_max3_u32 v40, v40, v20, v21
    v_max3_u32 v40, v40, v22, v23
    v_max3_u32 v40, v40, v24, v25
    v_max3_u32 v40, v40, v26, v27
    v_max3_u32 v40, v40, v28, v29
    v_max3_u32 v40, v40, v30, v31
    v_max3_u32 v40, v40, v32, v33
    v_max3_u32 v40, v40, v34, v35
    v_max3_u32 v40, v40, v36, v37
    v_max3_u32 v40, v40, v38, v39
    v_cmp_eq_u32 vcc, -1, v40
    s_nop 0
    s_cbranch_vccnz L_a_cp_45_s
    v_mfma_f32_16x16x32_bf16 v[72:75], v[24:27], a[0:3], 0
    v_mfma_f32_16x16x32_bf16 v[76:79], v[24:27], a[16:19], 0
    v_mfma_f32_16x16x32_bf16 v[72:75], v[28:31], a[4:7], v[72:75]
    v_mfma_f32_16x16x32_bf16 v[76:79], v[28:31], a[20:23], v[76:79]
    v_mfma_f32_16x16x32_bf16 v[72:75], v[32:35], a[8:11], v[72:75]
    v_mfma_f32_16x16x32_bf16 v[76:79], v[32:35], a[24:27], v[76:79]
    v_mfma_f32_16x16x32_bf16 v[72:75], v[36:39], a[12:15], v[72:75]
    v_mfma_f32_16x16x32_bf16 v[76:79], v[36:39], a[28:31], v[76:79]
    ds_write_b128 v11, v[16:19] offset:8704
    ds_write_b128 v11, v[20:23] offset:8832
    s_waitcnt lgkmcnt(0)
    ds_read_b64_tr_b16 a[84:85], v12 offset:8704
    ds_read_b64_tr_b16 a[90:91], v12 offset:8736
    ds_read_b64_tr_b16 a[96:97], v12 offset:8768
    ds_read_b64_tr_b16 a[102:103], v12 offset:8800
    ds_read_b64_tr_b16 a[108:109], v12 offset:8832
    ds_read_b64_tr_b16 a[114:115], v12 offset:8864
    ds_read_b64_tr_b16 a[120:121], v12 offset:8896
    ds_read_b64_tr_b16 a[126:127], v12 offset:8928
    v_cndmask_b32 v72, v72, v15, s[56:57]
    v_cndmask_b32 v73, v73, v15, s[56:57]
    v_cndmask_b32 v74, v74, v15, s[56:57]
    v_cndmask_b32 v75, v75, v15, s[56:57]
    v_cndmask_b32 v76, v76, v15, s[56:57]
    v_cndmask_b32 v77, v77, v15, s[56:57]
    v_cndmask_b32 v78, v78, v15, s[56:57]
    v_cndmask_b32 v79, v79, v15, s[56:57]
    v_max_f32 v40, v56, v57
    v_max3_f32 v40, v40, v58, v59
    v_max3_f32 v40, v40, v72, v73
    v_max3_f32 v40, v40, v74, v75
    v_mov_b32 v41, v40
    s_nop 1
    v_permlane16_swap_b32 v40, v41
    v_max_f32 v40, v40, v41
    v_mov_b32 v41, v40
    s_nop 1
    v_permlane32_swap_b32 v40, v41
    v_max_f32 v40, v40, v41
    v_mul_f32 v40, s54, v40
    v_fma_f32 v56, v56, s54, -v40
    v_fma_f32 v57, v57, s54, -v40
    v_fma_f32 v58, v58, s54, -v40
    v_fma_f32 v59, v59, s54, -v40
    v_fma_f32 v72, v72, s54, -v40
    v_fma_f32 v73, v73, s54, -v40
    v_fma_f32 v74, v74, s54, -v40
    v_fma_f32 v75, v75, s54, -v40
    v_exp_f32 v56, v56
    v_exp_f32 v57, v57
    v_exp_f32 v58, v58
    v_exp_f32 v59, v59
    v_exp_f32 v72, v72
    v_exp_f32 v73, v73
    v_exp_f32 v74, v74
    v_exp_f32 v75, v75
    v_add_f32 v40, v56, v57
    v_add_f32 v40, v40, v58
    v_add_f32 v40, v40, v59
    v_add_f32 v40, v40, v72
    v_add_f32 v40, v40, v73
    v_add_f32 v40, v40, v74
    v_add_f32 v40, v40, v75
    v_mov_b32 v41, v40
    s_nop 1
    v_permlane16_swap_b32 v40, v41
    v_add_f32 v40, v40, v41
    v_mov_b32 v41, v40
    s_nop 1
    v_permlane32_swap_b32 v40, v41
    v_add_f32 v40, v40, v41
    v_rcp_f32 v40, v40
    s_nop 0
    v_mul_f32 v56, v56, v40
    v_mul_f32 v57, v57, v40
    v_mul_f32 v58, v58, v40
    v_mul_f32 v59, v59, v40
    v_mul_f32 v72, v72, v40
    v_mul_f32 v73, v73, v40
    v_mul_f32 v74, v74, v40
    v_mul_f32 v75, v75, v40
    v_cvt_pk_bf16_f32 v24, v56, v57
    v_cvt_pk_bf16_f32 v25, v58, v59
    v_cvt_pk_bf16_f32 v28, v72, v73
    v_cvt_pk_bf16_f32 v29, v74, v75
    v_max_f32 v40, v60, v61
    v_max3_f32 v40, v40, v62, v63
    v_max3_f32 v40, v40, v68, v69
    v_max3_f32 v40, v40, v70, v71
    v_max3_f32 v40, v40, v76, v77
    v_max3_f32 v40, v40, v78, v79
    v_mov_b32 v41, v40
    s_nop 1
    v_permlane16_swap_b32 v40, v41
    v_max_f32 v40, v40, v41
    v_mov_b32 v41, v40
    s_nop 1
    v_permlane32_swap_b32 v40, v41
    v_max_f32 v40, v40, v41
    v_mul_f32 v40, s54, v40
    v_fma_f32 v60, v60, s54, -v40
    v_fma_f32 v61, v61, s54, -v40
    v_fma_f32 v62, v62, s54, -v40
    v_fma_f32 v63, v63, s54, -v40
    v_fma_f32 v68, v68, s54, -v40
    v_fma_f32 v69, v69, s54, -v40
    v_fma_f32 v70, v70, s54, -v40
    v_fma_f32 v71, v71, s54, -v40
    v_fma_f32 v76, v76, s54, -v40
    v_fma_f32 v77, v77, s54, -v40
    v_fma_f32 v78, v78, s54, -v40
    v_fma_f32 v79, v79, s54, -v40
    v_exp_f32 v60, v60
    v_exp_f32 v61, v61
    v_exp_f32 v62, v62
    v_exp_f32 v63, v63
    v_exp_f32 v68, v68
    v_exp_f32 v69, v69
    v_exp_f32 v70, v70
    v_exp_f32 v71, v71
    v_exp_f32 v76, v76
    v_exp_f32 v77, v77
    v_exp_f32 v78, v78
    v_exp_f32 v79, v79
    v_add_f32 v40, v60, v61
    v_add_f32 v40, v40, v62
    v_add_f32 v40, v40, v63
    v_add_f32 v40, v40, v68
    v_add_f32 v40, v40, v69
    v_add_f32 v40, v40, v70
    v_add_f32 v40, v40, v71
    v_add_f32 v40, v40, v76
    v_add_f32 v40, v40, v77
    v_add_f32 v40, v40, v78
    v_add_f32 v40, v40, v79
    v_mov_b32 v41, v40
    s_nop 1
    v_permlane16_swap_b32 v40, v41
    v_add_f32 v40, v40, v41
    v_mov_b32 v41, v40
    s_nop 1
    v_permlane32_swap_b32 v40, v41
    v_add_f32 v40, v40, v41
    v_rcp_f32 v40, v40
    s_nop 0
    v_mul_f32 v60, v60, v40
    v_mul_f32 v61, v61, v40
    v_mul_f32 v62, v62, v40
    v_mul_f32 v63, v63, v40
    v_mul_f32 v68, v68, v40
    v_mul_f32 v69, v69, v40
    v_mul_f32 v70, v70, v40
    v_mul_f32 v71, v71, v40
    v_mul_f32 v76, v76, v40
    v_mul_f32 v77, v77, v40
    v_mul_f32 v78, v78, v40
    v_mul_f32 v79, v79, v40
    v_cvt_pk_bf16_f32 v30, v60, v61
    v_cvt_pk_bf16_f32 v31, v62, v63
    v_cvt_pk_bf16_f32 v32, v68, v69
    v_cvt_pk_bf16_f32 v33, v70, v71
    v_cvt_pk_bf16_f32 v34, v76, v77
    v_cvt_pk_bf16_f32 v35, v78, v79
    s_waitcnt lgkmcnt(0)
    s_nop 0
    v_mfma_f32_16x16x16_bf16 v[64:67], a[80:81], v[24:25], 0
    v_mfma_f32_16x16x16_bf16 v[68:71], a[86:87], v[24:25], 0
    v_mfma_f32_16x16x16_bf16 v[72:75], a[92:93], v[24:25], 0
    v_mfma_f32_16x16x16_bf16 v[76:79], a[98:99], v[24:25], 0
    v_mfma_f32_16x16x16_bf16 v[80:83], a[104:105], v[24:25], 0
    v_mfma_f32_16x16x16_bf16 v[84:87], a[110:111], v[24:25], 0
    v_mfma_f32_16x16x16_bf16 v[88:91], a[116:117], v[24:25], 0
    v_mfma_f32_16x16x16_bf16 v[92:95], a[122:123], v[24:25], 0
    v_mfma_f32_16x16x16_bf16 v[64:67], a[84:85], v[28:29], v[64:67]
    v_mfma_f32_16x16x16_bf16 v[68:71], a[90:91], v[28:29], v[68:71]
    v_mfma_f32_16x16x16_bf16 v[72:75], a[96:97], v[28:29], v[72:75]
    v_mfma_f32_16x16x16_bf16 v[76:79], a[102:103], v[28:29], v[76:79]
    v_mfma_f32_16x16x16_bf16 v[80:83], a[108:109], v[28:29], v[80:83]
    v_mfma_f32_16x16x16_bf16 v[84:87], a[114:115], v[28:29], v[84:87]
    v_mfma_f32_16x16x16_bf16 v[88:91], a[120:121], v[28:29], v[88:91]
    v_mfma_f32_16x16x16_bf16 v[92:95], a[126:127], v[28:29], v[92:95]
    v_mfma_f32_16x16x16_bf16 v[96:99], a[80:81], v[30:31], 0
    v_mfma_f32_16x16x16_bf16 v[100:103], a[86:87], v[30:31], 0
    v_mfma_f32_16x16x16_bf16 v[104:107], a[92:93], v[30:31], 0
    v_mfma_f32_16x16x16_bf16 v[108:111], a[98:99], v[30:31], 0
    v_mfma_f32_16x16x16_bf16 v[112:115], a[104:105], v[30:31], 0
    v_mfma_f32_16x16x16_bf16 v[116:119], a[110:111], v[30:31], 0
    v_mfma_f32_16x16x16_bf16 v[120:123], a[116:117], v[30:31], 0
    v_mfma_f32_16x16x16_bf16 v[124:127], a[122:123], v[30:31], 0
    v_mfma_f32_16x16x16_bf16 v[96:99], a[82:83], v[32:33], v[96:99]
    v_mfma_f32_16x16x16_bf16 v[100:103], a[88:89], v[32:33], v[100:103]
    v_mfma_f32_16x16x16_bf16 v[104:107], a[94:95], v[32:33], v[104:107]
    v_mfma_f32_16x16x16_bf16 v[108:111], a[100:101], v[32:33], v[108:111]
    v_mfma_f32_16x16x16_bf16 v[112:115], a[106:107], v[32:33], v[112:115]
    v_mfma_f32_16x16x16_bf16 v[116:119], a[112:113], v[32:33], v[116:119]
    v_mfma_f32_16x16x16_bf16 v[120:123], a[118:119], v[32:33], v[120:123]
    v_mfma_f32_16x16x16_bf16 v[124:127], a[124:125], v[32:33], v[124:127]
    v_mfma_f32_16x16x16_bf16 v[96:99], a[84:85], v[34:35], v[96:99]
    v_mfma_f32_16x16x16_bf16 v[100:103], a[90:91], v[34:35], v[100:103]
    v_mfma_f32_16x16x16_bf16 v[104:107], a[96:97], v[34:35], v[104:107]
    v_mfma_f32_16x16x16_bf16 v[108:111], a[102:103], v[34:35], v[108:111]
    v_mfma_f32_16x16x16_bf16 v[112:115], a[108:109], v[34:35], v[112:115]
    v_mfma_f32_16x16x16_bf16 v[116:119], a[114:115], v[34:35], v[116:119]
    v_mfma_f32_16x16x16_bf16 v[120:123], a[120:121], v[34:35], v[120:123]
    v_mfma_f32_16x16x16_bf16 v[124:127], a[126:127], v[34:35], v[124:127]
    s_add_u32 s46, s63, 4096
    v_cvt_pk_bf16_f32 v64, v64, v65
    v_cvt_pk_bf16_f32 v65, v66, v67
    v_cvt_pk_bf16_f32 v66, v68, v69
    v_cvt_pk_bf16_f32 v67, v70, v71
    buffer_store_dwordx4 v[64:67], v10, s[12:15], s63 offen offset:0 sc1
    v_cvt_pk_bf16_f32 v72, v72, v73
    v_cvt_pk_bf16_f32 v73, v74, v75
    v_cvt_pk_bf16_f32 v74, v76, v77
    v_cvt_pk_bf16_f32 v75, v78, v79
    buffer_store_dwordx4 v[72:75], v10, s[12:15], s63 offen offset:2048 sc1
    v_cvt_pk_bf16_f32 v80, v80, v81
    v_cvt_pk_bf16_f32 v81, v82, v83
    v_cvt_pk_bf16_f32 v82, v84, v85
    v_cvt_pk_bf16_f32 v83, v86, v87
    buffer_store_dwordx4 v[80:83], v10, s[12:15], s46 offen offset:0 sc1
    v_cvt_pk_bf16_f32 v88, v88, v89
    v_cvt_pk_bf16_f32 v89, v90, v91
    v_cvt_pk_bf16_f32 v90, v92, v93
    v_cvt_pk_bf16_f32 v91, v94, v95
    buffer_store_dwordx4 v[88:91], v10, s[12:15], s46 offen offset:2048 sc1
    v_cvt_pk_bf16_f32 v96, v96, v97
    v_cvt_pk_bf16_f32 v97, v98, v99
    v_cvt_pk_bf16_f32 v98, v100, v101
    v_cvt_pk_bf16_f32 v99, v102, v103
    buffer_store_dwordx4 v[96:99], v10, s[12:15], s63 offen offset:256 sc1
    v_cvt_pk_bf16_f32 v104, v104, v105
    v_cvt_pk_bf16_f32 v105, v106, v107
    v_cvt_pk_bf16_f32 v106, v108, v109
    v_cvt_pk_bf16_f32 v107, v110, v111
    buffer_store_dwordx4 v[104:107], v10, s[12:15], s63 offen offset:2304 sc1
    v_cvt_pk_bf16_f32 v112, v112, v113
    v_cvt_pk_bf16_f32 v113, v114, v115
    v_cvt_pk_bf16_f32 v114, v116, v117
    v_cvt_pk_bf16_f32 v115, v118, v119
    buffer_store_dwordx4 v[112:115], v10, s[12:15], s46 offen offset:256 sc1
    v_cvt_pk_bf16_f32 v120, v120, v121
    v_cvt_pk_bf16_f32 v121, v122, v123
    v_cvt_pk_bf16_f32 v122, v124, v125
    v_cvt_pk_bf16_f32 v123, v126, v127
    buffer_store_dwordx4 v[120:123], v10, s[12:15], s46 offen offset:2304 sc1
    s_waitcnt vmcnt(0)
    v_mov_b32 v16, s60
    v_add_u32 v16, 1, v16
    v_mov_b32 v17, 0
    s_mov_b64 exec, 1
    buffer_store_dword v16, v17, s[12:15], s52 offen sc1
    s_mov_b64 exec, -1
L_sf_48:
    s_add_u32 s60, s60, 4
    s_cmp_lt_u32 s60, 64
    s_cbranch_scc1 L_a_loop_42
    s_branch L_c_done_1
L_w_g_10:
    s_lshr_b32 s53, s48, 2
    s_cmp_lt_u32 s53, 2
    s_cselect_b32 s46, 1, 0
    s_xor_b32 s53, s53, s46
    s_mov_b32 s74, 0
    s_mov_b32 s76, 0
    s_cmp_eq_u32 s53, 1
    s_cselect_b32 s75, 41, 58
    s_cmp_eq_u32 s53, 2
    s_cselect_b32 s75, 54, s75
L_w_g_10_e:
    s_lshl_b32 s46, s53, 3
    s_add_u32 s46, s46, 16
    s_load_dwordx2 s[4:5], s[0:1], s46
    s_lshl_b32 s49, s40, 2
    s_and_b32 s46, s48, 3
    s_add_u32 s49, s49, s46
    s_load_dwordx2 s[6:7], s[0:1], 72
    s_and_b32 s50, s44, 3
    s_lshr_b32 s51, s44, 2
    s_waitcnt lgkmcnt(0)
    s_mov_b32 s24, s4
    s_and_b32 s25, s5, 0xffff
    s_mov_b32 s26, 0x800000
    s_mov_b32 s27, 0x00020000
    s_cmp_lg_u32 s76, 0
    s_cbranch_scc1 L_g_n3_49
    s_cmp_ge_u32 s44, 3
    s_cbranch_scc1 L_g_n3_49
    s_mul_i32 s46, s48, 3
    s_add_u32 s46, s46, s44
    s_cmp_ge_u32 s46, 32
    s_cbranch_scc1 L_g_n3_49
    s_lshr_b32 s47, s46, 4
    s_add_u32 s47, s47, 1
    s_cmp_eq_u32 s47, 3
    s_cselect_b32 s47, 0, s47
    s_lshl_b32 s47, s47, 3
    s_add_u32 s47, s47, 16
    s_load_dwordx2 s[8:9], s[0:1], s47
    s_and_b32 s46, s46, 15
    s_lshl_b32 s46, s46, 19
    s_lshl_b32 s47, s40, 10
    s_add_u32 s46, s46, s47
    s_add_u32 s46, s46, 384
    v_lshlrev_b32 v10, 13, v1
    s_waitcnt lgkmcnt(0)
    s_mov_b32 s28, s8
    s_and_b32 s29, s9, 0xffff
    s_mov_b32 s30, 0x800000
    s_mov_b32 s31, 0x00020000
    buffer_load_dword v16, v10, s[28:31], s46 offen
L_g_n3_49:
    s_cmp_lg_u32 s53, 0
    s_cbranch_scc1 L_g_nq_50
    s_load_dwordx4 s[8:11], s[0:1], 24
    v_bfe_u32 v10, v0, 1, 6
    v_lshlrev_b32 v10, 13, v10
    v_and_b32 v11, 1, v0
    v_lshl_add_u32 v10, v11, 7, v10
    v_bfe_u32 v11, v0, 7, 1
    v_lshl_add_u32 v10, v11, 22, v10
    s_lshl_b32 s46, s49, 8
    s_waitcnt lgkmcnt(0)
    s_mov_b32 s28, s10
    s_and_b32 s29, s11, 0xffff
    s_mov_b32 s30, 0x800000
    s_mov_b32 s31, 0x00020000
    s_mov_b32 s32, s8
    s_and_b32 s33, s9, 0xffff
    s_mov_b32 s34, 0x800000
    s_mov_b32 s35, 0x00020000
    s_lshl_b32 s47, s51, 19
    s_add_u32 s46, s46, s47
    s_add_u32 s47, s46, 0x200000
    buffer_load_dword v11, v10, s[28:31], s47 offen
    s_add_u32 s47, s46, 0x300000
    buffer_load_dword v12, v10, s[28:31], s47 offen
L_g_nq_50:
    v_lshrrev_b32 v3, 4, v1
    v_and_b32 v4, 15, v1
    v_lshlrev_b32 v5, 2, v3
    v_xor_b32 v4, v4, v5
    v_mul_u32_u24 v3, 8192, v3
    v_lshl_add_u32 v3, v4, 4, v3
    s_mul_i32 s46, s51, 512
    s_mul_i32 s47, s50, 16
    s_add_u32 s46, s46, s47
    s_mul_i32 s46, s46, 8192
    s_lshl_b32 s47, s49, 8
    s_add_u32 s46, s46, s47
    s_lshl_b32 s45, s51, 16
    s_mul_i32 s47, s50, 4096
    s_add_u32 s45, s45, s47
    v_bfe_u32 v4, v1, 2, 2
    v_bfe_u32 v5, v1, 4, 1
    v_lshlrev_b32 v5, 1, v5
    v_bfe_u32 v6, v1, 0, 1
    v_add_u32 v5, v5, v6
    s_lshl_b32 s47, s50, 2
    v_add_u32 v5, s47, v5
    v_lshlrev_b32 v6, 2, v4
    v_xor_b32 v5, v5, v6
    v_lshlrev_b32 v5, 4, v5
    v_lshl_add_u32 v5, v4, 8, v5
    v_bfe_u32 v6, v1, 1, 1
    v_lshl_add_u32 v5, v6, 3, v5
    v_lshrrev_b32 v6, 5, v1
    v_mul_u32_u24 v6, 2048, v6
    v_add_u32 v5, v5, v6
    s_lshl_b32 s47, s51, 16
    v_add_u32 v5, s47, v5
    v_bfe_u32 v4, v1, 2, 2
    v_xor_b32 v5, s50, v4
    v_lshlrev_b32 v5, 6, v5
    v_lshl_add_u32 v5, v4, 8, v5
    v_and_b32 v6, 3, v1
    v_lshl_add_u32 v5, v6, 4, v5
    v_lshrrev_b32 v6, 4, v1
    v_lshl_add_u32 v5, v6, 11, v5
    v_lshrrev_b32 v6, 5, v1
    s_lshl_b32 s47, s51, 16
    v_add_u32 v5, s47, v5
    s_add_u32 m0, s45, 0
    s_add_u32 s47, s46, 0x0
    buffer_load_dwordx4 v3, s[24:27], s47 offen  lds
    s_add_u32 m0, s45, 1024
    s_add_u32 s47, s46, 0x8000
    buffer_load_dwordx4 v3, s[24:27], s47 offen  lds
    s_add_u32 m0, s45, 2048
    s_add_u32 s47, s46, 0x10000
    buffer_load_dwordx4 v3, s[24:27], s47 offen  lds
    s_add_u32 m0, s45, 3072
    s_add_u32 s47, s46, 0x18000
    buffer_load_dwordx4 v3, s[24:27], s47 offen  lds
    s_add_u32 m0, s45, 16384
    s_add_u32 s47, s46, 0x80000
    buffer_load_dwordx4 v3, s[24:27], s47 offen  lds
    s_add_u32 m0, s45, 17408
    s_add_u32 s47, s46, 0x88000
    buffer_load_dwordx4 v3, s[24:27], s47 offen  lds
    s_add_u32 m0, s45, 18432
    s_add_u32 s47, s46, 0x90000
    buffer_load_dwordx4 v3, s[24:27], s47 offen  lds
    s_add_u32 m0, s45, 19456
    s_add_u32 s47, s46, 0x98000
    buffer_load_dwordx4 v3, s[24:27], s47 offen  lds
    s_add_u32 m0, s45, 32768
    s_add_u32 s47, s46, 0x100000
    buffer_load_dwordx4 v3, s[24:27], s47 offen  lds
    s_add_u32 m0, s45, 33792
    s_add_u32 s47, s46, 0x108000
    buffer_load_dwordx4 v3, s[24:27], s47 offen  lds
    s_add_u32 m0, s45, 34816
    s_add_u32 s47, s46, 0x110000
    buffer_load_dwordx4 v3, s[24:27], s47 offen  lds
    s_add_u32 m0, s45, 35840
    s_add_u32 s47, s46, 0x118000
    buffer_load_dwordx4 v3, s[24:27], s47 offen  lds
    s_add_u32 m0, s45, 49152
    s_add_u32 s47, s46, 0x180000
    buffer_load_dwordx4 v3, s[24:27], s47 offen  lds
    s_add_u32 m0, s45, 50176
    s_add_u32 s47, s46, 0x188000
    buffer_load_dwordx4 v3, s[24:27], s47 offen  lds
    s_add_u32 m0, s45, 51200
    s_add_u32 s47, s46, 0x190000
    buffer_load_dwordx4 v3, s[24:27], s47 offen  lds
    s_add_u32 m0, s45, 52224
    s_add_u32 s47, s46, 0x198000
    buffer_load_dwordx4 v3, s[24:27], s47 offen  lds
    s_waitcnt vmcnt(12) lgkmcnt(0)
    s_barrier
    ds_read_b64_tr_b16 a[0:1], v5 offset:0
    ds_read_b64_tr_b16 a[2:3], v5 offset:1024
    ds_read_b64_tr_b16 a[4:5], v5 offset:8
    ds_read_b64_tr_b16 a[6:7], v5 offset:1032
    ds_read_b64_tr_b16 a[8:9], v5 offset:8192
    ds_read_b64_tr_b16 a[10:11], v5 offset:9216
    ds_read_b64_tr_b16 a[12:13], v5 offset:8200
    ds_read_b64_tr_b16 a[14:15], v5 offset:9224
    s_waitcnt vmcnt(8) lgkmcnt(0)
    s_barrier
    s_add_u32 m0, s45, 0
    s_add_u32 s47, s46, 0x200000
    buffer_load_dwordx4 v3, s[24:27], s47 offen  lds
    s_add_u32 m0, s45, 1024
    s_add_u32 s47, s46, 0x208000
    buffer_load_dwordx4 v3, s[24:27], s47 offen  lds
    s_add_u32 m0, s45, 2048
    s_add_u32 s47, s46, 0x210000
    buffer_load_dwordx4 v3, s[24:27], s47 offen  lds
    s_add_u32 m0, s45, 3072
    s_add_u32 s47, s46, 0x218000
    buffer_load_dwordx4 v3, s[24:27], s47 offen  lds
    ds_read_b64_tr_b16 a[16:17], v5 offset:16384
    ds_read_b64_tr_b16 a[18:19], v5 offset:17408
    ds_read_b64_tr_b16 a[20:21], v5 offset:16392
    ds_read_b64_tr_b16 a[22:23], v5 offset:17416
    ds_read_b64_tr_b16 a[24:25], v5 offset:24576
    ds_read_b64_tr_b16 a[26:27], v5 offset:25600
    ds_read_b64_tr_b16 a[28:29], v5 offset:24584
    ds_read_b64_tr_b16 a[30:31], v5 offset:25608
    s_waitcnt vmcnt(8) lgkmcnt(0)
    s_barrier
    s_add_u32 m0, s45, 16384
    s_add_u32 s47, s46, 0x280000
    buffer_load_dwordx4 v3, s[24:27], s47 offen  lds
    s_add_u32 m0, s45, 17408
    s_add_u32 s47, s46, 0x288000
    buffer_load_dwordx4 v3, s[24:27], s47 offen  lds
    s_add_u32 m0, s45, 18432
    s_add_u32 s47, s46, 0x290000
    buffer_load_dwordx4 v3, s[24:27], s47 offen  lds
    s_add_u32 m0, s45, 19456
    s_add_u32 s47, s46, 0x298000
    buffer_load_dwordx4 v3, s[24:27], s47 offen  lds
    ds_read_b64_tr_b16 a[32:33], v5 offset:32768
    ds_read_b64_tr_b16 a[34:35], v5 offset:33792
    ds_read_b64_tr_b16 a[36:37], v5 offset:32776
    ds_read_b64_tr_b16 a[38:39], v5 offset:33800
    ds_read_b64_tr_b16 a[40:41], v5 offset:40960
    ds_read_b64_tr_b16 a[42:43], v5 offset:41984
    ds_read_b64_tr_b16 a[44:45], v5 offset:40968
    ds_read_b64_tr_b16 a[46:47], v5 offset:41992
    s_waitcnt vmcnt(8) lgkmcnt(0)
    s_barrier
    s_add_u32 m0, s45, 32768
    s_add_u32 s47, s46, 0x300000
    buffer_load_dwordx4 v3, s[24:27], s47 offen  lds
    s_add_u32 m0, s45, 33792
    s_add_u32 s47, s46, 0x308000
    buffer_load_dwordx4 v3, s[24:27], s47 offen  lds
    s_add_u32 m0, s45, 34816
    s_add_u32 s47, s46, 0x310000
    buffer_load_dwordx4 v3, s[24:27], s47 offen  lds
    s_add_u32 m0, s45, 35840
    s_add_u32 s47, s46, 0x318000
    buffer_load_dwordx4 v3, s[24:27], s47 offen  lds
    ds_read_b64_tr_b16 a[48:49], v5 offset:49152
    ds_read_b64_tr_b16 a[50:51], v5 offset:50176
    ds_read_b64_tr_b16 a[52:53], v5 offset:49160
    ds_read_b64_tr_b16 a[54:55], v5 offset:50184
    ds_read_b64_tr_b16 a[56:57], v5 offset:57344
    ds_read_b64_tr_b16 a[58:59], v5 offset:58368
    ds_read_b64_tr_b16 a[60:61], v5 offset:57352
    ds_read_b64_tr_b16 a[62:63], v5 offset:58376
    s_waitcnt vmcnt(8) lgkmcnt(0)
    s_barrier
    s_add_u32 m0, s45, 49152
    s_add_u32 s47, s46, 0x380000
    buffer_load_dwordx4 v3, s[24:27], s47 offen  lds
    s_add_u32 m0, s45, 50176
    s_add_u32 s47, s46, 0x388000
    buffer_load_dwordx4 v3, s[24:27], s47 offen  lds
    s_add_u32 m0, s45, 51200
    s_add_u32 s47, s46, 0x390000
    buffer_load_dwordx4 v3, s[24:27], s47 offen  lds
    s_add_u32 m0, s45, 52224
    s_add_u32 s47, s46, 0x398000
    buffer_load_dwordx4 v3, s[24:27], s47 offen  lds
    ds_read_b64_tr_b16 a[64:65], v5 offset:0
    ds_read_b64_tr_b16 a[66:67], v5 offset:1024
    ds_read_b64_tr_b16 a[68:69], v5 offset:8
    ds_read_b64_tr_b16 a[70:71], v5 offset:1032
    ds_read_b64_tr_b16 a[72:73], v5 offset:8192
    ds_read_b64_tr_b16 a[74:75], v5 offset:9216
    ds_read_b64_tr_b16 a[76:77], v5 offset:8200
    ds_read_b64_tr_b16 a[78:79], v5 offset:9224
    s_waitcnt vmcnt(8) lgkmcnt(0)
    s_barrier
    ds_read_b64_tr_b16 a[80:81], v5 offset:16384
    ds_read_b64_tr_b16 a[82:83], v5 offset:17408
    ds_read_b64_tr_b16 a[84:85], v5 offset:16392
    ds_read_b64_tr_b16 a[86:87], v5 offset:17416
    ds_read_b64_tr_b16 a[88:89], v5 offset:24576
    ds_read_b64_tr_b16 a[90:91], v5 offset:25600
    ds_read_b64_tr_b16 a[92:93], v5 offset:24584
    ds_read_b64_tr_b16 a[94:95], v5 offset:25608
    s_waitcnt vmcnt(4) lgkmcnt(0)
    s_barrier
    ds_read_b64_tr_b16 a[96:97], v5 offset:32768
    ds_read_b64_tr_b16 a[98:99], v5 offset:33792
    ds_read_b64_tr_b16 a[100:101], v5 offset:32776
    ds_read_b64_tr_b16 a[102:103], v5 offset:33800
    ds_read_b64_tr_b16 a[104:105], v5 offset:40960
    ds_read_b64_tr_b16 a[106:107], v5 offset:41984
    ds_read_b64_tr_b16 a[108:109], v5 offset:40968
    ds_read_b64_tr_b16 a[110:111], v5 offset:41992
    s_waitcnt vmcnt(0) lgkmcnt(0)
    s_barrier
    ds_read_b64_tr_b16 a[112:113], v5 offset:49152
    ds_read_b64_tr_b16 a[114:115], v5 offset:50176
    ds_read_b64_tr_b16 a[116:117], v5 offset:49160
    ds_read_b64_tr_b16 a[118:119], v5 offset:50184
    ds_read_b64_tr_b16 a[120:121], v5 offset:57344
    ds_read_b64_tr_b16 a[122:123], v5 offset:58368
    ds_read_b64_tr_b16 a[124:125], v5 offset:57352
    ds_read_b64_tr_b16 a[126:127], v5 offset:58376
    s_waitcnt lgkmcnt(0)
    s_barrier
    v_lshlrev_b32 v2, 4, v1
    s_mul_i32 s64, s44, 8192
    s_add_u32 s46, s64, 0x400000
    v_add_u32 v3, s46, v2
    s_mul_i32 s46, s51, 32768
    v_add_u32 v4, s46, v2
    v_and_b32 v6, 15, v1
    v_lshlrev_b32 v6, 4, v6
    v_lshrrev_b32 v7, 4, v1
    v_lshl_add_u32 v6, v7, 9, v6
    v_add_u32 v4, s46, v6
    s_lshl_b32 s46, s50, 12
    s_add_u32 s46, s46, 131072
    v_add_u32 v5, s46, v2
    v_and_b32 v7, 3, v1
    v_lshlrev_b32 v7, 7, v7
    v_add_u32 v7, 0x109400, v7
    s_mul_i32 s46, s49, 24576
    s_lshl_b32 s47, s53, 13
    s_add_u32 s46, s46, s47
    s_lshl_b32 s47, s50, 10
    s_add_u32 s46, s46, s47
    s_add_u32 s46, s46, 0x2000000
    v_and_b32 v8, 15, v1
    v_lshlrev_b32 v8, 4, v8
    v_bfe_u32 v9, v1, 4, 1
    v_lshl_add_u32 v8, v9, 12, v8
    v_lshrrev_b32 v9, 5, v1
    v_lshl_add_u32 v8, v9, 8, v8
    v_add_u32 v8, s46, v2
    v_add_u32 v9, 4096, v8
    s_lshl_b32 s52, s40, 2
    s_add_u32 s52, s52, s53
    s_lshl_b32 s52, s52, 2
    s_and_b32 s47, s48, 3
    s_add_u32 s52, s52, s47
    s_lshl_b32 s52, s52, 7
    s_add_u32 s52, s52, 0x10a400
    s_add_u32 s52, s52, s76
    v_mov_b32 v120, -1
    v_mov_b32 v121, -1
    v_mov_b32 v122, -1
    v_mov_b32 v123, -1
    s_lshl_b32 s46, s49, 12
    s_lshl_b32 s47, s50, 10
    s_add_u32 s46, s46, s47
    s_add_u32 s46, s46, 0x1000000
    v_add_u32 v64, s46, v2
    s_and_b32 s46, s48, 3
    s_lshl_b32 s46, s46, 16
    s_lshl_b32 s47, s50, 14
    s_add_u32 s46, s46, s47
    s_lshl_b32 s47, s40, 8
    s_add_u32 s46, s46, s47
    s_add_u32 s46, s46, 0x7800000
    v_and_b32 v65, 15, v1
    v_lshlrev_b32 v65, 4, v65
    v_lshrrev_b32 v66, 4, v1
    v_lshl_add_u32 v65, v66, 11, v65
    v_add_u32 v65, s46, v65
    v_add_u32 v68, 8192, v65
    s_lshl_b32 s58, s74, 17
    s_lshl_b32 s46, s53, 3
    s_sub_u32 s46, 80, s46
    s_load_dwordx2 s[8:9], s[0:1], s46
    v_lshlrev_b32 v66, 7, v1
    s_mul_i32 s57, s49, 229376
    s_waitcnt lgkmcnt(0)
    s_mov_b32 s32, s8
    s_and_b32 s33, s9, 0xffff
    s_mov_b32 s34, 0x700000
    s_mov_b32 s35, 0x00020000
    s_mov_b32 s60, 0
    s_mul_i32 s61, s74, 65536
    s_mov_b32 s62, 0
    s_mul_i32 s63, s74, 786432
    s_mul_i32 s85, s78, 65536
    s_mul_i32 s86, s78, 786432
    s_sub_u32 s46, s78, 1
    s_sub_u32 s75, s75, s74
    s_add_u32 s75, s75, s46
    s_lshr_b32 s75, s75, s46
    s_mov_b32 s67, 0
    s_mov_b32 s68, 3
    s_mov_b32 s71, 0
    v_mov_b32 v15, 147456
    v_mov_b32 v14, 0
    ds_write_b32 v15, v14 offset:4
    ds_write_b32 v15, v14 offset:12
    ds_write_b32 v15, v14 offset:16
    v_mov_b32 v114, 1
    v_mov_b32 v115, 0
    s_mov_b32 s81, 0
    s_mul_i32 s87, s78, 2
    s_sub_u32 s87, s74, s87
    s_add_u32 s87, s87, 1
    s_lshl_b32 s46, s44, 5
    v_add_u32 v119, s46, v15
    v_lshrrev_b32 v113, 4, v1
    v_mul_u32_u24 v113, s78, v113
    v_add_u32 v113, s74, v113
    s_mov_b32 s72, 0
    s_cmp_lg_u32 s44, 0
    s_cbranch_scc1 L_zwok_60
    v_and_b32 v10, 7, v1
    v_lshlrev_b32 v10, 5, v10
    s_mov_b32 s70, 0
L_zw_59:
    buffer_load_dword v11, v10, s[16:19], 0 offen sc1
    s_waitcnt vmcnt(0)
    v_add_u32_dpp v11, v11, v11 row_ror:1 row_mask:0xf bank_mask:0xf
    s_nop 1
    v_add_u32_dpp v11, v11, v11 row_ror:2 row_mask:0xf bank_mask:0xf
    s_nop 1
    v_add_u32_dpp v11, v11, v11 row_ror:4 row_mask:0xf bank_mask:0xf
    v_cmp_ne_u32 vcc, 0x100, v11
    s_add_u32 s70, s70, 1
    s_cbranch_vccz L_zwok_60
    s_sleep 4
    s_cmp_lt_u32 s70, 524288
    s_cbranch_scc1 L_zw_59
    s_branch L_c_done_1
L_zwok_60:
L_g_restart_51:
    s_cmp_lg_u32 s44, 0
    s_cbranch_scc1 L_g_nsp_52
    s_mov_b32 s70, 0
L_g_sp_58:
    s_add_u32 s54, s60, 0
    s_mul_i32 s55, s54, s78
    v_add_u32 v12, s55, v113
    v_and_b32 v13, 7, v12
    v_lshl_add_u32 v13, v13, 9, v7
    buffer_load_dword v11, v13, s[12:15], 0 offen sc1
    s_waitcnt vmcnt(0)
    v_cmp_ge_u32 vcc, v12, v11
    s_add_u32 s70, s70, 1
    s_and_b32 s46, vcc_lo, 0xffff
    s_cbranch_scc0 L_g_sp_58_ok
    s_sleep 3
    s_cmp_lt_u32 s70, 524288
    s_cbranch_scc1 L_g_sp_58
    s_branch L_c_done_1
L_g_sp_58_ok:
    v_cmp_ge_u32 vcc, v12, v11
    s_nop 0
    s_ff1_i32_b64 s46, vcc
    s_lshr_b32 s46, s46, 4
    s_min_u32 s46, s46, 4
    s_add_u32 s46, s46, s54
    s_min_u32 s46, s46, s75
    v_mov_b32 v118, s46
    ds_write_b32 v15, v118 offset:20
L_g_nsp_52:
    s_waitcnt lgkmcnt(0)
    s_barrier
    ds_read_b32 v14, v15 offset:20
    s_waitcnt lgkmcnt(0)
    v_readfirstlane_b32 s66, v14
    s_nop 3
L_g_restart_51_go:
    s_mov_b32 s69, 0
    s_cmp_gt_u32 s62, s60
    s_cbranch_scc1 L_g_nd_61
    s_cmp_ge_u32 s62, s66
    s_cbranch_scc1 L_g_nd_61
    s_add_u32 s47, s61, 4096
    s_add_u32 m0, s64, 0
    s_nop 0
    buffer_load_dwordx4 v3, s[12:15], s61 offen offset:0 sc1 lds
    buffer_load_dwordx4 v3, s[12:15], s61 offen offset:1024 sc1 lds
    buffer_load_dwordx4 v3, s[12:15], s61 offen offset:2048 sc1 lds
    buffer_load_dwordx4 v3, s[12:15], s61 offen offset:3072 sc1 lds
    s_add_u32 m0, s64, 4096
    s_nop 0
    buffer_load_dwordx4 v3, s[12:15], s47 offen offset:0 sc1 lds
    buffer_load_dwordx4 v3, s[12:15], s47 offen offset:1024 sc1 lds
    buffer_load_dwordx4 v3, s[12:15], s47 offen offset:2048 sc1 lds
    buffer_load_dwordx4 v3, s[12:15], s47 offen offset:3072 sc1 lds
    s_add_u32 s61, s61, s85
    s_add_u32 s62, s62, 1
    s_xor_b32 s64, s64, 0x10000
    s_mov_b32 s69, 1
L_g_nd_61:
    s_cmp_eq_u32 s51, 1
    s_cbranch_scc1 L_g_g1r_53
    s_add_u32 s59, s60, 1
    s_mov_b32 s69, 0
    s_cmp_gt_u32 s62, s59
    s_cbranch_scc1 L_g_nd_62
    s_cmp_ge_u32 s62, s66
    s_cbranch_scc1 L_g_nd_62
    s_add_u32 s47, s61, 4096
    s_add_u32 m0, s64, 0
    s_nop 0
    buffer_load_dwordx4 v3, s[12:15], s61 offen offset:0 sc1 lds
    buffer_load_dwordx4 v3, s[12:15], s61 offen offset:1024 sc1 lds
    buffer_load_dwordx4 v3, s[12:15], s61 offen offset:2048 sc1 lds
    buffer_load_dwordx4 v3, s[12:15], s61 offen offset:3072 sc1 lds
    s_add_u32 m0, s64, 4096
    s_nop 0
    buffer_load_dwordx4 v3, s[12:15], s47 offen offset:0 sc1 lds
    buffer_load_dwordx4 v3, s[12:15], s47 offen offset:1024 sc1 lds
    buffer_load_dwordx4 v3, s[12:15], s47 offen offset:2048 sc1 lds
    buffer_load_dwordx4 v3, s[12:15], s47 offen offset:3072 sc1 lds
    s_add_u32 s61, s61, s85
    s_add_u32 s62, s62, 1
    s_xor_b32 s64, s64, 0x10000
    s_mov_b32 s69, 1
L_g_nd_62:
    s_cmp_eq_u32 s69, 1
    s_cbranch_scc1 L_g_w0_63
    s_waitcnt vmcnt(0)
L_g_w0_63:
    s_waitcnt vmcnt(8)
    s_cmp_lg_u32 s44, 0
    s_cbranch_scc1 L_g_nl_64
    s_cmp_lt_u32 s66, s75
    s_cselect_b32 s81, 1, 2
L_g_nl_64:
L_g_loop0_54_l:
    s_barrier
    ds_read_b128 v[32:35], v4 offset:0
    ds_read_b128 v[36:39], v4 offset:256
    ds_read_b128 v[40:43], v4 offset:2048
    ds_read_b128 v[44:47], v4 offset:2304
    ds_read_b128 v[48:51], v4 offset:4096
    ds_read_b128 v[52:55], v4 offset:4352
    ds_read_b128 v[56:59], v4 offset:6144
    ds_read_b128 v[60:63], v4 offset:6400
    s_branch L_g_loop0_54_m
.p2align 6
L_g_loop0_54:
    s_barrier
L_g_loop0_54_m:
    s_setprio 2
    s_waitcnt lgkmcnt(6)
    v_mfma_f32_16x16x32_bf16 v[16:19], a[0:3], v[32:35], 0
    v_mfma_f32_16x16x32_bf16 v[20:23], a[4:7], v[32:35], 0
    ds_read_b128 v[32:35], v4 offset:8192
    v_mfma_f32_16x16x32_bf16 v[28:31], a[4:7], v[36:39], 0
    v_mfma_f32_16x16x32_bf16 v[24:27], a[0:3], v[36:39], 0
    ds_read_b128 v[36:39], v4 offset:8448
    s_cmp_eq_u32 s81, 1
    s_cbranch_scc1 L_g_h1_68
L_g_h1_68_b:
    s_waitcnt lgkmcnt(6)
    v_mfma_f32_16x16x32_bf16 v[16:19], a[8:11], v[40:43], v[16:19]
    v_mfma_f32_16x16x32_bf16 v[20:23], a[12:15], v[40:43], v[20:23]
    ds_read_b128 v[40:43], v4 offset:10240
    v_mfma_f32_16x16x32_bf16 v[28:31], a[12:15], v[44:47], v[28:31]
    v_mfma_f32_16x16x32_bf16 v[24:27], a[8:11], v[44:47], v[24:27]
    ds_read_b128 v[44:47], v4 offset:10496
    s_waitcnt lgkmcnt(6)
    v_mfma_f32_16x16x32_bf16 v[16:19], a[16:19], v[48:51], v[16:19]
    v_mfma_f32_16x16x32_bf16 v[20:23], a[20:23], v[48:51], v[20:23]
    ds_read_b128 v[48:51], v4 offset:12288
    v_mfma_f32_16x16x32_bf16 v[28:31], a[20:23], v[52:55], v[28:31]
    v_mfma_f32_16x16x32_bf16 v[24:27], a[16:19], v[52:55], v[24:27]
    ds_read_b128 v[52:55], v4 offset:12544
    s_waitcnt lgkmcnt(6)
    v_mfma_f32_16x16x32_bf16 v[16:19], a[24:27], v[56:59], v[16:19]
    v_mfma_f32_16x16x32_bf16 v[20:23], a[28:31], v[56:59], v[20:23]
    ds_read_b128 v[56:59], v4 offset:14336
    v_mfma_f32_16x16x32_bf16 v[28:31], a[28:31], v[60:63], v[28:31]
    v_mfma_f32_16x16x32_bf16 v[24:27], a[24:27], v[60:63], v[24:27]
    ds_read_b128 v[60:63], v4 offset:14592
    s_waitcnt lgkmcnt(6)
    v_mfma_f32_16x16x32_bf16 v[16:19], a[32:35], v[32:35], v[16:19]
    v_mfma_f32_16x16x32_bf16 v[20:23], a[36:39], v[32:35], v[20:23]
    ds_read_b128 v[32:35], v4 offset:16384
    v_mfma_f32_16x16x32_bf16 v[28:31], a[36:39], v[36:39], v[28:31]
    v_mfma_f32_16x16x32_bf16 v[24:27], a[32:35], v[36:39], v[24:27]
    ds_read_b128 v[36:39], v4 offset:16640
    s_waitcnt lgkmcnt(6)
    v_mfma_f32_16x16x32_bf16 v[16:19], a[40:43], v[40:43], v[16:19]
    v_mfma_f32_16x16x32_bf16 v[20:23], a[44:47], v[40:43], v[20:23]
    ds_read_b128 v[40:43], v4 offset:18432
    v_mfma_f32_16x16x32_bf16 v[28:31], a[44:47], v[44:47], v[28:31]
    v_mfma_f32_16x16x32_bf16 v[24:27], a[40:43], v[44:47], v[24:27]
    ds_read_b128 v[44:47], v4 offset:18688
    s_waitcnt lgkmcnt(6)
    v_mfma_f32_16x16x32_bf16 v[16:19], a[48:51], v[48:51], v[16:19]
    v_mfma_f32_16x16x32_bf16 v[20:23], a[52:55], v[48:51], v[20:23]
    ds_read_b128 v[48:51], v4 offset:20480
    v_mfma_f32_16x16x32_bf16 v[28:31], a[52:55], v[52:55], v[28:31]
    v_mfma_f32_16x16x32_bf16 v[24:27], a[48:51], v[52:55], v[24:27]
    ds_read_b128 v[52:55], v4 offset:20736
    s_waitcnt lgkmcnt(6)
    v_mfma_f32_16x16x32_bf16 v[16:19], a[56:59], v[56:59], v[16:19]
    v_mfma_f32_16x16x32_bf16 v[20:23], a[60:63], v[56:59], v[20:23]
    ds_read_b128 v[56:59], v4 offset:22528
    v_mfma_f32_16x16x32_bf16 v[28:31], a[60:63], v[60:63], v[28:31]
    v_mfma_f32_16x16x32_bf16 v[24:27], a[56:59], v[60:63], v[24:27]
    ds_read_b128 v[60:63], v4 offset:22784
    s_waitcnt lgkmcnt(6)
    v_mfma_f32_16x16x32_bf16 v[16:19], a[64:67], v[32:35], v[16:19]
    v_mfma_f32_16x16x32_bf16 v[20:23], a[68:71], v[32:35], v[20:23]
    ds_read_b128 v[32:35], v4 offset:24576
    v_mfma_f32_16x16x32_bf16 v[28:31], a[68:71], v[36:39], v[28:31]
    v_mfma_f32_16x16x32_bf16 v[24:27], a[64:67], v[36:39], v[24:27]
    ds_read_b128 v[36:39], v4 offset:24832
    s_waitcnt lgkmcnt(6)
    v_mfma_f32_16x16x32_bf16 v[16:19], a[72:75], v[40:43], v[16:19]
    v_mfma_f32_16x16x32_bf16 v[20:23], a[76:79], v[40:43], v[20:23]
    ds_read_b128 v[40:43], v4 offset:26624
    v_mfma_f32_16x16x32_bf16 v[28:31], a[76:79], v[44:47], v[28:31]
    v_mfma_f32_16x16x32_bf16 v[24:27], a[72:75], v[44:47], v[24:27]
    ds_read_b128 v[44:47], v4 offset:26880
    s_waitcnt lgkmcnt(6)
    v_mfma_f32_16x16x32_bf16 v[16:19], a[80:83], v[48:51], v[16:19]
    v_mfma_f32_16x16x32_bf16 v[20:23], a[84:87], v[48:51], v[20:23]
    ds_read_b128 v[48:51], v4 offset:28672
    v_mfma_f32_16x16x32_bf16 v[28:31], a[84:87], v[52:55], v[28:31]
    v_mfma_f32_16x16x32_bf16 v[24:27], a[80:83], v[52:55], v[24:27]
    ds_read_b128 v[52:55], v4 offset:28928
    s_waitcnt lgkmcnt(6)
    v_mfma_f32_16x16x32_bf16 v[16:19], a[88:91], v[56:59], v[16:19]
    v_mfma_f32_16x16x32_bf16 v[20:23], a[92:95], v[56:59], v[20:23]
    ds_read_b128 v[56:59], v4 offset:30720
    v_mfma_f32_16x16x32_bf16 v[28:31], a[92:95], v[60:63], v[28:31]
    v_mfma_f32_16x16x32_bf16 v[24:27], a[88:91], v[60:63], v[24:27]
    ds_read_b128 v[60:63], v4 offset:30976
    s_waitcnt lgkmcnt(6)
    v_mfma_f32_16x16x32_bf16 v[16:19], a[96:99], v[32:35], v[16:19]
    v_mfma_f32_16x16x32_bf16 v[20:23], a[100:103], v[32:35], v[20:23]
    v_mfma_f32_16x16x32_bf16 v[28:31], a[100:103], v[36:39], v[28:31]
    v_mfma_f32_16x16x32_bf16 v[24:27], a[96:99], v[36:39], v[24:27]
    s_waitcnt lgkmcnt(4)
    v_mfma_f32_16x16x32_bf16 v[16:19], a[104:107], v[40:43], v[16:19]
    v_mfma_f32_16x16x32_bf16 v[20:23], a[108:111], v[40:43], v[20:23]
    v_mfma_f32_16x16x32_bf16 v[28:31], a[108:111], v[44:47], v[28:31]
    v_mfma_f32_16x16x32_bf16 v[24:27], a[104:107], v[44:47], v[24:27]
    s_waitcnt lgkmcnt(2)
    v_mfma_f32_16x16x32_bf16 v[16:19], a[112:115], v[48:51], v[16:19]
    v_mfma_f32_16x16x32_bf16 v[20:23], a[116:119], v[48:51], v[20:23]
    s_cmp_eq_u32 s81, 1
    s_cbranch_scc1 L_g_h2_69
L_g_h2_69_b:
    ds_write_b32 v119, v118
    v_mfma_f32_16x16x32_bf16 v[28:31], a[116:119], v[52:55], v[28:31]
    v_mfma_f32_16x16x32_bf16 v[24:27], a[112:115], v[52:55], v[24:27]
    s_waitcnt lgkmcnt(0)
    v_mfma_f32_16x16x32_bf16 v[16:19], a[120:123], v[56:59], v[16:19]
    v_mfma_f32_16x16x32_bf16 v[20:23], a[124:127], v[56:59], v[20:23]
    v_mfma_f32_16x16x32_bf16 v[28:31], a[124:127], v[60:63], v[28:31]
    v_mfma_f32_16x16x32_bf16 v[24:27], a[120:123], v[60:63], v[24:27]
    v_xor_b32 v4, 0x10000, v4
    s_setprio 0
    s_waitcnt vmcnt(0)
    s_waitcnt lgkmcnt(0)
    s_barrier
    ds_read_b32 v14, v15
    s_nop 6
    ds_write_b128 v5, v[16:19] offset:0
    ds_write_b128 v5, v[20:23] offset:1024
    ds_write_b128 v5, v[24:27] offset:2048
    ds_write_b128 v5, v[28:31] offset:3072
    s_waitcnt lgkmcnt(4)
    v_readfirstlane_b32 s66, v14
    s_add_u32 s60, s60, 1
    s_mov_b32 s65, 0
    s_cmp_le_u32 s62, s60
    s_cbranch_scc1 L_g_dp_70_l
L_g_dp_70_a:
    s_cmp_ge_u32 s62, s66
    s_cbranch_scc1 L_g_dp_70_d
    s_add_u32 s47, s61, 4096
    s_mov_b32 m0, s64
    s_add_u32 s62, s62, 1
    buffer_load_dwordx4 v3, s[12:15], s61 offen offset:0 sc1 lds
    buffer_load_dwordx4 v3, s[12:15], s61 offen offset:1024 sc1 lds
    buffer_load_dwordx4 v3, s[12:15], s61 offen offset:2048 sc1 lds
    buffer_load_dwordx4 v3, s[12:15], s61 offen offset:3072 sc1 lds
    s_add_u32 m0, s64, 4096
    s_add_u32 s61, s61, s85
    buffer_load_dwordx4 v3, s[12:15], s47 offen offset:0 sc1 lds
    buffer_load_dwordx4 v3, s[12:15], s47 offen offset:1024 sc1 lds
    buffer_load_dwordx4 v3, s[12:15], s47 offen offset:2048 sc1 lds
    buffer_load_dwordx4 v3, s[12:15], s47 offen offset:3072 sc1 lds
    s_xor_b32 s64, s64, 0x10000
L_g_dp_70_d:
    s_cmp_le_u32 s66, s60
    s_cbranch_scc1 L_g_ex0_67
    s_cmp_lg_u32 s65, 0
    s_cbranch_scc1 L_g_nw_66
    ds_read_b128 v[32:35], v4 offset:0
    ds_read_b128 v[36:39], v4 offset:256
    ds_read_b128 v[40:43], v4 offset:2048
    ds_read_b128 v[44:47], v4 offset:2304
    ds_read_b128 v[48:51], v4 offset:4096
    ds_read_b128 v[52:55], v4 offset:4352
    ds_read_b128 v[56:59], v4 offset:6144
    ds_read_b128 v[60:63], v4 offset:6400
    s_cmp_lg_u32 s44, 0
    s_cbranch_scc1 L_g_nl_71
    s_mov_b32 s46, s66
    s_cmp_lg_u32 s81, 0
    s_cbranch_scc1 L_g_nl_71_e
    v_cmp_ge_u32 vcc, v12, v11
    s_nop 0
    s_ff1_i32_b64 s46, vcc
    s_lshr_b32 s46, s46, 4
    s_min_u32 s46, s46, 4
    s_add_u32 s46, s46, s54
    s_min_u32 s46, s46, s75
    v_mov_b32 v118, s46
L_g_nl_71_e:
    s_add_u32 s47, s60, 3
    s_min_u32 s47, s47, s75
    s_cmp_lt_u32 s46, s47
    s_cselect_b32 s81, 1, 0
    s_cbranch_scc1 L_g_nl_71
    s_add_u32 s54, s60, 2
    s_mul_i32 s55, s54, s78
    v_add_u32 v12, s55, v113
    v_and_b32 v13, 7, v12
    v_lshl_add_u32 v13, v13, 9, v7
    buffer_load_dword v11, v13, s[12:15], 0 offen sc1
L_g_nl_71:
    s_waitcnt lgkmcnt(8)
    s_branch L_g_loop0_54
L_g_ex0_67:
    s_cmp_lg_u32 s44, 0
    s_cbranch_scc1 L_g_ex0_67_n
    ds_write_b32 v15, v118 offset:20
    s_cmp_ge_u32 s60, s75
    s_cbranch_scc1 L_g_ex0_67_n
    s_sleep 6
    s_add_u32 s54, s60, 0
    s_mul_i32 s55, s54, s78
    v_add_u32 v12, s55, v113
    v_and_b32 v13, 7, v12
    v_lshl_add_u32 v13, v13, 9, v7
    buffer_load_dword v11, v13, s[12:15], 0 offen sc1
    s_waitcnt vmcnt(0)
    v_cmp_ge_u32 vcc, v12, v11
    s_nop 0
    s_ff1_i32_b64 s46, vcc
    s_lshr_b32 s46, s46, 4
    s_min_u32 s46, s46, 4
    s_add_u32 s46, s46, s54
    s_min_u32 s46, s46, s75
    v_mov_b32 v118, s46
    ds_write_b32 v15, v118 offset:20
L_g_ex0_67_n:
    s_waitcnt lgkmcnt(0)
    s_barrier
    ds_read_b32 v14, v15 offset:20
    s_waitcnt lgkmcnt(0)
    v_readfirstlane_b32 s66, v14
    s_barrier
    s_cmp_gt_u32 s66, s60
    s_cbranch_scc1 L_g_restart_51_go
    s_branch L_g_tail_56
L_g_g1r_53:
    s_mov_b32 s65, 1
    s_branch L_g_loop1_55_e
.p2align 6
L_g_loop1_55:
    s_mov_b32 s65, 0
L_g_loop1_55_e:
    s_barrier
    s_bitcmp1_b32 s67, 1
    s_cbranch_scc0 L_g_nfl_72
    s_cmp_lg_u32 s44, 4
    s_cbranch_scc1 L_g_nfl_72_d
    s_mul_i32 s59, s60, s78
    s_add_u32 s59, s59, s87
    v_mov_b32 v10, s59
    buffer_store_dword v10, v115, s[12:15], s52 offen sc1
L_g_nfl_72_d:
    ds_read_b128 v[80:83], v5 offset:0
    ds_read_b128 v[84:87], v5 offset:1024
    ds_read_b128 v[88:91], v5 offset:2048
    ds_read_b128 v[92:95], v5 offset:3072
    s_cmp_le_u32 s62, s60
    s_cbranch_scc1 L_g_dp_77_l
L_g_dp_77_a:
    s_cmp_ge_u32 s62, s66
    s_cbranch_scc1 L_g_dp_77_d
    s_add_u32 s47, s61, 4096
    s_mov_b32 m0, s64
    s_add_u32 s62, s62, 1
    buffer_load_dwordx4 v3, s[12:15], s61 offen offset:0 sc1 lds
    buffer_load_dwordx4 v3, s[12:15], s61 offen offset:1024 sc1 lds
    buffer_load_dwordx4 v3, s[12:15], s61 offen offset:2048 sc1 lds
    buffer_load_dwordx4 v3, s[12:15], s61 offen offset:3072 sc1 lds
    s_add_u32 m0, s64, 4096
    s_add_u32 s61, s61, s85
    buffer_load_dwordx4 v3, s[12:15], s47 offen offset:0 sc1 lds
    buffer_load_dwordx4 v3, s[12:15], s47 offen offset:1024 sc1 lds
    buffer_load_dwordx4 v3, s[12:15], s47 offen offset:2048 sc1 lds
    buffer_load_dwordx4 v3, s[12:15], s47 offen offset:3072 sc1 lds
    s_xor_b32 s64, s64, 0x10000
L_g_dp_77_d:
    s_bitcmp1_b32 s67, 0
    s_cbranch_scc0 L_g_nep_73
    s_waitcnt lgkmcnt(0)
    v_add_f32 v80, v80, v16
    v_add_f32 v81, v81, v17
    v_add_f32 v82, v82, v18
    v_add_f32 v83, v83, v19
    v_add_f32 v84, v84, v20
    v_add_f32 v85, v85, v21
    v_add_f32 v86, v86, v22
    v_add_f32 v87, v87, v23
    v_add_f32 v88, v88, v24
    v_add_f32 v89, v89, v25
    v_add_f32 v90, v90, v26
    v_add_f32 v91, v91, v27
    v_add_f32 v92, v92, v28
    v_add_f32 v93, v93, v29
    v_add_f32 v94, v94, v30
    v_add_f32 v95, v95, v31
    v_cvt_pk_bf16_f32 v104, v80, v81
    v_cvt_pk_bf16_f32 v105, v82, v83
    v_cvt_pk_bf16_f32 v106, v84, v85
    v_cvt_pk_bf16_f32 v107, v86, v87
    buffer_store_dwordx4 v[104:107], v8, s[12:15], s63 offen sc1
    v_cvt_pk_bf16_f32 v108, v88, v89
    v_cvt_pk_bf16_f32 v109, v90, v91
    v_cvt_pk_bf16_f32 v110, v92, v93
    v_cvt_pk_bf16_f32 v111, v94, v95
    buffer_store_dwordx4 v[108:111], v9, s[12:15], s63 offen sc1
    s_add_u32 s63, s63, s86
    s_cmp_lg_u32 s53, 2
    s_cbranch_scc1 L_g_pf_78
    s_lshl_b32 s73, s58, 1
    buffer_store_dwordx4 v[120:123], v64, s[12:15], s58 offen sc1
    buffer_store_dwordx4 v[120:123], v65, s[12:15], s73 offen sc1
    buffer_store_dwordx4 v[120:123], v68, s[12:15], s73 offen sc1
    s_add_u32 s58, s58, 131072
L_g_pf_78:
    s_cmp_le_u32 s60, 2
    s_cbranch_scc1 L_g_nep_73_e
L_g_nep_73:
    s_cmp_lg_u32 s65, 0
    s_cbranch_scc1 L_g_nw1_74
    ds_read_b128 v[32:35], v4 offset:0
    ds_read_b128 v[36:39], v4 offset:256
    ds_read_b128 v[40:43], v4 offset:2048
    ds_read_b128 v[44:47], v4 offset:2304
    ds_read_b128 v[48:51], v4 offset:4096
    ds_read_b128 v[52:55], v4 offset:4352
    ds_read_b128 v[56:59], v4 offset:6144
    ds_read_b128 v[60:63], v4 offset:6400
    s_barrier
L_g_jn_76:
    s_setprio 1
    s_waitcnt lgkmcnt(6)
    v_mfma_f32_16x16x32_bf16 v[16:19], a[0:3], v[32:35], 0
    ds_read_b32 v14, v15
    v_mfma_f32_16x16x32_bf16 v[20:23], a[4:7], v[32:35], 0
    ds_read_b128 v[32:35], v4 offset:8192
    v_mfma_f32_16x16x32_bf16 v[28:31], a[4:7], v[36:39], 0
    v_mfma_f32_16x16x32_bf16 v[24:27], a[0:3], v[36:39], 0
    ds_read_b128 v[36:39], v4 offset:8448
    s_waitcnt lgkmcnt(6)
    v_mfma_f32_16x16x32_bf16 v[16:19], a[8:11], v[40:43], v[16:19]
    v_mfma_f32_16x16x32_bf16 v[20:23], a[12:15], v[40:43], v[20:23]
    ds_read_b128 v[40:43], v4 offset:10240
    v_mfma_f32_16x16x32_bf16 v[28:31], a[12:15], v[44:47], v[28:31]
    v_mfma_f32_16x16x32_bf16 v[24:27], a[8:11], v[44:47], v[24:27]
    ds_read_b128 v[44:47], v4 offset:10496
    s_waitcnt lgkmcnt(6)
    v_mfma_f32_16x16x32_bf16 v[16:19], a[16:19], v[48:51], v[16:19]
    v_mfma_f32_16x16x32_bf16 v[20:23], a[20:23], v[48:51], v[20:23]
    ds_read_b128 v[48:51], v4 offset:12288
    v_mfma_f32_16x16x32_bf16 v[28:31], a[20:23], v[52:55], v[28:31]
    v_mfma_f32_16x16x32_bf16 v[24:27], a[16:19], v[52:55], v[24:27]
    ds_read_b128 v[52:55], v4 offset:12544
    s_waitcnt lgkmcnt(6)
    v_mfma_f32_16x16x32_bf16 v[16:19], a[24:27], v[56:59], v[16:19]
    v_mfma_f32_16x16x32_bf16 v[20:23], a[28:31], v[56:59], v[20:23]
    ds_read_b128 v[56:59], v4 offset:14336
    v_mfma_f32_16x16x32_bf16 v[28:31], a[28:31], v[60:63], v[28:31]
    v_mfma_f32_16x16x32_bf16 v[24:27], a[24:27], v[60:63], v[24:27]
    ds_read_b128 v[60:63], v4 offset:14592
    s_waitcnt lgkmcnt(6)
    v_mfma_f32_16x16x32_bf16 v[16:19], a[32:35], v[32:35], v[16:19]
    v_mfma_f32_16x16x32_bf16 v[20:23], a[36:39], v[32:35], v[20:23]
    ds_read_b128 v[32:35], v4 offset:16384
    v_mfma_f32_16x16x32_bf16 v[28:31], a[36:39], v[36:39], v[28:31]
    v_mfma_f32_16x16x32_bf16 v[24:27], a[32:35], v[36:39], v[24:27]
    ds_read_b128 v[36:39], v4 offset:16640
    s_waitcnt lgkmcnt(6)
    v_mfma_f32_16x16x32_bf16 v[16:19], a[40:43], v[40:43], v[16:19]
    v_mfma_f32_16x16x32_bf16 v[20:23], a[44:47], v[40:43], v[20:23]
    ds_read_b128 v[40:43], v4 offset:18432
    v_mfma_f32_16x16x32_bf16 v[28:31], a[44:47], v[44:47], v[28:31]
    v_mfma_f32_16x16x32_bf16 v[24:27], a[40:43], v[44:47], v[24:27]
    ds_read_b128 v[44:47], v4 offset:18688
    s_waitcnt lgkmcnt(6)
    v_mfma_f32_16x16x32_bf16 v[16:19], a[48:51], v[48:51], v[16:19]
    v_mfma_f32_16x16x32_bf16 v[20:23], a[52:55], v[48:51], v[20:23]
    ds_read_b128 v[48:51], v4 offset:20480
    v_mfma_f32_16x16x32_bf16 v[28:31], a[52:55], v[52:55], v[28:31]
    v_mfma_f32_16x16x32_bf16 v[24:27], a[48:51], v[52:55], v[24:27]
    ds_read_b128 v[52:55], v4 offset:20736
    s_waitcnt lgkmcnt(6)
    v_mfma_f32_16x16x32_bf16 v[16:19], a[56:59], v[56:59], v[16:19]
    v_mfma_f32_16x16x32_bf16 v[20:23], a[60:63], v[56:59], v[20:23]
    ds_read_b128 v[56:59], v4 offset:22528
    v_mfma_f32_16x16x32_bf16 v[28:31], a[60:63], v[60:63], v[28:31]
    v_mfma_f32_16x16x32_bf16 v[24:27], a[56:59], v[60:63], v[24:27]
    ds_read_b128 v[60:63], v4 offset:22784
    s_waitcnt lgkmcnt(6)
    v_mfma_f32_16x16x32_bf16 v[16:19], a[64:67], v[32:35], v[16:19]
    v_mfma_f32_16x16x32_bf16 v[20:23], a[68:71], v[32:35], v[20:23]
    ds_read_b128 v[32:35], v4 offset:24576
    v_mfma_f32_16x16x32_bf16 v[28:31], a[68:71], v[36:39], v[28:31]
    v_mfma_f32_16x16x32_bf16 v[24:27], a[64:67], v[36:39], v[24:27]
    ds_read_b128 v[36:39], v4 offset:24832
    s_waitcnt lgkmcnt(6)
    v_mfma_f32_16x16x32_bf16 v[16:19], a[72:75], v[40:43], v[16:19]
    v_mfma_f32_16x16x32_bf16 v[20:23], a[76:79], v[40:43], v[20:23]
    ds_read_b128 v[40:43], v4 offset:26624
    v_mfma_f32_16x16x32_bf16 v[28:31], a[76:79], v[44:47], v[28:31]
    v_mfma_f32_16x16x32_bf16 v[24:27], a[72:75], v[44:47], v[24:27]
    ds_read_b128 v[44:47], v4 offset:26880
    s_waitcnt lgkmcnt(6)
    v_mfma_f32_16x16x32_bf16 v[16:19], a[80:83], v[48:51], v[16:19]
    v_mfma_f32_16x16x32_bf16 v[20:23], a[84:87], v[48:51], v[20:23]
    ds_read_b128 v[48:51], v4 offset:28672
    v_mfma_f32_16x16x32_bf16 v[28:31], a[84:87], v[52:55], v[28:31]
    v_mfma_f32_16x16x32_bf16 v[24:27], a[80:83], v[52:55], v[24:27]
    ds_read_b128 v[52:55], v4 offset:28928
    s_waitcnt lgkmcnt(6)
    v_mfma_f32_16x16x32_bf16 v[16:19], a[88:91], v[56:59], v[16:19]
    v_mfma_f32_16x16x32_bf16 v[20:23], a[92:95], v[56:59], v[20:23]
    ds_read_b128 v[56:59], v4 offset:30720
    v_mfma_f32_16x16x32_bf16 v[28:31], a[92:95], v[60:63], v[28:31]
    v_mfma_f32_16x16x32_bf16 v[24:27], a[88:91], v[60:63], v[24:27]
    ds_read_b128 v[60:63], v4 offset:30976
    s_waitcnt lgkmcnt(6)
    v_mfma_f32_16x16x32_bf16 v[16:19], a[96:99], v[32:35], v[16:19]
    v_mfma_f32_16x16x32_bf16 v[20:23], a[100:103], v[32:35], v[20:23]
    v_mfma_f32_16x16x32_bf16 v[28:31], a[100:103], v[36:39], v[28:31]
    v_mfma_f32_16x16x32_bf16 v[24:27], a[96:99], v[36:39], v[24:27]
    s_waitcnt lgkmcnt(4)
    v_mfma_f32_16x16x32_bf16 v[16:19], a[104:107], v[40:43], v[16:19]
    v_mfma_f32_16x16x32_bf16 v[20:23], a[108:111], v[40:43], v[20:23]
    v_mfma_f32_16x16x32_bf16 v[28:31], a[108:111], v[44:47], v[28:31]
    v_mfma_f32_16x16x32_bf16 v[24:27], a[104:107], v[44:47], v[24:27]
    s_waitcnt lgkmcnt(2)
    v_mfma_f32_16x16x32_bf16 v[16:19], a[112:115], v[48:51], v[16:19]
    v_mfma_f32_16x16x32_bf16 v[20:23], a[116:119], v[48:51], v[20:23]
    v_mfma_f32_16x16x32_bf16 v[28:31], a[116:119], v[52:55], v[28:31]
    v_mfma_f32_16x16x32_bf16 v[24:27], a[112:115], v[52:55], v[24:27]
    s_waitcnt lgkmcnt(0)
    v_mfma_f32_16x16x32_bf16 v[16:19], a[120:123], v[56:59], v[16:19]
    v_mfma_f32_16x16x32_bf16 v[20:23], a[124:127], v[56:59], v[20:23]
    v_mfma_f32_16x16x32_bf16 v[28:31], a[124:127], v[60:63], v[28:31]
    v_mfma_f32_16x16x32_bf16 v[24:27], a[120:123], v[60:63], v[24:27]
    v_xor_b32 v4, 0x10000, v4
    s_setprio 0
    s_waitcnt vmcnt(0)
    v_readfirstlane_b32 s66, v14
    s_lshl_b32 s67, s67, 1
    s_or_b32 s67, s67, 1
    s_add_u32 s60, s60, 1
    s_cmp_gt_u32 s66, s60
    s_cbranch_scc1 L_g_loop1_55
    s_barrier
    ds_read_b32 v14, v15 offset:20
    ds_read_b128 v[80:83], v5 offset:0
    ds_read_b128 v[84:87], v5 offset:1024
    ds_read_b128 v[88:91], v5 offset:2048
    ds_read_b128 v[92:95], v5 offset:3072
    s_waitcnt lgkmcnt(4)
    v_readfirstlane_b32 s66, v14
    s_barrier
    s_mov_b32 s69, 0
    s_cmp_gt_u32 s62, s60
    s_cbranch_scc1 L_g_nd_79
    s_cmp_ge_u32 s62, s66
    s_cbranch_scc1 L_g_nd_79
    s_add_u32 s47, s61, 4096
    s_add_u32 m0, s64, 0
    s_nop 0
    buffer_load_dwordx4 v3, s[12:15], s61 offen offset:0 sc1 lds
    buffer_load_dwordx4 v3, s[12:15], s61 offen offset:1024 sc1 lds
    buffer_load_dwordx4 v3, s[12:15], s61 offen offset:2048 sc1 lds
    buffer_load_dwordx4 v3, s[12:15], s61 offen offset:3072 sc1 lds
    s_add_u32 m0, s64, 4096
    s_nop 0
    buffer_load_dwordx4 v3, s[12:15], s47 offen offset:0 sc1 lds
    buffer_load_dwordx4 v3, s[12:15], s47 offen offset:1024 sc1 lds
    buffer_load_dwordx4 v3, s[12:15], s47 offen offset:2048 sc1 lds
    buffer_load_dwordx4 v3, s[12:15], s47 offen offset:3072 sc1 lds
    s_add_u32 s61, s61, s85
    s_add_u32 s62, s62, 1
    s_xor_b32 s64, s64, 0x10000
    s_mov_b32 s69, 1
L_g_nd_79:
    s_waitcnt lgkmcnt(3)
    v_add_f32 v80, v80, v16
    v_add_f32 v81, v81, v17
    v_add_f32 v82, v82, v18
    v_add_f32 v83, v83, v19
    s_waitcnt lgkmcnt(2)
    v_add_f32 v84, v84, v20
    v_add_f32 v85, v85, v21
    v_add_f32 v86, v86, v22
    v_add_f32 v87, v87, v23
    s_waitcnt lgkmcnt(1)
    v_add_f32 v88, v88, v24
    v_add_f32 v89, v89, v25
    v_add_f32 v90, v90, v26
    v_add_f32 v91, v91, v27
    s_waitcnt lgkmcnt(0)
    v_add_f32 v92, v92, v28
    v_add_f32 v93, v93, v29
    v_add_f32 v94, v94, v30
    v_add_f32 v95, v95, v31
    v_cvt_pk_bf16_f32 v104, v80, v81
    v_cvt_pk_bf16_f32 v105, v82, v83
    v_cvt_pk_bf16_f32 v106, v84, v85
    v_cvt_pk_bf16_f32 v107, v86, v87
    buffer_store_dwordx4 v[104:107], v8, s[12:15], s63 offen sc1
    v_cvt_pk_bf16_f32 v108, v88, v89
    v_cvt_pk_bf16_f32 v109, v90, v91
    v_cvt_pk_bf16_f32 v110, v92, v93
    v_cvt_pk_bf16_f32 v111, v94, v95
    buffer_store_dwordx4 v[108:111], v9, s[12:15], s63 offen sc1
    s_add_u32 s63, s63, s86
    s_cmp_lg_u32 s53, 2
    s_cbranch_scc1 L_g_pf_80
    s_lshl_b32 s73, s58, 1
    buffer_store_dwordx4 v[120:123], v64, s[12:15], s58 offen sc1
    buffer_store_dwordx4 v[120:123], v65, s[12:15], s73 offen sc1
    buffer_store_dwordx4 v[120:123], v68, s[12:15], s73 offen sc1
    s_add_u32 s58, s58, 131072
L_g_pf_80:
    s_mov_b32 s67, 0
    s_mov_b32 s71, 1
    s_cmp_gt_u32 s66, s60
    s_cbranch_scc1 L_g_g1r_53
    v_mov_b32 v10, 1
    s_mov_b64 exec, 1
    s_waitcnt vmcnt(0)
    ds_add_rtn_u32 v10, v15, v10 offset:4
    s_waitcnt lgkmcnt(0)
    v_readfirstlane_b32 s46, v10
    s_mov_b64 exec, -1
    s_mov_b32 s71, 0
    s_sub_u32 s59, s60, 1
    s_mul_i32 s59, s59, s78
    s_add_u32 s59, s59, s74
    s_cmp_lg_u32 s46, s68
    s_cbranch_scc1 L_g_df_81
    v_mov_b32 v10, s59
    v_add_u32 v10, 1, v10
    v_mov_b32 v11, 0
    s_mov_b64 exec, 1
    buffer_store_dword v10, v11, s[12:15], s52 offen sc1
    s_mov_b64 exec, -1
L_sf_82:
L_g_df_81:
    s_add_u32 s68, s68, 4
    s_cmp_gt_u32 s66, s60
    s_cbranch_scc1 L_g_g1r_53
L_g_tail_56:
    s_cmp_lt_u32 s60, s75
    s_cbranch_scc1 L_g_restart_51
    s_waitcnt vmcnt(0)
    s_barrier
    s_branch L_w_p2_11
L_g_h1_68:
    s_add_u32 s54, s60, 1
    s_mul_i32 s55, s54, s78
    v_add_u32 v12, s55, v113
    v_and_b32 v13, 7, v12
    v_lshl_add_u32 v13, v13, 9, v7
    buffer_load_dword v11, v13, s[12:15], 0 offen sc1
    s_branch L_g_h1_68_b
L_g_h2_69:
    s_waitcnt vmcnt(0)
    v_cmp_ge_u32 vcc, v12, v11
    s_nop 0
    s_ff1_i32_b64 s46, vcc
    s_lshr_b32 s46, s46, 4
    s_min_u32 s46, s46, 4
    s_add_u32 s46, s46, s54
    s_min_u32 s46, s46, s75
    v_mov_b32 v118, s46
    s_branch L_g_h2_69_b
L_g_dp_70_l:
    s_cmp_ge_u32 s62, s66
    s_cbranch_scc1 L_g_dp_70_d
    s_mov_b32 s65, 1
    s_add_u32 s47, s61, 4096
    s_mov_b32 m0, s64
    s_add_u32 s62, s62, 1
    buffer_load_dwordx4 v3, s[12:15], s61 offen offset:0 sc1 lds
    buffer_load_dwordx4 v3, s[12:15], s61 offen offset:1024 sc1 lds
    buffer_load_dwordx4 v3, s[12:15], s61 offen offset:2048 sc1 lds
    buffer_load_dwordx4 v3, s[12:15], s61 offen offset:3072 sc1 lds
    s_add_u32 m0, s64, 4096
    s_add_u32 s61, s61, s85
    buffer_load_dwordx4 v3, s[12:15], s47 offen offset:0 sc1 lds
    buffer_load_dwordx4 v3, s[12:15], s47 offen offset:1024 sc1 lds
    buffer_load_dwordx4 v3, s[12:15], s47 offen offset:2048 sc1 lds
    buffer_load_dwordx4 v3, s[12:15], s47 offen offset:3072 sc1 lds
    s_xor_b32 s64, s64, 0x10000
    s_branch L_g_dp_70_a
L_g_nw_66:
    s_waitcnt vmcnt(0) lgkmcnt(0)
    s_cmp_lg_u32 s44, 0
    s_cbranch_scc1 L_g_nl_83
    s_cmp_lt_u32 s66, s75
    s_cselect_b32 s81, 1, 2
L_g_nl_83:
    s_branch L_g_loop0_54_l
L_g_nfl_72:
    s_cmp_eq_u32 s71, 0
    s_cbranch_scc1 L_g_nfl_72_d
    v_mov_b32 v10, 1
    s_mov_b64 exec, 1
    s_waitcnt vmcnt(0)
    ds_add_rtn_u32 v10, v15, v10 offset:4
    s_waitcnt lgkmcnt(0)
    v_readfirstlane_b32 s46, v10
    s_mov_b64 exec, -1
    s_mov_b32 s71, 0
    s_sub_u32 s59, s60, 1
    s_mul_i32 s59, s59, s78
    s_add_u32 s59, s59, s74
    s_cmp_lg_u32 s46, s68
    s_cbranch_scc1 L_g_df_84
    v_mov_b32 v10, s59
    v_add_u32 v10, 1, v10
    v_mov_b32 v11, 0
    s_mov_b64 exec, 1
    buffer_store_dword v10, v11, s[12:15], s52 offen sc1
    s_mov_b64 exec, -1
L_sf_85:
L_g_df_84:
    s_add_u32 s68, s68, 4
    s_mov_b32 s65, 2
    s_branch L_g_nfl_72_d
L_g_dp_77_l:
    s_cmp_ge_u32 s62, s66
    s_cbranch_scc1 L_g_dp_77_d
    s_or_b32 s65, s65, 1
    s_add_u32 s47, s61, 4096
    s_mov_b32 m0, s64
    s_add_u32 s62, s62, 1
    buffer_load_dwordx4 v3, s[12:15], s61 offen offset:0 sc1 lds
    buffer_load_dwordx4 v3, s[12:15], s61 offen offset:1024 sc1 lds
    buffer_load_dwordx4 v3, s[12:15], s61 offen offset:2048 sc1 lds
    buffer_load_dwordx4 v3, s[12:15], s61 offen offset:3072 sc1 lds
    s_add_u32 m0, s64, 4096
    s_add_u32 s61, s61, s85
    buffer_load_dwordx4 v3, s[12:15], s47 offen offset:0 sc1 lds
    buffer_load_dwordx4 v3, s[12:15], s47 offen offset:1024 sc1 lds
    buffer_load_dwordx4 v3, s[12:15], s47 offen offset:2048 sc1 lds
    buffer_load_dwordx4 v3, s[12:15], s47 offen offset:3072 sc1 lds
    s_xor_b32 s64, s64, 0x10000
    s_branch L_g_dp_77_a
L_g_nep_73_e:
    v_mov_b32 v10, 1
    s_mov_b64 exec, 1
    s_waitcnt vmcnt(0)
    ds_add_rtn_u32 v10, v15, v10 offset:4
    s_waitcnt lgkmcnt(0)
    v_readfirstlane_b32 s46, v10
    s_mov_b64 exec, -1
    s_mov_b32 s71, 0
    s_sub_u32 s59, s60, 1
    s_mul_i32 s59, s59, s78
    s_add_u32 s59, s59, s74
    s_cmp_lg_u32 s46, s68
    s_cbranch_scc1 L_g_df_86
    v_mov_b32 v10, s59
    v_add_u32 v10, 1, v10
    v_mov_b32 v11, 0
    s_mov_b64 exec, 1
    buffer_store_dword v10, v11, s[12:15], s52 offen sc1
    s_mov_b64 exec, -1
L_sf_87:
L_g_df_86:
    s_add_u32 s68, s68, 4
    s_branch L_g_nep_73
L_g_nw1_74:
    s_cmp_eq_u32 s65, 2
    s_cbranch_scc1 L_g_nw1_74_w
    s_waitcnt vmcnt(0)
L_g_nw1_74_w:
    s_barrier
    ds_read_b128 v[32:35], v4 offset:0
    ds_read_b128 v[36:39], v4 offset:256
    ds_read_b128 v[40:43], v4 offset:2048
    ds_read_b128 v[44:47], v4 offset:2304
    ds_read_b128 v[48:51], v4 offset:4096
    ds_read_b128 v[52:55], v4 offset:4352
    ds_read_b128 v[56:59], v4 offset:6144
    ds_read_b128 v[60:63], v4 offset:6400
    s_branch L_g_jn_76
L_w_p2_11:
    s_cmp_lg_u32 s44, 0
    s_cbranch_scc1 L_w_p2_11_h
    s_mov_b32 s47, 63
    s_cmp_eq_u32 s53, 0
    s_cbranch_scc1 L_w_p2_11_q
    s_sub_u32 s52, s52, s76
    v_mov_b32 v10, 1
    v_mov_b32 v11, 131072
    s_mov_b64 exec, 1
    buffer_atomic_add v10, v11, s[12:15], s52 offen sc0
    s_waitcnt vmcnt(0)
    v_readfirstlane_b32 s46, v10
    s_mov_b64 exec, -1
    s_mov_b32 s47, 63
    s_nop 1
    s_cmp_eq_u32 s46, 0
    s_cbranch_scc1 L_w_p2_11_h
L_w_p2_11_q:
    v_mov_b32 v10, s47
    v_add_u32 v10, 1, v10
    v_mov_b32 v11, 0
    s_mov_b64 exec, 1
    buffer_store_dword v10, v11, s[12:15], s52 offen sc1
    s_mov_b64 exec, -1
L_sf_88:
L_w_p2_11_h:
    s_cmp_eq_u32 s76, 0
    s_cbranch_scc1 L_w_p2_11_m
    s_cmp_eq_u32 s79, 1
    s_cbranch_scc1 L_w_h_17
    s_mov_b32 s79, 1
    s_cmp_lt_u32 s77, 14
    s_cselect_b32 s53, 2, s53
    s_cselect_b32 s48, s48, 3
    s_branch L_w_h_17_n
L_w_p2_11_m:
    s_cmp_lt_u32 s48, 8
    s_cselect_b32 s75, 58, 58
    s_cmp_lt_u32 s48, 4
    s_cselect_b32 s75, 64, s75
L_w_p2_11_r:
    s_lshr_b32 s42, s40, 1
    s_and_b32 s43, s40, 1
    s_lshl_b32 s43, s43, 2
    s_and_b32 s46, s48, 3
    s_add_u32 s43, s43, s46
    s_cmp_lt_u32 s48, 4
    s_cbranch_scc1 L_w_wo_12
    s_cmp_lt_u32 s48, 8
    s_cbranch_scc1 L_w_f2_13
    s_cmp_lg_u32 s43, 7
    s_cbranch_scc1 L_w_f1_14
    s_mov_b32 s43, 2
    s_cmp_eq_u32 s76, 0
    s_cbranch_scc1 L_w_c_16
    s_mov_b32 s43, 7
    s_mov_b32 s78, 2
L_w_f1_14_t:
    s_cmp_lt_u32 s41, 8
    s_cselect_b32 s74, 58, 59
    s_cselect_b32 s75, 64, 64
    s_lshl_b32 s43, s43, 1
    s_add_u32 s43, s43, s74
    s_cmp_lt_u32 s43, s75
    s_cbranch_scc1 L_w_h_17_f
    s_branch L_c_done_1
L_w_f1_14_d:
    s_cmp_eq_u32 s76, 0
    s_cbranch_scc1 L_c_done_1
    s_and_b32 s42, s49, 3
    s_lshr_b32 s43, s49, 2
    s_mov_b32 s78, 64
    s_branch L_w_f1_14_t
L_replica:
    s_setprio 0
    s_barrier
    s_and_b32 s48, s41, 7
    s_add_u32 s48, s48, 4
    s_cmp_lt_u32 s41, 8
    s_cselect_b32 s74, 58, 59
    s_cselect_b32 s75, 64, 64
    s_cselect_b32 s76, 1, 2
    s_cselect_b32 s46, 58, 59
    s_cselect_b32 s47, 64, 64
    s_mov_b32 s78, 2
    s_mul_i32 s76, s76, 65536
    s_cmp_lt_u32 s48, 8
    s_cselect_b32 s74, s46, s74
    s_cselect_b32 s75, s47, s75
    s_branch L_w_p2_11_r
L_w_f1_14:
    s_load_dwordx2 s[4:5], s[0:1], 64
    s_load_dwordx2 s[6:7], s[0:1], 72
    s_and_b32 s50, s44, 3
    s_lshr_b32 s51, s44, 2
    s_waitcnt lgkmcnt(0)
    s_mov_b32 s24, s4
    s_and_b32 s25, s5, 0xffff
    s_mov_b32 s26, 0x700000
    s_mov_b32 s27, 0x00020000
    s_mul_i32 s49, s42, 7
    s_add_u32 s49, s49, s43
    v_lshrrev_b32 v3, 4, v1
    v_and_b32 v4, 15, v1
    v_lshlrev_b32 v5, 2, v3
    v_xor_b32 v4, v4, v5
    v_mul_u32_u24 v3, 7168, v3
    v_lshl_add_u32 v3, v4, 4, v3
    s_mul_i32 s46, s51, 512
    s_mul_i32 s47, s50, 16
    s_add_u32 s46, s46, s47
    s_mul_i32 s46, s46, 7168
    s_lshl_b32 s47, s49, 8
    s_add_u32 s46, s46, s47
    s_lshl_b32 s45, s51, 16
    s_mul_i32 s47, s50, 4096
    s_add_u32 s45, s45, s47
    v_bfe_u32 v4, v1, 2, 2
    v_bfe_u32 v5, v1, 4, 1
    v_lshlrev_b32 v5, 1, v5
    v_bfe_u32 v6, v1, 1, 1
    v_add_u32 v5, v5, v6
    s_lshl_b32 s47, s50, 2
    v_add_u32 v5, s47, v5
    v_lshlrev_b32 v6, 2, v4
    v_xor_b32 v5, v5, v6
    v_lshlrev_b32 v5, 4, v5
    v_lshl_add_u32 v5, v4, 8, v5
    v_bfe_u32 v6, v1, 0, 1
    v_lshl_add_u32 v5, v6, 3, v5
    v_lshrrev_b32 v6, 5, v1
    v_mul_u32_u24 v6, 2048, v6
    v_add_u32 v5, v5, v6
    s_lshl_b32 s47, s51, 16
    v_add_u32 v5, s47, v5
    s_add_u32 m0, s45, 0
    s_add_u32 s47, s46, 0x0
    buffer_load_dwordx4 v3, s[24:27], s47 offen  lds
    s_add_u32 m0, s45, 1024
    s_add_u32 s47, s46, 0x7000
    buffer_load_dwordx4 v3, s[24:27], s47 offen  lds
    s_add_u32 m0, s45, 2048
    s_add_u32 s47, s46, 0xe000
    buffer_load_dwordx4 v3, s[24:27], s47 offen  lds
    s_add_u32 m0, s45, 3072
    s_add_u32 s47, s46, 0x15000
    buffer_load_dwordx4 v3, s[24:27], s47 offen  lds
    s_add_u32 m0, s45, 16384
    s_add_u32 s47, s46, 0x70000
    buffer_load_dwordx4 v3, s[24:27], s47 offen  lds
    s_add_u32 m0, s45, 17408
    s_add_u32 s47, s46, 0x77000
    buffer_load_dwordx4 v3, s[24:27], s47 offen  lds
    s_add_u32 m0, s45, 18432
    s_add_u32 s47, s46, 0x7e000
    buffer_load_dwordx4 v3, s[24:27], s47 offen  lds
    s_add_u32 m0, s45, 19456
    s_add_u32 s47, s46, 0x85000
    buffer_load_dwordx4 v3, s[24:27], s47 offen  lds
    s_add_u32 m0, s45, 32768
    s_add_u32 s47, s46, 0xe0000
    buffer_load_dwordx4 v3, s[24:27], s47 offen  lds
    s_add_u32 m0, s45, 33792
    s_add_u32 s47, s46, 0xe7000
    buffer_load_dwordx4 v3, s[24:27], s47 offen  lds
    s_add_u32 m0, s45, 34816
    s_add_u32 s47, s46, 0xee000
    buffer_load_dwordx4 v3, s[24:27], s47 offen  lds
    s_add_u32 m0, s45, 35840
    s_add_u32 s47, s46, 0xf5000
    buffer_load_dwordx4 v3, s[24:27], s47 offen  lds
    s_add_u32 m0, s45, 49152
    s_add_u32 s47, s46, 0x150000
    buffer_load_dwordx4 v3, s[24:27], s47 offen  lds
    s_add_u32 m0, s45, 50176
    s_add_u32 s47, s46, 0x157000
    buffer_load_dwordx4 v3, s[24:27], s47 offen  lds
    s_add_u32 m0, s45, 51200
    s_add_u32 s47, s46, 0x15e000
    buffer_load_dwordx4 v3, s[24:27], s47 offen  lds
    s_add_u32 m0, s45, 52224
    s_add_u32 s47, s46, 0x165000
    buffer_load_dwordx4 v3, s[24:27], s47 offen  lds
    s_waitcnt vmcnt(12) lgkmcnt(0)
    s_barrier
    ds_read_b64_tr_b16 a[0:1], v5 offset:0
    ds_read_b64_tr_b16 a[2:3], v5 offset:1024
    ds_read_b64_tr_b16 a[4:5], v5 offset:4096
    ds_read_b64_tr_b16 a[6:7], v5 offset:5120
    ds_read_b64_tr_b16 a[8:9], v5 offset:8192
    ds_read_b64_tr_b16 a[10:11], v5 offset:9216
    ds_read_b64_tr_b16 a[12:13], v5 offset:12288
    ds_read_b64_tr_b16 a[14:15], v5 offset:13312
    s_waitcnt vmcnt(8) lgkmcnt(0)
    s_barrier
    s_add_u32 m0, s45, 0
    s_add_u32 s47, s46, 0x1c0000
    buffer_load_dwordx4 v3, s[24:27], s47 offen  lds
    s_add_u32 m0, s45, 1024
    s_add_u32 s47, s46, 0x1c7000
    buffer_load_dwordx4 v3, s[24:27], s47 offen  lds
    s_add_u32 m0, s45, 2048
    s_add_u32 s47, s46, 0x1ce000
    buffer_load_dwordx4 v3, s[24:27], s47 offen  lds
    s_add_u32 m0, s45, 3072
    s_add_u32 s47, s46, 0x1d5000
    buffer_load_dwordx4 v3, s[24:27], s47 offen  lds
    ds_read_b64_tr_b16 a[16:17], v5 offset:16384
    ds_read_b64_tr_b16 a[18:19], v5 offset:17408
    ds_read_b64_tr_b16 a[20:21], v5 offset:20480
    ds_read_b64_tr_b16 a[22:23], v5 offset:21504
    ds_read_b64_tr_b16 a[24:25], v5 offset:24576
    ds_read_b64_tr_b16 a[26:27], v5 offset:25600
    ds_read_b64_tr_b16 a[28:29], v5 offset:28672
    ds_read_b64_tr_b16 a[30:31], v5 offset:29696
    s_waitcnt vmcnt(8) lgkmcnt(0)
    s_barrier
    s_add_u32 m0, s45, 16384
    s_add_u32 s47, s46, 0x230000
    buffer_load_dwordx4 v3, s[24:27], s47 offen  lds
    s_add_u32 m0, s45, 17408
    s_add_u32 s47, s46, 0x237000
    buffer_load_dwordx4 v3, s[24:27], s47 offen  lds
    s_add_u32 m0, s45, 18432
    s_add_u32 s47, s46, 0x23e000
    buffer_load_dwordx4 v3, s[24:27], s47 offen  lds
    s_add_u32 m0, s45, 19456
    s_add_u32 s47, s46, 0x245000
    buffer_load_dwordx4 v3, s[24:27], s47 offen  lds
    ds_read_b64_tr_b16 a[32:33], v5 offset:32768
    ds_read_b64_tr_b16 a[34:35], v5 offset:33792
    ds_read_b64_tr_b16 a[36:37], v5 offset:36864
    ds_read_b64_tr_b16 a[38:39], v5 offset:37888
    ds_read_b64_tr_b16 a[40:41], v5 offset:40960
    ds_read_b64_tr_b16 a[42:43], v5 offset:41984
    ds_read_b64_tr_b16 a[44:45], v5 offset:45056
    ds_read_b64_tr_b16 a[46:47], v5 offset:46080
    s_waitcnt vmcnt(8) lgkmcnt(0)
    s_barrier
    s_add_u32 m0, s45, 32768
    s_add_u32 s47, s46, 0x2a0000
    buffer_load_dwordx4 v3, s[24:27], s47 offen  lds
    s_add_u32 m0, s45, 33792
    s_add_u32 s47, s46, 0x2a7000
    buffer_load_dwordx4 v3, s[24:27], s47 offen  lds
    s_add_u32 m0, s45, 34816
    s_add_u32 s47, s46, 0x2ae000
    buffer_load_dwordx4 v3, s[24:27], s47 offen  lds
    s_add_u32 m0, s45, 35840
    s_add_u32 s47, s46, 0x2b5000
    buffer_load_dwordx4 v3, s[24:27], s47 offen  lds
    ds_read_b64_tr_b16 a[48:49], v5 offset:49152
    ds_read_b64_tr_b16 a[50:51], v5 offset:50176
    ds_read_b64_tr_b16 a[52:53], v5 offset:53248
    ds_read_b64_tr_b16 a[54:55], v5 offset:54272
    ds_read_b64_tr_b16 a[56:57], v5 offset:57344
    ds_read_b64_tr_b16 a[58:59], v5 offset:58368
    ds_read_b64_tr_b16 a[60:61], v5 offset:61440
    ds_read_b64_tr_b16 a[62:63], v5 offset:62464
    s_waitcnt vmcnt(8) lgkmcnt(0)
    s_barrier
    s_add_u32 m0, s45, 49152
    s_add_u32 s47, s46, 0x310000
    buffer_load_dwordx4 v3, s[24:27], s47 offen  lds
    s_add_u32 m0, s45, 50176
    s_add_u32 s47, s46, 0x317000
    buffer_load_dwordx4 v3, s[24:27], s47 offen  lds
    s_add_u32 m0, s45, 51200
    s_add_u32 s47, s46, 0x31e000
    buffer_load_dwordx4 v3, s[24:27], s47 offen  lds
    s_add_u32 m0, s45, 52224
    s_add_u32 s47, s46, 0x325000
    buffer_load_dwordx4 v3, s[24:27], s47 offen  lds
    ds_read_b64_tr_b16 a[64:65], v5 offset:0
    ds_read_b64_tr_b16 a[66:67], v5 offset:1024
    ds_read_b64_tr_b16 a[68:69], v5 offset:4096
    ds_read_b64_tr_b16 a[70:71], v5 offset:5120
    ds_read_b64_tr_b16 a[72:73], v5 offset:8192
    ds_read_b64_tr_b16 a[74:75], v5 offset:9216
    ds_read_b64_tr_b16 a[76:77], v5 offset:12288
    ds_read_b64_tr_b16 a[78:79], v5 offset:13312
    s_waitcnt vmcnt(8) lgkmcnt(0)
    s_barrier
    ds_read_b64_tr_b16 a[80:81], v5 offset:16384
    ds_read_b64_tr_b16 a[82:83], v5 offset:17408
    ds_read_b64_tr_b16 a[84:85], v5 offset:20480
    ds_read_b64_tr_b16 a[86:87], v5 offset:21504
    ds_read_b64_tr_b16 a[88:89], v5 offset:24576
    ds_read_b64_tr_b16 a[90:91], v5 offset:25600
    ds_read_b64_tr_b16 a[92:93], v5 offset:28672
    ds_read_b64_tr_b16 a[94:95], v5 offset:29696
    s_waitcnt vmcnt(4) lgkmcnt(0)
    s_barrier
    ds_read_b64_tr_b16 a[96:97], v5 offset:32768
    ds_read_b64_tr_b16 a[98:99], v5 offset:33792
    ds_read_b64_tr_b16 a[100:101], v5 offset:36864
    ds_read_b64_tr_b16 a[102:103], v5 offset:37888
    ds_read_b64_tr_b16 a[104:105], v5 offset:40960
    ds_read_b64_tr_b16 a[106:107], v5 offset:41984
    ds_read_b64_tr_b16 a[108:109], v5 offset:45056
    ds_read_b64_tr_b16 a[110:111], v5 offset:46080
    s_waitcnt vmcnt(0) lgkmcnt(0)
    s_barrier
    ds_read_b64_tr_b16 a[112:113], v5 offset:49152
    ds_read_b64_tr_b16 a[114:115], v5 offset:50176
    ds_read_b64_tr_b16 a[116:117], v5 offset:53248
    ds_read_b64_tr_b16 a[118:119], v5 offset:54272
    ds_read_b64_tr_b16 a[120:121], v5 offset:57344
    ds_read_b64_tr_b16 a[122:123], v5 offset:58368
    ds_read_b64_tr_b16 a[124:125], v5 offset:61440
    ds_read_b64_tr_b16 a[126:127], v5 offset:62464
    s_waitcnt lgkmcnt(0)
    s_barrier
    v_lshlrev_b32 v2, 4, v1
    s_mul_i32 s64, s44, 8192
    s_add_u32 s46, s64, 0xc00000
    v_add_u32 v3, s46, v2
    s_mul_i32 s46, s51, 32768
    v_add_u32 v4, s46, v2
    v_and_b32 v6, 15, v1
    v_lshlrev_b32 v6, 4, v6
    v_lshrrev_b32 v7, 4, v1
    v_lshl_add_u32 v6, v7, 9, v6
    s_lshl_b32 s46, s50, 12
    s_add_u32 s46, s46, 131072
    v_add_u32 v5, s46, v2
    v_and_b32 v7, 3, v1
    v_lshlrev_b32 v7, 7, v7
    v_add_u32 v7, 0x10ec00, v7
    s_lshl_b32 s46, s49, 13
    s_lshl_b32 s47, s50, 11
    s_add_u32 s46, s46, s47
    s_add_u32 s46, s46, 0x6000000
    v_add_u32 v8, s46, v2
    s_lshl_b32 s52, s49, 7
    s_add_u32 s52, s52, 0x106400
    s_add_u32 s52, s52, s76
    s_mov_b32 s28, s6
    s_and_b32 s29, s7, 0xffff
    s_mov_b32 s30, 0x1c00
    s_mov_b32 s31, 0x00020000
    s_lshl_b32 s46, s49, 8
    s_lshl_b32 s47, s50, 6
    s_add_u32 s46, s46, s47
    v_lshrrev_b32 v9, 5, v1
    v_lshlrev_b32 v9, 3, v9
    buffer_load_dwordx2 v[32:33], v9, s[28:31], s46 offen offset:0
    buffer_load_dwordx2 v[34:35], v9, s[28:31], s46 offen offset:16
    buffer_load_dwordx2 v[36:37], v9, s[28:31], s46 offen offset:32
    buffer_load_dwordx2 v[38:39], v9, s[28:31], s46 offen offset:48
    v_add_u32 v9, 1024, v8
    s_mov_b32 s56, 0xbdd2d3e8
    s_mov_b32 s57, 0xbdd2d3e8
    v_mov_b32 v112, 0xc0135761
    s_waitcnt vmcnt(0)
    v_lshlrev_b32 v64, 16, v32
    v_and_b32 v65, 0xffff0000, v32
    v_lshlrev_b32 v66, 16, v33
    v_and_b32 v67, 0xffff0000, v33
    v_lshlrev_b32 v68, 16, v34
    v_and_b32 v69, 0xffff0000, v34
    v_lshlrev_b32 v70, 16, v35
    v_and_b32 v71, 0xffff0000, v35
    v_lshlrev_b32 v72, 16, v36
    v_and_b32 v73, 0xffff0000, v36
    v_lshlrev_b32 v74, 16, v37
    v_and_b32 v75, 0xffff0000, v37
    v_lshlrev_b32 v76, 16, v38
    v_and_b32 v77, 0xffff0000, v38
    v_lshlrev_b32 v78, 16, v39
    v_and_b32 v79, 0xffff0000, v39
    s_mul_i32 s46, s43, 8192
    s_add_u32 s46, s46, 0xc00000
    s_mul_i32 s47, s42, 0
    s_add_u32 s46, s46, s47
    v_min_u32 v116, 63, v1
    v_lshlrev_b32 v116, 7, v116
    v_add_u32 v116, s46, v116
    s_mov_b32 s60, 0
    s_mul_i32 s61, s74, 65536
    s_mov_b32 s62, 0
    s_mul_i32 s63, s74, 229376
    s_mul_i32 s85, s78, 65536
    s_mul_i32 s86, s78, 229376
    s_sub_u32 s46, s78, 1
    s_sub_u32 s75, s75, s74
    s_add_u32 s75, s75, s46
    s_lshr_b32 s75, s75, s46
    s_mov_b32 s67, 0
    s_mov_b32 s68, 3
    s_mov_b32 s71, 0
    v_mov_b32 v15, 147456
    v_mov_b32 v14, 0
    ds_write_b32 v15, v14 offset:4
    ds_write_b32 v15, v14 offset:12
    ds_write_b32 v15, v14 offset:16
    v_mov_b32 v114, 1
    v_mov_b32 v115, 0
    s_mov_b32 s81, 0
    s_mul_i32 s87, s78, 3
    s_sub_u32 s87, s74, s87
    s_add_u32 s87, s87, 1
    s_lshl_b32 s46, s44, 5
    v_add_u32 v119, s46, v15
    v_lshrrev_b32 v113, 4, v1
    v_mul_u32_u24 v113, s78, v113
    v_add_u32 v113, s74, v113
    s_mov_b32 s72, 0
L_g_restart_89:
    s_cmp_lg_u32 s44, 0
    s_cbranch_scc1 L_g_nsp_90
    s_mov_b32 s70, 0
L_g_sp_96:
    s_add_u32 s54, s60, 0
    s_mul_i32 s55, s54, s78
    v_add_u32 v12, s55, v113
    v_mul_u32_u24 v13, 171, v12
    v_lshrrev_b32 v13, 9, v13
    v_mad_i32_i24 v13, v13, -3, v12
    v_lshl_add_u32 v13, v13, 9, v7
    buffer_load_dword v11, v13, s[12:15], 0 offen sc1
    s_waitcnt vmcnt(0)
    v_cmp_ge_u32 vcc, v12, v11
    s_add_u32 s70, s70, 1
    s_and_b32 s46, vcc_lo, 0xffff
    s_cbranch_scc0 L_g_sp_96_ok
    s_sleep 3
    s_cmp_lt_u32 s70, 524288
    s_cbranch_scc1 L_g_sp_96
    s_branch L_c_done_1
L_g_sp_96_ok:
    v_cmp_ge_u32 vcc, v12, v11
    s_nop 0
    s_ff1_i32_b64 s46, vcc
    s_lshr_b32 s46, s46, 4
    s_min_u32 s46, s46, 4
    s_add_u32 s46, s46, s54
    s_min_u32 s46, s46, s75
    v_mov_b32 v118, s46
    ds_write_b32 v15, v118 offset:20
L_g_nsp_90:
    s_waitcnt lgkmcnt(0)
    s_barrier
    ds_read_b32 v14, v15 offset:20
    s_waitcnt lgkmcnt(0)
    v_readfirstlane_b32 s66, v14
    s_nop 3
L_g_restart_89_go:
    s_mov_b32 s69, 0
    s_cmp_gt_u32 s62, s60
    s_cbranch_scc1 L_g_nd_97
    s_cmp_ge_u32 s62, s66
    s_cbranch_scc1 L_g_nd_97
    s_add_u32 s47, s61, 4096
    s_add_u32 m0, s64, 0
    s_nop 0
    buffer_load_dwordx4 v3, s[12:15], s61 offen offset:0 sc1 lds
    buffer_load_dwordx4 v3, s[12:15], s61 offen offset:1024 sc1 lds
    buffer_load_dwordx4 v3, s[12:15], s61 offen offset:2048 sc1 lds
    buffer_load_dwordx4 v3, s[12:15], s61 offen offset:3072 sc1 lds
    s_add_u32 m0, s64, 4096
    s_nop 0
    buffer_load_dwordx4 v3, s[12:15], s47 offen offset:0 sc1 lds
    buffer_load_dwordx4 v3, s[12:15], s47 offen offset:1024 sc1 lds
    buffer_load_dwordx4 v3, s[12:15], s47 offen offset:2048 sc1 lds
    buffer_load_dwordx4 v3, s[12:15], s47 offen offset:3072 sc1 lds
    s_add_u32 s61, s61, s85
    s_add_u32 s62, s62, 1
    s_xor_b32 s64, s64, 0x10000
    s_mov_b32 s69, 1
L_g_nd_97:
    s_cmp_eq_u32 s51, 1
    s_cbranch_scc1 L_g_g1r_91
    s_add_u32 s59, s60, 1
    s_mov_b32 s69, 0
    s_cmp_gt_u32 s62, s59
    s_cbranch_scc1 L_g_nd_98
    s_cmp_ge_u32 s62, s66
    s_cbranch_scc1 L_g_nd_98
    s_add_u32 s47, s61, 4096
    s_add_u32 m0, s64, 0
    s_nop 0
    buffer_load_dwordx4 v3, s[12:15], s61 offen offset:0 sc1 lds
    buffer_load_dwordx4 v3, s[12:15], s61 offen offset:1024 sc1 lds
    buffer_load_dwordx4 v3, s[12:15], s61 offen offset:2048 sc1 lds
    buffer_load_dwordx4 v3, s[12:15], s61 offen offset:3072 sc1 lds
    s_add_u32 m0, s64, 4096
    s_nop 0
    buffer_load_dwordx4 v3, s[12:15], s47 offen offset:0 sc1 lds
    buffer_load_dwordx4 v3, s[12:15], s47 offen offset:1024 sc1 lds
    buffer_load_dwordx4 v3, s[12:15], s47 offen offset:2048 sc1 lds
    buffer_load_dwordx4 v3, s[12:15], s47 offen offset:3072 sc1 lds
    s_add_u32 s61, s61, s85
    s_add_u32 s62, s62, 1
    s_xor_b32 s64, s64, 0x10000
    s_mov_b32 s69, 1
L_g_nd_98:
    s_cmp_eq_u32 s69, 1
    s_cbranch_scc1 L_g_w0_99
    s_waitcnt vmcnt(0)
L_g_w0_99:
    s_waitcnt vmcnt(8)
    s_cmp_lg_u32 s44, 0
    s_cbranch_scc1 L_g_nl_100
    s_cmp_lt_u32 s66, s75
    s_cselect_b32 s81, 1, 2
L_g_nl_100:
L_g_loop0_92_l:
    s_barrier
    ds_read_b128 v[32:35], v4 offset:0
    ds_read_b128 v[36:39], v4 offset:1024
    ds_read_b128 v[40:43], v4 offset:2048
    ds_read_b128 v[44:47], v4 offset:3072
    ds_read_b128 v[48:51], v4 offset:4096
    ds_read_b128 v[52:55], v4 offset:5120
    ds_read_b128 v[56:59], v4 offset:6144
    ds_read_b128 v[60:63], v4 offset:7168
    s_branch L_g_loop0_92_m
.p2align 6
L_g_loop0_92:
    s_barrier
L_g_loop0_92_m:
    s_setprio 2
    s_waitcnt lgkmcnt(6)
    v_mfma_f32_32x32x16_bf16 v[16:31], a[0:3], v[32:35], v[64:79]
    ds_read_b128 v[32:35], v4 offset:8192
    v_mfma_f32_32x32x16_bf16 v[16:31], a[4:7], v[36:39], v[16:31]
    ds_read_b128 v[36:39], v4 offset:9216
    s_cmp_eq_u32 s81, 1
    s_cbranch_scc1 L_g_h1_104
L_g_h1_104_b:
    s_waitcnt lgkmcnt(6)
    v_mfma_f32_32x32x16_bf16 v[16:31], a[8:11], v[40:43], v[16:31]
    ds_read_b128 v[40:43], v4 offset:10240
    v_mfma_f32_32x32x16_bf16 v[16:31], a[12:15], v[44:47], v[16:31]
    ds_read_b128 v[44:47], v4 offset:11264
    s_waitcnt lgkmcnt(6)
    v_mfma_f32_32x32x16_bf16 v[16:31], a[16:19], v[48:51], v[16:31]
    ds_read_b128 v[48:51], v4 offset:12288
    v_mfma_f32_32x32x16_bf16 v[16:31], a[20:23], v[52:55], v[16:31]
    ds_read_b128 v[52:55], v4 offset:13312
    s_waitcnt lgkmcnt(6)
    v_mfma_f32_32x32x16_bf16 v[16:31], a[24:27], v[56:59], v[16:31]
    ds_read_b128 v[56:59], v4 offset:14336
    v_mfma_f32_32x32x16_bf16 v[16:31], a[28:31], v[60:63], v[16:31]
    ds_read_b128 v[60:63], v4 offset:15360
    s_waitcnt lgkmcnt(6)
    v_mfma_f32_32x32x16_bf16 v[16:31], a[32:35], v[32:35], v[16:31]
    ds_read_b128 v[32:35], v4 offset:16384
    v_mfma_f32_32x32x16_bf16 v[16:31], a[36:39], v[36:39], v[16:31]
    ds_read_b128 v[36:39], v4 offset:17408
    s_waitcnt lgkmcnt(6)
    v_mfma_f32_32x32x16_bf16 v[16:31], a[40:43], v[40:43], v[16:31]
    ds_read_b128 v[40:43], v4 offset:18432
    v_mfma_f32_32x32x16_bf16 v[16:31], a[44:47], v[44:47], v[16:31]
    ds_read_b128 v[44:47], v4 offset:19456
    s_waitcnt lgkmcnt(6)
    v_mfma_f32_32x32x16_bf16 v[16:31], a[48:51], v[48:51], v[16:31]
    ds_read_b128 v[48:51], v4 offset:20480
    v_mfma_f32_32x32x16_bf16 v[16:31], a[52:55], v[52:55], v[16:31]
    ds_read_b128 v[52:55], v4 offset:21504
    s_waitcnt lgkmcnt(6)
    v_mfma_f32_32x32x16_bf16 v[16:31], a[56:59], v[56:59], v[16:31]
    ds_read_b128 v[56:59], v4 offset:22528
    v_mfma_f32_32x32x16_bf16 v[16:31], a[60:63], v[60:63], v[16:31]
    ds_read_b128 v[60:63], v4 offset:23552
    s_waitcnt lgkmcnt(6)
    v_mfma_f32_32x32x16_bf16 v[16:31], a[64:67], v[32:35], v[16:31]
    ds_read_b128 v[32:35], v4 offset:24576
    v_mfma_f32_32x32x16_bf16 v[16:31], a[68:71], v[36:39], v[16:31]
    ds_read_b128 v[36:39], v4 offset:25600
    s_waitcnt lgkmcnt(6)
    v_mfma_f32_32x32x16_bf16 v[16:31], a[72:75], v[40:43], v[16:31]
    ds_read_b128 v[40:43], v4 offset:26624
    v_mfma_f32_32x32x16_bf16 v[16:31], a[76:79], v[44:47], v[16:31]
    ds_read_b128 v[44:47], v4 offset:27648
    s_waitcnt lgkmcnt(6)
    v_mfma_f32_32x32x16_bf16 v[16:31], a[80:83], v[48:51], v[16:31]
    ds_read_b128 v[48:51], v4 offset:28672
    v_mfma_f32_32x32x16_bf16 v[16:31], a[84:87], v[52:55], v[16:31]
    ds_read_b128 v[52:55], v4 offset:29696
    s_waitcnt lgkmcnt(6)
    v_mfma_f32_32x32x16_bf16 v[16:31], a[88:91], v[56:59], v[16:31]
    ds_read_b128 v[56:59], v4 offset:30720
    v_mfma_f32_32x32x16_bf16 v[16:31], a[92:95], v[60:63], v[16:31]
    ds_read_b128 v[60:63], v4 offset:31744
    s_waitcnt lgkmcnt(6)
    v_mfma_f32_32x32x16_bf16 v[16:31], a[96:99], v[32:35], v[16:31]
    v_mfma_f32_32x32x16_bf16 v[16:31], a[100:103], v[36:39], v[16:31]
    s_waitcnt lgkmcnt(4)
    v_mfma_f32_32x32x16_bf16 v[16:31], a[104:107], v[40:43], v[16:31]
    v_mfma_f32_32x32x16_bf16 v[16:31], a[108:111], v[44:47], v[16:31]
    s_waitcnt lgkmcnt(2)
    v_mfma_f32_32x32x16_bf16 v[16:31], a[112:115], v[48:51], v[16:31]
    s_cmp_eq_u32 s81, 1
    s_cbranch_scc1 L_g_h2_105
L_g_h2_105_b:
    ds_write_b32 v119, v118
    v_mfma_f32_32x32x16_bf16 v[16:31], a[116:119], v[52:55], v[16:31]
    s_waitcnt lgkmcnt(0)
    v_mfma_f32_32x32x16_bf16 v[16:31], a[120:123], v[56:59], v[16:31]
    v_mfma_f32_32x32x16_bf16 v[16:31], a[124:127], v[60:63], v[16:31]
    v_xor_b32 v4, 0x10000, v4
    s_setprio 0
    s_waitcnt vmcnt(0)
    s_waitcnt lgkmcnt(0)
    s_barrier
    ds_read_b32 v14, v15
    s_nop 6
    ds_write_b128 v5, v[16:19] offset:0
    ds_write_b128 v5, v[20:23] offset:1024
    ds_write_b128 v5, v[24:27] offset:2048
    ds_write_b128 v5, v[28:31] offset:3072
    s_waitcnt lgkmcnt(4)
    v_readfirstlane_b32 s66, v14
    s_add_u32 s60, s60, 1
    s_mov_b32 s65, 0
    s_cmp_le_u32 s62, s60
    s_cbranch_scc1 L_g_dp_106_l
L_g_dp_106_a:
    s_cmp_ge_u32 s62, s66
    s_cbranch_scc1 L_g_dp_106_d
    s_add_u32 s47, s61, 4096
    s_mov_b32 m0, s64
    s_add_u32 s62, s62, 1
    buffer_load_dwordx4 v3, s[12:15], s61 offen offset:0 sc1 lds
    buffer_load_dwordx4 v3, s[12:15], s61 offen offset:1024 sc1 lds
    buffer_load_dwordx4 v3, s[12:15], s61 offen offset:2048 sc1 lds
    buffer_load_dwordx4 v3, s[12:15], s61 offen offset:3072 sc1 lds
    s_add_u32 m0, s64, 4096
    s_add_u32 s61, s61, s85
    buffer_load_dwordx4 v3, s[12:15], s47 offen offset:0 sc1 lds
    buffer_load_dwordx4 v3, s[12:15], s47 offen offset:1024 sc1 lds
    buffer_load_dwordx4 v3, s[12:15], s47 offen offset:2048 sc1 lds
    buffer_load_dwordx4 v3, s[12:15], s47 offen offset:3072 sc1 lds
    s_xor_b32 s64, s64, 0x10000
L_g_dp_106_d:
    s_cmp_lg_u32 s44, 2
    s_cbranch_scc1 L_g_pf_107
    s_cmp_ge_u32 s62, s66
    s_cbranch_scc1 L_g_pf_107
    buffer_load_dword v117, v116, s[12:15], s61 offen sc1
L_g_pf_107:
    s_cmp_le_u32 s66, s60
    s_cbranch_scc1 L_g_ex0_103
    s_cmp_lg_u32 s65, 0
    s_cbranch_scc1 L_g_nw_102
    ds_read_b128 v[32:35], v4 offset:0
    ds_read_b128 v[36:39], v4 offset:1024
    ds_read_b128 v[40:43], v4 offset:2048
    ds_read_b128 v[44:47], v4 offset:3072
    ds_read_b128 v[48:51], v4 offset:4096
    ds_read_b128 v[52:55], v4 offset:5120
    ds_read_b128 v[56:59], v4 offset:6144
    ds_read_b128 v[60:63], v4 offset:7168
    s_cmp_lg_u32 s44, 0
    s_cbranch_scc1 L_g_nl_108
    s_mov_b32 s46, s66
    s_cmp_lg_u32 s81, 0
    s_cbranch_scc1 L_g_nl_108_e
    v_cmp_ge_u32 vcc, v12, v11
    s_nop 0
    s_ff1_i32_b64 s46, vcc
    s_lshr_b32 s46, s46, 4
    s_min_u32 s46, s46, 4
    s_add_u32 s46, s46, s54
    s_min_u32 s46, s46, s75
    v_mov_b32 v118, s46
L_g_nl_108_e:
    s_add_u32 s47, s60, 3
    s_min_u32 s47, s47, s75
    s_cmp_lt_u32 s46, s47
    s_cselect_b32 s81, 1, 0
    s_cbranch_scc1 L_g_nl_108
    s_add_u32 s54, s60, 2
    s_mul_i32 s55, s54, s78
    v_add_u32 v12, s55, v113
    v_mul_u32_u24 v13, 171, v12
    v_lshrrev_b32 v13, 9, v13
    v_mad_i32_i24 v13, v13, -3, v12
    v_lshl_add_u32 v13, v13, 9, v7
    buffer_load_dword v11, v13, s[12:15], 0 offen sc1
L_g_nl_108:
    s_waitcnt lgkmcnt(8)
    s_branch L_g_loop0_92
L_g_ex0_103:
    s_cmp_lg_u32 s44, 0
    s_cbranch_scc1 L_g_ex0_103_n
    ds_write_b32 v15, v118 offset:20
    s_cmp_ge_u32 s60, s75
    s_cbranch_scc1 L_g_ex0_103_n
    s_sleep 6
    s_add_u32 s54, s60, 0
    s_mul_i32 s55, s54, s78
    v_add_u32 v12, s55, v113
    v_mul_u32_u24 v13, 171, v12
    v_lshrrev_b32 v13, 9, v13
    v_mad_i32_i24 v13, v13, -3, v12
    v_lshl_add_u32 v13, v13, 9, v7
    buffer_load_dword v11, v13, s[12:15], 0 offen sc1
    s_waitcnt vmcnt(0)
    v_cmp_ge_u32 vcc, v12, v11
    s_nop 0
    s_ff1_i32_b64 s46, vcc
    s_lshr_b32 s46, s46, 4
    s_min_u32 s46, s46, 4
    s_add_u32 s46, s46, s54
    s_min_u32 s46, s46, s75
    v_mov_b32 v118, s46
    ds_write_b32 v15, v118 offset:20
L_g_ex0_103_n:
    s_waitcnt lgkmcnt(0)
    s_barrier
    ds_read_b32 v14, v15 offset:20
    s_waitcnt lgkmcnt(0)
    v_readfirstlane_b32 s66, v14
    s_barrier
    s_cmp_gt_u32 s66, s60
    s_cbranch_scc1 L_g_restart_89_go
    s_branch L_g_tail_94
L_g_g1r_91:
    s_mov_b32 s65, 1
    s_branch L_g_loop1_93_e
.p2align 6
L_g_loop1_93:
    s_mov_b32 s65, 0
L_g_loop1_93_e:
    s_barrier
    s_bitcmp1_b32 s67, 2
    s_cbranch_scc0 L_g_nfl_109
    s_cmp_lg_u32 s44, 4
    s_cbranch_scc1 L_g_nfl_109_d
    s_mul_i32 s59, s60, s78
    s_add_u32 s59, s59, s87
    v_mov_b32 v10, s59
    buffer_store_dword v10, v115, s[12:15], s52 offen sc1
L_g_nfl_109_d:
    ds_read_b128 v[80:83], v5 offset:0
    ds_read_b128 v[84:87], v5 offset:1024
    ds_read_b128 v[88:91], v5 offset:2048
    ds_read_b128 v[92:95], v5 offset:3072
    s_cmp_le_u32 s62, s60
    s_cbranch_scc1 L_g_dp_114_l
L_g_dp_114_a:
    s_cmp_ge_u32 s62, s66
    s_cbranch_scc1 L_g_dp_114_d
    s_add_u32 s47, s61, 4096
    s_mov_b32 m0, s64
    s_add_u32 s62, s62, 1
    buffer_load_dwordx4 v3, s[12:15], s61 offen offset:0 sc1 lds
    buffer_load_dwordx4 v3, s[12:15], s61 offen offset:1024 sc1 lds
    buffer_load_dwordx4 v3, s[12:15], s61 offen offset:2048 sc1 lds
    buffer_load_dwordx4 v3, s[12:15], s61 offen offset:3072 sc1 lds
    s_add_u32 m0, s64, 4096
    s_add_u32 s61, s61, s85
    buffer_load_dwordx4 v3, s[12:15], s47 offen offset:0 sc1 lds
    buffer_load_dwordx4 v3, s[12:15], s47 offen offset:1024 sc1 lds
    buffer_load_dwordx4 v3, s[12:15], s47 offen offset:2048 sc1 lds
    buffer_load_dwordx4 v3, s[12:15], s47 offen offset:3072 sc1 lds
    s_xor_b32 s64, s64, 0x10000
L_g_dp_114_d:
    s_bitcmp1_b32 s67, 0
    s_cbranch_scc0 L_g_nep_110
    s_waitcnt lgkmcnt(0)
    v_add_f32 v80, v80, v16
    v_add_f32 v81, v81, v17
    v_add_f32 v82, v82, v18
    v_add_f32 v83, v83, v19
    v_add_f32 v84, v84, v20
    v_add_f32 v85, v85, v21
    v_add_f32 v86, v86, v22
    v_add_f32 v87, v87, v23
    v_add_f32 v88, v88, v24
    v_add_f32 v89, v89, v25
    v_add_f32 v90, v90, v26
    v_add_f32 v91, v91, v27
    v_add_f32 v92, v92, v28
    v_add_f32 v93, v93, v29
    v_add_f32 v94, v94, v30
    v_add_f32 v95, v95, v31
L_g_nep_110:
    v_mul_f32 v96, v80, v80
    v_mul_f32 v97, v81, v81
    v_mul_f32 v98, v82, v82
    v_mul_f32 v99, v83, v83
    v_mul_f32 v100, v84, v84
    v_mul_f32 v101, v85, v85
    v_mul_f32 v102, v86, v86
    v_mul_f32 v103, v87, v87
    v_fma_f32 v96, v96, s56, v112
    v_fma_f32 v97, v97, s56, v112
    v_fma_f32 v98, v98, s56, v112
    v_fma_f32 v99, v99, s56, v112
    v_fma_f32 v100, v100, s56, v112
    v_fma_f32 v101, v101, s56, v112
    v_fma_f32 v102, v102, s56, v112
    v_fma_f32 v103, v103, s56, v112
    v_mul_f32 v96, v96, v80
    v_mul_f32 v97, v97, v81
    v_mul_f32 v98, v98, v82
    v_mul_f32 v99, v99, v83
    v_mul_f32 v100, v100, v84
    v_mul_f32 v101, v101, v85
    v_mul_f32 v102, v102, v86
    v_mul_f32 v103, v103, v87
    v_exp_f32 v96, v96
    v_exp_f32 v97, v97
    v_exp_f32 v98, v98
    v_exp_f32 v99, v99
    v_exp_f32 v100, v100
    v_exp_f32 v101, v101
    v_exp_f32 v102, v102
    v_exp_f32 v103, v103
    v_add_f32 v96, 1.0, v96
    v_add_f32 v97, 1.0, v97
    v_add_f32 v98, 1.0, v98
    v_add_f32 v99, 1.0, v99
    v_add_f32 v100, 1.0, v100
    v_add_f32 v101, 1.0, v101
    v_add_f32 v102, 1.0, v102
    v_add_f32 v103, 1.0, v103
    v_rcp_f32 v96, v96
    v_rcp_f32 v97, v97
    v_rcp_f32 v98, v98
    v_rcp_f32 v99, v99
    v_rcp_f32 v100, v100
    v_rcp_f32 v101, v101
    v_rcp_f32 v102, v102
    v_rcp_f32 v103, v103
    v_mul_f32 v80, v80, v96
    v_mul_f32 v81, v81, v97
    s_cmp_lg_u32 s65, 0
    s_cbranch_scc1 L_g_nw1_111
    ds_read_b128 v[32:35], v4 offset:0
    ds_read_b128 v[36:39], v4 offset:1024
    ds_read_b128 v[40:43], v4 offset:2048
    ds_read_b128 v[44:47], v4 offset:3072
    ds_read_b128 v[48:51], v4 offset:4096
    ds_read_b128 v[52:55], v4 offset:5120
    ds_read_b128 v[56:59], v4 offset:6144
    ds_read_b128 v[60:63], v4 offset:7168
    s_barrier
L_g_jn_113:
    s_bitcmp1_b32 s67, 0
    s_cbranch_scc0 L_g_mm2_112
    s_setprio 1
    s_waitcnt lgkmcnt(6)
    v_mfma_f32_32x32x16_bf16 v[16:31], a[0:3], v[32:35], 0
    ds_read_b128 v[32:35], v4 offset:8192
    ds_read_b32 v14, v15
    v_mul_f32 v82, v82, v98
    v_mul_f32 v83, v83, v99
    v_mul_f32 v84, v84, v100
    v_mfma_f32_32x32x16_bf16 v[16:31], a[4:7], v[36:39], v[16:31]
    ds_read_b128 v[36:39], v4 offset:9216
    v_mul_f32 v85, v85, v101
    v_mul_f32 v86, v86, v102
    v_mul_f32 v87, v87, v103
    v_cvt_pk_bf16_f32 v104, v80, v81
    s_waitcnt lgkmcnt(6)
    v_mfma_f32_32x32x16_bf16 v[16:31], a[8:11], v[40:43], v[16:31]
    ds_read_b128 v[40:43], v4 offset:10240
    v_cvt_pk_bf16_f32 v105, v82, v83
    v_cvt_pk_bf16_f32 v106, v84, v85
    v_cvt_pk_bf16_f32 v107, v86, v87
    buffer_store_dwordx4 v[104:107], v8, s[12:15], s63 offen sc1
    v_mfma_f32_32x32x16_bf16 v[16:31], a[12:15], v[44:47], v[16:31]
    ds_read_b128 v[44:47], v4 offset:11264
    v_mul_f32 v96, v88, v88
    v_mul_f32 v97, v89, v89
    v_mul_f32 v98, v90, v90
    v_mul_f32 v99, v91, v91
    s_waitcnt lgkmcnt(6)
    v_mfma_f32_32x32x16_bf16 v[16:31], a[16:19], v[48:51], v[16:31]
    ds_read_b128 v[48:51], v4 offset:12288
    v_mul_f32 v100, v92, v92
    v_mul_f32 v101, v93, v93
    v_mul_f32 v102, v94, v94
    v_mul_f32 v103, v95, v95
    v_mfma_f32_32x32x16_bf16 v[16:31], a[20:23], v[52:55], v[16:31]
    ds_read_b128 v[52:55], v4 offset:13312
    v_fma_f32 v96, v96, s56, v112
    v_fma_f32 v97, v97, s56, v112
    v_fma_f32 v98, v98, s56, v112
    v_fma_f32 v99, v99, s56, v112
    s_waitcnt lgkmcnt(6)
    v_mfma_f32_32x32x16_bf16 v[16:31], a[24:27], v[56:59], v[16:31]
    ds_read_b128 v[56:59], v4 offset:14336
    v_fma_f32 v100, v100, s56, v112
    v_fma_f32 v101, v101, s56, v112
    v_fma_f32 v102, v102, s56, v112
    v_fma_f32 v103, v103, s56, v112
    v_mfma_f32_32x32x16_bf16 v[16:31], a[28:31], v[60:63], v[16:31]
    ds_read_b128 v[60:63], v4 offset:15360
    v_mul_f32 v96, v96, v88
    v_mul_f32 v97, v97, v89
    v_mul_f32 v98, v98, v90
    v_mul_f32 v99, v99, v91
    s_waitcnt lgkmcnt(6)
    v_mfma_f32_32x32x16_bf16 v[16:31], a[32:35], v[32:35], v[16:31]
    ds_read_b128 v[32:35], v4 offset:16384
    v_mul_f32 v100, v100, v92
    v_mul_f32 v101, v101, v93
    v_mul_f32 v102, v102, v94
    v_mul_f32 v103, v103, v95
    v_mfma_f32_32x32x16_bf16 v[16:31], a[36:39], v[36:39], v[16:31]
    ds_read_b128 v[36:39], v4 offset:17408
    v_exp_f32 v96, v96
    v_exp_f32 v97, v97
    s_waitcnt lgkmcnt(6)
    v_mfma_f32_32x32x16_bf16 v[16:31], a[40:43], v[40:43], v[16:31]
    ds_read_b128 v[40:43], v4 offset:18432
    v_exp_f32 v98, v98
    v_exp_f32 v99, v99
    v_mfma_f32_32x32x16_bf16 v[16:31], a[44:47], v[44:47], v[16:31]
    ds_read_b128 v[44:47], v4 offset:19456
    v_exp_f32 v100, v100
    v_exp_f32 v101, v101
    s_waitcnt lgkmcnt(6)
    v_mfma_f32_32x32x16_bf16 v[16:31], a[48:51], v[48:51], v[16:31]
    ds_read_b128 v[48:51], v4 offset:20480
    v_exp_f32 v102, v102
    v_exp_f32 v103, v103
    v_mfma_f32_32x32x16_bf16 v[16:31], a[52:55], v[52:55], v[16:31]
    ds_read_b128 v[52:55], v4 offset:21504
    v_add_f32 v96, 1.0, v96
    v_add_f32 v97, 1.0, v97
    v_add_f32 v98, 1.0, v98
    v_add_f32 v99, 1.0, v99
    s_waitcnt lgkmcnt(6)
    v_mfma_f32_32x32x16_bf16 v[16:31], a[56:59], v[56:59], v[16:31]
    ds_read_b128 v[56:59], v4 offset:22528
    v_add_f32 v100, 1.0, v100
    v_add_f32 v101, 1.0, v101
    v_add_f32 v102, 1.0, v102
    v_add_f32 v103, 1.0, v103
    v_mfma_f32_32x32x16_bf16 v[16:31], a[60:63], v[60:63], v[16:31]
    ds_read_b128 v[60:63], v4 offset:23552
    v_rcp_f32 v96, v96
    v_rcp_f32 v97, v97
    s_waitcnt lgkmcnt(6)
    v_mfma_f32_32x32x16_bf16 v[16:31], a[64:67], v[32:35], v[16:31]
    ds_read_b128 v[32:35], v4 offset:24576
    v_rcp_f32 v98, v98
    v_rcp_f32 v99, v99
    v_mfma_f32_32x32x16_bf16 v[16:31], a[68:71], v[36:39], v[16:31]
    ds_read_b128 v[36:39], v4 offset:25600
    v_rcp_f32 v100, v100
    v_rcp_f32 v101, v101
    s_waitcnt lgkmcnt(6)
    v_mfma_f32_32x32x16_bf16 v[16:31], a[72:75], v[40:43], v[16:31]
    ds_read_b128 v[40:43], v4 offset:26624
    v_rcp_f32 v102, v102
    v_rcp_f32 v103, v103
    v_mfma_f32_32x32x16_bf16 v[16:31], a[76:79], v[44:47], v[16:31]
    ds_read_b128 v[44:47], v4 offset:27648
    v_mul_f32 v88, v88, v96
    v_mul_f32 v89, v89, v97
    v_mul_f32 v90, v90, v98
    v_mul_f32 v91, v91, v99
    s_waitcnt lgkmcnt(6)
    v_mfma_f32_32x32x16_bf16 v[16:31], a[80:83], v[48:51], v[16:31]
    ds_read_b128 v[48:51], v4 offset:28672
    v_mul_f32 v92, v92, v100
    v_mul_f32 v93, v93, v101
    v_mul_f32 v94, v94, v102
    v_mul_f32 v95, v95, v103
    v_mfma_f32_32x32x16_bf16 v[16:31], a[84:87], v[52:55], v[16:31]
    ds_read_b128 v[52:55], v4 offset:29696
    v_cvt_pk_bf16_f32 v108, v88, v89
    v_cvt_pk_bf16_f32 v109, v90, v91
    v_cvt_pk_bf16_f32 v110, v92, v93
    v_cvt_pk_bf16_f32 v111, v94, v95
    s_waitcnt lgkmcnt(6)
    v_mfma_f32_32x32x16_bf16 v[16:31], a[88:91], v[56:59], v[16:31]
    ds_read_b128 v[56:59], v4 offset:30720
    buffer_store_dwordx4 v[108:111], v9, s[12:15], s63 offen sc1
    s_add_u32 s63, s63, s86
    v_mfma_f32_32x32x16_bf16 v[16:31], a[92:95], v[60:63], v[16:31]
    ds_read_b128 v[60:63], v4 offset:31744
    s_waitcnt lgkmcnt(6)
    v_mfma_f32_32x32x16_bf16 v[16:31], a[96:99], v[32:35], v[16:31]
    v_mfma_f32_32x32x16_bf16 v[16:31], a[100:103], v[36:39], v[16:31]
    s_waitcnt lgkmcnt(4)
    v_mfma_f32_32x32x16_bf16 v[16:31], a[104:107], v[40:43], v[16:31]
    v_mfma_f32_32x32x16_bf16 v[16:31], a[108:111], v[44:47], v[16:31]
    s_waitcnt lgkmcnt(2)
    v_mfma_f32_32x32x16_bf16 v[16:31], a[112:115], v[48:51], v[16:31]
    v_mfma_f32_32x32x16_bf16 v[16:31], a[116:119], v[52:55], v[16:31]
    s_waitcnt lgkmcnt(0)
    v_mfma_f32_32x32x16_bf16 v[16:31], a[120:123], v[56:59], v[16:31]
    v_mfma_f32_32x32x16_bf16 v[16:31], a[124:127], v[60:63], v[16:31]
    v_xor_b32 v4, 0x10000, v4
    s_setprio 0
    s_waitcnt vmcnt(2)
L_g_mm2_112_d:
    v_readfirstlane_b32 s66, v14
    s_lshl_b32 s67, s67, 1
    s_or_b32 s67, s67, 1
    s_add_u32 s60, s60, 1
    s_cmp_gt_u32 s66, s60
    s_cbranch_scc1 L_g_loop1_93
    s_barrier
    ds_read_b32 v14, v15 offset:20
    ds_read_b128 v[80:83], v5 offset:0
    ds_read_b128 v[84:87], v5 offset:1024
    ds_read_b128 v[88:91], v5 offset:2048
    ds_read_b128 v[92:95], v5 offset:3072
    s_waitcnt lgkmcnt(4)
    v_readfirstlane_b32 s66, v14
    s_barrier
    s_mov_b32 s69, 0
    s_cmp_gt_u32 s62, s60
    s_cbranch_scc1 L_g_nd_115
    s_cmp_ge_u32 s62, s66
    s_cbranch_scc1 L_g_nd_115
    s_add_u32 s47, s61, 4096
    s_add_u32 m0, s64, 0
    s_nop 0
    buffer_load_dwordx4 v3, s[12:15], s61 offen offset:0 sc1 lds
    buffer_load_dwordx4 v3, s[12:15], s61 offen offset:1024 sc1 lds
    buffer_load_dwordx4 v3, s[12:15], s61 offen offset:2048 sc1 lds
    buffer_load_dwordx4 v3, s[12:15], s61 offen offset:3072 sc1 lds
    s_add_u32 m0, s64, 4096
    s_nop 0
    buffer_load_dwordx4 v3, s[12:15], s47 offen offset:0 sc1 lds
    buffer_load_dwordx4 v3, s[12:15], s47 offen offset:1024 sc1 lds
    buffer_load_dwordx4 v3, s[12:15], s47 offen offset:2048 sc1 lds
    buffer_load_dwordx4 v3, s[12:15], s47 offen offset:3072 sc1 lds
    s_add_u32 s61, s61, s85
    s_add_u32 s62, s62, 1
    s_xor_b32 s64, s64, 0x10000
    s_mov_b32 s69, 1
L_g_nd_115:
    s_waitcnt lgkmcnt(3)
    v_add_f32 v80, v80, v16
    v_add_f32 v81, v81, v17
    v_add_f32 v82, v82, v18
    v_add_f32 v83, v83, v19
    s_waitcnt lgkmcnt(2)
    v_add_f32 v84, v84, v20
    v_add_f32 v85, v85, v21
    v_add_f32 v86, v86, v22
    v_add_f32 v87, v87, v23
    s_waitcnt lgkmcnt(1)
    v_add_f32 v88, v88, v24
    v_add_f32 v89, v89, v25
    v_add_f32 v90, v90, v26
    v_add_f32 v91, v91, v27
    s_waitcnt lgkmcnt(0)
    v_add_f32 v92, v92, v28
    v_add_f32 v93, v93, v29
    v_add_f32 v94, v94, v30
    v_add_f32 v95, v95, v31
    v_mul_f32 v96, v80, v80
    v_mul_f32 v97, v81, v81
    v_mul_f32 v98, v82, v82
    v_mul_f32 v99, v83, v83
    v_mul_f32 v100, v84, v84
    v_mul_f32 v101, v85, v85
    v_mul_f32 v102, v86, v86
    v_mul_f32 v103, v87, v87
    v_fma_f32 v96, v96, s56, v112
    v_fma_f32 v97, v97, s56, v112
    v_fma_f32 v98, v98, s56, v112
    v_fma_f32 v99, v99, s56, v112
    v_fma_f32 v100, v100, s56, v112
    v_fma_f32 v101, v101, s56, v112
    v_fma_f32 v102, v102, s56, v112
    v_fma_f32 v103, v103, s56, v112
    v_mul_f32 v96, v96, v80
    v_mul_f32 v97, v97, v81
    v_mul_f32 v98, v98, v82
    v_mul_f32 v99, v99, v83
    v_mul_f32 v100, v100, v84
    v_mul_f32 v101, v101, v85
    v_mul_f32 v102, v102, v86
    v_mul_f32 v103, v103, v87
    v_exp_f32 v96, v96
    v_exp_f32 v97, v97
    v_exp_f32 v98, v98
    v_exp_f32 v99, v99
    v_exp_f32 v100, v100
    v_exp_f32 v101, v101
    v_exp_f32 v102, v102
    v_exp_f32 v103, v103
    v_add_f32 v96, 1.0, v96
    v_add_f32 v97, 1.0, v97
    v_add_f32 v98, 1.0, v98
    v_add_f32 v99, 1.0, v99
    v_add_f32 v100, 1.0, v100
    v_add_f32 v101, 1.0, v101
    v_add_f32 v102, 1.0, v102
    v_add_f32 v103, 1.0, v103
    v_rcp_f32 v96, v96
    v_rcp_f32 v97, v97
    v_rcp_f32 v98, v98
    v_rcp_f32 v99, v99
    v_rcp_f32 v100, v100
    v_rcp_f32 v101, v101
    v_rcp_f32 v102, v102
    v_rcp_f32 v103, v103
    v_mul_f32 v80, v80, v96
    v_mul_f32 v81, v81, v97
    v_mul_f32 v82, v82, v98
    v_mul_f32 v83, v83, v99
    v_mul_f32 v84, v84, v100
    v_mul_f32 v85, v85, v101
    v_mul_f32 v86, v86, v102
    v_mul_f32 v87, v87, v103
    v_cvt_pk_bf16_f32 v104, v80, v81
    v_cvt_pk_bf16_f32 v105, v82, v83
    v_cvt_pk_bf16_f32 v106, v84, v85
    v_cvt_pk_bf16_f32 v107, v86, v87
    buffer_store_dwordx4 v[104:107], v8, s[12:15], s63 offen sc1
    v_mul_f32 v96, v88, v88
    v_mul_f32 v97, v89, v89
    v_mul_f32 v98, v90, v90
    v_mul_f32 v99, v91, v91
    v_mul_f32 v100, v92, v92
    v_mul_f32 v101, v93, v93
    v_mul_f32 v102, v94, v94
    v_mul_f32 v103, v95, v95
    v_fma_f32 v96, v96, s56, v112
    v_fma_f32 v97, v97, s56, v112
    v_fma_f32 v98, v98, s56, v112
    v_fma_f32 v99, v99, s56, v112
    v_fma_f32 v100, v100, s56, v112
    v_fma_f32 v101, v101, s56, v112
    v_fma_f32 v102, v102, s56, v112
    v_fma_f32 v103, v103, s56, v112
    v_mul_f32 v96, v96, v88
    v_mul_f32 v97, v97, v89
    v_mul_f32 v98, v98, v90
    v_mul_f32 v99, v99, v91
    v_mul_f32 v100, v100, v92
    v_mul_f32 v101, v101, v93
    v_mul_f32 v102, v102, v94
    v_mul_f32 v103, v103, v95
    v_exp_f32 v96, v96
    v_exp_f32 v97, v97
    v_exp_f32 v98, v98
    v_exp_f32 v99, v99
    v_exp_f32 v100, v100
    v_exp_f32 v101, v101
    v_exp_f32 v102, v102
    v_exp_f32 v103, v103
    v_add_f32 v96, 1.0, v96
    v_add_f32 v97, 1.0, v97
    v_add_f32 v98, 1.0, v98
    v_add_f32 v99, 1.0, v99
    v_add_f32 v100, 1.0, v100
    v_add_f32 v101, 1.0, v101
    v_add_f32 v102, 1.0, v102
    v_add_f32 v103, 1.0, v103
    v_rcp_f32 v96, v96
    v_rcp_f32 v97, v97
    v_rcp_f32 v98, v98
    v_rcp_f32 v99, v99
    v_rcp_f32 v100, v100
    v_rcp_f32 v101, v101
    v_rcp_f32 v102, v102
    v_rcp_f32 v103, v103
    v_mul_f32 v88, v88, v96
    v_mul_f32 v89, v89, v97
    v_mul_f32 v90, v90, v98
    v_mul_f32 v91, v91, v99
    v_mul_f32 v92, v92, v100
    v_mul_f32 v93, v93, v101
    v_mul_f32 v94, v94, v102
    v_mul_f32 v95, v95, v103
    v_cvt_pk_bf16_f32 v108, v88, v89
    v_cvt_pk_bf16_f32 v109, v90, v91
    v_cvt_pk_bf16_f32 v110, v92, v93
    v_cvt_pk_bf16_f32 v111, v94, v95
    buffer_store_dwordx4 v[108:111], v9, s[12:15], s63 offen sc1
    s_add_u32 s63, s63, s86
    s_mov_b32 s67, 0
    s_mov_b32 s71, 1
    s_cmp_gt_u32 s66, s60
    s_cbranch_scc1 L_g_g1r_91
    v_mov_b32 v10, 1
    s_mov_b64 exec, 1
    s_waitcnt vmcnt(0)
    ds_add_rtn_u32 v10, v15, v10 offset:4
    s_waitcnt lgkmcnt(0)
    v_readfirstlane_b32 s46, v10
    s_mov_b64 exec, -1
    s_mov_b32 s71, 0
    s_sub_u32 s59, s60, 1
    s_mul_i32 s59, s59, s78
    s_add_u32 s59, s59, s74
    s_cmp_lg_u32 s46, s68
    s_cbranch_scc1 L_g_df_116
    v_mov_b32 v10, s59
    v_add_u32 v10, 1, v10
    v_mov_b32 v11, 0
    s_mov_b64 exec, 1
    buffer_store_dword v10, v11, s[12:15], s52 offen sc1
    s_mov_b64 exec, -1
L_sf_117:
L_g_df_116:
    s_add_u32 s68, s68, 4
    s_cmp_gt_u32 s66, s60
    s_cbranch_scc1 L_g_g1r_91
L_g_tail_94:
    s_cmp_lt_u32 s60, s75
    s_cbranch_scc1 L_g_restart_89
    s_waitcnt vmcnt(0)
    s_barrier
    s_branch L_w_f1_14_d
L_g_h1_104:
    s_add_u32 s54, s60, 1
    s_mul_i32 s55, s54, s78
    v_add_u32 v12, s55, v113
    v_mul_u32_u24 v13, 171, v12
    v_lshrrev_b32 v13, 9, v13
    v_mad_i32_i24 v13, v13, -3, v12
    v_lshl_add_u32 v13, v13, 9, v7
    buffer_load_dword v11, v13, s[12:15], 0 offen sc1
    s_branch L_g_h1_104_b
L_g_h2_105:
    s_waitcnt vmcnt(0)
    v_cmp_ge_u32 vcc, v12, v11
    s_nop 0
    s_ff1_i32_b64 s46, vcc
    s_lshr_b32 s46, s46, 4
    s_min_u32 s46, s46, 4
    s_add_u32 s46, s46, s54
    s_min_u32 s46, s46, s75
    v_mov_b32 v118, s46
    s_branch L_g_h2_105_b
L_g_dp_106_l:
    s_cmp_ge_u32 s62, s66
    s_cbranch_scc1 L_g_dp_106_d
    s_mov_b32 s65, 1
    s_add_u32 s47, s61, 4096
    s_mov_b32 m0, s64
    s_add_u32 s62, s62, 1
    buffer_load_dwordx4 v3, s[12:15], s61 offen offset:0 sc1 lds
    buffer_load_dwordx4 v3, s[12:15], s61 offen offset:1024 sc1 lds
    buffer_load_dwordx4 v3, s[12:15], s61 offen offset:2048 sc1 lds
    buffer_load_dwordx4 v3, s[12:15], s61 offen offset:3072 sc1 lds
    s_add_u32 m0, s64, 4096
    s_add_u32 s61, s61, s85
    buffer_load_dwordx4 v3, s[12:15], s47 offen offset:0 sc1 lds
    buffer_load_dwordx4 v3, s[12:15], s47 offen offset:1024 sc1 lds
    buffer_load_dwordx4 v3, s[12:15], s47 offen offset:2048 sc1 lds
    buffer_load_dwordx4 v3, s[12:15], s47 offen offset:3072 sc1 lds
    s_xor_b32 s64, s64, 0x10000
    s_branch L_g_dp_106_a
L_g_nw_102:
    s_waitcnt vmcnt(0) lgkmcnt(0)
    s_cmp_lg_u32 s44, 0
    s_cbranch_scc1 L_g_nl_118
    s_cmp_lt_u32 s66, s75
    s_cselect_b32 s81, 1, 2
L_g_nl_118:
    s_branch L_g_loop0_92_l
L_g_nfl_109:
    s_cmp_eq_u32 s71, 0
    s_cbranch_scc1 L_g_nfl_109_d
    v_mov_b32 v10, 1
    s_mov_b64 exec, 1
    s_waitcnt vmcnt(0)
    ds_add_rtn_u32 v10, v15, v10 offset:4
    s_waitcnt lgkmcnt(0)
    v_readfirstlane_b32 s46, v10
    s_mov_b64 exec, -1
    s_mov_b32 s71, 0
    s_sub_u32 s59, s60, 1
    s_mul_i32 s59, s59, s78
    s_add_u32 s59, s59, s74
    s_cmp_lg_u32 s46, s68
    s_cbranch_scc1 L_g_df_119
    v_mov_b32 v10, s59
    v_add_u32 v10, 1, v10
    v_mov_b32 v11, 0
    s_mov_b64 exec, 1
    buffer_store_dword v10, v11, s[12:15], s52 offen sc1
    s_mov_b64 exec, -1
L_sf_120:
L_g_df_119:
    s_add_u32 s68, s68, 4
    s_mov_b32 s65, 2
    s_branch L_g_nfl_109_d
L_g_dp_114_l:
    s_cmp_ge_u32 s62, s66
    s_cbranch_scc1 L_g_dp_114_d
    s_or_b32 s65, s65, 1
    s_add_u32 s47, s61, 4096
    s_mov_b32 m0, s64
    s_add_u32 s62, s62, 1
    buffer_load_dwordx4 v3, s[12:15], s61 offen offset:0 sc1 lds
    buffer_load_dwordx4 v3, s[12:15], s61 offen offset:1024 sc1 lds
    buffer_load_dwordx4 v3, s[12:15], s61 offen offset:2048 sc1 lds
    buffer_load_dwordx4 v3, s[12:15], s61 offen offset:3072 sc1 lds
    s_add_u32 m0, s64, 4096
    s_add_u32 s61, s61, s85
    buffer_load_dwordx4 v3, s[12:15], s47 offen offset:0 sc1 lds
    buffer_load_dwordx4 v3, s[12:15], s47 offen offset:1024 sc1 lds
    buffer_load_dwordx4 v3, s[12:15], s47 offen offset:2048 sc1 lds
    buffer_load_dwordx4 v3, s[12:15], s47 offen offset:3072 sc1 lds
    s_xor_b32 s64, s64, 0x10000
    s_branch L_g_dp_114_a
L_g_nw1_111:
    s_cmp_eq_u32 s65, 2
    s_cbranch_scc1 L_g_nw1_111_w
    s_waitcnt vmcnt(0)
L_g_nw1_111_w:
    s_barrier
    ds_read_b128 v[32:35], v4 offset:0
    ds_read_b128 v[36:39], v4 offset:1024
    ds_read_b128 v[40:43], v4 offset:2048
    ds_read_b128 v[44:47], v4 offset:3072
    ds_read_b128 v[48:51], v4 offset:4096
    ds_read_b128 v[52:55], v4 offset:5120
    ds_read_b128 v[56:59], v4 offset:6144
    ds_read_b128 v[60:63], v4 offset:7168
    s_branch L_g_jn_113
L_g_mm2_112:
    s_setprio 1
    s_waitcnt lgkmcnt(6)
    v_mfma_f32_32x32x16_bf16 v[16:31], a[0:3], v[32:35], 0
    ds_read_b128 v[32:35], v4 offset:8192
    ds_read_b32 v14, v15
    v_mfma_f32_32x32x16_bf16 v[16:31], a[4:7], v[36:39], v[16:31]
    ds_read_b128 v[36:39], v4 offset:9216
    s_waitcnt lgkmcnt(6)
    v_mfma_f32_32x32x16_bf16 v[16:31], a[8:11], v[40:43], v[16:31]
    ds_read_b128 v[40:43], v4 offset:10240
    v_mfma_f32_32x32x16_bf16 v[16:31], a[12:15], v[44:47], v[16:31]
    ds_read_b128 v[44:47], v4 offset:11264
    s_waitcnt lgkmcnt(6)
    v_mfma_f32_32x32x16_bf16 v[16:31], a[16:19], v[48:51], v[16:31]
    ds_read_b128 v[48:51], v4 offset:12288
    v_mfma_f32_32x32x16_bf16 v[16:31], a[20:23], v[52:55], v[16:31]
    ds_read_b128 v[52:55], v4 offset:13312
    s_waitcnt lgkmcnt(6)
    v_mfma_f32_32x32x16_bf16 v[16:31], a[24:27], v[56:59], v[16:31]
    ds_read_b128 v[56:59], v4 offset:14336
    v_mfma_f32_32x32x16_bf16 v[16:31], a[28:31], v[60:63], v[16:31]
    ds_read_b128 v[60:63], v4 offset:15360
    s_waitcnt lgkmcnt(6)
    v_mfma_f32_32x32x16_bf16 v[16:31], a[32:35], v[32:35], v[16:31]
    ds_read_b128 v[32:35], v4 offset:16384
    v_mfma_f32_32x32x16_bf16 v[16:31], a[36:39], v[36:39], v[16:31]
    ds_read_b128 v[36:39], v4 offset:17408
    s_waitcnt lgkmcnt(6)
    v_mfma_f32_32x32x16_bf16 v[16:31], a[40:43], v[40:43], v[16:31]
    ds_read_b128 v[40:43], v4 offset:18432
    v_mfma_f32_32x32x16_bf16 v[16:31], a[44:47], v[44:47], v[16:31]
    ds_read_b128 v[44:47], v4 offset:19456
    s_waitcnt lgkmcnt(6)
    v_mfma_f32_32x32x16_bf16 v[16:31], a[48:51], v[48:51], v[16:31]
    ds_read_b128 v[48:51], v4 offset:20480
    v_mfma_f32_32x32x16_bf16 v[16:31], a[52:55], v[52:55], v[16:31]
    ds_read_b128 v[52:55], v4 offset:21504
    s_waitcnt lgkmcnt(6)
    v_mfma_f32_32x32x16_bf16 v[16:31], a[56:59], v[56:59], v[16:31]
    ds_read_b128 v[56:59], v4 offset:22528
    v_mfma_f32_32x32x16_bf16 v[16:31], a[60:63], v[60:63], v[16:31]
    ds_read_b128 v[60:63], v4 offset:23552
    s_waitcnt lgkmcnt(6)
    v_mfma_f32_32x32x16_bf16 v[16:31], a[64:67], v[32:35], v[16:31]
    ds_read_b128 v[32:35], v4 offset:24576
    v_mfma_f32_32x32x16_bf16 v[16:31], a[68:71], v[36:39], v[16:31]
    ds_read_b128 v[36:39], v4 offset:25600
    s_waitcnt lgkmcnt(6)
    v_mfma_f32_32x32x16_bf16 v[16:31], a[72:75], v[40:43], v[16:31]
    ds_read_b128 v[40:43], v4 offset:26624
    v_mfma_f32_32x32x16_bf16 v[16:31], a[76:79], v[44:47], v[16:31]
    ds_read_b128 v[44:47], v4 offset:27648
    s_waitcnt lgkmcnt(6)
    v_mfma_f32_32x32x16_bf16 v[16:31], a[80:83], v[48:51], v[16:31]
    ds_read_b128 v[48:51], v4 offset:28672
    v_mfma_f32_32x32x16_bf16 v[16:31], a[84:87], v[52:55], v[16:31]
    ds_read_b128 v[52:55], v4 offset:29696
    s_waitcnt lgkmcnt(6)
    v_mfma_f32_32x32x16_bf16 v[16:31], a[88:91], v[56:59], v[16:31]
    ds_read_b128 v[56:59], v4 offset:30720
    v_mfma_f32_32x32x16_bf16 v[16:31], a[92:95], v[60:63], v[16:31]
    ds_read_b128 v[60:63], v4 offset:31744
    s_waitcnt lgkmcnt(6)
    v_mfma_f32_32x32x16_bf16 v[16:31], a[96:99], v[32:35], v[16:31]
    v_mfma_f32_32x32x16_bf16 v[16:31], a[100:103], v[36:39], v[16:31]
    s_waitcnt lgkmcnt(4)
    v_mfma_f32_32x32x16_bf16 v[16:31], a[104:107], v[40:43], v[16:31]
    v_mfma_f32_32x32x16_bf16 v[16:31], a[108:111], v[44:47], v[16:31]
    s_waitcnt lgkmcnt(2)
    v_mfma_f32_32x32x16_bf16 v[16:31], a[112:115], v[48:51], v[16:31]
    v_mfma_f32_32x32x16_bf16 v[16:31], a[116:119], v[52:55], v[16:31]
    s_waitcnt lgkmcnt(0)
    v_mfma_f32_32x32x16_bf16 v[16:31], a[120:123], v[56:59], v[16:31]
    v_mfma_f32_32x32x16_bf16 v[16:31], a[124:127], v[60:63], v[16:31]
    v_xor_b32 v4, 0x10000, v4
    s_setprio 0
    s_waitcnt vmcnt(0)
    s_branch L_g_mm2_112_d
L_w_f2_13:
    s_load_dwordx2 s[4:5], s[0:1], 80
    s_load_dwordx2 s[6:7], s[0:1], 72
    s_and_b32 s50, s44, 3
    s_lshr_b32 s51, s44, 2
    s_waitcnt lgkmcnt(0)
    s_mov_b32 s24, s4
    s_and_b32 s25, s5, 0xffff
    s_mov_b32 s26, 0x700000
    s_mov_b32 s27, 0x00020000
    v_lshrrev_b32 v3, 4, v1
    v_and_b32 v4, 15, v1
    v_lshlrev_b32 v5, 2, v3
    v_xor_b32 v4, v4, v5
    v_mul_u32_u24 v3, 2048, v3
    v_lshl_add_u32 v3, v4, 4, v3
    s_mul_i32 s46, s51, 448
    s_mul_i32 s47, s50, 16
    s_add_u32 s46, s46, s47
    s_mul_i32 s47, s42, 896
    s_add_u32 s46, s46, s47
    s_mul_i32 s46, s46, 2048
    s_lshl_b32 s47, s43, 8
    s_add_u32 s46, s46, s47
    s_lshl_b32 s45, s51, 16
    s_mul_i32 s47, s50, 4096
    s_add_u32 s45, s45, s47
    v_bfe_u32 v4, v1, 2, 2
    v_bfe_u32 v5, v1, 4, 1
    v_lshlrev_b32 v5, 1, v5
    v_bfe_u32 v6, v1, 1, 1
    v_add_u32 v5, v5, v6
    s_lshl_b32 s47, s50, 2
    v_add_u32 v5, s47, v5
    v_lshlrev_b32 v6, 2, v4
    v_xor_b32 v5, v5, v6
    v_lshlrev_b32 v5, 4, v5
    v_lshl_add_u32 v5, v4, 8, v5
    v_bfe_u32 v6, v1, 0, 1
    v_lshl_add_u32 v5, v6, 3, v5
    v_lshrrev_b32 v6, 5, v1
    v_mul_u32_u24 v6, 1024, v6
    v_add_u32 v5, v5, v6
    s_lshl_b32 s47, s51, 16
    v_add_u32 v5, s47, v5
    v_bfe_u32 v4, v1, 2, 2
    v_xor_b32 v5, s50, v4
    v_lshlrev_b32 v5, 6, v5
    v_lshl_add_u32 v5, v4, 8, v5
    v_and_b32 v6, 3, v1
    v_lshl_add_u32 v5, v6, 3, v5
    v_lshrrev_b32 v6, 4, v1
    v_lshl_add_u32 v5, v6, 10, v5
    v_lshrrev_b32 v6, 5, v1
    v_lshl_add_u32 v5, v6, 11, v5
    s_lshl_b32 s47, s51, 16
    v_add_u32 v5, s47, v5
    s_add_u32 m0, s45, 0
    s_add_u32 s47, s46, 0x0
    buffer_load_dwordx4 v3, s[24:27], s47 offen nt lds
    s_add_u32 m0, s45, 1024
    s_add_u32 s47, s46, 0x2000
    buffer_load_dwordx4 v3, s[24:27], s47 offen nt lds
    s_add_u32 m0, s45, 2048
    s_add_u32 s47, s46, 0x4000
    buffer_load_dwordx4 v3, s[24:27], s47 offen nt lds
    s_add_u32 m0, s45, 3072
    s_add_u32 s47, s46, 0x6000
    buffer_load_dwordx4 v3, s[24:27], s47 offen nt lds
    s_add_u32 m0, s45, 16384
    s_add_u32 s47, s46, 0x20000
    buffer_load_dwordx4 v3, s[24:27], s47 offen nt lds
    s_add_u32 m0, s45, 17408
    s_add_u32 s47, s46, 0x22000
    buffer_load_dwordx4 v3, s[24:27], s47 offen nt lds
    s_add_u32 m0, s45, 18432
    s_add_u32 s47, s46, 0x24000
    buffer_load_dwordx4 v3, s[24:27], s47 offen nt lds
    s_add_u32 m0, s45, 19456
    s_add_u32 s47, s46, 0x26000
    buffer_load_dwordx4 v3, s[24:27], s47 offen nt lds
    s_add_u32 m0, s45, 32768
    s_add_u32 s47, s46, 0x40000
    buffer_load_dwordx4 v3, s[24:27], s47 offen nt lds
    s_add_u32 m0, s45, 33792
    s_add_u32 s47, s46, 0x42000
    buffer_load_dwordx4 v3, s[24:27], s47 offen nt lds
    s_add_u32 m0, s45, 34816
    s_add_u32 s47, s46, 0x44000
    buffer_load_dwordx4 v3, s[24:27], s47 offen nt lds
    s_add_u32 m0, s45, 35840
    s_add_u32 s47, s46, 0x46000
    buffer_load_dwordx4 v3, s[24:27], s47 offen nt lds
    s_add_u32 m0, s45, 49152
    s_add_u32 s47, s46, 0x60000
    buffer_load_dwordx4 v3, s[24:27], s47 offen nt lds
    s_add_u32 m0, s45, 50176
    s_add_u32 s47, s46, 0x62000
    buffer_load_dwordx4 v3, s[24:27], s47 offen nt lds
    s_add_u32 m0, s45, 51200
    s_add_u32 s47, s46, 0x64000
    buffer_load_dwordx4 v3, s[24:27], s47 offen nt lds
    s_add_u32 m0, s45, 52224
    s_add_u32 s47, s46, 0x66000
    buffer_load_dwordx4 v3, s[24:27], s47 offen nt lds
    s_waitcnt vmcnt(12) lgkmcnt(0)
    s_barrier
    ds_read_b64_tr_b16 a[0:1], v5 offset:0
    ds_read_b64_tr_b16 a[2:3], v5 offset:2048
    ds_read_b64_tr_b16 a[4:5], v5 offset:32
    ds_read_b64_tr_b16 a[6:7], v5 offset:2080
    ds_read_b64_tr_b16 a[8:9], v5 offset:8192
    ds_read_b64_tr_b16 a[10:11], v5 offset:10240
    ds_read_b64_tr_b16 a[12:13], v5 offset:8224
    ds_read_b64_tr_b16 a[14:15], v5 offset:10272
    s_waitcnt vmcnt(8) lgkmcnt(0)
    s_barrier
    s_add_u32 m0, s45, 0
    s_add_u32 s47, s46, 0x80000
    buffer_load_dwordx4 v3, s[24:27], s47 offen nt lds
    s_add_u32 m0, s45, 1024
    s_add_u32 s47, s46, 0x82000
    buffer_load_dwordx4 v3, s[24:27], s47 offen nt lds
    s_add_u32 m0, s45, 2048
    s_add_u32 s47, s46, 0x84000
    buffer_load_dwordx4 v3, s[24:27], s47 offen nt lds
    s_add_u32 m0, s45, 3072
    s_add_u32 s47, s46, 0x86000
    buffer_load_dwordx4 v3, s[24:27], s47 offen nt lds
    ds_read_b64_tr_b16 a[16:17], v5 offset:16384
    ds_read_b64_tr_b16 a[18:19], v5 offset:18432
    ds_read_b64_tr_b16 a[20:21], v5 offset:16416
    ds_read_b64_tr_b16 a[22:23], v5 offset:18464
    ds_read_b64_tr_b16 a[24:25], v5 offset:24576
    ds_read_b64_tr_b16 a[26:27], v5 offset:26624
    ds_read_b64_tr_b16 a[28:29], v5 offset:24608
    ds_read_b64_tr_b16 a[30:31], v5 offset:26656
    s_waitcnt vmcnt(8) lgkmcnt(0)
    s_barrier
    s_add_u32 m0, s45, 16384
    s_add_u32 s47, s46, 0xa0000
    buffer_load_dwordx4 v3, s[24:27], s47 offen nt lds
    s_add_u32 m0, s45, 17408
    s_add_u32 s47, s46, 0xa2000
    buffer_load_dwordx4 v3, s[24:27], s47 offen nt lds
    s_add_u32 m0, s45, 18432
    s_add_u32 s47, s46, 0xa4000
    buffer_load_dwordx4 v3, s[24:27], s47 offen nt lds
    s_add_u32 m0, s45, 19456
    s_add_u32 s47, s46, 0xa6000
    buffer_load_dwordx4 v3, s[24:27], s47 offen nt lds
    ds_read_b64_tr_b16 a[32:33], v5 offset:32768
    ds_read_b64_tr_b16 a[34:35], v5 offset:34816
    ds_read_b64_tr_b16 a[36:37], v5 offset:32800
    ds_read_b64_tr_b16 a[38:39], v5 offset:34848
    ds_read_b64_tr_b16 a[40:41], v5 offset:40960
    ds_read_b64_tr_b16 a[42:43], v5 offset:43008
    ds_read_b64_tr_b16 a[44:45], v5 offset:40992
    ds_read_b64_tr_b16 a[46:47], v5 offset:43040
    s_waitcnt vmcnt(8) lgkmcnt(0)
    s_barrier
    s_add_u32 m0, s45, 32768
    s_add_u32 s47, s46, 0xc0000
    buffer_load_dwordx4 v3, s[24:27], s47 offen nt lds
    s_add_u32 m0, s45, 33792
    s_add_u32 s47, s46, 0xc2000
    buffer_load_dwordx4 v3, s[24:27], s47 offen nt lds
    s_add_u32 m0, s45, 34816
    s_add_u32 s47, s46, 0xc4000
    buffer_load_dwordx4 v3, s[24:27], s47 offen nt lds
    s_add_u32 m0, s45, 35840
    s_add_u32 s47, s46, 0xc6000
    buffer_load_dwordx4 v3, s[24:27], s47 offen nt lds
    ds_read_b64_tr_b16 a[48:49], v5 offset:49152
    ds_read_b64_tr_b16 a[50:51], v5 offset:51200
    ds_read_b64_tr_b16 a[52:53], v5 offset:49184
    ds_read_b64_tr_b16 a[54:55], v5 offset:51232
    ds_read_b64_tr_b16 a[56:57], v5 offset:57344
    ds_read_b64_tr_b16 a[58:59], v5 offset:59392
    ds_read_b64_tr_b16 a[60:61], v5 offset:57376
    ds_read_b64_tr_b16 a[62:63], v5 offset:59424
    s_waitcnt vmcnt(8) lgkmcnt(0)
    s_barrier
    ds_read_b64_tr_b16 a[64:65], v5 offset:0
    ds_read_b64_tr_b16 a[66:67], v5 offset:2048
    ds_read_b64_tr_b16 a[68:69], v5 offset:32
    ds_read_b64_tr_b16 a[70:71], v5 offset:2080
    ds_read_b64_tr_b16 a[72:73], v5 offset:8192
    ds_read_b64_tr_b16 a[74:75], v5 offset:10240
    ds_read_b64_tr_b16 a[76:77], v5 offset:8224
    ds_read_b64_tr_b16 a[78:79], v5 offset:10272
    s_waitcnt vmcnt(4) lgkmcnt(0)
    s_barrier
    ds_read_b64_tr_b16 a[80:81], v5 offset:16384
    ds_read_b64_tr_b16 a[82:83], v5 offset:18432
    ds_read_b64_tr_b16 a[84:85], v5 offset:16416
    ds_read_b64_tr_b16 a[86:87], v5 offset:18464
    ds_read_b64_tr_b16 a[88:89], v5 offset:24576
    ds_read_b64_tr_b16 a[90:91], v5 offset:26624
    ds_read_b64_tr_b16 a[92:93], v5 offset:24608
    ds_read_b64_tr_b16 a[94:95], v5 offset:26656
    s_waitcnt vmcnt(0) lgkmcnt(0)
    s_barrier
    ds_read_b64_tr_b16 a[96:97], v5 offset:32768
    ds_read_b64_tr_b16 a[98:99], v5 offset:34816
    ds_read_b64_tr_b16 a[100:101], v5 offset:32800
    ds_read_b64_tr_b16 a[102:103], v5 offset:34848
    ds_read_b64_tr_b16 a[104:105], v5 offset:40960
    ds_read_b64_tr_b16 a[106:107], v5 offset:43008
    ds_read_b64_tr_b16 a[108:109], v5 offset:40992
    ds_read_b64_tr_b16 a[110:111], v5 offset:43040
    s_waitcnt lgkmcnt(0)
    s_barrier
    v_lshlrev_b32 v2, 4, v1
    s_mul_i32 s64, s44, 7168
    s_add_u32 s46, s64, 0x6000000
    s_mul_i32 s47, s42, 57344
    s_add_u32 s46, s46, s47
    v_add_u32 v3, s46, v2
    s_mul_i32 s46, s51, 28672
    v_add_u32 v4, s46, v2
    v_and_b32 v6, 15, v1
    v_lshlrev_b32 v6, 4, v6
    v_lshrrev_b32 v7, 4, v1
    v_lshl_add_u32 v6, v7, 9, v6
    v_add_u32 v4, s46, v6
    s_lshl_b32 s46, s50, 12
    s_add_u32 s46, s46, 131072
    v_add_u32 v5, s46, v2
    v_and_b32 v7, 15, v1
    v_min_u32 v7, 6, v7
    v_lshlrev_b32 v7, 7, v7
    s_mul_i32 s46, s42, 896
    s_add_u32 s46, s46, 0x106400
    v_add_u32 v7, s46, v7
    s_lshl_b32 s46, s42, 16
    s_lshl_b32 s47, s43, 11
    s_add_u32 s46, s46, s47
    s_lshl_b32 s47, s50, 9
    s_add_u32 s46, s46, s47
    s_add_u32 s46, s46, 0xb000000
    v_and_b32 v8, 31, v1
    v_lshlrev_b32 v8, 4, v8
    v_lshrrev_b32 v9, 5, v1
    v_lshl_add_u32 v8, v9, 14, v8
    v_add_u32 v8, s46, v8
    v_add_u32 v9, 0x8000, v8
    s_lshl_b32 s52, s43, 9
    s_lshl_b32 s47, s42, 7
    s_add_u32 s52, s52, s47
    s_add_u32 s52, s52, 0x108400
    s_add_u32 s52, s52, s76
    s_mul_i32 s46, s43, 7168
    s_add_u32 s46, s46, 0x6000000
    s_mul_i32 s47, s42, 57344
    s_add_u32 s46, s46, s47
    v_min_u32 v116, 55, v1
    v_lshlrev_b32 v116, 7, v116
    v_add_u32 v116, s46, v116
    s_mov_b32 s60, 0
    s_mul_i32 s61, s74, 229376
    s_mov_b32 s62, 0
    s_mul_i32 s63, s74, 262144
    s_mul_i32 s85, s78, 229376
    s_mul_i32 s86, s78, 262144
    s_sub_u32 s46, s78, 1
    s_sub_u32 s75, s75, s74
    s_add_u32 s75, s75, s46
    s_lshr_b32 s75, s75, s46
    s_mov_b32 s67, 0
    s_mov_b32 s68, 3
    s_mov_b32 s71, 0
    v_mov_b32 v15, 147456
    v_mov_b32 v14, 0
    ds_write_b32 v15, v14 offset:4
    ds_write_b32 v15, v14 offset:12
    ds_write_b32 v15, v14 offset:16
    v_mov_b32 v114, 1
    v_mov_b32 v115, 0
    s_mov_b32 s81, 0
    s_mul_i32 s87, s78, 2
    s_sub_u32 s87, s74, s87
    s_add_u32 s87, s87, 1
    s_lshl_b32 s46, s44, 5
    v_add_u32 v119, s46, v15
    v_lshrrev_b32 v113, 4, v1
    v_mul_u32_u24 v113, s78, v113
    v_add_u32 v113, s74, v113
    s_mov_b32 s72, 0
L_g_restart_121:
    s_cmp_lg_u32 s44, 0
    s_cbranch_scc1 L_g_nsp_122
    s_mov_b32 s70, 0
L_g_sp_128:
    s_add_u32 s54, s60, 0
    s_mul_i32 s55, s54, s78
    v_add_u32 v12, s55, v113
    v_subrev_u32 v13, 58, v12
    v_ashrrev_i32 v11, 31, v13
    v_and_b32 v13, 1, v13
    v_add_u32 v13, 1, v13
    v_bfi_b32 v13, v11, 0, v13
    v_lshl_add_u32 v13, v13, 16, v7
    buffer_load_dword v11, v13, s[12:15], 0 offen sc1
    s_waitcnt vmcnt(0)
    v_cmp_ge_u32 vcc, v12, v11
    s_add_u32 s70, s70, 1
    s_and_b32 s46, vcc_lo, 0xffff
    s_cbranch_scc0 L_g_sp_128_ok
    s_sleep 3
    s_cmp_lt_u32 s70, 524288
    s_cbranch_scc1 L_g_sp_128
    s_branch L_c_done_1
L_g_sp_128_ok:
    v_cmp_ge_u32 vcc, v12, v11
    s_nop 0
    s_ff1_i32_b64 s46, vcc
    s_lshr_b32 s46, s46, 4
    s_min_u32 s46, s46, 4
    s_add_u32 s46, s46, s54
    s_min_u32 s46, s46, s75
    v_mov_b32 v118, s46
    ds_write_b32 v15, v118 offset:20
L_g_nsp_122:
    s_waitcnt lgkmcnt(0)
    s_barrier
    ds_read_b32 v14, v15 offset:20
    s_waitcnt lgkmcnt(0)
    v_readfirstlane_b32 s66, v14
    s_nop 3
L_g_restart_121_go:
    s_mov_b32 s69, 0
    s_cmp_gt_u32 s62, s60
    s_cbranch_scc1 L_g_nd_129
    s_cmp_ge_u32 s62, s66
    s_cbranch_scc1 L_g_nd_129
    s_add_u32 s47, s61, 4096
    s_add_u32 m0, s64, 0
    s_nop 0
    buffer_load_dwordx4 v3, s[12:15], s61 offen offset:0 sc1 lds
    buffer_load_dwordx4 v3, s[12:15], s61 offen offset:1024 sc1 lds
    buffer_load_dwordx4 v3, s[12:15], s61 offen offset:2048 sc1 lds
    buffer_load_dwordx4 v3, s[12:15], s61 offen offset:3072 sc1 lds
    s_add_u32 m0, s64, 4096
    s_nop 0
    buffer_load_dwordx4 v3, s[12:15], s47 offen offset:0 sc1 lds
    buffer_load_dwordx4 v3, s[12:15], s47 offen offset:1024 sc1 lds
    buffer_load_dwordx4 v3, s[12:15], s47 offen offset:2048 sc1 lds
    s_add_u32 s61, s61, s85
    s_add_u32 s62, s62, 1
    s_xor_b32 s64, s64, 0x10000
    s_mov_b32 s69, 1
L_g_nd_129:
    s_cmp_eq_u32 s51, 1
    s_cbranch_scc1 L_g_g1r_123
    s_add_u32 s59, s60, 1
    s_mov_b32 s69, 0
    s_cmp_gt_u32 s62, s59
    s_cbranch_scc1 L_g_nd_130
    s_cmp_ge_u32 s62, s66
    s_cbranch_scc1 L_g_nd_130
    s_add_u32 s47, s61, 4096
    s_add_u32 m0, s64, 0
    s_nop 0
    buffer_load_dwordx4 v3, s[12:15], s61 offen offset:0 sc1 lds
    buffer_load_dwordx4 v3, s[12:15], s61 offen offset:1024 sc1 lds
    buffer_load_dwordx4 v3, s[12:15], s61 offen offset:2048 sc1 lds
    buffer_load_dwordx4 v3, s[12:15], s61 offen offset:3072 sc1 lds
    s_add_u32 m0, s64, 4096
    s_nop 0
    buffer_load_dwordx4 v3, s[12:15], s47 offen offset:0 sc1 lds
    buffer_load_dwordx4 v3, s[12:15], s47 offen offset:1024 sc1 lds
    buffer_load_dwordx4 v3, s[12:15], s47 offen offset:2048 sc1 lds
    s_add_u32 s61, s61, s85
    s_add_u32 s62, s62, 1
    s_xor_b32 s64, s64, 0x10000
    s_mov_b32 s69, 1
L_g_nd_130:
    s_cmp_eq_u32 s69, 1
    s_cbranch_scc1 L_g_w0_131
    s_waitcnt vmcnt(0)
L_g_w0_131:
    s_waitcnt vmcnt(7)
    s_cmp_lg_u32 s44, 0
    s_cbranch_scc1 L_g_nl_132
    s_cmp_lt_u32 s66, s75
    s_cselect_b32 s81, 1, 2
L_g_nl_132:
L_g_loop0_124_l:
    s_barrier
    ds_read_b128 v[32:35], v4 offset:0
    ds_read_b128 v[36:39], v4 offset:256
    ds_read_b128 v[40:43], v4 offset:2048
    ds_read_b128 v[44:47], v4 offset:2304
    ds_read_b128 v[48:51], v4 offset:4096
    ds_read_b128 v[52:55], v4 offset:4352
    ds_read_b128 v[56:59], v4 offset:6144
    ds_read_b128 v[60:63], v4 offset:6400
    s_branch L_g_loop0_124_m
.p2align 6
L_g_loop0_124:
    s_barrier
L_g_loop0_124_m:
    s_setprio 2
    s_waitcnt lgkmcnt(6)
    v_mfma_f32_16x16x32_bf16 v[16:19], v[32:35], a[0:3], 0
    v_mfma_f32_16x16x32_bf16 v[20:23], v[32:35], a[4:7], 0
    ds_read_b128 v[32:35], v4 offset:8192
    v_mfma_f32_16x16x32_bf16 v[28:31], v[36:39], a[4:7], 0
    v_mfma_f32_16x16x32_bf16 v[24:27], v[36:39], a[0:3], 0
    ds_read_b128 v[36:39], v4 offset:8448
    s_cmp_eq_u32 s81, 1
    s_cbranch_scc1 L_g_h1_136
L_g_h1_136_b:
    s_waitcnt lgkmcnt(6)
    v_mfma_f32_16x16x32_bf16 v[16:19], v[40:43], a[8:11], v[16:19]
    v_mfma_f32_16x16x32_bf16 v[20:23], v[40:43], a[12:15], v[20:23]
    ds_read_b128 v[40:43], v4 offset:10240
    v_mfma_f32_16x16x32_bf16 v[28:31], v[44:47], a[12:15], v[28:31]
    v_mfma_f32_16x16x32_bf16 v[24:27], v[44:47], a[8:11], v[24:27]
    ds_read_b128 v[44:47], v4 offset:10496
    s_waitcnt lgkmcnt(6)
    v_mfma_f32_16x16x32_bf16 v[16:19], v[48:51], a[16:19], v[16:19]
    v_mfma_f32_16x16x32_bf16 v[20:23], v[48:51], a[20:23], v[20:23]
    ds_read_b128 v[48:51], v4 offset:12288
    v_mfma_f32_16x16x32_bf16 v[28:31], v[52:55], a[20:23], v[28:31]
    v_mfma_f32_16x16x32_bf16 v[24:27], v[52:55], a[16:19], v[24:27]
    ds_read_b128 v[52:55], v4 offset:12544
    s_waitcnt lgkmcnt(6)
    v_mfma_f32_16x16x32_bf16 v[16:19], v[56:59], a[24:27], v[16:19]
    v_mfma_f32_16x16x32_bf16 v[20:23], v[56:59], a[28:31], v[20:23]
    ds_read_b128 v[56:59], v4 offset:14336
    v_mfma_f32_16x16x32_bf16 v[28:31], v[60:63], a[28:31], v[28:31]
    v_mfma_f32_16x16x32_bf16 v[24:27], v[60:63], a[24:27], v[24:27]
    ds_read_b128 v[60:63], v4 offset:14592
    s_waitcnt lgkmcnt(6)
    v_mfma_f32_16x16x32_bf16 v[16:19], v[32:35], a[32:35], v[16:19]
    v_mfma_f32_16x16x32_bf16 v[20:23], v[32:35], a[36:39], v[20:23]
    ds_read_b128 v[32:35], v4 offset:16384
    v_mfma_f32_16x16x32_bf16 v[28:31], v[36:39], a[36:39], v[28:31]
    v_mfma_f32_16x16x32_bf16 v[24:27], v[36:39], a[32:35], v[24:27]
    ds_read_b128 v[36:39], v4 offset:16640
    s_waitcnt lgkmcnt(6)
    v_mfma_f32_16x16x32_bf16 v[16:19], v[40:43], a[40:43], v[16:19]
    v_mfma_f32_16x16x32_bf16 v[20:23], v[40:43], a[44:47], v[20:23]
    ds_read_b128 v[40:43], v4 offset:18432
    v_mfma_f32_16x16x32_bf16 v[28:31], v[44:47], a[44:47], v[28:31]
    v_mfma_f32_16x16x32_bf16 v[24:27], v[44:47], a[40:43], v[24:27]
    ds_read_b128 v[44:47], v4 offset:18688
    s_waitcnt lgkmcnt(6)
    v_mfma_f32_16x16x32_bf16 v[16:19], v[48:51], a[48:51], v[16:19]
    v_mfma_f32_16x16x32_bf16 v[20:23], v[48:51], a[52:55], v[20:23]
    ds_read_b128 v[48:51], v4 offset:20480
    v_mfma_f32_16x16x32_bf16 v[28:31], v[52:55], a[52:55], v[28:31]
    v_mfma_f32_16x16x32_bf16 v[24:27], v[52:55], a[48:51], v[24:27]
    ds_read_b128 v[52:55], v4 offset:20736
    s_waitcnt lgkmcnt(6)
    v_mfma_f32_16x16x32_bf16 v[16:19], v[56:59], a[56:59], v[16:19]
    v_mfma_f32_16x16x32_bf16 v[20:23], v[56:59], a[60:63], v[20:23]
    ds_read_b128 v[56:59], v4 offset:22528
    v_mfma_f32_16x16x32_bf16 v[28:31], v[60:63], a[60:63], v[28:31]
    v_mfma_f32_16x16x32_bf16 v[24:27], v[60:63], a[56:59], v[24:27]
    ds_read_b128 v[60:63], v4 offset:22784
    s_waitcnt lgkmcnt(6)
    v_mfma_f32_16x16x32_bf16 v[16:19], v[32:35], a[64:67], v[16:19]
    v_mfma_f32_16x16x32_bf16 v[20:23], v[32:35], a[68:71], v[20:23]
    ds_read_b128 v[32:35], v4 offset:24576
    v_mfma_f32_16x16x32_bf16 v[28:31], v[36:39], a[68:71], v[28:31]
    v_mfma_f32_16x16x32_bf16 v[24:27], v[36:39], a[64:67], v[24:27]
    ds_read_b128 v[36:39], v4 offset:24832
    s_waitcnt lgkmcnt(6)
    v_mfma_f32_16x16x32_bf16 v[16:19], v[40:43], a[72:75], v[16:19]
    v_mfma_f32_16x16x32_bf16 v[20:23], v[40:43], a[76:79], v[20:23]
    ds_read_b128 v[40:43], v4 offset:26624
    v_mfma_f32_16x16x32_bf16 v[28:31], v[44:47], a[76:79], v[28:31]
    v_mfma_f32_16x16x32_bf16 v[24:27], v[44:47], a[72:75], v[24:27]
    ds_read_b128 v[44:47], v4 offset:26880
    s_waitcnt lgkmcnt(6)
    v_mfma_f32_16x16x32_bf16 v[16:19], v[48:51], a[80:83], v[16:19]
    v_mfma_f32_16x16x32_bf16 v[20:23], v[48:51], a[84:87], v[20:23]
    v_mfma_f32_16x16x32_bf16 v[28:31], v[52:55], a[84:87], v[28:31]
    v_mfma_f32_16x16x32_bf16 v[24:27], v[52:55], a[80:83], v[24:27]
    s_waitcnt lgkmcnt(4)
    v_mfma_f32_16x16x32_bf16 v[16:19], v[56:59], a[88:91], v[16:19]
    v_mfma_f32_16x16x32_bf16 v[20:23], v[56:59], a[92:95], v[20:23]
    v_mfma_f32_16x16x32_bf16 v[28:31], v[60:63], a[92:95], v[28:31]
    v_mfma_f32_16x16x32_bf16 v[24:27], v[60:63], a[88:91], v[24:27]
    s_waitcnt lgkmcnt(2)
    v_mfma_f32_16x16x32_bf16 v[16:19], v[32:35], a[96:99], v[16:19]
    v_mfma_f32_16x16x32_bf16 v[20:23], v[32:35], a[100:103], v[20:23]
    s_cmp_eq_u32 s81, 1
    s_cbranch_scc1 L_g_h2_137
L_g_h2_137_b:
    ds_write_b32 v119, v118
    v_mfma_f32_16x16x32_bf16 v[28:31], v[36:39], a[100:103], v[28:31]
    v_mfma_f32_16x16x32_bf16 v[24:27], v[36:39], a[96:99], v[24:27]
    s_waitcnt lgkmcnt(0)
    v_mfma_f32_16x16x32_bf16 v[16:19], v[40:43], a[104:107], v[16:19]
    v_mfma_f32_16x16x32_bf16 v[20:23], v[40:43], a[108:111], v[20:23]
    v_mfma_f32_16x16x32_bf16 v[28:31], v[44:47], a[108:111], v[28:31]
    v_mfma_f32_16x16x32_bf16 v[24:27], v[44:47], a[104:107], v[24:27]
    v_xor_b32 v4, 0x10000, v4
    s_setprio 0
    s_waitcnt vmcnt(0)
    s_waitcnt lgkmcnt(0)
    s_barrier
    ds_read_b32 v14, v15
    s_nop 6
    ds_write_b128 v5, v[16:19] offset:0
    ds_write_b128 v5, v[20:23] offset:1024
    ds_write_b128 v5, v[24:27] offset:2048
    ds_write_b128 v5, v[28:31] offset:3072
    s_waitcnt lgkmcnt(4)
    v_readfirstlane_b32 s66, v14
    s_add_u32 s60, s60, 1
    s_mov_b32 s65, 0
    s_cmp_le_u32 s62, s60
    s_cbranch_scc1 L_g_dp_138_l
L_g_dp_138_a:
    s_cmp_ge_u32 s62, s66
    s_cbranch_scc1 L_g_dp_138_d
    s_add_u32 s47, s61, 4096
    s_mov_b32 m0, s64
    s_add_u32 s62, s62, 1
    buffer_load_dwordx4 v3, s[12:15], s61 offen offset:0 sc1 lds
    buffer_load_dwordx4 v3, s[12:15], s61 offen offset:1024 sc1 lds
    buffer_load_dwordx4 v3, s[12:15], s61 offen offset:2048 sc1 lds
    buffer_load_dwordx4 v3, s[12:15], s61 offen offset:3072 sc1 lds
    s_add_u32 m0, s64, 4096
    s_add_u32 s61, s61, s85
    buffer_load_dwordx4 v3, s[12:15], s47 offen offset:0 sc1 lds
    buffer_load_dwordx4 v3, s[12:15], s47 offen offset:1024 sc1 lds
    buffer_load_dwordx4 v3, s[12:15], s47 offen offset:2048 sc1 lds
    s_xor_b32 s64, s64, 0x10000
L_g_dp_138_d:
    s_cmp_lg_u32 s44, 2
    s_cbranch_scc1 L_g_pf_139
    s_cmp_ge_u32 s62, s66
    s_cbranch_scc1 L_g_pf_139
    buffer_load_dword v117, v116, s[12:15], s61 offen sc1
L_g_pf_139:
    s_cmp_le_u32 s66, s60
    s_cbranch_scc1 L_g_ex0_135
    s_cmp_lg_u32 s65, 0
    s_cbranch_scc1 L_g_nw_134
    ds_read_b128 v[32:35], v4 offset:0
    ds_read_b128 v[36:39], v4 offset:256
    ds_read_b128 v[40:43], v4 offset:2048
    ds_read_b128 v[44:47], v4 offset:2304
    ds_read_b128 v[48:51], v4 offset:4096
    ds_read_b128 v[52:55], v4 offset:4352
    ds_read_b128 v[56:59], v4 offset:6144
    ds_read_b128 v[60:63], v4 offset:6400
    s_cmp_lg_u32 s44, 0
    s_cbranch_scc1 L_g_nl_140
    s_mov_b32 s46, s66
    s_cmp_lg_u32 s81, 0
    s_cbranch_scc1 L_g_nl_140_e
    v_cmp_ge_u32 vcc, v12, v11
    s_nop 0
    s_ff1_i32_b64 s46, vcc
    s_lshr_b32 s46, s46, 4
    s_min_u32 s46, s46, 4
    s_add_u32 s46, s46, s54
    s_min_u32 s46, s46, s75
    v_mov_b32 v118, s46
L_g_nl_140_e:
    s_add_u32 s47, s60, 3
    s_min_u32 s47, s47, s75
    s_cmp_lt_u32 s46, s47
    s_cselect_b32 s81, 1, 0
    s_cbranch_scc1 L_g_nl_140
    s_add_u32 s54, s60, 2
    s_mul_i32 s55, s54, s78
    v_add_u32 v12, s55, v113
    v_subrev_u32 v13, 58, v12
    v_ashrrev_i32 v11, 31, v13
    v_and_b32 v13, 1, v13
    v_add_u32 v13, 1, v13
    v_bfi_b32 v13, v11, 0, v13
    v_lshl_add_u32 v13, v13, 16, v7
    buffer_load_dword v11, v13, s[12:15], 0 offen sc1
L_g_nl_140:
    s_waitcnt lgkmcnt(8)
    s_branch L_g_loop0_124
L_g_ex0_135:
    s_cmp_lg_u32 s44, 0
    s_cbranch_scc1 L_g_ex0_135_n
    ds_write_b32 v15, v118 offset:20
    s_cmp_ge_u32 s60, s75
    s_cbranch_scc1 L_g_ex0_135_n
    s_sleep 6
    s_add_u32 s54, s60, 0
    s_mul_i32 s55, s54, s78
    v_add_u32 v12, s55, v113
    v_subrev_u32 v13, 58, v12
    v_ashrrev_i32 v11, 31, v13
    v_and_b32 v13, 1, v13
    v_add_u32 v13, 1, v13
    v_bfi_b32 v13, v11, 0, v13
    v_lshl_add_u32 v13, v13, 16, v7
    buffer_load_dword v11, v13, s[12:15], 0 offen sc1
    s_waitcnt vmcnt(0)
    v_cmp_ge_u32 vcc, v12, v11
    s_nop 0
    s_ff1_i32_b64 s46, vcc
    s_lshr_b32 s46, s46, 4
    s_min_u32 s46, s46, 4
    s_add_u32 s46, s46, s54
    s_min_u32 s46, s46, s75
    v_mov_b32 v118, s46
    ds_write_b32 v15, v118 offset:20
L_g_ex0_135_n:
    s_waitcnt lgkmcnt(0)
    s_barrier
    ds_read_b32 v14, v15 offset:20
    s_waitcnt lgkmcnt(0)
    v_readfirstlane_b32 s66, v14
    s_barrier
    s_cmp_gt_u32 s66, s60
    s_cbranch_scc1 L_g_restart_121_go
    s_branch L_g_tail_126
L_g_g1r_123:
    s_mov_b32 s65, 1
    s_branch L_g_loop1_125_e
.p2align 6
L_g_loop1_125:
    s_mov_b32 s65, 0
L_g_loop1_125_e:
    s_barrier
    s_bitcmp1_b32 s67, 1
    s_cbranch_scc0 L_g_nfl_141
    s_cmp_lg_u32 s44, 4
    s_cbranch_scc1 L_g_nfl_141_d
    s_mul_i32 s59, s60, s78
    s_add_u32 s59, s59, s87
    v_mov_b32 v10, s59
    buffer_store_dword v10, v115, s[12:15], s52 offen sc1
L_g_nfl_141_d:
    ds_read_b128 v[80:83], v5 offset:0
    ds_read_b128 v[84:87], v5 offset:1024
    ds_read_b128 v[88:91], v5 offset:2048
    ds_read_b128 v[92:95], v5 offset:3072
    s_cmp_le_u32 s62, s60
    s_cbranch_scc1 L_g_dp_146_l
L_g_dp_146_a:
    s_cmp_ge_u32 s62, s66
    s_cbranch_scc1 L_g_dp_146_d
    s_add_u32 s47, s61, 4096
    s_mov_b32 m0, s64
    s_add_u32 s62, s62, 1
    buffer_load_dwordx4 v3, s[12:15], s61 offen offset:0 sc1 lds
    buffer_load_dwordx4 v3, s[12:15], s61 offen offset:1024 sc1 lds
    buffer_load_dwordx4 v3, s[12:15], s61 offen offset:2048 sc1 lds
    buffer_load_dwordx4 v3, s[12:15], s61 offen offset:3072 sc1 lds
    s_add_u32 m0, s64, 4096
    s_add_u32 s61, s61, s85
    buffer_load_dwordx4 v3, s[12:15], s47 offen offset:0 sc1 lds
    buffer_load_dwordx4 v3, s[12:15], s47 offen offset:1024 sc1 lds
    buffer_load_dwordx4 v3, s[12:15], s47 offen offset:2048 sc1 lds
    s_xor_b32 s64, s64, 0x10000
L_g_dp_146_d:
    s_bitcmp1_b32 s67, 0
    s_cbranch_scc0 L_g_nep_142
    s_waitcnt lgkmcnt(0)
    v_add_f32 v80, v80, v16
    v_add_f32 v81, v81, v17
    v_add_f32 v82, v82, v18
    v_add_f32 v83, v83, v19
    v_add_f32 v84, v84, v20
    v_add_f32 v85, v85, v21
    v_add_f32 v86, v86, v22
    v_add_f32 v87, v87, v23
    v_add_f32 v88, v88, v24
    v_add_f32 v89, v89, v25
    v_add_f32 v90, v90, v26
    v_add_f32 v91, v91, v27
    v_add_f32 v92, v92, v28
    v_add_f32 v93, v93, v29
    v_add_f32 v94, v94, v30
    v_add_f32 v95, v95, v31
    v_cvt_pk_bf16_f32 v104, v80, v81
    v_cvt_pk_bf16_f32 v105, v82, v83
    v_cvt_pk_bf16_f32 v106, v84, v85
    v_cvt_pk_bf16_f32 v107, v86, v87
    s_nop 1
    v_permlane16_swap_b32 v104, v106
    v_permlane16_swap_b32 v105, v107
    buffer_store_dwordx4 v[104:107], v8, s[12:15], s63 offen sc1
    v_cvt_pk_bf16_f32 v108, v88, v89
    v_cvt_pk_bf16_f32 v109, v90, v91
    v_cvt_pk_bf16_f32 v110, v92, v93
    v_cvt_pk_bf16_f32 v111, v94, v95
    s_nop 1
    v_permlane16_swap_b32 v108, v110
    v_permlane16_swap_b32 v109, v111
    buffer_store_dwordx4 v[108:111], v9, s[12:15], s63 offen sc1
    s_add_u32 s63, s63, s86
L_g_nep_142:
    s_cmp_lg_u32 s65, 0
    s_cbranch_scc1 L_g_nw1_143
    ds_read_b128 v[32:35], v4 offset:0
    ds_read_b128 v[36:39], v4 offset:256
    ds_read_b128 v[40:43], v4 offset:2048
    ds_read_b128 v[44:47], v4 offset:2304
    ds_read_b128 v[48:51], v4 offset:4096
    ds_read_b128 v[52:55], v4 offset:4352
    ds_read_b128 v[56:59], v4 offset:6144
    ds_read_b128 v[60:63], v4 offset:6400
    s_barrier
L_g_jn_145:
    s_setprio 1
    s_waitcnt lgkmcnt(6)
    v_mfma_f32_16x16x32_bf16 v[16:19], v[32:35], a[0:3], 0
    ds_read_b32 v14, v15
    v_mfma_f32_16x16x32_bf16 v[20:23], v[32:35], a[4:7], 0
    ds_read_b128 v[32:35], v4 offset:8192
    v_mfma_f32_16x16x32_bf16 v[28:31], v[36:39], a[4:7], 0
    v_mfma_f32_16x16x32_bf16 v[24:27], v[36:39], a[0:3], 0
    ds_read_b128 v[36:39], v4 offset:8448
    s_waitcnt lgkmcnt(6)
    v_mfma_f32_16x16x32_bf16 v[16:19], v[40:43], a[8:11], v[16:19]
    v_mfma_f32_16x16x32_bf16 v[20:23], v[40:43], a[12:15], v[20:23]
    ds_read_b128 v[40:43], v4 offset:10240
    v_mfma_f32_16x16x32_bf16 v[28:31], v[44:47], a[12:15], v[28:31]
    v_mfma_f32_16x16x32_bf16 v[24:27], v[44:47], a[8:11], v[24:27]
    ds_read_b128 v[44:47], v4 offset:10496
    s_waitcnt lgkmcnt(6)
    v_mfma_f32_16x16x32_bf16 v[16:19], v[48:51], a[16:19], v[16:19]
    v_mfma_f32_16x16x32_bf16 v[20:23], v[48:51], a[20:23], v[20:23]
    ds_read_b128 v[48:51], v4 offset:12288
    v_mfma_f32_16x16x32_bf16 v[28:31], v[52:55], a[20:23], v[28:31]
    v_mfma_f32_16x16x32_bf16 v[24:27], v[52:55], a[16:19], v[24:27]
    ds_read_b128 v[52:55], v4 offset:12544
    s_waitcnt lgkmcnt(6)
    v_mfma_f32_16x16x32_bf16 v[16:19], v[56:59], a[24:27], v[16:19]
    v_mfma_f32_16x16x32_bf16 v[20:23], v[56:59], a[28:31], v[20:23]
    ds_read_b128 v[56:59], v4 offset:14336
    v_mfma_f32_16x16x32_bf16 v[28:31], v[60:63], a[28:31], v[28:31]
    v_mfma_f32_16x16x32_bf16 v[24:27], v[60:63], a[24:27], v[24:27]
    ds_read_b128 v[60:63], v4 offset:14592
    s_waitcnt lgkmcnt(6)
    v_mfma_f32_16x16x32_bf16 v[16:19], v[32:35], a[32:35], v[16:19]
    v_mfma_f32_16x16x32_bf16 v[20:23], v[32:35], a[36:39], v[20:23]
    ds_read_b128 v[32:35], v4 offset:16384
    v_mfma_f32_16x16x32_bf16 v[28:31], v[36:39], a[36:39], v[28:31]
    v_mfma_f32_16x16x32_bf16 v[24:27], v[36:39], a[32:35], v[24:27]
    ds_read_b128 v[36:39], v4 offset:16640
    s_waitcnt lgkmcnt(6)
    v_mfma_f32_16x16x32_bf16 v[16:19], v[40:43], a[40:43], v[16:19]
    v_mfma_f32_16x16x32_bf16 v[20:23], v[40:43], a[44:47], v[20:23]
    ds_read_b128 v[40:43], v4 offset:18432
    v_mfma_f32_16x16x32_bf16 v[28:31], v[44:47], a[44:47], v[28:31]
    v_mfma_f32_16x16x32_bf16 v[24:27], v[44:47], a[40:43], v[24:27]
    ds_read_b128 v[44:47], v4 offset:18688
    s_waitcnt lgkmcnt(6)
    v_mfma_f32_16x16x32_bf16 v[16:19], v[48:51], a[48:51], v[16:19]
    v_mfma_f32_16x16x32_bf16 v[20:23], v[48:51], a[52:55], v[20:23]
    ds_read_b128 v[48:51], v4 offset:20480
    v_mfma_f32_16x16x32_bf16 v[28:31], v[52:55], a[52:55], v[28:31]
    v_mfma_f32_16x16x32_bf16 v[24:27], v[52:55], a[48:51], v[24:27]
    ds_read_b128 v[52:55], v4 offset:20736
    s_waitcnt lgkmcnt(6)
    v_mfma_f32_16x16x32_bf16 v[16:19], v[56:59], a[56:59], v[16:19]
    v_mfma_f32_16x16x32_bf16 v[20:23], v[56:59], a[60:63], v[20:23]
    ds_read_b128 v[56:59], v4 offset:22528
    v_mfma_f32_16x16x32_bf16 v[28:31], v[60:63], a[60:63], v[28:31]
    v_mfma_f32_16x16x32_bf16 v[24:27], v[60:63], a[56:59], v[24:27]
    ds_read_b128 v[60:63], v4 offset:22784
    s_waitcnt lgkmcnt(6)
    v_mfma_f32_16x16x32_bf16 v[16:19], v[32:35], a[64:67], v[16:19]
    v_mfma_f32_16x16x32_bf16 v[20:23], v[32:35], a[68:71], v[20:23]
    ds_read_b128 v[32:35], v4 offset:24576
    v_mfma_f32_16x16x32_bf16 v[28:31], v[36:39], a[68:71], v[28:31]
    v_mfma_f32_16x16x32_bf16 v[24:27], v[36:39], a[64:67], v[24:27]
    ds_read_b128 v[36:39], v4 offset:24832
    s_waitcnt lgkmcnt(6)
    v_mfma_f32_16x16x32_bf16 v[16:19], v[40:43], a[72:75], v[16:19]
    v_mfma_f32_16x16x32_bf16 v[20:23], v[40:43], a[76:79], v[20:23]
    ds_read_b128 v[40:43], v4 offset:26624
    v_mfma_f32_16x16x32_bf16 v[28:31], v[44:47], a[76:79], v[28:31]
    v_mfma_f32_16x16x32_bf16 v[24:27], v[44:47], a[72:75], v[24:27]
    ds_read_b128 v[44:47], v4 offset:26880
    s_waitcnt lgkmcnt(6)
    v_mfma_f32_16x16x32_bf16 v[16:19], v[48:51], a[80:83], v[16:19]
    v_mfma_f32_16x16x32_bf16 v[20:23], v[48:51], a[84:87], v[20:23]
    v_mfma_f32_16x16x32_bf16 v[28:31], v[52:55], a[84:87], v[28:31]
    v_mfma_f32_16x16x32_bf16 v[24:27], v[52:55], a[80:83], v[24:27]
    s_waitcnt lgkmcnt(4)
    v_mfma_f32_16x16x32_bf16 v[16:19], v[56:59], a[88:91], v[16:19]
    v_mfma_f32_16x16x32_bf16 v[20:23], v[56:59], a[92:95], v[20:23]
    v_mfma_f32_16x16x32_bf16 v[28:31], v[60:63], a[92:95], v[28:31]
    v_mfma_f32_16x16x32_bf16 v[24:27], v[60:63], a[88:91], v[24:27]
    s_waitcnt lgkmcnt(2)
    v_mfma_f32_16x16x32_bf16 v[16:19], v[32:35], a[96:99], v[16:19]
    v_mfma_f32_16x16x32_bf16 v[20:23], v[32:35], a[100:103], v[20:23]
    v_mfma_f32_16x16x32_bf16 v[28:31], v[36:39], a[100:103], v[28:31]
    v_mfma_f32_16x16x32_bf16 v[24:27], v[36:39], a[96:99], v[24:27]
    s_waitcnt lgkmcnt(0)
    v_mfma_f32_16x16x32_bf16 v[16:19], v[40:43], a[104:107], v[16:19]
    v_mfma_f32_16x16x32_bf16 v[20:23], v[40:43], a[108:111], v[20:23]
    v_mfma_f32_16x16x32_bf16 v[28:31], v[44:47], a[108:111], v[28:31]
    v_mfma_f32_16x16x32_bf16 v[24:27], v[44:47], a[104:107], v[24:27]
    v_xor_b32 v4, 0x10000, v4
    s_setprio 0
    s_waitcnt vmcnt(0)
    v_readfirstlane_b32 s66, v14
    s_lshl_b32 s67, s67, 1
    s_or_b32 s67, s67, 1
    s_add_u32 s60, s60, 1
    s_cmp_gt_u32 s66, s60
    s_cbranch_scc1 L_g_loop1_125
    s_barrier
    ds_read_b32 v14, v15 offset:20
    ds_read_b128 v[80:83], v5 offset:0
    ds_read_b128 v[84:87], v5 offset:1024
    ds_read_b128 v[88:91], v5 offset:2048
    ds_read_b128 v[92:95], v5 offset:3072
    s_waitcnt lgkmcnt(4)
    v_readfirstlane_b32 s66, v14
    s_barrier
    s_mov_b32 s69, 0
    s_cmp_gt_u32 s62, s60
    s_cbranch_scc1 L_g_nd_147
    s_cmp_ge_u32 s62, s66
    s_cbranch_scc1 L_g_nd_147
    s_add_u32 s47, s61, 4096
    s_add_u32 m0, s64, 0
    s_nop 0
    buffer_load_dwordx4 v3, s[12:15], s61 offen offset:0 sc1 lds
    buffer_load_dwordx4 v3, s[12:15], s61 offen offset:1024 sc1 lds
    buffer_load_dwordx4 v3, s[12:15], s61 offen offset:2048 sc1 lds
    buffer_load_dwordx4 v3, s[12:15], s61 offen offset:3072 sc1 lds
    s_add_u32 m0, s64, 4096
    s_nop 0
    buffer_load_dwordx4 v3, s[12:15], s47 offen offset:0 sc1 lds
    buffer_load_dwordx4 v3, s[12:15], s47 offen offset:1024 sc1 lds
    buffer_load_dwordx4 v3, s[12:15], s47 offen offset:2048 sc1 lds
    s_add_u32 s61, s61, s85
    s_add_u32 s62, s62, 1
    s_xor_b32 s64, s64, 0x10000
    s_mov_b32 s69, 1
L_g_nd_147:
    s_waitcnt lgkmcnt(3)
    v_add_f32 v80, v80, v16
    v_add_f32 v81, v81, v17
    v_add_f32 v82, v82, v18
    v_add_f32 v83, v83, v19
    s_waitcnt lgkmcnt(2)
    v_add_f32 v84, v84, v20
    v_add_f32 v85, v85, v21
    v_add_f32 v86, v86, v22
    v_add_f32 v87, v87, v23
    s_waitcnt lgkmcnt(1)
    v_add_f32 v88, v88, v24
    v_add_f32 v89, v89, v25
    v_add_f32 v90, v90, v26
    v_add_f32 v91, v91, v27
    s_waitcnt lgkmcnt(0)
    v_add_f32 v92, v92, v28
    v_add_f32 v93, v93, v29
    v_add_f32 v94, v94, v30
    v_add_f32 v95, v95, v31
    v_cvt_pk_bf16_f32 v104, v80, v81
    v_cvt_pk_bf16_f32 v105, v82, v83
    v_cvt_pk_bf16_f32 v106, v84, v85
    v_cvt_pk_bf16_f32 v107, v86, v87
    s_nop 1
    v_permlane16_swap_b32 v104, v106
    v_permlane16_swap_b32 v105, v107
    buffer_store_dwordx4 v[104:107], v8, s[12:15], s63 offen sc1
    v_cvt_pk_bf16_f32 v108, v88, v89
    v_cvt_pk_bf16_f32 v109, v90, v91
    v_cvt_pk_bf16_f32 v110, v92, v93
    v_cvt_pk_bf16_f32 v111, v94, v95
    s_nop 1
    v_permlane16_swap_b32 v108, v110
    v_permlane16_swap_b32 v109, v111
    buffer_store_dwordx4 v[108:111], v9, s[12:15], s63 offen sc1
    s_add_u32 s63, s63, s86
    s_mov_b32 s67, 0
    s_mov_b32 s71, 1
    s_cmp_gt_u32 s66, s60
    s_cbranch_scc1 L_g_g1r_123
    v_mov_b32 v10, 1
    s_mov_b64 exec, 1
    s_waitcnt vmcnt(0)
    ds_add_rtn_u32 v10, v15, v10 offset:4
    s_waitcnt lgkmcnt(0)
    v_readfirstlane_b32 s46, v10
    s_mov_b64 exec, -1
    s_mov_b32 s71, 0
    s_sub_u32 s59, s60, 1
    s_mul_i32 s59, s59, s78
    s_add_u32 s59, s59, s74
    s_cmp_lg_u32 s46, s68
    s_cbranch_scc1 L_g_df_148
    v_mov_b32 v10, s59
    v_add_u32 v10, 1, v10
    v_mov_b32 v11, 0
    s_mov_b64 exec, 1
    buffer_store_dword v10, v11, s[12:15], s52 offen sc1
    s_mov_b64 exec, -1
L_sf_149:
L_g_df_148:
    s_add_u32 s68, s68, 4
    s_cmp_gt_u32 s66, s60
    s_cbranch_scc1 L_g_g1r_123
L_g_tail_126:
    s_cmp_lt_u32 s60, s75
    s_cbranch_scc1 L_g_restart_121
    s_waitcnt vmcnt(0)
    s_barrier
    s_branch L_c_done_1
L_g_h1_136:
    s_add_u32 s54, s60, 1
    s_mul_i32 s55, s54, s78
    v_add_u32 v12, s55, v113
    v_subrev_u32 v13, 58, v12
    v_ashrrev_i32 v11, 31, v13
    v_and_b32 v13, 1, v13
    v_add_u32 v13, 1, v13
    v_bfi_b32 v13, v11, 0, v13
    v_lshl_add_u32 v13, v13, 16, v7
    buffer_load_dword v11, v13, s[12:15], 0 offen sc1
    s_branch L_g_h1_136_b
L_g_h2_137:
    s_waitcnt vmcnt(0)
    v_cmp_ge_u32 vcc, v12, v11
    s_nop 0
    s_ff1_i32_b64 s46, vcc
    s_lshr_b32 s46, s46, 4
    s_min_u32 s46, s46, 4
    s_add_u32 s46, s46, s54
    s_min_u32 s46, s46, s75
    v_mov_b32 v118, s46
    s_branch L_g_h2_137_b
L_g_dp_138_l:
    s_cmp_ge_u32 s62, s66
    s_cbranch_scc1 L_g_dp_138_d
    s_mov_b32 s65, 1
    s_add_u32 s47, s61, 4096
    s_mov_b32 m0, s64
    s_add_u32 s62, s62, 1
    buffer_load_dwordx4 v3, s[12:15], s61 offen offset:0 sc1 lds
    buffer_load_dwordx4 v3, s[12:15], s61 offen offset:1024 sc1 lds
    buffer_load_dwordx4 v3, s[12:15], s61 offen offset:2048 sc1 lds
    buffer_load_dwordx4 v3, s[12:15], s61 offen offset:3072 sc1 lds
    s_add_u32 m0, s64, 4096
    s_add_u32 s61, s61, s85
    buffer_load_dwordx4 v3, s[12:15], s47 offen offset:0 sc1 lds
    buffer_load_dwordx4 v3, s[12:15], s47 offen offset:1024 sc1 lds
    buffer_load_dwordx4 v3, s[12:15], s47 offen offset:2048 sc1 lds
    s_xor_b32 s64, s64, 0x10000
    s_branch L_g_dp_138_a
L_g_nw_134:
    s_waitcnt vmcnt(0) lgkmcnt(0)
    s_cmp_lg_u32 s44, 0
    s_cbranch_scc1 L_g_nl_150
    s_cmp_lt_u32 s66, s75
    s_cselect_b32 s81, 1, 2
L_g_nl_150:
    s_branch L_g_loop0_124_l
L_g_nfl_141:
    s_cmp_eq_u32 s71, 0
    s_cbranch_scc1 L_g_nfl_141_d
    v_mov_b32 v10, 1
    s_mov_b64 exec, 1
    s_waitcnt vmcnt(0)
    ds_add_rtn_u32 v10, v15, v10 offset:4
    s_waitcnt lgkmcnt(0)
    v_readfirstlane_b32 s46, v10
    s_mov_b64 exec, -1
    s_mov_b32 s71, 0
    s_sub_u32 s59, s60, 1
    s_mul_i32 s59, s59, s78
    s_add_u32 s59, s59, s74
    s_cmp_lg_u32 s46, s68
    s_cbranch_scc1 L_g_df_151
    v_mov_b32 v10, s59
    v_add_u32 v10, 1, v10
    v_mov_b32 v11, 0
    s_mov_b64 exec, 1
    buffer_store_dword v10, v11, s[12:15], s52 offen sc1
    s_mov_b64 exec, -1
L_sf_152:
L_g_df_151:
    s_add_u32 s68, s68, 4
    s_mov_b32 s65, 2
    s_branch L_g_nfl_141_d
L_g_dp_146_l:
    s_cmp_ge_u32 s62, s66
    s_cbranch_scc1 L_g_dp_146_d
    s_or_b32 s65, s65, 1
    s_add_u32 s47, s61, 4096
    s_mov_b32 m0, s64
    s_add_u32 s62, s62, 1
    buffer_load_dwordx4 v3, s[12:15], s61 offen offset:0 sc1 lds
    buffer_load_dwordx4 v3, s[12:15], s61 offen offset:1024 sc1 lds
    buffer_load_dwordx4 v3, s[12:15], s61 offen offset:2048 sc1 lds
    buffer_load_dwordx4 v3, s[12:15], s61 offen offset:3072 sc1 lds
    s_add_u32 m0, s64, 4096
    s_add_u32 s61, s61, s85
    buffer_load_dwordx4 v3, s[12:15], s47 offen offset:0 sc1 lds
    buffer_load_dwordx4 v3, s[12:15], s47 offen offset:1024 sc1 lds
    buffer_load_dwordx4 v3, s[12:15], s47 offen offset:2048 sc1 lds
    s_xor_b32 s64, s64, 0x10000
    s_branch L_g_dp_146_a
L_g_nw1_143:
    s_cmp_eq_u32 s65, 2
    s_cbranch_scc1 L_g_nw1_143_w
    s_waitcnt vmcnt(0)
L_g_nw1_143_w:
    s_barrier
    ds_read_b128 v[32:35], v4 offset:0
    ds_read_b128 v[36:39], v4 offset:256
    ds_read_b128 v[40:43], v4 offset:2048
    ds_read_b128 v[44:47], v4 offset:2304
    ds_read_b128 v[48:51], v4 offset:4096
    ds_read_b128 v[52:55], v4 offset:4352
    ds_read_b128 v[56:59], v4 offset:6144
    ds_read_b128 v[60:63], v4 offset:6400
    s_branch L_g_jn_145
L_w_wo_12:
    s_load_dwordx2 s[4:5], s[0:1], 40
    s_load_dwordx2 s[6:7], s[0:1], 72
    s_and_b32 s50, s44, 3
    s_lshr_b32 s51, s44, 2
    s_waitcnt lgkmcnt(0)
    s_mov_b32 s24, s4
    s_and_b32 s25, s5, 0xffff
    s_mov_b32 s26, 0x800000
    s_mov_b32 s27, 0x00020000
    v_lshrrev_b32 v3, 4, v1
    v_and_b32 v4, 15, v1
    v_lshlrev_b32 v5, 2, v3
    v_xor_b32 v4, v4, v5
    v_mul_u32_u24 v3, 2048, v3
    v_lshl_add_u32 v3, v4, 4, v3
    s_mul_i32 s46, s51, 512
    s_mul_i32 s47, s50, 16
    s_add_u32 s46, s46, s47
    s_mul_i32 s47, s42, 1024
    s_add_u32 s46, s46, s47
    s_mul_i32 s46, s46, 2048
    s_lshl_b32 s47, s43, 8
    s_add_u32 s46, s46, s47
    s_lshl_b32 s45, s51, 16
    s_mul_i32 s47, s50, 4096
    s_add_u32 s45, s45, s47
    v_bfe_u32 v4, v1, 2, 2
    v_bfe_u32 v5, v1, 4, 1
    v_lshlrev_b32 v5, 1, v5
    v_bfe_u32 v6, v1, 1, 1
    v_add_u32 v5, v5, v6
    s_lshl_b32 s47, s50, 2
    v_add_u32 v5, s47, v5
    v_lshlrev_b32 v6, 2, v4
    v_xor_b32 v5, v5, v6
    v_lshlrev_b32 v5, 4, v5
    v_lshl_add_u32 v5, v4, 8, v5
    v_bfe_u32 v6, v1, 0, 1
    v_lshl_add_u32 v5, v6, 3, v5
    v_lshrrev_b32 v6, 5, v1
    v_mul_u32_u24 v6, 1024, v6
    v_add_u32 v5, v5, v6
    s_lshl_b32 s47, s51, 16
    v_add_u32 v5, s47, v5
    v_bfe_u32 v4, v1, 2, 2
    v_xor_b32 v5, s50, v4
    v_lshlrev_b32 v5, 6, v5
    v_lshl_add_u32 v5, v4, 8, v5
    v_and_b32 v6, 3, v1
    v_lshl_add_u32 v5, v6, 3, v5
    v_lshrrev_b32 v6, 4, v1
    v_lshl_add_u32 v5, v6, 10, v5
    v_lshrrev_b32 v6, 5, v1
    s_lshl_b32 s47, s51, 16
    v_add_u32 v5, s47, v5
    s_add_u32 m0, s45, 0
    s_add_u32 s47, s46, 0x0
    buffer_load_dwordx4 v3, s[24:27], s47 offen  lds
    s_add_u32 m0, s45, 1024
    s_add_u32 s47, s46, 0x2000
    buffer_load_dwordx4 v3, s[24:27], s47 offen  lds
    s_add_u32 m0, s45, 2048
    s_add_u32 s47, s46, 0x4000
    buffer_load_dwordx4 v3, s[24:27], s47 offen  lds
    s_add_u32 m0, s45, 3072
    s_add_u32 s47, s46, 0x6000
    buffer_load_dwordx4 v3, s[24:27], s47 offen  lds
    s_add_u32 m0, s45, 16384
    s_add_u32 s47, s46, 0x20000
    buffer_load_dwordx4 v3, s[24:27], s47 offen  lds
    s_add_u32 m0, s45, 17408
    s_add_u32 s47, s46, 0x22000
    buffer_load_dwordx4 v3, s[24:27], s47 offen  lds
    s_add_u32 m0, s45, 18432
    s_add_u32 s47, s46, 0x24000
    buffer_load_dwordx4 v3, s[24:27], s47 offen  lds
    s_add_u32 m0, s45, 19456
    s_add_u32 s47, s46, 0x26000
    buffer_load_dwordx4 v3, s[24:27], s47 offen  lds
    s_add_u32 m0, s45, 32768
    s_add_u32 s47, s46, 0x40000
    buffer_load_dwordx4 v3, s[24:27], s47 offen  lds
    s_add_u32 m0, s45, 33792
    s_add_u32 s47, s46, 0x42000
    buffer_load_dwordx4 v3, s[24:27], s47 offen  lds
    s_add_u32 m0, s45, 34816
    s_add_u32 s47, s46, 0x44000
    buffer_load_dwordx4 v3, s[24:27], s47 offen  lds
    s_add_u32 m0, s45, 35840
    s_add_u32 s47, s46, 0x46000
    buffer_load_dwordx4 v3, s[24:27], s47 offen  lds
    s_add_u32 m0, s45, 49152
    s_add_u32 s47, s46, 0x60000
    buffer_load_dwordx4 v3, s[24:27], s47 offen  lds
    s_add_u32 m0, s45, 50176
    s_add_u32 s47, s46, 0x62000
    buffer_load_dwordx4 v3, s[24:27], s47 offen  lds
    s_add_u32 m0, s45, 51200
    s_add_u32 s47, s46, 0x64000
    buffer_load_dwordx4 v3, s[24:27], s47 offen  lds
    s_add_u32 m0, s45, 52224
    s_add_u32 s47, s46, 0x66000
    buffer_load_dwordx4 v3, s[24:27], s47 offen  lds
    s_waitcnt vmcnt(12) lgkmcnt(0)
    s_barrier
    ds_read_b64_tr_b16 a[0:1], v5 offset:0
    ds_read_b64_tr_b16 a[2:3], v5 offset:4096
    ds_read_b64_tr_b16 a[4:5], v5 offset:32
    ds_read_b64_tr_b16 a[6:7], v5 offset:4128
    ds_read_b64_tr_b16 a[8:9], v5 offset:8192
    ds_read_b64_tr_b16 a[10:11], v5 offset:12288
    ds_read_b64_tr_b16 a[12:13], v5 offset:8224
    ds_read_b64_tr_b16 a[14:15], v5 offset:12320
    s_waitcnt vmcnt(8) lgkmcnt(0)
    s_barrier
    s_add_u32 m0, s45, 0
    s_add_u32 s47, s46, 0x80000
    buffer_load_dwordx4 v3, s[24:27], s47 offen  lds
    s_add_u32 m0, s45, 1024
    s_add_u32 s47, s46, 0x82000
    buffer_load_dwordx4 v3, s[24:27], s47 offen  lds
    s_add_u32 m0, s45, 2048
    s_add_u32 s47, s46, 0x84000
    buffer_load_dwordx4 v3, s[24:27], s47 offen  lds
    s_add_u32 m0, s45, 3072
    s_add_u32 s47, s46, 0x86000
    buffer_load_dwordx4 v3, s[24:27], s47 offen  lds
    ds_read_b64_tr_b16 a[16:17], v5 offset:16384
    ds_read_b64_tr_b16 a[18:19], v5 offset:20480
    ds_read_b64_tr_b16 a[20:21], v5 offset:16416
    ds_read_b64_tr_b16 a[22:23], v5 offset:20512
    ds_read_b64_tr_b16 a[24:25], v5 offset:24576
    ds_read_b64_tr_b16 a[26:27], v5 offset:28672
    ds_read_b64_tr_b16 a[28:29], v5 offset:24608
    ds_read_b64_tr_b16 a[30:31], v5 offset:28704
    s_waitcnt vmcnt(8) lgkmcnt(0)
    s_barrier
    s_add_u32 m0, s45, 16384
    s_add_u32 s47, s46, 0xa0000
    buffer_load_dwordx4 v3, s[24:27], s47 offen  lds
    s_add_u32 m0, s45, 17408
    s_add_u32 s47, s46, 0xa2000
    buffer_load_dwordx4 v3, s[24:27], s47 offen  lds
    s_add_u32 m0, s45, 18432
    s_add_u32 s47, s46, 0xa4000
    buffer_load_dwordx4 v3, s[24:27], s47 offen  lds
    s_add_u32 m0, s45, 19456
    s_add_u32 s47, s46, 0xa6000
    buffer_load_dwordx4 v3, s[24:27], s47 offen  lds
    ds_read_b64_tr_b16 a[32:33], v5 offset:32768
    ds_read_b64_tr_b16 a[34:35], v5 offset:36864
    ds_read_b64_tr_b16 a[36:37], v5 offset:32800
    ds_read_b64_tr_b16 a[38:39], v5 offset:36896
    ds_read_b64_tr_b16 a[40:41], v5 offset:40960
    ds_read_b64_tr_b16 a[42:43], v5 offset:45056
    ds_read_b64_tr_b16 a[44:45], v5 offset:40992
    ds_read_b64_tr_b16 a[46:47], v5 offset:45088
    s_waitcnt vmcnt(8) lgkmcnt(0)
    s_barrier
    s_add_u32 m0, s45, 32768
    s_add_u32 s47, s46, 0xc0000
    buffer_load_dwordx4 v3, s[24:27], s47 offen  lds
    s_add_u32 m0, s45, 33792
    s_add_u32 s47, s46, 0xc2000
    buffer_load_dwordx4 v3, s[24:27], s47 offen  lds
    s_add_u32 m0, s45, 34816
    s_add_u32 s47, s46, 0xc4000
    buffer_load_dwordx4 v3, s[24:27], s47 offen  lds
    s_add_u32 m0, s45, 35840
    s_add_u32 s47, s46, 0xc6000
    buffer_load_dwordx4 v3, s[24:27], s47 offen  lds
    ds_read_b64_tr_b16 a[48:49], v5 offset:49152
    ds_read_b64_tr_b16 a[50:51], v5 offset:53248
    ds_read_b64_tr_b16 a[52:53], v5 offset:49184
    ds_read_b64_tr_b16 a[54:55], v5 offset:53280
    ds_read_b64_tr_b16 a[56:57], v5 offset:57344
    ds_read_b64_tr_b16 a[58:59], v5 offset:61440
    ds_read_b64_tr_b16 a[60:61], v5 offset:57376
    ds_read_b64_tr_b16 a[62:63], v5 offset:61472
    s_waitcnt vmcnt(8) lgkmcnt(0)
    s_barrier
    s_add_u32 m0, s45, 49152
    s_add_u32 s47, s46, 0xe0000
    buffer_load_dwordx4 v3, s[24:27], s47 offen  lds
    s_add_u32 m0, s45, 50176
    s_add_u32 s47, s46, 0xe2000
    buffer_load_dwordx4 v3, s[24:27], s47 offen  lds
    s_add_u32 m0, s45, 51200
    s_add_u32 s47, s46, 0xe4000
    buffer_load_dwordx4 v3, s[24:27], s47 offen  lds
    s_add_u32 m0, s45, 52224
    s_add_u32 s47, s46, 0xe6000
    buffer_load_dwordx4 v3, s[24:27], s47 offen  lds
    ds_read_b64_tr_b16 a[64:65], v5 offset:0
    ds_read_b64_tr_b16 a[66:67], v5 offset:4096
    ds_read_b64_tr_b16 a[68:69], v5 offset:32
    ds_read_b64_tr_b16 a[70:71], v5 offset:4128
    ds_read_b64_tr_b16 a[72:73], v5 offset:8192
    ds_read_b64_tr_b16 a[74:75], v5 offset:12288
    ds_read_b64_tr_b16 a[76:77], v5 offset:8224
    ds_read_b64_tr_b16 a[78:79], v5 offset:12320
    s_waitcnt vmcnt(8) lgkmcnt(0)
    s_barrier
    ds_read_b64_tr_b16 a[80:81], v5 offset:16384
    ds_read_b64_tr_b16 a[82:83], v5 offset:20480
    ds_read_b64_tr_b16 a[84:85], v5 offset:16416
    ds_read_b64_tr_b16 a[86:87], v5 offset:20512
    ds_read_b64_tr_b16 a[88:89], v5 offset:24576
    ds_read_b64_tr_b16 a[90:91], v5 offset:28672
    ds_read_b64_tr_b16 a[92:93], v5 offset:24608
    ds_read_b64_tr_b16 a[94:95], v5 offset:28704
    s_waitcnt vmcnt(4) lgkmcnt(0)
    s_barrier
    ds_read_b64_tr_b16 a[96:97], v5 offset:32768
    ds_read_b64_tr_b16 a[98:99], v5 offset:36864
    ds_read_b64_tr_b16 a[100:101], v5 offset:32800
    ds_read_b64_tr_b16 a[102:103], v5 offset:36896
    ds_read_b64_tr_b16 a[104:105], v5 offset:40960
    ds_read_b64_tr_b16 a[106:107], v5 offset:45056
    ds_read_b64_tr_b16 a[108:109], v5 offset:40992
    ds_read_b64_tr_b16 a[110:111], v5 offset:45088
    s_waitcnt vmcnt(0) lgkmcnt(0)
    s_barrier
    ds_read_b64_tr_b16 a[112:113], v5 offset:49152
    ds_read_b64_tr_b16 a[114:115], v5 offset:53248
    ds_read_b64_tr_b16 a[116:117], v5 offset:49184
    ds_read_b64_tr_b16 a[118:119], v5 offset:53280
    ds_read_b64_tr_b16 a[120:121], v5 offset:57344
    ds_read_b64_tr_b16 a[122:123], v5 offset:61440
    ds_read_b64_tr_b16 a[124:125], v5 offset:57376
    ds_read_b64_tr_b16 a[126:127], v5 offset:61472
    s_waitcnt lgkmcnt(0)
    s_barrier
    s_load_dwordx2 s[8:9], s[0:1], 64
    s_load_dwordx2 s[10:11], s[0:1], 80
    s_lshl_b32 s46, s42, 3
    s_add_u32 s46, s46, s43
    s_mul_i32 s46, s46, 229376
    s_mul_i32 s47, s44, 28672
    s_add_u32 s46, s46, s47
    v_lshlrev_b32 v10, 7, v1
    s_waitcnt lgkmcnt(0)
    s_mov_b32 s28, s8
    s_and_b32 s29, s9, 0xffff
    s_mov_b32 s30, 0x700000
    s_mov_b32 s31, 0x00020000
    s_mov_b32 s32, s10
    s_and_b32 s33, s11, 0xffff
    s_mov_b32 s34, 0x700000
    s_mov_b32 s35, 0x00020000
    s_add_u32 s47, s46, 0
    buffer_load_dword v120, v10, s[28:31], s47 offen
    s_add_u32 s47, s46, 8192
    buffer_load_dword v121, v10, s[28:31], s47 offen
    s_add_u32 s47, s46, 16384
    buffer_load_dword v122, v10, s[28:31], s47 offen
    s_add_u32 s47, s46, 20480
    buffer_load_dword v123, v10, s[28:31], s47 offen
    v_lshlrev_b32 v2, 4, v1
    s_mul_i32 s64, s44, 8192
    s_add_u32 s46, s64, 0x5000000
    s_mul_i32 s47, s42, 65536
    s_add_u32 s46, s46, s47
    v_add_u32 v3, s46, v2
    s_mul_i32 s46, s51, 32768
    v_add_u32 v4, s46, v2
    v_and_b32 v6, 15, v1
    v_lshlrev_b32 v6, 4, v6
    v_lshrrev_b32 v7, 4, v1
    v_lshl_add_u32 v6, v7, 9, v6
    v_add_u32 v4, s46, v6
    s_lshl_b32 s46, s50, 12
    s_add_u32 s46, s46, 131072
    v_add_u32 v5, s46, v2
    v_and_b32 v7, 7, v1
    v_lshlrev_b32 v7, 9, v7
    s_lshl_b32 s46, s42, 12
    s_add_u32 s46, s46, 0x102000
    v_add_u32 v7, s46, v7
    s_lshl_b32 s46, s42, 16
    s_lshl_b32 s47, s43, 11
    s_add_u32 s46, s46, s47
    s_lshl_b32 s47, s50, 9
    s_add_u32 s46, s46, s47
    s_add_u32 s46, s46, 0x9000000
    v_and_b32 v8, 31, v1
    v_lshlrev_b32 v8, 4, v8
    v_lshrrev_b32 v9, 5, v1
    v_lshl_add_u32 v8, v9, 14, v8
    v_add_u32 v8, s46, v8
    v_add_u32 v9, 0x8000, v8
    s_lshl_b32 s52, s43, 9
    s_lshl_b32 s47, s42, 7
    s_add_u32 s52, s52, s47
    s_add_u32 s52, s52, 0x107400
    s_add_u32 s52, s52, s76
    s_mul_i32 s46, s43, 8192
    s_add_u32 s46, s46, 0x5000000
    s_mul_i32 s47, s42, 65536
    s_add_u32 s46, s46, s47
    v_min_u32 v116, 63, v1
    v_lshlrev_b32 v116, 7, v116
    v_add_u32 v116, s46, v116
    s_mov_b32 s60, 0
    s_mul_i32 s61, s74, 262144
    s_mov_b32 s62, 0
    s_mul_i32 s63, s74, 262144
    s_mul_i32 s85, s78, 262144
    s_mul_i32 s86, s78, 262144
    s_sub_u32 s46, s78, 1
    s_sub_u32 s75, s75, s74
    s_add_u32 s75, s75, s46
    s_lshr_b32 s75, s75, s46
    s_mov_b32 s67, 0
    s_mov_b32 s68, 3
    s_mov_b32 s71, 0
    v_mov_b32 v15, 147456
    v_mov_b32 v14, 0
    ds_write_b32 v15, v14 offset:4
    ds_write_b32 v15, v14 offset:12
    ds_write_b32 v15, v14 offset:16
    v_mov_b32 v114, 1
    v_mov_b32 v115, 0
    s_mov_b32 s81, 0
    s_mul_i32 s87, s78, 2
    s_sub_u32 s87, s74, s87
    s_add_u32 s87, s87, 1
    s_lshl_b32 s46, s44, 5
    v_add_u32 v119, s46, v15
    v_lshrrev_b32 v113, 4, v1
    v_mul_u32_u24 v113, s78, v113
    v_add_u32 v113, s74, v113
    s_mov_b32 s72, 0
L_g_restart_153:
    s_cmp_lg_u32 s44, 0
    s_cbranch_scc1 L_g_nsp_154
    s_mov_b32 s70, 0
L_g_sp_160:
    s_add_u32 s54, s60, 0
    s_mul_i32 s55, s54, s78
    v_add_u32 v12, s55, v113
    v_and_b32 v13, 3, v12
    v_lshl_add_u32 v13, v13, 7, v7
    buffer_load_dword v11, v13, s[12:15], 0 offen sc1
    s_waitcnt vmcnt(0)
    v_cmp_ge_u32 vcc, v12, v11
    s_add_u32 s70, s70, 1
    s_and_b32 s46, vcc_lo, 0xffff
    s_cbranch_scc0 L_g_sp_160_ok
    s_sleep 3
    s_cmp_lt_u32 s70, 524288
    s_cbranch_scc1 L_g_sp_160
    s_branch L_c_done_1
L_g_sp_160_ok:
    v_cmp_ge_u32 vcc, v12, v11
    s_nop 0
    s_ff1_i32_b64 s46, vcc
    s_lshr_b32 s46, s46, 4
    s_min_u32 s46, s46, 4
    s_add_u32 s46, s46, s54
    s_min_u32 s46, s46, s75
    v_mov_b32 v118, s46
    ds_write_b32 v15, v118 offset:20
L_g_nsp_154:
    s_waitcnt lgkmcnt(0)
    s_barrier
    ds_read_b32 v14, v15 offset:20
    s_waitcnt lgkmcnt(0)
    v_readfirstlane_b32 s66, v14
    s_nop 3
L_g_restart_153_go:
    s_mov_b32 s69, 0
    s_cmp_gt_u32 s62, s60
    s_cbranch_scc1 L_g_nd_161
    s_cmp_ge_u32 s62, s66
    s_cbranch_scc1 L_g_nd_161
    s_add_u32 s47, s61, 4096
    s_add_u32 m0, s64, 0
    s_nop 0
    buffer_load_dwordx4 v3, s[12:15], s61 offen offset:0 sc1 lds
    buffer_load_dwordx4 v3, s[12:15], s61 offen offset:1024 sc1 lds
    buffer_load_dwordx4 v3, s[12:15], s61 offen offset:2048 sc1 lds
    buffer_load_dwordx4 v3, s[12:15], s61 offen offset:3072 sc1 lds
    s_add_u32 m0, s64, 4096
    s_nop 0
    buffer_load_dwordx4 v3, s[12:15], s47 offen offset:0 sc1 lds
    buffer_load_dwordx4 v3, s[12:15], s47 offen offset:1024 sc1 lds
    buffer_load_dwordx4 v3, s[12:15], s47 offen offset:2048 sc1 lds
    buffer_load_dwordx4 v3, s[12:15], s47 offen offset:3072 sc1 lds
    s_add_u32 s61, s61, s85
    s_add_u32 s62, s62, 1
    s_xor_b32 s64, s64, 0x10000
    s_mov_b32 s69, 1
L_g_nd_161:
    s_cmp_eq_u32 s51, 1
    s_cbranch_scc1 L_g_g1r_155
    s_add_u32 s59, s60, 1
    s_mov_b32 s69, 0
    s_cmp_gt_u32 s62, s59
    s_cbranch_scc1 L_g_nd_162
    s_cmp_ge_u32 s62, s66
    s_cbranch_scc1 L_g_nd_162
    s_add_u32 s47, s61, 4096
    s_add_u32 m0, s64, 0
    s_nop 0
    buffer_load_dwordx4 v3, s[12:15], s61 offen offset:0 sc1 lds
    buffer_load_dwordx4 v3, s[12:15], s61 offen offset:1024 sc1 lds
    buffer_load_dwordx4 v3, s[12:15], s61 offen offset:2048 sc1 lds
    buffer_load_dwordx4 v3, s[12:15], s61 offen offset:3072 sc1 lds
    s_add_u32 m0, s64, 4096
    s_nop 0
    buffer_load_dwordx4 v3, s[12:15], s47 offen offset:0 sc1 lds
    buffer_load_dwordx4 v3, s[12:15], s47 offen offset:1024 sc1 lds
    buffer_load_dwordx4 v3, s[12:15], s47 offen offset:2048 sc1 lds
    buffer_load_dwordx4 v3, s[12:15], s47 offen offset:3072 sc1 lds
    s_add_u32 s61, s61, s85
    s_add_u32 s62, s62, 1
    s_xor_b32 s64, s64, 0x10000
    s_mov_b32 s69, 1
L_g_nd_162:
    s_cmp_eq_u32 s69, 1
    s_cbranch_scc1 L_g_w0_163
    s_waitcnt vmcnt(0)
L_g_w0_163:
    s_waitcnt vmcnt(8)
    s_cmp_lg_u32 s44, 0
    s_cbranch_scc1 L_g_nl_164
    s_cmp_lt_u32 s66, s75
    s_cselect_b32 s81, 1, 2
L_g_nl_164:
L_g_loop0_156_l:
    s_barrier
    ds_read_b128 v[32:35], v4 offset:0
    ds_read_b128 v[36:39], v4 offset:256
    ds_read_b128 v[40:43], v4 offset:2048
    ds_read_b128 v[44:47], v4 offset:2304
    ds_read_b128 v[48:51], v4 offset:4096
    ds_read_b128 v[52:55], v4 offset:4352
    ds_read_b128 v[56:59], v4 offset:6144
    ds_read_b128 v[60:63], v4 offset:6400
    s_branch L_g_loop0_156_m
.p2align 6
L_g_loop0_156:
    s_barrier
L_g_loop0_156_m:
    s_setprio 2
    s_waitcnt lgkmcnt(6)
    v_mfma_f32_16x16x32_bf16 v[16:19], v[32:35], a[0:3], 0
    v_mfma_f32_16x16x32_bf16 v[20:23], v[32:35], a[4:7], 0
    ds_read_b128 v[32:35], v4 offset:8192
    v_mfma_f32_16x16x32_bf16 v[28:31], v[36:39], a[4:7], 0
    v_mfma_f32_16x16x32_bf16 v[24:27], v[36:39], a[0:3], 0
    ds_read_b128 v[36:39], v4 offset:8448
    s_cmp_eq_u32 s81, 1
    s_cbranch_scc1 L_g_h1_168
L_g_h1_168_b:
    s_waitcnt lgkmcnt(6)
    v_mfma_f32_16x16x32_bf16 v[16:19], v[40:43], a[8:11], v[16:19]
    v_mfma_f32_16x16x32_bf16 v[20:23], v[40:43], a[12:15], v[20:23]
    ds_read_b128 v[40:43], v4 offset:10240
    v_mfma_f32_16x16x32_bf16 v[28:31], v[44:47], a[12:15], v[28:31]
    v_mfma_f32_16x16x32_bf16 v[24:27], v[44:47], a[8:11], v[24:27]
    ds_read_b128 v[44:47], v4 offset:10496
    s_waitcnt lgkmcnt(6)
    v_mfma_f32_16x16x32_bf16 v[16:19], v[48:51], a[16:19], v[16:19]
    v_mfma_f32_16x16x32_bf16 v[20:23], v[48:51], a[20:23], v[20:23]
    ds_read_b128 v[48:51], v4 offset:12288
    v_mfma_f32_16x16x32_bf16 v[28:31], v[52:55], a[20:23], v[28:31]
    v_mfma_f32_16x16x32_bf16 v[24:27], v[52:55], a[16:19], v[24:27]
    ds_read_b128 v[52:55], v4 offset:12544
    s_waitcnt lgkmcnt(6)
    v_mfma_f32_16x16x32_bf16 v[16:19], v[56:59], a[24:27], v[16:19]
    v_mfma_f32_16x16x32_bf16 v[20:23], v[56:59], a[28:31], v[20:23]
    ds_read_b128 v[56:59], v4 offset:14336
    v_mfma_f32_16x16x32_bf16 v[28:31], v[60:63], a[28:31], v[28:31]
    v_mfma_f32_16x16x32_bf16 v[24:27], v[60:63], a[24:27], v[24:27]
    ds_read_b128 v[60:63], v4 offset:14592
    s_waitcnt lgkmcnt(6)
    v_mfma_f32_16x16x32_bf16 v[16:19], v[32:35], a[32:35], v[16:19]
    v_mfma_f32_16x16x32_bf16 v[20:23], v[32:35], a[36:39], v[20:23]
    ds_read_b128 v[32:35], v4 offset:16384
    v_mfma_f32_16x16x32_bf16 v[28:31], v[36:39], a[36:39], v[28:31]
    v_mfma_f32_16x16x32_bf16 v[24:27], v[36:39], a[32:35], v[24:27]
    ds_read_b128 v[36:39], v4 offset:16640
    s_waitcnt lgkmcnt(6)
    v_mfma_f32_16x16x32_bf16 v[16:19], v[40:43], a[40:43], v[16:19]
    v_mfma_f32_16x16x32_bf16 v[20:23], v[40:43], a[44:47], v[20:23]
    ds_read_b128 v[40:43], v4 offset:18432
    v_mfma_f32_16x16x32_bf16 v[28:31], v[44:47], a[44:47], v[28:31]
    v_mfma_f32_16x16x32_bf16 v[24:27], v[44:47], a[40:43], v[24:27]
    ds_read_b128 v[44:47], v4 offset:18688
    s_waitcnt lgkmcnt(6)
    v_mfma_f32_16x16x32_bf16 v[16:19], v[48:51], a[48:51], v[16:19]
    v_mfma_f32_16x16x32_bf16 v[20:23], v[48:51], a[52:55], v[20:23]
    ds_read_b128 v[48:51], v4 offset:20480
    v_mfma_f32_16x16x32_bf16 v[28:31], v[52:55], a[52:55], v[28:31]
    v_mfma_f32_16x16x32_bf16 v[24:27], v[52:55], a[48:51], v[24:27]
    ds_read_b128 v[52:55], v4 offset:20736
    s_waitcnt lgkmcnt(6)
    v_mfma_f32_16x16x32_bf16 v[16:19], v[56:59], a[56:59], v[16:19]
    v_mfma_f32_16x16x32_bf16 v[20:23], v[56:59], a[60:63], v[20:23]
    ds_read_b128 v[56:59], v4 offset:22528
    v_mfma_f32_16x16x32_bf16 v[28:31], v[60:63], a[60:63], v[28:31]
    v_mfma_f32_16x16x32_bf16 v[24:27], v[60:63], a[56:59], v[24:27]
    ds_read_b128 v[60:63], v4 offset:22784
    s_waitcnt lgkmcnt(6)
    v_mfma_f32_16x16x32_bf16 v[16:19], v[32:35], a[64:67], v[16:19]
    v_mfma_f32_16x16x32_bf16 v[20:23], v[32:35], a[68:71], v[20:23]
    ds_read_b128 v[32:35], v4 offset:24576
    v_mfma_f32_16x16x32_bf16 v[28:31], v[36:39], a[68:71], v[28:31]
    v_mfma_f32_16x16x32_bf16 v[24:27], v[36:39], a[64:67], v[24:27]
    ds_read_b128 v[36:39], v4 offset:24832
    s_waitcnt lgkmcnt(6)
    v_mfma_f32_16x16x32_bf16 v[16:19], v[40:43], a[72:75], v[16:19]
    v_mfma_f32_16x16x32_bf16 v[20:23], v[40:43], a[76:79], v[20:23]
    ds_read_b128 v[40:43], v4 offset:26624
    v_mfma_f32_16x16x32_bf16 v[28:31], v[44:47], a[76:79], v[28:31]
    v_mfma_f32_16x16x32_bf16 v[24:27], v[44:47], a[72:75], v[24:27]
    ds_read_b128 v[44:47], v4 offset:26880
    s_waitcnt lgkmcnt(6)
    v_mfma_f32_16x16x32_bf16 v[16:19], v[48:51], a[80:83], v[16:19]
    v_mfma_f32_16x16x32_bf16 v[20:23], v[48:51], a[84:87], v[20:23]
    ds_read_b128 v[48:51], v4 offset:28672
    v_mfma_f32_16x16x32_bf16 v[28:31], v[52:55], a[84:87], v[28:31]
    v_mfma_f32_16x16x32_bf16 v[24:27], v[52:55], a[80:83], v[24:27]
    ds_read_b128 v[52:55], v4 offset:28928
    s_waitcnt lgkmcnt(6)
    v_mfma_f32_16x16x32_bf16 v[16:19], v[56:59], a[88:91], v[16:19]
    v_mfma_f32_16x16x32_bf16 v[20:23], v[56:59], a[92:95], v[20:23]
    ds_read_b128 v[56:59], v4 offset:30720
    v_mfma_f32_16x16x32_bf16 v[28:31], v[60:63], a[92:95], v[28:31]
    v_mfma_f32_16x16x32_bf16 v[24:27], v[60:63], a[88:91], v[24:27]
    ds_read_b128 v[60:63], v4 offset:30976
    s_waitcnt lgkmcnt(6)
    v_mfma_f32_16x16x32_bf16 v[16:19], v[32:35], a[96:99], v[16:19]
    v_mfma_f32_16x16x32_bf16 v[20:23], v[32:35], a[100:103], v[20:23]
    v_mfma_f32_16x16x32_bf16 v[28:31], v[36:39], a[100:103], v[28:31]
    v_mfma_f32_16x16x32_bf16 v[24:27], v[36:39], a[96:99], v[24:27]
    s_waitcnt lgkmcnt(4)
    v_mfma_f32_16x16x32_bf16 v[16:19], v[40:43], a[104:107], v[16:19]
    v_mfma_f32_16x16x32_bf16 v[20:23], v[40:43], a[108:111], v[20:23]
    v_mfma_f32_16x16x32_bf16 v[28:31], v[44:47], a[108:111], v[28:31]
    v_mfma_f32_16x16x32_bf16 v[24:27], v[44:47], a[104:107], v[24:27]
    s_waitcnt lgkmcnt(2)
    v_mfma_f32_16x16x32_bf16 v[16:19], v[48:51], a[112:115], v[16:19]
    v_mfma_f32_16x16x32_bf16 v[20:23], v[48:51], a[116:119], v[20:23]
    s_cmp_eq_u32 s81, 1
    s_cbranch_scc1 L_g_h2_169
L_g_h2_169_b:
    ds_write_b32 v119, v118
    v_mfma_f32_16x16x32_bf16 v[28:31], v[52:55], a[116:119], v[28:31]
    v_mfma_f32_16x16x32_bf16 v[24:27], v[52:55], a[112:115], v[24:27]
    s_waitcnt lgkmcnt(0)
    v_mfma_f32_16x16x32_bf16 v[16:19], v[56:59], a[120:123], v[16:19]
    v_mfma_f32_16x16x32_bf16 v[20:23], v[56:59], a[124:127], v[20:23]
    v_mfma_f32_16x16x32_bf16 v[28:31], v[60:63], a[124:127], v[28:31]
    v_mfma_f32_16x16x32_bf16 v[24:27], v[60:63], a[120:123], v[24:27]
    v_xor_b32 v4, 0x10000, v4
    s_setprio 0
    s_waitcnt vmcnt(0)
    s_waitcnt lgkmcnt(0)
    s_barrier
    ds_read_b32 v14, v15
    s_nop 6
    ds_write_b128 v5, v[16:19] offset:0
    ds_write_b128 v5, v[20:23] offset:1024
    ds_write_b128 v5, v[24:27] offset:2048
    ds_write_b128 v5, v[28:31] offset:3072
    s_waitcnt lgkmcnt(4)
    v_readfirstlane_b32 s66, v14
    s_add_u32 s60, s60, 1
    s_mov_b32 s65, 0
    s_cmp_le_u32 s62, s60
    s_cbranch_scc1 L_g_dp_170_l
L_g_dp_170_a:
    s_cmp_ge_u32 s62, s66
    s_cbranch_scc1 L_g_dp_170_d
    s_add_u32 s47, s61, 4096
    s_mov_b32 m0, s64
    s_add_u32 s62, s62, 1
    buffer_load_dwordx4 v3, s[12:15], s61 offen offset:0 sc1 lds
    buffer_load_dwordx4 v3, s[12:15], s61 offen offset:1024 sc1 lds
    buffer_load_dwordx4 v3, s[12:15], s61 offen offset:2048 sc1 lds
    buffer_load_dwordx4 v3, s[12:15], s61 offen offset:3072 sc1 lds
    s_add_u32 m0, s64, 4096
    s_add_u32 s61, s61, s85
    buffer_load_dwordx4 v3, s[12:15], s47 offen offset:0 sc1 lds
    buffer_load_dwordx4 v3, s[12:15], s47 offen offset:1024 sc1 lds
    buffer_load_dwordx4 v3, s[12:15], s47 offen offset:2048 sc1 lds
    buffer_load_dwordx4 v3, s[12:15], s47 offen offset:3072 sc1 lds
    s_xor_b32 s64, s64, 0x10000
L_g_dp_170_d:
    s_cmp_lg_u32 s44, 2
    s_cbranch_scc1 L_g_pf_171
    s_cmp_ge_u32 s62, s66
    s_cbranch_scc1 L_g_pf_171
    buffer_load_dword v117, v116, s[12:15], s61 offen sc1
L_g_pf_171:
    s_cmp_le_u32 s66, s60
    s_cbranch_scc1 L_g_ex0_167
    s_cmp_lg_u32 s65, 0
    s_cbranch_scc1 L_g_nw_166
    ds_read_b128 v[32:35], v4 offset:0
    ds_read_b128 v[36:39], v4 offset:256
    ds_read_b128 v[40:43], v4 offset:2048
    ds_read_b128 v[44:47], v4 offset:2304
    ds_read_b128 v[48:51], v4 offset:4096
    ds_read_b128 v[52:55], v4 offset:4352
    ds_read_b128 v[56:59], v4 offset:6144
    ds_read_b128 v[60:63], v4 offset:6400
    s_cmp_lg_u32 s44, 0
    s_cbranch_scc1 L_g_nl_172
    s_mov_b32 s46, s66
    s_cmp_lg_u32 s81, 0
    s_cbranch_scc1 L_g_nl_172_e
    v_cmp_ge_u32 vcc, v12, v11
    s_nop 0
    s_ff1_i32_b64 s46, vcc
    s_lshr_b32 s46, s46, 4
    s_min_u32 s46, s46, 4
    s_add_u32 s46, s46, s54
    s_min_u32 s46, s46, s75
    v_mov_b32 v118, s46
L_g_nl_172_e:
    s_add_u32 s47, s60, 3
    s_min_u32 s47, s47, s75
    s_cmp_lt_u32 s46, s47
    s_cselect_b32 s81, 1, 0
    s_cbranch_scc1 L_g_nl_172
    s_add_u32 s54, s60, 2
    s_mul_i32 s55, s54, s78
    v_add_u32 v12, s55, v113
    v_and_b32 v13, 3, v12
    v_lshl_add_u32 v13, v13, 7, v7
    buffer_load_dword v11, v13, s[12:15], 0 offen sc1
L_g_nl_172:
    s_waitcnt lgkmcnt(8)
    s_branch L_g_loop0_156
L_g_ex0_167:
    s_cmp_lg_u32 s44, 0
    s_cbranch_scc1 L_g_ex0_167_n
    ds_write_b32 v15, v118 offset:20
    s_cmp_ge_u32 s60, s75
    s_cbranch_scc1 L_g_ex0_167_n
    s_sleep 6
    s_add_u32 s54, s60, 0
    s_mul_i32 s55, s54, s78
    v_add_u32 v12, s55, v113
    v_and_b32 v13, 3, v12
    v_lshl_add_u32 v13, v13, 7, v7
    buffer_load_dword v11, v13, s[12:15], 0 offen sc1
    s_waitcnt vmcnt(0)
    v_cmp_ge_u32 vcc, v12, v11
    s_nop 0
    s_ff1_i32_b64 s46, vcc
    s_lshr_b32 s46, s46, 4
    s_min_u32 s46, s46, 4
    s_add_u32 s46, s46, s54
    s_min_u32 s46, s46, s75
    v_mov_b32 v118, s46
    ds_write_b32 v15, v118 offset:20
L_g_ex0_167_n:
    s_waitcnt lgkmcnt(0)
    s_barrier
    ds_read_b32 v14, v15 offset:20
    s_waitcnt lgkmcnt(0)
    v_readfirstlane_b32 s66, v14
    s_barrier
    s_cmp_gt_u32 s66, s60
    s_cbranch_scc1 L_g_restart_153_go
    s_branch L_g_tail_158
L_g_g1r_155:
    s_mov_b32 s65, 1
    s_branch L_g_loop1_157_e
.p2align 6
L_g_loop1_157:
    s_mov_b32 s65, 0
L_g_loop1_157_e:
    s_barrier
    s_bitcmp1_b32 s67, 1
    s_cbranch_scc0 L_g_nfl_173
    s_cmp_lg_u32 s44, 4
    s_cbranch_scc1 L_g_nfl_173_d
    s_mul_i32 s59, s60, s78
    s_add_u32 s59, s59, s87
    v_mov_b32 v10, s59
    buffer_store_dword v10, v115, s[12:15], s52 offen sc1
L_g_nfl_173_d:
    ds_read_b128 v[80:83], v5 offset:0
    ds_read_b128 v[84:87], v5 offset:1024
    ds_read_b128 v[88:91], v5 offset:2048
    ds_read_b128 v[92:95], v5 offset:3072
    s_cmp_le_u32 s62, s60
    s_cbranch_scc1 L_g_dp_178_l
L_g_dp_178_a:
    s_cmp_ge_u32 s62, s66
    s_cbranch_scc1 L_g_dp_178_d
    s_add_u32 s47, s61, 4096
    s_mov_b32 m0, s64
    s_add_u32 s62, s62, 1
    buffer_load_dwordx4 v3, s[12:15], s61 offen offset:0 sc1 lds
    buffer_load_dwordx4 v3, s[12:15], s61 offen offset:1024 sc1 lds
    buffer_load_dwordx4 v3, s[12:15], s61 offen offset:2048 sc1 lds
    buffer_load_dwordx4 v3, s[12:15], s61 offen offset:3072 sc1 lds
    s_add_u32 m0, s64, 4096
    s_add_u32 s61, s61, s85
    buffer_load_dwordx4 v3, s[12:15], s47 offen offset:0 sc1 lds
    buffer_load_dwordx4 v3, s[12:15], s47 offen offset:1024 sc1 lds
    buffer_load_dwordx4 v3, s[12:15], s47 offen offset:2048 sc1 lds
    buffer_load_dwordx4 v3, s[12:15], s47 offen offset:3072 sc1 lds
    s_xor_b32 s64, s64, 0x10000
L_g_dp_178_d:
    s_bitcmp1_b32 s67, 0
    s_cbranch_scc0 L_g_nep_174
    s_waitcnt lgkmcnt(0)
    v_add_f32 v80, v80, v16
    v_add_f32 v81, v81, v17
    v_add_f32 v82, v82, v18
    v_add_f32 v83, v83, v19
    v_add_f32 v84, v84, v20
    v_add_f32 v85, v85, v21
    v_add_f32 v86, v86, v22
    v_add_f32 v87, v87, v23
    v_add_f32 v88, v88, v24
    v_add_f32 v89, v89, v25
    v_add_f32 v90, v90, v26
    v_add_f32 v91, v91, v27
    v_add_f32 v92, v92, v28
    v_add_f32 v93, v93, v29
    v_add_f32 v94, v94, v30
    v_add_f32 v95, v95, v31
    v_cvt_pk_bf16_f32 v104, v80, v81
    v_cvt_pk_bf16_f32 v105, v82, v83
    v_cvt_pk_bf16_f32 v106, v84, v85
    v_cvt_pk_bf16_f32 v107, v86, v87
    s_nop 1
    v_permlane16_swap_b32 v104, v106
    v_permlane16_swap_b32 v105, v107
    buffer_store_dwordx4 v[104:107], v8, s[12:15], s63 offen sc1
    v_cvt_pk_bf16_f32 v108, v88, v89
    v_cvt_pk_bf16_f32 v109, v90, v91
    v_cvt_pk_bf16_f32 v110, v92, v93
    v_cvt_pk_bf16_f32 v111, v94, v95
    s_nop 1
    v_permlane16_swap_b32 v108, v110
    v_permlane16_swap_b32 v109, v111
    buffer_store_dwordx4 v[108:111], v9, s[12:15], s63 offen sc1
    s_add_u32 s63, s63, s86
L_g_nep_174:
    s_cmp_lg_u32 s65, 0
    s_cbranch_scc1 L_g_nw1_175
    ds_read_b128 v[32:35], v4 offset:0
    ds_read_b128 v[36:39], v4 offset:256
    ds_read_b128 v[40:43], v4 offset:2048
    ds_read_b128 v[44:47], v4 offset:2304
    ds_read_b128 v[48:51], v4 offset:4096
    ds_read_b128 v[52:55], v4 offset:4352
    ds_read_b128 v[56:59], v4 offset:6144
    ds_read_b128 v[60:63], v4 offset:6400
    s_barrier
L_g_jn_177:
    s_setprio 1
    s_waitcnt lgkmcnt(6)
    v_mfma_f32_16x16x32_bf16 v[16:19], v[32:35], a[0:3], 0
    ds_read_b32 v14, v15
    v_mfma_f32_16x16x32_bf16 v[20:23], v[32:35], a[4:7], 0
    ds_read_b128 v[32:35], v4 offset:8192
    v_mfma_f32_16x16x32_bf16 v[28:31], v[36:39], a[4:7], 0
    v_mfma_f32_16x16x32_bf16 v[24:27], v[36:39], a[0:3], 0
    ds_read_b128 v[36:39], v4 offset:8448
    s_waitcnt lgkmcnt(6)
    v_mfma_f32_16x16x32_bf16 v[16:19], v[40:43], a[8:11], v[16:19]
    v_mfma_f32_16x16x32_bf16 v[20:23], v[40:43], a[12:15], v[20:23]
    ds_read_b128 v[40:43], v4 offset:10240
    v_mfma_f32_16x16x32_bf16 v[28:31], v[44:47], a[12:15], v[28:31]
    v_mfma_f32_16x16x32_bf16 v[24:27], v[44:47], a[8:11], v[24:27]
    ds_read_b128 v[44:47], v4 offset:10496
    s_waitcnt lgkmcnt(6)
    v_mfma_f32_16x16x32_bf16 v[16:19], v[48:51], a[16:19], v[16:19]
    v_mfma_f32_16x16x32_bf16 v[20:23], v[48:51], a[20:23], v[20:23]
    ds_read_b128 v[48:51], v4 offset:12288
    v_mfma_f32_16x16x32_bf16 v[28:31], v[52:55], a[20:23], v[28:31]
    v_mfma_f32_16x16x32_bf16 v[24:27], v[52:55], a[16:19], v[24:27]
    ds_read_b128 v[52:55], v4 offset:12544
    s_waitcnt lgkmcnt(6)
    v_mfma_f32_16x16x32_bf16 v[16:19], v[56:59], a[24:27], v[16:19]
    v_mfma_f32_16x16x32_bf16 v[20:23], v[56:59], a[28:31], v[20:23]
    ds_read_b128 v[56:59], v4 offset:14336
    v_mfma_f32_16x16x32_bf16 v[28:31], v[60:63], a[28:31], v[28:31]
    v_mfma_f32_16x16x32_bf16 v[24:27], v[60:63], a[24:27], v[24:27]
    ds_read_b128 v[60:63], v4 offset:14592
    s_waitcnt lgkmcnt(6)
    v_mfma_f32_16x16x32_bf16 v[16:19], v[32:35], a[32:35], v[16:19]
    v_mfma_f32_16x16x32_bf16 v[20:23], v[32:35], a[36:39], v[20:23]
    ds_read_b128 v[32:35], v4 offset:16384
    v_mfma_f32_16x16x32_bf16 v[28:31], v[36:39], a[36:39], v[28:31]
    v_mfma_f32_16x16x32_bf16 v[24:27], v[36:39], a[32:35], v[24:27]
    ds_read_b128 v[36:39], v4 offset:16640
    s_waitcnt lgkmcnt(6)
    v_mfma_f32_16x16x32_bf16 v[16:19], v[40:43], a[40:43], v[16:19]
    v_mfma_f32_16x16x32_bf16 v[20:23], v[40:43], a[44:47], v[20:23]
    ds_read_b128 v[40:43], v4 offset:18432
    v_mfma_f32_16x16x32_bf16 v[28:31], v[44:47], a[44:47], v[28:31]
    v_mfma_f32_16x16x32_bf16 v[24:27], v[44:47], a[40:43], v[24:27]
    ds_read_b128 v[44:47], v4 offset:18688
    s_waitcnt lgkmcnt(6)
    v_mfma_f32_16x16x32_bf16 v[16:19], v[48:51], a[48:51], v[16:19]
    v_mfma_f32_16x16x32_bf16 v[20:23], v[48:51], a[52:55], v[20:23]
    ds_read_b128 v[48:51], v4 offset:20480
    v_mfma_f32_16x16x32_bf16 v[28:31], v[52:55], a[52:55], v[28:31]
    v_mfma_f32_16x16x32_bf16 v[24:27], v[52:55], a[48:51], v[24:27]
    ds_read_b128 v[52:55], v4 offset:20736
    s_waitcnt lgkmcnt(6)
    v_mfma_f32_16x16x32_bf16 v[16:19], v[56:59], a[56:59], v[16:19]
    v_mfma_f32_16x16x32_bf16 v[20:23], v[56:59], a[60:63], v[20:23]
    ds_read_b128 v[56:59], v4 offset:22528
    v_mfma_f32_16x16x32_bf16 v[28:31], v[60:63], a[60:63], v[28:31]
    v_mfma_f32_16x16x32_bf16 v[24:27], v[60:63], a[56:59], v[24:27]
    ds_read_b128 v[60:63], v4 offset:22784
    s_waitcnt lgkmcnt(6)
    v_mfma_f32_16x16x32_bf16 v[16:19], v[32:35], a[64:67], v[16:19]
    v_mfma_f32_16x16x32_bf16 v[20:23], v[32:35], a[68:71], v[20:23]
    ds_read_b128 v[32:35], v4 offset:24576
    v_mfma_f32_16x16x32_bf16 v[28:31], v[36:39], a[68:71], v[28:31]
    v_mfma_f32_16x16x32_bf16 v[24:27], v[36:39], a[64:67], v[24:27]
    ds_read_b128 v[36:39], v4 offset:24832
    s_waitcnt lgkmcnt(6)
    v_mfma_f32_16x16x32_bf16 v[16:19], v[40:43], a[72:75], v[16:19]
    v_mfma_f32_16x16x32_bf16 v[20:23], v[40:43], a[76:79], v[20:23]
    ds_read_b128 v[40:43], v4 offset:26624
    v_mfma_f32_16x16x32_bf16 v[28:31], v[44:47], a[76:79], v[28:31]
    v_mfma_f32_16x16x32_bf16 v[24:27], v[44:47], a[72:75], v[24:27]
    ds_read_b128 v[44:47], v4 offset:26880
    s_waitcnt lgkmcnt(6)
    v_mfma_f32_16x16x32_bf16 v[16:19], v[48:51], a[80:83], v[16:19]
    v_mfma_f32_16x16x32_bf16 v[20:23], v[48:51], a[84:87], v[20:23]
    ds_read_b128 v[48:51], v4 offset:28672
    v_mfma_f32_16x16x32_bf16 v[28:31], v[52:55], a[84:87], v[28:31]
    v_mfma_f32_16x16x32_bf16 v[24:27], v[52:55], a[80:83], v[24:27]
    ds_read_b128 v[52:55], v4 offset:28928
    s_waitcnt lgkmcnt(6)
    v_mfma_f32_16x16x32_bf16 v[16:19], v[56:59], a[88:91], v[16:19]
    v_mfma_f32_16x16x32_bf16 v[20:23], v[56:59], a[92:95], v[20:23]
    ds_read_b128 v[56:59], v4 offset:30720
    v_mfma_f32_16x16x32_bf16 v[28:31], v[60:63], a[92:95], v[28:31]
    v_mfma_f32_16x16x32_bf16 v[24:27], v[60:63], a[88:91], v[24:27]
    ds_read_b128 v[60:63], v4 offset:30976
    s_waitcnt lgkmcnt(6)
    v_mfma_f32_16x16x32_bf16 v[16:19], v[32:35], a[96:99], v[16:19]
    v_mfma_f32_16x16x32_bf16 v[20:23], v[32:35], a[100:103], v[20:23]
    v_mfma_f32_16x16x32_bf16 v[28:31], v[36:39], a[100:103], v[28:31]
    v_mfma_f32_16x16x32_bf16 v[24:27], v[36:39], a[96:99], v[24:27]
    s_waitcnt lgkmcnt(4)
    v_mfma_f32_16x16x32_bf16 v[16:19], v[40:43], a[104:107], v[16:19]
    v_mfma_f32_16x16x32_bf16 v[20:23], v[40:43], a[108:111], v[20:23]
    v_mfma_f32_16x16x32_bf16 v[28:31], v[44:47], a[108:111], v[28:31]
    v_mfma_f32_16x16x32_bf16 v[24:27], v[44:47], a[104:107], v[24:27]
    s_waitcnt lgkmcnt(2)
    v_mfma_f32_16x16x32_bf16 v[16:19], v[48:51], a[112:115], v[16:19]
    v_mfma_f32_16x16x32_bf16 v[20:23], v[48:51], a[116:119], v[20:23]
    v_mfma_f32_16x16x32_bf16 v[28:31], v[52:55], a[116:119], v[28:31]
    v_mfma_f32_16x16x32_bf16 v[24:27], v[52:55], a[112:115], v[24:27]
    s_waitcnt lgkmcnt(0)
    v_mfma_f32_16x16x32_bf16 v[16:19], v[56:59], a[120:123], v[16:19]
    v_mfma_f32_16x16x32_bf16 v[20:23], v[56:59], a[124:127], v[20:23]
    v_mfma_f32_16x16x32_bf16 v[28:31], v[60:63], a[124:127], v[28:31]
    v_mfma_f32_16x16x32_bf16 v[24:27], v[60:63], a[120:123], v[24:27]
    v_xor_b32 v4, 0x10000, v4
    s_setprio 0
    s_waitcnt vmcnt(0)
    v_readfirstlane_b32 s66, v14
    s_lshl_b32 s67, s67, 1
    s_or_b32 s67, s67, 1
    s_add_u32 s60, s60, 1
    s_cmp_gt_u32 s66, s60
    s_cbranch_scc1 L_g_loop1_157
    s_barrier
    ds_read_b32 v14, v15 offset:20
    ds_read_b128 v[80:83], v5 offset:0
    ds_read_b128 v[84:87], v5 offset:1024
    ds_read_b128 v[88:91], v5 offset:2048
    ds_read_b128 v[92:95], v5 offset:3072
    s_waitcnt lgkmcnt(4)
    v_readfirstlane_b32 s66, v14
    s_barrier
    s_mov_b32 s69, 0
    s_cmp_gt_u32 s62, s60
    s_cbranch_scc1 L_g_nd_179
    s_cmp_ge_u32 s62, s66
    s_cbranch_scc1 L_g_nd_179
    s_add_u32 s47, s61, 4096
    s_add_u32 m0, s64, 0
    s_nop 0
    buffer_load_dwordx4 v3, s[12:15], s61 offen offset:0 sc1 lds
    buffer_load_dwordx4 v3, s[12:15], s61 offen offset:1024 sc1 lds
    buffer_load_dwordx4 v3, s[12:15], s61 offen offset:2048 sc1 lds
    buffer_load_dwordx4 v3, s[12:15], s61 offen offset:3072 sc1 lds
    s_add_u32 m0, s64, 4096
    s_nop 0
    buffer_load_dwordx4 v3, s[12:15], s47 offen offset:0 sc1 lds
    buffer_load_dwordx4 v3, s[12:15], s47 offen offset:1024 sc1 lds
    buffer_load_dwordx4 v3, s[12:15], s47 offen offset:2048 sc1 lds
    buffer_load_dwordx4 v3, s[12:15], s47 offen offset:3072 sc1 lds
    s_add_u32 s61, s61, s85
    s_add_u32 s62, s62, 1
    s_xor_b32 s64, s64, 0x10000
    s_mov_b32 s69, 1
L_g_nd_179:
    s_waitcnt lgkmcnt(3)
    v_add_f32 v80, v80, v16
    v_add_f32 v81, v81, v17
    v_add_f32 v82, v82, v18
    v_add_f32 v83, v83, v19
    s_waitcnt lgkmcnt(2)
    v_add_f32 v84, v84, v20
    v_add_f32 v85, v85, v21
    v_add_f32 v86, v86, v22
    v_add_f32 v87, v87, v23
    s_waitcnt lgkmcnt(1)
    v_add_f32 v88, v88, v24
    v_add_f32 v89, v89, v25
    v_add_f32 v90, v90, v26
    v_add_f32 v91, v91, v27
    s_waitcnt lgkmcnt(0)
    v_add_f32 v92, v92, v28
    v_add_f32 v93, v93, v29
    v_add_f32 v94, v94, v30
    v_add_f32 v95, v95, v31
    v_cvt_pk_bf16_f32 v104, v80, v81
    v_cvt_pk_bf16_f32 v105, v82, v83
    v_cvt_pk_bf16_f32 v106, v84, v85
    v_cvt_pk_bf16_f32 v107, v86, v87
    s_nop 1
    v_permlane16_swap_b32 v104, v106
    v_permlane16_swap_b32 v105, v107
    buffer_store_dwordx4 v[104:107], v8, s[12:15], s63 offen sc1
    v_cvt_pk_bf16_f32 v108, v88, v89
    v_cvt_pk_bf16_f32 v109, v90, v91
    v_cvt_pk_bf16_f32 v110, v92, v93
    v_cvt_pk_bf16_f32 v111, v94, v95
    s_nop 1
    v_permlane16_swap_b32 v108, v110
    v_permlane16_swap_b32 v109, v111
    buffer_store_dwordx4 v[108:111], v9, s[12:15], s63 offen sc1
    s_add_u32 s63, s63, s86
    s_mov_b32 s67, 0
    s_mov_b32 s71, 1
    s_cmp_gt_u32 s66, s60
    s_cbranch_scc1 L_g_g1r_155
    v_mov_b32 v10, 1
    s_mov_b64 exec, 1
    s_waitcnt vmcnt(0)
    ds_add_rtn_u32 v10, v15, v10 offset:4
    s_waitcnt lgkmcnt(0)
    v_readfirstlane_b32 s46, v10
    s_mov_b64 exec, -1
    s_mov_b32 s71, 0
    s_sub_u32 s59, s60, 1
    s_mul_i32 s59, s59, s78
    s_add_u32 s59, s59, s74
    s_cmp_lg_u32 s46, s68
    s_cbranch_scc1 L_g_df_180
    v_mov_b32 v10, s59
    v_add_u32 v10, 1, v10
    v_mov_b32 v11, 0
    s_mov_b64 exec, 1
    buffer_store_dword v10, v11, s[12:15], s52 offen sc1
    s_mov_b64 exec, -1
L_sf_181:
L_g_df_180:
    s_add_u32 s68, s68, 4
    s_cmp_gt_u32 s66, s60
    s_cbranch_scc1 L_g_g1r_155
L_g_tail_158:
    s_cmp_lt_u32 s60, s75
    s_cbranch_scc1 L_g_restart_153
    s_waitcnt vmcnt(0)
    s_barrier
    s_branch L_c_done_1
L_g_h1_168:
    s_add_u32 s54, s60, 1
    s_mul_i32 s55, s54, s78
    v_add_u32 v12, s55, v113
    v_and_b32 v13, 3, v12
    v_lshl_add_u32 v13, v13, 7, v7
    buffer_load_dword v11, v13, s[12:15], 0 offen sc1
    s_branch L_g_h1_168_b
L_g_h2_169:
    s_waitcnt vmcnt(0)
    v_cmp_ge_u32 vcc, v12, v11
    s_nop 0
    s_ff1_i32_b64 s46, vcc
    s_lshr_b32 s46, s46, 4
    s_min_u32 s46, s46, 4
    s_add_u32 s46, s46, s54
    s_min_u32 s46, s46, s75
    v_mov_b32 v118, s46
    s_branch L_g_h2_169_b
L_g_dp_170_l:
    s_cmp_ge_u32 s62, s66
    s_cbranch_scc1 L_g_dp_170_d
    s_mov_b32 s65, 1
    s_add_u32 s47, s61, 4096
    s_mov_b32 m0, s64
    s_add_u32 s62, s62, 1
    buffer_load_dwordx4 v3, s[12:15], s61 offen offset:0 sc1 lds
    buffer_load_dwordx4 v3, s[12:15], s61 offen offset:1024 sc1 lds
    buffer_load_dwordx4 v3, s[12:15], s61 offen offset:2048 sc1 lds
    buffer_load_dwordx4 v3, s[12:15], s61 offen offset:3072 sc1 lds
    s_add_u32 m0, s64, 4096
    s_add_u32 s61, s61, s85
    buffer_load_dwordx4 v3, s[12:15], s47 offen offset:0 sc1 lds
    buffer_load_dwordx4 v3, s[12:15], s47 offen offset:1024 sc1 lds
    buffer_load_dwordx4 v3, s[12:15], s47 offen offset:2048 sc1 lds
    buffer_load_dwordx4 v3, s[12:15], s47 offen offset:3072 sc1 lds
    s_xor_b32 s64, s64, 0x10000
    s_branch L_g_dp_170_a
L_g_nw_166:
    s_waitcnt vmcnt(0) lgkmcnt(0)
    s_cmp_lg_u32 s44, 0
    s_cbranch_scc1 L_g_nl_182
    s_cmp_lt_u32 s66, s75
    s_cselect_b32 s81, 1, 2
L_g_nl_182:
    s_branch L_g_loop0_156_l
L_g_nfl_173:
    s_cmp_eq_u32 s71, 0
    s_cbranch_scc1 L_g_nfl_173_d
    v_mov_b32 v10, 1
    s_mov_b64 exec, 1
    s_waitcnt vmcnt(0)
    ds_add_rtn_u32 v10, v15, v10 offset:4
    s_waitcnt lgkmcnt(0)
    v_readfirstlane_b32 s46, v10
    s_mov_b64 exec, -1
    s_mov_b32 s71, 0
    s_sub_u32 s59, s60, 1
    s_mul_i32 s59, s59, s78
    s_add_u32 s59, s59, s74
    s_cmp_lg_u32 s46, s68
    s_cbranch_scc1 L_g_df_183
    v_mov_b32 v10, s59
    v_add_u32 v10, 1, v10
    v_mov_b32 v11, 0
    s_mov_b64 exec, 1
    buffer_store_dword v10, v11, s[12:15], s52 offen sc1
    s_mov_b64 exec, -1
L_sf_184:
L_g_df_183:
    s_add_u32 s68, s68, 4
    s_mov_b32 s65, 2
    s_branch L_g_nfl_173_d
L_g_dp_178_l:
    s_cmp_ge_u32 s62, s66
    s_cbranch_scc1 L_g_dp_178_d
    s_or_b32 s65, s65, 1
    s_add_u32 s47, s61, 4096
    s_mov_b32 m0, s64
    s_add_u32 s62, s62, 1
    buffer_load_dwordx4 v3, s[12:15], s61 offen offset:0 sc1 lds
    buffer_load_dwordx4 v3, s[12:15], s61 offen offset:1024 sc1 lds
    buffer_load_dwordx4 v3, s[12:15], s61 offen offset:2048 sc1 lds
    buffer_load_dwordx4 v3, s[12:15], s61 offen offset:3072 sc1 lds
    s_add_u32 m0, s64, 4096
    s_add_u32 s61, s61, s85
    buffer_load_dwordx4 v3, s[12:15], s47 offen offset:0 sc1 lds
    buffer_load_dwordx4 v3, s[12:15], s47 offen offset:1024 sc1 lds
    buffer_load_dwordx4 v3, s[12:15], s47 offen offset:2048 sc1 lds
    buffer_load_dwordx4 v3, s[12:15], s47 offen offset:3072 sc1 lds
    s_xor_b32 s64, s64, 0x10000
    s_branch L_g_dp_178_a
L_g_nw1_175:
    s_cmp_eq_u32 s65, 2
    s_cbranch_scc1 L_g_nw1_175_w
    s_waitcnt vmcnt(0)
L_g_nw1_175_w:
    s_barrier
    ds_read_b128 v[32:35], v4 offset:0
    ds_read_b128 v[36:39], v4 offset:256
    ds_read_b128 v[40:43], v4 offset:2048
    ds_read_b128 v[44:47], v4 offset:2304
    ds_read_b128 v[48:51], v4 offset:4096
    ds_read_b128 v[52:55], v4 offset:4352
    ds_read_b128 v[56:59], v4 offset:6144
    ds_read_b128 v[60:63], v4 offset:6400
    s_branch L_g_jn_177
L_c_chain_9:
    v_mov_b32 v4, 0
    v_mov_b32 v5, 0
    v_mov_b32 v6, 0
    v_mov_b32 v7, 0
    v_mov_b32 v8, 0
    v_mov_b32 v9, 0
    v_mov_b32 v10, 0
    v_mov_b32 v11, 0
    v_mov_b32 v12, 0
    v_mov_b32 v13, 0
    v_mov_b32 v14, 0
    v_mov_b32 v15, 0
    v_mov_b32 v32, -1
    v_mov_b32 v33, -1
    v_mov_b32 v34, -1
    v_mov_b32 v35, -1
    v_lshlrev_b32 v2, 4, v1
    s_lshl_b32 s45, s40, 16
    s_lshl_b32 s46, s41, 12
    s_add_u32 s45, s45, s46
    s_and_b32 s46, s44, 3
    s_lshl_b32 s46, s46, 10
    s_add_u32 s45, s45, s46
    s_lshr_b32 s46, s44, 2
    s_lshl_b32 s46, s46, 19
    s_add_u32 s45, s45, s46
    s_add_u32 s45, s45, 0x7000000
    buffer_store_dwordx4 v[32:35], v2, s[12:15], s45 offen sc1
    s_lshl_b32 s45, s40, 15
    s_lshl_b32 s46, s41, 11
    s_add_u32 s45, s45, s46
    s_lshl_b32 s46, s44, 8
    s_add_u32 s45, s45, s46
    s_add_u32 s45, s45, 0x7100000
    s_mov_b64 exec, 0xffff
    buffer_store_dwordx4 v[32:35], v2, s[12:15], s45 offen sc1
    s_lshl_b32 s45, s40, 16
    s_lshl_b32 s46, s41, 8
    s_add_u32 s45, s45, s46
    s_and_b32 s46, s44, 3
    s_lshl_b32 s46, s46, 14
    s_add_u32 s45, s45, s46
    s_add_u32 s45, s45, 0x7180000
    buffer_store_dwordx4 v[32:35], v2, s[12:15], s45 offen sc1
    s_mov_b64 exec, -1
    s_and_b32 s47, s44, 3
    s_cmp_eq_u32 s47, 3
    s_cbranch_scc1 L_c_t3_185
    s_cmp_eq_u32 s40, 7
    s_cselect_b32 s46, 8, 4
    s_cmp_ge_u32 s44, s46
    s_cbranch_scc1 L_c_t3_185
    s_lshl_b32 s46, s47, 3
    s_add_u32 s46, s46, 16
    s_load_dwordx2 s[4:5], s[0:1], s46
    v_lshlrev_b32 v2, 13, v1
    s_lshl_b32 s45, s41, 19
    s_lshl_b32 s46, s40, 10
    s_add_u32 s45, s45, s46
    s_add_u32 s45, s45, 384
    s_lshr_b32 s46, s44, 2
    s_lshl_b32 s46, s46, 9
    s_add_u32 s45, s45, s46
    s_waitcnt lgkmcnt(0)
    s_mov_b32 s24, s4
    s_and_b32 s25, s5, 0xffff
    s_mov_b32 s26, 0x800000
    s_mov_b32 s27, 0x00020000
    buffer_load_dword v110, v2, s[24:27], s45 offen
L_c_t3_185:
    s_cmp_lg_u32 s44, 3
    s_cbranch_scc1 L_c_t3_185_o
    s_load_dwordx2 s[4:5], s[0:1], 40
    v_lshlrev_b32 v2, 10, v1
    s_lshl_b32 s45, s40, 20
    s_lshl_b32 s46, s41, 16
    s_add_u32 s45, s45, s46
    s_add_u32 s45, s45, 384
    s_waitcnt lgkmcnt(0)
    s_mov_b32 s24, s4
    s_and_b32 s25, s5, 0xffff
    s_mov_b32 s26, 0x800000
    s_mov_b32 s27, 0x00020000
    buffer_load_dword v110, v2, s[24:27], s45 offen
L_c_t3_185_o:
    v_lshlrev_b32 v2, 4, v1
    v_and_b32 v3, 8, v1
    v_cmp_eq_u32 vcc, 0, v3
    v_mov_b32 v3, 0xeeeeeeee
    v_mov_b32 v4, 0x44444444
    v_cndmask_b32 v3, v3, v4, vcc
    v_and_b32 v100, 15, v1
    v_lshrrev_b32 v101, 4, v1
    v_and_b32 v102, 1, v101
    v_lshrrev_b32 v103, 1, v101
    v_lshlrev_b32 v104, 2, v102
    v_lshl_add_u32 v104, v103, 1, v104
    v_and_b32 v105, 1, v1
    v_add_u32 v104, v104, v105
    v_and_b32 v106, 7, v1
    v_bfe_u32 v107, v1, 3, 1
    s_lshr_b32 s42, s41, 2
    s_and_b32 s43, s41, 3
    s_lshl_b32 s49, s40, 2
    s_add_u32 s49, s49, s42
    s_lshl_b32 s45, s44, 14
    v_lshlrev_b32 v22, 3, v101
    v_bfe_u32 v23, v1, 2, 2
    v_add_u32 v22, v22, v23
    v_and_b32 v23, 3, v1
    v_lshlrev_b32 v24, 3, v23
    v_lshl_add_u32 v20, v22, 6, v24
    v_lshl_add_u32 v21, v22, 7, v24
    v_lshrrev_b32 v22, 2, v1
    v_lshlrev_b32 v23, 4, v23
    v_lshl_add_u32 v24, v22, 13, v23
    v_lshrrev_b32 v22, 3, v1
    v_lshlrev_b32 v23, 4, v106
    v_lshl_add_u32 v25, v22, 11, v23
    s_cmp_ge_u32 s44, 4
    s_cbranch_scc1 L_v_init_186
    s_lshr_b32 s50, s44, 1
    s_and_b32 s51, s44, 1
    s_load_dwordx4 s[4:7], s[0:1], 16
    s_lshl_b32 s46, s49, 8
    s_lshl_b32 s48, s43, 6
    s_add_u32 s46, s46, s48
    s_lshl_b32 s48, s44, 21
    s_add_u32 s46, s46, s48
    s_lshl_b32 s52, s51, 5
    s_xor_b32 s53, s50, 1
    s_lshl_b32 s53, s53, 16
    s_add_u32 s52, s52, s53
    v_add_u32 v20, s52, v20
    s_waitcnt lgkmcnt(0)
    s_mov_b32 s24, s6
    s_and_b32 s25, s7, 0xffff
    s_mov_b32 s26, 0x800000
    s_mov_b32 s27, 0x00020000
    s_mov_b32 s28, s4
    s_and_b32 s29, s5, 0xffff
    s_mov_b32 s30, 0x800000
    s_mov_b32 s31, 0x00020000
    s_lshl_b32 s52, s51, 9
    s_lshl_b32 s53, s50, 7
    s_add_u32 s52, s52, s53
    s_add_u32 s52, s52, 61440
    v_lshlrev_b32 v5, 1, v106
    v_lshl_add_u32 v5, v107, 8, v5
    v_lshl_add_u32 v5, v102, 6, v5
    v_lshl_add_u32 v5, v103, 5, v5
    v_add_u32 v5, s52, v5
    s_lshl_b32 s67, s49, 12
    s_lshl_b32 s53, s43, 10
    s_add_u32 s67, s67, s53
    s_add_u32 s67, s67, 0x1000000
    s_lshl_b32 s52, s40, 16
    s_lshl_b32 s53, s44, 11
    s_add_u32 s53, s52, s53
    s_add_u32 s53, s53, 0x7080000
    v_lshlrev_b32 v7, 3, v1
    v_add_u32 v7, s53, v7
    s_lshl_b32 s53, s44, 9
    s_add_u32 s53, s52, s53
    s_add_u32 s53, s53, 0x7180000
    v_lshlrev_b32 v28, 6, v103
    v_lshl_add_u32 v28, v106, 3, v28
    v_lshl_add_u32 v28, v102, 2, v28
    v_lshl_add_u32 v28, v107, 1, v28
    v_add_u32 v28, s53, v28
    s_lshl_b32 s52, s44, 10
    s_add_u32 s52, s52, 16384
    v_lshlrev_b32 v8, 8, v101
    v_lshl_add_u32 v8, v106, 4, v8
    v_lshl_add_u32 v8, v107, 3, v8
    v_add_u32 v8, s52, v8
    s_lshl_b32 s52, s44, 8
    s_add_u32 s52, s52, 20480
    v_lshlrev_b32 v9, 4, v106
    v_lshl_add_u32 v9, v101, 2, v9
    v_lshl_add_u32 v9, v107, 1, v9
    v_add_u32 v9, s52, v9
    s_mov_b32 s66, 0x3e0293ee
    s_add_u32 m0, s45, 0
    s_add_u32 s48, s46, 0x0
    buffer_load_dwordx4 v24, s[24:27], s48 offen  lds
    s_add_u32 m0, s45, 1024
    s_add_u32 s48, s46, 0x20000
    buffer_load_dwordx4 v24, s[24:27], s48 offen  lds
    s_add_u32 m0, s45, 2048
    s_add_u32 s48, s46, 0x40000
    buffer_load_dwordx4 v24, s[24:27], s48 offen  lds
    s_add_u32 m0, s45, 3072
    s_add_u32 s48, s46, 0x60000
    buffer_load_dwordx4 v24, s[24:27], s48 offen  lds
    s_add_u32 m0, s45, 4096
    s_add_u32 s48, s46, 0x80000
    buffer_load_dwordx4 v24, s[24:27], s48 offen  lds
    s_add_u32 m0, s45, 5120
    s_add_u32 s48, s46, 0xa0000
    buffer_load_dwordx4 v24, s[24:27], s48 offen  lds
    s_add_u32 m0, s45, 6144
    s_add_u32 s48, s46, 0xc0000
    buffer_load_dwordx4 v24, s[24:27], s48 offen  lds
    s_add_u32 m0, s45, 7168
    s_add_u32 s48, s46, 0xe0000
    buffer_load_dwordx4 v24, s[24:27], s48 offen  lds
    s_add_u32 m0, s45, 8192
    s_add_u32 s48, s46, 0x100000
    buffer_load_dwordx4 v24, s[24:27], s48 offen  lds
    s_add_u32 m0, s45, 9216
    s_add_u32 s48, s46, 0x120000
    buffer_load_dwordx4 v24, s[24:27], s48 offen  lds
    s_add_u32 m0, s45, 10240
    s_add_u32 s48, s46, 0x140000
    buffer_load_dwordx4 v24, s[24:27], s48 offen  lds
    s_add_u32 m0, s45, 11264
    s_add_u32 s48, s46, 0x160000
    buffer_load_dwordx4 v24, s[24:27], s48 offen  lds
    s_add_u32 m0, s45, 12288
    s_add_u32 s48, s46, 0x180000
    buffer_load_dwordx4 v24, s[24:27], s48 offen  lds
    s_add_u32 m0, s45, 13312
    s_add_u32 s48, s46, 0x1a0000
    buffer_load_dwordx4 v24, s[24:27], s48 offen  lds
    s_add_u32 m0, s45, 14336
    s_add_u32 s48, s46, 0x1c0000
    buffer_load_dwordx4 v24, s[24:27], s48 offen  lds
    s_add_u32 m0, s45, 15360
    s_add_u32 s48, s46, 0x1e0000
    buffer_load_dwordx4 v24, s[24:27], s48 offen  lds
    s_add_u32 s45, s45, 0x10000
    s_add_u32 m0, s45, 0
    s_add_u32 s48, s46, 0x0
    buffer_load_dwordx4 v24, s[28:31], s48 offen  lds
    s_add_u32 m0, s45, 1024
    s_add_u32 s48, s46, 0x20000
    buffer_load_dwordx4 v24, s[28:31], s48 offen  lds
    s_add_u32 m0, s45, 2048
    s_add_u32 s48, s46, 0x40000
    buffer_load_dwordx4 v24, s[28:31], s48 offen  lds
    s_add_u32 m0, s45, 3072
    s_add_u32 s48, s46, 0x60000
    buffer_load_dwordx4 v24, s[28:31], s48 offen  lds
    s_add_u32 m0, s45, 4096
    s_add_u32 s48, s46, 0x80000
    buffer_load_dwordx4 v24, s[28:31], s48 offen  lds
    s_add_u32 m0, s45, 5120
    s_add_u32 s48, s46, 0xa0000
    buffer_load_dwordx4 v24, s[28:31], s48 offen  lds
    s_add_u32 m0, s45, 6144
    s_add_u32 s48, s46, 0xc0000
    buffer_load_dwordx4 v24, s[28:31], s48 offen  lds
    s_add_u32 m0, s45, 7168
    s_add_u32 s48, s46, 0xe0000
    buffer_load_dwordx4 v24, s[28:31], s48 offen  lds
    s_add_u32 m0, s45, 8192
    s_add_u32 s48, s46, 0x100000
    buffer_load_dwordx4 v24, s[28:31], s48 offen  lds
    s_add_u32 m0, s45, 9216
    s_add_u32 s48, s46, 0x120000
    buffer_load_dwordx4 v24, s[28:31], s48 offen  lds
    s_add_u32 m0, s45, 10240
    s_add_u32 s48, s46, 0x140000
    buffer_load_dwordx4 v24, s[28:31], s48 offen  lds
    s_add_u32 m0, s45, 11264
    s_add_u32 s48, s46, 0x160000
    buffer_load_dwordx4 v24, s[28:31], s48 offen  lds
    s_add_u32 m0, s45, 12288
    s_add_u32 s48, s46, 0x180000
    buffer_load_dwordx4 v24, s[28:31], s48 offen  lds
    s_add_u32 m0, s45, 13312
    s_add_u32 s48, s46, 0x1a0000
    buffer_load_dwordx4 v24, s[28:31], s48 offen  lds
    s_add_u32 m0, s45, 14336
    s_add_u32 s48, s46, 0x1c0000
    buffer_load_dwordx4 v24, s[28:31], s48 offen  lds
    s_add_u32 m0, s45, 15360
    s_add_u32 s48, s46, 0x1e0000
    buffer_load_dwordx4 v24, s[28:31], s48 offen  lds
    s_add_u32 s45, s45, 0x10000
    s_waitcnt vmcnt(0)
    s_barrier
    s_cmp_lg_u32 s44, 0
    s_cbranch_scc1 L_zwok_189
    v_and_b32 v16, 7, v1
    v_lshlrev_b32 v16, 5, v16
    s_mov_b32 s70, 0
L_zw_188:
    buffer_load_dword v17, v16, s[16:19], 0 offen sc1
    s_waitcnt vmcnt(0)
    v_add_u32_dpp v17, v17, v17 row_ror:1 row_mask:0xf bank_mask:0xf
    s_nop 1
    v_add_u32_dpp v17, v17, v17 row_ror:2 row_mask:0xf bank_mask:0xf
    s_nop 1
    v_add_u32_dpp v17, v17, v17 row_ror:4 row_mask:0xf bank_mask:0xf
    v_cmp_ne_u32 vcc, 0x100, v17
    s_add_u32 s70, s70, 1
    s_cbranch_vccz L_zwok_189
    s_sleep 4
    s_cmp_lt_u32 s70, 524288
    s_cbranch_scc1 L_zw_188
    s_branch L_c_done_1
L_zwok_189:
    s_cmp_lg_u32 s44, 0
    s_cbranch_scc1 L_c_nr_190
    s_or_b32 s47, s39, 0x100
    v_mov_b32 v16, s47
    s_lshl_b32 s52, s40, 6
    s_lshl_b32 s53, s41, 2
    s_add_u32 s52, s52, s53
    s_add_u32 s52, s52, 0x101000
    v_mov_b32 v17, 0
    s_mov_b64 exec, 1
    buffer_store_dword v16, v17, s[12:15], s52 offen sc1
    s_mov_b64 exec, -1
L_c_nr_190:
    ds_read_b64_tr_b16 a[0:1], v20 offset:0
    ds_read_b64_tr_b16 a[2:3], v20 offset:256
    ds_read_b64_tr_b16 a[4:5], v20 offset:2048
    ds_read_b64_tr_b16 a[6:7], v20 offset:2304
    ds_read_b64_tr_b16 a[8:9], v20 offset:4096
    ds_read_b64_tr_b16 a[10:11], v20 offset:4352
    ds_read_b64_tr_b16 a[12:13], v20 offset:6144
    ds_read_b64_tr_b16 a[14:15], v20 offset:6400
    s_waitcnt lgkmcnt(0)
    ds_read_b64_tr_b16 a[16:17], v20 offset:8192
    ds_read_b64_tr_b16 a[18:19], v20 offset:8448
    ds_read_b64_tr_b16 a[20:21], v20 offset:10240
    ds_read_b64_tr_b16 a[22:23], v20 offset:10496
    ds_read_b64_tr_b16 a[24:25], v20 offset:12288
    ds_read_b64_tr_b16 a[26:27], v20 offset:12544
    ds_read_b64_tr_b16 a[28:29], v20 offset:14336
    ds_read_b64_tr_b16 a[30:31], v20 offset:14592
    s_waitcnt lgkmcnt(0)
    ds_read_b64_tr_b16 a[32:33], v20 offset:16384
    ds_read_b64_tr_b16 a[34:35], v20 offset:16640
    ds_read_b64_tr_b16 a[36:37], v20 offset:18432
    ds_read_b64_tr_b16 a[38:39], v20 offset:18688
    ds_read_b64_tr_b16 a[40:41], v20 offset:20480
    ds_read_b64_tr_b16 a[42:43], v20 offset:20736
    ds_read_b64_tr_b16 a[44:45], v20 offset:22528
    ds_read_b64_tr_b16 a[46:47], v20 offset:22784
    s_waitcnt lgkmcnt(0)
    ds_read_b64_tr_b16 a[48:49], v20 offset:24576
    ds_read_b64_tr_b16 a[50:51], v20 offset:24832
    ds_read_b64_tr_b16 a[52:53], v20 offset:26624
    ds_read_b64_tr_b16 a[54:55], v20 offset:26880
    ds_read_b64_tr_b16 a[56:57], v20 offset:28672
    ds_read_b64_tr_b16 a[58:59], v20 offset:28928
    ds_read_b64_tr_b16 a[60:61], v20 offset:30720
    ds_read_b64_tr_b16 a[62:63], v20 offset:30976
    s_waitcnt lgkmcnt(0)
    ds_read_b64_tr_b16 a[64:65], v20 offset:32768
    ds_read_b64_tr_b16 a[66:67], v20 offset:33024
    ds_read_b64_tr_b16 a[68:69], v20 offset:34816
    ds_read_b64_tr_b16 a[70:71], v20 offset:35072
    ds_read_b64_tr_b16 a[72:73], v20 offset:36864
    ds_read_b64_tr_b16 a[74:75], v20 offset:37120
    ds_read_b64_tr_b16 a[76:77], v20 offset:38912
    ds_read_b64_tr_b16 a[78:79], v20 offset:39168
    s_waitcnt lgkmcnt(0)
    ds_read_b64_tr_b16 a[80:81], v20 offset:40960
    ds_read_b64_tr_b16 a[82:83], v20 offset:41216
    ds_read_b64_tr_b16 a[84:85], v20 offset:43008
    ds_read_b64_tr_b16 a[86:87], v20 offset:43264
    ds_read_b64_tr_b16 a[88:89], v20 offset:45056
    ds_read_b64_tr_b16 a[90:91], v20 offset:45312
    ds_read_b64_tr_b16 a[92:93], v20 offset:47104
    ds_read_b64_tr_b16 a[94:95], v20 offset:47360
    s_waitcnt lgkmcnt(0)
    ds_read_b64_tr_b16 a[96:97], v20 offset:49152
    ds_read_b64_tr_b16 a[98:99], v20 offset:49408
    ds_read_b64_tr_b16 a[100:101], v20 offset:51200
    ds_read_b64_tr_b16 a[102:103], v20 offset:51456
    ds_read_b64_tr_b16 a[104:105], v20 offset:53248
    ds_read_b64_tr_b16 a[106:107], v20 offset:53504
    ds_read_b64_tr_b16 a[108:109], v20 offset:55296
    ds_read_b64_tr_b16 a[110:111], v20 offset:55552
    s_waitcnt lgkmcnt(0)
    ds_read_b64_tr_b16 a[112:113], v20 offset:57344
    ds_read_b64_tr_b16 a[114:115], v20 offset:57600
    ds_read_b64_tr_b16 a[116:117], v20 offset:59392
    ds_read_b64_tr_b16 a[118:119], v20 offset:59648
    ds_read_b64_tr_b16 a[120:121], v20 offset:61440
    ds_read_b64_tr_b16 a[122:123], v20 offset:61696
    ds_read_b64_tr_b16 a[124:125], v20 offset:63488
    ds_read_b64_tr_b16 a[126:127], v20 offset:63744
    s_waitcnt lgkmcnt(0)
    s_mov_b32 s63, 0
    s_barrier
    s_lshl_b32 s52, s40, 2
    s_add_u32 s52, s52, s44
    s_mul_i32 s52, s52, 24576
    s_lshl_b32 s53, s41, 9
    s_add_u32 s52, s52, s53
    s_add_u32 s52, s52, 0x2004000
    v_and_b32 v14, 3, v1
    v_lshlrev_b32 v14, 7, v14
    v_add_u32 v14, s52, v14
    s_lshl_b32 s52, s40, 16
    s_lshl_b32 s53, s41, 9
    s_add_u32 s53, s53, s52
    s_lshl_b32 s54, s44, 6
    s_add_u32 s53, s53, s54
    s_add_u32 s53, s53, 0x7080000
    v_lshlrev_b32 v4, 3, v106
    v_lshl_add_u32 v10, v102, 6, v4
    v_lshl_add_u32 v4, v101, 7, v4
    v_add_u32 v4, s53, v4
    v_mov_b32 v54, 0xfffefffe
    v_mov_b32 v56, 0
    v_mov_b32 v57, 0
    v_mov_b32 v58, 0
    v_mov_b32 v59, 0
    s_lshl_b32 s53, s41, 7
    s_add_u32 s53, s53, s52
    s_add_u32 s53, s53, 0x7180000
    v_add_u32 v10, s53, v10
    s_cmp_ge_u32 s44, 2
    s_cselect_b64 vcc, -1, 0
    v_cndmask_b32 v4, v4, v10, vcc
    s_mul_i32 s52, s49, 24576
    s_lshl_b32 s53, s44, 12
    s_add_u32 s52, s52, s53
    s_lshl_b32 s53, s43, 10
    s_add_u32 s52, s52, s53
    s_add_u32 s52, s52, 0x2002000
    v_add_u32 v6, s52, v2
    v_lshrrev_b32 v10, 3, v1
    v_lshlrev_b32 v10, 8, v10
    v_lshl_add_u32 v10, v106, 4, v10
    v_add_u32 v10, 61568, v10
    v_add_u32 v11, 27648, v2
    v_cmp_gt_u32 s[52:53], 32, v1
    s_nop 1
    v_cndmask_b32 v10, v11, v10, s[52:53]
    v_cndmask_b32 v6, v6, v10, vcc
    v_mov_b32 v24, -1
    v_mov_b32 v25, -1
    v_mov_b32 v26, -1
    v_mov_b32 v27, -1
    s_and_b32 s52, s40, 1
    s_lshl_b32 s52, s52, 14
    s_lshl_b32 s53, s41, 10
    s_add_u32 s52, s52, s53
    s_lshl_b32 s53, s50, 9
    s_add_u32 s52, s52, s53
    s_lshl_b32 s53, s51, 7
    s_add_u32 s52, s52, s53
    s_add_u32 s52, s52, 0x7a0000
    v_mov_b32 v46, s52
    v_add_u32 v44, 65536, v2
    s_lshl_b32 s52, s50, 10
    s_add_u32 s52, s52, 62464
    v_add_u32 v31, s52, v2
    s_lshl_b32 s53, s51, 9
    s_add_u32 s52, s52, s53
    v_lshlrev_b32 v45, 4, v100
    v_lshl_add_u32 v45, v103, 8, v45
    v_lshl_add_u32 v45, v102, 3, v45
    v_add_u32 v45, s52, v45
    s_mul_i32 s52, s49, 24576
    s_lshl_b32 s53, s50, 13
    s_add_u32 s52, s52, s53
    s_lshl_b32 s53, s43, 10
    s_add_u32 s52, s52, s53
    s_add_u32 s52, s52, 0x4b80000
    v_add_u32 v13, s52, v2
    v_mov_b32 v29, 26644
    v_mov_b32 v30, 0
    ds_write_b32 v29, v30
    v_mov_b32 v30, 1
    s_lshl_b32 s58, s40, 11
    s_lshl_b32 s53, s44, 7
    s_add_u32 s58, s58, s53
    s_add_u32 s58, s58, 0x10a600
    s_mov_b32 s69, 0
    v_mov_b32 v0, 0
    s_cmp_ge_u32 s44, 2
    s_cselect_b32 s50, 0, 0x00ff00ff
    s_mov_b32 s51, 0x00ff00ff
    s_xor_b32 s45, s44, 2
    s_xor_b32 s46, s41, 6
    s_or_b32 s45, s45, s46
    s_cbranch_scc1 L_c_join_187_p
    s_lshl_b32 s45, s40, 21
    s_add_u32 s45, s45, 0x79c0000
    v_and_b32 v10, 31, v1
    v_lshlrev_b32 v10, 4, v10
    v_lshl_add_u32 v10, v103, 13, v10
    buffer_store_dwordx4 v[24:27], v10, s[12:15], s45 offen sc1
    s_add_u32 s46, s45, 0x1000
    s_load_dword s47, s[22:23], s46
    s_mov_b32 s60, -1
    s_mov_b32 s61, -1
    s_waitcnt vmcnt(0) lgkmcnt(0)
    s_add_u32 s46, s45, 0
    s_memtime s[84:85]
    s_waitcnt lgkmcnt(0)
    s_load_dword s47, s[22:23], s46
    s_waitcnt lgkmcnt(0)
    s_memtime s[86:87]
    s_waitcnt lgkmcnt(0)
    s_sub_u32 s86, s86, s84
    s_min_u32 s60, s60, s86
    s_add_u32 s46, s45, 8192
    s_memtime s[84:85]
    s_waitcnt lgkmcnt(0)
    s_load_dword s47, s[22:23], s46
    s_waitcnt lgkmcnt(0)
    s_memtime s[86:87]
    s_waitcnt lgkmcnt(0)
    s_sub_u32 s86, s86, s84
    s_min_u32 s61, s61, s86
    s_add_u32 s46, s45, 128
    s_memtime s[84:85]
    s_waitcnt lgkmcnt(0)
    s_load_dword s47, s[22:23], s46
    s_waitcnt lgkmcnt(0)
    s_memtime s[86:87]
    s_waitcnt lgkmcnt(0)
    s_sub_u32 s86, s86, s84
    s_min_u32 s60, s60, s86
    s_add_u32 s46, s45, 8320
    s_memtime s[84:85]
    s_waitcnt lgkmcnt(0)
    s_load_dword s47, s[22:23], s46
    s_waitcnt lgkmcnt(0)
    s_memtime s[86:87]
    s_waitcnt lgkmcnt(0)
    s_sub_u32 s86, s86, s84
    s_min_u32 s61, s61, s86
    s_add_u32 s46, s45, 256
    s_memtime s[84:85]
    s_waitcnt lgkmcnt(0)
    s_load_dword s47, s[22:23], s46
    s_waitcnt lgkmcnt(0)
    s_memtime s[86:87]
    s_waitcnt lgkmcnt(0)
    s_sub_u32 s86, s86, s84
    s_min_u32 s60, s60, s86
    s_add_u32 s46, s45, 8448
    s_memtime s[84:85]
    s_waitcnt lgkmcnt(0)
    s_load_dword s47, s[22:23], s46
    s_waitcnt lgkmcnt(0)
    s_memtime s[86:87]
    s_waitcnt lgkmcnt(0)
    s_sub_u32 s86, s86, s84
    s_min_u32 s61, s61, s86
    s_add_u32 s46, s45, 384
    s_memtime s[84:85]
    s_waitcnt lgkmcnt(0)
    s_load_dword s47, s[22:23], s46
    s_waitcnt lgkmcnt(0)
    s_memtime s[86:87]
    s_waitcnt lgkmcnt(0)
    s_sub_u32 s86, s86, s84
    s_min_u32 s60, s60, s86
    s_add_u32 s46, s45, 8576
    s_memtime s[84:85]
    s_waitcnt lgkmcnt(0)
    s_load_dword s47, s[22:23], s46
    s_waitcnt lgkmcnt(0)
    s_memtime s[86:87]
    s_waitcnt lgkmcnt(0)
    s_sub_u32 s86, s86, s84
    s_min_u32 s61, s61, s86
    s_cmp_gt_u32 s60, s61
    s_cselect_b32 s45, 3, 2
    v_mov_b32 v10, s45
    v_mov_b32 v11, 0
    s_lshl_b32 s45, s40, 7
    s_add_u32 s45, s45, 0x101800
    s_mov_b64 exec, 1
    buffer_store_dword v10, v11, s[12:15], s45 offen sc1
    s_mov_b64 exec, -1
L_c_join_187_p:
    s_setprio 1
    s_branch L_c_join_187
L_v_init_186:
    s_sub_u32 s54, s44, 4
    s_lshr_b32 s51, s54, 1
    s_and_b32 s50, s54, 1
    s_load_dwordx4 s[4:7], s[0:1], 32
    s_load_dwordx2 s[8:9], s[0:1], 8
    s_waitcnt lgkmcnt(0)
    s_mov_b32 s24, s4
    s_and_b32 s25, s5, 0xffff
    s_mov_b32 s26, 0x800000
    s_mov_b32 s27, 0x00020000
    s_mov_b32 s28, s6
    s_and_b32 s29, s7, 0xffff
    s_mov_b32 s30, 0x800000
    s_mov_b32 s31, 0x00020000
    s_mov_b32 s32, s8
    s_and_b32 s33, s9, 0xffff
    s_mov_b32 s34, 0x4000
    s_mov_b32 s35, 0x00020000
    s_lshl_b32 s45, s54, 12
    s_add_u32 s45, s45, 0x20000
    v_add_u32 v20, s45, v20
    v_add_u32 v21, s45, v21
    v_add_u32 v22, s45, v2
    s_lshl_b32 s46, s49, 8
    s_lshl_b32 s48, s43, 6
    s_add_u32 s46, s46, s48
    s_lshl_b32 s48, s54, 21
    s_add_u32 s46, s46, s48
    s_add_u32 s48, s46, 0x0
    buffer_load_dwordx4 a[0:3], v24, s[24:27], s48 offen
    s_add_u32 s48, s46, 0x20000
    buffer_load_dwordx4 a[32:35], v24, s[24:27], s48 offen
    s_add_u32 s48, s46, 0x40000
    buffer_load_dwordx4 a[4:7], v24, s[24:27], s48 offen
    s_add_u32 s48, s46, 0x60000
    buffer_load_dwordx4 a[36:39], v24, s[24:27], s48 offen
    s_add_u32 s48, s46, 0x80000
    buffer_load_dwordx4 a[8:11], v24, s[24:27], s48 offen
    s_add_u32 s48, s46, 0xa0000
    buffer_load_dwordx4 a[40:43], v24, s[24:27], s48 offen
    s_add_u32 s48, s46, 0xc0000
    buffer_load_dwordx4 a[12:15], v24, s[24:27], s48 offen
    s_add_u32 s48, s46, 0xe0000
    buffer_load_dwordx4 a[44:47], v24, s[24:27], s48 offen
    s_add_u32 s48, s46, 0x100000
    buffer_load_dwordx4 a[16:19], v24, s[24:27], s48 offen
    s_add_u32 s48, s46, 0x120000
    buffer_load_dwordx4 a[48:51], v24, s[24:27], s48 offen
    s_add_u32 s48, s46, 0x140000
    buffer_load_dwordx4 a[20:23], v24, s[24:27], s48 offen
    s_add_u32 s48, s46, 0x160000
    buffer_load_dwordx4 a[52:55], v24, s[24:27], s48 offen
    s_add_u32 s48, s46, 0x180000
    buffer_load_dwordx4 a[24:27], v24, s[24:27], s48 offen
    s_add_u32 s48, s46, 0x1a0000
    buffer_load_dwordx4 a[56:59], v24, s[24:27], s48 offen
    s_add_u32 s48, s46, 0x1c0000
    buffer_load_dwordx4 a[28:31], v24, s[24:27], s48 offen
    s_add_u32 s48, s46, 0x1e0000
    buffer_load_dwordx4 a[60:63], v24, s[24:27], s48 offen
    s_lshl_b32 s52, s40, 15
    s_lshl_b32 s53, s42, 11
    s_add_u32 s52, s52, s53
    s_lshl_b32 s53, s43, 9
    s_add_u32 s52, s52, s53
    s_lshl_b32 s53, s51, 8
    s_add_u32 s52, s52, s53
    s_add_u32 s52, s52, 0x7100000
    v_bfe_u32 v4, v1, 1, 1
    v_lshlrev_b32 v4, 7, v4
    v_lshl_add_u32 v4, v104, 4, v4
    v_and_b32 v5, 12, v100
    v_add_u32 v4, v4, v5
    v_add_u32 v4, s52, v4
    v_mov_b32 v26, -1
    s_lshl_b32 s52, s51, 5
    s_add_u32 s52, s52, 28160
    v_and_b32 v5, 14, v100
    v_lshlrev_b32 v5, 1, v5
    v_lshl_add_u32 v5, v104, 6, v5
    v_add_u32 v5, s52, v5
    s_lshl_b32 s52, s41, 14
    s_lshl_b32 s53, s54, 11
    s_add_u32 s52, s52, s53
    s_add_u32 s52, s52, 0x7800000
    v_lshlrev_b32 v6, 3, v101
    v_lshl_add_u32 v6, v106, 5, v6
    v_and_b32 v7, 3, v1
    v_lshlrev_b32 v7, 3, v7
    v_bfe_u32 v30, v1, 2, 3
    v_lshl_add_u32 v7, v30, 5, v7
    v_lshl_add_u32 v7, v103, 2, v7
    v_add_u32 v7, s52, v7
    s_lshl_b32 s53, s40, 8
    s_add_u32 s52, s52, s53
    v_add_u32 v6, s52, v6
    v_lshlrev_b32 v30, 4, v100
    v_lshl_add_u32 v30, v101, 18, v30
    v_add_u32 v30, s52, v30
    v_mov_b32 v32, -1
    v_mov_b32 v33, -1
    v_mov_b32 v34, -1
    v_mov_b32 v35, -1
    buffer_store_dwordx4 v[32:35], v30, s[12:15], 0 offen sc1
    s_mov_b32 s53, 8192
    buffer_store_dwordx4 v[32:35], v30, s[12:15], s53 offen sc1
    s_lshl_b32 s55, s40, 16
    s_add_u32 s55, s55, 0x7000000
    s_lshl_b32 s52, s41, 10
    s_lshl_b32 s53, s54, 8
    s_add_u32 s52, s52, s53
    s_add_u32 s52, s52, s55
    v_lshlrev_b32 v8, 2, v1
    v_add_u32 v8, s52, v8
    s_lshl_b32 s53, s54, 12
    v_add_u32 v10, s53, v2
    v_add_u32 v9, s55, v10
    s_lshl_b32 s52, s40, 15
    s_lshl_b32 s53, s54, 11
    s_add_u32 s52, s52, s53
    s_add_u32 s52, s52, 0x7100000
    v_add_u32 v11, s52, v2
    s_lshl_b32 s52, s54, 9
    s_add_u32 s52, s52, 53248
    v_lshlrev_b32 v12, 4, v100
    v_lshl_add_u32 v12, v102, 3, v12
    v_lshl_add_u32 v12, v103, 8, v12
    v_add_u32 v12, s52, v12
    s_lshl_b32 s52, s51, 3
    s_add_u32 s52, s52, 49152
    v_add_u32 v13, s52, v2
    s_lshl_b32 s52, s54, 10
    s_add_u32 s52, s52, 49152
    v_add_u32 v14, s52, v2
    s_lshl_b32 s52, s40, 2
    s_add_u32 s52, s52, s54
    s_mul_i32 s52, s52, 24576
    s_add_u32 s52, s52, 0x2004000
    v_add_u32 v15, s52, v2
    s_lshl_b32 s52, s54, 10
    v_add_u32 v27, s52, v2
    v_lshlrev_b32 v30, 11, v106
    v_lshl_add_u32 v30, v101, 5, v30
    v_lshl_add_u32 v30, v107, 2, v30
    s_lshl_b32 s52, s54, 9
    buffer_load_dword v112, v30, s[32:35], s52 offen offset:0
    buffer_load_dword v113, v30, s[32:35], s52 offen offset:8
    buffer_load_dword v114, v30, s[32:35], s52 offen offset:16
    buffer_load_dword v115, v30, s[32:35], s52 offen offset:24
    buffer_load_dword v116, v30, s[32:35], s52 offen offset:128
    buffer_load_dword v117, v30, s[32:35], s52 offen offset:136
    buffer_load_dword v118, v30, s[32:35], s52 offen offset:144
    buffer_load_dword v119, v30, s[32:35], s52 offen offset:152
    buffer_load_dword v120, v30, s[32:35], s52 offen offset:256
    buffer_load_dword v121, v30, s[32:35], s52 offen offset:264
    buffer_load_dword v122, v30, s[32:35], s52 offen offset:272
    buffer_load_dword v123, v30, s[32:35], s52 offen offset:280
    buffer_load_dword v124, v30, s[32:35], s52 offen offset:384
    buffer_load_dword v125, v30, s[32:35], s52 offen offset:392
    buffer_load_dword v126, v30, s[32:35], s52 offen offset:400
    buffer_load_dword v127, v30, s[32:35], s52 offen offset:408
    s_lshl_b32 s46, s40, 2
    s_add_u32 s46, s46, s54
    s_lshl_b32 s46, s46, 18
    s_lshl_b32 s48, s41, 7
    s_add_u32 s46, s46, s48
    s_add_u32 s48, s46, 0x0
    buffer_load_dwordx4 a[64:67], v25, s[28:31], s48 offen
    s_add_u32 s48, s46, 0x4000
    buffer_load_dwordx4 a[80:83], v25, s[28:31], s48 offen
    s_add_u32 s48, s46, 0x8000
    buffer_load_dwordx4 a[96:99], v25, s[28:31], s48 offen
    s_add_u32 s48, s46, 0xc000
    buffer_load_dwordx4 a[112:115], v25, s[28:31], s48 offen
    s_add_u32 s48, s46, 0x10000
    buffer_load_dwordx4 a[68:71], v25, s[28:31], s48 offen
    s_add_u32 s48, s46, 0x14000
    buffer_load_dwordx4 a[84:87], v25, s[28:31], s48 offen
    s_add_u32 s48, s46, 0x18000
    buffer_load_dwordx4 a[100:103], v25, s[28:31], s48 offen
    s_add_u32 s48, s46, 0x1c000
    buffer_load_dwordx4 a[116:119], v25, s[28:31], s48 offen
    s_add_u32 s48, s46, 0x20000
    buffer_load_dwordx4 a[72:75], v25, s[28:31], s48 offen
    s_add_u32 s48, s46, 0x24000
    buffer_load_dwordx4 a[88:91], v25, s[28:31], s48 offen
    s_add_u32 s48, s46, 0x28000
    buffer_load_dwordx4 a[104:107], v25, s[28:31], s48 offen
    s_add_u32 s48, s46, 0x2c000
    buffer_load_dwordx4 a[120:123], v25, s[28:31], s48 offen
    s_add_u32 s48, s46, 0x30000
    buffer_load_dwordx4 a[76:79], v25, s[28:31], s48 offen
    s_add_u32 s48, s46, 0x34000
    buffer_load_dwordx4 a[92:95], v25, s[28:31], s48 offen
    s_add_u32 s48, s46, 0x38000
    buffer_load_dwordx4 a[108:111], v25, s[28:31], s48 offen
    s_add_u32 s48, s46, 0x3c000
    buffer_load_dwordx4 a[124:127], v25, s[28:31], s48 offen
    s_waitcnt vmcnt(16)
    ds_write_b128 v22, a[0:3] offset:0
    ds_write_b128 v22, a[32:35] offset:1024
    ds_write_b128 v22, a[4:7] offset:2048
    ds_write_b128 v22, a[36:39] offset:3072
    s_waitcnt lgkmcnt(0)
    ds_read_b64_tr_b16 a[0:1], v20 offset:0
    ds_read_b64_tr_b16 a[2:3], v20 offset:256
    ds_read_b64_tr_b16 a[32:33], v20 offset:32
    ds_read_b64_tr_b16 a[34:35], v20 offset:288
    ds_read_b64_tr_b16 a[4:5], v20 offset:2048
    ds_read_b64_tr_b16 a[6:7], v20 offset:2304
    ds_read_b64_tr_b16 a[36:37], v20 offset:2080
    ds_read_b64_tr_b16 a[38:39], v20 offset:2336
    s_waitcnt lgkmcnt(0)
    ds_write_b128 v22, a[8:11] offset:0
    ds_write_b128 v22, a[40:43] offset:1024
    ds_write_b128 v22, a[12:15] offset:2048
    ds_write_b128 v22, a[44:47] offset:3072
    s_waitcnt lgkmcnt(0)
    ds_read_b64_tr_b16 a[8:9], v20 offset:0
    ds_read_b64_tr_b16 a[10:11], v20 offset:256
    ds_read_b64_tr_b16 a[40:41], v20 offset:32
    ds_read_b64_tr_b16 a[42:43], v20 offset:288
    ds_read_b64_tr_b16 a[12:13], v20 offset:2048
    ds_read_b64_tr_b16 a[14:15], v20 offset:2304
    ds_read_b64_tr_b16 a[44:45], v20 offset:2080
    ds_read_b64_tr_b16 a[46:47], v20 offset:2336
    s_waitcnt lgkmcnt(0)
    ds_write_b128 v22, a[16:19] offset:0
    ds_write_b128 v22, a[48:51] offset:1024
    ds_write_b128 v22, a[20:23] offset:2048
    ds_write_b128 v22, a[52:55] offset:3072
    s_waitcnt lgkmcnt(0)
    ds_read_b64_tr_b16 a[16:17], v20 offset:0
    ds_read_b64_tr_b16 a[18:19], v20 offset:256
    ds_read_b64_tr_b16 a[48:49], v20 offset:32
    ds_read_b64_tr_b16 a[50:51], v20 offset:288
    ds_read_b64_tr_b16 a[20:21], v20 offset:2048
    ds_read_b64_tr_b16 a[22:23], v20 offset:2304
    ds_read_b64_tr_b16 a[52:53], v20 offset:2080
    ds_read_b64_tr_b16 a[54:55], v20 offset:2336
    s_waitcnt lgkmcnt(0)
    ds_write_b128 v22, a[24:27] offset:0
    ds_write_b128 v22, a[56:59] offset:1024
    ds_write_b128 v22, a[28:31] offset:2048
    ds_write_b128 v22, a[60:63] offset:3072
    s_waitcnt lgkmcnt(0)
    ds_read_b64_tr_b16 a[24:25], v20 offset:0
    ds_read_b64_tr_b16 a[26:27], v20 offset:256
    ds_read_b64_tr_b16 a[56:57], v20 offset:32
    ds_read_b64_tr_b16 a[58:59], v20 offset:288
    ds_read_b64_tr_b16 a[28:29], v20 offset:2048
    ds_read_b64_tr_b16 a[30:31], v20 offset:2304
    ds_read_b64_tr_b16 a[60:61], v20 offset:2080
    ds_read_b64_tr_b16 a[62:63], v20 offset:2336
    s_waitcnt lgkmcnt(0)
    s_barrier
    s_waitcnt vmcnt(0)
    ds_write_b128 v22, a[64:67] offset:0
    ds_write_b128 v22, a[80:83] offset:1024
    ds_write_b128 v22, a[96:99] offset:2048
    ds_write_b128 v22, a[112:115] offset:3072
    s_waitcnt lgkmcnt(0)
    ds_read_b64_tr_b16 a[64:65], v21 offset:0
    ds_read_b64_tr_b16 a[66:67], v21 offset:512
    ds_read_b64_tr_b16 a[80:81], v21 offset:32
    ds_read_b64_tr_b16 a[82:83], v21 offset:544
    ds_read_b64_tr_b16 a[96:97], v21 offset:64
    ds_read_b64_tr_b16 a[98:99], v21 offset:576
    ds_read_b64_tr_b16 a[112:113], v21 offset:96
    ds_read_b64_tr_b16 a[114:115], v21 offset:608
    s_waitcnt lgkmcnt(0)
    ds_write_b128 v22, a[68:71] offset:0
    ds_write_b128 v22, a[84:87] offset:1024
    ds_write_b128 v22, a[100:103] offset:2048
    ds_write_b128 v22, a[116:119] offset:3072
    s_waitcnt lgkmcnt(0)
    ds_read_b64_tr_b16 a[68:69], v21 offset:0
    ds_read_b64_tr_b16 a[70:71], v21 offset:512
    ds_read_b64_tr_b16 a[84:85], v21 offset:32
    ds_read_b64_tr_b16 a[86:87], v21 offset:544
    ds_read_b64_tr_b16 a[100:101], v21 offset:64
    ds_read_b64_tr_b16 a[102:103], v21 offset:576
    ds_read_b64_tr_b16 a[116:117], v21 offset:96
    ds_read_b64_tr_b16 a[118:119], v21 offset:608
    s_waitcnt lgkmcnt(0)
    ds_write_b128 v22, a[72:75] offset:0
    ds_write_b128 v22, a[88:91] offset:1024
    ds_write_b128 v22, a[104:107] offset:2048
    ds_write_b128 v22, a[120:123] offset:3072
    s_waitcnt lgkmcnt(0)
    ds_read_b64_tr_b16 a[72:73], v21 offset:0
    ds_read_b64_tr_b16 a[74:75], v21 offset:512
    ds_read_b64_tr_b16 a[88:89], v21 offset:32
    ds_read_b64_tr_b16 a[90:91], v21 offset:544
    ds_read_b64_tr_b16 a[104:105], v21 offset:64
    ds_read_b64_tr_b16 a[106:107], v21 offset:576
    ds_read_b64_tr_b16 a[120:121], v21 offset:96
    ds_read_b64_tr_b16 a[122:123], v21 offset:608
    s_waitcnt lgkmcnt(0)
    ds_write_b128 v22, a[76:79] offset:0
    ds_write_b128 v22, a[92:95] offset:1024
    ds_write_b128 v22, a[108:111] offset:2048
    ds_write_b128 v22, a[124:127] offset:3072
    s_waitcnt lgkmcnt(0)
    ds_read_b64_tr_b16 a[76:77], v21 offset:0
    ds_read_b64_tr_b16 a[78:79], v21 offset:512
    ds_read_b64_tr_b16 a[92:93], v21 offset:32
    ds_read_b64_tr_b16 a[94:95], v21 offset:544
    ds_read_b64_tr_b16 a[108:109], v21 offset:64
    ds_read_b64_tr_b16 a[110:111], v21 offset:576
    ds_read_b64_tr_b16 a[124:125], v21 offset:96
    ds_read_b64_tr_b16 a[126:127], v21 offset:608
    s_waitcnt lgkmcnt(0)
    s_mov_b32 s65, 0
    s_waitcnt vmcnt(0)
    s_barrier
    s_lshl_b32 s57, s40, 11
    s_lshl_b32 s53, s54, 7
    s_add_u32 s57, s57, s53
    s_add_u32 s57, s57, 0x10a600
    s_mov_b32 s69, 0
    s_mov_b32 s68, 0
    s_cmp_gt_u32 s69, s68
    s_cbranch_scc1 L_kv_ok_192
    s_mov_b32 s70, 0
L_kv_lp_191:
    v_and_b32 v22, 1, v1
    v_lshlrev_b32 v22, 9, v22
    buffer_load_dword v23, v22, s[12:15], s57 offen sc1
    s_waitcnt vmcnt(0)
    v_readlane_b32 s69, v23, 0
    v_readlane_b32 s45, v23, 1
    s_add_u32 s70, s70, 1
    s_nop 2
    s_min_u32 s69, s69, s45
    s_cmp_gt_u32 s69, s68
    s_cbranch_scc1 L_kv_ok_192
    s_sleep 4
    s_cmp_lt_u32 s70, 524288
    s_cbranch_scc1 L_kv_lp_191
    s_branch L_c_done_1
L_kv_ok_192:
    v_lshlrev_b32 v28, 9, v101
    v_lshl_add_u32 v28, v100, 4, v28
    s_lshl_b32 s52, s54, 13
    s_add_u32 s52, s52, 0x7a0000
    v_add_u32 v28, s52, v28
    s_lshl_b32 s59, s54, 12
    s_add_u32 s59, s59, 65536
    v_lshlrev_b32 v31, 4, v100
    v_lshl_add_u32 v31, v103, 8, v31
    v_add_u32 v31, 20480, v31
    s_lshl_b32 s52, s54, 11
    s_add_u32 s52, s52, 53248
    v_add_u32 v25, s52, v2
    v_mov_b32 v29, 26640
    v_mov_b32 v30, 0
    ds_write_b32 v29, v30
    v_mov_b32 v30, 1
    s_mov_b32 s58, 0
    s_mov_b32 s64, 0
    s_add_u32 s46, s65, 4096
    buffer_load_dwordx4 v[32:35], v15, s[12:15], s65 offen offset:0 sc1
    buffer_load_dwordx4 v[48:51], v15, s[12:15], s46 offen offset:0 sc1
    buffer_load_dwordx4 v[36:39], v15, s[12:15], s65 offen offset:1024 sc1
    buffer_load_dwordx4 v[52:55], v15, s[12:15], s46 offen offset:1024 sc1
    buffer_load_dwordx4 v[40:43], v15, s[12:15], s65 offen offset:2048 sc1
    buffer_load_dwordx4 v[56:59], v15, s[12:15], s46 offen offset:2048 sc1
    buffer_load_dwordx4 v[44:47], v15, s[12:15], s65 offen offset:3072 sc1
    buffer_load_dwordx4 v[60:63], v15, s[12:15], s46 offen offset:3072 sc1
    s_add_u32 s65, s65, 786432
    s_waitcnt vmcnt(0)
    v_mfma_f32_16x16x32_bf16 v[64:67], v[32:35], a[64:67], 0
    v_mfma_f32_16x16x32_bf16 v[68:71], v[48:51], a[64:67], 0
    v_mfma_f32_16x16x32_bf16 v[64:67], v[36:39], a[68:71], v[64:67]
    v_mfma_f32_16x16x32_bf16 v[68:71], v[52:55], a[68:71], v[68:71]
    v_mfma_f32_16x16x32_bf16 v[64:67], v[40:43], a[72:75], v[64:67]
    v_mfma_f32_16x16x32_bf16 v[68:71], v[56:59], a[72:75], v[68:71]
    v_mfma_f32_16x16x32_bf16 v[64:67], v[44:47], a[76:79], v[64:67]
    v_mfma_f32_16x16x32_bf16 v[68:71], v[60:63], a[76:79], v[68:71]
    v_mfma_f32_16x16x32_bf16 v[72:75], v[32:35], a[80:83], 0
    v_mfma_f32_16x16x32_bf16 v[76:79], v[48:51], a[80:83], 0
    v_mfma_f32_16x16x32_bf16 v[72:75], v[36:39], a[84:87], v[72:75]
    v_mfma_f32_16x16x32_bf16 v[76:79], v[52:55], a[84:87], v[76:79]
    v_mfma_f32_16x16x32_bf16 v[72:75], v[40:43], a[88:91], v[72:75]
    v_mfma_f32_16x16x32_bf16 v[76:79], v[56:59], a[88:91], v[76:79]
    v_mfma_f32_16x16x32_bf16 v[72:75], v[44:47], a[92:95], v[72:75]
    v_mfma_f32_16x16x32_bf16 v[76:79], v[60:63], a[92:95], v[76:79]
    v_cvt_pk_bf16_f32 v64, v64, v65
    v_cvt_pk_bf16_f32 v65, v66, v67
    v_cvt_pk_bf16_f32 v66, v68, v69
    v_cvt_pk_bf16_f32 v67, v70, v71
    ds_write_b128 v10, v[64:67] offset:32768
    v_mfma_f32_16x16x32_bf16 v[80:83], v[32:35], a[96:99], 0
    v_mfma_f32_16x16x32_bf16 v[84:87], v[48:51], a[96:99], 0
    v_mfma_f32_16x16x32_bf16 v[80:83], v[36:39], a[100:103], v[80:83]
    v_mfma_f32_16x16x32_bf16 v[84:87], v[52:55], a[100:103], v[84:87]
    v_mfma_f32_16x16x32_bf16 v[80:83], v[40:43], a[104:107], v[80:83]
    v_mfma_f32_16x16x32_bf16 v[84:87], v[56:59], a[104:107], v[84:87]
    v_mfma_f32_16x16x32_bf16 v[80:83], v[44:47], a[108:111], v[80:83]
    v_mfma_f32_16x16x32_bf16 v[84:87], v[60:63], a[108:111], v[84:87]
    v_cvt_pk_bf16_f32 v72, v72, v73
    v_cvt_pk_bf16_f32 v73, v74, v75
    v_cvt_pk_bf16_f32 v74, v76, v77
    v_cvt_pk_bf16_f32 v75, v78, v79
    ds_write_b128 v10, v[72:75] offset:33792
    v_mfma_f32_16x16x32_bf16 v[88:91], v[32:35], a[112:115], 0
    v_mfma_f32_16x16x32_bf16 v[92:95], v[48:51], a[112:115], 0
    v_mfma_f32_16x16x32_bf16 v[88:91], v[36:39], a[116:119], v[88:91]
    v_mfma_f32_16x16x32_bf16 v[92:95], v[52:55], a[116:119], v[92:95]
    v_mfma_f32_16x16x32_bf16 v[88:91], v[40:43], a[120:123], v[88:91]
    v_mfma_f32_16x16x32_bf16 v[92:95], v[56:59], a[120:123], v[92:95]
    v_mfma_f32_16x16x32_bf16 v[88:91], v[44:47], a[124:127], v[88:91]
    v_mfma_f32_16x16x32_bf16 v[92:95], v[60:63], a[124:127], v[92:95]
    v_cvt_pk_bf16_f32 v80, v80, v81
    v_cvt_pk_bf16_f32 v81, v82, v83
    v_cvt_pk_bf16_f32 v82, v84, v85
    v_cvt_pk_bf16_f32 v83, v86, v87
    ds_write_b128 v10, v[80:83] offset:34816
    s_nop 2
    v_cvt_pk_bf16_f32 v88, v88, v89
    v_cvt_pk_bf16_f32 v89, v90, v91
    v_cvt_pk_bf16_f32 v90, v92, v93
    v_cvt_pk_bf16_f32 v91, v94, v95
    ds_write_b128 v10, v[88:91] offset:35840
    s_mov_b64 s[66:67], 0
    s_mov_b32 s63, 0
    s_mov_b32 s68, 1
    s_cmp_gt_u32 s69, s68
    s_cbranch_scc1 L_kv_ok_194
    s_mov_b32 s70, 0
L_kv_lp_193:
    v_and_b32 v22, 1, v1
    v_lshlrev_b32 v22, 9, v22
    buffer_load_dword v23, v22, s[12:15], s57 offen sc1
    s_waitcnt vmcnt(0)
    v_readlane_b32 s69, v23, 0
    v_readlane_b32 s45, v23, 1
    s_add_u32 s70, s70, 1
    s_nop 2
    s_min_u32 s69, s69, s45
    s_cmp_gt_u32 s69, s68
    s_cbranch_scc1 L_kv_ok_194
    s_sleep 4
    s_cmp_lt_u32 s70, 524288
    s_cbranch_scc1 L_kv_lp_193
    s_branch L_c_done_1
L_kv_ok_194:
    v_lshrrev_b32 v22, 3, v1
    v_lshlrev_b32 v22, 7, v22
    s_mov_b32 s45, 0x101800
    s_mov_b32 s46, 0
    s_mov_b32 s70, 0
L_spin_195:
    buffer_load_dword v23, v22, s[12:15], s45 offen sc1
    s_waitcnt vmcnt(0)
    v_cmp_ge_u32 vcc, s46, v23
    s_add_u32 s70, s70, 1
    s_cbranch_vccz L_spok_196
    s_sleep 3
    s_cmp_lt_u32 s70, 524288
    s_cbranch_scc1 L_spin_195
    s_branch L_c_done_1
L_spok_196:
    v_cmp_eq_u32 s[66:67], 3, v23
    s_nop 3
    s_bitcmp1_b32 s66, 0
    s_cselect_b32 s63, 8192, 0
    s_waitcnt lgkmcnt(0)
    v_min_u32 v64, -2, v112
    v_min_u32 v65, -2, v113
    v_min_u32 v66, -2, v114
    v_min_u32 v67, -2, v115
    v_min_u32 v68, -2, v116
    v_min_u32 v69, -2, v117
    v_min_u32 v70, -2, v118
    v_min_u32 v71, -2, v119
    v_min_u32 v72, -2, v120
    v_min_u32 v73, -2, v121
    v_min_u32 v74, -2, v122
    v_min_u32 v75, -2, v123
    v_min_u32 v76, -2, v124
    v_min_u32 v77, -2, v125
    v_min_u32 v78, -2, v126
    v_min_u32 v79, -2, v127
    v_mov_b32 v16, 0
    v_mov_b32 v17, 0
    v_mov_b32 v18, 0
    v_mov_b32 v19, 0
    v_mov_b32 v20, 0
    v_mov_b32 v21, 0
    v_mov_b32 v22, 0
    v_mov_b32 v23, 0
L_c_join_187:
    s_mov_b32 s60, 0
    s_mov_b32 s61, 0
    s_mov_b32 s62, 0
    s_cmp_lg_u32 s44, 0
    s_cbranch_scc1 L_c_nh_197
    v_lshlrev_b32 v17, 3, v1
    s_lshl_b32 s46, s40, 3
    v_mov_b32 v21, s46
    s_mov_b32 s45, 0x101000
    s_mov_b32 s70, 0
L_c_rp_198:
    buffer_load_dwordx2 v[18:19], v17, s[12:15], s45 offen sc1
    buffer_load_dwordx2 v[22:23], v21, s[12:15], s45 offen offset:512 sc1
    s_waitcnt vmcnt(0)
    v_min3_u32 v20, v18, v19, v22
    v_min_u32 v20, v20, v23
    v_cmp_eq_u32 vcc, 0, v20
    s_cbranch_vccnz L_rt_199
    v_cmp_eq_u32 s[52:53], v18, v16
    v_cmp_eq_u32 vcc, v19, v16
    v_cmp_eq_u32 s[54:55], v22, v16
    v_cmp_eq_u32 s[56:57], v23, v16
    s_lshl_b32 s46, s40, 3
    s_nop 3
    s_and_b64 s[52:53], s[52:53], vcc
    s_lshr_b64 s[52:53], s[52:53], s46
    s_and_b32 s52, s52, 0xff
    s_cmp_eq_u32 s52, 0xff
    s_cselect_b32 s52, 1, 0
    v_mov_b32 v16, s52
    v_mov_b32 v17, 26624
    ds_write_b32 v17, v16
L_c_nh_197:
    s_waitcnt lgkmcnt(0)
    s_barrier
    v_mov_b32 v17, 26624
    ds_read_b32 v16, v17
    s_waitcnt lgkmcnt(0)
    v_readfirstlane_b32 s52, v16
    s_nop 3
    s_cmp_ge_u32 s44, 4
    s_cbranch_scc1 L_vf_202
    s_mov_b32 s57, s58
    s_mov_b32 s58, 0
    s_cmp_ge_u32 s44, 2
    s_cbranch_scc1 L_sf_200
    buffer_load_dwordx4 v[32:35], v6, s[12:15], 0 offen sc1
L_sf_200:
    s_mov_b32 s54, s52
    v_add_u32 v52, 786432, v6
    s_mul_i32 s53, s49, 24576
    s_lshl_b32 s55, s43, 11
    s_add_u32 s53, s53, s55
    s_and_b32 s55, s44, 1
    s_lshl_b32 s55, s55, 10
    s_add_u32 s53, s53, s55
    s_add_u32 s53, s53, 0x2184000
    v_and_b32 v53, 7, v1
    v_lshlrev_b32 v53, 7, v53
    v_add_u32 v53, s53, v53
    s_cmp_ge_u32 s44, 2
    s_cselect_b64 vcc, -1, 0
    s_cselect_b64 s[52:53], 0xff, -1
    v_cndmask_b32 v52, v52, v53, vcc
    s_cselect_b32 s55, 786432, 0
    v_readfirstlane_b32 s56, v52
    s_nop 3
    s_sub_u32 s56, s56, s55
    s_cmp_eq_u32 s54, 0
    s_cbranch_scc1 L_ss_201
.p2align 6
L_s_loop_204:
    v_mov_b32 v16, 0
    v_mov_b32 v17, 0
    v_mov_b32 v18, 0
    v_mov_b32 v19, 0
    s_add_u32 s58, s58, 4
    s_mov_b32 s70, 1
    s_waitcnt vmcnt(0) lgkmcnt(0)
    s_barrier
    ds_read_b128 v[64:67], v2 offset:0
    ds_read_b128 v[68:71], v2 offset:1024
    ds_read_b128 v[72:75], v2 offset:2048
    ds_read_b128 v[76:79], v2 offset:3072
    ds_read_b128 v[80:83], v2 offset:4096
    ds_read_b128 v[84:87], v2 offset:5120
    ds_read_b128 v[88:91], v2 offset:6144
    ds_read_b128 v[92:95], v2 offset:7168
    ds_read_b128 v[96:99], v2 offset:8192
    ds_read_b128 v[100:103], v2 offset:9216
    ds_read_b128 v[104:107], v2 offset:10240
    ds_read_b128 v[108:111], v2 offset:11264
    s_waitcnt lgkmcnt(11)
    v_smfmac_f32_16x16x64_bf16 v[16:19], v[64:67], a[0:7], v3
    ds_read_b128 v[112:115], v2 offset:12288
    s_waitcnt lgkmcnt(11)
    v_smfmac_f32_16x16x64_bf16 v[16:19], v[68:71], a[8:15], v3
    ds_read_b128 v[116:119], v2 offset:13312
    s_waitcnt lgkmcnt(11)
    v_smfmac_f32_16x16x64_bf16 v[16:19], v[72:75], a[16:23], v3
    ds_read_b128 v[120:123], v2 offset:14336
    s_waitcnt lgkmcnt(11)
    v_smfmac_f32_16x16x64_bf16 v[16:19], v[76:79], a[24:31], v3
    ds_read_b128 v[124:127], v2 offset:15360
    s_waitcnt lgkmcnt(11)
    v_smfmac_f32_16x16x64_bf16 v[16:19], v[80:83], a[32:39], v3
    s_waitcnt lgkmcnt(10)
    v_smfmac_f32_16x16x64_bf16 v[16:19], v[84:87], a[40:47], v3
    s_waitcnt lgkmcnt(9)
    v_smfmac_f32_16x16x64_bf16 v[16:19], v[88:91], a[48:55], v3
    s_waitcnt lgkmcnt(8)
    v_smfmac_f32_16x16x64_bf16 v[16:19], v[92:95], a[56:63], v3
    s_waitcnt lgkmcnt(7)
    v_smfmac_f32_16x16x64_bf16 v[16:19], v[96:99], a[64:71], v3
    s_waitcnt lgkmcnt(6)
    v_smfmac_f32_16x16x64_bf16 v[16:19], v[100:103], a[72:79], v3
    s_waitcnt lgkmcnt(5)
    v_smfmac_f32_16x16x64_bf16 v[16:19], v[104:107], a[80:87], v3
    s_waitcnt lgkmcnt(4)
    v_smfmac_f32_16x16x64_bf16 v[16:19], v[108:111], a[88:95], v3
    s_waitcnt lgkmcnt(3)
    v_smfmac_f32_16x16x64_bf16 v[16:19], v[112:115], a[96:103], v3
    s_waitcnt lgkmcnt(2)
    v_smfmac_f32_16x16x64_bf16 v[16:19], v[116:119], a[104:111], v3
    s_waitcnt lgkmcnt(1)
    v_smfmac_f32_16x16x64_bf16 v[16:19], v[120:123], a[112:119], v3
    s_waitcnt lgkmcnt(0)
    v_smfmac_f32_16x16x64_bf16 v[16:19], v[124:127], a[120:127], v3
    s_nop 7
    v_permlane32_swap_b32 v16, v18
    v_permlane32_swap_b32 v17, v19
    v_add_f32 v16, v16, v18
    v_add_f32 v17, v17, v19
    v_cvt_pk_bf16_f32 v16, v16, v17
    ds_write_b16 v5, v16
    ds_write_b16_d16_hi v5, v16 offset:16
    s_mov_b64 exec, 1
    ds_add_u32 v29, v30
    s_mov_b64 exec, -1
L_s_xl_206:
    ds_read_b32 v10, v29
    ds_read_b128 v[64:67], v2 offset:61440
    s_cmp_eq_u32 s60, 63
    s_cbranch_scc1 L_s_last_205
    s_cmp_ge_u32 s44, 2
    s_cbranch_scc1 L_s_w2_207
    s_waitcnt lgkmcnt(0)
    v_mfma_f32_16x16x32_bf16 v[16:19], v[32:35], v[64:67], 0
L_s_w2_207_b:
    v_cmp_ne_u32 vcc, s58, v10
    s_nop 0
    s_cbranch_vccnz L_rt_209
    s_mov_b64 exec, s[50:51]
    s_nop 3
    v_cvt_pk_bf16_f32 v16, v16, v17
    v_cvt_pk_bf16_f32 v17, v18, v19
    v_pk_min_u16 v16, v16, v54
    v_pk_min_u16 v17, v17, v54
    buffer_store_dwordx2 v[16:17], v4, s[12:15], s61 offen
    s_mov_b64 exec, -1
L_s_w3_208_b:
    s_sleep 5
    s_mov_b32 s70, 1
L_s_xp_210:
    buffer_load_dwordx2 v[64:65], v7, s[12:15], s61 offen offset:0 sc1
    buffer_load_short_d16_hi v56, v28, s[12:15], s61 offen offset:0 sc1
    buffer_load_dwordx2 v[66:67], v7, s[12:15], s61 offen offset:512 sc1
    buffer_load_short_d16_hi v57, v28, s[12:15], s61 offen offset:128 sc1
    buffer_load_dwordx2 v[68:69], v7, s[12:15], s61 offen offset:1024 sc1
    buffer_load_short_d16_hi v58, v28, s[12:15], s61 offen offset:256 sc1
    buffer_load_dwordx2 v[70:71], v7, s[12:15], s61 offen offset:1536 sc1
    buffer_load_short_d16_hi v59, v28, s[12:15], s61 offen offset:384 sc1
    s_mov_b32 s46, 0x00003f80
    s_mov_b32 s47, 0x3f800000
    s_waitcnt vmcnt(6)
    v_dot2_f32_bf16 v16, v64, s46, 0
    v_dot2_f32_bf16 v17, v64, s47, 0
    v_dot2_f32_bf16 v18, v65, s46, 0
    v_dot2_f32_bf16 v19, v65, s47, 0
    s_waitcnt vmcnt(4)
    v_dot2_f32_bf16 v16, v66, s46, v16
    v_dot2_f32_bf16 v17, v66, s47, v17
    v_dot2_f32_bf16 v18, v67, s46, v18
    v_dot2_f32_bf16 v19, v67, s47, v19
    v_add_f32 v20, v56, v57
    s_waitcnt vmcnt(2)
    v_dot2_f32_bf16 v16, v68, s46, v16
    v_dot2_f32_bf16 v17, v68, s47, v17
    v_dot2_f32_bf16 v18, v69, s46, v18
    v_dot2_f32_bf16 v19, v69, s47, v19
    v_add_f32 v20, v20, v58
    s_waitcnt vmcnt(0)
    v_dot2_f32_bf16 v16, v70, s46, v16
    v_dot2_f32_bf16 v17, v70, s47, v17
    v_dot2_f32_bf16 v18, v71, s46, v18
    v_dot2_f32_bf16 v19, v71, s47, v19
    v_add_f32 v20, v20, v59
    s_nop 0
    v_cmp_u_f32 s[46:47], v16, v17
    v_cmp_u_f32 s[48:49], v18, v19
    v_cmp_u_f32 vcc, v20, v20
    v_max3_f32 v10, v16, v17, v18
    s_or_b64 s[46:47], s[46:47], s[48:49]
    v_max3_f32 v10, v10, v19, v20
    s_or_b64 vcc, vcc, s[46:47]
    s_cbranch_scc1 L_s_xf_211
L_s_xok_212:
    v_max_f32_dpp v11, v10, v10 row_ror:8 row_mask:0xf bank_mask:0xf
    v_max_f32_dpp v10, v10, v10 row_ror:8 row_mask:0xf bank_mask:0xf
    s_nop 1
    v_permlane16_swap_b32 v10, v11
    v_max_f32 v12, v10, v11
    v_max_f32 v10, v10, v11
    s_nop 1
    v_permlane32_swap_b32 v10, v12
    v_max_f32 v10, v10, v12
    v_mul_f32 v10, s66, v10
    v_fma_f32 v16, v16, s66, -v10
    v_fma_f32 v17, v17, s66, -v10
    v_fma_f32 v18, v18, s66, -v10
    v_fma_f32 v19, v19, s66, -v10
    v_fma_f32 v20, v20, s66, -v10
    v_exp_f32 v16, v16
    v_exp_f32 v17, v17
    v_exp_f32 v18, v18
    v_exp_f32 v19, v19
    v_exp_f32 v20, v20
    v_add_f32 v10, v16, v17
    v_add_f32 v11, v18, v19
    v_add_f32 v10, v10, v20
    v_add_f32 v10, v10, v11
    s_nop 1
    v_add_f32_dpp v11, v10, v10 row_ror:8 row_mask:0xf bank_mask:0xf
    v_add_f32_dpp v10, v10, v10 row_ror:8 row_mask:0xf bank_mask:0xf
    s_nop 1
    v_permlane16_swap_b32 v10, v11
    v_add_f32 v12, v10, v11
    v_add_f32 v10, v10, v11
    s_nop 1
    v_permlane32_swap_b32 v10, v12
    v_add_f32 v10, v10, v12
    v_rcp_f32 v10, v10
    s_nop 0
    v_mul_f32 v16, v16, v10
    v_mul_f32 v17, v17, v10
    v_mul_f32 v18, v18, v10
    v_mul_f32 v19, v19, v10
    v_mul_f32 v20, v20, v10
    v_cvt_pk_bf16_f32 v16, v16, v17
    v_cvt_pk_bf16_f32 v17, v18, v19
    v_cvt_pk_bf16_f32 v18, v20, v20
    ds_write_b64 v8, v[16:17]
    ds_write_b16 v9, v18
    s_waitcnt lgkmcnt(0)
    s_barrier
    s_add_u32 s63, s63, 786432
    s_cmp_ge_u32 s44, 2
    s_cbranch_scc1 L_s_nk_213
    buffer_load_dwordx4 v[32:35], v6, s[12:15], s63 offen sc1
L_s_nk_213:
    s_add_u32 s45, s60, 2
    s_cmp_le_u32 s69, s45
    s_cbranch_scc1 L_s_nk_213_w
    s_add_u32 s45, s63, 786432
    s_mov_b64 exec, 0xf
    buffer_load_dword v15, v14, s[12:15], s45 offen sc1
    s_mov_b64 exec, -1
L_s_nk_213_w:
    s_cmp_eq_u32 s44, 3
    s_cbranch_scc1 L_s_nr_214
    s_xor_b32 s45, s61, 0x8000
    s_mov_b64 exec, s[50:51]
    buffer_store_dwordx2 v[24:25], v4, s[12:15], s45 offen
    s_mov_b64 exec, -1
L_s_nr_214:
    s_cmp_lg_u32 s44, 3
    s_cbranch_scc1 L_s_np_215
    ds_read_b128 v[20:23], v6
    s_lshl_b32 s45, s60, 17
    s_add_u32 s45, s45, s67
    s_waitcnt lgkmcnt(0)
    v_min_u32 v20, -2, v20
    v_min_u32 v21, -2, v21
    v_min_u32 v22, -2, v22
    v_min_u32 v23, -2, v23
    buffer_store_dwordx4 v[20:23], v2, s[12:15], s45 offen sc1
L_s_np_215:
    s_add_u32 s68, s60, 2
    s_min_u32 s68, s68, 63
    v_readlane_b32 s45, v0, 0
    v_readlane_b32 s46, v0, 1
    s_nop 0
    s_min_u32 s45, s45, s46
    s_max_u32 s69, s69, s45
    s_cmp_gt_u32 s69, s68
    s_cbranch_scc1 L_kv_ok_218
    s_mov_b32 s70, 0
L_kv_lp_217:
    v_and_b32 v22, 1, v1
    v_lshlrev_b32 v22, 9, v22
    buffer_load_dword v23, v22, s[12:15], s57 offen sc1
    s_waitcnt vmcnt(0)
    v_readlane_b32 s69, v23, 0
    v_readlane_b32 s45, v23, 1
    s_add_u32 s70, s70, 1
    s_nop 2
    s_min_u32 s69, s69, s45
    s_cmp_gt_u32 s69, s68
    s_cbranch_scc1 L_kv_ok_218
    s_sleep 4
    s_cmp_lt_u32 s70, 524288
    s_cbranch_scc1 L_kv_lp_217
    s_branch L_c_done_1
L_kv_ok_218:
    s_add_u32 s45, s60, 7
    s_min_u32 s45, s45, 63
    s_cmp_gt_u32 s69, s45
    s_cbranch_scc1 L_s_na_216
    v_and_b32 v22, 1, v1
    v_lshlrev_b32 v22, 9, v22
    buffer_load_dword v0, v22, s[12:15], s57 offen sc1
L_s_na_216:
    s_sub_u32 s45, s60, 4
    s_cmp_gt_u32 s45, 24
    s_cbranch_scc1 L_s_xe_219
    s_sleep 1
    s_setprio 0
    s_bitcmp1_b32 s45, 0
    s_cbranch_scc1 L_s_x1_220
    s_cmp_eq_u32 s45, 0
    s_cbranch_scc1 L_s_x0_221
    s_bitcmp1_b32 s44, 0
    s_cbranch_scc1 L_s_x0_221
    ds_read_b128 v[40:43], v31
    s_sub_u32 s46, s45, 2
    s_lshr_b32 s47, s46, 2
    s_mul_i32 s47, s47, 786432
    s_and_b32 s46, s46, 2
    s_lshl_b32 s46, s46, 11
    s_add_u32 s47, s47, s46
    s_waitcnt lgkmcnt(0)
    buffer_store_dwordx4 v[40:43], v13, s[12:15], s47 offen sc1
L_s_x0_221:
    s_cmp_eq_u32 s45, 24
    s_cbranch_scc1 L_s_xe_219
    ds_read_b128 v[64:67], v44 offset:0
    ds_read_b128 v[68:71], v44 offset:1024
    ds_read_b128 v[72:75], v44 offset:2048
    ds_read_b128 v[76:79], v44 offset:3072
    ds_read_b128 v[80:83], v44 offset:4096
    ds_read_b128 v[84:87], v44 offset:5120
    ds_read_b128 v[88:91], v44 offset:6144
    ds_read_b128 v[92:95], v44 offset:7168
    ds_read_b128 v[96:99], v44 offset:8192
    ds_read_b128 v[100:103], v44 offset:9216
    ds_read_b128 v[104:107], v44 offset:10240
    ds_read_b128 v[108:111], v44 offset:11264
    s_waitcnt lgkmcnt(11)
    v_mfma_f32_16x16x32_bf16 v[36:39], a[0:3], v[64:67], 0
    ds_read_b128 v[112:115], v44 offset:12288
    s_waitcnt lgkmcnt(11)
    v_mfma_f32_16x16x32_bf16 v[36:39], a[4:7], v[68:71], v[36:39]
    ds_read_b128 v[116:119], v44 offset:13312
    s_waitcnt lgkmcnt(11)
    v_mfma_f32_16x16x32_bf16 v[36:39], a[8:11], v[72:75], v[36:39]
    ds_read_b128 v[120:123], v44 offset:14336
    s_waitcnt lgkmcnt(11)
    v_mfma_f32_16x16x32_bf16 v[36:39], a[12:15], v[76:79], v[36:39]
    ds_read_b128 v[124:127], v44 offset:15360
    s_waitcnt lgkmcnt(11)
    v_mfma_f32_16x16x32_bf16 v[36:39], a[16:19], v[80:83], v[36:39]
    s_waitcnt lgkmcnt(10)
    v_mfma_f32_16x16x32_bf16 v[36:39], a[20:23], v[84:87], v[36:39]
    s_waitcnt lgkmcnt(9)
    v_mfma_f32_16x16x32_bf16 v[36:39], a[24:27], v[88:91], v[36:39]
    s_waitcnt lgkmcnt(8)
    v_mfma_f32_16x16x32_bf16 v[36:39], a[28:31], v[92:95], v[36:39]
    s_waitcnt lgkmcnt(7)
    v_mfma_f32_16x16x32_bf16 v[36:39], a[32:35], v[96:99], v[36:39]
    s_waitcnt lgkmcnt(6)
    v_mfma_f32_16x16x32_bf16 v[36:39], a[36:39], v[100:103], v[36:39]
    s_waitcnt lgkmcnt(5)
    v_mfma_f32_16x16x32_bf16 v[36:39], a[40:43], v[104:107], v[36:39]
    s_waitcnt lgkmcnt(4)
    v_mfma_f32_16x16x32_bf16 v[36:39], a[44:47], v[108:111], v[36:39]
    s_waitcnt lgkmcnt(3)
    v_mfma_f32_16x16x32_bf16 v[36:39], a[48:51], v[112:115], v[36:39]
    s_waitcnt lgkmcnt(2)
    v_mfma_f32_16x16x32_bf16 v[36:39], a[52:55], v[116:119], v[36:39]
    s_waitcnt lgkmcnt(1)
    v_mfma_f32_16x16x32_bf16 v[36:39], a[56:59], v[120:123], v[36:39]
    s_waitcnt lgkmcnt(0)
    v_mfma_f32_16x16x32_bf16 v[36:39], a[60:63], v[124:127], v[36:39]
    s_branch L_s_xe_219
L_s_x1_220:
    ds_read_b128 v[64:67], v44 offset:16384
    ds_read_b128 v[68:71], v44 offset:17408
    ds_read_b128 v[72:75], v44 offset:18432
    ds_read_b128 v[76:79], v44 offset:19456
    ds_read_b128 v[80:83], v44 offset:20480
    ds_read_b128 v[84:87], v44 offset:21504
    ds_read_b128 v[88:91], v44 offset:22528
    ds_read_b128 v[92:95], v44 offset:23552
    ds_read_b128 v[96:99], v44 offset:24576
    ds_read_b128 v[100:103], v44 offset:25600
    ds_read_b128 v[104:107], v44 offset:26624
    ds_read_b128 v[108:111], v44 offset:27648
    s_waitcnt lgkmcnt(11)
    v_mfma_f32_16x16x32_bf16 v[36:39], a[64:67], v[64:67], v[36:39]
    ds_read_b128 v[112:115], v44 offset:28672
    s_waitcnt lgkmcnt(11)
    v_mfma_f32_16x16x32_bf16 v[36:39], a[68:71], v[68:71], v[36:39]
    ds_read_b128 v[116:119], v44 offset:29696
    s_waitcnt lgkmcnt(11)
    v_mfma_f32_16x16x32_bf16 v[36:39], a[72:75], v[72:75], v[36:39]
    ds_read_b128 v[120:123], v44 offset:30720
    s_waitcnt lgkmcnt(11)
    v_mfma_f32_16x16x32_bf16 v[36:39], a[76:79], v[76:79], v[36:39]
    ds_read_b128 v[124:127], v44 offset:31744
    s_waitcnt lgkmcnt(11)
    v_mfma_f32_16x16x32_bf16 v[36:39], a[80:83], v[80:83], v[36:39]
    s_waitcnt lgkmcnt(10)
    v_mfma_f32_16x16x32_bf16 v[36:39], a[84:87], v[84:87], v[36:39]
    s_waitcnt lgkmcnt(9)
    v_mfma_f32_16x16x32_bf16 v[36:39], a[88:91], v[88:91], v[36:39]
    s_waitcnt lgkmcnt(8)
    v_mfma_f32_16x16x32_bf16 v[36:39], a[92:95], v[92:95], v[36:39]
    s_waitcnt lgkmcnt(7)
    v_mfma_f32_16x16x32_bf16 v[36:39], a[96:99], v[96:99], v[36:39]
    s_waitcnt lgkmcnt(6)
    v_mfma_f32_16x16x32_bf16 v[36:39], a[100:103], v[100:103], v[36:39]
    s_waitcnt lgkmcnt(5)
    v_mfma_f32_16x16x32_bf16 v[36:39], a[104:107], v[104:107], v[36:39]
    s_waitcnt lgkmcnt(4)
    v_mfma_f32_16x16x32_bf16 v[36:39], a[108:111], v[108:111], v[36:39]
    s_waitcnt lgkmcnt(3)
    v_mfma_f32_16x16x32_bf16 v[36:39], a[112:115], v[112:115], v[36:39]
    s_waitcnt lgkmcnt(2)
    v_mfma_f32_16x16x32_bf16 v[36:39], a[116:119], v[116:119], v[36:39]
    s_waitcnt lgkmcnt(1)
    v_mfma_f32_16x16x32_bf16 v[36:39], a[120:123], v[120:123], v[36:39]
    s_waitcnt lgkmcnt(0)
    v_mfma_f32_16x16x32_bf16 v[36:39], a[124:127], v[124:127], v[36:39]
    s_nop 7
    v_cvt_pk_bf16_f32 v40, v36, v37
    v_cvt_pk_bf16_f32 v41, v38, v39
    ds_write_b64 v45, v[40:41]
    s_waitcnt lgkmcnt(0)
L_s_xe_219:
    s_setprio 1
    s_add_u32 s60, s60, 1
    s_add_u32 s61, s61, 0x4000
    s_and_b32 s61, s61, 0xffff
    s_branch L_s_loop_204
L_s_last_205:
    s_waitcnt lgkmcnt(0)
    s_barrier
    s_cmp_lg_u32 s44, 3
    s_cbranch_scc1 L_s_np_222
    ds_read_b128 v[20:23], v6
    s_lshl_b32 s45, s60, 17
    s_add_u32 s45, s45, s67
    s_waitcnt lgkmcnt(0)
    v_min_u32 v20, -2, v20
    v_min_u32 v21, -2, v21
    v_min_u32 v22, -2, v22
    v_min_u32 v23, -2, v23
    buffer_store_dwordx4 v[20:23], v2, s[12:15], s45 offen sc1
L_s_np_222:
    s_branch L_replica
L_rt_199:
    s_add_u32 s70, s70, 1
    s_cmp_lt_u32 s70, 524288
    s_cbranch_scc1 L_c_rp_198
    s_branch L_c_done_1
L_rt_209:
    s_add_u32 s70, s70, 1
    s_cmp_lt_u32 s70, 524288
    s_cbranch_scc1 L_s_xl_206
    s_branch L_c_done_1
L_s_w2_207:
    s_cmp_eq_u32 s44, 3
    s_cbranch_scc1 L_s_w3_208
    s_waitcnt lgkmcnt(0)
    v_mfma_f32_16x16x32_bf16 v[16:19], v[64:67], v[64:67], 0
    s_branch L_s_w2_207_b
L_s_w3_208:
    s_sleep 3
    s_branch L_s_w3_208_b
L_s_xf_211:
    v_or_b32 v72, 0xffff, v56
    v_or_b32 v73, 0xffff, v57
    v_or_b32 v74, 0xffff, v58
    v_or_b32 v75, 0xffff, v59
    v_max3_u32 v11, v64, v65, v66
    v_max3_u32 v11, v11, v67, v68
    v_max3_u32 v11, v11, v69, v70
    v_max3_u32 v11, v11, v71, v72
    v_max3_u32 v11, v11, v73, v74
    v_max_u32 v11, v11, v75
    v_cmp_eq_u32 vcc, -1, v11
    s_add_u32 s70, s70, 1
    s_cbranch_vccz L_s_xok_212
    s_cmp_lt_u32 s70, 524288
    s_cbranch_scc1 L_s_xp_210
    s_branch L_c_done_1
L_ss_201:
.p2align 6
L_s_loop_223:
    v_mov_b32 v16, 0
    v_mov_b32 v17, 0
    v_mov_b32 v18, 0
    v_mov_b32 v19, 0
    s_add_u32 s58, s58, 4
    s_mov_b32 s70, 1
    s_waitcnt vmcnt(0) lgkmcnt(0)
    s_barrier
    ds_read_b128 v[64:67], v2 offset:0
    ds_read_b128 v[68:71], v2 offset:1024
    ds_read_b128 v[72:75], v2 offset:2048
    ds_read_b128 v[76:79], v2 offset:3072
    ds_read_b128 v[80:83], v2 offset:4096
    ds_read_b128 v[84:87], v2 offset:5120
    ds_read_b128 v[88:91], v2 offset:6144
    ds_read_b128 v[92:95], v2 offset:7168
    ds_read_b128 v[96:99], v2 offset:8192
    ds_read_b128 v[100:103], v2 offset:9216
    ds_read_b128 v[104:107], v2 offset:10240
    ds_read_b128 v[108:111], v2 offset:11264
    s_waitcnt lgkmcnt(11)
    v_smfmac_f32_16x16x64_bf16 v[16:19], v[64:67], a[0:7], v3
    ds_read_b128 v[112:115], v2 offset:12288
    s_waitcnt lgkmcnt(11)
    v_smfmac_f32_16x16x64_bf16 v[16:19], v[68:71], a[8:15], v3
    ds_read_b128 v[116:119], v2 offset:13312
    s_waitcnt lgkmcnt(11)
    v_smfmac_f32_16x16x64_bf16 v[16:19], v[72:75], a[16:23], v3
    ds_read_b128 v[120:123], v2 offset:14336
    s_waitcnt lgkmcnt(11)
    v_smfmac_f32_16x16x64_bf16 v[16:19], v[76:79], a[24:31], v3
    ds_read_b128 v[124:127], v2 offset:15360
    s_waitcnt lgkmcnt(11)
    v_smfmac_f32_16x16x64_bf16 v[16:19], v[80:83], a[32:39], v3
    s_waitcnt lgkmcnt(10)
    v_smfmac_f32_16x16x64_bf16 v[16:19], v[84:87], a[40:47], v3
    s_waitcnt lgkmcnt(9)
    v_smfmac_f32_16x16x64_bf16 v[16:19], v[88:91], a[48:55], v3
    s_waitcnt lgkmcnt(8)
    v_smfmac_f32_16x16x64_bf16 v[16:19], v[92:95], a[56:63], v3
    s_waitcnt lgkmcnt(7)
    v_smfmac_f32_16x16x64_bf16 v[16:19], v[96:99], a[64:71], v3
    s_waitcnt lgkmcnt(6)
    v_smfmac_f32_16x16x64_bf16 v[16:19], v[100:103], a[72:79], v3
    s_waitcnt lgkmcnt(5)
    v_smfmac_f32_16x16x64_bf16 v[16:19], v[104:107], a[80:87], v3
    s_waitcnt lgkmcnt(4)
    v_smfmac_f32_16x16x64_bf16 v[16:19], v[108:111], a[88:95], v3
    s_waitcnt lgkmcnt(3)
    v_smfmac_f32_16x16x64_bf16 v[16:19], v[112:115], a[96:103], v3
    s_waitcnt lgkmcnt(2)
    v_smfmac_f32_16x16x64_bf16 v[16:19], v[116:119], a[104:111], v3
    s_waitcnt lgkmcnt(1)
    v_smfmac_f32_16x16x64_bf16 v[16:19], v[120:123], a[112:119], v3
    s_waitcnt lgkmcnt(0)
    v_smfmac_f32_16x16x64_bf16 v[16:19], v[124:127], a[120:127], v3
    s_nop 7
    v_permlane32_swap_b32 v16, v18
    v_permlane32_swap_b32 v17, v19
    v_add_f32 v16, v16, v18
    v_add_f32 v17, v17, v19
    v_cvt_pk_bf16_f32 v16, v16, v17
    ds_write_b16 v5, v16
    ds_write_b16_d16_hi v5, v16 offset:16
    s_mov_b64 exec, 1
    ds_add_u32 v29, v30
    s_mov_b64 exec, -1
L_s_xl_225:
    ds_read_b32 v10, v29
    ds_read_b128 v[64:67], v2 offset:61440
    s_cmp_eq_u32 s60, 63
    s_cbranch_scc1 L_s_last_224
    s_cmp_ge_u32 s44, 2
    s_cbranch_scc1 L_s_w2_226
    s_waitcnt lgkmcnt(0)
    v_mfma_f32_16x16x32_bf16 v[16:19], v[32:35], v[64:67], 0
L_s_w2_226_b:
    v_cmp_ne_u32 vcc, s58, v10
    s_nop 0
    s_cbranch_vccnz L_rt_228
    s_mov_b64 exec, s[50:51]
    s_nop 3
    v_cvt_pk_bf16_f32 v16, v16, v17
    v_cvt_pk_bf16_f32 v17, v18, v19
    v_pk_min_u16 v16, v16, v54
    v_pk_min_u16 v17, v17, v54
    buffer_store_dwordx2 v[16:17], v4, s[12:15], s61 offen sc1
    s_mov_b64 exec, -1
L_s_w3_227_b:
    s_sleep 5
    s_mov_b32 s70, 1
L_s_xp_229:
    buffer_load_dwordx2 v[64:65], v7, s[12:15], s61 offen offset:0 sc1
    buffer_load_short_d16_hi v56, v28, s[12:15], s61 offen offset:0 sc1
    buffer_load_dwordx2 v[66:67], v7, s[12:15], s61 offen offset:512 sc1
    buffer_load_short_d16_hi v57, v28, s[12:15], s61 offen offset:128 sc1
    buffer_load_dwordx2 v[68:69], v7, s[12:15], s61 offen offset:1024 sc1
    buffer_load_short_d16_hi v58, v28, s[12:15], s61 offen offset:256 sc1
    buffer_load_dwordx2 v[70:71], v7, s[12:15], s61 offen offset:1536 sc1
    buffer_load_short_d16_hi v59, v28, s[12:15], s61 offen offset:384 sc1
    s_mov_b32 s46, 0x00003f80
    s_mov_b32 s47, 0x3f800000
    s_waitcnt vmcnt(6)
    v_dot2_f32_bf16 v16, v64, s46, 0
    v_dot2_f32_bf16 v17, v64, s47, 0
    v_dot2_f32_bf16 v18, v65, s46, 0
    v_dot2_f32_bf16 v19, v65, s47, 0
    s_waitcnt vmcnt(4)
    v_dot2_f32_bf16 v16, v66, s46, v16
    v_dot2_f32_bf16 v17, v66, s47, v17
    v_dot2_f32_bf16 v18, v67, s46, v18
    v_dot2_f32_bf16 v19, v67, s47, v19
    v_add_f32 v20, v56, v57
    s_waitcnt vmcnt(2)
    v_dot2_f32_bf16 v16, v68, s46, v16
    v_dot2_f32_bf16 v17, v68, s47, v17
    v_dot2_f32_bf16 v18, v69, s46, v18
    v_dot2_f32_bf16 v19, v69, s47, v19
    v_add_f32 v20, v20, v58
    s_waitcnt vmcnt(0)
    v_dot2_f32_bf16 v16, v70, s46, v16
    v_dot2_f32_bf16 v17, v70, s47, v17
    v_dot2_f32_bf16 v18, v71, s46, v18
    v_dot2_f32_bf16 v19, v71, s47, v19
    v_add_f32 v20, v20, v59
    s_nop 0
    v_cmp_u_f32 s[46:47], v16, v17
    v_cmp_u_f32 s[48:49], v18, v19
    v_cmp_u_f32 vcc, v20, v20
    v_max3_f32 v10, v16, v17, v18
    s_or_b64 s[46:47], s[46:47], s[48:49]
    v_max3_f32 v10, v10, v19, v20
    s_or_b64 vcc, vcc, s[46:47]
    s_cbranch_scc1 L_s_xf_230
L_s_xok_231:
    v_max_f32_dpp v11, v10, v10 row_ror:8 row_mask:0xf bank_mask:0xf
    v_max_f32_dpp v10, v10, v10 row_ror:8 row_mask:0xf bank_mask:0xf
    s_nop 1
    v_permlane16_swap_b32 v10, v11
    v_max_f32 v12, v10, v11
    v_max_f32 v10, v10, v11
    s_nop 1
    v_permlane32_swap_b32 v10, v12
    v_max_f32 v10, v10, v12
    v_mul_f32 v10, s66, v10
    v_fma_f32 v16, v16, s66, -v10
    v_fma_f32 v17, v17, s66, -v10
    v_fma_f32 v18, v18, s66, -v10
    v_fma_f32 v19, v19, s66, -v10
    v_fma_f32 v20, v20, s66, -v10
    v_exp_f32 v16, v16
    v_exp_f32 v17, v17
    v_exp_f32 v18, v18
    v_exp_f32 v19, v19
    v_exp_f32 v20, v20
    v_add_f32 v10, v16, v17
    v_add_f32 v11, v18, v19
    v_add_f32 v10, v10, v20
    v_add_f32 v10, v10, v11
    s_nop 1
    v_add_f32_dpp v11, v10, v10 row_ror:8 row_mask:0xf bank_mask:0xf
    v_add_f32_dpp v10, v10, v10 row_ror:8 row_mask:0xf bank_mask:0xf
    s_nop 1
    v_permlane16_swap_b32 v10, v11
    v_add_f32 v12, v10, v11
    v_add_f32 v10, v10, v11
    s_nop 1
    v_permlane32_swap_b32 v10, v12
    v_add_f32 v10, v10, v12
    v_rcp_f32 v10, v10
    s_nop 0
    v_mul_f32 v16, v16, v10
    v_mul_f32 v17, v17, v10
    v_mul_f32 v18, v18, v10
    v_mul_f32 v19, v19, v10
    v_mul_f32 v20, v20, v10
    v_cvt_pk_bf16_f32 v16, v16, v17
    v_cvt_pk_bf16_f32 v17, v18, v19
    v_cvt_pk_bf16_f32 v18, v20, v20
    ds_write_b64 v8, v[16:17]
    ds_write_b16 v9, v18
    s_waitcnt lgkmcnt(0)
    s_barrier
    s_add_u32 s63, s63, 786432
    s_cmp_ge_u32 s44, 2
    s_cbranch_scc1 L_s_nk_232
    buffer_load_dwordx4 v[32:35], v6, s[12:15], s63 offen sc1
L_s_nk_232:
    s_add_u32 s45, s60, 2
    s_cmp_le_u32 s69, s45
    s_cbranch_scc1 L_s_nk_232_w
    s_add_u32 s45, s63, 786432
    s_mov_b64 exec, 0xf
    buffer_load_dword v15, v14, s[12:15], s45 offen sc1
    s_mov_b64 exec, -1
L_s_nk_232_w:
    s_cmp_eq_u32 s44, 3
    s_cbranch_scc1 L_s_nr_233
    s_xor_b32 s45, s61, 0x8000
    s_mov_b64 exec, s[50:51]
    buffer_store_dwordx2 v[24:25], v4, s[12:15], s45 offen sc1
    s_mov_b64 exec, -1
L_s_nr_233:
    s_cmp_lg_u32 s44, 3
    s_cbranch_scc1 L_s_np_234
    ds_read_b128 v[20:23], v6
    s_lshl_b32 s45, s60, 17
    s_add_u32 s45, s45, s67
    s_waitcnt lgkmcnt(0)
    v_min_u32 v20, -2, v20
    v_min_u32 v21, -2, v21
    v_min_u32 v22, -2, v22
    v_min_u32 v23, -2, v23
    buffer_store_dwordx4 v[20:23], v2, s[12:15], s45 offen sc1
L_s_np_234:
    s_add_u32 s68, s60, 2
    s_min_u32 s68, s68, 63
    v_readlane_b32 s45, v0, 0
    v_readlane_b32 s46, v0, 1
    s_nop 0
    s_min_u32 s45, s45, s46
    s_max_u32 s69, s69, s45
    s_cmp_gt_u32 s69, s68
    s_cbranch_scc1 L_kv_ok_237
    s_mov_b32 s70, 0
L_kv_lp_236:
    v_and_b32 v22, 1, v1
    v_lshlrev_b32 v22, 9, v22
    buffer_load_dword v23, v22, s[12:15], s57 offen sc1
    s_waitcnt vmcnt(0)
    v_readlane_b32 s69, v23, 0
    v_readlane_b32 s45, v23, 1
    s_add_u32 s70, s70, 1
    s_nop 2
    s_min_u32 s69, s69, s45
    s_cmp_gt_u32 s69, s68
    s_cbranch_scc1 L_kv_ok_237
    s_sleep 4
    s_cmp_lt_u32 s70, 524288
    s_cbranch_scc1 L_kv_lp_236
    s_branch L_c_done_1
L_kv_ok_237:
    s_add_u32 s45, s60, 7
    s_min_u32 s45, s45, 63
    s_cmp_gt_u32 s69, s45
    s_cbranch_scc1 L_s_na_235
    v_and_b32 v22, 1, v1
    v_lshlrev_b32 v22, 9, v22
    buffer_load_dword v0, v22, s[12:15], s57 offen sc1
L_s_na_235:
    s_sub_u32 s45, s60, 4
    s_cmp_gt_u32 s45, 24
    s_cbranch_scc1 L_s_xe_238
    s_sleep 1
    s_setprio 0
    s_bitcmp1_b32 s45, 0
    s_cbranch_scc1 L_s_x1_239
    s_cmp_eq_u32 s45, 0
    s_cbranch_scc1 L_s_x0_240
    s_bitcmp1_b32 s44, 0
    s_cbranch_scc1 L_s_x0_240
    ds_read_b128 v[40:43], v31
    s_sub_u32 s46, s45, 2
    s_lshr_b32 s47, s46, 2
    s_mul_i32 s47, s47, 786432
    s_and_b32 s46, s46, 2
    s_lshl_b32 s46, s46, 11
    s_add_u32 s47, s47, s46
    s_waitcnt lgkmcnt(0)
    buffer_store_dwordx4 v[40:43], v13, s[12:15], s47 offen sc1
L_s_x0_240:
    s_cmp_eq_u32 s45, 24
    s_cbranch_scc1 L_s_xe_238
    ds_read_b128 v[64:67], v44 offset:0
    ds_read_b128 v[68:71], v44 offset:1024
    ds_read_b128 v[72:75], v44 offset:2048
    ds_read_b128 v[76:79], v44 offset:3072
    ds_read_b128 v[80:83], v44 offset:4096
    ds_read_b128 v[84:87], v44 offset:5120
    ds_read_b128 v[88:91], v44 offset:6144
    ds_read_b128 v[92:95], v44 offset:7168
    ds_read_b128 v[96:99], v44 offset:8192
    ds_read_b128 v[100:103], v44 offset:9216
    ds_read_b128 v[104:107], v44 offset:10240
    ds_read_b128 v[108:111], v44 offset:11264
    s_waitcnt lgkmcnt(11)
    v_mfma_f32_16x16x32_bf16 v[36:39], a[0:3], v[64:67], 0
    ds_read_b128 v[112:115], v44 offset:12288
    s_waitcnt lgkmcnt(11)
    v_mfma_f32_16x16x32_bf16 v[36:39], a[4:7], v[68:71], v[36:39]
    ds_read_b128 v[116:119], v44 offset:13312
    s_waitcnt lgkmcnt(11)
    v_mfma_f32_16x16x32_bf16 v[36:39], a[8:11], v[72:75], v[36:39]
    ds_read_b128 v[120:123], v44 offset:14336
    s_waitcnt lgkmcnt(11)
    v_mfma_f32_16x16x32_bf16 v[36:39], a[12:15], v[76:79], v[36:39]
    ds_read_b128 v[124:127], v44 offset:15360
    s_waitcnt lgkmcnt(11)
    v_mfma_f32_16x16x32_bf16 v[36:39], a[16:19], v[80:83], v[36:39]
    s_waitcnt lgkmcnt(10)
    v_mfma_f32_16x16x32_bf16 v[36:39], a[20:23], v[84:87], v[36:39]
    s_waitcnt lgkmcnt(9)
    v_mfma_f32_16x16x32_bf16 v[36:39], a[24:27], v[88:91], v[36:39]
    s_waitcnt lgkmcnt(8)
    v_mfma_f32_16x16x32_bf16 v[36:39], a[28:31], v[92:95], v[36:39]
    s_waitcnt lgkmcnt(7)
    v_mfma_f32_16x16x32_bf16 v[36:39], a[32:35], v[96:99], v[36:39]
    s_waitcnt lgkmcnt(6)
    v_mfma_f32_16x16x32_bf16 v[36:39], a[36:39], v[100:103], v[36:39]
    s_waitcnt lgkmcnt(5)
    v_mfma_f32_16x16x32_bf16 v[36:39], a[40:43], v[104:107], v[36:39]
    s_waitcnt lgkmcnt(4)
    v_mfma_f32_16x16x32_bf16 v[36:39], a[44:47], v[108:111], v[36:39]
    s_waitcnt lgkmcnt(3)
    v_mfma_f32_16x16x32_bf16 v[36:39], a[48:51], v[112:115], v[36:39]
    s_waitcnt lgkmcnt(2)
    v_mfma_f32_16x16x32_bf16 v[36:39], a[52:55], v[116:119], v[36:39]
    s_waitcnt lgkmcnt(1)
    v_mfma_f32_16x16x32_bf16 v[36:39], a[56:59], v[120:123], v[36:39]
    s_waitcnt lgkmcnt(0)
    v_mfma_f32_16x16x32_bf16 v[36:39], a[60:63], v[124:127], v[36:39]
    s_branch L_s_xe_238
L_s_x1_239:
    ds_read_b128 v[64:67], v44 offset:16384
    ds_read_b128 v[68:71], v44 offset:17408
    ds_read_b128 v[72:75], v44 offset:18432
    ds_read_b128 v[76:79], v44 offset:19456
    ds_read_b128 v[80:83], v44 offset:20480
    ds_read_b128 v[84:87], v44 offset:21504
    ds_read_b128 v[88:91], v44 offset:22528
    ds_read_b128 v[92:95], v44 offset:23552
    ds_read_b128 v[96:99], v44 offset:24576
    ds_read_b128 v[100:103], v44 offset:25600
    ds_read_b128 v[104:107], v44 offset:26624
    ds_read_b128 v[108:111], v44 offset:27648
    s_waitcnt lgkmcnt(11)
    v_mfma_f32_16x16x32_bf16 v[36:39], a[64:67], v[64:67], v[36:39]
    ds_read_b128 v[112:115], v44 offset:28672
    s_waitcnt lgkmcnt(11)
    v_mfma_f32_16x16x32_bf16 v[36:39], a[68:71], v[68:71], v[36:39]
    ds_read_b128 v[116:119], v44 offset:29696
    s_waitcnt lgkmcnt(11)
    v_mfma_f32_16x16x32_bf16 v[36:39], a[72:75], v[72:75], v[36:39]
    ds_read_b128 v[120:123], v44 offset:30720
    s_waitcnt lgkmcnt(11)
    v_mfma_f32_16x16x32_bf16 v[36:39], a[76:79], v[76:79], v[36:39]
    ds_read_b128 v[124:127], v44 offset:31744
    s_waitcnt lgkmcnt(11)
    v_mfma_f32_16x16x32_bf16 v[36:39], a[80:83], v[80:83], v[36:39]
    s_waitcnt lgkmcnt(10)
    v_mfma_f32_16x16x32_bf16 v[36:39], a[84:87], v[84:87], v[36:39]
    s_waitcnt lgkmcnt(9)
    v_mfma_f32_16x16x32_bf16 v[36:39], a[88:91], v[88:91], v[36:39]
    s_waitcnt lgkmcnt(8)
    v_mfma_f32_16x16x32_bf16 v[36:39], a[92:95], v[92:95], v[36:39]
    s_waitcnt lgkmcnt(7)
    v_mfma_f32_16x16x32_bf16 v[36:39], a[96:99], v[96:99], v[36:39]
    s_waitcnt lgkmcnt(6)
    v_mfma_f32_16x16x32_bf16 v[36:39], a[100:103], v[100:103], v[36:39]
    s_waitcnt lgkmcnt(5)
    v_mfma_f32_16x16x32_bf16 v[36:39], a[104:107], v[104:107], v[36:39]
    s_waitcnt lgkmcnt(4)
    v_mfma_f32_16x16x32_bf16 v[36:39], a[108:111], v[108:111], v[36:39]
    s_waitcnt lgkmcnt(3)
    v_mfma_f32_16x16x32_bf16 v[36:39], a[112:115], v[112:115], v[36:39]
    s_waitcnt lgkmcnt(2)
    v_mfma_f32_16x16x32_bf16 v[36:39], a[116:119], v[116:119], v[36:39]
    s_waitcnt lgkmcnt(1)
    v_mfma_f32_16x16x32_bf16 v[36:39], a[120:123], v[120:123], v[36:39]
    s_waitcnt lgkmcnt(0)
    v_mfma_f32_16x16x32_bf16 v[36:39], a[124:127], v[124:127], v[36:39]
    s_nop 7
    v_cvt_pk_bf16_f32 v40, v36, v37
    v_cvt_pk_bf16_f32 v41, v38, v39
    ds_write_b64 v45, v[40:41]
    s_waitcnt lgkmcnt(0)
L_s_xe_238:
    s_setprio 1
    s_add_u32 s60, s60, 1
    s_add_u32 s61, s61, 0x4000
    s_and_b32 s61, s61, 0xffff
    s_branch L_s_loop_223
L_s_last_224:
    s_waitcnt lgkmcnt(0)
    s_barrier
    s_cmp_lg_u32 s44, 3
    s_cbranch_scc1 L_s_np_241
    ds_read_b128 v[20:23], v6
    s_lshl_b32 s45, s60, 17
    s_add_u32 s45, s45, s67
    s_waitcnt lgkmcnt(0)
    v_min_u32 v20, -2, v20
    v_min_u32 v21, -2, v21
    v_min_u32 v22, -2, v22
    v_min_u32 v23, -2, v23
    buffer_store_dwordx4 v[20:23], v2, s[12:15], s45 offen sc1
L_s_np_241:
    s_branch L_replica
L_rt_228:
    s_add_u32 s70, s70, 1
    s_cmp_lt_u32 s70, 524288
    s_cbranch_scc1 L_s_xl_225
    s_branch L_c_done_1
L_s_w2_226:
    s_cmp_eq_u32 s44, 3
    s_cbranch_scc1 L_s_w3_227
    s_waitcnt lgkmcnt(0)
    v_mfma_f32_16x16x32_bf16 v[16:19], v[64:67], v[64:67], 0
    s_branch L_s_w2_226_b
L_s_w3_227:
    s_sleep 3
    s_branch L_s_w3_227_b
L_s_xf_230:
    v_or_b32 v72, 0xffff, v56
    v_or_b32 v73, 0xffff, v57
    v_or_b32 v74, 0xffff, v58
    v_or_b32 v75, 0xffff, v59
    v_max3_u32 v11, v64, v65, v66
    v_max3_u32 v11, v11, v67, v68
    v_max3_u32 v11, v11, v69, v70
    v_max3_u32 v11, v11, v71, v72
    v_max3_u32 v11, v11, v73, v74
    v_max_u32 v11, v11, v75
    v_cmp_eq_u32 vcc, -1, v11
    s_add_u32 s70, s70, 1
    s_cbranch_vccz L_s_xok_231
    s_cmp_lt_u32 s70, 524288
    s_cbranch_scc1 L_s_xp_229
    s_branch L_c_done_1
L_vf_202:
    s_cmp_eq_u32 s52, 0
    s_cbranch_scc1 L_vs_203
    s_mov_b32 s70, 1
    v_mov_b32 v16, 0
    v_mov_b32 v17, 0
    s_branch L_v_l1m_244
.p2align 6
L_v_loop_242:
    s_mov_b32 s70, 1
    buffer_load_dwordx4 v[64:67], v9, s[12:15], s61 offen offset:0 sc1
    buffer_load_dwordx4 v[68:71], v9, s[12:15], s61 offen offset:1024 sc1
    buffer_load_dwordx4 v[72:75], v9, s[12:15], s61 offen offset:2048 sc1
    buffer_load_dwordx4 v[76:79], v9, s[12:15], s61 offen offset:3072 sc1
    v_mov_b32 v16, 0
    v_mov_b32 v17, 0
    v_mov_b32 v18, 0
    v_mov_b32 v19, 0
    v_mov_b32 v20, 0
    v_mov_b32 v21, 0
    v_mov_b32 v22, 0
    v_mov_b32 v23, 0
L_v_l1m_244:
    s_waitcnt vmcnt(3)
    ds_write_b128 v10, v[64:67] offset:0
    v_max3_u32 v24, v64, v65, v66
    v_max_u32 v24, v24, v67
    v_cmp_eq_u32 s[48:49], -1, v24
    s_waitcnt vmcnt(2)
    ds_write_b128 v10, v[68:71] offset:1024
    v_max3_u32 v24, v68, v69, v70
    v_max_u32 v24, v24, v71
    v_cmp_eq_u32 s[50:51], -1, v24
    s_waitcnt vmcnt(1)
    ds_write_b128 v10, v[72:75] offset:2048
    v_max3_u32 v24, v72, v73, v74
    v_max_u32 v24, v24, v75
    v_cmp_eq_u32 s[52:53], -1, v24
    s_waitcnt vmcnt(0)
    ds_write_b128 v10, v[76:79] offset:3072
    v_max3_u32 v24, v76, v77, v78
    v_max_u32 v24, v24, v79
    v_cmp_eq_u32 s[54:55], -1, v24
    s_or_b64 s[46:47], s[48:49], s[50:51]
    s_or_b64 vcc, s[52:53], s[54:55]
    s_or_b64 vcc, vcc, s[46:47]
    s_cbranch_scc1 L_v_l1_243
L_v_l1ok_245:
    s_waitcnt lgkmcnt(0)
    s_barrier
    v_smfmac_f32_16x16x64_bf16 v[16:19], v[64:67], a[0:7], v3
    v_smfmac_f32_16x16x64_bf16 v[20:23], v[64:67], a[32:39], v3
    v_smfmac_f32_16x16x64_bf16 v[16:19], v[68:71], a[8:15], v3
    v_smfmac_f32_16x16x64_bf16 v[20:23], v[68:71], a[40:47], v3
    v_smfmac_f32_16x16x64_bf16 v[16:19], v[72:75], a[16:23], v3
    v_smfmac_f32_16x16x64_bf16 v[20:23], v[72:75], a[48:55], v3
    v_smfmac_f32_16x16x64_bf16 v[16:19], v[76:79], a[24:31], v3
    v_smfmac_f32_16x16x64_bf16 v[20:23], v[76:79], a[56:63], v3
    s_nop 6
    v_permlane32_swap_b32 v16, v18
    v_permlane32_swap_b32 v17, v19
    v_permlane32_swap_b32 v20, v22
    v_permlane32_swap_b32 v21, v23
    v_add_f32 v16, v16, v18
    v_add_f32 v17, v17, v19
    v_add_f32 v18, v20, v22
    v_add_f32 v19, v21, v23
    ds_write_b128 v14, v[16:19]
    s_mov_b64 exec, 1
    ds_add_u32 v29, v30
    s_mov_b64 exec, -1
    s_add_u32 s58, s58, 4
    s_bitcmp1_b32 s44, 0
    s_cbranch_scc1 L_v_k1_247_c
    s_mov_b32 s70, 0
L_v_rl_248:
    ds_read_b32 v24, v29
    ds_read_b64 v[16:17], v13 offset:0
    ds_read_b64 v[18:19], v13 offset:1024
    ds_read_b64 v[20:21], v13 offset:2048
    ds_read_b64 v[22:23], v13 offset:3072
    s_waitcnt lgkmcnt(2)
    v_cmp_ne_u32 vcc, s58, v24
    v_add_f32 v16, v16, v18
    v_add_f32 v17, v17, v19
    s_waitcnt lgkmcnt(0)
    s_cbranch_vccnz L_rt_249
    v_add_f32 v20, v20, v22
    v_add_f32 v21, v21, v23
    v_add_f32 v16, v16, v20
    v_add_f32 v17, v17, v21
    s_mov_b32 vcc_lo, 0x55555555
    s_mov_b32 vcc_hi, 0x55555555
    v_cndmask_b32_dpp v18, v17, v16, vcc quad_perm:[1,0,3,2] row_mask:0xf bank_mask:0xf
    s_not_b64 vcc, vcc
    v_cndmask_b32_dpp v19, v16, v17, vcc quad_perm:[1,0,3,2] row_mask:0xf bank_mask:0xf
    v_cvt_pk_bf16_f32 v18, v18, v19
    v_min_u32 v18, -2, v18
    buffer_store_dword v18, v4, s[12:15], s62 offen
    ds_write_b32 v5, v18
L_v_k1_247:
    s_cmp_eq_u32 s60, 63
    s_cbranch_scc1 L_v_last_246
    ds_read_b128 v[80:83], v27 offset:32768
    ds_read_b128 v[84:87], v27 offset:36864
    ds_read_b128 v[88:91], v27 offset:40960
    ds_read_b128 v[92:95], v27 offset:45056
    v_mov_b32 v96, 0
    v_mov_b32 v97, 0
    v_mov_b32 v98, 0
    v_mov_b32 v99, 0
    v_mov_b32 v100, 0
    v_mov_b32 v101, 0
    v_mov_b32 v102, 0
    v_mov_b32 v103, 0
    v_mov_b32 v104, 0
    v_mov_b32 v105, 0
    v_mov_b32 v106, 0
    v_mov_b32 v107, 0
    v_mov_b32 v108, 0
    v_mov_b32 v109, 0
    v_mov_b32 v110, 0
    v_mov_b32 v111, 0
    s_bitcmp1_b32 s44, 0
    s_cbranch_scc0 L_v_sv_250
    s_sleep 1
L_v_sv_250:
    s_sleep 3
    s_mov_b32 s70, 1
    buffer_load_dwordx4 v[64:67], v11, s[12:15], s62 offen offset:0 sc1
    buffer_load_dwordx4 v[68:71], v11, s[12:15], s62 offen offset:1024 sc1
L_v_vp_251_m:
    s_waitcnt vmcnt(0)
    v_max3_u32 v20, v64, v65, v66
    v_max3_u32 v20, v20, v67, v68
    v_max3_u32 v20, v20, v69, v70
    v_max_u32 v20, v20, v71
    v_cmp_eq_u32 vcc, -1, v20
    s_cbranch_vccnz L_rt_252
    v_smfmac_f32_16x16x64_bf16 v[96:99], v[64:67], a[64:71], v3
    v_smfmac_f32_16x16x64_bf16 v[96:99], v[68:71], a[72:79], v3
    v_smfmac_f32_16x16x64_bf16 v[100:103], v[64:67], a[80:87], v3
    v_smfmac_f32_16x16x64_bf16 v[100:103], v[68:71], a[88:95], v3
    v_smfmac_f32_16x16x64_bf16 v[104:107], v[64:67], a[96:103], v3
    v_smfmac_f32_16x16x64_bf16 v[104:107], v[68:71], a[104:111], v3
    v_smfmac_f32_16x16x64_bf16 v[108:111], v[64:67], a[112:119], v3
    v_smfmac_f32_16x16x64_bf16 v[108:111], v[68:71], a[120:127], v3
    s_nop 1
    v_cvt_pk_bf16_f32 v96, v96, v97
    v_cvt_pk_bf16_f32 v97, v98, v99
    ds_write_b64 v12, v[96:97] offset:0
    v_cvt_pk_bf16_f32 v100, v100, v101
    v_cvt_pk_bf16_f32 v101, v102, v103
    ds_write_b64 v12, v[100:101] offset:2048
    v_cvt_pk_bf16_f32 v104, v104, v105
    v_cvt_pk_bf16_f32 v105, v106, v107
    ds_write_b64 v12, v[104:105] offset:4096
    v_cvt_pk_bf16_f32 v108, v108, v109
    v_cvt_pk_bf16_f32 v109, v110, v111
    ds_write_b64 v12, v[108:109] offset:6144
    s_bitcmp1_b32 s44, 0
    s_cbranch_scc1 L_v_r8_253
L_v_r8_253_l:
    s_add_u32 s46, s65, 4096
    buffer_load_dwordx4 v[32:35], v15, s[12:15], s65 offen offset:0 sc1
    buffer_load_dwordx4 v[48:51], v15, s[12:15], s46 offen offset:0 sc1
    buffer_load_dwordx4 v[36:39], v15, s[12:15], s65 offen offset:1024 sc1
    buffer_load_dwordx4 v[52:55], v15, s[12:15], s46 offen offset:1024 sc1
    buffer_load_dwordx4 v[40:43], v15, s[12:15], s65 offen offset:2048 sc1
    buffer_load_dwordx4 v[56:59], v15, s[12:15], s46 offen offset:2048 sc1
    buffer_load_dwordx4 v[44:47], v15, s[12:15], s65 offen offset:3072 sc1
    buffer_load_dwordx4 v[60:63], v15, s[12:15], s46 offen offset:3072 sc1
    s_add_u32 s65, s65, 786432
L_v_r8_253:
    s_waitcnt lgkmcnt(0)
    s_barrier
    ds_read_b128 v[96:99], v2 offset:16384
    ds_read_b128 v[100:103], v2 offset:17408
    ds_read_b128 v[104:107], v2 offset:18432
    ds_read_b128 v[108:111], v2 offset:19456
    ds_read_b128 v[112:115], v31 offset:0
    ds_read_b128 v[116:119], v25 offset:0
    ds_read_b128 v[120:123], v31 offset:512
    ds_read_b128 v[124:127], v25 offset:1024
    s_waitcnt lgkmcnt(7)
    v_mfma_f32_16x16x32_bf16 v[16:19], v[80:83], v[96:99], 0
    s_waitcnt lgkmcnt(6)
    v_mfma_f32_16x16x32_bf16 v[16:19], v[84:87], v[100:103], v[16:19]
    s_waitcnt lgkmcnt(5)
    v_mfma_f32_16x16x32_bf16 v[16:19], v[88:91], v[104:107], v[16:19]
    s_waitcnt lgkmcnt(4)
    v_mfma_f32_16x16x32_bf16 v[16:19], v[92:95], v[108:111], v[16:19]
    s_waitcnt lgkmcnt(2)
    v_mfma_f32_16x16x32_bf16 v[16:19], v[116:119], v[112:115], v[16:19]
    s_waitcnt lgkmcnt(0)
    v_mfma_f32_16x16x32_bf16 v[16:19], v[124:127], v[120:123], v[16:19]
    s_mov_b32 exec_lo, 0x00ff00ff
    s_mov_b32 exec_hi, 0x00ff00ff
    s_nop 5
    v_cvt_pk_bf16_f32 v16, v16, v17
    v_cvt_pk_bf16_f32 v17, v18, v19
    v_min_u32 v16, -2, v16
    v_min_u32 v17, -2, v17
    buffer_store_dwordx2 v[16:17], v6, s[12:15], s63 offen sc1
    s_mov_b64 exec, -1
    s_waitcnt vmcnt(1)
    s_sub_u32 s45, s60, 3
    s_cmp_ge_u32 s45, 24
    s_cbranch_scc1 L_v_nx_254_s
    s_cmp_eq_u32 s45, 0
    s_cbranch_scc1 L_v_fl_255
L_v_fl_255_b:
    s_and_b32 s46, s45, 1
    s_lshl_b32 s47, s46, 14
    s_add_u32 s47, s47, s59
    s_lshl_b32 s46, s46, 15
    s_lshr_b32 s48, s45, 2
    s_lshl_b32 s48, s48, 16
    s_add_u32 s46, s46, s48
    s_and_b32 s48, s45, 2
    s_lshl_b32 s48, s48, 7
    s_add_u32 s46, s46, s48
    s_add_u32 m0, s47, 0
    s_add_u32 s48, s46, 0
    buffer_load_dwordx4 v28, s[12:15], s48 offen sc1 lds
    s_add_u32 m0, s47, 1024
    s_add_u32 s48, s46, 2048
    buffer_load_dwordx4 v28, s[12:15], s48 offen sc1 lds
    s_add_u32 m0, s47, 2048
    s_add_u32 s48, s46, 4096
    buffer_load_dwordx4 v28, s[12:15], s48 offen sc1 lds
    s_add_u32 m0, s47, 3072
    s_add_u32 s48, s46, 6144
    buffer_load_dwordx4 v28, s[12:15], s48 offen sc1 lds
L_v_nx_254:
    s_add_u32 s61, s61, 0x4000
    s_and_b32 s61, s61, 0xffff
    s_mov_b32 s70, 1
    s_sleep 5
    buffer_load_dword v96, v7, s[12:15], s63 offen offset:0 sc1
    buffer_load_dword v97, v7, s[12:15], s63 offen offset:256 sc1
    buffer_load_dword v98, v7, s[12:15], s63 offen offset:512 sc1
    buffer_load_dword v99, v7, s[12:15], s63 offen offset:768 sc1
    buffer_load_dword v100, v7, s[12:15], s63 offen offset:1024 sc1
    buffer_load_dword v101, v7, s[12:15], s63 offen offset:1280 sc1
    buffer_load_dword v102, v7, s[12:15], s63 offen offset:1536 sc1
    buffer_load_dword v103, v7, s[12:15], s63 offen offset:1792 sc1
    v_mfma_f32_16x16x32_bf16 v[64:67], v[32:35], a[64:67], 0
    v_mfma_f32_16x16x32_bf16 v[68:71], v[48:51], a[64:67], 0
    v_mfma_f32_16x16x32_bf16 v[64:67], v[36:39], a[68:71], v[64:67]
    v_mfma_f32_16x16x32_bf16 v[68:71], v[52:55], a[68:71], v[68:71]
    v_mfma_f32_16x16x32_bf16 v[64:67], v[40:43], a[72:75], v[64:67]
    v_mfma_f32_16x16x32_bf16 v[68:71], v[56:59], a[72:75], v[68:71]
    v_mfma_f32_16x16x32_bf16 v[64:67], v[44:47], a[76:79], v[64:67]
    v_mfma_f32_16x16x32_bf16 v[68:71], v[60:63], a[76:79], v[68:71]
    v_mfma_f32_16x16x32_bf16 v[72:75], v[32:35], a[80:83], 0
    v_mfma_f32_16x16x32_bf16 v[76:79], v[48:51], a[80:83], 0
    v_mfma_f32_16x16x32_bf16 v[72:75], v[36:39], a[84:87], v[72:75]
    v_mfma_f32_16x16x32_bf16 v[76:79], v[52:55], a[84:87], v[76:79]
    v_mfma_f32_16x16x32_bf16 v[72:75], v[40:43], a[88:91], v[72:75]
    v_mfma_f32_16x16x32_bf16 v[76:79], v[56:59], a[88:91], v[76:79]
    v_mfma_f32_16x16x32_bf16 v[72:75], v[44:47], a[92:95], v[72:75]
    v_mfma_f32_16x16x32_bf16 v[76:79], v[60:63], a[92:95], v[76:79]
    v_cvt_pk_bf16_f32 v64, v64, v65
    v_cvt_pk_bf16_f32 v65, v66, v67
    v_cvt_pk_bf16_f32 v66, v68, v69
    v_cvt_pk_bf16_f32 v67, v70, v71
    ds_write_b128 v10, v[64:67] offset:32768
    v_mfma_f32_16x16x32_bf16 v[80:83], v[32:35], a[96:99], 0
    v_mfma_f32_16x16x32_bf16 v[84:87], v[48:51], a[96:99], 0
    v_mfma_f32_16x16x32_bf16 v[80:83], v[36:39], a[100:103], v[80:83]
    v_mfma_f32_16x16x32_bf16 v[84:87], v[52:55], a[100:103], v[84:87]
    v_mfma_f32_16x16x32_bf16 v[80:83], v[40:43], a[104:107], v[80:83]
    v_mfma_f32_16x16x32_bf16 v[84:87], v[56:59], a[104:107], v[84:87]
    v_mfma_f32_16x16x32_bf16 v[80:83], v[44:47], a[108:111], v[80:83]
    v_mfma_f32_16x16x32_bf16 v[84:87], v[60:63], a[108:111], v[84:87]
    v_cvt_pk_bf16_f32 v72, v72, v73
    v_cvt_pk_bf16_f32 v73, v74, v75
    v_cvt_pk_bf16_f32 v74, v76, v77
    v_cvt_pk_bf16_f32 v75, v78, v79
    ds_write_b128 v10, v[72:75] offset:33792
L_v_gp_256:
    s_waitcnt vmcnt(7)
    v_lshlrev_b32 v20, 16, v96
    v_and_b32 v21, 0xffff0000, v96
    s_waitcnt vmcnt(6)
    v_lshlrev_b32 v22, 16, v97
    v_and_b32 v23, 0xffff0000, v97
    v_add_f32 v20, v20, v22
    v_add_f32 v21, v21, v23
    s_waitcnt vmcnt(5)
    v_lshlrev_b32 v22, 16, v98
    v_and_b32 v23, 0xffff0000, v98
    v_add_f32 v20, v20, v22
    v_add_f32 v21, v21, v23
    s_waitcnt vmcnt(4)
    v_lshlrev_b32 v22, 16, v99
    v_and_b32 v23, 0xffff0000, v99
    v_add_f32 v20, v20, v22
    v_add_f32 v21, v21, v23
    s_waitcnt vmcnt(3)
    v_lshlrev_b32 v22, 16, v100
    v_and_b32 v23, 0xffff0000, v100
    v_add_f32 v20, v20, v22
    v_add_f32 v21, v21, v23
    s_waitcnt vmcnt(2)
    v_lshlrev_b32 v22, 16, v101
    v_and_b32 v23, 0xffff0000, v101
    v_add_f32 v20, v20, v22
    v_add_f32 v21, v21, v23
    s_waitcnt vmcnt(1)
    v_lshlrev_b32 v22, 16, v102
    v_and_b32 v23, 0xffff0000, v102
    v_add_f32 v20, v20, v22
    v_add_f32 v21, v21, v23
    s_waitcnt vmcnt(0)
    v_lshlrev_b32 v22, 16, v103
    v_and_b32 v23, 0xffff0000, v103
    v_add_f32 v20, v20, v22
    v_add_f32 v21, v21, v23
    v_cmp_u_f32 vcc, v20, v21
    v_cvt_pk_bf16_f32 v20, v20, v21
    s_cbranch_vccnz L_v_gf_258
L_v_gok_257:
    buffer_store_dword v20, v8, s[12:15], s61 offen
    s_xor_b32 s45, s61, 0x8000
    buffer_store_dword v26, v8, s[12:15], s45 offen
    s_bitcmp1_b32 s44, 0
    s_cbranch_scc1 L_v_nr_259
    s_xor_b32 s45, s62, 0x4000
    buffer_store_dword v26, v4, s[12:15], s45 offen
L_v_nr_259:
    s_add_u32 s60, s60, 1
    s_add_u32 s62, s62, 0x2000
    s_and_b32 s62, s62, 0x7fff
    s_and_b32 s45, s60, 0x38
    s_bitcmp1_b64 s[66:67], s45
    s_cselect_b32 s45, 8192, 0
    s_lshl_b32 s63, s60, 18
    s_add_u32 s63, s63, s45
    v_mfma_f32_16x16x32_bf16 v[88:91], v[32:35], a[112:115], 0
    v_mfma_f32_16x16x32_bf16 v[92:95], v[48:51], a[112:115], 0
    v_mfma_f32_16x16x32_bf16 v[88:91], v[36:39], a[116:119], v[88:91]
    v_mfma_f32_16x16x32_bf16 v[92:95], v[52:55], a[116:119], v[92:95]
    v_mfma_f32_16x16x32_bf16 v[88:91], v[40:43], a[120:123], v[88:91]
    v_mfma_f32_16x16x32_bf16 v[92:95], v[56:59], a[120:123], v[92:95]
    v_mfma_f32_16x16x32_bf16 v[88:91], v[44:47], a[124:127], v[88:91]
    v_mfma_f32_16x16x32_bf16 v[92:95], v[60:63], a[124:127], v[92:95]
    v_cvt_pk_bf16_f32 v80, v80, v81
    v_cvt_pk_bf16_f32 v81, v82, v83
    v_cvt_pk_bf16_f32 v82, v84, v85
    v_cvt_pk_bf16_f32 v83, v86, v87
    ds_write_b128 v10, v[80:83] offset:34816
    s_nop 2
    v_cvt_pk_bf16_f32 v88, v88, v89
    v_cvt_pk_bf16_f32 v89, v90, v91
    v_cvt_pk_bf16_f32 v90, v92, v93
    v_cvt_pk_bf16_f32 v91, v94, v95
    ds_write_b128 v10, v[88:91] offset:35840
    s_sleep 3
    s_branch L_v_loop_242
L_v_last_246:
    s_waitcnt lgkmcnt(0)
    s_barrier
    s_branch L_replica
L_v_l1_243:
    s_mov_b64 exec, s[48:49]
    s_cbranch_execz L_v_ls_260
    buffer_load_dwordx4 v[64:67], v9, s[12:15], s61 offen offset:0 sc1
L_v_ls_260:
    s_mov_b64 exec, s[50:51]
    s_cbranch_execz L_v_ls_261
    buffer_load_dwordx4 v[68:71], v9, s[12:15], s61 offen offset:1024 sc1
L_v_ls_261:
    s_mov_b64 exec, s[52:53]
    s_cbranch_execz L_v_ls_262
    buffer_load_dwordx4 v[72:75], v9, s[12:15], s61 offen offset:2048 sc1
L_v_ls_262:
    s_mov_b64 exec, s[54:55]
    s_cbranch_execz L_v_ls_263
    buffer_load_dwordx4 v[76:79], v9, s[12:15], s61 offen offset:3072 sc1
L_v_ls_263:
    s_mov_b64 exec, -1
    s_add_u32 s70, s70, 1
    s_cmp_ge_u32 s70, 524288
    s_cbranch_scc1 L_c_done_1
    s_waitcnt vmcnt(0)
    s_cmp_eq_u64 s[48:49], 0
    s_cbranch_scc1 L_v_lc_264
    ds_write_b128 v10, v[64:67] offset:0
    v_max3_u32 v24, v64, v65, v66
    v_max_u32 v24, v24, v67
    v_cmp_eq_u32 s[48:49], -1, v24
L_v_lc_264:
    s_cmp_eq_u64 s[50:51], 0
    s_cbranch_scc1 L_v_lc_265
    ds_write_b128 v10, v[68:71] offset:1024
    v_max3_u32 v24, v68, v69, v70
    v_max_u32 v24, v24, v71
    v_cmp_eq_u32 s[50:51], -1, v24
L_v_lc_265:
    s_cmp_eq_u64 s[52:53], 0
    s_cbranch_scc1 L_v_lc_266
    ds_write_b128 v10, v[72:75] offset:2048
    v_max3_u32 v24, v72, v73, v74
    v_max_u32 v24, v24, v75
    v_cmp_eq_u32 s[52:53], -1, v24
L_v_lc_266:
    s_cmp_eq_u64 s[54:55], 0
    s_cbranch_scc1 L_v_lc_267
    ds_write_b128 v10, v[76:79] offset:3072
    v_max3_u32 v24, v76, v77, v78
    v_max_u32 v24, v24, v79
    v_cmp_eq_u32 s[54:55], -1, v24
L_v_lc_267:
    s_or_b64 s[46:47], s[48:49], s[50:51]
    s_or_b64 vcc, s[52:53], s[54:55]
    s_or_b64 vcc, vcc, s[46:47]
    s_cbranch_scc1 L_v_l1_243
    s_branch L_v_l1ok_245
L_v_k1_247_c:
    s_add_u32 s46, s65, 4096
    buffer_load_dwordx4 v[32:35], v15, s[12:15], s65 offen offset:0 sc1
    buffer_load_dwordx4 v[48:51], v15, s[12:15], s46 offen offset:0 sc1
    buffer_load_dwordx4 v[36:39], v15, s[12:15], s65 offen offset:1024 sc1
    buffer_load_dwordx4 v[52:55], v15, s[12:15], s46 offen offset:1024 sc1
    buffer_load_dwordx4 v[40:43], v15, s[12:15], s65 offen offset:2048 sc1
    buffer_load_dwordx4 v[56:59], v15, s[12:15], s46 offen offset:2048 sc1
    buffer_load_dwordx4 v[44:47], v15, s[12:15], s65 offen offset:3072 sc1
    buffer_load_dwordx4 v[60:63], v15, s[12:15], s46 offen offset:3072 sc1
    s_add_u32 s65, s65, 786432
    s_branch L_v_k1_247
L_rt_249:
    s_add_u32 s70, s70, 1
    s_cmp_lt_u32 s70, 524288
    s_cbranch_scc1 L_v_rl_248
    s_branch L_c_done_1
L_v_vp_251:
    buffer_load_dwordx4 v[64:67], v11, s[12:15], s62 offen offset:0 sc1
    buffer_load_dwordx4 v[68:71], v11, s[12:15], s62 offen offset:1024 sc1
    s_branch L_v_vp_251_m
L_rt_252:
    s_add_u32 s70, s70, 1
    s_cmp_lt_u32 s70, 524288
    s_cbranch_scc1 L_v_vp_251
    s_branch L_c_done_1
L_v_fl_255:
    v_and_b32 v22, 31, v1
    v_lshlrev_b32 v22, 7, v22
    s_mov_b32 s46, 0x109400
    s_mov_b32 s47, 56
    s_mov_b32 s70, 0
L_spin_268:
    buffer_load_dword v23, v22, s[12:15], s46 offen sc1
    s_waitcnt vmcnt(0)
    v_cmp_ge_u32 vcc, s47, v23
    s_add_u32 s70, s70, 1
    s_cbranch_vccz L_spok_269
    s_sleep 3
    s_cmp_lt_u32 s70, 524288
    s_cbranch_scc1 L_spin_268
    s_branch L_c_done_1
L_spok_269:
    s_branch L_v_fl_255_b
L_v_nx_254_s:
    s_sleep 2
    s_branch L_v_nx_254
L_v_gf_258:
    v_max3_u32 v24, v96, v97, v98
    v_max3_u32 v24, v24, v99, v100
    v_max3_u32 v24, v24, v101, v102
    v_max_u32 v24, v24, v103
    v_cmp_eq_u32 vcc, -1, v24
    v_min_u32 v20, -2, v20
    s_add_u32 s70, s70, 1
    s_cbranch_vccz L_v_gok_257
    buffer_load_dword v96, v7, s[12:15], s63 offen offset:0 sc1
    buffer_load_dword v97, v7, s[12:15], s63 offen offset:256 sc1
    buffer_load_dword v98, v7, s[12:15], s63 offen offset:512 sc1
    buffer_load_dword v99, v7, s[12:15], s63 offen offset:768 sc1
    buffer_load_dword v100, v7, s[12:15], s63 offen offset:1024 sc1
    buffer_load_dword v101, v7, s[12:15], s63 offen offset:1280 sc1
    buffer_load_dword v102, v7, s[12:15], s63 offen offset:1536 sc1
    buffer_load_dword v103, v7, s[12:15], s63 offen offset:1792 sc1
    s_cmp_lt_u32 s70, 524288
    s_cbranch_scc1 L_v_gp_256
    s_branch L_c_done_1
L_vs_203:
    s_mov_b32 s70, 1
    v_mov_b32 v16, 0
    v_mov_b32 v17, 0
    s_branch L_v_l1m_272
.p2align 6
L_v_loop_270:
    s_mov_b32 s70, 1
    buffer_load_dwordx4 v[64:67], v9, s[12:15], s61 offen offset:0 sc1
    buffer_load_dwordx4 v[68:71], v9, s[12:15], s61 offen offset:1024 sc1
    buffer_load_dwordx4 v[72:75], v9, s[12:15], s61 offen offset:2048 sc1
    buffer_load_dwordx4 v[76:79], v9, s[12:15], s61 offen offset:3072 sc1
    v_mov_b32 v16, 0
    v_mov_b32 v17, 0
    v_mov_b32 v18, 0
    v_mov_b32 v19, 0
    v_mov_b32 v20, 0
    v_mov_b32 v21, 0
    v_mov_b32 v22, 0
    v_mov_b32 v23, 0
L_v_l1m_272:
    s_waitcnt vmcnt(3)
    ds_write_b128 v10, v[64:67] offset:0
    v_max3_u32 v24, v64, v65, v66
    v_max_u32 v24, v24, v67
    v_cmp_eq_u32 s[48:49], -1, v24
    s_waitcnt vmcnt(2)
    ds_write_b128 v10, v[68:71] offset:1024
    v_max3_u32 v24, v68, v69, v70
    v_max_u32 v24, v24, v71
    v_cmp_eq_u32 s[50:51], -1, v24
    s_waitcnt vmcnt(1)
    ds_write_b128 v10, v[72:75] offset:2048
    v_max3_u32 v24, v72, v73, v74
    v_max_u32 v24, v24, v75
    v_cmp_eq_u32 s[52:53], -1, v24
    s_waitcnt vmcnt(0)
    ds_write_b128 v10, v[76:79] offset:3072
    v_max3_u32 v24, v76, v77, v78
    v_max_u32 v24, v24, v79
    v_cmp_eq_u32 s[54:55], -1, v24
    s_or_b64 s[46:47], s[48:49], s[50:51]
    s_or_b64 vcc, s[52:53], s[54:55]
    s_or_b64 vcc, vcc, s[46:47]
    s_cbranch_scc1 L_v_l1_271
L_v_l1ok_273:
    s_waitcnt lgkmcnt(0)
    s_barrier
    v_smfmac_f32_16x16x64_bf16 v[16:19], v[64:67], a[0:7], v3
    v_smfmac_f32_16x16x64_bf16 v[20:23], v[64:67], a[32:39], v3
    v_smfmac_f32_16x16x64_bf16 v[16:19], v[68:71], a[8:15], v3
    v_smfmac_f32_16x16x64_bf16 v[20:23], v[68:71], a[40:47], v3
    v_smfmac_f32_16x16x64_bf16 v[16:19], v[72:75], a[16:23], v3
    v_smfmac_f32_16x16x64_bf16 v[20:23], v[72:75], a[48:55], v3
    v_smfmac_f32_16x16x64_bf16 v[16:19], v[76:79], a[24:31], v3
    v_smfmac_f32_16x16x64_bf16 v[20:23], v[76:79], a[56:63], v3
    s_nop 6
    v_permlane32_swap_b32 v16, v18
    v_permlane32_swap_b32 v17, v19
    v_permlane32_swap_b32 v20, v22
    v_permlane32_swap_b32 v21, v23
    v_add_f32 v16, v16, v18
    v_add_f32 v17, v17, v19
    v_add_f32 v18, v20, v22
    v_add_f32 v19, v21, v23
    ds_write_b128 v14, v[16:19]
    s_mov_b64 exec, 1
    ds_add_u32 v29, v30
    s_mov_b64 exec, -1
    s_add_u32 s58, s58, 4
    s_bitcmp1_b32 s44, 0
    s_cbranch_scc1 L_v_k1_275_c
    s_mov_b32 s70, 0
L_v_rl_276:
    ds_read_b32 v24, v29
    ds_read_b64 v[16:17], v13 offset:0
    ds_read_b64 v[18:19], v13 offset:1024
    ds_read_b64 v[20:21], v13 offset:2048
    ds_read_b64 v[22:23], v13 offset:3072
    s_waitcnt lgkmcnt(2)
    v_cmp_ne_u32 vcc, s58, v24
    v_add_f32 v16, v16, v18
    v_add_f32 v17, v17, v19
    s_waitcnt lgkmcnt(0)
    s_cbranch_vccnz L_rt_277
    v_add_f32 v20, v20, v22
    v_add_f32 v21, v21, v23
    v_add_f32 v16, v16, v20
    v_add_f32 v17, v17, v21
    s_mov_b32 vcc_lo, 0x55555555
    s_mov_b32 vcc_hi, 0x55555555
    v_cndmask_b32_dpp v18, v17, v16, vcc quad_perm:[1,0,3,2] row_mask:0xf bank_mask:0xf
    s_not_b64 vcc, vcc
    v_cndmask_b32_dpp v19, v16, v17, vcc quad_perm:[1,0,3,2] row_mask:0xf bank_mask:0xf
    v_cvt_pk_bf16_f32 v18, v18, v19
    v_min_u32 v18, -2, v18
    buffer_store_dword v18, v4, s[12:15], s62 offen sc1
    ds_write_b32 v5, v18
L_v_k1_275:
    s_cmp_eq_u32 s60, 63
    s_cbranch_scc1 L_v_last_274
    ds_read_b128 v[80:83], v27 offset:32768
    ds_read_b128 v[84:87], v27 offset:36864
    ds_read_b128 v[88:91], v27 offset:40960
    ds_read_b128 v[92:95], v27 offset:45056
    v_mov_b32 v96, 0
    v_mov_b32 v97, 0
    v_mov_b32 v98, 0
    v_mov_b32 v99, 0
    v_mov_b32 v100, 0
    v_mov_b32 v101, 0
    v_mov_b32 v102, 0
    v_mov_b32 v103, 0
    v_mov_b32 v104, 0
    v_mov_b32 v105, 0
    v_mov_b32 v106, 0
    v_mov_b32 v107, 0
    v_mov_b32 v108, 0
    v_mov_b32 v109, 0
    v_mov_b32 v110, 0
    v_mov_b32 v111, 0
    s_bitcmp1_b32 s44, 0
    s_cbranch_scc0 L_v_sv_278
    s_sleep 1
L_v_sv_278:
    s_sleep 3
    s_mov_b32 s70, 1
    buffer_load_dwordx4 v[64:67], v11, s[12:15], s62 offen offset:0 sc1
    buffer_load_dwordx4 v[68:71], v11, s[12:15], s62 offen offset:1024 sc1
L_v_vp_279_m:
    s_waitcnt vmcnt(0)
    v_max3_u32 v20, v64, v65, v66
    v_max3_u32 v20, v20, v67, v68
    v_max3_u32 v20, v20, v69, v70
    v_max_u32 v20, v20, v71
    v_cmp_eq_u32 vcc, -1, v20
    s_cbranch_vccnz L_rt_280
    v_smfmac_f32_16x16x64_bf16 v[96:99], v[64:67], a[64:71], v3
    v_smfmac_f32_16x16x64_bf16 v[96:99], v[68:71], a[72:79], v3
    v_smfmac_f32_16x16x64_bf16 v[100:103], v[64:67], a[80:87], v3
    v_smfmac_f32_16x16x64_bf16 v[100:103], v[68:71], a[88:95], v3
    v_smfmac_f32_16x16x64_bf16 v[104:107], v[64:67], a[96:103], v3
    v_smfmac_f32_16x16x64_bf16 v[104:107], v[68:71], a[104:111], v3
    v_smfmac_f32_16x16x64_bf16 v[108:111], v[64:67], a[112:119], v3
    v_smfmac_f32_16x16x64_bf16 v[108:111], v[68:71], a[120:127], v3
    s_nop 1
    v_cvt_pk_bf16_f32 v96, v96, v97
    v_cvt_pk_bf16_f32 v97, v98, v99
    ds_write_b64 v12, v[96:97] offset:0
    v_cvt_pk_bf16_f32 v100, v100, v101
    v_cvt_pk_bf16_f32 v101, v102, v103
    ds_write_b64 v12, v[100:101] offset:2048
    v_cvt_pk_bf16_f32 v104, v104, v105
    v_cvt_pk_bf16_f32 v105, v106, v107
    ds_write_b64 v12, v[104:105] offset:4096
    v_cvt_pk_bf16_f32 v108, v108, v109
    v_cvt_pk_bf16_f32 v109, v110, v111
    ds_write_b64 v12, v[108:109] offset:6144
    s_bitcmp1_b32 s44, 0
    s_cbranch_scc1 L_v_r8_281
L_v_r8_281_l:
    s_add_u32 s46, s65, 4096
    buffer_load_dwordx4 v[32:35], v15, s[12:15], s65 offen offset:0 sc1
    buffer_load_dwordx4 v[48:51], v15, s[12:15], s46 offen offset:0 sc1
    buffer_load_dwordx4 v[36:39], v15, s[12:15], s65 offen offset:1024 sc1
    buffer_load_dwordx4 v[52:55], v15, s[12:15], s46 offen offset:1024 sc1
    buffer_load_dwordx4 v[40:43], v15, s[12:15], s65 offen offset:2048 sc1
    buffer_load_dwordx4 v[56:59], v15, s[12:15], s46 offen offset:2048 sc1
    buffer_load_dwordx4 v[44:47], v15, s[12:15], s65 offen offset:3072 sc1
    buffer_load_dwordx4 v[60:63], v15, s[12:15], s46 offen offset:3072 sc1
    s_add_u32 s65, s65, 786432
L_v_r8_281:
    s_waitcnt lgkmcnt(0)
    s_barrier
    ds_read_b128 v[96:99], v2 offset:16384
    ds_read_b128 v[100:103], v2 offset:17408
    ds_read_b128 v[104:107], v2 offset:18432
    ds_read_b128 v[108:111], v2 offset:19456
    ds_read_b128 v[112:115], v31 offset:0
    ds_read_b128 v[116:119], v25 offset:0
    ds_read_b128 v[120:123], v31 offset:512
    ds_read_b128 v[124:127], v25 offset:1024
    s_waitcnt lgkmcnt(7)
    v_mfma_f32_16x16x32_bf16 v[16:19], v[80:83], v[96:99], 0
    s_waitcnt lgkmcnt(6)
    v_mfma_f32_16x16x32_bf16 v[16:19], v[84:87], v[100:103], v[16:19]
    s_waitcnt lgkmcnt(5)
    v_mfma_f32_16x16x32_bf16 v[16:19], v[88:91], v[104:107], v[16:19]
    s_waitcnt lgkmcnt(4)
    v_mfma_f32_16x16x32_bf16 v[16:19], v[92:95], v[108:111], v[16:19]
    s_waitcnt lgkmcnt(2)
    v_mfma_f32_16x16x32_bf16 v[16:19], v[116:119], v[112:115], v[16:19]
    s_waitcnt lgkmcnt(0)
    v_mfma_f32_16x16x32_bf16 v[16:19], v[124:127], v[120:123], v[16:19]
    s_mov_b32 exec_lo, 0x00ff00ff
    s_mov_b32 exec_hi, 0x00ff00ff
    s_nop 5
    v_cvt_pk_bf16_f32 v16, v16, v17
    v_cvt_pk_bf16_f32 v17, v18, v19
    v_min_u32 v16, -2, v16
    v_min_u32 v17, -2, v17
    buffer_store_dwordx2 v[16:17], v6, s[12:15], s63 offen sc1
    s_mov_b64 exec, -1
    s_waitcnt vmcnt(1)
    s_sub_u32 s45, s60, 3
    s_cmp_ge_u32 s45, 24
    s_cbranch_scc1 L_v_nx_282_s
    s_cmp_eq_u32 s45, 0
    s_cbranch_scc1 L_v_fl_283
L_v_fl_283_b:
    s_and_b32 s46, s45, 1
    s_lshl_b32 s47, s46, 14
    s_add_u32 s47, s47, s59
    s_lshl_b32 s46, s46, 15
    s_lshr_b32 s48, s45, 2
    s_lshl_b32 s48, s48, 16
    s_add_u32 s46, s46, s48
    s_and_b32 s48, s45, 2
    s_lshl_b32 s48, s48, 7
    s_add_u32 s46, s46, s48
    s_add_u32 m0, s47, 0
    s_add_u32 s48, s46, 0
    buffer_load_dwordx4 v28, s[12:15], s48 offen sc1 lds
    s_add_u32 m0, s47, 1024
    s_add_u32 s48, s46, 2048
    buffer_load_dwordx4 v28, s[12:15], s48 offen sc1 lds
    s_add_u32 m0, s47, 2048
    s_add_u32 s48, s46, 4096
    buffer_load_dwordx4 v28, s[12:15], s48 offen sc1 lds
    s_add_u32 m0, s47, 3072
    s_add_u32 s48, s46, 6144
    buffer_load_dwordx4 v28, s[12:15], s48 offen sc1 lds
L_v_nx_282:
    s_add_u32 s61, s61, 0x4000
    s_and_b32 s61, s61, 0xffff
    s_mov_b32 s70, 1
    s_sleep 5
    buffer_load_dword v96, v7, s[12:15], s63 offen offset:0 sc1
    buffer_load_dword v97, v7, s[12:15], s63 offen offset:256 sc1
    buffer_load_dword v98, v7, s[12:15], s63 offen offset:512 sc1
    buffer_load_dword v99, v7, s[12:15], s63 offen offset:768 sc1
    buffer_load_dword v100, v7, s[12:15], s63 offen offset:1024 sc1
    buffer_load_dword v101, v7, s[12:15], s63 offen offset:1280 sc1
    buffer_load_dword v102, v7, s[12:15], s63 offen offset:1536 sc1
    buffer_load_dword v103, v7, s[12:15], s63 offen offset:1792 sc1
    v_mfma_f32_16x16x32_bf16 v[64:67], v[32:35], a[64:67], 0
    v_mfma_f32_16x16x32_bf16 v[68:71], v[48:51], a[64:67], 0
    v_mfma_f32_16x16x32_bf16 v[64:67], v[36:39], a[68:71], v[64:67]
    v_mfma_f32_16x16x32_bf16 v[68:71], v[52:55], a[68:71], v[68:71]
    v_mfma_f32_16x16x32_bf16 v[64:67], v[40:43], a[72:75], v[64:67]
    v_mfma_f32_16x16x32_bf16 v[68:71], v[56:59], a[72:75], v[68:71]
    v_mfma_f32_16x16x32_bf16 v[64:67], v[44:47], a[76:79], v[64:67]
    v_mfma_f32_16x16x32_bf16 v[68:71], v[60:63], a[76:79], v[68:71]
    v_mfma_f32_16x16x32_bf16 v[72:75], v[32:35], a[80:83], 0
    v_mfma_f32_16x16x32_bf16 v[76:79], v[48:51], a[80:83], 0
    v_mfma_f32_16x16x32_bf16 v[72:75], v[36:39], a[84:87], v[72:75]
    v_mfma_f32_16x16x32_bf16 v[76:79], v[52:55], a[84:87], v[76:79]
    v_mfma_f32_16x16x32_bf16 v[72:75], v[40:43], a[88:91], v[72:75]
    v_mfma_f32_16x16x32_bf16 v[76:79], v[56:59], a[88:91], v[76:79]
    v_mfma_f32_16x16x32_bf16 v[72:75], v[44:47], a[92:95], v[72:75]
    v_mfma_f32_16x16x32_bf16 v[76:79], v[60:63], a[92:95], v[76:79]
    v_cvt_pk_bf16_f32 v64, v64, v65
    v_cvt_pk_bf16_f32 v65, v66, v67
    v_cvt_pk_bf16_f32 v66, v68, v69
    v_cvt_pk_bf16_f32 v67, v70, v71
    ds_write_b128 v10, v[64:67] offset:32768
    v_mfma_f32_16x16x32_bf16 v[80:83], v[32:35], a[96:99], 0
    v_mfma_f32_16x16x32_bf16 v[84:87], v[48:51], a[96:99], 0
    v_mfma_f32_16x16x32_bf16 v[80:83], v[36:39], a[100:103], v[80:83]
    v_mfma_f32_16x16x32_bf16 v[84:87], v[52:55], a[100:103], v[84:87]
    v_mfma_f32_16x16x32_bf16 v[80:83], v[40:43], a[104:107], v[80:83]
    v_mfma_f32_16x16x32_bf16 v[84:87], v[56:59], a[104:107], v[84:87]
    v_mfma_f32_16x16x32_bf16 v[80:83], v[44:47], a[108:111], v[80:83]
    v_mfma_f32_16x16x32_bf16 v[84:87], v[60:63], a[108:111], v[84:87]
    v_cvt_pk_bf16_f32 v72, v72, v73
    v_cvt_pk_bf16_f32 v73, v74, v75
    v_cvt_pk_bf16_f32 v74, v76, v77
    v_cvt_pk_bf16_f32 v75, v78, v79
    ds_write_b128 v10, v[72:75] offset:33792
L_v_gp_284:
    s_waitcnt vmcnt(7)
    v_lshlrev_b32 v20, 16, v96
    v_and_b32 v21, 0xffff0000, v96
    s_waitcnt vmcnt(6)
    v_lshlrev_b32 v22, 16, v97
    v_and_b32 v23, 0xffff0000, v97
    v_add_f32 v20, v20, v22
    v_add_f32 v21, v21, v23
    s_waitcnt vmcnt(5)
    v_lshlrev_b32 v22, 16, v98
    v_and_b32 v23, 0xffff0000, v98
    v_add_f32 v20, v20, v22
    v_add_f32 v21, v21, v23
    s_waitcnt vmcnt(4)
    v_lshlrev_b32 v22, 16, v99
    v_and_b32 v23, 0xffff0000, v99
    v_add_f32 v20, v20, v22
    v_add_f32 v21, v21, v23
    s_waitcnt vmcnt(3)
    v_lshlrev_b32 v22, 16, v100
    v_and_b32 v23, 0xffff0000, v100
    v_add_f32 v20, v20, v22
    v_add_f32 v21, v21, v23
    s_waitcnt vmcnt(2)
    v_lshlrev_b32 v22, 16, v101
    v_and_b32 v23, 0xffff0000, v101
    v_add_f32 v20, v20, v22
    v_add_f32 v21, v21, v23
    s_waitcnt vmcnt(1)
    v_lshlrev_b32 v22, 16, v102
    v_and_b32 v23, 0xffff0000, v102
    v_add_f32 v20, v20, v22
    v_add_f32 v21, v21, v23
    s_waitcnt vmcnt(0)
    v_lshlrev_b32 v22, 16, v103
    v_and_b32 v23, 0xffff0000, v103
    v_add_f32 v20, v20, v22
    v_add_f32 v21, v21, v23
    v_cmp_u_f32 vcc, v20, v21
    v_cvt_pk_bf16_f32 v20, v20, v21
    s_cbranch_vccnz L_v_gf_286
L_v_gok_285:
    buffer_store_dword v20, v8, s[12:15], s61 offen sc1
    s_xor_b32 s45, s61, 0x8000
    buffer_store_dword v26, v8, s[12:15], s45 offen sc1
    s_bitcmp1_b32 s44, 0
    s_cbranch_scc1 L_v_nr_287
    s_xor_b32 s45, s62, 0x4000
    buffer_store_dword v26, v4, s[12:15], s45 offen sc1
L_v_nr_287:
    s_add_u32 s60, s60, 1
    s_add_u32 s62, s62, 0x2000
    s_and_b32 s62, s62, 0x7fff
    s_and_b32 s45, s60, 0x38
    s_bitcmp1_b64 s[66:67], s45
    s_cselect_b32 s45, 8192, 0
    s_lshl_b32 s63, s60, 18
    s_add_u32 s63, s63, s45
    v_mfma_f32_16x16x32_bf16 v[88:91], v[32:35], a[112:115], 0
    v_mfma_f32_16x16x32_bf16 v[92:95], v[48:51], a[112:115], 0
    v_mfma_f32_16x16x32_bf16 v[88:91], v[36:39], a[116:119], v[88:91]
    v_mfma_f32_16x16x32_bf16 v[92:95], v[52:55], a[116:119], v[92:95]
    v_mfma_f32_16x16x32_bf16 v[88:91], v[40:43], a[120:123], v[88:91]
    v_mfma_f32_16x16x32_bf16 v[92:95], v[56:59], a[120:123], v[92:95]
    v_mfma_f32_16x16x32_bf16 v[88:91], v[44:47], a[124:127], v[88:91]
    v_mfma_f32_16x16x32_bf16 v[92:95], v[60:63], a[124:127], v[92:95]
    v_cvt_pk_bf16_f32 v80, v80, v81
    v_cvt_pk_bf16_f32 v81, v82, v83
    v_cvt_pk_bf16_f32 v82, v84, v85
    v_cvt_pk_bf16_f32 v83, v86, v87
    ds_write_b128 v10, v[80:83] offset:34816
    s_nop 2
    v_cvt_pk_bf16_f32 v88, v88, v89
    v_cvt_pk_bf16_f32 v89, v90, v91
    v_cvt_pk_bf16_f32 v90, v92, v93
    v_cvt_pk_bf16_f32 v91, v94, v95
    ds_write_b128 v10, v[88:91] offset:35840
    s_sleep 3
    s_branch L_v_loop_270
L_v_last_274:
    s_waitcnt lgkmcnt(0)
    s_barrier
    s_branch L_replica
L_v_l1_271:
    s_mov_b64 exec, s[48:49]
    s_cbranch_execz L_v_ls_288
    buffer_load_dwordx4 v[64:67], v9, s[12:15], s61 offen offset:0 sc1
L_v_ls_288:
    s_mov_b64 exec, s[50:51]
    s_cbranch_execz L_v_ls_289
    buffer_load_dwordx4 v[68:71], v9, s[12:15], s61 offen offset:1024 sc1
L_v_ls_289:
    s_mov_b64 exec, s[52:53]
    s_cbranch_execz L_v_ls_290
    buffer_load_dwordx4 v[72:75], v9, s[12:15], s61 offen offset:2048 sc1
L_v_ls_290:
    s_mov_b64 exec, s[54:55]
    s_cbranch_execz L_v_ls_291
    buffer_load_dwordx4 v[76:79], v9, s[12:15], s61 offen offset:3072 sc1
L_v_ls_291:
    s_mov_b64 exec, -1
    s_add_u32 s70, s70, 1
    s_cmp_ge_u32 s70, 524288
    s_cbranch_scc1 L_c_done_1
    s_waitcnt vmcnt(0)
    s_cmp_eq_u64 s[48:49], 0
    s_cbranch_scc1 L_v_lc_292
    ds_write_b128 v10, v[64:67] offset:0
    v_max3_u32 v24, v64, v65, v66
    v_max_u32 v24, v24, v67
    v_cmp_eq_u32 s[48:49], -1, v24
L_v_lc_292:
    s_cmp_eq_u64 s[50:51], 0
    s_cbranch_scc1 L_v_lc_293
    ds_write_b128 v10, v[68:71] offset:1024
    v_max3_u32 v24, v68, v69, v70
    v_max_u32 v24, v24, v71
    v_cmp_eq_u32 s[50:51], -1, v24
L_v_lc_293:
    s_cmp_eq_u64 s[52:53], 0
    s_cbranch_scc1 L_v_lc_294
    ds_write_b128 v10, v[72:75] offset:2048
    v_max3_u32 v24, v72, v73, v74
    v_max_u32 v24, v24, v75
    v_cmp_eq_u32 s[52:53], -1, v24
L_v_lc_294:
    s_cmp_eq_u64 s[54:55], 0
    s_cbranch_scc1 L_v_lc_295
    ds_write_b128 v10, v[76:79] offset:3072
    v_max3_u32 v24, v76, v77, v78
    v_max_u32 v24, v24, v79
    v_cmp_eq_u32 s[54:55], -1, v24
L_v_lc_295:
    s_or_b64 s[46:47], s[48:49], s[50:51]
    s_or_b64 vcc, s[52:53], s[54:55]
    s_or_b64 vcc, vcc, s[46:47]
    s_cbranch_scc1 L_v_l1_271
    s_branch L_v_l1ok_273
L_v_k1_275_c:
    s_add_u32 s46, s65, 4096
    buffer_load_dwordx4 v[32:35], v15, s[12:15], s65 offen offset:0 sc1
    buffer_load_dwordx4 v[48:51], v15, s[12:15], s46 offen offset:0 sc1
    buffer_load_dwordx4 v[36:39], v15, s[12:15], s65 offen offset:1024 sc1
    buffer_load_dwordx4 v[52:55], v15, s[12:15], s46 offen offset:1024 sc1
    buffer_load_dwordx4 v[40:43], v15, s[12:15], s65 offen offset:2048 sc1
    buffer_load_dwordx4 v[56:59], v15, s[12:15], s46 offen offset:2048 sc1
    buffer_load_dwordx4 v[44:47], v15, s[12:15], s65 offen offset:3072 sc1
    buffer_load_dwordx4 v[60:63], v15, s[12:15], s46 offen offset:3072 sc1
    s_add_u32 s65, s65, 786432
    s_branch L_v_k1_275
L_rt_277:
    s_add_u32 s70, s70, 1
    s_cmp_lt_u32 s70, 524288
    s_cbranch_scc1 L_v_rl_276
    s_branch L_c_done_1
L_v_vp_279:
    buffer_load_dwordx4 v[64:67], v11, s[12:15], s62 offen offset:0 sc1
    buffer_load_dwordx4 v[68:71], v11, s[12:15], s62 offen offset:1024 sc1
    s_branch L_v_vp_279_m
L_rt_280:
    s_add_u32 s70, s70, 1
    s_cmp_lt_u32 s70, 524288
    s_cbranch_scc1 L_v_vp_279
    s_branch L_c_done_1
L_v_fl_283:
    v_and_b32 v22, 31, v1
    v_lshlrev_b32 v22, 7, v22
    s_mov_b32 s46, 0x109400
    s_mov_b32 s47, 56
    s_mov_b32 s70, 0
L_spin_296:
    buffer_load_dword v23, v22, s[12:15], s46 offen sc1
    s_waitcnt vmcnt(0)
    v_cmp_ge_u32 vcc, s47, v23
    s_add_u32 s70, s70, 1
    s_cbranch_vccz L_spok_297
    s_sleep 3
    s_cmp_lt_u32 s70, 524288
    s_cbranch_scc1 L_spin_296
    s_branch L_c_done_1
L_spok_297:
    s_branch L_v_fl_283_b
L_v_nx_282_s:
    s_sleep 2
    s_branch L_v_nx_282
L_v_gf_286:
    v_max3_u32 v24, v96, v97, v98
    v_max3_u32 v24, v24, v99, v100
    v_max3_u32 v24, v24, v101, v102
    v_max_u32 v24, v24, v103
    v_cmp_eq_u32 vcc, -1, v24
    v_min_u32 v20, -2, v20
    s_add_u32 s70, s70, 1
    s_cbranch_vccz L_v_gok_285
    buffer_load_dword v96, v7, s[12:15], s63 offen offset:0 sc1
    buffer_load_dword v97, v7, s[12:15], s63 offen offset:256 sc1
    buffer_load_dword v98, v7, s[12:15], s63 offen offset:512 sc1
    buffer_load_dword v99, v7, s[12:15], s63 offen offset:768 sc1
    buffer_load_dword v100, v7, s[12:15], s63 offen offset:1024 sc1
    buffer_load_dword v101, v7, s[12:15], s63 offen offset:1280 sc1
    buffer_load_dword v102, v7, s[12:15], s63 offen offset:1536 sc1
    buffer_load_dword v103, v7, s[12:15], s63 offen offset:1792 sc1
    s_cmp_lt_u32 s70, 524288
    s_cbranch_scc1 L_v_gp_284
    s_branch L_c_done_1
L_c_done_1:
    s_endpgm
.section .rodata,"a"
.p2align 6
.amdhsa_kernel k3_chain_kernel
  .amdhsa_next_free_vgpr 256
  .amdhsa_next_free_sgpr 102
  .amdhsa_accum_offset 128
  .amdhsa_group_segment_fixed_size 0
  .amdhsa_kernarg_size 136
  .amdhsa_user_sgpr_count 2
  .amdhsa_user_sgpr_kernarg_segment_ptr 1
  .amdhsa_system_sgpr_workgroup_id_x 1
.end_amdhsa_kernel
```

```asm
; @launch kernel=k3_chain_kernel grid=(256,1,1) block=(512,1,1) lds=147712
.amdgcn_target "amdgcn-amd-amdhsa--gfx950"
.text
.globl k3_chain_kernel
.p2align 8
.type k3_chain_kernel,@function
k3_chain_kernel:
    s_cmp_ge_u32 s2, 256
    s_cbranch_scc1 L_c_done_1
    s_load_dwordx4 s[20:23], s[0:1], 120
    v_and_b32 v1, 63, v0
    v_lshrrev_b32 v2, 6, v0
    s_nop 0
    v_readfirstlane_b32 s44, v2
    s_waitcnt lgkmcnt(0)
    s_mov_b32 s12, s22
    s_and_b32 s13, s23, 0xffff
    s_mov_b32 s14, 0x10000000
    s_mov_b32 s15, 0x00020000
    s_mov_b32 s16, s20
    s_and_b32 s17, s21, 0xffff
    s_mov_b32 s18, 0x100
    s_mov_b32 s19, 0x00020000
    s_getpc_b64 s[24:25]
L_c_here_2:
    v_lshlrev_b32 v3, 7, v0
    v_mov_b32 v5, s25
    v_add_co_u32 v4, vcc, s24, v3
    s_nop 1
    v_addc_co_u32 v5, vcc, 0, v5, vcc
    v_cmp_gt_u32 vcc, L_c_done_1 - L_c_here_2, v3
    s_and_saveexec_b64 s[26:27], vcc
    s_cbranch_execz L_c_ct_3
    global_load_dword v109, v[4:5], off
L_c_ct_3:
    s_mov_b64 exec, s[26:27]
    s_load_dwordx4 s[8:11], s[0:1], 96
    v_lshrrev_b32 v5, 3, v0
    v_mul_u32_u24 v6, 24576, v5
    v_and_b32 v7, 7, v0
    v_lshl_add_u32 v6, v7, 4, v6
    v_add_u32 v7, 12288, v6
    v_lshlrev_b32 v5, 2, v5
    s_lshr_b32 s50, s2, 5
    s_and_b32 s51, s2, 31
    s_mul_i32 s52, s50, 1572864
    s_lshl_b32 s53, s51, 7
    s_add_u32 s52, s52, s53
    s_lshl_b32 s53, s50, 8
    s_waitcnt lgkmcnt(0)
    s_mov_b32 s28, s10
    s_and_b32 s29, s11, 0xffff
    s_mov_b32 s30, 0xc00000
    s_mov_b32 s31, 0x00020000
    s_mov_b32 s32, s8
    s_and_b32 s33, s9, 0xffff
    s_mov_b32 s34, 0x800
    s_mov_b32 s35, 0x00020000
    buffer_load_dword v8, v5, s[32:35], s53 offen
    buffer_load_dwordx4 v[12:15], v6, s[28:31], s52 offen nt
    buffer_load_dwordx4 v[16:19], v7, s[28:31], s52 offen nt
    s_getreg_b32 s39, hwreg(HW_REG_XCC_ID)
    s_and_b32 s39, s39, 7
    s_cmp_lg_u32 s44, 1
    s_cbranch_scc1 L_nz_7
    v_mov_b32 v32, 0
    v_mov_b32 v33, 0
    v_mov_b32 v34, 0
    v_mov_b32 v35, 0
    v_lshlrev_b32 v4, 4, v1
    s_lshl_b32 s45, s2, 10
    s_add_u32 s45, s45, 0x100000
    buffer_store_dwordx4 v[32:35], v4, s[12:15], s45 offen sc1
L_nz_7:
    s_waitcnt vmcnt(0)
    v_lshlrev_b32 v9, 16, v8
    v_and_b32 v10, 0xffff0000, v8
    v_mul_f32 v20, 0xbfb8aa3b, v9
    v_mul_f32 v21, 0xbfb8aa3b, v10
    v_exp_f32 v20, v20
    v_exp_f32 v21, v21
    s_nop 0
    v_add_f32 v20, 1.0, v20
    v_add_f32 v21, 1.0, v21
    v_rcp_f32 v20, v20
    v_rcp_f32 v21, v21
    s_nop 0
    v_mul_f32 v9, v9, v20
    v_mul_f32 v10, v10, v21
    v_cvt_pk_bf16_f32 v9, 0, v9
    v_cvt_pk_bf16_f32 v10, 0, v10
    v_lshlrev_b32 v28, 16, v12
    v_and_b32 v29, 0xffff0000, v12
    v_lshlrev_b32 v30, 16, v16
    v_and_b32 v31, 0xffff0000, v16
    v_mul_f32 v20, v28, v9
    v_mul_f32 v21, v29, v9
    v_fmac_f32 v20, v30, v10
    v_fmac_f32 v21, v31, v10
    v_lshlrev_b32 v28, 16, v13
    v_and_b32 v29, 0xffff0000, v13
    v_lshlrev_b32 v30, 16, v17
    v_and_b32 v31, 0xffff0000, v17
    v_mul_f32 v22, v28, v9
    v_mul_f32 v23, v29, v9
    v_fmac_f32 v22, v30, v10
    v_fmac_f32 v23, v31, v10
    v_lshlrev_b32 v28, 16, v14
    v_and_b32 v29, 0xffff0000, v14
    v_lshlrev_b32 v30, 16, v18
    v_and_b32 v31, 0xffff0000, v18
    v_mul_f32 v24, v28, v9
    v_mul_f32 v25, v29, v9
    v_fmac_f32 v24, v30, v10
    v_fmac_f32 v25, v31, v10
    v_lshlrev_b32 v28, 16, v15
    v_and_b32 v29, 0xffff0000, v15
    v_lshlrev_b32 v30, 16, v19
    v_and_b32 v31, 0xffff0000, v19
    v_mul_f32 v26, v28, v9
    v_mul_f32 v27, v29, v9
    v_fmac_f32 v26, v30, v10
    v_fmac_f32 v27, v31, v10
    s_nop 1
    v_add_f32_dpp v20, v20, v20 row_ror:8 row_mask:0xf bank_mask:0xf
    v_add_f32_dpp v21, v21, v21 row_ror:8 row_mask:0xf bank_mask:0xf
    v_add_f32_dpp v22, v22, v22 row_ror:8 row_mask:0xf bank_mask:0xf
    v_add_f32_dpp v23, v23, v23 row_ror:8 row_mask:0xf bank_mask:0xf
    v_add_f32_dpp v24, v24, v24 row_ror:8 row_mask:0xf bank_mask:0xf
    v_add_f32_dpp v25, v25, v25 row_ror:8 row_mask:0xf bank_mask:0xf
    v_add_f32_dpp v26, v26, v26 row_ror:8 row_mask:0xf bank_mask:0xf
    v_add_f32_dpp v27, v27, v27 row_ror:8 row_mask:0xf bank_mask:0xf
    s_nop 1
    v_permlane16_swap_b32 v20, v24
    v_permlane16_swap_b32 v21, v25
    v_permlane16_swap_b32 v22, v26
    v_permlane16_swap_b32 v23, v27
    v_add_f32 v20, v20, v24
    v_add_f32 v21, v21, v25
    v_add_f32 v22, v22, v26
    v_add_f32 v23, v23, v27
    s_nop 1
    v_permlane32_swap_b32 v20, v22
    v_permlane32_swap_b32 v21, v23
    v_add_f32 v20, v20, v22
    v_add_f32 v21, v21, v23
    v_and_b32 v22, 7, v1
    v_lshlrev_b32 v22, 5, v22
    v_bfe_u32 v23, v1, 4, 1
    v_lshl_add_u32 v22, v23, 4, v22
    v_lshrrev_b32 v23, 5, v1
    v_lshl_add_u32 v22, v23, 3, v22
    s_lshl_b32 s52, s44, 8
    s_add_u32 s52, s52, 139776
    v_add_u32 v22, s52, v22
    ds_write_b64 v22, v[20:21]
    s_waitcnt lgkmcnt(0)
    s_barrier
    s_cmp_lg_u32 s44, 1
    s_cbranch_scc1 L_m1_8
    v_lshlrev_b32 v22, 2, v1
    v_add_u32 v23, 139776, v22
    ds_read_b32 v24, v23 offset:0
    ds_read_b32 v25, v23 offset:256
    ds_read_b32 v26, v23 offset:512
    ds_read_b32 v27, v23 offset:768
    ds_read_b32 v28, v23 offset:1024
    ds_read_b32 v29, v23 offset:1280
    ds_read_b32 v30, v23 offset:1536
    ds_read_b32 v31, v23 offset:1792
    s_waitcnt lgkmcnt(0)
    v_add_f32 v24, v24, v28
    v_add_f32 v25, v25, v29
    v_add_f32 v26, v26, v30
    v_add_f32 v27, v27, v31
    v_add_f32 v24, v24, v26
    v_add_f32 v25, v25, v27
    v_add_f32 v24, v24, v25
    s_lshl_b32 s52, s2, 8
    s_add_u32 s52, s52, 0x10000
    buffer_store_dword v24, v22, s[12:15], s52 offen sc1
L_m1_8:
    s_cmp_lg_u32 s44, 1
    s_cbranch_scc1 L_tk_4
    v_mov_b32 v3, 1
    s_mov_b32 s40, s39
    s_lshl_b32 s45, s40, 5
    v_mov_b32 v4, 0
    s_waitcnt vmcnt(0)
    s_mov_b64 exec, 1
    buffer_atomic_add v3, v4, s[16:19], s45 offen sc0
    s_waitcnt vmcnt(0)
    v_readfirstlane_b32 s41, v3
    s_nop 3
    s_cmp_lt_u32 s41, 32
    s_cbranch_scc1 L_got_5
    v_mov_b32 v3, 1
    buffer_atomic_add v3, v4, s[16:19], 0 offen offset:16 sc0
    s_waitcnt vmcnt(0)
    v_readfirstlane_b32 s46, v3
    s_mov_b64 exec, -1
    v_and_b32 v4, 7, v1
    v_lshlrev_b32 v4, 5, v4
    s_mov_b32 s70, 0
L_sp_6:
    s_sleep 8
    buffer_load_dword v3, v4, s[16:19], 0 offen sc1
    s_waitcnt vmcnt(0)
    s_mov_b32 s48, 0
    v_readlane_b32 s50, v3, 0
    v_readlane_b32 s51, v3, 1
    v_readlane_b32 s52, v3, 2
    v_readlane_b32 s53, v3, 3
    v_readlane_b32 s54, v3, 4
    v_readlane_b32 s55, v3, 5
    v_readlane_b32 s56, v3, 6
    v_readlane_b32 s57, v3, 7
    s_nop 3
    s_add_u32 s48, s48, s50
    s_add_u32 s48, s48, s51
    s_add_u32 s48, s48, s52
    s_add_u32 s48, s48, s53
    s_add_u32 s48, s48, s54
    s_add_u32 s48, s48, s55
    s_add_u32 s48, s48, s56
    s_add_u32 s48, s48, s57
    s_add_u32 s70, s70, 1
    s_cmp_ge_u32 s70, 524288
    s_cbranch_scc1 L_c_done_1
    s_cmp_lt_u32 s48, 256
    s_cbranch_scc1 L_sp_6
    s_min_u32 s48, s50, 32
    s_mov_b32 s40, 0
    s_add_u32 s41, s48, s46
    s_cmp_lt_u32 s41, 32
    s_cbranch_scc1 L_got_5
    s_sub_u32 s46, s41, 32
    s_min_u32 s48, s51, 32
    s_mov_b32 s40, 1
    s_add_u32 s41, s48, s46
    s_cmp_lt_u32 s41, 32
    s_cbranch_scc1 L_got_5
    s_sub_u32 s46, s41, 32
    s_min_u32 s48, s52, 32
    s_mov_b32 s40, 2
    s_add_u32 s41, s48, s46
    s_cmp_lt_u32 s41, 32
    s_cbranch_scc1 L_got_5
    s_sub_u32 s46, s41, 32
    s_min_u32 s48, s53, 32
    s_mov_b32 s40, 3
    s_add_u32 s41, s48, s46
    s_cmp_lt_u32 s41, 32
    s_cbranch_scc1 L_got_5
    s_sub_u32 s46, s41, 32
    s_min_u32 s48, s54, 32
    s_mov_b32 s40, 4
    s_add_u32 s41, s48, s46
    s_cmp_lt_u32 s41, 32
    s_cbranch_scc1 L_got_5
    s_sub_u32 s46, s41, 32
    s_min_u32 s48, s55, 32
    s_mov_b32 s40, 5
    s_add_u32 s41, s48, s46
    s_cmp_lt_u32 s41, 32
    s_cbranch_scc1 L_got_5
    s_sub_u32 s46, s41, 32
    s_min_u32 s48, s56, 32
    s_mov_b32 s40, 6
    s_add_u32 s41, s48, s46
    s_cmp_lt_u32 s41, 32
    s_cbranch_scc1 L_got_5
    s_sub_u32 s46, s41, 32
    s_min_u32 s48, s57, 32
    s_mov_b32 s40, 7
    s_add_u32 s41, s48, s46
    s_cmp_lt_u32 s41, 32
    s_cbranch_scc1 L_got_5
    s_sub_u32 s46, s41, 32
    s_branch L_c_done_1
L_got_5:
    s_mov_b64 exec, -1
    s_lshl_b32 s45, s40, 8
    s_or_b32 s45, s45, s41
    v_mov_b32 v3, s45
    v_mov_b32 v4, 147464
    ds_write_b32 v4, v3
    s_waitcnt lgkmcnt(0)
L_tk_4:
    s_barrier
    v_mov_b32 v4, 147464
    ds_read_b32 v3, v4
    s_waitcnt lgkmcnt(0)
    v_readfirstlane_b32 s45, v3
    s_nop 3
    s_lshr_b32 s40, s45, 8
    s_and_b32 s41, s45, 0xff
    s_lshr_b32 s45, s40, 2
    s_xor_b32 s45, s45, 1
    s_lshl_b32 s45, s45, 4
    s_and_b32 s40, s40, 3
    s_lshl_b32 s40, s40, 1
    s_lshr_b32 s46, s41, 4
    s_add_u32 s40, s40, s46
    s_and_b32 s41, s41, 15
    s_add_u32 s41, s41, s45
    s_cmp_lt_u32 s41, 16
    s_cbranch_scc1 L_c_chain_9
    s_sub_u32 s48, s41, 16
    s_mov_b32 s78, 1
    s_cmp_lt_u32 s48, 12
    s_cbranch_scc1 L_w_g_10
    s_and_b32 s42, s48, 3
    s_mov_b32 s43, s40
    s_load_dwordx2 s[4:5], s[0:1], 0
    v_lshlrev_b32 v2, 4, v1
    v_lshlrev_b32 v3, 5, v1
    s_lshl_b32 s55, s43, 2
    s_add_u32 s55, s55, s42
    s_waitcnt lgkmcnt(0)
    s_mov_b32 s24, s4
    s_and_b32 s25, s5, 0xffff
    s_mov_b32 s26, 0x400000
    s_mov_b32 s27, 0x00020000
    s_lshl_b32 s46, s42, 3
    s_add_u32 s46, s46, s44
    s_lshl_b32 s46, s46, 11
    v_add_u32 v7, s46, v2
    s_lshl_b32 s63, s43, 16
    buffer_load_dwordx4 a[0:3], v7, s[24:27], s63 offen
    buffer_load_dwordx4 a[4:7], v7, s[24:27], s63 offen offset:1024
    s_cmp_lg_u32 s44, 0
    s_cbranch_scc1 L_zwok_19
    v_and_b32 v8, 7, v1
    v_lshlrev_b32 v8, 5, v8
    s_mov_b32 s70, 0
L_zw_18:
    buffer_load_dword v9, v8, s[16:19], 0 offen sc1
    s_waitcnt vmcnt(0)
    v_add_u32_dpp v9, v9, v9 row_ror:1 row_mask:0xf bank_mask:0xf
    s_nop 1
    v_add_u32_dpp v9, v9, v9 row_ror:2 row_mask:0xf bank_mask:0xf
    s_nop 1
    v_add_u32_dpp v9, v9, v9 row_ror:4 row_mask:0xf bank_mask:0xf
    v_cmp_ne_u32 vcc, 0x100, v9
    s_add_u32 s70, s70, 1
    s_cbranch_vccz L_zwok_19
    s_sleep 4
    s_cmp_lt_u32 s70, 524288
    s_cbranch_scc1 L_zw_18
    s_branch L_c_done_1
L_zwok_19:
    s_barrier
    v_lshlrev_b32 v4, 4, v0
    s_mov_b32 s46, 0x10000
    buffer_load_dwordx4 v[32:35], v4, s[12:15], s46 offen sc1
    s_mov_b32 s46, 0x12000
    buffer_load_dwordx4 v[36:39], v4, s[12:15], s46 offen sc1
    s_mov_b32 s46, 0x14000
    buffer_load_dwordx4 v[40:43], v4, s[12:15], s46 offen sc1
    s_mov_b32 s46, 0x16000
    buffer_load_dwordx4 v[44:47], v4, s[12:15], s46 offen sc1
    s_mov_b32 s46, 0x18000
    buffer_load_dwordx4 v[48:51], v4, s[12:15], s46 offen sc1
    s_mov_b32 s46, 0x1a000
    buffer_load_dwordx4 v[52:55], v4, s[12:15], s46 offen sc1
    s_mov_b32 s46, 0x1c000
    buffer_load_dwordx4 v[56:59], v4, s[12:15], s46 offen sc1
    s_mov_b32 s46, 0x1e000
    buffer_load_dwordx4 v[60:63], v4, s[12:15], s46 offen sc1
    s_cmp_lg_u32 s44, 0
    s_cbranch_scc1 L_l_nx_20
    s_cmp_ge_u32 s42, 2
    s_cbranch_scc1 L_l_nx_20
    s_or_b32 s47, s39, 0x100
    v_mov_b32 v8, s47
    v_mov_b32 v9, 0
    s_lshl_b32 s46, s40, 3
    s_lshl_b32 s47, s42, 2
    s_add_u32 s46, s46, s47
    s_add_u32 s46, s46, 0x101200
    s_mov_b64 exec, 1
    buffer_store_dword v8, v9, s[12:15], s46 offen sc1
    s_mov_b64 exec, -1
L_l_nx_20:
    s_mul_i32 s46, s44, 2064
    s_add_u32 s46, s46, 32768
    v_add_u32 v10, s46, v2
    v_and_b32 v11, 7, v1
    v_lshrrev_b32 v12, 3, v1
    v_mul_u32_u24 v13, 2064, v11
    v_lshl_add_u32 v13, v12, 4, v13
    s_lshl_b32 s46, s44, 8
    s_add_u32 s46, s46, 32768
    v_add_u32 v13, s46, v13
    v_lshlrev_b32 v11, 4, v11
    v_lshl_add_u32 v11, v12, 9, v11
    s_lshl_b32 s46, s44, 13
    s_lshl_b32 s47, s42, 7
    s_add_u32 s46, s46, s47
    s_add_u32 s46, s46, 0x400000
    v_add_u32 v11, s46, v11
    v_add_u32 v12, 4096, v11
    s_lshl_b32 s52, s43, 9
    s_lshl_b32 s47, s42, 7
    s_add_u32 s52, s52, s47
    s_add_u32 s52, s52, 0x109400
    s_mov_b32 s60, s43
    s_waitcnt vmcnt(0)
    v_add_f32 v32, v32, v48
    v_add_f32 v33, v33, v49
    v_add_f32 v34, v34, v50
    v_add_f32 v35, v35, v51
    v_add_f32 v36, v36, v52
    v_add_f32 v37, v37, v53
    v_add_f32 v38, v38, v54
    v_add_f32 v39, v39, v55
    v_add_f32 v40, v40, v56
    v_add_f32 v41, v41, v57
    v_add_f32 v42, v42, v58
    v_add_f32 v43, v43, v59
    v_add_f32 v44, v44, v60
    v_add_f32 v45, v45, v61
    v_add_f32 v46, v46, v62
    v_add_f32 v47, v47, v63
    v_add_f32 v32, v32, v40
    v_add_f32 v33, v33, v41
    v_add_f32 v34, v34, v42
    v_add_f32 v35, v35, v43
    v_add_f32 v36, v36, v44
    v_add_f32 v37, v37, v45
    v_add_f32 v38, v38, v46
    v_add_f32 v39, v39, v47
    v_add_f32 v32, v32, v36
    v_add_f32 v33, v33, v37
    v_add_f32 v34, v34, v38
    v_add_f32 v35, v35, v39
    v_cvt_pk_bf16_f32 v32, 0, v32
    v_cvt_pk_bf16_f32 v33, 0, v33
    v_cvt_pk_bf16_f32 v34, 0, v34
    v_cvt_pk_bf16_f32 v35, 0, v35
    ds_write_b128 v4, v[32:35]
    s_waitcnt lgkmcnt(0)
    s_barrier
    ds_read_b128 v[48:51], v3 offset:0
    ds_read_b128 v[52:55], v3 offset:16
    ds_read_b128 v[56:59], v3 offset:2048
    ds_read_b128 v[60:63], v3 offset:2064
    ds_read_b128 v[32:35], v3 offset:4096
    ds_read_b128 v[36:39], v3 offset:4112
    ds_read_b128 v[40:43], v3 offset:6144
    ds_read_b128 v[44:47], v3 offset:6160
    s_waitcnt lgkmcnt(0)
    v_add_f32 v32, 1.0, v32
    v_add_f32 v33, 1.0, v33
    v_add_f32 v34, 1.0, v34
    v_add_f32 v35, 1.0, v35
    v_add_f32 v36, 1.0, v36
    v_add_f32 v37, 1.0, v37
    v_add_f32 v38, 1.0, v38
    v_add_f32 v39, 1.0, v39
    v_add_f32 v40, 1.0, v40
    v_add_f32 v41, 1.0, v41
    v_add_f32 v42, 1.0, v42
    v_add_f32 v43, 1.0, v43
    v_add_f32 v44, 1.0, v44
    v_add_f32 v45, 1.0, v45
    v_add_f32 v46, 1.0, v46
    v_add_f32 v47, 1.0, v47
    v_cvt_pk_bf16_f32 v32, 0, v32
    v_cvt_pk_bf16_f32 v33, 0, v33
    v_cvt_pk_bf16_f32 v34, 0, v34
    v_cvt_pk_bf16_f32 v35, 0, v35
    v_cvt_pk_bf16_f32 v36, 0, v36
    v_cvt_pk_bf16_f32 v37, 0, v37
    v_cvt_pk_bf16_f32 v38, 0, v38
    v_cvt_pk_bf16_f32 v39, 0, v39
    v_cvt_pk_bf16_f32 v40, 0, v40
    v_cvt_pk_bf16_f32 v41, 0, v41
    v_cvt_pk_bf16_f32 v42, 0, v42
    v_cvt_pk_bf16_f32 v43, 0, v43
    v_cvt_pk_bf16_f32 v44, 0, v44
    v_cvt_pk_bf16_f32 v45, 0, v45
    v_cvt_pk_bf16_f32 v46, 0, v46
    v_cvt_pk_bf16_f32 v47, 0, v47
L_l_sub_21:
    s_lshl_b32 s63, s60, 16
    v_accvgpr_read_b32 v96, a0
    v_accvgpr_read_b32 v97, a1
    v_accvgpr_read_b32 v98, a2
    v_accvgpr_read_b32 v99, a3
    v_accvgpr_read_b32 v100, a4
    v_accvgpr_read_b32 v101, a5
    v_accvgpr_read_b32 v102, a6
    v_accvgpr_read_b32 v103, a7
    v_lshlrev_b32 v64, 16, v96
    v_and_b32 v65, 0xffff0000, v96
    v_lshlrev_b32 v66, 16, v97
    v_and_b32 v67, 0xffff0000, v97
    v_lshlrev_b32 v68, 16, v98
    v_and_b32 v69, 0xffff0000, v98
    v_lshlrev_b32 v70, 16, v99
    v_and_b32 v71, 0xffff0000, v99
    v_lshlrev_b32 v72, 16, v100
    v_and_b32 v73, 0xffff0000, v100
    v_lshlrev_b32 v74, 16, v101
    v_and_b32 v75, 0xffff0000, v101
    v_lshlrev_b32 v76, 16, v102
    v_and_b32 v77, 0xffff0000, v102
    v_lshlrev_b32 v78, 16, v103
    v_and_b32 v79, 0xffff0000, v103
    v_pk_add_f32 v[80:81], v[64:65], v[72:73]
    v_pk_add_f32 v[82:83], v[66:67], v[74:75]
    v_pk_add_f32 v[84:85], v[68:69], v[76:77]
    v_pk_add_f32 v[86:87], v[70:71], v[78:79]
    v_pk_add_f32 v[80:81], v[80:81], v[84:85]
    v_pk_add_f32 v[82:83], v[82:83], v[86:87]
    v_pk_add_f32 v[80:81], v[80:81], v[82:83]
    v_add_f32 v14, v80, v81
    s_nop 1
    v_add_f32_dpp v14, v14, v14 row_shr:1 row_mask:0xf bank_mask:0xf bound_ctrl:0
    s_nop 1
    v_add_f32_dpp v14, v14, v14 row_shr:2 row_mask:0xf bank_mask:0xf bound_ctrl:0
    s_nop 1
    v_add_f32_dpp v14, v14, v14 row_shr:4 row_mask:0xf bank_mask:0xf bound_ctrl:0
    s_nop 1
    v_add_f32_dpp v14, v14, v14 row_shr:8 row_mask:0xf bank_mask:0xf bound_ctrl:0
    s_nop 1
    v_add_f32_dpp v14, v14, v14 row_bcast:15 row_mask:0xa bank_mask:0xf
    s_nop 1
    v_add_f32_dpp v14, v14, v14 row_bcast:31 row_mask:0xc bank_mask:0xf
    s_nop 1
    v_readlane_b32 s46, v14, 63
    s_nop 1
    v_mov_b32 v15, s46
    v_mul_f32 v15, 0x3a800000, v15
    v_pk_add_f32 v[80:81], v[64:65], v[14:15] op_sel:[0,1] op_sel_hi:[1,1] neg_lo:[0,1] neg_hi:[0,1]
    v_pk_add_f32 v[82:83], v[66:67], v[14:15] op_sel:[0,1] op_sel_hi:[1,1] neg_lo:[0,1] neg_hi:[0,1]
    v_pk_add_f32 v[84:85], v[68:69], v[14:15] op_sel:[0,1] op_sel_hi:[1,1] neg_lo:[0,1] neg_hi:[0,1]
    v_pk_add_f32 v[86:87], v[70:71], v[14:15] op_sel:[0,1] op_sel_hi:[1,1] neg_lo:[0,1] neg_hi:[0,1]
    v_pk_add_f32 v[88:89], v[72:73], v[14:15] op_sel:[0,1] op_sel_hi:[1,1] neg_lo:[0,1] neg_hi:[0,1]
    v_pk_add_f32 v[90:91], v[74:75], v[14:15] op_sel:[0,1] op_sel_hi:[1,1] neg_lo:[0,1] neg_hi:[0,1]
    v_pk_add_f32 v[92:93], v[76:77], v[14:15] op_sel:[0,1] op_sel_hi:[1,1] neg_lo:[0,1] neg_hi:[0,1]
    v_pk_add_f32 v[94:95], v[78:79], v[14:15] op_sel:[0,1] op_sel_hi:[1,1] neg_lo:[0,1] neg_hi:[0,1]
    v_pk_mul_f32 v[104:105], v[80:81], v[80:81]
    v_pk_mul_f32 v[106:107], v[82:83], v[82:83]
    v_pk_fma_f32 v[104:105], v[84:85], v[84:85], v[104:105]
    v_pk_fma_f32 v[106:107], v[86:87], v[86:87], v[106:107]
    v_pk_fma_f32 v[104:105], v[88:89], v[88:89], v[104:105]
    v_pk_fma_f32 v[106:107], v[90:91], v[90:91], v[106:107]
    v_pk_fma_f32 v[104:105], v[92:93], v[92:93], v[104:105]
    v_pk_fma_f32 v[106:107], v[94:95], v[94:95], v[106:107]
    v_pk_add_f32 v[104:105], v[104:105], v[106:107]
    v_add_f32 v14, v104, v105
    v_cvt_pk_bf16_f32 v15, 0, v15
    s_nop 1
    v_add_f32_dpp v14, v14, v14 row_shr:1 row_mask:0xf bank_mask:0xf bound_ctrl:0
    s_nop 1
    v_add_f32_dpp v14, v14, v14 row_shr:2 row_mask:0xf bank_mask:0xf bound_ctrl:0
    s_nop 1
    v_add_f32_dpp v14, v14, v14 row_shr:4 row_mask:0xf bank_mask:0xf bound_ctrl:0
    s_nop 1
    v_add_f32_dpp v14, v14, v14 row_shr:8 row_mask:0xf bank_mask:0xf bound_ctrl:0
    s_nop 1
    v_add_f32_dpp v14, v14, v14 row_bcast:15 row_mask:0xa bank_mask:0xf
    s_nop 1
    v_add_f32_dpp v14, v14, v14 row_bcast:31 row_mask:0xc bank_mask:0xf
    s_nop 1
    v_readlane_b32 s47, v14, 63
    v_pk_add_f32 v[64:65], v[64:65], v[14:15] op_sel:[0,1] op_sel_hi:[1,1] neg_lo:[0,1] neg_hi:[0,1]
    v_pk_add_f32 v[66:67], v[66:67], v[14:15] op_sel:[0,1] op_sel_hi:[1,1] neg_lo:[0,1] neg_hi:[0,1]
    v_pk_add_f32 v[68:69], v[68:69], v[14:15] op_sel:[0,1] op_sel_hi:[1,1] neg_lo:[0,1] neg_hi:[0,1]
    v_pk_add_f32 v[70:71], v[70:71], v[14:15] op_sel:[0,1] op_sel_hi:[1,1] neg_lo:[0,1] neg_hi:[0,1]
    v_pk_add_f32 v[72:73], v[72:73], v[14:15] op_sel:[0,1] op_sel_hi:[1,1] neg_lo:[0,1] neg_hi:[0,1]
    v_pk_add_f32 v[74:75], v[74:75], v[14:15] op_sel:[0,1] op_sel_hi:[1,1] neg_lo:[0,1] neg_hi:[0,1]
    v_pk_add_f32 v[76:77], v[76:77], v[14:15] op_sel:[0,1] op_sel_hi:[1,1] neg_lo:[0,1] neg_hi:[0,1]
    v_pk_add_f32 v[78:79], v[78:79], v[14:15] op_sel:[0,1] op_sel_hi:[1,1] neg_lo:[0,1] neg_hi:[0,1]
    v_mov_b32 v14, s47
    v_mul_f32 v14, 0x3a800000, v14
    v_cvt_pk_bf16_f32 v14, 0, v14
    v_add_f32 v14, 0x3727c5ac, v14
    v_cvt_pk_bf16_f32 v14, 0, v14
    v_sqrt_f32 v14, v14
    s_nop 0
    v_cvt_pk_bf16_f32 v14, 0, v14
    v_rcp_f32 v14, v14
    v_cvt_pk_bf16_f32 v64, 0, v64
    v_cvt_pk_bf16_f32 v65, 0, v65
    v_cvt_pk_bf16_f32 v66, 0, v66
    v_cvt_pk_bf16_f32 v67, 0, v67
    v_cvt_pk_bf16_f32 v68, 0, v68
    v_cvt_pk_bf16_f32 v69, 0, v69
    v_cvt_pk_bf16_f32 v70, 0, v70
    v_cvt_pk_bf16_f32 v71, 0, v71
    v_cvt_pk_bf16_f32 v72, 0, v72
    v_cvt_pk_bf16_f32 v73, 0, v73
    v_cvt_pk_bf16_f32 v74, 0, v74
    v_cvt_pk_bf16_f32 v75, 0, v75
    v_cvt_pk_bf16_f32 v76, 0, v76
    v_cvt_pk_bf16_f32 v77, 0, v77
    v_cvt_pk_bf16_f32 v78, 0, v78
    v_cvt_pk_bf16_f32 v79, 0, v79
    v_pk_mul_f32 v[64:65], v[64:65], v[14:15] op_sel_hi:[1,0]
    v_pk_mul_f32 v[66:67], v[66:67], v[14:15] op_sel_hi:[1,0]
    v_pk_mul_f32 v[68:69], v[68:69], v[14:15] op_sel_hi:[1,0]
    v_pk_mul_f32 v[70:71], v[70:71], v[14:15] op_sel_hi:[1,0]
    v_pk_mul_f32 v[72:73], v[72:73], v[14:15] op_sel_hi:[1,0]
    v_pk_mul_f32 v[74:75], v[74:75], v[14:15] op_sel_hi:[1,0]
    v_pk_mul_f32 v[76:77], v[76:77], v[14:15] op_sel_hi:[1,0]
    v_pk_mul_f32 v[78:79], v[78:79], v[14:15] op_sel_hi:[1,0]
    v_cvt_pk_bf16_f32 v64, 0, v64
    v_cvt_pk_bf16_f32 v65, 0, v65
    v_cvt_pk_bf16_f32 v66, 0, v66
    v_cvt_pk_bf16_f32 v67, 0, v67
    v_cvt_pk_bf16_f32 v68, 0, v68
    v_cvt_pk_bf16_f32 v69, 0, v69
    v_cvt_pk_bf16_f32 v70, 0, v70
    v_cvt_pk_bf16_f32 v71, 0, v71
    v_cvt_pk_bf16_f32 v72, 0, v72
    v_cvt_pk_bf16_f32 v73, 0, v73
    v_cvt_pk_bf16_f32 v74, 0, v74
    v_cvt_pk_bf16_f32 v75, 0, v75
    v_cvt_pk_bf16_f32 v76, 0, v76
    v_cvt_pk_bf16_f32 v77, 0, v77
    v_cvt_pk_bf16_f32 v78, 0, v78
    v_cvt_pk_bf16_f32 v79, 0, v79
    v_pk_mul_f32 v[64:65], v[64:65], v[32:33]
    v_pk_mul_f32 v[66:67], v[66:67], v[34:35]
    v_pk_mul_f32 v[68:69], v[68:69], v[36:37]
    v_pk_mul_f32 v[70:71], v[70:71], v[38:39]
    v_pk_mul_f32 v[72:73], v[72:73], v[40:41]
    v_pk_mul_f32 v[74:75], v[74:75], v[42:43]
    v_pk_mul_f32 v[76:77], v[76:77], v[44:45]
    v_pk_mul_f32 v[78:79], v[78:79], v[46:47]
    v_cvt_pk_bf16_f32 v64, 0, v64
    v_cvt_pk_bf16_f32 v65, 0, v65
    v_cvt_pk_bf16_f32 v66, 0, v66
    v_cvt_pk_bf16_f32 v67, 0, v67
    v_cvt_pk_bf16_f32 v68, 0, v68
    v_cvt_pk_bf16_f32 v69, 0, v69
    v_cvt_pk_bf16_f32 v70, 0, v70
    v_cvt_pk_bf16_f32 v71, 0, v71
    v_cvt_pk_bf16_f32 v72, 0, v72
    v_cvt_pk_bf16_f32 v73, 0, v73
    v_cvt_pk_bf16_f32 v74, 0, v74
    v_cvt_pk_bf16_f32 v75, 0, v75
    v_cvt_pk_bf16_f32 v76, 0, v76
    v_cvt_pk_bf16_f32 v77, 0, v77
    v_cvt_pk_bf16_f32 v78, 0, v78
    v_cvt_pk_bf16_f32 v79, 0, v79
    v_pk_add_f32 v[64:65], v[64:65], v[48:49]
    v_pk_add_f32 v[66:67], v[66:67], v[50:51]
    v_pk_add_f32 v[68:69], v[68:69], v[52:53]
    v_pk_add_f32 v[70:71], v[70:71], v[54:55]
    v_pk_add_f32 v[72:73], v[72:73], v[56:57]
    v_pk_add_f32 v[74:75], v[74:75], v[58:59]
    v_pk_add_f32 v[76:77], v[76:77], v[60:61]
    v_pk_add_f32 v[78:79], v[78:79], v[62:63]
    v_cvt_pk_bf16_f32 v104, v64, v65
    v_cvt_pk_bf16_f32 v105, v66, v67
    v_cvt_pk_bf16_f32 v106, v68, v69
    v_cvt_pk_bf16_f32 v107, v70, v71
    v_cvt_pk_bf16_f32 v108, v72, v73
    v_cvt_pk_bf16_f32 v109, v74, v75
    v_cvt_pk_bf16_f32 v110, v76, v77
    v_cvt_pk_bf16_f32 v111, v78, v79
    ds_write_b128 v10, v[104:107]
    ds_write_b128 v10, v[108:111] offset:1024
    s_waitcnt lgkmcnt(0)
    s_barrier
    ds_read_b128 v[104:107], v13
    ds_read_b128 v[108:111], v13 offset:128
    s_waitcnt lgkmcnt(1)
    buffer_store_dwordx4 v[104:107], v11, s[12:15], s63 offen sc1
    s_waitcnt lgkmcnt(0)
    buffer_store_dwordx4 v[108:111], v12, s[12:15], s63 offen sc1
    s_waitcnt vmcnt(0)
    s_barrier
    s_cmp_lg_u32 s44, 0
    s_cbranch_scc1 L_sf_23
    v_mov_b32 v14, s60
    v_add_u32 v14, 1, v14
    v_mov_b32 v15, 0
    s_mov_b64 exec, 1
    buffer_store_dword v14, v15, s[12:15], s52 offen sc1
    s_mov_b64 exec, -1
L_sf_23:
    s_cmp_ge_u32 s60, 8
    s_cbranch_scc1 L_l_end_22
    s_add_u32 s63, s63, 524288
    buffer_load_dwordx4 a[8:11], v7, s[24:27], s63 offen
    buffer_load_dwordx4 a[12:15], v7, s[24:27], s63 offen offset:1024
    s_add_u32 s63, s63, 524288
    buffer_load_dwordx4 a[16:19], v7, s[24:27], s63 offen
    buffer_load_dwordx4 a[20:23], v7, s[24:27], s63 offen offset:1024
    s_add_u32 s63, s63, 524288
    buffer_load_dwordx4 a[24:27], v7, s[24:27], s63 offen
    buffer_load_dwordx4 a[28:31], v7, s[24:27], s63 offen offset:1024
    s_add_u32 s63, s63, 524288
    buffer_load_dwordx4 a[32:35], v7, s[24:27], s63 offen
    buffer_load_dwordx4 a[36:39], v7, s[24:27], s63 offen offset:1024
    s_add_u32 s63, s63, 524288
    buffer_load_dwordx4 a[40:43], v7, s[24:27], s63 offen
    buffer_load_dwordx4 a[44:47], v7, s[24:27], s63 offen offset:1024
    s_add_u32 s63, s63, 524288
    buffer_load_dwordx4 a[48:51], v7, s[24:27], s63 offen
    buffer_load_dwordx4 a[52:55], v7, s[24:27], s63 offen offset:1024
    s_add_u32 s63, s63, 524288
    buffer_load_dwordx4 a[56:59], v7, s[24:27], s63 offen
    buffer_load_dwordx4 a[60:63], v7, s[24:27], s63 offen offset:1024
    s_waitcnt vmcnt(0)
L_l_end_22:
    v_accvgpr_mov_b32 a0, a8
    v_accvgpr_mov_b32 a1, a9
    v_accvgpr_mov_b32 a2, a10
    v_accvgpr_mov_b32 a3, a11
    v_accvgpr_mov_b32 a4, a12
    v_accvgpr_mov_b32 a5, a13
    v_accvgpr_mov_b32 a6, a14
    v_accvgpr_mov_b32 a7, a15
    v_accvgpr_mov_b32 a8, a16
    v_accvgpr_mov_b32 a9, a17
    v_accvgpr_mov_b32 a10, a18
    v_accvgpr_mov_b32 a11, a19
    v_accvgpr_mov_b32 a12, a20
    v_accvgpr_mov_b32 a13, a21
    v_accvgpr_mov_b32 a14, a22
    v_accvgpr_mov_b32 a15, a23
    v_accvgpr_mov_b32 a16, a24
    v_accvgpr_mov_b32 a17, a25
    v_accvgpr_mov_b32 a18, a26
    v_accvgpr_mov_b32 a19, a27
    v_accvgpr_mov_b32 a20, a28
    v_accvgpr_mov_b32 a21, a29
    v_accvgpr_mov_b32 a22, a30
    v_accvgpr_mov_b32 a23, a31
    v_accvgpr_mov_b32 a24, a32
    v_accvgpr_mov_b32 a25, a33
    v_accvgpr_mov_b32 a26, a34
    v_accvgpr_mov_b32 a27, a35
    v_accvgpr_mov_b32 a28, a36
    v_accvgpr_mov_b32 a29, a37
    v_accvgpr_mov_b32 a30, a38
    v_accvgpr_mov_b32 a31, a39
    v_accvgpr_mov_b32 a32, a40
    v_accvgpr_mov_b32 a33, a41
    v_accvgpr_mov_b32 a34, a42
    v_accvgpr_mov_b32 a35, a43
    v_accvgpr_mov_b32 a36, a44
    v_accvgpr_mov_b32 a37, a45
    v_accvgpr_mov_b32 a38, a46
    v_accvgpr_mov_b32 a39, a47
    v_accvgpr_mov_b32 a40, a48
    v_accvgpr_mov_b32 a41, a49
    v_accvgpr_mov_b32 a42, a50
    v_accvgpr_mov_b32 a43, a51
    v_accvgpr_mov_b32 a44, a52
    v_accvgpr_mov_b32 a45, a53
    v_accvgpr_mov_b32 a46, a54
    v_accvgpr_mov_b32 a47, a55
    v_accvgpr_mov_b32 a48, a56
    v_accvgpr_mov_b32 a49, a57
    v_accvgpr_mov_b32 a50, a58
    v_accvgpr_mov_b32 a51, a59
    v_accvgpr_mov_b32 a52, a60
    v_accvgpr_mov_b32 a53, a61
    v_accvgpr_mov_b32 a54, a62
    v_accvgpr_mov_b32 a55, a63
    s_add_u32 s60, s60, 8
    s_cmp_lt_u32 s60, 64
    s_cbranch_scc1 L_l_sub_21
    s_cmp_lt_u32 s48, 14
    s_cbranch_scc1 L_w_h_17_s
    s_and_b32 s55, s48, 1
    s_lshl_b32 s55, s55, 3
    s_add_u32 s55, s55, s40
    s_load_dwordx4 s[8:11], s[0:1], 96
    v_lshrrev_b32 v5, 3, v0
    s_mov_b32 s46, 196608
    v_mul_lo_u32 v4, v5, s46
    v_and_b32 v6, 7, v0
    v_lshl_add_u32 v4, v6, 4, v4
    v_lshlrev_b32 v5, 5, v5
    s_waitcnt lgkmcnt(0)
    s_mov_b32 s28, s10
    s_and_b32 s29, s11, 0xffff
    s_mov_b32 s30, 0xc00000
    s_mov_b32 s31, 0x00020000
    s_mov_b32 s32, s8
    s_and_b32 s33, s9, 0xffff
    s_mov_b32 s34, 0x800
    s_mov_b32 s35, 0x00020000
    buffer_load_dwordx4 v[8:11], v5, s[32:35], 0 offen
    buffer_load_dwordx4 v[12:15], v5, s[32:35], 0 offen offset:16
    s_waitcnt vmcnt(0)
    v_lshlrev_b32 v16, 16, v8
    v_and_b32 v17, 0xffff0000, v8
    v_lshlrev_b32 v18, 16, v9
    v_and_b32 v19, 0xffff0000, v9
    v_lshlrev_b32 v20, 16, v10
    v_and_b32 v21, 0xffff0000, v10
    v_lshlrev_b32 v22, 16, v11
    v_and_b32 v23, 0xffff0000, v11
    v_lshlrev_b32 v24, 16, v12
    v_and_b32 v25, 0xffff0000, v12
    v_lshlrev_b32 v26, 16, v13
    v_and_b32 v27, 0xffff0000, v13
    v_lshlrev_b32 v28, 16, v14
    v_and_b32 v29, 0xffff0000, v14
    v_lshlrev_b32 v30, 16, v15
    v_and_b32 v31, 0xffff0000, v15
    v_mul_f32 v112, 0xbfb8aa3b, v16
    v_mul_f32 v113, 0xbfb8aa3b, v17
    v_mul_f32 v114, 0xbfb8aa3b, v18
    v_mul_f32 v115, 0xbfb8aa3b, v19
    v_mul_f32 v116, 0xbfb8aa3b, v20
    v_mul_f32 v117, 0xbfb8aa3b, v21
    v_mul_f32 v118, 0xbfb8aa3b, v22
    v_mul_f32 v119, 0xbfb8aa3b, v23
    v_mul_f32 v120, 0xbfb8aa3b, v24
    v_mul_f32 v121, 0xbfb8aa3b, v25
    v_mul_f32 v122, 0xbfb8aa3b, v26
    v_mul_f32 v123, 0xbfb8aa3b, v27
    v_mul_f32 v124, 0xbfb8aa3b, v28
    v_mul_f32 v125, 0xbfb8aa3b, v29
    v_mul_f32 v126, 0xbfb8aa3b, v30
    v_mul_f32 v127, 0xbfb8aa3b, v31
    v_exp_f32 v112, v112
    v_exp_f32 v113, v113
    v_exp_f32 v114, v114
    v_exp_f32 v115, v115
    v_exp_f32 v116, v116
    v_exp_f32 v117, v117
    v_exp_f32 v118, v118
    v_exp_f32 v119, v119
    v_exp_f32 v120, v120
    v_exp_f32 v121, v121
    v_exp_f32 v122, v122
    v_exp_f32 v123, v123
    v_exp_f32 v124, v124
    v_exp_f32 v125, v125
    v_exp_f32 v126, v126
    v_exp_f32 v127, v127
    v_add_f32 v112, 1.0, v112
    v_add_f32 v113, 1.0, v113
    v_add_f32 v114, 1.0, v114
    v_add_f32 v115, 1.0, v115
    v_add_f32 v116, 1.0, v116
    v_add_f32 v117, 1.0, v117
    v_add_f32 v118, 1.0, v118
    v_add_f32 v119, 1.0, v119
    v_add_f32 v120, 1.0, v120
    v_add_f32 v121, 1.0, v121
    v_add_f32 v122, 1.0, v122
    v_add_f32 v123, 1.0, v123
    v_add_f32 v124, 1.0, v124
    v_add_f32 v125, 1.0, v125
    v_add_f32 v126, 1.0, v126
    v_add_f32 v127, 1.0, v127
    v_rcp_f32 v112, v112
    v_rcp_f32 v113, v113
    v_rcp_f32 v114, v114
    v_rcp_f32 v115, v115
    v_rcp_f32 v116, v116
    v_rcp_f32 v117, v117
    v_rcp_f32 v118, v118
    v_rcp_f32 v119, v119
    v_rcp_f32 v120, v120
    v_rcp_f32 v121, v121
    v_rcp_f32 v122, v122
    v_rcp_f32 v123, v123
    v_rcp_f32 v124, v124
    v_rcp_f32 v125, v125
    v_rcp_f32 v126, v126
    v_rcp_f32 v127, v127
    v_mul_f32 v16, v16, v112
    v_mul_f32 v17, v17, v113
    v_mul_f32 v18, v18, v114
    v_mul_f32 v19, v19, v115
    v_mul_f32 v20, v20, v116
    v_mul_f32 v21, v21, v117
    v_mul_f32 v22, v22, v118
    v_mul_f32 v23, v23, v119
    v_mul_f32 v24, v24, v120
    v_mul_f32 v25, v25, v121
    v_mul_f32 v26, v26, v122
    v_mul_f32 v27, v27, v123
    v_mul_f32 v28, v28, v124
    v_mul_f32 v29, v29, v125
    v_mul_f32 v30, v30, v126
    v_mul_f32 v31, v31, v127
    v_cvt_pk_bf16_f32 v16, 0, v16
    v_cvt_pk_bf16_f32 v17, 0, v17
    v_cvt_pk_bf16_f32 v18, 0, v18
    v_cvt_pk_bf16_f32 v19, 0, v19
    v_cvt_pk_bf16_f32 v20, 0, v20
    v_cvt_pk_bf16_f32 v21, 0, v21
    v_cvt_pk_bf16_f32 v22, 0, v22
    v_cvt_pk_bf16_f32 v23, 0, v23
    v_cvt_pk_bf16_f32 v24, 0, v24
    v_cvt_pk_bf16_f32 v25, 0, v25
    v_cvt_pk_bf16_f32 v26, 0, v26
    v_cvt_pk_bf16_f32 v27, 0, v27
    v_cvt_pk_bf16_f32 v28, 0, v28
    v_cvt_pk_bf16_f32 v29, 0, v29
    v_cvt_pk_bf16_f32 v30, 0, v30
    v_cvt_pk_bf16_f32 v31, 0, v31
    s_lshl_b32 s53, s55, 9
    s_add_u32 s53, s53, 4096
L_m_loop_24:
    s_add_u32 s46, s53, 0
    buffer_load_dwordx4 v[32:35], v4, s[28:31], s46 offen nt
    s_add_u32 s46, s53, 12288
    buffer_load_dwordx4 v[36:39], v4, s[28:31], s46 offen nt
    s_add_u32 s46, s53, 24576
    buffer_load_dwordx4 v[40:43], v4, s[28:31], s46 offen nt
    s_add_u32 s46, s53, 36864
    buffer_load_dwordx4 v[44:47], v4, s[28:31], s46 offen nt
    s_add_u32 s46, s53, 49152
    buffer_load_dwordx4 v[48:51], v4, s[28:31], s46 offen nt
    s_add_u32 s46, s53, 61440
    buffer_load_dwordx4 v[52:55], v4, s[28:31], s46 offen nt
    s_add_u32 s46, s53, 73728
    buffer_load_dwordx4 v[56:59], v4, s[28:31], s46 offen nt
    s_add_u32 s46, s53, 86016
    buffer_load_dwordx4 v[60:63], v4, s[28:31], s46 offen nt
    s_add_u32 s46, s53, 98304
    buffer_load_dwordx4 v[64:67], v4, s[28:31], s46 offen nt
    s_add_u32 s46, s53, 110592
    buffer_load_dwordx4 v[68:71], v4, s[28:31], s46 offen nt
    s_add_u32 s46, s53, 122880
    buffer_load_dwordx4 v[72:75], v4, s[28:31], s46 offen nt
    s_add_u32 s46, s53, 135168
    buffer_load_dwordx4 v[76:79], v4, s[28:31], s46 offen nt
    s_add_u32 s46, s53, 147456
    buffer_load_dwordx4 v[80:83], v4, s[28:31], s46 offen nt
    s_add_u32 s46, s53, 159744
    buffer_load_dwordx4 v[84:87], v4, s[28:31], s46 offen nt
    s_add_u32 s46, s53, 172032
    buffer_load_dwordx4 v[88:91], v4, s[28:31], s46 offen nt
    s_add_u32 s46, s53, 184320
    buffer_load_dwordx4 v[92:95], v4, s[28:31], s46 offen nt
    s_waitcnt vmcnt(15)
    v_lshlrev_b32 v104, 16, v32
    v_and_b32 v105, 0xffff0000, v32
    v_mul_f32 v96, v104, v16
    v_mul_f32 v97, v105, v16
    v_lshlrev_b32 v104, 16, v33
    v_and_b32 v105, 0xffff0000, v33
    v_mul_f32 v98, v104, v16
    v_mul_f32 v99, v105, v16
    v_lshlrev_b32 v104, 16, v34
    v_and_b32 v105, 0xffff0000, v34
    v_mul_f32 v100, v104, v16
    v_mul_f32 v101, v105, v16
    v_lshlrev_b32 v104, 16, v35
    v_and_b32 v105, 0xffff0000, v35
    v_mul_f32 v102, v104, v16
    v_mul_f32 v103, v105, v16
    s_waitcnt vmcnt(14)
    v_lshlrev_b32 v104, 16, v36
    v_and_b32 v105, 0xffff0000, v36
    v_fmac_f32 v96, v104, v17
    v_fmac_f32 v97, v105, v17
    v_lshlrev_b32 v104, 16, v37
    v_and_b32 v105, 0xffff0000, v37
    v_fmac_f32 v98, v104, v17
    v_fmac_f32 v99, v105, v17
    v_lshlrev_b32 v104, 16, v38
    v_and_b32 v105, 0xffff0000, v38
    v_fmac_f32 v100, v104, v17
    v_fmac_f32 v101, v105, v17
    v_lshlrev_b32 v104, 16, v39
    v_and_b32 v105, 0xffff0000, v39
    v_fmac_f32 v102, v104, v17
    v_fmac_f32 v103, v105, v17
    s_waitcnt vmcnt(13)
    v_lshlrev_b32 v104, 16, v40
    v_and_b32 v105, 0xffff0000, v40
    v_fmac_f32 v96, v104, v18
    v_fmac_f32 v97, v105, v18
    v_lshlrev_b32 v104, 16, v41
    v_and_b32 v105, 0xffff0000, v41
    v_fmac_f32 v98, v104, v18
    v_fmac_f32 v99, v105, v18
    v_lshlrev_b32 v104, 16, v42
    v_and_b32 v105, 0xffff0000, v42
    v_fmac_f32 v100, v104, v18
    v_fmac_f32 v101, v105, v18
    v_lshlrev_b32 v104, 16, v43
    v_and_b32 v105, 0xffff0000, v43
    v_fmac_f32 v102, v104, v18
    v_fmac_f32 v103, v105, v18
    s_waitcnt vmcnt(12)
    v_lshlrev_b32 v104, 16, v44
    v_and_b32 v105, 0xffff0000, v44
    v_fmac_f32 v96, v104, v19
    v_fmac_f32 v97, v105, v19
    v_lshlrev_b32 v104, 16, v45
    v_and_b32 v105, 0xffff0000, v45
    v_fmac_f32 v98, v104, v19
    v_fmac_f32 v99, v105, v19
    v_lshlrev_b32 v104, 16, v46
    v_and_b32 v105, 0xffff0000, v46
    v_fmac_f32 v100, v104, v19
    v_fmac_f32 v101, v105, v19
    v_lshlrev_b32 v104, 16, v47
    v_and_b32 v105, 0xffff0000, v47
    v_fmac_f32 v102, v104, v19
    v_fmac_f32 v103, v105, v19
    s_waitcnt vmcnt(11)
    v_lshlrev_b32 v104, 16, v48
    v_and_b32 v105, 0xffff0000, v48
    v_fmac_f32 v96, v104, v20
    v_fmac_f32 v97, v105, v20
    v_lshlrev_b32 v104, 16, v49
    v_and_b32 v105, 0xffff0000, v49
    v_fmac_f32 v98, v104, v20
    v_fmac_f32 v99, v105, v20
    v_lshlrev_b32 v104, 16, v50
    v_and_b32 v105, 0xffff0000, v50
    v_fmac_f32 v100, v104, v20
    v_fmac_f32 v101, v105, v20
    v_lshlrev_b32 v104, 16, v51
    v_and_b32 v105, 0xffff0000, v51
    v_fmac_f32 v102, v104, v20
    v_fmac_f32 v103, v105, v20
    s_waitcnt vmcnt(10)
    v_lshlrev_b32 v104, 16, v52
    v_and_b32 v105, 0xffff0000, v52
    v_fmac_f32 v96, v104, v21
    v_fmac_f32 v97, v105, v21
    v_lshlrev_b32 v104, 16, v53
    v_and_b32 v105, 0xffff0000, v53
    v_fmac_f32 v98, v104, v21
    v_fmac_f32 v99, v105, v21
    v_lshlrev_b32 v104, 16, v54
    v_and_b32 v105, 0xffff0000, v54
    v_fmac_f32 v100, v104, v21
    v_fmac_f32 v101, v105, v21
    v_lshlrev_b32 v104, 16, v55
    v_and_b32 v105, 0xffff0000, v55
    v_fmac_f32 v102, v104, v21
    v_fmac_f32 v103, v105, v21
    s_waitcnt vmcnt(9)
    v_lshlrev_b32 v104, 16, v56
    v_and_b32 v105, 0xffff0000, v56
    v_fmac_f32 v96, v104, v22
    v_fmac_f32 v97, v105, v22
    v_lshlrev_b32 v104, 16, v57
    v_and_b32 v105, 0xffff0000, v57
    v_fmac_f32 v98, v104, v22
    v_fmac_f32 v99, v105, v22
    v_lshlrev_b32 v104, 16, v58
    v_and_b32 v105, 0xffff0000, v58
    v_fmac_f32 v100, v104, v22
    v_fmac_f32 v101, v105, v22
    v_lshlrev_b32 v104, 16, v59
    v_and_b32 v105, 0xffff0000, v59
    v_fmac_f32 v102, v104, v22
    v_fmac_f32 v103, v105, v22
    s_waitcnt vmcnt(8)
    v_lshlrev_b32 v104, 16, v60
    v_and_b32 v105, 0xffff0000, v60
    v_fmac_f32 v96, v104, v23
    v_fmac_f32 v97, v105, v23
    v_lshlrev_b32 v104, 16, v61
    v_and_b32 v105, 0xffff0000, v61
    v_fmac_f32 v98, v104, v23
    v_fmac_f32 v99, v105, v23
    v_lshlrev_b32 v104, 16, v62
    v_and_b32 v105, 0xffff0000, v62
    v_fmac_f32 v100, v104, v23
    v_fmac_f32 v101, v105, v23
    v_lshlrev_b32 v104, 16, v63
    v_and_b32 v105, 0xffff0000, v63
    v_fmac_f32 v102, v104, v23
    v_fmac_f32 v103, v105, v23
    s_waitcnt vmcnt(7)
    v_lshlrev_b32 v104, 16, v64
    v_and_b32 v105, 0xffff0000, v64
    v_fmac_f32 v96, v104, v24
    v_fmac_f32 v97, v105, v24
    v_lshlrev_b32 v104, 16, v65
    v_and_b32 v105, 0xffff0000, v65
    v_fmac_f32 v98, v104, v24
    v_fmac_f32 v99, v105, v24
    v_lshlrev_b32 v104, 16, v66
    v_and_b32 v105, 0xffff0000, v66
    v_fmac_f32 v100, v104, v24
    v_fmac_f32 v101, v105, v24
    v_lshlrev_b32 v104, 16, v67
    v_and_b32 v105, 0xffff0000, v67
    v_fmac_f32 v102, v104, v24
    v_fmac_f32 v103, v105, v24
    s_waitcnt vmcnt(6)
    v_lshlrev_b32 v104, 16, v68
    v_and_b32 v105, 0xffff0000, v68
    v_fmac_f32 v96, v104, v25
    v_fmac_f32 v97, v105, v25
    v_lshlrev_b32 v104, 16, v69
    v_and_b32 v105, 0xffff0000, v69
    v_fmac_f32 v98, v104, v25
    v_fmac_f32 v99, v105, v25
    v_lshlrev_b32 v104, 16, v70
    v_and_b32 v105, 0xffff0000, v70
    v_fmac_f32 v100, v104, v25
    v_fmac_f32 v101, v105, v25
    v_lshlrev_b32 v104, 16, v71
    v_and_b32 v105, 0xffff0000, v71
    v_fmac_f32 v102, v104, v25
    v_fmac_f32 v103, v105, v25
    s_waitcnt vmcnt(5)
    v_lshlrev_b32 v104, 16, v72
    v_and_b32 v105, 0xffff0000, v72
    v_fmac_f32 v96, v104, v26
    v_fmac_f32 v97, v105, v26
    v_lshlrev_b32 v104, 16, v73
    v_and_b32 v105, 0xffff0000, v73
    v_fmac_f32 v98, v104, v26
    v_fmac_f32 v99, v105, v26
    v_lshlrev_b32 v104, 16, v74
    v_and_b32 v105, 0xffff0000, v74
    v_fmac_f32 v100, v104, v26
    v_fmac_f32 v101, v105, v26
    v_lshlrev_b32 v104, 16, v75
    v_and_b32 v105, 0xffff0000, v75
    v_fmac_f32 v102, v104, v26
    v_fmac_f32 v103, v105, v26
    s_waitcnt vmcnt(4)
    v_lshlrev_b32 v104, 16, v76
    v_and_b32 v105, 0xffff0000, v76
    v_fmac_f32 v96, v104, v27
    v_fmac_f32 v97, v105, v27
    v_lshlrev_b32 v104, 16, v77
    v_and_b32 v105, 0xffff0000, v77
    v_fmac_f32 v98, v104, v27
    v_fmac_f32 v99, v105, v27
    v_lshlrev_b32 v104, 16, v78
    v_and_b32 v105, 0xffff0000, v78
    v_fmac_f32 v100, v104, v27
    v_fmac_f32 v101, v105, v27
    v_lshlrev_b32 v104, 16, v79
    v_and_b32 v105, 0xffff0000, v79
    v_fmac_f32 v102, v104, v27
    v_fmac_f32 v103, v105, v27
    s_waitcnt vmcnt(3)
    v_lshlrev_b32 v104, 16, v80
    v_and_b32 v105, 0xffff0000, v80
    v_fmac_f32 v96, v104, v28
    v_fmac_f32 v97, v105, v28
    v_lshlrev_b32 v104, 16, v81
    v_and_b32 v105, 0xffff0000, v81
    v_fmac_f32 v98, v104, v28
    v_fmac_f32 v99, v105, v28
    v_lshlrev_b32 v104, 16, v82
    v_and_b32 v105, 0xffff0000, v82
    v_fmac_f32 v100, v104, v28
    v_fmac_f32 v101, v105, v28
    v_lshlrev_b32 v104, 16, v83
    v_and_b32 v105, 0xffff0000, v83
    v_fmac_f32 v102, v104, v28
    v_fmac_f32 v103, v105, v28
    s_waitcnt vmcnt(2)
    v_lshlrev_b32 v104, 16, v84
    v_and_b32 v105, 0xffff0000, v84
    v_fmac_f32 v96, v104, v29
    v_fmac_f32 v97, v105, v29
    v_lshlrev_b32 v104, 16, v85
    v_and_b32 v105, 0xffff0000, v85
    v_fmac_f32 v98, v104, v29
    v_fmac_f32 v99, v105, v29
    v_lshlrev_b32 v104, 16, v86
    v_and_b32 v105, 0xffff0000, v86
    v_fmac_f32 v100, v104, v29
    v_fmac_f32 v101, v105, v29
    v_lshlrev_b32 v104, 16, v87
    v_and_b32 v105, 0xffff0000, v87
    v_fmac_f32 v102, v104, v29
    v_fmac_f32 v103, v105, v29
    s_waitcnt vmcnt(1)
    v_lshlrev_b32 v104, 16, v88
    v_and_b32 v105, 0xffff0000, v88
    v_fmac_f32 v96, v104, v30
    v_fmac_f32 v97, v105, v30
    v_lshlrev_b32 v104, 16, v89
    v_and_b32 v105, 0xffff0000, v89
    v_fmac_f32 v98, v104, v30
    v_fmac_f32 v99, v105, v30
    v_lshlrev_b32 v104, 16, v90
    v_and_b32 v105, 0xffff0000, v90
    v_fmac_f32 v100, v104, v30
    v_fmac_f32 v101, v105, v30
    v_lshlrev_b32 v104, 16, v91
    v_and_b32 v105, 0xffff0000, v91
    v_fmac_f32 v102, v104, v30
    v_fmac_f32 v103, v105, v30
    s_waitcnt vmcnt(0)
    v_lshlrev_b32 v104, 16, v92
    v_and_b32 v105, 0xffff0000, v92
    v_fmac_f32 v96, v104, v31
    v_fmac_f32 v97, v105, v31
    v_lshlrev_b32 v104, 16, v93
    v_and_b32 v105, 0xffff0000, v93
    v_fmac_f32 v98, v104, v31
    v_fmac_f32 v99, v105, v31
    v_lshlrev_b32 v104, 16, v94
    v_and_b32 v105, 0xffff0000, v94
    v_fmac_f32 v100, v104, v31
    v_fmac_f32 v101, v105, v31
    v_lshlrev_b32 v104, 16, v95
    v_and_b32 v105, 0xffff0000, v95
    v_fmac_f32 v102, v104, v31
    v_fmac_f32 v103, v105, v31
    v_lshlrev_b32 v104, 5, v0
    ds_write_b128 v104, v[96:99]
    ds_write_b128 v104, v[100:103] offset:16
    v_lshlrev_b32 v105, 2, v1
    s_lshl_b32 s46, s44, 11
    v_add_u32 v104, s46, v105
    s_waitcnt lgkmcnt(0)
    ds_read_b32 v96, v104 offset:0
    ds_read_b32 v97, v104 offset:256
    ds_read_b32 v98, v104 offset:512
    ds_read_b32 v99, v104 offset:768
    ds_read_b32 v100, v104 offset:1024
    ds_read_b32 v101, v104 offset:1280
    ds_read_b32 v102, v104 offset:1536
    ds_read_b32 v103, v104 offset:1792
    s_waitcnt lgkmcnt(0)
    v_add_f32 v96, v96, v100
    v_add_f32 v97, v97, v101
    v_add_f32 v98, v98, v102
    v_add_f32 v99, v99, v103
    v_add_f32 v96, v96, v98
    v_add_f32 v97, v97, v99
    v_add_f32 v96, v96, v97
    v_lshlrev_b32 v104, 2, v0
    ds_write_b32 v104, v96 offset:16384
    s_waitcnt lgkmcnt(0)
    s_barrier
    s_cmp_lg_u32 s44, 0
    s_cbranch_scc1 L_m_sk_25
    ds_read_b32 v96, v105 offset:16384
    ds_read_b32 v97, v105 offset:16640
    ds_read_b32 v98, v105 offset:16896
    ds_read_b32 v99, v105 offset:17152
    ds_read_b32 v100, v105 offset:17408
    ds_read_b32 v101, v105 offset:17664
    ds_read_b32 v102, v105 offset:17920
    ds_read_b32 v103, v105 offset:18176
    s_waitcnt lgkmcnt(0)
    v_add_f32 v96, v96, v100
    v_add_f32 v97, v97, v101
    v_add_f32 v98, v98, v102
    v_add_f32 v99, v99, v103
    v_add_f32 v96, v96, v98
    v_add_f32 v97, v97, v99
    v_add_f32 v96, v96, v97
    v_cvt_pk_bf16_f32 v96, 0, v96
    s_lshl_b32 s46, s53, 1
    buffer_store_dword v96, v105, s[12:15], s46 offen sc1
L_m_sk_25:
    s_barrier
    s_add_u32 s53, s53, 128
    s_and_b32 s46, s53, 511
    s_cmp_lg_u32 s46, 0
    s_cbranch_scc1 L_m_loop_24
    s_lshl_b32 s54, s55, 7
    s_add_u32 s54, s54, 0x10e400
    s_mov_b32 s60, 0
    s_waitcnt vmcnt(0)
    s_cmp_lg_u32 s44, 0
    s_cbranch_scc1 L_sf_26
    v_mov_b32 v8, s60
    v_add_u32 v8, 1, v8
    v_mov_b32 v9, 0
    s_mov_b64 exec, 1
    buffer_store_dword v8, v9, s[12:15], s54 offen sc1
    s_mov_b64 exec, -1
L_sf_26:
    s_barrier
L_w_h_17_s:
    s_mov_b32 s77, s48
    s_cmp_eq_u32 s48, 14
    s_cselect_b32 s53, 2, 1
    s_sub_u32 s48, s48, 12
    s_min_u32 s48, s48, 2
    s_mov_b32 s79, 0
L_w_h_17_n:
    s_cmp_eq_u32 s53, 1
    s_cselect_b32 s74, 41, 54
    s_cselect_b32 s75, 58, 64
    s_mov_b32 s76, 65536
    s_branch L_w_g_10_e
L_w_h_17:
    s_mov_b32 s48, s77
    s_cmp_lt_u32 s48, 14
    s_cbranch_scc1 L_w_att_15
    s_and_b32 s42, s40, 3
    s_lshr_b32 s43, s40, 2
    s_cmp_eq_u32 s48, 14
    s_cbranch_scc1 L_w_c_16
    s_mov_b32 s75, 58
    s_mov_b32 s76, 0
    s_mov_b32 s78, 2
L_w_h_17_f:
    s_load_dwordx2 s[4:5], s[0:1], 112
    s_load_dwordx2 s[6:7], s[0:1], 88
    v_lshlrev_b32 v2, 4, v1
    v_lshlrev_b32 v3, 5, v1
    s_waitcnt lgkmcnt(0)
    s_mov_b32 s24, s4
    s_and_b32 s25, s5, 0xffff
    s_mov_b32 s26, 0x400000
    s_mov_b32 s27, 0x00020000
    s_mov_b32 s28, s6
    s_and_b32 s29, s7, 0xffff
    s_mov_b32 s30, 0x800
    s_mov_b32 s31, 0x00020000
    s_cmp_lg_u32 s44, 0
    s_cbranch_scc1 L_mw_27
    v_and_b32 v8, 15, v1
    v_lshlrev_b32 v8, 7, v8
    s_mov_b32 s46, 0x10e400
    s_mov_b32 s47, 0
    s_mov_b32 s70, 0
L_spin_28:
    buffer_load_dword v9, v8, s[12:15], s46 offen sc1
    s_waitcnt vmcnt(0)
    v_cmp_ge_u32 vcc, s47, v9
    s_add_u32 s70, s70, 1
    s_cbranch_vccz L_spok_29
    s_sleep 2
    s_cmp_lt_u32 s70, 524288
    s_cbranch_scc1 L_spin_28
    s_branch L_c_done_1
L_spok_29:
L_mw_27:
    s_barrier
    s_mov_b32 s46, 20480
    buffer_load_dwordx4 v[16:19], v3, s[12:15], s46 offen offset:0 sc1
    buffer_load_dwordx4 v[20:23], v3, s[12:15], s46 offen offset:16 sc1
    buffer_load_dwordx4 v[24:27], v3, s[12:15], s46 offen offset:2048 sc1
    buffer_load_dwordx4 v[28:31], v3, s[12:15], s46 offen offset:2064 sc1
    buffer_load_dwordx4 v[48:51], v2, s[28:31], 0 offen
    buffer_load_dwordx4 v[52:55], v2, s[28:31], 0 offen offset:1024
    s_waitcnt vmcnt(0)
    v_lshlrev_b32 v32, 16, v48
    v_and_b32 v33, 0xffff0000, v48
    v_lshlrev_b32 v34, 16, v49
    v_and_b32 v35, 0xffff0000, v49
    v_lshlrev_b32 v36, 16, v50
    v_and_b32 v37, 0xffff0000, v50
    v_lshlrev_b32 v38, 16, v51
    v_and_b32 v39, 0xffff0000, v51
    v_lshlrev_b32 v40, 16, v52
    v_and_b32 v41, 0xffff0000, v52
    v_lshlrev_b32 v42, 16, v53
    v_and_b32 v43, 0xffff0000, v53
    v_lshlrev_b32 v44, 16, v54
    v_and_b32 v45, 0xffff0000, v54
    v_lshlrev_b32 v46, 16, v55
    v_and_b32 v47, 0xffff0000, v55
    s_lshl_b32 s46, s42, 14
    s_lshl_b32 s47, s44, 11
    s_add_u32 s46, s46, s47
    s_add_u32 s46, s46, 0xb000000
    v_add_u32 v4, s46, v2
    v_and_b32 v5, 31, v1
    v_lshlrev_b32 v5, 7, v5
    v_add_u32 v5, 0x108400, v5
    v_lshlrev_b32 v6, 2, v1
    s_lshl_b32 s46, s44, 9
    v_add_u32 v6, s46, v6
    s_lshl_b32 s46, s44, 12
    v_add_u32 v7, s46, v3
    s_lshl_b32 s46, s42, 3
    s_add_u32 s46, s46, s44
    s_lshl_b32 s46, s46, 11
    v_add_u32 v8, s46, v2
    v_add_u32 v9, 0x800000, v8
    s_mov_b32 s60, s43
L_r_loop_30:
    s_lshl_b32 s61, s60, 18
    s_lshl_b32 s63, s60, 16
    s_cmp_lg_u32 s44, 0
    s_cbranch_scc1 L_r_nsp_31
    s_mov_b32 s70, 0
L_spin_32:
    buffer_load_dword v14, v5, s[12:15], s76 offen sc1
    s_waitcnt vmcnt(0)
    v_cmp_ge_u32 vcc, s60, v14
    s_add_u32 s70, s70, 1
    s_cbranch_vccz L_spok_33
    s_sleep 3
    s_cmp_lt_u32 s70, 524288
    s_cbranch_scc1 L_spin_32
    s_branch L_c_done_1
L_spok_33:
L_r_nsp_31:
    s_barrier
    buffer_load_dwordx4 v[96:99], v4, s[12:15], s61 offen offset:0 sc1
    buffer_load_dwordx4 v[100:103], v4, s[12:15], s61 offen offset:1024 sc1
    s_add_u32 s61, s61, 65536
    buffer_load_dwordx4 v[104:107], v4, s[12:15], s61 offen offset:0 sc1
    buffer_load_dwordx4 v[108:111], v4, s[12:15], s61 offen offset:1024 sc1
    s_add_u32 s61, s61, 65536
    buffer_load_dwordx4 v[112:115], v4, s[12:15], s61 offen offset:0 sc1
    buffer_load_dwordx4 v[116:119], v4, s[12:15], s61 offen offset:1024 sc1
    s_add_u32 s61, s61, 65536
    buffer_load_dwordx4 v[120:123], v4, s[12:15], s61 offen offset:0 sc1
    buffer_load_dwordx4 v[124:127], v4, s[12:15], s61 offen offset:1024 sc1
    buffer_load_dwordx4 a[0:3], v9, s[12:15], s63 offen sc1
    buffer_load_dwordx4 a[4:7], v9, s[12:15], s63 offen offset:1024 sc1
    s_waitcnt vmcnt(8)
    v_lshlrev_b32 v64, 16, v96
    v_and_b32 v65, 0xffff0000, v96
    v_lshlrev_b32 v66, 16, v97
    v_and_b32 v67, 0xffff0000, v97
    v_lshlrev_b32 v68, 16, v98
    v_and_b32 v69, 0xffff0000, v98
    v_lshlrev_b32 v70, 16, v99
    v_and_b32 v71, 0xffff0000, v99
    v_lshlrev_b32 v72, 16, v100
    v_and_b32 v73, 0xffff0000, v100
    v_lshlrev_b32 v74, 16, v101
    v_and_b32 v75, 0xffff0000, v101
    v_lshlrev_b32 v76, 16, v102
    v_and_b32 v77, 0xffff0000, v102
    v_lshlrev_b32 v78, 16, v103
    v_and_b32 v79, 0xffff0000, v103
    s_waitcnt vmcnt(6)
    v_lshlrev_b32 v14, 16, v104
    v_and_b32 v15, 0xffff0000, v104
    v_pk_add_f32 v[64:65], v[64:65], v[14:15]
    v_lshlrev_b32 v14, 16, v105
    v_and_b32 v15, 0xffff0000, v105
    v_pk_add_f32 v[66:67], v[66:67], v[14:15]
    v_lshlrev_b32 v14, 16, v106
    v_and_b32 v15, 0xffff0000, v106
    v_pk_add_f32 v[68:69], v[68:69], v[14:15]
    v_lshlrev_b32 v14, 16, v107
    v_and_b32 v15, 0xffff0000, v107
    v_pk_add_f32 v[70:71], v[70:71], v[14:15]
    v_lshlrev_b32 v14, 16, v108
    v_and_b32 v15, 0xffff0000, v108
    v_pk_add_f32 v[72:73], v[72:73], v[14:15]
    v_lshlrev_b32 v14, 16, v109
    v_and_b32 v15, 0xffff0000, v109
    v_pk_add_f32 v[74:75], v[74:75], v[14:15]
    v_lshlrev_b32 v14, 16, v110
    v_and_b32 v15, 0xffff0000, v110
    v_pk_add_f32 v[76:77], v[76:77], v[14:15]
    v_lshlrev_b32 v14, 16, v111
    v_and_b32 v15, 0xffff0000, v111
    v_pk_add_f32 v[78:79], v[78:79], v[14:15]
    s_waitcnt vmcnt(4)
    v_lshlrev_b32 v14, 16, v112
    v_and_b32 v15, 0xffff0000, v112
    v_pk_add_f32 v[64:65], v[64:65], v[14:15]
    v_lshlrev_b32 v14, 16, v113
    v_and_b32 v15, 0xffff0000, v113
    v_pk_add_f32 v[66:67], v[66:67], v[14:15]
    v_lshlrev_b32 v14, 16, v114
    v_and_b32 v15, 0xffff0000, v114
    v_pk_add_f32 v[68:69], v[68:69], v[14:15]
    v_lshlrev_b32 v14, 16, v115
    v_and_b32 v15, 0xffff0000, v115
    v_pk_add_f32 v[70:71], v[70:71], v[14:15]
    v_lshlrev_b32 v14, 16, v116
    v_and_b32 v15, 0xffff0000, v116
    v_pk_add_f32 v[72:73], v[72:73], v[14:15]
    v_lshlrev_b32 v14, 16, v117
    v_and_b32 v15, 0xffff0000, v117
    v_pk_add_f32 v[74:75], v[74:75], v[14:15]
    v_lshlrev_b32 v14, 16, v118
    v_and_b32 v15, 0xffff0000, v118
    v_pk_add_f32 v[76:77], v[76:77], v[14:15]
    v_lshlrev_b32 v14, 16, v119
    v_and_b32 v15, 0xffff0000, v119
    v_pk_add_f32 v[78:79], v[78:79], v[14:15]
    s_waitcnt vmcnt(2)
    v_lshlrev_b32 v14, 16, v120
    v_and_b32 v15, 0xffff0000, v120
    v_pk_add_f32 v[64:65], v[64:65], v[14:15]
    v_lshlrev_b32 v14, 16, v121
    v_and_b32 v15, 0xffff0000, v121
    v_pk_add_f32 v[66:67], v[66:67], v[14:15]
    v_lshlrev_b32 v14, 16, v122
    v_and_b32 v15, 0xffff0000, v122
    v_pk_add_f32 v[68:69], v[68:69], v[14:15]
    v_lshlrev_b32 v14, 16, v123
    v_and_b32 v15, 0xffff0000, v123
    v_pk_add_f32 v[70:71], v[70:71], v[14:15]
    v_lshlrev_b32 v14, 16, v124
    v_and_b32 v15, 0xffff0000, v124
    v_pk_add_f32 v[72:73], v[72:73], v[14:15]
    v_lshlrev_b32 v14, 16, v125
    v_and_b32 v15, 0xffff0000, v125
    v_pk_add_f32 v[74:75], v[74:75], v[14:15]
    v_lshlrev_b32 v14, 16, v126
    v_and_b32 v15, 0xffff0000, v126
    v_pk_add_f32 v[76:77], v[76:77], v[14:15]
    v_lshlrev_b32 v14, 16, v127
    v_and_b32 v15, 0xffff0000, v127
    v_pk_add_f32 v[78:79], v[78:79], v[14:15]
    ds_write_b32 v6, v64 offset:0
    ds_write_b32 v6, v65 offset:4096
    ds_write_b32 v6, v66 offset:8192
    ds_write_b32 v6, v67 offset:12288
    ds_write_b32 v6, v68 offset:16384
    ds_write_b32 v6, v69 offset:20480
    ds_write_b32 v6, v70 offset:24576
    ds_write_b32 v6, v71 offset:28672
    ds_write_b32 v6, v72 offset:256
    ds_write_b32 v6, v73 offset:4352
    ds_write_b32 v6, v74 offset:8448
    ds_write_b32 v6, v75 offset:12544
    ds_write_b32 v6, v76 offset:16640
    ds_write_b32 v6, v77 offset:20736
    ds_write_b32 v6, v78 offset:24832
    ds_write_b32 v6, v79 offset:28928
    s_waitcnt lgkmcnt(0)
    s_barrier
    ds_read_b128 v[64:67], v7
    ds_read_b128 v[68:71], v7 offset:16
    ds_read_b128 v[72:75], v7 offset:2048
    ds_read_b128 v[76:79], v7 offset:2064
    s_waitcnt vmcnt(0)
    v_accvgpr_read_b32 v96, a0
    v_accvgpr_read_b32 v97, a1
    v_accvgpr_read_b32 v98, a2
    v_accvgpr_read_b32 v99, a3
    v_accvgpr_read_b32 v100, a4
    v_accvgpr_read_b32 v101, a5
    v_accvgpr_read_b32 v102, a6
    v_accvgpr_read_b32 v103, a7
    v_lshlrev_b32 v80, 16, v96
    v_and_b32 v81, 0xffff0000, v96
    v_lshlrev_b32 v82, 16, v97
    v_and_b32 v83, 0xffff0000, v97
    v_lshlrev_b32 v84, 16, v98
    v_and_b32 v85, 0xffff0000, v98
    v_lshlrev_b32 v86, 16, v99
    v_and_b32 v87, 0xffff0000, v99
    v_lshlrev_b32 v88, 16, v100
    v_and_b32 v89, 0xffff0000, v100
    v_lshlrev_b32 v90, 16, v101
    v_and_b32 v91, 0xffff0000, v101
    v_lshlrev_b32 v92, 16, v102
    v_and_b32 v93, 0xffff0000, v102
    v_lshlrev_b32 v94, 16, v103
    v_and_b32 v95, 0xffff0000, v103
    s_waitcnt lgkmcnt(0)
    v_cvt_pk_bf16_f32 v64, 0, v64
    v_cvt_pk_bf16_f32 v65, 0, v65
    v_cvt_pk_bf16_f32 v66, 0, v66
    v_cvt_pk_bf16_f32 v67, 0, v67
    v_cvt_pk_bf16_f32 v68, 0, v68
    v_cvt_pk_bf16_f32 v69, 0, v69
    v_cvt_pk_bf16_f32 v70, 0, v70
    v_cvt_pk_bf16_f32 v71, 0, v71
    v_cvt_pk_bf16_f32 v72, 0, v72
    v_cvt_pk_bf16_f32 v73, 0, v73
    v_cvt_pk_bf16_f32 v74, 0, v74
    v_cvt_pk_bf16_f32 v75, 0, v75
    v_cvt_pk_bf16_f32 v76, 0, v76
    v_cvt_pk_bf16_f32 v77, 0, v77
    v_cvt_pk_bf16_f32 v78, 0, v78
    v_cvt_pk_bf16_f32 v79, 0, v79
    v_pk_add_f32 v[64:65], v[64:65], v[32:33]
    v_pk_add_f32 v[66:67], v[66:67], v[34:35]
    v_pk_add_f32 v[68:69], v[68:69], v[36:37]
    v_pk_add_f32 v[70:71], v[70:71], v[38:39]
    v_pk_add_f32 v[72:73], v[72:73], v[40:41]
    v_pk_add_f32 v[74:75], v[74:75], v[42:43]
    v_pk_add_f32 v[76:77], v[76:77], v[44:45]
    v_pk_add_f32 v[78:79], v[78:79], v[46:47]
    v_cvt_pk_bf16_f32 v64, 0, v64
    v_cvt_pk_bf16_f32 v65, 0, v65
    v_cvt_pk_bf16_f32 v66, 0, v66
    v_cvt_pk_bf16_f32 v67, 0, v67
    v_cvt_pk_bf16_f32 v68, 0, v68
    v_cvt_pk_bf16_f32 v69, 0, v69
    v_cvt_pk_bf16_f32 v70, 0, v70
    v_cvt_pk_bf16_f32 v71, 0, v71
    v_cvt_pk_bf16_f32 v72, 0, v72
    v_cvt_pk_bf16_f32 v73, 0, v73
    v_cvt_pk_bf16_f32 v74, 0, v74
    v_cvt_pk_bf16_f32 v75, 0, v75
    v_cvt_pk_bf16_f32 v76, 0, v76
    v_cvt_pk_bf16_f32 v77, 0, v77
    v_cvt_pk_bf16_f32 v78, 0, v78
    v_cvt_pk_bf16_f32 v79, 0, v79
    v_pk_mul_f32 v[64:65], v[64:65], v[16:17]
    v_pk_mul_f32 v[66:67], v[66:67], v[18:19]
    v_pk_mul_f32 v[68:69], v[68:69], v[20:21]
    v_pk_mul_f32 v[70:71], v[70:71], v[22:23]
    v_pk_mul_f32 v[72:73], v[72:73], v[24:25]
    v_pk_mul_f32 v[74:75], v[74:75], v[26:27]
    v_pk_mul_f32 v[76:77], v[76:77], v[28:29]
    v_pk_mul_f32 v[78:79], v[78:79], v[30:31]
    v_cvt_pk_bf16_f32 v64, 0, v64
    v_cvt_pk_bf16_f32 v65, 0, v65
    v_cvt_pk_bf16_f32 v66, 0, v66
    v_cvt_pk_bf16_f32 v67, 0, v67
    v_cvt_pk_bf16_f32 v68, 0, v68
    v_cvt_pk_bf16_f32 v69, 0, v69
    v_cvt_pk_bf16_f32 v70, 0, v70
    v_cvt_pk_bf16_f32 v71, 0, v71
    v_cvt_pk_bf16_f32 v72, 0, v72
    v_cvt_pk_bf16_f32 v73, 0, v73
    v_cvt_pk_bf16_f32 v74, 0, v74
    v_cvt_pk_bf16_f32 v75, 0, v75
    v_cvt_pk_bf16_f32 v76, 0, v76
    v_cvt_pk_bf16_f32 v77, 0, v77
    v_cvt_pk_bf16_f32 v78, 0, v78
    v_cvt_pk_bf16_f32 v79, 0, v79
    v_pk_add_f32 v[64:65], v[64:65], v[80:81]
    v_pk_add_f32 v[66:67], v[66:67], v[82:83]
    v_pk_add_f32 v[68:69], v[68:69], v[84:85]
    v_pk_add_f32 v[70:71], v[70:71], v[86:87]
    v_pk_add_f32 v[72:73], v[72:73], v[88:89]
    v_pk_add_f32 v[74:75], v[74:75], v[90:91]
    v_pk_add_f32 v[76:77], v[76:77], v[92:93]
    v_pk_add_f32 v[78:79], v[78:79], v[94:95]
    v_cvt_pk_bf16_f32 v96, v64, v65
    v_cvt_pk_bf16_f32 v97, v66, v67
    v_cvt_pk_bf16_f32 v98, v68, v69
    v_cvt_pk_bf16_f32 v99, v70, v71
    v_cvt_pk_bf16_f32 v100, v72, v73
    v_cvt_pk_bf16_f32 v101, v74, v75
    v_cvt_pk_bf16_f32 v102, v76, v77
    v_cvt_pk_bf16_f32 v103, v78, v79
    buffer_store_dwordx4 v[96:99], v8, s[24:27], s63 offen
    buffer_store_dwordx4 v[100:103], v8, s[24:27], s63 offen offset:1024
    s_add_u32 s60, s60, s78
    s_cmp_lt_u32 s60, s75
    s_cbranch_scc1 L_r_loop_30
    s_branch L_c_done_1
L_w_c_16:
    s_load_dwordx2 s[4:5], s[0:1], 0
    s_load_dwordx2 s[6:7], s[0:1], 88
    v_lshlrev_b32 v2, 4, v1
    v_lshlrev_b32 v3, 5, v1
    s_waitcnt lgkmcnt(0)
    s_mov_b32 s24, s4
    s_and_b32 s25, s5, 0xffff
    s_mov_b32 s26, 0x400000
    s_mov_b32 s27, 0x00020000
    s_mov_b32 s28, s6
    s_and_b32 s29, s7, 0xffff
    s_mov_b32 s30, 0x800
    s_mov_b32 s31, 0x00020000
    s_cmp_lg_u32 s44, 0
    s_cbranch_scc1 L_mw_34
    v_and_b32 v8, 15, v1
    v_lshlrev_b32 v8, 7, v8
    s_mov_b32 s46, 0x10e400
    s_mov_b32 s47, 0
    s_mov_b32 s70, 0
L_spin_35:
    buffer_load_dword v9, v8, s[12:15], s46 offen sc1
    s_waitcnt vmcnt(0)
    v_cmp_ge_u32 vcc, s47, v9
    s_add_u32 s70, s70, 1
    s_cbranch_vccz L_spok_36
    s_sleep 2
    s_cmp_lt_u32 s70, 524288
    s_cbranch_scc1 L_spin_35
    s_branch L_c_done_1
L_spok_36:
L_mw_34:
    s_barrier
    s_mov_b32 s46, 8192
    buffer_load_dwordx4 v[16:19], v3, s[12:15], s46 offen offset:0 sc1
    buffer_load_dwordx4 v[20:23], v3, s[12:15], s46 offen offset:16 sc1
    buffer_load_dwordx4 v[24:27], v3, s[12:15], s46 offen offset:2048 sc1
    buffer_load_dwordx4 v[28:31], v3, s[12:15], s46 offen offset:2064 sc1
    s_mov_b32 s46, 16384
    buffer_load_dwordx4 v[32:35], v3, s[12:15], s46 offen offset:0 sc1
    buffer_load_dwordx4 v[36:39], v3, s[12:15], s46 offen offset:16 sc1
    buffer_load_dwordx4 v[40:43], v3, s[12:15], s46 offen offset:2048 sc1
    buffer_load_dwordx4 v[44:47], v3, s[12:15], s46 offen offset:2064 sc1
    s_mov_b32 s46, 12288
    buffer_load_dwordx4 v[48:51], v3, s[12:15], s46 offen offset:0 sc1
    buffer_load_dwordx4 v[52:55], v3, s[12:15], s46 offen offset:16 sc1
    buffer_load_dwordx4 v[56:59], v3, s[12:15], s46 offen offset:2048 sc1
    buffer_load_dwordx4 v[60:63], v3, s[12:15], s46 offen offset:2064 sc1
    s_waitcnt vmcnt(0)
    v_add_f32 v32, 1.0, v32
    v_add_f32 v33, 1.0, v33
    v_add_f32 v34, 1.0, v34
    v_add_f32 v35, 1.0, v35
    v_add_f32 v36, 1.0, v36
    v_add_f32 v37, 1.0, v37
    v_add_f32 v38, 1.0, v38
    v_add_f32 v39, 1.0, v39
    v_add_f32 v40, 1.0, v40
    v_add_f32 v41, 1.0, v41
    v_add_f32 v42, 1.0, v42
    v_add_f32 v43, 1.0, v43
    v_add_f32 v44, 1.0, v44
    v_add_f32 v45, 1.0, v45
    v_add_f32 v46, 1.0, v46
    v_add_f32 v47, 1.0, v47
    v_cvt_pk_bf16_f32 v32, 0, v32
    v_cvt_pk_bf16_f32 v33, 0, v33
    v_cvt_pk_bf16_f32 v34, 0, v34
    v_cvt_pk_bf16_f32 v35, 0, v35
    v_cvt_pk_bf16_f32 v36, 0, v36
    v_cvt_pk_bf16_f32 v37, 0, v37
    v_cvt_pk_bf16_f32 v38, 0, v38
    v_cvt_pk_bf16_f32 v39, 0, v39
    v_cvt_pk_bf16_f32 v40, 0, v40
    v_cvt_pk_bf16_f32 v41, 0, v41
    v_cvt_pk_bf16_f32 v42, 0, v42
    v_cvt_pk_bf16_f32 v43, 0, v43
    v_cvt_pk_bf16_f32 v44, 0, v44
    v_cvt_pk_bf16_f32 v45, 0, v45
    v_cvt_pk_bf16_f32 v46, 0, v46
    v_cvt_pk_bf16_f32 v47, 0, v47
    s_lshl_b32 s46, s42, 14
    s_lshl_b32 s47, s44, 11
    s_add_u32 s46, s46, s47
    s_add_u32 s46, s46, 0x9000000
    v_add_u32 v4, s46, v2
    v_and_b32 v5, 31, v1
    v_lshlrev_b32 v5, 7, v5
    v_add_u32 v5, 0x107400, v5
    v_lshlrev_b32 v6, 2, v1
    s_lshl_b32 s46, s44, 9
    v_add_u32 v6, s46, v6
    s_lshl_b32 s46, s44, 12
    v_add_u32 v7, s46, v3
    s_lshl_b32 s46, s42, 3
    s_add_u32 s46, s46, s44
    s_lshl_b32 s46, s46, 11
    v_add_u32 v8, s46, v2
    v_add_u32 v9, 0x800000, v8
    s_mul_i32 s46, s44, 2064
    s_add_u32 s46, s46, 32768
    v_add_u32 v10, s46, v2
    v_and_b32 v11, 7, v1
    v_lshrrev_b32 v12, 3, v1
    v_mul_u32_u24 v13, 2064, v11
    v_lshl_add_u32 v13, v12, 4, v13
    s_lshl_b32 s46, s44, 8
    s_add_u32 s46, s46, 32768
    v_add_u32 v13, s46, v13
    v_lshlrev_b32 v11, 4, v11
    v_lshl_add_u32 v11, v12, 9, v11
    s_lshl_b32 s46, s44, 13
    s_lshl_b32 s47, s42, 7
    s_add_u32 s46, s46, s47
    s_add_u32 s46, s46, 0xc00000
    v_add_u32 v11, s46, v11
    v_add_u32 v12, 4096, v11
    s_lshl_b32 s52, s43, 9
    s_lshl_b32 s47, s42, 7
    s_add_u32 s52, s52, s47
    s_add_u32 s52, s52, 0x10ec00
    s_mov_b32 s60, s43
L_r_loop_37:
    s_lshl_b32 s61, s60, 18
    s_lshl_b32 s63, s60, 16
    buffer_load_dwordx4 a[0:3], v8, s[24:27], s63 offen
    buffer_load_dwordx4 a[4:7], v8, s[24:27], s63 offen offset:1024
    s_cmp_lg_u32 s44, 0
    s_cbranch_scc1 L_r_nsp_38
    s_mov_b32 s70, 0
L_spin_39:
    buffer_load_dword v14, v5, s[12:15], 0 offen sc1
    s_waitcnt vmcnt(0)
    v_cmp_ge_u32 vcc, s60, v14
    s_add_u32 s70, s70, 1
    s_cbranch_vccz L_spok_40
    s_sleep 3
    s_cmp_lt_u32 s70, 524288
    s_cbranch_scc1 L_spin_39
    s_branch L_c_done_1
L_spok_40:
L_r_nsp_38:
    s_barrier
    buffer_load_dwordx4 v[96:99], v4, s[12:15], s61 offen offset:0 sc1
    buffer_load_dwordx4 v[100:103], v4, s[12:15], s61 offen offset:1024 sc1
    s_add_u32 s61, s61, 65536
    buffer_load_dwordx4 v[104:107], v4, s[12:15], s61 offen offset:0 sc1
    buffer_load_dwordx4 v[108:111], v4, s[12:15], s61 offen offset:1024 sc1
    s_add_u32 s61, s61, 65536
    buffer_load_dwordx4 v[112:115], v4, s[12:15], s61 offen offset:0 sc1
    buffer_load_dwordx4 v[116:119], v4, s[12:15], s61 offen offset:1024 sc1
    s_add_u32 s61, s61, 65536
    buffer_load_dwordx4 v[120:123], v4, s[12:15], s61 offen offset:0 sc1
    buffer_load_dwordx4 v[124:127], v4, s[12:15], s61 offen offset:1024 sc1
    s_waitcnt vmcnt(8)
    v_accvgpr_read_b32 v64, a0
    v_accvgpr_read_b32 v65, a1
    v_accvgpr_read_b32 v66, a2
    v_accvgpr_read_b32 v67, a3
    v_accvgpr_read_b32 v68, a4
    v_accvgpr_read_b32 v69, a5
    v_accvgpr_read_b32 v70, a6
    v_accvgpr_read_b32 v71, a7
    v_lshlrev_b32 v80, 16, v64
    v_and_b32 v81, 0xffff0000, v64
    v_lshlrev_b32 v82, 16, v65
    v_and_b32 v83, 0xffff0000, v65
    v_lshlrev_b32 v84, 16, v66
    v_and_b32 v85, 0xffff0000, v66
    v_lshlrev_b32 v86, 16, v67
    v_and_b32 v87, 0xffff0000, v67
    v_lshlrev_b32 v88, 16, v68
    v_and_b32 v89, 0xffff0000, v68
    v_lshlrev_b32 v90, 16, v69
    v_and_b32 v91, 0xffff0000, v69
    v_lshlrev_b32 v92, 16, v70
    v_and_b32 v93, 0xffff0000, v70
    v_lshlrev_b32 v94, 16, v71
    v_and_b32 v95, 0xffff0000, v71
    s_waitcnt vmcnt(6)
    v_lshlrev_b32 v64, 16, v96
    v_and_b32 v65, 0xffff0000, v96
    v_lshlrev_b32 v66, 16, v97
    v_and_b32 v67, 0xffff0000, v97
    v_lshlrev_b32 v68, 16, v98
    v_and_b32 v69, 0xffff0000, v98
    v_lshlrev_b32 v70, 16, v99
    v_and_b32 v71, 0xffff0000, v99
    v_lshlrev_b32 v72, 16, v100
    v_and_b32 v73, 0xffff0000, v100
    v_lshlrev_b32 v74, 16, v101
    v_and_b32 v75, 0xffff0000, v101
    v_lshlrev_b32 v76, 16, v102
    v_and_b32 v77, 0xffff0000, v102
    v_lshlrev_b32 v78, 16, v103
    v_and_b32 v79, 0xffff0000, v103
    s_waitcnt vmcnt(4)
    v_lshlrev_b32 v14, 16, v104
    v_and_b32 v15, 0xffff0000, v104
    v_pk_add_f32 v[64:65], v[64:65], v[14:15]
    v_lshlrev_b32 v14, 16, v105
    v_and_b32 v15, 0xffff0000, v105
    v_pk_add_f32 v[66:67], v[66:67], v[14:15]
    v_lshlrev_b32 v14, 16, v106
    v_and_b32 v15, 0xffff0000, v106
    v_pk_add_f32 v[68:69], v[68:69], v[14:15]
    v_lshlrev_b32 v14, 16, v107
    v_and_b32 v15, 0xffff0000, v107
    v_pk_add_f32 v[70:71], v[70:71], v[14:15]
    v_lshlrev_b32 v14, 16, v108
    v_and_b32 v15, 0xffff0000, v108
    v_pk_add_f32 v[72:73], v[72:73], v[14:15]
    v_lshlrev_b32 v14, 16, v109
    v_and_b32 v15, 0xffff0000, v109
    v_pk_add_f32 v[74:75], v[74:75], v[14:15]
    v_lshlrev_b32 v14, 16, v110
    v_and_b32 v15, 0xffff0000, v110
    v_pk_add_f32 v[76:77], v[76:77], v[14:15]
    v_lshlrev_b32 v14, 16, v111
    v_and_b32 v15, 0xffff0000, v111
    v_pk_add_f32 v[78:79], v[78:79], v[14:15]
    s_waitcnt vmcnt(2)
    v_lshlrev_b32 v14, 16, v112
    v_and_b32 v15, 0xffff0000, v112
    v_pk_add_f32 v[64:65], v[64:65], v[14:15]
    v_lshlrev_b32 v14, 16, v113
    v_and_b32 v15, 0xffff0000, v113
    v_pk_add_f32 v[66:67], v[66:67], v[14:15]
    v_lshlrev_b32 v14, 16, v114
    v_and_b32 v15, 0xffff0000, v114
    v_pk_add_f32 v[68:69], v[68:69], v[14:15]
    v_lshlrev_b32 v14, 16, v115
    v_and_b32 v15, 0xffff0000, v115
    v_pk_add_f32 v[70:71], v[70:71], v[14:15]
    v_lshlrev_b32 v14, 16, v116
    v_and_b32 v15, 0xffff0000, v116
    v_pk_add_f32 v[72:73], v[72:73], v[14:15]
    v_lshlrev_b32 v14, 16, v117
    v_and_b32 v15, 0xffff0000, v117
    v_pk_add_f32 v[74:75], v[74:75], v[14:15]
    v_lshlrev_b32 v14, 16, v118
    v_and_b32 v15, 0xffff0000, v118
    v_pk_add_f32 v[76:77], v[76:77], v[14:15]
    v_lshlrev_b32 v14, 16, v119
    v_and_b32 v15, 0xffff0000, v119
    v_pk_add_f32 v[78:79], v[78:79], v[14:15]
    s_waitcnt vmcnt(0)
    v_lshlrev_b32 v14, 16, v120
    v_and_b32 v15, 0xffff0000, v120
    v_pk_add_f32 v[64:65], v[64:65], v[14:15]
    v_lshlrev_b32 v14, 16, v121
    v_and_b32 v15, 0xffff0000, v121
    v_pk_add_f32 v[66:67], v[66:67], v[14:15]
    v_lshlrev_b32 v14, 16, v122
    v_and_b32 v15, 0xffff0000, v122
    v_pk_add_f32 v[68:69], v[68:69], v[14:15]
    v_lshlrev_b32 v14, 16, v123
    v_and_b32 v15, 0xffff0000, v123
    v_pk_add_f32 v[70:71], v[70:71], v[14:15]
    v_lshlrev_b32 v14, 16, v124
    v_and_b32 v15, 0xffff0000, v124
    v_pk_add_f32 v[72:73], v[72:73], v[14:15]
    v_lshlrev_b32 v14, 16, v125
    v_and_b32 v15, 0xffff0000, v125
    v_pk_add_f32 v[74:75], v[74:75], v[14:15]
    v_lshlrev_b32 v14, 16, v126
    v_and_b32 v15, 0xffff0000, v126
    v_pk_add_f32 v[76:77], v[76:77], v[14:15]
    v_lshlrev_b32 v14, 16, v127
    v_and_b32 v15, 0xffff0000, v127
    v_pk_add_f32 v[78:79], v[78:79], v[14:15]
    ds_write_b32 v6, v64 offset:0
    ds_write_b32 v6, v65 offset:4096
    ds_write_b32 v6, v66 offset:8192
    ds_write_b32 v6, v67 offset:12288
    ds_write_b32 v6, v68 offset:16384
    ds_write_b32 v6, v69 offset:20480
    ds_write_b32 v6, v70 offset:24576
    ds_write_b32 v6, v71 offset:28672
    ds_write_b32 v6, v72 offset:256
    ds_write_b32 v6, v73 offset:4352
    ds_write_b32 v6, v74 offset:8448
    ds_write_b32 v6, v75 offset:12544
    ds_write_b32 v6, v76 offset:16640
    ds_write_b32 v6, v77 offset:20736
    ds_write_b32 v6, v78 offset:24832
    ds_write_b32 v6, v79 offset:28928
    s_waitcnt lgkmcnt(0)
    s_barrier
    ds_read_b128 v[64:67], v7
    ds_read_b128 v[68:71], v7 offset:16
    ds_read_b128 v[72:75], v7 offset:2048
    ds_read_b128 v[76:79], v7 offset:2064
    s_waitcnt vmcnt(0)
    s_waitcnt lgkmcnt(0)
    v_cvt_pk_bf16_f32 v64, 0, v64
    v_cvt_pk_bf16_f32 v65, 0, v65
    v_cvt_pk_bf16_f32 v66, 0, v66
    v_cvt_pk_bf16_f32 v67, 0, v67
    v_cvt_pk_bf16_f32 v68, 0, v68
    v_cvt_pk_bf16_f32 v69, 0, v69
    v_cvt_pk_bf16_f32 v70, 0, v70
    v_cvt_pk_bf16_f32 v71, 0, v71
    v_cvt_pk_bf16_f32 v72, 0, v72
    v_cvt_pk_bf16_f32 v73, 0, v73
    v_cvt_pk_bf16_f32 v74, 0, v74
    v_cvt_pk_bf16_f32 v75, 0, v75
    v_cvt_pk_bf16_f32 v76, 0, v76
    v_cvt_pk_bf16_f32 v77, 0, v77
    v_cvt_pk_bf16_f32 v78, 0, v78
    v_cvt_pk_bf16_f32 v79, 0, v79
    v_pk_mul_f32 v[64:65], v[64:65], v[16:17]
    v_pk_mul_f32 v[66:67], v[66:67], v[18:19]
    v_pk_mul_f32 v[68:69], v[68:69], v[20:21]
    v_pk_mul_f32 v[70:71], v[70:71], v[22:23]
    v_pk_mul_f32 v[72:73], v[72:73], v[24:25]
    v_pk_mul_f32 v[74:75], v[74:75], v[26:27]
    v_pk_mul_f32 v[76:77], v[76:77], v[28:29]
    v_pk_mul_f32 v[78:79], v[78:79], v[30:31]
    v_cvt_pk_bf16_f32 v64, 0, v64
    v_cvt_pk_bf16_f32 v65, 0, v65
    v_cvt_pk_bf16_f32 v66, 0, v66
    v_cvt_pk_bf16_f32 v67, 0, v67
    v_cvt_pk_bf16_f32 v68, 0, v68
    v_cvt_pk_bf16_f32 v69, 0, v69
    v_cvt_pk_bf16_f32 v70, 0, v70
    v_cvt_pk_bf16_f32 v71, 0, v71
    v_cvt_pk_bf16_f32 v72, 0, v72
    v_cvt_pk_bf16_f32 v73, 0, v73
    v_cvt_pk_bf16_f32 v74, 0, v74
    v_cvt_pk_bf16_f32 v75, 0, v75
    v_cvt_pk_bf16_f32 v76, 0, v76
    v_cvt_pk_bf16_f32 v77, 0, v77
    v_cvt_pk_bf16_f32 v78, 0, v78
    v_cvt_pk_bf16_f32 v79, 0, v79
    v_pk_add_f32 v[64:65], v[64:65], v[80:81]
    v_pk_add_f32 v[66:67], v[66:67], v[82:83]
    v_pk_add_f32 v[68:69], v[68:69], v[84:85]
    v_pk_add_f32 v[70:71], v[70:71], v[86:87]
    v_pk_add_f32 v[72:73], v[72:73], v[88:89]
    v_pk_add_f32 v[74:75], v[74:75], v[90:91]
    v_pk_add_f32 v[76:77], v[76:77], v[92:93]
    v_pk_add_f32 v[78:79], v[78:79], v[94:95]
    v_cvt_pk_bf16_f32 v96, v64, v65
    v_cvt_pk_bf16_f32 v97, v66, v67
    v_cvt_pk_bf16_f32 v98, v68, v69
    v_cvt_pk_bf16_f32 v99, v70, v71
    v_cvt_pk_bf16_f32 v100, v72, v73
    v_cvt_pk_bf16_f32 v101, v74, v75
    v_cvt_pk_bf16_f32 v102, v76, v77
    v_cvt_pk_bf16_f32 v103, v78, v79
    buffer_store_dwordx4 v[96:99], v9, s[12:15], s63 offen sc1
    buffer_store_dwordx4 v[100:103], v9, s[12:15], s63 offen offset:1024 sc1
    v_lshlrev_b32 v64, 16, v96
    v_and_b32 v65, 0xffff0000, v96
    v_lshlrev_b32 v66, 16, v97
    v_and_b32 v67, 0xffff0000, v97
    v_lshlrev_b32 v68, 16, v98
    v_and_b32 v69, 0xffff0000, v98
    v_lshlrev_b32 v70, 16, v99
    v_and_b32 v71, 0xffff0000, v99
    v_lshlrev_b32 v72, 16, v100
    v_and_b32 v73, 0xffff0000, v100
    v_lshlrev_b32 v74, 16, v101
    v_and_b32 v75, 0xffff0000, v101
    v_lshlrev_b32 v76, 16, v102
    v_and_b32 v77, 0xffff0000, v102
    v_lshlrev_b32 v78, 16, v103
    v_and_b32 v79, 0xffff0000, v103
    v_pk_add_f32 v[80:81], v[64:65], v[72:73]
    v_pk_add_f32 v[82:83], v[66:67], v[74:75]
    v_pk_add_f32 v[84:85], v[68:69], v[76:77]
    v_pk_add_f32 v[86:87], v[70:71], v[78:79]
    v_pk_add_f32 v[80:81], v[80:81], v[84:85]
    v_pk_add_f32 v[82:83], v[82:83], v[86:87]
    v_pk_add_f32 v[80:81], v[80:81], v[82:83]
    v_add_f32 v14, v80, v81
    s_nop 1
    v_add_f32_dpp v14, v14, v14 row_shr:1 row_mask:0xf bank_mask:0xf bound_ctrl:0
    s_nop 1
    v_add_f32_dpp v14, v14, v14 row_shr:2 row_mask:0xf bank_mask:0xf bound_ctrl:0
    s_nop 1
    v_add_f32_dpp v14, v14, v14 row_shr:4 row_mask:0xf bank_mask:0xf bound_ctrl:0
    s_nop 1
    v_add_f32_dpp v14, v14, v14 row_shr:8 row_mask:0xf bank_mask:0xf bound_ctrl:0
    s_nop 1
    v_add_f32_dpp v14, v14, v14 row_bcast:15 row_mask:0xa bank_mask:0xf
    s_nop 1
    v_add_f32_dpp v14, v14, v14 row_bcast:31 row_mask:0xc bank_mask:0xf
    s_nop 1
    v_readlane_b32 s46, v14, 63
    s_nop 1
    v_mov_b32 v15, s46
    v_mul_f32 v15, 0x3a800000, v15
    v_pk_add_f32 v[80:81], v[64:65], v[14:15] op_sel:[0,1] op_sel_hi:[1,1] neg_lo:[0,1] neg_hi:[0,1]
    v_pk_add_f32 v[82:83], v[66:67], v[14:15] op_sel:[0,1] op_sel_hi:[1,1] neg_lo:[0,1] neg_hi:[0,1]
    v_pk_add_f32 v[84:85], v[68:69], v[14:15] op_sel:[0,1] op_sel_hi:[1,1] neg_lo:[0,1] neg_hi:[0,1]
    v_pk_add_f32 v[86:87], v[70:71], v[14:15] op_sel:[0,1] op_sel_hi:[1,1] neg_lo:[0,1] neg_hi:[0,1]
    v_pk_add_f32 v[88:89], v[72:73], v[14:15] op_sel:[0,1] op_sel_hi:[1,1] neg_lo:[0,1] neg_hi:[0,1]
    v_pk_add_f32 v[90:91], v[74:75], v[14:15] op_sel:[0,1] op_sel_hi:[1,1] neg_lo:[0,1] neg_hi:[0,1]
    v_pk_add_f32 v[92:93], v[76:77], v[14:15] op_sel:[0,1] op_sel_hi:[1,1] neg_lo:[0,1] neg_hi:[0,1]
    v_pk_add_f32 v[94:95], v[78:79], v[14:15] op_sel:[0,1] op_sel_hi:[1,1] neg_lo:[0,1] neg_hi:[0,1]
    v_pk_mul_f32 v[104:105], v[80:81], v[80:81]
    v_pk_mul_f32 v[106:107], v[82:83], v[82:83]
    v_pk_fma_f32 v[104:105], v[84:85], v[84:85], v[104:105]
    v_pk_fma_f32 v[106:107], v[86:87], v[86:87], v[106:107]
    v_pk_fma_f32 v[104:105], v[88:89], v[88:89], v[104:105]
    v_pk_fma_f32 v[106:107], v[90:91], v[90:91], v[106:107]
    v_pk_fma_f32 v[104:105], v[92:93], v[92:93], v[104:105]
    v_pk_fma_f32 v[106:107], v[94:95], v[94:95], v[106:107]
    v_pk_add_f32 v[104:105], v[104:105], v[106:107]
    v_add_f32 v14, v104, v105
    v_cvt_pk_bf16_f32 v15, 0, v15
    s_nop 1
    v_add_f32_dpp v14, v14, v14 row_shr:1 row_mask:0xf bank_mask:0xf bound_ctrl:0
    s_nop 1
    v_add_f32_dpp v14, v14, v14 row_shr:2 row_mask:0xf bank_mask:0xf bound_ctrl:0
    s_nop 1
    v_add_f32_dpp v14, v14, v14 row_shr:4 row_mask:0xf bank_mask:0xf bound_ctrl:0
    s_nop 1
    v_add_f32_dpp v14, v14, v14 row_shr:8 row_mask:0xf bank_mask:0xf bound_ctrl:0
    s_nop 1
    v_add_f32_dpp v14, v14, v14 row_bcast:15 row_mask:0xa bank_mask:0xf
    s_nop 1
    v_add_f32_dpp v14, v14, v14 row_bcast:31 row_mask:0xc bank_mask:0xf
    s_nop 1
    v_readlane_b32 s47, v14, 63
    v_pk_add_f32 v[64:65], v[64:65], v[14:15] op_sel:[0,1] op_sel_hi:[1,1] neg_lo:[0,1] neg_hi:[0,1]
    v_pk_add_f32 v[66:67], v[66:67], v[14:15] op_sel:[0,1] op_sel_hi:[1,1] neg_lo:[0,1] neg_hi:[0,1]
    v_pk_add_f32 v[68:69], v[68:69], v[14:15] op_sel:[0,1] op_sel_hi:[1,1] neg_lo:[0,1] neg_hi:[0,1]
    v_pk_add_f32 v[70:71], v[70:71], v[14:15] op_sel:[0,1] op_sel_hi:[1,1] neg_lo:[0,1] neg_hi:[0,1]
    v_pk_add_f32 v[72:73], v[72:73], v[14:15] op_sel:[0,1] op_sel_hi:[1,1] neg_lo:[0,1] neg_hi:[0,1]
    v_pk_add_f32 v[74:75], v[74:75], v[14:15] op_sel:[0,1] op_sel_hi:[1,1] neg_lo:[0,1] neg_hi:[0,1]
    v_pk_add_f32 v[76:77], v[76:77], v[14:15] op_sel:[0,1] op_sel_hi:[1,1] neg_lo:[0,1] neg_hi:[0,1]
    v_pk_add_f32 v[78:79], v[78:79], v[14:15] op_sel:[0,1] op_sel_hi:[1,1] neg_lo:[0,1] neg_hi:[0,1]
    v_mov_b32 v14, s47
    v_mul_f32 v14, 0x3a800000, v14
    v_cvt_pk_bf16_f32 v14, 0, v14
    v_add_f32 v14, 0x3727c5ac, v14
    v_cvt_pk_bf16_f32 v14, 0, v14
    v_sqrt_f32 v14, v14
    s_nop 0
    v_cvt_pk_bf16_f32 v14, 0, v14
    v_rcp_f32 v14, v14
    v_cvt_pk_bf16_f32 v64, 0, v64
    v_cvt_pk_bf16_f32 v65, 0, v65
    v_cvt_pk_bf16_f32 v66, 0, v66
    v_cvt_pk_bf16_f32 v67, 0, v67
    v_cvt_pk_bf16_f32 v68, 0, v68
    v_cvt_pk_bf16_f32 v69, 0, v69
    v_cvt_pk_bf16_f32 v70, 0, v70
    v_cvt_pk_bf16_f32 v71, 0, v71
    v_cvt_pk_bf16_f32 v72, 0, v72
    v_cvt_pk_bf16_f32 v73, 0, v73
    v_cvt_pk_bf16_f32 v74, 0, v74
    v_cvt_pk_bf16_f32 v75, 0, v75
    v_cvt_pk_bf16_f32 v76, 0, v76
    v_cvt_pk_bf16_f32 v77, 0, v77
    v_cvt_pk_bf16_f32 v78, 0, v78
    v_cvt_pk_bf16_f32 v79, 0, v79
    v_pk_mul_f32 v[64:65], v[64:65], v[14:15] op_sel_hi:[1,0]
    v_pk_mul_f32 v[66:67], v[66:67], v[14:15] op_sel_hi:[1,0]
    v_pk_mul_f32 v[68:69], v[68:69], v[14:15] op_sel_hi:[1,0]
    v_pk_mul_f32 v[70:71], v[70:71], v[14:15] op_sel_hi:[1,0]
    v_pk_mul_f32 v[72:73], v[72:73], v[14:15] op_sel_hi:[1,0]
    v_pk_mul_f32 v[74:75], v[74:75], v[14:15] op_sel_hi:[1,0]
    v_pk_mul_f32 v[76:77], v[76:77], v[14:15] op_sel_hi:[1,0]
    v_pk_mul_f32 v[78:79], v[78:79], v[14:15] op_sel_hi:[1,0]
    v_cvt_pk_bf16_f32 v64, 0, v64
    v_cvt_pk_bf16_f32 v65, 0, v65
    v_cvt_pk_bf16_f32 v66, 0, v66
    v_cvt_pk_bf16_f32 v67, 0, v67
    v_cvt_pk_bf16_f32 v68, 0, v68
    v_cvt_pk_bf16_f32 v69, 0, v69
    v_cvt_pk_bf16_f32 v70, 0, v70
    v_cvt_pk_bf16_f32 v71, 0, v71
    v_cvt_pk_bf16_f32 v72, 0, v72
    v_cvt_pk_bf16_f32 v73, 0, v73
    v_cvt_pk_bf16_f32 v74, 0, v74
    v_cvt_pk_bf16_f32 v75, 0, v75
    v_cvt_pk_bf16_f32 v76, 0, v76
    v_cvt_pk_bf16_f32 v77, 0, v77
    v_cvt_pk_bf16_f32 v78, 0, v78
    v_cvt_pk_bf16_f32 v79, 0, v79
    v_pk_mul_f32 v[64:65], v[64:65], v[32:33]
    v_pk_mul_f32 v[66:67], v[66:67], v[34:35]
    v_pk_mul_f32 v[68:69], v[68:69], v[36:37]
    v_pk_mul_f32 v[70:71], v[70:71], v[38:39]
    v_pk_mul_f32 v[72:73], v[72:73], v[40:41]
    v_pk_mul_f32 v[74:75], v[74:75], v[42:43]
    v_pk_mul_f32 v[76:77], v[76:77], v[44:45]
    v_pk_mul_f32 v[78:79], v[78:79], v[46:47]
    v_cvt_pk_bf16_f32 v64, 0, v64
    v_cvt_pk_bf16_f32 v65, 0, v65
    v_cvt_pk_bf16_f32 v66, 0, v66
    v_cvt_pk_bf16_f32 v67, 0, v67
    v_cvt_pk_bf16_f32 v68, 0, v68
    v_cvt_pk_bf16_f32 v69, 0, v69
    v_cvt_pk_bf16_f32 v70, 0, v70
    v_cvt_pk_bf16_f32 v71, 0, v71
    v_cvt_pk_bf16_f32 v72, 0, v72
    v_cvt_pk_bf16_f32 v73, 0, v73
    v_cvt_pk_bf16_f32 v74, 0, v74
    v_cvt_pk_bf16_f32 v75, 0, v75
    v_cvt_pk_bf16_f32 v76, 0, v76
    v_cvt_pk_bf16_f32 v77, 0, v77
    v_cvt_pk_bf16_f32 v78, 0, v78
    v_cvt_pk_bf16_f32 v79, 0, v79
    v_pk_add_f32 v[64:65], v[64:65], v[48:49]
    v_pk_add_f32 v[66:67], v[66:67], v[50:51]
    v_pk_add_f32 v[68:69], v[68:69], v[52:53]
    v_pk_add_f32 v[70:71], v[70:71], v[54:55]
    v_pk_add_f32 v[72:73], v[72:73], v[56:57]
    v_pk_add_f32 v[74:75], v[74:75], v[58:59]
    v_pk_add_f32 v[76:77], v[76:77], v[60:61]
    v_pk_add_f32 v[78:79], v[78:79], v[62:63]
    v_cvt_pk_bf16_f32 v104, v64, v65
    v_cvt_pk_bf16_f32 v105, v66, v67
    v_cvt_pk_bf16_f32 v106, v68, v69
    v_cvt_pk_bf16_f32 v107, v70, v71
    v_cvt_pk_bf16_f32 v108, v72, v73
    v_cvt_pk_bf16_f32 v109, v74, v75
    v_cvt_pk_bf16_f32 v110, v76, v77
    v_cvt_pk_bf16_f32 v111, v78, v79
    ds_write_b128 v10, v[104:107]
    ds_write_b128 v10, v[108:111] offset:1024
    s_waitcnt lgkmcnt(0)
    s_barrier
    ds_read_b128 v[104:107], v13
    ds_read_b128 v[108:111], v13 offset:128
    s_waitcnt lgkmcnt(1)
    buffer_store_dwordx4 v[104:107], v11, s[12:15], s63 offen sc1
    s_waitcnt lgkmcnt(0)
    buffer_store_dwordx4 v[108:111], v12, s[12:15], s63 offen sc1
    s_waitcnt vmcnt(0)
    s_barrier
    s_cmp_lg_u32 s44, 0
    s_cbranch_scc1 L_sf_41
    v_mov_b32 v14, s60
    v_add_u32 v14, 1, v14
    v_mov_b32 v15, 0
    s_mov_b64 exec, 1
    buffer_store_dword v14, v15, s[12:15], s52 offen sc1
    s_mov_b64 exec, -1
L_sf_41:
    s_add_u32 s60, s60, 3
    s_cmp_lt_u32 s60, 64
    s_cbranch_scc1 L_r_loop_37
    s_branch L_c_done_1
L_w_att_15:
    s_lshl_b32 s42, s40, 2
    s_and_b32 s46, s44, 3
    s_add_u32 s42, s42, s46
    s_and_b32 s43, s48, 1
    s_lshl_b32 s43, s43, 1
    s_lshr_b32 s46, s44, 2
    s_add_u32 s43, s43, s46
    s_mul_i32 s46, s42, 24576
    s_add_u32 s46, s46, 0x2000000
    v_lshlrev_b32 v2, 4, v1
    v_add_u32 v3, s46, v2
    v_add_u32 v5, 4096, v3
    v_lshrrev_b32 v4, 4, v1
    v_and_b32 v9, 15, v1
    s_lshl_b32 s46, s42, 12
    s_add_u32 s46, s46, 0x1000000
    v_and_b32 v6, 7, v1
    v_lshlrev_b32 v6, 4, v6
    v_lshl_add_u32 v6, v4, 7, v6
    v_add_u32 v6, s46, v6
    v_and_b32 v7, 31, v1
    v_lshlrev_b32 v7, 4, v7
    v_lshrrev_b32 v10, 5, v1
    v_lshl_add_u32 v7, v10, 10, v7
    v_add_u32 v7, s46, v7
    s_mul_i32 s50, s44, 13056
    v_mul_u32_u24 v8, 272, v9
    v_lshl_add_u32 v8, v4, 4, v8
    v_add_u32 v8, s50, v8
    v_bfe_u32 v11, v1, 2, 3
    v_mul_u32_u24 v11, 272, v11
    v_lshl_add_u32 v11, v10, 6, v11
    v_and_b32 v12, 3, v1
    v_lshl_add_u32 v11, v12, 4, v11
    v_add_u32 v11, s50, v11
    v_mul_u32_u24 v14, 272, v4
    v_lshl_add_u32 v14, v9, 4, v14
    v_add_u32 v14, s50, v14
    v_mov_b32 v16, 0
    v_mov_b32 v17, 0
    v_mov_b32 v18, 0
    v_mov_b32 v19, 0
    ds_write_b128 v14, v[16:19] offset:10880
    ds_write_b128 v14, v[16:19] offset:11968
    v_lshlrev_b32 v12, 2, v4
    v_bfe_u32 v13, v1, 2, 2
    v_add_u32 v12, v12, v13
    v_mul_u32_u24 v12, 272, v12
    v_and_b32 v13, 3, v1
    v_lshl_add_u32 v12, v13, 3, v12
    v_add_u32 v12, s50, v12
    v_lshlrev_b32 v13, 10, v13
    s_lshl_b32 s46, s42, 12
    s_add_u32 s46, s46, 0x1000000
    v_add_u32 v13, s46, v13
    v_lshlrev_b32 v10, 9, v4
    v_lshl_add_u32 v10, v9, 4, v10
    s_lshl_b32 s46, s42, 13
    s_add_u32 s46, s46, 0x5000000
    v_add_u32 v10, s46, v10
    s_lshl_b32 s52, s42, 9
    s_lshl_b32 s47, s43, 7
    s_add_u32 s52, s52, s47
    s_add_u32 s52, s52, 0x102000
    v_min_u32 v42, 2, v1
    v_lshlrev_b32 v42, 9, v42
    s_lshl_b32 s46, s40, 11
    s_and_b32 s47, s42, 3
    s_lshl_b32 s47, s47, 7
    s_add_u32 s46, s46, s47
    s_add_u32 s46, s46, 0x10a400
    v_add_u32 v48, s46, v42
    s_mul_i32 s46, s42, 24576
    s_add_u32 s46, s46, 0x2000000
    v_lshlrev_b32 v49, 7, v1
    v_add_u32 v49, s46, v49
    v_cmp_le_u32 s[56:57], 32, v1
    v_lshlrev_b32 v14, 2, v4
    s_mov_b32 s54, 0x3e0293ee
    s_mov_b32 s60, s43
    v_add_u32 v15, 0, v14
    v_cmp_gt_u32 s[84:85], v15, v9
    v_add_u32 v15, 1, v14
    v_cmp_gt_u32 s[86:87], v15, v9
    v_add_u32 v15, 2, v14
    v_cmp_gt_u32 s[88:89], v15, v9
    v_add_u32 v15, 3, v14
    v_cmp_gt_u32 s[90:91], v15, v9
L_a_loop_42:
    s_mul_i32 s45, s60, 786432
    s_add_u32 s48, s45, 8192
    s_add_u32 s49, s45, 16384
    s_lshl_b32 s61, s60, 17
    s_lshl_b32 s63, s60, 18
    s_mov_b32 s70, 0
L_spin_43:
    buffer_load_dword v40, v48, s[12:15], 0 offen sc1
    s_waitcnt vmcnt(0)
    v_cmp_ge_u32 vcc, s60, v40
    s_add_u32 s70, s70, 1
    s_cbranch_vccz L_spok_44
    s_sleep 3
    s_cmp_lt_u32 s70, 524288
    s_cbranch_scc1 L_spin_43
    s_branch L_c_done_1
L_spok_44:
    buffer_load_dwordx4 a[0:3], v3, s[12:15], s45 offen offset:0 sc1
    buffer_load_dwordx4 a[4:7], v3, s[12:15], s45 offen offset:1024 sc1
    buffer_load_dwordx4 a[8:11], v3, s[12:15], s45 offen offset:2048 sc1
    buffer_load_dwordx4 a[12:15], v3, s[12:15], s45 offen offset:3072 sc1
    buffer_load_dwordx4 a[16:19], v5, s[12:15], s45 offen offset:0 sc1
    buffer_load_dwordx4 a[20:23], v5, s[12:15], s45 offen offset:1024 sc1
    buffer_load_dwordx4 a[24:27], v5, s[12:15], s45 offen offset:2048 sc1
    buffer_load_dwordx4 a[28:31], v5, s[12:15], s45 offen offset:3072 sc1
    buffer_load_dwordx4 a[32:35], v3, s[12:15], s48 offen offset:0 sc1
    buffer_load_dwordx4 a[36:39], v3, s[12:15], s48 offen offset:1024 sc1
    buffer_load_dwordx4 a[40:43], v3, s[12:15], s48 offen offset:2048 sc1
    buffer_load_dwordx4 a[44:47], v3, s[12:15], s48 offen offset:3072 sc1
    buffer_load_dwordx4 a[48:51], v5, s[12:15], s48 offen offset:0 sc1
    buffer_load_dwordx4 a[52:55], v5, s[12:15], s48 offen offset:1024 sc1
    buffer_load_dwordx4 a[56:59], v5, s[12:15], s48 offen offset:2048 sc1
    buffer_load_dwordx4 a[60:63], v5, s[12:15], s48 offen offset:3072 sc1
    buffer_load_dwordx4 v[16:19], v3, s[12:15], s49 offen offset:0 sc1
    buffer_load_dwordx4 v[20:23], v3, s[12:15], s49 offen offset:1024 sc1
    buffer_load_dwordx4 v[24:27], v3, s[12:15], s49 offen offset:2048 sc1
    buffer_load_dwordx4 v[28:31], v3, s[12:15], s49 offen offset:3072 sc1
    buffer_load_dwordx4 v[32:35], v5, s[12:15], s49 offen offset:0 sc1
    buffer_load_dwordx4 v[36:39], v5, s[12:15], s49 offen offset:1024 sc1
    buffer_load_dwordx4 v[40:43], v5, s[12:15], s49 offen offset:2048 sc1
    buffer_load_dwordx4 v[44:47], v5, s[12:15], s49 offen offset:3072 sc1
    s_waitcnt vmcnt(0)
    ds_write_b128 v8, v[16:19] offset:0
    ds_write_b128 v8, v[20:23] offset:64
    ds_write_b128 v8, v[24:27] offset:128
    ds_write_b128 v8, v[28:31] offset:192
    ds_write_b128 v8, v[32:35] offset:4352
    ds_write_b128 v8, v[36:39] offset:4416
    ds_write_b128 v8, v[40:43] offset:4480
    ds_write_b128 v8, v[44:47] offset:4544
    v_mfma_f32_16x16x32_bf16 v[56:59], a[32:35], a[0:3], 0
    v_mfma_f32_16x16x32_bf16 v[60:63], a[32:35], a[16:19], 0
    v_mfma_f32_16x16x32_bf16 v[68:71], a[48:51], a[16:19], 0
    v_mfma_f32_16x16x32_bf16 v[56:59], a[36:39], a[4:7], v[56:59]
    v_mfma_f32_16x16x32_bf16 v[60:63], a[36:39], a[20:23], v[60:63]
    v_mfma_f32_16x16x32_bf16 v[68:71], a[52:55], a[20:23], v[68:71]
    v_mfma_f32_16x16x32_bf16 v[56:59], a[40:43], a[8:11], v[56:59]
    v_mfma_f32_16x16x32_bf16 v[60:63], a[40:43], a[24:27], v[60:63]
    v_mfma_f32_16x16x32_bf16 v[68:71], a[56:59], a[24:27], v[68:71]
    v_mfma_f32_16x16x32_bf16 v[56:59], a[44:47], a[12:15], v[56:59]
    v_mfma_f32_16x16x32_bf16 v[60:63], a[44:47], a[28:31], v[60:63]
    v_mfma_f32_16x16x32_bf16 v[68:71], a[60:63], a[28:31], v[68:71]
    s_waitcnt lgkmcnt(0)
    ds_read_b64_tr_b16 a[80:81], v12 offset:0
    ds_read_b64_tr_b16 a[82:83], v12 offset:4352
    ds_read_b64_tr_b16 a[86:87], v12 offset:32
    ds_read_b64_tr_b16 a[88:89], v12 offset:4384
    ds_read_b64_tr_b16 a[92:93], v12 offset:64
    ds_read_b64_tr_b16 a[94:95], v12 offset:4416
    ds_read_b64_tr_b16 a[98:99], v12 offset:96
    ds_read_b64_tr_b16 a[100:101], v12 offset:4448
    s_waitcnt lgkmcnt(0)
    ds_read_b64_tr_b16 a[104:105], v12 offset:128
    ds_read_b64_tr_b16 a[106:107], v12 offset:4480
    ds_read_b64_tr_b16 a[110:111], v12 offset:160
    ds_read_b64_tr_b16 a[112:113], v12 offset:4512
    ds_read_b64_tr_b16 a[116:117], v12 offset:192
    ds_read_b64_tr_b16 a[118:119], v12 offset:4544
    ds_read_b64_tr_b16 a[122:123], v12 offset:224
    ds_read_b64_tr_b16 a[124:125], v12 offset:4576
    v_mov_b32 v15, 0xff800000
    v_cndmask_b32 v56, v56, v15, s[84:85]
    v_cndmask_b32 v68, v68, v15, s[84:85]
    v_cndmask_b32 v57, v57, v15, s[86:87]
    v_cndmask_b32 v69, v69, v15, s[86:87]
    v_cndmask_b32 v58, v58, v15, s[88:89]
    v_cndmask_b32 v70, v70, v15, s[88:89]
    v_cndmask_b32 v59, v59, v15, s[90:91]
    v_cndmask_b32 v71, v71, v15, s[90:91]
    s_mov_b32 s70, 0
L_a_cp_45:
    s_add_u32 s70, s70, 1
    s_cmp_ge_u32 s60, 63
    s_cbranch_scc1 L_a_fl_46
    buffer_load_dword v40, v13, s[12:15], s61 offen sc1
    s_waitcnt vmcnt(0)
    v_cmp_eq_u32 vcc, -1, v40
    s_add_u32 s70, s70, 1
    s_cbranch_vccz L_a_fl_46
L_a_cp_45_s:
    s_sleep 4
    s_cmp_lt_u32 s70, 524288
    s_cbranch_scc1 L_a_cp_45
    s_branch L_c_done_1
L_a_fl_46:
    buffer_load_dwordx4 v[24:27], v6, s[12:15], s61 offen offset:0 sc1
    buffer_load_dwordx4 v[28:31], v6, s[12:15], s61 offen offset:1024 sc1
    buffer_load_dwordx4 v[32:35], v6, s[12:15], s61 offen offset:2048 sc1
    buffer_load_dwordx4 v[36:39], v6, s[12:15], s61 offen offset:3072 sc1
    buffer_load_dwordx4 v[16:19], v7, s[12:15], s61 offen offset:512 sc1
    buffer_load_dwordx4 v[20:23], v7, s[12:15], s61 offen offset:2560 sc1
    s_waitcnt vmcnt(0)
    v_max_u32 v40, v16, v17
    v_max3_u32 v40, v40, v18, v19
    v_max3_u32 v40, v40, v20, v21
    v_max3_u32 v40, v40, v22, v23
    v_max3_u32 v40, v40, v24, v25
    v_max3_u32 v40, v40, v26, v27
    v_max3_u32 v40, v40, v28, v29
    v_max3_u32 v40, v40, v30, v31
    v_max3_u32 v40, v40, v32, v33
    v_max3_u32 v40, v40, v34, v35
    v_max3_u32 v40, v40, v36, v37
    v_max3_u32 v40, v40, v38, v39
    v_cmp_eq_u32 vcc, -1, v40
    s_nop 0
    s_cbranch_vccnz L_a_cp_45_s
    v_mfma_f32_16x16x32_bf16 v[72:75], v[24:27], a[0:3], 0
    v_mfma_f32_16x16x32_bf16 v[76:79], v[24:27], a[16:19], 0
    v_mfma_f32_16x16x32_bf16 v[72:75], v[28:31], a[4:7], v[72:75]
    v_mfma_f32_16x16x32_bf16 v[76:79], v[28:31], a[20:23], v[76:79]
    v_mfma_f32_16x16x32_bf16 v[72:75], v[32:35], a[8:11], v[72:75]
    v_mfma_f32_16x16x32_bf16 v[76:79], v[32:35], a[24:27], v[76:79]
    v_mfma_f32_16x16x32_bf16 v[72:75], v[36:39], a[12:15], v[72:75]
    v_mfma_f32_16x16x32_bf16 v[76:79], v[36:39], a[28:31], v[76:79]
    ds_write_b128 v11, v[16:19] offset:8704
    ds_write_b128 v11, v[20:23] offset:8832
    s_waitcnt lgkmcnt(0)
    ds_read_b64_tr_b16 a[84:85], v12 offset:8704
    ds_read_b64_tr_b16 a[90:91], v12 offset:8736
    ds_read_b64_tr_b16 a[96:97], v12 offset:8768
    ds_read_b64_tr_b16 a[102:103], v12 offset:8800
    ds_read_b64_tr_b16 a[108:109], v12 offset:8832
    ds_read_b64_tr_b16 a[114:115], v12 offset:8864
    ds_read_b64_tr_b16 a[120:121], v12 offset:8896
    ds_read_b64_tr_b16 a[126:127], v12 offset:8928
    v_cndmask_b32 v72, v72, v15, s[56:57]
    v_cndmask_b32 v73, v73, v15, s[56:57]
    v_cndmask_b32 v74, v74, v15, s[56:57]
    v_cndmask_b32 v75, v75, v15, s[56:57]
    v_cndmask_b32 v76, v76, v15, s[56:57]
    v_cndmask_b32 v77, v77, v15, s[56:57]
    v_cndmask_b32 v78, v78, v15, s[56:57]
    v_cndmask_b32 v79, v79, v15, s[56:57]
    v_max_f32 v40, v56, v57
    v_max3_f32 v40, v40, v58, v59
    v_max3_f32 v40, v40, v72, v73
    v_max3_f32 v40, v40, v74, v75
    v_mov_b32 v41, v40
    s_nop 1
    v_permlane16_swap_b32 v40, v41
    v_max_f32 v40, v40, v41
    v_mov_b32 v41, v40
    s_nop 1
    v_permlane32_swap_b32 v40, v41
    v_max_f32 v40, v40, v41
    v_mul_f32 v40, s54, v40
    v_fma_f32 v56, v56, s54, -v40
    v_fma_f32 v57, v57, s54, -v40
    v_fma_f32 v58, v58, s54, -v40
    v_fma_f32 v59, v59, s54, -v40
    v_fma_f32 v72, v72, s54, -v40
    v_fma_f32 v73, v73, s54, -v40
    v_fma_f32 v74, v74, s54, -v40
    v_fma_f32 v75, v75, s54, -v40
    v_exp_f32 v56, v56
    v_exp_f32 v57, v57
    v_exp_f32 v58, v58
    v_exp_f32 v59, v59
    v_exp_f32 v72, v72
    v_exp_f32 v73, v73
    v_exp_f32 v74, v74
    v_exp_f32 v75, v75
    v_add_f32 v40, v56, v57
    v_add_f32 v40, v40, v58
    v_add_f32 v40, v40, v59
    v_add_f32 v40, v40, v72
    v_add_f32 v40, v40, v73
    v_add_f32 v40, v40, v74
    v_add_f32 v40, v40, v75
    v_mov_b32 v41, v40
    s_nop 1
    v_permlane16_swap_b32 v40, v41
    v_add_f32 v40, v40, v41
    v_mov_b32 v41, v40
    s_nop 1
    v_permlane32_swap_b32 v40, v41
    v_add_f32 v40, v40, v41
    v_rcp_f32 v40, v40
    s_nop 0
    v_mul_f32 v56, v56, v40
    v_mul_f32 v57, v57, v40
    v_mul_f32 v58, v58, v40
    v_mul_f32 v59, v59, v40
    v_mul_f32 v72, v72, v40
    v_mul_f32 v73, v73, v40
    v_mul_f32 v74, v74, v40
    v_mul_f32 v75, v75, v40
    v_cvt_pk_bf16_f32 v24, v56, v57
    v_cvt_pk_bf16_f32 v25, v58, v59
    v_cvt_pk_bf16_f32 v28, v72, v73
    v_cvt_pk_bf16_f32 v29, v74, v75
    v_max_f32 v40, v60, v61
    v_max3_f32 v40, v40, v62, v63
    v_max3_f32 v40, v40, v68, v69
    v_max3_f32 v40, v40, v70, v71
    v_max3_f32 v40, v40, v76, v77
    v_max3_f32 v40, v40, v78, v79
    v_mov_b32 v41, v40
    s_nop 1
    v_permlane16_swap_b32 v40, v41
    v_max_f32 v40, v40, v41
    v_mov_b32 v41, v40
    s_nop 1
    v_permlane32_swap_b32 v40, v41
    v_max_f32 v40, v40, v41
    v_mul_f32 v40, s54, v40
    v_fma_f32 v60, v60, s54, -v40
    v_fma_f32 v61, v61, s54, -v40
    v_fma_f32 v62, v62, s54, -v40
    v_fma_f32 v63, v63, s54, -v40
    v_fma_f32 v68, v68, s54, -v40
    v_fma_f32 v69, v69, s54, -v40
    v_fma_f32 v70, v70, s54, -v40
    v_fma_f32 v71, v71, s54, -v40
    v_fma_f32 v76, v76, s54, -v40
    v_fma_f32 v77, v77, s54, -v40
    v_fma_f32 v78, v78, s54, -v40
    v_fma_f32 v79, v79, s54, -v40
    v_exp_f32 v60, v60
    v_exp_f32 v61, v61
    v_exp_f32 v62, v62
    v_exp_f32 v63, v63
    v_exp_f32 v68, v68
    v_exp_f32 v69, v69
    v_exp_f32 v70, v70
    v_exp_f32 v71, v71
    v_exp_f32 v76, v76
    v_exp_f32 v77, v77
    v_exp_f32 v78, v78
    v_exp_f32 v79, v79
    v_add_f32 v40, v60, v61
    v_add_f32 v40, v40, v62
    v_add_f32 v40, v40, v63
    v_add_f32 v40, v40, v68
    v_add_f32 v40, v40, v69
    v_add_f32 v40, v40, v70
    v_add_f32 v40, v40, v71
    v_add_f32 v40, v40, v76
    v_add_f32 v40, v40, v77
    v_add_f32 v40, v40, v78
    v_add_f32 v40, v40, v79
    v_mov_b32 v41, v40
    s_nop 1
    v_permlane16_swap_b32 v40, v41
    v_add_f32 v40, v40, v41
    v_mov_b32 v41, v40
    s_nop 1
    v_permlane32_swap_b32 v40, v41
    v_add_f32 v40, v40, v41
    v_rcp_f32 v40, v40
    s_nop 0
    v_mul_f32 v60, v60, v40
    v_mul_f32 v61, v61, v40
    v_mul_f32 v62, v62, v40
    v_mul_f32 v63, v63, v40
    v_mul_f32 v68, v68, v40
    v_mul_f32 v69, v69, v40
    v_mul_f32 v70, v70, v40
    v_mul_f32 v71, v71, v40
    v_mul_f32 v76, v76, v40
    v_mul_f32 v77, v77, v40
    v_mul_f32 v78, v78, v40
    v_mul_f32 v79, v79, v40
    v_cvt_pk_bf16_f32 v30, v60, v61
    v_cvt_pk_bf16_f32 v31, v62, v63
    v_cvt_pk_bf16_f32 v32, v68, v69
    v_cvt_pk_bf16_f32 v33, v70, v71
    v_cvt_pk_bf16_f32 v34, v76, v77
    v_cvt_pk_bf16_f32 v35, v78, v79
    s_waitcnt lgkmcnt(0)
    s_nop 0
    v_mfma_f32_16x16x16_bf16 v[64:67], a[80:81], v[24:25], 0
    v_mfma_f32_16x16x16_bf16 v[68:71], a[86:87], v[24:25], 0
    v_mfma_f32_16x16x16_bf16 v[72:75], a[92:93], v[24:25], 0
    v_mfma_f32_16x16x16_bf16 v[76:79], a[98:99], v[24:25], 0
    v_mfma_f32_16x16x16_bf16 v[80:83], a[104:105], v[24:25], 0
    v_mfma_f32_16x16x16_bf16 v[84:87], a[110:111], v[24:25], 0
    v_mfma_f32_16x16x16_bf16 v[88:91], a[116:117], v[24:25], 0
    v_mfma_f32_16x16x16_bf16 v[92:95], a[122:123], v[24:25], 0
    v_mfma_f32_16x16x16_bf16 v[64:67], a[84:85], v[28:29], v[64:67]
    v_mfma_f32_16x16x16_bf16 v[68:71], a[90:91], v[28:29], v[68:71]
    v_mfma_f32_16x16x16_bf16 v[72:75], a[96:97], v[28:29], v[72:75]
    v_mfma_f32_16x16x16_bf16 v[76:79], a[102:103], v[28:29], v[76:79]
    v_mfma_f32_16x16x16_bf16 v[80:83], a[108:109], v[28:29], v[80:83]
    v_mfma_f32_16x16x16_bf16 v[84:87], a[114:115], v[28:29], v[84:87]
    v_mfma_f32_16x16x16_bf16 v[88:91], a[120:121], v[28:29], v[88:91]
    v_mfma_f32_16x16x16_bf16 v[92:95], a[126:127], v[28:29], v[92:95]
    v_mfma_f32_16x16x16_bf16 v[96:99], a[80:81], v[30:31], 0
    v_mfma_f32_16x16x16_bf16 v[100:103], a[86:87], v[30:31], 0
    v_mfma_f32_16x16x16_bf16 v[104:107], a[92:93], v[30:31], 0
    v_mfma_f32_16x16x16_bf16 v[108:111], a[98:99], v[30:31], 0
    v_mfma_f32_16x16x16_bf16 v[112:115], a[104:105], v[30:31], 0
    v_mfma_f32_16x16x16_bf16 v[116:119], a[110:111], v[30:31], 0
    v_mfma_f32_16x16x16_bf16 v[120:123], a[116:117], v[30:31], 0
    v_mfma_f32_16x16x16_bf16 v[124:127], a[122:123], v[30:31], 0
    v_mfma_f32_16x16x16_bf16 v[96:99], a[82:83], v[32:33], v[96:99]
    v_mfma_f32_16x16x16_bf16 v[100:103], a[88:89], v[32:33], v[100:103]
    v_mfma_f32_16x16x16_bf16 v[104:107], a[94:95], v[32:33], v[104:107]
    v_mfma_f32_16x16x16_bf16 v[108:111], a[100:101], v[32:33], v[108:111]
    v_mfma_f32_16x16x16_bf16 v[112:115], a[106:107], v[32:33], v[112:115]
    v_mfma_f32_16x16x16_bf16 v[116:119], a[112:113], v[32:33], v[116:119]
    v_mfma_f32_16x16x16_bf16 v[120:123], a[118:119], v[32:33], v[120:123]
    v_mfma_f32_16x16x16_bf16 v[124:127], a[124:125], v[32:33], v[124:127]
    v_mfma_f32_16x16x16_bf16 v[96:99], a[84:85], v[34:35], v[96:99]
    v_mfma_f32_16x16x16_bf16 v[100:103], a[90:91], v[34:35], v[100:103]
    v_mfma_f32_16x16x16_bf16 v[104:107], a[96:97], v[34:35], v[104:107]
    v_mfma_f32_16x16x16_bf16 v[108:111], a[102:103], v[34:35], v[108:111]
    v_mfma_f32_16x16x16_bf16 v[112:115], a[108:109], v[34:35], v[112:115]
    v_mfma_f32_16x16x16_bf16 v[116:119], a[114:115], v[34:35], v[116:119]
    v_mfma_f32_16x16x16_bf16 v[120:123], a[120:121], v[34:35], v[120:123]
    v_mfma_f32_16x16x16_bf16 v[124:127], a[126:127], v[34:35], v[124:127]
    s_add_u32 s46, s63, 4096
    v_cvt_pk_bf16_f32 v64, v64, v65
    v_cvt_pk_bf16_f32 v65, v66, v67
    v_cvt_pk_bf16_f32 v66, v68, v69
    v_cvt_pk_bf16_f32 v67, v70, v71
    buffer_store_dwordx4 v[64:67], v10, s[12:15], s63 offen offset:0 sc1
    v_cvt_pk_bf16_f32 v72, v72, v73
    v_cvt_pk_bf16_f32 v73, v74, v75
    v_cvt_pk_bf16_f32 v74, v76, v77
    v_cvt_pk_bf16_f32 v75, v78, v79
    buffer_store_dwordx4 v[72:75], v10, s[12:15], s63 offen offset:2048 sc1
    v_cvt_pk_bf16_f32 v80, v80, v81
    v_cvt_pk_bf16_f32 v81, v82, v83
    v_cvt_pk_bf16_f32 v82, v84, v85
    v_cvt_pk_bf16_f32 v83, v86, v87
    buffer_store_dwordx4 v[80:83], v10, s[12:15], s46 offen offset:0 sc1
    v_cvt_pk_bf16_f32 v88, v88, v89
    v_cvt_pk_bf16_f32 v89, v90, v91
    v_cvt_pk_bf16_f32 v90, v92, v93
    v_cvt_pk_bf16_f32 v91, v94, v95
    buffer_store_dwordx4 v[88:91], v10, s[12:15], s46 offen offset:2048 sc1
    v_cvt_pk_bf16_f32 v96, v96, v97
    v_cvt_pk_bf16_f32 v97, v98, v99
    v_cvt_pk_bf16_f32 v98, v100, v101
    v_cvt_pk_bf16_f32 v99, v102, v103
    buffer_store_dwordx4 v[96:99], v10, s[12:15], s63 offen offset:256 sc1
    v_cvt_pk_bf16_f32 v104, v104, v105
    v_cvt_pk_bf16_f32 v105, v106, v107
    v_cvt_pk_bf16_f32 v106, v108, v109
    v_cvt_pk_bf16_f32 v107, v110, v111
    buffer_store_dwordx4 v[104:107], v10, s[12:15], s63 offen offset:2304 sc1
    v_cvt_pk_bf16_f32 v112, v112, v113
    v_cvt_pk_bf16_f32 v113, v114, v115
    v_cvt_pk_bf16_f32 v114, v116, v117
    v_cvt_pk_bf16_f32 v115, v118, v119
    buffer_store_dwordx4 v[112:115], v10, s[12:15], s46 offen offset:256 sc1
    v_cvt_pk_bf16_f32 v120, v120, v121
    v_cvt_pk_bf16_f32 v121, v122, v123
    v_cvt_pk_bf16_f32 v122, v124, v125
    v_cvt_pk_bf16_f32 v123, v126, v127
    buffer_store_dwordx4 v[120:123], v10, s[12:15], s46 offen offset:2304 sc1
    s_waitcnt vmcnt(0)
    v_mov_b32 v16, s60
    v_add_u32 v16, 1, v16
    v_mov_b32 v17, 0
    s_mov_b64 exec, 1
    buffer_store_dword v16, v17, s[12:15], s52 offen sc1
    s_mov_b64 exec, -1
L_sf_48:
    s_add_u32 s60, s60, 4
    s_cmp_lt_u32 s60, 64
    s_cbranch_scc1 L_a_loop_42
    s_branch L_c_done_1
L_w_g_10:
    s_lshr_b32 s53, s48, 2
    s_cmp_lt_u32 s53, 2
    s_cselect_b32 s46, 1, 0
    s_xor_b32 s53, s53, s46
    s_mov_b32 s74, 0
    s_mov_b32 s76, 0
    s_cmp_eq_u32 s53, 1
    s_cselect_b32 s75, 41, 58
    s_cmp_eq_u32 s53, 2
    s_cselect_b32 s75, 54, s75
L_w_g_10_e:
    s_lshl_b32 s46, s53, 3
    s_add_u32 s46, s46, 16
    s_load_dwordx2 s[4:5], s[0:1], s46
    s_lshl_b32 s49, s40, 2
    s_and_b32 s46, s48, 3
    s_add_u32 s49, s49, s46
    s_load_dwordx2 s[6:7], s[0:1], 72
    s_and_b32 s50, s44, 3
    s_lshr_b32 s51, s44, 2
    s_waitcnt lgkmcnt(0)
    s_mov_b32 s24, s4
    s_and_b32 s25, s5, 0xffff
    s_mov_b32 s26, 0x800000
    s_mov_b32 s27, 0x00020000
    s_cmp_lg_u32 s76, 0
    s_cbranch_scc1 L_g_n3_49
    s_cmp_ge_u32 s44, 3
    s_cbranch_scc1 L_g_n3_49
    s_mul_i32 s46, s48, 3
    s_add_u32 s46, s46, s44
    s_cmp_ge_u32 s46, 32
    s_cbranch_scc1 L_g_n3_49
    s_lshr_b32 s47, s46, 4
    s_add_u32 s47, s47, 1
    s_cmp_eq_u32 s47, 3
    s_cselect_b32 s47, 0, s47
    s_lshl_b32 s47, s47, 3
    s_add_u32 s47, s47, 16
    s_load_dwordx2 s[8:9], s[0:1], s47
    s_and_b32 s46, s46, 15
    s_lshl_b32 s46, s46, 19
    s_lshl_b32 s47, s40, 10
    s_add_u32 s46, s46, s47
    s_add_u32 s46, s46, 384
    v_lshlrev_b32 v10, 13, v1
    s_waitcnt lgkmcnt(0)
    s_mov_b32 s28, s8
    s_and_b32 s29, s9, 0xffff
    s_mov_b32 s30, 0x800000
    s_mov_b32 s31, 0x00020000
    buffer_load_dword v16, v10, s[28:31], s46 offen
L_g_n3_49:
    s_cmp_lg_u32 s53, 0
    s_cbranch_scc1 L_g_nq_50
    s_load_dwordx4 s[8:11], s[0:1], 24
    v_bfe_u32 v10, v0, 1, 6
    v_lshlrev_b32 v10, 13, v10
    v_and_b32 v11, 1, v0
    v_lshl_add_u32 v10, v11, 7, v10
    v_bfe_u32 v11, v0, 7, 1
    v_lshl_add_u32 v10, v11, 22, v10
    s_lshl_b32 s46, s49, 8
    s_waitcnt lgkmcnt(0)
    s_mov_b32 s28, s10
    s_and_b32 s29, s11, 0xffff
    s_mov_b32 s30, 0x800000
    s_mov_b32 s31, 0x00020000
    s_mov_b32 s32, s8
    s_and_b32 s33, s9, 0xffff
    s_mov_b32 s34, 0x800000
    s_mov_b32 s35, 0x00020000
    s_lshl_b32 s47, s51, 19
    s_add_u32 s46, s46, s47
    s_add_u32 s47, s46, 0x200000
    buffer_load_dword v11, v10, s[28:31], s47 offen
    s_add_u32 s47, s46, 0x300000
    buffer_load_dword v12, v10, s[28:31], s47 offen
L_g_nq_50:
    v_lshrrev_b32 v3, 4, v1
    v_and_b32 v4, 15, v1
    v_lshlrev_b32 v5, 2, v3
    v_xor_b32 v4, v4, v5
    v_mul_u32_u24 v3, 8192, v3
    v_lshl_add_u32 v3, v4, 4, v3
    s_mul_i32 s46, s51, 512
    s_mul_i32 s47, s50, 16
    s_add_u32 s46, s46, s47
    s_mul_i32 s46, s46, 8192
    s_lshl_b32 s47, s49, 8
    s_add_u32 s46, s46, s47
    s_lshl_b32 s45, s51, 16
    s_mul_i32 s47, s50, 4096
    s_add_u32 s45, s45, s47
    v_bfe_u32 v4, v1, 2, 2
    v_bfe_u32 v5, v1, 4, 1
    v_lshlrev_b32 v5, 1, v5
    v_bfe_u32 v6, v1, 0, 1
    v_add_u32 v5, v5, v6
    s_lshl_b32 s47, s50, 2
    v_add_u32 v5, s47, v5
    v_lshlrev_b32 v6, 2, v4
    v_xor_b32 v5, v5, v6
    v_lshlrev_b32 v5, 4, v5
    v_lshl_add_u32 v5, v4, 8, v5
    v_bfe_u32 v6, v1, 1, 1
    v_lshl_add_u32 v5, v6, 3, v5
    v_lshrrev_b32 v6, 5, v1
    v_mul_u32_u24 v6, 2048, v6
    v_add_u32 v5, v5, v6
    s_lshl_b32 s47, s51, 16
    v_add_u32 v5, s47, v5
    v_bfe_u32 v4, v1, 2, 2
    v_xor_b32 v5, s50, v4
    v_lshlrev_b32 v5, 6, v5
    v_lshl_add_u32 v5, v4, 8, v5
    v_and_b32 v6, 3, v1
    v_lshl_add_u32 v5, v6, 4, v5
    v_lshrrev_b32 v6, 4, v1
    v_lshl_add_u32 v5, v6, 11, v5
    v_lshrrev_b32 v6, 5, v1
    s_lshl_b32 s47, s51, 16
    v_add_u32 v5, s47, v5
    s_add_u32 m0, s45, 0
    s_add_u32 s47, s46, 0x0
    buffer_load_dwordx4 v3, s[24:27], s47 offen  lds
    s_add_u32 m0, s45, 1024
    s_add_u32 s47, s46, 0x8000
    buffer_load_dwordx4 v3, s[24:27], s47 offen  lds
    s_add_u32 m0, s45, 2048
    s_add_u32 s47, s46, 0x10000
    buffer_load_dwordx4 v3, s[24:27], s47 offen  lds
    s_add_u32 m0, s45, 3072
    s_add_u32 s47, s46, 0x18000
    buffer_load_dwordx4 v3, s[24:27], s47 offen  lds
    s_add_u32 m0, s45, 16384
    s_add_u32 s47, s46, 0x80000
    buffer_load_dwordx4 v3, s[24:27], s47 offen  lds
    s_add_u32 m0, s45, 17408
    s_add_u32 s47, s46, 0x88000
    buffer_load_dwordx4 v3, s[24:27], s47 offen  lds
    s_add_u32 m0, s45, 18432
    s_add_u32 s47, s46, 0x90000
    buffer_load_dwordx4 v3, s[24:27], s47 offen  lds
    s_add_u32 m0, s45, 19456
    s_add_u32 s47, s46, 0x98000
    buffer_load_dwordx4 v3, s[24:27], s47 offen  lds
    s_add_u32 m0, s45, 32768
    s_add_u32 s47, s46, 0x100000
    buffer_load_dwordx4 v3, s[24:27], s47 offen  lds
    s_add_u32 m0, s45, 33792
    s_add_u32 s47, s46, 0x108000
    buffer_load_dwordx4 v3, s[24:27], s47 offen  lds
    s_add_u32 m0, s45, 34816
    s_add_u32 s47, s46, 0x110000
    buffer_load_dwordx4 v3, s[24:27], s47 offen  lds
    s_add_u32 m0, s45, 35840
    s_add_u32 s47, s46, 0x118000
    buffer_load_dwordx4 v3, s[24:27], s47 offen  lds
    s_add_u32 m0, s45, 49152
    s_add_u32 s47, s46, 0x180000
    buffer_load_dwordx4 v3, s[24:27], s47 offen  lds
    s_add_u32 m0, s45, 50176
    s_add_u32 s47, s46, 0x188000
    buffer_load_dwordx4 v3, s[24:27], s47 offen  lds
    s_add_u32 m0, s45, 51200
    s_add_u32 s47, s46, 0x190000
    buffer_load_dwordx4 v3, s[24:27], s47 offen  lds
    s_add_u32 m0, s45, 52224
    s_add_u32 s47, s46, 0x198000
    buffer_load_dwordx4 v3, s[24:27], s47 offen  lds
    s_waitcnt vmcnt(12) lgkmcnt(0)
    s_barrier
    ds_read_b64_tr_b16 a[0:1], v5 offset:0
    ds_read_b64_tr_b16 a[2:3], v5 offset:1024
    ds_read_b64_tr_b16 a[4:5], v5 offset:8
    ds_read_b64_tr_b16 a[6:7], v5 offset:1032
    ds_read_b64_tr_b16 a[8:9], v5 offset:8192
    ds_read_b64_tr_b16 a[10:11], v5 offset:9216
    ds_read_b64_tr_b16 a[12:13], v5 offset:8200
    ds_read_b64_tr_b16 a[14:15], v5 offset:9224
    s_waitcnt vmcnt(8) lgkmcnt(0)
    s_barrier
    s_add_u32 m0, s45, 0
    s_add_u32 s47, s46, 0x200000
    buffer_load_dwordx4 v3, s[24:27], s47 offen  lds
    s_add_u32 m0, s45, 1024
    s_add_u32 s47, s46, 0x208000
    buffer_load_dwordx4 v3, s[24:27], s47 offen  lds
    s_add_u32 m0, s45, 2048
    s_add_u32 s47, s46, 0x210000
    buffer_load_dwordx4 v3, s[24:27], s47 offen  lds
    s_add_u32 m0, s45, 3072
    s_add_u32 s47, s46, 0x218000
    buffer_load_dwordx4 v3, s[24:27], s47 offen  lds
    ds_read_b64_tr_b16 a[16:17], v5 offset:16384
    ds_read_b64_tr_b16 a[18:19], v5 offset:17408
    ds_read_b64_tr_b16 a[20:21], v5 offset:16392
    ds_read_b64_tr_b16 a[22:23], v5 offset:17416
    ds_read_b64_tr_b16 a[24:25], v5 offset:24576
    ds_read_b64_tr_b16 a[26:27], v5 offset:25600
    ds_read_b64_tr_b16 a[28:29], v5 offset:24584
    ds_read_b64_tr_b16 a[30:31], v5 offset:25608
    s_waitcnt vmcnt(8) lgkmcnt(0)
    s_barrier
    s_add_u32 m0, s45, 16384
    s_add_u32 s47, s46, 0x280000
    buffer_load_dwordx4 v3, s[24:27], s47 offen  lds
    s_add_u32 m0, s45, 17408
    s_add_u32 s47, s46, 0x288000
    buffer_load_dwordx4 v3, s[24:27], s47 offen  lds
    s_add_u32 m0, s45, 18432
    s_add_u32 s47, s46, 0x290000
    buffer_load_dwordx4 v3, s[24:27], s47 offen  lds
    s_add_u32 m0, s45, 19456
    s_add_u32 s47, s46, 0x298000
    buffer_load_dwordx4 v3, s[24:27], s47 offen  lds
    ds_read_b64_tr_b16 a[32:33], v5 offset:32768
    ds_read_b64_tr_b16 a[34:35], v5 offset:33792
    ds_read_b64_tr_b16 a[36:37], v5 offset:32776
    ds_read_b64_tr_b16 a[38:39], v5 offset:33800
    ds_read_b64_tr_b16 a[40:41], v5 offset:40960
    ds_read_b64_tr_b16 a[42:43], v5 offset:41984
    ds_read_b64_tr_b16 a[44:45], v5 offset:40968
    ds_read_b64_tr_b16 a[46:47], v5 offset:41992
    s_waitcnt vmcnt(8) lgkmcnt(0)
    s_barrier
    s_add_u32 m0, s45, 32768
    s_add_u32 s47, s46, 0x300000
    buffer_load_dwordx4 v3, s[24:27], s47 offen  lds
    s_add_u32 m0, s45, 33792
    s_add_u32 s47, s46, 0x308000
    buffer_load_dwordx4 v3, s[24:27], s47 offen  lds
    s_add_u32 m0, s45, 34816
    s_add_u32 s47, s46, 0x310000
    buffer_load_dwordx4 v3, s[24:27], s47 offen  lds
    s_add_u32 m0, s45, 35840
    s_add_u32 s47, s46, 0x318000
    buffer_load_dwordx4 v3, s[24:27], s47 offen  lds
    ds_read_b64_tr_b16 a[48:49], v5 offset:49152
    ds_read_b64_tr_b16 a[50:51], v5 offset:50176
    ds_read_b64_tr_b16 a[52:53], v5 offset:49160
    ds_read_b64_tr_b16 a[54:55], v5 offset:50184
    ds_read_b64_tr_b16 a[56:57], v5 offset:57344
    ds_read_b64_tr_b16 a[58:59], v5 offset:58368
    ds_read_b64_tr_b16 a[60:61], v5 offset:57352
    ds_read_b64_tr_b16 a[62:63], v5 offset:58376
    s_waitcnt vmcnt(8) lgkmcnt(0)
    s_barrier
    s_add_u32 m0, s45, 49152
    s_add_u32 s47, s46, 0x380000
    buffer_load_dwordx4 v3, s[24:27], s47 offen  lds
    s_add_u32 m0, s45, 50176
    s_add_u32 s47, s46, 0x388000
    buffer_load_dwordx4 v3, s[24:27], s47 offen  lds
    s_add_u32 m0, s45, 51200
    s_add_u32 s47, s46, 0x390000
    buffer_load_dwordx4 v3, s[24:27], s47 offen  lds
    s_add_u32 m0, s45, 52224
    s_add_u32 s47, s46, 0x398000
    buffer_load_dwordx4 v3, s[24:27], s47 offen  lds
    ds_read_b64_tr_b16 a[64:65], v5 offset:0
    ds_read_b64_tr_b16 a[66:67], v5 offset:1024
    ds_read_b64_tr_b16 a[68:69], v5 offset:8
    ds_read_b64_tr_b16 a[70:71], v5 offset:1032
    ds_read_b64_tr_b16 a[72:73], v5 offset:8192
    ds_read_b64_tr_b16 a[74:75], v5 offset:9216
    ds_read_b64_tr_b16 a[76:77], v5 offset:8200
    ds_read_b64_tr_b16 a[78:79], v5 offset:9224
    s_waitcnt vmcnt(8) lgkmcnt(0)
    s_barrier
    ds_read_b64_tr_b16 a[80:81], v5 offset:16384
    ds_read_b64_tr_b16 a[82:83], v5 offset:17408
    ds_read_b64_tr_b16 a[84:85], v5 offset:16392
    ds_read_b64_tr_b16 a[86:87], v5 offset:17416
    ds_read_b64_tr_b16 a[88:89], v5 offset:24576
    ds_read_b64_tr_b16 a[90:91], v5 offset:25600
    ds_read_b64_tr_b16 a[92:93], v5 offset:24584
    ds_read_b64_tr_b16 a[94:95], v5 offset:25608
    s_waitcnt vmcnt(4) lgkmcnt(0)
    s_barrier
    ds_read_b64_tr_b16 a[96:97], v5 offset:32768
    ds_read_b64_tr_b16 a[98:99], v5 offset:33792
    ds_read_b64_tr_b16 a[100:101], v5 offset:32776
    ds_read_b64_tr_b16 a[102:103], v5 offset:33800
    ds_read_b64_tr_b16 a[104:105], v5 offset:40960
    ds_read_b64_tr_b16 a[106:107], v5 offset:41984
    ds_read_b64_tr_b16 a[108:109], v5 offset:40968
    ds_read_b64_tr_b16 a[110:111], v5 offset:41992
    s_waitcnt vmcnt(0) lgkmcnt(0)
    s_barrier
    ds_read_b64_tr_b16 a[112:113], v5 offset:49152
    ds_read_b64_tr_b16 a[114:115], v5 offset:50176
    ds_read_b64_tr_b16 a[116:117], v5 offset:49160
    ds_read_b64_tr_b16 a[118:119], v5 offset:50184
    ds_read_b64_tr_b16 a[120:121], v5 offset:57344
    ds_read_b64_tr_b16 a[122:123], v5 offset:58368
    ds_read_b64_tr_b16 a[124:125], v5 offset:57352
    ds_read_b64_tr_b16 a[126:127], v5 offset:58376
    s_waitcnt lgkmcnt(0)
    s_barrier
    v_lshlrev_b32 v2, 4, v1
    s_mul_i32 s64, s44, 8192
    s_add_u32 s46, s64, 0x400000
    v_add_u32 v3, s46, v2
    s_mul_i32 s46, s51, 32768
    v_add_u32 v4, s46, v2
    v_and_b32 v6, 15, v1
    v_lshlrev_b32 v6, 4, v6
    v_lshrrev_b32 v7, 4, v1
    v_lshl_add_u32 v6, v7, 9, v6
    v_add_u32 v4, s46, v6
    s_lshl_b32 s46, s50, 12
    s_add_u32 s46, s46, 131072
    v_add_u32 v5, s46, v2
    v_and_b32 v7, 3, v1
    v_lshlrev_b32 v7, 7, v7
    v_add_u32 v7, 0x109400, v7
    s_mul_i32 s46, s49, 24576
    s_lshl_b32 s47, s53, 13
    s_add_u32 s46, s46, s47
    s_lshl_b32 s47, s50, 10
    s_add_u32 s46, s46, s47
    s_add_u32 s46, s46, 0x2000000
    v_and_b32 v8, 15, v1
    v_lshlrev_b32 v8, 4, v8
    v_bfe_u32 v9, v1, 4, 1
    v_lshl_add_u32 v8, v9, 12, v8
    v_lshrrev_b32 v9, 5, v1
    v_lshl_add_u32 v8, v9, 8, v8
    v_add_u32 v8, s46, v2
    v_add_u32 v9, 4096, v8
    s_lshl_b32 s52, s40, 2
    s_add_u32 s52, s52, s53
    s_lshl_b32 s52, s52, 2
    s_and_b32 s47, s48, 3
    s_add_u32 s52, s52, s47
    s_lshl_b32 s52, s52, 7
    s_add_u32 s52, s52, 0x10a400
    s_add_u32 s52, s52, s76
    v_mov_b32 v120, -1
    v_mov_b32 v121, -1
    v_mov_b32 v122, -1
    v_mov_b32 v123, -1
    s_lshl_b32 s46, s49, 12
    s_lshl_b32 s47, s50, 10
    s_add_u32 s46, s46, s47
    s_add_u32 s46, s46, 0x1000000
    v_add_u32 v64, s46, v2
    s_and_b32 s46, s48, 3
    s_lshl_b32 s46, s46, 16
    s_lshl_b32 s47, s50, 14
    s_add_u32 s46, s46, s47
    s_lshl_b32 s47, s40, 8
    s_add_u32 s46, s46, s47
    s_add_u32 s46, s46, 0x7800000
    v_and_b32 v65, 15, v1
    v_lshlrev_b32 v65, 4, v65
    v_lshrrev_b32 v66, 4, v1
    v_lshl_add_u32 v65, v66, 11, v65
    v_add_u32 v65, s46, v65
    v_add_u32 v68, 8192, v65
    s_lshl_b32 s58, s74, 17
    s_lshl_b32 s46, s53, 3
    s_sub_u32 s46, 80, s46
    s_load_dwordx2 s[8:9], s[0:1], s46
    v_lshlrev_b32 v66, 7, v1
    s_mul_i32 s57, s49, 229376
    s_waitcnt lgkmcnt(0)
    s_mov_b32 s32, s8
    s_and_b32 s33, s9, 0xffff
    s_mov_b32 s34, 0x700000
    s_mov_b32 s35, 0x00020000
    s_mov_b32 s60, 0
    s_mul_i32 s61, s74, 65536
    s_mov_b32 s62, 0
    s_mul_i32 s63, s74, 786432
    s_mul_i32 s85, s78, 65536
    s_mul_i32 s86, s78, 786432
    s_sub_u32 s46, s78, 1
    s_sub_u32 s75, s75, s74
    s_add_u32 s75, s75, s46
    s_lshr_b32 s75, s75, s46
    s_mov_b32 s67, 0
    s_mov_b32 s68, 3
    s_mov_b32 s71, 0
    v_mov_b32 v15, 147456
    v_mov_b32 v14, 0
    ds_write_b32 v15, v14 offset:4
    ds_write_b32 v15, v14 offset:12
    ds_write_b32 v15, v14 offset:16
    v_mov_b32 v114, 1
    v_mov_b32 v115, 0
    s_mov_b32 s81, 0
    s_mul_i32 s87, s78, 2
    s_sub_u32 s87, s74, s87
    s_add_u32 s87, s87, 1
    s_lshl_b32 s46, s44, 5
    v_add_u32 v119, s46, v15
    v_lshrrev_b32 v113, 4, v1
    v_mul_u32_u24 v113, s78, v113
    v_add_u32 v113, s74, v113
    s_mov_b32 s72, 0
    s_cmp_lg_u32 s44, 0
    s_cbranch_scc1 L_zwok_60
    v_and_b32 v10, 7, v1
    v_lshlrev_b32 v10, 5, v10
    s_mov_b32 s70, 0
L_zw_59:
    buffer_load_dword v11, v10, s[16:19], 0 offen sc1
    s_waitcnt vmcnt(0)
    v_add_u32_dpp v11, v11, v11 row_ror:1 row_mask:0xf bank_mask:0xf
    s_nop 1
    v_add_u32_dpp v11, v11, v11 row_ror:2 row_mask:0xf bank_mask:0xf
    s_nop 1
    v_add_u32_dpp v11, v11, v11 row_ror:4 row_mask:0xf bank_mask:0xf
    v_cmp_ne_u32 vcc, 0x100, v11
    s_add_u32 s70, s70, 1
    s_cbranch_vccz L_zwok_60
    s_sleep 4
    s_cmp_lt_u32 s70, 524288
    s_cbranch_scc1 L_zw_59
    s_branch L_c_done_1
L_zwok_60:
L_g_restart_51:
    s_cmp_lg_u32 s44, 0
    s_cbranch_scc1 L_g_nsp_52
    s_mov_b32 s70, 0
L_g_sp_58:
    s_add_u32 s54, s60, 0
    s_mul_i32 s55, s54, s78
    v_add_u32 v12, s55, v113
    v_and_b32 v13, 7, v12
    v_lshl_add_u32 v13, v13, 9, v7
    buffer_load_dword v11, v13, s[12:15], 0 offen sc1
    s_waitcnt vmcnt(0)
    v_cmp_ge_u32 vcc, v12, v11
    s_add_u32 s70, s70, 1
    s_and_b32 s46, vcc_lo, 0xffff
    s_cbranch_scc0 L_g_sp_58_ok
    s_sleep 3
    s_cmp_lt_u32 s70, 524288
    s_cbranch_scc1 L_g_sp_58
    s_branch L_c_done_1
L_g_sp_58_ok:
    v_cmp_ge_u32 vcc, v12, v11
    s_nop 0
    s_ff1_i32_b64 s46, vcc
    s_lshr_b32 s46, s46, 4
    s_min_u32 s46, s46, 4
    s_add_u32 s46, s46, s54
    s_min_u32 s46, s46, s75
    v_mov_b32 v118, s46
    ds_write_b32 v15, v118 offset:20
L_g_nsp_52:
    s_waitcnt lgkmcnt(0)
    s_barrier
    ds_read_b32 v14, v15 offset:20
    s_waitcnt lgkmcnt(0)
    v_readfirstlane_b32 s66, v14
    s_nop 3
L_g_restart_51_go:
    s_mov_b32 s69, 0
    s_cmp_gt_u32 s62, s60
    s_cbranch_scc1 L_g_nd_61
    s_cmp_ge_u32 s62, s66
    s_cbranch_scc1 L_g_nd_61
    s_add_u32 s47, s61, 4096
    s_add_u32 m0, s64, 0
    s_nop 0
    buffer_load_dwordx4 v3, s[12:15], s61 offen offset:0 sc1 lds
    buffer_load_dwordx4 v3, s[12:15], s61 offen offset:1024 sc1 lds
    buffer_load_dwordx4 v3, s[12:15], s61 offen offset:2048 sc1 lds
    buffer_load_dwordx4 v3, s[12:15], s61 offen offset:3072 sc1 lds
    s_add_u32 m0, s64, 4096
    s_nop 0
    buffer_load_dwordx4 v3, s[12:15], s47 offen offset:0 sc1 lds
    buffer_load_dwordx4 v3, s[12:15], s47 offen offset:1024 sc1 lds
    buffer_load_dwordx4 v3, s[12:15], s47 offen offset:2048 sc1 lds
    buffer_load_dwordx4 v3, s[12:15], s47 offen offset:3072 sc1 lds
    s_add_u32 s61, s61, s85
    s_add_u32 s62, s62, 1
    s_xor_b32 s64, s64, 0x10000
    s_mov_b32 s69, 1
L_g_nd_61:
    s_cmp_eq_u32 s51, 1
    s_cbranch_scc1 L_g_g1r_53
    s_add_u32 s59, s60, 1
    s_mov_b32 s69, 0
    s_cmp_gt_u32 s62, s59
    s_cbranch_scc1 L_g_nd_62
    s_cmp_ge_u32 s62, s66
    s_cbranch_scc1 L_g_nd_62
    s_add_u32 s47, s61, 4096
    s_add_u32 m0, s64, 0
    s_nop 0
    buffer_load_dwordx4 v3, s[12:15], s61 offen offset:0 sc1 lds
    buffer_load_dwordx4 v3, s[12:15], s61 offen offset:1024 sc1 lds
    buffer_load_dwordx4 v3, s[12:15], s61 offen offset:2048 sc1 lds
    buffer_load_dwordx4 v3, s[12:15], s61 offen offset:3072 sc1 lds
    s_add_u32 m0, s64, 4096
    s_nop 0
    buffer_load_dwordx4 v3, s[12:15], s47 offen offset:0 sc1 lds
    buffer_load_dwordx4 v3, s[12:15], s47 offen offset:1024 sc1 lds
    buffer_load_dwordx4 v3, s[12:15], s47 offen offset:2048 sc1 lds
    buffer_load_dwordx4 v3, s[12:15], s47 offen offset:3072 sc1 lds
    s_add_u32 s61, s61, s85
    s_add_u32 s62, s62, 1
    s_xor_b32 s64, s64, 0x10000
    s_mov_b32 s69, 1
L_g_nd_62:
    s_cmp_eq_u32 s69, 1
    s_cbranch_scc1 L_g_w0_63
    s_waitcnt vmcnt(0)
L_g_w0_63:
    s_waitcnt vmcnt(8)
    s_cmp_lg_u32 s44, 0
    s_cbranch_scc1 L_g_nl_64
    s_cmp_lt_u32 s66, s75
    s_cselect_b32 s81, 1, 2
L_g_nl_64:
L_g_loop0_54_l:
    s_barrier
    ds_read_b128 v[32:35], v4 offset:0
    ds_read_b128 v[36:39], v4 offset:256
    ds_read_b128 v[40:43], v4 offset:2048
    ds_read_b128 v[44:47], v4 offset:2304
    ds_read_b128 v[48:51], v4 offset:4096
    ds_read_b128 v[52:55], v4 offset:4352
    ds_read_b128 v[56:59], v4 offset:6144
    ds_read_b128 v[60:63], v4 offset:6400
    s_branch L_g_loop0_54_m
.p2align 6
L_g_loop0_54:
    s_barrier
L_g_loop0_54_m:
    s_setprio 2
    s_waitcnt lgkmcnt(6)
    v_mfma_f32_16x16x32_bf16 v[16:19], a[0:3], v[32:35], 0
    v_mfma_f32_16x16x32_bf16 v[20:23], a[4:7], v[32:35], 0
    ds_read_b128 v[32:35], v4 offset:8192
    v_mfma_f32_16x16x32_bf16 v[28:31], a[4:7], v[36:39], 0
    v_mfma_f32_16x16x32_bf16 v[24:27], a[0:3], v[36:39], 0
    ds_read_b128 v[36:39], v4 offset:8448
    s_cmp_eq_u32 s81, 1
    s_cbranch_scc1 L_g_h1_68
L_g_h1_68_b:
    s_waitcnt lgkmcnt(6)
    v_mfma_f32_16x16x32_bf16 v[16:19], a[8:11], v[40:43], v[16:19]
    v_mfma_f32_16x16x32_bf16 v[20:23], a[12:15], v[40:43], v[20:23]
    ds_read_b128 v[40:43], v4 offset:10240
    v_mfma_f32_16x16x32_bf16 v[28:31], a[12:15], v[44:47], v[28:31]
    v_mfma_f32_16x16x32_bf16 v[24:27], a[8:11], v[44:47], v[24:27]
    ds_read_b128 v[44:47], v4 offset:10496
    s_waitcnt lgkmcnt(6)
    v_mfma_f32_16x16x32_bf16 v[16:19], a[16:19], v[48:51], v[16:19]
    v_mfma_f32_16x16x32_bf16 v[20:23], a[20:23], v[48:51], v[20:23]
    ds_read_b128 v[48:51], v4 offset:12288
    v_mfma_f32_16x16x32_bf16 v[28:31], a[20:23], v[52:55], v[28:31]
    v_mfma_f32_16x16x32_bf16 v[24:27], a[16:19], v[52:55], v[24:27]
    ds_read_b128 v[52:55], v4 offset:12544
    s_waitcnt lgkmcnt(6)
    v_mfma_f32_16x16x32_bf16 v[16:19], a[24:27], v[56:59], v[16:19]
    v_mfma_f32_16x16x32_bf16 v[20:23], a[28:31], v[56:59], v[20:23]
    ds_read_b128 v[56:59], v4 offset:14336
    v_mfma_f32_16x16x32_bf16 v[28:31], a[28:31], v[60:63], v[28:31]
    v_mfma_f32_16x16x32_bf16 v[24:27], a[24:27], v[60:63], v[24:27]
    ds_read_b128 v[60:63], v4 offset:14592
    s_waitcnt lgkmcnt(6)
    v_mfma_f32_16x16x32_bf16 v[16:19], a[32:35], v[32:35], v[16:19]
    v_mfma_f32_16x16x32_bf16 v[20:23], a[36:39], v[32:35], v[20:23]
    ds_read_b128 v[32:35], v4 offset:16384
    v_mfma_f32_16x16x32_bf16 v[28:31], a[36:39], v[36:39], v[28:31]
    v_mfma_f32_16x16x32_bf16 v[24:27], a[32:35], v[36:39], v[24:27]
    ds_read_b128 v[36:39], v4 offset:16640
    s_waitcnt lgkmcnt(6)
    v_mfma_f32_16x16x32_bf16 v[16:19], a[40:43], v[40:43], v[16:19]
    v_mfma_f32_16x16x32_bf16 v[20:23], a[44:47], v[40:43], v[20:23]
    ds_read_b128 v[40:43], v4 offset:18432
    v_mfma_f32_16x16x32_bf16 v[28:31], a[44:47], v[44:47], v[28:31]
    v_mfma_f32_16x16x32_bf16 v[24:27], a[40:43], v[44:47], v[24:27]
    ds_read_b128 v[44:47], v4 offset:18688
    s_waitcnt lgkmcnt(6)
    v_mfma_f32_16x16x32_bf16 v[16:19], a[48:51], v[48:51], v[16:19]
    v_mfma_f32_16x16x32_bf16 v[20:23], a[52:55], v[48:51], v[20:23]
    ds_read_b128 v[48:51], v4 offset:20480
    v_mfma_f32_16x16x32_bf16 v[28:31], a[52:55], v[52:55], v[28:31]
    v_mfma_f32_16x16x32_bf16 v[24:27], a[48:51], v[52:55], v[24:27]
    ds_read_b128 v[52:55], v4 offset:20736
    s_waitcnt lgkmcnt(6)
    v_mfma_f32_16x16x32_bf16 v[16:19], a[56:59], v[56:59], v[16:19]
    v_mfma_f32_16x16x32_bf16 v[20:23], a[60:63], v[56:59], v[20:23]
    ds_read_b128 v[56:59], v4 offset:22528
    v_mfma_f32_16x16x32_bf16 v[28:31], a[60:63], v[60:63], v[28:31]
    v_mfma_f32_16x16x32_bf16 v[24:27], a[56:59], v[60:63], v[24:27]
    ds_read_b128 v[60:63], v4 offset:22784
    s_waitcnt lgkmcnt(6)
    v_mfma_f32_16x16x32_bf16 v[16:19], a[64:67], v[32:35], v[16:19]
    v_mfma_f32_16x16x32_bf16 v[20:23], a[68:71], v[32:35], v[20:23]
    ds_read_b128 v[32:35], v4 offset:24576
    v_mfma_f32_16x16x32_bf16 v[28:31], a[68:71], v[36:39], v[28:31]
    v_mfma_f32_16x16x32_bf16 v[24:27], a[64:67], v[36:39], v[24:27]
    ds_read_b128 v[36:39], v4 offset:24832
    s_waitcnt lgkmcnt(6)
    v_mfma_f32_16x16x32_bf16 v[16:19], a[72:75], v[40:43], v[16:19]
    v_mfma_f32_16x16x32_bf16 v[20:23], a[76:79], v[40:43], v[20:23]
    ds_read_b128 v[40:43], v4 offset:26624
    v_mfma_f32_16x16x32_bf16 v[28:31], a[76:79], v[44:47], v[28:31]
    v_mfma_f32_16x16x32_bf16 v[24:27], a[72:75], v[44:47], v[24:27]
    ds_read_b128 v[44:47], v4 offset:26880
    s_waitcnt lgkmcnt(6)
    v_mfma_f32_16x16x32_bf16 v[16:19], a[80:83], v[48:51], v[16:19]
    v_mfma_f32_16x16x32_bf16 v[20:23], a[84:87], v[48:51], v[20:23]
    ds_read_b128 v[48:51], v4 offset:28672
    v_mfma_f32_16x16x32_bf16 v[28:31], a[84:87], v[52:55], v[28:31]
    v_mfma_f32_16x16x32_bf16 v[24:27], a[80:83], v[52:55], v[24:27]
    ds_read_b128 v[52:55], v4 offset:28928
    s_waitcnt lgkmcnt(6)
    v_mfma_f32_16x16x32_bf16 v[16:19], a[88:91], v[56:59], v[16:19]
    v_mfma_f32_16x16x32_bf16 v[20:23], a[92:95], v[56:59], v[20:23]
    ds_read_b128 v[56:59], v4 offset:30720
    v_mfma_f32_16x16x32_bf16 v[28:31], a[92:95], v[60:63], v[28:31]
    v_mfma_f32_16x16x32_bf16 v[24:27], a[88:91], v[60:63], v[24:27]
    ds_read_b128 v[60:63], v4 offset:30976
    s_waitcnt lgkmcnt(6)
    v_mfma_f32_16x16x32_bf16 v[16:19], a[96:99], v[32:35], v[16:19]
    v_mfma_f32_16x16x32_bf16 v[20:23], a[100:103], v[32:35], v[20:23]
    v_mfma_f32_16x16x32_bf16 v[28:31], a[100:103], v[36:39], v[28:31]
    v_mfma_f32_16x16x32_bf16 v[24:27], a[96:99], v[36:39], v[24:27]
    s_waitcnt lgkmcnt(4)
    v_mfma_f32_16x16x32_bf16 v[16:19], a[104:107], v[40:43], v[16:19]
    v_mfma_f32_16x16x32_bf16 v[20:23], a[108:111], v[40:43], v[20:23]
    v_mfma_f32_16x16x32_bf16 v[28:31], a[108:111], v[44:47], v[28:31]
    v_mfma_f32_16x16x32_bf16 v[24:27], a[104:107], v[44:47], v[24:27]
    s_waitcnt lgkmcnt(2)
    v_mfma_f32_16x16x32_bf16 v[16:19], a[112:115], v[48:51], v[16:19]
    v_mfma_f32_16x16x32_bf16 v[20:23], a[116:119], v[48:51], v[20:23]
    s_cmp_eq_u32 s81, 1
    s_cbranch_scc1 L_g_h2_69
L_g_h2_69_b:
    ds_write_b32 v119, v118
    v_mfma_f32_16x16x32_bf16 v[28:31], a[116:119], v[52:55], v[28:31]
    v_mfma_f32_16x16x32_bf16 v[24:27], a[112:115], v[52:55], v[24:27]
    s_waitcnt lgkmcnt(0)
    v_mfma_f32_16x16x32_bf16 v[16:19], a[120:123], v[56:59], v[16:19]
    v_mfma_f32_16x16x32_bf16 v[20:23], a[124:127], v[56:59], v[20:23]
    v_mfma_f32_16x16x32_bf16 v[28:31], a[124:127], v[60:63], v[28:31]
    v_mfma_f32_16x16x32_bf16 v[24:27], a[120:123], v[60:63], v[24:27]
    v_xor_b32 v4, 0x10000, v4
    s_setprio 0
    s_waitcnt vmcnt(0)
    s_waitcnt lgkmcnt(0)
    s_barrier
    ds_read_b32 v14, v15
    s_nop 6
    ds_write_b128 v5, v[16:19] offset:0
    ds_write_b128 v5, v[20:23] offset:1024
    ds_write_b128 v5, v[24:27] offset:2048
    ds_write_b128 v5, v[28:31] offset:3072
    s_waitcnt lgkmcnt(4)
    v_readfirstlane_b32 s66, v14
    s_add_u32 s60, s60, 1
    s_mov_b32 s65, 0
    s_cmp_le_u32 s62, s60
    s_cbranch_scc1 L_g_dp_70_l
L_g_dp_70_a:
    s_cmp_ge_u32 s62, s66
    s_cbranch_scc1 L_g_dp_70_d
    s_add_u32 s47, s61, 4096
    s_mov_b32 m0, s64
    s_add_u32 s62, s62, 1
    buffer_load_dwordx4 v3, s[12:15], s61 offen offset:0 sc1 lds
    buffer_load_dwordx4 v3, s[12:15], s61 offen offset:1024 sc1 lds
    buffer_load_dwordx4 v3, s[12:15], s61 offen offset:2048 sc1 lds
    buffer_load_dwordx4 v3, s[12:15], s61 offen offset:3072 sc1 lds
    s_add_u32 m0, s64, 4096
    s_add_u32 s61, s61, s85
    buffer_load_dwordx4 v3, s[12:15], s47 offen offset:0 sc1 lds
    buffer_load_dwordx4 v3, s[12:15], s47 offen offset:1024 sc1 lds
    buffer_load_dwordx4 v3, s[12:15], s47 offen offset:2048 sc1 lds
    buffer_load_dwordx4 v3, s[12:15], s47 offen offset:3072 sc1 lds
    s_xor_b32 s64, s64, 0x10000
L_g_dp_70_d:
    s_cmp_le_u32 s66, s60
    s_cbranch_scc1 L_g_ex0_67
    s_cmp_lg_u32 s65, 0
    s_cbranch_scc1 L_g_nw_66
    ds_read_b128 v[32:35], v4 offset:0
    ds_read_b128 v[36:39], v4 offset:256
    ds_read_b128 v[40:43], v4 offset:2048
    ds_read_b128 v[44:47], v4 offset:2304
    ds_read_b128 v[48:51], v4 offset:4096
    ds_read_b128 v[52:55], v4 offset:4352
    ds_read_b128 v[56:59], v4 offset:6144
    ds_read_b128 v[60:63], v4 offset:6400
    s_cmp_lg_u32 s44, 0
    s_cbranch_scc1 L_g_nl_71
    s_mov_b32 s46, s66
    s_cmp_lg_u32 s81, 0
    s_cbranch_scc1 L_g_nl_71_e
    v_cmp_ge_u32 vcc, v12, v11
    s_nop 0
    s_ff1_i32_b64 s46, vcc
    s_lshr_b32 s46, s46, 4
    s_min_u32 s46, s46, 4
    s_add_u32 s46, s46, s54
    s_min_u32 s46, s46, s75
    v_mov_b32 v118, s46
L_g_nl_71_e:
    s_add_u32 s47, s60, 3
    s_min_u32 s47, s47, s75
    s_cmp_lt_u32 s46, s47
    s_cselect_b32 s81, 1, 0
    s_cbranch_scc1 L_g_nl_71
    s_add_u32 s54, s60, 2
    s_mul_i32 s55, s54, s78
    v_add_u32 v12, s55, v113
    v_and_b32 v13, 7, v12
    v_lshl_add_u32 v13, v13, 9, v7
    buffer_load_dword v11, v13, s[12:15], 0 offen sc1
L_g_nl_71:
    s_waitcnt lgkmcnt(8)
    s_branch L_g_loop0_54
L_g_ex0_67:
    s_cmp_lg_u32 s44, 0
    s_cbranch_scc1 L_g_ex0_67_n
    ds_write_b32 v15, v118 offset:20
    s_cmp_ge_u32 s60, s75
    s_cbranch_scc1 L_g_ex0_67_n
    s_sleep 6
    s_add_u32 s54, s60, 0
    s_mul_i32 s55, s54, s78
    v_add_u32 v12, s55, v113
    v_and_b32 v13, 7, v12
    v_lshl_add_u32 v13, v13, 9, v7
    buffer_load_dword v11, v13, s[12:15], 0 offen sc1
    s_waitcnt vmcnt(0)
    v_cmp_ge_u32 vcc, v12, v11
    s_nop 0
    s_ff1_i32_b64 s46, vcc
    s_lshr_b32 s46, s46, 4
    s_min_u32 s46, s46, 4
    s_add_u32 s46, s46, s54
    s_min_u32 s46, s46, s75
    v_mov_b32 v118, s46
    ds_write_b32 v15, v118 offset:20
L_g_ex0_67_n:
    s_waitcnt lgkmcnt(0)
    s_barrier
    ds_read_b32 v14, v15 offset:20
    s_waitcnt lgkmcnt(0)
    v_readfirstlane_b32 s66, v14
    s_barrier
    s_cmp_gt_u32 s66, s60
    s_cbranch_scc1 L_g_restart_51_go
    s_branch L_g_tail_56
L_g_g1r_53:
    s_mov_b32 s65, 1
    s_branch L_g_loop1_55_e
.p2align 6
L_g_loop1_55:
    s_mov_b32 s65, 0
L_g_loop1_55_e:
    s_barrier
    s_bitcmp1_b32 s67, 1
    s_cbranch_scc0 L_g_nfl_72
    s_cmp_lg_u32 s44, 4
    s_cbranch_scc1 L_g_nfl_72_d
    s_mul_i32 s59, s60, s78
    s_add_u32 s59, s59, s87
    v_mov_b32 v10, s59
    buffer_store_dword v10, v115, s[12:15], s52 offen sc1
L_g_nfl_72_d:
    ds_read_b128 v[80:83], v5 offset:0
    ds_read_b128 v[84:87], v5 offset:1024
    ds_read_b128 v[88:91], v5 offset:2048
    ds_read_b128 v[92:95], v5 offset:3072
    s_cmp_le_u32 s62, s60
    s_cbranch_scc1 L_g_dp_77_l
L_g_dp_77_a:
    s_cmp_ge_u32 s62, s66
    s_cbranch_scc1 L_g_dp_77_d
    s_add_u32 s47, s61, 4096
    s_mov_b32 m0, s64
    s_add_u32 s62, s62, 1
    buffer_load_dwordx4 v3, s[12:15], s61 offen offset:0 sc1 lds
    buffer_load_dwordx4 v3, s[12:15], s61 offen offset:1024 sc1 lds
    buffer_load_dwordx4 v3, s[12:15], s61 offen offset:2048 sc1 lds
    buffer_load_dwordx4 v3, s[12:15], s61 offen offset:3072 sc1 lds
    s_add_u32 m0, s64, 4096
    s_add_u32 s61, s61, s85
    buffer_load_dwordx4 v3, s[12:15], s47 offen offset:0 sc1 lds
    buffer_load_dwordx4 v3, s[12:15], s47 offen offset:1024 sc1 lds
    buffer_load_dwordx4 v3, s[12:15], s47 offen offset:2048 sc1 lds
    buffer_load_dwordx4 v3, s[12:15], s47 offen offset:3072 sc1 lds
    s_xor_b32 s64, s64, 0x10000
L_g_dp_77_d:
    s_bitcmp1_b32 s67, 0
    s_cbranch_scc0 L_g_nep_73
    s_waitcnt lgkmcnt(0)
    v_add_f32 v80, v80, v16
    v_add_f32 v81, v81, v17
    v_add_f32 v82, v82, v18
    v_add_f32 v83, v83, v19
    v_add_f32 v84, v84, v20
    v_add_f32 v85, v85, v21
    v_add_f32 v86, v86, v22
    v_add_f32 v87, v87, v23
    v_add_f32 v88, v88, v24
    v_add_f32 v89, v89, v25
    v_add_f32 v90, v90, v26
    v_add_f32 v91, v91, v27
    v_add_f32 v92, v92, v28
    v_add_f32 v93, v93, v29
    v_add_f32 v94, v94, v30
    v_add_f32 v95, v95, v31
    v_cvt_pk_bf16_f32 v104, v80, v81
    v_cvt_pk_bf16_f32 v105, v82, v83
    v_cvt_pk_bf16_f32 v106, v84, v85
    v_cvt_pk_bf16_f32 v107, v86, v87
    buffer_store_dwordx4 v[104:107], v8, s[12:15], s63 offen sc1
    v_cvt_pk_bf16_f32 v108, v88, v89
    v_cvt_pk_bf16_f32 v109, v90, v91
    v_cvt_pk_bf16_f32 v110, v92, v93
    v_cvt_pk_bf16_f32 v111, v94, v95
    buffer_store_dwordx4 v[108:111], v9, s[12:15], s63 offen sc1
    s_add_u32 s63, s63, s86
    s_cmp_lg_u32 s53, 2
    s_cbranch_scc1 L_g_pf_78
    s_lshl_b32 s73, s58, 1
    buffer_store_dwordx4 v[120:123], v64, s[12:15], s58 offen sc1
    buffer_store_dwordx4 v[120:123], v65, s[12:15], s73 offen sc1
    buffer_store_dwordx4 v[120:123], v68, s[12:15], s73 offen sc1
    s_add_u32 s58, s58, 131072
L_g_pf_78:
    s_cmp_le_u32 s60, 2
    s_cbranch_scc1 L_g_nep_73_e
L_g_nep_73:
    s_cmp_lg_u32 s65, 0
    s_cbranch_scc1 L_g_nw1_74
    ds_read_b128 v[32:35], v4 offset:0
    ds_read_b128 v[36:39], v4 offset:256
    ds_read_b128 v[40:43], v4 offset:2048
    ds_read_b128 v[44:47], v4 offset:2304
    ds_read_b128 v[48:51], v4 offset:4096
    ds_read_b128 v[52:55], v4 offset:4352
    ds_read_b128 v[56:59], v4 offset:6144
    ds_read_b128 v[60:63], v4 offset:6400
    s_barrier
L_g_jn_76:
    s_setprio 1
    s_waitcnt lgkmcnt(6)
    v_mfma_f32_16x16x32_bf16 v[16:19], a[0:3], v[32:35], 0
    ds_read_b32 v14, v15
    v_mfma_f32_16x16x32_bf16 v[20:23], a[4:7], v[32:35], 0
    ds_read_b128 v[32:35], v4 offset:8192
    v_mfma_f32_16x16x32_bf16 v[28:31], a[4:7], v[36:39], 0
    v_mfma_f32_16x16x32_bf16 v[24:27], a[0:3], v[36:39], 0
    ds_read_b128 v[36:39], v4 offset:8448
    s_waitcnt lgkmcnt(6)
    v_mfma_f32_16x16x32_bf16 v[16:19], a[8:11], v[40:43], v[16:19]
    v_mfma_f32_16x16x32_bf16 v[20:23], a[12:15], v[40:43], v[20:23]
    ds_read_b128 v[40:43], v4 offset:10240
    v_mfma_f32_16x16x32_bf16 v[28:31], a[12:15], v[44:47], v[28:31]
    v_mfma_f32_16x16x32_bf16 v[24:27], a[8:11], v[44:47], v[24:27]
    ds_read_b128 v[44:47], v4 offset:10496
    s_waitcnt lgkmcnt(6)
    v_mfma_f32_16x16x32_bf16 v[16:19], a[16:19], v[48:51], v[16:19]
    v_mfma_f32_16x16x32_bf16 v[20:23], a[20:23], v[48:51], v[20:23]
    ds_read_b128 v[48:51], v4 offset:12288
    v_mfma_f32_16x16x32_bf16 v[28:31], a[20:23], v[52:55], v[28:31]
    v_mfma_f32_16x16x32_bf16 v[24:27], a[16:19], v[52:55], v[24:27]
    ds_read_b128 v[52:55], v4 offset:12544
    s_waitcnt lgkmcnt(6)
    v_mfma_f32_16x16x32_bf16 v[16:19], a[24:27], v[56:59], v[16:19]
    v_mfma_f32_16x16x32_bf16 v[20:23], a[28:31], v[56:59], v[20:23]
    ds_read_b128 v[56:59], v4 offset:14336
    v_mfma_f32_16x16x32_bf16 v[28:31], a[28:31], v[60:63], v[28:31]
    v_mfma_f32_16x16x32_bf16 v[24:27], a[24:27], v[60:63], v[24:27]
    ds_read_b128 v[60:63], v4 offset:14592
    s_waitcnt lgkmcnt(6)
    v_mfma_f32_16x16x32_bf16 v[16:19], a[32:35], v[32:35], v[16:19]
    v_mfma_f32_16x16x32_bf16 v[20:23], a[36:39], v[32:35], v[20:23]
    ds_read_b128 v[32:35], v4 offset:16384
    v_mfma_f32_16x16x32_bf16 v[28:31], a[36:39], v[36:39], v[28:31]
    v_mfma_f32_16x16x32_bf16 v[24:27], a[32:35], v[36:39], v[24:27]
    ds_read_b128 v[36:39], v4 offset:16640
    s_waitcnt lgkmcnt(6)
    v_mfma_f32_16x16x32_bf16 v[16:19], a[40:43], v[40:43], v[16:19]
    v_mfma_f32_16x16x32_bf16 v[20:23], a[44:47], v[40:43], v[20:23]
    ds_read_b128 v[40:43], v4 offset:18432
    v_mfma_f32_16x16x32_bf16 v[28:31], a[44:47], v[44:47], v[28:31]
    v_mfma_f32_16x16x32_bf16 v[24:27], a[40:43], v[44:47], v[24:27]
    ds_read_b128 v[44:47], v4 offset:18688
    s_waitcnt lgkmcnt(6)
    v_mfma_f32_16x16x32_bf16 v[16:19], a[48:51], v[48:51], v[16:19]
    v_mfma_f32_16x16x32_bf16 v[20:23], a[52:55], v[48:51], v[20:23]
    ds_read_b128 v[48:51], v4 offset:20480
    v_mfma_f32_16x16x32_bf16 v[28:31], a[52:55], v[52:55], v[28:31]
    v_mfma_f32_16x16x32_bf16 v[24:27], a[48:51], v[52:55], v[24:27]
    ds_read_b128 v[52:55], v4 offset:20736
    s_waitcnt lgkmcnt(6)
    v_mfma_f32_16x16x32_bf16 v[16:19], a[56:59], v[56:59], v[16:19]
    v_mfma_f32_16x16x32_bf16 v[20:23], a[60:63], v[56:59], v[20:23]
    ds_read_b128 v[56:59], v4 offset:22528
    v_mfma_f32_16x16x32_bf16 v[28:31], a[60:63], v[60:63], v[28:31]
    v_mfma_f32_16x16x32_bf16 v[24:27], a[56:59], v[60:63], v[24:27]
    ds_read_b128 v[60:63], v4 offset:22784
    s_waitcnt lgkmcnt(6)
    v_mfma_f32_16x16x32_bf16 v[16:19], a[64:67], v[32:35], v[16:19]
    v_mfma_f32_16x16x32_bf16 v[20:23], a[68:71], v[32:35], v[20:23]
    ds_read_b128 v[32:35], v4 offset:24576
    v_mfma_f32_16x16x32_bf16 v[28:31], a[68:71], v[36:39], v[28:31]
    v_mfma_f32_16x16x32_bf16 v[24:27], a[64:67], v[36:39], v[24:27]
    ds_read_b128 v[36:39], v4 offset:24832
    s_waitcnt lgkmcnt(6)
    v_mfma_f32_16x16x32_bf16 v[16:19], a[72:75], v[40:43], v[16:19]
    v_mfma_f32_16x16x32_bf16 v[20:23], a[76:79], v[40:43], v[20:23]
    ds_read_b128 v[40:43], v4 offset:26624
    v_mfma_f32_16x16x32_bf16 v[28:31], a[76:79], v[44:47], v[28:31]
    v_mfma_f32_16x16x32_bf16 v[24:27], a[72:75], v[44:47], v[24:27]
    ds_read_b128 v[44:47], v4 offset:26880
    s_waitcnt lgkmcnt(6)
    v_mfma_f32_16x16x32_bf16 v[16:19], a[80:83], v[48:51], v[16:19]
    v_mfma_f32_16x16x32_bf16 v[20:23], a[84:87], v[48:51], v[20:23]
    ds_read_b128 v[48:51], v4 offset:28672
    v_mfma_f32_16x16x32_bf16 v[28:31], a[84:87], v[52:55], v[28:31]
    v_mfma_f32_16x16x32_bf16 v[24:27], a[80:83], v[52:55], v[24:27]
    ds_read_b128 v[52:55], v4 offset:28928
    s_waitcnt lgkmcnt(6)
    v_mfma_f32_16x16x32_bf16 v[16:19], a[88:91], v[56:59], v[16:19]
    v_mfma_f32_16x16x32_bf16 v[20:23], a[92:95], v[56:59], v[20:23]
    ds_read_b128 v[56:59], v4 offset:30720
    v_mfma_f32_16x16x32_bf16 v[28:31], a[92:95], v[60:63], v[28:31]
    v_mfma_f32_16x16x32_bf16 v[24:27], a[88:91], v[60:63], v[24:27]
    ds_read_b128 v[60:63], v4 offset:30976
    s_waitcnt lgkmcnt(6)
    v_mfma_f32_16x16x32_bf16 v[16:19], a[96:99], v[32:35], v[16:19]
    v_mfma_f32_16x16x32_bf16 v[20:23], a[100:103], v[32:35], v[20:23]
    v_mfma_f32_16x16x32_bf16 v[28:31], a[100:103], v[36:39], v[28:31]
    v_mfma_f32_16x16x32_bf16 v[24:27], a[96:99], v[36:39], v[24:27]
    s_waitcnt lgkmcnt(4)
    v_mfma_f32_16x16x32_bf16 v[16:19], a[104:107], v[40:43], v[16:19]
    v_mfma_f32_16x16x32_bf16 v[20:23], a[108:111], v[40:43], v[20:23]
    v_mfma_f32_16x16x32_bf16 v[28:31], a[108:111], v[44:47], v[28:31]
    v_mfma_f32_16x16x32_bf16 v[24:27], a[104:107], v[44:47], v[24:27]
    s_waitcnt lgkmcnt(2)
    v_mfma_f32_16x16x32_bf16 v[16:19], a[112:115], v[48:51], v[16:19]
    v_mfma_f32_16x16x32_bf16 v[20:23], a[116:119], v[48:51], v[20:23]
    v_mfma_f32_16x16x32_bf16 v[28:31], a[116:119], v[52:55], v[28:31]
    v_mfma_f32_16x16x32_bf16 v[24:27], a[112:115], v[52:55], v[24:27]
    s_waitcnt lgkmcnt(0)
    v_mfma_f32_16x16x32_bf16 v[16:19], a[120:123], v[56:59], v[16:19]
    v_mfma_f32_16x16x32_bf16 v[20:23], a[124:127], v[56:59], v[20:23]
    v_mfma_f32_16x16x32_bf16 v[28:31], a[124:127], v[60:63], v[28:31]
    v_mfma_f32_16x16x32_bf16 v[24:27], a[120:123], v[60:63], v[24:27]
    v_xor_b32 v4, 0x10000, v4
    s_setprio 0
    s_waitcnt vmcnt(0)
    v_readfirstlane_b32 s66, v14
    s_lshl_b32 s67, s67, 1
    s_or_b32 s67, s67, 1
    s_add_u32 s60, s60, 1
    s_cmp_gt_u32 s66, s60
    s_cbranch_scc1 L_g_loop1_55
    s_barrier
    ds_read_b32 v14, v15 offset:20
    ds_read_b128 v[80:83], v5 offset:0
    ds_read_b128 v[84:87], v5 offset:1024
    ds_read_b128 v[88:91], v5 offset:2048
    ds_read_b128 v[92:95], v5 offset:3072
    s_waitcnt lgkmcnt(4)
    v_readfirstlane_b32 s66, v14
    s_barrier
    s_mov_b32 s69, 0
    s_cmp_gt_u32 s62, s60
    s_cbranch_scc1 L_g_nd_79
    s_cmp_ge_u32 s62, s66
    s_cbranch_scc1 L_g_nd_79
    s_add_u32 s47, s61, 4096
    s_add_u32 m0, s64, 0
    s_nop 0
    buffer_load_dwordx4 v3, s[12:15], s61 offen offset:0 sc1 lds
    buffer_load_dwordx4 v3, s[12:15], s61 offen offset:1024 sc1 lds
    buffer_load_dwordx4 v3, s[12:15], s61 offen offset:2048 sc1 lds
    buffer_load_dwordx4 v3, s[12:15], s61 offen offset:3072 sc1 lds
    s_add_u32 m0, s64, 4096
    s_nop 0
    buffer_load_dwordx4 v3, s[12:15], s47 offen offset:0 sc1 lds
    buffer_load_dwordx4 v3, s[12:15], s47 offen offset:1024 sc1 lds
    buffer_load_dwordx4 v3, s[12:15], s47 offen offset:2048 sc1 lds
    buffer_load_dwordx4 v3, s[12:15], s47 offen offset:3072 sc1 lds
    s_add_u32 s61, s61, s85
    s_add_u32 s62, s62, 1
    s_xor_b32 s64, s64, 0x10000
    s_mov_b32 s69, 1
L_g_nd_79:
    s_waitcnt lgkmcnt(3)
    v_add_f32 v80, v80, v16
    v_add_f32 v81, v81, v17
    v_add_f32 v82, v82, v18
    v_add_f32 v83, v83, v19
    s_waitcnt lgkmcnt(2)
    v_add_f32 v84, v84, v20
    v_add_f32 v85, v85, v21
    v_add_f32 v86, v86, v22
    v_add_f32 v87, v87, v23
    s_waitcnt lgkmcnt(1)
    v_add_f32 v88, v88, v24
    v_add_f32 v89, v89, v25
    v_add_f32 v90, v90, v26
    v_add_f32 v91, v91, v27
    s_waitcnt lgkmcnt(0)
    v_add_f32 v92, v92, v28
    v_add_f32 v93, v93, v29
    v_add_f32 v94, v94, v30
    v_add_f32 v95, v95, v31
    v_cvt_pk_bf16_f32 v104, v80, v81
    v_cvt_pk_bf16_f32 v105, v82, v83
    v_cvt_pk_bf16_f32 v106, v84, v85
    v_cvt_pk_bf16_f32 v107, v86, v87
    buffer_store_dwordx4 v[104:107], v8, s[12:15], s63 offen sc1
    v_cvt_pk_bf16_f32 v108, v88, v89
    v_cvt_pk_bf16_f32 v109, v90, v91
    v_cvt_pk_bf16_f32 v110, v92, v93
    v_cvt_pk_bf16_f32 v111, v94, v95
    buffer_store_dwordx4 v[108:111], v9, s[12:15], s63 offen sc1
    s_add_u32 s63, s63, s86
    s_cmp_lg_u32 s53, 2
    s_cbranch_scc1 L_g_pf_80
    s_lshl_b32 s73, s58, 1
    buffer_store_dwordx4 v[120:123], v64, s[12:15], s58 offen sc1
    buffer_store_dwordx4 v[120:123], v65, s[12:15], s73 offen sc1
    buffer_store_dwordx4 v[120:123], v68, s[12:15], s73 offen sc1
    s_add_u32 s58, s58, 131072
L_g_pf_80:
    s_mov_b32 s67, 0
    s_mov_b32 s71, 1
    s_cmp_gt_u32 s66, s60
    s_cbranch_scc1 L_g_g1r_53
    v_mov_b32 v10, 1
    s_mov_b64 exec, 1
    s_waitcnt vmcnt(0)
    ds_add_rtn_u32 v10, v15, v10 offset:4
    s_waitcnt lgkmcnt(0)
    v_readfirstlane_b32 s46, v10
    s_mov_b64 exec, -1
    s_mov_b32 s71, 0
    s_sub_u32 s59, s60, 1
    s_mul_i32 s59, s59, s78
    s_add_u32 s59, s59, s74
    s_cmp_lg_u32 s46, s68
    s_cbranch_scc1 L_g_df_81
    v_mov_b32 v10, s59
    v_add_u32 v10, 1, v10
    v_mov_b32 v11, 0
    s_mov_b64 exec, 1
    buffer_store_dword v10, v11, s[12:15], s52 offen sc1
    s_mov_b64 exec, -1
L_sf_82:
L_g_df_81:
    s_add_u32 s68, s68, 4
    s_cmp_gt_u32 s66, s60
    s_cbranch_scc1 L_g_g1r_53
L_g_tail_56:
    s_cmp_lt_u32 s60, s75
    s_cbranch_scc1 L_g_restart_51
    s_waitcnt vmcnt(0)
    s_barrier
    s_branch L_w_p2_11
L_g_h1_68:
    s_add_u32 s54, s60, 1
    s_mul_i32 s55, s54, s78
    v_add_u32 v12, s55, v113
    v_and_b32 v13, 7, v12
    v_lshl_add_u32 v13, v13, 9, v7
    buffer_load_dword v11, v13, s[12:15], 0 offen sc1
    s_branch L_g_h1_68_b
L_g_h2_69:
    s_waitcnt vmcnt(0)
    v_cmp_ge_u32 vcc, v12, v11
    s_nop 0
    s_ff1_i32_b64 s46, vcc
    s_lshr_b32 s46, s46, 4
    s_min_u32 s46, s46, 4
    s_add_u32 s46, s46, s54
    s_min_u32 s46, s46, s75
    v_mov_b32 v118, s46
    s_branch L_g_h2_69_b
L_g_dp_70_l:
    s_cmp_ge_u32 s62, s66
    s_cbranch_scc1 L_g_dp_70_d
    s_mov_b32 s65, 1
    s_add_u32 s47, s61, 4096
    s_mov_b32 m0, s64
    s_add_u32 s62, s62, 1
    buffer_load_dwordx4 v3, s[12:15], s61 offen offset:0 sc1 lds
    buffer_load_dwordx4 v3, s[12:15], s61 offen offset:1024 sc1 lds
    buffer_load_dwordx4 v3, s[12:15], s61 offen offset:2048 sc1 lds
    buffer_load_dwordx4 v3, s[12:15], s61 offen offset:3072 sc1 lds
    s_add_u32 m0, s64, 4096
    s_add_u32 s61, s61, s85
    buffer_load_dwordx4 v3, s[12:15], s47 offen offset:0 sc1 lds
    buffer_load_dwordx4 v3, s[12:15], s47 offen offset:1024 sc1 lds
    buffer_load_dwordx4 v3, s[12:15], s47 offen offset:2048 sc1 lds
    buffer_load_dwordx4 v3, s[12:15], s47 offen offset:3072 sc1 lds
    s_xor_b32 s64, s64, 0x10000
    s_branch L_g_dp_70_a
L_g_nw_66:
    s_waitcnt vmcnt(0) lgkmcnt(0)
    s_cmp_lg_u32 s44, 0
    s_cbranch_scc1 L_g_nl_83
    s_cmp_lt_u32 s66, s75
    s_cselect_b32 s81, 1, 2
L_g_nl_83:
    s_branch L_g_loop0_54_l
L_g_nfl_72:
    s_cmp_eq_u32 s71, 0
    s_cbranch_scc1 L_g_nfl_72_d
    v_mov_b32 v10, 1
    s_mov_b64 exec, 1
    s_waitcnt vmcnt(0)
    ds_add_rtn_u32 v10, v15, v10 offset:4
    s_waitcnt lgkmcnt(0)
    v_readfirstlane_b32 s46, v10
    s_mov_b64 exec, -1
    s_mov_b32 s71, 0
    s_sub_u32 s59, s60, 1
    s_mul_i32 s59, s59, s78
    s_add_u32 s59, s59, s74
    s_cmp_lg_u32 s46, s68
    s_cbranch_scc1 L_g_df_84
    v_mov_b32 v10, s59
    v_add_u32 v10, 1, v10
    v_mov_b32 v11, 0
    s_mov_b64 exec, 1
    buffer_store_dword v10, v11, s[12:15], s52 offen sc1
    s_mov_b64 exec, -1
L_sf_85:
L_g_df_84:
    s_add_u32 s68, s68, 4
    s_mov_b32 s65, 2
    s_branch L_g_nfl_72_d
L_g_dp_77_l:
    s_cmp_ge_u32 s62, s66
    s_cbranch_scc1 L_g_dp_77_d
    s_or_b32 s65, s65, 1
    s_add_u32 s47, s61, 4096
    s_mov_b32 m0, s64
    s_add_u32 s62, s62, 1
    buffer_load_dwordx4 v3, s[12:15], s61 offen offset:0 sc1 lds
    buffer_load_dwordx4 v3, s[12:15], s61 offen offset:1024 sc1 lds
    buffer_load_dwordx4 v3, s[12:15], s61 offen offset:2048 sc1 lds
    buffer_load_dwordx4 v3, s[12:15], s61 offen offset:3072 sc1 lds
    s_add_u32 m0, s64, 4096
    s_add_u32 s61, s61, s85
    buffer_load_dwordx4 v3, s[12:15], s47 offen offset:0 sc1 lds
    buffer_load_dwordx4 v3, s[12:15], s47 offen offset:1024 sc1 lds
    buffer_load_dwordx4 v3, s[12:15], s47 offen offset:2048 sc1 lds
    buffer_load_dwordx4 v3, s[12:15], s47 offen offset:3072 sc1 lds
    s_xor_b32 s64, s64, 0x10000
    s_branch L_g_dp_77_a
L_g_nep_73_e:
    v_mov_b32 v10, 1
    s_mov_b64 exec, 1
    s_waitcnt vmcnt(0)
    ds_add_rtn_u32 v10, v15, v10 offset:4
    s_waitcnt lgkmcnt(0)
    v_readfirstlane_b32 s46, v10
    s_mov_b64 exec, -1
    s_mov_b32 s71, 0
    s_sub_u32 s59, s60, 1
    s_mul_i32 s59, s59, s78
    s_add_u32 s59, s59, s74
    s_cmp_lg_u32 s46, s68
    s_cbranch_scc1 L_g_df_86
    v_mov_b32 v10, s59
    v_add_u32 v10, 1, v10
    v_mov_b32 v11, 0
    s_mov_b64 exec, 1
    buffer_store_dword v10, v11, s[12:15], s52 offen sc1
    s_mov_b64 exec, -1
L_sf_87:
L_g_df_86:
    s_add_u32 s68, s68, 4
    s_branch L_g_nep_73
L_g_nw1_74:
    s_cmp_eq_u32 s65, 2
    s_cbranch_scc1 L_g_nw1_74_w
    s_waitcnt vmcnt(0)
L_g_nw1_74_w:
    s_barrier
    ds_read_b128 v[32:35], v4 offset:0
    ds_read_b128 v[36:39], v4 offset:256
    ds_read_b128 v[40:43], v4 offset:2048
    ds_read_b128 v[44:47], v4 offset:2304
    ds_read_b128 v[48:51], v4 offset:4096
    ds_read_b128 v[52:55], v4 offset:4352
    ds_read_b128 v[56:59], v4 offset:6144
    ds_read_b128 v[60:63], v4 offset:6400
    s_branch L_g_jn_76
L_w_p2_11:
    s_cmp_lg_u32 s44, 0
    s_cbranch_scc1 L_w_p2_11_h
    s_mov_b32 s47, 63
    s_cmp_eq_u32 s53, 0
    s_cbranch_scc1 L_w_p2_11_q
    s_sub_u32 s52, s52, s76
    v_mov_b32 v10, 1
    v_mov_b32 v11, 131072
    s_mov_b64 exec, 1
    buffer_atomic_add v10, v11, s[12:15], s52 offen sc0
    s_waitcnt vmcnt(0)
    v_readfirstlane_b32 s46, v10
    s_mov_b64 exec, -1
    s_mov_b32 s47, 63
    s_nop 1
    s_cmp_eq_u32 s46, 0
    s_cbranch_scc1 L_w_p2_11_h
L_w_p2_11_q:
    v_mov_b32 v10, s47
    v_add_u32 v10, 1, v10
    v_mov_b32 v11, 0
    s_mov_b64 exec, 1
    buffer_store_dword v10, v11, s[12:15], s52 offen sc1
    s_mov_b64 exec, -1
L_sf_88:
L_w_p2_11_h:
    s_cmp_eq_u32 s76, 0
    s_cbranch_scc1 L_w_p2_11_m
    s_cmp_eq_u32 s79, 1
    s_cbranch_scc1 L_w_h_17
    s_mov_b32 s79, 1
    s_cmp_lt_u32 s77, 14
    s_cselect_b32 s53, 2, s53
    s_cselect_b32 s48, s48, 3
    s_branch L_w_h_17_n
L_w_p2_11_m:
    s_cmp_lt_u32 s48, 8
    s_cselect_b32 s75, 58, 58
    s_cmp_lt_u32 s48, 4
    s_cselect_b32 s75, 64, s75
L_w_p2_11_r:
    s_lshr_b32 s42, s40, 1
    s_and_b32 s43, s40, 1
    s_lshl_b32 s43, s43, 2
    s_and_b32 s46, s48, 3
    s_add_u32 s43, s43, s46
    s_cmp_lt_u32 s48, 4
    s_cbranch_scc1 L_w_wo_12
    s_cmp_lt_u32 s48, 8
    s_cbranch_scc1 L_w_f2_13
    s_cmp_lg_u32 s43, 7
    s_cbranch_scc1 L_w_f1_14
    s_mov_b32 s43, 2
    s_cmp_eq_u32 s76, 0
    s_cbranch_scc1 L_w_c_16
    s_mov_b32 s43, 7
    s_mov_b32 s78, 2
L_w_f1_14_t:
    s_cmp_lt_u32 s41, 8
    s_cselect_b32 s74, 58, 59
    s_cselect_b32 s75, 64, 64
    s_lshl_b32 s43, s43, 1
    s_add_u32 s43, s43, s74
    s_cmp_lt_u32 s43, s75
    s_cbranch_scc1 L_w_h_17_f
    s_branch L_c_done_1
L_w_f1_14_d:
    s_cmp_eq_u32 s76, 0
    s_cbranch_scc1 L_c_done_1
    s_and_b32 s42, s49, 3
    s_lshr_b32 s43, s49, 2
    s_mov_b32 s78, 64
    s_branch L_w_f1_14_t
L_replica:
    s_setprio 0
    s_barrier
    s_and_b32 s48, s41, 7
    s_add_u32 s48, s48, 4
    s_cmp_lt_u32 s41, 8
    s_cselect_b32 s74, 58, 59
    s_cselect_b32 s75, 64, 64
    s_cselect_b32 s76, 1, 2
    s_cselect_b32 s46, 58, 59
    s_cselect_b32 s47, 64, 64
    s_mov_b32 s78, 2
    s_mul_i32 s76, s76, 65536
    s_cmp_lt_u32 s48, 8
    s_cselect_b32 s74, s46, s74
    s_cselect_b32 s75, s47, s75
    s_branch L_w_p2_11_r
L_w_f1_14:
    s_load_dwordx2 s[4:5], s[0:1], 64
    s_load_dwordx2 s[6:7], s[0:1], 72
    s_and_b32 s50, s44, 3
    s_lshr_b32 s51, s44, 2
    s_waitcnt lgkmcnt(0)
    s_mov_b32 s24, s4
    s_and_b32 s25, s5, 0xffff
    s_mov_b32 s26, 0x700000
    s_mov_b32 s27, 0x00020000
    s_mul_i32 s49, s42, 7
    s_add_u32 s49, s49, s43
    v_lshrrev_b32 v3, 4, v1
    v_and_b32 v4, 15, v1
    v_lshlrev_b32 v5, 2, v3
    v_xor_b32 v4, v4, v5
    v_mul_u32_u24 v3, 7168, v3
    v_lshl_add_u32 v3, v4, 4, v3
    s_mul_i32 s46, s51, 512
    s_mul_i32 s47, s50, 16
    s_add_u32 s46, s46, s47
    s_mul_i32 s46, s46, 7168
    s_lshl_b32 s47, s49, 8
    s_add_u32 s46, s46, s47
    s_lshl_b32 s45, s51, 16
    s_mul_i32 s47, s50, 4096
    s_add_u32 s45, s45, s47
    v_bfe_u32 v4, v1, 2, 2
    v_bfe_u32 v5, v1, 4, 1
    v_lshlrev_b32 v5, 1, v5
    v_bfe_u32 v6, v1, 1, 1
    v_add_u32 v5, v5, v6
    s_lshl_b32 s47, s50, 2
    v_add_u32 v5, s47, v5
    v_lshlrev_b32 v6, 2, v4
    v_xor_b32 v5, v5, v6
    v_lshlrev_b32 v5, 4, v5
    v_lshl_add_u32 v5, v4, 8, v5
    v_bfe_u32 v6, v1, 0, 1
    v_lshl_add_u32 v5, v6, 3, v5
    v_lshrrev_b32 v6, 5, v1
    v_mul_u32_u24 v6, 2048, v6
    v_add_u32 v5, v5, v6
    s_lshl_b32 s47, s51, 16
    v_add_u32 v5, s47, v5
    s_add_u32 m0, s45, 0
    s_add_u32 s47, s46, 0x0
    buffer_load_dwordx4 v3, s[24:27], s47 offen  lds
    s_add_u32 m0, s45, 1024
    s_add_u32 s47, s46, 0x7000
    buffer_load_dwordx4 v3, s[24:27], s47 offen  lds
    s_add_u32 m0, s45, 2048
    s_add_u32 s47, s46, 0xe000
    buffer_load_dwordx4 v3, s[24:27], s47 offen  lds
    s_add_u32 m0, s45, 3072
    s_add_u32 s47, s46, 0x15000
    buffer_load_dwordx4 v3, s[24:27], s47 offen  lds
    s_add_u32 m0, s45, 16384
    s_add_u32 s47, s46, 0x70000
    buffer_load_dwordx4 v3, s[24:27], s47 offen  lds
    s_add_u32 m0, s45, 17408
    s_add_u32 s47, s46, 0x77000
    buffer_load_dwordx4 v3, s[24:27], s47 offen  lds
    s_add_u32 m0, s45, 18432
    s_add_u32 s47, s46, 0x7e000
    buffer_load_dwordx4 v3, s[24:27], s47 offen  lds
    s_add_u32 m0, s45, 19456
    s_add_u32 s47, s46, 0x85000
    buffer_load_dwordx4 v3, s[24:27], s47 offen  lds
    s_add_u32 m0, s45, 32768
    s_add_u32 s47, s46, 0xe0000
    buffer_load_dwordx4 v3, s[24:27], s47 offen  lds
    s_add_u32 m0, s45, 33792
    s_add_u32 s47, s46, 0xe7000
    buffer_load_dwordx4 v3, s[24:27], s47 offen  lds
    s_add_u32 m0, s45, 34816
    s_add_u32 s47, s46, 0xee000
    buffer_load_dwordx4 v3, s[24:27], s47 offen  lds
    s_add_u32 m0, s45, 35840
    s_add_u32 s47, s46, 0xf5000
    buffer_load_dwordx4 v3, s[24:27], s47 offen  lds
    s_add_u32 m0, s45, 49152
    s_add_u32 s47, s46, 0x150000
    buffer_load_dwordx4 v3, s[24:27], s47 offen  lds
    s_add_u32 m0, s45, 50176
    s_add_u32 s47, s46, 0x157000
    buffer_load_dwordx4 v3, s[24:27], s47 offen  lds
    s_add_u32 m0, s45, 51200
    s_add_u32 s47, s46, 0x15e000
    buffer_load_dwordx4 v3, s[24:27], s47 offen  lds
    s_add_u32 m0, s45, 52224
    s_add_u32 s47, s46, 0x165000
    buffer_load_dwordx4 v3, s[24:27], s47 offen  lds
    s_waitcnt vmcnt(12) lgkmcnt(0)
    s_barrier
    ds_read_b64_tr_b16 a[0:1], v5 offset:0
    ds_read_b64_tr_b16 a[2:3], v5 offset:1024
    ds_read_b64_tr_b16 a[4:5], v5 offset:4096
    ds_read_b64_tr_b16 a[6:7], v5 offset:5120
    ds_read_b64_tr_b16 a[8:9], v5 offset:8192
    ds_read_b64_tr_b16 a[10:11], v5 offset:9216
    ds_read_b64_tr_b16 a[12:13], v5 offset:12288
    ds_read_b64_tr_b16 a[14:15], v5 offset:13312
    s_waitcnt vmcnt(8) lgkmcnt(0)
    s_barrier
    s_add_u32 m0, s45, 0
    s_add_u32 s47, s46, 0x1c0000
    buffer_load_dwordx4 v3, s[24:27], s47 offen  lds
    s_add_u32 m0, s45, 1024
    s_add_u32 s47, s46, 0x1c7000
    buffer_load_dwordx4 v3, s[24:27], s47 offen  lds
    s_add_u32 m0, s45, 2048
    s_add_u32 s47, s46, 0x1ce000
    buffer_load_dwordx4 v3, s[24:27], s47 offen  lds
    s_add_u32 m0, s45, 3072
    s_add_u32 s47, s46, 0x1d5000
    buffer_load_dwordx4 v3, s[24:27], s47 offen  lds
    ds_read_b64_tr_b16 a[16:17], v5 offset:16384
    ds_read_b64_tr_b16 a[18:19], v5 offset:17408
    ds_read_b64_tr_b16 a[20:21], v5 offset:20480
    ds_read_b64_tr_b16 a[22:23], v5 offset:21504
    ds_read_b64_tr_b16 a[24:25], v5 offset:24576
    ds_read_b64_tr_b16 a[26:27], v5 offset:25600
    ds_read_b64_tr_b16 a[28:29], v5 offset:28672
    ds_read_b64_tr_b16 a[30:31], v5 offset:29696
    s_waitcnt vmcnt(8) lgkmcnt(0)
    s_barrier
    s_add_u32 m0, s45, 16384
    s_add_u32 s47, s46, 0x230000
    buffer_load_dwordx4 v3, s[24:27], s47 offen  lds
    s_add_u32 m0, s45, 17408
    s_add_u32 s47, s46, 0x237000
    buffer_load_dwordx4 v3, s[24:27], s47 offen  lds
    s_add_u32 m0, s45, 18432
    s_add_u32 s47, s46, 0x23e000
    buffer_load_dwordx4 v3, s[24:27], s47 offen  lds
    s_add_u32 m0, s45, 19456
    s_add_u32 s47, s46, 0x245000
    buffer_load_dwordx4 v3, s[24:27], s47 offen  lds
    ds_read_b64_tr_b16 a[32:33], v5 offset:32768
    ds_read_b64_tr_b16 a[34:35], v5 offset:33792
    ds_read_b64_tr_b16 a[36:37], v5 offset:36864
    ds_read_b64_tr_b16 a[38:39], v5 offset:37888
    ds_read_b64_tr_b16 a[40:41], v5 offset:40960
    ds_read_b64_tr_b16 a[42:43], v5 offset:41984
    ds_read_b64_tr_b16 a[44:45], v5 offset:45056
    ds_read_b64_tr_b16 a[46:47], v5 offset:46080
    s_waitcnt vmcnt(8) lgkmcnt(0)
    s_barrier
    s_add_u32 m0, s45, 32768
    s_add_u32 s47, s46, 0x2a0000
    buffer_load_dwordx4 v3, s[24:27], s47 offen  lds
    s_add_u32 m0, s45, 33792
    s_add_u32 s47, s46, 0x2a7000
    buffer_load_dwordx4 v3, s[24:27], s47 offen  lds
    s_add_u32 m0, s45, 34816
    s_add_u32 s47, s46, 0x2ae000
    buffer_load_dwordx4 v3, s[24:27], s47 offen  lds
    s_add_u32 m0, s45, 35840
    s_add_u32 s47, s46, 0x2b5000
    buffer_load_dwordx4 v3, s[24:27], s47 offen  lds
    ds_read_b64_tr_b16 a[48:49], v5 offset:49152
    ds_read_b64_tr_b16 a[50:51], v5 offset:50176
    ds_read_b64_tr_b16 a[52:53], v5 offset:53248
    ds_read_b64_tr_b16 a[54:55], v5 offset:54272
    ds_read_b64_tr_b16 a[56:57], v5 offset:57344
    ds_read_b64_tr_b16 a[58:59], v5 offset:58368
    ds_read_b64_tr_b16 a[60:61], v5 offset:61440
    ds_read_b64_tr_b16 a[62:63], v5 offset:62464
    s_waitcnt vmcnt(8) lgkmcnt(0)
    s_barrier
    s_add_u32 m0, s45, 49152
    s_add_u32 s47, s46, 0x310000
    buffer_load_dwordx4 v3, s[24:27], s47 offen  lds
    s_add_u32 m0, s45, 50176
    s_add_u32 s47, s46, 0x317000
    buffer_load_dwordx4 v3, s[24:27], s47 offen  lds
    s_add_u32 m0, s45, 51200
    s_add_u32 s47, s46, 0x31e000
    buffer_load_dwordx4 v3, s[24:27], s47 offen  lds
    s_add_u32 m0, s45, 52224
    s_add_u32 s47, s46, 0x325000
    buffer_load_dwordx4 v3, s[24:27], s47 offen  lds
    ds_read_b64_tr_b16 a[64:65], v5 offset:0
    ds_read_b64_tr_b16 a[66:67], v5 offset:1024
    ds_read_b64_tr_b16 a[68:69], v5 offset:4096
    ds_read_b64_tr_b16 a[70:71], v5 offset:5120
    ds_read_b64_tr_b16 a[72:73], v5 offset:8192
    ds_read_b64_tr_b16 a[74:75], v5 offset:9216
    ds_read_b64_tr_b16 a[76:77], v5 offset:12288
    ds_read_b64_tr_b16 a[78:79], v5 offset:13312
    s_waitcnt vmcnt(8) lgkmcnt(0)
    s_barrier
    ds_read_b64_tr_b16 a[80:81], v5 offset:16384
    ds_read_b64_tr_b16 a[82:83], v5 offset:17408
    ds_read_b64_tr_b16 a[84:85], v5 offset:20480
    ds_read_b64_tr_b16 a[86:87], v5 offset:21504
    ds_read_b64_tr_b16 a[88:89], v5 offset:24576
    ds_read_b64_tr_b16 a[90:91], v5 offset:25600
    ds_read_b64_tr_b16 a[92:93], v5 offset:28672
    ds_read_b64_tr_b16 a[94:95], v5 offset:29696
    s_waitcnt vmcnt(4) lgkmcnt(0)
    s_barrier
    ds_read_b64_tr_b16 a[96:97], v5 offset:32768
    ds_read_b64_tr_b16 a[98:99], v5 offset:33792
    ds_read_b64_tr_b16 a[100:101], v5 offset:36864
    ds_read_b64_tr_b16 a[102:103], v5 offset:37888
    ds_read_b64_tr_b16 a[104:105], v5 offset:40960
    ds_read_b64_tr_b16 a[106:107], v5 offset:41984
    ds_read_b64_tr_b16 a[108:109], v5 offset:45056
    ds_read_b64_tr_b16 a[110:111], v5 offset:46080
    s_waitcnt vmcnt(0) lgkmcnt(0)
    s_barrier
    ds_read_b64_tr_b16 a[112:113], v5 offset:49152
    ds_read_b64_tr_b16 a[114:115], v5 offset:50176
    ds_read_b64_tr_b16 a[116:117], v5 offset:53248
    ds_read_b64_tr_b16 a[118:119], v5 offset:54272
    ds_read_b64_tr_b16 a[120:121], v5 offset:57344
    ds_read_b64_tr_b16 a[122:123], v5 offset:58368
    ds_read_b64_tr_b16 a[124:125], v5 offset:61440
    ds_read_b64_tr_b16 a[126:127], v5 offset:62464
    s_waitcnt lgkmcnt(0)
    s_barrier
    v_lshlrev_b32 v2, 4, v1
    s_mul_i32 s64, s44, 8192
    s_add_u32 s46, s64, 0xc00000
    v_add_u32 v3, s46, v2
    s_mul_i32 s46, s51, 32768
    v_add_u32 v4, s46, v2
    v_and_b32 v6, 15, v1
    v_lshlrev_b32 v6, 4, v6
    v_lshrrev_b32 v7, 4, v1
    v_lshl_add_u32 v6, v7, 9, v6
    s_lshl_b32 s46, s50, 12
    s_add_u32 s46, s46, 131072
    v_add_u32 v5, s46, v2
    v_and_b32 v7, 3, v1
    v_lshlrev_b32 v7, 7, v7
    v_add_u32 v7, 0x10ec00, v7
    s_lshl_b32 s46, s49, 13
    s_lshl_b32 s47, s50, 11
    s_add_u32 s46, s46, s47
    s_add_u32 s46, s46, 0x6000000
    v_add_u32 v8, s46, v2
    s_lshl_b32 s52, s49, 7
    s_add_u32 s52, s52, 0x106400
    s_add_u32 s52, s52, s76
    s_mov_b32 s28, s6
    s_and_b32 s29, s7, 0xffff
    s_mov_b32 s30, 0x1c00
    s_mov_b32 s31, 0x00020000
    s_lshl_b32 s46, s49, 8
    s_lshl_b32 s47, s50, 6
    s_add_u32 s46, s46, s47
    v_lshrrev_b32 v9, 5, v1
    v_lshlrev_b32 v9, 3, v9
    buffer_load_dwordx2 v[32:33], v9, s[28:31], s46 offen offset:0
    buffer_load_dwordx2 v[34:35], v9, s[28:31], s46 offen offset:16
    buffer_load_dwordx2 v[36:37], v9, s[28:31], s46 offen offset:32
    buffer_load_dwordx2 v[38:39], v9, s[28:31], s46 offen offset:48
    v_add_u32 v9, 1024, v8
    s_mov_b32 s56, 0xbdd2d3e8
    s_mov_b32 s57, 0xbdd2d3e8
    v_mov_b32 v112, 0xc0135761
    s_waitcnt vmcnt(0)
    v_lshlrev_b32 v64, 16, v32
    v_and_b32 v65, 0xffff0000, v32
    v_lshlrev_b32 v66, 16, v33
    v_and_b32 v67, 0xffff0000, v33
    v_lshlrev_b32 v68, 16, v34
    v_and_b32 v69, 0xffff0000, v34
    v_lshlrev_b32 v70, 16, v35
    v_and_b32 v71, 0xffff0000, v35
    v_lshlrev_b32 v72, 16, v36
    v_and_b32 v73, 0xffff0000, v36
    v_lshlrev_b32 v74, 16, v37
    v_and_b32 v75, 0xffff0000, v37
    v_lshlrev_b32 v76, 16, v38
    v_and_b32 v77, 0xffff0000, v38
    v_lshlrev_b32 v78, 16, v39
    v_and_b32 v79, 0xffff0000, v39
    s_mul_i32 s46, s43, 8192
    s_add_u32 s46, s46, 0xc00000
    s_mul_i32 s47, s42, 0
    s_add_u32 s46, s46, s47
    v_min_u32 v116, 63, v1
    v_lshlrev_b32 v116, 7, v116
    v_add_u32 v116, s46, v116
    s_mov_b32 s60, 0
    s_mul_i32 s61, s74, 65536
    s_mov_b32 s62, 0
    s_mul_i32 s63, s74, 229376
    s_mul_i32 s85, s78, 65536
    s_mul_i32 s86, s78, 229376
    s_sub_u32 s46, s78, 1
    s_sub_u32 s75, s75, s74
    s_add_u32 s75, s75, s46
    s_lshr_b32 s75, s75, s46
    s_mov_b32 s67, 0
    s_mov_b32 s68, 3
    s_mov_b32 s71, 0
    v_mov_b32 v15, 147456
    v_mov_b32 v14, 0
    ds_write_b32 v15, v14 offset:4
    ds_write_b32 v15, v14 offset:12
    ds_write_b32 v15, v14 offset:16
    v_mov_b32 v114, 1
    v_mov_b32 v115, 0
    s_mov_b32 s81, 0
    s_mul_i32 s87, s78, 3
    s_sub_u32 s87, s74, s87
    s_add_u32 s87, s87, 1
    s_lshl_b32 s46, s44, 5
    v_add_u32 v119, s46, v15
    v_lshrrev_b32 v113, 4, v1
    v_mul_u32_u24 v113, s78, v113
    v_add_u32 v113, s74, v113
    s_mov_b32 s72, 0
L_g_restart_89:
    s_cmp_lg_u32 s44, 0
    s_cbranch_scc1 L_g_nsp_90
    s_mov_b32 s70, 0
L_g_sp_96:
    s_add_u32 s54, s60, 0
    s_mul_i32 s55, s54, s78
    v_add_u32 v12, s55, v113
    v_mul_u32_u24 v13, 171, v12
    v_lshrrev_b32 v13, 9, v13
    v_mad_i32_i24 v13, v13, -3, v12
    v_lshl_add_u32 v13, v13, 9, v7
    buffer_load_dword v11, v13, s[12:15], 0 offen sc1
    s_waitcnt vmcnt(0)
    v_cmp_ge_u32 vcc, v12, v11
    s_add_u32 s70, s70, 1
    s_and_b32 s46, vcc_lo, 0xffff
    s_cbranch_scc0 L_g_sp_96_ok
    s_sleep 3
    s_cmp_lt_u32 s70, 524288
    s_cbranch_scc1 L_g_sp_96
    s_branch L_c_done_1
L_g_sp_96_ok:
    v_cmp_ge_u32 vcc, v12, v11
    s_nop 0
    s_ff1_i32_b64 s46, vcc
    s_lshr_b32 s46, s46, 4
    s_min_u32 s46, s46, 4
    s_add_u32 s46, s46, s54
    s_min_u32 s46, s46, s75
    v_mov_b32 v118, s46
    ds_write_b32 v15, v118 offset:20
L_g_nsp_90:
    s_waitcnt lgkmcnt(0)
    s_barrier
    ds_read_b32 v14, v15 offset:20
    s_waitcnt lgkmcnt(0)
    v_readfirstlane_b32 s66, v14
    s_nop 3
L_g_restart_89_go:
    s_mov_b32 s69, 0
    s_cmp_gt_u32 s62, s60
    s_cbranch_scc1 L_g_nd_97
    s_cmp_ge_u32 s62, s66
    s_cbranch_scc1 L_g_nd_97
    s_add_u32 s47, s61, 4096
    s_add_u32 m0, s64, 0
    s_nop 0
    buffer_load_dwordx4 v3, s[12:15], s61 offen offset:0 sc1 lds
    buffer_load_dwordx4 v3, s[12:15], s61 offen offset:1024 sc1 lds
    buffer_load_dwordx4 v3, s[12:15], s61 offen offset:2048 sc1 lds
    buffer_load_dwordx4 v3, s[12:15], s61 offen offset:3072 sc1 lds
    s_add_u32 m0, s64, 4096
    s_nop 0
    buffer_load_dwordx4 v3, s[12:15], s47 offen offset:0 sc1 lds
    buffer_load_dwordx4 v3, s[12:15], s47 offen offset:1024 sc1 lds
    buffer_load_dwordx4 v3, s[12:15], s47 offen offset:2048 sc1 lds
    buffer_load_dwordx4 v3, s[12:15], s47 offen offset:3072 sc1 lds
    s_add_u32 s61, s61, s85
    s_add_u32 s62, s62, 1
    s_xor_b32 s64, s64, 0x10000
    s_mov_b32 s69, 1
L_g_nd_97:
    s_cmp_eq_u32 s51, 1
    s_cbranch_scc1 L_g_g1r_91
    s_add_u32 s59, s60, 1
    s_mov_b32 s69, 0
    s_cmp_gt_u32 s62, s59
    s_cbranch_scc1 L_g_nd_98
    s_cmp_ge_u32 s62, s66
    s_cbranch_scc1 L_g_nd_98
    s_add_u32 s47, s61, 4096
    s_add_u32 m0, s64, 0
    s_nop 0
    buffer_load_dwordx4 v3, s[12:15], s61 offen offset:0 sc1 lds
    buffer_load_dwordx4 v3, s[12:15], s61 offen offset:1024 sc1 lds
    buffer_load_dwordx4 v3, s[12:15], s61 offen offset:2048 sc1 lds
    buffer_load_dwordx4 v3, s[12:15], s61 offen offset:3072 sc1 lds
    s_add_u32 m0, s64, 4096
    s_nop 0
    buffer_load_dwordx4 v3, s[12:15], s47 offen offset:0 sc1 lds
    buffer_load_dwordx4 v3, s[12:15], s47 offen offset:1024 sc1 lds
    buffer_load_dwordx4 v3, s[12:15], s47 offen offset:2048 sc1 lds
    buffer_load_dwordx4 v3, s[12:15], s47 offen offset:3072 sc1 lds
    s_add_u32 s61, s61, s85
    s_add_u32 s62, s62, 1
    s_xor_b32 s64, s64, 0x10000
    s_mov_b32 s69, 1
L_g_nd_98:
    s_cmp_eq_u32 s69, 1
    s_cbranch_scc1 L_g_w0_99
    s_waitcnt vmcnt(0)
L_g_w0_99:
    s_waitcnt vmcnt(8)
    s_cmp_lg_u32 s44, 0
    s_cbranch_scc1 L_g_nl_100
    s_cmp_lt_u32 s66, s75
    s_cselect_b32 s81, 1, 2
L_g_nl_100:
L_g_loop0_92_l:
    s_barrier
    ds_read_b128 v[32:35], v4 offset:0
    ds_read_b128 v[36:39], v4 offset:1024
    ds_read_b128 v[40:43], v4 offset:2048
    ds_read_b128 v[44:47], v4 offset:3072
    ds_read_b128 v[48:51], v4 offset:4096
    ds_read_b128 v[52:55], v4 offset:5120
    ds_read_b128 v[56:59], v4 offset:6144
    ds_read_b128 v[60:63], v4 offset:7168
    s_branch L_g_loop0_92_m
.p2align 6
L_g_loop0_92:
    s_barrier
L_g_loop0_92_m:
    s_setprio 2
    s_waitcnt lgkmcnt(6)
    v_mfma_f32_32x32x16_bf16 v[16:31], a[0:3], v[32:35], v[64:79]
    ds_read_b128 v[32:35], v4 offset:8192
    v_mfma_f32_32x32x16_bf16 v[16:31], a[4:7], v[36:39], v[16:31]
    ds_read_b128 v[36:39], v4 offset:9216
    s_cmp_eq_u32 s81, 1
    s_cbranch_scc1 L_g_h1_104
L_g_h1_104_b:
    s_waitcnt lgkmcnt(6)
    v_mfma_f32_32x32x16_bf16 v[16:31], a[8:11], v[40:43], v[16:31]
    ds_read_b128 v[40:43], v4 offset:10240
    v_mfma_f32_32x32x16_bf16 v[16:31], a[12:15], v[44:47], v[16:31]
    ds_read_b128 v[44:47], v4 offset:11264
    s_waitcnt lgkmcnt(6)
    v_mfma_f32_32x32x16_bf16 v[16:31], a[16:19], v[48:51], v[16:31]
    ds_read_b128 v[48:51], v4 offset:12288
    v_mfma_f32_32x32x16_bf16 v[16:31], a[20:23], v[52:55], v[16:31]
    ds_read_b128 v[52:55], v4 offset:13312
    s_waitcnt lgkmcnt(6)
    v_mfma_f32_32x32x16_bf16 v[16:31], a[24:27], v[56:59], v[16:31]
    ds_read_b128 v[56:59], v4 offset:14336
    v_mfma_f32_32x32x16_bf16 v[16:31], a[28:31], v[60:63], v[16:31]
    ds_read_b128 v[60:63], v4 offset:15360
    s_waitcnt lgkmcnt(6)
    v_mfma_f32_32x32x16_bf16 v[16:31], a[32:35], v[32:35], v[16:31]
    ds_read_b128 v[32:35], v4 offset:16384
    v_mfma_f32_32x32x16_bf16 v[16:31], a[36:39], v[36:39], v[16:31]
    ds_read_b128 v[36:39], v4 offset:17408
    s_waitcnt lgkmcnt(6)
    v_mfma_f32_32x32x16_bf16 v[16:31], a[40:43], v[40:43], v[16:31]
    ds_read_b128 v[40:43], v4 offset:18432
    v_mfma_f32_32x32x16_bf16 v[16:31], a[44:47], v[44:47], v[16:31]
    ds_read_b128 v[44:47], v4 offset:19456
    s_waitcnt lgkmcnt(6)
    v_mfma_f32_32x32x16_bf16 v[16:31], a[48:51], v[48:51], v[16:31]
    ds_read_b128 v[48:51], v4 offset:20480
    v_mfma_f32_32x32x16_bf16 v[16:31], a[52:55], v[52:55], v[16:31]
    ds_read_b128 v[52:55], v4 offset:21504
    s_waitcnt lgkmcnt(6)
    v_mfma_f32_32x32x16_bf16 v[16:31], a[56:59], v[56:59], v[16:31]
    ds_read_b128 v[56:59], v4 offset:22528
    v_mfma_f32_32x32x16_bf16 v[16:31], a[60:63], v[60:63], v[16:31]
    ds_read_b128 v[60:63], v4 offset:23552
    s_waitcnt lgkmcnt(6)
    v_mfma_f32_32x32x16_bf16 v[16:31], a[64:67], v[32:35], v[16:31]
    ds_read_b128 v[32:35], v4 offset:24576
    v_mfma_f32_32x32x16_bf16 v[16:31], a[68:71], v[36:39], v[16:31]
    ds_read_b128 v[36:39], v4 offset:25600
    s_waitcnt lgkmcnt(6)
    v_mfma_f32_32x32x16_bf16 v[16:31], a[72:75], v[40:43], v[16:31]
    ds_read_b128 v[40:43], v4 offset:26624
    v_mfma_f32_32x32x16_bf16 v[16:31], a[76:79], v[44:47], v[16:31]
    ds_read_b128 v[44:47], v4 offset:27648
    s_waitcnt lgkmcnt(6)
    v_mfma_f32_32x32x16_bf16 v[16:31], a[80:83], v[48:51], v[16:31]
    ds_read_b128 v[48:51], v4 offset:28672
    v_mfma_f32_32x32x16_bf16 v[16:31], a[84:87], v[52:55], v[16:31]
    ds_read_b128 v[52:55], v4 offset:29696
    s_waitcnt lgkmcnt(6)
    v_mfma_f32_32x32x16_bf16 v[16:31], a[88:91], v[56:59], v[16:31]
    ds_read_b128 v[56:59], v4 offset:30720
    v_mfma_f32_32x32x16_bf16 v[16:31], a[92:95], v[60:63], v[16:31]
    ds_read_b128 v[60:63], v4 offset:31744
    s_waitcnt lgkmcnt(6)
    v_mfma_f32_32x32x16_bf16 v[16:31], a[96:99], v[32:35], v[16:31]
    v_mfma_f32_32x32x16_bf16 v[16:31], a[100:103], v[36:39], v[16:31]
    s_waitcnt lgkmcnt(4)
    v_mfma_f32_32x32x16_bf16 v[16:31], a[104:107], v[40:43], v[16:31]
    v_mfma_f32_32x32x16_bf16 v[16:31], a[108:111], v[44:47], v[16:31]
    s_waitcnt lgkmcnt(2)
    v_mfma_f32_32x32x16_bf16 v[16:31], a[112:115], v[48:51], v[16:31]
    s_cmp_eq_u32 s81, 1
    s_cbranch_scc1 L_g_h2_105
L_g_h2_105_b:
    ds_write_b32 v119, v118
    v_mfma_f32_32x32x16_bf16 v[16:31], a[116:119], v[52:55], v[16:31]
    s_waitcnt lgkmcnt(0)
    v_mfma_f32_32x32x16_bf16 v[16:31], a[120:123], v[56:59], v[16:31]
    v_mfma_f32_32x32x16_bf16 v[16:31], a[124:127], v[60:63], v[16:31]
    v_xor_b32 v4, 0x10000, v4
    s_setprio 0
    s_waitcnt vmcnt(0)
    s_waitcnt lgkmcnt(0)
    s_barrier
    ds_read_b32 v14, v15
    s_nop 6
    ds_write_b128 v5, v[16:19] offset:0
    ds_write_b128 v5, v[20:23] offset:1024
    ds_write_b128 v5, v[24:27] offset:2048
    ds_write_b128 v5, v[28:31] offset:3072
    s_waitcnt lgkmcnt(4)
    v_readfirstlane_b32 s66, v14
    s_add_u32 s60, s60, 1
    s_mov_b32 s65, 0
    s_cmp_le_u32 s62, s60
    s_cbranch_scc1 L_g_dp_106_l
L_g_dp_106_a:
    s_cmp_ge_u32 s62, s66
    s_cbranch_scc1 L_g_dp_106_d
    s_add_u32 s47, s61, 4096
    s_mov_b32 m0, s64
    s_add_u32 s62, s62, 1
    buffer_load_dwordx4 v3, s[12:15], s61 offen offset:0 sc1 lds
    buffer_load_dwordx4 v3, s[12:15], s61 offen offset:1024 sc1 lds
    buffer_load_dwordx4 v3, s[12:15], s61 offen offset:2048 sc1 lds
    buffer_load_dwordx4 v3, s[12:15], s61 offen offset:3072 sc1 lds
    s_add_u32 m0, s64, 4096
    s_add_u32 s61, s61, s85
    buffer_load_dwordx4 v3, s[12:15], s47 offen offset:0 sc1 lds
    buffer_load_dwordx4 v3, s[12:15], s47 offen offset:1024 sc1 lds
    buffer_load_dwordx4 v3, s[12:15], s47 offen offset:2048 sc1 lds
    buffer_load_dwordx4 v3, s[12:15], s47 offen offset:3072 sc1 lds
    s_xor_b32 s64, s64, 0x10000
L_g_dp_106_d:
    s_cmp_lg_u32 s44, 2
    s_cbranch_scc1 L_g_pf_107
    s_cmp_ge_u32 s62, s66
    s_cbranch_scc1 L_g_pf_107
    buffer_load_dword v117, v116, s[12:15], s61 offen sc1
L_g_pf_107:
    s_cmp_le_u32 s66, s60
    s_cbranch_scc1 L_g_ex0_103
    s_cmp_lg_u32 s65, 0
    s_cbranch_scc1 L_g_nw_102
    ds_read_b128 v[32:35], v4 offset:0
    ds_read_b128 v[36:39], v4 offset:1024
    ds_read_b128 v[40:43], v4 offset:2048
    ds_read_b128 v[44:47], v4 offset:3072
    ds_read_b128 v[48:51], v4 offset:4096
    ds_read_b128 v[52:55], v4 offset:5120
    ds_read_b128 v[56:59], v4 offset:6144
    ds_read_b128 v[60:63], v4 offset:7168
    s_cmp_lg_u32 s44, 0
    s_cbranch_scc1 L_g_nl_108
    s_mov_b32 s46, s66
    s_cmp_lg_u32 s81, 0
    s_cbranch_scc1 L_g_nl_108_e
    v_cmp_ge_u32 vcc, v12, v11
    s_nop 0
    s_ff1_i32_b64 s46, vcc
    s_lshr_b32 s46, s46, 4
    s_min_u32 s46, s46, 4
    s_add_u32 s46, s46, s54
    s_min_u32 s46, s46, s75
    v_mov_b32 v118, s46
L_g_nl_108_e:
    s_add_u32 s47, s60, 3
    s_min_u32 s47, s47, s75
    s_cmp_lt_u32 s46, s47
    s_cselect_b32 s81, 1, 0
    s_cbranch_scc1 L_g_nl_108
    s_add_u32 s54, s60, 2
    s_mul_i32 s55, s54, s78
    v_add_u32 v12, s55, v113
    v_mul_u32_u24 v13, 171, v12
    v_lshrrev_b32 v13, 9, v13
    v_mad_i32_i24 v13, v13, -3, v12
    v_lshl_add_u32 v13, v13, 9, v7
    buffer_load_dword v11, v13, s[12:15], 0 offen sc1
L_g_nl_108:
    s_waitcnt lgkmcnt(8)
    s_branch L_g_loop0_92
L_g_ex0_103:
    s_cmp_lg_u32 s44, 0
    s_cbranch_scc1 L_g_ex0_103_n
    ds_write_b32 v15, v118 offset:20
    s_cmp_ge_u32 s60, s75
    s_cbranch_scc1 L_g_ex0_103_n
    s_sleep 6
    s_add_u32 s54, s60, 0
    s_mul_i32 s55, s54, s78
    v_add_u32 v12, s55, v113
    v_mul_u32_u24 v13, 171, v12
    v_lshrrev_b32 v13, 9, v13
    v_mad_i32_i24 v13, v13, -3, v12
    v_lshl_add_u32 v13, v13, 9, v7
    buffer_load_dword v11, v13, s[12:15], 0 offen sc1
    s_waitcnt vmcnt(0)
    v_cmp_ge_u32 vcc, v12, v11
    s_nop 0
    s_ff1_i32_b64 s46, vcc
    s_lshr_b32 s46, s46, 4
    s_min_u32 s46, s46, 4
    s_add_u32 s46, s46, s54
    s_min_u32 s46, s46, s75
    v_mov_b32 v118, s46
    ds_write_b32 v15, v118 offset:20
L_g_ex0_103_n:
    s_waitcnt lgkmcnt(0)
    s_barrier
    ds_read_b32 v14, v15 offset:20
    s_waitcnt lgkmcnt(0)
    v_readfirstlane_b32 s66, v14
    s_barrier
    s_cmp_gt_u32 s66, s60
    s_cbranch_scc1 L_g_restart_89_go
    s_branch L_g_tail_94
L_g_g1r_91:
    s_mov_b32 s65, 1
    s_branch L_g_loop1_93_e
.p2align 6
L_g_loop1_93:
    s_mov_b32 s65, 0
L_g_loop1_93_e:
    s_barrier
    s_bitcmp1_b32 s67, 2
    s_cbranch_scc0 L_g_nfl_109
    s_cmp_lg_u32 s44, 4
    s_cbranch_scc1 L_g_nfl_109_d
    s_mul_i32 s59, s60, s78
    s_add_u32 s59, s59, s87
    v_mov_b32 v10, s59
    buffer_store_dword v10, v115, s[12:15], s52 offen sc1
L_g_nfl_109_d:
    ds_read_b128 v[80:83], v5 offset:0
    ds_read_b128 v[84:87], v5 offset:1024
    ds_read_b128 v[88:91], v5 offset:2048
    ds_read_b128 v[92:95], v5 offset:3072
    s_cmp_le_u32 s62, s60
    s_cbranch_scc1 L_g_dp_114_l
L_g_dp_114_a:
    s_cmp_ge_u32 s62, s66
    s_cbranch_scc1 L_g_dp_114_d
    s_add_u32 s47, s61, 4096
    s_mov_b32 m0, s64
    s_add_u32 s62, s62, 1
    buffer_load_dwordx4 v3, s[12:15], s61 offen offset:0 sc1 lds
    buffer_load_dwordx4 v3, s[12:15], s61 offen offset:1024 sc1 lds
    buffer_load_dwordx4 v3, s[12:15], s61 offen offset:2048 sc1 lds
    buffer_load_dwordx4 v3, s[12:15], s61 offen offset:3072 sc1 lds
    s_add_u32 m0, s64, 4096
    s_add_u32 s61, s61, s85
    buffer_load_dwordx4 v3, s[12:15], s47 offen offset:0 sc1 lds
    buffer_load_dwordx4 v3, s[12:15], s47 offen offset:1024 sc1 lds
    buffer_load_dwordx4 v3, s[12:15], s47 offen offset:2048 sc1 lds
    buffer_load_dwordx4 v3, s[12:15], s47 offen offset:3072 sc1 lds
    s_xor_b32 s64, s64, 0x10000
L_g_dp_114_d:
    s_bitcmp1_b32 s67, 0
    s_cbranch_scc0 L_g_nep_110
    s_waitcnt lgkmcnt(0)
    v_add_f32 v80, v80, v16
    v_add_f32 v81, v81, v17
    v_add_f32 v82, v82, v18
    v_add_f32 v83, v83, v19
    v_add_f32 v84, v84, v20
    v_add_f32 v85, v85, v21
    v_add_f32 v86, v86, v22
    v_add_f32 v87, v87, v23
    v_add_f32 v88, v88, v24
    v_add_f32 v89, v89, v25
    v_add_f32 v90, v90, v26
    v_add_f32 v91, v91, v27
    v_add_f32 v92, v92, v28
    v_add_f32 v93, v93, v29
    v_add_f32 v94, v94, v30
    v_add_f32 v95, v95, v31
L_g_nep_110:
    v_mul_f32 v96, v80, v80
    v_mul_f32 v97, v81, v81
    v_mul_f32 v98, v82, v82
    v_mul_f32 v99, v83, v83
    v_mul_f32 v100, v84, v84
    v_mul_f32 v101, v85, v85
    v_mul_f32 v102, v86, v86
    v_mul_f32 v103, v87, v87
    v_fma_f32 v96, v96, s56, v112
    v_fma_f32 v97, v97, s56, v112
    v_fma_f32 v98, v98, s56, v112
    v_fma_f32 v99, v99, s56, v112
    v_fma_f32 v100, v100, s56, v112
    v_fma_f32 v101, v101, s56, v112
    v_fma_f32 v102, v102, s56, v112
    v_fma_f32 v103, v103, s56, v112
    v_mul_f32 v96, v96, v80
    v_mul_f32 v97, v97, v81
    v_mul_f32 v98, v98, v82
    v_mul_f32 v99, v99, v83
    v_mul_f32 v100, v100, v84
    v_mul_f32 v101, v101, v85
    v_mul_f32 v102, v102, v86
    v_mul_f32 v103, v103, v87
    v_exp_f32 v96, v96
    v_exp_f32 v97, v97
    v_exp_f32 v98, v98
    v_exp_f32 v99, v99
    v_exp_f32 v100, v100
    v_exp_f32 v101, v101
    v_exp_f32 v102, v102
    v_exp_f32 v103, v103
    v_add_f32 v96, 1.0, v96
    v_add_f32 v97, 1.0, v97
    v_add_f32 v98, 1.0, v98
    v_add_f32 v99, 1.0, v99
    v_add_f32 v100, 1.0, v100
    v_add_f32 v101, 1.0, v101
    v_add_f32 v102, 1.0, v102
    v_add_f32 v103, 1.0, v103
    v_rcp_f32 v96, v96
    v_rcp_f32 v97, v97
    v_rcp_f32 v98, v98
    v_rcp_f32 v99, v99
    v_rcp_f32 v100, v100
    v_rcp_f32 v101, v101
    v_rcp_f32 v102, v102
    v_rcp_f32 v103, v103
    v_mul_f32 v80, v80, v96
    v_mul_f32 v81, v81, v97
    s_cmp_lg_u32 s65, 0
    s_cbranch_scc1 L_g_nw1_111
    ds_read_b128 v[32:35], v4 offset:0
    ds_read_b128 v[36:39], v4 offset:1024
    ds_read_b128 v[40:43], v4 offset:2048
    ds_read_b128 v[44:47], v4 offset:3072
    ds_read_b128 v[48:51], v4 offset:4096
    ds_read_b128 v[52:55], v4 offset:5120
    ds_read_b128 v[56:59], v4 offset:6144
    ds_read_b128 v[60:63], v4 offset:7168
    s_barrier
L_g_jn_113:
    s_bitcmp1_b32 s67, 0
    s_cbranch_scc0 L_g_mm2_112
    s_setprio 1
    s_waitcnt lgkmcnt(6)
    v_mfma_f32_32x32x16_bf16 v[16:31], a[0:3], v[32:35], 0
    ds_read_b128 v[32:35], v4 offset:8192
    ds_read_b32 v14, v15
    v_mul_f32 v82, v82, v98
    v_mul_f32 v83, v83, v99
    v_mul_f32 v84, v84, v100
    v_mfma_f32_32x32x16_bf16 v[16:31], a[4:7], v[36:39], v[16:31]
    ds_read_b128 v[36:39], v4 offset:9216
    v_mul_f32 v85, v85, v101
    v_mul_f32 v86, v86, v102
    v_mul_f32 v87, v87, v103
    v_cvt_pk_bf16_f32 v104, v80, v81
    s_waitcnt lgkmcnt(6)
    v_mfma_f32_32x32x16_bf16 v[16:31], a[8:11], v[40:43], v[16:31]
    ds_read_b128 v[40:43], v4 offset:10240
    v_cvt_pk_bf16_f32 v105, v82, v83
    v_cvt_pk_bf16_f32 v106, v84, v85
    v_cvt_pk_bf16_f32 v107, v86, v87
    buffer_store_dwordx4 v[104:107], v8, s[12:15], s63 offen sc1
    v_mfma_f32_32x32x16_bf16 v[16:31], a[12:15], v[44:47], v[16:31]
    ds_read_b128 v[44:47], v4 offset:11264
    v_mul_f32 v96, v88, v88
    v_mul_f32 v97, v89, v89
    v_mul_f32 v98, v90, v90
    v_mul_f32 v99, v91, v91
    s_waitcnt lgkmcnt(6)
    v_mfma_f32_32x32x16_bf16 v[16:31], a[16:19], v[48:51], v[16:31]
    ds_read_b128 v[48:51], v4 offset:12288
    v_mul_f32 v100, v92, v92
    v_mul_f32 v101, v93, v93
    v_mul_f32 v102, v94, v94
    v_mul_f32 v103, v95, v95
    v_mfma_f32_32x32x16_bf16 v[16:31], a[20:23], v[52:55], v[16:31]
    ds_read_b128 v[52:55], v4 offset:13312
    v_fma_f32 v96, v96, s56, v112
    v_fma_f32 v97, v97, s56, v112
    v_fma_f32 v98, v98, s56, v112
    v_fma_f32 v99, v99, s56, v112
    s_waitcnt lgkmcnt(6)
    v_mfma_f32_32x32x16_bf16 v[16:31], a[24:27], v[56:59], v[16:31]
    ds_read_b128 v[56:59], v4 offset:14336
    v_fma_f32 v100, v100, s56, v112
    v_fma_f32 v101, v101, s56, v112
    v_fma_f32 v102, v102, s56, v112
    v_fma_f32 v103, v103, s56, v112
    v_mfma_f32_32x32x16_bf16 v[16:31], a[28:31], v[60:63], v[16:31]
    ds_read_b128 v[60:63], v4 offset:15360
    v_mul_f32 v96, v96, v88
    v_mul_f32 v97, v97, v89
    v_mul_f32 v98, v98, v90
    v_mul_f32 v99, v99, v91
    s_waitcnt lgkmcnt(6)
    v_mfma_f32_32x32x16_bf16 v[16:31], a[32:35], v[32:35], v[16:31]
    ds_read_b128 v[32:35], v4 offset:16384
    v_mul_f32 v100, v100, v92
    v_mul_f32 v101, v101, v93
    v_mul_f32 v102, v102, v94
    v_mul_f32 v103, v103, v95
    v_mfma_f32_32x32x16_bf16 v[16:31], a[36:39], v[36:39], v[16:31]
    ds_read_b128 v[36:39], v4 offset:17408
    v_exp_f32 v96, v96
    v_exp_f32 v97, v97
    s_waitcnt lgkmcnt(6)
    v_mfma_f32_32x32x16_bf16 v[16:31], a[40:43], v[40:43], v[16:31]
    ds_read_b128 v[40:43], v4 offset:18432
    v_exp_f32 v98, v98
    v_exp_f32 v99, v99
    v_mfma_f32_32x32x16_bf16 v[16:31], a[44:47], v[44:47], v[16:31]
    ds_read_b128 v[44:47], v4 offset:19456
    v_exp_f32 v100, v100
    v_exp_f32 v101, v101
    s_waitcnt lgkmcnt(6)
    v_mfma_f32_32x32x16_bf16 v[16:31], a[48:51], v[48:51], v[16:31]
    ds_read_b128 v[48:51], v4 offset:20480
    v_exp_f32 v102, v102
    v_exp_f32 v103, v103
    v_mfma_f32_32x32x16_bf16 v[16:31], a[52:55], v[52:55], v[16:31]
    ds_read_b128 v[52:55], v4 offset:21504
    v_add_f32 v96, 1.0, v96
    v_add_f32 v97, 1.0, v97
    v_add_f32 v98, 1.0, v98
    v_add_f32 v99, 1.0, v99
    s_waitcnt lgkmcnt(6)
    v_mfma_f32_32x32x16_bf16 v[16:31], a[56:59], v[56:59], v[16:31]
    ds_read_b128 v[56:59], v4 offset:22528
    v_add_f32 v100, 1.0, v100
    v_add_f32 v101, 1.0, v101
    v_add_f32 v102, 1.0, v102
    v_add_f32 v103, 1.0, v103
    v_mfma_f32_32x32x16_bf16 v[16:31], a[60:63], v[60:63], v[16:31]
    ds_read_b128 v[60:63], v4 offset:23552
    v_rcp_f32 v96, v96
    v_rcp_f32 v97, v97
    s_waitcnt lgkmcnt(6)
    v_mfma_f32_32x32x16_bf16 v[16:31], a[64:67], v[32:35], v[16:31]
    ds_read_b128 v[32:35], v4 offset:24576
    v_rcp_f32 v98, v98
    v_rcp_f32 v99, v99
    v_mfma_f32_32x32x16_bf16 v[16:31], a[68:71], v[36:39], v[16:31]
    ds_read_b128 v[36:39], v4 offset:25600
    v_rcp_f32 v100, v100
    v_rcp_f32 v101, v101
    s_waitcnt lgkmcnt(6)
    v_mfma_f32_32x32x16_bf16 v[16:31], a[72:75], v[40:43], v[16:31]
    ds_read_b128 v[40:43], v4 offset:26624
    v_rcp_f32 v102, v102
    v_rcp_f32 v103, v103
    v_mfma_f32_32x32x16_bf16 v[16:31], a[76:79], v[44:47], v[16:31]
    ds_read_b128 v[44:47], v4 offset:27648
    v_mul_f32 v88, v88, v96
    v_mul_f32 v89, v89, v97
    v_mul_f32 v90, v90, v98
    v_mul_f32 v91, v91, v99
    s_waitcnt lgkmcnt(6)
    v_mfma_f32_32x32x16_bf16 v[16:31], a[80:83], v[48:51], v[16:31]
    ds_read_b128 v[48:51], v4 offset:28672
    v_mul_f32 v92, v92, v100
    v_mul_f32 v93, v93, v101
    v_mul_f32 v94, v94, v102
    v_mul_f32 v95, v95, v103
    v_mfma_f32_32x32x16_bf16 v[16:31], a[84:87], v[52:55], v[16:31]
    ds_read_b128 v[52:55], v4 offset:29696
    v_cvt_pk_bf16_f32 v108, v88, v89
    v_cvt_pk_bf16_f32 v109, v90, v91
    v_cvt_pk_bf16_f32 v110, v92, v93
    v_cvt_pk_bf16_f32 v111, v94, v95
    s_waitcnt lgkmcnt(6)
    v_mfma_f32_32x32x16_bf16 v[16:31], a[88:91], v[56:59], v[16:31]
    ds_read_b128 v[56:59], v4 offset:30720
    buffer_store_dwordx4 v[108:111], v9, s[12:15], s63 offen sc1
    s_add_u32 s63, s63, s86
    v_mfma_f32_32x32x16_bf16 v[16:31], a[92:95], v[60:63], v[16:31]
    ds_read_b128 v[60:63], v4 offset:31744
    s_waitcnt lgkmcnt(6)
    v_mfma_f32_32x32x16_bf16 v[16:31], a[96:99], v[32:35], v[16:31]
    v_mfma_f32_32x32x16_bf16 v[16:31], a[100:103], v[36:39], v[16:31]
    s_waitcnt lgkmcnt(4)
    v_mfma_f32_32x32x16_bf16 v[16:31], a[104:107], v[40:43], v[16:31]
    v_mfma_f32_32x32x16_bf16 v[16:31], a[108:111], v[44:47], v[16:31]
    s_waitcnt lgkmcnt(2)
    v_mfma_f32_32x32x16_bf16 v[16:31], a[112:115], v[48:51], v[16:31]
    v_mfma_f32_32x32x16_bf16 v[16:31], a[116:119], v[52:55], v[16:31]
    s_waitcnt lgkmcnt(0)
    v_mfma_f32_32x32x16_bf16 v[16:31], a[120:123], v[56:59], v[16:31]
    v_mfma_f32_32x32x16_bf16 v[16:31], a[124:127], v[60:63], v[16:31]
    v_xor_b32 v4, 0x10000, v4
    s_setprio 0
    s_waitcnt vmcnt(2)
L_g_mm2_112_d:
    v_readfirstlane_b32 s66, v14
    s_lshl_b32 s67, s67, 1
    s_or_b32 s67, s67, 1
    s_add_u32 s60, s60, 1
    s_cmp_gt_u32 s66, s60
    s_cbranch_scc1 L_g_loop1_93
    s_barrier
    ds_read_b32 v14, v15 offset:20
    ds_read_b128 v[80:83], v5 offset:0
    ds_read_b128 v[84:87], v5 offset:1024
    ds_read_b128 v[88:91], v5 offset:2048
    ds_read_b128 v[92:95], v5 offset:3072
    s_waitcnt lgkmcnt(4)
    v_readfirstlane_b32 s66, v14
    s_barrier
    s_mov_b32 s69, 0
    s_cmp_gt_u32 s62, s60
    s_cbranch_scc1 L_g_nd_115
    s_cmp_ge_u32 s62, s66
    s_cbranch_scc1 L_g_nd_115
    s_add_u32 s47, s61, 4096
    s_add_u32 m0, s64, 0
    s_nop 0
    buffer_load_dwordx4 v3, s[12:15], s61 offen offset:0 sc1 lds
    buffer_load_dwordx4 v3, s[12:15], s61 offen offset:1024 sc1 lds
    buffer_load_dwordx4 v3, s[12:15], s61 offen offset:2048 sc1 lds
    buffer_load_dwordx4 v3, s[12:15], s61 offen offset:3072 sc1 lds
    s_add_u32 m0, s64, 4096
    s_nop 0
    buffer_load_dwordx4 v3, s[12:15], s47 offen offset:0 sc1 lds
    buffer_load_dwordx4 v3, s[12:15], s47 offen offset:1024 sc1 lds
    buffer_load_dwordx4 v3, s[12:15], s47 offen offset:2048 sc1 lds
    buffer_load_dwordx4 v3, s[12:15], s47 offen offset:3072 sc1 lds
    s_add_u32 s61, s61, s85
    s_add_u32 s62, s62, 1
    s_xor_b32 s64, s64, 0x10000
    s_mov_b32 s69, 1
L_g_nd_115:
    s_waitcnt lgkmcnt(3)
    v_add_f32 v80, v80, v16
    v_add_f32 v81, v81, v17
    v_add_f32 v82, v82, v18
    v_add_f32 v83, v83, v19
    s_waitcnt lgkmcnt(2)
    v_add_f32 v84, v84, v20
    v_add_f32 v85, v85, v21
    v_add_f32 v86, v86, v22
    v_add_f32 v87, v87, v23
    s_waitcnt lgkmcnt(1)
    v_add_f32 v88, v88, v24
    v_add_f32 v89, v89, v25
    v_add_f32 v90, v90, v26
    v_add_f32 v91, v91, v27
    s_waitcnt lgkmcnt(0)
    v_add_f32 v92, v92, v28
    v_add_f32 v93, v93, v29
    v_add_f32 v94, v94, v30
    v_add_f32 v95, v95, v31
    v_mul_f32 v96, v80, v80
    v_mul_f32 v97, v81, v81
    v_mul_f32 v98, v82, v82
    v_mul_f32 v99, v83, v83
    v_mul_f32 v100, v84, v84
    v_mul_f32 v101, v85, v85
    v_mul_f32 v102, v86, v86
    v_mul_f32 v103, v87, v87
    v_fma_f32 v96, v96, s56, v112
    v_fma_f32 v97, v97, s56, v112
    v_fma_f32 v98, v98, s56, v112
    v_fma_f32 v99, v99, s56, v112
    v_fma_f32 v100, v100, s56, v112
    v_fma_f32 v101, v101, s56, v112
    v_fma_f32 v102, v102, s56, v112
    v_fma_f32 v103, v103, s56, v112
    v_mul_f32 v96, v96, v80
    v_mul_f32 v97, v97, v81
    v_mul_f32 v98, v98, v82
    v_mul_f32 v99, v99, v83
    v_mul_f32 v100, v100, v84
    v_mul_f32 v101, v101, v85
    v_mul_f32 v102, v102, v86
    v_mul_f32 v103, v103, v87
    v_exp_f32 v96, v96
    v_exp_f32 v97, v97
    v_exp_f32 v98, v98
    v_exp_f32 v99, v99
    v_exp_f32 v100, v100
    v_exp_f32 v101, v101
    v_exp_f32 v102, v102
    v_exp_f32 v103, v103
    v_add_f32 v96, 1.0, v96
    v_add_f32 v97, 1.0, v97
    v_add_f32 v98, 1.0, v98
    v_add_f32 v99, 1.0, v99
    v_add_f32 v100, 1.0, v100
    v_add_f32 v101, 1.0, v101
    v_add_f32 v102, 1.0, v102
    v_add_f32 v103, 1.0, v103
    v_rcp_f32 v96, v96
    v_rcp_f32 v97, v97
    v_rcp_f32 v98, v98
    v_rcp_f32 v99, v99
    v_rcp_f32 v100, v100
    v_rcp_f32 v101, v101
    v_rcp_f32 v102, v102
    v_rcp_f32 v103, v103
    v_mul_f32 v80, v80, v96
    v_mul_f32 v81, v81, v97
    v_mul_f32 v82, v82, v98
    v_mul_f32 v83, v83, v99
    v_mul_f32 v84, v84, v100
    v_mul_f32 v85, v85, v101
    v_mul_f32 v86, v86, v102
    v_mul_f32 v87, v87, v103
    v_cvt_pk_bf16_f32 v104, v80, v81
    v_cvt_pk_bf16_f32 v105, v82, v83
    v_cvt_pk_bf16_f32 v106, v84, v85
    v_cvt_pk_bf16_f32 v107, v86, v87
    buffer_store_dwordx4 v[104:107], v8, s[12:15], s63 offen sc1
    v_mul_f32 v96, v88, v88
    v_mul_f32 v97, v89, v89
    v_mul_f32 v98, v90, v90
    v_mul_f32 v99, v91, v91
    v_mul_f32 v100, v92, v92
    v_mul_f32 v101, v93, v93
    v_mul_f32 v102, v94, v94
    v_mul_f32 v103, v95, v95
    v_fma_f32 v96, v96, s56, v112
    v_fma_f32 v97, v97, s56, v112
    v_fma_f32 v98, v98, s56, v112
    v_fma_f32 v99, v99, s56, v112
    v_fma_f32 v100, v100, s56, v112
    v_fma_f32 v101, v101, s56, v112
    v_fma_f32 v102, v102, s56, v112
    v_fma_f32 v103, v103, s56, v112
    v_mul_f32 v96, v96, v88
    v_mul_f32 v97, v97, v89
    v_mul_f32 v98, v98, v90
    v_mul_f32 v99, v99, v91
    v_mul_f32 v100, v100, v92
    v_mul_f32 v101, v101, v93
    v_mul_f32 v102, v102, v94
    v_mul_f32 v103, v103, v95
    v_exp_f32 v96, v96
    v_exp_f32 v97, v97
    v_exp_f32 v98, v98
    v_exp_f32 v99, v99
    v_exp_f32 v100, v100
    v_exp_f32 v101, v101
    v_exp_f32 v102, v102
    v_exp_f32 v103, v103
    v_add_f32 v96, 1.0, v96
    v_add_f32 v97, 1.0, v97
    v_add_f32 v98, 1.0, v98
    v_add_f32 v99, 1.0, v99
    v_add_f32 v100, 1.0, v100
    v_add_f32 v101, 1.0, v101
    v_add_f32 v102, 1.0, v102
    v_add_f32 v103, 1.0, v103
    v_rcp_f32 v96, v96
    v_rcp_f32 v97, v97
    v_rcp_f32 v98, v98
    v_rcp_f32 v99, v99
    v_rcp_f32 v100, v100
    v_rcp_f32 v101, v101
    v_rcp_f32 v102, v102
    v_rcp_f32 v103, v103
    v_mul_f32 v88, v88, v96
    v_mul_f32 v89, v89, v97
    v_mul_f32 v90, v90, v98
    v_mul_f32 v91, v91, v99
    v_mul_f32 v92, v92, v100
    v_mul_f32 v93, v93, v101
    v_mul_f32 v94, v94, v102
    v_mul_f32 v95, v95, v103
    v_cvt_pk_bf16_f32 v108, v88, v89
    v_cvt_pk_bf16_f32 v109, v90, v91
    v_cvt_pk_bf16_f32 v110, v92, v93
    v_cvt_pk_bf16_f32 v111, v94, v95
    buffer_store_dwordx4 v[108:111], v9, s[12:15], s63 offen sc1
    s_add_u32 s63, s63, s86
    s_mov_b32 s67, 0
    s_mov_b32 s71, 1
    s_cmp_gt_u32 s66, s60
    s_cbranch_scc1 L_g_g1r_91
    v_mov_b32 v10, 1
    s_mov_b64 exec, 1
    s_waitcnt vmcnt(0)
    ds_add_rtn_u32 v10, v15, v10 offset:4
    s_waitcnt lgkmcnt(0)
    v_readfirstlane_b32 s46, v10
    s_mov_b64 exec, -1
    s_mov_b32 s71, 0
    s_sub_u32 s59, s60, 1
    s_mul_i32 s59, s59, s78
    s_add_u32 s59, s59, s74
    s_cmp_lg_u32 s46, s68
    s_cbranch_scc1 L_g_df_116
    v_mov_b32 v10, s59
    v_add_u32 v10, 1, v10
    v_mov_b32 v11, 0
    s_mov_b64 exec, 1
    buffer_store_dword v10, v11, s[12:15], s52 offen sc1
    s_mov_b64 exec, -1
L_sf_117:
L_g_df_116:
    s_add_u32 s68, s68, 4
    s_cmp_gt_u32 s66, s60
    s_cbranch_scc1 L_g_g1r_91
L_g_tail_94:
    s_cmp_lt_u32 s60, s75
    s_cbranch_scc1 L_g_restart_89
    s_waitcnt vmcnt(0)
    s_barrier
    s_branch L_w_f1_14_d
L_g_h1_104:
    s_add_u32 s54, s60, 1
    s_mul_i32 s55, s54, s78
    v_add_u32 v12, s55, v113
    v_mul_u32_u24 v13, 171, v12
    v_lshrrev_b32 v13, 9, v13
    v_mad_i32_i24 v13, v13, -3, v12
    v_lshl_add_u32 v13, v13, 9, v7
    buffer_load_dword v11, v13, s[12:15], 0 offen sc1
    s_branch L_g_h1_104_b
L_g_h2_105:
    s_waitcnt vmcnt(0)
    v_cmp_ge_u32 vcc, v12, v11
    s_nop 0
    s_ff1_i32_b64 s46, vcc
    s_lshr_b32 s46, s46, 4
    s_min_u32 s46, s46, 4
    s_add_u32 s46, s46, s54
    s_min_u32 s46, s46, s75
    v_mov_b32 v118, s46
    s_branch L_g_h2_105_b
L_g_dp_106_l:
    s_cmp_ge_u32 s62, s66
    s_cbranch_scc1 L_g_dp_106_d
    s_mov_b32 s65, 1
    s_add_u32 s47, s61, 4096
    s_mov_b32 m0, s64
    s_add_u32 s62, s62, 1
    buffer_load_dwordx4 v3, s[12:15], s61 offen offset:0 sc1 lds
    buffer_load_dwordx4 v3, s[12:15], s61 offen offset:1024 sc1 lds
    buffer_load_dwordx4 v3, s[12:15], s61 offen offset:2048 sc1 lds
    buffer_load_dwordx4 v3, s[12:15], s61 offen offset:3072 sc1 lds
    s_add_u32 m0, s64, 4096
    s_add_u32 s61, s61, s85
    buffer_load_dwordx4 v3, s[12:15], s47 offen offset:0 sc1 lds
    buffer_load_dwordx4 v3, s[12:15], s47 offen offset:1024 sc1 lds
    buffer_load_dwordx4 v3, s[12:15], s47 offen offset:2048 sc1 lds
    buffer_load_dwordx4 v3, s[12:15], s47 offen offset:3072 sc1 lds
    s_xor_b32 s64, s64, 0x10000
    s_branch L_g_dp_106_a
L_g_nw_102:
    s_waitcnt vmcnt(0) lgkmcnt(0)
    s_cmp_lg_u32 s44, 0
    s_cbranch_scc1 L_g_nl_118
    s_cmp_lt_u32 s66, s75
    s_cselect_b32 s81, 1, 2
L_g_nl_118:
    s_branch L_g_loop0_92_l
L_g_nfl_109:
    s_cmp_eq_u32 s71, 0
    s_cbranch_scc1 L_g_nfl_109_d
    v_mov_b32 v10, 1
    s_mov_b64 exec, 1
    s_waitcnt vmcnt(0)
    ds_add_rtn_u32 v10, v15, v10 offset:4
    s_waitcnt lgkmcnt(0)
    v_readfirstlane_b32 s46, v10
    s_mov_b64 exec, -1
    s_mov_b32 s71, 0
    s_sub_u32 s59, s60, 1
    s_mul_i32 s59, s59, s78
    s_add_u32 s59, s59, s74
    s_cmp_lg_u32 s46, s68
    s_cbranch_scc1 L_g_df_119
    v_mov_b32 v10, s59
    v_add_u32 v10, 1, v10
    v_mov_b32 v11, 0
    s_mov_b64 exec, 1
    buffer_store_dword v10, v11, s[12:15], s52 offen sc1
    s_mov_b64 exec, -1
L_sf_120:
L_g_df_119:
    s_add_u32 s68, s68, 4
    s_mov_b32 s65, 2
    s_branch L_g_nfl_109_d
L_g_dp_114_l:
    s_cmp_ge_u32 s62, s66
    s_cbranch_scc1 L_g_dp_114_d
    s_or_b32 s65, s65, 1
    s_add_u32 s47, s61, 4096
    s_mov_b32 m0, s64
    s_add_u32 s62, s62, 1
    buffer_load_dwordx4 v3, s[12:15], s61 offen offset:0 sc1 lds
    buffer_load_dwordx4 v3, s[12:15], s61 offen offset:1024 sc1 lds
    buffer_load_dwordx4 v3, s[12:15], s61 offen offset:2048 sc1 lds
    buffer_load_dwordx4 v3, s[12:15], s61 offen offset:3072 sc1 lds
    s_add_u32 m0, s64, 4096
    s_add_u32 s61, s61, s85
    buffer_load_dwordx4 v3, s[12:15], s47 offen offset:0 sc1 lds
    buffer_load_dwordx4 v3, s[12:15], s47 offen offset:1024 sc1 lds
    buffer_load_dwordx4 v3, s[12:15], s47 offen offset:2048 sc1 lds
    buffer_load_dwordx4 v3, s[12:15], s47 offen offset:3072 sc1 lds
    s_xor_b32 s64, s64, 0x10000
    s_branch L_g_dp_114_a
L_g_nw1_111:
    s_cmp_eq_u32 s65, 2
    s_cbranch_scc1 L_g_nw1_111_w
    s_waitcnt vmcnt(0)
L_g_nw1_111_w:
    s_barrier
    ds_read_b128 v[32:35], v4 offset:0
    ds_read_b128 v[36:39], v4 offset:1024
    ds_read_b128 v[40:43], v4 offset:2048
    ds_read_b128 v[44:47], v4 offset:3072
    ds_read_b128 v[48:51], v4 offset:4096
    ds_read_b128 v[52:55], v4 offset:5120
    ds_read_b128 v[56:59], v4 offset:6144
    ds_read_b128 v[60:63], v4 offset:7168
    s_branch L_g_jn_113
L_g_mm2_112:
    s_setprio 1
    s_waitcnt lgkmcnt(6)
    v_mfma_f32_32x32x16_bf16 v[16:31], a[0:3], v[32:35], 0
    ds_read_b128 v[32:35], v4 offset:8192
    ds_read_b32 v14, v15
    v_mfma_f32_32x32x16_bf16 v[16:31], a[4:7], v[36:39], v[16:31]
    ds_read_b128 v[36:39], v4 offset:9216
    s_waitcnt lgkmcnt(6)
    v_mfma_f32_32x32x16_bf16 v[16:31], a[8:11], v[40:43], v[16:31]
    ds_read_b128 v[40:43], v4 offset:10240
    v_mfma_f32_32x32x16_bf16 v[16:31], a[12:15], v[44:47], v[16:31]
    ds_read_b128 v[44:47], v4 offset:11264
    s_waitcnt lgkmcnt(6)
    v_mfma_f32_32x32x16_bf16 v[16:31], a[16:19], v[48:51], v[16:31]
    ds_read_b128 v[48:51], v4 offset:12288
    v_mfma_f32_32x32x16_bf16 v[16:31], a[20:23], v[52:55], v[16:31]
    ds_read_b128 v[52:55], v4 offset:13312
    s_waitcnt lgkmcnt(6)
    v_mfma_f32_32x32x16_bf16 v[16:31], a[24:27], v[56:59], v[16:31]
    ds_read_b128 v[56:59], v4 offset:14336
    v_mfma_f32_32x32x16_bf16 v[16:31], a[28:31], v[60:63], v[16:31]
    ds_read_b128 v[60:63], v4 offset:15360
    s_waitcnt lgkmcnt(6)
    v_mfma_f32_32x32x16_bf16 v[16:31], a[32:35], v[32:35], v[16:31]
    ds_read_b128 v[32:35], v4 offset:16384
    v_mfma_f32_32x32x16_bf16 v[16:31], a[36:39], v[36:39], v[16:31]
    ds_read_b128 v[36:39], v4 offset:17408
    s_waitcnt lgkmcnt(6)
    v_mfma_f32_32x32x16_bf16 v[16:31], a[40:43], v[40:43], v[16:31]
    ds_read_b128 v[40:43], v4 offset:18432
    v_mfma_f32_32x32x16_bf16 v[16:31], a[44:47], v[44:47], v[16:31]
    ds_read_b128 v[44:47], v4 offset:19456
    s_waitcnt lgkmcnt(6)
    v_mfma_f32_32x32x16_bf16 v[16:31], a[48:51], v[48:51], v[16:31]
    ds_read_b128 v[48:51], v4 offset:20480
    v_mfma_f32_32x32x16_bf16 v[16:31], a[52:55], v[52:55], v[16:31]
    ds_read_b128 v[52:55], v4 offset:21504
    s_waitcnt lgkmcnt(6)
    v_mfma_f32_32x32x16_bf16 v[16:31], a[56:59], v[56:59], v[16:31]
    ds_read_b128 v[56:59], v4 offset:22528
    v_mfma_f32_32x32x16_bf16 v[16:31], a[60:63], v[60:63], v[16:31]
    ds_read_b128 v[60:63], v4 offset:23552
    s_waitcnt lgkmcnt(6)
    v_mfma_f32_32x32x16_bf16 v[16:31], a[64:67], v[32:35], v[16:31]
    ds_read_b128 v[32:35], v4 offset:24576
    v_mfma_f32_32x32x16_bf16 v[16:31], a[68:71], v[36:39], v[16:31]
    ds_read_b128 v[36:39], v4 offset:25600
    s_waitcnt lgkmcnt(6)
    v_mfma_f32_32x32x16_bf16 v[16:31], a[72:75], v[40:43], v[16:31]
    ds_read_b128 v[40:43], v4 offset:26624
    v_mfma_f32_32x32x16_bf16 v[16:31], a[76:79], v[44:47], v[16:31]
    ds_read_b128 v[44:47], v4 offset:27648
    s_waitcnt lgkmcnt(6)
    v_mfma_f32_32x32x16_bf16 v[16:31], a[80:83], v[48:51], v[16:31]
    ds_read_b128 v[48:51], v4 offset:28672
    v_mfma_f32_32x32x16_bf16 v[16:31], a[84:87], v[52:55], v[16:31]
    ds_read_b128 v[52:55], v4 offset:29696
    s_waitcnt lgkmcnt(6)
    v_mfma_f32_32x32x16_bf16 v[16:31], a[88:91], v[56:59], v[16:31]
    ds_read_b128 v[56:59], v4 offset:30720
    v_mfma_f32_32x32x16_bf16 v[16:31], a[92:95], v[60:63], v[16:31]
    ds_read_b128 v[60:63], v4 offset:31744
    s_waitcnt lgkmcnt(6)
    v_mfma_f32_32x32x16_bf16 v[16:31], a[96:99], v[32:35], v[16:31]
    v_mfma_f32_32x32x16_bf16 v[16:31], a[100:103], v[36:39], v[16:31]
    s_waitcnt lgkmcnt(4)
    v_mfma_f32_32x32x16_bf16 v[16:31], a[104:107], v[40:43], v[16:31]
    v_mfma_f32_32x32x16_bf16 v[16:31], a[108:111], v[44:47], v[16:31]
    s_waitcnt lgkmcnt(2)
    v_mfma_f32_32x32x16_bf16 v[16:31], a[112:115], v[48:51], v[16:31]
    v_mfma_f32_32x32x16_bf16 v[16:31], a[116:119], v[52:55], v[16:31]
    s_waitcnt lgkmcnt(0)
    v_mfma_f32_32x32x16_bf16 v[16:31], a[120:123], v[56:59], v[16:31]
    v_mfma_f32_32x32x16_bf16 v[16:31], a[124:127], v[60:63], v[16:31]
    v_xor_b32 v4, 0x10000, v4
    s_setprio 0
    s_waitcnt vmcnt(0)
    s_branch L_g_mm2_112_d
L_w_f2_13:
    s_load_dwordx2 s[4:5], s[0:1], 80
    s_load_dwordx2 s[6:7], s[0:1], 72
    s_and_b32 s50, s44, 3
    s_lshr_b32 s51, s44, 2
    s_waitcnt lgkmcnt(0)
    s_mov_b32 s24, s4
    s_and_b32 s25, s5, 0xffff
    s_mov_b32 s26, 0x700000
    s_mov_b32 s27, 0x00020000
    v_lshrrev_b32 v3, 4, v1
    v_and_b32 v4, 15, v1
    v_lshlrev_b32 v5, 2, v3
    v_xor_b32 v4, v4, v5
    v_mul_u32_u24 v3, 2048, v3
    v_lshl_add_u32 v3, v4, 4, v3
    s_mul_i32 s46, s51, 448
    s_mul_i32 s47, s50, 16
    s_add_u32 s46, s46, s47
    s_mul_i32 s47, s42, 896
    s_add_u32 s46, s46, s47
    s_mul_i32 s46, s46, 2048
    s_lshl_b32 s47, s43, 8
    s_add_u32 s46, s46, s47
    s_lshl_b32 s45, s51, 16
    s_mul_i32 s47, s50, 4096
    s_add_u32 s45, s45, s47
    v_bfe_u32 v4, v1, 2, 2
    v_bfe_u32 v5, v1, 4, 1
    v_lshlrev_b32 v5, 1, v5
    v_bfe_u32 v6, v1, 1, 1
    v_add_u32 v5, v5, v6
    s_lshl_b32 s47, s50, 2
    v_add_u32 v5, s47, v5
    v_lshlrev_b32 v6, 2, v4
    v_xor_b32 v5, v5, v6
    v_lshlrev_b32 v5, 4, v5
    v_lshl_add_u32 v5, v4, 8, v5
    v_bfe_u32 v6, v1, 0, 1
    v_lshl_add_u32 v5, v6, 3, v5
    v_lshrrev_b32 v6, 5, v1
    v_mul_u32_u24 v6, 1024, v6
    v_add_u32 v5, v5, v6
    s_lshl_b32 s47, s51, 16
    v_add_u32 v5, s47, v5
    v_bfe_u32 v4, v1, 2, 2
    v_xor_b32 v5, s50, v4
    v_lshlrev_b32 v5, 6, v5
    v_lshl_add_u32 v5, v4, 8, v5
    v_and_b32 v6, 3, v1
    v_lshl_add_u32 v5, v6, 3, v5
    v_lshrrev_b32 v6, 4, v1
    v_lshl_add_u32 v5, v6, 10, v5
    v_lshrrev_b32 v6, 5, v1
    v_lshl_add_u32 v5, v6, 11, v5
    s_lshl_b32 s47, s51, 16
    v_add_u32 v5, s47, v5
    s_add_u32 m0, s45, 0
    s_add_u32 s47, s46, 0x0
    buffer_load_dwordx4 v3, s[24:27], s47 offen nt lds
    s_add_u32 m0, s45, 1024
    s_add_u32 s47, s46, 0x2000
    buffer_load_dwordx4 v3, s[24:27], s47 offen nt lds
    s_add_u32 m0, s45, 2048
    s_add_u32 s47, s46, 0x4000
    buffer_load_dwordx4 v3, s[24:27], s47 offen nt lds
    s_add_u32 m0, s45, 3072
    s_add_u32 s47, s46, 0x6000
    buffer_load_dwordx4 v3, s[24:27], s47 offen nt lds
    s_add_u32 m0, s45, 16384
    s_add_u32 s47, s46, 0x20000
    buffer_load_dwordx4 v3, s[24:27], s47 offen nt lds
    s_add_u32 m0, s45, 17408
    s_add_u32 s47, s46, 0x22000
    buffer_load_dwordx4 v3, s[24:27], s47 offen nt lds
    s_add_u32 m0, s45, 18432
    s_add_u32 s47, s46, 0x24000
    buffer_load_dwordx4 v3, s[24:27], s47 offen nt lds
    s_add_u32 m0, s45, 19456
    s_add_u32 s47, s46, 0x26000
    buffer_load_dwordx4 v3, s[24:27], s47 offen nt lds
    s_add_u32 m0, s45, 32768
    s_add_u32 s47, s46, 0x40000
    buffer_load_dwordx4 v3, s[24:27], s47 offen nt lds
    s_add_u32 m0, s45, 33792
    s_add_u32 s47, s46, 0x42000
    buffer_load_dwordx4 v3, s[24:27], s47 offen nt lds
    s_add_u32 m0, s45, 34816
    s_add_u32 s47, s46, 0x44000
    buffer_load_dwordx4 v3, s[24:27], s47 offen nt lds
    s_add_u32 m0, s45, 35840
    s_add_u32 s47, s46, 0x46000
    buffer_load_dwordx4 v3, s[24:27], s47 offen nt lds
    s_add_u32 m0, s45, 49152
    s_add_u32 s47, s46, 0x60000
    buffer_load_dwordx4 v3, s[24:27], s47 offen nt lds
    s_add_u32 m0, s45, 50176
    s_add_u32 s47, s46, 0x62000
    buffer_load_dwordx4 v3, s[24:27], s47 offen nt lds
    s_add_u32 m0, s45, 51200
    s_add_u32 s47, s46, 0x64000
    buffer_load_dwordx4 v3, s[24:27], s47 offen nt lds
    s_add_u32 m0, s45, 52224
    s_add_u32 s47, s46, 0x66000
    buffer_load_dwordx4 v3, s[24:27], s47 offen nt lds
    s_waitcnt vmcnt(12) lgkmcnt(0)
    s_barrier
    ds_read_b64_tr_b16 a[0:1], v5 offset:0
    ds_read_b64_tr_b16 a[2:3], v5 offset:2048
    ds_read_b64_tr_b16 a[4:5], v5 offset:32
    ds_read_b64_tr_b16 a[6:7], v5 offset:2080
    ds_read_b64_tr_b16 a[8:9], v5 offset:8192
    ds_read_b64_tr_b16 a[10:11], v5 offset:10240
    ds_read_b64_tr_b16 a[12:13], v5 offset:8224
    ds_read_b64_tr_b16 a[14:15], v5 offset:10272
    s_waitcnt vmcnt(8) lgkmcnt(0)
    s_barrier
    s_add_u32 m0, s45, 0
    s_add_u32 s47, s46, 0x80000
    buffer_load_dwordx4 v3, s[24:27], s47 offen nt lds
    s_add_u32 m0, s45, 1024
    s_add_u32 s47, s46, 0x82000
    buffer_load_dwordx4 v3, s[24:27], s47 offen nt lds
    s_add_u32 m0, s45, 2048
    s_add_u32 s47, s46, 0x84000
    buffer_load_dwordx4 v3, s[24:27], s47 offen nt lds
    s_add_u32 m0, s45, 3072
    s_add_u32 s47, s46, 0x86000
    buffer_load_dwordx4 v3, s[24:27], s47 offen nt lds
    ds_read_b64_tr_b16 a[16:17], v5 offset:16384
    ds_read_b64_tr_b16 a[18:19], v5 offset:18432
    ds_read_b64_tr_b16 a[20:21], v5 offset:16416
    ds_read_b64_tr_b16 a[22:23], v5 offset:18464
    ds_read_b64_tr_b16 a[24:25], v5 offset:24576
    ds_read_b64_tr_b16 a[26:27], v5 offset:26624
    ds_read_b64_tr_b16 a[28:29], v5 offset:24608
    ds_read_b64_tr_b16 a[30:31], v5 offset:26656
    s_waitcnt vmcnt(8) lgkmcnt(0)
    s_barrier
    s_add_u32 m0, s45, 16384
    s_add_u32 s47, s46, 0xa0000
    buffer_load_dwordx4 v3, s[24:27], s47 offen nt lds
    s_add_u32 m0, s45, 17408
    s_add_u32 s47, s46, 0xa2000
    buffer_load_dwordx4 v3, s[24:27], s47 offen nt lds
    s_add_u32 m0, s45, 18432
    s_add_u32 s47, s46, 0xa4000
    buffer_load_dwordx4 v3, s[24:27], s47 offen nt lds
    s_add_u32 m0, s45, 19456
    s_add_u32 s47, s46, 0xa6000
    buffer_load_dwordx4 v3, s[24:27], s47 offen nt lds
    ds_read_b64_tr_b16 a[32:33], v5 offset:32768
    ds_read_b64_tr_b16 a[34:35], v5 offset:34816
    ds_read_b64_tr_b16 a[36:37], v5 offset:32800
    ds_read_b64_tr_b16 a[38:39], v5 offset:34848
    ds_read_b64_tr_b16 a[40:41], v5 offset:40960
    ds_read_b64_tr_b16 a[42:43], v5 offset:43008
    ds_read_b64_tr_b16 a[44:45], v5 offset:40992
    ds_read_b64_tr_b16 a[46:47], v5 offset:43040
    s_waitcnt vmcnt(8) lgkmcnt(0)
    s_barrier
    s_add_u32 m0, s45, 32768
    s_add_u32 s47, s46, 0xc0000
    buffer_load_dwordx4 v3, s[24:27], s47 offen nt lds
    s_add_u32 m0, s45, 33792
    s_add_u32 s47, s46, 0xc2000
    buffer_load_dwordx4 v3, s[24:27], s47 offen nt lds
    s_add_u32 m0, s45, 34816
    s_add_u32 s47, s46, 0xc4000
    buffer_load_dwordx4 v3, s[24:27], s47 offen nt lds
    s_add_u32 m0, s45, 35840
    s_add_u32 s47, s46, 0xc6000
    buffer_load_dwordx4 v3, s[24:27], s47 offen nt lds
    ds_read_b64_tr_b16 a[48:49], v5 offset:49152
    ds_read_b64_tr_b16 a[50:51], v5 offset:51200
    ds_read_b64_tr_b16 a[52:53], v5 offset:49184
    ds_read_b64_tr_b16 a[54:55], v5 offset:51232
    ds_read_b64_tr_b16 a[56:57], v5 offset:57344
    ds_read_b64_tr_b16 a[58:59], v5 offset:59392
    ds_read_b64_tr_b16 a[60:61], v5 offset:57376
    ds_read_b64_tr_b16 a[62:63], v5 offset:59424
    s_waitcnt vmcnt(8) lgkmcnt(0)
    s_barrier
    ds_read_b64_tr_b16 a[64:65], v5 offset:0
    ds_read_b64_tr_b16 a[66:67], v5 offset:2048
    ds_read_b64_tr_b16 a[68:69], v5 offset:32
    ds_read_b64_tr_b16 a[70:71], v5 offset:2080
    ds_read_b64_tr_b16 a[72:73], v5 offset:8192
    ds_read_b64_tr_b16 a[74:75], v5 offset:10240
    ds_read_b64_tr_b16 a[76:77], v5 offset:8224
    ds_read_b64_tr_b16 a[78:79], v5 offset:10272
    s_waitcnt vmcnt(4) lgkmcnt(0)
    s_barrier
    ds_read_b64_tr_b16 a[80:81], v5 offset:16384
    ds_read_b64_tr_b16 a[82:83], v5 offset:18432
    ds_read_b64_tr_b16 a[84:85], v5 offset:16416
    ds_read_b64_tr_b16 a[86:87], v5 offset:18464
    ds_read_b64_tr_b16 a[88:89], v5 offset:24576
    ds_read_b64_tr_b16 a[90:91], v5 offset:26624
    ds_read_b64_tr_b16 a[92:93], v5 offset:24608
    ds_read_b64_tr_b16 a[94:95], v5 offset:26656
    s_waitcnt vmcnt(0) lgkmcnt(0)
    s_barrier
    ds_read_b64_tr_b16 a[96:97], v5 offset:32768
    ds_read_b64_tr_b16 a[98:99], v5 offset:34816
    ds_read_b64_tr_b16 a[100:101], v5 offset:32800
    ds_read_b64_tr_b16 a[102:103], v5 offset:34848
    ds_read_b64_tr_b16 a[104:105], v5 offset:40960
    ds_read_b64_tr_b16 a[106:107], v5 offset:43008
    ds_read_b64_tr_b16 a[108:109], v5 offset:40992
    ds_read_b64_tr_b16 a[110:111], v5 offset:43040
    s_waitcnt lgkmcnt(0)
    s_barrier
    v_lshlrev_b32 v2, 4, v1
    s_mul_i32 s64, s44, 7168
    s_add_u32 s46, s64, 0x6000000
    s_mul_i32 s47, s42, 57344
    s_add_u32 s46, s46, s47
    v_add_u32 v3, s46, v2
    s_mul_i32 s46, s51, 28672
    v_add_u32 v4, s46, v2
    v_and_b32 v6, 15, v1
    v_lshlrev_b32 v6, 4, v6
    v_lshrrev_b32 v7, 4, v1
    v_lshl_add_u32 v6, v7, 9, v6
    v_add_u32 v4, s46, v6
    s_lshl_b32 s46, s50, 12
    s_add_u32 s46, s46, 131072
    v_add_u32 v5, s46, v2
    v_and_b32 v7, 15, v1
    v_min_u32 v7, 6, v7
    v_lshlrev_b32 v7, 7, v7
    s_mul_i32 s46, s42, 896
    s_add_u32 s46, s46, 0x106400
    v_add_u32 v7, s46, v7
    s_lshl_b32 s46, s42, 16
    s_lshl_b32 s47, s43, 11
    s_add_u32 s46, s46, s47
    s_lshl_b32 s47, s50, 9
    s_add_u32 s46, s46, s47
    s_add_u32 s46, s46, 0xb000000
    v_and_b32 v8, 31, v1
    v_lshlrev_b32 v8, 4, v8
    v_lshrrev_b32 v9, 5, v1
    v_lshl_add_u32 v8, v9, 14, v8
    v_add_u32 v8, s46, v8
    v_add_u32 v9, 0x8000, v8
    s_lshl_b32 s52, s43, 9
    s_lshl_b32 s47, s42, 7
    s_add_u32 s52, s52, s47
    s_add_u32 s52, s52, 0x108400
    s_add_u32 s52, s52, s76
    s_mul_i32 s46, s43, 7168
    s_add_u32 s46, s46, 0x6000000
    s_mul_i32 s47, s42, 57344
    s_add_u32 s46, s46, s47
    v_min_u32 v116, 55, v1
    v_lshlrev_b32 v116, 7, v116
    v_add_u32 v116, s46, v116
    s_mov_b32 s60, 0
    s_mul_i32 s61, s74, 229376
    s_mov_b32 s62, 0
    s_mul_i32 s63, s74, 262144
    s_mul_i32 s85, s78, 229376
    s_mul_i32 s86, s78, 262144
    s_sub_u32 s46, s78, 1
    s_sub_u32 s75, s75, s74
    s_add_u32 s75, s75, s46
    s_lshr_b32 s75, s75, s46
    s_mov_b32 s67, 0
    s_mov_b32 s68, 3
    s_mov_b32 s71, 0
    v_mov_b32 v15, 147456
    v_mov_b32 v14, 0
    ds_write_b32 v15, v14 offset:4
    ds_write_b32 v15, v14 offset:12
    ds_write_b32 v15, v14 offset:16
    v_mov_b32 v114, 1
    v_mov_b32 v115, 0
    s_mov_b32 s81, 0
    s_mul_i32 s87, s78, 2
    s_sub_u32 s87, s74, s87
    s_add_u32 s87, s87, 1
    s_lshl_b32 s46, s44, 5
    v_add_u32 v119, s46, v15
    v_lshrrev_b32 v113, 4, v1
    v_mul_u32_u24 v113, s78, v113
    v_add_u32 v113, s74, v113
    s_mov_b32 s72, 0
L_g_restart_121:
    s_cmp_lg_u32 s44, 0
    s_cbranch_scc1 L_g_nsp_122
    s_mov_b32 s70, 0
L_g_sp_128:
    s_add_u32 s54, s60, 0
    s_mul_i32 s55, s54, s78
    v_add_u32 v12, s55, v113
    v_subrev_u32 v13, 58, v12
    v_ashrrev_i32 v11, 31, v13
    v_and_b32 v13, 1, v13
    v_add_u32 v13, 1, v13
    v_bfi_b32 v13, v11, 0, v13
    v_lshl_add_u32 v13, v13, 16, v7
    buffer_load_dword v11, v13, s[12:15], 0 offen sc1
    s_waitcnt vmcnt(0)
    v_cmp_ge_u32 vcc, v12, v11
    s_add_u32 s70, s70, 1
    s_and_b32 s46, vcc_lo, 0xffff
    s_cbranch_scc0 L_g_sp_128_ok
    s_sleep 3
    s_cmp_lt_u32 s70, 524288
    s_cbranch_scc1 L_g_sp_128
    s_branch L_c_done_1
L_g_sp_128_ok:
    v_cmp_ge_u32 vcc, v12, v11
    s_nop 0
    s_ff1_i32_b64 s46, vcc
    s_lshr_b32 s46, s46, 4
    s_min_u32 s46, s46, 4
    s_add_u32 s46, s46, s54
    s_min_u32 s46, s46, s75
    v_mov_b32 v118, s46
    ds_write_b32 v15, v118 offset:20
L_g_nsp_122:
    s_waitcnt lgkmcnt(0)
    s_barrier
    ds_read_b32 v14, v15 offset:20
    s_waitcnt lgkmcnt(0)
    v_readfirstlane_b32 s66, v14
    s_nop 3
L_g_restart_121_go:
    s_mov_b32 s69, 0
    s_cmp_gt_u32 s62, s60
    s_cbranch_scc1 L_g_nd_129
    s_cmp_ge_u32 s62, s66
    s_cbranch_scc1 L_g_nd_129
    s_add_u32 s47, s61, 4096
    s_add_u32 m0, s64, 0
    s_nop 0
    buffer_load_dwordx4 v3, s[12:15], s61 offen offset:0 sc1 lds
    buffer_load_dwordx4 v3, s[12:15], s61 offen offset:1024 sc1 lds
    buffer_load_dwordx4 v3, s[12:15], s61 offen offset:2048 sc1 lds
    buffer_load_dwordx4 v3, s[12:15], s61 offen offset:3072 sc1 lds
    s_add_u32 m0, s64, 4096
    s_nop 0
    buffer_load_dwordx4 v3, s[12:15], s47 offen offset:0 sc1 lds
    buffer_load_dwordx4 v3, s[12:15], s47 offen offset:1024 sc1 lds
    buffer_load_dwordx4 v3, s[12:15], s47 offen offset:2048 sc1 lds
    s_add_u32 s61, s61, s85
    s_add_u32 s62, s62, 1
    s_xor_b32 s64, s64, 0x10000
    s_mov_b32 s69, 1
L_g_nd_129:
    s_cmp_eq_u32 s51, 1
    s_cbranch_scc1 L_g_g1r_123
    s_add_u32 s59, s60, 1
    s_mov_b32 s69, 0
    s_cmp_gt_u32 s62, s59
    s_cbranch_scc1 L_g_nd_130
    s_cmp_ge_u32 s62, s66
    s_cbranch_scc1 L_g_nd_130
    s_add_u32 s47, s61, 4096
    s_add_u32 m0, s64, 0
    s_nop 0
    buffer_load_dwordx4 v3, s[12:15], s61 offen offset:0 sc1 lds
    buffer_load_dwordx4 v3, s[12:15], s61 offen offset:1024 sc1 lds
    buffer_load_dwordx4 v3, s[12:15], s61 offen offset:2048 sc1 lds
    buffer_load_dwordx4 v3, s[12:15], s61 offen offset:3072 sc1 lds
    s_add_u32 m0, s64, 4096
    s_nop 0
    buffer_load_dwordx4 v3, s[12:15], s47 offen offset:0 sc1 lds
    buffer_load_dwordx4 v3, s[12:15], s47 offen offset:1024 sc1 lds
    buffer_load_dwordx4 v3, s[12:15], s47 offen offset:2048 sc1 lds
    s_add_u32 s61, s61, s85
    s_add_u32 s62, s62, 1
    s_xor_b32 s64, s64, 0x10000
    s_mov_b32 s69, 1
L_g_nd_130:
    s_cmp_eq_u32 s69, 1
    s_cbranch_scc1 L_g_w0_131
    s_waitcnt vmcnt(0)
L_g_w0_131:
    s_waitcnt vmcnt(7)
    s_cmp_lg_u32 s44, 0
    s_cbranch_scc1 L_g_nl_132
    s_cmp_lt_u32 s66, s75
    s_cselect_b32 s81, 1, 2
L_g_nl_132:
L_g_loop0_124_l:
    s_barrier
    ds_read_b128 v[32:35], v4 offset:0
    ds_read_b128 v[36:39], v4 offset:256
    ds_read_b128 v[40:43], v4 offset:2048
    ds_read_b128 v[44:47], v4 offset:2304
    ds_read_b128 v[48:51], v4 offset:4096
    ds_read_b128 v[52:55], v4 offset:4352
    ds_read_b128 v[56:59], v4 offset:6144
    ds_read_b128 v[60:63], v4 offset:6400
    s_branch L_g_loop0_124_m
.p2align 6
L_g_loop0_124:
    s_barrier
L_g_loop0_124_m:
    s_setprio 2
    s_waitcnt lgkmcnt(6)
    v_mfma_f32_16x16x32_bf16 v[16:19], v[32:35], a[0:3], 0
    v_mfma_f32_16x16x32_bf16 v[20:23], v[32:35], a[4:7], 0
    ds_read_b128 v[32:35], v4 offset:8192
    v_mfma_f32_16x16x32_bf16 v[28:31], v[36:39], a[4:7], 0
    v_mfma_f32_16x16x32_bf16 v[24:27], v[36:39], a[0:3], 0
    ds_read_b128 v[36:39], v4 offset:8448
    s_cmp_eq_u32 s81, 1
    s_cbranch_scc1 L_g_h1_136
L_g_h1_136_b:
    s_waitcnt lgkmcnt(6)
    v_mfma_f32_16x16x32_bf16 v[16:19], v[40:43], a[8:11], v[16:19]
    v_mfma_f32_16x16x32_bf16 v[20:23], v[40:43], a[12:15], v[20:23]
    ds_read_b128 v[40:43], v4 offset:10240
    v_mfma_f32_16x16x32_bf16 v[28:31], v[44:47], a[12:15], v[28:31]
    v_mfma_f32_16x16x32_bf16 v[24:27], v[44:47], a[8:11], v[24:27]
    ds_read_b128 v[44:47], v4 offset:10496
    s_waitcnt lgkmcnt(6)
    v_mfma_f32_16x16x32_bf16 v[16:19], v[48:51], a[16:19], v[16:19]
    v_mfma_f32_16x16x32_bf16 v[20:23], v[48:51], a[20:23], v[20:23]
    ds_read_b128 v[48:51], v4 offset:12288
    v_mfma_f32_16x16x32_bf16 v[28:31], v[52:55], a[20:23], v[28:31]
    v_mfma_f32_16x16x32_bf16 v[24:27], v[52:55], a[16:19], v[24:27]
    ds_read_b128 v[52:55], v4 offset:12544
    s_waitcnt lgkmcnt(6)
    v_mfma_f32_16x16x32_bf16 v[16:19], v[56:59], a[24:27], v[16:19]
    v_mfma_f32_16x16x32_bf16 v[20:23], v[56:59], a[28:31], v[20:23]
    ds_read_b128 v[56:59], v4 offset:14336
    v_mfma_f32_16x16x32_bf16 v[28:31], v[60:63], a[28:31], v[28:31]
    v_mfma_f32_16x16x32_bf16 v[24:27], v[60:63], a[24:27], v[24:27]
    ds_read_b128 v[60:63], v4 offset:14592
    s_waitcnt lgkmcnt(6)
    v_mfma_f32_16x16x32_bf16 v[16:19], v[32:35], a[32:35], v[16:19]
    v_mfma_f32_16x16x32_bf16 v[20:23], v[32:35], a[36:39], v[20:23]
    ds_read_b128 v[32:35], v4 offset:16384
    v_mfma_f32_16x16x32_bf16 v[28:31], v[36:39], a[36:39], v[28:31]
    v_mfma_f32_16x16x32_bf16 v[24:27], v[36:39], a[32:35], v[24:27]
    ds_read_b128 v[36:39], v4 offset:16640
    s_waitcnt lgkmcnt(6)
    v_mfma_f32_16x16x32_bf16 v[16:19], v[40:43], a[40:43], v[16:19]
    v_mfma_f32_16x16x32_bf16 v[20:23], v[40:43], a[44:47], v[20:23]
    ds_read_b128 v[40:43], v4 offset:18432
    v_mfma_f32_16x16x32_bf16 v[28:31], v[44:47], a[44:47], v[28:31]
    v_mfma_f32_16x16x32_bf16 v[24:27], v[44:47], a[40:43], v[24:27]
    ds_read_b128 v[44:47], v4 offset:18688
    s_waitcnt lgkmcnt(6)
    v_mfma_f32_16x16x32_bf16 v[16:19], v[48:51], a[48:51], v[16:19]
    v_mfma_f32_16x16x32_bf16 v[20:23], v[48:51], a[52:55], v[20:23]
    ds_read_b128 v[48:51], v4 offset:20480
    v_mfma_f32_16x16x32_bf16 v[28:31], v[52:55], a[52:55], v[28:31]
    v_mfma_f32_16x16x32_bf16 v[24:27], v[52:55], a[48:51], v[24:27]
    ds_read_b128 v[52:55], v4 offset:20736
    s_waitcnt lgkmcnt(6)
    v_mfma_f32_16x16x32_bf16 v[16:19], v[56:59], a[56:59], v[16:19]
    v_mfma_f32_16x16x32_bf16 v[20:23], v[56:59], a[60:63], v[20:23]
    ds_read_b128 v[56:59], v4 offset:22528
    v_mfma_f32_16x16x32_bf16 v[28:31], v[60:63], a[60:63], v[28:31]
    v_mfma_f32_16x16x32_bf16 v[24:27], v[60:63], a[56:59], v[24:27]
    ds_read_b128 v[60:63], v4 offset:22784
    s_waitcnt lgkmcnt(6)
    v_mfma_f32_16x16x32_bf16 v[16:19], v[32:35], a[64:67], v[16:19]
    v_mfma_f32_16x16x32_bf16 v[20:23], v[32:35], a[68:71], v[20:23]
    ds_read_b128 v[32:35], v4 offset:24576
    v_mfma_f32_16x16x32_bf16 v[28:31], v[36:39], a[68:71], v[28:31]
    v_mfma_f32_16x16x32_bf16 v[24:27], v[36:39], a[64:67], v[24:27]
    ds_read_b128 v[36:39], v4 offset:24832
    s_waitcnt lgkmcnt(6)
    v_mfma_f32_16x16x32_bf16 v[16:19], v[40:43], a[72:75], v[16:19]
    v_mfma_f32_16x16x32_bf16 v[20:23], v[40:43], a[76:79], v[20:23]
    ds_read_b128 v[40:43], v4 offset:26624
    v_mfma_f32_16x16x32_bf16 v[28:31], v[44:47], a[76:79], v[28:31]
    v_mfma_f32_16x16x32_bf16 v[24:27], v[44:47], a[72:75], v[24:27]
    ds_read_b128 v[44:47], v4 offset:26880
    s_waitcnt lgkmcnt(6)
    v_mfma_f32_16x16x32_bf16 v[16:19], v[48:51], a[80:83], v[16:19]
    v_mfma_f32_16x16x32_bf16 v[20:23], v[48:51], a[84:87], v[20:23]
    v_mfma_f32_16x16x32_bf16 v[28:31], v[52:55], a[84:87], v[28:31]
    v_mfma_f32_16x16x32_bf16 v[24:27], v[52:55], a[80:83], v[24:27]
    s_waitcnt lgkmcnt(4)
    v_mfma_f32_16x16x32_bf16 v[16:19], v[56:59], a[88:91], v[16:19]
    v_mfma_f32_16x16x32_bf16 v[20:23], v[56:59], a[92:95], v[20:23]
    v_mfma_f32_16x16x32_bf16 v[28:31], v[60:63], a[92:95], v[28:31]
    v_mfma_f32_16x16x32_bf16 v[24:27], v[60:63], a[88:91], v[24:27]
    s_waitcnt lgkmcnt(2)
    v_mfma_f32_16x16x32_bf16 v[16:19], v[32:35], a[96:99], v[16:19]
    v_mfma_f32_16x16x32_bf16 v[20:23], v[32:35], a[100:103], v[20:23]
    s_cmp_eq_u32 s81, 1
    s_cbranch_scc1 L_g_h2_137
L_g_h2_137_b:
    ds_write_b32 v119, v118
    v_mfma_f32_16x16x32_bf16 v[28:31], v[36:39], a[100:103], v[28:31]
    v_mfma_f32_16x16x32_bf16 v[24:27], v[36:39], a[96:99], v[24:27]
    s_waitcnt lgkmcnt(0)
    v_mfma_f32_16x16x32_bf16 v[16:19], v[40:43], a[104:107], v[16:19]
    v_mfma_f32_16x16x32_bf16 v[20:23], v[40:43], a[108:111], v[20:23]
    v_mfma_f32_16x16x32_bf16 v[28:31], v[44:47], a[108:111], v[28:31]
    v_mfma_f32_16x16x32_bf16 v[24:27], v[44:47], a[104:107], v[24:27]
    v_xor_b32 v4, 0x10000, v4
    s_setprio 0
    s_waitcnt vmcnt(0)
    s_waitcnt lgkmcnt(0)
    s_barrier
    ds_read_b32 v14, v15
    s_nop 6
    ds_write_b128 v5, v[16:19] offset:0
    ds_write_b128 v5, v[20:23] offset:1024
    ds_write_b128 v5, v[24:27] offset:2048
    ds_write_b128 v5, v[28:31] offset:3072
    s_waitcnt lgkmcnt(4)
    v_readfirstlane_b32 s66, v14
    s_add_u32 s60, s60, 1
    s_mov_b32 s65, 0
    s_cmp_le_u32 s62, s60
    s_cbranch_scc1 L_g_dp_138_l
L_g_dp_138_a:
    s_cmp_ge_u32 s62, s66
    s_cbranch_scc1 L_g_dp_138_d
    s_add_u32 s47, s61, 4096
    s_mov_b32 m0, s64
    s_add_u32 s62, s62, 1
    buffer_load_dwordx4 v3, s[12:15], s61 offen offset:0 sc1 lds
    buffer_load_dwordx4 v3, s[12:15], s61 offen offset:1024 sc1 lds
    buffer_load_dwordx4 v3, s[12:15], s61 offen offset:2048 sc1 lds
    buffer_load_dwordx4 v3, s[12:15], s61 offen offset:3072 sc1 lds
    s_add_u32 m0, s64, 4096
    s_add_u32 s61, s61, s85
    buffer_load_dwordx4 v3, s[12:15], s47 offen offset:0 sc1 lds
    buffer_load_dwordx4 v3, s[12:15], s47 offen offset:1024 sc1 lds
    buffer_load_dwordx4 v3, s[12:15], s47 offen offset:2048 sc1 lds
    s_xor_b32 s64, s64, 0x10000
L_g_dp_138_d:
    s_cmp_lg_u32 s44, 2
    s_cbranch_scc1 L_g_pf_139
    s_cmp_ge_u32 s62, s66
    s_cbranch_scc1 L_g_pf_139
    buffer_load_dword v117, v116, s[12:15], s61 offen sc1
L_g_pf_139:
    s_cmp_le_u32 s66, s60
    s_cbranch_scc1 L_g_ex0_135
    s_cmp_lg_u32 s65, 0
    s_cbranch_scc1 L_g_nw_134
    ds_read_b128 v[32:35], v4 offset:0
    ds_read_b128 v[36:39], v4 offset:256
    ds_read_b128 v[40:43], v4 offset:2048
    ds_read_b128 v[44:47], v4 offset:2304
    ds_read_b128 v[48:51], v4 offset:4096
    ds_read_b128 v[52:55], v4 offset:4352
    ds_read_b128 v[56:59], v4 offset:6144
    ds_read_b128 v[60:63], v4 offset:6400
    s_cmp_lg_u32 s44, 0
    s_cbranch_scc1 L_g_nl_140
    s_mov_b32 s46, s66
    s_cmp_lg_u32 s81, 0
    s_cbranch_scc1 L_g_nl_140_e
    v_cmp_ge_u32 vcc, v12, v11
    s_nop 0
    s_ff1_i32_b64 s46, vcc
    s_lshr_b32 s46, s46, 4
    s_min_u32 s46, s46, 4
    s_add_u32 s46, s46, s54
    s_min_u32 s46, s46, s75
    v_mov_b32 v118, s46
L_g_nl_140_e:
    s_add_u32 s47, s60, 3
    s_min_u32 s47, s47, s75
    s_cmp_lt_u32 s46, s47
    s_cselect_b32 s81, 1, 0
    s_cbranch_scc1 L_g_nl_140
    s_add_u32 s54, s60, 2
    s_mul_i32 s55, s54, s78
    v_add_u32 v12, s55, v113
    v_subrev_u32 v13, 58, v12
    v_ashrrev_i32 v11, 31, v13
    v_and_b32 v13, 1, v13
    v_add_u32 v13, 1, v13
    v_bfi_b32 v13, v11, 0, v13
    v_lshl_add_u32 v13, v13, 16, v7
    buffer_load_dword v11, v13, s[12:15], 0 offen sc1
L_g_nl_140:
    s_waitcnt lgkmcnt(8)
    s_branch L_g_loop0_124
L_g_ex0_135:
    s_cmp_lg_u32 s44, 0
    s_cbranch_scc1 L_g_ex0_135_n
    ds_write_b32 v15, v118 offset:20
    s_cmp_ge_u32 s60, s75
    s_cbranch_scc1 L_g_ex0_135_n
    s_sleep 6
    s_add_u32 s54, s60, 0
    s_mul_i32 s55, s54, s78
    v_add_u32 v12, s55, v113
    v_subrev_u32 v13, 58, v12
    v_ashrrev_i32 v11, 31, v13
    v_and_b32 v13, 1, v13
    v_add_u32 v13, 1, v13
    v_bfi_b32 v13, v11, 0, v13
    v_lshl_add_u32 v13, v13, 16, v7
    buffer_load_dword v11, v13, s[12:15], 0 offen sc1
    s_waitcnt vmcnt(0)
    v_cmp_ge_u32 vcc, v12, v11
    s_nop 0
    s_ff1_i32_b64 s46, vcc
    s_lshr_b32 s46, s46, 4
    s_min_u32 s46, s46, 4
    s_add_u32 s46, s46, s54
    s_min_u32 s46, s46, s75
    v_mov_b32 v118, s46
    ds_write_b32 v15, v118 offset:20
L_g_ex0_135_n:
    s_waitcnt lgkmcnt(0)
    s_barrier
    ds_read_b32 v14, v15 offset:20
    s_waitcnt lgkmcnt(0)
    v_readfirstlane_b32 s66, v14
    s_barrier
    s_cmp_gt_u32 s66, s60
    s_cbranch_scc1 L_g_restart_121_go
    s_branch L_g_tail_126
L_g_g1r_123:
    s_mov_b32 s65, 1
    s_branch L_g_loop1_125_e
.p2align 6
L_g_loop1_125:
    s_mov_b32 s65, 0
L_g_loop1_125_e:
    s_barrier
    s_bitcmp1_b32 s67, 1
    s_cbranch_scc0 L_g_nfl_141
    s_cmp_lg_u32 s44, 4
    s_cbranch_scc1 L_g_nfl_141_d
    s_mul_i32 s59, s60, s78
    s_add_u32 s59, s59, s87
    v_mov_b32 v10, s59
    buffer_store_dword v10, v115, s[12:15], s52 offen sc1
L_g_nfl_141_d:
    ds_read_b128 v[80:83], v5 offset:0
    ds_read_b128 v[84:87], v5 offset:1024
    ds_read_b128 v[88:91], v5 offset:2048
    ds_read_b128 v[92:95], v5 offset:3072
    s_cmp_le_u32 s62, s60
    s_cbranch_scc1 L_g_dp_146_l
L_g_dp_146_a:
    s_cmp_ge_u32 s62, s66
    s_cbranch_scc1 L_g_dp_146_d
    s_add_u32 s47, s61, 4096
    s_mov_b32 m0, s64
    s_add_u32 s62, s62, 1
    buffer_load_dwordx4 v3, s[12:15], s61 offen offset:0 sc1 lds
    buffer_load_dwordx4 v3, s[12:15], s61 offen offset:1024 sc1 lds
    buffer_load_dwordx4 v3, s[12:15], s61 offen offset:2048 sc1 lds
    buffer_load_dwordx4 v3, s[12:15], s61 offen offset:3072 sc1 lds
    s_add_u32 m0, s64, 4096
    s_add_u32 s61, s61, s85
    buffer_load_dwordx4 v3, s[12:15], s47 offen offset:0 sc1 lds
    buffer_load_dwordx4 v3, s[12:15], s47 offen offset:1024 sc1 lds
    buffer_load_dwordx4 v3, s[12:15], s47 offen offset:2048 sc1 lds
    s_xor_b32 s64, s64, 0x10000
L_g_dp_146_d:
    s_bitcmp1_b32 s67, 0
    s_cbranch_scc0 L_g_nep_142
    s_waitcnt lgkmcnt(0)
    v_add_f32 v80, v80, v16
    v_add_f32 v81, v81, v17
    v_add_f32 v82, v82, v18
    v_add_f32 v83, v83, v19
    v_add_f32 v84, v84, v20
    v_add_f32 v85, v85, v21
    v_add_f32 v86, v86, v22
    v_add_f32 v87, v87, v23
    v_add_f32 v88, v88, v24
    v_add_f32 v89, v89, v25
    v_add_f32 v90, v90, v26
    v_add_f32 v91, v91, v27
    v_add_f32 v92, v92, v28
    v_add_f32 v93, v93, v29
    v_add_f32 v94, v94, v30
    v_add_f32 v95, v95, v31
    v_cvt_pk_bf16_f32 v104, v80, v81
    v_cvt_pk_bf16_f32 v105, v82, v83
    v_cvt_pk_bf16_f32 v106, v84, v85
    v_cvt_pk_bf16_f32 v107, v86, v87
    s_nop 1
    v_permlane16_swap_b32 v104, v106
    v_permlane16_swap_b32 v105, v107
    buffer_store_dwordx4 v[104:107], v8, s[12:15], s63 offen sc1
    v_cvt_pk_bf16_f32 v108, v88, v89
    v_cvt_pk_bf16_f32 v109, v90, v91
    v_cvt_pk_bf16_f32 v110, v92, v93
    v_cvt_pk_bf16_f32 v111, v94, v95
    s_nop 1
    v_permlane16_swap_b32 v108, v110
    v_permlane16_swap_b32 v109, v111
    buffer_store_dwordx4 v[108:111], v9, s[12:15], s63 offen sc1
    s_add_u32 s63, s63, s86
L_g_nep_142:
    s_cmp_lg_u32 s65, 0
    s_cbranch_scc1 L_g_nw1_143
    ds_read_b128 v[32:35], v4 offset:0
    ds_read_b128 v[36:39], v4 offset:256
    ds_read_b128 v[40:43], v4 offset:2048
    ds_read_b128 v[44:47], v4 offset:2304
    ds_read_b128 v[48:51], v4 offset:4096
    ds_read_b128 v[52:55], v4 offset:4352
    ds_read_b128 v[56:59], v4 offset:6144
    ds_read_b128 v[60:63], v4 offset:6400
    s_barrier
L_g_jn_145:
    s_setprio 1
    s_waitcnt lgkmcnt(6)
    v_mfma_f32_16x16x32_bf16 v[16:19], v[32:35], a[0:3], 0
    ds_read_b32 v14, v15
    v_mfma_f32_16x16x32_bf16 v[20:23], v[32:35], a[4:7], 0
    ds_read_b128 v[32:35], v4 offset:8192
    v_mfma_f32_16x16x32_bf16 v[28:31], v[36:39], a[4:7], 0
    v_mfma_f32_16x16x32_bf16 v[24:27], v[36:39], a[0:3], 0
    ds_read_b128 v[36:39], v4 offset:8448
    s_waitcnt lgkmcnt(6)
    v_mfma_f32_16x16x32_bf16 v[16:19], v[40:43], a[8:11], v[16:19]
    v_mfma_f32_16x16x32_bf16 v[20:23], v[40:43], a[12:15], v[20:23]
    ds_read_b128 v[40:43], v4 offset:10240
    v_mfma_f32_16x16x32_bf16 v[28:31], v[44:47], a[12:15], v[28:31]
    v_mfma_f32_16x16x32_bf16 v[24:27], v[44:47], a[8:11], v[24:27]
    ds_read_b128 v[44:47], v4 offset:10496
    s_waitcnt lgkmcnt(6)
    v_mfma_f32_16x16x32_bf16 v[16:19], v[48:51], a[16:19], v[16:19]
    v_mfma_f32_16x16x32_bf16 v[20:23], v[48:51], a[20:23], v[20:23]
    ds_read_b128 v[48:51], v4 offset:12288
    v_mfma_f32_16x16x32_bf16 v[28:31], v[52:55], a[20:23], v[28:31]
    v_mfma_f32_16x16x32_bf16 v[24:27], v[52:55], a[16:19], v[24:27]
    ds_read_b128 v[52:55], v4 offset:12544
    s_waitcnt lgkmcnt(6)
    v_mfma_f32_16x16x32_bf16 v[16:19], v[56:59], a[24:27], v[16:19]
    v_mfma_f32_16x16x32_bf16 v[20:23], v[56:59], a[28:31], v[20:23]
    ds_read_b128 v[56:59], v4 offset:14336
    v_mfma_f32_16x16x32_bf16 v[28:31], v[60:63], a[28:31], v[28:31]
    v_mfma_f32_16x16x32_bf16 v[24:27], v[60:63], a[24:27], v[24:27]
    ds_read_b128 v[60:63], v4 offset:14592
    s_waitcnt lgkmcnt(6)
    v_mfma_f32_16x16x32_bf16 v[16:19], v[32:35], a[32:35], v[16:19]
    v_mfma_f32_16x16x32_bf16 v[20:23], v[32:35], a[36:39], v[20:23]
    ds_read_b128 v[32:35], v4 offset:16384
    v_mfma_f32_16x16x32_bf16 v[28:31], v[36:39], a[36:39], v[28:31]
    v_mfma_f32_16x16x32_bf16 v[24:27], v[36:39], a[32:35], v[24:27]
    ds_read_b128 v[36:39], v4 offset:16640
    s_waitcnt lgkmcnt(6)
    v_mfma_f32_16x16x32_bf16 v[16:19], v[40:43], a[40:43], v[16:19]
    v_mfma_f32_16x16x32_bf16 v[20:23], v[40:43], a[44:47], v[20:23]
    ds_read_b128 v[40:43], v4 offset:18432
    v_mfma_f32_16x16x32_bf16 v[28:31], v[44:47], a[44:47], v[28:31]
    v_mfma_f32_16x16x32_bf16 v[24:27], v[44:47], a[40:43], v[24:27]
    ds_read_b128 v[44:47], v4 offset:18688
    s_waitcnt lgkmcnt(6)
    v_mfma_f32_16x16x32_bf16 v[16:19], v[48:51], a[48:51], v[16:19]
    v_mfma_f32_16x16x32_bf16 v[20:23], v[48:51], a[52:55], v[20:23]
    ds_read_b128 v[48:51], v4 offset:20480
    v_mfma_f32_16x16x32_bf16 v[28:31], v[52:55], a[52:55], v[28:31]
    v_mfma_f32_16x16x32_bf16 v[24:27], v[52:55], a[48:51], v[24:27]
    ds_read_b128 v[52:55], v4 offset:20736
    s_waitcnt lgkmcnt(6)
    v_mfma_f32_16x16x32_bf16 v[16:19], v[56:59], a[56:59], v[16:19]
    v_mfma_f32_16x16x32_bf16 v[20:23], v[56:59], a[60:63], v[20:23]
    ds_read_b128 v[56:59], v4 offset:22528
    v_mfma_f32_16x16x32_bf16 v[28:31], v[60:63], a[60:63], v[28:31]
    v_mfma_f32_16x16x32_bf16 v[24:27], v[60:63], a[56:59], v[24:27]
    ds_read_b128 v[60:63], v4 offset:22784
    s_waitcnt lgkmcnt(6)
    v_mfma_f32_16x16x32_bf16 v[16:19], v[32:35], a[64:67], v[16:19]
    v_mfma_f32_16x16x32_bf16 v[20:23], v[32:35], a[68:71], v[20:23]
    ds_read_b128 v[32:35], v4 offset:24576
    v_mfma_f32_16x16x32_bf16 v[28:31], v[36:39], a[68:71], v[28:31]
    v_mfma_f32_16x16x32_bf16 v[24:27], v[36:39], a[64:67], v[24:27]
    ds_read_b128 v[36:39], v4 offset:24832
    s_waitcnt lgkmcnt(6)
    v_mfma_f32_16x16x32_bf16 v[16:19], v[40:43], a[72:75], v[16:19]
    v_mfma_f32_16x16x32_bf16 v[20:23], v[40:43], a[76:79], v[20:23]
    ds_read_b128 v[40:43], v4 offset:26624
    v_mfma_f32_16x16x32_bf16 v[28:31], v[44:47], a[76:79], v[28:31]
    v_mfma_f32_16x16x32_bf16 v[24:27], v[44:47], a[72:75], v[24:27]
    ds_read_b128 v[44:47], v4 offset:26880
    s_waitcnt lgkmcnt(6)
    v_mfma_f32_16x16x32_bf16 v[16:19], v[48:51], a[80:83], v[16:19]
    v_mfma_f32_16x16x32_bf16 v[20:23], v[48:51], a[84:87], v[20:23]
    v_mfma_f32_16x16x32_bf16 v[28:31], v[52:55], a[84:87], v[28:31]
    v_mfma_f32_16x16x32_bf16 v[24:27], v[52:55], a[80:83], v[24:27]
    s_waitcnt lgkmcnt(4)
    v_mfma_f32_16x16x32_bf16 v[16:19], v[56:59], a[88:91], v[16:19]
    v_mfma_f32_16x16x32_bf16 v[20:23], v[56:59], a[92:95], v[20:23]
    v_mfma_f32_16x16x32_bf16 v[28:31], v[60:63], a[92:95], v[28:31]
    v_mfma_f32_16x16x32_bf16 v[24:27], v[60:63], a[88:91], v[24:27]
    s_waitcnt lgkmcnt(2)
    v_mfma_f32_16x16x32_bf16 v[16:19], v[32:35], a[96:99], v[16:19]
    v_mfma_f32_16x16x32_bf16 v[20:23], v[32:35], a[100:103], v[20:23]
    v_mfma_f32_16x16x32_bf16 v[28:31], v[36:39], a[100:103], v[28:31]
    v_mfma_f32_16x16x32_bf16 v[24:27], v[36:39], a[96:99], v[24:27]
    s_waitcnt lgkmcnt(0)
    v_mfma_f32_16x16x32_bf16 v[16:19], v[40:43], a[104:107], v[16:19]
    v_mfma_f32_16x16x32_bf16 v[20:23], v[40:43], a[108:111], v[20:23]
    v_mfma_f32_16x16x32_bf16 v[28:31], v[44:47], a[108:111], v[28:31]
    v_mfma_f32_16x16x32_bf16 v[24:27], v[44:47], a[104:107], v[24:27]
    v_xor_b32 v4, 0x10000, v4
    s_setprio 0
    s_waitcnt vmcnt(0)
    v_readfirstlane_b32 s66, v14
    s_lshl_b32 s67, s67, 1
    s_or_b32 s67, s67, 1
    s_add_u32 s60, s60, 1
    s_cmp_gt_u32 s66, s60
    s_cbranch_scc1 L_g_loop1_125
    s_barrier
    ds_read_b32 v14, v15 offset:20
    ds_read_b128 v[80:83], v5 offset:0
    ds_read_b128 v[84:87], v5 offset:1024
    ds_read_b128 v[88:91], v5 offset:2048
    ds_read_b128 v[92:95], v5 offset:3072
    s_waitcnt lgkmcnt(4)
    v_readfirstlane_b32 s66, v14
    s_barrier
    s_mov_b32 s69, 0
    s_cmp_gt_u32 s62, s60
    s_cbranch_scc1 L_g_nd_147
    s_cmp_ge_u32 s62, s66
    s_cbranch_scc1 L_g_nd_147
    s_add_u32 s47, s61, 4096
    s_add_u32 m0, s64, 0
    s_nop 0
    buffer_load_dwordx4 v3, s[12:15], s61 offen offset:0 sc1 lds
    buffer_load_dwordx4 v3, s[12:15], s61 offen offset:1024 sc1 lds
    buffer_load_dwordx4 v3, s[12:15], s61 offen offset:2048 sc1 lds
    buffer_load_dwordx4 v3, s[12:15], s61 offen offset:3072 sc1 lds
    s_add_u32 m0, s64, 4096
    s_nop 0
    buffer_load_dwordx4 v3, s[12:15], s47 offen offset:0 sc1 lds
    buffer_load_dwordx4 v3, s[12:15], s47 offen offset:1024 sc1 lds
    buffer_load_dwordx4 v3, s[12:15], s47 offen offset:2048 sc1 lds
    s_add_u32 s61, s61, s85
    s_add_u32 s62, s62, 1
    s_xor_b32 s64, s64, 0x10000
    s_mov_b32 s69, 1
L_g_nd_147:
    s_waitcnt lgkmcnt(3)
    v_add_f32 v80, v80, v16
    v_add_f32 v81, v81, v17
    v_add_f32 v82, v82, v18
    v_add_f32 v83, v83, v19
    s_waitcnt lgkmcnt(2)
    v_add_f32 v84, v84, v20
    v_add_f32 v85, v85, v21
    v_add_f32 v86, v86, v22
    v_add_f32 v87, v87, v23
    s_waitcnt lgkmcnt(1)
    v_add_f32 v88, v88, v24
    v_add_f32 v89, v89, v25
    v_add_f32 v90, v90, v26
    v_add_f32 v91, v91, v27
    s_waitcnt lgkmcnt(0)
    v_add_f32 v92, v92, v28
    v_add_f32 v93, v93, v29
    v_add_f32 v94, v94, v30
    v_add_f32 v95, v95, v31
    v_cvt_pk_bf16_f32 v104, v80, v81
    v_cvt_pk_bf16_f32 v105, v82, v83
    v_cvt_pk_bf16_f32 v106, v84, v85
    v_cvt_pk_bf16_f32 v107, v86, v87
    s_nop 1
    v_permlane16_swap_b32 v104, v106
    v_permlane16_swap_b32 v105, v107
    buffer_store_dwordx4 v[104:107], v8, s[12:15], s63 offen sc1
    v_cvt_pk_bf16_f32 v108, v88, v89
    v_cvt_pk_bf16_f32 v109, v90, v91
    v_cvt_pk_bf16_f32 v110, v92, v93
    v_cvt_pk_bf16_f32 v111, v94, v95
    s_nop 1
    v_permlane16_swap_b32 v108, v110
    v_permlane16_swap_b32 v109, v111
    buffer_store_dwordx4 v[108:111], v9, s[12:15], s63 offen sc1
    s_add_u32 s63, s63, s86
    s_mov_b32 s67, 0
    s_mov_b32 s71, 1
    s_cmp_gt_u32 s66, s60
    s_cbranch_scc1 L_g_g1r_123
    v_mov_b32 v10, 1
    s_mov_b64 exec, 1
    s_waitcnt vmcnt(0)
    ds_add_rtn_u32 v10, v15, v10 offset:4
    s_waitcnt lgkmcnt(0)
    v_readfirstlane_b32 s46, v10
    s_mov_b64 exec, -1
    s_mov_b32 s71, 0
    s_sub_u32 s59, s60, 1
    s_mul_i32 s59, s59, s78
    s_add_u32 s59, s59, s74
    s_cmp_lg_u32 s46, s68
    s_cbranch_scc1 L_g_df_148
    v_mov_b32 v10, s59
    v_add_u32 v10, 1, v10
    v_mov_b32 v11, 0
    s_mov_b64 exec, 1
    buffer_store_dword v10, v11, s[12:15], s52 offen sc1
    s_mov_b64 exec, -1
L_sf_149:
L_g_df_148:
    s_add_u32 s68, s68, 4
    s_cmp_gt_u32 s66, s60
    s_cbranch_scc1 L_g_g1r_123
L_g_tail_126:
    s_cmp_lt_u32 s60, s75
    s_cbranch_scc1 L_g_restart_121
    s_waitcnt vmcnt(0)
    s_barrier
    s_branch L_c_done_1
L_g_h1_136:
    s_add_u32 s54, s60, 1
    s_mul_i32 s55, s54, s78
    v_add_u32 v12, s55, v113
    v_subrev_u32 v13, 58, v12
    v_ashrrev_i32 v11, 31, v13
    v_and_b32 v13, 1, v13
    v_add_u32 v13, 1, v13
    v_bfi_b32 v13, v11, 0, v13
    v_lshl_add_u32 v13, v13, 16, v7
    buffer_load_dword v11, v13, s[12:15], 0 offen sc1
    s_branch L_g_h1_136_b
L_g_h2_137:
    s_waitcnt vmcnt(0)
    v_cmp_ge_u32 vcc, v12, v11
    s_nop 0
    s_ff1_i32_b64 s46, vcc
    s_lshr_b32 s46, s46, 4
    s_min_u32 s46, s46, 4
    s_add_u32 s46, s46, s54
    s_min_u32 s46, s46, s75
    v_mov_b32 v118, s46
    s_branch L_g_h2_137_b
L_g_dp_138_l:
    s_cmp_ge_u32 s62, s66
    s_cbranch_scc1 L_g_dp_138_d
    s_mov_b32 s65, 1
    s_add_u32 s47, s61, 4096
    s_mov_b32 m0, s64
    s_add_u32 s62, s62, 1
    buffer_load_dwordx4 v3, s[12:15], s61 offen offset:0 sc1 lds
    buffer_load_dwordx4 v3, s[12:15], s61 offen offset:1024 sc1 lds
    buffer_load_dwordx4 v3, s[12:15], s61 offen offset:2048 sc1 lds
    buffer_load_dwordx4 v3, s[12:15], s61 offen offset:3072 sc1 lds
    s_add_u32 m0, s64, 4096
    s_add_u32 s61, s61, s85
    buffer_load_dwordx4 v3, s[12:15], s47 offen offset:0 sc1 lds
    buffer_load_dwordx4 v3, s[12:15], s47 offen offset:1024 sc1 lds
    buffer_load_dwordx4 v3, s[12:15], s47 offen offset:2048 sc1 lds
    s_xor_b32 s64, s64, 0x10000
    s_branch L_g_dp_138_a
L_g_nw_134:
    s_waitcnt vmcnt(0) lgkmcnt(0)
    s_cmp_lg_u32 s44, 0
    s_cbranch_scc1 L_g_nl_150
    s_cmp_lt_u32 s66, s75
    s_cselect_b32 s81, 1, 2
L_g_nl_150:
    s_branch L_g_loop0_124_l
L_g_nfl_141:
    s_cmp_eq_u32 s71, 0
    s_cbranch_scc1 L_g_nfl_141_d
    v_mov_b32 v10, 1
    s_mov_b64 exec, 1
    s_waitcnt vmcnt(0)
    ds_add_rtn_u32 v10, v15, v10 offset:4
    s_waitcnt lgkmcnt(0)
    v_readfirstlane_b32 s46, v10
    s_mov_b64 exec, -1
    s_mov_b32 s71, 0
    s_sub_u32 s59, s60, 1
    s_mul_i32 s59, s59, s78
    s_add_u32 s59, s59, s74
    s_cmp_lg_u32 s46, s68
    s_cbranch_scc1 L_g_df_151
    v_mov_b32 v10, s59
    v_add_u32 v10, 1, v10
    v_mov_b32 v11, 0
    s_mov_b64 exec, 1
    buffer_store_dword v10, v11, s[12:15], s52 offen sc1
    s_mov_b64 exec, -1
L_sf_152:
L_g_df_151:
    s_add_u32 s68, s68, 4
    s_mov_b32 s65, 2
    s_branch L_g_nfl_141_d
L_g_dp_146_l:
    s_cmp_ge_u32 s62, s66
    s_cbranch_scc1 L_g_dp_146_d
    s_or_b32 s65, s65, 1
    s_add_u32 s47, s61, 4096
    s_mov_b32 m0, s64
    s_add_u32 s62, s62, 1
    buffer_load_dwordx4 v3, s[12:15], s61 offen offset:0 sc1 lds
    buffer_load_dwordx4 v3, s[12:15], s61 offen offset:1024 sc1 lds
    buffer_load_dwordx4 v3, s[12:15], s61 offen offset:2048 sc1 lds
    buffer_load_dwordx4 v3, s[12:15], s61 offen offset:3072 sc1 lds
    s_add_u32 m0, s64, 4096
    s_add_u32 s61, s61, s85
    buffer_load_dwordx4 v3, s[12:15], s47 offen offset:0 sc1 lds
    buffer_load_dwordx4 v3, s[12:15], s47 offen offset:1024 sc1 lds
    buffer_load_dwordx4 v3, s[12:15], s47 offen offset:2048 sc1 lds
    s_xor_b32 s64, s64, 0x10000
    s_branch L_g_dp_146_a
L_g_nw1_143:
    s_cmp_eq_u32 s65, 2
    s_cbranch_scc1 L_g_nw1_143_w
    s_waitcnt vmcnt(0)
L_g_nw1_143_w:
    s_barrier
    ds_read_b128 v[32:35], v4 offset:0
    ds_read_b128 v[36:39], v4 offset:256
    ds_read_b128 v[40:43], v4 offset:2048
    ds_read_b128 v[44:47], v4 offset:2304
    ds_read_b128 v[48:51], v4 offset:4096
    ds_read_b128 v[52:55], v4 offset:4352
    ds_read_b128 v[56:59], v4 offset:6144
    ds_read_b128 v[60:63], v4 offset:6400
    s_branch L_g_jn_145
L_w_wo_12:
    s_load_dwordx2 s[4:5], s[0:1], 40
    s_load_dwordx2 s[6:7], s[0:1], 72
    s_and_b32 s50, s44, 3
    s_lshr_b32 s51, s44, 2
    s_waitcnt lgkmcnt(0)
    s_mov_b32 s24, s4
    s_and_b32 s25, s5, 0xffff
    s_mov_b32 s26, 0x800000
    s_mov_b32 s27, 0x00020000
    v_lshrrev_b32 v3, 4, v1
    v_and_b32 v4, 15, v1
    v_lshlrev_b32 v5, 2, v3
    v_xor_b32 v4, v4, v5
    v_mul_u32_u24 v3, 2048, v3
    v_lshl_add_u32 v3, v4, 4, v3
    s_mul_i32 s46, s51, 512
    s_mul_i32 s47, s50, 16
    s_add_u32 s46, s46, s47
    s_mul_i32 s47, s42, 1024
    s_add_u32 s46, s46, s47
    s_mul_i32 s46, s46, 2048
    s_lshl_b32 s47, s43, 8
    s_add_u32 s46, s46, s47
    s_lshl_b32 s45, s51, 16
    s_mul_i32 s47, s50, 4096
    s_add_u32 s45, s45, s47
    v_bfe_u32 v4, v1, 2, 2
    v_bfe_u32 v5, v1, 4, 1
    v_lshlrev_b32 v5, 1, v5
    v_bfe_u32 v6, v1, 1, 1
    v_add_u32 v5, v5, v6
    s_lshl_b32 s47, s50, 2
    v_add_u32 v5, s47, v5
    v_lshlrev_b32 v6, 2, v4
    v_xor_b32 v5, v5, v6
    v_lshlrev_b32 v5, 4, v5
    v_lshl_add_u32 v5, v4, 8, v5
    v_bfe_u32 v6, v1, 0, 1
    v_lshl_add_u32 v5, v6, 3, v5
    v_lshrrev_b32 v6, 5, v1
    v_mul_u32_u24 v6, 1024, v6
    v_add_u32 v5, v5, v6
    s_lshl_b32 s47, s51, 16
    v_add_u32 v5, s47, v5
    v_bfe_u32 v4, v1, 2, 2
    v_xor_b32 v5, s50, v4
    v_lshlrev_b32 v5, 6, v5
    v_lshl_add_u32 v5, v4, 8, v5
    v_and_b32 v6, 3, v1
    v_lshl_add_u32 v5, v6, 3, v5
    v_lshrrev_b32 v6, 4, v1
    v_lshl_add_u32 v5, v6, 10, v5
    v_lshrrev_b32 v6, 5, v1
    s_lshl_b32 s47, s51, 16
    v_add_u32 v5, s47, v5
    s_add_u32 m0, s45, 0
    s_add_u32 s47, s46, 0x0
    buffer_load_dwordx4 v3, s[24:27], s47 offen  lds
    s_add_u32 m0, s45, 1024
    s_add_u32 s47, s46, 0x2000
    buffer_load_dwordx4 v3, s[24:27], s47 offen  lds
    s_add_u32 m0, s45, 2048
    s_add_u32 s47, s46, 0x4000
    buffer_load_dwordx4 v3, s[24:27], s47 offen  lds
    s_add_u32 m0, s45, 3072
    s_add_u32 s47, s46, 0x6000
    buffer_load_dwordx4 v3, s[24:27], s47 offen  lds
    s_add_u32 m0, s45, 16384
    s_add_u32 s47, s46, 0x20000
    buffer_load_dwordx4 v3, s[24:27], s47 offen  lds
    s_add_u32 m0, s45, 17408
    s_add_u32 s47, s46, 0x22000
    buffer_load_dwordx4 v3, s[24:27], s47 offen  lds
    s_add_u32 m0, s45, 18432
    s_add_u32 s47, s46, 0x24000
    buffer_load_dwordx4 v3, s[24:27], s47 offen  lds
    s_add_u32 m0, s45, 19456
    s_add_u32 s47, s46, 0x26000
    buffer_load_dwordx4 v3, s[24:27], s47 offen  lds
    s_add_u32 m0, s45, 32768
    s_add_u32 s47, s46, 0x40000
    buffer_load_dwordx4 v3, s[24:27], s47 offen  lds
    s_add_u32 m0, s45, 33792
    s_add_u32 s47, s46, 0x42000
    buffer_load_dwordx4 v3, s[24:27], s47 offen  lds
    s_add_u32 m0, s45, 34816
    s_add_u32 s47, s46, 0x44000
    buffer_load_dwordx4 v3, s[24:27], s47 offen  lds
    s_add_u32 m0, s45, 35840
    s_add_u32 s47, s46, 0x46000
    buffer_load_dwordx4 v3, s[24:27], s47 offen  lds
    s_add_u32 m0, s45, 49152
    s_add_u32 s47, s46, 0x60000
    buffer_load_dwordx4 v3, s[24:27], s47 offen  lds
    s_add_u32 m0, s45, 50176
    s_add_u32 s47, s46, 0x62000
    buffer_load_dwordx4 v3, s[24:27], s47 offen  lds
    s_add_u32 m0, s45, 51200
    s_add_u32 s47, s46, 0x64000
    buffer_load_dwordx4 v3, s[24:27], s47 offen  lds
    s_add_u32 m0, s45, 52224
    s_add_u32 s47, s46, 0x66000
    buffer_load_dwordx4 v3, s[24:27], s47 offen  lds
    s_waitcnt vmcnt(12) lgkmcnt(0)
    s_barrier
    ds_read_b64_tr_b16 a[0:1], v5 offset:0
    ds_read_b64_tr_b16 a[2:3], v5 offset:4096
    ds_read_b64_tr_b16 a[4:5], v5 offset:32
    ds_read_b64_tr_b16 a[6:7], v5 offset:4128
    ds_read_b64_tr_b16 a[8:9], v5 offset:8192
    ds_read_b64_tr_b16 a[10:11], v5 offset:12288
    ds_read_b64_tr_b16 a[12:13], v5 offset:8224
    ds_read_b64_tr_b16 a[14:15], v5 offset:12320
    s_waitcnt vmcnt(8) lgkmcnt(0)
    s_barrier
    s_add_u32 m0, s45, 0
    s_add_u32 s47, s46, 0x80000
    buffer_load_dwordx4 v3, s[24:27], s47 offen  lds
    s_add_u32 m0, s45, 1024
    s_add_u32 s47, s46, 0x82000
    buffer_load_dwordx4 v3, s[24:27], s47 offen  lds
    s_add_u32 m0, s45, 2048
    s_add_u32 s47, s46, 0x84000
    buffer_load_dwordx4 v3, s[24:27], s47 offen  lds
    s_add_u32 m0, s45, 3072
    s_add_u32 s47, s46, 0x86000
    buffer_load_dwordx4 v3, s[24:27], s47 offen  lds
    ds_read_b64_tr_b16 a[16:17], v5 offset:16384
    ds_read_b64_tr_b16 a[18:19], v5 offset:20480
    ds_read_b64_tr_b16 a[20:21], v5 offset:16416
    ds_read_b64_tr_b16 a[22:23], v5 offset:20512
    ds_read_b64_tr_b16 a[24:25], v5 offset:24576
    ds_read_b64_tr_b16 a[26:27], v5 offset:28672
    ds_read_b64_tr_b16 a[28:29], v5 offset:24608
    ds_read_b64_tr_b16 a[30:31], v5 offset:28704
    s_waitcnt vmcnt(8) lgkmcnt(0)
    s_barrier
    s_add_u32 m0, s45, 16384
    s_add_u32 s47, s46, 0xa0000
    buffer_load_dwordx4 v3, s[24:27], s47 offen  lds
    s_add_u32 m0, s45, 17408
    s_add_u32 s47, s46, 0xa2000
    buffer_load_dwordx4 v3, s[24:27], s47 offen  lds
    s_add_u32 m0, s45, 18432
    s_add_u32 s47, s46, 0xa4000
    buffer_load_dwordx4 v3, s[24:27], s47 offen  lds
    s_add_u32 m0, s45, 19456
    s_add_u32 s47, s46, 0xa6000
    buffer_load_dwordx4 v3, s[24:27], s47 offen  lds
    ds_read_b64_tr_b16 a[32:33], v5 offset:32768
    ds_read_b64_tr_b16 a[34:35], v5 offset:36864
    ds_read_b64_tr_b16 a[36:37], v5 offset:32800
    ds_read_b64_tr_b16 a[38:39], v5 offset:36896
    ds_read_b64_tr_b16 a[40:41], v5 offset:40960
    ds_read_b64_tr_b16 a[42:43], v5 offset:45056
    ds_read_b64_tr_b16 a[44:45], v5 offset:40992
    ds_read_b64_tr_b16 a[46:47], v5 offset:45088
    s_waitcnt vmcnt(8) lgkmcnt(0)
    s_barrier
    s_add_u32 m0, s45, 32768
    s_add_u32 s47, s46, 0xc0000
    buffer_load_dwordx4 v3, s[24:27], s47 offen  lds
    s_add_u32 m0, s45, 33792
    s_add_u32 s47, s46, 0xc2000
    buffer_load_dwordx4 v3, s[24:27], s47 offen  lds
    s_add_u32 m0, s45, 34816
    s_add_u32 s47, s46, 0xc4000
    buffer_load_dwordx4 v3, s[24:27], s47 offen  lds
    s_add_u32 m0, s45, 35840
    s_add_u32 s47, s46, 0xc6000
    buffer_load_dwordx4 v3, s[24:27], s47 offen  lds
    ds_read_b64_tr_b16 a[48:49], v5 offset:49152
    ds_read_b64_tr_b16 a[50:51], v5 offset:53248
    ds_read_b64_tr_b16 a[52:53], v5 offset:49184
    ds_read_b64_tr_b16 a[54:55], v5 offset:53280
    ds_read_b64_tr_b16 a[56:57], v5 offset:57344
    ds_read_b64_tr_b16 a[58:59], v5 offset:61440
    ds_read_b64_tr_b16 a[60:61], v5 offset:57376
    ds_read_b64_tr_b16 a[62:63], v5 offset:61472
    s_waitcnt vmcnt(8) lgkmcnt(0)
    s_barrier
    s_add_u32 m0, s45, 49152
    s_add_u32 s47, s46, 0xe0000
    buffer_load_dwordx4 v3, s[24:27], s47 offen  lds
    s_add_u32 m0, s45, 50176
    s_add_u32 s47, s46, 0xe2000
    buffer_load_dwordx4 v3, s[24:27], s47 offen  lds
    s_add_u32 m0, s45, 51200
    s_add_u32 s47, s46, 0xe4000
    buffer_load_dwordx4 v3, s[24:27], s47 offen  lds
    s_add_u32 m0, s45, 52224
    s_add_u32 s47, s46, 0xe6000
    buffer_load_dwordx4 v3, s[24:27], s47 offen  lds
    ds_read_b64_tr_b16 a[64:65], v5 offset:0
    ds_read_b64_tr_b16 a[66:67], v5 offset:4096
    ds_read_b64_tr_b16 a[68:69], v5 offset:32
    ds_read_b64_tr_b16 a[70:71], v5 offset:4128
    ds_read_b64_tr_b16 a[72:73], v5 offset:8192
    ds_read_b64_tr_b16 a[74:75], v5 offset:12288
    ds_read_b64_tr_b16 a[76:77], v5 offset:8224
    ds_read_b64_tr_b16 a[78:79], v5 offset:12320
    s_waitcnt vmcnt(8) lgkmcnt(0)
    s_barrier
    ds_read_b64_tr_b16 a[80:81], v5 offset:16384
    ds_read_b64_tr_b16 a[82:83], v5 offset:20480
    ds_read_b64_tr_b16 a[84:85], v5 offset:16416
    ds_read_b64_tr_b16 a[86:87], v5 offset:20512
    ds_read_b64_tr_b16 a[88:89], v5 offset:24576
    ds_read_b64_tr_b16 a[90:91], v5 offset:28672
    ds_read_b64_tr_b16 a[92:93], v5 offset:24608
    ds_read_b64_tr_b16 a[94:95], v5 offset:28704
    s_waitcnt vmcnt(4) lgkmcnt(0)
    s_barrier
    ds_read_b64_tr_b16 a[96:97], v5 offset:32768
    ds_read_b64_tr_b16 a[98:99], v5 offset:36864
    ds_read_b64_tr_b16 a[100:101], v5 offset:32800
    ds_read_b64_tr_b16 a[102:103], v5 offset:36896
    ds_read_b64_tr_b16 a[104:105], v5 offset:40960
    ds_read_b64_tr_b16 a[106:107], v5 offset:45056
    ds_read_b64_tr_b16 a[108:109], v5 offset:40992
    ds_read_b64_tr_b16 a[110:111], v5 offset:45088
    s_waitcnt vmcnt(0) lgkmcnt(0)
    s_barrier
    ds_read_b64_tr_b16 a[112:113], v5 offset:49152
    ds_read_b64_tr_b16 a[114:115], v5 offset:53248
    ds_read_b64_tr_b16 a[116:117], v5 offset:49184
    ds_read_b64_tr_b16 a[118:119], v5 offset:53280
    ds_read_b64_tr_b16 a[120:121], v5 offset:57344
    ds_read_b64_tr_b16 a[122:123], v5 offset:61440
    ds_read_b64_tr_b16 a[124:125], v5 offset:57376
    ds_read_b64_tr_b16 a[126:127], v5 offset:61472
    s_waitcnt lgkmcnt(0)
    s_barrier
    s_load_dwordx2 s[8:9], s[0:1], 64
    s_load_dwordx2 s[10:11], s[0:1], 80
    s_lshl_b32 s46, s42, 3
    s_add_u32 s46, s46, s43
    s_mul_i32 s46, s46, 229376
    s_mul_i32 s47, s44, 28672
    s_add_u32 s46, s46, s47
    v_lshlrev_b32 v10, 7, v1
    s_waitcnt lgkmcnt(0)
    s_mov_b32 s28, s8
    s_and_b32 s29, s9, 0xffff
    s_mov_b32 s30, 0x700000
    s_mov_b32 s31, 0x00020000
    s_mov_b32 s32, s10
    s_and_b32 s33, s11, 0xffff
    s_mov_b32 s34, 0x700000
    s_mov_b32 s35, 0x00020000
    s_add_u32 s47, s46, 0
    buffer_load_dword v120, v10, s[28:31], s47 offen
    s_add_u32 s47, s46, 8192
    buffer_load_dword v121, v10, s[28:31], s47 offen
    s_add_u32 s47, s46, 16384
    buffer_load_dword v122, v10, s[28:31], s47 offen
    s_add_u32 s47, s46, 20480
    buffer_load_dword v123, v10, s[28:31], s47 offen
    v_lshlrev_b32 v2, 4, v1
    s_mul_i32 s64, s44, 8192
    s_add_u32 s46, s64, 0x5000000
    s_mul_i32 s47, s42, 65536
    s_add_u32 s46, s46, s47
    v_add_u32 v3, s46, v2
    s_mul_i32 s46, s51, 32768
    v_add_u32 v4, s46, v2
    v_and_b32 v6, 15, v1
    v_lshlrev_b32 v6, 4, v6
    v_lshrrev_b32 v7, 4, v1
    v_lshl_add_u32 v6, v7, 9, v6
    v_add_u32 v4, s46, v6
    s_lshl_b32 s46, s50, 12
    s_add_u32 s46, s46, 131072
    v_add_u32 v5, s46, v2
    v_and_b32 v7, 7, v1
    v_lshlrev_b32 v7, 9, v7
    s_lshl_b32 s46, s42, 12
    s_add_u32 s46, s46, 0x102000
    v_add_u32 v7, s46, v7
    s_lshl_b32 s46, s42, 16
    s_lshl_b32 s47, s43, 11
    s_add_u32 s46, s46, s47
    s_lshl_b32 s47, s50, 9
    s_add_u32 s46, s46, s47
    s_add_u32 s46, s46, 0x9000000
    v_and_b32 v8, 31, v1
    v_lshlrev_b32 v8, 4, v8
    v_lshrrev_b32 v9, 5, v1
    v_lshl_add_u32 v8, v9, 14, v8
    v_add_u32 v8, s46, v8
    v_add_u32 v9, 0x8000, v8
    s_lshl_b32 s52, s43, 9
    s_lshl_b32 s47, s42, 7
    s_add_u32 s52, s52, s47
    s_add_u32 s52, s52, 0x107400
    s_add_u32 s52, s52, s76
    s_mul_i32 s46, s43, 8192
    s_add_u32 s46, s46, 0x5000000
    s_mul_i32 s47, s42, 65536
    s_add_u32 s46, s46, s47
    v_min_u32 v116, 63, v1
    v_lshlrev_b32 v116, 7, v116
    v_add_u32 v116, s46, v116
    s_mov_b32 s60, 0
    s_mul_i32 s61, s74, 262144
    s_mov_b32 s62, 0
    s_mul_i32 s63, s74, 262144
    s_mul_i32 s85, s78, 262144
    s_mul_i32 s86, s78, 262144
    s_sub_u32 s46, s78, 1
    s_sub_u32 s75, s75, s74
    s_add_u32 s75, s75, s46
    s_lshr_b32 s75, s75, s46
    s_mov_b32 s67, 0
    s_mov_b32 s68, 3
    s_mov_b32 s71, 0
    v_mov_b32 v15, 147456
    v_mov_b32 v14, 0
    ds_write_b32 v15, v14 offset:4
    ds_write_b32 v15, v14 offset:12
    ds_write_b32 v15, v14 offset:16
    v_mov_b32 v114, 1
    v_mov_b32 v115, 0
    s_mov_b32 s81, 0
    s_mul_i32 s87, s78, 2
    s_sub_u32 s87, s74, s87
    s_add_u32 s87, s87, 1
    s_lshl_b32 s46, s44, 5
    v_add_u32 v119, s46, v15
    v_lshrrev_b32 v113, 4, v1
    v_mul_u32_u24 v113, s78, v113
    v_add_u32 v113, s74, v113
    s_mov_b32 s72, 0
L_g_restart_153:
    s_cmp_lg_u32 s44, 0
    s_cbranch_scc1 L_g_nsp_154
    s_mov_b32 s70, 0
L_g_sp_160:
    s_add_u32 s54, s60, 0
    s_mul_i32 s55, s54, s78
    v_add_u32 v12, s55, v113
    v_and_b32 v13, 3, v12
    v_lshl_add_u32 v13, v13, 7, v7
    buffer_load_dword v11, v13, s[12:15], 0 offen sc1
    s_waitcnt vmcnt(0)
    v_cmp_ge_u32 vcc, v12, v11
    s_add_u32 s70, s70, 1
    s_and_b32 s46, vcc_lo, 0xffff
    s_cbranch_scc0 L_g_sp_160_ok
    s_sleep 3
    s_cmp_lt_u32 s70, 524288
    s_cbranch_scc1 L_g_sp_160
    s_branch L_c_done_1
L_g_sp_160_ok:
    v_cmp_ge_u32 vcc, v12, v11
    s_nop 0
    s_ff1_i32_b64 s46, vcc
    s_lshr_b32 s46, s46, 4
    s_min_u32 s46, s46, 4
    s_add_u32 s46, s46, s54
    s_min_u32 s46, s46, s75
    v_mov_b32 v118, s46
    ds_write_b32 v15, v118 offset:20
L_g_nsp_154:
    s_waitcnt lgkmcnt(0)
    s_barrier
    ds_read_b32 v14, v15 offset:20
    s_waitcnt lgkmcnt(0)
    v_readfirstlane_b32 s66, v14
    s_nop 3
L_g_restart_153_go:
    s_mov_b32 s69, 0
    s_cmp_gt_u32 s62, s60
    s_cbranch_scc1 L_g_nd_161
    s_cmp_ge_u32 s62, s66
    s_cbranch_scc1 L_g_nd_161
    s_add_u32 s47, s61, 4096
    s_add_u32 m0, s64, 0
    s_nop 0
    buffer_load_dwordx4 v3, s[12:15], s61 offen offset:0 sc1 lds
    buffer_load_dwordx4 v3, s[12:15], s61 offen offset:1024 sc1 lds
    buffer_load_dwordx4 v3, s[12:15], s61 offen offset:2048 sc1 lds
    buffer_load_dwordx4 v3, s[12:15], s61 offen offset:3072 sc1 lds
    s_add_u32 m0, s64, 4096
    s_nop 0
    buffer_load_dwordx4 v3, s[12:15], s47 offen offset:0 sc1 lds
    buffer_load_dwordx4 v3, s[12:15], s47 offen offset:1024 sc1 lds
    buffer_load_dwordx4 v3, s[12:15], s47 offen offset:2048 sc1 lds
    buffer_load_dwordx4 v3, s[12:15], s47 offen offset:3072 sc1 lds
    s_add_u32 s61, s61, s85
    s_add_u32 s62, s62, 1
    s_xor_b32 s64, s64, 0x10000
    s_mov_b32 s69, 1
L_g_nd_161:
    s_cmp_eq_u32 s51, 1
    s_cbranch_scc1 L_g_g1r_155
    s_add_u32 s59, s60, 1
    s_mov_b32 s69, 0
    s_cmp_gt_u32 s62, s59
    s_cbranch_scc1 L_g_nd_162
    s_cmp_ge_u32 s62, s66
    s_cbranch_scc1 L_g_nd_162
    s_add_u32 s47, s61, 4096
    s_add_u32 m0, s64, 0
    s_nop 0
    buffer_load_dwordx4 v3, s[12:15], s61 offen offset:0 sc1 lds
    buffer_load_dwordx4 v3, s[12:15], s61 offen offset:1024 sc1 lds
    buffer_load_dwordx4 v3, s[12:15], s61 offen offset:2048 sc1 lds
    buffer_load_dwordx4 v3, s[12:15], s61 offen offset:3072 sc1 lds
    s_add_u32 m0, s64, 4096
    s_nop 0
    buffer_load_dwordx4 v3, s[12:15], s47 offen offset:0 sc1 lds
    buffer_load_dwordx4 v3, s[12:15], s47 offen offset:1024 sc1 lds
    buffer_load_dwordx4 v3, s[12:15], s47 offen offset:2048 sc1 lds
    buffer_load_dwordx4 v3, s[12:15], s47 offen offset:3072 sc1 lds
    s_add_u32 s61, s61, s85
    s_add_u32 s62, s62, 1
    s_xor_b32 s64, s64, 0x10000
    s_mov_b32 s69, 1
L_g_nd_162:
    s_cmp_eq_u32 s69, 1
    s_cbranch_scc1 L_g_w0_163
    s_waitcnt vmcnt(0)
L_g_w0_163:
    s_waitcnt vmcnt(8)
    s_cmp_lg_u32 s44, 0
    s_cbranch_scc1 L_g_nl_164
    s_cmp_lt_u32 s66, s75
    s_cselect_b32 s81, 1, 2
L_g_nl_164:
L_g_loop0_156_l:
    s_barrier
    ds_read_b128 v[32:35], v4 offset:0
    ds_read_b128 v[36:39], v4 offset:256
    ds_read_b128 v[40:43], v4 offset:2048
    ds_read_b128 v[44:47], v4 offset:2304
    ds_read_b128 v[48:51], v4 offset:4096
    ds_read_b128 v[52:55], v4 offset:4352
    ds_read_b128 v[56:59], v4 offset:6144
    ds_read_b128 v[60:63], v4 offset:6400
    s_branch L_g_loop0_156_m
.p2align 6
L_g_loop0_156:
    s_barrier
L_g_loop0_156_m:
    s_setprio 2
    s_waitcnt lgkmcnt(6)
    v_mfma_f32_16x16x32_bf16 v[16:19], v[32:35], a[0:3], 0
    v_mfma_f32_16x16x32_bf16 v[20:23], v[32:35], a[4:7], 0
    ds_read_b128 v[32:35], v4 offset:8192
    v_mfma_f32_16x16x32_bf16 v[28:31], v[36:39], a[4:7], 0
    v_mfma_f32_16x16x32_bf16 v[24:27], v[36:39], a[0:3], 0
    ds_read_b128 v[36:39], v4 offset:8448
    s_cmp_eq_u32 s81, 1
    s_cbranch_scc1 L_g_h1_168
L_g_h1_168_b:
    s_waitcnt lgkmcnt(6)
    v_mfma_f32_16x16x32_bf16 v[16:19], v[40:43], a[8:11], v[16:19]
    v_mfma_f32_16x16x32_bf16 v[20:23], v[40:43], a[12:15], v[20:23]
    ds_read_b128 v[40:43], v4 offset:10240
    v_mfma_f32_16x16x32_bf16 v[28:31], v[44:47], a[12:15], v[28:31]
    v_mfma_f32_16x16x32_bf16 v[24:27], v[44:47], a[8:11], v[24:27]
    ds_read_b128 v[44:47], v4 offset:10496
    s_waitcnt lgkmcnt(6)
    v_mfma_f32_16x16x32_bf16 v[16:19], v[48:51], a[16:19], v[16:19]
    v_mfma_f32_16x16x32_bf16 v[20:23], v[48:51], a[20:23], v[20:23]
    ds_read_b128 v[48:51], v4 offset:12288
    v_mfma_f32_16x16x32_bf16 v[28:31], v[52:55], a[20:23], v[28:31]
    v_mfma_f32_16x16x32_bf16 v[24:27], v[52:55], a[16:19], v[24:27]
    ds_read_b128 v[52:55], v4 offset:12544
    s_waitcnt lgkmcnt(6)
    v_mfma_f32_16x16x32_bf16 v[16:19], v[56:59], a[24:27], v[16:19]
    v_mfma_f32_16x16x32_bf16 v[20:23], v[56:59], a[28:31], v[20:23]
    ds_read_b128 v[56:59], v4 offset:14336
    v_mfma_f32_16x16x32_bf16 v[28:31], v[60:63], a[28:31], v[28:31]
    v_mfma_f32_16x16x32_bf16 v[24:27], v[60:63], a[24:27], v[24:27]
    ds_read_b128 v[60:63], v4 offset:14592
    s_waitcnt lgkmcnt(6)
    v_mfma_f32_16x16x32_bf16 v[16:19], v[32:35], a[32:35], v[16:19]
    v_mfma_f32_16x16x32_bf16 v[20:23], v[32:35], a[36:39], v[20:23]
    ds_read_b128 v[32:35], v4 offset:16384
    v_mfma_f32_16x16x32_bf16 v[28:31], v[36:39], a[36:39], v[28:31]
    v_mfma_f32_16x16x32_bf16 v[24:27], v[36:39], a[32:35], v[24:27]
    ds_read_b128 v[36:39], v4 offset:16640
    s_waitcnt lgkmcnt(6)
    v_mfma_f32_16x16x32_bf16 v[16:19], v[40:43], a[40:43], v[16:19]
    v_mfma_f32_16x16x32_bf16 v[20:23], v[40:43], a[44:47], v[20:23]
    ds_read_b128 v[40:43], v4 offset:18432
    v_mfma_f32_16x16x32_bf16 v[28:31], v[44:47], a[44:47], v[28:31]
    v_mfma_f32_16x16x32_bf16 v[24:27], v[44:47], a[40:43], v[24:27]
    ds_read_b128 v[44:47], v4 offset:18688
    s_waitcnt lgkmcnt(6)
    v_mfma_f32_16x16x32_bf16 v[16:19], v[48:51], a[48:51], v[16:19]
    v_mfma_f32_16x16x32_bf16 v[20:23], v[48:51], a[52:55], v[20:23]
    ds_read_b128 v[48:51], v4 offset:20480
    v_mfma_f32_16x16x32_bf16 v[28:31], v[52:55], a[52:55], v[28:31]
    v_mfma_f32_16x16x32_bf16 v[24:27], v[52:55], a[48:51], v[24:27]
    ds_read_b128 v[52:55], v4 offset:20736
    s_waitcnt lgkmcnt(6)
    v_mfma_f32_16x16x32_bf16 v[16:19], v[56:59], a[56:59], v[16:19]
    v_mfma_f32_16x16x32_bf16 v[20:23], v[56:59], a[60:63], v[20:23]
    ds_read_b128 v[56:59], v4 offset:22528
    v_mfma_f32_16x16x32_bf16 v[28:31], v[60:63], a[60:63], v[28:31]
    v_mfma_f32_16x16x32_bf16 v[24:27], v[60:63], a[56:59], v[24:27]
    ds_read_b128 v[60:63], v4 offset:22784
    s_waitcnt lgkmcnt(6)
    v_mfma_f32_16x16x32_bf16 v[16:19], v[32:35], a[64:67], v[16:19]
    v_mfma_f32_16x16x32_bf16 v[20:23], v[32:35], a[68:71], v[20:23]
    ds_read_b128 v[32:35], v4 offset:24576
    v_mfma_f32_16x16x32_bf16 v[28:31], v[36:39], a[68:71], v[28:31]
    v_mfma_f32_16x16x32_bf16 v[24:27], v[36:39], a[64:67], v[24:27]
    ds_read_b128 v[36:39], v4 offset:24832
    s_waitcnt lgkmcnt(6)
    v_mfma_f32_16x16x32_bf16 v[16:19], v[40:43], a[72:75], v[16:19]
    v_mfma_f32_16x16x32_bf16 v[20:23], v[40:43], a[76:79], v[20:23]
    ds_read_b128 v[40:43], v4 offset:26624
    v_mfma_f32_16x16x32_bf16 v[28:31], v[44:47], a[76:79], v[28:31]
    v_mfma_f32_16x16x32_bf16 v[24:27], v[44:47], a[72:75], v[24:27]
    ds_read_b128 v[44:47], v4 offset:26880
    s_waitcnt lgkmcnt(6)
    v_mfma_f32_16x16x32_bf16 v[16:19], v[48:51], a[80:83], v[16:19]
    v_mfma_f32_16x16x32_bf16 v[20:23], v[48:51], a[84:87], v[20:23]
    ds_read_b128 v[48:51], v4 offset:28672
    v_mfma_f32_16x16x32_bf16 v[28:31], v[52:55], a[84:87], v[28:31]
    v_mfma_f32_16x16x32_bf16 v[24:27], v[52:55], a[80:83], v[24:27]
    ds_read_b128 v[52:55], v4 offset:28928
    s_waitcnt lgkmcnt(6)
    v_mfma_f32_16x16x32_bf16 v[16:19], v[56:59], a[88:91], v[16:19]
    v_mfma_f32_16x16x32_bf16 v[20:23], v[56:59], a[92:95], v[20:23]
    ds_read_b128 v[56:59], v4 offset:30720
    v_mfma_f32_16x16x32_bf16 v[28:31], v[60:63], a[92:95], v[28:31]
    v_mfma_f32_16x16x32_bf16 v[24:27], v[60:63], a[88:91], v[24:27]
    ds_read_b128 v[60:63], v4 offset:30976
    s_waitcnt lgkmcnt(6)
    v_mfma_f32_16x16x32_bf16 v[16:19], v[32:35], a[96:99], v[16:19]
    v_mfma_f32_16x16x32_bf16 v[20:23], v[32:35], a[100:103], v[20:23]
    v_mfma_f32_16x16x32_bf16 v[28:31], v[36:39], a[100:103], v[28:31]
    v_mfma_f32_16x16x32_bf16 v[24:27], v[36:39], a[96:99], v[24:27]
    s_waitcnt lgkmcnt(4)
    v_mfma_f32_16x16x32_bf16 v[16:19], v[40:43], a[104:107], v[16:19]
    v_mfma_f32_16x16x32_bf16 v[20:23], v[40:43], a[108:111], v[20:23]
    v_mfma_f32_16x16x32_bf16 v[28:31], v[44:47], a[108:111], v[28:31]
    v_mfma_f32_16x16x32_bf16 v[24:27], v[44:47], a[104:107], v[24:27]
    s_waitcnt lgkmcnt(2)
    v_mfma_f32_16x16x32_bf16 v[16:19], v[48:51], a[112:115], v[16:19]
    v_mfma_f32_16x16x32_bf16 v[20:23], v[48:51], a[116:119], v[20:23]
    s_cmp_eq_u32 s81, 1
    s_cbranch_scc1 L_g_h2_169
L_g_h2_169_b:
    ds_write_b32 v119, v118
    v_mfma_f32_16x16x32_bf16 v[28:31], v[52:55], a[116:119], v[28:31]
    v_mfma_f32_16x16x32_bf16 v[24:27], v[52:55], a[112:115], v[24:27]
    s_waitcnt lgkmcnt(0)
    v_mfma_f32_16x16x32_bf16 v[16:19], v[56:59], a[120:123], v[16:19]
    v_mfma_f32_16x16x32_bf16 v[20:23], v[56:59], a[124:127], v[20:23]
    v_mfma_f32_16x16x32_bf16 v[28:31], v[60:63], a[124:127], v[28:31]
    v_mfma_f32_16x16x32_bf16 v[24:27], v[60:63], a[120:123], v[24:27]
    v_xor_b32 v4, 0x10000, v4
    s_setprio 0
    s_waitcnt vmcnt(0)
    s_waitcnt lgkmcnt(0)
    s_barrier
    ds_read_b32 v14, v15
    s_nop 6
    ds_write_b128 v5, v[16:19] offset:0
    ds_write_b128 v5, v[20:23] offset:1024
    ds_write_b128 v5, v[24:27] offset:2048
    ds_write_b128 v5, v[28:31] offset:3072
    s_waitcnt lgkmcnt(4)
    v_readfirstlane_b32 s66, v14
    s_add_u32 s60, s60, 1
    s_mov_b32 s65, 0
    s_cmp_le_u32 s62, s60
    s_cbranch_scc1 L_g_dp_170_l
L_g_dp_170_a:
    s_cmp_ge_u32 s62, s66
    s_cbranch_scc1 L_g_dp_170_d
    s_add_u32 s47, s61, 4096
    s_mov_b32 m0, s64
    s_add_u32 s62, s62, 1
    buffer_load_dwordx4 v3, s[12:15], s61 offen offset:0 sc1 lds
    buffer_load_dwordx4 v3, s[12:15], s61 offen offset:1024 sc1 lds
    buffer_load_dwordx4 v3, s[12:15], s61 offen offset:2048 sc1 lds
    buffer_load_dwordx4 v3, s[12:15], s61 offen offset:3072 sc1 lds
    s_add_u32 m0, s64, 4096
    s_add_u32 s61, s61, s85
    buffer_load_dwordx4 v3, s[12:15], s47 offen offset:0 sc1 lds
    buffer_load_dwordx4 v3, s[12:15], s47 offen offset:1024 sc1 lds
    buffer_load_dwordx4 v3, s[12:15], s47 offen offset:2048 sc1 lds
    buffer_load_dwordx4 v3, s[12:15], s47 offen offset:3072 sc1 lds
    s_xor_b32 s64, s64, 0x10000
L_g_dp_170_d:
    s_cmp_lg_u32 s44, 2
    s_cbranch_scc1 L_g_pf_171
    s_cmp_ge_u32 s62, s66
    s_cbranch_scc1 L_g_pf_171
    buffer_load_dword v117, v116, s[12:15], s61 offen sc1
L_g_pf_171:
    s_cmp_le_u32 s66, s60
    s_cbranch_scc1 L_g_ex0_167
    s_cmp_lg_u32 s65, 0
    s_cbranch_scc1 L_g_nw_166
    ds_read_b128 v[32:35], v4 offset:0
    ds_read_b128 v[36:39], v4 offset:256
    ds_read_b128 v[40:43], v4 offset:2048
    ds_read_b128 v[44:47], v4 offset:2304
    ds_read_b128 v[48:51], v4 offset:4096
    ds_read_b128 v[52:55], v4 offset:4352
    ds_read_b128 v[56:59], v4 offset:6144
    ds_read_b128 v[60:63], v4 offset:6400
    s_cmp_lg_u32 s44, 0
    s_cbranch_scc1 L_g_nl_172
    s_mov_b32 s46, s66
    s_cmp_lg_u32 s81, 0
    s_cbranch_scc1 L_g_nl_172_e
    v_cmp_ge_u32 vcc, v12, v11
    s_nop 0
    s_ff1_i32_b64 s46, vcc
    s_lshr_b32 s46, s46, 4
    s_min_u32 s46, s46, 4
    s_add_u32 s46, s46, s54
    s_min_u32 s46, s46, s75
    v_mov_b32 v118, s46
L_g_nl_172_e:
    s_add_u32 s47, s60, 3
    s_min_u32 s47, s47, s75
    s_cmp_lt_u32 s46, s47
    s_cselect_b32 s81, 1, 0
    s_cbranch_scc1 L_g_nl_172
    s_add_u32 s54, s60, 2
    s_mul_i32 s55, s54, s78
    v_add_u32 v12, s55, v113
    v_and_b32 v13, 3, v12
    v_lshl_add_u32 v13, v13, 7, v7
    buffer_load_dword v11, v13, s[12:15], 0 offen sc1
L_g_nl_172:
    s_waitcnt lgkmcnt(8)
    s_branch L_g_loop0_156
L_g_ex0_167:
    s_cmp_lg_u32 s44, 0
    s_cbranch_scc1 L_g_ex0_167_n
    ds_write_b32 v15, v118 offset:20
    s_cmp_ge_u32 s60, s75
    s_cbranch_scc1 L_g_ex0_167_n
    s_sleep 6
    s_add_u32 s54, s60, 0
    s_mul_i32 s55, s54, s78
    v_add_u32 v12, s55, v113
    v_and_b32 v13, 3, v12
    v_lshl_add_u32 v13, v13, 7, v7
    buffer_load_dword v11, v13, s[12:15], 0 offen sc1
    s_waitcnt vmcnt(0)
    v_cmp_ge_u32 vcc, v12, v11
    s_nop 0
    s_ff1_i32_b64 s46, vcc
    s_lshr_b32 s46, s46, 4
    s_min_u32 s46, s46, 4
    s_add_u32 s46, s46, s54
    s_min_u32 s46, s46, s75
    v_mov_b32 v118, s46
    ds_write_b32 v15, v118 offset:20
L_g_ex0_167_n:
    s_waitcnt lgkmcnt(0)
    s_barrier
    ds_read_b32 v14, v15 offset:20
    s_waitcnt lgkmcnt(0)
    v_readfirstlane_b32 s66, v14
    s_barrier
    s_cmp_gt_u32 s66, s60
    s_cbranch_scc1 L_g_restart_153_go
    s_branch L_g_tail_158
L_g_g1r_155:
    s_mov_b32 s65, 1
    s_branch L_g_loop1_157_e
.p2align 6
L_g_loop1_157:
    s_mov_b32 s65, 0
L_g_loop1_157_e:
    s_barrier
    s_bitcmp1_b32 s67, 1
    s_cbranch_scc0 L_g_nfl_173
    s_cmp_lg_u32 s44, 4
    s_cbranch_scc1 L_g_nfl_173_d
    s_mul_i32 s59, s60, s78
    s_add_u32 s59, s59, s87
    v_mov_b32 v10, s59
    buffer_store_dword v10, v115, s[12:15], s52 offen sc1
L_g_nfl_173_d:
    ds_read_b128 v[80:83], v5 offset:0
    ds_read_b128 v[84:87], v5 offset:1024
    ds_read_b128 v[88:91], v5 offset:2048
    ds_read_b128 v[92:95], v5 offset:3072
    s_cmp_le_u32 s62, s60
    s_cbranch_scc1 L_g_dp_178_l
L_g_dp_178_a:
    s_cmp_ge_u32 s62, s66
    s_cbranch_scc1 L_g_dp_178_d
    s_add_u32 s47, s61, 4096
    s_mov_b32 m0, s64
    s_add_u32 s62, s62, 1
    buffer_load_dwordx4 v3, s[12:15], s61 offen offset:0 sc1 lds
    buffer_load_dwordx4 v3, s[12:15], s61 offen offset:1024 sc1 lds
    buffer_load_dwordx4 v3, s[12:15], s61 offen offset:2048 sc1 lds
    buffer_load_dwordx4 v3, s[12:15], s61 offen offset:3072 sc1 lds
    s_add_u32 m0, s64, 4096
    s_add_u32 s61, s61, s85
    buffer_load_dwordx4 v3, s[12:15], s47 offen offset:0 sc1 lds
    buffer_load_dwordx4 v3, s[12:15], s47 offen offset:1024 sc1 lds
    buffer_load_dwordx4 v3, s[12:15], s47 offen offset:2048 sc1 lds
    buffer_load_dwordx4 v3, s[12:15], s47 offen offset:3072 sc1 lds
    s_xor_b32 s64, s64, 0x10000
L_g_dp_178_d:
    s_bitcmp1_b32 s67, 0
    s_cbranch_scc0 L_g_nep_174
    s_waitcnt lgkmcnt(0)
    v_add_f32 v80, v80, v16
    v_add_f32 v81, v81, v17
    v_add_f32 v82, v82, v18
    v_add_f32 v83, v83, v19
    v_add_f32 v84, v84, v20
    v_add_f32 v85, v85, v21
    v_add_f32 v86, v86, v22
    v_add_f32 v87, v87, v23
    v_add_f32 v88, v88, v24
    v_add_f32 v89, v89, v25
    v_add_f32 v90, v90, v26
    v_add_f32 v91, v91, v27
    v_add_f32 v92, v92, v28
    v_add_f32 v93, v93, v29
    v_add_f32 v94, v94, v30
    v_add_f32 v95, v95, v31
    v_cvt_pk_bf16_f32 v104, v80, v81
    v_cvt_pk_bf16_f32 v105, v82, v83
    v_cvt_pk_bf16_f32 v106, v84, v85
    v_cvt_pk_bf16_f32 v107, v86, v87
    s_nop 1
    v_permlane16_swap_b32 v104, v106
    v_permlane16_swap_b32 v105, v107
    buffer_store_dwordx4 v[104:107], v8, s[12:15], s63 offen sc1
    v_cvt_pk_bf16_f32 v108, v88, v89
    v_cvt_pk_bf16_f32 v109, v90, v91
    v_cvt_pk_bf16_f32 v110, v92, v93
    v_cvt_pk_bf16_f32 v111, v94, v95
    s_nop 1
    v_permlane16_swap_b32 v108, v110
    v_permlane16_swap_b32 v109, v111
    buffer_store_dwordx4 v[108:111], v9, s[12:15], s63 offen sc1
    s_add_u32 s63, s63, s86
L_g_nep_174:
    s_cmp_lg_u32 s65, 0
    s_cbranch_scc1 L_g_nw1_175
    ds_read_b128 v[32:35], v4 offset:0
    ds_read_b128 v[36:39], v4 offset:256
    ds_read_b128 v[40:43], v4 offset:2048
    ds_read_b128 v[44:47], v4 offset:2304
    ds_read_b128 v[48:51], v4 offset:4096
    ds_read_b128 v[52:55], v4 offset:4352
    ds_read_b128 v[56:59], v4 offset:6144
    ds_read_b128 v[60:63], v4 offset:6400
    s_barrier
L_g_jn_177:
    s_setprio 1
    s_waitcnt lgkmcnt(6)
    v_mfma_f32_16x16x32_bf16 v[16:19], v[32:35], a[0:3], 0
    ds_read_b32 v14, v15
    v_mfma_f32_16x16x32_bf16 v[20:23], v[32:35], a[4:7], 0
    ds_read_b128 v[32:35], v4 offset:8192
    v_mfma_f32_16x16x32_bf16 v[28:31], v[36:39], a[4:7], 0
    v_mfma_f32_16x16x32_bf16 v[24:27], v[36:39], a[0:3], 0
    ds_read_b128 v[36:39], v4 offset:8448
    s_waitcnt lgkmcnt(6)
    v_mfma_f32_16x16x32_bf16 v[16:19], v[40:43], a[8:11], v[16:19]
    v_mfma_f32_16x16x32_bf16 v[20:23], v[40:43], a[12:15], v[20:23]
    ds_read_b128 v[40:43], v4 offset:10240
    v_mfma_f32_16x16x32_bf16 v[28:31], v[44:47], a[12:15], v[28:31]
    v_mfma_f32_16x16x32_bf16 v[24:27], v[44:47], a[8:11], v[24:27]
    ds_read_b128 v[44:47], v4 offset:10496
    s_waitcnt lgkmcnt(6)
    v_mfma_f32_16x16x32_bf16 v[16:19], v[48:51], a[16:19], v[16:19]
    v_mfma_f32_16x16x32_bf16 v[20:23], v[48:51], a[20:23], v[20:23]
    ds_read_b128 v[48:51], v4 offset:12288
    v_mfma_f32_16x16x32_bf16 v[28:31], v[52:55], a[20:23], v[28:31]
    v_mfma_f32_16x16x32_bf16 v[24:27], v[52:55], a[16:19], v[24:27]
    ds_read_b128 v[52:55], v4 offset:12544
    s_waitcnt lgkmcnt(6)
    v_mfma_f32_16x16x32_bf16 v[16:19], v[56:59], a[24:27], v[16:19]
    v_mfma_f32_16x16x32_bf16 v[20:23], v[56:59], a[28:31], v[20:23]
    ds_read_b128 v[56:59], v4 offset:14336
    v_mfma_f32_16x16x32_bf16 v[28:31], v[60:63], a[28:31], v[28:31]
    v_mfma_f32_16x16x32_bf16 v[24:27], v[60:63], a[24:27], v[24:27]
    ds_read_b128 v[60:63], v4 offset:14592
    s_waitcnt lgkmcnt(6)
    v_mfma_f32_16x16x32_bf16 v[16:19], v[32:35], a[32:35], v[16:19]
    v_mfma_f32_16x16x32_bf16 v[20:23], v[32:35], a[36:39], v[20:23]
    ds_read_b128 v[32:35], v4 offset:16384
    v_mfma_f32_16x16x32_bf16 v[28:31], v[36:39], a[36:39], v[28:31]
    v_mfma_f32_16x16x32_bf16 v[24:27], v[36:39], a[32:35], v[24:27]
    ds_read_b128 v[36:39], v4 offset:16640
    s_waitcnt lgkmcnt(6)
    v_mfma_f32_16x16x32_bf16 v[16:19], v[40:43], a[40:43], v[16:19]
    v_mfma_f32_16x16x32_bf16 v[20:23], v[40:43], a[44:47], v[20:23]
    ds_read_b128 v[40:43], v4 offset:18432
    v_mfma_f32_16x16x32_bf16 v[28:31], v[44:47], a[44:47], v[28:31]
    v_mfma_f32_16x16x32_bf16 v[24:27], v[44:47], a[40:43], v[24:27]
    ds_read_b128 v[44:47], v4 offset:18688
    s_waitcnt lgkmcnt(6)
    v_mfma_f32_16x16x32_bf16 v[16:19], v[48:51], a[48:51], v[16:19]
    v_mfma_f32_16x16x32_bf16 v[20:23], v[48:51], a[52:55], v[20:23]
    ds_read_b128 v[48:51], v4 offset:20480
    v_mfma_f32_16x16x32_bf16 v[28:31], v[52:55], a[52:55], v[28:31]
    v_mfma_f32_16x16x32_bf16 v[24:27], v[52:55], a[48:51], v[24:27]
    ds_read_b128 v[52:55], v4 offset:20736
    s_waitcnt lgkmcnt(6)
    v_mfma_f32_16x16x32_bf16 v[16:19], v[56:59], a[56:59], v[16:19]
    v_mfma_f32_16x16x32_bf16 v[20:23], v[56:59], a[60:63], v[20:23]
    ds_read_b128 v[56:59], v4 offset:22528
    v_mfma_f32_16x16x32_bf16 v[28:31], v[60:63], a[60:63], v[28:31]
    v_mfma_f32_16x16x32_bf16 v[24:27], v[60:63], a[56:59], v[24:27]
    ds_read_b128 v[60:63], v4 offset:22784
    s_waitcnt lgkmcnt(6)
    v_mfma_f32_16x16x32_bf16 v[16:19], v[32:35], a[64:67], v[16:19]
    v_mfma_f32_16x16x32_bf16 v[20:23], v[32:35], a[68:71], v[20:23]
    ds_read_b128 v[32:35], v4 offset:24576
    v_mfma_f32_16x16x32_bf16 v[28:31], v[36:39], a[68:71], v[28:31]
    v_mfma_f32_16x16x32_bf16 v[24:27], v[36:39], a[64:67], v[24:27]
    ds_read_b128 v[36:39], v4 offset:24832
    s_waitcnt lgkmcnt(6)
    v_mfma_f32_16x16x32_bf16 v[16:19], v[40:43], a[72:75], v[16:19]
    v_mfma_f32_16x16x32_bf16 v[20:23], v[40:43], a[76:79], v[20:23]
    ds_read_b128 v[40:43], v4 offset:26624
    v_mfma_f32_16x16x32_bf16 v[28:31], v[44:47], a[76:79], v[28:31]
    v_mfma_f32_16x16x32_bf16 v[24:27], v[44:47], a[72:75], v[24:27]
    ds_read_b128 v[44:47], v4 offset:26880
    s_waitcnt lgkmcnt(6)
    v_mfma_f32_16x16x32_bf16 v[16:19], v[48:51], a[80:83], v[16:19]
    v_mfma_f32_16x16x32_bf16 v[20:23], v[48:51], a[84:87], v[20:23]
    ds_read_b128 v[48:51], v4 offset:28672
    v_mfma_f32_16x16x32_bf16 v[28:31], v[52:55], a[84:87], v[28:31]
    v_mfma_f32_16x16x32_bf16 v[24:27], v[52:55], a[80:83], v[24:27]
    ds_read_b128 v[52:55], v4 offset:28928
    s_waitcnt lgkmcnt(6)
    v_mfma_f32_16x16x32_bf16 v[16:19], v[56:59], a[88:91], v[16:19]
    v_mfma_f32_16x16x32_bf16 v[20:23], v[56:59], a[92:95], v[20:23]
    ds_read_b128 v[56:59], v4 offset:30720
    v_mfma_f32_16x16x32_bf16 v[28:31], v[60:63], a[92:95], v[28:31]
    v_mfma_f32_16x16x32_bf16 v[24:27], v[60:63], a[88:91], v[24:27]
    ds_read_b128 v[60:63], v4 offset:30976
    s_waitcnt lgkmcnt(6)
    v_mfma_f32_16x16x32_bf16 v[16:19], v[32:35], a[96:99], v[16:19]
    v_mfma_f32_16x16x32_bf16 v[20:23], v[32:35], a[100:103], v[20:23]
    v_mfma_f32_16x16x32_bf16 v[28:31], v[36:39], a[100:103], v[28:31]
    v_mfma_f32_16x16x32_bf16 v[24:27], v[36:39], a[96:99], v[24:27]
    s_waitcnt lgkmcnt(4)
    v_mfma_f32_16x16x32_bf16 v[16:19], v[40:43], a[104:107], v[16:19]
    v_mfma_f32_16x16x32_bf16 v[20:23], v[40:43], a[108:111], v[20:23]
    v_mfma_f32_16x16x32_bf16 v[28:31], v[44:47], a[108:111], v[28:31]
    v_mfma_f32_16x16x32_bf16 v[24:27], v[44:47], a[104:107], v[24:27]
    s_waitcnt lgkmcnt(2)
    v_mfma_f32_16x16x32_bf16 v[16:19], v[48:51], a[112:115], v[16:19]
    v_mfma_f32_16x16x32_bf16 v[20:23], v[48:51], a[116:119], v[20:23]
    v_mfma_f32_16x16x32_bf16 v[28:31], v[52:55], a[116:119], v[28:31]
    v_mfma_f32_16x16x32_bf16 v[24:27], v[52:55], a[112:115], v[24:27]
    s_waitcnt lgkmcnt(0)
    v_mfma_f32_16x16x32_bf16 v[16:19], v[56:59], a[120:123], v[16:19]
    v_mfma_f32_16x16x32_bf16 v[20:23], v[56:59], a[124:127], v[20:23]
    v_mfma_f32_16x16x32_bf16 v[28:31], v[60:63], a[124:127], v[28:31]
    v_mfma_f32_16x16x32_bf16 v[24:27], v[60:63], a[120:123], v[24:27]
    v_xor_b32 v4, 0x10000, v4
    s_setprio 0
    s_waitcnt vmcnt(0)
    v_readfirstlane_b32 s66, v14
    s_lshl_b32 s67, s67, 1
    s_or_b32 s67, s67, 1
    s_add_u32 s60, s60, 1
    s_cmp_gt_u32 s66, s60
    s_cbranch_scc1 L_g_loop1_157
    s_barrier
    ds_read_b32 v14, v15 offset:20
    ds_read_b128 v[80:83], v5 offset:0
    ds_read_b128 v[84:87], v5 offset:1024
    ds_read_b128 v[88:91], v5 offset:2048
    ds_read_b128 v[92:95], v5 offset:3072
    s_waitcnt lgkmcnt(4)
    v_readfirstlane_b32 s66, v14
    s_barrier
    s_mov_b32 s69, 0
    s_cmp_gt_u32 s62, s60
    s_cbranch_scc1 L_g_nd_179
    s_cmp_ge_u32 s62, s66
    s_cbranch_scc1 L_g_nd_179
    s_add_u32 s47, s61, 4096
    s_add_u32 m0, s64, 0
    s_nop 0
    buffer_load_dwordx4 v3, s[12:15], s61 offen offset:0 sc1 lds
    buffer_load_dwordx4 v3, s[12:15], s61 offen offset:1024 sc1 lds
    buffer_load_dwordx4 v3, s[12:15], s61 offen offset:2048 sc1 lds
    buffer_load_dwordx4 v3, s[12:15], s61 offen offset:3072 sc1 lds
    s_add_u32 m0, s64, 4096
    s_nop 0
    buffer_load_dwordx4 v3, s[12:15], s47 offen offset:0 sc1 lds
    buffer_load_dwordx4 v3, s[12:15], s47 offen offset:1024 sc1 lds
    buffer_load_dwordx4 v3, s[12:15], s47 offen offset:2048 sc1 lds
    buffer_load_dwordx4 v3, s[12:15], s47 offen offset:3072 sc1 lds
    s_add_u32 s61, s61, s85
    s_add_u32 s62, s62, 1
    s_xor_b32 s64, s64, 0x10000
    s_mov_b32 s69, 1
L_g_nd_179:
    s_waitcnt lgkmcnt(3)
    v_add_f32 v80, v80, v16
    v_add_f32 v81, v81, v17
    v_add_f32 v82, v82, v18
    v_add_f32 v83, v83, v19
    s_waitcnt lgkmcnt(2)
    v_add_f32 v84, v84, v20
    v_add_f32 v85, v85, v21
    v_add_f32 v86, v86, v22
    v_add_f32 v87, v87, v23
    s_waitcnt lgkmcnt(1)
    v_add_f32 v88, v88, v24
    v_add_f32 v89, v89, v25
    v_add_f32 v90, v90, v26
    v_add_f32 v91, v91, v27
    s_waitcnt lgkmcnt(0)
    v_add_f32 v92, v92, v28
    v_add_f32 v93, v93, v29
    v_add_f32 v94, v94, v30
    v_add_f32 v95, v95, v31
    v_cvt_pk_bf16_f32 v104, v80, v81
    v_cvt_pk_bf16_f32 v105, v82, v83
    v_cvt_pk_bf16_f32 v106, v84, v85
    v_cvt_pk_bf16_f32 v107, v86, v87
    s_nop 1
    v_permlane16_swap_b32 v104, v106
    v_permlane16_swap_b32 v105, v107
    buffer_store_dwordx4 v[104:107], v8, s[12:15], s63 offen sc1
    v_cvt_pk_bf16_f32 v108, v88, v89
    v_cvt_pk_bf16_f32 v109, v90, v91
    v_cvt_pk_bf16_f32 v110, v92, v93
    v_cvt_pk_bf16_f32 v111, v94, v95
    s_nop 1
    v_permlane16_swap_b32 v108, v110
    v_permlane16_swap_b32 v109, v111
    buffer_store_dwordx4 v[108:111], v9, s[12:15], s63 offen sc1
    s_add_u32 s63, s63, s86
    s_mov_b32 s67, 0
    s_mov_b32 s71, 1
    s_cmp_gt_u32 s66, s60
    s_cbranch_scc1 L_g_g1r_155
    v_mov_b32 v10, 1
    s_mov_b64 exec, 1
    s_waitcnt vmcnt(0)
    ds_add_rtn_u32 v10, v15, v10 offset:4
    s_waitcnt lgkmcnt(0)
    v_readfirstlane_b32 s46, v10
    s_mov_b64 exec, -1
    s_mov_b32 s71, 0
    s_sub_u32 s59, s60, 1
    s_mul_i32 s59, s59, s78
    s_add_u32 s59, s59, s74
    s_cmp_lg_u32 s46, s68
    s_cbranch_scc1 L_g_df_180
    v_mov_b32 v10, s59
    v_add_u32 v10, 1, v10
    v_mov_b32 v11, 0
    s_mov_b64 exec, 1
    buffer_store_dword v10, v11, s[12:15], s52 offen sc1
    s_mov_b64 exec, -1
L_sf_181:
L_g_df_180:
    s_add_u32 s68, s68, 4
    s_cmp_gt_u32 s66, s60
    s_cbranch_scc1 L_g_g1r_155
L_g_tail_158:
    s_cmp_lt_u32 s60, s75
    s_cbranch_scc1 L_g_restart_153
    s_waitcnt vmcnt(0)
    s_barrier
    s_branch L_c_done_1
L_g_h1_168:
    s_add_u32 s54, s60, 1
    s_mul_i32 s55, s54, s78
    v_add_u32 v12, s55, v113
    v_and_b32 v13, 3, v12
    v_lshl_add_u32 v13, v13, 7, v7
    buffer_load_dword v11, v13, s[12:15], 0 offen sc1
    s_branch L_g_h1_168_b
L_g_h2_169:
    s_waitcnt vmcnt(0)
    v_cmp_ge_u32 vcc, v12, v11
    s_nop 0
    s_ff1_i32_b64 s46, vcc
    s_lshr_b32 s46, s46, 4
    s_min_u32 s46, s46, 4
    s_add_u32 s46, s46, s54
    s_min_u32 s46, s46, s75
    v_mov_b32 v118, s46
    s_branch L_g_h2_169_b
L_g_dp_170_l:
    s_cmp_ge_u32 s62, s66
    s_cbranch_scc1 L_g_dp_170_d
    s_mov_b32 s65, 1
    s_add_u32 s47, s61, 4096
    s_mov_b32 m0, s64
    s_add_u32 s62, s62, 1
    buffer_load_dwordx4 v3, s[12:15], s61 offen offset:0 sc1 lds
    buffer_load_dwordx4 v3, s[12:15], s61 offen offset:1024 sc1 lds
    buffer_load_dwordx4 v3, s[12:15], s61 offen offset:2048 sc1 lds
    buffer_load_dwordx4 v3, s[12:15], s61 offen offset:3072 sc1 lds
    s_add_u32 m0, s64, 4096
    s_add_u32 s61, s61, s85
    buffer_load_dwordx4 v3, s[12:15], s47 offen offset:0 sc1 lds
    buffer_load_dwordx4 v3, s[12:15], s47 offen offset:1024 sc1 lds
    buffer_load_dwordx4 v3, s[12:15], s47 offen offset:2048 sc1 lds
    buffer_load_dwordx4 v3, s[12:15], s47 offen offset:3072 sc1 lds
    s_xor_b32 s64, s64, 0x10000
    s_branch L_g_dp_170_a
L_g_nw_166:
    s_waitcnt vmcnt(0) lgkmcnt(0)
    s_cmp_lg_u32 s44, 0
    s_cbranch_scc1 L_g_nl_182
    s_cmp_lt_u32 s66, s75
    s_cselect_b32 s81, 1, 2
L_g_nl_182:
    s_branch L_g_loop0_156_l
L_g_nfl_173:
    s_cmp_eq_u32 s71, 0
    s_cbranch_scc1 L_g_nfl_173_d
    v_mov_b32 v10, 1
    s_mov_b64 exec, 1
    s_waitcnt vmcnt(0)
    ds_add_rtn_u32 v10, v15, v10 offset:4
    s_waitcnt lgkmcnt(0)
    v_readfirstlane_b32 s46, v10
    s_mov_b64 exec, -1
    s_mov_b32 s71, 0
    s_sub_u32 s59, s60, 1
    s_mul_i32 s59, s59, s78
    s_add_u32 s59, s59, s74
    s_cmp_lg_u32 s46, s68
    s_cbranch_scc1 L_g_df_183
    v_mov_b32 v10, s59
    v_add_u32 v10, 1, v10
    v_mov_b32 v11, 0
    s_mov_b64 exec, 1
    buffer_store_dword v10, v11, s[12:15], s52 offen sc1
    s_mov_b64 exec, -1
L_sf_184:
L_g_df_183:
    s_add_u32 s68, s68, 4
    s_mov_b32 s65, 2
    s_branch L_g_nfl_173_d
L_g_dp_178_l:
    s_cmp_ge_u32 s62, s66
    s_cbranch_scc1 L_g_dp_178_d
    s_or_b32 s65, s65, 1
    s_add_u32 s47, s61, 4096
    s_mov_b32 m0, s64
    s_add_u32 s62, s62, 1
    buffer_load_dwordx4 v3, s[12:15], s61 offen offset:0 sc1 lds
    buffer_load_dwordx4 v3, s[12:15], s61 offen offset:1024 sc1 lds
    buffer_load_dwordx4 v3, s[12:15], s61 offen offset:2048 sc1 lds
    buffer_load_dwordx4 v3, s[12:15], s61 offen offset:3072 sc1 lds
    s_add_u32 m0, s64, 4096
    s_add_u32 s61, s61, s85
    buffer_load_dwordx4 v3, s[12:15], s47 offen offset:0 sc1 lds
    buffer_load_dwordx4 v3, s[12:15], s47 offen offset:1024 sc1 lds
    buffer_load_dwordx4 v3, s[12:15], s47 offen offset:2048 sc1 lds
    buffer_load_dwordx4 v3, s[12:15], s47 offen offset:3072 sc1 lds
    s_xor_b32 s64, s64, 0x10000
    s_branch L_g_dp_178_a
L_g_nw1_175:
    s_cmp_eq_u32 s65, 2
    s_cbranch_scc1 L_g_nw1_175_w
    s_waitcnt vmcnt(0)
L_g_nw1_175_w:
    s_barrier
    ds_read_b128 v[32:35], v4 offset:0
    ds_read_b128 v[36:39], v4 offset:256
    ds_read_b128 v[40:43], v4 offset:2048
    ds_read_b128 v[44:47], v4 offset:2304
    ds_read_b128 v[48:51], v4 offset:4096
    ds_read_b128 v[52:55], v4 offset:4352
    ds_read_b128 v[56:59], v4 offset:6144
    ds_read_b128 v[60:63], v4 offset:6400
    s_branch L_g_jn_177
L_c_chain_9:
    v_mov_b32 v4, 0
    v_mov_b32 v5, 0
    v_mov_b32 v6, 0
    v_mov_b32 v7, 0
    v_mov_b32 v8, 0
    v_mov_b32 v9, 0
    v_mov_b32 v10, 0
    v_mov_b32 v11, 0
    v_mov_b32 v12, 0
    v_mov_b32 v13, 0
    v_mov_b32 v14, 0
    v_mov_b32 v15, 0
    v_mov_b32 v32, -1
    v_mov_b32 v33, -1
    v_mov_b32 v34, -1
    v_mov_b32 v35, -1
    v_lshlrev_b32 v2, 4, v1
    s_lshl_b32 s45, s40, 16
    s_lshl_b32 s46, s41, 12
    s_add_u32 s45, s45, s46
    s_and_b32 s46, s44, 3
    s_lshl_b32 s46, s46, 10
    s_add_u32 s45, s45, s46
    s_lshr_b32 s46, s44, 2
    s_lshl_b32 s46, s46, 19
    s_add_u32 s45, s45, s46
    s_add_u32 s45, s45, 0x7000000
    buffer_store_dwordx4 v[32:35], v2, s[12:15], s45 offen sc1
    s_lshl_b32 s45, s40, 15
    s_lshl_b32 s46, s41, 11
    s_add_u32 s45, s45, s46
    s_lshl_b32 s46, s44, 8
    s_add_u32 s45, s45, s46
    s_add_u32 s45, s45, 0x7100000
    s_mov_b64 exec, 0xffff
    buffer_store_dwordx4 v[32:35], v2, s[12:15], s45 offen sc1
    s_lshl_b32 s45, s40, 16
    s_lshl_b32 s46, s41, 8
    s_add_u32 s45, s45, s46
    s_and_b32 s46, s44, 3
    s_lshl_b32 s46, s46, 14
    s_add_u32 s45, s45, s46
    s_add_u32 s45, s45, 0x7180000
    buffer_store_dwordx4 v[32:35], v2, s[12:15], s45 offen sc1
    s_mov_b64 exec, -1
    s_and_b32 s47, s44, 3
    s_cmp_eq_u32 s47, 3
    s_cbranch_scc1 L_c_t3_185
    s_cmp_eq_u32 s40, 7
    s_cselect_b32 s46, 8, 4
    s_cmp_ge_u32 s44, s46
    s_cbranch_scc1 L_c_t3_185
    s_lshl_b32 s46, s47, 3
    s_add_u32 s46, s46, 16
    s_load_dwordx2 s[4:5], s[0:1], s46
    v_lshlrev_b32 v2, 13, v1
    s_lshl_b32 s45, s41, 19
    s_lshl_b32 s46, s40, 10
    s_add_u32 s45, s45, s46
    s_add_u32 s45, s45, 384
    s_lshr_b32 s46, s44, 2
    s_lshl_b32 s46, s46, 9
    s_add_u32 s45, s45, s46
    s_waitcnt lgkmcnt(0)
    s_mov_b32 s24, s4
    s_and_b32 s25, s5, 0xffff
    s_mov_b32 s26, 0x800000
    s_mov_b32 s27, 0x00020000
    buffer_load_dword v110, v2, s[24:27], s45 offen
L_c_t3_185:
    s_cmp_lg_u32 s44, 3
    s_cbranch_scc1 L_c_t3_185_o
    s_load_dwordx2 s[4:5], s[0:1], 40
    v_lshlrev_b32 v2, 10, v1
    s_lshl_b32 s45, s40, 20
    s_lshl_b32 s46, s41, 16
    s_add_u32 s45, s45, s46
    s_add_u32 s45, s45, 384
    s_waitcnt lgkmcnt(0)
    s_mov_b32 s24, s4
    s_and_b32 s25, s5, 0xffff
    s_mov_b32 s26, 0x800000
    s_mov_b32 s27, 0x00020000
    buffer_load_dword v110, v2, s[24:27], s45 offen
L_c_t3_185_o:
    v_lshlrev_b32 v2, 4, v1
    v_and_b32 v3, 8, v1
    v_cmp_eq_u32 vcc, 0, v3
    v_mov_b32 v3, 0xeeeeeeee
    v_mov_b32 v4, 0x44444444
    v_cndmask_b32 v3, v3, v4, vcc
    v_and_b32 v100, 15, v1
    v_lshrrev_b32 v101, 4, v1
    v_and_b32 v102, 1, v101
    v_lshrrev_b32 v103, 1, v101
    v_lshlrev_b32 v104, 2, v102
    v_lshl_add_u32 v104, v103, 1, v104
    v_and_b32 v105, 1, v1
    v_add_u32 v104, v104, v105
    v_and_b32 v106, 7, v1
    v_bfe_u32 v107, v1, 3, 1
    s_lshr_b32 s42, s41, 2
    s_and_b32 s43, s41, 3
    s_lshl_b32 s49, s40, 2
    s_add_u32 s49, s49, s42
    s_lshl_b32 s45, s44, 14
    v_lshlrev_b32 v22, 3, v101
    v_bfe_u32 v23, v1, 2, 2
    v_add_u32 v22, v22, v23
    v_and_b32 v23, 3, v1
    v_lshlrev_b32 v24, 3, v23
    v_lshl_add_u32 v20, v22, 6, v24
    v_lshl_add_u32 v21, v22, 7, v24
    v_lshrrev_b32 v22, 2, v1
    v_lshlrev_b32 v23, 4, v23
    v_lshl_add_u32 v24, v22, 13, v23
    v_lshrrev_b32 v22, 3, v1
    v_lshlrev_b32 v23, 4, v106
    v_lshl_add_u32 v25, v22, 11, v23
    s_cmp_ge_u32 s44, 4
    s_cbranch_scc1 L_v_init_186
    s_lshr_b32 s50, s44, 1
    s_and_b32 s51, s44, 1
    s_load_dwordx4 s[4:7], s[0:1], 16
    s_lshl_b32 s46, s49, 8
    s_lshl_b32 s48, s43, 6
    s_add_u32 s46, s46, s48
    s_lshl_b32 s48, s44, 21
    s_add_u32 s46, s46, s48
    s_lshl_b32 s52, s51, 5
    s_xor_b32 s53, s50, 1
    s_lshl_b32 s53, s53, 16
    s_add_u32 s52, s52, s53
    v_add_u32 v20, s52, v20
    s_waitcnt lgkmcnt(0)
    s_mov_b32 s24, s6
    s_and_b32 s25, s7, 0xffff
    s_mov_b32 s26, 0x800000
    s_mov_b32 s27, 0x00020000
    s_mov_b32 s28, s4
    s_and_b32 s29, s5, 0xffff
    s_mov_b32 s30, 0x800000
    s_mov_b32 s31, 0x00020000
    s_lshl_b32 s52, s51, 9
    s_lshl_b32 s53, s50, 7
    s_add_u32 s52, s52, s53
    s_add_u32 s52, s52, 61440
    v_lshlrev_b32 v5, 1, v106
    v_lshl_add_u32 v5, v107, 8, v5
    v_lshl_add_u32 v5, v102, 6, v5
    v_lshl_add_u32 v5, v103, 5, v5
    v_add_u32 v5, s52, v5
    s_lshl_b32 s67, s49, 12
    s_lshl_b32 s53, s43, 10
    s_add_u32 s67, s67, s53
    s_add_u32 s67, s67, 0x1000000
    s_lshl_b32 s52, s40, 16
    s_lshl_b32 s53, s44, 11
    s_add_u32 s53, s52, s53
    s_add_u32 s53, s53, 0x7080000
    v_lshlrev_b32 v7, 3, v1
    v_add_u32 v7, s53, v7
    s_lshl_b32 s53, s44, 9
    s_add_u32 s53, s52, s53
    s_add_u32 s53, s53, 0x7180000
    v_lshlrev_b32 v28, 6, v103
    v_lshl_add_u32 v28, v106, 3, v28
    v_lshl_add_u32 v28, v102, 2, v28
    v_lshl_add_u32 v28, v107, 1, v28
    v_add_u32 v28, s53, v28
    s_lshl_b32 s52, s44, 10
    s_add_u32 s52, s52, 16384
    v_lshlrev_b32 v8, 8, v101
    v_lshl_add_u32 v8, v106, 4, v8
    v_lshl_add_u32 v8, v107, 3, v8
    v_add_u32 v8, s52, v8
    s_lshl_b32 s52, s44, 8
    s_add_u32 s52, s52, 20480
    v_lshlrev_b32 v9, 4, v106
    v_lshl_add_u32 v9, v101, 2, v9
    v_lshl_add_u32 v9, v107, 1, v9
    v_add_u32 v9, s52, v9
    s_mov_b32 s66, 0x3e0293ee
    s_add_u32 m0, s45, 0
    s_add_u32 s48, s46, 0x0
    buffer_load_dwordx4 v24, s[24:27], s48 offen  lds
    s_add_u32 m0, s45, 1024
    s_add_u32 s48, s46, 0x20000
    buffer_load_dwordx4 v24, s[24:27], s48 offen  lds
    s_add_u32 m0, s45, 2048
    s_add_u32 s48, s46, 0x40000
    buffer_load_dwordx4 v24, s[24:27], s48 offen  lds
    s_add_u32 m0, s45, 3072
    s_add_u32 s48, s46, 0x60000
    buffer_load_dwordx4 v24, s[24:27], s48 offen  lds
    s_add_u32 m0, s45, 4096
    s_add_u32 s48, s46, 0x80000
    buffer_load_dwordx4 v24, s[24:27], s48 offen  lds
    s_add_u32 m0, s45, 5120
    s_add_u32 s48, s46, 0xa0000
    buffer_load_dwordx4 v24, s[24:27], s48 offen  lds
    s_add_u32 m0, s45, 6144
    s_add_u32 s48, s46, 0xc0000
    buffer_load_dwordx4 v24, s[24:27], s48 offen  lds
    s_add_u32 m0, s45, 7168
    s_add_u32 s48, s46, 0xe0000
    buffer_load_dwordx4 v24, s[24:27], s48 offen  lds
    s_add_u32 m0, s45, 8192
    s_add_u32 s48, s46, 0x100000
    buffer_load_dwordx4 v24, s[24:27], s48 offen  lds
    s_add_u32 m0, s45, 9216
    s_add_u32 s48, s46, 0x120000
    buffer_load_dwordx4 v24, s[24:27], s48 offen  lds
    s_add_u32 m0, s45, 10240
    s_add_u32 s48, s46, 0x140000
    buffer_load_dwordx4 v24, s[24:27], s48 offen  lds
    s_add_u32 m0, s45, 11264
    s_add_u32 s48, s46, 0x160000
    buffer_load_dwordx4 v24, s[24:27], s48 offen  lds
    s_add_u32 m0, s45, 12288
    s_add_u32 s48, s46, 0x180000
    buffer_load_dwordx4 v24, s[24:27], s48 offen  lds
    s_add_u32 m0, s45, 13312
    s_add_u32 s48, s46, 0x1a0000
    buffer_load_dwordx4 v24, s[24:27], s48 offen  lds
    s_add_u32 m0, s45, 14336
    s_add_u32 s48, s46, 0x1c0000
    buffer_load_dwordx4 v24, s[24:27], s48 offen  lds
    s_add_u32 m0, s45, 15360
    s_add_u32 s48, s46, 0x1e0000
    buffer_load_dwordx4 v24, s[24:27], s48 offen  lds
    s_add_u32 s45, s45, 0x10000
    s_add_u32 m0, s45, 0
    s_add_u32 s48, s46, 0x0
    buffer_load_dwordx4 v24, s[28:31], s48 offen  lds
    s_add_u32 m0, s45, 1024
    s_add_u32 s48, s46, 0x20000
    buffer_load_dwordx4 v24, s[28:31], s48 offen  lds
    s_add_u32 m0, s45, 2048
    s_add_u32 s48, s46, 0x40000
    buffer_load_dwordx4 v24, s[28:31], s48 offen  lds
    s_add_u32 m0, s45, 3072
    s_add_u32 s48, s46, 0x60000
    buffer_load_dwordx4 v24, s[28:31], s48 offen  lds
    s_add_u32 m0, s45, 4096
    s_add_u32 s48, s46, 0x80000
    buffer_load_dwordx4 v24, s[28:31], s48 offen  lds
    s_add_u32 m0, s45, 5120
    s_add_u32 s48, s46, 0xa0000
    buffer_load_dwordx4 v24, s[28:31], s48 offen  lds
    s_add_u32 m0, s45, 6144
    s_add_u32 s48, s46, 0xc0000
    buffer_load_dwordx4 v24, s[28:31], s48 offen  lds
    s_add_u32 m0, s45, 7168
    s_add_u32 s48, s46, 0xe0000
    buffer_load_dwordx4 v24, s[28:31], s48 offen  lds
    s_add_u32 m0, s45, 8192
    s_add_u32 s48, s46, 0x100000
    buffer_load_dwordx4 v24, s[28:31], s48 offen  lds
    s_add_u32 m0, s45, 9216
    s_add_u32 s48, s46, 0x120000
    buffer_load_dwordx4 v24, s[28:31], s48 offen  lds
    s_add_u32 m0, s45, 10240
    s_add_u32 s48, s46, 0x140000
    buffer_load_dwordx4 v24, s[28:31], s48 offen  lds
    s_add_u32 m0, s45, 11264
    s_add_u32 s48, s46, 0x160000
    buffer_load_dwordx4 v24, s[28:31], s48 offen  lds
    s_add_u32 m0, s45, 12288
    s_add_u32 s48, s46, 0x180000
    buffer_load_dwordx4 v24, s[28:31], s48 offen  lds
    s_add_u32 m0, s45, 13312
    s_add_u32 s48, s46, 0x1a0000
    buffer_load_dwordx4 v24, s[28:31], s48 offen  lds
    s_add_u32 m0, s45, 14336
    s_add_u32 s48, s46, 0x1c0000
    buffer_load_dwordx4 v24, s[28:31], s48 offen  lds
    s_add_u32 m0, s45, 15360
    s_add_u32 s48, s46, 0x1e0000
    buffer_load_dwordx4 v24, s[28:31], s48 offen  lds
    s_add_u32 s45, s45, 0x10000
    s_waitcnt vmcnt(0)
    s_barrier
    s_cmp_lg_u32 s44, 0
    s_cbranch_scc1 L_zwok_189
    v_and_b32 v16, 7, v1
    v_lshlrev_b32 v16, 5, v16
    s_mov_b32 s70, 0
L_zw_188:
    buffer_load_dword v17, v16, s[16:19], 0 offen sc1
    s_waitcnt vmcnt(0)
    v_add_u32_dpp v17, v17, v17 row_ror:1 row_mask:0xf bank_mask:0xf
    s_nop 1
    v_add_u32_dpp v17, v17, v17 row_ror:2 row_mask:0xf bank_mask:0xf
    s_nop 1
    v_add_u32_dpp v17, v17, v17 row_ror:4 row_mask:0xf bank_mask:0xf
    v_cmp_ne_u32 vcc, 0x100, v17
    s_add_u32 s70, s70, 1
    s_cbranch_vccz L_zwok_189
    s_sleep 4
    s_cmp_lt_u32 s70, 524288
    s_cbranch_scc1 L_zw_188
    s_branch L_c_done_1
L_zwok_189:
    s_cmp_lg_u32 s44, 0
    s_cbranch_scc1 L_c_nr_190
    s_or_b32 s47, s39, 0x100
    v_mov_b32 v16, s47
    s_lshl_b32 s52, s40, 6
    s_lshl_b32 s53, s41, 2
    s_add_u32 s52, s52, s53
    s_add_u32 s52, s52, 0x101000
    v_mov_b32 v17, 0
    s_mov_b64 exec, 1
    buffer_store_dword v16, v17, s[12:15], s52 offen sc1
    s_mov_b64 exec, -1
L_c_nr_190:
    ds_read_b64_tr_b16 a[0:1], v20 offset:0
    ds_read_b64_tr_b16 a[2:3], v20 offset:256
    ds_read_b64_tr_b16 a[4:5], v20 offset:2048
    ds_read_b64_tr_b16 a[6:7], v20 offset:2304
    ds_read_b64_tr_b16 a[8:9], v20 offset:4096
    ds_read_b64_tr_b16 a[10:11], v20 offset:4352
    ds_read_b64_tr_b16 a[12:13], v20 offset:6144
    ds_read_b64_tr_b16 a[14:15], v20 offset:6400
    s_waitcnt lgkmcnt(0)
    ds_read_b64_tr_b16 a[16:17], v20 offset:8192
    ds_read_b64_tr_b16 a[18:19], v20 offset:8448
    ds_read_b64_tr_b16 a[20:21], v20 offset:10240
    ds_read_b64_tr_b16 a[22:23], v20 offset:10496
    ds_read_b64_tr_b16 a[24:25], v20 offset:12288
    ds_read_b64_tr_b16 a[26:27], v20 offset:12544
    ds_read_b64_tr_b16 a[28:29], v20 offset:14336
    ds_read_b64_tr_b16 a[30:31], v20 offset:14592
    s_waitcnt lgkmcnt(0)
    ds_read_b64_tr_b16 a[32:33], v20 offset:16384
    ds_read_b64_tr_b16 a[34:35], v20 offset:16640
    ds_read_b64_tr_b16 a[36:37], v20 offset:18432
    ds_read_b64_tr_b16 a[38:39], v20 offset:18688
    ds_read_b64_tr_b16 a[40:41], v20 offset:20480
    ds_read_b64_tr_b16 a[42:43], v20 offset:20736
    ds_read_b64_tr_b16 a[44:45], v20 offset:22528
    ds_read_b64_tr_b16 a[46:47], v20 offset:22784
    s_waitcnt lgkmcnt(0)
    ds_read_b64_tr_b16 a[48:49], v20 offset:24576
    ds_read_b64_tr_b16 a[50:51], v20 offset:24832
    ds_read_b64_tr_b16 a[52:53], v20 offset:26624
    ds_read_b64_tr_b16 a[54:55], v20 offset:26880
    ds_read_b64_tr_b16 a[56:57], v20 offset:28672
    ds_read_b64_tr_b16 a[58:59], v20 offset:28928
    ds_read_b64_tr_b16 a[60:61], v20 offset:30720
    ds_read_b64_tr_b16 a[62:63], v20 offset:30976
    s_waitcnt lgkmcnt(0)
    ds_read_b64_tr_b16 a[64:65], v20 offset:32768
    ds_read_b64_tr_b16 a[66:67], v20 offset:33024
    ds_read_b64_tr_b16 a[68:69], v20 offset:34816
    ds_read_b64_tr_b16 a[70:71], v20 offset:35072
    ds_read_b64_tr_b16 a[72:73], v20 offset:36864
    ds_read_b64_tr_b16 a[74:75], v20 offset:37120
    ds_read_b64_tr_b16 a[76:77], v20 offset:38912
    ds_read_b64_tr_b16 a[78:79], v20 offset:39168
    s_waitcnt lgkmcnt(0)
    ds_read_b64_tr_b16 a[80:81], v20 offset:40960
    ds_read_b64_tr_b16 a[82:83], v20 offset:41216
    ds_read_b64_tr_b16 a[84:85], v20 offset:43008
    ds_read_b64_tr_b16 a[86:87], v20 offset:43264
    ds_read_b64_tr_b16 a[88:89], v20 offset:45056
    ds_read_b64_tr_b16 a[90:91], v20 offset:45312
    ds_read_b64_tr_b16 a[92:93], v20 offset:47104
    ds_read_b64_tr_b16 a[94:95], v20 offset:47360
    s_waitcnt lgkmcnt(0)
    ds_read_b64_tr_b16 a[96:97], v20 offset:49152
    ds_read_b64_tr_b16 a[98:99], v20 offset:49408
    ds_read_b64_tr_b16 a[100:101], v20 offset:51200
    ds_read_b64_tr_b16 a[102:103], v20 offset:51456
    ds_read_b64_tr_b16 a[104:105], v20 offset:53248
    ds_read_b64_tr_b16 a[106:107], v20 offset:53504
    ds_read_b64_tr_b16 a[108:109], v20 offset:55296
    ds_read_b64_tr_b16 a[110:111], v20 offset:55552
    s_waitcnt lgkmcnt(0)
    ds_read_b64_tr_b16 a[112:113], v20 offset:57344
    ds_read_b64_tr_b16 a[114:115], v20 offset:57600
    ds_read_b64_tr_b16 a[116:117], v20 offset:59392
    ds_read_b64_tr_b16 a[118:119], v20 offset:59648
    ds_read_b64_tr_b16 a[120:121], v20 offset:61440
    ds_read_b64_tr_b16 a[122:123], v20 offset:61696
    ds_read_b64_tr_b16 a[124:125], v20 offset:63488
    ds_read_b64_tr_b16 a[126:127], v20 offset:63744
    s_waitcnt lgkmcnt(0)
    s_mov_b32 s63, 0
    s_barrier
    s_lshl_b32 s52, s40, 2
    s_add_u32 s52, s52, s44
    s_mul_i32 s52, s52, 24576
    s_lshl_b32 s53, s41, 9
    s_add_u32 s52, s52, s53
    s_add_u32 s52, s52, 0x2004000
    v_and_b32 v14, 3, v1
    v_lshlrev_b32 v14, 7, v14
    v_add_u32 v14, s52, v14
    s_lshl_b32 s52, s40, 16
    s_lshl_b32 s53, s41, 9
    s_add_u32 s53, s53, s52
    s_lshl_b32 s54, s44, 6
    s_add_u32 s53, s53, s54
    s_add_u32 s53, s53, 0x7080000
    v_lshlrev_b32 v4, 3, v106
    v_lshl_add_u32 v10, v102, 6, v4
    v_lshl_add_u32 v4, v101, 7, v4
    v_add_u32 v4, s53, v4
    v_mov_b32 v54, 0xfffefffe
    v_mov_b32 v56, 0
    v_mov_b32 v57, 0
    v_mov_b32 v58, 0
    v_mov_b32 v59, 0
    s_lshl_b32 s53, s41, 7
    s_add_u32 s53, s53, s52
    s_add_u32 s53, s53, 0x7180000
    v_add_u32 v10, s53, v10
    s_cmp_ge_u32 s44, 2
    s_cselect_b64 vcc, -1, 0
    v_cndmask_b32 v4, v4, v10, vcc
    s_mul_i32 s52, s49, 24576
    s_lshl_b32 s53, s44, 12
    s_add_u32 s52, s52, s53
    s_lshl_b32 s53, s43, 10
    s_add_u32 s52, s52, s53
    s_add_u32 s52, s52, 0x2002000
    v_add_u32 v6, s52, v2
    v_lshrrev_b32 v10, 3, v1
    v_lshlrev_b32 v10, 8, v10
    v_lshl_add_u32 v10, v106, 4, v10
    v_add_u32 v10, 61568, v10
    v_add_u32 v11, 27648, v2
    v_cmp_gt_u32 s[52:53], 32, v1
    s_nop 1
    v_cndmask_b32 v10, v11, v10, s[52:53]
    v_cndmask_b32 v6, v6, v10, vcc
    v_mov_b32 v24, -1
    v_mov_b32 v25, -1
    v_mov_b32 v26, -1
    v_mov_b32 v27, -1
    s_and_b32 s52, s40, 1
    s_lshl_b32 s52, s52, 14
    s_lshl_b32 s53, s41, 10
    s_add_u32 s52, s52, s53
    s_lshl_b32 s53, s50, 9
    s_add_u32 s52, s52, s53
    s_lshl_b32 s53, s51, 7
    s_add_u32 s52, s52, s53
    s_add_u32 s52, s52, 0x7a0000
    v_mov_b32 v46, s52
    v_add_u32 v44, 65536, v2
    s_lshl_b32 s52, s50, 10
    s_add_u32 s52, s52, 62464
    v_add_u32 v31, s52, v2
    s_lshl_b32 s53, s51, 9
    s_add_u32 s52, s52, s53
    v_lshlrev_b32 v45, 4, v100
    v_lshl_add_u32 v45, v103, 8, v45
    v_lshl_add_u32 v45, v102, 3, v45
    v_add_u32 v45, s52, v45
    s_mul_i32 s52, s49, 24576
    s_lshl_b32 s53, s50, 13
    s_add_u32 s52, s52, s53
    s_lshl_b32 s53, s43, 10
    s_add_u32 s52, s52, s53
    s_add_u32 s52, s52, 0x4b80000
    v_add_u32 v13, s52, v2
    v_mov_b32 v29, 26644
    v_mov_b32 v30, 0
    ds_write_b32 v29, v30
    v_mov_b32 v30, 1
    s_lshl_b32 s58, s40, 11
    s_lshl_b32 s53, s44, 7
    s_add_u32 s58, s58, s53
    s_add_u32 s58, s58, 0x10a600
    s_mov_b32 s69, 0
    v_mov_b32 v0, 0
    s_cmp_ge_u32 s44, 2
    s_cselect_b32 s50, 0, 0x00ff00ff
    s_mov_b32 s51, 0x00ff00ff
    s_xor_b32 s45, s44, 2
    s_xor_b32 s46, s41, 6
    s_or_b32 s45, s45, s46
    s_cbranch_scc1 L_c_join_187_p
    s_lshl_b32 s45, s40, 21
    s_add_u32 s45, s45, 0x79c0000
    v_and_b32 v10, 31, v1
    v_lshlrev_b32 v10, 4, v10
    v_lshl_add_u32 v10, v103, 13, v10
    buffer_store_dwordx4 v[24:27], v10, s[12:15], s45 offen sc1
    s_add_u32 s46, s45, 0x1000
    s_load_dword s47, s[22:23], s46
    s_mov_b32 s60, -1
    s_mov_b32 s61, -1
    s_waitcnt vmcnt(0) lgkmcnt(0)
    s_add_u32 s46, s45, 0
    s_memtime s[84:85]
    s_waitcnt lgkmcnt(0)
    s_load_dword s47, s[22:23], s46
    s_waitcnt lgkmcnt(0)
    s_memtime s[86:87]
    s_waitcnt lgkmcnt(0)
    s_sub_u32 s86, s86, s84
    s_min_u32 s60, s60, s86
    s_add_u32 s46, s45, 8192
    s_memtime s[84:85]
    s_waitcnt lgkmcnt(0)
    s_load_dword s47, s[22:23], s46
    s_waitcnt lgkmcnt(0)
    s_memtime s[86:87]
    s_waitcnt lgkmcnt(0)
    s_sub_u32 s86, s86, s84
    s_min_u32 s61, s61, s86
    s_add_u32 s46, s45, 128
    s_memtime s[84:85]
    s_waitcnt lgkmcnt(0)
    s_load_dword s47, s[22:23], s46
    s_waitcnt lgkmcnt(0)
    s_memtime s[86:87]
    s_waitcnt lgkmcnt(0)
    s_sub_u32 s86, s86, s84
    s_min_u32 s60, s60, s86
    s_add_u32 s46, s45, 8320
    s_memtime s[84:85]
    s_waitcnt lgkmcnt(0)
    s_load_dword s47, s[22:23], s46
    s_waitcnt lgkmcnt(0)
    s_memtime s[86:87]
    s_waitcnt lgkmcnt(0)
    s_sub_u32 s86, s86, s84
    s_min_u32 s61, s61, s86
    s_add_u32 s46, s45, 256
    s_memtime s[84:85]
    s_waitcnt lgkmcnt(0)
    s_load_dword s47, s[22:23], s46
    s_waitcnt lgkmcnt(0)
    s_memtime s[86:87]
    s_waitcnt lgkmcnt(0)
    s_sub_u32 s86, s86, s84
    s_min_u32 s60, s60, s86
    s_add_u32 s46, s45, 8448
    s_memtime s[84:85]
    s_waitcnt lgkmcnt(0)
    s_load_dword s47, s[22:23], s46
    s_waitcnt lgkmcnt(0)
    s_memtime s[86:87]
    s_waitcnt lgkmcnt(0)
    s_sub_u32 s86, s86, s84
    s_min_u32 s61, s61, s86
    s_add_u32 s46, s45, 384
    s_memtime s[84:85]
    s_waitcnt lgkmcnt(0)
    s_load_dword s47, s[22:23], s46
    s_waitcnt lgkmcnt(0)
    s_memtime s[86:87]
    s_waitcnt lgkmcnt(0)
    s_sub_u32 s86, s86, s84
    s_min_u32 s60, s60, s86
    s_add_u32 s46, s45, 8576
    s_memtime s[84:85]
    s_waitcnt lgkmcnt(0)
    s_load_dword s47, s[22:23], s46
    s_waitcnt lgkmcnt(0)
    s_memtime s[86:87]
    s_waitcnt lgkmcnt(0)
    s_sub_u32 s86, s86, s84
    s_min_u32 s61, s61, s86
    s_cmp_gt_u32 s60, s61
    s_cselect_b32 s45, 3, 2
    v_mov_b32 v10, s45
    v_mov_b32 v11, 0
    s_lshl_b32 s45, s40, 7
    s_add_u32 s45, s45, 0x101800
    s_mov_b64 exec, 1
    buffer_store_dword v10, v11, s[12:15], s45 offen sc1
    s_mov_b64 exec, -1
L_c_join_187_p:
    s_setprio 1
    s_branch L_c_join_187
L_v_init_186:
    s_sub_u32 s54, s44, 4
    s_lshr_b32 s51, s54, 1
    s_and_b32 s50, s54, 1
    s_load_dwordx4 s[4:7], s[0:1], 32
    s_load_dwordx2 s[8:9], s[0:1], 8
    s_waitcnt lgkmcnt(0)
    s_mov_b32 s24, s4
    s_and_b32 s25, s5, 0xffff
    s_mov_b32 s26, 0x800000
    s_mov_b32 s27, 0x00020000
    s_mov_b32 s28, s6
    s_and_b32 s29, s7, 0xffff
    s_mov_b32 s30, 0x800000
    s_mov_b32 s31, 0x00020000
    s_mov_b32 s32, s8
    s_and_b32 s33, s9, 0xffff
    s_mov_b32 s34, 0x4000
    s_mov_b32 s35, 0x00020000
    s_lshl_b32 s45, s54, 12
    s_add_u32 s45, s45, 0x20000
    v_add_u32 v20, s45, v20
    v_add_u32 v21, s45, v21
    v_add_u32 v22, s45, v2
    s_lshl_b32 s46, s49, 8
    s_lshl_b32 s48, s43, 6
    s_add_u32 s46, s46, s48
    s_lshl_b32 s48, s54, 21
    s_add_u32 s46, s46, s48
    s_add_u32 s48, s46, 0x0
    buffer_load_dwordx4 a[0:3], v24, s[24:27], s48 offen
    s_add_u32 s48, s46, 0x20000
    buffer_load_dwordx4 a[32:35], v24, s[24:27], s48 offen
    s_add_u32 s48, s46, 0x40000
    buffer_load_dwordx4 a[4:7], v24, s[24:27], s48 offen
    s_add_u32 s48, s46, 0x60000
    buffer_load_dwordx4 a[36:39], v24, s[24:27], s48 offen
    s_add_u32 s48, s46, 0x80000
    buffer_load_dwordx4 a[8:11], v24, s[24:27], s48 offen
    s_add_u32 s48, s46, 0xa0000
    buffer_load_dwordx4 a[40:43], v24, s[24:27], s48 offen
    s_add_u32 s48, s46, 0xc0000
    buffer_load_dwordx4 a[12:15], v24, s[24:27], s48 offen
    s_add_u32 s48, s46, 0xe0000
    buffer_load_dwordx4 a[44:47], v24, s[24:27], s48 offen
    s_add_u32 s48, s46, 0x100000
    buffer_load_dwordx4 a[16:19], v24, s[24:27], s48 offen
    s_add_u32 s48, s46, 0x120000
    buffer_load_dwordx4 a[48:51], v24, s[24:27], s48 offen
    s_add_u32 s48, s46, 0x140000
    buffer_load_dwordx4 a[20:23], v24, s[24:27], s48 offen
    s_add_u32 s48, s46, 0x160000
    buffer_load_dwordx4 a[52:55], v24, s[24:27], s48 offen
    s_add_u32 s48, s46, 0x180000
    buffer_load_dwordx4 a[24:27], v24, s[24:27], s48 offen
    s_add_u32 s48, s46, 0x1a0000
    buffer_load_dwordx4 a[56:59], v24, s[24:27], s48 offen
    s_add_u32 s48, s46, 0x1c0000
    buffer_load_dwordx4 a[28:31], v24, s[24:27], s48 offen
    s_add_u32 s48, s46, 0x1e0000
    buffer_load_dwordx4 a[60:63], v24, s[24:27], s48 offen
    s_lshl_b32 s52, s40, 15
    s_lshl_b32 s53, s42, 11
    s_add_u32 s52, s52, s53
    s_lshl_b32 s53, s43, 9
    s_add_u32 s52, s52, s53
    s_lshl_b32 s53, s51, 8
    s_add_u32 s52, s52, s53
    s_add_u32 s52, s52, 0x7100000
    v_bfe_u32 v4, v1, 1, 1
    v_lshlrev_b32 v4, 7, v4
    v_lshl_add_u32 v4, v104, 4, v4
    v_and_b32 v5, 12, v100
    v_add_u32 v4, v4, v5
    v_add_u32 v4, s52, v4
    v_mov_b32 v26, -1
    s_lshl_b32 s52, s51, 5
    s_add_u32 s52, s52, 28160
    v_and_b32 v5, 14, v100
    v_lshlrev_b32 v5, 1, v5
    v_lshl_add_u32 v5, v104, 6, v5
    v_add_u32 v5, s52, v5
    s_lshl_b32 s52, s41, 14
    s_lshl_b32 s53, s54, 11
    s_add_u32 s52, s52, s53
    s_add_u32 s52, s52, 0x7800000
    v_lshlrev_b32 v6, 3, v101
    v_lshl_add_u32 v6, v106, 5, v6
    v_and_b32 v7, 3, v1
    v_lshlrev_b32 v7, 3, v7
    v_bfe_u32 v30, v1, 2, 3
    v_lshl_add_u32 v7, v30, 5, v7
    v_lshl_add_u32 v7, v103, 2, v7
    v_add_u32 v7, s52, v7
    s_lshl_b32 s53, s40, 8
    s_add_u32 s52, s52, s53
    v_add_u32 v6, s52, v6
    v_lshlrev_b32 v30, 4, v100
    v_lshl_add_u32 v30, v101, 18, v30
    v_add_u32 v30, s52, v30
    v_mov_b32 v32, -1
    v_mov_b32 v33, -1
    v_mov_b32 v34, -1
    v_mov_b32 v35, -1
    buffer_store_dwordx4 v[32:35], v30, s[12:15], 0 offen sc1
    s_mov_b32 s53, 8192
    buffer_store_dwordx4 v[32:35], v30, s[12:15], s53 offen sc1
    s_lshl_b32 s55, s40, 16
    s_add_u32 s55, s55, 0x7000000
    s_lshl_b32 s52, s41, 10
    s_lshl_b32 s53, s54, 8
    s_add_u32 s52, s52, s53
    s_add_u32 s52, s52, s55
    v_lshlrev_b32 v8, 2, v1
    v_add_u32 v8, s52, v8
    s_lshl_b32 s53, s54, 12
    v_add_u32 v10, s53, v2
    v_add_u32 v9, s55, v10
    s_lshl_b32 s52, s40, 15
    s_lshl_b32 s53, s54, 11
    s_add_u32 s52, s52, s53
    s_add_u32 s52, s52, 0x7100000
    v_add_u32 v11, s52, v2
    s_lshl_b32 s52, s54, 9
    s_add_u32 s52, s52, 53248
    v_lshlrev_b32 v12, 4, v100
    v_lshl_add_u32 v12, v102, 3, v12
    v_lshl_add_u32 v12, v103, 8, v12
    v_add_u32 v12, s52, v12
    s_lshl_b32 s52, s51, 3
    s_add_u32 s52, s52, 49152
    v_add_u32 v13, s52, v2
    s_lshl_b32 s52, s54, 10
    s_add_u32 s52, s52, 49152
    v_add_u32 v14, s52, v2
    s_lshl_b32 s52, s40, 2
    s_add_u32 s52, s52, s54
    s_mul_i32 s52, s52, 24576
    s_add_u32 s52, s52, 0x2004000
    v_add_u32 v15, s52, v2
    s_lshl_b32 s52, s54, 10
    v_add_u32 v27, s52, v2
    v_lshlrev_b32 v30, 11, v106
    v_lshl_add_u32 v30, v101, 5, v30
    v_lshl_add_u32 v30, v107, 2, v30
    s_lshl_b32 s52, s54, 9
    buffer_load_dword v112, v30, s[32:35], s52 offen offset:0
    buffer_load_dword v113, v30, s[32:35], s52 offen offset:8
    buffer_load_dword v114, v30, s[32:35], s52 offen offset:16
    buffer_load_dword v115, v30, s[32:35], s52 offen offset:24
    buffer_load_dword v116, v30, s[32:35], s52 offen offset:128
    buffer_load_dword v117, v30, s[32:35], s52 offen offset:136
    buffer_load_dword v118, v30, s[32:35], s52 offen offset:144
    buffer_load_dword v119, v30, s[32:35], s52 offen offset:152
    buffer_load_dword v120, v30, s[32:35], s52 offen offset:256
    buffer_load_dword v121, v30, s[32:35], s52 offen offset:264
    buffer_load_dword v122, v30, s[32:35], s52 offen offset:272
    buffer_load_dword v123, v30, s[32:35], s52 offen offset:280
    buffer_load_dword v124, v30, s[32:35], s52 offen offset:384
    buffer_load_dword v125, v30, s[32:35], s52 offen offset:392
    buffer_load_dword v126, v30, s[32:35], s52 offen offset:400
    buffer_load_dword v127, v30, s[32:35], s52 offen offset:408
    s_lshl_b32 s46, s40, 2
    s_add_u32 s46, s46, s54
    s_lshl_b32 s46, s46, 18
    s_lshl_b32 s48, s41, 7
    s_add_u32 s46, s46, s48
    s_add_u32 s48, s46, 0x0
    buffer_load_dwordx4 a[64:67], v25, s[28:31], s48 offen
    s_add_u32 s48, s46, 0x4000
    buffer_load_dwordx4 a[80:83], v25, s[28:31], s48 offen
    s_add_u32 s48, s46, 0x8000
    buffer_load_dwordx4 a[96:99], v25, s[28:31], s48 offen
    s_add_u32 s48, s46, 0xc000
    buffer_load_dwordx4 a[112:115], v25, s[28:31], s48 offen
    s_add_u32 s48, s46, 0x10000
    buffer_load_dwordx4 a[68:71], v25, s[28:31], s48 offen
    s_add_u32 s48, s46, 0x14000
    buffer_load_dwordx4 a[84:87], v25, s[28:31], s48 offen
    s_add_u32 s48, s46, 0x18000
    buffer_load_dwordx4 a[100:103], v25, s[28:31], s48 offen
    s_add_u32 s48, s46, 0x1c000
    buffer_load_dwordx4 a[116:119], v25, s[28:31], s48 offen
    s_add_u32 s48, s46, 0x20000
    buffer_load_dwordx4 a[72:75], v25, s[28:31], s48 offen
    s_add_u32 s48, s46, 0x24000
    buffer_load_dwordx4 a[88:91], v25, s[28:31], s48 offen
    s_add_u32 s48, s46, 0x28000
    buffer_load_dwordx4 a[104:107], v25, s[28:31], s48 offen
    s_add_u32 s48, s46, 0x2c000
    buffer_load_dwordx4 a[120:123], v25, s[28:31], s48 offen
    s_add_u32 s48, s46, 0x30000
    buffer_load_dwordx4 a[76:79], v25, s[28:31], s48 offen
    s_add_u32 s48, s46, 0x34000
    buffer_load_dwordx4 a[92:95], v25, s[28:31], s48 offen
    s_add_u32 s48, s46, 0x38000
    buffer_load_dwordx4 a[108:111], v25, s[28:31], s48 offen
    s_add_u32 s48, s46, 0x3c000
    buffer_load_dwordx4 a[124:127], v25, s[28:31], s48 offen
    s_waitcnt vmcnt(16)
    ds_write_b128 v22, a[0:3] offset:0
    ds_write_b128 v22, a[32:35] offset:1024
    ds_write_b128 v22, a[4:7] offset:2048
    ds_write_b128 v22, a[36:39] offset:3072
    s_waitcnt lgkmcnt(0)
    ds_read_b64_tr_b16 a[0:1], v20 offset:0
    ds_read_b64_tr_b16 a[2:3], v20 offset:256
    ds_read_b64_tr_b16 a[32:33], v20 offset:32
    ds_read_b64_tr_b16 a[34:35], v20 offset:288
    ds_read_b64_tr_b16 a[4:5], v20 offset:2048
    ds_read_b64_tr_b16 a[6:7], v20 offset:2304
    ds_read_b64_tr_b16 a[36:37], v20 offset:2080
    ds_read_b64_tr_b16 a[38:39], v20 offset:2336
    s_waitcnt lgkmcnt(0)
    ds_write_b128 v22, a[8:11] offset:0
    ds_write_b128 v22, a[40:43] offset:1024
    ds_write_b128 v22, a[12:15] offset:2048
    ds_write_b128 v22, a[44:47] offset:3072
    s_waitcnt lgkmcnt(0)
    ds_read_b64_tr_b16 a[8:9], v20 offset:0
    ds_read_b64_tr_b16 a[10:11], v20 offset:256
    ds_read_b64_tr_b16 a[40:41], v20 offset:32
    ds_read_b64_tr_b16 a[42:43], v20 offset:288
    ds_read_b64_tr_b16 a[12:13], v20 offset:2048
    ds_read_b64_tr_b16 a[14:15], v20 offset:2304
    ds_read_b64_tr_b16 a[44:45], v20 offset:2080
    ds_read_b64_tr_b16 a[46:47], v20 offset:2336
    s_waitcnt lgkmcnt(0)
    ds_write_b128 v22, a[16:19] offset:0
    ds_write_b128 v22, a[48:51] offset:1024
    ds_write_b128 v22, a[20:23] offset:2048
    ds_write_b128 v22, a[52:55] offset:3072
    s_waitcnt lgkmcnt(0)
    ds_read_b64_tr_b16 a[16:17], v20 offset:0
    ds_read_b64_tr_b16 a[18:19], v20 offset:256
    ds_read_b64_tr_b16 a[48:49], v20 offset:32
    ds_read_b64_tr_b16 a[50:51], v20 offset:288
    ds_read_b64_tr_b16 a[20:21], v20 offset:2048
    ds_read_b64_tr_b16 a[22:23], v20 offset:2304
    ds_read_b64_tr_b16 a[52:53], v20 offset:2080
    ds_read_b64_tr_b16 a[54:55], v20 offset:2336
    s_waitcnt lgkmcnt(0)
    ds_write_b128 v22, a[24:27] offset:0
    ds_write_b128 v22, a[56:59] offset:1024
    ds_write_b128 v22, a[28:31] offset:2048
    ds_write_b128 v22, a[60:63] offset:3072
    s_waitcnt lgkmcnt(0)
    ds_read_b64_tr_b16 a[24:25], v20 offset:0
    ds_read_b64_tr_b16 a[26:27], v20 offset:256
    ds_read_b64_tr_b16 a[56:57], v20 offset:32
    ds_read_b64_tr_b16 a[58:59], v20 offset:288
    ds_read_b64_tr_b16 a[28:29], v20 offset:2048
    ds_read_b64_tr_b16 a[30:31], v20 offset:2304
    ds_read_b64_tr_b16 a[60:61], v20 offset:2080
    ds_read_b64_tr_b16 a[62:63], v20 offset:2336
    s_waitcnt lgkmcnt(0)
    s_barrier
    s_waitcnt vmcnt(0)
    ds_write_b128 v22, a[64:67] offset:0
    ds_write_b128 v22, a[80:83] offset:1024
    ds_write_b128 v22, a[96:99] offset:2048
    ds_write_b128 v22, a[112:115] offset:3072
    s_waitcnt lgkmcnt(0)
    ds_read_b64_tr_b16 a[64:65], v21 offset:0
    ds_read_b64_tr_b16 a[66:67], v21 offset:512
    ds_read_b64_tr_b16 a[80:81], v21 offset:32
    ds_read_b64_tr_b16 a[82:83], v21 offset:544
    ds_read_b64_tr_b16 a[96:97], v21 offset:64
    ds_read_b64_tr_b16 a[98:99], v21 offset:576
    ds_read_b64_tr_b16 a[112:113], v21 offset:96
    ds_read_b64_tr_b16 a[114:115], v21 offset:608
    s_waitcnt lgkmcnt(0)
    ds_write_b128 v22, a[68:71] offset:0
    ds_write_b128 v22, a[84:87] offset:1024
    ds_write_b128 v22, a[100:103] offset:2048
    ds_write_b128 v22, a[116:119] offset:3072
    s_waitcnt lgkmcnt(0)
    ds_read_b64_tr_b16 a[68:69], v21 offset:0
    ds_read_b64_tr_b16 a[70:71], v21 offset:512
    ds_read_b64_tr_b16 a[84:85], v21 offset:32
    ds_read_b64_tr_b16 a[86:87], v21 offset:544
    ds_read_b64_tr_b16 a[100:101], v21 offset:64
    ds_read_b64_tr_b16 a[102:103], v21 offset:576
    ds_read_b64_tr_b16 a[116:117], v21 offset:96
    ds_read_b64_tr_b16 a[118:119], v21 offset:608
    s_waitcnt lgkmcnt(0)
    ds_write_b128 v22, a[72:75] offset:0
    ds_write_b128 v22, a[88:91] offset:1024
    ds_write_b128 v22, a[104:107] offset:2048
    ds_write_b128 v22, a[120:123] offset:3072
    s_waitcnt lgkmcnt(0)
    ds_read_b64_tr_b16 a[72:73], v21 offset:0
    ds_read_b64_tr_b16 a[74:75], v21 offset:512
    ds_read_b64_tr_b16 a[88:89], v21 offset:32
    ds_read_b64_tr_b16 a[90:91], v21 offset:544
    ds_read_b64_tr_b16 a[104:105], v21 offset:64
    ds_read_b64_tr_b16 a[106:107], v21 offset:576
    ds_read_b64_tr_b16 a[120:121], v21 offset:96
    ds_read_b64_tr_b16 a[122:123], v21 offset:608
    s_waitcnt lgkmcnt(0)
    ds_write_b128 v22, a[76:79] offset:0
    ds_write_b128 v22, a[92:95] offset:1024
    ds_write_b128 v22, a[108:111] offset:2048
    ds_write_b128 v22, a[124:127] offset:3072
    s_waitcnt lgkmcnt(0)
    ds_read_b64_tr_b16 a[76:77], v21 offset:0
    ds_read_b64_tr_b16 a[78:79], v21 offset:512
    ds_read_b64_tr_b16 a[92:93], v21 offset:32
    ds_read_b64_tr_b16 a[94:95], v21 offset:544
    ds_read_b64_tr_b16 a[108:109], v21 offset:64
    ds_read_b64_tr_b16 a[110:111], v21 offset:576
    ds_read_b64_tr_b16 a[124:125], v21 offset:96
    ds_read_b64_tr_b16 a[126:127], v21 offset:608
    s_waitcnt lgkmcnt(0)
    s_mov_b32 s65, 0
    s_waitcnt vmcnt(0)
    s_barrier
    s_lshl_b32 s57, s40, 11
    s_lshl_b32 s53, s54, 7
    s_add_u32 s57, s57, s53
    s_add_u32 s57, s57, 0x10a600
    s_mov_b32 s69, 0
    s_mov_b32 s68, 0
    s_cmp_gt_u32 s69, s68
    s_cbranch_scc1 L_kv_ok_192
    s_mov_b32 s70, 0
L_kv_lp_191:
    v_and_b32 v22, 1, v1
    v_lshlrev_b32 v22, 9, v22
    buffer_load_dword v23, v22, s[12:15], s57 offen sc1
    s_waitcnt vmcnt(0)
    v_readlane_b32 s69, v23, 0
    v_readlane_b32 s45, v23, 1
    s_add_u32 s70, s70, 1
    s_nop 2
    s_min_u32 s69, s69, s45
    s_cmp_gt_u32 s69, s68
    s_cbranch_scc1 L_kv_ok_192
    s_sleep 4
    s_cmp_lt_u32 s70, 524288
    s_cbranch_scc1 L_kv_lp_191
    s_branch L_c_done_1
L_kv_ok_192:
    v_lshlrev_b32 v28, 9, v101
    v_lshl_add_u32 v28, v100, 4, v28
    s_lshl_b32 s52, s54, 13
    s_add_u32 s52, s52, 0x7a0000
    v_add_u32 v28, s52, v28
    s_lshl_b32 s59, s54, 12
    s_add_u32 s59, s59, 65536
    v_lshlrev_b32 v31, 4, v100
    v_lshl_add_u32 v31, v103, 8, v31
    v_add_u32 v31, 20480, v31
    s_lshl_b32 s52, s54, 11
    s_add_u32 s52, s52, 53248
    v_add_u32 v25, s52, v2
    v_mov_b32 v29, 26640
    v_mov_b32 v30, 0
    ds_write_b32 v29, v30
    v_mov_b32 v30, 1
    s_mov_b32 s58, 0
    s_mov_b32 s64, 0
    s_add_u32 s46, s65, 4096
    buffer_load_dwordx4 v[32:35], v15, s[12:15], s65 offen offset:0 sc1
    buffer_load_dwordx4 v[48:51], v15, s[12:15], s46 offen offset:0 sc1
    buffer_load_dwordx4 v[36:39], v15, s[12:15], s65 offen offset:1024 sc1
    buffer_load_dwordx4 v[52:55], v15, s[12:15], s46 offen offset:1024 sc1
    buffer_load_dwordx4 v[40:43], v15, s[12:15], s65 offen offset:2048 sc1
    buffer_load_dwordx4 v[56:59], v15, s[12:15], s46 offen offset:2048 sc1
    buffer_load_dwordx4 v[44:47], v15, s[12:15], s65 offen offset:3072 sc1
    buffer_load_dwordx4 v[60:63], v15, s[12:15], s46 offen offset:3072 sc1
    s_add_u32 s65, s65, 786432
    s_waitcnt vmcnt(0)
    v_mfma_f32_16x16x32_bf16 v[64:67], v[32:35], a[64:67], 0
    v_mfma_f32_16x16x32_bf16 v[68:71], v[48:51], a[64:67], 0
    v_mfma_f32_16x16x32_bf16 v[64:67], v[36:39], a[68:71], v[64:67]
    v_mfma_f32_16x16x32_bf16 v[68:71], v[52:55], a[68:71], v[68:71]
    v_mfma_f32_16x16x32_bf16 v[64:67], v[40:43], a[72:75], v[64:67]
    v_mfma_f32_16x16x32_bf16 v[68:71], v[56:59], a[72:75], v[68:71]
    v_mfma_f32_16x16x32_bf16 v[64:67], v[44:47], a[76:79], v[64:67]
    v_mfma_f32_16x16x32_bf16 v[68:71], v[60:63], a[76:79], v[68:71]
    v_mfma_f32_16x16x32_bf16 v[72:75], v[32:35], a[80:83], 0
    v_mfma_f32_16x16x32_bf16 v[76:79], v[48:51], a[80:83], 0
    v_mfma_f32_16x16x32_bf16 v[72:75], v[36:39], a[84:87], v[72:75]
    v_mfma_f32_16x16x32_bf16 v[76:79], v[52:55], a[84:87], v[76:79]
    v_mfma_f32_16x16x32_bf16 v[72:75], v[40:43], a[88:91], v[72:75]
    v_mfma_f32_16x16x32_bf16 v[76:79], v[56:59], a[88:91], v[76:79]
    v_mfma_f32_16x16x32_bf16 v[72:75], v[44:47], a[92:95], v[72:75]
    v_mfma_f32_16x16x32_bf16 v[76:79], v[60:63], a[92:95], v[76:79]
    v_cvt_pk_bf16_f32 v64, v64, v65
    v_cvt_pk_bf16_f32 v65, v66, v67
    v_cvt_pk_bf16_f32 v66, v68, v69
    v_cvt_pk_bf16_f32 v67, v70, v71
    ds_write_b128 v10, v[64:67] offset:32768
    v_mfma_f32_16x16x32_bf16 v[80:83], v[32:35], a[96:99], 0
    v_mfma_f32_16x16x32_bf16 v[84:87], v[48:51], a[96:99], 0
    v_mfma_f32_16x16x32_bf16 v[80:83], v[36:39], a[100:103], v[80:83]
    v_mfma_f32_16x16x32_bf16 v[84:87], v[52:55], a[100:103], v[84:87]
    v_mfma_f32_16x16x32_bf16 v[80:83], v[40:43], a[104:107], v[80:83]
    v_mfma_f32_16x16x32_bf16 v[84:87], v[56:59], a[104:107], v[84:87]
    v_mfma_f32_16x16x32_bf16 v[80:83], v[44:47], a[108:111], v[80:83]
    v_mfma_f32_16x16x32_bf16 v[84:87], v[60:63], a[108:111], v[84:87]
    v_cvt_pk_bf16_f32 v72, v72, v73
    v_cvt_pk_bf16_f32 v73, v74, v75
    v_cvt_pk_bf16_f32 v74, v76, v77
    v_cvt_pk_bf16_f32 v75, v78, v79
    ds_write_b128 v10, v[72:75] offset:33792
    v_mfma_f32_16x16x32_bf16 v[88:91], v[32:35], a[112:115], 0
    v_mfma_f32_16x16x32_bf16 v[92:95], v[48:51], a[112:115], 0
    v_mfma_f32_16x16x32_bf16 v[88:91], v[36:39], a[116:119], v[88:91]
    v_mfma_f32_16x16x32_bf16 v[92:95], v[52:55], a[116:119], v[92:95]
    v_mfma_f32_16x16x32_bf16 v[88:91], v[40:43], a[120:123], v[88:91]
    v_mfma_f32_16x16x32_bf16 v[92:95], v[56:59], a[120:123], v[92:95]
    v_mfma_f32_16x16x32_bf16 v[88:91], v[44:47], a[124:127], v[88:91]
    v_mfma_f32_16x16x32_bf16 v[92:95], v[60:63], a[124:127], v[92:95]
    v_cvt_pk_bf16_f32 v80, v80, v81
    v_cvt_pk_bf16_f32 v81, v82, v83
    v_cvt_pk_bf16_f32 v82, v84, v85
    v_cvt_pk_bf16_f32 v83, v86, v87
    ds_write_b128 v10, v[80:83] offset:34816
    s_nop 2
    v_cvt_pk_bf16_f32 v88, v88, v89
    v_cvt_pk_bf16_f32 v89, v90, v91
    v_cvt_pk_bf16_f32 v90, v92, v93
    v_cvt_pk_bf16_f32 v91, v94, v95
    ds_write_b128 v10, v[88:91] offset:35840
    s_mov_b64 s[66:67], 0
    s_mov_b32 s63, 0
    s_mov_b32 s68, 1
    s_cmp_gt_u32 s69, s68
    s_cbranch_scc1 L_kv_ok_194
    s_mov_b32 s70, 0
L_kv_lp_193:
    v_and_b32 v22, 1, v1
    v_lshlrev_b32 v22, 9, v22
    buffer_load_dword v23, v22, s[12:15], s57 offen sc1
    s_waitcnt vmcnt(0)
    v_readlane_b32 s69, v23, 0
    v_readlane_b32 s45, v23, 1
    s_add_u32 s70, s70, 1
    s_nop 2
    s_min_u32 s69, s69, s45
    s_cmp_gt_u32 s69, s68
    s_cbranch_scc1 L_kv_ok_194
    s_sleep 4
    s_cmp_lt_u32 s70, 524288
    s_cbranch_scc1 L_kv_lp_193
    s_branch L_c_done_1
L_kv_ok_194:
    v_lshrrev_b32 v22, 3, v1
    v_lshlrev_b32 v22, 7, v22
    s_mov_b32 s45, 0x101800
    s_mov_b32 s46, 0
    s_mov_b32 s70, 0
L_spin_195:
    buffer_load_dword v23, v22, s[12:15], s45 offen sc1
    s_waitcnt vmcnt(0)
    v_cmp_ge_u32 vcc, s46, v23
    s_add_u32 s70, s70, 1
    s_cbranch_vccz L_spok_196
    s_sleep 3
    s_cmp_lt_u32 s70, 524288
    s_cbranch_scc1 L_spin_195
    s_branch L_c_done_1
L_spok_196:
    v_cmp_eq_u32 s[66:67], 3, v23
    s_nop 3
    s_bitcmp1_b32 s66, 0
    s_cselect_b32 s63, 8192, 0
    s_waitcnt lgkmcnt(0)
    v_min_u32 v64, -2, v112
    v_min_u32 v65, -2, v113
    v_min_u32 v66, -2, v114
    v_min_u32 v67, -2, v115
    v_min_u32 v68, -2, v116
    v_min_u32 v69, -2, v117
    v_min_u32 v70, -2, v118
    v_min_u32 v71, -2, v119
    v_min_u32 v72, -2, v120
    v_min_u32 v73, -2, v121
    v_min_u32 v74, -2, v122
    v_min_u32 v75, -2, v123
    v_min_u32 v76, -2, v124
    v_min_u32 v77, -2, v125
    v_min_u32 v78, -2, v126
    v_min_u32 v79, -2, v127
    v_mov_b32 v16, 0
    v_mov_b32 v17, 0
    v_mov_b32 v18, 0
    v_mov_b32 v19, 0
    v_mov_b32 v20, 0
    v_mov_b32 v21, 0
    v_mov_b32 v22, 0
    v_mov_b32 v23, 0
L_c_join_187:
    s_mov_b32 s60, 0
    s_mov_b32 s61, 0
    s_mov_b32 s62, 0
    s_cmp_lg_u32 s44, 0
    s_cbranch_scc1 L_c_nh_197
    v_lshlrev_b32 v17, 3, v1
    s_lshl_b32 s46, s40, 3
    v_mov_b32 v21, s46
    s_mov_b32 s45, 0x101000
    s_mov_b32 s70, 0
L_c_rp_198:
    buffer_load_dwordx2 v[18:19], v17, s[12:15], s45 offen sc1
    buffer_load_dwordx2 v[22:23], v21, s[12:15], s45 offen offset:512 sc1
    s_waitcnt vmcnt(0)
    v_min3_u32 v20, v18, v19, v22
    v_min_u32 v20, v20, v23
    v_cmp_eq_u32 vcc, 0, v20
    s_cbranch_vccnz L_rt_199
    v_cmp_eq_u32 s[52:53], v18, v16
    v_cmp_eq_u32 vcc, v19, v16
    v_cmp_eq_u32 s[54:55], v22, v16
    v_cmp_eq_u32 s[56:57], v23, v16
    s_lshl_b32 s46, s40, 3
    s_nop 3
    s_and_b64 s[52:53], s[52:53], vcc
    s_lshr_b64 s[52:53], s[52:53], s46
    s_and_b32 s52, s52, 0xff
    s_cmp_eq_u32 s52, 0xff
    s_cselect_b32 s52, 1, 0
    v_mov_b32 v16, s52
    v_mov_b32 v17, 26624
    ds_write_b32 v17, v16
L_c_nh_197:
    s_waitcnt lgkmcnt(0)
    s_barrier
    v_mov_b32 v17, 26624
    ds_read_b32 v16, v17
    s_waitcnt lgkmcnt(0)
    v_readfirstlane_b32 s52, v16
    s_nop 3
    s_cmp_ge_u32 s44, 4
    s_cbranch_scc1 L_vf_202
    s_mov_b32 s57, s58
    s_mov_b32 s58, 0
    s_cmp_ge_u32 s44, 2
    s_cbranch_scc1 L_sf_200
    buffer_load_dwordx4 v[32:35], v6, s[12:15], 0 offen sc1
L_sf_200:
    s_mov_b32 s54, s52
    v_add_u32 v52, 786432, v6
    s_mul_i32 s53, s49, 24576
    s_lshl_b32 s55, s43, 11
    s_add_u32 s53, s53, s55
    s_and_b32 s55, s44, 1
    s_lshl_b32 s55, s55, 10
    s_add_u32 s53, s53, s55
    s_add_u32 s53, s53, 0x2184000
    v_and_b32 v53, 7, v1
    v_lshlrev_b32 v53, 7, v53
    v_add_u32 v53, s53, v53
    s_cmp_ge_u32 s44, 2
    s_cselect_b64 vcc, -1, 0
    s_cselect_b64 s[52:53], 0xff, -1
    v_cndmask_b32 v52, v52, v53, vcc
    s_cselect_b32 s55, 786432, 0
    v_readfirstlane_b32 s56, v52
    s_nop 3
    s_sub_u32 s56, s56, s55
    s_cmp_eq_u32 s54, 0
    s_cbranch_scc1 L_ss_201
.p2align 6
L_s_loop_204:
    v_mov_b32 v16, 0
    v_mov_b32 v17, 0
    v_mov_b32 v18, 0
    v_mov_b32 v19, 0
    s_add_u32 s58, s58, 4
    s_mov_b32 s70, 1
    s_waitcnt vmcnt(0) lgkmcnt(0)
    s_barrier
    ds_read_b128 v[64:67], v2 offset:0
    ds_read_b128 v[68:71], v2 offset:1024
    ds_read_b128 v[72:75], v2 offset:2048
    ds_read_b128 v[76:79], v2 offset:3072
    ds_read_b128 v[80:83], v2 offset:4096
    ds_read_b128 v[84:87], v2 offset:5120
    ds_read_b128 v[88:91], v2 offset:6144
    ds_read_b128 v[92:95], v2 offset:7168
    ds_read_b128 v[96:99], v2 offset:8192
    ds_read_b128 v[100:103], v2 offset:9216
    ds_read_b128 v[104:107], v2 offset:10240
    ds_read_b128 v[108:111], v2 offset:11264
    s_waitcnt lgkmcnt(11)
    v_smfmac_f32_16x16x64_bf16 v[16:19], v[64:67], a[0:7], v3
    ds_read_b128 v[112:115], v2 offset:12288
    s_waitcnt lgkmcnt(11)
    v_smfmac_f32_16x16x64_bf16 v[16:19], v[68:71], a[8:15], v3
    ds_read_b128 v[116:119], v2 offset:13312
    s_waitcnt lgkmcnt(11)
    v_smfmac_f32_16x16x64_bf16 v[16:19], v[72:75], a[16:23], v3
    ds_read_b128 v[120:123], v2 offset:14336
    s_waitcnt lgkmcnt(11)
    v_smfmac_f32_16x16x64_bf16 v[16:19], v[76:79], a[24:31], v3
    ds_read_b128 v[124:127], v2 offset:15360
    s_waitcnt lgkmcnt(11)
    v_smfmac_f32_16x16x64_bf16 v[16:19], v[80:83], a[32:39], v3
    s_waitcnt lgkmcnt(10)
    v_smfmac_f32_16x16x64_bf16 v[16:19], v[84:87], a[40:47], v3
    s_waitcnt lgkmcnt(9)
    v_smfmac_f32_16x16x64_bf16 v[16:19], v[88:91], a[48:55], v3
    s_waitcnt lgkmcnt(8)
    v_smfmac_f32_16x16x64_bf16 v[16:19], v[92:95], a[56:63], v3
    s_waitcnt lgkmcnt(7)
    v_smfmac_f32_16x16x64_bf16 v[16:19], v[96:99], a[64:71], v3
    s_waitcnt lgkmcnt(6)
    v_smfmac_f32_16x16x64_bf16 v[16:19], v[100:103], a[72:79], v3
    s_waitcnt lgkmcnt(5)
    v_smfmac_f32_16x16x64_bf16 v[16:19], v[104:107], a[80:87], v3
    s_waitcnt lgkmcnt(4)
    v_smfmac_f32_16x16x64_bf16 v[16:19], v[108:111], a[88:95], v3
    s_waitcnt lgkmcnt(3)
    v_smfmac_f32_16x16x64_bf16 v[16:19], v[112:115], a[96:103], v3
    s_waitcnt lgkmcnt(2)
    v_smfmac_f32_16x16x64_bf16 v[16:19], v[116:119], a[104:111], v3
    s_waitcnt lgkmcnt(1)
    v_smfmac_f32_16x16x64_bf16 v[16:19], v[120:123], a[112:119], v3
    s_waitcnt lgkmcnt(0)
    v_smfmac_f32_16x16x64_bf16 v[16:19], v[124:127], a[120:127], v3
    s_nop 7
    v_permlane32_swap_b32 v16, v18
    v_permlane32_swap_b32 v17, v19
    v_add_f32 v16, v16, v18
    v_add_f32 v17, v17, v19
    v_cvt_pk_bf16_f32 v16, v16, v17
    ds_write_b16 v5, v16
    ds_write_b16_d16_hi v5, v16 offset:16
    s_mov_b64 exec, 1
    ds_add_u32 v29, v30
    s_mov_b64 exec, -1
L_s_xl_206:
    ds_read_b32 v10, v29
    ds_read_b128 v[64:67], v2 offset:61440
    s_cmp_eq_u32 s60, 63
    s_cbranch_scc1 L_s_last_205
    s_cmp_ge_u32 s44, 2
    s_cbranch_scc1 L_s_w2_207
    s_waitcnt lgkmcnt(0)
    v_mfma_f32_16x16x32_bf16 v[16:19], v[32:35], v[64:67], 0
L_s_w2_207_b:
    v_cmp_ne_u32 vcc, s58, v10
    s_nop 0
    s_cbranch_vccnz L_rt_209
    s_mov_b64 exec, s[50:51]
    s_nop 3
    v_cvt_pk_bf16_f32 v16, v16, v17
    v_cvt_pk_bf16_f32 v17, v18, v19
    v_pk_min_u16 v16, v16, v54
    v_pk_min_u16 v17, v17, v54
    buffer_store_dwordx2 v[16:17], v4, s[12:15], s61 offen
    s_mov_b64 exec, -1
L_s_w3_208_b:
    s_sleep 5
    s_mov_b32 s70, 1
L_s_xp_211:
    buffer_load_dwordx2 v[64:65], v7, s[12:15], s61 offen offset:0 sc1
    buffer_load_short_d16_hi v56, v28, s[12:15], s61 offen offset:0 sc1
    buffer_load_dwordx2 v[66:67], v7, s[12:15], s61 offen offset:512 sc1
    buffer_load_short_d16_hi v57, v28, s[12:15], s61 offen offset:128 sc1
    buffer_load_dwordx2 v[68:69], v7, s[12:15], s61 offen offset:1024 sc1
    buffer_load_short_d16_hi v58, v28, s[12:15], s61 offen offset:256 sc1
    buffer_load_dwordx2 v[70:71], v7, s[12:15], s61 offen offset:1536 sc1
    buffer_load_short_d16_hi v59, v28, s[12:15], s61 offen offset:384 sc1
L_s_xc_210_b:
    s_mov_b32 s46, 0x00003f80
    s_mov_b32 s47, 0x3f800000
    s_waitcnt vmcnt(6)
    v_dot2_f32_bf16 v16, v64, s46, 0
    v_dot2_f32_bf16 v17, v64, s47, 0
    v_dot2_f32_bf16 v18, v65, s46, 0
    v_dot2_f32_bf16 v19, v65, s47, 0
    s_waitcnt vmcnt(4)
    v_dot2_f32_bf16 v16, v66, s46, v16
    v_dot2_f32_bf16 v17, v66, s47, v17
    v_dot2_f32_bf16 v18, v67, s46, v18
    v_dot2_f32_bf16 v19, v67, s47, v19
    v_add_f32 v20, v56, v57
    s_waitcnt vmcnt(2)
    v_dot2_f32_bf16 v16, v68, s46, v16
    v_dot2_f32_bf16 v17, v68, s47, v17
    v_dot2_f32_bf16 v18, v69, s46, v18
    v_dot2_f32_bf16 v19, v69, s47, v19
    v_add_f32 v20, v20, v58
    s_waitcnt vmcnt(0)
    v_dot2_f32_bf16 v16, v70, s46, v16
    v_dot2_f32_bf16 v17, v70, s47, v17
    v_dot2_f32_bf16 v18, v71, s46, v18
    v_dot2_f32_bf16 v19, v71, s47, v19
    v_add_f32 v20, v20, v59
    s_nop 0
    v_cmp_u_f32 s[46:47], v16, v17
    v_cmp_u_f32 s[48:49], v18, v19
    v_cmp_u_f32 vcc, v20, v20
    v_max3_f32 v10, v16, v17, v18
    s_or_b64 s[46:47], s[46:47], s[48:49]
    v_max3_f32 v10, v10, v19, v20
    s_or_b64 vcc, vcc, s[46:47]
    s_cbranch_scc1 L_s_xf_212
L_s_xok_213:
    v_max_f32_dpp v11, v10, v10 row_ror:8 row_mask:0xf bank_mask:0xf
    v_max_f32_dpp v10, v10, v10 row_ror:8 row_mask:0xf bank_mask:0xf
    s_nop 1
    v_permlane16_swap_b32 v10, v11
    v_max_f32 v12, v10, v11
    v_max_f32 v10, v10, v11
    s_nop 1
    v_permlane32_swap_b32 v10, v12
    v_max_f32 v10, v10, v12
    v_mul_f32 v10, s66, v10
    v_fma_f32 v16, v16, s66, -v10
    v_fma_f32 v17, v17, s66, -v10
    v_fma_f32 v18, v18, s66, -v10
    v_fma_f32 v19, v19, s66, -v10
    v_fma_f32 v20, v20, s66, -v10
    v_exp_f32 v16, v16
    v_exp_f32 v17, v17
    v_exp_f32 v18, v18
    v_exp_f32 v19, v19
    v_exp_f32 v20, v20
    v_add_f32 v10, v16, v17
    v_add_f32 v11, v18, v19
    v_add_f32 v10, v10, v20
    v_add_f32 v10, v10, v11
    s_nop 1
    v_add_f32_dpp v11, v10, v10 row_ror:8 row_mask:0xf bank_mask:0xf
    v_add_f32_dpp v10, v10, v10 row_ror:8 row_mask:0xf bank_mask:0xf
    s_nop 1
    v_permlane16_swap_b32 v10, v11
    v_add_f32 v12, v10, v11
    v_add_f32 v10, v10, v11
    s_nop 1
    v_permlane32_swap_b32 v10, v12
    v_add_f32 v10, v10, v12
    v_rcp_f32 v10, v10
    s_nop 0
    v_mul_f32 v16, v16, v10
    v_mul_f32 v17, v17, v10
    v_mul_f32 v18, v18, v10
    v_mul_f32 v19, v19, v10
    v_mul_f32 v20, v20, v10
    v_cvt_pk_bf16_f32 v16, v16, v17
    v_cvt_pk_bf16_f32 v17, v18, v19
    v_cvt_pk_bf16_f32 v18, v20, v20
    ds_write_b64 v8, v[16:17]
    ds_write_b16 v9, v18
    s_waitcnt lgkmcnt(0)
    s_barrier
    s_add_u32 s63, s63, 786432
    s_cmp_ge_u32 s44, 2
    s_cbranch_scc1 L_s_nk_214
    buffer_load_dwordx4 v[32:35], v6, s[12:15], s63 offen sc1
L_s_nk_214:
    s_add_u32 s45, s60, 2
    s_cmp_le_u32 s69, s45
    s_cbranch_scc1 L_s_nk_214_w
    s_add_u32 s45, s63, 786432
    s_mov_b64 exec, 0xf
    buffer_load_dword v15, v14, s[12:15], s45 offen sc1
    s_mov_b64 exec, -1
L_s_nk_214_w:
    s_cmp_eq_u32 s44, 3
    s_cbranch_scc1 L_s_nr_215
    s_xor_b32 s45, s61, 0x8000
    s_mov_b64 exec, s[50:51]
    buffer_store_dwordx2 v[24:25], v4, s[12:15], s45 offen
    s_mov_b64 exec, -1
L_s_nr_215:
    s_cmp_lg_u32 s44, 3
    s_cbranch_scc1 L_s_np_216
    ds_read_b128 v[20:23], v6
    s_lshl_b32 s45, s60, 17
    s_add_u32 s45, s45, s67
    s_waitcnt lgkmcnt(0)
    v_min_u32 v20, -2, v20
    v_min_u32 v21, -2, v21
    v_min_u32 v22, -2, v22
    v_min_u32 v23, -2, v23
    buffer_store_dwordx4 v[20:23], v2, s[12:15], s45 offen sc1
L_s_np_216:
    s_add_u32 s68, s60, 2
    s_min_u32 s68, s68, 63
    v_readlane_b32 s45, v0, 0
    v_readlane_b32 s46, v0, 1
    s_nop 0
    s_min_u32 s45, s45, s46
    s_max_u32 s69, s69, s45
    s_cmp_gt_u32 s69, s68
    s_cbranch_scc1 L_kv_ok_219
    s_mov_b32 s70, 0
L_kv_lp_218:
    v_and_b32 v22, 1, v1
    v_lshlrev_b32 v22, 9, v22
    buffer_load_dword v23, v22, s[12:15], s57 offen sc1
    s_waitcnt vmcnt(0)
    v_readlane_b32 s69, v23, 0
    v_readlane_b32 s45, v23, 1
    s_add_u32 s70, s70, 1
    s_nop 2
    s_min_u32 s69, s69, s45
    s_cmp_gt_u32 s69, s68
    s_cbranch_scc1 L_kv_ok_219
    s_sleep 4
    s_cmp_lt_u32 s70, 524288
    s_cbranch_scc1 L_kv_lp_218
    s_branch L_c_done_1
L_kv_ok_219:
    s_add_u32 s45, s60, 7
    s_min_u32 s45, s45, 63
    s_cmp_gt_u32 s69, s45
    s_cbranch_scc1 L_s_na_217
    v_and_b32 v22, 1, v1
    v_lshlrev_b32 v22, 9, v22
    buffer_load_dword v0, v22, s[12:15], s57 offen sc1
L_s_na_217:
    s_sub_u32 s45, s60, 4
    s_cmp_gt_u32 s45, 24
    s_cbranch_scc1 L_s_xe_220
    s_sleep 1
    s_setprio 0
    s_bitcmp1_b32 s45, 0
    s_cbranch_scc1 L_s_x1_221
    s_cmp_eq_u32 s45, 0
    s_cbranch_scc1 L_s_x0_222
    s_bitcmp1_b32 s44, 0
    s_cbranch_scc1 L_s_x0_222
    ds_read_b128 v[40:43], v31
    s_sub_u32 s46, s45, 2
    s_lshr_b32 s47, s46, 2
    s_mul_i32 s47, s47, 786432
    s_and_b32 s46, s46, 2
    s_lshl_b32 s46, s46, 11
    s_add_u32 s47, s47, s46
    s_waitcnt lgkmcnt(0)
    buffer_store_dwordx4 v[40:43], v13, s[12:15], s47 offen sc1
L_s_x0_222:
    s_cmp_eq_u32 s45, 24
    s_cbranch_scc1 L_s_xe_220
    ds_read_b128 v[64:67], v44 offset:0
    ds_read_b128 v[68:71], v44 offset:1024
    ds_read_b128 v[72:75], v44 offset:2048
    ds_read_b128 v[76:79], v44 offset:3072
    ds_read_b128 v[80:83], v44 offset:4096
    ds_read_b128 v[84:87], v44 offset:5120
    ds_read_b128 v[88:91], v44 offset:6144
    ds_read_b128 v[92:95], v44 offset:7168
    ds_read_b128 v[96:99], v44 offset:8192
    ds_read_b128 v[100:103], v44 offset:9216
    ds_read_b128 v[104:107], v44 offset:10240
    ds_read_b128 v[108:111], v44 offset:11264
    s_waitcnt lgkmcnt(11)
    v_mfma_f32_16x16x32_bf16 v[36:39], a[0:3], v[64:67], 0
    ds_read_b128 v[112:115], v44 offset:12288
    s_waitcnt lgkmcnt(11)
    v_mfma_f32_16x16x32_bf16 v[36:39], a[4:7], v[68:71], v[36:39]
    ds_read_b128 v[116:119], v44 offset:13312
    s_waitcnt lgkmcnt(11)
    v_mfma_f32_16x16x32_bf16 v[36:39], a[8:11], v[72:75], v[36:39]
    ds_read_b128 v[120:123], v44 offset:14336
    s_waitcnt lgkmcnt(11)
    v_mfma_f32_16x16x32_bf16 v[36:39], a[12:15], v[76:79], v[36:39]
    ds_read_b128 v[124:127], v44 offset:15360
    s_waitcnt lgkmcnt(11)
    v_mfma_f32_16x16x32_bf16 v[36:39], a[16:19], v[80:83], v[36:39]
    s_waitcnt lgkmcnt(10)
    v_mfma_f32_16x16x32_bf16 v[36:39], a[20:23], v[84:87], v[36:39]
    s_waitcnt lgkmcnt(9)
    v_mfma_f32_16x16x32_bf16 v[36:39], a[24:27], v[88:91], v[36:39]
    s_waitcnt lgkmcnt(8)
    v_mfma_f32_16x16x32_bf16 v[36:39], a[28:31], v[92:95], v[36:39]
    s_waitcnt lgkmcnt(7)
    v_mfma_f32_16x16x32_bf16 v[36:39], a[32:35], v[96:99], v[36:39]
    s_waitcnt lgkmcnt(6)
    v_mfma_f32_16x16x32_bf16 v[36:39], a[36:39], v[100:103], v[36:39]
    s_waitcnt lgkmcnt(5)
    v_mfma_f32_16x16x32_bf16 v[36:39], a[40:43], v[104:107], v[36:39]
    s_waitcnt lgkmcnt(4)
    v_mfma_f32_16x16x32_bf16 v[36:39], a[44:47], v[108:111], v[36:39]
    s_waitcnt lgkmcnt(3)
    v_mfma_f32_16x16x32_bf16 v[36:39], a[48:51], v[112:115], v[36:39]
    s_waitcnt lgkmcnt(2)
    v_mfma_f32_16x16x32_bf16 v[36:39], a[52:55], v[116:119], v[36:39]
    s_waitcnt lgkmcnt(1)
    v_mfma_f32_16x16x32_bf16 v[36:39], a[56:59], v[120:123], v[36:39]
    s_waitcnt lgkmcnt(0)
    v_mfma_f32_16x16x32_bf16 v[36:39], a[60:63], v[124:127], v[36:39]
    s_branch L_s_xe_220
L_s_x1_221:
    ds_read_b128 v[64:67], v44 offset:16384
    ds_read_b128 v[68:71], v44 offset:17408
    ds_read_b128 v[72:75], v44 offset:18432
    ds_read_b128 v[76:79], v44 offset:19456
    ds_read_b128 v[80:83], v44 offset:20480
    ds_read_b128 v[84:87], v44 offset:21504
    ds_read_b128 v[88:91], v44 offset:22528
    ds_read_b128 v[92:95], v44 offset:23552
    ds_read_b128 v[96:99], v44 offset:24576
    ds_read_b128 v[100:103], v44 offset:25600
    ds_read_b128 v[104:107], v44 offset:26624
    ds_read_b128 v[108:111], v44 offset:27648
    s_waitcnt lgkmcnt(11)
    v_mfma_f32_16x16x32_bf16 v[36:39], a[64:67], v[64:67], v[36:39]
    ds_read_b128 v[112:115], v44 offset:28672
    s_waitcnt lgkmcnt(11)
    v_mfma_f32_16x16x32_bf16 v[36:39], a[68:71], v[68:71], v[36:39]
    ds_read_b128 v[116:119], v44 offset:29696
    s_waitcnt lgkmcnt(11)
    v_mfma_f32_16x16x32_bf16 v[36:39], a[72:75], v[72:75], v[36:39]
    ds_read_b128 v[120:123], v44 offset:30720
    s_waitcnt lgkmcnt(11)
    v_mfma_f32_16x16x32_bf16 v[36:39], a[76:79], v[76:79], v[36:39]
    ds_read_b128 v[124:127], v44 offset:31744
    s_waitcnt lgkmcnt(11)
    v_mfma_f32_16x16x32_bf16 v[36:39], a[80:83], v[80:83], v[36:39]
    s_waitcnt lgkmcnt(10)
    v_mfma_f32_16x16x32_bf16 v[36:39], a[84:87], v[84:87], v[36:39]
    s_waitcnt lgkmcnt(9)
    v_mfma_f32_16x16x32_bf16 v[36:39], a[88:91], v[88:91], v[36:39]
    s_waitcnt lgkmcnt(8)
    v_mfma_f32_16x16x32_bf16 v[36:39], a[92:95], v[92:95], v[36:39]
    s_waitcnt lgkmcnt(7)
    v_mfma_f32_16x16x32_bf16 v[36:39], a[96:99], v[96:99], v[36:39]
    s_waitcnt lgkmcnt(6)
    v_mfma_f32_16x16x32_bf16 v[36:39], a[100:103], v[100:103], v[36:39]
    s_waitcnt lgkmcnt(5)
    v_mfma_f32_16x16x32_bf16 v[36:39], a[104:107], v[104:107], v[36:39]
    s_waitcnt lgkmcnt(4)
    v_mfma_f32_16x16x32_bf16 v[36:39], a[108:111], v[108:111], v[36:39]
    s_waitcnt lgkmcnt(3)
    v_mfma_f32_16x16x32_bf16 v[36:39], a[112:115], v[112:115], v[36:39]
    s_waitcnt lgkmcnt(2)
    v_mfma_f32_16x16x32_bf16 v[36:39], a[116:119], v[116:119], v[36:39]
    s_waitcnt lgkmcnt(1)
    v_mfma_f32_16x16x32_bf16 v[36:39], a[120:123], v[120:123], v[36:39]
    s_waitcnt lgkmcnt(0)
    v_mfma_f32_16x16x32_bf16 v[36:39], a[124:127], v[124:127], v[36:39]
    s_nop 7
    v_cvt_pk_bf16_f32 v40, v36, v37
    v_cvt_pk_bf16_f32 v41, v38, v39
    ds_write_b64 v45, v[40:41]
    s_waitcnt lgkmcnt(0)
L_s_xe_220:
    s_setprio 1
    s_add_u32 s60, s60, 1
    s_add_u32 s61, s61, 0x4000
    s_and_b32 s61, s61, 0xffff
    s_branch L_s_loop_204
L_s_last_205:
    s_waitcnt lgkmcnt(0)
    s_barrier
    s_cmp_lg_u32 s44, 3
    s_cbranch_scc1 L_s_np_223
    ds_read_b128 v[20:23], v6
    s_lshl_b32 s45, s60, 17
    s_add_u32 s45, s45, s67
    s_waitcnt lgkmcnt(0)
    v_min_u32 v20, -2, v20
    v_min_u32 v21, -2, v21
    v_min_u32 v22, -2, v22
    v_min_u32 v23, -2, v23
    buffer_store_dwordx4 v[20:23], v2, s[12:15], s45 offen sc1
L_s_np_223:
    s_branch L_replica
L_rt_199:
    s_add_u32 s70, s70, 1
    s_cmp_lt_u32 s70, 524288
    s_cbranch_scc1 L_c_rp_198
    s_branch L_c_done_1
L_rt_209:
    s_add_u32 s70, s70, 1
    s_cmp_lt_u32 s70, 524288
    s_cbranch_scc1 L_s_xl_206
    s_branch L_c_done_1
L_s_w2_207:
    s_cmp_eq_u32 s44, 3
    s_cbranch_scc1 L_s_w3_208
    s_waitcnt lgkmcnt(0)
    v_mfma_f32_16x16x32_bf16 v[16:19], v[64:67], v[64:67], 0
    s_branch L_s_w2_207_b
L_s_w3_208:
    s_sleep 3
    s_branch L_s_w3_208_b
L_s_xf_212:
    v_or_b32 v72, 0xffff, v56
    v_or_b32 v73, 0xffff, v57
    v_or_b32 v74, 0xffff, v58
    v_or_b32 v75, 0xffff, v59
    v_max3_u32 v11, v64, v65, v66
    v_max3_u32 v11, v11, v67, v68
    v_max3_u32 v11, v11, v69, v70
    v_max3_u32 v11, v11, v71, v72
    v_max3_u32 v11, v11, v73, v74
    v_max_u32 v11, v11, v75
    v_cmp_eq_u32 vcc, -1, v11
    s_add_u32 s70, s70, 1
    s_cbranch_vccz L_s_xok_213
    s_cmp_lt_u32 s70, 524288
    s_cbranch_scc1 L_s_xp_211
    s_branch L_c_done_1
L_ss_201:
.p2align 6
L_s_loop_224:
    v_mov_b32 v16, 0
    v_mov_b32 v17, 0
    v_mov_b32 v18, 0
    v_mov_b32 v19, 0
    s_add_u32 s58, s58, 4
    s_mov_b32 s70, 1
    s_waitcnt vmcnt(0) lgkmcnt(0)
    s_barrier
    ds_read_b128 v[64:67], v2 offset:0
    ds_read_b128 v[68:71], v2 offset:1024
    ds_read_b128 v[72:75], v2 offset:2048
    ds_read_b128 v[76:79], v2 offset:3072
    ds_read_b128 v[80:83], v2 offset:4096
    ds_read_b128 v[84:87], v2 offset:5120
    ds_read_b128 v[88:91], v2 offset:6144
    ds_read_b128 v[92:95], v2 offset:7168
    ds_read_b128 v[96:99], v2 offset:8192
    ds_read_b128 v[100:103], v2 offset:9216
    ds_read_b128 v[104:107], v2 offset:10240
    ds_read_b128 v[108:111], v2 offset:11264
    s_waitcnt lgkmcnt(11)
    v_smfmac_f32_16x16x64_bf16 v[16:19], v[64:67], a[0:7], v3
    ds_read_b128 v[112:115], v2 offset:12288
    s_waitcnt lgkmcnt(11)
    v_smfmac_f32_16x16x64_bf16 v[16:19], v[68:71], a[8:15], v3
    ds_read_b128 v[116:119], v2 offset:13312
    s_waitcnt lgkmcnt(11)
    v_smfmac_f32_16x16x64_bf16 v[16:19], v[72:75], a[16:23], v3
    ds_read_b128 v[120:123], v2 offset:14336
    s_waitcnt lgkmcnt(11)
    v_smfmac_f32_16x16x64_bf16 v[16:19], v[76:79], a[24:31], v3
    ds_read_b128 v[124:127], v2 offset:15360
    s_waitcnt lgkmcnt(11)
    v_smfmac_f32_16x16x64_bf16 v[16:19], v[80:83], a[32:39], v3
    s_waitcnt lgkmcnt(10)
    v_smfmac_f32_16x16x64_bf16 v[16:19], v[84:87], a[40:47], v3
    s_waitcnt lgkmcnt(9)
    v_smfmac_f32_16x16x64_bf16 v[16:19], v[88:91], a[48:55], v3
    s_waitcnt lgkmcnt(8)
    v_smfmac_f32_16x16x64_bf16 v[16:19], v[92:95], a[56:63], v3
    s_waitcnt lgkmcnt(7)
    v_smfmac_f32_16x16x64_bf16 v[16:19], v[96:99], a[64:71], v3
    s_waitcnt lgkmcnt(6)
    v_smfmac_f32_16x16x64_bf16 v[16:19], v[100:103], a[72:79], v3
    s_waitcnt lgkmcnt(5)
    v_smfmac_f32_16x16x64_bf16 v[16:19], v[104:107], a[80:87], v3
    s_waitcnt lgkmcnt(4)
    v_smfmac_f32_16x16x64_bf16 v[16:19], v[108:111], a[88:95], v3
    s_waitcnt lgkmcnt(3)
    v_smfmac_f32_16x16x64_bf16 v[16:19], v[112:115], a[96:103], v3
    s_waitcnt lgkmcnt(2)
    v_smfmac_f32_16x16x64_bf16 v[16:19], v[116:119], a[104:111], v3
    s_waitcnt lgkmcnt(1)
    v_smfmac_f32_16x16x64_bf16 v[16:19], v[120:123], a[112:119], v3
    s_waitcnt lgkmcnt(0)
    v_smfmac_f32_16x16x64_bf16 v[16:19], v[124:127], a[120:127], v3
    s_nop 7
    v_permlane32_swap_b32 v16, v18
    v_permlane32_swap_b32 v17, v19
    v_add_f32 v16, v16, v18
    v_add_f32 v17, v17, v19
    v_cvt_pk_bf16_f32 v16, v16, v17
    ds_write_b16 v5, v16
    ds_write_b16_d16_hi v5, v16 offset:16
    s_mov_b64 exec, 1
    ds_add_u32 v29, v30
    s_mov_b64 exec, -1
L_s_xl_226:
    ds_read_b32 v10, v29
    ds_read_b128 v[64:67], v2 offset:61440
    s_cmp_eq_u32 s60, 63
    s_cbranch_scc1 L_s_last_225
    s_cmp_ge_u32 s44, 2
    s_cbranch_scc1 L_s_w2_227
    s_waitcnt lgkmcnt(0)
    v_mfma_f32_16x16x32_bf16 v[16:19], v[32:35], v[64:67], 0
L_s_w2_227_b:
    v_cmp_ne_u32 vcc, s58, v10
    s_nop 0
    s_cbranch_vccnz L_rt_229
    s_mov_b64 exec, s[50:51]
    s_nop 3
    v_cvt_pk_bf16_f32 v16, v16, v17
    v_cvt_pk_bf16_f32 v17, v18, v19
    v_pk_min_u16 v16, v16, v54
    v_pk_min_u16 v17, v17, v54
    buffer_store_dwordx2 v[16:17], v4, s[12:15], s61 offen sc1
    s_mov_b64 exec, -1
L_s_w3_228_b:
    s_sleep 5
    s_mov_b32 s70, 1
L_s_xp_231:
    buffer_load_dwordx2 v[64:65], v7, s[12:15], s61 offen offset:0 sc1
    buffer_load_short_d16_hi v56, v28, s[12:15], s61 offen offset:0 sc1
    buffer_load_dwordx2 v[66:67], v7, s[12:15], s61 offen offset:512 sc1
    buffer_load_short_d16_hi v57, v28, s[12:15], s61 offen offset:128 sc1
    buffer_load_dwordx2 v[68:69], v7, s[12:15], s61 offen offset:1024 sc1
    buffer_load_short_d16_hi v58, v28, s[12:15], s61 offen offset:256 sc1
    buffer_load_dwordx2 v[70:71], v7, s[12:15], s61 offen offset:1536 sc1
    buffer_load_short_d16_hi v59, v28, s[12:15], s61 offen offset:384 sc1
L_s_xc_230_b:
    s_mov_b32 s46, 0x00003f80
    s_mov_b32 s47, 0x3f800000
    s_waitcnt vmcnt(6)
    v_dot2_f32_bf16 v16, v64, s46, 0
    v_dot2_f32_bf16 v17, v64, s47, 0
    v_dot2_f32_bf16 v18, v65, s46, 0
    v_dot2_f32_bf16 v19, v65, s47, 0
    s_waitcnt vmcnt(4)
    v_dot2_f32_bf16 v16, v66, s46, v16
    v_dot2_f32_bf16 v17, v66, s47, v17
    v_dot2_f32_bf16 v18, v67, s46, v18
    v_dot2_f32_bf16 v19, v67, s47, v19
    v_add_f32 v20, v56, v57
    s_waitcnt vmcnt(2)
    v_dot2_f32_bf16 v16, v68, s46, v16
    v_dot2_f32_bf16 v17, v68, s47, v17
    v_dot2_f32_bf16 v18, v69, s46, v18
    v_dot2_f32_bf16 v19, v69, s47, v19
    v_add_f32 v20, v20, v58
    s_waitcnt vmcnt(0)
    v_dot2_f32_bf16 v16, v70, s46, v16
    v_dot2_f32_bf16 v17, v70, s47, v17
    v_dot2_f32_bf16 v18, v71, s46, v18
    v_dot2_f32_bf16 v19, v71, s47, v19
    v_add_f32 v20, v20, v59
    s_nop 0
    v_cmp_u_f32 s[46:47], v16, v17
    v_cmp_u_f32 s[48:49], v18, v19
    v_cmp_u_f32 vcc, v20, v20
    v_max3_f32 v10, v16, v17, v18
    s_or_b64 s[46:47], s[46:47], s[48:49]
    v_max3_f32 v10, v10, v19, v20
    s_or_b64 vcc, vcc, s[46:47]
    s_cbranch_scc1 L_s_xf_232
L_s_xok_233:
    v_max_f32_dpp v11, v10, v10 row_ror:8 row_mask:0xf bank_mask:0xf
    v_max_f32_dpp v10, v10, v10 row_ror:8 row_mask:0xf bank_mask:0xf
    s_nop 1
    v_permlane16_swap_b32 v10, v11
    v_max_f32 v12, v10, v11
    v_max_f32 v10, v10, v11
    s_nop 1
    v_permlane32_swap_b32 v10, v12
    v_max_f32 v10, v10, v12
    v_mul_f32 v10, s66, v10
    v_fma_f32 v16, v16, s66, -v10
    v_fma_f32 v17, v17, s66, -v10
    v_fma_f32 v18, v18, s66, -v10
    v_fma_f32 v19, v19, s66, -v10
    v_fma_f32 v20, v20, s66, -v10
    v_exp_f32 v16, v16
    v_exp_f32 v17, v17
    v_exp_f32 v18, v18
    v_exp_f32 v19, v19
    v_exp_f32 v20, v20
    v_add_f32 v10, v16, v17
    v_add_f32 v11, v18, v19
    v_add_f32 v10, v10, v20
    v_add_f32 v10, v10, v11
    s_nop 1
    v_add_f32_dpp v11, v10, v10 row_ror:8 row_mask:0xf bank_mask:0xf
    v_add_f32_dpp v10, v10, v10 row_ror:8 row_mask:0xf bank_mask:0xf
    s_nop 1
    v_permlane16_swap_b32 v10, v11
    v_add_f32 v12, v10, v11
    v_add_f32 v10, v10, v11
    s_nop 1
    v_permlane32_swap_b32 v10, v12
    v_add_f32 v10, v10, v12
    v_rcp_f32 v10, v10
    s_nop 0
    v_mul_f32 v16, v16, v10
    v_mul_f32 v17, v17, v10
    v_mul_f32 v18, v18, v10
    v_mul_f32 v19, v19, v10
    v_mul_f32 v20, v20, v10
    v_cvt_pk_bf16_f32 v16, v16, v17
    v_cvt_pk_bf16_f32 v17, v18, v19
    v_cvt_pk_bf16_f32 v18, v20, v20
    ds_write_b64 v8, v[16:17]
    ds_write_b16 v9, v18
    s_waitcnt lgkmcnt(0)
    s_barrier
    s_add_u32 s63, s63, 786432
    s_cmp_ge_u32 s44, 2
    s_cbranch_scc1 L_s_nk_234
    buffer_load_dwordx4 v[32:35], v6, s[12:15], s63 offen sc1
L_s_nk_234:
    s_add_u32 s45, s60, 2
    s_cmp_le_u32 s69, s45
    s_cbranch_scc1 L_s_nk_234_w
    s_add_u32 s45, s63, 786432
    s_mov_b64 exec, 0xf
    buffer_load_dword v15, v14, s[12:15], s45 offen sc1
    s_mov_b64 exec, -1
L_s_nk_234_w:
    s_cmp_eq_u32 s44, 3
    s_cbranch_scc1 L_s_nr_235
    s_xor_b32 s45, s61, 0x8000
    s_mov_b64 exec, s[50:51]
    buffer_store_dwordx2 v[24:25], v4, s[12:15], s45 offen sc1
    s_mov_b64 exec, -1
L_s_nr_235:
    s_cmp_lg_u32 s44, 3
    s_cbranch_scc1 L_s_np_236
    ds_read_b128 v[20:23], v6
    s_lshl_b32 s45, s60, 17
    s_add_u32 s45, s45, s67
    s_waitcnt lgkmcnt(0)
    v_min_u32 v20, -2, v20
    v_min_u32 v21, -2, v21
    v_min_u32 v22, -2, v22
    v_min_u32 v23, -2, v23
    buffer_store_dwordx4 v[20:23], v2, s[12:15], s45 offen sc1
L_s_np_236:
    s_add_u32 s68, s60, 2
    s_min_u32 s68, s68, 63
    v_readlane_b32 s45, v0, 0
    v_readlane_b32 s46, v0, 1
    s_nop 0
    s_min_u32 s45, s45, s46
    s_max_u32 s69, s69, s45
    s_cmp_gt_u32 s69, s68
    s_cbranch_scc1 L_kv_ok_239
    s_mov_b32 s70, 0
L_kv_lp_238:
    v_and_b32 v22, 1, v1
    v_lshlrev_b32 v22, 9, v22
    buffer_load_dword v23, v22, s[12:15], s57 offen sc1
    s_waitcnt vmcnt(0)
    v_readlane_b32 s69, v23, 0
    v_readlane_b32 s45, v23, 1
    s_add_u32 s70, s70, 1
    s_nop 2
    s_min_u32 s69, s69, s45
    s_cmp_gt_u32 s69, s68
    s_cbranch_scc1 L_kv_ok_239
    s_sleep 4
    s_cmp_lt_u32 s70, 524288
    s_cbranch_scc1 L_kv_lp_238
    s_branch L_c_done_1
L_kv_ok_239:
    s_add_u32 s45, s60, 7
    s_min_u32 s45, s45, 63
    s_cmp_gt_u32 s69, s45
    s_cbranch_scc1 L_s_na_237
    v_and_b32 v22, 1, v1
    v_lshlrev_b32 v22, 9, v22
    buffer_load_dword v0, v22, s[12:15], s57 offen sc1
L_s_na_237:
    s_sub_u32 s45, s60, 4
    s_cmp_gt_u32 s45, 24
    s_cbranch_scc1 L_s_xe_240
    s_sleep 1
    s_setprio 0
    s_bitcmp1_b32 s45, 0
    s_cbranch_scc1 L_s_x1_241
    s_cmp_eq_u32 s45, 0
    s_cbranch_scc1 L_s_x0_242
    s_bitcmp1_b32 s44, 0
    s_cbranch_scc1 L_s_x0_242
    ds_read_b128 v[40:43], v31
    s_sub_u32 s46, s45, 2
    s_lshr_b32 s47, s46, 2
    s_mul_i32 s47, s47, 786432
    s_and_b32 s46, s46, 2
    s_lshl_b32 s46, s46, 11
    s_add_u32 s47, s47, s46
    s_waitcnt lgkmcnt(0)
    buffer_store_dwordx4 v[40:43], v13, s[12:15], s47 offen sc1
L_s_x0_242:
    s_cmp_eq_u32 s45, 24
    s_cbranch_scc1 L_s_xe_240
    ds_read_b128 v[64:67], v44 offset:0
    ds_read_b128 v[68:71], v44 offset:1024
    ds_read_b128 v[72:75], v44 offset:2048
    ds_read_b128 v[76:79], v44 offset:3072
    ds_read_b128 v[80:83], v44 offset:4096
    ds_read_b128 v[84:87], v44 offset:5120
    ds_read_b128 v[88:91], v44 offset:6144
    ds_read_b128 v[92:95], v44 offset:7168
    ds_read_b128 v[96:99], v44 offset:8192
    ds_read_b128 v[100:103], v44 offset:9216
    ds_read_b128 v[104:107], v44 offset:10240
    ds_read_b128 v[108:111], v44 offset:11264
    s_waitcnt lgkmcnt(11)
    v_mfma_f32_16x16x32_bf16 v[36:39], a[0:3], v[64:67], 0
    ds_read_b128 v[112:115], v44 offset:12288
    s_waitcnt lgkmcnt(11)
    v_mfma_f32_16x16x32_bf16 v[36:39], a[4:7], v[68:71], v[36:39]
    ds_read_b128 v[116:119], v44 offset:13312
    s_waitcnt lgkmcnt(11)
    v_mfma_f32_16x16x32_bf16 v[36:39], a[8:11], v[72:75], v[36:39]
    ds_read_b128 v[120:123], v44 offset:14336
    s_waitcnt lgkmcnt(11)
    v_mfma_f32_16x16x32_bf16 v[36:39], a[12:15], v[76:79], v[36:39]
    ds_read_b128 v[124:127], v44 offset:15360
    s_waitcnt lgkmcnt(11)
    v_mfma_f32_16x16x32_bf16 v[36:39], a[16:19], v[80:83], v[36:39]
    s_waitcnt lgkmcnt(10)
    v_mfma_f32_16x16x32_bf16 v[36:39], a[20:23], v[84:87], v[36:39]
    s_waitcnt lgkmcnt(9)
    v_mfma_f32_16x16x32_bf16 v[36:39], a[24:27], v[88:91], v[36:39]
    s_waitcnt lgkmcnt(8)
    v_mfma_f32_16x16x32_bf16 v[36:39], a[28:31], v[92:95], v[36:39]
    s_waitcnt lgkmcnt(7)
    v_mfma_f32_16x16x32_bf16 v[36:39], a[32:35], v[96:99], v[36:39]
    s_waitcnt lgkmcnt(6)
    v_mfma_f32_16x16x32_bf16 v[36:39], a[36:39], v[100:103], v[36:39]
    s_waitcnt lgkmcnt(5)
    v_mfma_f32_16x16x32_bf16 v[36:39], a[40:43], v[104:107], v[36:39]
    s_waitcnt lgkmcnt(4)
    v_mfma_f32_16x16x32_bf16 v[36:39], a[44:47], v[108:111], v[36:39]
    s_waitcnt lgkmcnt(3)
    v_mfma_f32_16x16x32_bf16 v[36:39], a[48:51], v[112:115], v[36:39]
    s_waitcnt lgkmcnt(2)
    v_mfma_f32_16x16x32_bf16 v[36:39], a[52:55], v[116:119], v[36:39]
    s_waitcnt lgkmcnt(1)
    v_mfma_f32_16x16x32_bf16 v[36:39], a[56:59], v[120:123], v[36:39]
    s_waitcnt lgkmcnt(0)
    v_mfma_f32_16x16x32_bf16 v[36:39], a[60:63], v[124:127], v[36:39]
    s_branch L_s_xe_240
L_s_x1_241:
    ds_read_b128 v[64:67], v44 offset:16384
    ds_read_b128 v[68:71], v44 offset:17408
    ds_read_b128 v[72:75], v44 offset:18432
    ds_read_b128 v[76:79], v44 offset:19456
    ds_read_b128 v[80:83], v44 offset:20480
    ds_read_b128 v[84:87], v44 offset:21504
    ds_read_b128 v[88:91], v44 offset:22528
    ds_read_b128 v[92:95], v44 offset:23552
    ds_read_b128 v[96:99], v44 offset:24576
    ds_read_b128 v[100:103], v44 offset:25600
    ds_read_b128 v[104:107], v44 offset:26624
    ds_read_b128 v[108:111], v44 offset:27648
    s_waitcnt lgkmcnt(11)
    v_mfma_f32_16x16x32_bf16 v[36:39], a[64:67], v[64:67], v[36:39]
    ds_read_b128 v[112:115], v44 offset:28672
    s_waitcnt lgkmcnt(11)
    v_mfma_f32_16x16x32_bf16 v[36:39], a[68:71], v[68:71], v[36:39]
    ds_read_b128 v[116:119], v44 offset:29696
    s_waitcnt lgkmcnt(11)
    v_mfma_f32_16x16x32_bf16 v[36:39], a[72:75], v[72:75], v[36:39]
    ds_read_b128 v[120:123], v44 offset:30720
    s_waitcnt lgkmcnt(11)
    v_mfma_f32_16x16x32_bf16 v[36:39], a[76:79], v[76:79], v[36:39]
    ds_read_b128 v[124:127], v44 offset:31744
    s_waitcnt lgkmcnt(11)
    v_mfma_f32_16x16x32_bf16 v[36:39], a[80:83], v[80:83], v[36:39]
    s_waitcnt lgkmcnt(10)
    v_mfma_f32_16x16x32_bf16 v[36:39], a[84:87], v[84:87], v[36:39]
    s_waitcnt lgkmcnt(9)
    v_mfma_f32_16x16x32_bf16 v[36:39], a[88:91], v[88:91], v[36:39]
    s_waitcnt lgkmcnt(8)
    v_mfma_f32_16x16x32_bf16 v[36:39], a[92:95], v[92:95], v[36:39]
    s_waitcnt lgkmcnt(7)
    v_mfma_f32_16x16x32_bf16 v[36:39], a[96:99], v[96:99], v[36:39]
    s_waitcnt lgkmcnt(6)
    v_mfma_f32_16x16x32_bf16 v[36:39], a[100:103], v[100:103], v[36:39]
    s_waitcnt lgkmcnt(5)
    v_mfma_f32_16x16x32_bf16 v[36:39], a[104:107], v[104:107], v[36:39]
    s_waitcnt lgkmcnt(4)
    v_mfma_f32_16x16x32_bf16 v[36:39], a[108:111], v[108:111], v[36:39]
    s_waitcnt lgkmcnt(3)
    v_mfma_f32_16x16x32_bf16 v[36:39], a[112:115], v[112:115], v[36:39]
    s_waitcnt lgkmcnt(2)
    v_mfma_f32_16x16x32_bf16 v[36:39], a[116:119], v[116:119], v[36:39]
    s_waitcnt lgkmcnt(1)
    v_mfma_f32_16x16x32_bf16 v[36:39], a[120:123], v[120:123], v[36:39]
    s_waitcnt lgkmcnt(0)
    v_mfma_f32_16x16x32_bf16 v[36:39], a[124:127], v[124:127], v[36:39]
    s_nop 7
    v_cvt_pk_bf16_f32 v40, v36, v37
    v_cvt_pk_bf16_f32 v41, v38, v39
    ds_write_b64 v45, v[40:41]
    s_waitcnt lgkmcnt(0)
L_s_xe_240:
    s_setprio 1
    s_add_u32 s60, s60, 1
    s_add_u32 s61, s61, 0x4000
    s_and_b32 s61, s61, 0xffff
    s_branch L_s_loop_224
L_s_last_225:
    s_waitcnt lgkmcnt(0)
    s_barrier
    s_cmp_lg_u32 s44, 3
    s_cbranch_scc1 L_s_np_243
    ds_read_b128 v[20:23], v6
    s_lshl_b32 s45, s60, 17
    s_add_u32 s45, s45, s67
    s_waitcnt lgkmcnt(0)
    v_min_u32 v20, -2, v20
    v_min_u32 v21, -2, v21
    v_min_u32 v22, -2, v22
    v_min_u32 v23, -2, v23
    buffer_store_dwordx4 v[20:23], v2, s[12:15], s45 offen sc1
L_s_np_243:
    s_branch L_replica
L_rt_229:
    s_add_u32 s70, s70, 1
    s_cmp_lt_u32 s70, 524288
    s_cbranch_scc1 L_s_xl_226
    s_branch L_c_done_1
L_s_w2_227:
    s_cmp_eq_u32 s44, 3
    s_cbranch_scc1 L_s_w3_228
    s_waitcnt lgkmcnt(0)
    v_mfma_f32_16x16x32_bf16 v[16:19], v[64:67], v[64:67], 0
    s_branch L_s_w2_227_b
L_s_w3_228:
    s_sleep 3
    s_branch L_s_w3_228_b
L_s_xf_232:
    v_or_b32 v72, 0xffff, v56
    v_or_b32 v73, 0xffff, v57
    v_or_b32 v74, 0xffff, v58
    v_or_b32 v75, 0xffff, v59
    v_max3_u32 v11, v64, v65, v66
    v_max3_u32 v11, v11, v67, v68
    v_max3_u32 v11, v11, v69, v70
    v_max3_u32 v11, v11, v71, v72
    v_max3_u32 v11, v11, v73, v74
    v_max_u32 v11, v11, v75
    v_cmp_eq_u32 vcc, -1, v11
    s_add_u32 s70, s70, 1
    s_cbranch_vccz L_s_xok_233
    s_cmp_lt_u32 s70, 524288
    s_cbranch_scc1 L_s_xp_231
    s_branch L_c_done_1
L_vf_202:
    s_cmp_eq_u32 s52, 0
    s_cbranch_scc1 L_vs_203
    s_mov_b32 s70, 1
    v_mov_b32 v16, 0
    v_mov_b32 v17, 0
    s_branch L_v_l1m_246
.p2align 6
L_v_loop_244:
    s_mov_b32 s70, 1
    buffer_load_dwordx4 v[64:67], v9, s[12:15], s61 offen offset:0 sc1
    buffer_load_dwordx4 v[68:71], v9, s[12:15], s61 offen offset:1024 sc1
    buffer_load_dwordx4 v[72:75], v9, s[12:15], s61 offen offset:2048 sc1
    buffer_load_dwordx4 v[76:79], v9, s[12:15], s61 offen offset:3072 sc1
    v_mov_b32 v16, 0
    v_mov_b32 v17, 0
    v_mov_b32 v18, 0
    v_mov_b32 v19, 0
    v_mov_b32 v20, 0
    v_mov_b32 v21, 0
    v_mov_b32 v22, 0
    v_mov_b32 v23, 0
L_v_l1m_246:
    s_waitcnt vmcnt(3)
    ds_write_b128 v10, v[64:67] offset:0
    v_max3_u32 v24, v64, v65, v66
    v_max_u32 v24, v24, v67
    v_cmp_eq_u32 s[48:49], -1, v24
    s_waitcnt vmcnt(2)
    ds_write_b128 v10, v[68:71] offset:1024
    v_max3_u32 v24, v68, v69, v70
    v_max_u32 v24, v24, v71
    v_cmp_eq_u32 s[50:51], -1, v24
    s_waitcnt vmcnt(1)
    ds_write_b128 v10, v[72:75] offset:2048
    v_max3_u32 v24, v72, v73, v74
    v_max_u32 v24, v24, v75
    v_cmp_eq_u32 s[52:53], -1, v24
    s_waitcnt vmcnt(0)
    ds_write_b128 v10, v[76:79] offset:3072
    v_max3_u32 v24, v76, v77, v78
    v_max_u32 v24, v24, v79
    v_cmp_eq_u32 s[54:55], -1, v24
    s_or_b64 s[46:47], s[48:49], s[50:51]
    s_or_b64 vcc, s[52:53], s[54:55]
    s_or_b64 vcc, vcc, s[46:47]
    s_cbranch_scc1 L_v_l1_245
L_v_l1ok_247:
    s_waitcnt lgkmcnt(0)
    s_barrier
    v_smfmac_f32_16x16x64_bf16 v[16:19], v[64:67], a[0:7], v3
    v_smfmac_f32_16x16x64_bf16 v[20:23], v[64:67], a[32:39], v3
    v_smfmac_f32_16x16x64_bf16 v[16:19], v[68:71], a[8:15], v3
    v_smfmac_f32_16x16x64_bf16 v[20:23], v[68:71], a[40:47], v3
    v_smfmac_f32_16x16x64_bf16 v[16:19], v[72:75], a[16:23], v3
    v_smfmac_f32_16x16x64_bf16 v[20:23], v[72:75], a[48:55], v3
    v_smfmac_f32_16x16x64_bf16 v[16:19], v[76:79], a[24:31], v3
    v_smfmac_f32_16x16x64_bf16 v[20:23], v[76:79], a[56:63], v3
    s_nop 6
    v_permlane32_swap_b32 v16, v18
    v_permlane32_swap_b32 v17, v19
    v_permlane32_swap_b32 v20, v22
    v_permlane32_swap_b32 v21, v23
    v_add_f32 v16, v16, v18
    v_add_f32 v17, v17, v19
    v_add_f32 v18, v20, v22
    v_add_f32 v19, v21, v23
    ds_write_b128 v14, v[16:19]
    s_mov_b64 exec, 1
    ds_add_u32 v29, v30
    s_mov_b64 exec, -1
    s_add_u32 s58, s58, 4
    s_bitcmp1_b32 s44, 0
    s_cbranch_scc1 L_v_k1_249_c
    s_mov_b32 s70, 0
L_v_rl_250:
    ds_read_b32 v24, v29
    ds_read_b64 v[16:17], v13 offset:0
    ds_read_b64 v[18:19], v13 offset:1024
    ds_read_b64 v[20:21], v13 offset:2048
    ds_read_b64 v[22:23], v13 offset:3072
    s_waitcnt lgkmcnt(2)
    v_cmp_ne_u32 vcc, s58, v24
    v_add_f32 v16, v16, v18
    v_add_f32 v17, v17, v19
    s_waitcnt lgkmcnt(0)
    s_cbranch_vccnz L_rt_251
    v_add_f32 v20, v20, v22
    v_add_f32 v21, v21, v23
    v_add_f32 v16, v16, v20
    v_add_f32 v17, v17, v21
    s_mov_b32 vcc_lo, 0x55555555
    s_mov_b32 vcc_hi, 0x55555555
    v_cndmask_b32_dpp v18, v17, v16, vcc quad_perm:[1,0,3,2] row_mask:0xf bank_mask:0xf
    s_not_b64 vcc, vcc
    v_cndmask_b32_dpp v19, v16, v17, vcc quad_perm:[1,0,3,2] row_mask:0xf bank_mask:0xf
    v_cvt_pk_bf16_f32 v18, v18, v19
    v_min_u32 v18, -2, v18
    buffer_store_dword v18, v4, s[12:15], s62 offen
    ds_write_b32 v5, v18
L_v_k1_249:
    s_cmp_eq_u32 s60, 63
    s_cbranch_scc1 L_v_last_248
    ds_read_b128 v[80:83], v27 offset:32768
    ds_read_b128 v[84:87], v27 offset:36864
    ds_read_b128 v[88:91], v27 offset:40960
    ds_read_b128 v[92:95], v27 offset:45056
    v_mov_b32 v96, 0
    v_mov_b32 v97, 0
    v_mov_b32 v98, 0
    v_mov_b32 v99, 0
    v_mov_b32 v100, 0
    v_mov_b32 v101, 0
    v_mov_b32 v102, 0
    v_mov_b32 v103, 0
    v_mov_b32 v104, 0
    v_mov_b32 v105, 0
    v_mov_b32 v106, 0
    v_mov_b32 v107, 0
    v_mov_b32 v108, 0
    v_mov_b32 v109, 0
    v_mov_b32 v110, 0
    v_mov_b32 v111, 0
    s_bitcmp1_b32 s44, 0
    s_cbranch_scc0 L_v_sv_252
    s_sleep 1
L_v_sv_252:
    s_sleep 3
    s_mov_b32 s70, 1
    buffer_load_dwordx4 v[64:67], v11, s[12:15], s62 offen offset:0 sc1
    buffer_load_dwordx4 v[68:71], v11, s[12:15], s62 offen offset:1024 sc1
L_v_vp_253_m:
    s_waitcnt vmcnt(0)
    v_max3_u32 v20, v64, v65, v66
    v_max3_u32 v20, v20, v67, v68
    v_max3_u32 v20, v20, v69, v70
    v_max_u32 v20, v20, v71
    v_cmp_eq_u32 vcc, -1, v20
    s_cbranch_vccnz L_rt_254
    v_smfmac_f32_16x16x64_bf16 v[96:99], v[64:67], a[64:71], v3
    v_smfmac_f32_16x16x64_bf16 v[96:99], v[68:71], a[72:79], v3
    v_smfmac_f32_16x16x64_bf16 v[100:103], v[64:67], a[80:87], v3
    v_smfmac_f32_16x16x64_bf16 v[100:103], v[68:71], a[88:95], v3
    v_smfmac_f32_16x16x64_bf16 v[104:107], v[64:67], a[96:103], v3
    v_smfmac_f32_16x16x64_bf16 v[104:107], v[68:71], a[104:111], v3
    v_smfmac_f32_16x16x64_bf16 v[108:111], v[64:67], a[112:119], v3
    v_smfmac_f32_16x16x64_bf16 v[108:111], v[68:71], a[120:127], v3
    s_nop 1
    v_cvt_pk_bf16_f32 v96, v96, v97
    v_cvt_pk_bf16_f32 v97, v98, v99
    ds_write_b64 v12, v[96:97] offset:0
    v_cvt_pk_bf16_f32 v100, v100, v101
    v_cvt_pk_bf16_f32 v101, v102, v103
    ds_write_b64 v12, v[100:101] offset:2048
    v_cvt_pk_bf16_f32 v104, v104, v105
    v_cvt_pk_bf16_f32 v105, v106, v107
    ds_write_b64 v12, v[104:105] offset:4096
    v_cvt_pk_bf16_f32 v108, v108, v109
    v_cvt_pk_bf16_f32 v109, v110, v111
    ds_write_b64 v12, v[108:109] offset:6144
    s_bitcmp1_b32 s44, 0
    s_cbranch_scc1 L_v_r8_255
L_v_r8_255_l:
    s_add_u32 s46, s65, 4096
    buffer_load_dwordx4 v[32:35], v15, s[12:15], s65 offen offset:0 sc1
    buffer_load_dwordx4 v[48:51], v15, s[12:15], s46 offen offset:0 sc1
    buffer_load_dwordx4 v[36:39], v15, s[12:15], s65 offen offset:1024 sc1
    buffer_load_dwordx4 v[52:55], v15, s[12:15], s46 offen offset:1024 sc1
    buffer_load_dwordx4 v[40:43], v15, s[12:15], s65 offen offset:2048 sc1
    buffer_load_dwordx4 v[56:59], v15, s[12:15], s46 offen offset:2048 sc1
    buffer_load_dwordx4 v[44:47], v15, s[12:15], s65 offen offset:3072 sc1
    buffer_load_dwordx4 v[60:63], v15, s[12:15], s46 offen offset:3072 sc1
    s_add_u32 s65, s65, 786432
L_v_r8_255:
    s_waitcnt lgkmcnt(0)
    s_barrier
    ds_read_b128 v[96:99], v2 offset:16384
    ds_read_b128 v[100:103], v2 offset:17408
    ds_read_b128 v[104:107], v2 offset:18432
    ds_read_b128 v[108:111], v2 offset:19456
    ds_read_b128 v[112:115], v31 offset:0
    ds_read_b128 v[116:119], v25 offset:0
    ds_read_b128 v[120:123], v31 offset:512
    ds_read_b128 v[124:127], v25 offset:1024
    s_waitcnt lgkmcnt(7)
    v_mfma_f32_16x16x32_bf16 v[16:19], v[80:83], v[96:99], 0
    s_waitcnt lgkmcnt(6)
    v_mfma_f32_16x16x32_bf16 v[16:19], v[84:87], v[100:103], v[16:19]
    s_waitcnt lgkmcnt(5)
    v_mfma_f32_16x16x32_bf16 v[16:19], v[88:91], v[104:107], v[16:19]
    s_waitcnt lgkmcnt(4)
    v_mfma_f32_16x16x32_bf16 v[16:19], v[92:95], v[108:111], v[16:19]
    s_waitcnt lgkmcnt(2)
    v_mfma_f32_16x16x32_bf16 v[16:19], v[116:119], v[112:115], v[16:19]
    s_waitcnt lgkmcnt(0)
    v_mfma_f32_16x16x32_bf16 v[16:19], v[124:127], v[120:123], v[16:19]
    s_mov_b32 exec_lo, 0x00ff00ff
    s_mov_b32 exec_hi, 0x00ff00ff
    s_nop 5
    v_cvt_pk_bf16_f32 v16, v16, v17
    v_cvt_pk_bf16_f32 v17, v18, v19
    v_min_u32 v16, -2, v16
    v_min_u32 v17, -2, v17
    buffer_store_dwordx2 v[16:17], v6, s[12:15], s63 offen sc1
    s_mov_b64 exec, -1
    s_waitcnt vmcnt(1)
    s_sub_u32 s45, s60, 3
    s_cmp_ge_u32 s45, 24
    s_cbranch_scc1 L_v_nx_256_s
    s_cmp_eq_u32 s45, 0
    s_cbranch_scc1 L_v_fl_257
L_v_fl_257_b:
    s_and_b32 s46, s45, 1
    s_lshl_b32 s47, s46, 14
    s_add_u32 s47, s47, s59
    s_lshl_b32 s46, s46, 15
    s_lshr_b32 s48, s45, 2
    s_lshl_b32 s48, s48, 16
    s_add_u32 s46, s46, s48
    s_and_b32 s48, s45, 2
    s_lshl_b32 s48, s48, 7
    s_add_u32 s46, s46, s48
    s_add_u32 m0, s47, 0
    s_add_u32 s48, s46, 0
    buffer_load_dwordx4 v28, s[12:15], s48 offen sc1 lds
    s_add_u32 m0, s47, 1024
    s_add_u32 s48, s46, 2048
    buffer_load_dwordx4 v28, s[12:15], s48 offen sc1 lds
    s_add_u32 m0, s47, 2048
    s_add_u32 s48, s46, 4096
    buffer_load_dwordx4 v28, s[12:15], s48 offen sc1 lds
    s_add_u32 m0, s47, 3072
    s_add_u32 s48, s46, 6144
    buffer_load_dwordx4 v28, s[12:15], s48 offen sc1 lds
L_v_nx_256:
    s_add_u32 s61, s61, 0x4000
    s_and_b32 s61, s61, 0xffff
    s_mov_b32 s70, 1
    s_sleep 5
    buffer_load_dword v96, v7, s[12:15], s63 offen offset:0 sc1
    buffer_load_dword v97, v7, s[12:15], s63 offen offset:256 sc1
    buffer_load_dword v98, v7, s[12:15], s63 offen offset:512 sc1
    buffer_load_dword v99, v7, s[12:15], s63 offen offset:768 sc1
    buffer_load_dword v100, v7, s[12:15], s63 offen offset:1024 sc1
    buffer_load_dword v101, v7, s[12:15], s63 offen offset:1280 sc1
    buffer_load_dword v102, v7, s[12:15], s63 offen offset:1536 sc1
    buffer_load_dword v103, v7, s[12:15], s63 offen offset:1792 sc1
    v_mfma_f32_16x16x32_bf16 v[64:67], v[32:35], a[64:67], 0
    v_mfma_f32_16x16x32_bf16 v[68:71], v[48:51], a[64:67], 0
    v_mfma_f32_16x16x32_bf16 v[64:67], v[36:39], a[68:71], v[64:67]
    v_mfma_f32_16x16x32_bf16 v[68:71], v[52:55], a[68:71], v[68:71]
    v_mfma_f32_16x16x32_bf16 v[64:67], v[40:43], a[72:75], v[64:67]
    v_mfma_f32_16x16x32_bf16 v[68:71], v[56:59], a[72:75], v[68:71]
    v_mfma_f32_16x16x32_bf16 v[64:67], v[44:47], a[76:79], v[64:67]
    v_mfma_f32_16x16x32_bf16 v[68:71], v[60:63], a[76:79], v[68:71]
    v_mfma_f32_16x16x32_bf16 v[72:75], v[32:35], a[80:83], 0
    v_mfma_f32_16x16x32_bf16 v[76:79], v[48:51], a[80:83], 0
    v_mfma_f32_16x16x32_bf16 v[72:75], v[36:39], a[84:87], v[72:75]
    v_mfma_f32_16x16x32_bf16 v[76:79], v[52:55], a[84:87], v[76:79]
    v_mfma_f32_16x16x32_bf16 v[72:75], v[40:43], a[88:91], v[72:75]
    v_mfma_f32_16x16x32_bf16 v[76:79], v[56:59], a[88:91], v[76:79]
    v_mfma_f32_16x16x32_bf16 v[72:75], v[44:47], a[92:95], v[72:75]
    v_mfma_f32_16x16x32_bf16 v[76:79], v[60:63], a[92:95], v[76:79]
    v_cvt_pk_bf16_f32 v64, v64, v65
    v_cvt_pk_bf16_f32 v65, v66, v67
    v_cvt_pk_bf16_f32 v66, v68, v69
    v_cvt_pk_bf16_f32 v67, v70, v71
    ds_write_b128 v10, v[64:67] offset:32768
    v_mfma_f32_16x16x32_bf16 v[80:83], v[32:35], a[96:99], 0
    v_mfma_f32_16x16x32_bf16 v[84:87], v[48:51], a[96:99], 0
    v_mfma_f32_16x16x32_bf16 v[80:83], v[36:39], a[100:103], v[80:83]
    v_mfma_f32_16x16x32_bf16 v[84:87], v[52:55], a[100:103], v[84:87]
    v_mfma_f32_16x16x32_bf16 v[80:83], v[40:43], a[104:107], v[80:83]
    v_mfma_f32_16x16x32_bf16 v[84:87], v[56:59], a[104:107], v[84:87]
    v_mfma_f32_16x16x32_bf16 v[80:83], v[44:47], a[108:111], v[80:83]
    v_mfma_f32_16x16x32_bf16 v[84:87], v[60:63], a[108:111], v[84:87]
    v_cvt_pk_bf16_f32 v72, v72, v73
    v_cvt_pk_bf16_f32 v73, v74, v75
    v_cvt_pk_bf16_f32 v74, v76, v77
    v_cvt_pk_bf16_f32 v75, v78, v79
    ds_write_b128 v10, v[72:75] offset:33792
L_v_gp_258:
    s_waitcnt vmcnt(7)
    v_lshlrev_b32 v20, 16, v96
    v_and_b32 v21, 0xffff0000, v96
    s_waitcnt vmcnt(6)
    v_lshlrev_b32 v22, 16, v97
    v_and_b32 v23, 0xffff0000, v97
    v_add_f32 v20, v20, v22
    v_add_f32 v21, v21, v23
    s_waitcnt vmcnt(5)
    v_lshlrev_b32 v22, 16, v98
    v_and_b32 v23, 0xffff0000, v98
    v_add_f32 v20, v20, v22
    v_add_f32 v21, v21, v23
    s_waitcnt vmcnt(4)
    v_lshlrev_b32 v22, 16, v99
    v_and_b32 v23, 0xffff0000, v99
    v_add_f32 v20, v20, v22
    v_add_f32 v21, v21, v23
    s_waitcnt vmcnt(3)
    v_lshlrev_b32 v22, 16, v100
    v_and_b32 v23, 0xffff0000, v100
    v_add_f32 v20, v20, v22
    v_add_f32 v21, v21, v23
    s_waitcnt vmcnt(2)
    v_lshlrev_b32 v22, 16, v101
    v_and_b32 v23, 0xffff0000, v101
    v_add_f32 v20, v20, v22
    v_add_f32 v21, v21, v23
    s_waitcnt vmcnt(1)
    v_lshlrev_b32 v22, 16, v102
    v_and_b32 v23, 0xffff0000, v102
    v_add_f32 v20, v20, v22
    v_add_f32 v21, v21, v23
    s_waitcnt vmcnt(0)
    v_lshlrev_b32 v22, 16, v103
    v_and_b32 v23, 0xffff0000, v103
    v_add_f32 v20, v20, v22
    v_add_f32 v21, v21, v23
    v_cmp_u_f32 vcc, v20, v21
    v_cvt_pk_bf16_f32 v20, v20, v21
    s_cbranch_vccnz L_v_gf_260
L_v_gok_259:
    buffer_store_dword v20, v8, s[12:15], s61 offen
    s_xor_b32 s45, s61, 0x8000
    buffer_store_dword v26, v8, s[12:15], s45 offen
    s_bitcmp1_b32 s44, 0
    s_cbranch_scc1 L_v_nr_261
    s_xor_b32 s45, s62, 0x4000
    buffer_store_dword v26, v4, s[12:15], s45 offen
L_v_nr_261:
    s_add_u32 s60, s60, 1
    s_add_u32 s62, s62, 0x2000
    s_and_b32 s62, s62, 0x7fff
    s_and_b32 s45, s60, 0x38
    s_bitcmp1_b64 s[66:67], s45
    s_cselect_b32 s45, 8192, 0
    s_lshl_b32 s63, s60, 18
    s_add_u32 s63, s63, s45
    v_mfma_f32_16x16x32_bf16 v[88:91], v[32:35], a[112:115], 0
    v_mfma_f32_16x16x32_bf16 v[92:95], v[48:51], a[112:115], 0
    v_mfma_f32_16x16x32_bf16 v[88:91], v[36:39], a[116:119], v[88:91]
    v_mfma_f32_16x16x32_bf16 v[92:95], v[52:55], a[116:119], v[92:95]
    v_mfma_f32_16x16x32_bf16 v[88:91], v[40:43], a[120:123], v[88:91]
    v_mfma_f32_16x16x32_bf16 v[92:95], v[56:59], a[120:123], v[92:95]
    v_mfma_f32_16x16x32_bf16 v[88:91], v[44:47], a[124:127], v[88:91]
    v_mfma_f32_16x16x32_bf16 v[92:95], v[60:63], a[124:127], v[92:95]
    v_cvt_pk_bf16_f32 v80, v80, v81
    v_cvt_pk_bf16_f32 v81, v82, v83
    v_cvt_pk_bf16_f32 v82, v84, v85
    v_cvt_pk_bf16_f32 v83, v86, v87
    ds_write_b128 v10, v[80:83] offset:34816
    s_nop 2
    v_cvt_pk_bf16_f32 v88, v88, v89
    v_cvt_pk_bf16_f32 v89, v90, v91
    v_cvt_pk_bf16_f32 v90, v92, v93
    v_cvt_pk_bf16_f32 v91, v94, v95
    ds_write_b128 v10, v[88:91] offset:35840
    s_sleep 3
    s_branch L_v_loop_244
L_v_last_248:
    s_waitcnt lgkmcnt(0)
    s_barrier
    s_branch L_replica
L_v_l1_245:
    s_mov_b64 exec, s[48:49]
    s_cbranch_execz L_v_ls_262
    buffer_load_dwordx4 v[64:67], v9, s[12:15], s61 offen offset:0 sc1
L_v_ls_262:
    s_mov_b64 exec, s[50:51]
    s_cbranch_execz L_v_ls_263
    buffer_load_dwordx4 v[68:71], v9, s[12:15], s61 offen offset:1024 sc1
L_v_ls_263:
    s_mov_b64 exec, s[52:53]
    s_cbranch_execz L_v_ls_264
    buffer_load_dwordx4 v[72:75], v9, s[12:15], s61 offen offset:2048 sc1
L_v_ls_264:
    s_mov_b64 exec, s[54:55]
    s_cbranch_execz L_v_ls_265
    buffer_load_dwordx4 v[76:79], v9, s[12:15], s61 offen offset:3072 sc1
L_v_ls_265:
    s_mov_b64 exec, -1
    s_add_u32 s70, s70, 1
    s_cmp_ge_u32 s70, 524288
    s_cbranch_scc1 L_c_done_1
    s_waitcnt vmcnt(0)
    s_cmp_eq_u64 s[48:49], 0
    s_cbranch_scc1 L_v_lc_266
    ds_write_b128 v10, v[64:67] offset:0
    v_max3_u32 v24, v64, v65, v66
    v_max_u32 v24, v24, v67
    v_cmp_eq_u32 s[48:49], -1, v24
L_v_lc_266:
    s_cmp_eq_u64 s[50:51], 0
    s_cbranch_scc1 L_v_lc_267
    ds_write_b128 v10, v[68:71] offset:1024
    v_max3_u32 v24, v68, v69, v70
    v_max_u32 v24, v24, v71
    v_cmp_eq_u32 s[50:51], -1, v24
L_v_lc_267:
    s_cmp_eq_u64 s[52:53], 0
    s_cbranch_scc1 L_v_lc_268
    ds_write_b128 v10, v[72:75] offset:2048
    v_max3_u32 v24, v72, v73, v74
    v_max_u32 v24, v24, v75
    v_cmp_eq_u32 s[52:53], -1, v24
L_v_lc_268:
    s_cmp_eq_u64 s[54:55], 0
    s_cbranch_scc1 L_v_lc_269
    ds_write_b128 v10, v[76:79] offset:3072
    v_max3_u32 v24, v76, v77, v78
    v_max_u32 v24, v24, v79
    v_cmp_eq_u32 s[54:55], -1, v24
L_v_lc_269:
    s_or_b64 s[46:47], s[48:49], s[50:51]
    s_or_b64 vcc, s[52:53], s[54:55]
    s_or_b64 vcc, vcc, s[46:47]
    s_cbranch_scc1 L_v_l1_245
    s_branch L_v_l1ok_247
L_v_k1_249_c:
    s_add_u32 s46, s65, 4096
    buffer_load_dwordx4 v[32:35], v15, s[12:15], s65 offen offset:0 sc1
    buffer_load_dwordx4 v[48:51], v15, s[12:15], s46 offen offset:0 sc1
    buffer_load_dwordx4 v[36:39], v15, s[12:15], s65 offen offset:1024 sc1
    buffer_load_dwordx4 v[52:55], v15, s[12:15], s46 offen offset:1024 sc1
    buffer_load_dwordx4 v[40:43], v15, s[12:15], s65 offen offset:2048 sc1
    buffer_load_dwordx4 v[56:59], v15, s[12:15], s46 offen offset:2048 sc1
    buffer_load_dwordx4 v[44:47], v15, s[12:15], s65 offen offset:3072 sc1
    buffer_load_dwordx4 v[60:63], v15, s[12:15], s46 offen offset:3072 sc1
    s_add_u32 s65, s65, 786432
    s_branch L_v_k1_249
L_rt_251:
    s_add_u32 s70, s70, 1
    s_cmp_lt_u32 s70, 524288
    s_cbranch_scc1 L_v_rl_250
    s_branch L_c_done_1
L_v_vp_253:
    buffer_load_dwordx4 v[64:67], v11, s[12:15], s62 offen offset:0 sc1
    buffer_load_dwordx4 v[68:71], v11, s[12:15], s62 offen offset:1024 sc1
    s_branch L_v_vp_253_m
L_rt_254:
    s_add_u32 s70, s70, 1
    s_cmp_lt_u32 s70, 524288
    s_cbranch_scc1 L_v_vp_253
    s_branch L_c_done_1
L_v_fl_257:
    v_and_b32 v22, 31, v1
    v_lshlrev_b32 v22, 7, v22
    s_mov_b32 s46, 0x109400
    s_mov_b32 s47, 56
    s_mov_b32 s70, 0
L_spin_270:
    buffer_load_dword v23, v22, s[12:15], s46 offen sc1
    s_waitcnt vmcnt(0)
    v_cmp_ge_u32 vcc, s47, v23
    s_add_u32 s70, s70, 1
    s_cbranch_vccz L_spok_271
    s_sleep 3
    s_cmp_lt_u32 s70, 524288
    s_cbranch_scc1 L_spin_270
    s_branch L_c_done_1
L_spok_271:
    s_branch L_v_fl_257_b
L_v_nx_256_s:
    s_sleep 2
    s_branch L_v_nx_256
L_v_gf_260:
    v_max3_u32 v24, v96, v97, v98
    v_max3_u32 v24, v24, v99, v100
    v_max3_u32 v24, v24, v101, v102
    v_max_u32 v24, v24, v103
    v_cmp_eq_u32 vcc, -1, v24
    v_min_u32 v20, -2, v20
    s_add_u32 s70, s70, 1
    s_cbranch_vccz L_v_gok_259
    buffer_load_dword v96, v7, s[12:15], s63 offen offset:0 sc1
    buffer_load_dword v97, v7, s[12:15], s63 offen offset:256 sc1
    buffer_load_dword v98, v7, s[12:15], s63 offen offset:512 sc1
    buffer_load_dword v99, v7, s[12:15], s63 offen offset:768 sc1
    buffer_load_dword v100, v7, s[12:15], s63 offen offset:1024 sc1
    buffer_load_dword v101, v7, s[12:15], s63 offen offset:1280 sc1
    buffer_load_dword v102, v7, s[12:15], s63 offen offset:1536 sc1
    buffer_load_dword v103, v7, s[12:15], s63 offen offset:1792 sc1
    s_cmp_lt_u32 s70, 524288
    s_cbranch_scc1 L_v_gp_258
    s_branch L_c_done_1
L_vs_203:
    s_mov_b32 s70, 1
    v_mov_b32 v16, 0
    v_mov_b32 v17, 0
    s_branch L_v_l1m_274
.p2align 6
L_v_loop_272:
    s_mov_b32 s70, 1
    buffer_load_dwordx4 v[64:67], v9, s[12:15], s61 offen offset:0 sc1
    buffer_load_dwordx4 v[68:71], v9, s[12:15], s61 offen offset:1024 sc1
    buffer_load_dwordx4 v[72:75], v9, s[12:15], s61 offen offset:2048 sc1
    buffer_load_dwordx4 v[76:79], v9, s[12:15], s61 offen offset:3072 sc1
    v_mov_b32 v16, 0
    v_mov_b32 v17, 0
    v_mov_b32 v18, 0
    v_mov_b32 v19, 0
    v_mov_b32 v20, 0
    v_mov_b32 v21, 0
    v_mov_b32 v22, 0
    v_mov_b32 v23, 0
L_v_l1m_274:
    s_waitcnt vmcnt(3)
    ds_write_b128 v10, v[64:67] offset:0
    v_max3_u32 v24, v64, v65, v66
    v_max_u32 v24, v24, v67
    v_cmp_eq_u32 s[48:49], -1, v24
    s_waitcnt vmcnt(2)
    ds_write_b128 v10, v[68:71] offset:1024
    v_max3_u32 v24, v68, v69, v70
    v_max_u32 v24, v24, v71
    v_cmp_eq_u32 s[50:51], -1, v24
    s_waitcnt vmcnt(1)
    ds_write_b128 v10, v[72:75] offset:2048
    v_max3_u32 v24, v72, v73, v74
    v_max_u32 v24, v24, v75
    v_cmp_eq_u32 s[52:53], -1, v24
    s_waitcnt vmcnt(0)
    ds_write_b128 v10, v[76:79] offset:3072
    v_max3_u32 v24, v76, v77, v78
    v_max_u32 v24, v24, v79
    v_cmp_eq_u32 s[54:55], -1, v24
    s_or_b64 s[46:47], s[48:49], s[50:51]
    s_or_b64 vcc, s[52:53], s[54:55]
    s_or_b64 vcc, vcc, s[46:47]
    s_cbranch_scc1 L_v_l1_273
L_v_l1ok_275:
    s_waitcnt lgkmcnt(0)
    s_barrier
    v_smfmac_f32_16x16x64_bf16 v[16:19], v[64:67], a[0:7], v3
    v_smfmac_f32_16x16x64_bf16 v[20:23], v[64:67], a[32:39], v3
    v_smfmac_f32_16x16x64_bf16 v[16:19], v[68:71], a[8:15], v3
    v_smfmac_f32_16x16x64_bf16 v[20:23], v[68:71], a[40:47], v3
    v_smfmac_f32_16x16x64_bf16 v[16:19], v[72:75], a[16:23], v3
    v_smfmac_f32_16x16x64_bf16 v[20:23], v[72:75], a[48:55], v3
    v_smfmac_f32_16x16x64_bf16 v[16:19], v[76:79], a[24:31], v3
    v_smfmac_f32_16x16x64_bf16 v[20:23], v[76:79], a[56:63], v3
    s_nop 6
    v_permlane32_swap_b32 v16, v18
    v_permlane32_swap_b32 v17, v19
    v_permlane32_swap_b32 v20, v22
    v_permlane32_swap_b32 v21, v23
    v_add_f32 v16, v16, v18
    v_add_f32 v17, v17, v19
    v_add_f32 v18, v20, v22
    v_add_f32 v19, v21, v23
    ds_write_b128 v14, v[16:19]
    s_mov_b64 exec, 1
    ds_add_u32 v29, v30
    s_mov_b64 exec, -1
    s_add_u32 s58, s58, 4
    s_bitcmp1_b32 s44, 0
    s_cbranch_scc1 L_v_k1_277_c
    s_mov_b32 s70, 0
L_v_rl_278:
    ds_read_b32 v24, v29
    ds_read_b64 v[16:17], v13 offset:0
    ds_read_b64 v[18:19], v13 offset:1024
    ds_read_b64 v[20:21], v13 offset:2048
    ds_read_b64 v[22:23], v13 offset:3072
    s_waitcnt lgkmcnt(2)
    v_cmp_ne_u32 vcc, s58, v24
    v_add_f32 v16, v16, v18
    v_add_f32 v17, v17, v19
    s_waitcnt lgkmcnt(0)
    s_cbranch_vccnz L_rt_279
    v_add_f32 v20, v20, v22
    v_add_f32 v21, v21, v23
    v_add_f32 v16, v16, v20
    v_add_f32 v17, v17, v21
    s_mov_b32 vcc_lo, 0x55555555
    s_mov_b32 vcc_hi, 0x55555555
    v_cndmask_b32_dpp v18, v17, v16, vcc quad_perm:[1,0,3,2] row_mask:0xf bank_mask:0xf
    s_not_b64 vcc, vcc
    v_cndmask_b32_dpp v19, v16, v17, vcc quad_perm:[1,0,3,2] row_mask:0xf bank_mask:0xf
    v_cvt_pk_bf16_f32 v18, v18, v19
    v_min_u32 v18, -2, v18
    buffer_store_dword v18, v4, s[12:15], s62 offen sc1
    ds_write_b32 v5, v18
L_v_k1_277:
    s_cmp_eq_u32 s60, 63
    s_cbranch_scc1 L_v_last_276
    ds_read_b128 v[80:83], v27 offset:32768
    ds_read_b128 v[84:87], v27 offset:36864
    ds_read_b128 v[88:91], v27 offset:40960
    ds_read_b128 v[92:95], v27 offset:45056
    v_mov_b32 v96, 0
    v_mov_b32 v97, 0
    v_mov_b32 v98, 0
    v_mov_b32 v99, 0
    v_mov_b32 v100, 0
    v_mov_b32 v101, 0
    v_mov_b32 v102, 0
    v_mov_b32 v103, 0
    v_mov_b32 v104, 0
    v_mov_b32 v105, 0
    v_mov_b32 v106, 0
    v_mov_b32 v107, 0
    v_mov_b32 v108, 0
    v_mov_b32 v109, 0
    v_mov_b32 v110, 0
    v_mov_b32 v111, 0
    s_bitcmp1_b32 s44, 0
    s_cbranch_scc0 L_v_sv_280
    s_sleep 1
L_v_sv_280:
    s_sleep 3
    s_mov_b32 s70, 1
    buffer_load_dwordx4 v[64:67], v11, s[12:15], s62 offen offset:0 sc1
    buffer_load_dwordx4 v[68:71], v11, s[12:15], s62 offen offset:1024 sc1
L_v_vp_281_m:
    s_waitcnt vmcnt(0)
    v_max3_u32 v20, v64, v65, v66
    v_max3_u32 v20, v20, v67, v68
    v_max3_u32 v20, v20, v69, v70
    v_max_u32 v20, v20, v71
    v_cmp_eq_u32 vcc, -1, v20
    s_cbranch_vccnz L_rt_282
    v_smfmac_f32_16x16x64_bf16 v[96:99], v[64:67], a[64:71], v3
    v_smfmac_f32_16x16x64_bf16 v[96:99], v[68:71], a[72:79], v3
    v_smfmac_f32_16x16x64_bf16 v[100:103], v[64:67], a[80:87], v3
    v_smfmac_f32_16x16x64_bf16 v[100:103], v[68:71], a[88:95], v3
    v_smfmac_f32_16x16x64_bf16 v[104:107], v[64:67], a[96:103], v3
    v_smfmac_f32_16x16x64_bf16 v[104:107], v[68:71], a[104:111], v3
    v_smfmac_f32_16x16x64_bf16 v[108:111], v[64:67], a[112:119], v3
    v_smfmac_f32_16x16x64_bf16 v[108:111], v[68:71], a[120:127], v3
    s_nop 1
    v_cvt_pk_bf16_f32 v96, v96, v97
    v_cvt_pk_bf16_f32 v97, v98, v99
    ds_write_b64 v12, v[96:97] offset:0
    v_cvt_pk_bf16_f32 v100, v100, v101
    v_cvt_pk_bf16_f32 v101, v102, v103
    ds_write_b64 v12, v[100:101] offset:2048
    v_cvt_pk_bf16_f32 v104, v104, v105
    v_cvt_pk_bf16_f32 v105, v106, v107
    ds_write_b64 v12, v[104:105] offset:4096
    v_cvt_pk_bf16_f32 v108, v108, v109
    v_cvt_pk_bf16_f32 v109, v110, v111
    ds_write_b64 v12, v[108:109] offset:6144
    s_bitcmp1_b32 s44, 0
    s_cbranch_scc1 L_v_r8_283
L_v_r8_283_l:
    s_add_u32 s46, s65, 4096
    buffer_load_dwordx4 v[32:35], v15, s[12:15], s65 offen offset:0 sc1
    buffer_load_dwordx4 v[48:51], v15, s[12:15], s46 offen offset:0 sc1
    buffer_load_dwordx4 v[36:39], v15, s[12:15], s65 offen offset:1024 sc1
    buffer_load_dwordx4 v[52:55], v15, s[12:15], s46 offen offset:1024 sc1
    buffer_load_dwordx4 v[40:43], v15, s[12:15], s65 offen offset:2048 sc1
    buffer_load_dwordx4 v[56:59], v15, s[12:15], s46 offen offset:2048 sc1
    buffer_load_dwordx4 v[44:47], v15, s[12:15], s65 offen offset:3072 sc1
    buffer_load_dwordx4 v[60:63], v15, s[12:15], s46 offen offset:3072 sc1
    s_add_u32 s65, s65, 786432
L_v_r8_283:
    s_waitcnt lgkmcnt(0)
    s_barrier
    ds_read_b128 v[96:99], v2 offset:16384
    ds_read_b128 v[100:103], v2 offset:17408
    ds_read_b128 v[104:107], v2 offset:18432
    ds_read_b128 v[108:111], v2 offset:19456
    ds_read_b128 v[112:115], v31 offset:0
    ds_read_b128 v[116:119], v25 offset:0
    ds_read_b128 v[120:123], v31 offset:512
    ds_read_b128 v[124:127], v25 offset:1024
    s_waitcnt lgkmcnt(7)
    v_mfma_f32_16x16x32_bf16 v[16:19], v[80:83], v[96:99], 0
    s_waitcnt lgkmcnt(6)
    v_mfma_f32_16x16x32_bf16 v[16:19], v[84:87], v[100:103], v[16:19]
    s_waitcnt lgkmcnt(5)
    v_mfma_f32_16x16x32_bf16 v[16:19], v[88:91], v[104:107], v[16:19]
    s_waitcnt lgkmcnt(4)
    v_mfma_f32_16x16x32_bf16 v[16:19], v[92:95], v[108:111], v[16:19]
    s_waitcnt lgkmcnt(2)
    v_mfma_f32_16x16x32_bf16 v[16:19], v[116:119], v[112:115], v[16:19]
    s_waitcnt lgkmcnt(0)
    v_mfma_f32_16x16x32_bf16 v[16:19], v[124:127], v[120:123], v[16:19]
    s_mov_b32 exec_lo, 0x00ff00ff
    s_mov_b32 exec_hi, 0x00ff00ff
    s_nop 5
    v_cvt_pk_bf16_f32 v16, v16, v17
    v_cvt_pk_bf16_f32 v17, v18, v19
    v_min_u32 v16, -2, v16
    v_min_u32 v17, -2, v17
    buffer_store_dwordx2 v[16:17], v6, s[12:15], s63 offen sc1
    s_mov_b64 exec, -1
    s_waitcnt vmcnt(1)
    s_sub_u32 s45, s60, 3
    s_cmp_ge_u32 s45, 24
    s_cbranch_scc1 L_v_nx_284_s
    s_cmp_eq_u32 s45, 0
    s_cbranch_scc1 L_v_fl_285
L_v_fl_285_b:
    s_and_b32 s46, s45, 1
    s_lshl_b32 s47, s46, 14
    s_add_u32 s47, s47, s59
    s_lshl_b32 s46, s46, 15
    s_lshr_b32 s48, s45, 2
    s_lshl_b32 s48, s48, 16
    s_add_u32 s46, s46, s48
    s_and_b32 s48, s45, 2
    s_lshl_b32 s48, s48, 7
    s_add_u32 s46, s46, s48
    s_add_u32 m0, s47, 0
    s_add_u32 s48, s46, 0
    buffer_load_dwordx4 v28, s[12:15], s48 offen sc1 lds
    s_add_u32 m0, s47, 1024
    s_add_u32 s48, s46, 2048
    buffer_load_dwordx4 v28, s[12:15], s48 offen sc1 lds
    s_add_u32 m0, s47, 2048
    s_add_u32 s48, s46, 4096
    buffer_load_dwordx4 v28, s[12:15], s48 offen sc1 lds
    s_add_u32 m0, s47, 3072
    s_add_u32 s48, s46, 6144
    buffer_load_dwordx4 v28, s[12:15], s48 offen sc1 lds
L_v_nx_284:
    s_add_u32 s61, s61, 0x4000
    s_and_b32 s61, s61, 0xffff
    s_mov_b32 s70, 1
    s_sleep 5
    buffer_load_dword v96, v7, s[12:15], s63 offen offset:0 sc1
    buffer_load_dword v97, v7, s[12:15], s63 offen offset:256 sc1
    buffer_load_dword v98, v7, s[12:15], s63 offen offset:512 sc1
    buffer_load_dword v99, v7, s[12:15], s63 offen offset:768 sc1
    buffer_load_dword v100, v7, s[12:15], s63 offen offset:1024 sc1
    buffer_load_dword v101, v7, s[12:15], s63 offen offset:1280 sc1
    buffer_load_dword v102, v7, s[12:15], s63 offen offset:1536 sc1
    buffer_load_dword v103, v7, s[12:15], s63 offen offset:1792 sc1
    v_mfma_f32_16x16x32_bf16 v[64:67], v[32:35], a[64:67], 0
    v_mfma_f32_16x16x32_bf16 v[68:71], v[48:51], a[64:67], 0
    v_mfma_f32_16x16x32_bf16 v[64:67], v[36:39], a[68:71], v[64:67]
    v_mfma_f32_16x16x32_bf16 v[68:71], v[52:55], a[68:71], v[68:71]
    v_mfma_f32_16x16x32_bf16 v[64:67], v[40:43], a[72:75], v[64:67]
    v_mfma_f32_16x16x32_bf16 v[68:71], v[56:59], a[72:75], v[68:71]
    v_mfma_f32_16x16x32_bf16 v[64:67], v[44:47], a[76:79], v[64:67]
    v_mfma_f32_16x16x32_bf16 v[68:71], v[60:63], a[76:79], v[68:71]
    v_mfma_f32_16x16x32_bf16 v[72:75], v[32:35], a[80:83], 0
    v_mfma_f32_16x16x32_bf16 v[76:79], v[48:51], a[80:83], 0
    v_mfma_f32_16x16x32_bf16 v[72:75], v[36:39], a[84:87], v[72:75]
    v_mfma_f32_16x16x32_bf16 v[76:79], v[52:55], a[84:87], v[76:79]
    v_mfma_f32_16x16x32_bf16 v[72:75], v[40:43], a[88:91], v[72:75]
    v_mfma_f32_16x16x32_bf16 v[76:79], v[56:59], a[88:91], v[76:79]
    v_mfma_f32_16x16x32_bf16 v[72:75], v[44:47], a[92:95], v[72:75]
    v_mfma_f32_16x16x32_bf16 v[76:79], v[60:63], a[92:95], v[76:79]
    v_cvt_pk_bf16_f32 v64, v64, v65
    v_cvt_pk_bf16_f32 v65, v66, v67
    v_cvt_pk_bf16_f32 v66, v68, v69
    v_cvt_pk_bf16_f32 v67, v70, v71
    ds_write_b128 v10, v[64:67] offset:32768
    v_mfma_f32_16x16x32_bf16 v[80:83], v[32:35], a[96:99], 0
    v_mfma_f32_16x16x32_bf16 v[84:87], v[48:51], a[96:99], 0
    v_mfma_f32_16x16x32_bf16 v[80:83], v[36:39], a[100:103], v[80:83]
    v_mfma_f32_16x16x32_bf16 v[84:87], v[52:55], a[100:103], v[84:87]
    v_mfma_f32_16x16x32_bf16 v[80:83], v[40:43], a[104:107], v[80:83]
    v_mfma_f32_16x16x32_bf16 v[84:87], v[56:59], a[104:107], v[84:87]
    v_mfma_f32_16x16x32_bf16 v[80:83], v[44:47], a[108:111], v[80:83]
    v_mfma_f32_16x16x32_bf16 v[84:87], v[60:63], a[108:111], v[84:87]
    v_cvt_pk_bf16_f32 v72, v72, v73
    v_cvt_pk_bf16_f32 v73, v74, v75
    v_cvt_pk_bf16_f32 v74, v76, v77
    v_cvt_pk_bf16_f32 v75, v78, v79
    ds_write_b128 v10, v[72:75] offset:33792
L_v_gp_286:
    s_waitcnt vmcnt(7)
    v_lshlrev_b32 v20, 16, v96
    v_and_b32 v21, 0xffff0000, v96
    s_waitcnt vmcnt(6)
    v_lshlrev_b32 v22, 16, v97
    v_and_b32 v23, 0xffff0000, v97
    v_add_f32 v20, v20, v22
    v_add_f32 v21, v21, v23
    s_waitcnt vmcnt(5)
    v_lshlrev_b32 v22, 16, v98
    v_and_b32 v23, 0xffff0000, v98
    v_add_f32 v20, v20, v22
    v_add_f32 v21, v21, v23
    s_waitcnt vmcnt(4)
    v_lshlrev_b32 v22, 16, v99
    v_and_b32 v23, 0xffff0000, v99
    v_add_f32 v20, v20, v22
    v_add_f32 v21, v21, v23
    s_waitcnt vmcnt(3)
    v_lshlrev_b32 v22, 16, v100
    v_and_b32 v23, 0xffff0000, v100
    v_add_f32 v20, v20, v22
    v_add_f32 v21, v21, v23
    s_waitcnt vmcnt(2)
    v_lshlrev_b32 v22, 16, v101
    v_and_b32 v23, 0xffff0000, v101
    v_add_f32 v20, v20, v22
    v_add_f32 v21, v21, v23
    s_waitcnt vmcnt(1)
    v_lshlrev_b32 v22, 16, v102
    v_and_b32 v23, 0xffff0000, v102
    v_add_f32 v20, v20, v22
    v_add_f32 v21, v21, v23
    s_waitcnt vmcnt(0)
    v_lshlrev_b32 v22, 16, v103
    v_and_b32 v23, 0xffff0000, v103
    v_add_f32 v20, v20, v22
    v_add_f32 v21, v21, v23
    v_cmp_u_f32 vcc, v20, v21
    v_cvt_pk_bf16_f32 v20, v20, v21
    s_cbranch_vccnz L_v_gf_288
L_v_gok_287:
    buffer_store_dword v20, v8, s[12:15], s61 offen sc1
    s_xor_b32 s45, s61, 0x8000
    buffer_store_dword v26, v8, s[12:15], s45 offen sc1
    s_bitcmp1_b32 s44, 0
    s_cbranch_scc1 L_v_nr_289
    s_xor_b32 s45, s62, 0x4000
    buffer_store_dword v26, v4, s[12:15], s45 offen sc1
L_v_nr_289:
    s_add_u32 s60, s60, 1
    s_add_u32 s62, s62, 0x2000
    s_and_b32 s62, s62, 0x7fff
    s_and_b32 s45, s60, 0x38
    s_bitcmp1_b64 s[66:67], s45
    s_cselect_b32 s45, 8192, 0
    s_lshl_b32 s63, s60, 18
    s_add_u32 s63, s63, s45
    v_mfma_f32_16x16x32_bf16 v[88:91], v[32:35], a[112:115], 0
    v_mfma_f32_16x16x32_bf16 v[92:95], v[48:51], a[112:115], 0
    v_mfma_f32_16x16x32_bf16 v[88:91], v[36:39], a[116:119], v[88:91]
    v_mfma_f32_16x16x32_bf16 v[92:95], v[52:55], a[116:119], v[92:95]
    v_mfma_f32_16x16x32_bf16 v[88:91], v[40:43], a[120:123], v[88:91]
    v_mfma_f32_16x16x32_bf16 v[92:95], v[56:59], a[120:123], v[92:95]
    v_mfma_f32_16x16x32_bf16 v[88:91], v[44:47], a[124:127], v[88:91]
    v_mfma_f32_16x16x32_bf16 v[92:95], v[60:63], a[124:127], v[92:95]
    v_cvt_pk_bf16_f32 v80, v80, v81
    v_cvt_pk_bf16_f32 v81, v82, v83
    v_cvt_pk_bf16_f32 v82, v84, v85
    v_cvt_pk_bf16_f32 v83, v86, v87
    ds_write_b128 v10, v[80:83] offset:34816
    s_nop 2
    v_cvt_pk_bf16_f32 v88, v88, v89
    v_cvt_pk_bf16_f32 v89, v90, v91
    v_cvt_pk_bf16_f32 v90, v92, v93
    v_cvt_pk_bf16_f32 v91, v94, v95
    ds_write_b128 v10, v[88:91] offset:35840
    s_sleep 3
    s_branch L_v_loop_272
L_v_last_276:
    s_waitcnt lgkmcnt(0)
    s_barrier
    s_branch L_replica
L_v_l1_273:
    s_mov_b64 exec, s[48:49]
    s_cbranch_execz L_v_ls_290
    buffer_load_dwordx4 v[64:67], v9, s[12:15], s61 offen offset:0 sc1
L_v_ls_290:
    s_mov_b64 exec, s[50:51]
    s_cbranch_execz L_v_ls_291
    buffer_load_dwordx4 v[68:71], v9, s[12:15], s61 offen offset:1024 sc1
L_v_ls_291:
    s_mov_b64 exec, s[52:53]
    s_cbranch_execz L_v_ls_292
    buffer_load_dwordx4 v[72:75], v9, s[12:15], s61 offen offset:2048 sc1
L_v_ls_292:
    s_mov_b64 exec, s[54:55]
    s_cbranch_execz L_v_ls_293
    buffer_load_dwordx4 v[76:79], v9, s[12:15], s61 offen offset:3072 sc1
L_v_ls_293:
    s_mov_b64 exec, -1
    s_add_u32 s70, s70, 1
    s_cmp_ge_u32 s70, 524288
    s_cbranch_scc1 L_c_done_1
    s_waitcnt vmcnt(0)
    s_cmp_eq_u64 s[48:49], 0
    s_cbranch_scc1 L_v_lc_294
    ds_write_b128 v10, v[64:67] offset:0
    v_max3_u32 v24, v64, v65, v66
    v_max_u32 v24, v24, v67
    v_cmp_eq_u32 s[48:49], -1, v24
L_v_lc_294:
    s_cmp_eq_u64 s[50:51], 0
    s_cbranch_scc1 L_v_lc_295
    ds_write_b128 v10, v[68:71] offset:1024
    v_max3_u32 v24, v68, v69, v70
    v_max_u32 v24, v24, v71
    v_cmp_eq_u32 s[50:51], -1, v24
L_v_lc_295:
    s_cmp_eq_u64 s[52:53], 0
    s_cbranch_scc1 L_v_lc_296
    ds_write_b128 v10, v[72:75] offset:2048
    v_max3_u32 v24, v72, v73, v74
    v_max_u32 v24, v24, v75
    v_cmp_eq_u32 s[52:53], -1, v24
L_v_lc_296:
    s_cmp_eq_u64 s[54:55], 0
    s_cbranch_scc1 L_v_lc_297
    ds_write_b128 v10, v[76:79] offset:3072
    v_max3_u32 v24, v76, v77, v78
    v_max_u32 v24, v24, v79
    v_cmp_eq_u32 s[54:55], -1, v24
L_v_lc_297:
    s_or_b64 s[46:47], s[48:49], s[50:51]
    s_or_b64 vcc, s[52:53], s[54:55]
    s_or_b64 vcc, vcc, s[46:47]
    s_cbranch_scc1 L_v_l1_273
    s_branch L_v_l1ok_275
L_v_k1_277_c:
    s_add_u32 s46, s65, 4096
    buffer_load_dwordx4 v[32:35], v15, s[12:15], s65 offen offset:0 sc1
    buffer_load_dwordx4 v[48:51], v15, s[12:15], s46 offen offset:0 sc1
    buffer_load_dwordx4 v[36:39], v15, s[12:15], s65 offen offset:1024 sc1
    buffer_load_dwordx4 v[52:55], v15, s[12:15], s46 offen offset:1024 sc1
    buffer_load_dwordx4 v[40:43], v15, s[12:15], s65 offen offset:2048 sc1
    buffer_load_dwordx4 v[56:59], v15, s[12:15], s46 offen offset:2048 sc1
    buffer_load_dwordx4 v[44:47], v15, s[12:15], s65 offen offset:3072 sc1
    buffer_load_dwordx4 v[60:63], v15, s[12:15], s46 offen offset:3072 sc1
    s_add_u32 s65, s65, 786432
    s_branch L_v_k1_277
L_rt_279:
    s_add_u32 s70, s70, 1
    s_cmp_lt_u32 s70, 524288
    s_cbranch_scc1 L_v_rl_278
    s_branch L_c_done_1
L_v_vp_281:
    buffer_load_dwordx4 v[64:67], v11, s[12:15], s62 offen offset:0 sc1
    buffer_load_dwordx4 v[68:71], v11, s[12:15], s62 offen offset:1024 sc1
    s_branch L_v_vp_281_m
L_rt_282:
    s_add_u32 s70, s70, 1
    s_cmp_lt_u32 s70, 524288
    s_cbranch_scc1 L_v_vp_281
    s_branch L_c_done_1
L_v_fl_285:
    v_and_b32 v22, 31, v1
    v_lshlrev_b32 v22, 7, v22
    s_mov_b32 s46, 0x109400
    s_mov_b32 s47, 56
    s_mov_b32 s70, 0
L_spin_298:
    buffer_load_dword v23, v22, s[12:15], s46 offen sc1
    s_waitcnt vmcnt(0)
    v_cmp_ge_u32 vcc, s47, v23
    s_add_u32 s70, s70, 1
    s_cbranch_vccz L_spok_299
    s_sleep 3
    s_cmp_lt_u32 s70, 524288
    s_cbranch_scc1 L_spin_298
    s_branch L_c_done_1
L_spok_299:
    s_branch L_v_fl_285_b
L_v_nx_284_s:
    s_sleep 2
    s_branch L_v_nx_284
L_v_gf_288:
    v_max3_u32 v24, v96, v97, v98
    v_max3_u32 v24, v24, v99, v100
    v_max3_u32 v24, v24, v101, v102
    v_max_u32 v24, v24, v103
    v_cmp_eq_u32 vcc, -1, v24
    v_min_u32 v20, -2, v20
    s_add_u32 s70, s70, 1
    s_cbranch_vccz L_v_gok_287
    buffer_load_dword v96, v7, s[12:15], s63 offen offset:0 sc1
    buffer_load_dword v97, v7, s[12:15], s63 offen offset:256 sc1
    buffer_load_dword v98, v7, s[12:15], s63 offen offset:512 sc1
    buffer_load_dword v99, v7, s[12:15], s63 offen offset:768 sc1
    buffer_load_dword v100, v7, s[12:15], s63 offen offset:1024 sc1
    buffer_load_dword v101, v7, s[12:15], s63 offen offset:1280 sc1
    buffer_load_dword v102, v7, s[12:15], s63 offen offset:1536 sc1
    buffer_load_dword v103, v7, s[12:15], s63 offen offset:1792 sc1
    s_cmp_lt_u32 s70, 524288
    s_cbranch_scc1 L_v_gp_286
    s_branch L_c_done_1
L_c_done_1:
    s_endpgm
.section .rodata,"a"
.p2align 6
.amdhsa_kernel k3_chain_kernel
  .amdhsa_next_free_vgpr 256
  .amdhsa_next_free_sgpr 102
  .amdhsa_accum_offset 128
  .amdhsa_group_segment_fixed_size 0
  .amdhsa_kernarg_size 136
  .amdhsa_user_sgpr_count 2
  .amdhsa_user_sgpr_kernarg_segment_ptr 1
  .amdhsa_system_sgpr_workgroup_id_x 1
.end_amdhsa_kernel
```

```asm
; @launch kernel=k3_chain_kernel grid=(256,1,1) block=(512,1,1) lds=147712
.amdgcn_target "amdgcn-amd-amdhsa--gfx950"
.text
.globl k3_chain_kernel
.p2align 8
.type k3_chain_kernel,@function
k3_chain_kernel:
    s_cmp_ge_u32 s2, 256
    s_cbranch_scc1 L_c_done_1
    s_load_dwordx4 s[20:23], s[0:1], 120
    v_and_b32 v1, 63, v0
    v_lshrrev_b32 v2, 6, v0
    s_nop 0
    v_readfirstlane_b32 s44, v2
    s_waitcnt lgkmcnt(0)
    s_mov_b32 s12, s22
    s_and_b32 s13, s23, 0xffff
    s_mov_b32 s14, 0x10000000
    s_mov_b32 s15, 0x00020000
    s_mov_b32 s16, s20
    s_and_b32 s17, s21, 0xffff
    s_mov_b32 s18, 0x100
    s_mov_b32 s19, 0x00020000
    s_getpc_b64 s[24:25]
L_c_here_2:
    v_lshlrev_b32 v3, 7, v0
    v_mov_b32 v5, s25
    v_add_co_u32 v4, vcc, s24, v3
    s_nop 1
    v_addc_co_u32 v5, vcc, 0, v5, vcc
    v_cmp_gt_u32 vcc, L_c_done_1 - L_c_here_2, v3
    s_and_saveexec_b64 s[26:27], vcc
    s_cbranch_execz L_c_ct_3
    global_load_dword v109, v[4:5], off
L_c_ct_3:
    s_mov_b64 exec, s[26:27]
    s_load_dwordx4 s[8:11], s[0:1], 96
    v_lshrrev_b32 v5, 3, v0
    v_mul_u32_u24 v6, 24576, v5
    v_and_b32 v7, 7, v0
    v_lshl_add_u32 v6, v7, 4, v6
    v_add_u32 v7, 12288, v6
    v_lshlrev_b32 v5, 2, v5
    s_lshr_b32 s50, s2, 5
    s_and_b32 s51, s2, 31
    s_mul_i32 s52, s50, 1572864
    s_lshl_b32 s53, s51, 7
    s_add_u32 s52, s52, s53
    s_lshl_b32 s53, s50, 8
    s_waitcnt lgkmcnt(0)
    s_mov_b32 s28, s10
    s_and_b32 s29, s11, 0xffff
    s_mov_b32 s30, 0xc00000
    s_mov_b32 s31, 0x00020000
    s_mov_b32 s32, s8
    s_and_b32 s33, s9, 0xffff
    s_mov_b32 s34, 0x800
    s_mov_b32 s35, 0x00020000
    buffer_load_dword v8, v5, s[32:35], s53 offen
    buffer_load_dwordx4 v[12:15], v6, s[28:31], s52 offen nt
    buffer_load_dwordx4 v[16:19], v7, s[28:31], s52 offen nt
    s_getreg_b32 s39, hwreg(HW_REG_XCC_ID)
    s_and_b32 s39, s39, 7
    s_cmp_lg_u32 s44, 1
    s_cbranch_scc1 L_nz_7
    v_mov_b32 v32, 0
    v_mov_b32 v33, 0
    v_mov_b32 v34, 0
    v_mov_b32 v35, 0
    v_lshlrev_b32 v4, 4, v1
    s_lshl_b32 s45, s2, 10
    s_add_u32 s45, s45, 0x100000
    buffer_store_dwordx4 v[32:35], v4, s[12:15], s45 offen sc1
L_nz_7:
    s_waitcnt vmcnt(0)
    v_lshlrev_b32 v9, 16, v8
    v_and_b32 v10, 0xffff0000, v8
    v_mul_f32 v20, 0xbfb8aa3b, v9
    v_mul_f32 v21, 0xbfb8aa3b, v10
    v_exp_f32 v20, v20
    v_exp_f32 v21, v21
    s_nop 0
    v_add_f32 v20, 1.0, v20
    v_add_f32 v21, 1.0, v21
    v_rcp_f32 v20, v20
    v_rcp_f32 v21, v21
    s_nop 0
    v_mul_f32 v9, v9, v20
    v_mul_f32 v10, v10, v21
    v_cvt_pk_bf16_f32 v9, 0, v9
    v_cvt_pk_bf16_f32 v10, 0, v10
    v_lshlrev_b32 v28, 16, v12
    v_and_b32 v29, 0xffff0000, v12
    v_lshlrev_b32 v30, 16, v16
    v_and_b32 v31, 0xffff0000, v16
    v_mul_f32 v20, v28, v9
    v_mul_f32 v21, v29, v9
    v_fmac_f32 v20, v30, v10
    v_fmac_f32 v21, v31, v10
    v_lshlrev_b32 v28, 16, v13
    v_and_b32 v29, 0xffff0000, v13
    v_lshlrev_b32 v30, 16, v17
    v_and_b32 v31, 0xffff0000, v17
    v_mul_f32 v22, v28, v9
    v_mul_f32 v23, v29, v9
    v_fmac_f32 v22, v30, v10
    v_fmac_f32 v23, v31, v10
    v_lshlrev_b32 v28, 16, v14
    v_and_b32 v29, 0xffff0000, v14
    v_lshlrev_b32 v30, 16, v18
    v_and_b32 v31, 0xffff0000, v18
    v_mul_f32 v24, v28, v9
    v_mul_f32 v25, v29, v9
    v_fmac_f32 v24, v30, v10
    v_fmac_f32 v25, v31, v10
    v_lshlrev_b32 v28, 16, v15
    v_and_b32 v29, 0xffff0000, v15
    v_lshlrev_b32 v30, 16, v19
    v_and_b32 v31, 0xffff0000, v19
    v_mul_f32 v26, v28, v9
    v_mul_f32 v27, v29, v9
    v_fmac_f32 v26, v30, v10
    v_fmac_f32 v27, v31, v10
    s_nop 1
    v_add_f32_dpp v20, v20, v20 row_ror:8 row_mask:0xf bank_mask:0xf
    v_add_f32_dpp v21, v21, v21 row_ror:8 row_mask:0xf bank_mask:0xf
    v_add_f32_dpp v22, v22, v22 row_ror:8 row_mask:0xf bank_mask:0xf
    v_add_f32_dpp v23, v23, v23 row_ror:8 row_mask:0xf bank_mask:0xf
    v_add_f32_dpp v24, v24, v24 row_ror:8 row_mask:0xf bank_mask:0xf
    v_add_f32_dpp v25, v25, v25 row_ror:8 row_mask:0xf bank_mask:0xf
    v_add_f32_dpp v26, v26, v26 row_ror:8 row_mask:0xf bank_mask:0xf
    v_add_f32_dpp v27, v27, v27 row_ror:8 row_mask:0xf bank_mask:0xf
    s_nop 1
    v_permlane16_swap_b32 v20, v24
    v_permlane16_swap_b32 v21, v25
    v_permlane16_swap_b32 v22, v26
    v_permlane16_swap_b32 v23, v27
    v_add_f32 v20, v20, v24
    v_add_f32 v21, v21, v25
    v_add_f32 v22, v22, v26
    v_add_f32 v23, v23, v27
    s_nop 1
    v_permlane32_swap_b32 v20, v22
    v_permlane32_swap_b32 v21, v23
    v_add_f32 v20, v20, v22
    v_add_f32 v21, v21, v23
    v_and_b32 v22, 7, v1
    v_lshlrev_b32 v22, 5, v22
    v_bfe_u32 v23, v1, 4, 1
    v_lshl_add_u32 v22, v23, 4, v22
    v_lshrrev_b32 v23, 5, v1
    v_lshl_add_u32 v22, v23, 3, v22
    s_lshl_b32 s52, s44, 8
    s_add_u32 s52, s52, 139776
    v_add_u32 v22, s52, v22
    ds_write_b64 v22, v[20:21]
    s_waitcnt lgkmcnt(0)
    s_barrier
    s_cmp_lg_u32 s44, 1
    s_cbranch_scc1 L_m1_8
    v_lshlrev_b32 v22, 2, v1
    v_add_u32 v23, 139776, v22
    ds_read_b32 v24, v23 offset:0
    ds_read_b32 v25, v23 offset:256
    ds_read_b32 v26, v23 offset:512
    ds_read_b32 v27, v23 offset:768
    ds_read_b32 v28, v23 offset:1024
    ds_read_b32 v29, v23 offset:1280
    ds_read_b32 v30, v23 offset:1536
    ds_read_b32 v31, v23 offset:1792
    s_waitcnt lgkmcnt(0)
    v_add_f32 v24, v24, v28
    v_add_f32 v25, v25, v29
    v_add_f32 v26, v26, v30
    v_add_f32 v27, v27, v31
    v_add_f32 v24, v24, v26
    v_add_f32 v25, v25, v27
    v_add_f32 v24, v24, v25
    s_lshl_b32 s52, s2, 8
    s_add_u32 s52, s52, 0x10000
    buffer_store_dword v24, v22, s[12:15], s52 offen sc1
L_m1_8:
    s_cmp_lg_u32 s44, 1
    s_cbranch_scc1 L_tk_4
    v_mov_b32 v3, 1
    s_mov_b32 s40, s39
    s_lshl_b32 s45, s40, 5
    v_mov_b32 v4, 0
    s_waitcnt vmcnt(0)
    s_mov_b64 exec, 1
    buffer_atomic_add v3, v4, s[16:19], s45 offen sc0
    s_waitcnt vmcnt(0)
    v_readfirstlane_b32 s41, v3
    s_nop 3
    s_cmp_lt_u32 s41, 32
    s_cbranch_scc1 L_got_5
    v_mov_b32 v3, 1
    buffer_atomic_add v3, v4, s[16:19], 0 offen offset:16 sc0
    s_waitcnt vmcnt(0)
    v_readfirstlane_b32 s46, v3
    s_mov_b64 exec, -1
    v_and_b32 v4, 7, v1
    v_lshlrev_b32 v4, 5, v4
    s_mov_b32 s70, 0
L_sp_6:
    s_sleep 8
    buffer_load_dword v3, v4, s[16:19], 0 offen sc1
    s_waitcnt vmcnt(0)
    s_mov_b32 s48, 0
    v_readlane_b32 s50, v3, 0
    v_readlane_b32 s51, v3, 1
    v_readlane_b32 s52, v3, 2
    v_readlane_b32 s53, v3, 3
    v_readlane_b32 s54, v3, 4
    v_readlane_b32 s55, v3, 5
    v_readlane_b32 s56, v3, 6
    v_readlane_b32 s57, v3, 7
    s_nop 3
    s_add_u32 s48, s48, s50
    s_add_u32 s48, s48, s51
    s_add_u32 s48, s48, s52
    s_add_u32 s48, s48, s53
    s_add_u32 s48, s48, s54
    s_add_u32 s48, s48, s55
    s_add_u32 s48, s48, s56
    s_add_u32 s48, s48, s57
    s_add_u32 s70, s70, 1
    s_cmp_ge_u32 s70, 524288
    s_cbranch_scc1 L_c_done_1
    s_cmp_lt_u32 s48, 256
    s_cbranch_scc1 L_sp_6
    s_min_u32 s48, s50, 32
    s_mov_b32 s40, 0
    s_add_u32 s41, s48, s46
    s_cmp_lt_u32 s41, 32
    s_cbranch_scc1 L_got_5
    s_sub_u32 s46, s41, 32
    s_min_u32 s48, s51, 32
    s_mov_b32 s40, 1
    s_add_u32 s41, s48, s46
    s_cmp_lt_u32 s41, 32
    s_cbranch_scc1 L_got_5
    s_sub_u32 s46, s41, 32
    s_min_u32 s48, s52, 32
    s_mov_b32 s40, 2
    s_add_u32 s41, s48, s46
    s_cmp_lt_u32 s41, 32
    s_cbranch_scc1 L_got_5
    s_sub_u32 s46, s41, 32
    s_min_u32 s48, s53, 32
    s_mov_b32 s40, 3
    s_add_u32 s41, s48, s46
    s_cmp_lt_u32 s41, 32
    s_cbranch_scc1 L_got_5
    s_sub_u32 s46, s41, 32
    s_min_u32 s48, s54, 32
    s_mov_b32 s40, 4
    s_add_u32 s41, s48, s46
    s_cmp_lt_u32 s41, 32
    s_cbranch_scc1 L_got_5
    s_sub_u32 s46, s41, 32
    s_min_u32 s48, s55, 32
    s_mov_b32 s40, 5
    s_add_u32 s41, s48, s46
    s_cmp_lt_u32 s41, 32
    s_cbranch_scc1 L_got_5
    s_sub_u32 s46, s41, 32
    s_min_u32 s48, s56, 32
    s_mov_b32 s40, 6
    s_add_u32 s41, s48, s46
    s_cmp_lt_u32 s41, 32
    s_cbranch_scc1 L_got_5
    s_sub_u32 s46, s41, 32
    s_min_u32 s48, s57, 32
    s_mov_b32 s40, 7
    s_add_u32 s41, s48, s46
    s_cmp_lt_u32 s41, 32
    s_cbranch_scc1 L_got_5
    s_sub_u32 s46, s41, 32
    s_branch L_c_done_1
L_got_5:
    s_mov_b64 exec, -1
    s_lshl_b32 s45, s40, 8
    s_or_b32 s45, s45, s41
    v_mov_b32 v3, s45
    v_mov_b32 v4, 147464
    ds_write_b32 v4, v3
    s_waitcnt lgkmcnt(0)
L_tk_4:
    s_barrier
    v_mov_b32 v4, 147464
    ds_read_b32 v3, v4
    s_waitcnt lgkmcnt(0)
    v_readfirstlane_b32 s45, v3
    s_nop 3
    s_lshr_b32 s40, s45, 8
    s_and_b32 s41, s45, 0xff
    s_lshr_b32 s45, s40, 2
    s_xor_b32 s45, s45, 1
    s_lshl_b32 s45, s45, 4
    s_and_b32 s40, s40, 3
    s_lshl_b32 s40, s40, 1
    s_lshr_b32 s46, s41, 4
    s_add_u32 s40, s40, s46
    s_and_b32 s41, s41, 15
    s_add_u32 s41, s41, s45
    s_cmp_lt_u32 s41, 16
    s_cbranch_scc1 L_c_chain_9
    s_sub_u32 s48, s41, 16
    s_mov_b32 s78, 1
    s_cmp_lt_u32 s48, 12
    s_cbranch_scc1 L_w_g_10
    s_and_b32 s42, s48, 3
    s_mov_b32 s43, s40
    s_load_dwordx2 s[4:5], s[0:1], 0
    v_lshlrev_b32 v2, 4, v1
    v_lshlrev_b32 v3, 5, v1
    s_lshl_b32 s55, s43, 2
    s_add_u32 s55, s55, s42
    s_waitcnt lgkmcnt(0)
    s_mov_b32 s24, s4
    s_and_b32 s25, s5, 0xffff
    s_mov_b32 s26, 0x400000
    s_mov_b32 s27, 0x00020000
    s_lshl_b32 s46, s42, 3
    s_add_u32 s46, s46, s44
    s_lshl_b32 s46, s46, 11
    v_add_u32 v7, s46, v2
    s_lshl_b32 s63, s43, 16
    buffer_load_dwordx4 a[0:3], v7, s[24:27], s63 offen
    buffer_load_dwordx4 a[4:7], v7, s[24:27], s63 offen offset:1024
    s_cmp_lg_u32 s44, 0
    s_cbranch_scc1 L_zwok_19
    v_and_b32 v8, 7, v1
    v_lshlrev_b32 v8, 5, v8
    s_mov_b32 s70, 0
L_zw_18:
    buffer_load_dword v9, v8, s[16:19], 0 offen sc1
    s_waitcnt vmcnt(0)
    v_add_u32_dpp v9, v9, v9 row_ror:1 row_mask:0xf bank_mask:0xf
    s_nop 1
    v_add_u32_dpp v9, v9, v9 row_ror:2 row_mask:0xf bank_mask:0xf
    s_nop 1
    v_add_u32_dpp v9, v9, v9 row_ror:4 row_mask:0xf bank_mask:0xf
    v_cmp_ne_u32 vcc, 0x100, v9
    s_add_u32 s70, s70, 1
    s_cbranch_vccz L_zwok_19
    s_sleep 4
    s_cmp_lt_u32 s70, 524288
    s_cbranch_scc1 L_zw_18
    s_branch L_c_done_1
L_zwok_19:
    s_barrier
    v_lshlrev_b32 v4, 4, v0
    s_mov_b32 s46, 0x10000
    buffer_load_dwordx4 v[32:35], v4, s[12:15], s46 offen sc1
    s_mov_b32 s46, 0x12000
    buffer_load_dwordx4 v[36:39], v4, s[12:15], s46 offen sc1
    s_mov_b32 s46, 0x14000
    buffer_load_dwordx4 v[40:43], v4, s[12:15], s46 offen sc1
    s_mov_b32 s46, 0x16000
    buffer_load_dwordx4 v[44:47], v4, s[12:15], s46 offen sc1
    s_mov_b32 s46, 0x18000
    buffer_load_dwordx4 v[48:51], v4, s[12:15], s46 offen sc1
    s_mov_b32 s46, 0x1a000
    buffer_load_dwordx4 v[52:55], v4, s[12:15], s46 offen sc1
    s_mov_b32 s46, 0x1c000
    buffer_load_dwordx4 v[56:59], v4, s[12:15], s46 offen sc1
    s_mov_b32 s46, 0x1e000
    buffer_load_dwordx4 v[60:63], v4, s[12:15], s46 offen sc1
    s_cmp_lg_u32 s44, 0
    s_cbranch_scc1 L_l_nx_20
    s_cmp_ge_u32 s42, 2
    s_cbranch_scc1 L_l_nx_20
    s_or_b32 s47, s39, 0x100
    v_mov_b32 v8, s47
    v_mov_b32 v9, 0
    s_lshl_b32 s46, s40, 3
    s_lshl_b32 s47, s42, 2
    s_add_u32 s46, s46, s47
    s_add_u32 s46, s46, 0x101200
    s_mov_b64 exec, 1
    buffer_store_dword v8, v9, s[12:15], s46 offen sc1
    s_mov_b64 exec, -1
L_l_nx_20:
    s_mul_i32 s46, s44, 2064
    s_add_u32 s46, s46, 32768
    v_add_u32 v10, s46, v2
    v_and_b32 v11, 7, v1
    v_lshrrev_b32 v12, 3, v1
    v_mul_u32_u24 v13, 2064, v11
    v_lshl_add_u32 v13, v12, 4, v13
    s_lshl_b32 s46, s44, 8
    s_add_u32 s46, s46, 32768
    v_add_u32 v13, s46, v13
    v_lshlrev_b32 v11, 4, v11
    v_lshl_add_u32 v11, v12, 9, v11
    s_lshl_b32 s46, s44, 13
    s_lshl_b32 s47, s42, 7
    s_add_u32 s46, s46, s47
    s_add_u32 s46, s46, 0x400000
    v_add_u32 v11, s46, v11
    v_add_u32 v12, 4096, v11
    s_lshl_b32 s52, s43, 9
    s_lshl_b32 s47, s42, 7
    s_add_u32 s52, s52, s47
    s_add_u32 s52, s52, 0x109400
    s_mov_b32 s60, s43
    s_waitcnt vmcnt(0)
    v_add_f32 v32, v32, v48
    v_add_f32 v33, v33, v49
    v_add_f32 v34, v34, v50
    v_add_f32 v35, v35, v51
    v_add_f32 v36, v36, v52
    v_add_f32 v37, v37, v53
    v_add_f32 v38, v38, v54
    v_add_f32 v39, v39, v55
    v_add_f32 v40, v40, v56
    v_add_f32 v41, v41, v57
    v_add_f32 v42, v42, v58
    v_add_f32 v43, v43, v59
    v_add_f32 v44, v44, v60
    v_add_f32 v45, v45, v61
    v_add_f32 v46, v46, v62
    v_add_f32 v47, v47, v63
    v_add_f32 v32, v32, v40
    v_add_f32 v33, v33, v41
    v_add_f32 v34, v34, v42
    v_add_f32 v35, v35, v43
    v_add_f32 v36, v36, v44
    v_add_f32 v37, v37, v45
    v_add_f32 v38, v38, v46
    v_add_f32 v39, v39, v47
    v_add_f32 v32, v32, v36
    v_add_f32 v33, v33, v37
    v_add_f32 v34, v34, v38
    v_add_f32 v35, v35, v39
    v_cvt_pk_bf16_f32 v32, 0, v32
    v_cvt_pk_bf16_f32 v33, 0, v33
    v_cvt_pk_bf16_f32 v34, 0, v34
    v_cvt_pk_bf16_f32 v35, 0, v35
    ds_write_b128 v4, v[32:35]
    s_waitcnt lgkmcnt(0)
    s_barrier
    ds_read_b128 v[48:51], v3 offset:0
    ds_read_b128 v[52:55], v3 offset:16
    ds_read_b128 v[56:59], v3 offset:2048
    ds_read_b128 v[60:63], v3 offset:2064
    ds_read_b128 v[32:35], v3 offset:4096
    ds_read_b128 v[36:39], v3 offset:4112
    ds_read_b128 v[40:43], v3 offset:6144
    ds_read_b128 v[44:47], v3 offset:6160
    s_waitcnt lgkmcnt(0)
    v_add_f32 v32, 1.0, v32
    v_add_f32 v33, 1.0, v33
    v_add_f32 v34, 1.0, v34
    v_add_f32 v35, 1.0, v35
    v_add_f32 v36, 1.0, v36
    v_add_f32 v37, 1.0, v37
    v_add_f32 v38, 1.0, v38
    v_add_f32 v39, 1.0, v39
    v_add_f32 v40, 1.0, v40
    v_add_f32 v41, 1.0, v41
    v_add_f32 v42, 1.0, v42
    v_add_f32 v43, 1.0, v43
    v_add_f32 v44, 1.0, v44
    v_add_f32 v45, 1.0, v45
    v_add_f32 v46, 1.0, v46
    v_add_f32 v47, 1.0, v47
    v_cvt_pk_bf16_f32 v32, 0, v32
    v_cvt_pk_bf16_f32 v33, 0, v33
    v_cvt_pk_bf16_f32 v34, 0, v34
    v_cvt_pk_bf16_f32 v35, 0, v35
    v_cvt_pk_bf16_f32 v36, 0, v36
    v_cvt_pk_bf16_f32 v37, 0, v37
    v_cvt_pk_bf16_f32 v38, 0, v38
    v_cvt_pk_bf16_f32 v39, 0, v39
    v_cvt_pk_bf16_f32 v40, 0, v40
    v_cvt_pk_bf16_f32 v41, 0, v41
    v_cvt_pk_bf16_f32 v42, 0, v42
    v_cvt_pk_bf16_f32 v43, 0, v43
    v_cvt_pk_bf16_f32 v44, 0, v44
    v_cvt_pk_bf16_f32 v45, 0, v45
    v_cvt_pk_bf16_f32 v46, 0, v46
    v_cvt_pk_bf16_f32 v47, 0, v47
L_l_sub_21:
    s_lshl_b32 s63, s60, 16
    v_accvgpr_read_b32 v96, a0
    v_accvgpr_read_b32 v97, a1
    v_accvgpr_read_b32 v98, a2
    v_accvgpr_read_b32 v99, a3
    v_accvgpr_read_b32 v100, a4
    v_accvgpr_read_b32 v101, a5
    v_accvgpr_read_b32 v102, a6
    v_accvgpr_read_b32 v103, a7
    v_lshlrev_b32 v64, 16, v96
    v_and_b32 v65, 0xffff0000, v96
    v_lshlrev_b32 v66, 16, v97
    v_and_b32 v67, 0xffff0000, v97
    v_lshlrev_b32 v68, 16, v98
    v_and_b32 v69, 0xffff0000, v98
    v_lshlrev_b32 v70, 16, v99
    v_and_b32 v71, 0xffff0000, v99
    v_lshlrev_b32 v72, 16, v100
    v_and_b32 v73, 0xffff0000, v100
    v_lshlrev_b32 v74, 16, v101
    v_and_b32 v75, 0xffff0000, v101
    v_lshlrev_b32 v76, 16, v102
    v_and_b32 v77, 0xffff0000, v102
    v_lshlrev_b32 v78, 16, v103
    v_and_b32 v79, 0xffff0000, v103
    v_pk_add_f32 v[80:81], v[64:65], v[72:73]
    v_pk_add_f32 v[82:83], v[66:67], v[74:75]
    v_pk_add_f32 v[84:85], v[68:69], v[76:77]
    v_pk_add_f32 v[86:87], v[70:71], v[78:79]
    v_pk_add_f32 v[80:81], v[80:81], v[84:85]
    v_pk_add_f32 v[82:83], v[82:83], v[86:87]
    v_pk_add_f32 v[80:81], v[80:81], v[82:83]
    v_add_f32 v14, v80, v81
    s_nop 1
    v_add_f32_dpp v14, v14, v14 row_shr:1 row_mask:0xf bank_mask:0xf bound_ctrl:0
    s_nop 1
    v_add_f32_dpp v14, v14, v14 row_shr:2 row_mask:0xf bank_mask:0xf bound_ctrl:0
    s_nop 1
    v_add_f32_dpp v14, v14, v14 row_shr:4 row_mask:0xf bank_mask:0xf bound_ctrl:0
    s_nop 1
    v_add_f32_dpp v14, v14, v14 row_shr:8 row_mask:0xf bank_mask:0xf bound_ctrl:0
    s_nop 1
    v_add_f32_dpp v14, v14, v14 row_bcast:15 row_mask:0xa bank_mask:0xf
    s_nop 1
    v_add_f32_dpp v14, v14, v14 row_bcast:31 row_mask:0xc bank_mask:0xf
    s_nop 1
    v_readlane_b32 s46, v14, 63
    s_nop 1
    v_mov_b32 v15, s46
    v_mul_f32 v15, 0x3a800000, v15
    v_pk_add_f32 v[80:81], v[64:65], v[14:15] op_sel:[0,1] op_sel_hi:[1,1] neg_lo:[0,1] neg_hi:[0,1]
    v_pk_add_f32 v[82:83], v[66:67], v[14:15] op_sel:[0,1] op_sel_hi:[1,1] neg_lo:[0,1] neg_hi:[0,1]
    v_pk_add_f32 v[84:85], v[68:69], v[14:15] op_sel:[0,1] op_sel_hi:[1,1] neg_lo:[0,1] neg_hi:[0,1]
    v_pk_add_f32 v[86:87], v[70:71], v[14:15] op_sel:[0,1] op_sel_hi:[1,1] neg_lo:[0,1] neg_hi:[0,1]
    v_pk_add_f32 v[88:89], v[72:73], v[14:15] op_sel:[0,1] op_sel_hi:[1,1] neg_lo:[0,1] neg_hi:[0,1]
    v_pk_add_f32 v[90:91], v[74:75], v[14:15] op_sel:[0,1] op_sel_hi:[1,1] neg_lo:[0,1] neg_hi:[0,1]
    v_pk_add_f32 v[92:93], v[76:77], v[14:15] op_sel:[0,1] op_sel_hi:[1,1] neg_lo:[0,1] neg_hi:[0,1]
    v_pk_add_f32 v[94:95], v[78:79], v[14:15] op_sel:[0,1] op_sel_hi:[1,1] neg_lo:[0,1] neg_hi:[0,1]
    v_pk_mul_f32 v[104:105], v[80:81], v[80:81]
    v_pk_mul_f32 v[106:107], v[82:83], v[82:83]
    v_pk_fma_f32 v[104:105], v[84:85], v[84:85], v[104:105]
    v_pk_fma_f32 v[106:107], v[86:87], v[86:87], v[106:107]
    v_pk_fma_f32 v[104:105], v[88:89], v[88:89], v[104:105]
    v_pk_fma_f32 v[106:107], v[90:91], v[90:91], v[106:107]
    v_pk_fma_f32 v[104:105], v[92:93], v[92:93], v[104:105]
    v_pk_fma_f32 v[106:107], v[94:95], v[94:95], v[106:107]
    v_pk_add_f32 v[104:105], v[104:105], v[106:107]
    v_add_f32 v14, v104, v105
    v_cvt_pk_bf16_f32 v15, 0, v15
    s_nop 1
    v_add_f32_dpp v14, v14, v14 row_shr:1 row_mask:0xf bank_mask:0xf bound_ctrl:0
    s_nop 1
    v_add_f32_dpp v14, v14, v14 row_shr:2 row_mask:0xf bank_mask:0xf bound_ctrl:0
    s_nop 1
    v_add_f32_dpp v14, v14, v14 row_shr:4 row_mask:0xf bank_mask:0xf bound_ctrl:0
    s_nop 1
    v_add_f32_dpp v14, v14, v14 row_shr:8 row_mask:0xf bank_mask:0xf bound_ctrl:0
    s_nop 1
    v_add_f32_dpp v14, v14, v14 row_bcast:15 row_mask:0xa bank_mask:0xf
    s_nop 1
    v_add_f32_dpp v14, v14, v14 row_bcast:31 row_mask:0xc bank_mask:0xf
    s_nop 1
    v_readlane_b32 s47, v14, 63
    v_pk_add_f32 v[64:65], v[64:65], v[14:15] op_sel:[0,1] op_sel_hi:[1,1] neg_lo:[0,1] neg_hi:[0,1]
    v_pk_add_f32 v[66:67], v[66:67], v[14:15] op_sel:[0,1] op_sel_hi:[1,1] neg_lo:[0,1] neg_hi:[0,1]
    v_pk_add_f32 v[68:69], v[68:69], v[14:15] op_sel:[0,1] op_sel_hi:[1,1] neg_lo:[0,1] neg_hi:[0,1]
    v_pk_add_f32 v[70:71], v[70:71], v[14:15] op_sel:[0,1] op_sel_hi:[1,1] neg_lo:[0,1] neg_hi:[0,1]
    v_pk_add_f32 v[72:73], v[72:73], v[14:15] op_sel:[0,1] op_sel_hi:[1,1] neg_lo:[0,1] neg_hi:[0,1]
    v_pk_add_f32 v[74:75], v[74:75], v[14:15] op_sel:[0,1] op_sel_hi:[1,1] neg_lo:[0,1] neg_hi:[0,1]
    v_pk_add_f32 v[76:77], v[76:77], v[14:15] op_sel:[0,1] op_sel_hi:[1,1] neg_lo:[0,1] neg_hi:[0,1]
    v_pk_add_f32 v[78:79], v[78:79], v[14:15] op_sel:[0,1] op_sel_hi:[1,1] neg_lo:[0,1] neg_hi:[0,1]
    v_mov_b32 v14, s47
    v_mul_f32 v14, 0x3a800000, v14
    v_cvt_pk_bf16_f32 v14, 0, v14
    v_add_f32 v14, 0x3727c5ac, v14
    v_cvt_pk_bf16_f32 v14, 0, v14
    v_sqrt_f32 v14, v14
    s_nop 0
    v_cvt_pk_bf16_f32 v14, 0, v14
    v_rcp_f32 v14, v14
    v_cvt_pk_bf16_f32 v64, 0, v64
    v_cvt_pk_bf16_f32 v65, 0, v65
    v_cvt_pk_bf16_f32 v66, 0, v66
    v_cvt_pk_bf16_f32 v67, 0, v67
    v_cvt_pk_bf16_f32 v68, 0, v68
    v_cvt_pk_bf16_f32 v69, 0, v69
    v_cvt_pk_bf16_f32 v70, 0, v70
    v_cvt_pk_bf16_f32 v71, 0, v71
    v_cvt_pk_bf16_f32 v72, 0, v72
    v_cvt_pk_bf16_f32 v73, 0, v73
    v_cvt_pk_bf16_f32 v74, 0, v74
    v_cvt_pk_bf16_f32 v75, 0, v75
    v_cvt_pk_bf16_f32 v76, 0, v76
    v_cvt_pk_bf16_f32 v77, 0, v77
    v_cvt_pk_bf16_f32 v78, 0, v78
    v_cvt_pk_bf16_f32 v79, 0, v79
    v_pk_mul_f32 v[64:65], v[64:65], v[14:15] op_sel_hi:[1,0]
    v_pk_mul_f32 v[66:67], v[66:67], v[14:15] op_sel_hi:[1,0]
    v_pk_mul_f32 v[68:69], v[68:69], v[14:15] op_sel_hi:[1,0]
    v_pk_mul_f32 v[70:71], v[70:71], v[14:15] op_sel_hi:[1,0]
    v_pk_mul_f32 v[72:73], v[72:73], v[14:15] op_sel_hi:[1,0]
    v_pk_mul_f32 v[74:75], v[74:75], v[14:15] op_sel_hi:[1,0]
    v_pk_mul_f32 v[76:77], v[76:77], v[14:15] op_sel_hi:[1,0]
    v_pk_mul_f32 v[78:79], v[78:79], v[14:15] op_sel_hi:[1,0]
    v_cvt_pk_bf16_f32 v64, 0, v64
    v_cvt_pk_bf16_f32 v65, 0, v65
    v_cvt_pk_bf16_f32 v66, 0, v66
    v_cvt_pk_bf16_f32 v67, 0, v67
    v_cvt_pk_bf16_f32 v68, 0, v68
    v_cvt_pk_bf16_f32 v69, 0, v69
    v_cvt_pk_bf16_f32 v70, 0, v70
    v_cvt_pk_bf16_f32 v71, 0, v71
    v_cvt_pk_bf16_f32 v72, 0, v72
    v_cvt_pk_bf16_f32 v73, 0, v73
    v_cvt_pk_bf16_f32 v74, 0, v74
    v_cvt_pk_bf16_f32 v75, 0, v75
    v_cvt_pk_bf16_f32 v76, 0, v76
    v_cvt_pk_bf16_f32 v77, 0, v77
    v_cvt_pk_bf16_f32 v78, 0, v78
    v_cvt_pk_bf16_f32 v79, 0, v79
    v_pk_mul_f32 v[64:65], v[64:65], v[32:33]
    v_pk_mul_f32 v[66:67], v[66:67], v[34:35]
    v_pk_mul_f32 v[68:69], v[68:69], v[36:37]
    v_pk_mul_f32 v[70:71], v[70:71], v[38:39]
    v_pk_mul_f32 v[72:73], v[72:73], v[40:41]
    v_pk_mul_f32 v[74:75], v[74:75], v[42:43]
    v_pk_mul_f32 v[76:77], v[76:77], v[44:45]
    v_pk_mul_f32 v[78:79], v[78:79], v[46:47]
    v_cvt_pk_bf16_f32 v64, 0, v64
    v_cvt_pk_bf16_f32 v65, 0, v65
    v_cvt_pk_bf16_f32 v66, 0, v66
    v_cvt_pk_bf16_f32 v67, 0, v67
    v_cvt_pk_bf16_f32 v68, 0, v68
    v_cvt_pk_bf16_f32 v69, 0, v69
    v_cvt_pk_bf16_f32 v70, 0, v70
    v_cvt_pk_bf16_f32 v71, 0, v71
    v_cvt_pk_bf16_f32 v72, 0, v72
    v_cvt_pk_bf16_f32 v73, 0, v73
    v_cvt_pk_bf16_f32 v74, 0, v74
    v_cvt_pk_bf16_f32 v75, 0, v75
    v_cvt_pk_bf16_f32 v76, 0, v76
    v_cvt_pk_bf16_f32 v77, 0, v77
    v_cvt_pk_bf16_f32 v78, 0, v78
    v_cvt_pk_bf16_f32 v79, 0, v79
    v_pk_add_f32 v[64:65], v[64:65], v[48:49]
    v_pk_add_f32 v[66:67], v[66:67], v[50:51]
    v_pk_add_f32 v[68:69], v[68:69], v[52:53]
    v_pk_add_f32 v[70:71], v[70:71], v[54:55]
    v_pk_add_f32 v[72:73], v[72:73], v[56:57]
    v_pk_add_f32 v[74:75], v[74:75], v[58:59]
    v_pk_add_f32 v[76:77], v[76:77], v[60:61]
    v_pk_add_f32 v[78:79], v[78:79], v[62:63]
    v_cvt_pk_bf16_f32 v104, v64, v65
    v_cvt_pk_bf16_f32 v105, v66, v67
    v_cvt_pk_bf16_f32 v106, v68, v69
    v_cvt_pk_bf16_f32 v107, v70, v71
    v_cvt_pk_bf16_f32 v108, v72, v73
    v_cvt_pk_bf16_f32 v109, v74, v75
    v_cvt_pk_bf16_f32 v110, v76, v77
    v_cvt_pk_bf16_f32 v111, v78, v79
    ds_write_b128 v10, v[104:107]
    ds_write_b128 v10, v[108:111] offset:1024
    s_waitcnt lgkmcnt(0)
    s_barrier
    ds_read_b128 v[104:107], v13
    ds_read_b128 v[108:111], v13 offset:128
    s_waitcnt lgkmcnt(1)
    buffer_store_dwordx4 v[104:107], v11, s[12:15], s63 offen sc1
    s_waitcnt lgkmcnt(0)
    buffer_store_dwordx4 v[108:111], v12, s[12:15], s63 offen sc1
    s_waitcnt vmcnt(0)
    s_barrier
    s_cmp_lg_u32 s44, 0
    s_cbranch_scc1 L_sf_23
    v_mov_b32 v14, s60
    v_add_u32 v14, 1, v14
    v_mov_b32 v15, 0
    s_mov_b64 exec, 1
    buffer_store_dword v14, v15, s[12:15], s52 offen sc1
    s_mov_b64 exec, -1
L_sf_23:
    s_cmp_ge_u32 s60, 8
    s_cbranch_scc1 L_l_end_22
    s_add_u32 s63, s63, 524288
    buffer_load_dwordx4 a[8:11], v7, s[24:27], s63 offen
    buffer_load_dwordx4 a[12:15], v7, s[24:27], s63 offen offset:1024
    s_add_u32 s63, s63, 524288
    buffer_load_dwordx4 a[16:19], v7, s[24:27], s63 offen
    buffer_load_dwordx4 a[20:23], v7, s[24:27], s63 offen offset:1024
    s_add_u32 s63, s63, 524288
    buffer_load_dwordx4 a[24:27], v7, s[24:27], s63 offen
    buffer_load_dwordx4 a[28:31], v7, s[24:27], s63 offen offset:1024
    s_add_u32 s63, s63, 524288
    buffer_load_dwordx4 a[32:35], v7, s[24:27], s63 offen
    buffer_load_dwordx4 a[36:39], v7, s[24:27], s63 offen offset:1024
    s_add_u32 s63, s63, 524288
    buffer_load_dwordx4 a[40:43], v7, s[24:27], s63 offen
    buffer_load_dwordx4 a[44:47], v7, s[24:27], s63 offen offset:1024
    s_add_u32 s63, s63, 524288
    buffer_load_dwordx4 a[48:51], v7, s[24:27], s63 offen
    buffer_load_dwordx4 a[52:55], v7, s[24:27], s63 offen offset:1024
    s_add_u32 s63, s63, 524288
    buffer_load_dwordx4 a[56:59], v7, s[24:27], s63 offen
    buffer_load_dwordx4 a[60:63], v7, s[24:27], s63 offen offset:1024
    s_waitcnt vmcnt(0)
L_l_end_22:
    v_accvgpr_mov_b32 a0, a8
    v_accvgpr_mov_b32 a1, a9
    v_accvgpr_mov_b32 a2, a10
    v_accvgpr_mov_b32 a3, a11
    v_accvgpr_mov_b32 a4, a12
    v_accvgpr_mov_b32 a5, a13
    v_accvgpr_mov_b32 a6, a14
    v_accvgpr_mov_b32 a7, a15
    v_accvgpr_mov_b32 a8, a16
    v_accvgpr_mov_b32 a9, a17
    v_accvgpr_mov_b32 a10, a18
    v_accvgpr_mov_b32 a11, a19
    v_accvgpr_mov_b32 a12, a20
    v_accvgpr_mov_b32 a13, a21
    v_accvgpr_mov_b32 a14, a22
    v_accvgpr_mov_b32 a15, a23
    v_accvgpr_mov_b32 a16, a24
    v_accvgpr_mov_b32 a17, a25
    v_accvgpr_mov_b32 a18, a26
    v_accvgpr_mov_b32 a19, a27
    v_accvgpr_mov_b32 a20, a28
    v_accvgpr_mov_b32 a21, a29
    v_accvgpr_mov_b32 a22, a30
    v_accvgpr_mov_b32 a23, a31
    v_accvgpr_mov_b32 a24, a32
    v_accvgpr_mov_b32 a25, a33
    v_accvgpr_mov_b32 a26, a34
    v_accvgpr_mov_b32 a27, a35
    v_accvgpr_mov_b32 a28, a36
    v_accvgpr_mov_b32 a29, a37
    v_accvgpr_mov_b32 a30, a38
    v_accvgpr_mov_b32 a31, a39
    v_accvgpr_mov_b32 a32, a40
    v_accvgpr_mov_b32 a33, a41
    v_accvgpr_mov_b32 a34, a42
    v_accvgpr_mov_b32 a35, a43
    v_accvgpr_mov_b32 a36, a44
    v_accvgpr_mov_b32 a37, a45
    v_accvgpr_mov_b32 a38, a46
    v_accvgpr_mov_b32 a39, a47
    v_accvgpr_mov_b32 a40, a48
    v_accvgpr_mov_b32 a41, a49
    v_accvgpr_mov_b32 a42, a50
    v_accvgpr_mov_b32 a43, a51
    v_accvgpr_mov_b32 a44, a52
    v_accvgpr_mov_b32 a45, a53
    v_accvgpr_mov_b32 a46, a54
    v_accvgpr_mov_b32 a47, a55
    v_accvgpr_mov_b32 a48, a56
    v_accvgpr_mov_b32 a49, a57
    v_accvgpr_mov_b32 a50, a58
    v_accvgpr_mov_b32 a51, a59
    v_accvgpr_mov_b32 a52, a60
    v_accvgpr_mov_b32 a53, a61
    v_accvgpr_mov_b32 a54, a62
    v_accvgpr_mov_b32 a55, a63
    s_add_u32 s60, s60, 8
    s_cmp_lt_u32 s60, 64
    s_cbranch_scc1 L_l_sub_21
    s_cmp_lt_u32 s48, 14
    s_cbranch_scc1 L_w_h_17_s
    s_and_b32 s55, s48, 1
    s_lshl_b32 s55, s55, 3
    s_add_u32 s55, s55, s40
    s_load_dwordx4 s[8:11], s[0:1], 96
    v_lshrrev_b32 v5, 3, v0
    s_mov_b32 s46, 196608
    v_mul_lo_u32 v4, v5, s46
    v_and_b32 v6, 7, v0
    v_lshl_add_u32 v4, v6, 4, v4
    v_lshlrev_b32 v5, 5, v5
    s_waitcnt lgkmcnt(0)
    s_mov_b32 s28, s10
    s_and_b32 s29, s11, 0xffff
    s_mov_b32 s30, 0xc00000
    s_mov_b32 s31, 0x00020000
    s_mov_b32 s32, s8
    s_and_b32 s33, s9, 0xffff
    s_mov_b32 s34, 0x800
    s_mov_b32 s35, 0x00020000
    buffer_load_dwordx4 v[8:11], v5, s[32:35], 0 offen
    buffer_load_dwordx4 v[12:15], v5, s[32:35], 0 offen offset:16
    s_waitcnt vmcnt(0)
    v_lshlrev_b32 v16, 16, v8
    v_and_b32 v17, 0xffff0000, v8
    v_lshlrev_b32 v18, 16, v9
    v_and_b32 v19, 0xffff0000, v9
    v_lshlrev_b32 v20, 16, v10
    v_and_b32 v21, 0xffff0000, v10
    v_lshlrev_b32 v22, 16, v11
    v_and_b32 v23, 0xffff0000, v11
    v_lshlrev_b32 v24, 16, v12
    v_and_b32 v25, 0xffff0000, v12
    v_lshlrev_b32 v26, 16, v13
    v_and_b32 v27, 0xffff0000, v13
    v_lshlrev_b32 v28, 16, v14
    v_and_b32 v29, 0xffff0000, v14
    v_lshlrev_b32 v30, 16, v15
    v_and_b32 v31, 0xffff0000, v15
    v_mul_f32 v112, 0xbfb8aa3b, v16
    v_mul_f32 v113, 0xbfb8aa3b, v17
    v_mul_f32 v114, 0xbfb8aa3b, v18
    v_mul_f32 v115, 0xbfb8aa3b, v19
    v_mul_f32 v116, 0xbfb8aa3b, v20
    v_mul_f32 v117, 0xbfb8aa3b, v21
    v_mul_f32 v118, 0xbfb8aa3b, v22
    v_mul_f32 v119, 0xbfb8aa3b, v23
    v_mul_f32 v120, 0xbfb8aa3b, v24
    v_mul_f32 v121, 0xbfb8aa3b, v25
    v_mul_f32 v122, 0xbfb8aa3b, v26
    v_mul_f32 v123, 0xbfb8aa3b, v27
    v_mul_f32 v124, 0xbfb8aa3b, v28
    v_mul_f32 v125, 0xbfb8aa3b, v29
    v_mul_f32 v126, 0xbfb8aa3b, v30
    v_mul_f32 v127, 0xbfb8aa3b, v31
    v_exp_f32 v112, v112
    v_exp_f32 v113, v113
    v_exp_f32 v114, v114
    v_exp_f32 v115, v115
    v_exp_f32 v116, v116
    v_exp_f32 v117, v117
    v_exp_f32 v118, v118
    v_exp_f32 v119, v119
    v_exp_f32 v120, v120
    v_exp_f32 v121, v121
    v_exp_f32 v122, v122
    v_exp_f32 v123, v123
    v_exp_f32 v124, v124
    v_exp_f32 v125, v125
    v_exp_f32 v126, v126
    v_exp_f32 v127, v127
    v_add_f32 v112, 1.0, v112
    v_add_f32 v113, 1.0, v113
    v_add_f32 v114, 1.0, v114
    v_add_f32 v115, 1.0, v115
    v_add_f32 v116, 1.0, v116
    v_add_f32 v117, 1.0, v117
    v_add_f32 v118, 1.0, v118
    v_add_f32 v119, 1.0, v119
    v_add_f32 v120, 1.0, v120
    v_add_f32 v121, 1.0, v121
    v_add_f32 v122, 1.0, v122
    v_add_f32 v123, 1.0, v123
    v_add_f32 v124, 1.0, v124
    v_add_f32 v125, 1.0, v125
    v_add_f32 v126, 1.0, v126
    v_add_f32 v127, 1.0, v127
    v_rcp_f32 v112, v112
    v_rcp_f32 v113, v113
    v_rcp_f32 v114, v114
    v_rcp_f32 v115, v115
    v_rcp_f32 v116, v116
    v_rcp_f32 v117, v117
    v_rcp_f32 v118, v118
    v_rcp_f32 v119, v119
    v_rcp_f32 v120, v120
    v_rcp_f32 v121, v121
    v_rcp_f32 v122, v122
    v_rcp_f32 v123, v123
    v_rcp_f32 v124, v124
    v_rcp_f32 v125, v125
    v_rcp_f32 v126, v126
    v_rcp_f32 v127, v127
    v_mul_f32 v16, v16, v112
    v_mul_f32 v17, v17, v113
    v_mul_f32 v18, v18, v114
    v_mul_f32 v19, v19, v115
    v_mul_f32 v20, v20, v116
    v_mul_f32 v21, v21, v117
    v_mul_f32 v22, v22, v118
    v_mul_f32 v23, v23, v119
    v_mul_f32 v24, v24, v120
    v_mul_f32 v25, v25, v121
    v_mul_f32 v26, v26, v122
    v_mul_f32 v27, v27, v123
    v_mul_f32 v28, v28, v124
    v_mul_f32 v29, v29, v125
    v_mul_f32 v30, v30, v126
    v_mul_f32 v31, v31, v127
    v_cvt_pk_bf16_f32 v16, 0, v16
    v_cvt_pk_bf16_f32 v17, 0, v17
    v_cvt_pk_bf16_f32 v18, 0, v18
    v_cvt_pk_bf16_f32 v19, 0, v19
    v_cvt_pk_bf16_f32 v20, 0, v20
    v_cvt_pk_bf16_f32 v21, 0, v21
    v_cvt_pk_bf16_f32 v22, 0, v22
    v_cvt_pk_bf16_f32 v23, 0, v23
    v_cvt_pk_bf16_f32 v24, 0, v24
    v_cvt_pk_bf16_f32 v25, 0, v25
    v_cvt_pk_bf16_f32 v26, 0, v26
    v_cvt_pk_bf16_f32 v27, 0, v27
    v_cvt_pk_bf16_f32 v28, 0, v28
    v_cvt_pk_bf16_f32 v29, 0, v29
    v_cvt_pk_bf16_f32 v30, 0, v30
    v_cvt_pk_bf16_f32 v31, 0, v31
    s_lshl_b32 s53, s55, 9
    s_add_u32 s53, s53, 4096
L_m_loop_24:
    s_add_u32 s46, s53, 0
    buffer_load_dwordx4 v[32:35], v4, s[28:31], s46 offen nt
    s_add_u32 s46, s53, 12288
    buffer_load_dwordx4 v[36:39], v4, s[28:31], s46 offen nt
    s_add_u32 s46, s53, 24576
    buffer_load_dwordx4 v[40:43], v4, s[28:31], s46 offen nt
    s_add_u32 s46, s53, 36864
    buffer_load_dwordx4 v[44:47], v4, s[28:31], s46 offen nt
    s_add_u32 s46, s53, 49152
    buffer_load_dwordx4 v[48:51], v4, s[28:31], s46 offen nt
    s_add_u32 s46, s53, 61440
    buffer_load_dwordx4 v[52:55], v4, s[28:31], s46 offen nt
    s_add_u32 s46, s53, 73728
    buffer_load_dwordx4 v[56:59], v4, s[28:31], s46 offen nt
    s_add_u32 s46, s53, 86016
    buffer_load_dwordx4 v[60:63], v4, s[28:31], s46 offen nt
    s_add_u32 s46, s53, 98304
    buffer_load_dwordx4 v[64:67], v4, s[28:31], s46 offen nt
    s_add_u32 s46, s53, 110592
    buffer_load_dwordx4 v[68:71], v4, s[28:31], s46 offen nt
    s_add_u32 s46, s53, 122880
    buffer_load_dwordx4 v[72:75], v4, s[28:31], s46 offen nt
    s_add_u32 s46, s53, 135168
    buffer_load_dwordx4 v[76:79], v4, s[28:31], s46 offen nt
    s_add_u32 s46, s53, 147456
    buffer_load_dwordx4 v[80:83], v4, s[28:31], s46 offen nt
    s_add_u32 s46, s53, 159744
    buffer_load_dwordx4 v[84:87], v4, s[28:31], s46 offen nt
    s_add_u32 s46, s53, 172032
    buffer_load_dwordx4 v[88:91], v4, s[28:31], s46 offen nt
    s_add_u32 s46, s53, 184320
    buffer_load_dwordx4 v[92:95], v4, s[28:31], s46 offen nt
    s_waitcnt vmcnt(15)
    v_lshlrev_b32 v104, 16, v32
    v_and_b32 v105, 0xffff0000, v32
    v_mul_f32 v96, v104, v16
    v_mul_f32 v97, v105, v16
    v_lshlrev_b32 v104, 16, v33
    v_and_b32 v105, 0xffff0000, v33
    v_mul_f32 v98, v104, v16
    v_mul_f32 v99, v105, v16
    v_lshlrev_b32 v104, 16, v34
    v_and_b32 v105, 0xffff0000, v34
    v_mul_f32 v100, v104, v16
    v_mul_f32 v101, v105, v16
    v_lshlrev_b32 v104, 16, v35
    v_and_b32 v105, 0xffff0000, v35
    v_mul_f32 v102, v104, v16
    v_mul_f32 v103, v105, v16
    s_waitcnt vmcnt(14)
    v_lshlrev_b32 v104, 16, v36
    v_and_b32 v105, 0xffff0000, v36
    v_fmac_f32 v96, v104, v17
    v_fmac_f32 v97, v105, v17
    v_lshlrev_b32 v104, 16, v37
    v_and_b32 v105, 0xffff0000, v37
    v_fmac_f32 v98, v104, v17
    v_fmac_f32 v99, v105, v17
    v_lshlrev_b32 v104, 16, v38
    v_and_b32 v105, 0xffff0000, v38
    v_fmac_f32 v100, v104, v17
    v_fmac_f32 v101, v105, v17
    v_lshlrev_b32 v104, 16, v39
    v_and_b32 v105, 0xffff0000, v39
    v_fmac_f32 v102, v104, v17
    v_fmac_f32 v103, v105, v17
    s_waitcnt vmcnt(13)
    v_lshlrev_b32 v104, 16, v40
    v_and_b32 v105, 0xffff0000, v40
    v_fmac_f32 v96, v104, v18
    v_fmac_f32 v97, v105, v18
    v_lshlrev_b32 v104, 16, v41
    v_and_b32 v105, 0xffff0000, v41
    v_fmac_f32 v98, v104, v18
    v_fmac_f32 v99, v105, v18
    v_lshlrev_b32 v104, 16, v42
    v_and_b32 v105, 0xffff0000, v42
    v_fmac_f32 v100, v104, v18
    v_fmac_f32 v101, v105, v18
    v_lshlrev_b32 v104, 16, v43
    v_and_b32 v105, 0xffff0000, v43
    v_fmac_f32 v102, v104, v18
    v_fmac_f32 v103, v105, v18
    s_waitcnt vmcnt(12)
    v_lshlrev_b32 v104, 16, v44
    v_and_b32 v105, 0xffff0000, v44
    v_fmac_f32 v96, v104, v19
    v_fmac_f32 v97, v105, v19
    v_lshlrev_b32 v104, 16, v45
    v_and_b32 v105, 0xffff0000, v45
    v_fmac_f32 v98, v104, v19
    v_fmac_f32 v99, v105, v19
    v_lshlrev_b32 v104, 16, v46
    v_and_b32 v105, 0xffff0000, v46
    v_fmac_f32 v100, v104, v19
    v_fmac_f32 v101, v105, v19
    v_lshlrev_b32 v104, 16, v47
    v_and_b32 v105, 0xffff0000, v47
    v_fmac_f32 v102, v104, v19
    v_fmac_f32 v103, v105, v19
    s_waitcnt vmcnt(11)
    v_lshlrev_b32 v104, 16, v48
    v_and_b32 v105, 0xffff0000, v48
    v_fmac_f32 v96, v104, v20
    v_fmac_f32 v97, v105, v20
    v_lshlrev_b32 v104, 16, v49
    v_and_b32 v105, 0xffff0000, v49
    v_fmac_f32 v98, v104, v20
    v_fmac_f32 v99, v105, v20
    v_lshlrev_b32 v104, 16, v50
    v_and_b32 v105, 0xffff0000, v50
    v_fmac_f32 v100, v104, v20
    v_fmac_f32 v101, v105, v20
    v_lshlrev_b32 v104, 16, v51
    v_and_b32 v105, 0xffff0000, v51
    v_fmac_f32 v102, v104, v20
    v_fmac_f32 v103, v105, v20
    s_waitcnt vmcnt(10)
    v_lshlrev_b32 v104, 16, v52
    v_and_b32 v105, 0xffff0000, v52
    v_fmac_f32 v96, v104, v21
    v_fmac_f32 v97, v105, v21
    v_lshlrev_b32 v104, 16, v53
    v_and_b32 v105, 0xffff0000, v53
    v_fmac_f32 v98, v104, v21
    v_fmac_f32 v99, v105, v21
    v_lshlrev_b32 v104, 16, v54
    v_and_b32 v105, 0xffff0000, v54
    v_fmac_f32 v100, v104, v21
    v_fmac_f32 v101, v105, v21
    v_lshlrev_b32 v104, 16, v55
    v_and_b32 v105, 0xffff0000, v55
    v_fmac_f32 v102, v104, v21
    v_fmac_f32 v103, v105, v21
    s_waitcnt vmcnt(9)
    v_lshlrev_b32 v104, 16, v56
    v_and_b32 v105, 0xffff0000, v56
    v_fmac_f32 v96, v104, v22
    v_fmac_f32 v97, v105, v22
    v_lshlrev_b32 v104, 16, v57
    v_and_b32 v105, 0xffff0000, v57
    v_fmac_f32 v98, v104, v22
    v_fmac_f32 v99, v105, v22
    v_lshlrev_b32 v104, 16, v58
    v_and_b32 v105, 0xffff0000, v58
    v_fmac_f32 v100, v104, v22
    v_fmac_f32 v101, v105, v22
    v_lshlrev_b32 v104, 16, v59
    v_and_b32 v105, 0xffff0000, v59
    v_fmac_f32 v102, v104, v22
    v_fmac_f32 v103, v105, v22
    s_waitcnt vmcnt(8)
    v_lshlrev_b32 v104, 16, v60
    v_and_b32 v105, 0xffff0000, v60
    v_fmac_f32 v96, v104, v23
    v_fmac_f32 v97, v105, v23
    v_lshlrev_b32 v104, 16, v61
    v_and_b32 v105, 0xffff0000, v61
    v_fmac_f32 v98, v104, v23
    v_fmac_f32 v99, v105, v23
    v_lshlrev_b32 v104, 16, v62
    v_and_b32 v105, 0xffff0000, v62
    v_fmac_f32 v100, v104, v23
    v_fmac_f32 v101, v105, v23
    v_lshlrev_b32 v104, 16, v63
    v_and_b32 v105, 0xffff0000, v63
    v_fmac_f32 v102, v104, v23
    v_fmac_f32 v103, v105, v23
    s_waitcnt vmcnt(7)
    v_lshlrev_b32 v104, 16, v64
    v_and_b32 v105, 0xffff0000, v64
    v_fmac_f32 v96, v104, v24
    v_fmac_f32 v97, v105, v24
    v_lshlrev_b32 v104, 16, v65
    v_and_b32 v105, 0xffff0000, v65
    v_fmac_f32 v98, v104, v24
    v_fmac_f32 v99, v105, v24
    v_lshlrev_b32 v104, 16, v66
    v_and_b32 v105, 0xffff0000, v66
    v_fmac_f32 v100, v104, v24
    v_fmac_f32 v101, v105, v24
    v_lshlrev_b32 v104, 16, v67
    v_and_b32 v105, 0xffff0000, v67
    v_fmac_f32 v102, v104, v24
    v_fmac_f32 v103, v105, v24
    s_waitcnt vmcnt(6)
    v_lshlrev_b32 v104, 16, v68
    v_and_b32 v105, 0xffff0000, v68
    v_fmac_f32 v96, v104, v25
    v_fmac_f32 v97, v105, v25
    v_lshlrev_b32 v104, 16, v69
    v_and_b32 v105, 0xffff0000, v69
    v_fmac_f32 v98, v104, v25
    v_fmac_f32 v99, v105, v25
    v_lshlrev_b32 v104, 16, v70
    v_and_b32 v105, 0xffff0000, v70
    v_fmac_f32 v100, v104, v25
    v_fmac_f32 v101, v105, v25
    v_lshlrev_b32 v104, 16, v71
    v_and_b32 v105, 0xffff0000, v71
    v_fmac_f32 v102, v104, v25
    v_fmac_f32 v103, v105, v25
    s_waitcnt vmcnt(5)
    v_lshlrev_b32 v104, 16, v72
    v_and_b32 v105, 0xffff0000, v72
    v_fmac_f32 v96, v104, v26
    v_fmac_f32 v97, v105, v26
    v_lshlrev_b32 v104, 16, v73
    v_and_b32 v105, 0xffff0000, v73
    v_fmac_f32 v98, v104, v26
    v_fmac_f32 v99, v105, v26
    v_lshlrev_b32 v104, 16, v74
    v_and_b32 v105, 0xffff0000, v74
    v_fmac_f32 v100, v104, v26
    v_fmac_f32 v101, v105, v26
    v_lshlrev_b32 v104, 16, v75
    v_and_b32 v105, 0xffff0000, v75
    v_fmac_f32 v102, v104, v26
    v_fmac_f32 v103, v105, v26
    s_waitcnt vmcnt(4)
    v_lshlrev_b32 v104, 16, v76
    v_and_b32 v105, 0xffff0000, v76
    v_fmac_f32 v96, v104, v27
    v_fmac_f32 v97, v105, v27
    v_lshlrev_b32 v104, 16, v77
    v_and_b32 v105, 0xffff0000, v77
    v_fmac_f32 v98, v104, v27
    v_fmac_f32 v99, v105, v27
    v_lshlrev_b32 v104, 16, v78
    v_and_b32 v105, 0xffff0000, v78
    v_fmac_f32 v100, v104, v27
    v_fmac_f32 v101, v105, v27
    v_lshlrev_b32 v104, 16, v79
    v_and_b32 v105, 0xffff0000, v79
    v_fmac_f32 v102, v104, v27
    v_fmac_f32 v103, v105, v27
    s_waitcnt vmcnt(3)
    v_lshlrev_b32 v104, 16, v80
    v_and_b32 v105, 0xffff0000, v80
    v_fmac_f32 v96, v104, v28
    v_fmac_f32 v97, v105, v28
    v_lshlrev_b32 v104, 16, v81
    v_and_b32 v105, 0xffff0000, v81
    v_fmac_f32 v98, v104, v28
    v_fmac_f32 v99, v105, v28
    v_lshlrev_b32 v104, 16, v82
    v_and_b32 v105, 0xffff0000, v82
    v_fmac_f32 v100, v104, v28
    v_fmac_f32 v101, v105, v28
    v_lshlrev_b32 v104, 16, v83
    v_and_b32 v105, 0xffff0000, v83
    v_fmac_f32 v102, v104, v28
    v_fmac_f32 v103, v105, v28
    s_waitcnt vmcnt(2)
    v_lshlrev_b32 v104, 16, v84
    v_and_b32 v105, 0xffff0000, v84
    v_fmac_f32 v96, v104, v29
    v_fmac_f32 v97, v105, v29
    v_lshlrev_b32 v104, 16, v85
    v_and_b32 v105, 0xffff0000, v85
    v_fmac_f32 v98, v104, v29
    v_fmac_f32 v99, v105, v29
    v_lshlrev_b32 v104, 16, v86
    v_and_b32 v105, 0xffff0000, v86
    v_fmac_f32 v100, v104, v29
    v_fmac_f32 v101, v105, v29
    v_lshlrev_b32 v104, 16, v87
    v_and_b32 v105, 0xffff0000, v87
    v_fmac_f32 v102, v104, v29
    v_fmac_f32 v103, v105, v29
    s_waitcnt vmcnt(1)
    v_lshlrev_b32 v104, 16, v88
    v_and_b32 v105, 0xffff0000, v88
    v_fmac_f32 v96, v104, v30
    v_fmac_f32 v97, v105, v30
    v_lshlrev_b32 v104, 16, v89
    v_and_b32 v105, 0xffff0000, v89
    v_fmac_f32 v98, v104, v30
    v_fmac_f32 v99, v105, v30
    v_lshlrev_b32 v104, 16, v90
    v_and_b32 v105, 0xffff0000, v90
    v_fmac_f32 v100, v104, v30
    v_fmac_f32 v101, v105, v30
    v_lshlrev_b32 v104, 16, v91
    v_and_b32 v105, 0xffff0000, v91
    v_fmac_f32 v102, v104, v30
    v_fmac_f32 v103, v105, v30
    s_waitcnt vmcnt(0)
    v_lshlrev_b32 v104, 16, v92
    v_and_b32 v105, 0xffff0000, v92
    v_fmac_f32 v96, v104, v31
    v_fmac_f32 v97, v105, v31
    v_lshlrev_b32 v104, 16, v93
    v_and_b32 v105, 0xffff0000, v93
    v_fmac_f32 v98, v104, v31
    v_fmac_f32 v99, v105, v31
    v_lshlrev_b32 v104, 16, v94
    v_and_b32 v105, 0xffff0000, v94
    v_fmac_f32 v100, v104, v31
    v_fmac_f32 v101, v105, v31
    v_lshlrev_b32 v104, 16, v95
    v_and_b32 v105, 0xffff0000, v95
    v_fmac_f32 v102, v104, v31
    v_fmac_f32 v103, v105, v31
    v_lshlrev_b32 v104, 5, v0
    ds_write_b128 v104, v[96:99]
    ds_write_b128 v104, v[100:103] offset:16
    v_lshlrev_b32 v105, 2, v1
    s_lshl_b32 s46, s44, 11
    v_add_u32 v104, s46, v105
    s_waitcnt lgkmcnt(0)
    ds_read_b32 v96, v104 offset:0
    ds_read_b32 v97, v104 offset:256
    ds_read_b32 v98, v104 offset:512
    ds_read_b32 v99, v104 offset:768
    ds_read_b32 v100, v104 offset:1024
    ds_read_b32 v101, v104 offset:1280
    ds_read_b32 v102, v104 offset:1536
    ds_read_b32 v103, v104 offset:1792
    s_waitcnt lgkmcnt(0)
    v_add_f32 v96, v96, v100
    v_add_f32 v97, v97, v101
    v_add_f32 v98, v98, v102
    v_add_f32 v99, v99, v103
    v_add_f32 v96, v96, v98
    v_add_f32 v97, v97, v99
    v_add_f32 v96, v96, v97
    v_lshlrev_b32 v104, 2, v0
    ds_write_b32 v104, v96 offset:16384
    s_waitcnt lgkmcnt(0)
    s_barrier
    s_cmp_lg_u32 s44, 0
    s_cbranch_scc1 L_m_sk_25
    ds_read_b32 v96, v105 offset:16384
    ds_read_b32 v97, v105 offset:16640
    ds_read_b32 v98, v105 offset:16896
    ds_read_b32 v99, v105 offset:17152
    ds_read_b32 v100, v105 offset:17408
    ds_read_b32 v101, v105 offset:17664
    ds_read_b32 v102, v105 offset:17920
    ds_read_b32 v103, v105 offset:18176
    s_waitcnt lgkmcnt(0)
    v_add_f32 v96, v96, v100
    v_add_f32 v97, v97, v101
    v_add_f32 v98, v98, v102
    v_add_f32 v99, v99, v103
    v_add_f32 v96, v96, v98
    v_add_f32 v97, v97, v99
    v_add_f32 v96, v96, v97
    v_cvt_pk_bf16_f32 v96, 0, v96
    s_lshl_b32 s46, s53, 1
    buffer_store_dword v96, v105, s[12:15], s46 offen sc1
L_m_sk_25:
    s_barrier
    s_add_u32 s53, s53, 128
    s_and_b32 s46, s53, 511
    s_cmp_lg_u32 s46, 0
    s_cbranch_scc1 L_m_loop_24
    s_lshl_b32 s54, s55, 7
    s_add_u32 s54, s54, 0x10e400
    s_mov_b32 s60, 0
    s_waitcnt vmcnt(0)
    s_cmp_lg_u32 s44, 0
    s_cbranch_scc1 L_sf_26
    v_mov_b32 v8, s60
    v_add_u32 v8, 1, v8
    v_mov_b32 v9, 0
    s_mov_b64 exec, 1
    buffer_store_dword v8, v9, s[12:15], s54 offen sc1
    s_mov_b64 exec, -1
L_sf_26:
    s_barrier
L_w_h_17_s:
    s_mov_b32 s77, s48
    s_cmp_eq_u32 s48, 14
    s_cselect_b32 s53, 2, 1
    s_sub_u32 s48, s48, 12
    s_min_u32 s48, s48, 2
    s_mov_b32 s79, 0
L_w_h_17_n:
    s_cmp_eq_u32 s53, 1
    s_cselect_b32 s74, 41, 54
    s_cselect_b32 s75, 58, 64
    s_mov_b32 s76, 65536
    s_branch L_w_g_10_e
L_w_h_17:
    s_mov_b32 s48, s77
    s_cmp_lt_u32 s48, 14
    s_cbranch_scc1 L_w_att_15
    s_and_b32 s42, s40, 3
    s_lshr_b32 s43, s40, 2
    s_cmp_eq_u32 s48, 14
    s_cbranch_scc1 L_w_c_16
    s_mov_b32 s75, 58
    s_mov_b32 s76, 0
    s_mov_b32 s78, 2
L_w_h_17_f:
    s_load_dwordx2 s[4:5], s[0:1], 112
    s_load_dwordx2 s[6:7], s[0:1], 88
    v_lshlrev_b32 v2, 4, v1
    v_lshlrev_b32 v3, 5, v1
    s_waitcnt lgkmcnt(0)
    s_mov_b32 s24, s4
    s_and_b32 s25, s5, 0xffff
    s_mov_b32 s26, 0x400000
    s_mov_b32 s27, 0x00020000
    s_mov_b32 s28, s6
    s_and_b32 s29, s7, 0xffff
    s_mov_b32 s30, 0x800
    s_mov_b32 s31, 0x00020000
    s_cmp_lg_u32 s44, 0
    s_cbranch_scc1 L_mw_27
    v_and_b32 v8, 15, v1
    v_lshlrev_b32 v8, 7, v8
    s_mov_b32 s46, 0x10e400
    s_mov_b32 s47, 0
    s_mov_b32 s70, 0
L_spin_28:
    buffer_load_dword v9, v8, s[12:15], s46 offen sc1
    s_waitcnt vmcnt(0)
    v_cmp_ge_u32 vcc, s47, v9
    s_add_u32 s70, s70, 1
    s_cbranch_vccz L_spok_29
    s_sleep 2
    s_cmp_lt_u32 s70, 524288
    s_cbranch_scc1 L_spin_28
    s_branch L_c_done_1
L_spok_29:
L_mw_27:
    s_barrier
    s_mov_b32 s46, 20480
    buffer_load_dwordx4 v[16:19], v3, s[12:15], s46 offen offset:0 sc1
    buffer_load_dwordx4 v[20:23], v3, s[12:15], s46 offen offset:16 sc1
    buffer_load_dwordx4 v[24:27], v3, s[12:15], s46 offen offset:2048 sc1
    buffer_load_dwordx4 v[28:31], v3, s[12:15], s46 offen offset:2064 sc1
    buffer_load_dwordx4 v[48:51], v2, s[28:31], 0 offen
    buffer_load_dwordx4 v[52:55], v2, s[28:31], 0 offen offset:1024
    s_waitcnt vmcnt(0)
    v_lshlrev_b32 v32, 16, v48
    v_and_b32 v33, 0xffff0000, v48
    v_lshlrev_b32 v34, 16, v49
    v_and_b32 v35, 0xffff0000, v49
    v_lshlrev_b32 v36, 16, v50
    v_and_b32 v37, 0xffff0000, v50
    v_lshlrev_b32 v38, 16, v51
    v_and_b32 v39, 0xffff0000, v51
    v_lshlrev_b32 v40, 16, v52
    v_and_b32 v41, 0xffff0000, v52
    v_lshlrev_b32 v42, 16, v53
    v_and_b32 v43, 0xffff0000, v53
    v_lshlrev_b32 v44, 16, v54
    v_and_b32 v45, 0xffff0000, v54
    v_lshlrev_b32 v46, 16, v55
    v_and_b32 v47, 0xffff0000, v55
    s_lshl_b32 s46, s42, 14
    s_lshl_b32 s47, s44, 11
    s_add_u32 s46, s46, s47
    s_add_u32 s46, s46, 0xb000000
    v_add_u32 v4, s46, v2
    v_and_b32 v5, 31, v1
    v_lshlrev_b32 v5, 7, v5
    v_add_u32 v5, 0x108400, v5
    v_lshlrev_b32 v6, 2, v1
    s_lshl_b32 s46, s44, 9
    v_add_u32 v6, s46, v6
    s_lshl_b32 s46, s44, 12
    v_add_u32 v7, s46, v3
    s_lshl_b32 s46, s42, 3
    s_add_u32 s46, s46, s44
    s_lshl_b32 s46, s46, 11
    v_add_u32 v8, s46, v2
    v_add_u32 v9, 0x800000, v8
    s_mov_b32 s60, s43
L_r_loop_30:
    s_lshl_b32 s61, s60, 18
    s_lshl_b32 s63, s60, 16
    s_cmp_lg_u32 s44, 0
    s_cbranch_scc1 L_r_nsp_31
    s_mov_b32 s70, 0
L_spin_32:
    buffer_load_dword v14, v5, s[12:15], s76 offen sc1
    s_waitcnt vmcnt(0)
    v_cmp_ge_u32 vcc, s60, v14
    s_add_u32 s70, s70, 1
    s_cbranch_vccz L_spok_33
    s_sleep 3
    s_cmp_lt_u32 s70, 524288
    s_cbranch_scc1 L_spin_32
    s_branch L_c_done_1
L_spok_33:
L_r_nsp_31:
    s_barrier
    buffer_load_dwordx4 v[96:99], v4, s[12:15], s61 offen offset:0 sc1
    buffer_load_dwordx4 v[100:103], v4, s[12:15], s61 offen offset:1024 sc1
    s_add_u32 s61, s61, 65536
    buffer_load_dwordx4 v[104:107], v4, s[12:15], s61 offen offset:0 sc1
    buffer_load_dwordx4 v[108:111], v4, s[12:15], s61 offen offset:1024 sc1
    s_add_u32 s61, s61, 65536
    buffer_load_dwordx4 v[112:115], v4, s[12:15], s61 offen offset:0 sc1
    buffer_load_dwordx4 v[116:119], v4, s[12:15], s61 offen offset:1024 sc1
    s_add_u32 s61, s61, 65536
    buffer_load_dwordx4 v[120:123], v4, s[12:15], s61 offen offset:0 sc1
    buffer_load_dwordx4 v[124:127], v4, s[12:15], s61 offen offset:1024 sc1
    buffer_load_dwordx4 a[0:3], v9, s[12:15], s63 offen sc1
    buffer_load_dwordx4 a[4:7], v9, s[12:15], s63 offen offset:1024 sc1
    s_waitcnt vmcnt(8)
    v_lshlrev_b32 v64, 16, v96
    v_and_b32 v65, 0xffff0000, v96
    v_lshlrev_b32 v66, 16, v97
    v_and_b32 v67, 0xffff0000, v97
    v_lshlrev_b32 v68, 16, v98
    v_and_b32 v69, 0xffff0000, v98
    v_lshlrev_b32 v70, 16, v99
    v_and_b32 v71, 0xffff0000, v99
    v_lshlrev_b32 v72, 16, v100
    v_and_b32 v73, 0xffff0000, v100
    v_lshlrev_b32 v74, 16, v101
    v_and_b32 v75, 0xffff0000, v101
    v_lshlrev_b32 v76, 16, v102
    v_and_b32 v77, 0xffff0000, v102
    v_lshlrev_b32 v78, 16, v103
    v_and_b32 v79, 0xffff0000, v103
    s_waitcnt vmcnt(6)
    v_lshlrev_b32 v14, 16, v104
    v_and_b32 v15, 0xffff0000, v104
    v_pk_add_f32 v[64:65], v[64:65], v[14:15]
    v_lshlrev_b32 v14, 16, v105
    v_and_b32 v15, 0xffff0000, v105
    v_pk_add_f32 v[66:67], v[66:67], v[14:15]
    v_lshlrev_b32 v14, 16, v106
    v_and_b32 v15, 0xffff0000, v106
    v_pk_add_f32 v[68:69], v[68:69], v[14:15]
    v_lshlrev_b32 v14, 16, v107
    v_and_b32 v15, 0xffff0000, v107
    v_pk_add_f32 v[70:71], v[70:71], v[14:15]
    v_lshlrev_b32 v14, 16, v108
    v_and_b32 v15, 0xffff0000, v108
    v_pk_add_f32 v[72:73], v[72:73], v[14:15]
    v_lshlrev_b32 v14, 16, v109
    v_and_b32 v15, 0xffff0000, v109
    v_pk_add_f32 v[74:75], v[74:75], v[14:15]
    v_lshlrev_b32 v14, 16, v110
    v_and_b32 v15, 0xffff0000, v110
    v_pk_add_f32 v[76:77], v[76:77], v[14:15]
    v_lshlrev_b32 v14, 16, v111
    v_and_b32 v15, 0xffff0000, v111
    v_pk_add_f32 v[78:79], v[78:79], v[14:15]
    s_waitcnt vmcnt(4)
    v_lshlrev_b32 v14, 16, v112
    v_and_b32 v15, 0xffff0000, v112
    v_pk_add_f32 v[64:65], v[64:65], v[14:15]
    v_lshlrev_b32 v14, 16, v113
    v_and_b32 v15, 0xffff0000, v113
    v_pk_add_f32 v[66:67], v[66:67], v[14:15]
    v_lshlrev_b32 v14, 16, v114
    v_and_b32 v15, 0xffff0000, v114
    v_pk_add_f32 v[68:69], v[68:69], v[14:15]
    v_lshlrev_b32 v14, 16, v115
    v_and_b32 v15, 0xffff0000, v115
    v_pk_add_f32 v[70:71], v[70:71], v[14:15]
    v_lshlrev_b32 v14, 16, v116
    v_and_b32 v15, 0xffff0000, v116
    v_pk_add_f32 v[72:73], v[72:73], v[14:15]
    v_lshlrev_b32 v14, 16, v117
    v_and_b32 v15, 0xffff0000, v117
    v_pk_add_f32 v[74:75], v[74:75], v[14:15]
    v_lshlrev_b32 v14, 16, v118
    v_and_b32 v15, 0xffff0000, v118
    v_pk_add_f32 v[76:77], v[76:77], v[14:15]
    v_lshlrev_b32 v14, 16, v119
    v_and_b32 v15, 0xffff0000, v119
    v_pk_add_f32 v[78:79], v[78:79], v[14:15]
    s_waitcnt vmcnt(2)
    v_lshlrev_b32 v14, 16, v120
    v_and_b32 v15, 0xffff0000, v120
    v_pk_add_f32 v[64:65], v[64:65], v[14:15]
    v_lshlrev_b32 v14, 16, v121
    v_and_b32 v15, 0xffff0000, v121
    v_pk_add_f32 v[66:67], v[66:67], v[14:15]
    v_lshlrev_b32 v14, 16, v122
    v_and_b32 v15, 0xffff0000, v122
    v_pk_add_f32 v[68:69], v[68:69], v[14:15]
    v_lshlrev_b32 v14, 16, v123
    v_and_b32 v15, 0xffff0000, v123
    v_pk_add_f32 v[70:71], v[70:71], v[14:15]
    v_lshlrev_b32 v14, 16, v124
    v_and_b32 v15, 0xffff0000, v124
    v_pk_add_f32 v[72:73], v[72:73], v[14:15]
    v_lshlrev_b32 v14, 16, v125
    v_and_b32 v15, 0xffff0000, v125
    v_pk_add_f32 v[74:75], v[74:75], v[14:15]
    v_lshlrev_b32 v14, 16, v126
    v_and_b32 v15, 0xffff0000, v126
    v_pk_add_f32 v[76:77], v[76:77], v[14:15]
    v_lshlrev_b32 v14, 16, v127
    v_and_b32 v15, 0xffff0000, v127
    v_pk_add_f32 v[78:79], v[78:79], v[14:15]
    ds_write_b32 v6, v64 offset:0
    ds_write_b32 v6, v65 offset:4096
    ds_write_b32 v6, v66 offset:8192
    ds_write_b32 v6, v67 offset:12288
    ds_write_b32 v6, v68 offset:16384
    ds_write_b32 v6, v69 offset:20480
    ds_write_b32 v6, v70 offset:24576
    ds_write_b32 v6, v71 offset:28672
    ds_write_b32 v6, v72 offset:256
    ds_write_b32 v6, v73 offset:4352
    ds_write_b32 v6, v74 offset:8448
    ds_write_b32 v6, v75 offset:12544
    ds_write_b32 v6, v76 offset:16640
    ds_write_b32 v6, v77 offset:20736
    ds_write_b32 v6, v78 offset:24832
    ds_write_b32 v6, v79 offset:28928
    s_waitcnt lgkmcnt(0)
    s_barrier
    ds_read_b128 v[64:67], v7
    ds_read_b128 v[68:71], v7 offset:16
    ds_read_b128 v[72:75], v7 offset:2048
    ds_read_b128 v[76:79], v7 offset:2064
    s_waitcnt vmcnt(0)
    v_accvgpr_read_b32 v96, a0
    v_accvgpr_read_b32 v97, a1
    v_accvgpr_read_b32 v98, a2
    v_accvgpr_read_b32 v99, a3
    v_accvgpr_read_b32 v100, a4
    v_accvgpr_read_b32 v101, a5
    v_accvgpr_read_b32 v102, a6
    v_accvgpr_read_b32 v103, a7
    v_lshlrev_b32 v80, 16, v96
    v_and_b32 v81, 0xffff0000, v96
    v_lshlrev_b32 v82, 16, v97
    v_and_b32 v83, 0xffff0000, v97
    v_lshlrev_b32 v84, 16, v98
    v_and_b32 v85, 0xffff0000, v98
    v_lshlrev_b32 v86, 16, v99
    v_and_b32 v87, 0xffff0000, v99
    v_lshlrev_b32 v88, 16, v100
    v_and_b32 v89, 0xffff0000, v100
    v_lshlrev_b32 v90, 16, v101
    v_and_b32 v91, 0xffff0000, v101
    v_lshlrev_b32 v92, 16, v102
    v_and_b32 v93, 0xffff0000, v102
    v_lshlrev_b32 v94, 16, v103
    v_and_b32 v95, 0xffff0000, v103
    s_waitcnt lgkmcnt(0)
    v_cvt_pk_bf16_f32 v64, 0, v64
    v_cvt_pk_bf16_f32 v65, 0, v65
    v_cvt_pk_bf16_f32 v66, 0, v66
    v_cvt_pk_bf16_f32 v67, 0, v67
    v_cvt_pk_bf16_f32 v68, 0, v68
    v_cvt_pk_bf16_f32 v69, 0, v69
    v_cvt_pk_bf16_f32 v70, 0, v70
    v_cvt_pk_bf16_f32 v71, 0, v71
    v_cvt_pk_bf16_f32 v72, 0, v72
    v_cvt_pk_bf16_f32 v73, 0, v73
    v_cvt_pk_bf16_f32 v74, 0, v74
    v_cvt_pk_bf16_f32 v75, 0, v75
    v_cvt_pk_bf16_f32 v76, 0, v76
    v_cvt_pk_bf16_f32 v77, 0, v77
    v_cvt_pk_bf16_f32 v78, 0, v78
    v_cvt_pk_bf16_f32 v79, 0, v79
    v_pk_add_f32 v[64:65], v[64:65], v[32:33]
    v_pk_add_f32 v[66:67], v[66:67], v[34:35]
    v_pk_add_f32 v[68:69], v[68:69], v[36:37]
    v_pk_add_f32 v[70:71], v[70:71], v[38:39]
    v_pk_add_f32 v[72:73], v[72:73], v[40:41]
    v_pk_add_f32 v[74:75], v[74:75], v[42:43]
    v_pk_add_f32 v[76:77], v[76:77], v[44:45]
    v_pk_add_f32 v[78:79], v[78:79], v[46:47]
    v_cvt_pk_bf16_f32 v64, 0, v64
    v_cvt_pk_bf16_f32 v65, 0, v65
    v_cvt_pk_bf16_f32 v66, 0, v66
    v_cvt_pk_bf16_f32 v67, 0, v67
    v_cvt_pk_bf16_f32 v68, 0, v68
    v_cvt_pk_bf16_f32 v69, 0, v69
    v_cvt_pk_bf16_f32 v70, 0, v70
    v_cvt_pk_bf16_f32 v71, 0, v71
    v_cvt_pk_bf16_f32 v72, 0, v72
    v_cvt_pk_bf16_f32 v73, 0, v73
    v_cvt_pk_bf16_f32 v74, 0, v74
    v_cvt_pk_bf16_f32 v75, 0, v75
    v_cvt_pk_bf16_f32 v76, 0, v76
    v_cvt_pk_bf16_f32 v77, 0, v77
    v_cvt_pk_bf16_f32 v78, 0, v78
    v_cvt_pk_bf16_f32 v79, 0, v79
    v_pk_mul_f32 v[64:65], v[64:65], v[16:17]
    v_pk_mul_f32 v[66:67], v[66:67], v[18:19]
    v_pk_mul_f32 v[68:69], v[68:69], v[20:21]
    v_pk_mul_f32 v[70:71], v[70:71], v[22:23]
    v_pk_mul_f32 v[72:73], v[72:73], v[24:25]
    v_pk_mul_f32 v[74:75], v[74:75], v[26:27]
    v_pk_mul_f32 v[76:77], v[76:77], v[28:29]
    v_pk_mul_f32 v[78:79], v[78:79], v[30:31]
    v_cvt_pk_bf16_f32 v64, 0, v64
    v_cvt_pk_bf16_f32 v65, 0, v65
    v_cvt_pk_bf16_f32 v66, 0, v66
    v_cvt_pk_bf16_f32 v67, 0, v67
    v_cvt_pk_bf16_f32 v68, 0, v68
    v_cvt_pk_bf16_f32 v69, 0, v69
    v_cvt_pk_bf16_f32 v70, 0, v70
    v_cvt_pk_bf16_f32 v71, 0, v71
    v_cvt_pk_bf16_f32 v72, 0, v72
    v_cvt_pk_bf16_f32 v73, 0, v73
    v_cvt_pk_bf16_f32 v74, 0, v74
    v_cvt_pk_bf16_f32 v75, 0, v75
    v_cvt_pk_bf16_f32 v76, 0, v76
    v_cvt_pk_bf16_f32 v77, 0, v77
    v_cvt_pk_bf16_f32 v78, 0, v78
    v_cvt_pk_bf16_f32 v79, 0, v79
    v_pk_add_f32 v[64:65], v[64:65], v[80:81]
    v_pk_add_f32 v[66:67], v[66:67], v[82:83]
    v_pk_add_f32 v[68:69], v[68:69], v[84:85]
    v_pk_add_f32 v[70:71], v[70:71], v[86:87]
    v_pk_add_f32 v[72:73], v[72:73], v[88:89]
    v_pk_add_f32 v[74:75], v[74:75], v[90:91]
    v_pk_add_f32 v[76:77], v[76:77], v[92:93]
    v_pk_add_f32 v[78:79], v[78:79], v[94:95]
    v_cvt_pk_bf16_f32 v96, v64, v65
    v_cvt_pk_bf16_f32 v97, v66, v67
    v_cvt_pk_bf16_f32 v98, v68, v69
    v_cvt_pk_bf16_f32 v99, v70, v71
    v_cvt_pk_bf16_f32 v100, v72, v73
    v_cvt_pk_bf16_f32 v101, v74, v75
    v_cvt_pk_bf16_f32 v102, v76, v77
    v_cvt_pk_bf16_f32 v103, v78, v79
    buffer_store_dwordx4 v[96:99], v8, s[24:27], s63 offen
    buffer_store_dwordx4 v[100:103], v8, s[24:27], s63 offen offset:1024
    s_add_u32 s60, s60, s78
    s_cmp_lt_u32 s60, s75
    s_cbranch_scc1 L_r_loop_30
    s_branch L_c_done_1
L_w_c_16:
    s_load_dwordx2 s[4:5], s[0:1], 0
    s_load_dwordx2 s[6:7], s[0:1], 88
    v_lshlrev_b32 v2, 4, v1
    v_lshlrev_b32 v3, 5, v1
    s_waitcnt lgkmcnt(0)
    s_mov_b32 s24, s4
    s_and_b32 s25, s5, 0xffff
    s_mov_b32 s26, 0x400000
    s_mov_b32 s27, 0x00020000
    s_mov_b32 s28, s6
    s_and_b32 s29, s7, 0xffff
    s_mov_b32 s30, 0x800
    s_mov_b32 s31, 0x00020000
    s_cmp_lg_u32 s44, 0
    s_cbranch_scc1 L_mw_34
    v_and_b32 v8, 15, v1
    v_lshlrev_b32 v8, 7, v8
    s_mov_b32 s46, 0x10e400
    s_mov_b32 s47, 0
    s_mov_b32 s70, 0
L_spin_35:
    buffer_load_dword v9, v8, s[12:15], s46 offen sc1
    s_waitcnt vmcnt(0)
    v_cmp_ge_u32 vcc, s47, v9
    s_add_u32 s70, s70, 1
    s_cbranch_vccz L_spok_36
    s_sleep 2
    s_cmp_lt_u32 s70, 524288
    s_cbranch_scc1 L_spin_35
    s_branch L_c_done_1
L_spok_36:
L_mw_34:
    s_barrier
    s_mov_b32 s46, 8192
    buffer_load_dwordx4 v[16:19], v3, s[12:15], s46 offen offset:0 sc1
    buffer_load_dwordx4 v[20:23], v3, s[12:15], s46 offen offset:16 sc1
    buffer_load_dwordx4 v[24:27], v3, s[12:15], s46 offen offset:2048 sc1
    buffer_load_dwordx4 v[28:31], v3, s[12:15], s46 offen offset:2064 sc1
    s_mov_b32 s46, 16384
    buffer_load_dwordx4 v[32:35], v3, s[12:15], s46 offen offset:0 sc1
    buffer_load_dwordx4 v[36:39], v3, s[12:15], s46 offen offset:16 sc1
    buffer_load_dwordx4 v[40:43], v3, s[12:15], s46 offen offset:2048 sc1
    buffer_load_dwordx4 v[44:47], v3, s[12:15], s46 offen offset:2064 sc1
    s_mov_b32 s46, 12288
    buffer_load_dwordx4 v[48:51], v3, s[12:15], s46 offen offset:0 sc1
    buffer_load_dwordx4 v[52:55], v3, s[12:15], s46 offen offset:16 sc1
    buffer_load_dwordx4 v[56:59], v3, s[12:15], s46 offen offset:2048 sc1
    buffer_load_dwordx4 v[60:63], v3, s[12:15], s46 offen offset:2064 sc1
    s_waitcnt vmcnt(0)
    v_add_f32 v32, 1.0, v32
    v_add_f32 v33, 1.0, v33
    v_add_f32 v34, 1.0, v34
    v_add_f32 v35, 1.0, v35
    v_add_f32 v36, 1.0, v36
    v_add_f32 v37, 1.0, v37
    v_add_f32 v38, 1.0, v38
    v_add_f32 v39, 1.0, v39
    v_add_f32 v40, 1.0, v40
    v_add_f32 v41, 1.0, v41
    v_add_f32 v42, 1.0, v42
    v_add_f32 v43, 1.0, v43
    v_add_f32 v44, 1.0, v44
    v_add_f32 v45, 1.0, v45
    v_add_f32 v46, 1.0, v46
    v_add_f32 v47, 1.0, v47
    v_cvt_pk_bf16_f32 v32, 0, v32
    v_cvt_pk_bf16_f32 v33, 0, v33
    v_cvt_pk_bf16_f32 v34, 0, v34
    v_cvt_pk_bf16_f32 v35, 0, v35
    v_cvt_pk_bf16_f32 v36, 0, v36
    v_cvt_pk_bf16_f32 v37, 0, v37
    v_cvt_pk_bf16_f32 v38, 0, v38
    v_cvt_pk_bf16_f32 v39, 0, v39
    v_cvt_pk_bf16_f32 v40, 0, v40
    v_cvt_pk_bf16_f32 v41, 0, v41
    v_cvt_pk_bf16_f32 v42, 0, v42
    v_cvt_pk_bf16_f32 v43, 0, v43
    v_cvt_pk_bf16_f32 v44, 0, v44
    v_cvt_pk_bf16_f32 v45, 0, v45
    v_cvt_pk_bf16_f32 v46, 0, v46
    v_cvt_pk_bf16_f32 v47, 0, v47
    s_lshl_b32 s46, s42, 14
    s_lshl_b32 s47, s44, 11
    s_add_u32 s46, s46, s47
    s_add_u32 s46, s46, 0x9000000
    v_add_u32 v4, s46, v2
    v_and_b32 v5, 31, v1
    v_lshlrev_b32 v5, 7, v5
    v_add_u32 v5, 0x107400, v5
    v_lshlrev_b32 v6, 2, v1
    s_lshl_b32 s46, s44, 9
    v_add_u32 v6, s46, v6
    s_lshl_b32 s46, s44, 12
    v_add_u32 v7, s46, v3
    s_lshl_b32 s46, s42, 3
    s_add_u32 s46, s46, s44
    s_lshl_b32 s46, s46, 11
    v_add_u32 v8, s46, v2
    v_add_u32 v9, 0x800000, v8
    s_mul_i32 s46, s44, 2064
    s_add_u32 s46, s46, 32768
    v_add_u32 v10, s46, v2
    v_and_b32 v11, 7, v1
    v_lshrrev_b32 v12, 3, v1
    v_mul_u32_u24 v13, 2064, v11
    v_lshl_add_u32 v13, v12, 4, v13
    s_lshl_b32 s46, s44, 8
    s_add_u32 s46, s46, 32768
    v_add_u32 v13, s46, v13
    v_lshlrev_b32 v11, 4, v11
    v_lshl_add_u32 v11, v12, 9, v11
    s_lshl_b32 s46, s44, 13
    s_lshl_b32 s47, s42, 7
    s_add_u32 s46, s46, s47
    s_add_u32 s46, s46, 0xc00000
    v_add_u32 v11, s46, v11
    v_add_u32 v12, 4096, v11
    s_lshl_b32 s52, s43, 9
    s_lshl_b32 s47, s42, 7
    s_add_u32 s52, s52, s47
    s_add_u32 s52, s52, 0x10ec00
    s_mov_b32 s60, s43
L_r_loop_37:
    s_lshl_b32 s61, s60, 18
    s_lshl_b32 s63, s60, 16
    buffer_load_dwordx4 a[0:3], v8, s[24:27], s63 offen
    buffer_load_dwordx4 a[4:7], v8, s[24:27], s63 offen offset:1024
    s_cmp_lg_u32 s44, 0
    s_cbranch_scc1 L_r_nsp_38
    s_mov_b32 s70, 0
L_spin_39:
    buffer_load_dword v14, v5, s[12:15], 0 offen sc1
    s_waitcnt vmcnt(0)
    v_cmp_ge_u32 vcc, s60, v14
    s_add_u32 s70, s70, 1
    s_cbranch_vccz L_spok_40
    s_sleep 3
    s_cmp_lt_u32 s70, 524288
    s_cbranch_scc1 L_spin_39
    s_branch L_c_done_1
L_spok_40:
L_r_nsp_38:
    s_barrier
    buffer_load_dwordx4 v[96:99], v4, s[12:15], s61 offen offset:0 sc1
    buffer_load_dwordx4 v[100:103], v4, s[12:15], s61 offen offset:1024 sc1
    s_add_u32 s61, s61, 65536
    buffer_load_dwordx4 v[104:107], v4, s[12:15], s61 offen offset:0 sc1
    buffer_load_dwordx4 v[108:111], v4, s[12:15], s61 offen offset:1024 sc1
    s_add_u32 s61, s61, 65536
    buffer_load_dwordx4 v[112:115], v4, s[12:15], s61 offen offset:0 sc1
    buffer_load_dwordx4 v[116:119], v4, s[12:15], s61 offen offset:1024 sc1
    s_add_u32 s61, s61, 65536
    buffer_load_dwordx4 v[120:123], v4, s[12:15], s61 offen offset:0 sc1
    buffer_load_dwordx4 v[124:127], v4, s[12:15], s61 offen offset:1024 sc1
    s_waitcnt vmcnt(8)
    v_accvgpr_read_b32 v64, a0
    v_accvgpr_read_b32 v65, a1
    v_accvgpr_read_b32 v66, a2
    v_accvgpr_read_b32 v67, a3
    v_accvgpr_read_b32 v68, a4
    v_accvgpr_read_b32 v69, a5
    v_accvgpr_read_b32 v70, a6
    v_accvgpr_read_b32 v71, a7
    v_lshlrev_b32 v80, 16, v64
    v_and_b32 v81, 0xffff0000, v64
    v_lshlrev_b32 v82, 16, v65
    v_and_b32 v83, 0xffff0000, v65
    v_lshlrev_b32 v84, 16, v66
    v_and_b32 v85, 0xffff0000, v66
    v_lshlrev_b32 v86, 16, v67
    v_and_b32 v87, 0xffff0000, v67
    v_lshlrev_b32 v88, 16, v68
    v_and_b32 v89, 0xffff0000, v68
    v_lshlrev_b32 v90, 16, v69
    v_and_b32 v91, 0xffff0000, v69
    v_lshlrev_b32 v92, 16, v70
    v_and_b32 v93, 0xffff0000, v70
    v_lshlrev_b32 v94, 16, v71
    v_and_b32 v95, 0xffff0000, v71
    s_waitcnt vmcnt(6)
    v_lshlrev_b32 v64, 16, v96
    v_and_b32 v65, 0xffff0000, v96
    v_lshlrev_b32 v66, 16, v97
    v_and_b32 v67, 0xffff0000, v97
    v_lshlrev_b32 v68, 16, v98
    v_and_b32 v69, 0xffff0000, v98
    v_lshlrev_b32 v70, 16, v99
    v_and_b32 v71, 0xffff0000, v99
    v_lshlrev_b32 v72, 16, v100
    v_and_b32 v73, 0xffff0000, v100
    v_lshlrev_b32 v74, 16, v101
    v_and_b32 v75, 0xffff0000, v101
    v_lshlrev_b32 v76, 16, v102
    v_and_b32 v77, 0xffff0000, v102
    v_lshlrev_b32 v78, 16, v103
    v_and_b32 v79, 0xffff0000, v103
    s_waitcnt vmcnt(4)
    v_lshlrev_b32 v14, 16, v104
    v_and_b32 v15, 0xffff0000, v104
    v_pk_add_f32 v[64:65], v[64:65], v[14:15]
    v_lshlrev_b32 v14, 16, v105
    v_and_b32 v15, 0xffff0000, v105
    v_pk_add_f32 v[66:67], v[66:67], v[14:15]
    v_lshlrev_b32 v14, 16, v106
    v_and_b32 v15, 0xffff0000, v106
    v_pk_add_f32 v[68:69], v[68:69], v[14:15]
    v_lshlrev_b32 v14, 16, v107
    v_and_b32 v15, 0xffff0000, v107
    v_pk_add_f32 v[70:71], v[70:71], v[14:15]
    v_lshlrev_b32 v14, 16, v108
    v_and_b32 v15, 0xffff0000, v108
    v_pk_add_f32 v[72:73], v[72:73], v[14:15]
    v_lshlrev_b32 v14, 16, v109
    v_and_b32 v15, 0xffff0000, v109
    v_pk_add_f32 v[74:75], v[74:75], v[14:15]
    v_lshlrev_b32 v14, 16, v110
    v_and_b32 v15, 0xffff0000, v110
    v_pk_add_f32 v[76:77], v[76:77], v[14:15]
    v_lshlrev_b32 v14, 16, v111
    v_and_b32 v15, 0xffff0000, v111
    v_pk_add_f32 v[78:79], v[78:79], v[14:15]
    s_waitcnt vmcnt(2)
    v_lshlrev_b32 v14, 16, v112
    v_and_b32 v15, 0xffff0000, v112
    v_pk_add_f32 v[64:65], v[64:65], v[14:15]
    v_lshlrev_b32 v14, 16, v113
    v_and_b32 v15, 0xffff0000, v113
    v_pk_add_f32 v[66:67], v[66:67], v[14:15]
    v_lshlrev_b32 v14, 16, v114
    v_and_b32 v15, 0xffff0000, v114
    v_pk_add_f32 v[68:69], v[68:69], v[14:15]
    v_lshlrev_b32 v14, 16, v115
    v_and_b32 v15, 0xffff0000, v115
    v_pk_add_f32 v[70:71], v[70:71], v[14:15]
    v_lshlrev_b32 v14, 16, v116
    v_and_b32 v15, 0xffff0000, v116
    v_pk_add_f32 v[72:73], v[72:73], v[14:15]
    v_lshlrev_b32 v14, 16, v117
    v_and_b32 v15, 0xffff0000, v117
    v_pk_add_f32 v[74:75], v[74:75], v[14:15]
    v_lshlrev_b32 v14, 16, v118
    v_and_b32 v15, 0xffff0000, v118
    v_pk_add_f32 v[76:77], v[76:77], v[14:15]
    v_lshlrev_b32 v14, 16, v119
    v_and_b32 v15, 0xffff0000, v119
    v_pk_add_f32 v[78:79], v[78:79], v[14:15]
    s_waitcnt vmcnt(0)
    v_lshlrev_b32 v14, 16, v120
    v_and_b32 v15, 0xffff0000, v120
    v_pk_add_f32 v[64:65], v[64:65], v[14:15]
    v_lshlrev_b32 v14, 16, v121
    v_and_b32 v15, 0xffff0000, v121
    v_pk_add_f32 v[66:67], v[66:67], v[14:15]
    v_lshlrev_b32 v14, 16, v122
    v_and_b32 v15, 0xffff0000, v122
    v_pk_add_f32 v[68:69], v[68:69], v[14:15]
    v_lshlrev_b32 v14, 16, v123
    v_and_b32 v15, 0xffff0000, v123
    v_pk_add_f32 v[70:71], v[70:71], v[14:15]
    v_lshlrev_b32 v14, 16, v124
    v_and_b32 v15, 0xffff0000, v124
    v_pk_add_f32 v[72:73], v[72:73], v[14:15]
    v_lshlrev_b32 v14, 16, v125
    v_and_b32 v15, 0xffff0000, v125
    v_pk_add_f32 v[74:75], v[74:75], v[14:15]
    v_lshlrev_b32 v14, 16, v126
    v_and_b32 v15, 0xffff0000, v126
    v_pk_add_f32 v[76:77], v[76:77], v[14:15]
    v_lshlrev_b32 v14, 16, v127
    v_and_b32 v15, 0xffff0000, v127
    v_pk_add_f32 v[78:79], v[78:79], v[14:15]
    ds_write_b32 v6, v64 offset:0
    ds_write_b32 v6, v65 offset:4096
    ds_write_b32 v6, v66 offset:8192
    ds_write_b32 v6, v67 offset:12288
    ds_write_b32 v6, v68 offset:16384
    ds_write_b32 v6, v69 offset:20480
    ds_write_b32 v6, v70 offset:24576
    ds_write_b32 v6, v71 offset:28672
    ds_write_b32 v6, v72 offset:256
    ds_write_b32 v6, v73 offset:4352
    ds_write_b32 v6, v74 offset:8448
    ds_write_b32 v6, v75 offset:12544
    ds_write_b32 v6, v76 offset:16640
    ds_write_b32 v6, v77 offset:20736
    ds_write_b32 v6, v78 offset:24832
    ds_write_b32 v6, v79 offset:28928
    s_waitcnt lgkmcnt(0)
    s_barrier
    ds_read_b128 v[64:67], v7
    ds_read_b128 v[68:71], v7 offset:16
    ds_read_b128 v[72:75], v7 offset:2048
    ds_read_b128 v[76:79], v7 offset:2064
    s_waitcnt vmcnt(0)
    s_waitcnt lgkmcnt(0)
    v_cvt_pk_bf16_f32 v64, 0, v64
    v_cvt_pk_bf16_f32 v65, 0, v65
    v_cvt_pk_bf16_f32 v66, 0, v66
    v_cvt_pk_bf16_f32 v67, 0, v67
    v_cvt_pk_bf16_f32 v68, 0, v68
    v_cvt_pk_bf16_f32 v69, 0, v69
    v_cvt_pk_bf16_f32 v70, 0, v70
    v_cvt_pk_bf16_f32 v71, 0, v71
    v_cvt_pk_bf16_f32 v72, 0, v72
    v_cvt_pk_bf16_f32 v73, 0, v73
    v_cvt_pk_bf16_f32 v74, 0, v74
    v_cvt_pk_bf16_f32 v75, 0, v75
    v_cvt_pk_bf16_f32 v76, 0, v76
    v_cvt_pk_bf16_f32 v77, 0, v77
    v_cvt_pk_bf16_f32 v78, 0, v78
    v_cvt_pk_bf16_f32 v79, 0, v79
    v_pk_mul_f32 v[64:65], v[64:65], v[16:17]
    v_pk_mul_f32 v[66:67], v[66:67], v[18:19]
    v_pk_mul_f32 v[68:69], v[68:69], v[20:21]
    v_pk_mul_f32 v[70:71], v[70:71], v[22:23]
    v_pk_mul_f32 v[72:73], v[72:73], v[24:25]
    v_pk_mul_f32 v[74:75], v[74:75], v[26:27]
    v_pk_mul_f32 v[76:77], v[76:77], v[28:29]
    v_pk_mul_f32 v[78:79], v[78:79], v[30:31]
    v_cvt_pk_bf16_f32 v64, 0, v64
    v_cvt_pk_bf16_f32 v65, 0, v65
    v_cvt_pk_bf16_f32 v66, 0, v66
    v_cvt_pk_bf16_f32 v67, 0, v67
    v_cvt_pk_bf16_f32 v68, 0, v68
    v_cvt_pk_bf16_f32 v69, 0, v69
    v_cvt_pk_bf16_f32 v70, 0, v70
    v_cvt_pk_bf16_f32 v71, 0, v71
    v_cvt_pk_bf16_f32 v72, 0, v72
    v_cvt_pk_bf16_f32 v73, 0, v73
    v_cvt_pk_bf16_f32 v74, 0, v74
    v_cvt_pk_bf16_f32 v75, 0, v75
    v_cvt_pk_bf16_f32 v76, 0, v76
    v_cvt_pk_bf16_f32 v77, 0, v77
    v_cvt_pk_bf16_f32 v78, 0, v78
    v_cvt_pk_bf16_f32 v79, 0, v79
    v_pk_add_f32 v[64:65], v[64:65], v[80:81]
    v_pk_add_f32 v[66:67], v[66:67], v[82:83]
    v_pk_add_f32 v[68:69], v[68:69], v[84:85]
    v_pk_add_f32 v[70:71], v[70:71], v[86:87]
    v_pk_add_f32 v[72:73], v[72:73], v[88:89]
    v_pk_add_f32 v[74:75], v[74:75], v[90:91]
    v_pk_add_f32 v[76:77], v[76:77], v[92:93]
    v_pk_add_f32 v[78:79], v[78:79], v[94:95]
    v_cvt_pk_bf16_f32 v96, v64, v65
    v_cvt_pk_bf16_f32 v97, v66, v67
    v_cvt_pk_bf16_f32 v98, v68, v69
    v_cvt_pk_bf16_f32 v99, v70, v71
    v_cvt_pk_bf16_f32 v100, v72, v73
    v_cvt_pk_bf16_f32 v101, v74, v75
    v_cvt_pk_bf16_f32 v102, v76, v77
    v_cvt_pk_bf16_f32 v103, v78, v79
    buffer_store_dwordx4 v[96:99], v9, s[12:15], s63 offen sc1
    buffer_store_dwordx4 v[100:103], v9, s[12:15], s63 offen offset:1024 sc1
    v_lshlrev_b32 v64, 16, v96
    v_and_b32 v65, 0xffff0000, v96
    v_lshlrev_b32 v66, 16, v97
    v_and_b32 v67, 0xffff0000, v97
    v_lshlrev_b32 v68, 16, v98
    v_and_b32 v69, 0xffff0000, v98
    v_lshlrev_b32 v70, 16, v99
    v_and_b32 v71, 0xffff0000, v99
    v_lshlrev_b32 v72, 16, v100
    v_and_b32 v73, 0xffff0000, v100
    v_lshlrev_b32 v74, 16, v101
    v_and_b32 v75, 0xffff0000, v101
    v_lshlrev_b32 v76, 16, v102
    v_and_b32 v77, 0xffff0000, v102
    v_lshlrev_b32 v78, 16, v103
    v_and_b32 v79, 0xffff0000, v103
    v_pk_add_f32 v[80:81], v[64:65], v[72:73]
    v_pk_add_f32 v[82:83], v[66:67], v[74:75]
    v_pk_add_f32 v[84:85], v[68:69], v[76:77]
    v_pk_add_f32 v[86:87], v[70:71], v[78:79]
    v_pk_add_f32 v[80:81], v[80:81], v[84:85]
    v_pk_add_f32 v[82:83], v[82:83], v[86:87]
    v_pk_add_f32 v[80:81], v[80:81], v[82:83]
    v_add_f32 v14, v80, v81
    s_nop 1
    v_add_f32_dpp v14, v14, v14 row_shr:1 row_mask:0xf bank_mask:0xf bound_ctrl:0
    s_nop 1
    v_add_f32_dpp v14, v14, v14 row_shr:2 row_mask:0xf bank_mask:0xf bound_ctrl:0
    s_nop 1
    v_add_f32_dpp v14, v14, v14 row_shr:4 row_mask:0xf bank_mask:0xf bound_ctrl:0
    s_nop 1
    v_add_f32_dpp v14, v14, v14 row_shr:8 row_mask:0xf bank_mask:0xf bound_ctrl:0
    s_nop 1
    v_add_f32_dpp v14, v14, v14 row_bcast:15 row_mask:0xa bank_mask:0xf
    s_nop 1
    v_add_f32_dpp v14, v14, v14 row_bcast:31 row_mask:0xc bank_mask:0xf
    s_nop 1
    v_readlane_b32 s46, v14, 63
    s_nop 1
    v_mov_b32 v15, s46
    v_mul_f32 v15, 0x3a800000, v15
    v_pk_add_f32 v[80:81], v[64:65], v[14:15] op_sel:[0,1] op_sel_hi:[1,1] neg_lo:[0,1] neg_hi:[0,1]
    v_pk_add_f32 v[82:83], v[66:67], v[14:15] op_sel:[0,1] op_sel_hi:[1,1] neg_lo:[0,1] neg_hi:[0,1]
    v_pk_add_f32 v[84:85], v[68:69], v[14:15] op_sel:[0,1] op_sel_hi:[1,1] neg_lo:[0,1] neg_hi:[0,1]
    v_pk_add_f32 v[86:87], v[70:71], v[14:15] op_sel:[0,1] op_sel_hi:[1,1] neg_lo:[0,1] neg_hi:[0,1]
    v_pk_add_f32 v[88:89], v[72:73], v[14:15] op_sel:[0,1] op_sel_hi:[1,1] neg_lo:[0,1] neg_hi:[0,1]
    v_pk_add_f32 v[90:91], v[74:75], v[14:15] op_sel:[0,1] op_sel_hi:[1,1] neg_lo:[0,1] neg_hi:[0,1]
    v_pk_add_f32 v[92:93], v[76:77], v[14:15] op_sel:[0,1] op_sel_hi:[1,1] neg_lo:[0,1] neg_hi:[0,1]
    v_pk_add_f32 v[94:95], v[78:79], v[14:15] op_sel:[0,1] op_sel_hi:[1,1] neg_lo:[0,1] neg_hi:[0,1]
    v_pk_mul_f32 v[104:105], v[80:81], v[80:81]
    v_pk_mul_f32 v[106:107], v[82:83], v[82:83]
    v_pk_fma_f32 v[104:105], v[84:85], v[84:85], v[104:105]
    v_pk_fma_f32 v[106:107], v[86:87], v[86:87], v[106:107]
    v_pk_fma_f32 v[104:105], v[88:89], v[88:89], v[104:105]
    v_pk_fma_f32 v[106:107], v[90:91], v[90:91], v[106:107]
    v_pk_fma_f32 v[104:105], v[92:93], v[92:93], v[104:105]
    v_pk_fma_f32 v[106:107], v[94:95], v[94:95], v[106:107]
    v_pk_add_f32 v[104:105], v[104:105], v[106:107]
    v_add_f32 v14, v104, v105
    v_cvt_pk_bf16_f32 v15, 0, v15
    s_nop 1
    v_add_f32_dpp v14, v14, v14 row_shr:1 row_mask:0xf bank_mask:0xf bound_ctrl:0
    s_nop 1
    v_add_f32_dpp v14, v14, v14 row_shr:2 row_mask:0xf bank_mask:0xf bound_ctrl:0
    s_nop 1
    v_add_f32_dpp v14, v14, v14 row_shr:4 row_mask:0xf bank_mask:0xf bound_ctrl:0
    s_nop 1
    v_add_f32_dpp v14, v14, v14 row_shr:8 row_mask:0xf bank_mask:0xf bound_ctrl:0
    s_nop 1
    v_add_f32_dpp v14, v14, v14 row_bcast:15 row_mask:0xa bank_mask:0xf
    s_nop 1
    v_add_f32_dpp v14, v14, v14 row_bcast:31 row_mask:0xc bank_mask:0xf
    s_nop 1
    v_readlane_b32 s47, v14, 63
    v_pk_add_f32 v[64:65], v[64:65], v[14:15] op_sel:[0,1] op_sel_hi:[1,1] neg_lo:[0,1] neg_hi:[0,1]
    v_pk_add_f32 v[66:67], v[66:67], v[14:15] op_sel:[0,1] op_sel_hi:[1,1] neg_lo:[0,1] neg_hi:[0,1]
    v_pk_add_f32 v[68:69], v[68:69], v[14:15] op_sel:[0,1] op_sel_hi:[1,1] neg_lo:[0,1] neg_hi:[0,1]
    v_pk_add_f32 v[70:71], v[70:71], v[14:15] op_sel:[0,1] op_sel_hi:[1,1] neg_lo:[0,1] neg_hi:[0,1]
    v_pk_add_f32 v[72:73], v[72:73], v[14:15] op_sel:[0,1] op_sel_hi:[1,1] neg_lo:[0,1] neg_hi:[0,1]
    v_pk_add_f32 v[74:75], v[74:75], v[14:15] op_sel:[0,1] op_sel_hi:[1,1] neg_lo:[0,1] neg_hi:[0,1]
    v_pk_add_f32 v[76:77], v[76:77], v[14:15] op_sel:[0,1] op_sel_hi:[1,1] neg_lo:[0,1] neg_hi:[0,1]
    v_pk_add_f32 v[78:79], v[78:79], v[14:15] op_sel:[0,1] op_sel_hi:[1,1] neg_lo:[0,1] neg_hi:[0,1]
    v_mov_b32 v14, s47
    v_mul_f32 v14, 0x3a800000, v14
    v_cvt_pk_bf16_f32 v14, 0, v14
    v_add_f32 v14, 0x3727c5ac, v14
    v_cvt_pk_bf16_f32 v14, 0, v14
    v_sqrt_f32 v14, v14
    s_nop 0
    v_cvt_pk_bf16_f32 v14, 0, v14
    v_rcp_f32 v14, v14
    v_cvt_pk_bf16_f32 v64, 0, v64
    v_cvt_pk_bf16_f32 v65, 0, v65
    v_cvt_pk_bf16_f32 v66, 0, v66
    v_cvt_pk_bf16_f32 v67, 0, v67
    v_cvt_pk_bf16_f32 v68, 0, v68
    v_cvt_pk_bf16_f32 v69, 0, v69
    v_cvt_pk_bf16_f32 v70, 0, v70
    v_cvt_pk_bf16_f32 v71, 0, v71
    v_cvt_pk_bf16_f32 v72, 0, v72
    v_cvt_pk_bf16_f32 v73, 0, v73
    v_cvt_pk_bf16_f32 v74, 0, v74
    v_cvt_pk_bf16_f32 v75, 0, v75
    v_cvt_pk_bf16_f32 v76, 0, v76
    v_cvt_pk_bf16_f32 v77, 0, v77
    v_cvt_pk_bf16_f32 v78, 0, v78
    v_cvt_pk_bf16_f32 v79, 0, v79
    v_pk_mul_f32 v[64:65], v[64:65], v[14:15] op_sel_hi:[1,0]
    v_pk_mul_f32 v[66:67], v[66:67], v[14:15] op_sel_hi:[1,0]
    v_pk_mul_f32 v[68:69], v[68:69], v[14:15] op_sel_hi:[1,0]
    v_pk_mul_f32 v[70:71], v[70:71], v[14:15] op_sel_hi:[1,0]
    v_pk_mul_f32 v[72:73], v[72:73], v[14:15] op_sel_hi:[1,0]
    v_pk_mul_f32 v[74:75], v[74:75], v[14:15] op_sel_hi:[1,0]
    v_pk_mul_f32 v[76:77], v[76:77], v[14:15] op_sel_hi:[1,0]
    v_pk_mul_f32 v[78:79], v[78:79], v[14:15] op_sel_hi:[1,0]
    v_cvt_pk_bf16_f32 v64, 0, v64
    v_cvt_pk_bf16_f32 v65, 0, v65
    v_cvt_pk_bf16_f32 v66, 0, v66
    v_cvt_pk_bf16_f32 v67, 0, v67
    v_cvt_pk_bf16_f32 v68, 0, v68
    v_cvt_pk_bf16_f32 v69, 0, v69
    v_cvt_pk_bf16_f32 v70, 0, v70
    v_cvt_pk_bf16_f32 v71, 0, v71
    v_cvt_pk_bf16_f32 v72, 0, v72
    v_cvt_pk_bf16_f32 v73, 0, v73
    v_cvt_pk_bf16_f32 v74, 0, v74
    v_cvt_pk_bf16_f32 v75, 0, v75
    v_cvt_pk_bf16_f32 v76, 0, v76
    v_cvt_pk_bf16_f32 v77, 0, v77
    v_cvt_pk_bf16_f32 v78, 0, v78
    v_cvt_pk_bf16_f32 v79, 0, v79
    v_pk_mul_f32 v[64:65], v[64:65], v[32:33]
    v_pk_mul_f32 v[66:67], v[66:67], v[34:35]
    v_pk_mul_f32 v[68:69], v[68:69], v[36:37]
    v_pk_mul_f32 v[70:71], v[70:71], v[38:39]
    v_pk_mul_f32 v[72:73], v[72:73], v[40:41]
    v_pk_mul_f32 v[74:75], v[74:75], v[42:43]
    v_pk_mul_f32 v[76:77], v[76:77], v[44:45]
    v_pk_mul_f32 v[78:79], v[78:79], v[46:47]
    v_cvt_pk_bf16_f32 v64, 0, v64
    v_cvt_pk_bf16_f32 v65, 0, v65
    v_cvt_pk_bf16_f32 v66, 0, v66
    v_cvt_pk_bf16_f32 v67, 0, v67
    v_cvt_pk_bf16_f32 v68, 0, v68
    v_cvt_pk_bf16_f32 v69, 0, v69
    v_cvt_pk_bf16_f32 v70, 0, v70
    v_cvt_pk_bf16_f32 v71, 0, v71
    v_cvt_pk_bf16_f32 v72, 0, v72
    v_cvt_pk_bf16_f32 v73, 0, v73
    v_cvt_pk_bf16_f32 v74, 0, v74
    v_cvt_pk_bf16_f32 v75, 0, v75
    v_cvt_pk_bf16_f32 v76, 0, v76
    v_cvt_pk_bf16_f32 v77, 0, v77
    v_cvt_pk_bf16_f32 v78, 0, v78
    v_cvt_pk_bf16_f32 v79, 0, v79
    v_pk_add_f32 v[64:65], v[64:65], v[48:49]
    v_pk_add_f32 v[66:67], v[66:67], v[50:51]
    v_pk_add_f32 v[68:69], v[68:69], v[52:53]
    v_pk_add_f32 v[70:71], v[70:71], v[54:55]
    v_pk_add_f32 v[72:73], v[72:73], v[56:57]
    v_pk_add_f32 v[74:75], v[74:75], v[58:59]
    v_pk_add_f32 v[76:77], v[76:77], v[60:61]
    v_pk_add_f32 v[78:79], v[78:79], v[62:63]
    v_cvt_pk_bf16_f32 v104, v64, v65
    v_cvt_pk_bf16_f32 v105, v66, v67
    v_cvt_pk_bf16_f32 v106, v68, v69
    v_cvt_pk_bf16_f32 v107, v70, v71
    v_cvt_pk_bf16_f32 v108, v72, v73
    v_cvt_pk_bf16_f32 v109, v74, v75
    v_cvt_pk_bf16_f32 v110, v76, v77
    v_cvt_pk_bf16_f32 v111, v78, v79
    ds_write_b128 v10, v[104:107]
    ds_write_b128 v10, v[108:111] offset:1024
    s_waitcnt lgkmcnt(0)
    s_barrier
    ds_read_b128 v[104:107], v13
    ds_read_b128 v[108:111], v13 offset:128
    s_waitcnt lgkmcnt(1)
    buffer_store_dwordx4 v[104:107], v11, s[12:15], s63 offen sc1
    s_waitcnt lgkmcnt(0)
    buffer_store_dwordx4 v[108:111], v12, s[12:15], s63 offen sc1
    s_waitcnt vmcnt(0)
    s_barrier
    s_cmp_lg_u32 s44, 0
    s_cbranch_scc1 L_sf_41
    v_mov_b32 v14, s60
    v_add_u32 v14, 1, v14
    v_mov_b32 v15, 0
    s_mov_b64 exec, 1
    buffer_store_dword v14, v15, s[12:15], s52 offen sc1
    s_mov_b64 exec, -1
L_sf_41:
    s_add_u32 s60, s60, 3
    s_cmp_lt_u32 s60, 64
    s_cbranch_scc1 L_r_loop_37
    s_branch L_c_done_1
L_w_att_15:
    s_lshl_b32 s42, s40, 2
    s_and_b32 s46, s44, 3
    s_add_u32 s42, s42, s46
    s_and_b32 s43, s48, 1
    s_lshl_b32 s43, s43, 1
    s_lshr_b32 s46, s44, 2
    s_add_u32 s43, s43, s46
    s_mul_i32 s46, s42, 24576
    s_add_u32 s46, s46, 0x2000000
    v_lshlrev_b32 v2, 4, v1
    v_add_u32 v3, s46, v2
    v_add_u32 v5, 4096, v3
    v_lshrrev_b32 v4, 4, v1
    v_and_b32 v9, 15, v1
    s_lshl_b32 s46, s42, 12
    s_add_u32 s46, s46, 0x1000000
    v_and_b32 v6, 7, v1
    v_lshlrev_b32 v6, 4, v6
    v_lshl_add_u32 v6, v4, 7, v6
    v_add_u32 v6, s46, v6
    v_and_b32 v7, 31, v1
    v_lshlrev_b32 v7, 4, v7
    v_lshrrev_b32 v10, 5, v1
    v_lshl_add_u32 v7, v10, 10, v7
    v_add_u32 v7, s46, v7
    s_mul_i32 s50, s44, 13056
    v_mul_u32_u24 v8, 272, v9
    v_lshl_add_u32 v8, v4, 4, v8
    v_add_u32 v8, s50, v8
    v_bfe_u32 v11, v1, 2, 3
    v_mul_u32_u24 v11, 272, v11
    v_lshl_add_u32 v11, v10, 6, v11
    v_and_b32 v12, 3, v1
    v_lshl_add_u32 v11, v12, 4, v11
    v_add_u32 v11, s50, v11
    v_mul_u32_u24 v14, 272, v4
    v_lshl_add_u32 v14, v9, 4, v14
    v_add_u32 v14, s50, v14
    v_mov_b32 v16, 0
    v_mov_b32 v17, 0
    v_mov_b32 v18, 0
    v_mov_b32 v19, 0
    ds_write_b128 v14, v[16:19] offset:10880
    ds_write_b128 v14, v[16:19] offset:11968
    v_lshlrev_b32 v12, 2, v4
    v_bfe_u32 v13, v1, 2, 2
    v_add_u32 v12, v12, v13
    v_mul_u32_u24 v12, 272, v12
    v_and_b32 v13, 3, v1
    v_lshl_add_u32 v12, v13, 3, v12
    v_add_u32 v12, s50, v12
    v_lshlrev_b32 v13, 10, v13
    s_lshl_b32 s46, s42, 12
    s_add_u32 s46, s46, 0x1000000
    v_add_u32 v13, s46, v13
    v_lshlrev_b32 v10, 9, v4
    v_lshl_add_u32 v10, v9, 4, v10
    s_lshl_b32 s46, s42, 13
    s_add_u32 s46, s46, 0x5000000
    v_add_u32 v10, s46, v10
    s_lshl_b32 s52, s42, 9
    s_lshl_b32 s47, s43, 7
    s_add_u32 s52, s52, s47
    s_add_u32 s52, s52, 0x102000
    v_min_u32 v42, 2, v1
    v_lshlrev_b32 v42, 9, v42
    s_lshl_b32 s46, s40, 11
    s_and_b32 s47, s42, 3
    s_lshl_b32 s47, s47, 7
    s_add_u32 s46, s46, s47
    s_add_u32 s46, s46, 0x10a400
    v_add_u32 v48, s46, v42
    s_mul_i32 s46, s42, 24576
    s_add_u32 s46, s46, 0x2000000
    v_lshlrev_b32 v49, 7, v1
    v_add_u32 v49, s46, v49
    v_cmp_le_u32 s[56:57], 32, v1
    v_lshlrev_b32 v14, 2, v4
    s_mov_b32 s54, 0x3e0293ee
    s_mov_b32 s60, s43
    v_add_u32 v15, 0, v14
    v_cmp_gt_u32 s[84:85], v15, v9
    v_add_u32 v15, 1, v14
    v_cmp_gt_u32 s[86:87], v15, v9
    v_add_u32 v15, 2, v14
    v_cmp_gt_u32 s[88:89], v15, v9
    v_add_u32 v15, 3, v14
    v_cmp_gt_u32 s[90:91], v15, v9
L_a_loop_42:
    s_mul_i32 s45, s60, 786432
    s_add_u32 s48, s45, 8192
    s_add_u32 s49, s45, 16384
    s_lshl_b32 s61, s60, 17
    s_lshl_b32 s63, s60, 18
    s_mov_b32 s70, 0
L_spin_43:
    buffer_load_dword v40, v48, s[12:15], 0 offen sc1
    s_waitcnt vmcnt(0)
    v_cmp_ge_u32 vcc, s60, v40
    s_add_u32 s70, s70, 1
    s_cbranch_vccz L_spok_44
    s_sleep 3
    s_cmp_lt_u32 s70, 524288
    s_cbranch_scc1 L_spin_43
    s_branch L_c_done_1
L_spok_44:
    buffer_load_dwordx4 a[0:3], v3, s[12:15], s45 offen offset:0 sc1
    buffer_load_dwordx4 a[4:7], v3, s[12:15], s45 offen offset:1024 sc1
    buffer_load_dwordx4 a[8:11], v3, s[12:15], s45 offen offset:2048 sc1
    buffer_load_dwordx4 a[12:15], v3, s[12:15], s45 offen offset:3072 sc1
    buffer_load_dwordx4 a[16:19], v5, s[12:15], s45 offen offset:0 sc1
    buffer_load_dwordx4 a[20:23], v5, s[12:15], s45 offen offset:1024 sc1
    buffer_load_dwordx4 a[24:27], v5, s[12:15], s45 offen offset:2048 sc1
    buffer_load_dwordx4 a[28:31], v5, s[12:15], s45 offen offset:3072 sc1
    buffer_load_dwordx4 a[32:35], v3, s[12:15], s48 offen offset:0 sc1
    buffer_load_dwordx4 a[36:39], v3, s[12:15], s48 offen offset:1024 sc1
    buffer_load_dwordx4 a[40:43], v3, s[12:15], s48 offen offset:2048 sc1
    buffer_load_dwordx4 a[44:47], v3, s[12:15], s48 offen offset:3072 sc1
    buffer_load_dwordx4 a[48:51], v5, s[12:15], s48 offen offset:0 sc1
    buffer_load_dwordx4 a[52:55], v5, s[12:15], s48 offen offset:1024 sc1
    buffer_load_dwordx4 a[56:59], v5, s[12:15], s48 offen offset:2048 sc1
    buffer_load_dwordx4 a[60:63], v5, s[12:15], s48 offen offset:3072 sc1
    buffer_load_dwordx4 v[16:19], v3, s[12:15], s49 offen offset:0 sc1
    buffer_load_dwordx4 v[20:23], v3, s[12:15], s49 offen offset:1024 sc1
    buffer_load_dwordx4 v[24:27], v3, s[12:15], s49 offen offset:2048 sc1
    buffer_load_dwordx4 v[28:31], v3, s[12:15], s49 offen offset:3072 sc1
    buffer_load_dwordx4 v[32:35], v5, s[12:15], s49 offen offset:0 sc1
    buffer_load_dwordx4 v[36:39], v5, s[12:15], s49 offen offset:1024 sc1
    buffer_load_dwordx4 v[40:43], v5, s[12:15], s49 offen offset:2048 sc1
    buffer_load_dwordx4 v[44:47], v5, s[12:15], s49 offen offset:3072 sc1
    s_waitcnt vmcnt(0)
    ds_write_b128 v8, v[16:19] offset:0
    ds_write_b128 v8, v[20:23] offset:64
    ds_write_b128 v8, v[24:27] offset:128
    ds_write_b128 v8, v[28:31] offset:192
    ds_write_b128 v8, v[32:35] offset:4352
    ds_write_b128 v8, v[36:39] offset:4416
    ds_write_b128 v8, v[40:43] offset:4480
    ds_write_b128 v8, v[44:47] offset:4544
    v_mfma_f32_16x16x32_bf16 v[56:59], a[32:35], a[0:3], 0
    v_mfma_f32_16x16x32_bf16 v[60:63], a[32:35], a[16:19], 0
    v_mfma_f32_16x16x32_bf16 v[68:71], a[48:51], a[16:19], 0
    v_mfma_f32_16x16x32_bf16 v[56:59], a[36:39], a[4:7], v[56:59]
    v_mfma_f32_16x16x32_bf16 v[60:63], a[36:39], a[20:23], v[60:63]
    v_mfma_f32_16x16x32_bf16 v[68:71], a[52:55], a[20:23], v[68:71]
    v_mfma_f32_16x16x32_bf16 v[56:59], a[40:43], a[8:11], v[56:59]
    v_mfma_f32_16x16x32_bf16 v[60:63], a[40:43], a[24:27], v[60:63]
    v_mfma_f32_16x16x32_bf16 v[68:71], a[56:59], a[24:27], v[68:71]
    v_mfma_f32_16x16x32_bf16 v[56:59], a[44:47], a[12:15], v[56:59]
    v_mfma_f32_16x16x32_bf16 v[60:63], a[44:47], a[28:31], v[60:63]
    v_mfma_f32_16x16x32_bf16 v[68:71], a[60:63], a[28:31], v[68:71]
    s_waitcnt lgkmcnt(0)
    ds_read_b64_tr_b16 a[80:81], v12 offset:0
    ds_read_b64_tr_b16 a[82:83], v12 offset:4352
    ds_read_b64_tr_b16 a[86:87], v12 offset:32
    ds_read_b64_tr_b16 a[88:89], v12 offset:4384
    ds_read_b64_tr_b16 a[92:93], v12 offset:64
    ds_read_b64_tr_b16 a[94:95], v12 offset:4416
    ds_read_b64_tr_b16 a[98:99], v12 offset:96
    ds_read_b64_tr_b16 a[100:101], v12 offset:4448
    s_waitcnt lgkmcnt(0)
    ds_read_b64_tr_b16 a[104:105], v12 offset:128
    ds_read_b64_tr_b16 a[106:107], v12 offset:4480
    ds_read_b64_tr_b16 a[110:111], v12 offset:160
    ds_read_b64_tr_b16 a[112:113], v12 offset:4512
    ds_read_b64_tr_b16 a[116:117], v12 offset:192
    ds_read_b64_tr_b16 a[118:119], v12 offset:4544
    ds_read_b64_tr_b16 a[122:123], v12 offset:224
    ds_read_b64_tr_b16 a[124:125], v12 offset:4576
    v_mov_b32 v15, 0xff800000
    v_cndmask_b32 v56, v56, v15, s[84:85]
    v_cndmask_b32 v68, v68, v15, s[84:85]
    v_cndmask_b32 v57, v57, v15, s[86:87]
    v_cndmask_b32 v69, v69, v15, s[86:87]
    v_cndmask_b32 v58, v58, v15, s[88:89]
    v_cndmask_b32 v70, v70, v15, s[88:89]
    v_cndmask_b32 v59, v59, v15, s[90:91]
    v_cndmask_b32 v71, v71, v15, s[90:91]
    s_mov_b32 s70, 0
L_a_cp_45:
    s_add_u32 s70, s70, 1
    s_cmp_ge_u32 s60, 63
    s_cbranch_scc1 L_a_fl_46
    buffer_load_dword v40, v13, s[12:15], s61 offen sc1
    s_waitcnt vmcnt(0)
    v_cmp_eq_u32 vcc, -1, v40
    s_add_u32 s70, s70, 1
    s_cbranch_vccz L_a_fl_46
L_a_cp_45_s:
    s_sleep 4
    s_cmp_lt_u32 s70, 524288
    s_cbranch_scc1 L_a_cp_45
    s_branch L_c_done_1
L_a_fl_46:
    buffer_load_dwordx4 v[24:27], v6, s[12:15], s61 offen offset:0 sc1
    buffer_load_dwordx4 v[28:31], v6, s[12:15], s61 offen offset:1024 sc1
    buffer_load_dwordx4 v[32:35], v6, s[12:15], s61 offen offset:2048 sc1
    buffer_load_dwordx4 v[36:39], v6, s[12:15], s61 offen offset:3072 sc1
    buffer_load_dwordx4 v[16:19], v7, s[12:15], s61 offen offset:512 sc1
    buffer_load_dwordx4 v[20:23], v7, s[12:15], s61 offen offset:2560 sc1
    s_waitcnt vmcnt(0)
    v_max_u32 v40, v16, v17
    v_max3_u32 v40, v40, v18, v19
    v_max3_u32 v40, v40, v20, v21
    v_max3_u32 v40, v40, v22, v23
    v_max3_u32 v40, v40, v24, v25
    v_max3_u32 v40, v40, v26, v27
    v_max3_u32 v40, v40, v28, v29
    v_max3_u32 v40, v40, v30, v31
    v_max3_u32 v40, v40, v32, v33
    v_max3_u32 v40, v40, v34, v35
    v_max3_u32 v40, v40, v36, v37
    v_max3_u32 v40, v40, v38, v39
    v_cmp_eq_u32 vcc, -1, v40
    s_nop 0
    s_cbranch_vccnz L_a_cp_45_s
    v_mfma_f32_16x16x32_bf16 v[72:75], v[24:27], a[0:3], 0
    v_mfma_f32_16x16x32_bf16 v[76:79], v[24:27], a[16:19], 0
    v_mfma_f32_16x16x32_bf16 v[72:75], v[28:31], a[4:7], v[72:75]
    v_mfma_f32_16x16x32_bf16 v[76:79], v[28:31], a[20:23], v[76:79]
    v_mfma_f32_16x16x32_bf16 v[72:75], v[32:35], a[8:11], v[72:75]
    v_mfma_f32_16x16x32_bf16 v[76:79], v[32:35], a[24:27], v[76:79]
    v_mfma_f32_16x16x32_bf16 v[72:75], v[36:39], a[12:15], v[72:75]
    v_mfma_f32_16x16x32_bf16 v[76:79], v[36:39], a[28:31], v[76:79]
    ds_write_b128 v11, v[16:19] offset:8704
    ds_write_b128 v11, v[20:23] offset:8832
    s_waitcnt lgkmcnt(0)
    ds_read_b64_tr_b16 a[84:85], v12 offset:8704
    ds_read_b64_tr_b16 a[90:91], v12 offset:8736
    ds_read_b64_tr_b16 a[96:97], v12 offset:8768
    ds_read_b64_tr_b16 a[102:103], v12 offset:8800
    ds_read_b64_tr_b16 a[108:109], v12 offset:8832
    ds_read_b64_tr_b16 a[114:115], v12 offset:8864
    ds_read_b64_tr_b16 a[120:121], v12 offset:8896
    ds_read_b64_tr_b16 a[126:127], v12 offset:8928
    v_cndmask_b32 v72, v72, v15, s[56:57]
    v_cndmask_b32 v73, v73, v15, s[56:57]
    v_cndmask_b32 v74, v74, v15, s[56:57]
    v_cndmask_b32 v75, v75, v15, s[56:57]
    v_cndmask_b32 v76, v76, v15, s[56:57]
    v_cndmask_b32 v77, v77, v15, s[56:57]
    v_cndmask_b32 v78, v78, v15, s[56:57]
    v_cndmask_b32 v79, v79, v15, s[56:57]
    v_max_f32 v40, v56, v57
    v_max3_f32 v40, v40, v58, v59
    v_max3_f32 v40, v40, v72, v73
    v_max3_f32 v40, v40, v74, v75
    v_mov_b32 v41, v40
    s_nop 1
    v_permlane16_swap_b32 v40, v41
    v_max_f32 v40, v40, v41
    v_mov_b32 v41, v40
    s_nop 1
    v_permlane32_swap_b32 v40, v41
    v_max_f32 v40, v40, v41
    v_mul_f32 v40, s54, v40
    v_fma_f32 v56, v56, s54, -v40
    v_fma_f32 v57, v57, s54, -v40
    v_fma_f32 v58, v58, s54, -v40
    v_fma_f32 v59, v59, s54, -v40
    v_fma_f32 v72, v72, s54, -v40
    v_fma_f32 v73, v73, s54, -v40
    v_fma_f32 v74, v74, s54, -v40
    v_fma_f32 v75, v75, s54, -v40
    v_exp_f32 v56, v56
    v_exp_f32 v57, v57
    v_exp_f32 v58, v58
    v_exp_f32 v59, v59
    v_exp_f32 v72, v72
    v_exp_f32 v73, v73
    v_exp_f32 v74, v74
    v_exp_f32 v75, v75
    v_add_f32 v40, v56, v57
    v_add_f32 v40, v40, v58
    v_add_f32 v40, v40, v59
    v_add_f32 v40, v40, v72
    v_add_f32 v40, v40, v73
    v_add_f32 v40, v40, v74
    v_add_f32 v40, v40, v75
    v_mov_b32 v41, v40
    s_nop 1
    v_permlane16_swap_b32 v40, v41
    v_add_f32 v40, v40, v41
    v_mov_b32 v41, v40
    s_nop 1
    v_permlane32_swap_b32 v40, v41
    v_add_f32 v40, v40, v41
    v_rcp_f32 v40, v40
    s_nop 0
    v_mul_f32 v56, v56, v40
    v_mul_f32 v57, v57, v40
    v_mul_f32 v58, v58, v40
    v_mul_f32 v59, v59, v40
    v_mul_f32 v72, v72, v40
    v_mul_f32 v73, v73, v40
    v_mul_f32 v74, v74, v40
    v_mul_f32 v75, v75, v40
    v_cvt_pk_bf16_f32 v24, v56, v57
    v_cvt_pk_bf16_f32 v25, v58, v59
    v_cvt_pk_bf16_f32 v28, v72, v73
    v_cvt_pk_bf16_f32 v29, v74, v75
    v_max_f32 v40, v60, v61
    v_max3_f32 v40, v40, v62, v63
    v_max3_f32 v40, v40, v68, v69
    v_max3_f32 v40, v40, v70, v71
    v_max3_f32 v40, v40, v76, v77
    v_max3_f32 v40, v40, v78, v79
    v_mov_b32 v41, v40
    s_nop 1
    v_permlane16_swap_b32 v40, v41
    v_max_f32 v40, v40, v41
    v_mov_b32 v41, v40
    s_nop 1
    v_permlane32_swap_b32 v40, v41
    v_max_f32 v40, v40, v41
    v_mul_f32 v40, s54, v40
    v_fma_f32 v60, v60, s54, -v40
    v_fma_f32 v61, v61, s54, -v40
    v_fma_f32 v62, v62, s54, -v40
    v_fma_f32 v63, v63, s54, -v40
    v_fma_f32 v68, v68, s54, -v40
    v_fma_f32 v69, v69, s54, -v40
    v_fma_f32 v70, v70, s54, -v40
    v_fma_f32 v71, v71, s54, -v40
    v_fma_f32 v76, v76, s54, -v40
    v_fma_f32 v77, v77, s54, -v40
    v_fma_f32 v78, v78, s54, -v40
    v_fma_f32 v79, v79, s54, -v40
    v_exp_f32 v60, v60
    v_exp_f32 v61, v61
    v_exp_f32 v62, v62
    v_exp_f32 v63, v63
    v_exp_f32 v68, v68
    v_exp_f32 v69, v69
    v_exp_f32 v70, v70
    v_exp_f32 v71, v71
    v_exp_f32 v76, v76
    v_exp_f32 v77, v77
    v_exp_f32 v78, v78
    v_exp_f32 v79, v79
    v_add_f32 v40, v60, v61
    v_add_f32 v40, v40, v62
    v_add_f32 v40, v40, v63
    v_add_f32 v40, v40, v68
    v_add_f32 v40, v40, v69
    v_add_f32 v40, v40, v70
    v_add_f32 v40, v40, v71
    v_add_f32 v40, v40, v76
    v_add_f32 v40, v40, v77
    v_add_f32 v40, v40, v78
    v_add_f32 v40, v40, v79
    v_mov_b32 v41, v40
    s_nop 1
    v_permlane16_swap_b32 v40, v41
    v_add_f32 v40, v40, v41
    v_mov_b32 v41, v40
    s_nop 1
    v_permlane32_swap_b32 v40, v41
    v_add_f32 v40, v40, v41
    v_rcp_f32 v40, v40
    s_nop 0
    v_mul_f32 v60, v60, v40
    v_mul_f32 v61, v61, v40
    v_mul_f32 v62, v62, v40
    v_mul_f32 v63, v63, v40
    v_mul_f32 v68, v68, v40
    v_mul_f32 v69, v69, v40
    v_mul_f32 v70, v70, v40
    v_mul_f32 v71, v71, v40
    v_mul_f32 v76, v76, v40
    v_mul_f32 v77, v77, v40
    v_mul_f32 v78, v78, v40
    v_mul_f32 v79, v79, v40
    v_cvt_pk_bf16_f32 v30, v60, v61
    v_cvt_pk_bf16_f32 v31, v62, v63
    v_cvt_pk_bf16_f32 v32, v68, v69
    v_cvt_pk_bf16_f32 v33, v70, v71
    v_cvt_pk_bf16_f32 v34, v76, v77
    v_cvt_pk_bf16_f32 v35, v78, v79
    s_waitcnt lgkmcnt(0)
    s_nop 0
    v_mfma_f32_16x16x16_bf16 v[64:67], a[80:81], v[24:25], 0
    v_mfma_f32_16x16x16_bf16 v[68:71], a[86:87], v[24:25], 0
    v_mfma_f32_16x16x16_bf16 v[72:75], a[92:93], v[24:25], 0
    v_mfma_f32_16x16x16_bf16 v[76:79], a[98:99], v[24:25], 0
    v_mfma_f32_16x16x16_bf16 v[80:83], a[104:105], v[24:25], 0
    v_mfma_f32_16x16x16_bf16 v[84:87], a[110:111], v[24:25], 0
    v_mfma_f32_16x16x16_bf16 v[88:91], a[116:117], v[24:25], 0
    v_mfma_f32_16x16x16_bf16 v[92:95], a[122:123], v[24:25], 0
    v_mfma_f32_16x16x16_bf16 v[64:67], a[84:85], v[28:29], v[64:67]
    v_mfma_f32_16x16x16_bf16 v[68:71], a[90:91], v[28:29], v[68:71]
    v_mfma_f32_16x16x16_bf16 v[72:75], a[96:97], v[28:29], v[72:75]
    v_mfma_f32_16x16x16_bf16 v[76:79], a[102:103], v[28:29], v[76:79]
    v_mfma_f32_16x16x16_bf16 v[80:83], a[108:109], v[28:29], v[80:83]
    v_mfma_f32_16x16x16_bf16 v[84:87], a[114:115], v[28:29], v[84:87]
    v_mfma_f32_16x16x16_bf16 v[88:91], a[120:121], v[28:29], v[88:91]
    v_mfma_f32_16x16x16_bf16 v[92:95], a[126:127], v[28:29], v[92:95]
    v_mfma_f32_16x16x16_bf16 v[96:99], a[80:81], v[30:31], 0
    v_mfma_f32_16x16x16_bf16 v[100:103], a[86:87], v[30:31], 0
    v_mfma_f32_16x16x16_bf16 v[104:107], a[92:93], v[30:31], 0
    v_mfma_f32_16x16x16_bf16 v[108:111], a[98:99], v[30:31], 0
    v_mfma_f32_16x16x16_bf16 v[112:115], a[104:105], v[30:31], 0
    v_mfma_f32_16x16x16_bf16 v[116:119], a[110:111], v[30:31], 0
    v_mfma_f32_16x16x16_bf16 v[120:123], a[116:117], v[30:31], 0
    v_mfma_f32_16x16x16_bf16 v[124:127], a[122:123], v[30:31], 0
    v_mfma_f32_16x16x16_bf16 v[96:99], a[82:83], v[32:33], v[96:99]
    v_mfma_f32_16x16x16_bf16 v[100:103], a[88:89], v[32:33], v[100:103]
    v_mfma_f32_16x16x16_bf16 v[104:107], a[94:95], v[32:33], v[104:107]
    v_mfma_f32_16x16x16_bf16 v[108:111], a[100:101], v[32:33], v[108:111]
    v_mfma_f32_16x16x16_bf16 v[112:115], a[106:107], v[32:33], v[112:115]
    v_mfma_f32_16x16x16_bf16 v[116:119], a[112:113], v[32:33], v[116:119]
    v_mfma_f32_16x16x16_bf16 v[120:123], a[118:119], v[32:33], v[120:123]
    v_mfma_f32_16x16x16_bf16 v[124:127], a[124:125], v[32:33], v[124:127]
    v_mfma_f32_16x16x16_bf16 v[96:99], a[84:85], v[34:35], v[96:99]
    v_mfma_f32_16x16x16_bf16 v[100:103], a[90:91], v[34:35], v[100:103]
    v_mfma_f32_16x16x16_bf16 v[104:107], a[96:97], v[34:35], v[104:107]
    v_mfma_f32_16x16x16_bf16 v[108:111], a[102:103], v[34:35], v[108:111]
    v_mfma_f32_16x16x16_bf16 v[112:115], a[108:109], v[34:35], v[112:115]
    v_mfma_f32_16x16x16_bf16 v[116:119], a[114:115], v[34:35], v[116:119]
    v_mfma_f32_16x16x16_bf16 v[120:123], a[120:121], v[34:35], v[120:123]
    v_mfma_f32_16x16x16_bf16 v[124:127], a[126:127], v[34:35], v[124:127]
    s_add_u32 s46, s63, 4096
    v_cvt_pk_bf16_f32 v64, v64, v65
    v_cvt_pk_bf16_f32 v65, v66, v67
    v_cvt_pk_bf16_f32 v66, v68, v69
    v_cvt_pk_bf16_f32 v67, v70, v71
    buffer_store_dwordx4 v[64:67], v10, s[12:15], s63 offen offset:0 sc1
    v_cvt_pk_bf16_f32 v72, v72, v73
    v_cvt_pk_bf16_f32 v73, v74, v75
    v_cvt_pk_bf16_f32 v74, v76, v77
    v_cvt_pk_bf16_f32 v75, v78, v79
    buffer_store_dwordx4 v[72:75], v10, s[12:15], s63 offen offset:2048 sc1
    v_cvt_pk_bf16_f32 v80, v80, v81
    v_cvt_pk_bf16_f32 v81, v82, v83
    v_cvt_pk_bf16_f32 v82, v84, v85
    v_cvt_pk_bf16_f32 v83, v86, v87
    buffer_store_dwordx4 v[80:83], v10, s[12:15], s46 offen offset:0 sc1
    v_cvt_pk_bf16_f32 v88, v88, v89
    v_cvt_pk_bf16_f32 v89, v90, v91
    v_cvt_pk_bf16_f32 v90, v92, v93
    v_cvt_pk_bf16_f32 v91, v94, v95
    buffer_store_dwordx4 v[88:91], v10, s[12:15], s46 offen offset:2048 sc1
    v_cvt_pk_bf16_f32 v96, v96, v97
    v_cvt_pk_bf16_f32 v97, v98, v99
    v_cvt_pk_bf16_f32 v98, v100, v101
    v_cvt_pk_bf16_f32 v99, v102, v103
    buffer_store_dwordx4 v[96:99], v10, s[12:15], s63 offen offset:256 sc1
    v_cvt_pk_bf16_f32 v104, v104, v105
    v_cvt_pk_bf16_f32 v105, v106, v107
    v_cvt_pk_bf16_f32 v106, v108, v109
    v_cvt_pk_bf16_f32 v107, v110, v111
    buffer_store_dwordx4 v[104:107], v10, s[12:15], s63 offen offset:2304 sc1
    v_cvt_pk_bf16_f32 v112, v112, v113
    v_cvt_pk_bf16_f32 v113, v114, v115
    v_cvt_pk_bf16_f32 v114, v116, v117
    v_cvt_pk_bf16_f32 v115, v118, v119
    buffer_store_dwordx4 v[112:115], v10, s[12:15], s46 offen offset:256 sc1
    v_cvt_pk_bf16_f32 v120, v120, v121
    v_cvt_pk_bf16_f32 v121, v122, v123
    v_cvt_pk_bf16_f32 v122, v124, v125
    v_cvt_pk_bf16_f32 v123, v126, v127
    buffer_store_dwordx4 v[120:123], v10, s[12:15], s46 offen offset:2304 sc1
    s_waitcnt vmcnt(0)
    v_mov_b32 v16, s60
    v_add_u32 v16, 1, v16
    v_mov_b32 v17, 0
    s_mov_b64 exec, 1
    buffer_store_dword v16, v17, s[12:15], s52 offen sc1
    s_mov_b64 exec, -1
L_sf_48:
    s_add_u32 s60, s60, 4
    s_cmp_lt_u32 s60, 64
    s_cbranch_scc1 L_a_loop_42
    s_branch L_c_done_1
L_w_g_10:
    s_lshr_b32 s53, s48, 2
    s_cmp_lt_u32 s53, 2
    s_cselect_b32 s46, 1, 0
    s_xor_b32 s53, s53, s46
    s_mov_b32 s74, 0
    s_mov_b32 s76, 0
    s_cmp_eq_u32 s53, 1
    s_cselect_b32 s75, 41, 58
    s_cmp_eq_u32 s53, 2
    s_cselect_b32 s75, 54, s75
L_w_g_10_e:
    s_lshl_b32 s46, s53, 3
    s_add_u32 s46, s46, 16
    s_load_dwordx2 s[4:5], s[0:1], s46
    s_lshl_b32 s49, s40, 2
    s_and_b32 s46, s48, 3
    s_add_u32 s49, s49, s46
    s_load_dwordx2 s[6:7], s[0:1], 72
    s_and_b32 s50, s44, 3
    s_lshr_b32 s51, s44, 2
    s_waitcnt lgkmcnt(0)
    s_mov_b32 s24, s4
    s_and_b32 s25, s5, 0xffff
    s_mov_b32 s26, 0x800000
    s_mov_b32 s27, 0x00020000
    s_cmp_lg_u32 s76, 0
    s_cbranch_scc1 L_g_n3_49
    s_cmp_ge_u32 s44, 3
    s_cbranch_scc1 L_g_n3_49
    s_mul_i32 s46, s48, 3
    s_add_u32 s46, s46, s44
    s_cmp_ge_u32 s46, 32
    s_cbranch_scc1 L_g_n3_49
    s_lshr_b32 s47, s46, 4
    s_add_u32 s47, s47, 1
    s_cmp_eq_u32 s47, 3
    s_cselect_b32 s47, 0, s47
    s_lshl_b32 s47, s47, 3
    s_add_u32 s47, s47, 16
    s_load_dwordx2 s[8:9], s[0:1], s47
    s_and_b32 s46, s46, 15
    s_lshl_b32 s46, s46, 19
    s_lshl_b32 s47, s40, 10
    s_add_u32 s46, s46, s47
    s_add_u32 s46, s46, 384
    v_lshlrev_b32 v10, 13, v1
    s_waitcnt lgkmcnt(0)
    s_mov_b32 s28, s8
    s_and_b32 s29, s9, 0xffff
    s_mov_b32 s30, 0x800000
    s_mov_b32 s31, 0x00020000
    buffer_load_dword v16, v10, s[28:31], s46 offen
L_g_n3_49:
    s_cmp_lg_u32 s53, 0
    s_cbranch_scc1 L_g_nq_50
    s_load_dwordx4 s[8:11], s[0:1], 24
    v_bfe_u32 v10, v0, 1, 6
    v_lshlrev_b32 v10, 13, v10
    v_and_b32 v11, 1, v0
    v_lshl_add_u32 v10, v11, 7, v10
    v_bfe_u32 v11, v0, 7, 1
    v_lshl_add_u32 v10, v11, 22, v10
    s_lshl_b32 s46, s49, 8
    s_waitcnt lgkmcnt(0)
    s_mov_b32 s28, s10
    s_and_b32 s29, s11, 0xffff
    s_mov_b32 s30, 0x800000
    s_mov_b32 s31, 0x00020000
    s_mov_b32 s32, s8
    s_and_b32 s33, s9, 0xffff
    s_mov_b32 s34, 0x800000
    s_mov_b32 s35, 0x00020000
    s_lshl_b32 s47, s51, 19
    s_add_u32 s46, s46, s47
    s_add_u32 s47, s46, 0x200000
    buffer_load_dword v11, v10, s[28:31], s47 offen
    s_add_u32 s47, s46, 0x300000
    buffer_load_dword v12, v10, s[28:31], s47 offen
L_g_nq_50:
    v_lshrrev_b32 v3, 4, v1
    v_and_b32 v4, 15, v1
    v_lshlrev_b32 v5, 2, v3
    v_xor_b32 v4, v4, v5
    v_mul_u32_u24 v3, 8192, v3
    v_lshl_add_u32 v3, v4, 4, v3
    s_mul_i32 s46, s51, 512
    s_mul_i32 s47, s50, 16
    s_add_u32 s46, s46, s47
    s_mul_i32 s46, s46, 8192
    s_lshl_b32 s47, s49, 8
    s_add_u32 s46, s46, s47
    s_lshl_b32 s45, s51, 16
    s_mul_i32 s47, s50, 4096
    s_add_u32 s45, s45, s47
    v_bfe_u32 v4, v1, 2, 2
    v_bfe_u32 v5, v1, 4, 1
    v_lshlrev_b32 v5, 1, v5
    v_bfe_u32 v6, v1, 0, 1
    v_add_u32 v5, v5, v6
    s_lshl_b32 s47, s50, 2
    v_add_u32 v5, s47, v5
    v_lshlrev_b32 v6, 2, v4
    v_xor_b32 v5, v5, v6
    v_lshlrev_b32 v5, 4, v5
    v_lshl_add_u32 v5, v4, 8, v5
    v_bfe_u32 v6, v1, 1, 1
    v_lshl_add_u32 v5, v6, 3, v5
    v_lshrrev_b32 v6, 5, v1
    v_mul_u32_u24 v6, 2048, v6
    v_add_u32 v5, v5, v6
    s_lshl_b32 s47, s51, 16
    v_add_u32 v5, s47, v5
    v_bfe_u32 v4, v1, 2, 2
    v_xor_b32 v5, s50, v4
    v_lshlrev_b32 v5, 6, v5
    v_lshl_add_u32 v5, v4, 8, v5
    v_and_b32 v6, 3, v1
    v_lshl_add_u32 v5, v6, 4, v5
    v_lshrrev_b32 v6, 4, v1
    v_lshl_add_u32 v5, v6, 11, v5
    v_lshrrev_b32 v6, 5, v1
    s_lshl_b32 s47, s51, 16
    v_add_u32 v5, s47, v5
    s_add_u32 m0, s45, 0
    s_add_u32 s47, s46, 0x0
    buffer_load_dwordx4 v3, s[24:27], s47 offen  lds
    s_add_u32 m0, s45, 1024
    s_add_u32 s47, s46, 0x8000
    buffer_load_dwordx4 v3, s[24:27], s47 offen  lds
    s_add_u32 m0, s45, 2048
    s_add_u32 s47, s46, 0x10000
    buffer_load_dwordx4 v3, s[24:27], s47 offen  lds
    s_add_u32 m0, s45, 3072
    s_add_u32 s47, s46, 0x18000
    buffer_load_dwordx4 v3, s[24:27], s47 offen  lds
    s_add_u32 m0, s45, 16384
    s_add_u32 s47, s46, 0x80000
    buffer_load_dwordx4 v3, s[24:27], s47 offen  lds
    s_add_u32 m0, s45, 17408
    s_add_u32 s47, s46, 0x88000
    buffer_load_dwordx4 v3, s[24:27], s47 offen  lds
    s_add_u32 m0, s45, 18432
    s_add_u32 s47, s46, 0x90000
    buffer_load_dwordx4 v3, s[24:27], s47 offen  lds
    s_add_u32 m0, s45, 19456
    s_add_u32 s47, s46, 0x98000
    buffer_load_dwordx4 v3, s[24:27], s47 offen  lds
    s_add_u32 m0, s45, 32768
    s_add_u32 s47, s46, 0x100000
    buffer_load_dwordx4 v3, s[24:27], s47 offen  lds
    s_add_u32 m0, s45, 33792
    s_add_u32 s47, s46, 0x108000
    buffer_load_dwordx4 v3, s[24:27], s47 offen  lds
    s_add_u32 m0, s45, 34816
    s_add_u32 s47, s46, 0x110000
    buffer_load_dwordx4 v3, s[24:27], s47 offen  lds
    s_add_u32 m0, s45, 35840
    s_add_u32 s47, s46, 0x118000
    buffer_load_dwordx4 v3, s[24:27], s47 offen  lds
    s_add_u32 m0, s45, 49152
    s_add_u32 s47, s46, 0x180000
    buffer_load_dwordx4 v3, s[24:27], s47 offen  lds
    s_add_u32 m0, s45, 50176
    s_add_u32 s47, s46, 0x188000
    buffer_load_dwordx4 v3, s[24:27], s47 offen  lds
    s_add_u32 m0, s45, 51200
    s_add_u32 s47, s46, 0x190000
    buffer_load_dwordx4 v3, s[24:27], s47 offen  lds
    s_add_u32 m0, s45, 52224
    s_add_u32 s47, s46, 0x198000
    buffer_load_dwordx4 v3, s[24:27], s47 offen  lds
    s_waitcnt vmcnt(12) lgkmcnt(0)
    s_barrier
    ds_read_b64_tr_b16 a[0:1], v5 offset:0
    ds_read_b64_tr_b16 a[2:3], v5 offset:1024
    ds_read_b64_tr_b16 a[4:5], v5 offset:8
    ds_read_b64_tr_b16 a[6:7], v5 offset:1032
    ds_read_b64_tr_b16 a[8:9], v5 offset:8192
    ds_read_b64_tr_b16 a[10:11], v5 offset:9216
    ds_read_b64_tr_b16 a[12:13], v5 offset:8200
    ds_read_b64_tr_b16 a[14:15], v5 offset:9224
    s_waitcnt vmcnt(8) lgkmcnt(0)
    s_barrier
    s_add_u32 m0, s45, 0
    s_add_u32 s47, s46, 0x200000
    buffer_load_dwordx4 v3, s[24:27], s47 offen  lds
    s_add_u32 m0, s45, 1024
    s_add_u32 s47, s46, 0x208000
    buffer_load_dwordx4 v3, s[24:27], s47 offen  lds
    s_add_u32 m0, s45, 2048
    s_add_u32 s47, s46, 0x210000
    buffer_load_dwordx4 v3, s[24:27], s47 offen  lds
    s_add_u32 m0, s45, 3072
    s_add_u32 s47, s46, 0x218000
    buffer_load_dwordx4 v3, s[24:27], s47 offen  lds
    ds_read_b64_tr_b16 a[16:17], v5 offset:16384
    ds_read_b64_tr_b16 a[18:19], v5 offset:17408
    ds_read_b64_tr_b16 a[20:21], v5 offset:16392
    ds_read_b64_tr_b16 a[22:23], v5 offset:17416
    ds_read_b64_tr_b16 a[24:25], v5 offset:24576
    ds_read_b64_tr_b16 a[26:27], v5 offset:25600
    ds_read_b64_tr_b16 a[28:29], v5 offset:24584
    ds_read_b64_tr_b16 a[30:31], v5 offset:25608
    s_waitcnt vmcnt(8) lgkmcnt(0)
    s_barrier
    s_add_u32 m0, s45, 16384
    s_add_u32 s47, s46, 0x280000
    buffer_load_dwordx4 v3, s[24:27], s47 offen  lds
    s_add_u32 m0, s45, 17408
    s_add_u32 s47, s46, 0x288000
    buffer_load_dwordx4 v3, s[24:27], s47 offen  lds
    s_add_u32 m0, s45, 18432
    s_add_u32 s47, s46, 0x290000
    buffer_load_dwordx4 v3, s[24:27], s47 offen  lds
    s_add_u32 m0, s45, 19456
    s_add_u32 s47, s46, 0x298000
    buffer_load_dwordx4 v3, s[24:27], s47 offen  lds
    ds_read_b64_tr_b16 a[32:33], v5 offset:32768
    ds_read_b64_tr_b16 a[34:35], v5 offset:33792
    ds_read_b64_tr_b16 a[36:37], v5 offset:32776
    ds_read_b64_tr_b16 a[38:39], v5 offset:33800
    ds_read_b64_tr_b16 a[40:41], v5 offset:40960
    ds_read_b64_tr_b16 a[42:43], v5 offset:41984
    ds_read_b64_tr_b16 a[44:45], v5 offset:40968
    ds_read_b64_tr_b16 a[46:47], v5 offset:41992
    s_waitcnt vmcnt(8) lgkmcnt(0)
    s_barrier
    s_add_u32 m0, s45, 32768
    s_add_u32 s47, s46, 0x300000
    buffer_load_dwordx4 v3, s[24:27], s47 offen  lds
    s_add_u32 m0, s45, 33792
    s_add_u32 s47, s46, 0x308000
    buffer_load_dwordx4 v3, s[24:27], s47 offen  lds
    s_add_u32 m0, s45, 34816
    s_add_u32 s47, s46, 0x310000
    buffer_load_dwordx4 v3, s[24:27], s47 offen  lds
    s_add_u32 m0, s45, 35840
    s_add_u32 s47, s46, 0x318000
    buffer_load_dwordx4 v3, s[24:27], s47 offen  lds
    ds_read_b64_tr_b16 a[48:49], v5 offset:49152
    ds_read_b64_tr_b16 a[50:51], v5 offset:50176
    ds_read_b64_tr_b16 a[52:53], v5 offset:49160
    ds_read_b64_tr_b16 a[54:55], v5 offset:50184
    ds_read_b64_tr_b16 a[56:57], v5 offset:57344
    ds_read_b64_tr_b16 a[58:59], v5 offset:58368
    ds_read_b64_tr_b16 a[60:61], v5 offset:57352
    ds_read_b64_tr_b16 a[62:63], v5 offset:58376
    s_waitcnt vmcnt(8) lgkmcnt(0)
    s_barrier
    s_add_u32 m0, s45, 49152
    s_add_u32 s47, s46, 0x380000
    buffer_load_dwordx4 v3, s[24:27], s47 offen  lds
    s_add_u32 m0, s45, 50176
    s_add_u32 s47, s46, 0x388000
    buffer_load_dwordx4 v3, s[24:27], s47 offen  lds
    s_add_u32 m0, s45, 51200
    s_add_u32 s47, s46, 0x390000
    buffer_load_dwordx4 v3, s[24:27], s47 offen  lds
    s_add_u32 m0, s45, 52224
    s_add_u32 s47, s46, 0x398000
    buffer_load_dwordx4 v3, s[24:27], s47 offen  lds
    ds_read_b64_tr_b16 a[64:65], v5 offset:0
    ds_read_b64_tr_b16 a[66:67], v5 offset:1024
    ds_read_b64_tr_b16 a[68:69], v5 offset:8
    ds_read_b64_tr_b16 a[70:71], v5 offset:1032
    ds_read_b64_tr_b16 a[72:73], v5 offset:8192
    ds_read_b64_tr_b16 a[74:75], v5 offset:9216
    ds_read_b64_tr_b16 a[76:77], v5 offset:8200
    ds_read_b64_tr_b16 a[78:79], v5 offset:9224
    s_waitcnt vmcnt(8) lgkmcnt(0)
    s_barrier
    ds_read_b64_tr_b16 a[80:81], v5 offset:16384
    ds_read_b64_tr_b16 a[82:83], v5 offset:17408
    ds_read_b64_tr_b16 a[84:85], v5 offset:16392
    ds_read_b64_tr_b16 a[86:87], v5 offset:17416
    ds_read_b64_tr_b16 a[88:89], v5 offset:24576
    ds_read_b64_tr_b16 a[90:91], v5 offset:25600
    ds_read_b64_tr_b16 a[92:93], v5 offset:24584
    ds_read_b64_tr_b16 a[94:95], v5 offset:25608
    s_waitcnt vmcnt(4) lgkmcnt(0)
    s_barrier
    ds_read_b64_tr_b16 a[96:97], v5 offset:32768
    ds_read_b64_tr_b16 a[98:99], v5 offset:33792
    ds_read_b64_tr_b16 a[100:101], v5 offset:32776
    ds_read_b64_tr_b16 a[102:103], v5 offset:33800
    ds_read_b64_tr_b16 a[104:105], v5 offset:40960
    ds_read_b64_tr_b16 a[106:107], v5 offset:41984
    ds_read_b64_tr_b16 a[108:109], v5 offset:40968
    ds_read_b64_tr_b16 a[110:111], v5 offset:41992
    s_waitcnt vmcnt(0) lgkmcnt(0)
    s_barrier
    ds_read_b64_tr_b16 a[112:113], v5 offset:49152
    ds_read_b64_tr_b16 a[114:115], v5 offset:50176
    ds_read_b64_tr_b16 a[116:117], v5 offset:49160
    ds_read_b64_tr_b16 a[118:119], v5 offset:50184
    ds_read_b64_tr_b16 a[120:121], v5 offset:57344
    ds_read_b64_tr_b16 a[122:123], v5 offset:58368
    ds_read_b64_tr_b16 a[124:125], v5 offset:57352
    ds_read_b64_tr_b16 a[126:127], v5 offset:58376
    s_waitcnt lgkmcnt(0)
    s_barrier
    v_lshlrev_b32 v2, 4, v1
    s_mul_i32 s64, s44, 8192
    s_add_u32 s46, s64, 0x400000
    v_add_u32 v3, s46, v2
    s_mul_i32 s46, s51, 32768
    v_add_u32 v4, s46, v2
    v_and_b32 v6, 15, v1
    v_lshlrev_b32 v6, 4, v6
    v_lshrrev_b32 v7, 4, v1
    v_lshl_add_u32 v6, v7, 9, v6
    v_add_u32 v4, s46, v6
    s_lshl_b32 s46, s50, 12
    s_add_u32 s46, s46, 131072
    v_add_u32 v5, s46, v2
    v_and_b32 v7, 3, v1
    v_lshlrev_b32 v7, 7, v7
    v_add_u32 v7, 0x109400, v7
    s_mul_i32 s46, s49, 24576
    s_lshl_b32 s47, s53, 13
    s_add_u32 s46, s46, s47
    s_lshl_b32 s47, s50, 10
    s_add_u32 s46, s46, s47
    s_add_u32 s46, s46, 0x2000000
    v_and_b32 v8, 15, v1
    v_lshlrev_b32 v8, 4, v8
    v_bfe_u32 v9, v1, 4, 1
    v_lshl_add_u32 v8, v9, 12, v8
    v_lshrrev_b32 v9, 5, v1
    v_lshl_add_u32 v8, v9, 8, v8
    v_add_u32 v8, s46, v2
    v_add_u32 v9, 4096, v8
    s_lshl_b32 s52, s40, 2
    s_add_u32 s52, s52, s53
    s_lshl_b32 s52, s52, 2
    s_and_b32 s47, s48, 3
    s_add_u32 s52, s52, s47
    s_lshl_b32 s52, s52, 7
    s_add_u32 s52, s52, 0x10a400
    s_add_u32 s52, s52, s76
    v_mov_b32 v120, -1
    v_mov_b32 v121, -1
    v_mov_b32 v122, -1
    v_mov_b32 v123, -1
    s_lshl_b32 s46, s49, 12
    s_lshl_b32 s47, s50, 10
    s_add_u32 s46, s46, s47
    s_add_u32 s46, s46, 0x1000000
    v_add_u32 v64, s46, v2
    s_and_b32 s46, s48, 3
    s_lshl_b32 s46, s46, 16
    s_lshl_b32 s47, s50, 14
    s_add_u32 s46, s46, s47
    s_lshl_b32 s47, s40, 8
    s_add_u32 s46, s46, s47
    s_add_u32 s46, s46, 0x7800000
    v_and_b32 v65, 15, v1
    v_lshlrev_b32 v65, 4, v65
    v_lshrrev_b32 v66, 4, v1
    v_lshl_add_u32 v65, v66, 11, v65
    v_add_u32 v65, s46, v65
    v_add_u32 v68, 8192, v65
    s_lshl_b32 s58, s74, 17
    s_lshl_b32 s46, s53, 3
    s_sub_u32 s46, 80, s46
    s_load_dwordx2 s[8:9], s[0:1], s46
    v_lshlrev_b32 v66, 7, v1
    s_mul_i32 s57, s49, 229376
    s_waitcnt lgkmcnt(0)
    s_mov_b32 s32, s8
    s_and_b32 s33, s9, 0xffff
    s_mov_b32 s34, 0x700000
    s_mov_b32 s35, 0x00020000
    s_mov_b32 s60, 0
    s_mul_i32 s61, s74, 65536
    s_mov_b32 s62, 0
    s_mul_i32 s63, s74, 786432
    s_mul_i32 s85, s78, 65536
    s_mul_i32 s86, s78, 786432
    s_sub_u32 s46, s78, 1
    s_sub_u32 s75, s75, s74
    s_add_u32 s75, s75, s46
    s_lshr_b32 s75, s75, s46
    s_mov_b32 s67, 0
    s_mov_b32 s68, 3
    s_mov_b32 s71, 0
    v_mov_b32 v15, 147456
    v_mov_b32 v14, 0
    ds_write_b32 v15, v14 offset:4
    ds_write_b32 v15, v14 offset:12
    ds_write_b32 v15, v14 offset:16
    v_mov_b32 v114, 1
    v_mov_b32 v115, 0
    s_mov_b32 s81, 0
    s_mul_i32 s87, s78, 2
    s_sub_u32 s87, s74, s87
    s_add_u32 s87, s87, 1
    s_lshl_b32 s46, s44, 5
    v_add_u32 v119, s46, v15
    v_lshrrev_b32 v113, 4, v1
    v_mul_u32_u24 v113, s78, v113
    v_add_u32 v113, s74, v113
    s_mov_b32 s72, 0
    s_cmp_lg_u32 s44, 0
    s_cbranch_scc1 L_zwok_60
    v_and_b32 v10, 7, v1
    v_lshlrev_b32 v10, 5, v10
    s_mov_b32 s70, 0
L_zw_59:
    buffer_load_dword v11, v10, s[16:19], 0 offen sc1
    s_waitcnt vmcnt(0)
    v_add_u32_dpp v11, v11, v11 row_ror:1 row_mask:0xf bank_mask:0xf
    s_nop 1
    v_add_u32_dpp v11, v11, v11 row_ror:2 row_mask:0xf bank_mask:0xf
    s_nop 1
    v_add_u32_dpp v11, v11, v11 row_ror:4 row_mask:0xf bank_mask:0xf
    v_cmp_ne_u32 vcc, 0x100, v11
    s_add_u32 s70, s70, 1
    s_cbranch_vccz L_zwok_60
    s_sleep 4
    s_cmp_lt_u32 s70, 524288
    s_cbranch_scc1 L_zw_59
    s_branch L_c_done_1
L_zwok_60:
L_g_restart_51:
    s_cmp_lg_u32 s44, 0
    s_cbranch_scc1 L_g_nsp_52
    s_mov_b32 s70, 0
L_g_sp_58:
    s_add_u32 s54, s60, 0
    s_mul_i32 s55, s54, s78
    v_add_u32 v12, s55, v113
    v_and_b32 v13, 7, v12
    v_lshl_add_u32 v13, v13, 9, v7
    buffer_load_dword v11, v13, s[12:15], 0 offen sc1
    s_waitcnt vmcnt(0)
    v_cmp_ge_u32 vcc, v12, v11
    s_add_u32 s70, s70, 1
    s_and_b32 s46, vcc_lo, 0xffff
    s_cbranch_scc0 L_g_sp_58_ok
    s_sleep 3
    s_cmp_lt_u32 s70, 524288
    s_cbranch_scc1 L_g_sp_58
    s_branch L_c_done_1
L_g_sp_58_ok:
    v_cmp_ge_u32 vcc, v12, v11
    s_nop 0
    s_ff1_i32_b64 s46, vcc
    s_lshr_b32 s46, s46, 4
    s_min_u32 s46, s46, 4
    s_add_u32 s46, s46, s54
    s_min_u32 s46, s46, s75
    v_mov_b32 v118, s46
    ds_write_b32 v15, v118 offset:20
L_g_nsp_52:
    s_waitcnt lgkmcnt(0)
    s_barrier
    ds_read_b32 v14, v15 offset:20
    s_waitcnt lgkmcnt(0)
    v_readfirstlane_b32 s66, v14
    s_nop 3
L_g_restart_51_go:
    s_mov_b32 s69, 0
    s_cmp_gt_u32 s62, s60
    s_cbranch_scc1 L_g_nd_61
    s_cmp_ge_u32 s62, s66
    s_cbranch_scc1 L_g_nd_61
    s_add_u32 s47, s61, 4096
    s_add_u32 m0, s64, 0
    s_nop 0
    buffer_load_dwordx4 v3, s[12:15], s61 offen offset:0 sc1 lds
    buffer_load_dwordx4 v3, s[12:15], s61 offen offset:1024 sc1 lds
    buffer_load_dwordx4 v3, s[12:15], s61 offen offset:2048 sc1 lds
    buffer_load_dwordx4 v3, s[12:15], s61 offen offset:3072 sc1 lds
    s_add_u32 m0, s64, 4096
    s_nop 0
    buffer_load_dwordx4 v3, s[12:15], s47 offen offset:0 sc1 lds
    buffer_load_dwordx4 v3, s[12:15], s47 offen offset:1024 sc1 lds
    buffer_load_dwordx4 v3, s[12:15], s47 offen offset:2048 sc1 lds
    buffer_load_dwordx4 v3, s[12:15], s47 offen offset:3072 sc1 lds
    s_add_u32 s61, s61, s85
    s_add_u32 s62, s62, 1
    s_xor_b32 s64, s64, 0x10000
    s_mov_b32 s69, 1
L_g_nd_61:
    s_cmp_eq_u32 s51, 1
    s_cbranch_scc1 L_g_g1r_53
    s_add_u32 s59, s60, 1
    s_mov_b32 s69, 0
    s_cmp_gt_u32 s62, s59
    s_cbranch_scc1 L_g_nd_62
    s_cmp_ge_u32 s62, s66
    s_cbranch_scc1 L_g_nd_62
    s_add_u32 s47, s61, 4096
    s_add_u32 m0, s64, 0
    s_nop 0
    buffer_load_dwordx4 v3, s[12:15], s61 offen offset:0 sc1 lds
    buffer_load_dwordx4 v3, s[12:15], s61 offen offset:1024 sc1 lds
    buffer_load_dwordx4 v3, s[12:15], s61 offen offset:2048 sc1 lds
    buffer_load_dwordx4 v3, s[12:15], s61 offen offset:3072 sc1 lds
    s_add_u32 m0, s64, 4096
    s_nop 0
    buffer_load_dwordx4 v3, s[12:15], s47 offen offset:0 sc1 lds
    buffer_load_dwordx4 v3, s[12:15], s47 offen offset:1024 sc1 lds
    buffer_load_dwordx4 v3, s[12:15], s47 offen offset:2048 sc1 lds
    buffer_load_dwordx4 v3, s[12:15], s47 offen offset:3072 sc1 lds
    s_add_u32 s61, s61, s85
    s_add_u32 s62, s62, 1
    s_xor_b32 s64, s64, 0x10000
    s_mov_b32 s69, 1
L_g_nd_62:
    s_cmp_eq_u32 s69, 1
    s_cbranch_scc1 L_g_w0_63
    s_waitcnt vmcnt(0)
L_g_w0_63:
    s_waitcnt vmcnt(8)
    s_cmp_lg_u32 s44, 0
    s_cbranch_scc1 L_g_nl_64
    s_cmp_lt_u32 s66, s75
    s_cselect_b32 s81, 1, 2
L_g_nl_64:
L_g_loop0_54_l:
    s_barrier
    ds_read_b128 v[32:35], v4 offset:0
    ds_read_b128 v[36:39], v4 offset:256
    ds_read_b128 v[40:43], v4 offset:2048
    ds_read_b128 v[44:47], v4 offset:2304
    ds_read_b128 v[48:51], v4 offset:4096
    ds_read_b128 v[52:55], v4 offset:4352
    ds_read_b128 v[56:59], v4 offset:6144
    ds_read_b128 v[60:63], v4 offset:6400
    s_branch L_g_loop0_54_m
.p2align 6
L_g_loop0_54:
    s_barrier
L_g_loop0_54_m:
    s_setprio 2
    s_waitcnt lgkmcnt(6)
    v_mfma_f32_16x16x32_bf16 v[16:19], a[0:3], v[32:35], 0
    v_mfma_f32_16x16x32_bf16 v[20:23], a[4:7], v[32:35], 0
    ds_read_b128 v[32:35], v4 offset:8192
    v_mfma_f32_16x16x32_bf16 v[28:31], a[4:7], v[36:39], 0
    v_mfma_f32_16x16x32_bf16 v[24:27], a[0:3], v[36:39], 0
    ds_read_b128 v[36:39], v4 offset:8448
    s_cmp_eq_u32 s81, 1
    s_cbranch_scc1 L_g_h1_68
L_g_h1_68_b:
    s_waitcnt lgkmcnt(6)
    v_mfma_f32_16x16x32_bf16 v[16:19], a[8:11], v[40:43], v[16:19]
    v_mfma_f32_16x16x32_bf16 v[20:23], a[12:15], v[40:43], v[20:23]
    ds_read_b128 v[40:43], v4 offset:10240
    v_mfma_f32_16x16x32_bf16 v[28:31], a[12:15], v[44:47], v[28:31]
    v_mfma_f32_16x16x32_bf16 v[24:27], a[8:11], v[44:47], v[24:27]
    ds_read_b128 v[44:47], v4 offset:10496
    s_waitcnt lgkmcnt(6)
    v_mfma_f32_16x16x32_bf16 v[16:19], a[16:19], v[48:51], v[16:19]
    v_mfma_f32_16x16x32_bf16 v[20:23], a[20:23], v[48:51], v[20:23]
    ds_read_b128 v[48:51], v4 offset:12288
    v_mfma_f32_16x16x32_bf16 v[28:31], a[20:23], v[52:55], v[28:31]
    v_mfma_f32_16x16x32_bf16 v[24:27], a[16:19], v[52:55], v[24:27]
    ds_read_b128 v[52:55], v4 offset:12544
    s_waitcnt lgkmcnt(6)
    v_mfma_f32_16x16x32_bf16 v[16:19], a[24:27], v[56:59], v[16:19]
    v_mfma_f32_16x16x32_bf16 v[20:23], a[28:31], v[56:59], v[20:23]
    ds_read_b128 v[56:59], v4 offset:14336
    v_mfma_f32_16x16x32_bf16 v[28:31], a[28:31], v[60:63], v[28:31]
    v_mfma_f32_16x16x32_bf16 v[24:27], a[24:27], v[60:63], v[24:27]
    ds_read_b128 v[60:63], v4 offset:14592
    s_waitcnt lgkmcnt(6)
    v_mfma_f32_16x16x32_bf16 v[16:19], a[32:35], v[32:35], v[16:19]
    v_mfma_f32_16x16x32_bf16 v[20:23], a[36:39], v[32:35], v[20:23]
    ds_read_b128 v[32:35], v4 offset:16384
    v_mfma_f32_16x16x32_bf16 v[28:31], a[36:39], v[36:39], v[28:31]
    v_mfma_f32_16x16x32_bf16 v[24:27], a[32:35], v[36:39], v[24:27]
    ds_read_b128 v[36:39], v4 offset:16640
    s_waitcnt lgkmcnt(6)
    v_mfma_f32_16x16x32_bf16 v[16:19], a[40:43], v[40:43], v[16:19]
    v_mfma_f32_16x16x32_bf16 v[20:23], a[44:47], v[40:43], v[20:23]
    ds_read_b128 v[40:43], v4 offset:18432
    v_mfma_f32_16x16x32_bf16 v[28:31], a[44:47], v[44:47], v[28:31]
    v_mfma_f32_16x16x32_bf16 v[24:27], a[40:43], v[44:47], v[24:27]
    ds_read_b128 v[44:47], v4 offset:18688
    s_waitcnt lgkmcnt(6)
    v_mfma_f32_16x16x32_bf16 v[16:19], a[48:51], v[48:51], v[16:19]
    v_mfma_f32_16x16x32_bf16 v[20:23], a[52:55], v[48:51], v[20:23]
    ds_read_b128 v[48:51], v4 offset:20480
    v_mfma_f32_16x16x32_bf16 v[28:31], a[52:55], v[52:55], v[28:31]
    v_mfma_f32_16x16x32_bf16 v[24:27], a[48:51], v[52:55], v[24:27]
    ds_read_b128 v[52:55], v4 offset:20736
    s_waitcnt lgkmcnt(6)
    v_mfma_f32_16x16x32_bf16 v[16:19], a[56:59], v[56:59], v[16:19]
    v_mfma_f32_16x16x32_bf16 v[20:23], a[60:63], v[56:59], v[20:23]
    ds_read_b128 v[56:59], v4 offset:22528
    v_mfma_f32_16x16x32_bf16 v[28:31], a[60:63], v[60:63], v[28:31]
    v_mfma_f32_16x16x32_bf16 v[24:27], a[56:59], v[60:63], v[24:27]
    ds_read_b128 v[60:63], v4 offset:22784
    s_waitcnt lgkmcnt(6)
    v_mfma_f32_16x16x32_bf16 v[16:19], a[64:67], v[32:35], v[16:19]
    v_mfma_f32_16x16x32_bf16 v[20:23], a[68:71], v[32:35], v[20:23]
    ds_read_b128 v[32:35], v4 offset:24576
    v_mfma_f32_16x16x32_bf16 v[28:31], a[68:71], v[36:39], v[28:31]
    v_mfma_f32_16x16x32_bf16 v[24:27], a[64:67], v[36:39], v[24:27]
    ds_read_b128 v[36:39], v4 offset:24832
    s_waitcnt lgkmcnt(6)
    v_mfma_f32_16x16x32_bf16 v[16:19], a[72:75], v[40:43], v[16:19]
    v_mfma_f32_16x16x32_bf16 v[20:23], a[76:79], v[40:43], v[20:23]
    ds_read_b128 v[40:43], v4 offset:26624
    v_mfma_f32_16x16x32_bf16 v[28:31], a[76:79], v[44:47], v[28:31]
    v_mfma_f32_16x16x32_bf16 v[24:27], a[72:75], v[44:47], v[24:27]
    ds_read_b128 v[44:47], v4 offset:26880
    s_waitcnt lgkmcnt(6)
    v_mfma_f32_16x16x32_bf16 v[16:19], a[80:83], v[48:51], v[16:19]
    v_mfma_f32_16x16x32_bf16 v[20:23], a[84:87], v[48:51], v[20:23]
    ds_read_b128 v[48:51], v4 offset:28672
    v_mfma_f32_16x16x32_bf16 v[28:31], a[84:87], v[52:55], v[28:31]
    v_mfma_f32_16x16x32_bf16 v[24:27], a[80:83], v[52:55], v[24:27]
    ds_read_b128 v[52:55], v4 offset:28928
    s_waitcnt lgkmcnt(6)
    v_mfma_f32_16x16x32_bf16 v[16:19], a[88:91], v[56:59], v[16:19]
    v_mfma_f32_16x16x32_bf16 v[20:23], a[92:95], v[56:59], v[20:23]
    ds_read_b128 v[56:59], v4 offset:30720
    v_mfma_f32_16x16x32_bf16 v[28:31], a[92:95], v[60:63], v[28:31]
    v_mfma_f32_16x16x32_bf16 v[24:27], a[88:91], v[60:63], v[24:27]
    ds_read_b128 v[60:63], v4 offset:30976
    s_waitcnt lgkmcnt(6)
    v_mfma_f32_16x16x32_bf16 v[16:19], a[96:99], v[32:35], v[16:19]
    v_mfma_f32_16x16x32_bf16 v[20:23], a[100:103], v[32:35], v[20:23]
    v_mfma_f32_16x16x32_bf16 v[28:31], a[100:103], v[36:39], v[28:31]
    v_mfma_f32_16x16x32_bf16 v[24:27], a[96:99], v[36:39], v[24:27]
    s_waitcnt lgkmcnt(4)
    v_mfma_f32_16x16x32_bf16 v[16:19], a[104:107], v[40:43], v[16:19]
    v_mfma_f32_16x16x32_bf16 v[20:23], a[108:111], v[40:43], v[20:23]
    v_mfma_f32_16x16x32_bf16 v[28:31], a[108:111], v[44:47], v[28:31]
    v_mfma_f32_16x16x32_bf16 v[24:27], a[104:107], v[44:47], v[24:27]
    s_waitcnt lgkmcnt(2)
    v_mfma_f32_16x16x32_bf16 v[16:19], a[112:115], v[48:51], v[16:19]
    v_mfma_f32_16x16x32_bf16 v[20:23], a[116:119], v[48:51], v[20:23]
    s_cmp_eq_u32 s81, 1
    s_cbranch_scc1 L_g_h2_69
L_g_h2_69_b:
    ds_write_b32 v119, v118
    v_mfma_f32_16x16x32_bf16 v[28:31], a[116:119], v[52:55], v[28:31]
    v_mfma_f32_16x16x32_bf16 v[24:27], a[112:115], v[52:55], v[24:27]
    s_waitcnt lgkmcnt(0)
    v_mfma_f32_16x16x32_bf16 v[16:19], a[120:123], v[56:59], v[16:19]
    v_mfma_f32_16x16x32_bf16 v[20:23], a[124:127], v[56:59], v[20:23]
    v_mfma_f32_16x16x32_bf16 v[28:31], a[124:127], v[60:63], v[28:31]
    v_mfma_f32_16x16x32_bf16 v[24:27], a[120:123], v[60:63], v[24:27]
    v_xor_b32 v4, 0x10000, v4
    s_setprio 0
    s_waitcnt vmcnt(0)
    s_waitcnt lgkmcnt(0)
    s_barrier
    ds_read_b32 v14, v15
    s_nop 6
    ds_write_b128 v5, v[16:19] offset:0
    ds_write_b128 v5, v[20:23] offset:1024
    ds_write_b128 v5, v[24:27] offset:2048
    ds_write_b128 v5, v[28:31] offset:3072
    s_waitcnt lgkmcnt(4)
    v_readfirstlane_b32 s66, v14
    s_add_u32 s60, s60, 1
    s_mov_b32 s65, 0
    s_cmp_le_u32 s62, s60
    s_cbranch_scc1 L_g_dp_70_l
L_g_dp_70_a:
    s_cmp_ge_u32 s62, s66
    s_cbranch_scc1 L_g_dp_70_d
    s_add_u32 s47, s61, 4096
    s_mov_b32 m0, s64
    s_add_u32 s62, s62, 1
    buffer_load_dwordx4 v3, s[12:15], s61 offen offset:0 sc1 lds
    buffer_load_dwordx4 v3, s[12:15], s61 offen offset:1024 sc1 lds
    buffer_load_dwordx4 v3, s[12:15], s61 offen offset:2048 sc1 lds
    buffer_load_dwordx4 v3, s[12:15], s61 offen offset:3072 sc1 lds
    s_add_u32 m0, s64, 4096
    s_add_u32 s61, s61, s85
    buffer_load_dwordx4 v3, s[12:15], s47 offen offset:0 sc1 lds
    buffer_load_dwordx4 v3, s[12:15], s47 offen offset:1024 sc1 lds
    buffer_load_dwordx4 v3, s[12:15], s47 offen offset:2048 sc1 lds
    buffer_load_dwordx4 v3, s[12:15], s47 offen offset:3072 sc1 lds
    s_xor_b32 s64, s64, 0x10000
L_g_dp_70_d:
    s_cmp_le_u32 s66, s60
    s_cbranch_scc1 L_g_ex0_67
    s_cmp_lg_u32 s65, 0
    s_cbranch_scc1 L_g_nw_66
    ds_read_b128 v[32:35], v4 offset:0
    ds_read_b128 v[36:39], v4 offset:256
    ds_read_b128 v[40:43], v4 offset:2048
    ds_read_b128 v[44:47], v4 offset:2304
    ds_read_b128 v[48:51], v4 offset:4096
    ds_read_b128 v[52:55], v4 offset:4352
    ds_read_b128 v[56:59], v4 offset:6144
    ds_read_b128 v[60:63], v4 offset:6400
    s_cmp_lg_u32 s44, 0
    s_cbranch_scc1 L_g_nl_71
    s_mov_b32 s46, s66
    s_cmp_lg_u32 s81, 0
    s_cbranch_scc1 L_g_nl_71_e
    v_cmp_ge_u32 vcc, v12, v11
    s_nop 0
    s_ff1_i32_b64 s46, vcc
    s_lshr_b32 s46, s46, 4
    s_min_u32 s46, s46, 4
    s_add_u32 s46, s46, s54
    s_min_u32 s46, s46, s75
    v_mov_b32 v118, s46
L_g_nl_71_e:
    s_add_u32 s47, s60, 3
    s_min_u32 s47, s47, s75
    s_cmp_lt_u32 s46, s47
    s_cselect_b32 s81, 1, 0
    s_cbranch_scc1 L_g_nl_71
    s_add_u32 s54, s60, 2
    s_mul_i32 s55, s54, s78
    v_add_u32 v12, s55, v113
    v_and_b32 v13, 7, v12
    v_lshl_add_u32 v13, v13, 9, v7
    buffer_load_dword v11, v13, s[12:15], 0 offen sc1
L_g_nl_71:
    s_waitcnt lgkmcnt(8)
    s_branch L_g_loop0_54
L_g_ex0_67:
    s_cmp_lg_u32 s44, 0
    s_cbranch_scc1 L_g_ex0_67_n
    ds_write_b32 v15, v118 offset:20
    s_cmp_ge_u32 s60, s75
    s_cbranch_scc1 L_g_ex0_67_n
    s_sleep 6
    s_add_u32 s54, s60, 0
    s_mul_i32 s55, s54, s78
    v_add_u32 v12, s55, v113
    v_and_b32 v13, 7, v12
    v_lshl_add_u32 v13, v13, 9, v7
    buffer_load_dword v11, v13, s[12:15], 0 offen sc1
    s_waitcnt vmcnt(0)
    v_cmp_ge_u32 vcc, v12, v11
    s_nop 0
    s_ff1_i32_b64 s46, vcc
    s_lshr_b32 s46, s46, 4
    s_min_u32 s46, s46, 4
    s_add_u32 s46, s46, s54
    s_min_u32 s46, s46, s75
    v_mov_b32 v118, s46
    ds_write_b32 v15, v118 offset:20
L_g_ex0_67_n:
    s_waitcnt lgkmcnt(0)
    s_barrier
    ds_read_b32 v14, v15 offset:20
    s_waitcnt lgkmcnt(0)
    v_readfirstlane_b32 s66, v14
    s_barrier
    s_cmp_gt_u32 s66, s60
    s_cbranch_scc1 L_g_restart_51_go
    s_branch L_g_tail_56
L_g_g1r_53:
    s_mov_b32 s65, 1
    s_branch L_g_loop1_55_e
.p2align 6
L_g_loop1_55:
    s_mov_b32 s65, 0
L_g_loop1_55_e:
    s_barrier
    s_bitcmp1_b32 s67, 1
    s_cbranch_scc0 L_g_nfl_72
    s_cmp_lg_u32 s44, 4
    s_cbranch_scc1 L_g_nfl_72_d
    s_mul_i32 s59, s60, s78
    s_add_u32 s59, s59, s87
    v_mov_b32 v10, s59
    buffer_store_dword v10, v115, s[12:15], s52 offen sc1
L_g_nfl_72_d:
    ds_read_b128 v[80:83], v5 offset:0
    ds_read_b128 v[84:87], v5 offset:1024
    ds_read_b128 v[88:91], v5 offset:2048
    ds_read_b128 v[92:95], v5 offset:3072
    s_cmp_le_u32 s62, s60
    s_cbranch_scc1 L_g_dp_77_l
L_g_dp_77_a:
    s_cmp_ge_u32 s62, s66
    s_cbranch_scc1 L_g_dp_77_d
    s_add_u32 s47, s61, 4096
    s_mov_b32 m0, s64
    s_add_u32 s62, s62, 1
    buffer_load_dwordx4 v3, s[12:15], s61 offen offset:0 sc1 lds
    buffer_load_dwordx4 v3, s[12:15], s61 offen offset:1024 sc1 lds
    buffer_load_dwordx4 v3, s[12:15], s61 offen offset:2048 sc1 lds
    buffer_load_dwordx4 v3, s[12:15], s61 offen offset:3072 sc1 lds
    s_add_u32 m0, s64, 4096
    s_add_u32 s61, s61, s85
    buffer_load_dwordx4 v3, s[12:15], s47 offen offset:0 sc1 lds
    buffer_load_dwordx4 v3, s[12:15], s47 offen offset:1024 sc1 lds
    buffer_load_dwordx4 v3, s[12:15], s47 offen offset:2048 sc1 lds
    buffer_load_dwordx4 v3, s[12:15], s47 offen offset:3072 sc1 lds
    s_xor_b32 s64, s64, 0x10000
L_g_dp_77_d:
    s_bitcmp1_b32 s67, 0
    s_cbranch_scc0 L_g_nep_73
    s_waitcnt lgkmcnt(0)
    v_add_f32 v80, v80, v16
    v_add_f32 v81, v81, v17
    v_add_f32 v82, v82, v18
    v_add_f32 v83, v83, v19
    v_add_f32 v84, v84, v20
    v_add_f32 v85, v85, v21
    v_add_f32 v86, v86, v22
    v_add_f32 v87, v87, v23
    v_add_f32 v88, v88, v24
    v_add_f32 v89, v89, v25
    v_add_f32 v90, v90, v26
    v_add_f32 v91, v91, v27
    v_add_f32 v92, v92, v28
    v_add_f32 v93, v93, v29
    v_add_f32 v94, v94, v30
    v_add_f32 v95, v95, v31
    v_cvt_pk_bf16_f32 v104, v80, v81
    v_cvt_pk_bf16_f32 v105, v82, v83
    v_cvt_pk_bf16_f32 v106, v84, v85
    v_cvt_pk_bf16_f32 v107, v86, v87
    buffer_store_dwordx4 v[104:107], v8, s[12:15], s63 offen sc1
    v_cvt_pk_bf16_f32 v108, v88, v89
    v_cvt_pk_bf16_f32 v109, v90, v91
    v_cvt_pk_bf16_f32 v110, v92, v93
    v_cvt_pk_bf16_f32 v111, v94, v95
    buffer_store_dwordx4 v[108:111], v9, s[12:15], s63 offen sc1
    s_add_u32 s63, s63, s86
    s_cmp_lg_u32 s53, 2
    s_cbranch_scc1 L_g_pf_78
    s_lshl_b32 s73, s58, 1
    buffer_store_dwordx4 v[120:123], v64, s[12:15], s58 offen sc1
    buffer_store_dwordx4 v[120:123], v65, s[12:15], s73 offen sc1
    buffer_store_dwordx4 v[120:123], v68, s[12:15], s73 offen sc1
    s_add_u32 s58, s58, 131072
L_g_pf_78:
    s_cmp_le_u32 s60, 2
    s_cbranch_scc1 L_g_nep_73_e
L_g_nep_73:
    s_cmp_lg_u32 s65, 0
    s_cbranch_scc1 L_g_nw1_74
    ds_read_b128 v[32:35], v4 offset:0
    ds_read_b128 v[36:39], v4 offset:256
    ds_read_b128 v[40:43], v4 offset:2048
    ds_read_b128 v[44:47], v4 offset:2304
    ds_read_b128 v[48:51], v4 offset:4096
    ds_read_b128 v[52:55], v4 offset:4352
    ds_read_b128 v[56:59], v4 offset:6144
    ds_read_b128 v[60:63], v4 offset:6400
    s_barrier
L_g_jn_76:
    s_setprio 1
    s_waitcnt lgkmcnt(6)
    v_mfma_f32_16x16x32_bf16 v[16:19], a[0:3], v[32:35], 0
    ds_read_b32 v14, v15
    v_mfma_f32_16x16x32_bf16 v[20:23], a[4:7], v[32:35], 0
    ds_read_b128 v[32:35], v4 offset:8192
    v_mfma_f32_16x16x32_bf16 v[28:31], a[4:7], v[36:39], 0
    v_mfma_f32_16x16x32_bf16 v[24:27], a[0:3], v[36:39], 0
    ds_read_b128 v[36:39], v4 offset:8448
    s_waitcnt lgkmcnt(6)
    v_mfma_f32_16x16x32_bf16 v[16:19], a[8:11], v[40:43], v[16:19]
    v_mfma_f32_16x16x32_bf16 v[20:23], a[12:15], v[40:43], v[20:23]
    ds_read_b128 v[40:43], v4 offset:10240
    v_mfma_f32_16x16x32_bf16 v[28:31], a[12:15], v[44:47], v[28:31]
    v_mfma_f32_16x16x32_bf16 v[24:27], a[8:11], v[44:47], v[24:27]
    ds_read_b128 v[44:47], v4 offset:10496
    s_waitcnt lgkmcnt(6)
    v_mfma_f32_16x16x32_bf16 v[16:19], a[16:19], v[48:51], v[16:19]
    v_mfma_f32_16x16x32_bf16 v[20:23], a[20:23], v[48:51], v[20:23]
    ds_read_b128 v[48:51], v4 offset:12288
    v_mfma_f32_16x16x32_bf16 v[28:31], a[20:23], v[52:55], v[28:31]
    v_mfma_f32_16x16x32_bf16 v[24:27], a[16:19], v[52:55], v[24:27]
    ds_read_b128 v[52:55], v4 offset:12544
    s_waitcnt lgkmcnt(6)
    v_mfma_f32_16x16x32_bf16 v[16:19], a[24:27], v[56:59], v[16:19]
    v_mfma_f32_16x16x32_bf16 v[20:23], a[28:31], v[56:59], v[20:23]
    ds_read_b128 v[56:59], v4 offset:14336
    v_mfma_f32_16x16x32_bf16 v[28:31], a[28:31], v[60:63], v[28:31]
    v_mfma_f32_16x16x32_bf16 v[24:27], a[24:27], v[60:63], v[24:27]
    ds_read_b128 v[60:63], v4 offset:14592
    s_waitcnt lgkmcnt(6)
    v_mfma_f32_16x16x32_bf16 v[16:19], a[32:35], v[32:35], v[16:19]
    v_mfma_f32_16x16x32_bf16 v[20:23], a[36:39], v[32:35], v[20:23]
    ds_read_b128 v[32:35], v4 offset:16384
    v_mfma_f32_16x16x32_bf16 v[28:31], a[36:39], v[36:39], v[28:31]
    v_mfma_f32_16x16x32_bf16 v[24:27], a[32:35], v[36:39], v[24:27]
    ds_read_b128 v[36:39], v4 offset:16640
    s_waitcnt lgkmcnt(6)
    v_mfma_f32_16x16x32_bf16 v[16:19], a[40:43], v[40:43], v[16:19]
    v_mfma_f32_16x16x32_bf16 v[20:23], a[44:47], v[40:43], v[20:23]
    ds_read_b128 v[40:43], v4 offset:18432
    v_mfma_f32_16x16x32_bf16 v[28:31], a[44:47], v[44:47], v[28:31]
    v_mfma_f32_16x16x32_bf16 v[24:27], a[40:43], v[44:47], v[24:27]
    ds_read_b128 v[44:47], v4 offset:18688
    s_waitcnt lgkmcnt(6)
    v_mfma_f32_16x16x32_bf16 v[16:19], a[48:51], v[48:51], v[16:19]
    v_mfma_f32_16x16x32_bf16 v[20:23], a[52:55], v[48:51], v[20:23]
    ds_read_b128 v[48:51], v4 offset:20480
    v_mfma_f32_16x16x32_bf16 v[28:31], a[52:55], v[52:55], v[28:31]
    v_mfma_f32_16x16x32_bf16 v[24:27], a[48:51], v[52:55], v[24:27]
    ds_read_b128 v[52:55], v4 offset:20736
    s_waitcnt lgkmcnt(6)
    v_mfma_f32_16x16x32_bf16 v[16:19], a[56:59], v[56:59], v[16:19]
    v_mfma_f32_16x16x32_bf16 v[20:23], a[60:63], v[56:59], v[20:23]
    ds_read_b128 v[56:59], v4 offset:22528
    v_mfma_f32_16x16x32_bf16 v[28:31], a[60:63], v[60:63], v[28:31]
    v_mfma_f32_16x16x32_bf16 v[24:27], a[56:59], v[60:63], v[24:27]
    ds_read_b128 v[60:63], v4 offset:22784
    s_waitcnt lgkmcnt(6)
    v_mfma_f32_16x16x32_bf16 v[16:19], a[64:67], v[32:35], v[16:19]
    v_mfma_f32_16x16x32_bf16 v[20:23], a[68:71], v[32:35], v[20:23]
    ds_read_b128 v[32:35], v4 offset:24576
    v_mfma_f32_16x16x32_bf16 v[28:31], a[68:71], v[36:39], v[28:31]
    v_mfma_f32_16x16x32_bf16 v[24:27], a[64:67], v[36:39], v[24:27]
    ds_read_b128 v[36:39], v4 offset:24832
    s_waitcnt lgkmcnt(6)
    v_mfma_f32_16x16x32_bf16 v[16:19], a[72:75], v[40:43], v[16:19]
    v_mfma_f32_16x16x32_bf16 v[20:23], a[76:79], v[40:43], v[20:23]
    ds_read_b128 v[40:43], v4 offset:26624
    v_mfma_f32_16x16x32_bf16 v[28:31], a[76:79], v[44:47], v[28:31]
    v_mfma_f32_16x16x32_bf16 v[24:27], a[72:75], v[44:47], v[24:27]
    ds_read_b128 v[44:47], v4 offset:26880
    s_waitcnt lgkmcnt(6)
    v_mfma_f32_16x16x32_bf16 v[16:19], a[80:83], v[48:51], v[16:19]
    v_mfma_f32_16x16x32_bf16 v[20:23], a[84:87], v[48:51], v[20:23]
    ds_read_b128 v[48:51], v4 offset:28672
    v_mfma_f32_16x16x32_bf16 v[28:31], a[84:87], v[52:55], v[28:31]
    v_mfma_f32_16x16x32_bf16 v[24:27], a[80:83], v[52:55], v[24:27]
    ds_read_b128 v[52:55], v4 offset:28928
    s_waitcnt lgkmcnt(6)
    v_mfma_f32_16x16x32_bf16 v[16:19], a[88:91], v[56:59], v[16:19]
    v_mfma_f32_16x16x32_bf16 v[20:23], a[92:95], v[56:59], v[20:23]
    ds_read_b128 v[56:59], v4 offset:30720
    v_mfma_f32_16x16x32_bf16 v[28:31], a[92:95], v[60:63], v[28:31]
    v_mfma_f32_16x16x32_bf16 v[24:27], a[88:91], v[60:63], v[24:27]
    ds_read_b128 v[60:63], v4 offset:30976
    s_waitcnt lgkmcnt(6)
    v_mfma_f32_16x16x32_bf16 v[16:19], a[96:99], v[32:35], v[16:19]
    v_mfma_f32_16x16x32_bf16 v[20:23], a[100:103], v[32:35], v[20:23]
    v_mfma_f32_16x16x32_bf16 v[28:31], a[100:103], v[36:39], v[28:31]
    v_mfma_f32_16x16x32_bf16 v[24:27], a[96:99], v[36:39], v[24:27]
    s_waitcnt lgkmcnt(4)
    v_mfma_f32_16x16x32_bf16 v[16:19], a[104:107], v[40:43], v[16:19]
    v_mfma_f32_16x16x32_bf16 v[20:23], a[108:111], v[40:43], v[20:23]
    v_mfma_f32_16x16x32_bf16 v[28:31], a[108:111], v[44:47], v[28:31]
    v_mfma_f32_16x16x32_bf16 v[24:27], a[104:107], v[44:47], v[24:27]
    s_waitcnt lgkmcnt(2)
    v_mfma_f32_16x16x32_bf16 v[16:19], a[112:115], v[48:51], v[16:19]
    v_mfma_f32_16x16x32_bf16 v[20:23], a[116:119], v[48:51], v[20:23]
    v_mfma_f32_16x16x32_bf16 v[28:31], a[116:119], v[52:55], v[28:31]
    v_mfma_f32_16x16x32_bf16 v[24:27], a[112:115], v[52:55], v[24:27]
    s_waitcnt lgkmcnt(0)
    v_mfma_f32_16x16x32_bf16 v[16:19], a[120:123], v[56:59], v[16:19]
    v_mfma_f32_16x16x32_bf16 v[20:23], a[124:127], v[56:59], v[20:23]
    v_mfma_f32_16x16x32_bf16 v[28:31], a[124:127], v[60:63], v[28:31]
    v_mfma_f32_16x16x32_bf16 v[24:27], a[120:123], v[60:63], v[24:27]
    v_xor_b32 v4, 0x10000, v4
    s_setprio 0
    s_waitcnt vmcnt(0)
    v_readfirstlane_b32 s66, v14
    s_lshl_b32 s67, s67, 1
    s_or_b32 s67, s67, 1
    s_add_u32 s60, s60, 1
    s_cmp_gt_u32 s66, s60
    s_cbranch_scc1 L_g_loop1_55
    s_barrier
    ds_read_b32 v14, v15 offset:20
    ds_read_b128 v[80:83], v5 offset:0
    ds_read_b128 v[84:87], v5 offset:1024
    ds_read_b128 v[88:91], v5 offset:2048
    ds_read_b128 v[92:95], v5 offset:3072
    s_waitcnt lgkmcnt(4)
    v_readfirstlane_b32 s66, v14
    s_barrier
    s_mov_b32 s69, 0
    s_cmp_gt_u32 s62, s60
    s_cbranch_scc1 L_g_nd_79
    s_cmp_ge_u32 s62, s66
    s_cbranch_scc1 L_g_nd_79
    s_add_u32 s47, s61, 4096
    s_add_u32 m0, s64, 0
    s_nop 0
    buffer_load_dwordx4 v3, s[12:15], s61 offen offset:0 sc1 lds
    buffer_load_dwordx4 v3, s[12:15], s61 offen offset:1024 sc1 lds
    buffer_load_dwordx4 v3, s[12:15], s61 offen offset:2048 sc1 lds
    buffer_load_dwordx4 v3, s[12:15], s61 offen offset:3072 sc1 lds
    s_add_u32 m0, s64, 4096
    s_nop 0
    buffer_load_dwordx4 v3, s[12:15], s47 offen offset:0 sc1 lds
    buffer_load_dwordx4 v3, s[12:15], s47 offen offset:1024 sc1 lds
    buffer_load_dwordx4 v3, s[12:15], s47 offen offset:2048 sc1 lds
    buffer_load_dwordx4 v3, s[12:15], s47 offen offset:3072 sc1 lds
    s_add_u32 s61, s61, s85
    s_add_u32 s62, s62, 1
    s_xor_b32 s64, s64, 0x10000
    s_mov_b32 s69, 1
L_g_nd_79:
    s_waitcnt lgkmcnt(3)
    v_add_f32 v80, v80, v16
    v_add_f32 v81, v81, v17
    v_add_f32 v82, v82, v18
    v_add_f32 v83, v83, v19
    s_waitcnt lgkmcnt(2)
    v_add_f32 v84, v84, v20
    v_add_f32 v85, v85, v21
    v_add_f32 v86, v86, v22
    v_add_f32 v87, v87, v23
    s_waitcnt lgkmcnt(1)
    v_add_f32 v88, v88, v24
    v_add_f32 v89, v89, v25
    v_add_f32 v90, v90, v26
    v_add_f32 v91, v91, v27
    s_waitcnt lgkmcnt(0)
    v_add_f32 v92, v92, v28
    v_add_f32 v93, v93, v29
    v_add_f32 v94, v94, v30
    v_add_f32 v95, v95, v31
    v_cvt_pk_bf16_f32 v104, v80, v81
    v_cvt_pk_bf16_f32 v105, v82, v83
    v_cvt_pk_bf16_f32 v106, v84, v85
    v_cvt_pk_bf16_f32 v107, v86, v87
    buffer_store_dwordx4 v[104:107], v8, s[12:15], s63 offen sc1
    v_cvt_pk_bf16_f32 v108, v88, v89
    v_cvt_pk_bf16_f32 v109, v90, v91
    v_cvt_pk_bf16_f32 v110, v92, v93
    v_cvt_pk_bf16_f32 v111, v94, v95
    buffer_store_dwordx4 v[108:111], v9, s[12:15], s63 offen sc1
    s_add_u32 s63, s63, s86
    s_cmp_lg_u32 s53, 2
    s_cbranch_scc1 L_g_pf_80
    s_lshl_b32 s73, s58, 1
    buffer_store_dwordx4 v[120:123], v64, s[12:15], s58 offen sc1
    buffer_store_dwordx4 v[120:123], v65, s[12:15], s73 offen sc1
    buffer_store_dwordx4 v[120:123], v68, s[12:15], s73 offen sc1
    s_add_u32 s58, s58, 131072
L_g_pf_80:
    s_mov_b32 s67, 0
    s_mov_b32 s71, 1
    s_cmp_gt_u32 s66, s60
    s_cbranch_scc1 L_g_g1r_53
    v_mov_b32 v10, 1
    s_mov_b64 exec, 1
    s_waitcnt vmcnt(0)
    ds_add_rtn_u32 v10, v15, v10 offset:4
    s_waitcnt lgkmcnt(0)
    v_readfirstlane_b32 s46, v10
    s_mov_b64 exec, -1
    s_mov_b32 s71, 0
    s_sub_u32 s59, s60, 1
    s_mul_i32 s59, s59, s78
    s_add_u32 s59, s59, s74
    s_cmp_lg_u32 s46, s68
    s_cbranch_scc1 L_g_df_81
    v_mov_b32 v10, s59
    v_add_u32 v10, 1, v10
    v_mov_b32 v11, 0
    s_mov_b64 exec, 1
    buffer_store_dword v10, v11, s[12:15], s52 offen sc1
    s_mov_b64 exec, -1
L_sf_82:
L_g_df_81:
    s_add_u32 s68, s68, 4
    s_cmp_gt_u32 s66, s60
    s_cbranch_scc1 L_g_g1r_53
L_g_tail_56:
    s_cmp_lt_u32 s60, s75
    s_cbranch_scc1 L_g_restart_51
    s_waitcnt vmcnt(0)
    s_barrier
    s_branch L_w_p2_11
L_g_h1_68:
    s_add_u32 s54, s60, 1
    s_mul_i32 s55, s54, s78
    v_add_u32 v12, s55, v113
    v_and_b32 v13, 7, v12
    v_lshl_add_u32 v13, v13, 9, v7
    buffer_load_dword v11, v13, s[12:15], 0 offen sc1
    s_branch L_g_h1_68_b
L_g_h2_69:
    s_waitcnt vmcnt(0)
    v_cmp_ge_u32 vcc, v12, v11
    s_nop 0
    s_ff1_i32_b64 s46, vcc
    s_lshr_b32 s46, s46, 4
    s_min_u32 s46, s46, 4
    s_add_u32 s46, s46, s54
    s_min_u32 s46, s46, s75
    v_mov_b32 v118, s46
    s_branch L_g_h2_69_b
L_g_dp_70_l:
    s_cmp_ge_u32 s62, s66
    s_cbranch_scc1 L_g_dp_70_d
    s_mov_b32 s65, 1
    s_add_u32 s47, s61, 4096
    s_mov_b32 m0, s64
    s_add_u32 s62, s62, 1
    buffer_load_dwordx4 v3, s[12:15], s61 offen offset:0 sc1 lds
    buffer_load_dwordx4 v3, s[12:15], s61 offen offset:1024 sc1 lds
    buffer_load_dwordx4 v3, s[12:15], s61 offen offset:2048 sc1 lds
    buffer_load_dwordx4 v3, s[12:15], s61 offen offset:3072 sc1 lds
    s_add_u32 m0, s64, 4096
    s_add_u32 s61, s61, s85
    buffer_load_dwordx4 v3, s[12:15], s47 offen offset:0 sc1 lds
    buffer_load_dwordx4 v3, s[12:15], s47 offen offset:1024 sc1 lds
    buffer_load_dwordx4 v3, s[12:15], s47 offen offset:2048 sc1 lds
    buffer_load_dwordx4 v3, s[12:15], s47 offen offset:3072 sc1 lds
    s_xor_b32 s64, s64, 0x10000
    s_branch L_g_dp_70_a
L_g_nw_66:
    s_waitcnt vmcnt(0) lgkmcnt(0)
    s_cmp_lg_u32 s44, 0
    s_cbranch_scc1 L_g_nl_83
    s_cmp_lt_u32 s66, s75
    s_cselect_b32 s81, 1, 2
L_g_nl_83:
    s_branch L_g_loop0_54_l
L_g_nfl_72:
    s_cmp_eq_u32 s71, 0
    s_cbranch_scc1 L_g_nfl_72_d
    v_mov_b32 v10, 1
    s_mov_b64 exec, 1
    s_waitcnt vmcnt(0)
    ds_add_rtn_u32 v10, v15, v10 offset:4
    s_waitcnt lgkmcnt(0)
    v_readfirstlane_b32 s46, v10
    s_mov_b64 exec, -1
    s_mov_b32 s71, 0
    s_sub_u32 s59, s60, 1
    s_mul_i32 s59, s59, s78
    s_add_u32 s59, s59, s74
    s_cmp_lg_u32 s46, s68
    s_cbranch_scc1 L_g_df_84
    v_mov_b32 v10, s59
    v_add_u32 v10, 1, v10
    v_mov_b32 v11, 0
    s_mov_b64 exec, 1
    buffer_store_dword v10, v11, s[12:15], s52 offen sc1
    s_mov_b64 exec, -1
L_sf_85:
L_g_df_84:
    s_add_u32 s68, s68, 4
    s_mov_b32 s65, 2
    s_branch L_g_nfl_72_d
L_g_dp_77_l:
    s_cmp_ge_u32 s62, s66
    s_cbranch_scc1 L_g_dp_77_d
    s_or_b32 s65, s65, 1
    s_add_u32 s47, s61, 4096
    s_mov_b32 m0, s64
    s_add_u32 s62, s62, 1
    buffer_load_dwordx4 v3, s[12:15], s61 offen offset:0 sc1 lds
    buffer_load_dwordx4 v3, s[12:15], s61 offen offset:1024 sc1 lds
    buffer_load_dwordx4 v3, s[12:15], s61 offen offset:2048 sc1 lds
    buffer_load_dwordx4 v3, s[12:15], s61 offen offset:3072 sc1 lds
    s_add_u32 m0, s64, 4096
    s_add_u32 s61, s61, s85
    buffer_load_dwordx4 v3, s[12:15], s47 offen offset:0 sc1 lds
    buffer_load_dwordx4 v3, s[12:15], s47 offen offset:1024 sc1 lds
    buffer_load_dwordx4 v3, s[12:15], s47 offen offset:2048 sc1 lds
    buffer_load_dwordx4 v3, s[12:15], s47 offen offset:3072 sc1 lds
    s_xor_b32 s64, s64, 0x10000
    s_branch L_g_dp_77_a
L_g_nep_73_e:
    v_mov_b32 v10, 1
    s_mov_b64 exec, 1
    s_waitcnt vmcnt(0)
    ds_add_rtn_u32 v10, v15, v10 offset:4
    s_waitcnt lgkmcnt(0)
    v_readfirstlane_b32 s46, v10
    s_mov_b64 exec, -1
    s_mov_b32 s71, 0
    s_sub_u32 s59, s60, 1
    s_mul_i32 s59, s59, s78
    s_add_u32 s59, s59, s74
    s_cmp_lg_u32 s46, s68
    s_cbranch_scc1 L_g_df_86
    v_mov_b32 v10, s59
    v_add_u32 v10, 1, v10
    v_mov_b32 v11, 0
    s_mov_b64 exec, 1
    buffer_store_dword v10, v11, s[12:15], s52 offen sc1
    s_mov_b64 exec, -1
L_sf_87:
L_g_df_86:
    s_add_u32 s68, s68, 4
    s_branch L_g_nep_73
L_g_nw1_74:
    s_cmp_eq_u32 s65, 2
    s_cbranch_scc1 L_g_nw1_74_w
    s_waitcnt vmcnt(0)
L_g_nw1_74_w:
    s_barrier
    ds_read_b128 v[32:35], v4 offset:0
    ds_read_b128 v[36:39], v4 offset:256
    ds_read_b128 v[40:43], v4 offset:2048
    ds_read_b128 v[44:47], v4 offset:2304
    ds_read_b128 v[48:51], v4 offset:4096
    ds_read_b128 v[52:55], v4 offset:4352
    ds_read_b128 v[56:59], v4 offset:6144
    ds_read_b128 v[60:63], v4 offset:6400
    s_branch L_g_jn_76
L_w_p2_11:
    s_cmp_lg_u32 s44, 0
    s_cbranch_scc1 L_w_p2_11_h
    s_mov_b32 s47, 63
    s_cmp_eq_u32 s53, 0
    s_cbranch_scc1 L_w_p2_11_q
    s_sub_u32 s52, s52, s76
    v_mov_b32 v10, 1
    v_mov_b32 v11, 131072
    s_mov_b64 exec, 1
    buffer_atomic_add v10, v11, s[12:15], s52 offen sc0
    s_waitcnt vmcnt(0)
    v_readfirstlane_b32 s46, v10
    s_mov_b64 exec, -1
    s_mov_b32 s47, 63
    s_nop 1
    s_cmp_eq_u32 s46, 0
    s_cbranch_scc1 L_w_p2_11_h
L_w_p2_11_q:
    v_mov_b32 v10, s47
    v_add_u32 v10, 1, v10
    v_mov_b32 v11, 0
    s_mov_b64 exec, 1
    buffer_store_dword v10, v11, s[12:15], s52 offen sc1
    s_mov_b64 exec, -1
L_sf_88:
L_w_p2_11_h:
    s_cmp_eq_u32 s76, 0
    s_cbranch_scc1 L_w_p2_11_m
    s_cmp_eq_u32 s79, 1
    s_cbranch_scc1 L_w_h_17
    s_mov_b32 s79, 1
    s_cmp_lt_u32 s77, 14
    s_cselect_b32 s53, 2, s53
    s_cselect_b32 s48, s48, 3
    s_branch L_w_h_17_n
L_w_p2_11_m:
    s_cmp_lt_u32 s48, 8
    s_cselect_b32 s75, 58, 58
    s_cmp_lt_u32 s48, 4
    s_cselect_b32 s75, 64, s75
L_w_p2_11_r:
    s_lshr_b32 s42, s40, 1
    s_and_b32 s43, s40, 1
    s_lshl_b32 s43, s43, 2
    s_and_b32 s46, s48, 3
    s_add_u32 s43, s43, s46
    s_cmp_lt_u32 s48, 4
    s_cbranch_scc1 L_w_wo_12
    s_cmp_lt_u32 s48, 8
    s_cbranch_scc1 L_w_f2_13
    s_cmp_lg_u32 s43, 7
    s_cbranch_scc1 L_w_f1_14
    s_mov_b32 s43, 2
    s_cmp_eq_u32 s76, 0
    s_cbranch_scc1 L_w_c_16
    s_mov_b32 s43, 7
    s_mov_b32 s78, 2
L_w_f1_14_t:
    s_cmp_lt_u32 s41, 8
    s_cselect_b32 s74, 58, 59
    s_cselect_b32 s75, 64, 64
    s_lshl_b32 s43, s43, 1
    s_add_u32 s43, s43, s74
    s_cmp_lt_u32 s43, s75
    s_cbranch_scc1 L_w_h_17_f
    s_branch L_c_done_1
L_w_f1_14_d:
    s_cmp_eq_u32 s76, 0
    s_cbranch_scc1 L_c_done_1
    s_and_b32 s42, s49, 3
    s_lshr_b32 s43, s49, 2
    s_mov_b32 s78, 64
    s_branch L_w_f1_14_t
L_replica:
    s_setprio 0
    s_barrier
    s_and_b32 s48, s41, 7
    s_add_u32 s48, s48, 4
    s_cmp_lt_u32 s41, 8
    s_cselect_b32 s74, 58, 59
    s_cselect_b32 s75, 64, 64
    s_cselect_b32 s76, 1, 2
    s_cselect_b32 s46, 58, 59
    s_cselect_b32 s47, 64, 64
    s_mov_b32 s78, 2
    s_mul_i32 s76, s76, 65536
    s_cmp_lt_u32 s48, 8
    s_cselect_b32 s74, s46, s74
    s_cselect_b32 s75, s47, s75
    s_branch L_w_p2_11_r
L_w_f1_14:
    s_load_dwordx2 s[4:5], s[0:1], 64
    s_load_dwordx2 s[6:7], s[0:1], 72
    s_and_b32 s50, s44, 3
    s_lshr_b32 s51, s44, 2
    s_waitcnt lgkmcnt(0)
    s_mov_b32 s24, s4
    s_and_b32 s25, s5, 0xffff
    s_mov_b32 s26, 0x700000
    s_mov_b32 s27, 0x00020000
    s_mul_i32 s49, s42, 7
    s_add_u32 s49, s49, s43
    v_lshrrev_b32 v3, 4, v1
    v_and_b32 v4, 15, v1
    v_lshlrev_b32 v5, 2, v3
    v_xor_b32 v4, v4, v5
    v_mul_u32_u24 v3, 7168, v3
    v_lshl_add_u32 v3, v4, 4, v3
    s_mul_i32 s46, s51, 512
    s_mul_i32 s47, s50, 16
    s_add_u32 s46, s46, s47
    s_mul_i32 s46, s46, 7168
    s_lshl_b32 s47, s49, 8
    s_add_u32 s46, s46, s47
    s_lshl_b32 s45, s51, 16
    s_mul_i32 s47, s50, 4096
    s_add_u32 s45, s45, s47
    v_bfe_u32 v4, v1, 2, 2
    v_bfe_u32 v5, v1, 4, 1
    v_lshlrev_b32 v5, 1, v5
    v_bfe_u32 v6, v1, 1, 1
    v_add_u32 v5, v5, v6
    s_lshl_b32 s47, s50, 2
    v_add_u32 v5, s47, v5
    v_lshlrev_b32 v6, 2, v4
    v_xor_b32 v5, v5, v6
    v_lshlrev_b32 v5, 4, v5
    v_lshl_add_u32 v5, v4, 8, v5
    v_bfe_u32 v6, v1, 0, 1
    v_lshl_add_u32 v5, v6, 3, v5
    v_lshrrev_b32 v6, 5, v1
    v_mul_u32_u24 v6, 2048, v6
    v_add_u32 v5, v5, v6
    s_lshl_b32 s47, s51, 16
    v_add_u32 v5, s47, v5
    s_add_u32 m0, s45, 0
    s_add_u32 s47, s46, 0x0
    buffer_load_dwordx4 v3, s[24:27], s47 offen  lds
    s_add_u32 m0, s45, 1024
    s_add_u32 s47, s46, 0x7000
    buffer_load_dwordx4 v3, s[24:27], s47 offen  lds
    s_add_u32 m0, s45, 2048
    s_add_u32 s47, s46, 0xe000
    buffer_load_dwordx4 v3, s[24:27], s47 offen  lds
    s_add_u32 m0, s45, 3072
    s_add_u32 s47, s46, 0x15000
    buffer_load_dwordx4 v3, s[24:27], s47 offen  lds
    s_add_u32 m0, s45, 16384
    s_add_u32 s47, s46, 0x70000
    buffer_load_dwordx4 v3, s[24:27], s47 offen  lds
    s_add_u32 m0, s45, 17408
    s_add_u32 s47, s46, 0x77000
    buffer_load_dwordx4 v3, s[24:27], s47 offen  lds
    s_add_u32 m0, s45, 18432
    s_add_u32 s47, s46, 0x7e000
    buffer_load_dwordx4 v3, s[24:27], s47 offen  lds
    s_add_u32 m0, s45, 19456
    s_add_u32 s47, s46, 0x85000
    buffer_load_dwordx4 v3, s[24:27], s47 offen  lds
    s_add_u32 m0, s45, 32768
    s_add_u32 s47, s46, 0xe0000
    buffer_load_dwordx4 v3, s[24:27], s47 offen  lds
    s_add_u32 m0, s45, 33792
    s_add_u32 s47, s46, 0xe7000
    buffer_load_dwordx4 v3, s[24:27], s47 offen  lds
    s_add_u32 m0, s45, 34816
    s_add_u32 s47, s46, 0xee000
    buffer_load_dwordx4 v3, s[24:27], s47 offen  lds
    s_add_u32 m0, s45, 35840
    s_add_u32 s47, s46, 0xf5000
    buffer_load_dwordx4 v3, s[24:27], s47 offen  lds
    s_add_u32 m0, s45, 49152
    s_add_u32 s47, s46, 0x150000
    buffer_load_dwordx4 v3, s[24:27], s47 offen  lds
    s_add_u32 m0, s45, 50176
    s_add_u32 s47, s46, 0x157000
    buffer_load_dwordx4 v3, s[24:27], s47 offen  lds
    s_add_u32 m0, s45, 51200
    s_add_u32 s47, s46, 0x15e000
    buffer_load_dwordx4 v3, s[24:27], s47 offen  lds
    s_add_u32 m0, s45, 52224
    s_add_u32 s47, s46, 0x165000
    buffer_load_dwordx4 v3, s[24:27], s47 offen  lds
    s_waitcnt vmcnt(12) lgkmcnt(0)
    s_barrier
    ds_read_b64_tr_b16 a[0:1], v5 offset:0
    ds_read_b64_tr_b16 a[2:3], v5 offset:1024
    ds_read_b64_tr_b16 a[4:5], v5 offset:4096
    ds_read_b64_tr_b16 a[6:7], v5 offset:5120
    ds_read_b64_tr_b16 a[8:9], v5 offset:8192
    ds_read_b64_tr_b16 a[10:11], v5 offset:9216
    ds_read_b64_tr_b16 a[12:13], v5 offset:12288
    ds_read_b64_tr_b16 a[14:15], v5 offset:13312
    s_waitcnt vmcnt(8) lgkmcnt(0)
    s_barrier
    s_add_u32 m0, s45, 0
    s_add_u32 s47, s46, 0x1c0000
    buffer_load_dwordx4 v3, s[24:27], s47 offen  lds
    s_add_u32 m0, s45, 1024
    s_add_u32 s47, s46, 0x1c7000
    buffer_load_dwordx4 v3, s[24:27], s47 offen  lds
    s_add_u32 m0, s45, 2048
    s_add_u32 s47, s46, 0x1ce000
    buffer_load_dwordx4 v3, s[24:27], s47 offen  lds
    s_add_u32 m0, s45, 3072
    s_add_u32 s47, s46, 0x1d5000
    buffer_load_dwordx4 v3, s[24:27], s47 offen  lds
    ds_read_b64_tr_b16 a[16:17], v5 offset:16384
    ds_read_b64_tr_b16 a[18:19], v5 offset:17408
    ds_read_b64_tr_b16 a[20:21], v5 offset:20480
    ds_read_b64_tr_b16 a[22:23], v5 offset:21504
    ds_read_b64_tr_b16 a[24:25], v5 offset:24576
    ds_read_b64_tr_b16 a[26:27], v5 offset:25600
    ds_read_b64_tr_b16 a[28:29], v5 offset:28672
    ds_read_b64_tr_b16 a[30:31], v5 offset:29696
    s_waitcnt vmcnt(8) lgkmcnt(0)
    s_barrier
    s_add_u32 m0, s45, 16384
    s_add_u32 s47, s46, 0x230000
    buffer_load_dwordx4 v3, s[24:27], s47 offen  lds
    s_add_u32 m0, s45, 17408
    s_add_u32 s47, s46, 0x237000
    buffer_load_dwordx4 v3, s[24:27], s47 offen  lds
    s_add_u32 m0, s45, 18432
    s_add_u32 s47, s46, 0x23e000
    buffer_load_dwordx4 v3, s[24:27], s47 offen  lds
    s_add_u32 m0, s45, 19456
    s_add_u32 s47, s46, 0x245000
    buffer_load_dwordx4 v3, s[24:27], s47 offen  lds
    ds_read_b64_tr_b16 a[32:33], v5 offset:32768
    ds_read_b64_tr_b16 a[34:35], v5 offset:33792
    ds_read_b64_tr_b16 a[36:37], v5 offset:36864
    ds_read_b64_tr_b16 a[38:39], v5 offset:37888
    ds_read_b64_tr_b16 a[40:41], v5 offset:40960
    ds_read_b64_tr_b16 a[42:43], v5 offset:41984
    ds_read_b64_tr_b16 a[44:45], v5 offset:45056
    ds_read_b64_tr_b16 a[46:47], v5 offset:46080
    s_waitcnt vmcnt(8) lgkmcnt(0)
    s_barrier
    s_add_u32 m0, s45, 32768
    s_add_u32 s47, s46, 0x2a0000
    buffer_load_dwordx4 v3, s[24:27], s47 offen  lds
    s_add_u32 m0, s45, 33792
    s_add_u32 s47, s46, 0x2a7000
    buffer_load_dwordx4 v3, s[24:27], s47 offen  lds
    s_add_u32 m0, s45, 34816
    s_add_u32 s47, s46, 0x2ae000
    buffer_load_dwordx4 v3, s[24:27], s47 offen  lds
    s_add_u32 m0, s45, 35840
    s_add_u32 s47, s46, 0x2b5000
    buffer_load_dwordx4 v3, s[24:27], s47 offen  lds
    ds_read_b64_tr_b16 a[48:49], v5 offset:49152
    ds_read_b64_tr_b16 a[50:51], v5 offset:50176
    ds_read_b64_tr_b16 a[52:53], v5 offset:53248
    ds_read_b64_tr_b16 a[54:55], v5 offset:54272
    ds_read_b64_tr_b16 a[56:57], v5 offset:57344
    ds_read_b64_tr_b16 a[58:59], v5 offset:58368
    ds_read_b64_tr_b16 a[60:61], v5 offset:61440
    ds_read_b64_tr_b16 a[62:63], v5 offset:62464
    s_waitcnt vmcnt(8) lgkmcnt(0)
    s_barrier
    s_add_u32 m0, s45, 49152
    s_add_u32 s47, s46, 0x310000
    buffer_load_dwordx4 v3, s[24:27], s47 offen  lds
    s_add_u32 m0, s45, 50176
    s_add_u32 s47, s46, 0x317000
    buffer_load_dwordx4 v3, s[24:27], s47 offen  lds
    s_add_u32 m0, s45, 51200
    s_add_u32 s47, s46, 0x31e000
    buffer_load_dwordx4 v3, s[24:27], s47 offen  lds
    s_add_u32 m0, s45, 52224
    s_add_u32 s47, s46, 0x325000
    buffer_load_dwordx4 v3, s[24:27], s47 offen  lds
    ds_read_b64_tr_b16 a[64:65], v5 offset:0
    ds_read_b64_tr_b16 a[66:67], v5 offset:1024
    ds_read_b64_tr_b16 a[68:69], v5 offset:4096
    ds_read_b64_tr_b16 a[70:71], v5 offset:5120
    ds_read_b64_tr_b16 a[72:73], v5 offset:8192
    ds_read_b64_tr_b16 a[74:75], v5 offset:9216
    ds_read_b64_tr_b16 a[76:77], v5 offset:12288
    ds_read_b64_tr_b16 a[78:79], v5 offset:13312
    s_waitcnt vmcnt(8) lgkmcnt(0)
    s_barrier
    ds_read_b64_tr_b16 a[80:81], v5 offset:16384
    ds_read_b64_tr_b16 a[82:83], v5 offset:17408
    ds_read_b64_tr_b16 a[84:85], v5 offset:20480
    ds_read_b64_tr_b16 a[86:87], v5 offset:21504
    ds_read_b64_tr_b16 a[88:89], v5 offset:24576
    ds_read_b64_tr_b16 a[90:91], v5 offset:25600
    ds_read_b64_tr_b16 a[92:93], v5 offset:28672
    ds_read_b64_tr_b16 a[94:95], v5 offset:29696
    s_waitcnt vmcnt(4) lgkmcnt(0)
    s_barrier
    ds_read_b64_tr_b16 a[96:97], v5 offset:32768
    ds_read_b64_tr_b16 a[98:99], v5 offset:33792
    ds_read_b64_tr_b16 a[100:101], v5 offset:36864
    ds_read_b64_tr_b16 a[102:103], v5 offset:37888
    ds_read_b64_tr_b16 a[104:105], v5 offset:40960
    ds_read_b64_tr_b16 a[106:107], v5 offset:41984
    ds_read_b64_tr_b16 a[108:109], v5 offset:45056
    ds_read_b64_tr_b16 a[110:111], v5 offset:46080
    s_waitcnt vmcnt(0) lgkmcnt(0)
    s_barrier
    ds_read_b64_tr_b16 a[112:113], v5 offset:49152
    ds_read_b64_tr_b16 a[114:115], v5 offset:50176
    ds_read_b64_tr_b16 a[116:117], v5 offset:53248
    ds_read_b64_tr_b16 a[118:119], v5 offset:54272
    ds_read_b64_tr_b16 a[120:121], v5 offset:57344
    ds_read_b64_tr_b16 a[122:123], v5 offset:58368
    ds_read_b64_tr_b16 a[124:125], v5 offset:61440
    ds_read_b64_tr_b16 a[126:127], v5 offset:62464
    s_waitcnt lgkmcnt(0)
    s_barrier
    v_lshlrev_b32 v2, 4, v1
    s_mul_i32 s64, s44, 8192
    s_add_u32 s46, s64, 0xc00000
    v_add_u32 v3, s46, v2
    s_mul_i32 s46, s51, 32768
    v_add_u32 v4, s46, v2
    v_and_b32 v6, 15, v1
    v_lshlrev_b32 v6, 4, v6
    v_lshrrev_b32 v7, 4, v1
    v_lshl_add_u32 v6, v7, 9, v6
    s_lshl_b32 s46, s50, 12
    s_add_u32 s46, s46, 131072
    v_add_u32 v5, s46, v2
    v_and_b32 v7, 3, v1
    v_lshlrev_b32 v7, 7, v7
    v_add_u32 v7, 0x10ec00, v7
    s_lshl_b32 s46, s49, 13
    s_lshl_b32 s47, s50, 11
    s_add_u32 s46, s46, s47
    s_add_u32 s46, s46, 0x6000000
    v_add_u32 v8, s46, v2
    s_lshl_b32 s52, s49, 7
    s_add_u32 s52, s52, 0x106400
    s_add_u32 s52, s52, s76
    s_mov_b32 s28, s6
    s_and_b32 s29, s7, 0xffff
    s_mov_b32 s30, 0x1c00
    s_mov_b32 s31, 0x00020000
    s_lshl_b32 s46, s49, 8
    s_lshl_b32 s47, s50, 6
    s_add_u32 s46, s46, s47
    v_lshrrev_b32 v9, 5, v1
    v_lshlrev_b32 v9, 3, v9
    buffer_load_dwordx2 v[32:33], v9, s[28:31], s46 offen offset:0
    buffer_load_dwordx2 v[34:35], v9, s[28:31], s46 offen offset:16
    buffer_load_dwordx2 v[36:37], v9, s[28:31], s46 offen offset:32
    buffer_load_dwordx2 v[38:39], v9, s[28:31], s46 offen offset:48
    v_add_u32 v9, 1024, v8
    s_mov_b32 s56, 0xbdd2d3e8
    s_mov_b32 s57, 0xbdd2d3e8
    v_mov_b32 v112, 0xc0135761
    s_waitcnt vmcnt(0)
    v_lshlrev_b32 v64, 16, v32
    v_and_b32 v65, 0xffff0000, v32
    v_lshlrev_b32 v66, 16, v33
    v_and_b32 v67, 0xffff0000, v33
    v_lshlrev_b32 v68, 16, v34
    v_and_b32 v69, 0xffff0000, v34
    v_lshlrev_b32 v70, 16, v35
    v_and_b32 v71, 0xffff0000, v35
    v_lshlrev_b32 v72, 16, v36
    v_and_b32 v73, 0xffff0000, v36
    v_lshlrev_b32 v74, 16, v37
    v_and_b32 v75, 0xffff0000, v37
    v_lshlrev_b32 v76, 16, v38
    v_and_b32 v77, 0xffff0000, v38
    v_lshlrev_b32 v78, 16, v39
    v_and_b32 v79, 0xffff0000, v39
    s_mul_i32 s46, s43, 8192
    s_add_u32 s46, s46, 0xc00000
    s_mul_i32 s47, s42, 0
    s_add_u32 s46, s46, s47
    v_min_u32 v116, 63, v1
    v_lshlrev_b32 v116, 7, v116
    v_add_u32 v116, s46, v116
    s_mov_b32 s60, 0
    s_mul_i32 s61, s74, 65536
    s_mov_b32 s62, 0
    s_mul_i32 s63, s74, 229376
    s_mul_i32 s85, s78, 65536
    s_mul_i32 s86, s78, 229376
    s_sub_u32 s46, s78, 1
    s_sub_u32 s75, s75, s74
    s_add_u32 s75, s75, s46
    s_lshr_b32 s75, s75, s46
    s_mov_b32 s67, 0
    s_mov_b32 s68, 3
    s_mov_b32 s71, 0
    v_mov_b32 v15, 147456
    v_mov_b32 v14, 0
    ds_write_b32 v15, v14 offset:4
    ds_write_b32 v15, v14 offset:12
    ds_write_b32 v15, v14 offset:16
    v_mov_b32 v114, 1
    v_mov_b32 v115, 0
    s_mov_b32 s81, 0
    s_mul_i32 s87, s78, 3
    s_sub_u32 s87, s74, s87
    s_add_u32 s87, s87, 1
    s_lshl_b32 s46, s44, 5
    v_add_u32 v119, s46, v15
    v_lshrrev_b32 v113, 4, v1
    v_mul_u32_u24 v113, s78, v113
    v_add_u32 v113, s74, v113
    s_mov_b32 s72, 0
L_g_restart_89:
    s_cmp_lg_u32 s44, 0
    s_cbranch_scc1 L_g_nsp_90
    s_mov_b32 s70, 0
L_g_sp_96:
    s_add_u32 s54, s60, 0
    s_mul_i32 s55, s54, s78
    v_add_u32 v12, s55, v113
    v_mul_u32_u24 v13, 171, v12
    v_lshrrev_b32 v13, 9, v13
    v_mad_i32_i24 v13, v13, -3, v12
    v_lshl_add_u32 v13, v13, 9, v7
    buffer_load_dword v11, v13, s[12:15], 0 offen sc1
    s_waitcnt vmcnt(0)
    v_cmp_ge_u32 vcc, v12, v11
    s_add_u32 s70, s70, 1
    s_and_b32 s46, vcc_lo, 0xffff
    s_cbranch_scc0 L_g_sp_96_ok
    s_sleep 3
    s_cmp_lt_u32 s70, 524288
    s_cbranch_scc1 L_g_sp_96
    s_branch L_c_done_1
L_g_sp_96_ok:
    v_cmp_ge_u32 vcc, v12, v11
    s_nop 0
    s_ff1_i32_b64 s46, vcc
    s_lshr_b32 s46, s46, 4
    s_min_u32 s46, s46, 4
    s_add_u32 s46, s46, s54
    s_min_u32 s46, s46, s75
    v_mov_b32 v118, s46
    ds_write_b32 v15, v118 offset:20
L_g_nsp_90:
    s_waitcnt lgkmcnt(0)
    s_barrier
    ds_read_b32 v14, v15 offset:20
    s_waitcnt lgkmcnt(0)
    v_readfirstlane_b32 s66, v14
    s_nop 3
L_g_restart_89_go:
    s_mov_b32 s69, 0
    s_cmp_gt_u32 s62, s60
    s_cbranch_scc1 L_g_nd_97
    s_cmp_ge_u32 s62, s66
    s_cbranch_scc1 L_g_nd_97
    s_add_u32 s47, s61, 4096
    s_add_u32 m0, s64, 0
    s_nop 0
    buffer_load_dwordx4 v3, s[12:15], s61 offen offset:0 sc1 lds
    buffer_load_dwordx4 v3, s[12:15], s61 offen offset:1024 sc1 lds
    buffer_load_dwordx4 v3, s[12:15], s61 offen offset:2048 sc1 lds
    buffer_load_dwordx4 v3, s[12:15], s61 offen offset:3072 sc1 lds
    s_add_u32 m0, s64, 4096
    s_nop 0
    buffer_load_dwordx4 v3, s[12:15], s47 offen offset:0 sc1 lds
    buffer_load_dwordx4 v3, s[12:15], s47 offen offset:1024 sc1 lds
    buffer_load_dwordx4 v3, s[12:15], s47 offen offset:2048 sc1 lds
    buffer_load_dwordx4 v3, s[12:15], s47 offen offset:3072 sc1 lds
    s_add_u32 s61, s61, s85
    s_add_u32 s62, s62, 1
    s_xor_b32 s64, s64, 0x10000
    s_mov_b32 s69, 1
L_g_nd_97:
    s_cmp_eq_u32 s51, 1
    s_cbranch_scc1 L_g_g1r_91
    s_add_u32 s59, s60, 1
    s_mov_b32 s69, 0
    s_cmp_gt_u32 s62, s59
    s_cbranch_scc1 L_g_nd_98
    s_cmp_ge_u32 s62, s66
    s_cbranch_scc1 L_g_nd_98
    s_add_u32 s47, s61, 4096
    s_add_u32 m0, s64, 0
    s_nop 0
    buffer_load_dwordx4 v3, s[12:15], s61 offen offset:0 sc1 lds
    buffer_load_dwordx4 v3, s[12:15], s61 offen offset:1024 sc1 lds
    buffer_load_dwordx4 v3, s[12:15], s61 offen offset:2048 sc1 lds
    buffer_load_dwordx4 v3, s[12:15], s61 offen offset:3072 sc1 lds
    s_add_u32 m0, s64, 4096
    s_nop 0
    buffer_load_dwordx4 v3, s[12:15], s47 offen offset:0 sc1 lds
    buffer_load_dwordx4 v3, s[12:15], s47 offen offset:1024 sc1 lds
    buffer_load_dwordx4 v3, s[12:15], s47 offen offset:2048 sc1 lds
    buffer_load_dwordx4 v3, s[12:15], s47 offen offset:3072 sc1 lds
    s_add_u32 s61, s61, s85
    s_add_u32 s62, s62, 1
    s_xor_b32 s64, s64, 0x10000
    s_mov_b32 s69, 1
L_g_nd_98:
    s_cmp_eq_u32 s69, 1
    s_cbranch_scc1 L_g_w0_99
    s_waitcnt vmcnt(0)
L_g_w0_99:
    s_waitcnt vmcnt(8)
    s_cmp_lg_u32 s44, 0
    s_cbranch_scc1 L_g_nl_100
    s_cmp_lt_u32 s66, s75
    s_cselect_b32 s81, 1, 2
L_g_nl_100:
L_g_loop0_92_l:
    s_barrier
    ds_read_b128 v[32:35], v4 offset:0
    ds_read_b128 v[36:39], v4 offset:1024
    ds_read_b128 v[40:43], v4 offset:2048
    ds_read_b128 v[44:47], v4 offset:3072
    ds_read_b128 v[48:51], v4 offset:4096
    ds_read_b128 v[52:55], v4 offset:5120
    ds_read_b128 v[56:59], v4 offset:6144
    ds_read_b128 v[60:63], v4 offset:7168
    s_branch L_g_loop0_92_m
.p2align 6
L_g_loop0_92:
    s_barrier
L_g_loop0_92_m:
    s_setprio 2
    s_waitcnt lgkmcnt(6)
    v_mfma_f32_32x32x16_bf16 v[16:31], a[0:3], v[32:35], v[64:79]
    ds_read_b128 v[32:35], v4 offset:8192
    v_mfma_f32_32x32x16_bf16 v[16:31], a[4:7], v[36:39], v[16:31]
    ds_read_b128 v[36:39], v4 offset:9216
    s_cmp_eq_u32 s81, 1
    s_cbranch_scc1 L_g_h1_104
L_g_h1_104_b:
    s_waitcnt lgkmcnt(6)
    v_mfma_f32_32x32x16_bf16 v[16:31], a[8:11], v[40:43], v[16:31]
    ds_read_b128 v[40:43], v4 offset:10240
    v_mfma_f32_32x32x16_bf16 v[16:31], a[12:15], v[44:47], v[16:31]
    ds_read_b128 v[44:47], v4 offset:11264
    s_waitcnt lgkmcnt(6)
    v_mfma_f32_32x32x16_bf16 v[16:31], a[16:19], v[48:51], v[16:31]
    ds_read_b128 v[48:51], v4 offset:12288
    v_mfma_f32_32x32x16_bf16 v[16:31], a[20:23], v[52:55], v[16:31]
    ds_read_b128 v[52:55], v4 offset:13312
    s_waitcnt lgkmcnt(6)
    v_mfma_f32_32x32x16_bf16 v[16:31], a[24:27], v[56:59], v[16:31]
    ds_read_b128 v[56:59], v4 offset:14336
    v_mfma_f32_32x32x16_bf16 v[16:31], a[28:31], v[60:63], v[16:31]
    ds_read_b128 v[60:63], v4 offset:15360
    s_waitcnt lgkmcnt(6)
    v_mfma_f32_32x32x16_bf16 v[16:31], a[32:35], v[32:35], v[16:31]
    ds_read_b128 v[32:35], v4 offset:16384
    v_mfma_f32_32x32x16_bf16 v[16:31], a[36:39], v[36:39], v[16:31]
    ds_read_b128 v[36:39], v4 offset:17408
    s_waitcnt lgkmcnt(6)
    v_mfma_f32_32x32x16_bf16 v[16:31], a[40:43], v[40:43], v[16:31]
    ds_read_b128 v[40:43], v4 offset:18432
    v_mfma_f32_32x32x16_bf16 v[16:31], a[44:47], v[44:47], v[16:31]
    ds_read_b128 v[44:47], v4 offset:19456
    s_waitcnt lgkmcnt(6)
    v_mfma_f32_32x32x16_bf16 v[16:31], a[48:51], v[48:51], v[16:31]
    ds_read_b128 v[48:51], v4 offset:20480
    v_mfma_f32_32x32x16_bf16 v[16:31], a[52:55], v[52:55], v[16:31]
    ds_read_b128 v[52:55], v4 offset:21504
    s_waitcnt lgkmcnt(6)
    v_mfma_f32_32x32x16_bf16 v[16:31], a[56:59], v[56:59], v[16:31]
    ds_read_b128 v[56:59], v4 offset:22528
    v_mfma_f32_32x32x16_bf16 v[16:31], a[60:63], v[60:63], v[16:31]
    ds_read_b128 v[60:63], v4 offset:23552
    s_waitcnt lgkmcnt(6)
    v_mfma_f32_32x32x16_bf16 v[16:31], a[64:67], v[32:35], v[16:31]
    ds_read_b128 v[32:35], v4 offset:24576
    v_mfma_f32_32x32x16_bf16 v[16:31], a[68:71], v[36:39], v[16:31]
    ds_read_b128 v[36:39], v4 offset:25600
    s_waitcnt lgkmcnt(6)
    v_mfma_f32_32x32x16_bf16 v[16:31], a[72:75], v[40:43], v[16:31]
    ds_read_b128 v[40:43], v4 offset:26624
    v_mfma_f32_32x32x16_bf16 v[16:31], a[76:79], v[44:47], v[16:31]
    ds_read_b128 v[44:47], v4 offset:27648
    s_waitcnt lgkmcnt(6)
    v_mfma_f32_32x32x16_bf16 v[16:31], a[80:83], v[48:51], v[16:31]
    ds_read_b128 v[48:51], v4 offset:28672
    v_mfma_f32_32x32x16_bf16 v[16:31], a[84:87], v[52:55], v[16:31]
    ds_read_b128 v[52:55], v4 offset:29696
    s_waitcnt lgkmcnt(6)
    v_mfma_f32_32x32x16_bf16 v[16:31], a[88:91], v[56:59], v[16:31]
    ds_read_b128 v[56:59], v4 offset:30720
    v_mfma_f32_32x32x16_bf16 v[16:31], a[92:95], v[60:63], v[16:31]
    ds_read_b128 v[60:63], v4 offset:31744
    s_waitcnt lgkmcnt(6)
    v_mfma_f32_32x32x16_bf16 v[16:31], a[96:99], v[32:35], v[16:31]
    v_mfma_f32_32x32x16_bf16 v[16:31], a[100:103], v[36:39], v[16:31]
    s_waitcnt lgkmcnt(4)
    v_mfma_f32_32x32x16_bf16 v[16:31], a[104:107], v[40:43], v[16:31]
    v_mfma_f32_32x32x16_bf16 v[16:31], a[108:111], v[44:47], v[16:31]
    s_waitcnt lgkmcnt(2)
    v_mfma_f32_32x32x16_bf16 v[16:31], a[112:115], v[48:51], v[16:31]
    s_cmp_eq_u32 s81, 1
    s_cbranch_scc1 L_g_h2_105
L_g_h2_105_b:
    ds_write_b32 v119, v118
    v_mfma_f32_32x32x16_bf16 v[16:31], a[116:119], v[52:55], v[16:31]
    s_waitcnt lgkmcnt(0)
    v_mfma_f32_32x32x16_bf16 v[16:31], a[120:123], v[56:59], v[16:31]
    v_mfma_f32_32x32x16_bf16 v[16:31], a[124:127], v[60:63], v[16:31]
    v_xor_b32 v4, 0x10000, v4
    s_setprio 0
    s_waitcnt vmcnt(0)
    s_waitcnt lgkmcnt(0)
    s_barrier
    ds_read_b32 v14, v15
    s_nop 6
    ds_write_b128 v5, v[16:19] offset:0
    ds_write_b128 v5, v[20:23] offset:1024
    ds_write_b128 v5, v[24:27] offset:2048
    ds_write_b128 v5, v[28:31] offset:3072
    s_waitcnt lgkmcnt(4)
    v_readfirstlane_b32 s66, v14
    s_add_u32 s60, s60, 1
    s_mov_b32 s65, 0
    s_cmp_le_u32 s62, s60
    s_cbranch_scc1 L_g_dp_106_l
L_g_dp_106_a:
    s_cmp_ge_u32 s62, s66
    s_cbranch_scc1 L_g_dp_106_d
    s_add_u32 s47, s61, 4096
    s_mov_b32 m0, s64
    s_add_u32 s62, s62, 1
    buffer_load_dwordx4 v3, s[12:15], s61 offen offset:0 sc1 lds
    buffer_load_dwordx4 v3, s[12:15], s61 offen offset:1024 sc1 lds
    buffer_load_dwordx4 v3, s[12:15], s61 offen offset:2048 sc1 lds
    buffer_load_dwordx4 v3, s[12:15], s61 offen offset:3072 sc1 lds
    s_add_u32 m0, s64, 4096
    s_add_u32 s61, s61, s85
    buffer_load_dwordx4 v3, s[12:15], s47 offen offset:0 sc1 lds
    buffer_load_dwordx4 v3, s[12:15], s47 offen offset:1024 sc1 lds
    buffer_load_dwordx4 v3, s[12:15], s47 offen offset:2048 sc1 lds
    buffer_load_dwordx4 v3, s[12:15], s47 offen offset:3072 sc1 lds
    s_xor_b32 s64, s64, 0x10000
L_g_dp_106_d:
    s_cmp_lg_u32 s44, 2
    s_cbranch_scc1 L_g_pf_107
    s_cmp_ge_u32 s62, s66
    s_cbranch_scc1 L_g_pf_107
    buffer_load_dword v117, v116, s[12:15], s61 offen sc1
L_g_pf_107:
    s_cmp_le_u32 s66, s60
    s_cbranch_scc1 L_g_ex0_103
    s_cmp_lg_u32 s65, 0
    s_cbranch_scc1 L_g_nw_102
    ds_read_b128 v[32:35], v4 offset:0
    ds_read_b128 v[36:39], v4 offset:1024
    ds_read_b128 v[40:43], v4 offset:2048
    ds_read_b128 v[44:47], v4 offset:3072
    ds_read_b128 v[48:51], v4 offset:4096
    ds_read_b128 v[52:55], v4 offset:5120
    ds_read_b128 v[56:59], v4 offset:6144
    ds_read_b128 v[60:63], v4 offset:7168
    s_cmp_lg_u32 s44, 0
    s_cbranch_scc1 L_g_nl_108
    s_mov_b32 s46, s66
    s_cmp_lg_u32 s81, 0
    s_cbranch_scc1 L_g_nl_108_e
    v_cmp_ge_u32 vcc, v12, v11
    s_nop 0
    s_ff1_i32_b64 s46, vcc
    s_lshr_b32 s46, s46, 4
    s_min_u32 s46, s46, 4
    s_add_u32 s46, s46, s54
    s_min_u32 s46, s46, s75
    v_mov_b32 v118, s46
L_g_nl_108_e:
    s_add_u32 s47, s60, 3
    s_min_u32 s47, s47, s75
    s_cmp_lt_u32 s46, s47
    s_cselect_b32 s81, 1, 0
    s_cbranch_scc1 L_g_nl_108
    s_add_u32 s54, s60, 2
    s_mul_i32 s55, s54, s78
    v_add_u32 v12, s55, v113
    v_mul_u32_u24 v13, 171, v12
    v_lshrrev_b32 v13, 9, v13
    v_mad_i32_i24 v13, v13, -3, v12
    v_lshl_add_u32 v13, v13, 9, v7
    buffer_load_dword v11, v13, s[12:15], 0 offen sc1
L_g_nl_108:
    s_waitcnt lgkmcnt(8)
    s_branch L_g_loop0_92
L_g_ex0_103:
    s_cmp_lg_u32 s44, 0
    s_cbranch_scc1 L_g_ex0_103_n
    ds_write_b32 v15, v118 offset:20
    s_cmp_ge_u32 s60, s75
    s_cbranch_scc1 L_g_ex0_103_n
    s_sleep 6
    s_add_u32 s54, s60, 0
    s_mul_i32 s55, s54, s78
    v_add_u32 v12, s55, v113
    v_mul_u32_u24 v13, 171, v12
    v_lshrrev_b32 v13, 9, v13
    v_mad_i32_i24 v13, v13, -3, v12
    v_lshl_add_u32 v13, v13, 9, v7
    buffer_load_dword v11, v13, s[12:15], 0 offen sc1
    s_waitcnt vmcnt(0)
    v_cmp_ge_u32 vcc, v12, v11
    s_nop 0
    s_ff1_i32_b64 s46, vcc
    s_lshr_b32 s46, s46, 4
    s_min_u32 s46, s46, 4
    s_add_u32 s46, s46, s54
    s_min_u32 s46, s46, s75
    v_mov_b32 v118, s46
    ds_write_b32 v15, v118 offset:20
L_g_ex0_103_n:
    s_waitcnt lgkmcnt(0)
    s_barrier
    ds_read_b32 v14, v15 offset:20
    s_waitcnt lgkmcnt(0)
    v_readfirstlane_b32 s66, v14
    s_barrier
    s_cmp_gt_u32 s66, s60
    s_cbranch_scc1 L_g_restart_89_go
    s_branch L_g_tail_94
L_g_g1r_91:
    s_mov_b32 s65, 1
    s_branch L_g_loop1_93_e
.p2align 6
L_g_loop1_93:
    s_mov_b32 s65, 0
L_g_loop1_93_e:
    s_barrier
    s_bitcmp1_b32 s67, 2
    s_cbranch_scc0 L_g_nfl_109
    s_cmp_lg_u32 s44, 4
    s_cbranch_scc1 L_g_nfl_109_d
    s_mul_i32 s59, s60, s78
    s_add_u32 s59, s59, s87
    v_mov_b32 v10, s59
    buffer_store_dword v10, v115, s[12:15], s52 offen sc1
L_g_nfl_109_d:
    ds_read_b128 v[80:83], v5 offset:0
    ds_read_b128 v[84:87], v5 offset:1024
    ds_read_b128 v[88:91], v5 offset:2048
    ds_read_b128 v[92:95], v5 offset:3072
    s_cmp_le_u32 s62, s60
    s_cbranch_scc1 L_g_dp_114_l
L_g_dp_114_a:
    s_cmp_ge_u32 s62, s66
    s_cbranch_scc1 L_g_dp_114_d
    s_add_u32 s47, s61, 4096
    s_mov_b32 m0, s64
    s_add_u32 s62, s62, 1
    buffer_load_dwordx4 v3, s[12:15], s61 offen offset:0 sc1 lds
    buffer_load_dwordx4 v3, s[12:15], s61 offen offset:1024 sc1 lds
    buffer_load_dwordx4 v3, s[12:15], s61 offen offset:2048 sc1 lds
    buffer_load_dwordx4 v3, s[12:15], s61 offen offset:3072 sc1 lds
    s_add_u32 m0, s64, 4096
    s_add_u32 s61, s61, s85
    buffer_load_dwordx4 v3, s[12:15], s47 offen offset:0 sc1 lds
    buffer_load_dwordx4 v3, s[12:15], s47 offen offset:1024 sc1 lds
    buffer_load_dwordx4 v3, s[12:15], s47 offen offset:2048 sc1 lds
    buffer_load_dwordx4 v3, s[12:15], s47 offen offset:3072 sc1 lds
    s_xor_b32 s64, s64, 0x10000
L_g_dp_114_d:
    s_bitcmp1_b32 s67, 0
    s_cbranch_scc0 L_g_nep_110
    s_waitcnt lgkmcnt(0)
    v_add_f32 v80, v80, v16
    v_add_f32 v81, v81, v17
    v_add_f32 v82, v82, v18
    v_add_f32 v83, v83, v19
    v_add_f32 v84, v84, v20
    v_add_f32 v85, v85, v21
    v_add_f32 v86, v86, v22
    v_add_f32 v87, v87, v23
    v_add_f32 v88, v88, v24
    v_add_f32 v89, v89, v25
    v_add_f32 v90, v90, v26
    v_add_f32 v91, v91, v27
    v_add_f32 v92, v92, v28
    v_add_f32 v93, v93, v29
    v_add_f32 v94, v94, v30
    v_add_f32 v95, v95, v31
L_g_nep_110:
    v_mul_f32 v96, v80, v80
    v_mul_f32 v97, v81, v81
    v_mul_f32 v98, v82, v82
    v_mul_f32 v99, v83, v83
    v_mul_f32 v100, v84, v84
    v_mul_f32 v101, v85, v85
    v_mul_f32 v102, v86, v86
    v_mul_f32 v103, v87, v87
    v_fma_f32 v96, v96, s56, v112
    v_fma_f32 v97, v97, s56, v112
    v_fma_f32 v98, v98, s56, v112
    v_fma_f32 v99, v99, s56, v112
    v_fma_f32 v100, v100, s56, v112
    v_fma_f32 v101, v101, s56, v112
    v_fma_f32 v102, v102, s56, v112
    v_fma_f32 v103, v103, s56, v112
    v_mul_f32 v96, v96, v80
    v_mul_f32 v97, v97, v81
    v_mul_f32 v98, v98, v82
    v_mul_f32 v99, v99, v83
    v_mul_f32 v100, v100, v84
    v_mul_f32 v101, v101, v85
    v_mul_f32 v102, v102, v86
    v_mul_f32 v103, v103, v87
    v_exp_f32 v96, v96
    v_exp_f32 v97, v97
    v_exp_f32 v98, v98
    v_exp_f32 v99, v99
    v_exp_f32 v100, v100
    v_exp_f32 v101, v101
    v_exp_f32 v102, v102
    v_exp_f32 v103, v103
    v_add_f32 v96, 1.0, v96
    v_add_f32 v97, 1.0, v97
    v_add_f32 v98, 1.0, v98
    v_add_f32 v99, 1.0, v99
    v_add_f32 v100, 1.0, v100
    v_add_f32 v101, 1.0, v101
    v_add_f32 v102, 1.0, v102
    v_add_f32 v103, 1.0, v103
    v_rcp_f32 v96, v96
    v_rcp_f32 v97, v97
    v_rcp_f32 v98, v98
    v_rcp_f32 v99, v99
    v_rcp_f32 v100, v100
    v_rcp_f32 v101, v101
    v_rcp_f32 v102, v102
    v_rcp_f32 v103, v103
    v_mul_f32 v80, v80, v96
    v_mul_f32 v81, v81, v97
    s_cmp_lg_u32 s65, 0
    s_cbranch_scc1 L_g_nw1_111
    ds_read_b128 v[32:35], v4 offset:0
    ds_read_b128 v[36:39], v4 offset:1024
    ds_read_b128 v[40:43], v4 offset:2048
    ds_read_b128 v[44:47], v4 offset:3072
    ds_read_b128 v[48:51], v4 offset:4096
    ds_read_b128 v[52:55], v4 offset:5120
    ds_read_b128 v[56:59], v4 offset:6144
    ds_read_b128 v[60:63], v4 offset:7168
    s_barrier
L_g_jn_113:
    s_bitcmp1_b32 s67, 0
    s_cbranch_scc0 L_g_mm2_112
    s_setprio 1
    s_waitcnt lgkmcnt(6)
    v_mfma_f32_32x32x16_bf16 v[16:31], a[0:3], v[32:35], 0
    ds_read_b128 v[32:35], v4 offset:8192
    ds_read_b32 v14, v15
    v_mul_f32 v82, v82, v98
    v_mul_f32 v83, v83, v99
    v_mul_f32 v84, v84, v100
    v_mfma_f32_32x32x16_bf16 v[16:31], a[4:7], v[36:39], v[16:31]
    ds_read_b128 v[36:39], v4 offset:9216
    v_mul_f32 v85, v85, v101
    v_mul_f32 v86, v86, v102
    v_mul_f32 v87, v87, v103
    v_cvt_pk_bf16_f32 v104, v80, v81
    s_waitcnt lgkmcnt(6)
    v_mfma_f32_32x32x16_bf16 v[16:31], a[8:11], v[40:43], v[16:31]
    ds_read_b128 v[40:43], v4 offset:10240
    v_cvt_pk_bf16_f32 v105, v82, v83
    v_cvt_pk_bf16_f32 v106, v84, v85
    v_cvt_pk_bf16_f32 v107, v86, v87
    buffer_store_dwordx4 v[104:107], v8, s[12:15], s63 offen sc1
    v_mfma_f32_32x32x16_bf16 v[16:31], a[12:15], v[44:47], v[16:31]
    ds_read_b128 v[44:47], v4 offset:11264
    v_mul_f32 v96, v88, v88
    v_mul_f32 v97, v89, v89
    v_mul_f32 v98, v90, v90
    v_mul_f32 v99, v91, v91
    s_waitcnt lgkmcnt(6)
    v_mfma_f32_32x32x16_bf16 v[16:31], a[16:19], v[48:51], v[16:31]
    ds_read_b128 v[48:51], v4 offset:12288
    v_mul_f32 v100, v92, v92
    v_mul_f32 v101, v93, v93
    v_mul_f32 v102, v94, v94
    v_mul_f32 v103, v95, v95
    v_mfma_f32_32x32x16_bf16 v[16:31], a[20:23], v[52:55], v[16:31]
    ds_read_b128 v[52:55], v4 offset:13312
    v_fma_f32 v96, v96, s56, v112
    v_fma_f32 v97, v97, s56, v112
    v_fma_f32 v98, v98, s56, v112
    v_fma_f32 v99, v99, s56, v112
    s_waitcnt lgkmcnt(6)
    v_mfma_f32_32x32x16_bf16 v[16:31], a[24:27], v[56:59], v[16:31]
    ds_read_b128 v[56:59], v4 offset:14336
    v_fma_f32 v100, v100, s56, v112
    v_fma_f32 v101, v101, s56, v112
    v_fma_f32 v102, v102, s56, v112
    v_fma_f32 v103, v103, s56, v112
    v_mfma_f32_32x32x16_bf16 v[16:31], a[28:31], v[60:63], v[16:31]
    ds_read_b128 v[60:63], v4 offset:15360
    v_mul_f32 v96, v96, v88
    v_mul_f32 v97, v97, v89
    v_mul_f32 v98, v98, v90
    v_mul_f32 v99, v99, v91
    s_waitcnt lgkmcnt(6)
    v_mfma_f32_32x32x16_bf16 v[16:31], a[32:35], v[32:35], v[16:31]
    ds_read_b128 v[32:35], v4 offset:16384
    v_mul_f32 v100, v100, v92
    v_mul_f32 v101, v101, v93
    v_mul_f32 v102, v102, v94
    v_mul_f32 v103, v103, v95
    v_mfma_f32_32x32x16_bf16 v[16:31], a[36:39], v[36:39], v[16:31]
    ds_read_b128 v[36:39], v4 offset:17408
    v_exp_f32 v96, v96
    v_exp_f32 v97, v97
    s_waitcnt lgkmcnt(6)
    v_mfma_f32_32x32x16_bf16 v[16:31], a[40:43], v[40:43], v[16:31]
    ds_read_b128 v[40:43], v4 offset:18432
    v_exp_f32 v98, v98
    v_exp_f32 v99, v99
    v_mfma_f32_32x32x16_bf16 v[16:31], a[44:47], v[44:47], v[16:31]
    ds_read_b128 v[44:47], v4 offset:19456
    v_exp_f32 v100, v100
    v_exp_f32 v101, v101
    s_waitcnt lgkmcnt(6)
    v_mfma_f32_32x32x16_bf16 v[16:31], a[48:51], v[48:51], v[16:31]
    ds_read_b128 v[48:51], v4 offset:20480
    v_exp_f32 v102, v102
    v_exp_f32 v103, v103
    v_mfma_f32_32x32x16_bf16 v[16:31], a[52:55], v[52:55], v[16:31]
    ds_read_b128 v[52:55], v4 offset:21504
    v_add_f32 v96, 1.0, v96
    v_add_f32 v97, 1.0, v97
    v_add_f32 v98, 1.0, v98
    v_add_f32 v99, 1.0, v99
    s_waitcnt lgkmcnt(6)
    v_mfma_f32_32x32x16_bf16 v[16:31], a[56:59], v[56:59], v[16:31]
    ds_read_b128 v[56:59], v4 offset:22528
    v_add_f32 v100, 1.0, v100
    v_add_f32 v101, 1.0, v101
    v_add_f32 v102, 1.0, v102
    v_add_f32 v103, 1.0, v103
    v_mfma_f32_32x32x16_bf16 v[16:31], a[60:63], v[60:63], v[16:31]
    ds_read_b128 v[60:63], v4 offset:23552
    v_rcp_f32 v96, v96
    v_rcp_f32 v97, v97
    s_waitcnt lgkmcnt(6)
    v_mfma_f32_32x32x16_bf16 v[16:31], a[64:67], v[32:35], v[16:31]
    ds_read_b128 v[32:35], v4 offset:24576
    v_rcp_f32 v98, v98
    v_rcp_f32 v99, v99
    v_mfma_f32_32x32x16_bf16 v[16:31], a[68:71], v[36:39], v[16:31]
    ds_read_b128 v[36:39], v4 offset:25600
    v_rcp_f32 v100, v100
    v_rcp_f32 v101, v101
    s_waitcnt lgkmcnt(6)
    v_mfma_f32_32x32x16_bf16 v[16:31], a[72:75], v[40:43], v[16:31]
    ds_read_b128 v[40:43], v4 offset:26624
    v_rcp_f32 v102, v102
    v_rcp_f32 v103, v103
    v_mfma_f32_32x32x16_bf16 v[16:31], a[76:79], v[44:47], v[16:31]
    ds_read_b128 v[44:47], v4 offset:27648
    v_mul_f32 v88, v88, v96
    v_mul_f32 v89, v89, v97
    v_mul_f32 v90, v90, v98
    v_mul_f32 v91, v91, v99
    s_waitcnt lgkmcnt(6)
    v_mfma_f32_32x32x16_bf16 v[16:31], a[80:83], v[48:51], v[16:31]
    ds_read_b128 v[48:51], v4 offset:28672
    v_mul_f32 v92, v92, v100
    v_mul_f32 v93, v93, v101
    v_mul_f32 v94, v94, v102
    v_mul_f32 v95, v95, v103
    v_mfma_f32_32x32x16_bf16 v[16:31], a[84:87], v[52:55], v[16:31]
    ds_read_b128 v[52:55], v4 offset:29696
    v_cvt_pk_bf16_f32 v108, v88, v89
    v_cvt_pk_bf16_f32 v109, v90, v91
    v_cvt_pk_bf16_f32 v110, v92, v93
    v_cvt_pk_bf16_f32 v111, v94, v95
    s_waitcnt lgkmcnt(6)
    v_mfma_f32_32x32x16_bf16 v[16:31], a[88:91], v[56:59], v[16:31]
    ds_read_b128 v[56:59], v4 offset:30720
    buffer_store_dwordx4 v[108:111], v9, s[12:15], s63 offen sc1
    s_add_u32 s63, s63, s86
    v_mfma_f32_32x32x16_bf16 v[16:31], a[92:95], v[60:63], v[16:31]
    ds_read_b128 v[60:63], v4 offset:31744
    s_waitcnt lgkmcnt(6)
    v_mfma_f32_32x32x16_bf16 v[16:31], a[96:99], v[32:35], v[16:31]
    v_mfma_f32_32x32x16_bf16 v[16:31], a[100:103], v[36:39], v[16:31]
    s_waitcnt lgkmcnt(4)
    v_mfma_f32_32x32x16_bf16 v[16:31], a[104:107], v[40:43], v[16:31]
    v_mfma_f32_32x32x16_bf16 v[16:31], a[108:111], v[44:47], v[16:31]
    s_waitcnt lgkmcnt(2)
    v_mfma_f32_32x32x16_bf16 v[16:31], a[112:115], v[48:51], v[16:31]
    v_mfma_f32_32x32x16_bf16 v[16:31], a[116:119], v[52:55], v[16:31]
    s_waitcnt lgkmcnt(0)
    v_mfma_f32_32x32x16_bf16 v[16:31], a[120:123], v[56:59], v[16:31]
    v_mfma_f32_32x32x16_bf16 v[16:31], a[124:127], v[60:63], v[16:31]
    v_xor_b32 v4, 0x10000, v4
    s_setprio 0
    s_waitcnt vmcnt(2)
L_g_mm2_112_d:
    v_readfirstlane_b32 s66, v14
    s_lshl_b32 s67, s67, 1
    s_or_b32 s67, s67, 1
    s_add_u32 s60, s60, 1
    s_cmp_gt_u32 s66, s60
    s_cbranch_scc1 L_g_loop1_93
    s_barrier
    ds_read_b32 v14, v15 offset:20
    ds_read_b128 v[80:83], v5 offset:0
    ds_read_b128 v[84:87], v5 offset:1024
    ds_read_b128 v[88:91], v5 offset:2048
    ds_read_b128 v[92:95], v5 offset:3072
    s_waitcnt lgkmcnt(4)
    v_readfirstlane_b32 s66, v14
    s_barrier
    s_mov_b32 s69, 0
    s_cmp_gt_u32 s62, s60
    s_cbranch_scc1 L_g_nd_115
    s_cmp_ge_u32 s62, s66
    s_cbranch_scc1 L_g_nd_115
    s_add_u32 s47, s61, 4096
    s_add_u32 m0, s64, 0
    s_nop 0
    buffer_load_dwordx4 v3, s[12:15], s61 offen offset:0 sc1 lds
    buffer_load_dwordx4 v3, s[12:15], s61 offen offset:1024 sc1 lds
    buffer_load_dwordx4 v3, s[12:15], s61 offen offset:2048 sc1 lds
    buffer_load_dwordx4 v3, s[12:15], s61 offen offset:3072 sc1 lds
    s_add_u32 m0, s64, 4096
    s_nop 0
    buffer_load_dwordx4 v3, s[12:15], s47 offen offset:0 sc1 lds
    buffer_load_dwordx4 v3, s[12:15], s47 offen offset:1024 sc1 lds
    buffer_load_dwordx4 v3, s[12:15], s47 offen offset:2048 sc1 lds
    buffer_load_dwordx4 v3, s[12:15], s47 offen offset:3072 sc1 lds
    s_add_u32 s61, s61, s85
    s_add_u32 s62, s62, 1
    s_xor_b32 s64, s64, 0x10000
    s_mov_b32 s69, 1
L_g_nd_115:
    s_waitcnt lgkmcnt(3)
    v_add_f32 v80, v80, v16
    v_add_f32 v81, v81, v17
    v_add_f32 v82, v82, v18
    v_add_f32 v83, v83, v19
    s_waitcnt lgkmcnt(2)
    v_add_f32 v84, v84, v20
    v_add_f32 v85, v85, v21
    v_add_f32 v86, v86, v22
    v_add_f32 v87, v87, v23
    s_waitcnt lgkmcnt(1)
    v_add_f32 v88, v88, v24
    v_add_f32 v89, v89, v25
    v_add_f32 v90, v90, v26
    v_add_f32 v91, v91, v27
    s_waitcnt lgkmcnt(0)
    v_add_f32 v92, v92, v28
    v_add_f32 v93, v93, v29
    v_add_f32 v94, v94, v30
    v_add_f32 v95, v95, v31
    v_mul_f32 v96, v80, v80
    v_mul_f32 v97, v81, v81
    v_mul_f32 v98, v82, v82
    v_mul_f32 v99, v83, v83
    v_mul_f32 v100, v84, v84
    v_mul_f32 v101, v85, v85
    v_mul_f32 v102, v86, v86
    v_mul_f32 v103, v87, v87
    v_fma_f32 v96, v96, s56, v112
    v_fma_f32 v97, v97, s56, v112
    v_fma_f32 v98, v98, s56, v112
    v_fma_f32 v99, v99, s56, v112
    v_fma_f32 v100, v100, s56, v112
    v_fma_f32 v101, v101, s56, v112
    v_fma_f32 v102, v102, s56, v112
    v_fma_f32 v103, v103, s56, v112
    v_mul_f32 v96, v96, v80
    v_mul_f32 v97, v97, v81
    v_mul_f32 v98, v98, v82
    v_mul_f32 v99, v99, v83
    v_mul_f32 v100, v100, v84
    v_mul_f32 v101, v101, v85
    v_mul_f32 v102, v102, v86
    v_mul_f32 v103, v103, v87
    v_exp_f32 v96, v96
    v_exp_f32 v97, v97
    v_exp_f32 v98, v98
    v_exp_f32 v99, v99
    v_exp_f32 v100, v100
    v_exp_f32 v101, v101
    v_exp_f32 v102, v102
    v_exp_f32 v103, v103
    v_add_f32 v96, 1.0, v96
    v_add_f32 v97, 1.0, v97
    v_add_f32 v98, 1.0, v98
    v_add_f32 v99, 1.0, v99
    v_add_f32 v100, 1.0, v100
    v_add_f32 v101, 1.0, v101
    v_add_f32 v102, 1.0, v102
    v_add_f32 v103, 1.0, v103
    v_rcp_f32 v96, v96
    v_rcp_f32 v97, v97
    v_rcp_f32 v98, v98
    v_rcp_f32 v99, v99
    v_rcp_f32 v100, v100
    v_rcp_f32 v101, v101
    v_rcp_f32 v102, v102
    v_rcp_f32 v103, v103
    v_mul_f32 v80, v80, v96
    v_mul_f32 v81, v81, v97
    v_mul_f32 v82, v82, v98
    v_mul_f32 v83, v83, v99
    v_mul_f32 v84, v84, v100
    v_mul_f32 v85, v85, v101
    v_mul_f32 v86, v86, v102
    v_mul_f32 v87, v87, v103
    v_cvt_pk_bf16_f32 v104, v80, v81
    v_cvt_pk_bf16_f32 v105, v82, v83
    v_cvt_pk_bf16_f32 v106, v84, v85
    v_cvt_pk_bf16_f32 v107, v86, v87
    buffer_store_dwordx4 v[104:107], v8, s[12:15], s63 offen sc1
    v_mul_f32 v96, v88, v88
    v_mul_f32 v97, v89, v89
    v_mul_f32 v98, v90, v90
    v_mul_f32 v99, v91, v91
    v_mul_f32 v100, v92, v92
    v_mul_f32 v101, v93, v93
    v_mul_f32 v102, v94, v94
    v_mul_f32 v103, v95, v95
    v_fma_f32 v96, v96, s56, v112
    v_fma_f32 v97, v97, s56, v112
    v_fma_f32 v98, v98, s56, v112
    v_fma_f32 v99, v99, s56, v112
    v_fma_f32 v100, v100, s56, v112
    v_fma_f32 v101, v101, s56, v112
    v_fma_f32 v102, v102, s56, v112
    v_fma_f32 v103, v103, s56, v112
    v_mul_f32 v96, v96, v88
    v_mul_f32 v97, v97, v89
    v_mul_f32 v98, v98, v90
    v_mul_f32 v99, v99, v91
    v_mul_f32 v100, v100, v92
    v_mul_f32 v101, v101, v93
    v_mul_f32 v102, v102, v94
    v_mul_f32 v103, v103, v95
    v_exp_f32 v96, v96
    v_exp_f32 v97, v97
    v_exp_f32 v98, v98
    v_exp_f32 v99, v99
    v_exp_f32 v100, v100
    v_exp_f32 v101, v101
    v_exp_f32 v102, v102
    v_exp_f32 v103, v103
    v_add_f32 v96, 1.0, v96
    v_add_f32 v97, 1.0, v97
    v_add_f32 v98, 1.0, v98
    v_add_f32 v99, 1.0, v99
    v_add_f32 v100, 1.0, v100
    v_add_f32 v101, 1.0, v101
    v_add_f32 v102, 1.0, v102
    v_add_f32 v103, 1.0, v103
    v_rcp_f32 v96, v96
    v_rcp_f32 v97, v97
    v_rcp_f32 v98, v98
    v_rcp_f32 v99, v99
    v_rcp_f32 v100, v100
    v_rcp_f32 v101, v101
    v_rcp_f32 v102, v102
    v_rcp_f32 v103, v103
    v_mul_f32 v88, v88, v96
    v_mul_f32 v89, v89, v97
    v_mul_f32 v90, v90, v98
    v_mul_f32 v91, v91, v99
    v_mul_f32 v92, v92, v100
    v_mul_f32 v93, v93, v101
    v_mul_f32 v94, v94, v102
    v_mul_f32 v95, v95, v103
    v_cvt_pk_bf16_f32 v108, v88, v89
    v_cvt_pk_bf16_f32 v109, v90, v91
    v_cvt_pk_bf16_f32 v110, v92, v93
    v_cvt_pk_bf16_f32 v111, v94, v95
    buffer_store_dwordx4 v[108:111], v9, s[12:15], s63 offen sc1
    s_add_u32 s63, s63, s86
    s_mov_b32 s67, 0
    s_mov_b32 s71, 1
    s_cmp_gt_u32 s66, s60
    s_cbranch_scc1 L_g_g1r_91
    v_mov_b32 v10, 1
    s_mov_b64 exec, 1
    s_waitcnt vmcnt(0)
    ds_add_rtn_u32 v10, v15, v10 offset:4
    s_waitcnt lgkmcnt(0)
    v_readfirstlane_b32 s46, v10
    s_mov_b64 exec, -1
    s_mov_b32 s71, 0
    s_sub_u32 s59, s60, 1
    s_mul_i32 s59, s59, s78
    s_add_u32 s59, s59, s74
    s_cmp_lg_u32 s46, s68
    s_cbranch_scc1 L_g_df_116
    v_mov_b32 v10, s59
    v_add_u32 v10, 1, v10
    v_mov_b32 v11, 0
    s_mov_b64 exec, 1
    buffer_store_dword v10, v11, s[12:15], s52 offen sc1
    s_mov_b64 exec, -1
L_sf_117:
L_g_df_116:
    s_add_u32 s68, s68, 4
    s_cmp_gt_u32 s66, s60
    s_cbranch_scc1 L_g_g1r_91
L_g_tail_94:
    s_cmp_lt_u32 s60, s75
    s_cbranch_scc1 L_g_restart_89
    s_waitcnt vmcnt(0)
    s_barrier
    s_branch L_w_f1_14_d
L_g_h1_104:
    s_add_u32 s54, s60, 1
    s_mul_i32 s55, s54, s78
    v_add_u32 v12, s55, v113
    v_mul_u32_u24 v13, 171, v12
    v_lshrrev_b32 v13, 9, v13
    v_mad_i32_i24 v13, v13, -3, v12
    v_lshl_add_u32 v13, v13, 9, v7
    buffer_load_dword v11, v13, s[12:15], 0 offen sc1
    s_branch L_g_h1_104_b
L_g_h2_105:
    s_waitcnt vmcnt(0)
    v_cmp_ge_u32 vcc, v12, v11
    s_nop 0
    s_ff1_i32_b64 s46, vcc
    s_lshr_b32 s46, s46, 4
    s_min_u32 s46, s46, 4
    s_add_u32 s46, s46, s54
    s_min_u32 s46, s46, s75
    v_mov_b32 v118, s46
    s_branch L_g_h2_105_b
L_g_dp_106_l:
    s_cmp_ge_u32 s62, s66
    s_cbranch_scc1 L_g_dp_106_d
    s_mov_b32 s65, 1
    s_add_u32 s47, s61, 4096
    s_mov_b32 m0, s64
    s_add_u32 s62, s62, 1
    buffer_load_dwordx4 v3, s[12:15], s61 offen offset:0 sc1 lds
    buffer_load_dwordx4 v3, s[12:15], s61 offen offset:1024 sc1 lds
    buffer_load_dwordx4 v3, s[12:15], s61 offen offset:2048 sc1 lds
    buffer_load_dwordx4 v3, s[12:15], s61 offen offset:3072 sc1 lds
    s_add_u32 m0, s64, 4096
    s_add_u32 s61, s61, s85
    buffer_load_dwordx4 v3, s[12:15], s47 offen offset:0 sc1 lds
    buffer_load_dwordx4 v3, s[12:15], s47 offen offset:1024 sc1 lds
    buffer_load_dwordx4 v3, s[12:15], s47 offen offset:2048 sc1 lds
    buffer_load_dwordx4 v3, s[12:15], s47 offen offset:3072 sc1 lds
    s_xor_b32 s64, s64, 0x10000
    s_branch L_g_dp_106_a
L_g_nw_102:
    s_waitcnt vmcnt(0) lgkmcnt(0)
    s_cmp_lg_u32 s44, 0
    s_cbranch_scc1 L_g_nl_118
    s_cmp_lt_u32 s66, s75
    s_cselect_b32 s81, 1, 2
L_g_nl_118:
    s_branch L_g_loop0_92_l
L_g_nfl_109:
    s_cmp_eq_u32 s71, 0
    s_cbranch_scc1 L_g_nfl_109_d
    v_mov_b32 v10, 1
    s_mov_b64 exec, 1
    s_waitcnt vmcnt(0)
    ds_add_rtn_u32 v10, v15, v10 offset:4
    s_waitcnt lgkmcnt(0)
    v_readfirstlane_b32 s46, v10
    s_mov_b64 exec, -1
    s_mov_b32 s71, 0
    s_sub_u32 s59, s60, 1
    s_mul_i32 s59, s59, s78
    s_add_u32 s59, s59, s74
    s_cmp_lg_u32 s46, s68
    s_cbranch_scc1 L_g_df_119
    v_mov_b32 v10, s59
    v_add_u32 v10, 1, v10
    v_mov_b32 v11, 0
    s_mov_b64 exec, 1
    buffer_store_dword v10, v11, s[12:15], s52 offen sc1
    s_mov_b64 exec, -1
L_sf_120:
L_g_df_119:
    s_add_u32 s68, s68, 4
    s_mov_b32 s65, 2
    s_branch L_g_nfl_109_d
L_g_dp_114_l:
    s_cmp_ge_u32 s62, s66
    s_cbranch_scc1 L_g_dp_114_d
    s_or_b32 s65, s65, 1
    s_add_u32 s47, s61, 4096
    s_mov_b32 m0, s64
    s_add_u32 s62, s62, 1
    buffer_load_dwordx4 v3, s[12:15], s61 offen offset:0 sc1 lds
    buffer_load_dwordx4 v3, s[12:15], s61 offen offset:1024 sc1 lds
    buffer_load_dwordx4 v3, s[12:15], s61 offen offset:2048 sc1 lds
    buffer_load_dwordx4 v3, s[12:15], s61 offen offset:3072 sc1 lds
    s_add_u32 m0, s64, 4096
    s_add_u32 s61, s61, s85
    buffer_load_dwordx4 v3, s[12:15], s47 offen offset:0 sc1 lds
    buffer_load_dwordx4 v3, s[12:15], s47 offen offset:1024 sc1 lds
    buffer_load_dwordx4 v3, s[12:15], s47 offen offset:2048 sc1 lds
    buffer_load_dwordx4 v3, s[12:15], s47 offen offset:3072 sc1 lds
    s_xor_b32 s64, s64, 0x10000
    s_branch L_g_dp_114_a
L_g_nw1_111:
    s_cmp_eq_u32 s65, 2
    s_cbranch_scc1 L_g_nw1_111_w
    s_waitcnt vmcnt(0)
L_g_nw1_111_w:
    s_barrier
    ds_read_b128 v[32:35], v4 offset:0
    ds_read_b128 v[36:39], v4 offset:1024
    ds_read_b128 v[40:43], v4 offset:2048
    ds_read_b128 v[44:47], v4 offset:3072
    ds_read_b128 v[48:51], v4 offset:4096
    ds_read_b128 v[52:55], v4 offset:5120
    ds_read_b128 v[56:59], v4 offset:6144
    ds_read_b128 v[60:63], v4 offset:7168
    s_branch L_g_jn_113
L_g_mm2_112:
    s_setprio 1
    s_waitcnt lgkmcnt(6)
    v_mfma_f32_32x32x16_bf16 v[16:31], a[0:3], v[32:35], 0
    ds_read_b128 v[32:35], v4 offset:8192
    ds_read_b32 v14, v15
    v_mfma_f32_32x32x16_bf16 v[16:31], a[4:7], v[36:39], v[16:31]
    ds_read_b128 v[36:39], v4 offset:9216
    s_waitcnt lgkmcnt(6)
    v_mfma_f32_32x32x16_bf16 v[16:31], a[8:11], v[40:43], v[16:31]
    ds_read_b128 v[40:43], v4 offset:10240
    v_mfma_f32_32x32x16_bf16 v[16:31], a[12:15], v[44:47], v[16:31]
    ds_read_b128 v[44:47], v4 offset:11264
    s_waitcnt lgkmcnt(6)
    v_mfma_f32_32x32x16_bf16 v[16:31], a[16:19], v[48:51], v[16:31]
    ds_read_b128 v[48:51], v4 offset:12288
    v_mfma_f32_32x32x16_bf16 v[16:31], a[20:23], v[52:55], v[16:31]
    ds_read_b128 v[52:55], v4 offset:13312
    s_waitcnt lgkmcnt(6)
    v_mfma_f32_32x32x16_bf16 v[16:31], a[24:27], v[56:59], v[16:31]
    ds_read_b128 v[56:59], v4 offset:14336
    v_mfma_f32_32x32x16_bf16 v[16:31], a[28:31], v[60:63], v[16:31]
    ds_read_b128 v[60:63], v4 offset:15360
    s_waitcnt lgkmcnt(6)
    v_mfma_f32_32x32x16_bf16 v[16:31], a[32:35], v[32:35], v[16:31]
    ds_read_b128 v[32:35], v4 offset:16384
    v_mfma_f32_32x32x16_bf16 v[16:31], a[36:39], v[36:39], v[16:31]
    ds_read_b128 v[36:39], v4 offset:17408
    s_waitcnt lgkmcnt(6)
    v_mfma_f32_32x32x16_bf16 v[16:31], a[40:43], v[40:43], v[16:31]
    ds_read_b128 v[40:43], v4 offset:18432
    v_mfma_f32_32x32x16_bf16 v[16:31], a[44:47], v[44:47], v[16:31]
    ds_read_b128 v[44:47], v4 offset:19456
    s_waitcnt lgkmcnt(6)
    v_mfma_f32_32x32x16_bf16 v[16:31], a[48:51], v[48:51], v[16:31]
    ds_read_b128 v[48:51], v4 offset:20480
    v_mfma_f32_32x32x16_bf16 v[16:31], a[52:55], v[52:55], v[16:31]
    ds_read_b128 v[52:55], v4 offset:21504
    s_waitcnt lgkmcnt(6)
    v_mfma_f32_32x32x16_bf16 v[16:31], a[56:59], v[56:59], v[16:31]
    ds_read_b128 v[56:59], v4 offset:22528
    v_mfma_f32_32x32x16_bf16 v[16:31], a[60:63], v[60:63], v[16:31]
    ds_read_b128 v[60:63], v4 offset:23552
    s_waitcnt lgkmcnt(6)
    v_mfma_f32_32x32x16_bf16 v[16:31], a[64:67], v[32:35], v[16:31]
    ds_read_b128 v[32:35], v4 offset:24576
    v_mfma_f32_32x32x16_bf16 v[16:31], a[68:71], v[36:39], v[16:31]
    ds_read_b128 v[36:39], v4 offset:25600
    s_waitcnt lgkmcnt(6)
    v_mfma_f32_32x32x16_bf16 v[16:31], a[72:75], v[40:43], v[16:31]
    ds_read_b128 v[40:43], v4 offset:26624
    v_mfma_f32_32x32x16_bf16 v[16:31], a[76:79], v[44:47], v[16:31]
    ds_read_b128 v[44:47], v4 offset:27648
    s_waitcnt lgkmcnt(6)
    v_mfma_f32_32x32x16_bf16 v[16:31], a[80:83], v[48:51], v[16:31]
    ds_read_b128 v[48:51], v4 offset:28672
    v_mfma_f32_32x32x16_bf16 v[16:31], a[84:87], v[52:55], v[16:31]
    ds_read_b128 v[52:55], v4 offset:29696
    s_waitcnt lgkmcnt(6)
    v_mfma_f32_32x32x16_bf16 v[16:31], a[88:91], v[56:59], v[16:31]
    ds_read_b128 v[56:59], v4 offset:30720
    v_mfma_f32_32x32x16_bf16 v[16:31], a[92:95], v[60:63], v[16:31]
    ds_read_b128 v[60:63], v4 offset:31744
    s_waitcnt lgkmcnt(6)
    v_mfma_f32_32x32x16_bf16 v[16:31], a[96:99], v[32:35], v[16:31]
    v_mfma_f32_32x32x16_bf16 v[16:31], a[100:103], v[36:39], v[16:31]
    s_waitcnt lgkmcnt(4)
    v_mfma_f32_32x32x16_bf16 v[16:31], a[104:107], v[40:43], v[16:31]
    v_mfma_f32_32x32x16_bf16 v[16:31], a[108:111], v[44:47], v[16:31]
    s_waitcnt lgkmcnt(2)
    v_mfma_f32_32x32x16_bf16 v[16:31], a[112:115], v[48:51], v[16:31]
    v_mfma_f32_32x32x16_bf16 v[16:31], a[116:119], v[52:55], v[16:31]
    s_waitcnt lgkmcnt(0)
    v_mfma_f32_32x32x16_bf16 v[16:31], a[120:123], v[56:59], v[16:31]
    v_mfma_f32_32x32x16_bf16 v[16:31], a[124:127], v[60:63], v[16:31]
    v_xor_b32 v4, 0x10000, v4
    s_setprio 0
    s_waitcnt vmcnt(0)
    s_branch L_g_mm2_112_d
L_w_f2_13:
    s_load_dwordx2 s[4:5], s[0:1], 80
    s_load_dwordx2 s[6:7], s[0:1], 72
    s_and_b32 s50, s44, 3
    s_lshr_b32 s51, s44, 2
    s_waitcnt lgkmcnt(0)
    s_mov_b32 s24, s4
    s_and_b32 s25, s5, 0xffff
    s_mov_b32 s26, 0x700000
    s_mov_b32 s27, 0x00020000
    v_lshrrev_b32 v3, 4, v1
    v_and_b32 v4, 15, v1
    v_lshlrev_b32 v5, 2, v3
    v_xor_b32 v4, v4, v5
    v_mul_u32_u24 v3, 2048, v3
    v_lshl_add_u32 v3, v4, 4, v3
    s_mul_i32 s46, s51, 448
    s_mul_i32 s47, s50, 16
    s_add_u32 s46, s46, s47
    s_mul_i32 s47, s42, 896
    s_add_u32 s46, s46, s47
    s_mul_i32 s46, s46, 2048
    s_lshl_b32 s47, s43, 8
    s_add_u32 s46, s46, s47
    s_lshl_b32 s45, s51, 16
    s_mul_i32 s47, s50, 4096
    s_add_u32 s45, s45, s47
    v_bfe_u32 v4, v1, 2, 2
    v_bfe_u32 v5, v1, 4, 1
    v_lshlrev_b32 v5, 1, v5
    v_bfe_u32 v6, v1, 1, 1
    v_add_u32 v5, v5, v6
    s_lshl_b32 s47, s50, 2
    v_add_u32 v5, s47, v5
    v_lshlrev_b32 v6, 2, v4
    v_xor_b32 v5, v5, v6
    v_lshlrev_b32 v5, 4, v5
    v_lshl_add_u32 v5, v4, 8, v5
    v_bfe_u32 v6, v1, 0, 1
    v_lshl_add_u32 v5, v6, 3, v5
    v_lshrrev_b32 v6, 5, v1
    v_mul_u32_u24 v6, 1024, v6
    v_add_u32 v5, v5, v6
    s_lshl_b32 s47, s51, 16
    v_add_u32 v5, s47, v5
    v_bfe_u32 v4, v1, 2, 2
    v_xor_b32 v5, s50, v4
    v_lshlrev_b32 v5, 6, v5
    v_lshl_add_u32 v5, v4, 8, v5
    v_and_b32 v6, 3, v1
    v_lshl_add_u32 v5, v6, 3, v5
    v_lshrrev_b32 v6, 4, v1
    v_lshl_add_u32 v5, v6, 10, v5
    v_lshrrev_b32 v6, 5, v1
    v_lshl_add_u32 v5, v6, 11, v5
    s_lshl_b32 s47, s51, 16
    v_add_u32 v5, s47, v5
    s_add_u32 m0, s45, 0
    s_add_u32 s47, s46, 0x0
    buffer_load_dwordx4 v3, s[24:27], s47 offen nt lds
    s_add_u32 m0, s45, 1024
    s_add_u32 s47, s46, 0x2000
    buffer_load_dwordx4 v3, s[24:27], s47 offen nt lds
    s_add_u32 m0, s45, 2048
    s_add_u32 s47, s46, 0x4000
    buffer_load_dwordx4 v3, s[24:27], s47 offen nt lds
    s_add_u32 m0, s45, 3072
    s_add_u32 s47, s46, 0x6000
    buffer_load_dwordx4 v3, s[24:27], s47 offen nt lds
    s_add_u32 m0, s45, 16384
    s_add_u32 s47, s46, 0x20000
    buffer_load_dwordx4 v3, s[24:27], s47 offen nt lds
    s_add_u32 m0, s45, 17408
    s_add_u32 s47, s46, 0x22000
    buffer_load_dwordx4 v3, s[24:27], s47 offen nt lds
    s_add_u32 m0, s45, 18432
    s_add_u32 s47, s46, 0x24000
    buffer_load_dwordx4 v3, s[24:27], s47 offen nt lds
    s_add_u32 m0, s45, 19456
    s_add_u32 s47, s46, 0x26000
    buffer_load_dwordx4 v3, s[24:27], s47 offen nt lds
    s_add_u32 m0, s45, 32768
    s_add_u32 s47, s46, 0x40000
    buffer_load_dwordx4 v3, s[24:27], s47 offen nt lds
    s_add_u32 m0, s45, 33792
    s_add_u32 s47, s46, 0x42000
    buffer_load_dwordx4 v3, s[24:27], s47 offen nt lds
    s_add_u32 m0, s45, 34816
    s_add_u32 s47, s46, 0x44000
    buffer_load_dwordx4 v3, s[24:27], s47 offen nt lds
    s_add_u32 m0, s45, 35840
    s_add_u32 s47, s46, 0x46000
    buffer_load_dwordx4 v3, s[24:27], s47 offen nt lds
    s_add_u32 m0, s45, 49152
    s_add_u32 s47, s46, 0x60000
    buffer_load_dwordx4 v3, s[24:27], s47 offen nt lds
    s_add_u32 m0, s45, 50176
    s_add_u32 s47, s46, 0x62000
    buffer_load_dwordx4 v3, s[24:27], s47 offen nt lds
    s_add_u32 m0, s45, 51200
    s_add_u32 s47, s46, 0x64000
    buffer_load_dwordx4 v3, s[24:27], s47 offen nt lds
    s_add_u32 m0, s45, 52224
    s_add_u32 s47, s46, 0x66000
    buffer_load_dwordx4 v3, s[24:27], s47 offen nt lds
    s_waitcnt vmcnt(12) lgkmcnt(0)
    s_barrier
    ds_read_b64_tr_b16 a[0:1], v5 offset:0
    ds_read_b64_tr_b16 a[2:3], v5 offset:2048
    ds_read_b64_tr_b16 a[4:5], v5 offset:32
    ds_read_b64_tr_b16 a[6:7], v5 offset:2080
    ds_read_b64_tr_b16 a[8:9], v5 offset:8192
    ds_read_b64_tr_b16 a[10:11], v5 offset:10240
    ds_read_b64_tr_b16 a[12:13], v5 offset:8224
    ds_read_b64_tr_b16 a[14:15], v5 offset:10272
    s_waitcnt vmcnt(8) lgkmcnt(0)
    s_barrier
    s_add_u32 m0, s45, 0
    s_add_u32 s47, s46, 0x80000
    buffer_load_dwordx4 v3, s[24:27], s47 offen nt lds
    s_add_u32 m0, s45, 1024
    s_add_u32 s47, s46, 0x82000
    buffer_load_dwordx4 v3, s[24:27], s47 offen nt lds
    s_add_u32 m0, s45, 2048
    s_add_u32 s47, s46, 0x84000
    buffer_load_dwordx4 v3, s[24:27], s47 offen nt lds
    s_add_u32 m0, s45, 3072
    s_add_u32 s47, s46, 0x86000
    buffer_load_dwordx4 v3, s[24:27], s47 offen nt lds
    ds_read_b64_tr_b16 a[16:17], v5 offset:16384
    ds_read_b64_tr_b16 a[18:19], v5 offset:18432
    ds_read_b64_tr_b16 a[20:21], v5 offset:16416
    ds_read_b64_tr_b16 a[22:23], v5 offset:18464
    ds_read_b64_tr_b16 a[24:25], v5 offset:24576
    ds_read_b64_tr_b16 a[26:27], v5 offset:26624
    ds_read_b64_tr_b16 a[28:29], v5 offset:24608
    ds_read_b64_tr_b16 a[30:31], v5 offset:26656
    s_waitcnt vmcnt(8) lgkmcnt(0)
    s_barrier
    s_add_u32 m0, s45, 16384
    s_add_u32 s47, s46, 0xa0000
    buffer_load_dwordx4 v3, s[24:27], s47 offen nt lds
    s_add_u32 m0, s45, 17408
    s_add_u32 s47, s46, 0xa2000
    buffer_load_dwordx4 v3, s[24:27], s47 offen nt lds
    s_add_u32 m0, s45, 18432
    s_add_u32 s47, s46, 0xa4000
    buffer_load_dwordx4 v3, s[24:27], s47 offen nt lds
    s_add_u32 m0, s45, 19456
    s_add_u32 s47, s46, 0xa6000
    buffer_load_dwordx4 v3, s[24:27], s47 offen nt lds
    ds_read_b64_tr_b16 a[32:33], v5 offset:32768
    ds_read_b64_tr_b16 a[34:35], v5 offset:34816
    ds_read_b64_tr_b16 a[36:37], v5 offset:32800
    ds_read_b64_tr_b16 a[38:39], v5 offset:34848
    ds_read_b64_tr_b16 a[40:41], v5 offset:40960
    ds_read_b64_tr_b16 a[42:43], v5 offset:43008
    ds_read_b64_tr_b16 a[44:45], v5 offset:40992
    ds_read_b64_tr_b16 a[46:47], v5 offset:43040
    s_waitcnt vmcnt(8) lgkmcnt(0)
    s_barrier
    s_add_u32 m0, s45, 32768
    s_add_u32 s47, s46, 0xc0000
    buffer_load_dwordx4 v3, s[24:27], s47 offen nt lds
    s_add_u32 m0, s45, 33792
    s_add_u32 s47, s46, 0xc2000
    buffer_load_dwordx4 v3, s[24:27], s47 offen nt lds
    s_add_u32 m0, s45, 34816
    s_add_u32 s47, s46, 0xc4000
    buffer_load_dwordx4 v3, s[24:27], s47 offen nt lds
    s_add_u32 m0, s45, 35840
    s_add_u32 s47, s46, 0xc6000
    buffer_load_dwordx4 v3, s[24:27], s47 offen nt lds
    ds_read_b64_tr_b16 a[48:49], v5 offset:49152
    ds_read_b64_tr_b16 a[50:51], v5 offset:51200
    ds_read_b64_tr_b16 a[52:53], v5 offset:49184
    ds_read_b64_tr_b16 a[54:55], v5 offset:51232
    ds_read_b64_tr_b16 a[56:57], v5 offset:57344
    ds_read_b64_tr_b16 a[58:59], v5 offset:59392
    ds_read_b64_tr_b16 a[60:61], v5 offset:57376
    ds_read_b64_tr_b16 a[62:63], v5 offset:59424
    s_waitcnt vmcnt(8) lgkmcnt(0)
    s_barrier
    ds_read_b64_tr_b16 a[64:65], v5 offset:0
    ds_read_b64_tr_b16 a[66:67], v5 offset:2048
    ds_read_b64_tr_b16 a[68:69], v5 offset:32
    ds_read_b64_tr_b16 a[70:71], v5 offset:2080
    ds_read_b64_tr_b16 a[72:73], v5 offset:8192
    ds_read_b64_tr_b16 a[74:75], v5 offset:10240
    ds_read_b64_tr_b16 a[76:77], v5 offset:8224
    ds_read_b64_tr_b16 a[78:79], v5 offset:10272
    s_waitcnt vmcnt(4) lgkmcnt(0)
    s_barrier
    ds_read_b64_tr_b16 a[80:81], v5 offset:16384
    ds_read_b64_tr_b16 a[82:83], v5 offset:18432
    ds_read_b64_tr_b16 a[84:85], v5 offset:16416
    ds_read_b64_tr_b16 a[86:87], v5 offset:18464
    ds_read_b64_tr_b16 a[88:89], v5 offset:24576
    ds_read_b64_tr_b16 a[90:91], v5 offset:26624
    ds_read_b64_tr_b16 a[92:93], v5 offset:24608
    ds_read_b64_tr_b16 a[94:95], v5 offset:26656
    s_waitcnt vmcnt(0) lgkmcnt(0)
    s_barrier
    ds_read_b64_tr_b16 a[96:97], v5 offset:32768
    ds_read_b64_tr_b16 a[98:99], v5 offset:34816
    ds_read_b64_tr_b16 a[100:101], v5 offset:32800
    ds_read_b64_tr_b16 a[102:103], v5 offset:34848
    ds_read_b64_tr_b16 a[104:105], v5 offset:40960
    ds_read_b64_tr_b16 a[106:107], v5 offset:43008
    ds_read_b64_tr_b16 a[108:109], v5 offset:40992
    ds_read_b64_tr_b16 a[110:111], v5 offset:43040
    s_waitcnt lgkmcnt(0)
    s_barrier
    v_lshlrev_b32 v2, 4, v1
    s_mul_i32 s64, s44, 7168
    s_add_u32 s46, s64, 0x6000000
    s_mul_i32 s47, s42, 57344
    s_add_u32 s46, s46, s47
    v_add_u32 v3, s46, v2
    s_mul_i32 s46, s51, 28672
    v_add_u32 v4, s46, v2
    v_and_b32 v6, 15, v1
    v_lshlrev_b32 v6, 4, v6
    v_lshrrev_b32 v7, 4, v1
    v_lshl_add_u32 v6, v7, 9, v6
    v_add_u32 v4, s46, v6
    s_lshl_b32 s46, s50, 12
    s_add_u32 s46, s46, 131072
    v_add_u32 v5, s46, v2
    v_and_b32 v7, 15, v1
    v_min_u32 v7, 6, v7
    v_lshlrev_b32 v7, 7, v7
    s_mul_i32 s46, s42, 896
    s_add_u32 s46, s46, 0x106400
    v_add_u32 v7, s46, v7
    s_lshl_b32 s46, s42, 16
    s_lshl_b32 s47, s43, 11
    s_add_u32 s46, s46, s47
    s_lshl_b32 s47, s50, 9
    s_add_u32 s46, s46, s47
    s_add_u32 s46, s46, 0xb000000
    v_and_b32 v8, 31, v1
    v_lshlrev_b32 v8, 4, v8
    v_lshrrev_b32 v9, 5, v1
    v_lshl_add_u32 v8, v9, 14, v8
    v_add_u32 v8, s46, v8
    v_add_u32 v9, 0x8000, v8
    s_lshl_b32 s52, s43, 9
    s_lshl_b32 s47, s42, 7
    s_add_u32 s52, s52, s47
    s_add_u32 s52, s52, 0x108400
    s_add_u32 s52, s52, s76
    s_mul_i32 s46, s43, 7168
    s_add_u32 s46, s46, 0x6000000
    s_mul_i32 s47, s42, 57344
    s_add_u32 s46, s46, s47
    v_min_u32 v116, 55, v1
    v_lshlrev_b32 v116, 7, v116
    v_add_u32 v116, s46, v116
    s_mov_b32 s60, 0
    s_mul_i32 s61, s74, 229376
    s_mov_b32 s62, 0
    s_mul_i32 s63, s74, 262144
    s_mul_i32 s85, s78, 229376
    s_mul_i32 s86, s78, 262144
    s_sub_u32 s46, s78, 1
    s_sub_u32 s75, s75, s74
    s_add_u32 s75, s75, s46
    s_lshr_b32 s75, s75, s46
    s_mov_b32 s67, 0
    s_mov_b32 s68, 3
    s_mov_b32 s71, 0
    v_mov_b32 v15, 147456
    v_mov_b32 v14, 0
    ds_write_b32 v15, v14 offset:4
    ds_write_b32 v15, v14 offset:12
    ds_write_b32 v15, v14 offset:16
    v_mov_b32 v114, 1
    v_mov_b32 v115, 0
    s_mov_b32 s81, 0
    s_mul_i32 s87, s78, 2
    s_sub_u32 s87, s74, s87
    s_add_u32 s87, s87, 1
    s_lshl_b32 s46, s44, 5
    v_add_u32 v119, s46, v15
    v_lshrrev_b32 v113, 4, v1
    v_mul_u32_u24 v113, s78, v113
    v_add_u32 v113, s74, v113
    s_mov_b32 s72, 0
L_g_restart_121:
    s_cmp_lg_u32 s44, 0
    s_cbranch_scc1 L_g_nsp_122
    s_mov_b32 s70, 0
L_g_sp_128:
    s_add_u32 s54, s60, 0
    s_mul_i32 s55, s54, s78
    v_add_u32 v12, s55, v113
    v_subrev_u32 v13, 58, v12
    v_ashrrev_i32 v11, 31, v13
    v_and_b32 v13, 1, v13
    v_add_u32 v13, 1, v13
    v_bfi_b32 v13, v11, 0, v13
    v_lshl_add_u32 v13, v13, 16, v7
    buffer_load_dword v11, v13, s[12:15], 0 offen sc1
    s_waitcnt vmcnt(0)
    v_cmp_ge_u32 vcc, v12, v11
    s_add_u32 s70, s70, 1
    s_and_b32 s46, vcc_lo, 0xffff
    s_cbranch_scc0 L_g_sp_128_ok
    s_sleep 3
    s_cmp_lt_u32 s70, 524288
    s_cbranch_scc1 L_g_sp_128
    s_branch L_c_done_1
L_g_sp_128_ok:
    v_cmp_ge_u32 vcc, v12, v11
    s_nop 0
    s_ff1_i32_b64 s46, vcc
    s_lshr_b32 s46, s46, 4
    s_min_u32 s46, s46, 4
    s_add_u32 s46, s46, s54
    s_min_u32 s46, s46, s75
    v_mov_b32 v118, s46
    ds_write_b32 v15, v118 offset:20
L_g_nsp_122:
    s_waitcnt lgkmcnt(0)
    s_barrier
    ds_read_b32 v14, v15 offset:20
    s_waitcnt lgkmcnt(0)
    v_readfirstlane_b32 s66, v14
    s_nop 3
L_g_restart_121_go:
    s_mov_b32 s69, 0
    s_cmp_gt_u32 s62, s60
    s_cbranch_scc1 L_g_nd_129
    s_cmp_ge_u32 s62, s66
    s_cbranch_scc1 L_g_nd_129
    s_add_u32 s47, s61, 4096
    s_add_u32 m0, s64, 0
    s_nop 0
    buffer_load_dwordx4 v3, s[12:15], s61 offen offset:0 sc1 lds
    buffer_load_dwordx4 v3, s[12:15], s61 offen offset:1024 sc1 lds
    buffer_load_dwordx4 v3, s[12:15], s61 offen offset:2048 sc1 lds
    buffer_load_dwordx4 v3, s[12:15], s61 offen offset:3072 sc1 lds
    s_add_u32 m0, s64, 4096
    s_nop 0
    buffer_load_dwordx4 v3, s[12:15], s47 offen offset:0 sc1 lds
    buffer_load_dwordx4 v3, s[12:15], s47 offen offset:1024 sc1 lds
    buffer_load_dwordx4 v3, s[12:15], s47 offen offset:2048 sc1 lds
    s_add_u32 s61, s61, s85
    s_add_u32 s62, s62, 1
    s_xor_b32 s64, s64, 0x10000
    s_mov_b32 s69, 1
L_g_nd_129:
    s_cmp_eq_u32 s51, 1
    s_cbranch_scc1 L_g_g1r_123
    s_add_u32 s59, s60, 1
    s_mov_b32 s69, 0
    s_cmp_gt_u32 s62, s59
    s_cbranch_scc1 L_g_nd_130
    s_cmp_ge_u32 s62, s66
    s_cbranch_scc1 L_g_nd_130
    s_add_u32 s47, s61, 4096
    s_add_u32 m0, s64, 0
    s_nop 0
    buffer_load_dwordx4 v3, s[12:15], s61 offen offset:0 sc1 lds
    buffer_load_dwordx4 v3, s[12:15], s61 offen offset:1024 sc1 lds
    buffer_load_dwordx4 v3, s[12:15], s61 offen offset:2048 sc1 lds
    buffer_load_dwordx4 v3, s[12:15], s61 offen offset:3072 sc1 lds
    s_add_u32 m0, s64, 4096
    s_nop 0
    buffer_load_dwordx4 v3, s[12:15], s47 offen offset:0 sc1 lds
    buffer_load_dwordx4 v3, s[12:15], s47 offen offset:1024 sc1 lds
    buffer_load_dwordx4 v3, s[12:15], s47 offen offset:2048 sc1 lds
    s_add_u32 s61, s61, s85
    s_add_u32 s62, s62, 1
    s_xor_b32 s64, s64, 0x10000
    s_mov_b32 s69, 1
L_g_nd_130:
    s_cmp_eq_u32 s69, 1
    s_cbranch_scc1 L_g_w0_131
    s_waitcnt vmcnt(0)
L_g_w0_131:
    s_waitcnt vmcnt(7)
    s_cmp_lg_u32 s44, 0
    s_cbranch_scc1 L_g_nl_132
    s_cmp_lt_u32 s66, s75
    s_cselect_b32 s81, 1, 2
L_g_nl_132:
L_g_loop0_124_l:
    s_barrier
    ds_read_b128 v[32:35], v4 offset:0
    ds_read_b128 v[36:39], v4 offset:256
    ds_read_b128 v[40:43], v4 offset:2048
    ds_read_b128 v[44:47], v4 offset:2304
    ds_read_b128 v[48:51], v4 offset:4096
    ds_read_b128 v[52:55], v4 offset:4352
    ds_read_b128 v[56:59], v4 offset:6144
    ds_read_b128 v[60:63], v4 offset:6400
    s_branch L_g_loop0_124_m
.p2align 6
L_g_loop0_124:
    s_barrier
L_g_loop0_124_m:
    s_setprio 2
    s_waitcnt lgkmcnt(6)
    v_mfma_f32_16x16x32_bf16 v[16:19], v[32:35], a[0:3], 0
    v_mfma_f32_16x16x32_bf16 v[20:23], v[32:35], a[4:7], 0
    ds_read_b128 v[32:35], v4 offset:8192
    v_mfma_f32_16x16x32_bf16 v[28:31], v[36:39], a[4:7], 0
    v_mfma_f32_16x16x32_bf16 v[24:27], v[36:39], a[0:3], 0
    ds_read_b128 v[36:39], v4 offset:8448
    s_cmp_eq_u32 s81, 1
    s_cbranch_scc1 L_g_h1_136
L_g_h1_136_b:
    s_waitcnt lgkmcnt(6)
    v_mfma_f32_16x16x32_bf16 v[16:19], v[40:43], a[8:11], v[16:19]
    v_mfma_f32_16x16x32_bf16 v[20:23], v[40:43], a[12:15], v[20:23]
    ds_read_b128 v[40:43], v4 offset:10240
    v_mfma_f32_16x16x32_bf16 v[28:31], v[44:47], a[12:15], v[28:31]
    v_mfma_f32_16x16x32_bf16 v[24:27], v[44:47], a[8:11], v[24:27]
    ds_read_b128 v[44:47], v4 offset:10496
    s_waitcnt lgkmcnt(6)
    v_mfma_f32_16x16x32_bf16 v[16:19], v[48:51], a[16:19], v[16:19]
    v_mfma_f32_16x16x32_bf16 v[20:23], v[48:51], a[20:23], v[20:23]
    ds_read_b128 v[48:51], v4 offset:12288
    v_mfma_f32_16x16x32_bf16 v[28:31], v[52:55], a[20:23], v[28:31]
    v_mfma_f32_16x16x32_bf16 v[24:27], v[52:55], a[16:19], v[24:27]
    ds_read_b128 v[52:55], v4 offset:12544
    s_waitcnt lgkmcnt(6)
    v_mfma_f32_16x16x32_bf16 v[16:19], v[56:59], a[24:27], v[16:19]
    v_mfma_f32_16x16x32_bf16 v[20:23], v[56:59], a[28:31], v[20:23]
    ds_read_b128 v[56:59], v4 offset:14336
    v_mfma_f32_16x16x32_bf16 v[28:31], v[60:63], a[28:31], v[28:31]
    v_mfma_f32_16x16x32_bf16 v[24:27], v[60:63], a[24:27], v[24:27]
    ds_read_b128 v[60:63], v4 offset:14592
    s_waitcnt lgkmcnt(6)
    v_mfma_f32_16x16x32_bf16 v[16:19], v[32:35], a[32:35], v[16:19]
    v_mfma_f32_16x16x32_bf16 v[20:23], v[32:35], a[36:39], v[20:23]
    ds_read_b128 v[32:35], v4 offset:16384
    v_mfma_f32_16x16x32_bf16 v[28:31], v[36:39], a[36:39], v[28:31]
    v_mfma_f32_16x16x32_bf16 v[24:27], v[36:39], a[32:35], v[24:27]
    ds_read_b128 v[36:39], v4 offset:16640
    s_waitcnt lgkmcnt(6)
    v_mfma_f32_16x16x32_bf16 v[16:19], v[40:43], a[40:43], v[16:19]
    v_mfma_f32_16x16x32_bf16 v[20:23], v[40:43], a[44:47], v[20:23]
    ds_read_b128 v[40:43], v4 offset:18432
    v_mfma_f32_16x16x32_bf16 v[28:31], v[44:47], a[44:47], v[28:31]
    v_mfma_f32_16x16x32_bf16 v[24:27], v[44:47], a[40:43], v[24:27]
    ds_read_b128 v[44:47], v4 offset:18688
    s_waitcnt lgkmcnt(6)
    v_mfma_f32_16x16x32_bf16 v[16:19], v[48:51], a[48:51], v[16:19]
    v_mfma_f32_16x16x32_bf16 v[20:23], v[48:51], a[52:55], v[20:23]
    ds_read_b128 v[48:51], v4 offset:20480
    v_mfma_f32_16x16x32_bf16 v[28:31], v[52:55], a[52:55], v[28:31]
    v_mfma_f32_16x16x32_bf16 v[24:27], v[52:55], a[48:51], v[24:27]
    ds_read_b128 v[52:55], v4 offset:20736
    s_waitcnt lgkmcnt(6)
    v_mfma_f32_16x16x32_bf16 v[16:19], v[56:59], a[56:59], v[16:19]
    v_mfma_f32_16x16x32_bf16 v[20:23], v[56:59], a[60:63], v[20:23]
    ds_read_b128 v[56:59], v4 offset:22528
    v_mfma_f32_16x16x32_bf16 v[28:31], v[60:63], a[60:63], v[28:31]
    v_mfma_f32_16x16x32_bf16 v[24:27], v[60:63], a[56:59], v[24:27]
    ds_read_b128 v[60:63], v4 offset:22784
    s_waitcnt lgkmcnt(6)
    v_mfma_f32_16x16x32_bf16 v[16:19], v[32:35], a[64:67], v[16:19]
    v_mfma_f32_16x16x32_bf16 v[20:23], v[32:35], a[68:71], v[20:23]
    ds_read_b128 v[32:35], v4 offset:24576
    v_mfma_f32_16x16x32_bf16 v[28:31], v[36:39], a[68:71], v[28:31]
    v_mfma_f32_16x16x32_bf16 v[24:27], v[36:39], a[64:67], v[24:27]
    ds_read_b128 v[36:39], v4 offset:24832
    s_waitcnt lgkmcnt(6)
    v_mfma_f32_16x16x32_bf16 v[16:19], v[40:43], a[72:75], v[16:19]
    v_mfma_f32_16x16x32_bf16 v[20:23], v[40:43], a[76:79], v[20:23]
    ds_read_b128 v[40:43], v4 offset:26624
    v_mfma_f32_16x16x32_bf16 v[28:31], v[44:47], a[76:79], v[28:31]
    v_mfma_f32_16x16x32_bf16 v[24:27], v[44:47], a[72:75], v[24:27]
    ds_read_b128 v[44:47], v4 offset:26880
    s_waitcnt lgkmcnt(6)
    v_mfma_f32_16x16x32_bf16 v[16:19], v[48:51], a[80:83], v[16:19]
    v_mfma_f32_16x16x32_bf16 v[20:23], v[48:51], a[84:87], v[20:23]
    v_mfma_f32_16x16x32_bf16 v[28:31], v[52:55], a[84:87], v[28:31]
    v_mfma_f32_16x16x32_bf16 v[24:27], v[52:55], a[80:83], v[24:27]
    s_waitcnt lgkmcnt(4)
    v_mfma_f32_16x16x32_bf16 v[16:19], v[56:59], a[88:91], v[16:19]
    v_mfma_f32_16x16x32_bf16 v[20:23], v[56:59], a[92:95], v[20:23]
    v_mfma_f32_16x16x32_bf16 v[28:31], v[60:63], a[92:95], v[28:31]
    v_mfma_f32_16x16x32_bf16 v[24:27], v[60:63], a[88:91], v[24:27]
    s_waitcnt lgkmcnt(2)
    v_mfma_f32_16x16x32_bf16 v[16:19], v[32:35], a[96:99], v[16:19]
    v_mfma_f32_16x16x32_bf16 v[20:23], v[32:35], a[100:103], v[20:23]
    s_cmp_eq_u32 s81, 1
    s_cbranch_scc1 L_g_h2_137
L_g_h2_137_b:
    ds_write_b32 v119, v118
    v_mfma_f32_16x16x32_bf16 v[28:31], v[36:39], a[100:103], v[28:31]
    v_mfma_f32_16x16x32_bf16 v[24:27], v[36:39], a[96:99], v[24:27]
    s_waitcnt lgkmcnt(0)
    v_mfma_f32_16x16x32_bf16 v[16:19], v[40:43], a[104:107], v[16:19]
    v_mfma_f32_16x16x32_bf16 v[20:23], v[40:43], a[108:111], v[20:23]
    v_mfma_f32_16x16x32_bf16 v[28:31], v[44:47], a[108:111], v[28:31]
    v_mfma_f32_16x16x32_bf16 v[24:27], v[44:47], a[104:107], v[24:27]
    v_xor_b32 v4, 0x10000, v4
    s_setprio 0
    s_waitcnt vmcnt(0)
    s_waitcnt lgkmcnt(0)
    s_barrier
    ds_read_b32 v14, v15
    s_nop 6
    ds_write_b128 v5, v[16:19] offset:0
    ds_write_b128 v5, v[20:23] offset:1024
    ds_write_b128 v5, v[24:27] offset:2048
    ds_write_b128 v5, v[28:31] offset:3072
    s_waitcnt lgkmcnt(4)
    v_readfirstlane_b32 s66, v14
    s_add_u32 s60, s60, 1
    s_mov_b32 s65, 0
    s_cmp_le_u32 s62, s60
    s_cbranch_scc1 L_g_dp_138_l
L_g_dp_138_a:
    s_cmp_ge_u32 s62, s66
    s_cbranch_scc1 L_g_dp_138_d
    s_add_u32 s47, s61, 4096
    s_mov_b32 m0, s64
    s_add_u32 s62, s62, 1
    buffer_load_dwordx4 v3, s[12:15], s61 offen offset:0 sc1 lds
    buffer_load_dwordx4 v3, s[12:15], s61 offen offset:1024 sc1 lds
    buffer_load_dwordx4 v3, s[12:15], s61 offen offset:2048 sc1 lds
    buffer_load_dwordx4 v3, s[12:15], s61 offen offset:3072 sc1 lds
    s_add_u32 m0, s64, 4096
    s_add_u32 s61, s61, s85
    buffer_load_dwordx4 v3, s[12:15], s47 offen offset:0 sc1 lds
    buffer_load_dwordx4 v3, s[12:15], s47 offen offset:1024 sc1 lds
    buffer_load_dwordx4 v3, s[12:15], s47 offen offset:2048 sc1 lds
    s_xor_b32 s64, s64, 0x10000
L_g_dp_138_d:
    s_cmp_lg_u32 s44, 2
    s_cbranch_scc1 L_g_pf_139
    s_cmp_ge_u32 s62, s66
    s_cbranch_scc1 L_g_pf_139
    buffer_load_dword v117, v116, s[12:15], s61 offen sc1
L_g_pf_139:
    s_cmp_le_u32 s66, s60
    s_cbranch_scc1 L_g_ex0_135
    s_cmp_lg_u32 s65, 0
    s_cbranch_scc1 L_g_nw_134
    ds_read_b128 v[32:35], v4 offset:0
    ds_read_b128 v[36:39], v4 offset:256
    ds_read_b128 v[40:43], v4 offset:2048
    ds_read_b128 v[44:47], v4 offset:2304
    ds_read_b128 v[48:51], v4 offset:4096
    ds_read_b128 v[52:55], v4 offset:4352
    ds_read_b128 v[56:59], v4 offset:6144
    ds_read_b128 v[60:63], v4 offset:6400
    s_cmp_lg_u32 s44, 0
    s_cbranch_scc1 L_g_nl_140
    s_mov_b32 s46, s66
    s_cmp_lg_u32 s81, 0
    s_cbranch_scc1 L_g_nl_140_e
    v_cmp_ge_u32 vcc, v12, v11
    s_nop 0
    s_ff1_i32_b64 s46, vcc
    s_lshr_b32 s46, s46, 4
    s_min_u32 s46, s46, 4
    s_add_u32 s46, s46, s54
    s_min_u32 s46, s46, s75
    v_mov_b32 v118, s46
L_g_nl_140_e:
    s_add_u32 s47, s60, 3
    s_min_u32 s47, s47, s75
    s_cmp_lt_u32 s46, s47
    s_cselect_b32 s81, 1, 0
    s_cbranch_scc1 L_g_nl_140
    s_add_u32 s54, s60, 2
    s_mul_i32 s55, s54, s78
    v_add_u32 v12, s55, v113
    v_subrev_u32 v13, 58, v12
    v_ashrrev_i32 v11, 31, v13
    v_and_b32 v13, 1, v13
    v_add_u32 v13, 1, v13
    v_bfi_b32 v13, v11, 0, v13
    v_lshl_add_u32 v13, v13, 16, v7
    buffer_load_dword v11, v13, s[12:15], 0 offen sc1
L_g_nl_140:
    s_waitcnt lgkmcnt(8)
    s_branch L_g_loop0_124
L_g_ex0_135:
    s_cmp_lg_u32 s44, 0
    s_cbranch_scc1 L_g_ex0_135_n
    ds_write_b32 v15, v118 offset:20
    s_cmp_ge_u32 s60, s75
    s_cbranch_scc1 L_g_ex0_135_n
    s_sleep 6
    s_add_u32 s54, s60, 0
    s_mul_i32 s55, s54, s78
    v_add_u32 v12, s55, v113
    v_subrev_u32 v13, 58, v12
    v_ashrrev_i32 v11, 31, v13
    v_and_b32 v13, 1, v13
    v_add_u32 v13, 1, v13
    v_bfi_b32 v13, v11, 0, v13
    v_lshl_add_u32 v13, v13, 16, v7
    buffer_load_dword v11, v13, s[12:15], 0 offen sc1
    s_waitcnt vmcnt(0)
    v_cmp_ge_u32 vcc, v12, v11
    s_nop 0
    s_ff1_i32_b64 s46, vcc
    s_lshr_b32 s46, s46, 4
    s_min_u32 s46, s46, 4
    s_add_u32 s46, s46, s54
    s_min_u32 s46, s46, s75
    v_mov_b32 v118, s46
    ds_write_b32 v15, v118 offset:20
L_g_ex0_135_n:
    s_waitcnt lgkmcnt(0)
    s_barrier
    ds_read_b32 v14, v15 offset:20
    s_waitcnt lgkmcnt(0)
    v_readfirstlane_b32 s66, v14
    s_barrier
    s_cmp_gt_u32 s66, s60
    s_cbranch_scc1 L_g_restart_121_go
    s_branch L_g_tail_126
L_g_g1r_123:
    s_mov_b32 s65, 1
    s_branch L_g_loop1_125_e
.p2align 6
L_g_loop1_125:
    s_mov_b32 s65, 0
L_g_loop1_125_e:
    s_barrier
    s_bitcmp1_b32 s67, 1
    s_cbranch_scc0 L_g_nfl_141
    s_cmp_lg_u32 s44, 4
    s_cbranch_scc1 L_g_nfl_141_d
    s_mul_i32 s59, s60, s78
    s_add_u32 s59, s59, s87
    v_mov_b32 v10, s59
    buffer_store_dword v10, v115, s[12:15], s52 offen sc1
L_g_nfl_141_d:
    ds_read_b128 v[80:83], v5 offset:0
    ds_read_b128 v[84:87], v5 offset:1024
    ds_read_b128 v[88:91], v5 offset:2048
    ds_read_b128 v[92:95], v5 offset:3072
    s_cmp_le_u32 s62, s60
    s_cbranch_scc1 L_g_dp_146_l
L_g_dp_146_a:
    s_cmp_ge_u32 s62, s66
    s_cbranch_scc1 L_g_dp_146_d
    s_add_u32 s47, s61, 4096
    s_mov_b32 m0, s64
    s_add_u32 s62, s62, 1
    buffer_load_dwordx4 v3, s[12:15], s61 offen offset:0 sc1 lds
    buffer_load_dwordx4 v3, s[12:15], s61 offen offset:1024 sc1 lds
    buffer_load_dwordx4 v3, s[12:15], s61 offen offset:2048 sc1 lds
    buffer_load_dwordx4 v3, s[12:15], s61 offen offset:3072 sc1 lds
    s_add_u32 m0, s64, 4096
    s_add_u32 s61, s61, s85
    buffer_load_dwordx4 v3, s[12:15], s47 offen offset:0 sc1 lds
    buffer_load_dwordx4 v3, s[12:15], s47 offen offset:1024 sc1 lds
    buffer_load_dwordx4 v3, s[12:15], s47 offen offset:2048 sc1 lds
    s_xor_b32 s64, s64, 0x10000
L_g_dp_146_d:
    s_bitcmp1_b32 s67, 0
    s_cbranch_scc0 L_g_nep_142
    s_waitcnt lgkmcnt(0)
    v_add_f32 v80, v80, v16
    v_add_f32 v81, v81, v17
    v_add_f32 v82, v82, v18
    v_add_f32 v83, v83, v19
    v_add_f32 v84, v84, v20
    v_add_f32 v85, v85, v21
    v_add_f32 v86, v86, v22
    v_add_f32 v87, v87, v23
    v_add_f32 v88, v88, v24
    v_add_f32 v89, v89, v25
    v_add_f32 v90, v90, v26
    v_add_f32 v91, v91, v27
    v_add_f32 v92, v92, v28
    v_add_f32 v93, v93, v29
    v_add_f32 v94, v94, v30
    v_add_f32 v95, v95, v31
    v_cvt_pk_bf16_f32 v104, v80, v81
    v_cvt_pk_bf16_f32 v105, v82, v83
    v_cvt_pk_bf16_f32 v106, v84, v85
    v_cvt_pk_bf16_f32 v107, v86, v87
    s_nop 1
    v_permlane16_swap_b32 v104, v106
    v_permlane16_swap_b32 v105, v107
    buffer_store_dwordx4 v[104:107], v8, s[12:15], s63 offen sc1
    v_cvt_pk_bf16_f32 v108, v88, v89
    v_cvt_pk_bf16_f32 v109, v90, v91
    v_cvt_pk_bf16_f32 v110, v92, v93
    v_cvt_pk_bf16_f32 v111, v94, v95
    s_nop 1
    v_permlane16_swap_b32 v108, v110
    v_permlane16_swap_b32 v109, v111
    buffer_store_dwordx4 v[108:111], v9, s[12:15], s63 offen sc1
    s_add_u32 s63, s63, s86
L_g_nep_142:
    s_cmp_lg_u32 s65, 0
    s_cbranch_scc1 L_g_nw1_143
    ds_read_b128 v[32:35], v4 offset:0
    ds_read_b128 v[36:39], v4 offset:256
    ds_read_b128 v[40:43], v4 offset:2048
    ds_read_b128 v[44:47], v4 offset:2304
    ds_read_b128 v[48:51], v4 offset:4096
    ds_read_b128 v[52:55], v4 offset:4352
    ds_read_b128 v[56:59], v4 offset:6144
    ds_read_b128 v[60:63], v4 offset:6400
    s_barrier
L_g_jn_145:
    s_setprio 1
    s_waitcnt lgkmcnt(6)
    v_mfma_f32_16x16x32_bf16 v[16:19], v[32:35], a[0:3], 0
    ds_read_b32 v14, v15
    v_mfma_f32_16x16x32_bf16 v[20:23], v[32:35], a[4:7], 0
    ds_read_b128 v[32:35], v4 offset:8192
    v_mfma_f32_16x16x32_bf16 v[28:31], v[36:39], a[4:7], 0
    v_mfma_f32_16x16x32_bf16 v[24:27], v[36:39], a[0:3], 0
    ds_read_b128 v[36:39], v4 offset:8448
    s_waitcnt lgkmcnt(6)
    v_mfma_f32_16x16x32_bf16 v[16:19], v[40:43], a[8:11], v[16:19]
    v_mfma_f32_16x16x32_bf16 v[20:23], v[40:43], a[12:15], v[20:23]
    ds_read_b128 v[40:43], v4 offset:10240
    v_mfma_f32_16x16x32_bf16 v[28:31], v[44:47], a[12:15], v[28:31]
    v_mfma_f32_16x16x32_bf16 v[24:27], v[44:47], a[8:11], v[24:27]
    ds_read_b128 v[44:47], v4 offset:10496
    s_waitcnt lgkmcnt(6)
    v_mfma_f32_16x16x32_bf16 v[16:19], v[48:51], a[16:19], v[16:19]
    v_mfma_f32_16x16x32_bf16 v[20:23], v[48:51], a[20:23], v[20:23]
    ds_read_b128 v[48:51], v4 offset:12288
    v_mfma_f32_16x16x32_bf16 v[28:31], v[52:55], a[20:23], v[28:31]
    v_mfma_f32_16x16x32_bf16 v[24:27], v[52:55], a[16:19], v[24:27]
    ds_read_b128 v[52:55], v4 offset:12544
    s_waitcnt lgkmcnt(6)
    v_mfma_f32_16x16x32_bf16 v[16:19], v[56:59], a[24:27], v[16:19]
    v_mfma_f32_16x16x32_bf16 v[20:23], v[56:59], a[28:31], v[20:23]
    ds_read_b128 v[56:59], v4 offset:14336
    v_mfma_f32_16x16x32_bf16 v[28:31], v[60:63], a[28:31], v[28:31]
    v_mfma_f32_16x16x32_bf16 v[24:27], v[60:63], a[24:27], v[24:27]
    ds_read_b128 v[60:63], v4 offset:14592
    s_waitcnt lgkmcnt(6)
    v_mfma_f32_16x16x32_bf16 v[16:19], v[32:35], a[32:35], v[16:19]
    v_mfma_f32_16x16x32_bf16 v[20:23], v[32:35], a[36:39], v[20:23]
    ds_read_b128 v[32:35], v4 offset:16384
    v_mfma_f32_16x16x32_bf16 v[28:31], v[36:39], a[36:39], v[28:31]
    v_mfma_f32_16x16x32_bf16 v[24:27], v[36:39], a[32:35], v[24:27]
    ds_read_b128 v[36:39], v4 offset:16640
    s_waitcnt lgkmcnt(6)
    v_mfma_f32_16x16x32_bf16 v[16:19], v[40:43], a[40:43], v[16:19]
    v_mfma_f32_16x16x32_bf16 v[20:23], v[40:43], a[44:47], v[20:23]
    ds_read_b128 v[40:43], v4 offset:18432
    v_mfma_f32_16x16x32_bf16 v[28:31], v[44:47], a[44:47], v[28:31]
    v_mfma_f32_16x16x32_bf16 v[24:27], v[44:47], a[40:43], v[24:27]
    ds_read_b128 v[44:47], v4 offset:18688
    s_waitcnt lgkmcnt(6)
    v_mfma_f32_16x16x32_bf16 v[16:19], v[48:51], a[48:51], v[16:19]
    v_mfma_f32_16x16x32_bf16 v[20:23], v[48:51], a[52:55], v[20:23]
    ds_read_b128 v[48:51], v4 offset:20480
    v_mfma_f32_16x16x32_bf16 v[28:31], v[52:55], a[52:55], v[28:31]
    v_mfma_f32_16x16x32_bf16 v[24:27], v[52:55], a[48:51], v[24:27]
    ds_read_b128 v[52:55], v4 offset:20736
    s_waitcnt lgkmcnt(6)
    v_mfma_f32_16x16x32_bf16 v[16:19], v[56:59], a[56:59], v[16:19]
    v_mfma_f32_16x16x32_bf16 v[20:23], v[56:59], a[60:63], v[20:23]
    ds_read_b128 v[56:59], v4 offset:22528
    v_mfma_f32_16x16x32_bf16 v[28:31], v[60:63], a[60:63], v[28:31]
    v_mfma_f32_16x16x32_bf16 v[24:27], v[60:63], a[56:59], v[24:27]
    ds_read_b128 v[60:63], v4 offset:22784
    s_waitcnt lgkmcnt(6)
    v_mfma_f32_16x16x32_bf16 v[16:19], v[32:35], a[64:67], v[16:19]
    v_mfma_f32_16x16x32_bf16 v[20:23], v[32:35], a[68:71], v[20:23]
    ds_read_b128 v[32:35], v4 offset:24576
    v_mfma_f32_16x16x32_bf16 v[28:31], v[36:39], a[68:71], v[28:31]
    v_mfma_f32_16x16x32_bf16 v[24:27], v[36:39], a[64:67], v[24:27]
    ds_read_b128 v[36:39], v4 offset:24832
    s_waitcnt lgkmcnt(6)
    v_mfma_f32_16x16x32_bf16 v[16:19], v[40:43], a[72:75], v[16:19]
    v_mfma_f32_16x16x32_bf16 v[20:23], v[40:43], a[76:79], v[20:23]
    ds_read_b128 v[40:43], v4 offset:26624
    v_mfma_f32_16x16x32_bf16 v[28:31], v[44:47], a[76:79], v[28:31]
    v_mfma_f32_16x16x32_bf16 v[24:27], v[44:47], a[72:75], v[24:27]
    ds_read_b128 v[44:47], v4 offset:26880
    s_waitcnt lgkmcnt(6)
    v_mfma_f32_16x16x32_bf16 v[16:19], v[48:51], a[80:83], v[16:19]
    v_mfma_f32_16x16x32_bf16 v[20:23], v[48:51], a[84:87], v[20:23]
    v_mfma_f32_16x16x32_bf16 v[28:31], v[52:55], a[84:87], v[28:31]
    v_mfma_f32_16x16x32_bf16 v[24:27], v[52:55], a[80:83], v[24:27]
    s_waitcnt lgkmcnt(4)
    v_mfma_f32_16x16x32_bf16 v[16:19], v[56:59], a[88:91], v[16:19]
    v_mfma_f32_16x16x32_bf16 v[20:23], v[56:59], a[92:95], v[20:23]
    v_mfma_f32_16x16x32_bf16 v[28:31], v[60:63], a[92:95], v[28:31]
    v_mfma_f32_16x16x32_bf16 v[24:27], v[60:63], a[88:91], v[24:27]
    s_waitcnt lgkmcnt(2)
    v_mfma_f32_16x16x32_bf16 v[16:19], v[32:35], a[96:99], v[16:19]
    v_mfma_f32_16x16x32_bf16 v[20:23], v[32:35], a[100:103], v[20:23]
    v_mfma_f32_16x16x32_bf16 v[28:31], v[36:39], a[100:103], v[28:31]
    v_mfma_f32_16x16x32_bf16 v[24:27], v[36:39], a[96:99], v[24:27]
    s_waitcnt lgkmcnt(0)
    v_mfma_f32_16x16x32_bf16 v[16:19], v[40:43], a[104:107], v[16:19]
    v_mfma_f32_16x16x32_bf16 v[20:23], v[40:43], a[108:111], v[20:23]
    v_mfma_f32_16x16x32_bf16 v[28:31], v[44:47], a[108:111], v[28:31]
    v_mfma_f32_16x16x32_bf16 v[24:27], v[44:47], a[104:107], v[24:27]
    v_xor_b32 v4, 0x10000, v4
    s_setprio 0
    s_waitcnt vmcnt(0)
    v_readfirstlane_b32 s66, v14
    s_lshl_b32 s67, s67, 1
    s_or_b32 s67, s67, 1
    s_add_u32 s60, s60, 1
    s_cmp_gt_u32 s66, s60
    s_cbranch_scc1 L_g_loop1_125
    s_barrier
    ds_read_b32 v14, v15 offset:20
    ds_read_b128 v[80:83], v5 offset:0
    ds_read_b128 v[84:87], v5 offset:1024
    ds_read_b128 v[88:91], v5 offset:2048
    ds_read_b128 v[92:95], v5 offset:3072
    s_waitcnt lgkmcnt(4)
    v_readfirstlane_b32 s66, v14
    s_barrier
    s_mov_b32 s69, 0
    s_cmp_gt_u32 s62, s60
    s_cbranch_scc1 L_g_nd_147
    s_cmp_ge_u32 s62, s66
    s_cbranch_scc1 L_g_nd_147
    s_add_u32 s47, s61, 4096
    s_add_u32 m0, s64, 0
    s_nop 0
    buffer_load_dwordx4 v3, s[12:15], s61 offen offset:0 sc1 lds
    buffer_load_dwordx4 v3, s[12:15], s61 offen offset:1024 sc1 lds
    buffer_load_dwordx4 v3, s[12:15], s61 offen offset:2048 sc1 lds
    buffer_load_dwordx4 v3, s[12:15], s61 offen offset:3072 sc1 lds
    s_add_u32 m0, s64, 4096
    s_nop 0
    buffer_load_dwordx4 v3, s[12:15], s47 offen offset:0 sc1 lds
    buffer_load_dwordx4 v3, s[12:15], s47 offen offset:1024 sc1 lds
    buffer_load_dwordx4 v3, s[12:15], s47 offen offset:2048 sc1 lds
    s_add_u32 s61, s61, s85
    s_add_u32 s62, s62, 1
    s_xor_b32 s64, s64, 0x10000
    s_mov_b32 s69, 1
L_g_nd_147:
    s_waitcnt lgkmcnt(3)
    v_add_f32 v80, v80, v16
    v_add_f32 v81, v81, v17
    v_add_f32 v82, v82, v18
    v_add_f32 v83, v83, v19
    s_waitcnt lgkmcnt(2)
    v_add_f32 v84, v84, v20
    v_add_f32 v85, v85, v21
    v_add_f32 v86, v86, v22
    v_add_f32 v87, v87, v23
    s_waitcnt lgkmcnt(1)
    v_add_f32 v88, v88, v24
    v_add_f32 v89, v89, v25
    v_add_f32 v90, v90, v26
    v_add_f32 v91, v91, v27
    s_waitcnt lgkmcnt(0)
    v_add_f32 v92, v92, v28
    v_add_f32 v93, v93, v29
    v_add_f32 v94, v94, v30
    v_add_f32 v95, v95, v31
    v_cvt_pk_bf16_f32 v104, v80, v81
    v_cvt_pk_bf16_f32 v105, v82, v83
    v_cvt_pk_bf16_f32 v106, v84, v85
    v_cvt_pk_bf16_f32 v107, v86, v87
    s_nop 1
    v_permlane16_swap_b32 v104, v106
    v_permlane16_swap_b32 v105, v107
    buffer_store_dwordx4 v[104:107], v8, s[12:15], s63 offen sc1
    v_cvt_pk_bf16_f32 v108, v88, v89
    v_cvt_pk_bf16_f32 v109, v90, v91
    v_cvt_pk_bf16_f32 v110, v92, v93
    v_cvt_pk_bf16_f32 v111, v94, v95
    s_nop 1
    v_permlane16_swap_b32 v108, v110
    v_permlane16_swap_b32 v109, v111
    buffer_store_dwordx4 v[108:111], v9, s[12:15], s63 offen sc1
    s_add_u32 s63, s63, s86
    s_mov_b32 s67, 0
    s_mov_b32 s71, 1
    s_cmp_gt_u32 s66, s60
    s_cbranch_scc1 L_g_g1r_123
    v_mov_b32 v10, 1
    s_mov_b64 exec, 1
    s_waitcnt vmcnt(0)
    ds_add_rtn_u32 v10, v15, v10 offset:4
    s_waitcnt lgkmcnt(0)
    v_readfirstlane_b32 s46, v10
    s_mov_b64 exec, -1
    s_mov_b32 s71, 0
    s_sub_u32 s59, s60, 1
    s_mul_i32 s59, s59, s78
    s_add_u32 s59, s59, s74
    s_cmp_lg_u32 s46, s68
    s_cbranch_scc1 L_g_df_148
    v_mov_b32 v10, s59
    v_add_u32 v10, 1, v10
    v_mov_b32 v11, 0
    s_mov_b64 exec, 1
    buffer_store_dword v10, v11, s[12:15], s52 offen sc1
    s_mov_b64 exec, -1
L_sf_149:
L_g_df_148:
    s_add_u32 s68, s68, 4
    s_cmp_gt_u32 s66, s60
    s_cbranch_scc1 L_g_g1r_123
L_g_tail_126:
    s_cmp_lt_u32 s60, s75
    s_cbranch_scc1 L_g_restart_121
    s_waitcnt vmcnt(0)
    s_barrier
    s_branch L_c_done_1
L_g_h1_136:
    s_add_u32 s54, s60, 1
    s_mul_i32 s55, s54, s78
    v_add_u32 v12, s55, v113
    v_subrev_u32 v13, 58, v12
    v_ashrrev_i32 v11, 31, v13
    v_and_b32 v13, 1, v13
    v_add_u32 v13, 1, v13
    v_bfi_b32 v13, v11, 0, v13
    v_lshl_add_u32 v13, v13, 16, v7
    buffer_load_dword v11, v13, s[12:15], 0 offen sc1
    s_branch L_g_h1_136_b
L_g_h2_137:
    s_waitcnt vmcnt(0)
    v_cmp_ge_u32 vcc, v12, v11
    s_nop 0
    s_ff1_i32_b64 s46, vcc
    s_lshr_b32 s46, s46, 4
    s_min_u32 s46, s46, 4
    s_add_u32 s46, s46, s54
    s_min_u32 s46, s46, s75
    v_mov_b32 v118, s46
    s_branch L_g_h2_137_b
L_g_dp_138_l:
    s_cmp_ge_u32 s62, s66
    s_cbranch_scc1 L_g_dp_138_d
    s_mov_b32 s65, 1
    s_add_u32 s47, s61, 4096
    s_mov_b32 m0, s64
    s_add_u32 s62, s62, 1
    buffer_load_dwordx4 v3, s[12:15], s61 offen offset:0 sc1 lds
    buffer_load_dwordx4 v3, s[12:15], s61 offen offset:1024 sc1 lds
    buffer_load_dwordx4 v3, s[12:15], s61 offen offset:2048 sc1 lds
    buffer_load_dwordx4 v3, s[12:15], s61 offen offset:3072 sc1 lds
    s_add_u32 m0, s64, 4096
    s_add_u32 s61, s61, s85
    buffer_load_dwordx4 v3, s[12:15], s47 offen offset:0 sc1 lds
    buffer_load_dwordx4 v3, s[12:15], s47 offen offset:1024 sc1 lds
    buffer_load_dwordx4 v3, s[12:15], s47 offen offset:2048 sc1 lds
    s_xor_b32 s64, s64, 0x10000
    s_branch L_g_dp_138_a
L_g_nw_134:
    s_waitcnt vmcnt(0) lgkmcnt(0)
    s_cmp_lg_u32 s44, 0
    s_cbranch_scc1 L_g_nl_150
    s_cmp_lt_u32 s66, s75
    s_cselect_b32 s81, 1, 2
L_g_nl_150:
    s_branch L_g_loop0_124_l
L_g_nfl_141:
    s_cmp_eq_u32 s71, 0
    s_cbranch_scc1 L_g_nfl_141_d
    v_mov_b32 v10, 1
    s_mov_b64 exec, 1
    s_waitcnt vmcnt(0)
    ds_add_rtn_u32 v10, v15, v10 offset:4
    s_waitcnt lgkmcnt(0)
    v_readfirstlane_b32 s46, v10
    s_mov_b64 exec, -1
    s_mov_b32 s71, 0
    s_sub_u32 s59, s60, 1
    s_mul_i32 s59, s59, s78
    s_add_u32 s59, s59, s74
    s_cmp_lg_u32 s46, s68
    s_cbranch_scc1 L_g_df_151
    v_mov_b32 v10, s59
    v_add_u32 v10, 1, v10
    v_mov_b32 v11, 0
    s_mov_b64 exec, 1
    buffer_store_dword v10, v11, s[12:15], s52 offen sc1
    s_mov_b64 exec, -1
L_sf_152:
L_g_df_151:
    s_add_u32 s68, s68, 4
    s_mov_b32 s65, 2
    s_branch L_g_nfl_141_d
L_g_dp_146_l:
    s_cmp_ge_u32 s62, s66
    s_cbranch_scc1 L_g_dp_146_d
    s_or_b32 s65, s65, 1
    s_add_u32 s47, s61, 4096
    s_mov_b32 m0, s64
    s_add_u32 s62, s62, 1
    buffer_load_dwordx4 v3, s[12:15], s61 offen offset:0 sc1 lds
    buffer_load_dwordx4 v3, s[12:15], s61 offen offset:1024 sc1 lds
    buffer_load_dwordx4 v3, s[12:15], s61 offen offset:2048 sc1 lds
    buffer_load_dwordx4 v3, s[12:15], s61 offen offset:3072 sc1 lds
    s_add_u32 m0, s64, 4096
    s_add_u32 s61, s61, s85
    buffer_load_dwordx4 v3, s[12:15], s47 offen offset:0 sc1 lds
    buffer_load_dwordx4 v3, s[12:15], s47 offen offset:1024 sc1 lds
    buffer_load_dwordx4 v3, s[12:15], s47 offen offset:2048 sc1 lds
    s_xor_b32 s64, s64, 0x10000
    s_branch L_g_dp_146_a
L_g_nw1_143:
    s_cmp_eq_u32 s65, 2
    s_cbranch_scc1 L_g_nw1_143_w
    s_waitcnt vmcnt(0)
L_g_nw1_143_w:
    s_barrier
    ds_read_b128 v[32:35], v4 offset:0
    ds_read_b128 v[36:39], v4 offset:256
    ds_read_b128 v[40:43], v4 offset:2048
    ds_read_b128 v[44:47], v4 offset:2304
    ds_read_b128 v[48:51], v4 offset:4096
    ds_read_b128 v[52:55], v4 offset:4352
    ds_read_b128 v[56:59], v4 offset:6144
    ds_read_b128 v[60:63], v4 offset:6400
    s_branch L_g_jn_145
L_w_wo_12:
    s_load_dwordx2 s[4:5], s[0:1], 40
    s_load_dwordx2 s[6:7], s[0:1], 72
    s_and_b32 s50, s44, 3
    s_lshr_b32 s51, s44, 2
    s_waitcnt lgkmcnt(0)
    s_mov_b32 s24, s4
    s_and_b32 s25, s5, 0xffff
    s_mov_b32 s26, 0x800000
    s_mov_b32 s27, 0x00020000
    v_lshrrev_b32 v3, 4, v1
    v_and_b32 v4, 15, v1
    v_lshlrev_b32 v5, 2, v3
    v_xor_b32 v4, v4, v5
    v_mul_u32_u24 v3, 2048, v3
    v_lshl_add_u32 v3, v4, 4, v3
    s_mul_i32 s46, s51, 512
    s_mul_i32 s47, s50, 16
    s_add_u32 s46, s46, s47
    s_mul_i32 s47, s42, 1024
    s_add_u32 s46, s46, s47
    s_mul_i32 s46, s46, 2048
    s_lshl_b32 s47, s43, 8
    s_add_u32 s46, s46, s47
    s_lshl_b32 s45, s51, 16
    s_mul_i32 s47, s50, 4096
    s_add_u32 s45, s45, s47
    v_bfe_u32 v4, v1, 2, 2
    v_bfe_u32 v5, v1, 4, 1
    v_lshlrev_b32 v5, 1, v5
    v_bfe_u32 v6, v1, 1, 1
    v_add_u32 v5, v5, v6
    s_lshl_b32 s47, s50, 2
    v_add_u32 v5, s47, v5
    v_lshlrev_b32 v6, 2, v4
    v_xor_b32 v5, v5, v6
    v_lshlrev_b32 v5, 4, v5
    v_lshl_add_u32 v5, v4, 8, v5
    v_bfe_u32 v6, v1, 0, 1
    v_lshl_add_u32 v5, v6, 3, v5
    v_lshrrev_b32 v6, 5, v1
    v_mul_u32_u24 v6, 1024, v6
    v_add_u32 v5, v5, v6
    s_lshl_b32 s47, s51, 16
    v_add_u32 v5, s47, v5
    v_bfe_u32 v4, v1, 2, 2
    v_xor_b32 v5, s50, v4
    v_lshlrev_b32 v5, 6, v5
    v_lshl_add_u32 v5, v4, 8, v5
    v_and_b32 v6, 3, v1
    v_lshl_add_u32 v5, v6, 3, v5
    v_lshrrev_b32 v6, 4, v1
    v_lshl_add_u32 v5, v6, 10, v5
    v_lshrrev_b32 v6, 5, v1
    s_lshl_b32 s47, s51, 16
    v_add_u32 v5, s47, v5
    s_add_u32 m0, s45, 0
    s_add_u32 s47, s46, 0x0
    buffer_load_dwordx4 v3, s[24:27], s47 offen  lds
    s_add_u32 m0, s45, 1024
    s_add_u32 s47, s46, 0x2000
    buffer_load_dwordx4 v3, s[24:27], s47 offen  lds
    s_add_u32 m0, s45, 2048
    s_add_u32 s47, s46, 0x4000
    buffer_load_dwordx4 v3, s[24:27], s47 offen  lds
    s_add_u32 m0, s45, 3072
    s_add_u32 s47, s46, 0x6000
    buffer_load_dwordx4 v3, s[24:27], s47 offen  lds
    s_add_u32 m0, s45, 16384
    s_add_u32 s47, s46, 0x20000
    buffer_load_dwordx4 v3, s[24:27], s47 offen  lds
    s_add_u32 m0, s45, 17408
    s_add_u32 s47, s46, 0x22000
    buffer_load_dwordx4 v3, s[24:27], s47 offen  lds
    s_add_u32 m0, s45, 18432
    s_add_u32 s47, s46, 0x24000
    buffer_load_dwordx4 v3, s[24:27], s47 offen  lds
    s_add_u32 m0, s45, 19456
    s_add_u32 s47, s46, 0x26000
    buffer_load_dwordx4 v3, s[24:27], s47 offen  lds
    s_add_u32 m0, s45, 32768
    s_add_u32 s47, s46, 0x40000
    buffer_load_dwordx4 v3, s[24:27], s47 offen  lds
    s_add_u32 m0, s45, 33792
    s_add_u32 s47, s46, 0x42000
    buffer_load_dwordx4 v3, s[24:27], s47 offen  lds
    s_add_u32 m0, s45, 34816
    s_add_u32 s47, s46, 0x44000
    buffer_load_dwordx4 v3, s[24:27], s47 offen  lds
    s_add_u32 m0, s45, 35840
    s_add_u32 s47, s46, 0x46000
    buffer_load_dwordx4 v3, s[24:27], s47 offen  lds
    s_add_u32 m0, s45, 49152
    s_add_u32 s47, s46, 0x60000
    buffer_load_dwordx4 v3, s[24:27], s47 offen  lds
    s_add_u32 m0, s45, 50176
    s_add_u32 s47, s46, 0x62000
    buffer_load_dwordx4 v3, s[24:27], s47 offen  lds
    s_add_u32 m0, s45, 51200
    s_add_u32 s47, s46, 0x64000
    buffer_load_dwordx4 v3, s[24:27], s47 offen  lds
    s_add_u32 m0, s45, 52224
    s_add_u32 s47, s46, 0x66000
    buffer_load_dwordx4 v3, s[24:27], s47 offen  lds
    s_waitcnt vmcnt(12) lgkmcnt(0)
    s_barrier
    ds_read_b64_tr_b16 a[0:1], v5 offset:0
    ds_read_b64_tr_b16 a[2:3], v5 offset:4096
    ds_read_b64_tr_b16 a[4:5], v5 offset:32
    ds_read_b64_tr_b16 a[6:7], v5 offset:4128
    ds_read_b64_tr_b16 a[8:9], v5 offset:8192
    ds_read_b64_tr_b16 a[10:11], v5 offset:12288
    ds_read_b64_tr_b16 a[12:13], v5 offset:8224
    ds_read_b64_tr_b16 a[14:15], v5 offset:12320
    s_waitcnt vmcnt(8) lgkmcnt(0)
    s_barrier
    s_add_u32 m0, s45, 0
    s_add_u32 s47, s46, 0x80000
    buffer_load_dwordx4 v3, s[24:27], s47 offen  lds
    s_add_u32 m0, s45, 1024
    s_add_u32 s47, s46, 0x82000
    buffer_load_dwordx4 v3, s[24:27], s47 offen  lds
    s_add_u32 m0, s45, 2048
    s_add_u32 s47, s46, 0x84000
    buffer_load_dwordx4 v3, s[24:27], s47 offen  lds
    s_add_u32 m0, s45, 3072
    s_add_u32 s47, s46, 0x86000
    buffer_load_dwordx4 v3, s[24:27], s47 offen  lds
    ds_read_b64_tr_b16 a[16:17], v5 offset:16384
    ds_read_b64_tr_b16 a[18:19], v5 offset:20480
    ds_read_b64_tr_b16 a[20:21], v5 offset:16416
    ds_read_b64_tr_b16 a[22:23], v5 offset:20512
    ds_read_b64_tr_b16 a[24:25], v5 offset:24576
    ds_read_b64_tr_b16 a[26:27], v5 offset:28672
    ds_read_b64_tr_b16 a[28:29], v5 offset:24608
    ds_read_b64_tr_b16 a[30:31], v5 offset:28704
    s_waitcnt vmcnt(8) lgkmcnt(0)
    s_barrier
    s_add_u32 m0, s45, 16384
    s_add_u32 s47, s46, 0xa0000
    buffer_load_dwordx4 v3, s[24:27], s47 offen  lds
    s_add_u32 m0, s45, 17408
    s_add_u32 s47, s46, 0xa2000
    buffer_load_dwordx4 v3, s[24:27], s47 offen  lds
    s_add_u32 m0, s45, 18432
    s_add_u32 s47, s46, 0xa4000
    buffer_load_dwordx4 v3, s[24:27], s47 offen  lds
    s_add_u32 m0, s45, 19456
    s_add_u32 s47, s46, 0xa6000
    buffer_load_dwordx4 v3, s[24:27], s47 offen  lds
    ds_read_b64_tr_b16 a[32:33], v5 offset:32768
    ds_read_b64_tr_b16 a[34:35], v5 offset:36864
    ds_read_b64_tr_b16 a[36:37], v5 offset:32800
    ds_read_b64_tr_b16 a[38:39], v5 offset:36896
    ds_read_b64_tr_b16 a[40:41], v5 offset:40960
    ds_read_b64_tr_b16 a[42:43], v5 offset:45056
    ds_read_b64_tr_b16 a[44:45], v5 offset:40992
    ds_read_b64_tr_b16 a[46:47], v5 offset:45088
    s_waitcnt vmcnt(8) lgkmcnt(0)
    s_barrier
    s_add_u32 m0, s45, 32768
    s_add_u32 s47, s46, 0xc0000
    buffer_load_dwordx4 v3, s[24:27], s47 offen  lds
    s_add_u32 m0, s45, 33792
    s_add_u32 s47, s46, 0xc2000
    buffer_load_dwordx4 v3, s[24:27], s47 offen  lds
    s_add_u32 m0, s45, 34816
    s_add_u32 s47, s46, 0xc4000
    buffer_load_dwordx4 v3, s[24:27], s47 offen  lds
    s_add_u32 m0, s45, 35840
    s_add_u32 s47, s46, 0xc6000
    buffer_load_dwordx4 v3, s[24:27], s47 offen  lds
    ds_read_b64_tr_b16 a[48:49], v5 offset:49152
    ds_read_b64_tr_b16 a[50:51], v5 offset:53248
    ds_read_b64_tr_b16 a[52:53], v5 offset:49184
    ds_read_b64_tr_b16 a[54:55], v5 offset:53280
    ds_read_b64_tr_b16 a[56:57], v5 offset:57344
    ds_read_b64_tr_b16 a[58:59], v5 offset:61440
    ds_read_b64_tr_b16 a[60:61], v5 offset:57376
    ds_read_b64_tr_b16 a[62:63], v5 offset:61472
    s_waitcnt vmcnt(8) lgkmcnt(0)
    s_barrier
    s_add_u32 m0, s45, 49152
    s_add_u32 s47, s46, 0xe0000
    buffer_load_dwordx4 v3, s[24:27], s47 offen  lds
    s_add_u32 m0, s45, 50176
    s_add_u32 s47, s46, 0xe2000
    buffer_load_dwordx4 v3, s[24:27], s47 offen  lds
    s_add_u32 m0, s45, 51200
    s_add_u32 s47, s46, 0xe4000
    buffer_load_dwordx4 v3, s[24:27], s47 offen  lds
    s_add_u32 m0, s45, 52224
    s_add_u32 s47, s46, 0xe6000
    buffer_load_dwordx4 v3, s[24:27], s47 offen  lds
    ds_read_b64_tr_b16 a[64:65], v5 offset:0
    ds_read_b64_tr_b16 a[66:67], v5 offset:4096
    ds_read_b64_tr_b16 a[68:69], v5 offset:32
    ds_read_b64_tr_b16 a[70:71], v5 offset:4128
    ds_read_b64_tr_b16 a[72:73], v5 offset:8192
    ds_read_b64_tr_b16 a[74:75], v5 offset:12288
    ds_read_b64_tr_b16 a[76:77], v5 offset:8224
    ds_read_b64_tr_b16 a[78:79], v5 offset:12320
    s_waitcnt vmcnt(8) lgkmcnt(0)
    s_barrier
    ds_read_b64_tr_b16 a[80:81], v5 offset:16384
    ds_read_b64_tr_b16 a[82:83], v5 offset:20480
    ds_read_b64_tr_b16 a[84:85], v5 offset:16416
    ds_read_b64_tr_b16 a[86:87], v5 offset:20512
    ds_read_b64_tr_b16 a[88:89], v5 offset:24576
    ds_read_b64_tr_b16 a[90:91], v5 offset:28672
    ds_read_b64_tr_b16 a[92:93], v5 offset:24608
    ds_read_b64_tr_b16 a[94:95], v5 offset:28704
    s_waitcnt vmcnt(4) lgkmcnt(0)
    s_barrier
    ds_read_b64_tr_b16 a[96:97], v5 offset:32768
    ds_read_b64_tr_b16 a[98:99], v5 offset:36864
    ds_read_b64_tr_b16 a[100:101], v5 offset:32800
    ds_read_b64_tr_b16 a[102:103], v5 offset:36896
    ds_read_b64_tr_b16 a[104:105], v5 offset:40960
    ds_read_b64_tr_b16 a[106:107], v5 offset:45056
    ds_read_b64_tr_b16 a[108:109], v5 offset:40992
    ds_read_b64_tr_b16 a[110:111], v5 offset:45088
    s_waitcnt vmcnt(0) lgkmcnt(0)
    s_barrier
    ds_read_b64_tr_b16 a[112:113], v5 offset:49152
    ds_read_b64_tr_b16 a[114:115], v5 offset:53248
    ds_read_b64_tr_b16 a[116:117], v5 offset:49184
    ds_read_b64_tr_b16 a[118:119], v5 offset:53280
    ds_read_b64_tr_b16 a[120:121], v5 offset:57344
    ds_read_b64_tr_b16 a[122:123], v5 offset:61440
    ds_read_b64_tr_b16 a[124:125], v5 offset:57376
    ds_read_b64_tr_b16 a[126:127], v5 offset:61472
    s_waitcnt lgkmcnt(0)
    s_barrier
    s_load_dwordx2 s[8:9], s[0:1], 64
    s_load_dwordx2 s[10:11], s[0:1], 80
    s_lshl_b32 s46, s42, 3
    s_add_u32 s46, s46, s43
    s_mul_i32 s46, s46, 229376
    s_mul_i32 s47, s44, 28672
    s_add_u32 s46, s46, s47
    v_lshlrev_b32 v10, 7, v1
    s_waitcnt lgkmcnt(0)
    s_mov_b32 s28, s8
    s_and_b32 s29, s9, 0xffff
    s_mov_b32 s30, 0x700000
    s_mov_b32 s31, 0x00020000
    s_mov_b32 s32, s10
    s_and_b32 s33, s11, 0xffff
    s_mov_b32 s34, 0x700000
    s_mov_b32 s35, 0x00020000
    s_add_u32 s47, s46, 0
    buffer_load_dword v120, v10, s[28:31], s47 offen
    s_add_u32 s47, s46, 8192
    buffer_load_dword v121, v10, s[28:31], s47 offen
    s_add_u32 s47, s46, 16384
    buffer_load_dword v122, v10, s[28:31], s47 offen
    s_add_u32 s47, s46, 20480
    buffer_load_dword v123, v10, s[28:31], s47 offen
    v_lshlrev_b32 v2, 4, v1
    s_mul_i32 s64, s44, 8192
    s_add_u32 s46, s64, 0x5000000
    s_mul_i32 s47, s42, 65536
    s_add_u32 s46, s46, s47
    v_add_u32 v3, s46, v2
    s_mul_i32 s46, s51, 32768
    v_add_u32 v4, s46, v2
    v_and_b32 v6, 15, v1
    v_lshlrev_b32 v6, 4, v6
    v_lshrrev_b32 v7, 4, v1
    v_lshl_add_u32 v6, v7, 9, v6
    v_add_u32 v4, s46, v6
    s_lshl_b32 s46, s50, 12
    s_add_u32 s46, s46, 131072
    v_add_u32 v5, s46, v2
    v_and_b32 v7, 7, v1
    v_lshlrev_b32 v7, 9, v7
    s_lshl_b32 s46, s42, 12
    s_add_u32 s46, s46, 0x102000
    v_add_u32 v7, s46, v7
    s_lshl_b32 s46, s42, 16
    s_lshl_b32 s47, s43, 11
    s_add_u32 s46, s46, s47
    s_lshl_b32 s47, s50, 9
    s_add_u32 s46, s46, s47
    s_add_u32 s46, s46, 0x9000000
    v_and_b32 v8, 31, v1
    v_lshlrev_b32 v8, 4, v8
    v_lshrrev_b32 v9, 5, v1
    v_lshl_add_u32 v8, v9, 14, v8
    v_add_u32 v8, s46, v8
    v_add_u32 v9, 0x8000, v8
    s_lshl_b32 s52, s43, 9
    s_lshl_b32 s47, s42, 7
    s_add_u32 s52, s52, s47
    s_add_u32 s52, s52, 0x107400
    s_add_u32 s52, s52, s76
    s_mul_i32 s46, s43, 8192
    s_add_u32 s46, s46, 0x5000000
    s_mul_i32 s47, s42, 65536
    s_add_u32 s46, s46, s47
    v_min_u32 v116, 63, v1
    v_lshlrev_b32 v116, 7, v116
    v_add_u32 v116, s46, v116
    s_mov_b32 s60, 0
    s_mul_i32 s61, s74, 262144
    s_mov_b32 s62, 0
    s_mul_i32 s63, s74, 262144
    s_mul_i32 s85, s78, 262144
    s_mul_i32 s86, s78, 262144
    s_sub_u32 s46, s78, 1
    s_sub_u32 s75, s75, s74
    s_add_u32 s75, s75, s46
    s_lshr_b32 s75, s75, s46
    s_mov_b32 s67, 0
    s_mov_b32 s68, 3
    s_mov_b32 s71, 0
    v_mov_b32 v15, 147456
    v_mov_b32 v14, 0
    ds_write_b32 v15, v14 offset:4
    ds_write_b32 v15, v14 offset:12
    ds_write_b32 v15, v14 offset:16
    v_mov_b32 v114, 1
    v_mov_b32 v115, 0
    s_mov_b32 s81, 0
    s_mul_i32 s87, s78, 2
    s_sub_u32 s87, s74, s87
    s_add_u32 s87, s87, 1
    s_lshl_b32 s46, s44, 5
    v_add_u32 v119, s46, v15
    v_lshrrev_b32 v113, 4, v1
    v_mul_u32_u24 v113, s78, v113
    v_add_u32 v113, s74, v113
    s_mov_b32 s72, 0
L_g_restart_153:
    s_cmp_lg_u32 s44, 0
    s_cbranch_scc1 L_g_nsp_154
    s_mov_b32 s70, 0
L_g_sp_160:
    s_add_u32 s54, s60, 0
    s_mul_i32 s55, s54, s78
    v_add_u32 v12, s55, v113
    v_and_b32 v13, 3, v12
    v_lshl_add_u32 v13, v13, 7, v7
    buffer_load_dword v11, v13, s[12:15], 0 offen sc1
    s_waitcnt vmcnt(0)
    v_cmp_ge_u32 vcc, v12, v11
    s_add_u32 s70, s70, 1
    s_and_b32 s46, vcc_lo, 0xffff
    s_cbranch_scc0 L_g_sp_160_ok
    s_sleep 3
    s_cmp_lt_u32 s70, 524288
    s_cbranch_scc1 L_g_sp_160
    s_branch L_c_done_1
L_g_sp_160_ok:
    v_cmp_ge_u32 vcc, v12, v11
    s_nop 0
    s_ff1_i32_b64 s46, vcc
    s_lshr_b32 s46, s46, 4
    s_min_u32 s46, s46, 4
    s_add_u32 s46, s46, s54
    s_min_u32 s46, s46, s75
    v_mov_b32 v118, s46
    ds_write_b32 v15, v118 offset:20
L_g_nsp_154:
    s_waitcnt lgkmcnt(0)
    s_barrier
    ds_read_b32 v14, v15 offset:20
    s_waitcnt lgkmcnt(0)
    v_readfirstlane_b32 s66, v14
    s_nop 3
L_g_restart_153_go:
    s_mov_b32 s69, 0
    s_cmp_gt_u32 s62, s60
    s_cbranch_scc1 L_g_nd_161
    s_cmp_ge_u32 s62, s66
    s_cbranch_scc1 L_g_nd_161
    s_add_u32 s47, s61, 4096
    s_add_u32 m0, s64, 0
    s_nop 0
    buffer_load_dwordx4 v3, s[12:15], s61 offen offset:0 sc1 lds
    buffer_load_dwordx4 v3, s[12:15], s61 offen offset:1024 sc1 lds
    buffer_load_dwordx4 v3, s[12:15], s61 offen offset:2048 sc1 lds
    buffer_load_dwordx4 v3, s[12:15], s61 offen offset:3072 sc1 lds
    s_add_u32 m0, s64, 4096
    s_nop 0
    buffer_load_dwordx4 v3, s[12:15], s47 offen offset:0 sc1 lds
    buffer_load_dwordx4 v3, s[12:15], s47 offen offset:1024 sc1 lds
    buffer_load_dwordx4 v3, s[12:15], s47 offen offset:2048 sc1 lds
    buffer_load_dwordx4 v3, s[12:15], s47 offen offset:3072 sc1 lds
    s_add_u32 s61, s61, s85
    s_add_u32 s62, s62, 1
    s_xor_b32 s64, s64, 0x10000
    s_mov_b32 s69, 1
L_g_nd_161:
    s_cmp_eq_u32 s51, 1
    s_cbranch_scc1 L_g_g1r_155
    s_add_u32 s59, s60, 1
    s_mov_b32 s69, 0
    s_cmp_gt_u32 s62, s59
    s_cbranch_scc1 L_g_nd_162
    s_cmp_ge_u32 s62, s66
    s_cbranch_scc1 L_g_nd_162
    s_add_u32 s47, s61, 4096
    s_add_u32 m0, s64, 0
    s_nop 0
    buffer_load_dwordx4 v3, s[12:15], s61 offen offset:0 sc1 lds
    buffer_load_dwordx4 v3, s[12:15], s61 offen offset:1024 sc1 lds
    buffer_load_dwordx4 v3, s[12:15], s61 offen offset:2048 sc1 lds
    buffer_load_dwordx4 v3, s[12:15], s61 offen offset:3072 sc1 lds
    s_add_u32 m0, s64, 4096
    s_nop 0
    buffer_load_dwordx4 v3, s[12:15], s47 offen offset:0 sc1 lds
    buffer_load_dwordx4 v3, s[12:15], s47 offen offset:1024 sc1 lds
    buffer_load_dwordx4 v3, s[12:15], s47 offen offset:2048 sc1 lds
    buffer_load_dwordx4 v3, s[12:15], s47 offen offset:3072 sc1 lds
    s_add_u32 s61, s61, s85
    s_add_u32 s62, s62, 1
    s_xor_b32 s64, s64, 0x10000
    s_mov_b32 s69, 1
L_g_nd_162:
    s_cmp_eq_u32 s69, 1
    s_cbranch_scc1 L_g_w0_163
    s_waitcnt vmcnt(0)
L_g_w0_163:
    s_waitcnt vmcnt(8)
    s_cmp_lg_u32 s44, 0
    s_cbranch_scc1 L_g_nl_164
    s_cmp_lt_u32 s66, s75
    s_cselect_b32 s81, 1, 2
L_g_nl_164:
L_g_loop0_156_l:
    s_barrier
    ds_read_b128 v[32:35], v4 offset:0
    ds_read_b128 v[36:39], v4 offset:256
    ds_read_b128 v[40:43], v4 offset:2048
    ds_read_b128 v[44:47], v4 offset:2304
    ds_read_b128 v[48:51], v4 offset:4096
    ds_read_b128 v[52:55], v4 offset:4352
    ds_read_b128 v[56:59], v4 offset:6144
    ds_read_b128 v[60:63], v4 offset:6400
    s_branch L_g_loop0_156_m
.p2align 6
L_g_loop0_156:
    s_barrier
L_g_loop0_156_m:
    s_setprio 2
    s_waitcnt lgkmcnt(6)
    v_mfma_f32_16x16x32_bf16 v[16:19], v[32:35], a[0:3], 0
    v_mfma_f32_16x16x32_bf16 v[20:23], v[32:35], a[4:7], 0
    ds_read_b128 v[32:35], v4 offset:8192
    v_mfma_f32_16x16x32_bf16 v[28:31], v[36:39], a[4:7], 0
    v_mfma_f32_16x16x32_bf16 v[24:27], v[36:39], a[0:3], 0
    ds_read_b128 v[36:39], v4 offset:8448
    s_cmp_eq_u32 s81, 1
    s_cbranch_scc1 L_g_h1_168
L_g_h1_168_b:
    s_waitcnt lgkmcnt(6)
    v_mfma_f32_16x16x32_bf16 v[16:19], v[40:43], a[8:11], v[16:19]
    v_mfma_f32_16x16x32_bf16 v[20:23], v[40:43], a[12:15], v[20:23]
    ds_read_b128 v[40:43], v4 offset:10240
    v_mfma_f32_16x16x32_bf16 v[28:31], v[44:47], a[12:15], v[28:31]
    v_mfma_f32_16x16x32_bf16 v[24:27], v[44:47], a[8:11], v[24:27]
    ds_read_b128 v[44:47], v4 offset:10496
    s_waitcnt lgkmcnt(6)
    v_mfma_f32_16x16x32_bf16 v[16:19], v[48:51], a[16:19], v[16:19]
    v_mfma_f32_16x16x32_bf16 v[20:23], v[48:51], a[20:23], v[20:23]
    ds_read_b128 v[48:51], v4 offset:12288
    v_mfma_f32_16x16x32_bf16 v[28:31], v[52:55], a[20:23], v[28:31]
    v_mfma_f32_16x16x32_bf16 v[24:27], v[52:55], a[16:19], v[24:27]
    ds_read_b128 v[52:55], v4 offset:12544
    s_waitcnt lgkmcnt(6)
    v_mfma_f32_16x16x32_bf16 v[16:19], v[56:59], a[24:27], v[16:19]
    v_mfma_f32_16x16x32_bf16 v[20:23], v[56:59], a[28:31], v[20:23]
    ds_read_b128 v[56:59], v4 offset:14336
    v_mfma_f32_16x16x32_bf16 v[28:31], v[60:63], a[28:31], v[28:31]
    v_mfma_f32_16x16x32_bf16 v[24:27], v[60:63], a[24:27], v[24:27]
    ds_read_b128 v[60:63], v4 offset:14592
    s_waitcnt lgkmcnt(6)
    v_mfma_f32_16x16x32_bf16 v[16:19], v[32:35], a[32:35], v[16:19]
    v_mfma_f32_16x16x32_bf16 v[20:23], v[32:35], a[36:39], v[20:23]
    ds_read_b128 v[32:35], v4 offset:16384
    v_mfma_f32_16x16x32_bf16 v[28:31], v[36:39], a[36:39], v[28:31]
    v_mfma_f32_16x16x32_bf16 v[24:27], v[36:39], a[32:35], v[24:27]
    ds_read_b128 v[36:39], v4 offset:16640
    s_waitcnt lgkmcnt(6)
    v_mfma_f32_16x16x32_bf16 v[16:19], v[40:43], a[40:43], v[16:19]
    v_mfma_f32_16x16x32_bf16 v[20:23], v[40:43], a[44:47], v[20:23]
    ds_read_b128 v[40:43], v4 offset:18432
    v_mfma_f32_16x16x32_bf16 v[28:31], v[44:47], a[44:47], v[28:31]
    v_mfma_f32_16x16x32_bf16 v[24:27], v[44:47], a[40:43], v[24:27]
    ds_read_b128 v[44:47], v4 offset:18688
    s_waitcnt lgkmcnt(6)
    v_mfma_f32_16x16x32_bf16 v[16:19], v[48:51], a[48:51], v[16:19]
    v_mfma_f32_16x16x32_bf16 v[20:23], v[48:51], a[52:55], v[20:23]
    ds_read_b128 v[48:51], v4 offset:20480
    v_mfma_f32_16x16x32_bf16 v[28:31], v[52:55], a[52:55], v[28:31]
    v_mfma_f32_16x16x32_bf16 v[24:27], v[52:55], a[48:51], v[24:27]
    ds_read_b128 v[52:55], v4 offset:20736
    s_waitcnt lgkmcnt(6)
    v_mfma_f32_16x16x32_bf16 v[16:19], v[56:59], a[56:59], v[16:19]
    v_mfma_f32_16x16x32_bf16 v[20:23], v[56:59], a[60:63], v[20:23]
    ds_read_b128 v[56:59], v4 offset:22528
    v_mfma_f32_16x16x32_bf16 v[28:31], v[60:63], a[60:63], v[28:31]
    v_mfma_f32_16x16x32_bf16 v[24:27], v[60:63], a[56:59], v[24:27]
    ds_read_b128 v[60:63], v4 offset:22784
    s_waitcnt lgkmcnt(6)
    v_mfma_f32_16x16x32_bf16 v[16:19], v[32:35], a[64:67], v[16:19]
    v_mfma_f32_16x16x32_bf16 v[20:23], v[32:35], a[68:71], v[20:23]
    ds_read_b128 v[32:35], v4 offset:24576
    v_mfma_f32_16x16x32_bf16 v[28:31], v[36:39], a[68:71], v[28:31]
    v_mfma_f32_16x16x32_bf16 v[24:27], v[36:39], a[64:67], v[24:27]
    ds_read_b128 v[36:39], v4 offset:24832
    s_waitcnt lgkmcnt(6)
    v_mfma_f32_16x16x32_bf16 v[16:19], v[40:43], a[72:75], v[16:19]
    v_mfma_f32_16x16x32_bf16 v[20:23], v[40:43], a[76:79], v[20:23]
    ds_read_b128 v[40:43], v4 offset:26624
    v_mfma_f32_16x16x32_bf16 v[28:31], v[44:47], a[76:79], v[28:31]
    v_mfma_f32_16x16x32_bf16 v[24:27], v[44:47], a[72:75], v[24:27]
    ds_read_b128 v[44:47], v4 offset:26880
    s_waitcnt lgkmcnt(6)
    v_mfma_f32_16x16x32_bf16 v[16:19], v[48:51], a[80:83], v[16:19]
    v_mfma_f32_16x16x32_bf16 v[20:23], v[48:51], a[84:87], v[20:23]
    ds_read_b128 v[48:51], v4 offset:28672
    v_mfma_f32_16x16x32_bf16 v[28:31], v[52:55], a[84:87], v[28:31]
    v_mfma_f32_16x16x32_bf16 v[24:27], v[52:55], a[80:83], v[24:27]
    ds_read_b128 v[52:55], v4 offset:28928
    s_waitcnt lgkmcnt(6)
    v_mfma_f32_16x16x32_bf16 v[16:19], v[56:59], a[88:91], v[16:19]
    v_mfma_f32_16x16x32_bf16 v[20:23], v[56:59], a[92:95], v[20:23]
    ds_read_b128 v[56:59], v4 offset:30720
    v_mfma_f32_16x16x32_bf16 v[28:31], v[60:63], a[92:95], v[28:31]
    v_mfma_f32_16x16x32_bf16 v[24:27], v[60:63], a[88:91], v[24:27]
    ds_read_b128 v[60:63], v4 offset:30976
    s_waitcnt lgkmcnt(6)
    v_mfma_f32_16x16x32_bf16 v[16:19], v[32:35], a[96:99], v[16:19]
    v_mfma_f32_16x16x32_bf16 v[20:23], v[32:35], a[100:103], v[20:23]
    v_mfma_f32_16x16x32_bf16 v[28:31], v[36:39], a[100:103], v[28:31]
    v_mfma_f32_16x16x32_bf16 v[24:27], v[36:39], a[96:99], v[24:27]
    s_waitcnt lgkmcnt(4)
    v_mfma_f32_16x16x32_bf16 v[16:19], v[40:43], a[104:107], v[16:19]
    v_mfma_f32_16x16x32_bf16 v[20:23], v[40:43], a[108:111], v[20:23]
    v_mfma_f32_16x16x32_bf16 v[28:31], v[44:47], a[108:111], v[28:31]
    v_mfma_f32_16x16x32_bf16 v[24:27], v[44:47], a[104:107], v[24:27]
    s_waitcnt lgkmcnt(2)
    v_mfma_f32_16x16x32_bf16 v[16:19], v[48:51], a[112:115], v[16:19]
    v_mfma_f32_16x16x32_bf16 v[20:23], v[48:51], a[116:119], v[20:23]
    s_cmp_eq_u32 s81, 1
    s_cbranch_scc1 L_g_h2_169
L_g_h2_169_b:
    ds_write_b32 v119, v118
    v_mfma_f32_16x16x32_bf16 v[28:31], v[52:55], a[116:119], v[28:31]
    v_mfma_f32_16x16x32_bf16 v[24:27], v[52:55], a[112:115], v[24:27]
    s_waitcnt lgkmcnt(0)
    v_mfma_f32_16x16x32_bf16 v[16:19], v[56:59], a[120:123], v[16:19]
    v_mfma_f32_16x16x32_bf16 v[20:23], v[56:59], a[124:127], v[20:23]
    v_mfma_f32_16x16x32_bf16 v[28:31], v[60:63], a[124:127], v[28:31]
    v_mfma_f32_16x16x32_bf16 v[24:27], v[60:63], a[120:123], v[24:27]
    v_xor_b32 v4, 0x10000, v4
    s_setprio 0
    s_waitcnt vmcnt(0)
    s_waitcnt lgkmcnt(0)
    s_barrier
    ds_read_b32 v14, v15
    s_nop 6
    ds_write_b128 v5, v[16:19] offset:0
    ds_write_b128 v5, v[20:23] offset:1024
    ds_write_b128 v5, v[24:27] offset:2048
    ds_write_b128 v5, v[28:31] offset:3072
    s_waitcnt lgkmcnt(4)
    v_readfirstlane_b32 s66, v14
    s_add_u32 s60, s60, 1
    s_mov_b32 s65, 0
    s_cmp_le_u32 s62, s60
    s_cbranch_scc1 L_g_dp_170_l
L_g_dp_170_a:
    s_cmp_ge_u32 s62, s66
    s_cbranch_scc1 L_g_dp_170_d
    s_add_u32 s47, s61, 4096
    s_mov_b32 m0, s64
    s_add_u32 s62, s62, 1
    buffer_load_dwordx4 v3, s[12:15], s61 offen offset:0 sc1 lds
    buffer_load_dwordx4 v3, s[12:15], s61 offen offset:1024 sc1 lds
    buffer_load_dwordx4 v3, s[12:15], s61 offen offset:2048 sc1 lds
    buffer_load_dwordx4 v3, s[12:15], s61 offen offset:3072 sc1 lds
    s_add_u32 m0, s64, 4096
    s_add_u32 s61, s61, s85
    buffer_load_dwordx4 v3, s[12:15], s47 offen offset:0 sc1 lds
    buffer_load_dwordx4 v3, s[12:15], s47 offen offset:1024 sc1 lds
    buffer_load_dwordx4 v3, s[12:15], s47 offen offset:2048 sc1 lds
    buffer_load_dwordx4 v3, s[12:15], s47 offen offset:3072 sc1 lds
    s_xor_b32 s64, s64, 0x10000
L_g_dp_170_d:
    s_cmp_lg_u32 s44, 2
    s_cbranch_scc1 L_g_pf_171
    s_cmp_ge_u32 s62, s66
    s_cbranch_scc1 L_g_pf_171
    buffer_load_dword v117, v116, s[12:15], s61 offen sc1
L_g_pf_171:
    s_cmp_le_u32 s66, s60
    s_cbranch_scc1 L_g_ex0_167
    s_cmp_lg_u32 s65, 0
    s_cbranch_scc1 L_g_nw_166
    ds_read_b128 v[32:35], v4 offset:0
    ds_read_b128 v[36:39], v4 offset:256
    ds_read_b128 v[40:43], v4 offset:2048
    ds_read_b128 v[44:47], v4 offset:2304
    ds_read_b128 v[48:51], v4 offset:4096
    ds_read_b128 v[52:55], v4 offset:4352
    ds_read_b128 v[56:59], v4 offset:6144
    ds_read_b128 v[60:63], v4 offset:6400
    s_cmp_lg_u32 s44, 0
    s_cbranch_scc1 L_g_nl_172
    s_mov_b32 s46, s66
    s_cmp_lg_u32 s81, 0
    s_cbranch_scc1 L_g_nl_172_e
    v_cmp_ge_u32 vcc, v12, v11
    s_nop 0
    s_ff1_i32_b64 s46, vcc
    s_lshr_b32 s46, s46, 4
    s_min_u32 s46, s46, 4
    s_add_u32 s46, s46, s54
    s_min_u32 s46, s46, s75
    v_mov_b32 v118, s46
L_g_nl_172_e:
    s_add_u32 s47, s60, 3
    s_min_u32 s47, s47, s75
    s_cmp_lt_u32 s46, s47
    s_cselect_b32 s81, 1, 0
    s_cbranch_scc1 L_g_nl_172
    s_add_u32 s54, s60, 2
    s_mul_i32 s55, s54, s78
    v_add_u32 v12, s55, v113
    v_and_b32 v13, 3, v12
    v_lshl_add_u32 v13, v13, 7, v7
    buffer_load_dword v11, v13, s[12:15], 0 offen sc1
L_g_nl_172:
    s_waitcnt lgkmcnt(8)
    s_branch L_g_loop0_156
L_g_ex0_167:
    s_cmp_lg_u32 s44, 0
    s_cbranch_scc1 L_g_ex0_167_n
    ds_write_b32 v15, v118 offset:20
    s_cmp_ge_u32 s60, s75
    s_cbranch_scc1 L_g_ex0_167_n
    s_sleep 6
    s_add_u32 s54, s60, 0
    s_mul_i32 s55, s54, s78
    v_add_u32 v12, s55, v113
    v_and_b32 v13, 3, v12
    v_lshl_add_u32 v13, v13, 7, v7
    buffer_load_dword v11, v13, s[12:15], 0 offen sc1
    s_waitcnt vmcnt(0)
    v_cmp_ge_u32 vcc, v12, v11
    s_nop 0
    s_ff1_i32_b64 s46, vcc
    s_lshr_b32 s46, s46, 4
    s_min_u32 s46, s46, 4
    s_add_u32 s46, s46, s54
    s_min_u32 s46, s46, s75
    v_mov_b32 v118, s46
    ds_write_b32 v15, v118 offset:20
L_g_ex0_167_n:
    s_waitcnt lgkmcnt(0)
    s_barrier
    ds_read_b32 v14, v15 offset:20
    s_waitcnt lgkmcnt(0)
    v_readfirstlane_b32 s66, v14
    s_barrier
    s_cmp_gt_u32 s66, s60
    s_cbranch_scc1 L_g_restart_153_go
    s_branch L_g_tail_158
L_g_g1r_155:
    s_mov_b32 s65, 1
    s_branch L_g_loop1_157_e
.p2align 6
L_g_loop1_157:
    s_mov_b32 s65, 0
L_g_loop1_157_e:
    s_barrier
    s_bitcmp1_b32 s67, 1
    s_cbranch_scc0 L_g_nfl_173
    s_cmp_lg_u32 s44, 4
    s_cbranch_scc1 L_g_nfl_173_d
    s_mul_i32 s59, s60, s78
    s_add_u32 s59, s59, s87
    v_mov_b32 v10, s59
    buffer_store_dword v10, v115, s[12:15], s52 offen sc1
L_g_nfl_173_d:
    ds_read_b128 v[80:83], v5 offset:0
    ds_read_b128 v[84:87], v5 offset:1024
    ds_read_b128 v[88:91], v5 offset:2048
    ds_read_b128 v[92:95], v5 offset:3072
    s_cmp_le_u32 s62, s60
    s_cbranch_scc1 L_g_dp_178_l
L_g_dp_178_a:
    s_cmp_ge_u32 s62, s66
    s_cbranch_scc1 L_g_dp_178_d
    s_add_u32 s47, s61, 4096
    s_mov_b32 m0, s64
    s_add_u32 s62, s62, 1
    buffer_load_dwordx4 v3, s[12:15], s61 offen offset:0 sc1 lds
    buffer_load_dwordx4 v3, s[12:15], s61 offen offset:1024 sc1 lds
    buffer_load_dwordx4 v3, s[12:15], s61 offen offset:2048 sc1 lds
    buffer_load_dwordx4 v3, s[12:15], s61 offen offset:3072 sc1 lds
    s_add_u32 m0, s64, 4096
    s_add_u32 s61, s61, s85
    buffer_load_dwordx4 v3, s[12:15], s47 offen offset:0 sc1 lds
    buffer_load_dwordx4 v3, s[12:15], s47 offen offset:1024 sc1 lds
    buffer_load_dwordx4 v3, s[12:15], s47 offen offset:2048 sc1 lds
    buffer_load_dwordx4 v3, s[12:15], s47 offen offset:3072 sc1 lds
    s_xor_b32 s64, s64, 0x10000
L_g_dp_178_d:
    s_bitcmp1_b32 s67, 0
    s_cbranch_scc0 L_g_nep_174
    s_waitcnt lgkmcnt(0)
    v_add_f32 v80, v80, v16
    v_add_f32 v81, v81, v17
    v_add_f32 v82, v82, v18
    v_add_f32 v83, v83, v19
    v_add_f32 v84, v84, v20
    v_add_f32 v85, v85, v21
    v_add_f32 v86, v86, v22
    v_add_f32 v87, v87, v23
    v_add_f32 v88, v88, v24
    v_add_f32 v89, v89, v25
    v_add_f32 v90, v90, v26
    v_add_f32 v91, v91, v27
    v_add_f32 v92, v92, v28
    v_add_f32 v93, v93, v29
    v_add_f32 v94, v94, v30
    v_add_f32 v95, v95, v31
    v_cvt_pk_bf16_f32 v104, v80, v81
    v_cvt_pk_bf16_f32 v105, v82, v83
    v_cvt_pk_bf16_f32 v106, v84, v85
    v_cvt_pk_bf16_f32 v107, v86, v87
    s_nop 1
    v_permlane16_swap_b32 v104, v106
    v_permlane16_swap_b32 v105, v107
    buffer_store_dwordx4 v[104:107], v8, s[12:15], s63 offen sc1
    v_cvt_pk_bf16_f32 v108, v88, v89
    v_cvt_pk_bf16_f32 v109, v90, v91
    v_cvt_pk_bf16_f32 v110, v92, v93
    v_cvt_pk_bf16_f32 v111, v94, v95
    s_nop 1
    v_permlane16_swap_b32 v108, v110
    v_permlane16_swap_b32 v109, v111
    buffer_store_dwordx4 v[108:111], v9, s[12:15], s63 offen sc1
    s_add_u32 s63, s63, s86
L_g_nep_174:
    s_cmp_lg_u32 s65, 0
    s_cbranch_scc1 L_g_nw1_175
    ds_read_b128 v[32:35], v4 offset:0
    ds_read_b128 v[36:39], v4 offset:256
    ds_read_b128 v[40:43], v4 offset:2048
    ds_read_b128 v[44:47], v4 offset:2304
    ds_read_b128 v[48:51], v4 offset:4096
    ds_read_b128 v[52:55], v4 offset:4352
    ds_read_b128 v[56:59], v4 offset:6144
    ds_read_b128 v[60:63], v4 offset:6400
    s_barrier
L_g_jn_177:
    s_setprio 1
    s_waitcnt lgkmcnt(6)
    v_mfma_f32_16x16x32_bf16 v[16:19], v[32:35], a[0:3], 0
    ds_read_b32 v14, v15
    v_mfma_f32_16x16x32_bf16 v[20:23], v[32:35], a[4:7], 0
    ds_read_b128 v[32:35], v4 offset:8192
    v_mfma_f32_16x16x32_bf16 v[28:31], v[36:39], a[4:7], 0
    v_mfma_f32_16x16x32_bf16 v[24:27], v[36:39], a[0:3], 0
    ds_read_b128 v[36:39], v4 offset:8448
    s_waitcnt lgkmcnt(6)
    v_mfma_f32_16x16x32_bf16 v[16:19], v[40:43], a[8:11], v[16:19]
    v_mfma_f32_16x16x32_bf16 v[20:23], v[40:43], a[12:15], v[20:23]
    ds_read_b128 v[40:43], v4 offset:10240
    v_mfma_f32_16x16x32_bf16 v[28:31], v[44:47], a[12:15], v[28:31]
    v_mfma_f32_16x16x32_bf16 v[24:27], v[44:47], a[8:11], v[24:27]
    ds_read_b128 v[44:47], v4 offset:10496
    s_waitcnt lgkmcnt(6)
    v_mfma_f32_16x16x32_bf16 v[16:19], v[48:51], a[16:19], v[16:19]
    v_mfma_f32_16x16x32_bf16 v[20:23], v[48:51], a[20:23], v[20:23]
    ds_read_b128 v[48:51], v4 offset:12288
    v_mfma_f32_16x16x32_bf16 v[28:31], v[52:55], a[20:23], v[28:31]
    v_mfma_f32_16x16x32_bf16 v[24:27], v[52:55], a[16:19], v[24:27]
    ds_read_b128 v[52:55], v4 offset:12544
    s_waitcnt lgkmcnt(6)
    v_mfma_f32_16x16x32_bf16 v[16:19], v[56:59], a[24:27], v[16:19]
    v_mfma_f32_16x16x32_bf16 v[20:23], v[56:59], a[28:31], v[20:23]
    ds_read_b128 v[56:59], v4 offset:14336
    v_mfma_f32_16x16x32_bf16 v[28:31], v[60:63], a[28:31], v[28:31]
    v_mfma_f32_16x16x32_bf16 v[24:27], v[60:63], a[24:27], v[24:27]
    ds_read_b128 v[60:63], v4 offset:14592
    s_waitcnt lgkmcnt(6)
    v_mfma_f32_16x16x32_bf16 v[16:19], v[32:35], a[32:35], v[16:19]
    v_mfma_f32_16x16x32_bf16 v[20:23], v[32:35], a[36:39], v[20:23]
    ds_read_b128 v[32:35], v4 offset:16384
    v_mfma_f32_16x16x32_bf16 v[28:31], v[36:39], a[36:39], v[28:31]
    v_mfma_f32_16x16x32_bf16 v[24:27], v[36:39], a[32:35], v[24:27]
    ds_read_b128 v[36:39], v4 offset:16640
    s_waitcnt lgkmcnt(6)
    v_mfma_f32_16x16x32_bf16 v[16:19], v[40:43], a[40:43], v[16:19]
    v_mfma_f32_16x16x32_bf16 v[20:23], v[40:43], a[44:47], v[20:23]
    ds_read_b128 v[40:43], v4 offset:18432
    v_mfma_f32_16x16x32_bf16 v[28:31], v[44:47], a[44:47], v[28:31]
    v_mfma_f32_16x16x32_bf16 v[24:27], v[44:47], a[40:43], v[24:27]
    ds_read_b128 v[44:47], v4 offset:18688
    s_waitcnt lgkmcnt(6)
    v_mfma_f32_16x16x32_bf16 v[16:19], v[48:51], a[48:51], v[16:19]
    v_mfma_f32_16x16x32_bf16 v[20:23], v[48:51], a[52:55], v[20:23]
    ds_read_b128 v[48:51], v4 offset:20480
    v_mfma_f32_16x16x32_bf16 v[28:31], v[52:55], a[52:55], v[28:31]
    v_mfma_f32_16x16x32_bf16 v[24:27], v[52:55], a[48:51], v[24:27]
    ds_read_b128 v[52:55], v4 offset:20736
    s_waitcnt lgkmcnt(6)
    v_mfma_f32_16x16x32_bf16 v[16:19], v[56:59], a[56:59], v[16:19]
    v_mfma_f32_16x16x32_bf16 v[20:23], v[56:59], a[60:63], v[20:23]
    ds_read_b128 v[56:59], v4 offset:22528
    v_mfma_f32_16x16x32_bf16 v[28:31], v[60:63], a[60:63], v[28:31]
    v_mfma_f32_16x16x32_bf16 v[24:27], v[60:63], a[56:59], v[24:27]
    ds_read_b128 v[60:63], v4 offset:22784
    s_waitcnt lgkmcnt(6)
    v_mfma_f32_16x16x32_bf16 v[16:19], v[32:35], a[64:67], v[16:19]
    v_mfma_f32_16x16x32_bf16 v[20:23], v[32:35], a[68:71], v[20:23]
    ds_read_b128 v[32:35], v4 offset:24576
    v_mfma_f32_16x16x32_bf16 v[28:31], v[36:39], a[68:71], v[28:31]
    v_mfma_f32_16x16x32_bf16 v[24:27], v[36:39], a[64:67], v[24:27]
    ds_read_b128 v[36:39], v4 offset:24832
    s_waitcnt lgkmcnt(6)
    v_mfma_f32_16x16x32_bf16 v[16:19], v[40:43], a[72:75], v[16:19]
    v_mfma_f32_16x16x32_bf16 v[20:23], v[40:43], a[76:79], v[20:23]
    ds_read_b128 v[40:43], v4 offset:26624
    v_mfma_f32_16x16x32_bf16 v[28:31], v[44:47], a[76:79], v[28:31]
    v_mfma_f32_16x16x32_bf16 v[24:27], v[44:47], a[72:75], v[24:27]
    ds_read_b128 v[44:47], v4 offset:26880
    s_waitcnt lgkmcnt(6)
    v_mfma_f32_16x16x32_bf16 v[16:19], v[48:51], a[80:83], v[16:19]
    v_mfma_f32_16x16x32_bf16 v[20:23], v[48:51], a[84:87], v[20:23]
    ds_read_b128 v[48:51], v4 offset:28672
    v_mfma_f32_16x16x32_bf16 v[28:31], v[52:55], a[84:87], v[28:31]
    v_mfma_f32_16x16x32_bf16 v[24:27], v[52:55], a[80:83], v[24:27]
    ds_read_b128 v[52:55], v4 offset:28928
    s_waitcnt lgkmcnt(6)
    v_mfma_f32_16x16x32_bf16 v[16:19], v[56:59], a[88:91], v[16:19]
    v_mfma_f32_16x16x32_bf16 v[20:23], v[56:59], a[92:95], v[20:23]
    ds_read_b128 v[56:59], v4 offset:30720
    v_mfma_f32_16x16x32_bf16 v[28:31], v[60:63], a[92:95], v[28:31]
    v_mfma_f32_16x16x32_bf16 v[24:27], v[60:63], a[88:91], v[24:27]
    ds_read_b128 v[60:63], v4 offset:30976
    s_waitcnt lgkmcnt(6)
    v_mfma_f32_16x16x32_bf16 v[16:19], v[32:35], a[96:99], v[16:19]
    v_mfma_f32_16x16x32_bf16 v[20:23], v[32:35], a[100:103], v[20:23]
    v_mfma_f32_16x16x32_bf16 v[28:31], v[36:39], a[100:103], v[28:31]
    v_mfma_f32_16x16x32_bf16 v[24:27], v[36:39], a[96:99], v[24:27]
    s_waitcnt lgkmcnt(4)
    v_mfma_f32_16x16x32_bf16 v[16:19], v[40:43], a[104:107], v[16:19]
    v_mfma_f32_16x16x32_bf16 v[20:23], v[40:43], a[108:111], v[20:23]
    v_mfma_f32_16x16x32_bf16 v[28:31], v[44:47], a[108:111], v[28:31]
    v_mfma_f32_16x16x32_bf16 v[24:27], v[44:47], a[104:107], v[24:27]
    s_waitcnt lgkmcnt(2)
    v_mfma_f32_16x16x32_bf16 v[16:19], v[48:51], a[112:115], v[16:19]
    v_mfma_f32_16x16x32_bf16 v[20:23], v[48:51], a[116:119], v[20:23]
    v_mfma_f32_16x16x32_bf16 v[28:31], v[52:55], a[116:119], v[28:31]
    v_mfma_f32_16x16x32_bf16 v[24:27], v[52:55], a[112:115], v[24:27]
    s_waitcnt lgkmcnt(0)
    v_mfma_f32_16x16x32_bf16 v[16:19], v[56:59], a[120:123], v[16:19]
    v_mfma_f32_16x16x32_bf16 v[20:23], v[56:59], a[124:127], v[20:23]
    v_mfma_f32_16x16x32_bf16 v[28:31], v[60:63], a[124:127], v[28:31]
    v_mfma_f32_16x16x32_bf16 v[24:27], v[60:63], a[120:123], v[24:27]
    v_xor_b32 v4, 0x10000, v4
    s_setprio 0
    s_waitcnt vmcnt(0)
    v_readfirstlane_b32 s66, v14
    s_lshl_b32 s67, s67, 1
    s_or_b32 s67, s67, 1
    s_add_u32 s60, s60, 1
    s_cmp_gt_u32 s66, s60
    s_cbranch_scc1 L_g_loop1_157
    s_barrier
    ds_read_b32 v14, v15 offset:20
    ds_read_b128 v[80:83], v5 offset:0
    ds_read_b128 v[84:87], v5 offset:1024
    ds_read_b128 v[88:91], v5 offset:2048
    ds_read_b128 v[92:95], v5 offset:3072
    s_waitcnt lgkmcnt(4)
    v_readfirstlane_b32 s66, v14
    s_barrier
    s_mov_b32 s69, 0
    s_cmp_gt_u32 s62, s60
    s_cbranch_scc1 L_g_nd_179
    s_cmp_ge_u32 s62, s66
    s_cbranch_scc1 L_g_nd_179
    s_add_u32 s47, s61, 4096
    s_add_u32 m0, s64, 0
    s_nop 0
    buffer_load_dwordx4 v3, s[12:15], s61 offen offset:0 sc1 lds
    buffer_load_dwordx4 v3, s[12:15], s61 offen offset:1024 sc1 lds
    buffer_load_dwordx4 v3, s[12:15], s61 offen offset:2048 sc1 lds
    buffer_load_dwordx4 v3, s[12:15], s61 offen offset:3072 sc1 lds
    s_add_u32 m0, s64, 4096
    s_nop 0
    buffer_load_dwordx4 v3, s[12:15], s47 offen offset:0 sc1 lds
    buffer_load_dwordx4 v3, s[12:15], s47 offen offset:1024 sc1 lds
    buffer_load_dwordx4 v3, s[12:15], s47 offen offset:2048 sc1 lds
    buffer_load_dwordx4 v3, s[12:15], s47 offen offset:3072 sc1 lds
    s_add_u32 s61, s61, s85
    s_add_u32 s62, s62, 1
    s_xor_b32 s64, s64, 0x10000
    s_mov_b32 s69, 1
L_g_nd_179:
    s_waitcnt lgkmcnt(3)
    v_add_f32 v80, v80, v16
    v_add_f32 v81, v81, v17
    v_add_f32 v82, v82, v18
    v_add_f32 v83, v83, v19
    s_waitcnt lgkmcnt(2)
    v_add_f32 v84, v84, v20
    v_add_f32 v85, v85, v21
    v_add_f32 v86, v86, v22
    v_add_f32 v87, v87, v23
    s_waitcnt lgkmcnt(1)
    v_add_f32 v88, v88, v24
    v_add_f32 v89, v89, v25
    v_add_f32 v90, v90, v26
    v_add_f32 v91, v91, v27
    s_waitcnt lgkmcnt(0)
    v_add_f32 v92, v92, v28
    v_add_f32 v93, v93, v29
    v_add_f32 v94, v94, v30
    v_add_f32 v95, v95, v31
    v_cvt_pk_bf16_f32 v104, v80, v81
    v_cvt_pk_bf16_f32 v105, v82, v83
    v_cvt_pk_bf16_f32 v106, v84, v85
    v_cvt_pk_bf16_f32 v107, v86, v87
    s_nop 1
    v_permlane16_swap_b32 v104, v106
    v_permlane16_swap_b32 v105, v107
    buffer_store_dwordx4 v[104:107], v8, s[12:15], s63 offen sc1
    v_cvt_pk_bf16_f32 v108, v88, v89
    v_cvt_pk_bf16_f32 v109, v90, v91
    v_cvt_pk_bf16_f32 v110, v92, v93
    v_cvt_pk_bf16_f32 v111, v94, v95
    s_nop 1
    v_permlane16_swap_b32 v108, v110
    v_permlane16_swap_b32 v109, v111
    buffer_store_dwordx4 v[108:111], v9, s[12:15], s63 offen sc1
    s_add_u32 s63, s63, s86
    s_mov_b32 s67, 0
    s_mov_b32 s71, 1
    s_cmp_gt_u32 s66, s60
    s_cbranch_scc1 L_g_g1r_155
    v_mov_b32 v10, 1
    s_mov_b64 exec, 1
    s_waitcnt vmcnt(0)
    ds_add_rtn_u32 v10, v15, v10 offset:4
    s_waitcnt lgkmcnt(0)
    v_readfirstlane_b32 s46, v10
    s_mov_b64 exec, -1
    s_mov_b32 s71, 0
    s_sub_u32 s59, s60, 1
    s_mul_i32 s59, s59, s78
    s_add_u32 s59, s59, s74
    s_cmp_lg_u32 s46, s68
    s_cbranch_scc1 L_g_df_180
    v_mov_b32 v10, s59
    v_add_u32 v10, 1, v10
    v_mov_b32 v11, 0
    s_mov_b64 exec, 1
    buffer_store_dword v10, v11, s[12:15], s52 offen sc1
    s_mov_b64 exec, -1
L_sf_181:
L_g_df_180:
    s_add_u32 s68, s68, 4
    s_cmp_gt_u32 s66, s60
    s_cbranch_scc1 L_g_g1r_155
L_g_tail_158:
    s_cmp_lt_u32 s60, s75
    s_cbranch_scc1 L_g_restart_153
    s_waitcnt vmcnt(0)
    s_barrier
    s_branch L_c_done_1
L_g_h1_168:
    s_add_u32 s54, s60, 1
    s_mul_i32 s55, s54, s78
    v_add_u32 v12, s55, v113
    v_and_b32 v13, 3, v12
    v_lshl_add_u32 v13, v13, 7, v7
    buffer_load_dword v11, v13, s[12:15], 0 offen sc1
    s_branch L_g_h1_168_b
L_g_h2_169:
    s_waitcnt vmcnt(0)
    v_cmp_ge_u32 vcc, v12, v11
    s_nop 0
    s_ff1_i32_b64 s46, vcc
    s_lshr_b32 s46, s46, 4
    s_min_u32 s46, s46, 4
    s_add_u32 s46, s46, s54
    s_min_u32 s46, s46, s75
    v_mov_b32 v118, s46
    s_branch L_g_h2_169_b
L_g_dp_170_l:
    s_cmp_ge_u32 s62, s66
    s_cbranch_scc1 L_g_dp_170_d
    s_mov_b32 s65, 1
    s_add_u32 s47, s61, 4096
    s_mov_b32 m0, s64
    s_add_u32 s62, s62, 1
    buffer_load_dwordx4 v3, s[12:15], s61 offen offset:0 sc1 lds
    buffer_load_dwordx4 v3, s[12:15], s61 offen offset:1024 sc1 lds
    buffer_load_dwordx4 v3, s[12:15], s61 offen offset:2048 sc1 lds
    buffer_load_dwordx4 v3, s[12:15], s61 offen offset:3072 sc1 lds
    s_add_u32 m0, s64, 4096
    s_add_u32 s61, s61, s85
    buffer_load_dwordx4 v3, s[12:15], s47 offen offset:0 sc1 lds
    buffer_load_dwordx4 v3, s[12:15], s47 offen offset:1024 sc1 lds
    buffer_load_dwordx4 v3, s[12:15], s47 offen offset:2048 sc1 lds
    buffer_load_dwordx4 v3, s[12:15], s47 offen offset:3072 sc1 lds
    s_xor_b32 s64, s64, 0x10000
    s_branch L_g_dp_170_a
L_g_nw_166:
    s_waitcnt vmcnt(0) lgkmcnt(0)
    s_cmp_lg_u32 s44, 0
    s_cbranch_scc1 L_g_nl_182
    s_cmp_lt_u32 s66, s75
    s_cselect_b32 s81, 1, 2
L_g_nl_182:
    s_branch L_g_loop0_156_l
L_g_nfl_173:
    s_cmp_eq_u32 s71, 0
    s_cbranch_scc1 L_g_nfl_173_d
    v_mov_b32 v10, 1
    s_mov_b64 exec, 1
    s_waitcnt vmcnt(0)
    ds_add_rtn_u32 v10, v15, v10 offset:4
    s_waitcnt lgkmcnt(0)
    v_readfirstlane_b32 s46, v10
    s_mov_b64 exec, -1
    s_mov_b32 s71, 0
    s_sub_u32 s59, s60, 1
    s_mul_i32 s59, s59, s78
    s_add_u32 s59, s59, s74
    s_cmp_lg_u32 s46, s68
    s_cbranch_scc1 L_g_df_183
    v_mov_b32 v10, s59
    v_add_u32 v10, 1, v10
    v_mov_b32 v11, 0
    s_mov_b64 exec, 1
    buffer_store_dword v10, v11, s[12:15], s52 offen sc1
    s_mov_b64 exec, -1
L_sf_184:
L_g_df_183:
    s_add_u32 s68, s68, 4
    s_mov_b32 s65, 2
    s_branch L_g_nfl_173_d
L_g_dp_178_l:
    s_cmp_ge_u32 s62, s66
    s_cbranch_scc1 L_g_dp_178_d
    s_or_b32 s65, s65, 1
    s_add_u32 s47, s61, 4096
    s_mov_b32 m0, s64
    s_add_u32 s62, s62, 1
    buffer_load_dwordx4 v3, s[12:15], s61 offen offset:0 sc1 lds
    buffer_load_dwordx4 v3, s[12:15], s61 offen offset:1024 sc1 lds
    buffer_load_dwordx4 v3, s[12:15], s61 offen offset:2048 sc1 lds
    buffer_load_dwordx4 v3, s[12:15], s61 offen offset:3072 sc1 lds
    s_add_u32 m0, s64, 4096
    s_add_u32 s61, s61, s85
    buffer_load_dwordx4 v3, s[12:15], s47 offen offset:0 sc1 lds
    buffer_load_dwordx4 v3, s[12:15], s47 offen offset:1024 sc1 lds
    buffer_load_dwordx4 v3, s[12:15], s47 offen offset:2048 sc1 lds
    buffer_load_dwordx4 v3, s[12:15], s47 offen offset:3072 sc1 lds
    s_xor_b32 s64, s64, 0x10000
    s_branch L_g_dp_178_a
L_g_nw1_175:
    s_cmp_eq_u32 s65, 2
    s_cbranch_scc1 L_g_nw1_175_w
    s_waitcnt vmcnt(0)
L_g_nw1_175_w:
    s_barrier
    ds_read_b128 v[32:35], v4 offset:0
    ds_read_b128 v[36:39], v4 offset:256
    ds_read_b128 v[40:43], v4 offset:2048
    ds_read_b128 v[44:47], v4 offset:2304
    ds_read_b128 v[48:51], v4 offset:4096
    ds_read_b128 v[52:55], v4 offset:4352
    ds_read_b128 v[56:59], v4 offset:6144
    ds_read_b128 v[60:63], v4 offset:6400
    s_branch L_g_jn_177
L_c_chain_9:
    v_mov_b32 v4, 0
    v_mov_b32 v5, 0
    v_mov_b32 v6, 0
    v_mov_b32 v7, 0
    v_mov_b32 v8, 0
    v_mov_b32 v9, 0
    v_mov_b32 v10, 0
    v_mov_b32 v11, 0
    v_mov_b32 v12, 0
    v_mov_b32 v13, 0
    v_mov_b32 v14, 0
    v_mov_b32 v15, 0
    v_mov_b32 v32, -1
    v_mov_b32 v33, -1
    v_mov_b32 v34, -1
    v_mov_b32 v35, -1
    v_lshlrev_b32 v2, 4, v1
    s_lshl_b32 s45, s40, 16
    s_lshl_b32 s46, s41, 12
    s_add_u32 s45, s45, s46
    s_and_b32 s46, s44, 3
    s_lshl_b32 s46, s46, 10
    s_add_u32 s45, s45, s46
    s_lshr_b32 s46, s44, 2
    s_lshl_b32 s46, s46, 19
    s_add_u32 s45, s45, s46
    s_add_u32 s45, s45, 0x7000000
    buffer_store_dwordx4 v[32:35], v2, s[12:15], s45 offen sc1
    s_lshl_b32 s45, s40, 15
    s_lshl_b32 s46, s41, 11
    s_add_u32 s45, s45, s46
    s_lshl_b32 s46, s44, 8
    s_add_u32 s45, s45, s46
    s_add_u32 s45, s45, 0x7100000
    s_mov_b64 exec, 0xffff
    buffer_store_dwordx4 v[32:35], v2, s[12:15], s45 offen sc1
    s_lshl_b32 s45, s40, 16
    s_lshl_b32 s46, s41, 8
    s_add_u32 s45, s45, s46
    s_and_b32 s46, s44, 3
    s_lshl_b32 s46, s46, 14
    s_add_u32 s45, s45, s46
    s_add_u32 s45, s45, 0x7180000
    buffer_store_dwordx4 v[32:35], v2, s[12:15], s45 offen sc1
    s_mov_b64 exec, -1
    s_and_b32 s47, s44, 3
    s_cmp_eq_u32 s47, 3
    s_cbranch_scc1 L_c_t3_185
    s_cmp_eq_u32 s40, 7
    s_cselect_b32 s46, 8, 4
    s_cmp_ge_u32 s44, s46
    s_cbranch_scc1 L_c_t3_185
    s_lshl_b32 s46, s47, 3
    s_add_u32 s46, s46, 16
    s_load_dwordx2 s[4:5], s[0:1], s46
    v_lshlrev_b32 v2, 13, v1
    s_lshl_b32 s45, s41, 19
    s_lshl_b32 s46, s40, 10
    s_add_u32 s45, s45, s46
    s_add_u32 s45, s45, 384
    s_lshr_b32 s46, s44, 2
    s_lshl_b32 s46, s46, 9
    s_add_u32 s45, s45, s46
    s_waitcnt lgkmcnt(0)
    s_mov_b32 s24, s4
    s_and_b32 s25, s5, 0xffff
    s_mov_b32 s26, 0x800000
    s_mov_b32 s27, 0x00020000
    buffer_load_dword v110, v2, s[24:27], s45 offen
L_c_t3_185:
    s_cmp_lg_u32 s44, 3
    s_cbranch_scc1 L_c_t3_185_o
    s_load_dwordx2 s[4:5], s[0:1], 40
    v_lshlrev_b32 v2, 10, v1
    s_lshl_b32 s45, s40, 20
    s_lshl_b32 s46, s41, 16
    s_add_u32 s45, s45, s46
    s_add_u32 s45, s45, 384
    s_waitcnt lgkmcnt(0)
    s_mov_b32 s24, s4
    s_and_b32 s25, s5, 0xffff
    s_mov_b32 s26, 0x800000
    s_mov_b32 s27, 0x00020000
    buffer_load_dword v110, v2, s[24:27], s45 offen
L_c_t3_185_o:
    v_lshlrev_b32 v2, 4, v1
    v_and_b32 v3, 8, v1
    v_cmp_eq_u32 vcc, 0, v3
    v_mov_b32 v3, 0xeeeeeeee
    v_mov_b32 v4, 0x44444444
    v_cndmask_b32 v3, v3, v4, vcc
    v_and_b32 v100, 15, v1
    v_lshrrev_b32 v101, 4, v1
    v_and_b32 v102, 1, v101
    v_lshrrev_b32 v103, 1, v101
    v_lshlrev_b32 v104, 2, v102
    v_lshl_add_u32 v104, v103, 1, v104
    v_and_b32 v105, 1, v1
    v_add_u32 v104, v104, v105
    v_and_b32 v106, 7, v1
    v_bfe_u32 v107, v1, 3, 1
    s_lshr_b32 s42, s41, 2
    s_and_b32 s43, s41, 3
    s_lshl_b32 s49, s40, 2
    s_add_u32 s49, s49, s42
    s_lshl_b32 s45, s44, 14
    v_lshlrev_b32 v22, 3, v101
    v_bfe_u32 v23, v1, 2, 2
    v_add_u32 v22, v22, v23
    v_and_b32 v23, 3, v1
    v_lshlrev_b32 v24, 3, v23
    v_lshl_add_u32 v20, v22, 6, v24
    v_lshl_add_u32 v21, v22, 7, v24
    v_lshrrev_b32 v22, 2, v1
    v_lshlrev_b32 v23, 4, v23
    v_lshl_add_u32 v24, v22, 13, v23
    v_lshrrev_b32 v22, 3, v1
    v_lshlrev_b32 v23, 4, v106
    v_lshl_add_u32 v25, v22, 11, v23
    s_cmp_ge_u32 s44, 4
    s_cbranch_scc1 L_v_init_186
    s_lshr_b32 s50, s44, 1
    s_and_b32 s51, s44, 1
    s_load_dwordx4 s[4:7], s[0:1], 16
    s_lshl_b32 s46, s49, 8
    s_lshl_b32 s48, s43, 6
    s_add_u32 s46, s46, s48
    s_lshl_b32 s48, s44, 21
    s_add_u32 s46, s46, s48
    s_lshl_b32 s52, s51, 5
    s_xor_b32 s53, s50, 1
    s_lshl_b32 s53, s53, 16
    s_add_u32 s52, s52, s53
    v_add_u32 v20, s52, v20
    s_waitcnt lgkmcnt(0)
    s_mov_b32 s24, s6
    s_and_b32 s25, s7, 0xffff
    s_mov_b32 s26, 0x800000
    s_mov_b32 s27, 0x00020000
    s_mov_b32 s28, s4
    s_and_b32 s29, s5, 0xffff
    s_mov_b32 s30, 0x800000
    s_mov_b32 s31, 0x00020000
    s_lshl_b32 s52, s51, 9
    s_lshl_b32 s53, s50, 7
    s_add_u32 s52, s52, s53
    s_add_u32 s52, s52, 61440
    v_lshlrev_b32 v5, 1, v106
    v_lshl_add_u32 v5, v107, 8, v5
    v_lshl_add_u32 v5, v102, 6, v5
    v_lshl_add_u32 v5, v103, 5, v5
    v_add_u32 v5, s52, v5
    s_lshl_b32 s67, s49, 12
    s_lshl_b32 s53, s43, 10
    s_add_u32 s67, s67, s53
    s_add_u32 s67, s67, 0x1000000
    s_lshl_b32 s52, s40, 16
    s_lshl_b32 s53, s44, 11
    s_add_u32 s53, s52, s53
    s_add_u32 s53, s53, 0x7080000
    v_lshlrev_b32 v7, 3, v1
    v_add_u32 v7, s53, v7
    s_lshl_b32 s53, s44, 9
    s_add_u32 s53, s52, s53
    s_add_u32 s53, s53, 0x7180000
    v_lshlrev_b32 v28, 6, v103
    v_lshl_add_u32 v28, v106, 3, v28
    v_lshl_add_u32 v28, v102, 2, v28
    v_lshl_add_u32 v28, v107, 1, v28
    v_add_u32 v28, s53, v28
    s_lshl_b32 s52, s44, 10
    s_add_u32 s52, s52, 16384
    v_lshlrev_b32 v8, 8, v101
    v_lshl_add_u32 v8, v106, 4, v8
    v_lshl_add_u32 v8, v107, 3, v8
    v_add_u32 v8, s52, v8
    s_lshl_b32 s52, s44, 8
    s_add_u32 s52, s52, 20480
    v_lshlrev_b32 v9, 4, v106
    v_lshl_add_u32 v9, v101, 2, v9
    v_lshl_add_u32 v9, v107, 1, v9
    v_add_u32 v9, s52, v9
    s_mov_b32 s66, 0x3e0293ee
    s_xor_b32 s52, s44, 2
    s_xor_b32 s53, s41, 6
    s_or_b32 s52, s52, s53
    s_cbranch_scc1 L_c_join_187_q
    s_lshl_b32 s52, s40, 21
    s_add_u32 s52, s52, 0x79c0000
    v_and_b32 v10, 31, v1
    v_lshlrev_b32 v10, 4, v10
    v_lshl_add_u32 v10, v103, 13, v10
    buffer_store_dwordx4 v[32:35], v10, s[12:15], s52 offen sc1
    s_add_u32 s52, s52, 0x1000
    s_load_dword s47, s[22:23], s52
L_c_join_187_q:
    s_add_u32 m0, s45, 0
    s_add_u32 s48, s46, 0x0
    buffer_load_dwordx4 v24, s[24:27], s48 offen  lds
    s_add_u32 m0, s45, 1024
    s_add_u32 s48, s46, 0x20000
    buffer_load_dwordx4 v24, s[24:27], s48 offen  lds
    s_add_u32 m0, s45, 2048
    s_add_u32 s48, s46, 0x40000
    buffer_load_dwordx4 v24, s[24:27], s48 offen  lds
    s_add_u32 m0, s45, 3072
    s_add_u32 s48, s46, 0x60000
    buffer_load_dwordx4 v24, s[24:27], s48 offen  lds
    s_add_u32 m0, s45, 4096
    s_add_u32 s48, s46, 0x80000
    buffer_load_dwordx4 v24, s[24:27], s48 offen  lds
    s_add_u32 m0, s45, 5120
    s_add_u32 s48, s46, 0xa0000
    buffer_load_dwordx4 v24, s[24:27], s48 offen  lds
    s_add_u32 m0, s45, 6144
    s_add_u32 s48, s46, 0xc0000
    buffer_load_dwordx4 v24, s[24:27], s48 offen  lds
    s_add_u32 m0, s45, 7168
    s_add_u32 s48, s46, 0xe0000
    buffer_load_dwordx4 v24, s[24:27], s48 offen  lds
    s_add_u32 m0, s45, 8192
    s_add_u32 s48, s46, 0x100000
    buffer_load_dwordx4 v24, s[24:27], s48 offen  lds
    s_add_u32 m0, s45, 9216
    s_add_u32 s48, s46, 0x120000
    buffer_load_dwordx4 v24, s[24:27], s48 offen  lds
    s_add_u32 m0, s45, 10240
    s_add_u32 s48, s46, 0x140000
    buffer_load_dwordx4 v24, s[24:27], s48 offen  lds
    s_add_u32 m0, s45, 11264
    s_add_u32 s48, s46, 0x160000
    buffer_load_dwordx4 v24, s[24:27], s48 offen  lds
    s_add_u32 m0, s45, 12288
    s_add_u32 s48, s46, 0x180000
    buffer_load_dwordx4 v24, s[24:27], s48 offen  lds
    s_add_u32 m0, s45, 13312
    s_add_u32 s48, s46, 0x1a0000
    buffer_load_dwordx4 v24, s[24:27], s48 offen  lds
    s_add_u32 m0, s45, 14336
    s_add_u32 s48, s46, 0x1c0000
    buffer_load_dwordx4 v24, s[24:27], s48 offen  lds
    s_add_u32 m0, s45, 15360
    s_add_u32 s48, s46, 0x1e0000
    buffer_load_dwordx4 v24, s[24:27], s48 offen  lds
    s_add_u32 s45, s45, 0x10000
    s_add_u32 m0, s45, 0
    s_add_u32 s48, s46, 0x0
    buffer_load_dwordx4 v24, s[28:31], s48 offen  lds
    s_add_u32 m0, s45, 1024
    s_add_u32 s48, s46, 0x20000
    buffer_load_dwordx4 v24, s[28:31], s48 offen  lds
    s_add_u32 m0, s45, 2048
    s_add_u32 s48, s46, 0x40000
    buffer_load_dwordx4 v24, s[28:31], s48 offen  lds
    s_add_u32 m0, s45, 3072
    s_add_u32 s48, s46, 0x60000
    buffer_load_dwordx4 v24, s[28:31], s48 offen  lds
    s_add_u32 m0, s45, 4096
    s_add_u32 s48, s46, 0x80000
    buffer_load_dwordx4 v24, s[28:31], s48 offen  lds
    s_add_u32 m0, s45, 5120
    s_add_u32 s48, s46, 0xa0000
    buffer_load_dwordx4 v24, s[28:31], s48 offen  lds
    s_add_u32 m0, s45, 6144
    s_add_u32 s48, s46, 0xc0000
    buffer_load_dwordx4 v24, s[28:31], s48 offen  lds
    s_add_u32 m0, s45, 7168
    s_add_u32 s48, s46, 0xe0000
    buffer_load_dwordx4 v24, s[28:31], s48 offen  lds
    s_add_u32 m0, s45, 8192
    s_add_u32 s48, s46, 0x100000
    buffer_load_dwordx4 v24, s[28:31], s48 offen  lds
    s_add_u32 m0, s45, 9216
    s_add_u32 s48, s46, 0x120000
    buffer_load_dwordx4 v24, s[28:31], s48 offen  lds
    s_add_u32 m0, s45, 10240
    s_add_u32 s48, s46, 0x140000
    buffer_load_dwordx4 v24, s[28:31], s48 offen  lds
    s_add_u32 m0, s45, 11264
    s_add_u32 s48, s46, 0x160000
    buffer_load_dwordx4 v24, s[28:31], s48 offen  lds
    s_add_u32 m0, s45, 12288
    s_add_u32 s48, s46, 0x180000
    buffer_load_dwordx4 v24, s[28:31], s48 offen  lds
    s_add_u32 m0, s45, 13312
    s_add_u32 s48, s46, 0x1a0000
    buffer_load_dwordx4 v24, s[28:31], s48 offen  lds
    s_add_u32 m0, s45, 14336
    s_add_u32 s48, s46, 0x1c0000
    buffer_load_dwordx4 v24, s[28:31], s48 offen  lds
    s_add_u32 m0, s45, 15360
    s_add_u32 s48, s46, 0x1e0000
    buffer_load_dwordx4 v24, s[28:31], s48 offen  lds
    s_add_u32 s45, s45, 0x10000
    s_waitcnt vmcnt(0)
    s_barrier
    s_cmp_lg_u32 s44, 0
    s_cbranch_scc1 L_zwok_189
    v_and_b32 v16, 7, v1
    v_lshlrev_b32 v16, 5, v16
    s_mov_b32 s70, 0
L_zw_188:
    buffer_load_dword v17, v16, s[16:19], 0 offen sc1
    s_waitcnt vmcnt(0)
    v_add_u32_dpp v17, v17, v17 row_ror:1 row_mask:0xf bank_mask:0xf
    s_nop 1
    v_add_u32_dpp v17, v17, v17 row_ror:2 row_mask:0xf bank_mask:0xf
    s_nop 1
    v_add_u32_dpp v17, v17, v17 row_ror:4 row_mask:0xf bank_mask:0xf
    v_cmp_ne_u32 vcc, 0x100, v17
    s_add_u32 s70, s70, 1
    s_cbranch_vccz L_zwok_189
    s_sleep 4
    s_cmp_lt_u32 s70, 524288
    s_cbranch_scc1 L_zw_188
    s_branch L_c_done_1
L_zwok_189:
    s_cmp_lg_u32 s44, 0
    s_cbranch_scc1 L_c_nr_190
    s_or_b32 s47, s39, 0x100
    v_mov_b32 v16, s47
    s_lshl_b32 s52, s40, 6
    s_lshl_b32 s53, s41, 2
    s_add_u32 s52, s52, s53
    s_add_u32 s52, s52, 0x101000
    v_mov_b32 v17, 0
    s_mov_b64 exec, 1
    buffer_store_dword v16, v17, s[12:15], s52 offen sc1
    s_mov_b64 exec, -1
L_c_nr_190:
    ds_read_b64_tr_b16 a[0:1], v20 offset:0
    ds_read_b64_tr_b16 a[2:3], v20 offset:256
    ds_read_b64_tr_b16 a[4:5], v20 offset:2048
    ds_read_b64_tr_b16 a[6:7], v20 offset:2304
    ds_read_b64_tr_b16 a[8:9], v20 offset:4096
    ds_read_b64_tr_b16 a[10:11], v20 offset:4352
    ds_read_b64_tr_b16 a[12:13], v20 offset:6144
    ds_read_b64_tr_b16 a[14:15], v20 offset:6400
    s_waitcnt lgkmcnt(0)
    ds_read_b64_tr_b16 a[16:17], v20 offset:8192
    ds_read_b64_tr_b16 a[18:19], v20 offset:8448
    ds_read_b64_tr_b16 a[20:21], v20 offset:10240
    ds_read_b64_tr_b16 a[22:23], v20 offset:10496
    ds_read_b64_tr_b16 a[24:25], v20 offset:12288
    ds_read_b64_tr_b16 a[26:27], v20 offset:12544
    ds_read_b64_tr_b16 a[28:29], v20 offset:14336
    ds_read_b64_tr_b16 a[30:31], v20 offset:14592
    s_waitcnt lgkmcnt(0)
    ds_read_b64_tr_b16 a[32:33], v20 offset:16384
    ds_read_b64_tr_b16 a[34:35], v20 offset:16640
    ds_read_b64_tr_b16 a[36:37], v20 offset:18432
    ds_read_b64_tr_b16 a[38:39], v20 offset:18688
    ds_read_b64_tr_b16 a[40:41], v20 offset:20480
    ds_read_b64_tr_b16 a[42:43], v20 offset:20736
    ds_read_b64_tr_b16 a[44:45], v20 offset:22528
    ds_read_b64_tr_b16 a[46:47], v20 offset:22784
    s_waitcnt lgkmcnt(0)
    ds_read_b64_tr_b16 a[48:49], v20 offset:24576
    ds_read_b64_tr_b16 a[50:51], v20 offset:24832
    ds_read_b64_tr_b16 a[52:53], v20 offset:26624
    ds_read_b64_tr_b16 a[54:55], v20 offset:26880
    ds_read_b64_tr_b16 a[56:57], v20 offset:28672
    ds_read_b64_tr_b16 a[58:59], v20 offset:28928
    ds_read_b64_tr_b16 a[60:61], v20 offset:30720
    ds_read_b64_tr_b16 a[62:63], v20 offset:30976
    s_waitcnt lgkmcnt(0)
    ds_read_b64_tr_b16 a[64:65], v20 offset:32768
    ds_read_b64_tr_b16 a[66:67], v20 offset:33024
    ds_read_b64_tr_b16 a[68:69], v20 offset:34816
    ds_read_b64_tr_b16 a[70:71], v20 offset:35072
    ds_read_b64_tr_b16 a[72:73], v20 offset:36864
    ds_read_b64_tr_b16 a[74:75], v20 offset:37120
    ds_read_b64_tr_b16 a[76:77], v20 offset:38912
    ds_read_b64_tr_b16 a[78:79], v20 offset:39168
    s_waitcnt lgkmcnt(0)
    ds_read_b64_tr_b16 a[80:81], v20 offset:40960
    ds_read_b64_tr_b16 a[82:83], v20 offset:41216
    ds_read_b64_tr_b16 a[84:85], v20 offset:43008
    ds_read_b64_tr_b16 a[86:87], v20 offset:43264
    ds_read_b64_tr_b16 a[88:89], v20 offset:45056
    ds_read_b64_tr_b16 a[90:91], v20 offset:45312
    ds_read_b64_tr_b16 a[92:93], v20 offset:47104
    ds_read_b64_tr_b16 a[94:95], v20 offset:47360
    s_waitcnt lgkmcnt(0)
    ds_read_b64_tr_b16 a[96:97], v20 offset:49152
    ds_read_b64_tr_b16 a[98:99], v20 offset:49408
    ds_read_b64_tr_b16 a[100:101], v20 offset:51200
    ds_read_b64_tr_b16 a[102:103], v20 offset:51456
    ds_read_b64_tr_b16 a[104:105], v20 offset:53248
    ds_read_b64_tr_b16 a[106:107], v20 offset:53504
    ds_read_b64_tr_b16 a[108:109], v20 offset:55296
    ds_read_b64_tr_b16 a[110:111], v20 offset:55552
    s_waitcnt lgkmcnt(0)
    ds_read_b64_tr_b16 a[112:113], v20 offset:57344
    ds_read_b64_tr_b16 a[114:115], v20 offset:57600
    ds_read_b64_tr_b16 a[116:117], v20 offset:59392
    ds_read_b64_tr_b16 a[118:119], v20 offset:59648
    ds_read_b64_tr_b16 a[120:121], v20 offset:61440
    ds_read_b64_tr_b16 a[122:123], v20 offset:61696
    ds_read_b64_tr_b16 a[124:125], v20 offset:63488
    ds_read_b64_tr_b16 a[126:127], v20 offset:63744
    s_waitcnt lgkmcnt(0)
    s_mov_b32 s63, 0
    s_barrier
    s_lshl_b32 s52, s40, 2
    s_add_u32 s52, s52, s44
    s_mul_i32 s52, s52, 24576
    s_lshl_b32 s53, s41, 9
    s_add_u32 s52, s52, s53
    s_add_u32 s52, s52, 0x2004000
    v_and_b32 v14, 3, v1
    v_lshlrev_b32 v14, 7, v14
    v_add_u32 v14, s52, v14
    s_lshl_b32 s52, s40, 16
    s_lshl_b32 s53, s41, 9
    s_add_u32 s53, s53, s52
    s_lshl_b32 s54, s44, 6
    s_add_u32 s53, s53, s54
    s_add_u32 s53, s53, 0x7080000
    v_lshlrev_b32 v4, 3, v106
    v_lshl_add_u32 v10, v102, 6, v4
    v_lshl_add_u32 v4, v101, 7, v4
    v_add_u32 v4, s53, v4
    v_mov_b32 v54, 0xfffefffe
    v_mov_b32 v56, 0
    v_mov_b32 v57, 0
    v_mov_b32 v58, 0
    v_mov_b32 v59, 0
    s_lshl_b32 s53, s41, 7
    s_add_u32 s53, s53, s52
    s_add_u32 s53, s53, 0x7180000
    v_add_u32 v10, s53, v10
    s_cmp_ge_u32 s44, 2
    s_cselect_b64 vcc, -1, 0
    v_cndmask_b32 v4, v4, v10, vcc
    s_mul_i32 s52, s49, 24576
    s_lshl_b32 s53, s44, 12
    s_add_u32 s52, s52, s53
    s_lshl_b32 s53, s43, 10
    s_add_u32 s52, s52, s53
    s_add_u32 s52, s52, 0x2002000
    v_add_u32 v6, s52, v2
    v_lshrrev_b32 v10, 3, v1
    v_lshlrev_b32 v10, 8, v10
    v_lshl_add_u32 v10, v106, 4, v10
    v_add_u32 v10, 61568, v10
    v_add_u32 v11, 27648, v2
    v_cmp_gt_u32 s[52:53], 32, v1
    s_nop 1
    v_cndmask_b32 v10, v11, v10, s[52:53]
    v_cndmask_b32 v6, v6, v10, vcc
    v_mov_b32 v24, -1
    v_mov_b32 v25, -1
    v_mov_b32 v26, -1
    v_mov_b32 v27, -1
    s_and_b32 s52, s40, 1
    s_lshl_b32 s52, s52, 14
    s_lshl_b32 s53, s41, 10
    s_add_u32 s52, s52, s53
    s_lshl_b32 s53, s50, 9
    s_add_u32 s52, s52, s53
    s_lshl_b32 s53, s51, 7
    s_add_u32 s52, s52, s53
    s_add_u32 s52, s52, 0x7a0000
    v_mov_b32 v46, s52
    v_add_u32 v44, 65536, v2
    s_lshl_b32 s52, s50, 10
    s_add_u32 s52, s52, 62464
    v_add_u32 v31, s52, v2
    s_lshl_b32 s53, s51, 9
    s_add_u32 s52, s52, s53
    v_lshlrev_b32 v45, 4, v100
    v_lshl_add_u32 v45, v103, 8, v45
    v_lshl_add_u32 v45, v102, 3, v45
    v_add_u32 v45, s52, v45
    s_mul_i32 s52, s49, 24576
    s_lshl_b32 s53, s50, 13
    s_add_u32 s52, s52, s53
    s_lshl_b32 s53, s43, 10
    s_add_u32 s52, s52, s53
    s_add_u32 s52, s52, 0x4b80000
    v_add_u32 v13, s52, v2
    v_mov_b32 v29, 26644
    v_mov_b32 v30, 0
    ds_write_b32 v29, v30
    v_mov_b32 v30, 1
    s_lshl_b32 s58, s40, 11
    s_lshl_b32 s53, s44, 7
    s_add_u32 s58, s58, s53
    s_add_u32 s58, s58, 0x10a600
    s_mov_b32 s69, 0
    v_mov_b32 v0, 0
    s_cmp_ge_u32 s44, 2
    s_cselect_b32 s50, 0, 0x00ff00ff
    s_mov_b32 s51, 0x00ff00ff
    s_xor_b32 s45, s44, 2
    s_xor_b32 s46, s41, 6
    s_or_b32 s45, s45, s46
    s_cbranch_scc1 L_c_join_187_p
    s_lshl_b32 s45, s40, 21
    s_add_u32 s45, s45, 0x79c0000
    s_mov_b32 s60, -1
    s_mov_b32 s61, -1
    s_waitcnt vmcnt(0) lgkmcnt(0)
    s_add_u32 s46, s45, 0
    s_memtime s[84:85]
    s_waitcnt lgkmcnt(0)
    s_load_dword s47, s[22:23], s46
    s_waitcnt lgkmcnt(0)
    s_memtime s[86:87]
    s_waitcnt lgkmcnt(0)
    s_sub_u32 s86, s86, s84
    s_min_u32 s60, s60, s86
    s_add_u32 s46, s45, 8192
    s_memtime s[84:85]
    s_waitcnt lgkmcnt(0)
    s_load_dword s47, s[22:23], s46
    s_waitcnt lgkmcnt(0)
    s_memtime s[86:87]
    s_waitcnt lgkmcnt(0)
    s_sub_u32 s86, s86, s84
    s_min_u32 s61, s61, s86
    s_add_u32 s46, s45, 128
    s_memtime s[84:85]
    s_waitcnt lgkmcnt(0)
    s_load_dword s47, s[22:23], s46
    s_waitcnt lgkmcnt(0)
    s_memtime s[86:87]
    s_waitcnt lgkmcnt(0)
    s_sub_u32 s86, s86, s84
    s_min_u32 s60, s60, s86
    s_add_u32 s46, s45, 8320
    s_memtime s[84:85]
    s_waitcnt lgkmcnt(0)
    s_load_dword s47, s[22:23], s46
    s_waitcnt lgkmcnt(0)
    s_memtime s[86:87]
    s_waitcnt lgkmcnt(0)
    s_sub_u32 s86, s86, s84
    s_min_u32 s61, s61, s86
    s_add_u32 s46, s45, 256
    s_memtime s[84:85]
    s_waitcnt lgkmcnt(0)
    s_load_dword s47, s[22:23], s46
    s_waitcnt lgkmcnt(0)
    s_memtime s[86:87]
    s_waitcnt lgkmcnt(0)
    s_sub_u32 s86, s86, s84
    s_min_u32 s60, s60, s86
    s_add_u32 s46, s45, 8448
    s_memtime s[84:85]
    s_waitcnt lgkmcnt(0)
    s_load_dword s47, s[22:23], s46
    s_waitcnt lgkmcnt(0)
    s_memtime s[86:87]
    s_waitcnt lgkmcnt(0)
    s_sub_u32 s86, s86, s84
    s_min_u32 s61, s61, s86
    s_cmp_gt_u32 s60, s61
    s_cselect_b32 s45, 3, 2
    v_mov_b32 v10, s45
    v_mov_b32 v11, 0
    s_lshl_b32 s45, s40, 7
    s_add_u32 s45, s45, 0x101800
    s_mov_b64 exec, 1
    buffer_store_dword v10, v11, s[12:15], s45 offen sc1
    s_mov_b64 exec, -1
L_c_join_187_p:
    s_setprio 1
    s_branch L_c_join_187
L_v_init_186:
    s_sub_u32 s54, s44, 4
    s_lshr_b32 s51, s54, 1
    s_and_b32 s50, s54, 1
    s_load_dwordx4 s[4:7], s[0:1], 32
    s_load_dwordx2 s[8:9], s[0:1], 8
    s_waitcnt lgkmcnt(0)
    s_mov_b32 s24, s4
    s_and_b32 s25, s5, 0xffff
    s_mov_b32 s26, 0x800000
    s_mov_b32 s27, 0x00020000
    s_mov_b32 s28, s6
    s_and_b32 s29, s7, 0xffff
    s_mov_b32 s30, 0x800000
    s_mov_b32 s31, 0x00020000
    s_mov_b32 s32, s8
    s_and_b32 s33, s9, 0xffff
    s_mov_b32 s34, 0x4000
    s_mov_b32 s35, 0x00020000
    s_lshl_b32 s45, s54, 12
    s_add_u32 s45, s45, 0x20000
    v_add_u32 v20, s45, v20
    v_add_u32 v21, s45, v21
    v_add_u32 v22, s45, v2
    s_lshl_b32 s46, s49, 8
    s_lshl_b32 s48, s43, 6
    s_add_u32 s46, s46, s48
    s_lshl_b32 s48, s54, 21
    s_add_u32 s46, s46, s48
    s_add_u32 s48, s46, 0x0
    buffer_load_dwordx4 a[0:3], v24, s[24:27], s48 offen
    s_add_u32 s48, s46, 0x20000
    buffer_load_dwordx4 a[32:35], v24, s[24:27], s48 offen
    s_add_u32 s48, s46, 0x40000
    buffer_load_dwordx4 a[4:7], v24, s[24:27], s48 offen
    s_add_u32 s48, s46, 0x60000
    buffer_load_dwordx4 a[36:39], v24, s[24:27], s48 offen
    s_add_u32 s48, s46, 0x80000
    buffer_load_dwordx4 a[8:11], v24, s[24:27], s48 offen
    s_add_u32 s48, s46, 0xa0000
    buffer_load_dwordx4 a[40:43], v24, s[24:27], s48 offen
    s_add_u32 s48, s46, 0xc0000
    buffer_load_dwordx4 a[12:15], v24, s[24:27], s48 offen
    s_add_u32 s48, s46, 0xe0000
    buffer_load_dwordx4 a[44:47], v24, s[24:27], s48 offen
    s_add_u32 s48, s46, 0x100000
    buffer_load_dwordx4 a[16:19], v24, s[24:27], s48 offen
    s_add_u32 s48, s46, 0x120000
    buffer_load_dwordx4 a[48:51], v24, s[24:27], s48 offen
    s_add_u32 s48, s46, 0x140000
    buffer_load_dwordx4 a[20:23], v24, s[24:27], s48 offen
    s_add_u32 s48, s46, 0x160000
    buffer_load_dwordx4 a[52:55], v24, s[24:27], s48 offen
    s_add_u32 s48, s46, 0x180000
    buffer_load_dwordx4 a[24:27], v24, s[24:27], s48 offen
    s_add_u32 s48, s46, 0x1a0000
    buffer_load_dwordx4 a[56:59], v24, s[24:27], s48 offen
    s_add_u32 s48, s46, 0x1c0000
    buffer_load_dwordx4 a[28:31], v24, s[24:27], s48 offen
    s_add_u32 s48, s46, 0x1e0000
    buffer_load_dwordx4 a[60:63], v24, s[24:27], s48 offen
    s_lshl_b32 s52, s40, 15
    s_lshl_b32 s53, s42, 11
    s_add_u32 s52, s52, s53
    s_lshl_b32 s53, s43, 9
    s_add_u32 s52, s52, s53
    s_lshl_b32 s53, s51, 8
    s_add_u32 s52, s52, s53
    s_add_u32 s52, s52, 0x7100000
    v_bfe_u32 v4, v1, 1, 1
    v_lshlrev_b32 v4, 7, v4
    v_lshl_add_u32 v4, v104, 4, v4
    v_and_b32 v5, 12, v100
    v_add_u32 v4, v4, v5
    v_add_u32 v4, s52, v4
    v_mov_b32 v26, -1
    s_lshl_b32 s52, s51, 5
    s_add_u32 s52, s52, 28160
    v_and_b32 v5, 14, v100
    v_lshlrev_b32 v5, 1, v5
    v_lshl_add_u32 v5, v104, 6, v5
    v_add_u32 v5, s52, v5
    s_lshl_b32 s52, s41, 14
    s_lshl_b32 s53, s54, 11
    s_add_u32 s52, s52, s53
    s_add_u32 s52, s52, 0x7800000
    v_lshlrev_b32 v6, 3, v101
    v_lshl_add_u32 v6, v106, 5, v6
    v_and_b32 v7, 3, v1
    v_lshlrev_b32 v7, 3, v7
    v_bfe_u32 v30, v1, 2, 3
    v_lshl_add_u32 v7, v30, 5, v7
    v_lshl_add_u32 v7, v103, 2, v7
    v_add_u32 v7, s52, v7
    s_lshl_b32 s53, s40, 8
    s_add_u32 s52, s52, s53
    v_add_u32 v6, s52, v6
    v_lshlrev_b32 v30, 4, v100
    v_lshl_add_u32 v30, v101, 18, v30
    v_add_u32 v30, s52, v30
    v_mov_b32 v32, -1
    v_mov_b32 v33, -1
    v_mov_b32 v34, -1
    v_mov_b32 v35, -1
    buffer_store_dwordx4 v[32:35], v30, s[12:15], 0 offen sc1
    s_mov_b32 s53, 8192
    buffer_store_dwordx4 v[32:35], v30, s[12:15], s53 offen sc1
    s_lshl_b32 s55, s40, 16
    s_add_u32 s55, s55, 0x7000000
    s_lshl_b32 s52, s41, 10
    s_lshl_b32 s53, s54, 8
    s_add_u32 s52, s52, s53
    s_add_u32 s52, s52, s55
    v_lshlrev_b32 v8, 2, v1
    v_add_u32 v8, s52, v8
    s_lshl_b32 s53, s54, 12
    v_add_u32 v10, s53, v2
    v_add_u32 v9, s55, v10
    s_lshl_b32 s52, s40, 15
    s_lshl_b32 s53, s54, 11
    s_add_u32 s52, s52, s53
    s_add_u32 s52, s52, 0x7100000
    v_add_u32 v11, s52, v2
    s_lshl_b32 s52, s54, 9
    s_add_u32 s52, s52, 53248
    v_lshlrev_b32 v12, 4, v100
    v_lshl_add_u32 v12, v102, 3, v12
    v_lshl_add_u32 v12, v103, 8, v12
    v_add_u32 v12, s52, v12
    s_lshl_b32 s52, s51, 3
    s_add_u32 s52, s52, 49152
    v_add_u32 v13, s52, v2
    s_lshl_b32 s52, s54, 10
    s_add_u32 s52, s52, 49152
    v_add_u32 v14, s52, v2
    s_lshl_b32 s52, s40, 2
    s_add_u32 s52, s52, s54
    s_mul_i32 s52, s52, 24576
    s_add_u32 s52, s52, 0x2004000
    v_add_u32 v15, s52, v2
    s_lshl_b32 s52, s54, 10
    v_add_u32 v27, s52, v2
    v_lshlrev_b32 v30, 11, v106
    v_lshl_add_u32 v30, v101, 5, v30
    s_lshl_b32 s52, s54, 9
    buffer_load_dwordx4 v[64:67], v30, s[32:35], s52 offen offset:0
    buffer_load_dwordx4 v[68:71], v30, s[32:35], s52 offen offset:16
    buffer_load_dwordx4 v[72:75], v30, s[32:35], s52 offen offset:128
    buffer_load_dwordx4 v[76:79], v30, s[32:35], s52 offen offset:144
    buffer_load_dwordx4 v[80:83], v30, s[32:35], s52 offen offset:256
    buffer_load_dwordx4 v[84:87], v30, s[32:35], s52 offen offset:272
    buffer_load_dwordx4 v[88:91], v30, s[32:35], s52 offen offset:384
    buffer_load_dwordx4 v[92:95], v30, s[32:35], s52 offen offset:400
    s_lshl_b32 s46, s40, 2
    s_add_u32 s46, s46, s54
    s_lshl_b32 s46, s46, 18
    s_lshl_b32 s48, s41, 7
    s_add_u32 s46, s46, s48
    s_add_u32 s48, s46, 0x0
    buffer_load_dwordx4 a[64:67], v25, s[28:31], s48 offen
    s_add_u32 s48, s46, 0x4000
    buffer_load_dwordx4 a[80:83], v25, s[28:31], s48 offen
    s_add_u32 s48, s46, 0x8000
    buffer_load_dwordx4 a[96:99], v25, s[28:31], s48 offen
    s_add_u32 s48, s46, 0xc000
    buffer_load_dwordx4 a[112:115], v25, s[28:31], s48 offen
    s_add_u32 s48, s46, 0x10000
    buffer_load_dwordx4 a[68:71], v25, s[28:31], s48 offen
    s_add_u32 s48, s46, 0x14000
    buffer_load_dwordx4 a[84:87], v25, s[28:31], s48 offen
    s_add_u32 s48, s46, 0x18000
    buffer_load_dwordx4 a[100:103], v25, s[28:31], s48 offen
    s_add_u32 s48, s46, 0x1c000
    buffer_load_dwordx4 a[116:119], v25, s[28:31], s48 offen
    s_add_u32 s48, s46, 0x20000
    buffer_load_dwordx4 a[72:75], v25, s[28:31], s48 offen
    s_add_u32 s48, s46, 0x24000
    buffer_load_dwordx4 a[88:91], v25, s[28:31], s48 offen
    s_add_u32 s48, s46, 0x28000
    buffer_load_dwordx4 a[104:107], v25, s[28:31], s48 offen
    s_add_u32 s48, s46, 0x2c000
    buffer_load_dwordx4 a[120:123], v25, s[28:31], s48 offen
    s_add_u32 s48, s46, 0x30000
    buffer_load_dwordx4 a[76:79], v25, s[28:31], s48 offen
    s_add_u32 s48, s46, 0x34000
    buffer_load_dwordx4 a[92:95], v25, s[28:31], s48 offen
    s_add_u32 s48, s46, 0x38000
    buffer_load_dwordx4 a[108:111], v25, s[28:31], s48 offen
    s_add_u32 s48, s46, 0x3c000
    buffer_load_dwordx4 a[124:127], v25, s[28:31], s48 offen
    s_waitcnt vmcnt(16)
    v_cmp_eq_u32 vcc, 1, v107
    s_nop 1
    v_cndmask_b32 v112, v64, v65, vcc
    v_cndmask_b32 v113, v66, v67, vcc
    v_cndmask_b32 v114, v68, v69, vcc
    v_cndmask_b32 v115, v70, v71, vcc
    v_cndmask_b32 v116, v72, v73, vcc
    v_cndmask_b32 v117, v74, v75, vcc
    v_cndmask_b32 v118, v76, v77, vcc
    v_cndmask_b32 v119, v78, v79, vcc
    v_cndmask_b32 v120, v80, v81, vcc
    v_cndmask_b32 v121, v82, v83, vcc
    v_cndmask_b32 v122, v84, v85, vcc
    v_cndmask_b32 v123, v86, v87, vcc
    v_cndmask_b32 v124, v88, v89, vcc
    v_cndmask_b32 v125, v90, v91, vcc
    v_cndmask_b32 v126, v92, v93, vcc
    v_cndmask_b32 v127, v94, v95, vcc
    ds_write_b128 v22, a[0:3] offset:0
    ds_write_b128 v22, a[32:35] offset:1024
    ds_write_b128 v22, a[4:7] offset:2048
    ds_write_b128 v22, a[36:39] offset:3072
    s_waitcnt lgkmcnt(0)
    ds_read_b64_tr_b16 a[0:1], v20 offset:0
    ds_read_b64_tr_b16 a[2:3], v20 offset:256
    ds_read_b64_tr_b16 a[32:33], v20 offset:32
    ds_read_b64_tr_b16 a[34:35], v20 offset:288
    ds_read_b64_tr_b16 a[4:5], v20 offset:2048
    ds_read_b64_tr_b16 a[6:7], v20 offset:2304
    ds_read_b64_tr_b16 a[36:37], v20 offset:2080
    ds_read_b64_tr_b16 a[38:39], v20 offset:2336
    s_waitcnt lgkmcnt(0)
    ds_write_b128 v22, a[8:11] offset:0
    ds_write_b128 v22, a[40:43] offset:1024
    ds_write_b128 v22, a[12:15] offset:2048
    ds_write_b128 v22, a[44:47] offset:3072
    s_waitcnt lgkmcnt(0)
    ds_read_b64_tr_b16 a[8:9], v20 offset:0
    ds_read_b64_tr_b16 a[10:11], v20 offset:256
    ds_read_b64_tr_b16 a[40:41], v20 offset:32
    ds_read_b64_tr_b16 a[42:43], v20 offset:288
    ds_read_b64_tr_b16 a[12:13], v20 offset:2048
    ds_read_b64_tr_b16 a[14:15], v20 offset:2304
    ds_read_b64_tr_b16 a[44:45], v20 offset:2080
    ds_read_b64_tr_b16 a[46:47], v20 offset:2336
    s_waitcnt lgkmcnt(0)
    ds_write_b128 v22, a[16:19] offset:0
    ds_write_b128 v22, a[48:51] offset:1024
    ds_write_b128 v22, a[20:23] offset:2048
    ds_write_b128 v22, a[52:55] offset:3072
    s_waitcnt lgkmcnt(0)
    ds_read_b64_tr_b16 a[16:17], v20 offset:0
    ds_read_b64_tr_b16 a[18:19], v20 offset:256
    ds_read_b64_tr_b16 a[48:49], v20 offset:32
    ds_read_b64_tr_b16 a[50:51], v20 offset:288
    ds_read_b64_tr_b16 a[20:21], v20 offset:2048
    ds_read_b64_tr_b16 a[22:23], v20 offset:2304
    ds_read_b64_tr_b16 a[52:53], v20 offset:2080
    ds_read_b64_tr_b16 a[54:55], v20 offset:2336
    s_waitcnt lgkmcnt(0)
    ds_write_b128 v22, a[24:27] offset:0
    ds_write_b128 v22, a[56:59] offset:1024
    ds_write_b128 v22, a[28:31] offset:2048
    ds_write_b128 v22, a[60:63] offset:3072
    s_waitcnt lgkmcnt(0)
    ds_read_b64_tr_b16 a[24:25], v20 offset:0
    ds_read_b64_tr_b16 a[26:27], v20 offset:256
    ds_read_b64_tr_b16 a[56:57], v20 offset:32
    ds_read_b64_tr_b16 a[58:59], v20 offset:288
    ds_read_b64_tr_b16 a[28:29], v20 offset:2048
    ds_read_b64_tr_b16 a[30:31], v20 offset:2304
    ds_read_b64_tr_b16 a[60:61], v20 offset:2080
    ds_read_b64_tr_b16 a[62:63], v20 offset:2336
    s_waitcnt lgkmcnt(0)
    s_barrier
    s_waitcnt vmcnt(0)
    ds_write_b128 v22, a[64:67] offset:0
    ds_write_b128 v22, a[80:83] offset:1024
    ds_write_b128 v22, a[96:99] offset:2048
    ds_write_b128 v22, a[112:115] offset:3072
    s_waitcnt lgkmcnt(0)
    ds_read_b64_tr_b16 a[64:65], v21 offset:0
    ds_read_b64_tr_b16 a[66:67], v21 offset:512
    ds_read_b64_tr_b16 a[80:81], v21 offset:32
    ds_read_b64_tr_b16 a[82:83], v21 offset:544
    ds_read_b64_tr_b16 a[96:97], v21 offset:64
    ds_read_b64_tr_b16 a[98:99], v21 offset:576
    ds_read_b64_tr_b16 a[112:113], v21 offset:96
    ds_read_b64_tr_b16 a[114:115], v21 offset:608
    s_waitcnt lgkmcnt(0)
    ds_write_b128 v22, a[68:71] offset:0
    ds_write_b128 v22, a[84:87] offset:1024
    ds_write_b128 v22, a[100:103] offset:2048
    ds_write_b128 v22, a[116:119] offset:3072
    s_waitcnt lgkmcnt(0)
    ds_read_b64_tr_b16 a[68:69], v21 offset:0
    ds_read_b64_tr_b16 a[70:71], v21 offset:512
    ds_read_b64_tr_b16 a[84:85], v21 offset:32
    ds_read_b64_tr_b16 a[86:87], v21 offset:544
    ds_read_b64_tr_b16 a[100:101], v21 offset:64
    ds_read_b64_tr_b16 a[102:103], v21 offset:576
    ds_read_b64_tr_b16 a[116:117], v21 offset:96
    ds_read_b64_tr_b16 a[118:119], v21 offset:608
    s_waitcnt lgkmcnt(0)
    ds_write_b128 v22, a[72:75] offset:0
    ds_write_b128 v22, a[88:91] offset:1024
    ds_write_b128 v22, a[104:107] offset:2048
    ds_write_b128 v22, a[120:123] offset:3072
    s_waitcnt lgkmcnt(0)
    ds_read_b64_tr_b16 a[72:73], v21 offset:0
    ds_read_b64_tr_b16 a[74:75], v21 offset:512
    ds_read_b64_tr_b16 a[88:89], v21 offset:32
    ds_read_b64_tr_b16 a[90:91], v21 offset:544
    ds_read_b64_tr_b16 a[104:105], v21 offset:64
    ds_read_b64_tr_b16 a[106:107], v21 offset:576
    ds_read_b64_tr_b16 a[120:121], v21 offset:96
    ds_read_b64_tr_b16 a[122:123], v21 offset:608
    s_waitcnt lgkmcnt(0)
    ds_write_b128 v22, a[76:79] offset:0
    ds_write_b128 v22, a[92:95] offset:1024
    ds_write_b128 v22, a[108:111] offset:2048
    ds_write_b128 v22, a[124:127] offset:3072
    s_waitcnt lgkmcnt(0)
    ds_read_b64_tr_b16 a[76:77], v21 offset:0
    ds_read_b64_tr_b16 a[78:79], v21 offset:512
    ds_read_b64_tr_b16 a[92:93], v21 offset:32
    ds_read_b64_tr_b16 a[94:95], v21 offset:544
    ds_read_b64_tr_b16 a[108:109], v21 offset:64
    ds_read_b64_tr_b16 a[110:111], v21 offset:576
    ds_read_b64_tr_b16 a[124:125], v21 offset:96
    ds_read_b64_tr_b16 a[126:127], v21 offset:608
    s_waitcnt lgkmcnt(0)
    s_mov_b32 s65, 0
    s_waitcnt vmcnt(0)
    s_barrier
    s_lshl_b32 s57, s40, 11
    s_lshl_b32 s53, s54, 7
    s_add_u32 s57, s57, s53
    s_add_u32 s57, s57, 0x10a600
    s_mov_b32 s69, 0
    s_mov_b32 s68, 0
    s_cmp_gt_u32 s69, s68
    s_cbranch_scc1 L_kv_ok_192
    s_mov_b32 s70, 0
L_kv_lp_191:
    v_and_b32 v22, 1, v1
    v_lshlrev_b32 v22, 9, v22
    buffer_load_dword v23, v22, s[12:15], s57 offen sc1
    s_waitcnt vmcnt(0)
    v_readlane_b32 s69, v23, 0
    v_readlane_b32 s45, v23, 1
    s_add_u32 s70, s70, 1
    s_nop 2
    s_min_u32 s69, s69, s45
    s_cmp_gt_u32 s69, s68
    s_cbranch_scc1 L_kv_ok_192
    s_sleep 4
    s_cmp_lt_u32 s70, 524288
    s_cbranch_scc1 L_kv_lp_191
    s_branch L_c_done_1
L_kv_ok_192:
    v_lshlrev_b32 v28, 9, v101
    v_lshl_add_u32 v28, v100, 4, v28
    s_lshl_b32 s52, s54, 13
    s_add_u32 s52, s52, 0x7a0000
    v_add_u32 v28, s52, v28
    s_lshl_b32 s59, s54, 12
    s_add_u32 s59, s59, 65536
    v_lshlrev_b32 v31, 4, v100
    v_lshl_add_u32 v31, v103, 8, v31
    v_add_u32 v31, 20480, v31
    s_lshl_b32 s52, s54, 11
    s_add_u32 s52, s52, 53248
    v_add_u32 v25, s52, v2
    v_mov_b32 v29, 26640
    v_mov_b32 v30, 0
    ds_write_b32 v29, v30
    v_mov_b32 v30, 1
    s_mov_b32 s58, 0
    s_mov_b32 s64, 0
    s_add_u32 s46, s65, 4096
    buffer_load_dwordx4 v[32:35], v15, s[12:15], s65 offen offset:0 sc1
    buffer_load_dwordx4 v[48:51], v15, s[12:15], s46 offen offset:0 sc1
    buffer_load_dwordx4 v[36:39], v15, s[12:15], s65 offen offset:1024 sc1
    buffer_load_dwordx4 v[52:55], v15, s[12:15], s46 offen offset:1024 sc1
    buffer_load_dwordx4 v[40:43], v15, s[12:15], s65 offen offset:2048 sc1
    buffer_load_dwordx4 v[56:59], v15, s[12:15], s46 offen offset:2048 sc1
    buffer_load_dwordx4 v[44:47], v15, s[12:15], s65 offen offset:3072 sc1
    buffer_load_dwordx4 v[60:63], v15, s[12:15], s46 offen offset:3072 sc1
    s_add_u32 s65, s65, 786432
    s_waitcnt vmcnt(0)
    v_mfma_f32_16x16x32_bf16 v[64:67], v[32:35], a[64:67], 0
    v_mfma_f32_16x16x32_bf16 v[68:71], v[48:51], a[64:67], 0
    v_mfma_f32_16x16x32_bf16 v[64:67], v[36:39], a[68:71], v[64:67]
    v_mfma_f32_16x16x32_bf16 v[68:71], v[52:55], a[68:71], v[68:71]
    v_mfma_f32_16x16x32_bf16 v[64:67], v[40:43], a[72:75], v[64:67]
    v_mfma_f32_16x16x32_bf16 v[68:71], v[56:59], a[72:75], v[68:71]
    v_mfma_f32_16x16x32_bf16 v[64:67], v[44:47], a[76:79], v[64:67]
    v_mfma_f32_16x16x32_bf16 v[68:71], v[60:63], a[76:79], v[68:71]
    v_mfma_f32_16x16x32_bf16 v[72:75], v[32:35], a[80:83], 0
    v_mfma_f32_16x16x32_bf16 v[76:79], v[48:51], a[80:83], 0
    v_mfma_f32_16x16x32_bf16 v[72:75], v[36:39], a[84:87], v[72:75]
    v_mfma_f32_16x16x32_bf16 v[76:79], v[52:55], a[84:87], v[76:79]
    v_mfma_f32_16x16x32_bf16 v[72:75], v[40:43], a[88:91], v[72:75]
    v_mfma_f32_16x16x32_bf16 v[76:79], v[56:59], a[88:91], v[76:79]
    v_mfma_f32_16x16x32_bf16 v[72:75], v[44:47], a[92:95], v[72:75]
    v_mfma_f32_16x16x32_bf16 v[76:79], v[60:63], a[92:95], v[76:79]
    v_cvt_pk_bf16_f32 v64, v64, v65
    v_cvt_pk_bf16_f32 v65, v66, v67
    v_cvt_pk_bf16_f32 v66, v68, v69
    v_cvt_pk_bf16_f32 v67, v70, v71
    ds_write_b128 v10, v[64:67] offset:32768
    v_mfma_f32_16x16x32_bf16 v[80:83], v[32:35], a[96:99], 0
    v_mfma_f32_16x16x32_bf16 v[84:87], v[48:51], a[96:99], 0
    v_mfma_f32_16x16x32_bf16 v[80:83], v[36:39], a[100:103], v[80:83]
    v_mfma_f32_16x16x32_bf16 v[84:87], v[52:55], a[100:103], v[84:87]
    v_mfma_f32_16x16x32_bf16 v[80:83], v[40:43], a[104:107], v[80:83]
    v_mfma_f32_16x16x32_bf16 v[84:87], v[56:59], a[104:107], v[84:87]
    v_mfma_f32_16x16x32_bf16 v[80:83], v[44:47], a[108:111], v[80:83]
    v_mfma_f32_16x16x32_bf16 v[84:87], v[60:63], a[108:111], v[84:87]
    v_cvt_pk_bf16_f32 v72, v72, v73
    v_cvt_pk_bf16_f32 v73, v74, v75
    v_cvt_pk_bf16_f32 v74, v76, v77
    v_cvt_pk_bf16_f32 v75, v78, v79
    ds_write_b128 v10, v[72:75] offset:33792
    v_mfma_f32_16x16x32_bf16 v[88:91], v[32:35], a[112:115], 0
    v_mfma_f32_16x16x32_bf16 v[92:95], v[48:51], a[112:115], 0
    v_mfma_f32_16x16x32_bf16 v[88:91], v[36:39], a[116:119], v[88:91]
    v_mfma_f32_16x16x32_bf16 v[92:95], v[52:55], a[116:119], v[92:95]
    v_mfma_f32_16x16x32_bf16 v[88:91], v[40:43], a[120:123], v[88:91]
    v_mfma_f32_16x16x32_bf16 v[92:95], v[56:59], a[120:123], v[92:95]
    v_mfma_f32_16x16x32_bf16 v[88:91], v[44:47], a[124:127], v[88:91]
    v_mfma_f32_16x16x32_bf16 v[92:95], v[60:63], a[124:127], v[92:95]
    v_cvt_pk_bf16_f32 v80, v80, v81
    v_cvt_pk_bf16_f32 v81, v82, v83
    v_cvt_pk_bf16_f32 v82, v84, v85
    v_cvt_pk_bf16_f32 v83, v86, v87
    ds_write_b128 v10, v[80:83] offset:34816
    s_nop 2
    v_cvt_pk_bf16_f32 v88, v88, v89
    v_cvt_pk_bf16_f32 v89, v90, v91
    v_cvt_pk_bf16_f32 v90, v92, v93
    v_cvt_pk_bf16_f32 v91, v94, v95
    ds_write_b128 v10, v[88:91] offset:35840
    s_mov_b64 s[66:67], 0
    s_mov_b32 s63, 0
    s_mov_b32 s68, 1
    s_cmp_gt_u32 s69, s68
    s_cbranch_scc1 L_kv_ok_194
    s_mov_b32 s70, 0
L_kv_lp_193:
    v_and_b32 v22, 1, v1
    v_lshlrev_b32 v22, 9, v22
    buffer_load_dword v23, v22, s[12:15], s57 offen sc1
    s_waitcnt vmcnt(0)
    v_readlane_b32 s69, v23, 0
    v_readlane_b32 s45, v23, 1
    s_add_u32 s70, s70, 1
    s_nop 2
    s_min_u32 s69, s69, s45
    s_cmp_gt_u32 s69, s68
    s_cbranch_scc1 L_kv_ok_194
    s_sleep 4
    s_cmp_lt_u32 s70, 524288
    s_cbranch_scc1 L_kv_lp_193
    s_branch L_c_done_1
L_kv_ok_194:
    s_waitcnt lgkmcnt(0)
    v_min_u32 v64, -2, v112
    v_min_u32 v65, -2, v113
    v_min_u32 v66, -2, v114
    v_min_u32 v67, -2, v115
    v_min_u32 v68, -2, v116
    v_min_u32 v69, -2, v117
    v_min_u32 v70, -2, v118
    v_min_u32 v71, -2, v119
    v_min_u32 v72, -2, v120
    v_min_u32 v73, -2, v121
    v_min_u32 v74, -2, v122
    v_min_u32 v75, -2, v123
    v_min_u32 v76, -2, v124
    v_min_u32 v77, -2, v125
    v_min_u32 v78, -2, v126
    v_min_u32 v79, -2, v127
    v_mov_b32 v16, 0
    v_mov_b32 v17, 0
    v_mov_b32 v18, 0
    v_mov_b32 v19, 0
    v_mov_b32 v20, 0
    v_mov_b32 v21, 0
    v_mov_b32 v22, 0
    v_mov_b32 v23, 0
L_c_join_187:
    s_mov_b32 s60, 0
    s_mov_b32 s61, 0
    s_mov_b32 s62, 0
    s_cmp_lg_u32 s44, 0
    s_cbranch_scc1 L_c_nh_195
    v_lshlrev_b32 v17, 3, v1
    s_lshl_b32 s46, s40, 3
    v_mov_b32 v21, s46
    s_mov_b32 s45, 0x101000
    s_mov_b32 s70, 0
L_c_rp_196:
    buffer_load_dwordx2 v[18:19], v17, s[12:15], s45 offen sc1
    buffer_load_dwordx2 v[22:23], v21, s[12:15], s45 offen offset:512 sc1
    s_waitcnt vmcnt(0)
    v_min3_u32 v20, v18, v19, v22
    v_min_u32 v20, v20, v23
    v_cmp_eq_u32 vcc, 0, v20
    s_cbranch_vccnz L_rt_197
    v_cmp_eq_u32 s[52:53], v18, v16
    v_cmp_eq_u32 vcc, v19, v16
    v_cmp_eq_u32 s[54:55], v22, v16
    v_cmp_eq_u32 s[56:57], v23, v16
    s_lshl_b32 s46, s40, 3
    s_nop 3
    s_and_b64 s[52:53], s[52:53], vcc
    s_lshr_b64 s[52:53], s[52:53], s46
    s_and_b32 s52, s52, 0xff
    s_cmp_eq_u32 s52, 0xff
    s_cselect_b32 s52, 1, 0
    v_mov_b32 v16, s52
    v_mov_b32 v17, 26624
    ds_write_b32 v17, v16
L_c_nh_195:
    s_waitcnt lgkmcnt(0)
    s_barrier
    v_mov_b32 v17, 26624
    ds_read_b32 v16, v17
    s_waitcnt lgkmcnt(0)
    v_readfirstlane_b32 s52, v16
    s_nop 3
    s_cmp_ge_u32 s44, 4
    s_cbranch_scc1 L_vf_200
    s_mov_b32 s57, s58
    s_mov_b32 s58, 0
    s_cmp_ge_u32 s44, 2
    s_cbranch_scc1 L_sf_198
    buffer_load_dwordx4 v[32:35], v6, s[12:15], 0 offen sc1
L_sf_198:
    s_mov_b32 s54, s52
    v_add_u32 v52, 786432, v6
    s_mul_i32 s53, s49, 24576
    s_lshl_b32 s55, s43, 11
    s_add_u32 s53, s53, s55
    s_and_b32 s55, s44, 1
    s_lshl_b32 s55, s55, 10
    s_add_u32 s53, s53, s55
    s_add_u32 s53, s53, 0x2184000
    v_and_b32 v53, 7, v1
    v_lshlrev_b32 v53, 7, v53
    v_add_u32 v53, s53, v53
    s_cmp_ge_u32 s44, 2
    s_cselect_b64 vcc, -1, 0
    s_cselect_b64 s[52:53], 0xff, -1
    v_cndmask_b32 v52, v52, v53, vcc
    s_cselect_b32 s55, 786432, 0
    v_readfirstlane_b32 s56, v52
    s_nop 3
    s_sub_u32 s56, s56, s55
    s_cmp_eq_u32 s54, 0
    s_cbranch_scc1 L_ss_199
.p2align 6
L_s_loop_202:
    v_mov_b32 v16, 0
    v_mov_b32 v17, 0
    v_mov_b32 v18, 0
    v_mov_b32 v19, 0
    s_add_u32 s58, s58, 4
    s_mov_b32 s70, 1
    s_waitcnt vmcnt(0) lgkmcnt(0)
    s_barrier
    ds_read_b128 v[64:67], v2 offset:0
    ds_read_b128 v[68:71], v2 offset:1024
    ds_read_b128 v[72:75], v2 offset:2048
    ds_read_b128 v[76:79], v2 offset:3072
    ds_read_b128 v[80:83], v2 offset:4096
    ds_read_b128 v[84:87], v2 offset:5120
    ds_read_b128 v[88:91], v2 offset:6144
    ds_read_b128 v[92:95], v2 offset:7168
    ds_read_b128 v[96:99], v2 offset:8192
    ds_read_b128 v[100:103], v2 offset:9216
    ds_read_b128 v[104:107], v2 offset:10240
    ds_read_b128 v[108:111], v2 offset:11264
    s_waitcnt lgkmcnt(11)
    v_smfmac_f32_16x16x64_bf16 v[16:19], v[64:67], a[0:7], v3
    ds_read_b128 v[112:115], v2 offset:12288
    s_waitcnt lgkmcnt(11)
    v_smfmac_f32_16x16x64_bf16 v[16:19], v[68:71], a[8:15], v3
    ds_read_b128 v[116:119], v2 offset:13312
    s_waitcnt lgkmcnt(11)
    v_smfmac_f32_16x16x64_bf16 v[16:19], v[72:75], a[16:23], v3
    ds_read_b128 v[120:123], v2 offset:14336
    s_waitcnt lgkmcnt(11)
    v_smfmac_f32_16x16x64_bf16 v[16:19], v[76:79], a[24:31], v3
    ds_read_b128 v[124:127], v2 offset:15360
    s_waitcnt lgkmcnt(11)
    v_smfmac_f32_16x16x64_bf16 v[16:19], v[80:83], a[32:39], v3
    s_waitcnt lgkmcnt(10)
    v_smfmac_f32_16x16x64_bf16 v[16:19], v[84:87], a[40:47], v3
    s_waitcnt lgkmcnt(9)
    v_smfmac_f32_16x16x64_bf16 v[16:19], v[88:91], a[48:55], v3
    s_waitcnt lgkmcnt(8)
    v_smfmac_f32_16x16x64_bf16 v[16:19], v[92:95], a[56:63], v3
    s_waitcnt lgkmcnt(7)
    v_smfmac_f32_16x16x64_bf16 v[16:19], v[96:99], a[64:71], v3
    s_waitcnt lgkmcnt(6)
    v_smfmac_f32_16x16x64_bf16 v[16:19], v[100:103], a[72:79], v3
    s_waitcnt lgkmcnt(5)
    v_smfmac_f32_16x16x64_bf16 v[16:19], v[104:107], a[80:87], v3
    s_waitcnt lgkmcnt(4)
    v_smfmac_f32_16x16x64_bf16 v[16:19], v[108:111], a[88:95], v3
    s_waitcnt lgkmcnt(3)
    v_smfmac_f32_16x16x64_bf16 v[16:19], v[112:115], a[96:103], v3
    s_waitcnt lgkmcnt(2)
    v_smfmac_f32_16x16x64_bf16 v[16:19], v[116:119], a[104:111], v3
    s_waitcnt lgkmcnt(1)
    v_smfmac_f32_16x16x64_bf16 v[16:19], v[120:123], a[112:119], v3
    s_waitcnt lgkmcnt(0)
    v_smfmac_f32_16x16x64_bf16 v[16:19], v[124:127], a[120:127], v3
    s_nop 7
    v_permlane32_swap_b32 v16, v18
    v_permlane32_swap_b32 v17, v19
    v_add_f32 v16, v16, v18
    v_add_f32 v17, v17, v19
    v_cvt_pk_bf16_f32 v16, v16, v17
    ds_write_b16 v5, v16
    ds_write_b16_d16_hi v5, v16 offset:16
    s_mov_b64 exec, 1
    ds_add_u32 v29, v30
    s_mov_b64 exec, -1
L_s_xl_204:
    ds_read_b32 v10, v29
    ds_read_b128 v[64:67], v2 offset:61440
    s_cmp_eq_u32 s60, 63
    s_cbranch_scc1 L_s_last_203
    s_cmp_ge_u32 s44, 2
    s_cbranch_scc1 L_s_w2_205
    s_waitcnt lgkmcnt(0)
    v_mfma_f32_16x16x32_bf16 v[16:19], v[32:35], v[64:67], 0
L_s_w2_205_b:
    v_cmp_ne_u32 vcc, s58, v10
    s_nop 0
    s_cbranch_vccnz L_rt_207
    s_mov_b64 exec, s[50:51]
    s_nop 3
    v_cvt_pk_bf16_f32 v16, v16, v17
    v_cvt_pk_bf16_f32 v17, v18, v19
    v_pk_min_u16 v16, v16, v54
    v_pk_min_u16 v17, v17, v54
    buffer_store_dwordx2 v[16:17], v4, s[12:15], s61 offen
    s_mov_b64 exec, -1
L_s_w3_206_b:
    s_sleep 5
    s_mov_b32 s70, 1
L_s_xp_209:
    buffer_load_dwordx2 v[64:65], v7, s[12:15], s61 offen offset:0 sc1
    buffer_load_short_d16_hi v56, v28, s[12:15], s61 offen offset:0 sc1
    buffer_load_dwordx2 v[66:67], v7, s[12:15], s61 offen offset:512 sc1
    buffer_load_short_d16_hi v57, v28, s[12:15], s61 offen offset:128 sc1
    buffer_load_dwordx2 v[68:69], v7, s[12:15], s61 offen offset:1024 sc1
    buffer_load_short_d16_hi v58, v28, s[12:15], s61 offen offset:256 sc1
    buffer_load_dwordx2 v[70:71], v7, s[12:15], s61 offen offset:1536 sc1
    buffer_load_short_d16_hi v59, v28, s[12:15], s61 offen offset:384 sc1
L_s_xc_208_b:
    s_mov_b32 s46, 0x00003f80
    s_mov_b32 s47, 0x3f800000
    s_waitcnt vmcnt(6)
    v_dot2_f32_bf16 v16, v64, s46, 0
    v_dot2_f32_bf16 v17, v64, s47, 0
    v_dot2_f32_bf16 v18, v65, s46, 0
    v_dot2_f32_bf16 v19, v65, s47, 0
    s_waitcnt vmcnt(4)
    v_dot2_f32_bf16 v16, v66, s46, v16
    v_dot2_f32_bf16 v17, v66, s47, v17
    v_dot2_f32_bf16 v18, v67, s46, v18
    v_dot2_f32_bf16 v19, v67, s47, v19
    v_add_f32 v20, v56, v57
    s_waitcnt vmcnt(2)
    v_dot2_f32_bf16 v16, v68, s46, v16
    v_dot2_f32_bf16 v17, v68, s47, v17
    v_dot2_f32_bf16 v18, v69, s46, v18
    v_dot2_f32_bf16 v19, v69, s47, v19
    v_add_f32 v20, v20, v58
    s_waitcnt vmcnt(0)
    v_dot2_f32_bf16 v16, v70, s46, v16
    v_dot2_f32_bf16 v17, v70, s47, v17
    v_dot2_f32_bf16 v18, v71, s46, v18
    v_dot2_f32_bf16 v19, v71, s47, v19
    v_add_f32 v20, v20, v59
    s_nop 0
    v_cmp_u_f32 s[46:47], v16, v17
    v_cmp_u_f32 s[48:49], v18, v19
    v_cmp_u_f32 vcc, v20, v20
    v_max3_f32 v10, v16, v17, v18
    s_or_b64 s[46:47], s[46:47], s[48:49]
    v_max3_f32 v10, v10, v19, v20
    s_or_b64 vcc, vcc, s[46:47]
    s_cbranch_scc1 L_s_xf_210
L_s_xok_211:
    v_max_f32_dpp v11, v10, v10 row_ror:8 row_mask:0xf bank_mask:0xf
    v_max_f32_dpp v10, v10, v10 row_ror:8 row_mask:0xf bank_mask:0xf
    s_nop 1
    v_permlane16_swap_b32 v10, v11
    v_max_f32 v12, v10, v11
    v_max_f32 v10, v10, v11
    s_nop 1
    v_permlane32_swap_b32 v10, v12
    v_max_f32 v10, v10, v12
    v_mul_f32 v10, s66, v10
    v_fma_f32 v16, v16, s66, -v10
    v_fma_f32 v17, v17, s66, -v10
    v_fma_f32 v18, v18, s66, -v10
    v_fma_f32 v19, v19, s66, -v10
    v_fma_f32 v20, v20, s66, -v10
    v_exp_f32 v16, v16
    v_exp_f32 v17, v17
    v_exp_f32 v18, v18
    v_exp_f32 v19, v19
    v_exp_f32 v20, v20
    v_add_f32 v10, v16, v17
    v_add_f32 v11, v18, v19
    v_add_f32 v10, v10, v20
    v_add_f32 v10, v10, v11
    s_nop 1
    v_add_f32_dpp v11, v10, v10 row_ror:8 row_mask:0xf bank_mask:0xf
    v_add_f32_dpp v10, v10, v10 row_ror:8 row_mask:0xf bank_mask:0xf
    s_nop 1
    v_permlane16_swap_b32 v10, v11
    v_add_f32 v12, v10, v11
    v_add_f32 v10, v10, v11
    s_nop 1
    v_permlane32_swap_b32 v10, v12
    v_add_f32 v10, v10, v12
    v_rcp_f32 v10, v10
    s_nop 0
    v_mul_f32 v16, v16, v10
    v_mul_f32 v17, v17, v10
    v_mul_f32 v18, v18, v10
    v_mul_f32 v19, v19, v10
    v_mul_f32 v20, v20, v10
    v_cvt_pk_bf16_f32 v16, v16, v17
    v_cvt_pk_bf16_f32 v17, v18, v19
    v_cvt_pk_bf16_f32 v18, v20, v20
    ds_write_b64 v8, v[16:17]
    ds_write_b16 v9, v18
    s_waitcnt lgkmcnt(0)
    s_barrier
    s_add_u32 s63, s63, 786432
    s_cmp_ge_u32 s44, 2
    s_cbranch_scc1 L_s_nk_212
    buffer_load_dwordx4 v[32:35], v6, s[12:15], s63 offen sc1
L_s_nk_212:
    s_add_u32 s45, s60, 2
    s_cmp_le_u32 s69, s45
    s_cbranch_scc1 L_s_nk_212_w
    s_add_u32 s45, s63, 786432
    s_mov_b64 exec, 0xf
    buffer_load_dword v15, v14, s[12:15], s45 offen sc1
    s_mov_b64 exec, -1
L_s_nk_212_w:
    s_cmp_eq_u32 s44, 3
    s_cbranch_scc1 L_s_nr_213
    s_xor_b32 s45, s61, 0x8000
    s_mov_b64 exec, s[50:51]
    buffer_store_dwordx2 v[24:25], v4, s[12:15], s45 offen
    s_mov_b64 exec, -1
L_s_nr_213:
    s_cmp_lg_u32 s44, 3
    s_cbranch_scc1 L_s_np_214
    ds_read_b128 v[20:23], v6
    s_lshl_b32 s45, s60, 17
    s_add_u32 s45, s45, s67
    s_waitcnt lgkmcnt(0)
    v_min_u32 v20, -2, v20
    v_min_u32 v21, -2, v21
    v_min_u32 v22, -2, v22
    v_min_u32 v23, -2, v23
    buffer_store_dwordx4 v[20:23], v2, s[12:15], s45 offen sc1
L_s_np_214:
    s_add_u32 s68, s60, 2
    s_min_u32 s68, s68, 63
    v_readlane_b32 s45, v0, 0
    v_readlane_b32 s46, v0, 1
    s_nop 0
    s_min_u32 s45, s45, s46
    s_max_u32 s69, s69, s45
    s_cmp_gt_u32 s69, s68
    s_cbranch_scc1 L_kv_ok_217
    s_mov_b32 s70, 0
L_kv_lp_216:
    v_and_b32 v22, 1, v1
    v_lshlrev_b32 v22, 9, v22
    buffer_load_dword v23, v22, s[12:15], s57 offen sc1
    s_waitcnt vmcnt(0)
    v_readlane_b32 s69, v23, 0
    v_readlane_b32 s45, v23, 1
    s_add_u32 s70, s70, 1
    s_nop 2
    s_min_u32 s69, s69, s45
    s_cmp_gt_u32 s69, s68
    s_cbranch_scc1 L_kv_ok_217
    s_sleep 4
    s_cmp_lt_u32 s70, 524288
    s_cbranch_scc1 L_kv_lp_216
    s_branch L_c_done_1
L_kv_ok_217:
    s_add_u32 s45, s60, 7
    s_min_u32 s45, s45, 63
    s_cmp_gt_u32 s69, s45
    s_cbranch_scc1 L_s_na_215
    v_and_b32 v22, 1, v1
    v_lshlrev_b32 v22, 9, v22
    buffer_load_dword v0, v22, s[12:15], s57 offen sc1
L_s_na_215:
    s_sub_u32 s45, s60, 4
    s_cmp_gt_u32 s45, 24
    s_cbranch_scc1 L_s_xe_218
    s_sleep 1
    s_setprio 0
    s_bitcmp1_b32 s45, 0
    s_cbranch_scc1 L_s_x1_219
    s_cmp_eq_u32 s45, 0
    s_cbranch_scc1 L_s_x0_220
    s_bitcmp1_b32 s44, 0
    s_cbranch_scc1 L_s_x0_220
    ds_read_b128 v[40:43], v31
    s_sub_u32 s46, s45, 2
    s_lshr_b32 s47, s46, 2
    s_mul_i32 s47, s47, 786432
    s_and_b32 s46, s46, 2
    s_lshl_b32 s46, s46, 11
    s_add_u32 s47, s47, s46
    s_waitcnt lgkmcnt(0)
    buffer_store_dwordx4 v[40:43], v13, s[12:15], s47 offen sc1
L_s_x0_220:
    s_cmp_eq_u32 s45, 24
    s_cbranch_scc1 L_s_xe_218
    ds_read_b128 v[64:67], v44 offset:0
    ds_read_b128 v[68:71], v44 offset:1024
    ds_read_b128 v[72:75], v44 offset:2048
    ds_read_b128 v[76:79], v44 offset:3072
    ds_read_b128 v[80:83], v44 offset:4096
    ds_read_b128 v[84:87], v44 offset:5120
    ds_read_b128 v[88:91], v44 offset:6144
    ds_read_b128 v[92:95], v44 offset:7168
    ds_read_b128 v[96:99], v44 offset:8192
    ds_read_b128 v[100:103], v44 offset:9216
    ds_read_b128 v[104:107], v44 offset:10240
    ds_read_b128 v[108:111], v44 offset:11264
    s_waitcnt lgkmcnt(11)
    v_mfma_f32_16x16x32_bf16 v[36:39], a[0:3], v[64:67], 0
    ds_read_b128 v[112:115], v44 offset:12288
    s_waitcnt lgkmcnt(11)
    v_mfma_f32_16x16x32_bf16 v[36:39], a[4:7], v[68:71], v[36:39]
    ds_read_b128 v[116:119], v44 offset:13312
    s_waitcnt lgkmcnt(11)
    v_mfma_f32_16x16x32_bf16 v[36:39], a[8:11], v[72:75], v[36:39]
    ds_read_b128 v[120:123], v44 offset:14336
    s_waitcnt lgkmcnt(11)
    v_mfma_f32_16x16x32_bf16 v[36:39], a[12:15], v[76:79], v[36:39]
    ds_read_b128 v[124:127], v44 offset:15360
    s_waitcnt lgkmcnt(11)
    v_mfma_f32_16x16x32_bf16 v[36:39], a[16:19], v[80:83], v[36:39]
    s_waitcnt lgkmcnt(10)
    v_mfma_f32_16x16x32_bf16 v[36:39], a[20:23], v[84:87], v[36:39]
    s_waitcnt lgkmcnt(9)
    v_mfma_f32_16x16x32_bf16 v[36:39], a[24:27], v[88:91], v[36:39]
    s_waitcnt lgkmcnt(8)
    v_mfma_f32_16x16x32_bf16 v[36:39], a[28:31], v[92:95], v[36:39]
    s_waitcnt lgkmcnt(7)
    v_mfma_f32_16x16x32_bf16 v[36:39], a[32:35], v[96:99], v[36:39]
    s_waitcnt lgkmcnt(6)
    v_mfma_f32_16x16x32_bf16 v[36:39], a[36:39], v[100:103], v[36:39]
    s_waitcnt lgkmcnt(5)
    v_mfma_f32_16x16x32_bf16 v[36:39], a[40:43], v[104:107], v[36:39]
    s_waitcnt lgkmcnt(4)
    v_mfma_f32_16x16x32_bf16 v[36:39], a[44:47], v[108:111], v[36:39]
    s_waitcnt lgkmcnt(3)
    v_mfma_f32_16x16x32_bf16 v[36:39], a[48:51], v[112:115], v[36:39]
    s_waitcnt lgkmcnt(2)
    v_mfma_f32_16x16x32_bf16 v[36:39], a[52:55], v[116:119], v[36:39]
    s_waitcnt lgkmcnt(1)
    v_mfma_f32_16x16x32_bf16 v[36:39], a[56:59], v[120:123], v[36:39]
    s_waitcnt lgkmcnt(0)
    v_mfma_f32_16x16x32_bf16 v[36:39], a[60:63], v[124:127], v[36:39]
    s_branch L_s_xe_218
L_s_x1_219:
    ds_read_b128 v[64:67], v44 offset:16384
    ds_read_b128 v[68:71], v44 offset:17408
    ds_read_b128 v[72:75], v44 offset:18432
    ds_read_b128 v[76:79], v44 offset:19456
    ds_read_b128 v[80:83], v44 offset:20480
    ds_read_b128 v[84:87], v44 offset:21504
    ds_read_b128 v[88:91], v44 offset:22528
    ds_read_b128 v[92:95], v44 offset:23552
    ds_read_b128 v[96:99], v44 offset:24576
    ds_read_b128 v[100:103], v44 offset:25600
    ds_read_b128 v[104:107], v44 offset:26624
    ds_read_b128 v[108:111], v44 offset:27648
    s_waitcnt lgkmcnt(11)
    v_mfma_f32_16x16x32_bf16 v[36:39], a[64:67], v[64:67], v[36:39]
    ds_read_b128 v[112:115], v44 offset:28672
    s_waitcnt lgkmcnt(11)
    v_mfma_f32_16x16x32_bf16 v[36:39], a[68:71], v[68:71], v[36:39]
    ds_read_b128 v[116:119], v44 offset:29696
    s_waitcnt lgkmcnt(11)
    v_mfma_f32_16x16x32_bf16 v[36:39], a[72:75], v[72:75], v[36:39]
    ds_read_b128 v[120:123], v44 offset:30720
    s_waitcnt lgkmcnt(11)
    v_mfma_f32_16x16x32_bf16 v[36:39], a[76:79], v[76:79], v[36:39]
    ds_read_b128 v[124:127], v44 offset:31744
    s_waitcnt lgkmcnt(11)
    v_mfma_f32_16x16x32_bf16 v[36:39], a[80:83], v[80:83], v[36:39]
    s_waitcnt lgkmcnt(10)
    v_mfma_f32_16x16x32_bf16 v[36:39], a[84:87], v[84:87], v[36:39]
    s_waitcnt lgkmcnt(9)
    v_mfma_f32_16x16x32_bf16 v[36:39], a[88:91], v[88:91], v[36:39]
    s_waitcnt lgkmcnt(8)
    v_mfma_f32_16x16x32_bf16 v[36:39], a[92:95], v[92:95], v[36:39]
    s_waitcnt lgkmcnt(7)
    v_mfma_f32_16x16x32_bf16 v[36:39], a[96:99], v[96:99], v[36:39]
    s_waitcnt lgkmcnt(6)
    v_mfma_f32_16x16x32_bf16 v[36:39], a[100:103], v[100:103], v[36:39]
    s_waitcnt lgkmcnt(5)
    v_mfma_f32_16x16x32_bf16 v[36:39], a[104:107], v[104:107], v[36:39]
    s_waitcnt lgkmcnt(4)
    v_mfma_f32_16x16x32_bf16 v[36:39], a[108:111], v[108:111], v[36:39]
    s_waitcnt lgkmcnt(3)
    v_mfma_f32_16x16x32_bf16 v[36:39], a[112:115], v[112:115], v[36:39]
    s_waitcnt lgkmcnt(2)
    v_mfma_f32_16x16x32_bf16 v[36:39], a[116:119], v[116:119], v[36:39]
    s_waitcnt lgkmcnt(1)
    v_mfma_f32_16x16x32_bf16 v[36:39], a[120:123], v[120:123], v[36:39]
    s_waitcnt lgkmcnt(0)
    v_mfma_f32_16x16x32_bf16 v[36:39], a[124:127], v[124:127], v[36:39]
    s_nop 7
    v_cvt_pk_bf16_f32 v40, v36, v37
    v_cvt_pk_bf16_f32 v41, v38, v39
    ds_write_b64 v45, v[40:41]
    s_waitcnt lgkmcnt(0)
L_s_xe_218:
    s_setprio 1
    s_add_u32 s60, s60, 1
    s_add_u32 s61, s61, 0x4000
    s_and_b32 s61, s61, 0xffff
    s_branch L_s_loop_202
L_s_last_203:
    s_waitcnt lgkmcnt(0)
    s_barrier
    s_cmp_lg_u32 s44, 3
    s_cbranch_scc1 L_s_np_221
    ds_read_b128 v[20:23], v6
    s_lshl_b32 s45, s60, 17
    s_add_u32 s45, s45, s67
    s_waitcnt lgkmcnt(0)
    v_min_u32 v20, -2, v20
    v_min_u32 v21, -2, v21
    v_min_u32 v22, -2, v22
    v_min_u32 v23, -2, v23
    buffer_store_dwordx4 v[20:23], v2, s[12:15], s45 offen sc1
L_s_np_221:
    s_branch L_replica
L_rt_197:
    s_add_u32 s70, s70, 1
    s_cmp_lt_u32 s70, 524288
    s_cbranch_scc1 L_c_rp_196
    s_branch L_c_done_1
L_rt_207:
    s_add_u32 s70, s70, 1
    s_cmp_lt_u32 s70, 524288
    s_cbranch_scc1 L_s_xl_204
    s_branch L_c_done_1
L_s_w2_205:
    s_cmp_eq_u32 s44, 3
    s_cbranch_scc1 L_s_w3_206
    s_waitcnt lgkmcnt(0)
    v_mfma_f32_16x16x32_bf16 v[16:19], v[64:67], v[64:67], 0
    s_branch L_s_w2_205_b
L_s_w3_206:
    s_sleep 3
    s_branch L_s_w3_206_b
L_s_xf_210:
    v_or_b32 v72, 0xffff, v56
    v_or_b32 v73, 0xffff, v57
    v_or_b32 v74, 0xffff, v58
    v_or_b32 v75, 0xffff, v59
    v_max3_u32 v11, v64, v65, v66
    v_max3_u32 v11, v11, v67, v68
    v_max3_u32 v11, v11, v69, v70
    v_max3_u32 v11, v11, v71, v72
    v_max3_u32 v11, v11, v73, v74
    v_max_u32 v11, v11, v75
    v_cmp_eq_u32 vcc, -1, v11
    s_add_u32 s70, s70, 1
    s_cbranch_vccz L_s_xok_211
    s_cmp_lt_u32 s70, 524288
    s_cbranch_scc1 L_s_xp_209
    s_branch L_c_done_1
L_ss_199:
.p2align 6
L_s_loop_222:
    v_mov_b32 v16, 0
    v_mov_b32 v17, 0
    v_mov_b32 v18, 0
    v_mov_b32 v19, 0
    s_add_u32 s58, s58, 4
    s_mov_b32 s70, 1
    s_waitcnt vmcnt(0) lgkmcnt(0)
    s_barrier
    ds_read_b128 v[64:67], v2 offset:0
    ds_read_b128 v[68:71], v2 offset:1024
    ds_read_b128 v[72:75], v2 offset:2048
    ds_read_b128 v[76:79], v2 offset:3072
    ds_read_b128 v[80:83], v2 offset:4096
    ds_read_b128 v[84:87], v2 offset:5120
    ds_read_b128 v[88:91], v2 offset:6144
    ds_read_b128 v[92:95], v2 offset:7168
    ds_read_b128 v[96:99], v2 offset:8192
    ds_read_b128 v[100:103], v2 offset:9216
    ds_read_b128 v[104:107], v2 offset:10240
    ds_read_b128 v[108:111], v2 offset:11264
    s_waitcnt lgkmcnt(11)
    v_smfmac_f32_16x16x64_bf16 v[16:19], v[64:67], a[0:7], v3
    ds_read_b128 v[112:115], v2 offset:12288
    s_waitcnt lgkmcnt(11)
    v_smfmac_f32_16x16x64_bf16 v[16:19], v[68:71], a[8:15], v3
    ds_read_b128 v[116:119], v2 offset:13312
    s_waitcnt lgkmcnt(11)
    v_smfmac_f32_16x16x64_bf16 v[16:19], v[72:75], a[16:23], v3
    ds_read_b128 v[120:123], v2 offset:14336
    s_waitcnt lgkmcnt(11)
    v_smfmac_f32_16x16x64_bf16 v[16:19], v[76:79], a[24:31], v3
    ds_read_b128 v[124:127], v2 offset:15360
    s_waitcnt lgkmcnt(11)
    v_smfmac_f32_16x16x64_bf16 v[16:19], v[80:83], a[32:39], v3
    s_waitcnt lgkmcnt(10)
    v_smfmac_f32_16x16x64_bf16 v[16:19], v[84:87], a[40:47], v3
    s_waitcnt lgkmcnt(9)
    v_smfmac_f32_16x16x64_bf16 v[16:19], v[88:91], a[48:55], v3
    s_waitcnt lgkmcnt(8)
    v_smfmac_f32_16x16x64_bf16 v[16:19], v[92:95], a[56:63], v3
    s_waitcnt lgkmcnt(7)
    v_smfmac_f32_16x16x64_bf16 v[16:19], v[96:99], a[64:71], v3
    s_waitcnt lgkmcnt(6)
    v_smfmac_f32_16x16x64_bf16 v[16:19], v[100:103], a[72:79], v3
    s_waitcnt lgkmcnt(5)
    v_smfmac_f32_16x16x64_bf16 v[16:19], v[104:107], a[80:87], v3
    s_waitcnt lgkmcnt(4)
    v_smfmac_f32_16x16x64_bf16 v[16:19], v[108:111], a[88:95], v3
    s_waitcnt lgkmcnt(3)
    v_smfmac_f32_16x16x64_bf16 v[16:19], v[112:115], a[96:103], v3
    s_waitcnt lgkmcnt(2)
    v_smfmac_f32_16x16x64_bf16 v[16:19], v[116:119], a[104:111], v3
    s_waitcnt lgkmcnt(1)
    v_smfmac_f32_16x16x64_bf16 v[16:19], v[120:123], a[112:119], v3
    s_waitcnt lgkmcnt(0)
    v_smfmac_f32_16x16x64_bf16 v[16:19], v[124:127], a[120:127], v3
    s_nop 7
    v_permlane32_swap_b32 v16, v18
    v_permlane32_swap_b32 v17, v19
    v_add_f32 v16, v16, v18
    v_add_f32 v17, v17, v19
    v_cvt_pk_bf16_f32 v16, v16, v17
    ds_write_b16 v5, v16
    ds_write_b16_d16_hi v5, v16 offset:16
    s_mov_b64 exec, 1
    ds_add_u32 v29, v30
    s_mov_b64 exec, -1
L_s_xl_224:
    ds_read_b32 v10, v29
    ds_read_b128 v[64:67], v2 offset:61440
    s_cmp_eq_u32 s60, 63
    s_cbranch_scc1 L_s_last_223
    s_cmp_ge_u32 s44, 2
    s_cbranch_scc1 L_s_w2_225
    s_waitcnt lgkmcnt(0)
    v_mfma_f32_16x16x32_bf16 v[16:19], v[32:35], v[64:67], 0
L_s_w2_225_b:
    v_cmp_ne_u32 vcc, s58, v10
    s_nop 0
    s_cbranch_vccnz L_rt_227
    s_mov_b64 exec, s[50:51]
    s_nop 3
    v_cvt_pk_bf16_f32 v16, v16, v17
    v_cvt_pk_bf16_f32 v17, v18, v19
    v_pk_min_u16 v16, v16, v54
    v_pk_min_u16 v17, v17, v54
    buffer_store_dwordx2 v[16:17], v4, s[12:15], s61 offen sc1
    s_mov_b64 exec, -1
L_s_w3_226_b:
    s_sleep 5
    s_mov_b32 s70, 1
L_s_xp_229:
    buffer_load_dwordx2 v[64:65], v7, s[12:15], s61 offen offset:0 sc1
    buffer_load_short_d16_hi v56, v28, s[12:15], s61 offen offset:0 sc1
    buffer_load_dwordx2 v[66:67], v7, s[12:15], s61 offen offset:512 sc1
    buffer_load_short_d16_hi v57, v28, s[12:15], s61 offen offset:128 sc1
    buffer_load_dwordx2 v[68:69], v7, s[12:15], s61 offen offset:1024 sc1
    buffer_load_short_d16_hi v58, v28, s[12:15], s61 offen offset:256 sc1
    buffer_load_dwordx2 v[70:71], v7, s[12:15], s61 offen offset:1536 sc1
    buffer_load_short_d16_hi v59, v28, s[12:15], s61 offen offset:384 sc1
L_s_xc_228_b:
    s_mov_b32 s46, 0x00003f80
    s_mov_b32 s47, 0x3f800000
    s_waitcnt vmcnt(6)
    v_dot2_f32_bf16 v16, v64, s46, 0
    v_dot2_f32_bf16 v17, v64, s47, 0
    v_dot2_f32_bf16 v18, v65, s46, 0
    v_dot2_f32_bf16 v19, v65, s47, 0
    s_waitcnt vmcnt(4)
    v_dot2_f32_bf16 v16, v66, s46, v16
    v_dot2_f32_bf16 v17, v66, s47, v17
    v_dot2_f32_bf16 v18, v67, s46, v18
    v_dot2_f32_bf16 v19, v67, s47, v19
    v_add_f32 v20, v56, v57
    s_waitcnt vmcnt(2)
    v_dot2_f32_bf16 v16, v68, s46, v16
    v_dot2_f32_bf16 v17, v68, s47, v17
    v_dot2_f32_bf16 v18, v69, s46, v18
    v_dot2_f32_bf16 v19, v69, s47, v19
    v_add_f32 v20, v20, v58
    s_waitcnt vmcnt(0)
    v_dot2_f32_bf16 v16, v70, s46, v16
    v_dot2_f32_bf16 v17, v70, s47, v17
    v_dot2_f32_bf16 v18, v71, s46, v18
    v_dot2_f32_bf16 v19, v71, s47, v19
    v_add_f32 v20, v20, v59
    s_nop 0
    v_cmp_u_f32 s[46:47], v16, v17
    v_cmp_u_f32 s[48:49], v18, v19
    v_cmp_u_f32 vcc, v20, v20
    v_max3_f32 v10, v16, v17, v18
    s_or_b64 s[46:47], s[46:47], s[48:49]
    v_max3_f32 v10, v10, v19, v20
    s_or_b64 vcc, vcc, s[46:47]
    s_cbranch_scc1 L_s_xf_230
L_s_xok_231:
    v_max_f32_dpp v11, v10, v10 row_ror:8 row_mask:0xf bank_mask:0xf
    v_max_f32_dpp v10, v10, v10 row_ror:8 row_mask:0xf bank_mask:0xf
    s_nop 1
    v_permlane16_swap_b32 v10, v11
    v_max_f32 v12, v10, v11
    v_max_f32 v10, v10, v11
    s_nop 1
    v_permlane32_swap_b32 v10, v12
    v_max_f32 v10, v10, v12
    v_mul_f32 v10, s66, v10
    v_fma_f32 v16, v16, s66, -v10
    v_fma_f32 v17, v17, s66, -v10
    v_fma_f32 v18, v18, s66, -v10
    v_fma_f32 v19, v19, s66, -v10
    v_fma_f32 v20, v20, s66, -v10
    v_exp_f32 v16, v16
    v_exp_f32 v17, v17
    v_exp_f32 v18, v18
    v_exp_f32 v19, v19
    v_exp_f32 v20, v20
    v_add_f32 v10, v16, v17
    v_add_f32 v11, v18, v19
    v_add_f32 v10, v10, v20
    v_add_f32 v10, v10, v11
    s_nop 1
    v_add_f32_dpp v11, v10, v10 row_ror:8 row_mask:0xf bank_mask:0xf
    v_add_f32_dpp v10, v10, v10 row_ror:8 row_mask:0xf bank_mask:0xf
    s_nop 1
    v_permlane16_swap_b32 v10, v11
    v_add_f32 v12, v10, v11
    v_add_f32 v10, v10, v11
    s_nop 1
    v_permlane32_swap_b32 v10, v12
    v_add_f32 v10, v10, v12
    v_rcp_f32 v10, v10
    s_nop 0
    v_mul_f32 v16, v16, v10
    v_mul_f32 v17, v17, v10
    v_mul_f32 v18, v18, v10
    v_mul_f32 v19, v19, v10
    v_mul_f32 v20, v20, v10
    v_cvt_pk_bf16_f32 v16, v16, v17
    v_cvt_pk_bf16_f32 v17, v18, v19
    v_cvt_pk_bf16_f32 v18, v20, v20
    ds_write_b64 v8, v[16:17]
    ds_write_b16 v9, v18
    s_waitcnt lgkmcnt(0)
    s_barrier
    s_add_u32 s63, s63, 786432
    s_cmp_ge_u32 s44, 2
    s_cbranch_scc1 L_s_nk_232
    buffer_load_dwordx4 v[32:35], v6, s[12:15], s63 offen sc1
L_s_nk_232:
    s_add_u32 s45, s60, 2
    s_cmp_le_u32 s69, s45
    s_cbranch_scc1 L_s_nk_232_w
    s_add_u32 s45, s63, 786432
    s_mov_b64 exec, 0xf
    buffer_load_dword v15, v14, s[12:15], s45 offen sc1
    s_mov_b64 exec, -1
L_s_nk_232_w:
    s_cmp_eq_u32 s44, 3
    s_cbranch_scc1 L_s_nr_233
    s_xor_b32 s45, s61, 0x8000
    s_mov_b64 exec, s[50:51]
    buffer_store_dwordx2 v[24:25], v4, s[12:15], s45 offen sc1
    s_mov_b64 exec, -1
L_s_nr_233:
    s_cmp_lg_u32 s44, 3
    s_cbranch_scc1 L_s_np_234
    ds_read_b128 v[20:23], v6
    s_lshl_b32 s45, s60, 17
    s_add_u32 s45, s45, s67
    s_waitcnt lgkmcnt(0)
    v_min_u32 v20, -2, v20
    v_min_u32 v21, -2, v21
    v_min_u32 v22, -2, v22
    v_min_u32 v23, -2, v23
    buffer_store_dwordx4 v[20:23], v2, s[12:15], s45 offen sc1
L_s_np_234:
    s_add_u32 s68, s60, 2
    s_min_u32 s68, s68, 63
    v_readlane_b32 s45, v0, 0
    v_readlane_b32 s46, v0, 1
    s_nop 0
    s_min_u32 s45, s45, s46
    s_max_u32 s69, s69, s45
    s_cmp_gt_u32 s69, s68
    s_cbranch_scc1 L_kv_ok_237
    s_mov_b32 s70, 0
L_kv_lp_236:
    v_and_b32 v22, 1, v1
    v_lshlrev_b32 v22, 9, v22
    buffer_load_dword v23, v22, s[12:15], s57 offen sc1
    s_waitcnt vmcnt(0)
    v_readlane_b32 s69, v23, 0
    v_readlane_b32 s45, v23, 1
    s_add_u32 s70, s70, 1
    s_nop 2
    s_min_u32 s69, s69, s45
    s_cmp_gt_u32 s69, s68
    s_cbranch_scc1 L_kv_ok_237
    s_sleep 4
    s_cmp_lt_u32 s70, 524288
    s_cbranch_scc1 L_kv_lp_236
    s_branch L_c_done_1
L_kv_ok_237:
    s_add_u32 s45, s60, 7
    s_min_u32 s45, s45, 63
    s_cmp_gt_u32 s69, s45
    s_cbranch_scc1 L_s_na_235
    v_and_b32 v22, 1, v1
    v_lshlrev_b32 v22, 9, v22
    buffer_load_dword v0, v22, s[12:15], s57 offen sc1
L_s_na_235:
    s_sub_u32 s45, s60, 4
    s_cmp_gt_u32 s45, 24
    s_cbranch_scc1 L_s_xe_238
    s_sleep 1
    s_setprio 0
    s_bitcmp1_b32 s45, 0
    s_cbranch_scc1 L_s_x1_239
    s_cmp_eq_u32 s45, 0
    s_cbranch_scc1 L_s_x0_240
    s_bitcmp1_b32 s44, 0
    s_cbranch_scc1 L_s_x0_240
    ds_read_b128 v[40:43], v31
    s_sub_u32 s46, s45, 2
    s_lshr_b32 s47, s46, 2
    s_mul_i32 s47, s47, 786432
    s_and_b32 s46, s46, 2
    s_lshl_b32 s46, s46, 11
    s_add_u32 s47, s47, s46
    s_waitcnt lgkmcnt(0)
    buffer_store_dwordx4 v[40:43], v13, s[12:15], s47 offen sc1
L_s_x0_240:
    s_cmp_eq_u32 s45, 24
    s_cbranch_scc1 L_s_xe_238
    ds_read_b128 v[64:67], v44 offset:0
    ds_read_b128 v[68:71], v44 offset:1024
    ds_read_b128 v[72:75], v44 offset:2048
    ds_read_b128 v[76:79], v44 offset:3072
    ds_read_b128 v[80:83], v44 offset:4096
    ds_read_b128 v[84:87], v44 offset:5120
    ds_read_b128 v[88:91], v44 offset:6144
    ds_read_b128 v[92:95], v44 offset:7168
    ds_read_b128 v[96:99], v44 offset:8192
    ds_read_b128 v[100:103], v44 offset:9216
    ds_read_b128 v[104:107], v44 offset:10240
    ds_read_b128 v[108:111], v44 offset:11264
    s_waitcnt lgkmcnt(11)
    v_mfma_f32_16x16x32_bf16 v[36:39], a[0:3], v[64:67], 0
    ds_read_b128 v[112:115], v44 offset:12288
    s_waitcnt lgkmcnt(11)
    v_mfma_f32_16x16x32_bf16 v[36:39], a[4:7], v[68:71], v[36:39]
    ds_read_b128 v[116:119], v44 offset:13312
    s_waitcnt lgkmcnt(11)
    v_mfma_f32_16x16x32_bf16 v[36:39], a[8:11], v[72:75], v[36:39]
    ds_read_b128 v[120:123], v44 offset:14336
    s_waitcnt lgkmcnt(11)
    v_mfma_f32_16x16x32_bf16 v[36:39], a[12:15], v[76:79], v[36:39]
    ds_read_b128 v[124:127], v44 offset:15360
    s_waitcnt lgkmcnt(11)
    v_mfma_f32_16x16x32_bf16 v[36:39], a[16:19], v[80:83], v[36:39]
    s_waitcnt lgkmcnt(10)
    v_mfma_f32_16x16x32_bf16 v[36:39], a[20:23], v[84:87], v[36:39]
    s_waitcnt lgkmcnt(9)
    v_mfma_f32_16x16x32_bf16 v[36:39], a[24:27], v[88:91], v[36:39]
    s_waitcnt lgkmcnt(8)
    v_mfma_f32_16x16x32_bf16 v[36:39], a[28:31], v[92:95], v[36:39]
    s_waitcnt lgkmcnt(7)
    v_mfma_f32_16x16x32_bf16 v[36:39], a[32:35], v[96:99], v[36:39]
    s_waitcnt lgkmcnt(6)
    v_mfma_f32_16x16x32_bf16 v[36:39], a[36:39], v[100:103], v[36:39]
    s_waitcnt lgkmcnt(5)
    v_mfma_f32_16x16x32_bf16 v[36:39], a[40:43], v[104:107], v[36:39]
    s_waitcnt lgkmcnt(4)
    v_mfma_f32_16x16x32_bf16 v[36:39], a[44:47], v[108:111], v[36:39]
    s_waitcnt lgkmcnt(3)
    v_mfma_f32_16x16x32_bf16 v[36:39], a[48:51], v[112:115], v[36:39]
    s_waitcnt lgkmcnt(2)
    v_mfma_f32_16x16x32_bf16 v[36:39], a[52:55], v[116:119], v[36:39]
    s_waitcnt lgkmcnt(1)
    v_mfma_f32_16x16x32_bf16 v[36:39], a[56:59], v[120:123], v[36:39]
    s_waitcnt lgkmcnt(0)
    v_mfma_f32_16x16x32_bf16 v[36:39], a[60:63], v[124:127], v[36:39]
    s_branch L_s_xe_238
L_s_x1_239:
    ds_read_b128 v[64:67], v44 offset:16384
    ds_read_b128 v[68:71], v44 offset:17408
    ds_read_b128 v[72:75], v44 offset:18432
    ds_read_b128 v[76:79], v44 offset:19456
    ds_read_b128 v[80:83], v44 offset:20480
    ds_read_b128 v[84:87], v44 offset:21504
    ds_read_b128 v[88:91], v44 offset:22528
    ds_read_b128 v[92:95], v44 offset:23552
    ds_read_b128 v[96:99], v44 offset:24576
    ds_read_b128 v[100:103], v44 offset:25600
    ds_read_b128 v[104:107], v44 offset:26624
    ds_read_b128 v[108:111], v44 offset:27648
    s_waitcnt lgkmcnt(11)
    v_mfma_f32_16x16x32_bf16 v[36:39], a[64:67], v[64:67], v[36:39]
    ds_read_b128 v[112:115], v44 offset:28672
    s_waitcnt lgkmcnt(11)
    v_mfma_f32_16x16x32_bf16 v[36:39], a[68:71], v[68:71], v[36:39]
    ds_read_b128 v[116:119], v44 offset:29696
    s_waitcnt lgkmcnt(11)
    v_mfma_f32_16x16x32_bf16 v[36:39], a[72:75], v[72:75], v[36:39]
    ds_read_b128 v[120:123], v44 offset:30720
    s_waitcnt lgkmcnt(11)
    v_mfma_f32_16x16x32_bf16 v[36:39], a[76:79], v[76:79], v[36:39]
    ds_read_b128 v[124:127], v44 offset:31744
    s_waitcnt lgkmcnt(11)
    v_mfma_f32_16x16x32_bf16 v[36:39], a[80:83], v[80:83], v[36:39]
    s_waitcnt lgkmcnt(10)
    v_mfma_f32_16x16x32_bf16 v[36:39], a[84:87], v[84:87], v[36:39]
    s_waitcnt lgkmcnt(9)
    v_mfma_f32_16x16x32_bf16 v[36:39], a[88:91], v[88:91], v[36:39]
    s_waitcnt lgkmcnt(8)
    v_mfma_f32_16x16x32_bf16 v[36:39], a[92:95], v[92:95], v[36:39]
    s_waitcnt lgkmcnt(7)
    v_mfma_f32_16x16x32_bf16 v[36:39], a[96:99], v[96:99], v[36:39]
    s_waitcnt lgkmcnt(6)
    v_mfma_f32_16x16x32_bf16 v[36:39], a[100:103], v[100:103], v[36:39]
    s_waitcnt lgkmcnt(5)
    v_mfma_f32_16x16x32_bf16 v[36:39], a[104:107], v[104:107], v[36:39]
    s_waitcnt lgkmcnt(4)
    v_mfma_f32_16x16x32_bf16 v[36:39], a[108:111], v[108:111], v[36:39]
    s_waitcnt lgkmcnt(3)
    v_mfma_f32_16x16x32_bf16 v[36:39], a[112:115], v[112:115], v[36:39]
    s_waitcnt lgkmcnt(2)
    v_mfma_f32_16x16x32_bf16 v[36:39], a[116:119], v[116:119], v[36:39]
    s_waitcnt lgkmcnt(1)
    v_mfma_f32_16x16x32_bf16 v[36:39], a[120:123], v[120:123], v[36:39]
    s_waitcnt lgkmcnt(0)
    v_mfma_f32_16x16x32_bf16 v[36:39], a[124:127], v[124:127], v[36:39]
    s_nop 7
    v_cvt_pk_bf16_f32 v40, v36, v37
    v_cvt_pk_bf16_f32 v41, v38, v39
    ds_write_b64 v45, v[40:41]
    s_waitcnt lgkmcnt(0)
L_s_xe_238:
    s_setprio 1
    s_add_u32 s60, s60, 1
    s_add_u32 s61, s61, 0x4000
    s_and_b32 s61, s61, 0xffff
    s_branch L_s_loop_222
L_s_last_223:
    s_waitcnt lgkmcnt(0)
    s_barrier
    s_cmp_lg_u32 s44, 3
    s_cbranch_scc1 L_s_np_241
    ds_read_b128 v[20:23], v6
    s_lshl_b32 s45, s60, 17
    s_add_u32 s45, s45, s67
    s_waitcnt lgkmcnt(0)
    v_min_u32 v20, -2, v20
    v_min_u32 v21, -2, v21
    v_min_u32 v22, -2, v22
    v_min_u32 v23, -2, v23
    buffer_store_dwordx4 v[20:23], v2, s[12:15], s45 offen sc1
L_s_np_241:
    s_branch L_replica
L_rt_227:
    s_add_u32 s70, s70, 1
    s_cmp_lt_u32 s70, 524288
    s_cbranch_scc1 L_s_xl_224
    s_branch L_c_done_1
L_s_w2_225:
    s_cmp_eq_u32 s44, 3
    s_cbranch_scc1 L_s_w3_226
    s_waitcnt lgkmcnt(0)
    v_mfma_f32_16x16x32_bf16 v[16:19], v[64:67], v[64:67], 0
    s_branch L_s_w2_225_b
L_s_w3_226:
    s_sleep 3
    s_branch L_s_w3_226_b
L_s_xf_230:
    v_or_b32 v72, 0xffff, v56
    v_or_b32 v73, 0xffff, v57
    v_or_b32 v74, 0xffff, v58
    v_or_b32 v75, 0xffff, v59
    v_max3_u32 v11, v64, v65, v66
    v_max3_u32 v11, v11, v67, v68
    v_max3_u32 v11, v11, v69, v70
    v_max3_u32 v11, v11, v71, v72
    v_max3_u32 v11, v11, v73, v74
    v_max_u32 v11, v11, v75
    v_cmp_eq_u32 vcc, -1, v11
    s_add_u32 s70, s70, 1
    s_cbranch_vccz L_s_xok_231
    s_cmp_lt_u32 s70, 524288
    s_cbranch_scc1 L_s_xp_229
    s_branch L_c_done_1
L_vf_200:
    s_cmp_eq_u32 s52, 0
    s_cbranch_scc1 L_vs_201
    s_mov_b32 s70, 1
    v_mov_b32 v16, 0
    v_mov_b32 v17, 0
    s_branch L_v_l1m_244
.p2align 6
L_v_loop_242:
    s_mov_b32 s70, 1
    buffer_load_dwordx4 v[64:67], v9, s[12:15], s61 offen offset:0 sc1
    buffer_load_dwordx4 v[68:71], v9, s[12:15], s61 offen offset:1024 sc1
    buffer_load_dwordx4 v[72:75], v9, s[12:15], s61 offen offset:2048 sc1
    buffer_load_dwordx4 v[76:79], v9, s[12:15], s61 offen offset:3072 sc1
    v_mov_b32 v16, 0
    v_mov_b32 v17, 0
    v_mov_b32 v18, 0
    v_mov_b32 v19, 0
    v_mov_b32 v20, 0
    v_mov_b32 v21, 0
    v_mov_b32 v22, 0
    v_mov_b32 v23, 0
L_v_l1m_244:
    s_waitcnt vmcnt(3)
    ds_write_b128 v10, v[64:67] offset:0
    v_max3_u32 v24, v64, v65, v66
    v_max_u32 v24, v24, v67
    v_cmp_eq_u32 s[48:49], -1, v24
    s_waitcnt vmcnt(2)
    ds_write_b128 v10, v[68:71] offset:1024
    v_max3_u32 v24, v68, v69, v70
    v_max_u32 v24, v24, v71
    v_cmp_eq_u32 s[50:51], -1, v24
    s_waitcnt vmcnt(1)
    ds_write_b128 v10, v[72:75] offset:2048
    v_max3_u32 v24, v72, v73, v74
    v_max_u32 v24, v24, v75
    v_cmp_eq_u32 s[52:53], -1, v24
    s_waitcnt vmcnt(0)
    ds_write_b128 v10, v[76:79] offset:3072
    v_max3_u32 v24, v76, v77, v78
    v_max_u32 v24, v24, v79
    v_cmp_eq_u32 s[54:55], -1, v24
    s_or_b64 s[46:47], s[48:49], s[50:51]
    s_or_b64 vcc, s[52:53], s[54:55]
    s_or_b64 vcc, vcc, s[46:47]
    s_cbranch_scc1 L_v_l1_243
L_v_l1ok_245:
    s_waitcnt lgkmcnt(0)
    s_barrier
    v_smfmac_f32_16x16x64_bf16 v[16:19], v[64:67], a[0:7], v3
    v_smfmac_f32_16x16x64_bf16 v[20:23], v[64:67], a[32:39], v3
    v_smfmac_f32_16x16x64_bf16 v[16:19], v[68:71], a[8:15], v3
    v_smfmac_f32_16x16x64_bf16 v[20:23], v[68:71], a[40:47], v3
    v_smfmac_f32_16x16x64_bf16 v[16:19], v[72:75], a[16:23], v3
    v_smfmac_f32_16x16x64_bf16 v[20:23], v[72:75], a[48:55], v3
    v_smfmac_f32_16x16x64_bf16 v[16:19], v[76:79], a[24:31], v3
    v_smfmac_f32_16x16x64_bf16 v[20:23], v[76:79], a[56:63], v3
    s_nop 6
    v_permlane32_swap_b32 v16, v18
    v_permlane32_swap_b32 v17, v19
    v_permlane32_swap_b32 v20, v22
    v_permlane32_swap_b32 v21, v23
    v_add_f32 v16, v16, v18
    v_add_f32 v17, v17, v19
    v_add_f32 v18, v20, v22
    v_add_f32 v19, v21, v23
    ds_write_b128 v14, v[16:19]
    s_mov_b64 exec, 1
    ds_add_u32 v29, v30
    s_mov_b64 exec, -1
    s_add_u32 s58, s58, 4
    s_bitcmp1_b32 s44, 0
    s_cbranch_scc1 L_v_k1_247_c
    s_mov_b32 s70, 0
L_v_rl_248:
    ds_read_b32 v24, v29
    ds_read_b64 v[16:17], v13 offset:0
    ds_read_b64 v[18:19], v13 offset:1024
    ds_read_b64 v[20:21], v13 offset:2048
    ds_read_b64 v[22:23], v13 offset:3072
    s_waitcnt lgkmcnt(2)
    v_cmp_ne_u32 vcc, s58, v24
    v_add_f32 v16, v16, v18
    v_add_f32 v17, v17, v19
    s_waitcnt lgkmcnt(0)
    s_cbranch_vccnz L_rt_249
    v_add_f32 v20, v20, v22
    v_add_f32 v21, v21, v23
    v_add_f32 v16, v16, v20
    v_add_f32 v17, v17, v21
    s_mov_b32 vcc_lo, 0x55555555
    s_mov_b32 vcc_hi, 0x55555555
    v_cndmask_b32_dpp v18, v17, v16, vcc quad_perm:[1,0,3,2] row_mask:0xf bank_mask:0xf
    s_not_b64 vcc, vcc
    v_cndmask_b32_dpp v19, v16, v17, vcc quad_perm:[1,0,3,2] row_mask:0xf bank_mask:0xf
    v_cvt_pk_bf16_f32 v18, v18, v19
    v_min_u32 v18, -2, v18
    buffer_store_dword v18, v4, s[12:15], s62 offen
    ds_write_b32 v5, v18
L_v_k1_247:
    s_cmp_eq_u32 s60, 63
    s_cbranch_scc1 L_v_last_246
    ds_read_b128 v[80:83], v27 offset:32768
    ds_read_b128 v[84:87], v27 offset:36864
    ds_read_b128 v[88:91], v27 offset:40960
    ds_read_b128 v[92:95], v27 offset:45056
    v_mov_b32 v96, 0
    v_mov_b32 v97, 0
    v_mov_b32 v98, 0
    v_mov_b32 v99, 0
    v_mov_b32 v100, 0
    v_mov_b32 v101, 0
    v_mov_b32 v102, 0
    v_mov_b32 v103, 0
    v_mov_b32 v104, 0
    v_mov_b32 v105, 0
    v_mov_b32 v106, 0
    v_mov_b32 v107, 0
    v_mov_b32 v108, 0
    v_mov_b32 v109, 0
    v_mov_b32 v110, 0
    v_mov_b32 v111, 0
    s_bitcmp1_b32 s44, 0
    s_cbranch_scc0 L_v_sv_250
    s_sleep 1
L_v_sv_250:
    s_sleep 3
    s_mov_b32 s70, 1
    buffer_load_dwordx4 v[64:67], v11, s[12:15], s62 offen offset:0 sc1
    buffer_load_dwordx4 v[68:71], v11, s[12:15], s62 offen offset:1024 sc1
L_v_vp_251_m:
    s_waitcnt vmcnt(0)
    v_max3_u32 v20, v64, v65, v66
    v_max3_u32 v20, v20, v67, v68
    v_max3_u32 v20, v20, v69, v70
    v_max_u32 v20, v20, v71
    v_cmp_eq_u32 vcc, -1, v20
    s_cbranch_vccnz L_rt_252
    v_smfmac_f32_16x16x64_bf16 v[96:99], v[64:67], a[64:71], v3
    v_smfmac_f32_16x16x64_bf16 v[96:99], v[68:71], a[72:79], v3
    v_smfmac_f32_16x16x64_bf16 v[100:103], v[64:67], a[80:87], v3
    v_smfmac_f32_16x16x64_bf16 v[100:103], v[68:71], a[88:95], v3
    v_smfmac_f32_16x16x64_bf16 v[104:107], v[64:67], a[96:103], v3
    v_smfmac_f32_16x16x64_bf16 v[104:107], v[68:71], a[104:111], v3
    v_smfmac_f32_16x16x64_bf16 v[108:111], v[64:67], a[112:119], v3
    v_smfmac_f32_16x16x64_bf16 v[108:111], v[68:71], a[120:127], v3
    s_nop 1
    v_cvt_pk_bf16_f32 v96, v96, v97
    v_cvt_pk_bf16_f32 v97, v98, v99
    ds_write_b64 v12, v[96:97] offset:0
    v_cvt_pk_bf16_f32 v100, v100, v101
    v_cvt_pk_bf16_f32 v101, v102, v103
    ds_write_b64 v12, v[100:101] offset:2048
    v_cvt_pk_bf16_f32 v104, v104, v105
    v_cvt_pk_bf16_f32 v105, v106, v107
    ds_write_b64 v12, v[104:105] offset:4096
    v_cvt_pk_bf16_f32 v108, v108, v109
    v_cvt_pk_bf16_f32 v109, v110, v111
    ds_write_b64 v12, v[108:109] offset:6144
    s_bitcmp1_b32 s44, 0
    s_cbranch_scc1 L_v_r8_253
L_v_r8_253_l:
    s_add_u32 s46, s65, 4096
    buffer_load_dwordx4 v[32:35], v15, s[12:15], s65 offen offset:0 sc1
    buffer_load_dwordx4 v[48:51], v15, s[12:15], s46 offen offset:0 sc1
    buffer_load_dwordx4 v[36:39], v15, s[12:15], s65 offen offset:1024 sc1
    buffer_load_dwordx4 v[52:55], v15, s[12:15], s46 offen offset:1024 sc1
    buffer_load_dwordx4 v[40:43], v15, s[12:15], s65 offen offset:2048 sc1
    buffer_load_dwordx4 v[56:59], v15, s[12:15], s46 offen offset:2048 sc1
    buffer_load_dwordx4 v[44:47], v15, s[12:15], s65 offen offset:3072 sc1
    buffer_load_dwordx4 v[60:63], v15, s[12:15], s46 offen offset:3072 sc1
    s_add_u32 s65, s65, 786432
L_v_r8_253:
    s_cmp_eq_u32 s60, 0
    s_cbranch_scc1 L_v_vt_254
L_v_vt_254_b:
    s_waitcnt lgkmcnt(0)
    s_barrier
    ds_read_b128 v[96:99], v2 offset:16384
    ds_read_b128 v[100:103], v2 offset:17408
    ds_read_b128 v[104:107], v2 offset:18432
    ds_read_b128 v[108:111], v2 offset:19456
    ds_read_b128 v[112:115], v31 offset:0
    ds_read_b128 v[116:119], v25 offset:0
    ds_read_b128 v[120:123], v31 offset:512
    ds_read_b128 v[124:127], v25 offset:1024
    s_waitcnt lgkmcnt(7)
    v_mfma_f32_16x16x32_bf16 v[16:19], v[80:83], v[96:99], 0
    s_waitcnt lgkmcnt(6)
    v_mfma_f32_16x16x32_bf16 v[16:19], v[84:87], v[100:103], v[16:19]
    s_waitcnt lgkmcnt(5)
    v_mfma_f32_16x16x32_bf16 v[16:19], v[88:91], v[104:107], v[16:19]
    s_waitcnt lgkmcnt(4)
    v_mfma_f32_16x16x32_bf16 v[16:19], v[92:95], v[108:111], v[16:19]
    s_waitcnt lgkmcnt(2)
    v_mfma_f32_16x16x32_bf16 v[16:19], v[116:119], v[112:115], v[16:19]
    s_waitcnt lgkmcnt(0)
    v_mfma_f32_16x16x32_bf16 v[16:19], v[124:127], v[120:123], v[16:19]
    s_mov_b32 exec_lo, 0x00ff00ff
    s_mov_b32 exec_hi, 0x00ff00ff
    s_nop 5
    v_cvt_pk_bf16_f32 v16, v16, v17
    v_cvt_pk_bf16_f32 v17, v18, v19
    v_min_u32 v16, -2, v16
    v_min_u32 v17, -2, v17
    buffer_store_dwordx2 v[16:17], v6, s[12:15], s63 offen sc1
    s_mov_b64 exec, -1
    s_waitcnt vmcnt(1)
    s_sub_u32 s45, s60, 3
    s_cmp_ge_u32 s45, 24
    s_cbranch_scc1 L_v_nx_255_s
    s_cmp_eq_u32 s45, 0
    s_cbranch_scc1 L_v_fl_256
L_v_fl_256_b:
    s_and_b32 s46, s45, 1
    s_lshl_b32 s47, s46, 14
    s_add_u32 s47, s47, s59
    s_lshl_b32 s46, s46, 15
    s_lshr_b32 s48, s45, 2
    s_lshl_b32 s48, s48, 16
    s_add_u32 s46, s46, s48
    s_and_b32 s48, s45, 2
    s_lshl_b32 s48, s48, 7
    s_add_u32 s46, s46, s48
    s_add_u32 m0, s47, 0
    s_add_u32 s48, s46, 0
    buffer_load_dwordx4 v28, s[12:15], s48 offen sc1 lds
    s_add_u32 m0, s47, 1024
    s_add_u32 s48, s46, 2048
    buffer_load_dwordx4 v28, s[12:15], s48 offen sc1 lds
    s_add_u32 m0, s47, 2048
    s_add_u32 s48, s46, 4096
    buffer_load_dwordx4 v28, s[12:15], s48 offen sc1 lds
    s_add_u32 m0, s47, 3072
    s_add_u32 s48, s46, 6144
    buffer_load_dwordx4 v28, s[12:15], s48 offen sc1 lds
L_v_nx_255:
    s_add_u32 s61, s61, 0x4000
    s_and_b32 s61, s61, 0xffff
    s_mov_b32 s70, 1
    s_sleep 5
    buffer_load_dword v96, v7, s[12:15], s63 offen offset:0 sc1
    buffer_load_dword v97, v7, s[12:15], s63 offen offset:256 sc1
    buffer_load_dword v98, v7, s[12:15], s63 offen offset:512 sc1
    buffer_load_dword v99, v7, s[12:15], s63 offen offset:768 sc1
    buffer_load_dword v100, v7, s[12:15], s63 offen offset:1024 sc1
    buffer_load_dword v101, v7, s[12:15], s63 offen offset:1280 sc1
    buffer_load_dword v102, v7, s[12:15], s63 offen offset:1536 sc1
    buffer_load_dword v103, v7, s[12:15], s63 offen offset:1792 sc1
    v_mfma_f32_16x16x32_bf16 v[64:67], v[32:35], a[64:67], 0
    v_mfma_f32_16x16x32_bf16 v[68:71], v[48:51], a[64:67], 0
    v_mfma_f32_16x16x32_bf16 v[64:67], v[36:39], a[68:71], v[64:67]
    v_mfma_f32_16x16x32_bf16 v[68:71], v[52:55], a[68:71], v[68:71]
    v_mfma_f32_16x16x32_bf16 v[64:67], v[40:43], a[72:75], v[64:67]
    v_mfma_f32_16x16x32_bf16 v[68:71], v[56:59], a[72:75], v[68:71]
    v_mfma_f32_16x16x32_bf16 v[64:67], v[44:47], a[76:79], v[64:67]
    v_mfma_f32_16x16x32_bf16 v[68:71], v[60:63], a[76:79], v[68:71]
    v_mfma_f32_16x16x32_bf16 v[72:75], v[32:35], a[80:83], 0
    v_mfma_f32_16x16x32_bf16 v[76:79], v[48:51], a[80:83], 0
    v_mfma_f32_16x16x32_bf16 v[72:75], v[36:39], a[84:87], v[72:75]
    v_mfma_f32_16x16x32_bf16 v[76:79], v[52:55], a[84:87], v[76:79]
    v_mfma_f32_16x16x32_bf16 v[72:75], v[40:43], a[88:91], v[72:75]
    v_mfma_f32_16x16x32_bf16 v[76:79], v[56:59], a[88:91], v[76:79]
    v_mfma_f32_16x16x32_bf16 v[72:75], v[44:47], a[92:95], v[72:75]
    v_mfma_f32_16x16x32_bf16 v[76:79], v[60:63], a[92:95], v[76:79]
    v_cvt_pk_bf16_f32 v64, v64, v65
    v_cvt_pk_bf16_f32 v65, v66, v67
    v_cvt_pk_bf16_f32 v66, v68, v69
    v_cvt_pk_bf16_f32 v67, v70, v71
    ds_write_b128 v10, v[64:67] offset:32768
    v_mfma_f32_16x16x32_bf16 v[80:83], v[32:35], a[96:99], 0
    v_mfma_f32_16x16x32_bf16 v[84:87], v[48:51], a[96:99], 0
    v_mfma_f32_16x16x32_bf16 v[80:83], v[36:39], a[100:103], v[80:83]
    v_mfma_f32_16x16x32_bf16 v[84:87], v[52:55], a[100:103], v[84:87]
    v_mfma_f32_16x16x32_bf16 v[80:83], v[40:43], a[104:107], v[80:83]
    v_mfma_f32_16x16x32_bf16 v[84:87], v[56:59], a[104:107], v[84:87]
    v_mfma_f32_16x16x32_bf16 v[80:83], v[44:47], a[108:111], v[80:83]
    v_mfma_f32_16x16x32_bf16 v[84:87], v[60:63], a[108:111], v[84:87]
    v_cvt_pk_bf16_f32 v72, v72, v73
    v_cvt_pk_bf16_f32 v73, v74, v75
    v_cvt_pk_bf16_f32 v74, v76, v77
    v_cvt_pk_bf16_f32 v75, v78, v79
    ds_write_b128 v10, v[72:75] offset:33792
L_v_gp_257:
    s_waitcnt vmcnt(7)
    v_lshlrev_b32 v20, 16, v96
    v_and_b32 v21, 0xffff0000, v96
    s_waitcnt vmcnt(6)
    v_lshlrev_b32 v22, 16, v97
    v_and_b32 v23, 0xffff0000, v97
    v_add_f32 v20, v20, v22
    v_add_f32 v21, v21, v23
    s_waitcnt vmcnt(5)
    v_lshlrev_b32 v22, 16, v98
    v_and_b32 v23, 0xffff0000, v98
    v_add_f32 v20, v20, v22
    v_add_f32 v21, v21, v23
    s_waitcnt vmcnt(4)
    v_lshlrev_b32 v22, 16, v99
    v_and_b32 v23, 0xffff0000, v99
    v_add_f32 v20, v20, v22
    v_add_f32 v21, v21, v23
    s_waitcnt vmcnt(3)
    v_lshlrev_b32 v22, 16, v100
    v_and_b32 v23, 0xffff0000, v100
    v_add_f32 v20, v20, v22
    v_add_f32 v21, v21, v23
    s_waitcnt vmcnt(2)
    v_lshlrev_b32 v22, 16, v101
    v_and_b32 v23, 0xffff0000, v101
    v_add_f32 v20, v20, v22
    v_add_f32 v21, v21, v23
    s_waitcnt vmcnt(1)
    v_lshlrev_b32 v22, 16, v102
    v_and_b32 v23, 0xffff0000, v102
    v_add_f32 v20, v20, v22
    v_add_f32 v21, v21, v23
    s_waitcnt vmcnt(0)
    v_lshlrev_b32 v22, 16, v103
    v_and_b32 v23, 0xffff0000, v103
    v_add_f32 v20, v20, v22
    v_add_f32 v21, v21, v23
    v_cmp_u_f32 vcc, v20, v21
    v_cvt_pk_bf16_f32 v20, v20, v21
    s_cbranch_vccnz L_v_gf_259
L_v_gok_258:
    buffer_store_dword v20, v8, s[12:15], s61 offen
    s_xor_b32 s45, s61, 0x8000
    buffer_store_dword v26, v8, s[12:15], s45 offen
    s_bitcmp1_b32 s44, 0
    s_cbranch_scc1 L_v_nr_260
    s_xor_b32 s45, s62, 0x4000
    buffer_store_dword v26, v4, s[12:15], s45 offen
L_v_nr_260:
    s_add_u32 s60, s60, 1
    s_add_u32 s62, s62, 0x2000
    s_and_b32 s62, s62, 0x7fff
    s_and_b32 s45, s60, 0x38
    s_bitcmp1_b64 s[66:67], s45
    s_cselect_b32 s45, 8192, 0
    s_lshl_b32 s63, s60, 18
    s_add_u32 s63, s63, s45
    v_mfma_f32_16x16x32_bf16 v[88:91], v[32:35], a[112:115], 0
    v_mfma_f32_16x16x32_bf16 v[92:95], v[48:51], a[112:115], 0
    v_mfma_f32_16x16x32_bf16 v[88:91], v[36:39], a[116:119], v[88:91]
    v_mfma_f32_16x16x32_bf16 v[92:95], v[52:55], a[116:119], v[92:95]
    v_mfma_f32_16x16x32_bf16 v[88:91], v[40:43], a[120:123], v[88:91]
    v_mfma_f32_16x16x32_bf16 v[92:95], v[56:59], a[120:123], v[92:95]
    v_mfma_f32_16x16x32_bf16 v[88:91], v[44:47], a[124:127], v[88:91]
    v_mfma_f32_16x16x32_bf16 v[92:95], v[60:63], a[124:127], v[92:95]
    v_cvt_pk_bf16_f32 v80, v80, v81
    v_cvt_pk_bf16_f32 v81, v82, v83
    v_cvt_pk_bf16_f32 v82, v84, v85
    v_cvt_pk_bf16_f32 v83, v86, v87
    ds_write_b128 v10, v[80:83] offset:34816
    s_nop 2
    v_cvt_pk_bf16_f32 v88, v88, v89
    v_cvt_pk_bf16_f32 v89, v90, v91
    v_cvt_pk_bf16_f32 v90, v92, v93
    v_cvt_pk_bf16_f32 v91, v94, v95
    ds_write_b128 v10, v[88:91] offset:35840
    s_sleep 3
    s_branch L_v_loop_242
L_v_last_246:
    s_waitcnt lgkmcnt(0)
    s_barrier
    s_branch L_replica
L_v_l1_243:
    s_mov_b64 exec, s[48:49]
    s_cbranch_execz L_v_ls_261
    buffer_load_dwordx4 v[64:67], v9, s[12:15], s61 offen offset:0 sc1
L_v_ls_261:
    s_mov_b64 exec, s[50:51]
    s_cbranch_execz L_v_ls_262
    buffer_load_dwordx4 v[68:71], v9, s[12:15], s61 offen offset:1024 sc1
L_v_ls_262:
    s_mov_b64 exec, s[52:53]
    s_cbranch_execz L_v_ls_263
    buffer_load_dwordx4 v[72:75], v9, s[12:15], s61 offen offset:2048 sc1
L_v_ls_263:
    s_mov_b64 exec, s[54:55]
    s_cbranch_execz L_v_ls_264
    buffer_load_dwordx4 v[76:79], v9, s[12:15], s61 offen offset:3072 sc1
L_v_ls_264:
    s_mov_b64 exec, -1
    s_add_u32 s70, s70, 1
    s_cmp_ge_u32 s70, 524288
    s_cbranch_scc1 L_c_done_1
    s_waitcnt vmcnt(0)
    s_cmp_eq_u64 s[48:49], 0
    s_cbranch_scc1 L_v_lc_265
    ds_write_b128 v10, v[64:67] offset:0
    v_max3_u32 v24, v64, v65, v66
    v_max_u32 v24, v24, v67
    v_cmp_eq_u32 s[48:49], -1, v24
L_v_lc_265:
    s_cmp_eq_u64 s[50:51], 0
    s_cbranch_scc1 L_v_lc_266
    ds_write_b128 v10, v[68:71] offset:1024
    v_max3_u32 v24, v68, v69, v70
    v_max_u32 v24, v24, v71
    v_cmp_eq_u32 s[50:51], -1, v24
L_v_lc_266:
    s_cmp_eq_u64 s[52:53], 0
    s_cbranch_scc1 L_v_lc_267
    ds_write_b128 v10, v[72:75] offset:2048
    v_max3_u32 v24, v72, v73, v74
    v_max_u32 v24, v24, v75
    v_cmp_eq_u32 s[52:53], -1, v24
L_v_lc_267:
    s_cmp_eq_u64 s[54:55], 0
    s_cbranch_scc1 L_v_lc_268
    ds_write_b128 v10, v[76:79] offset:3072
    v_max3_u32 v24, v76, v77, v78
    v_max_u32 v24, v24, v79
    v_cmp_eq_u32 s[54:55], -1, v24
L_v_lc_268:
    s_or_b64 s[46:47], s[48:49], s[50:51]
    s_or_b64 vcc, s[52:53], s[54:55]
    s_or_b64 vcc, vcc, s[46:47]
    s_cbranch_scc1 L_v_l1_243
    s_branch L_v_l1ok_245
L_v_k1_247_c:
    s_add_u32 s46, s65, 4096
    buffer_load_dwordx4 v[32:35], v15, s[12:15], s65 offen offset:0 sc1
    buffer_load_dwordx4 v[48:51], v15, s[12:15], s46 offen offset:0 sc1
    buffer_load_dwordx4 v[36:39], v15, s[12:15], s65 offen offset:1024 sc1
    buffer_load_dwordx4 v[52:55], v15, s[12:15], s46 offen offset:1024 sc1
    buffer_load_dwordx4 v[40:43], v15, s[12:15], s65 offen offset:2048 sc1
    buffer_load_dwordx4 v[56:59], v15, s[12:15], s46 offen offset:2048 sc1
    buffer_load_dwordx4 v[44:47], v15, s[12:15], s65 offen offset:3072 sc1
    buffer_load_dwordx4 v[60:63], v15, s[12:15], s46 offen offset:3072 sc1
    s_add_u32 s65, s65, 786432
    s_branch L_v_k1_247
L_rt_249:
    s_add_u32 s70, s70, 1
    s_cmp_lt_u32 s70, 524288
    s_cbranch_scc1 L_v_rl_248
    s_branch L_c_done_1
L_v_vp_251:
    buffer_load_dwordx4 v[64:67], v11, s[12:15], s62 offen offset:0 sc1
    buffer_load_dwordx4 v[68:71], v11, s[12:15], s62 offen offset:1024 sc1
    s_branch L_v_vp_251_m
L_rt_252:
    s_add_u32 s70, s70, 1
    s_cmp_lt_u32 s70, 524288
    s_cbranch_scc1 L_v_vp_251
    s_branch L_c_done_1
L_v_vt_254:
    v_lshrrev_b32 v22, 3, v1
    v_lshlrev_b32 v22, 7, v22
    s_mov_b32 s45, 0x101800
    s_mov_b32 s46, 0
    s_mov_b32 s70, 0
L_spin_269:
    buffer_load_dword v23, v22, s[12:15], s45 offen sc1
    s_waitcnt vmcnt(0)
    v_cmp_ge_u32 vcc, s46, v23
    s_add_u32 s70, s70, 1
    s_cbranch_vccz L_spok_270
    s_sleep 3
    s_cmp_lt_u32 s70, 524288
    s_cbranch_scc1 L_spin_269
    s_branch L_c_done_1
L_spok_270:
    v_cmp_eq_u32 s[66:67], 3, v23
    s_nop 3
    s_bitcmp1_b32 s66, 0
    s_cselect_b32 s45, 8192, 0
    s_add_u32 s63, s63, s45
    s_branch L_v_vt_254_b
L_v_fl_256:
    v_and_b32 v22, 31, v1
    v_lshlrev_b32 v22, 7, v22
    s_mov_b32 s46, 0x109400
    s_mov_b32 s47, 56
    s_mov_b32 s70, 0
L_spin_271:
    buffer_load_dword v23, v22, s[12:15], s46 offen sc1
    s_waitcnt vmcnt(0)
    v_cmp_ge_u32 vcc, s47, v23
    s_add_u32 s70, s70, 1
    s_cbranch_vccz L_spok_272
    s_sleep 3
    s_cmp_lt_u32 s70, 524288
    s_cbranch_scc1 L_spin_271
    s_branch L_c_done_1
L_spok_272:
    s_branch L_v_fl_256_b
L_v_nx_255_s:
    s_sleep 2
    s_branch L_v_nx_255
L_v_gf_259:
    v_max3_u32 v24, v96, v97, v98
    v_max3_u32 v24, v24, v99, v100
    v_max3_u32 v24, v24, v101, v102
    v_max_u32 v24, v24, v103
    v_cmp_eq_u32 vcc, -1, v24
    v_min_u32 v20, -2, v20
    s_add_u32 s70, s70, 1
    s_cbranch_vccz L_v_gok_258
    buffer_load_dword v96, v7, s[12:15], s63 offen offset:0 sc1
    buffer_load_dword v97, v7, s[12:15], s63 offen offset:256 sc1
    buffer_load_dword v98, v7, s[12:15], s63 offen offset:512 sc1
    buffer_load_dword v99, v7, s[12:15], s63 offen offset:768 sc1
    buffer_load_dword v100, v7, s[12:15], s63 offen offset:1024 sc1
    buffer_load_dword v101, v7, s[12:15], s63 offen offset:1280 sc1
    buffer_load_dword v102, v7, s[12:15], s63 offen offset:1536 sc1
    buffer_load_dword v103, v7, s[12:15], s63 offen offset:1792 sc1
    s_cmp_lt_u32 s70, 524288
    s_cbranch_scc1 L_v_gp_257
    s_branch L_c_done_1
L_vs_201:
    s_mov_b32 s70, 1
    v_mov_b32 v16, 0
    v_mov_b32 v17, 0
    s_branch L_v_l1m_275
.p2align 6
L_v_loop_273:
    s_mov_b32 s70, 1
    buffer_load_dwordx4 v[64:67], v9, s[12:15], s61 offen offset:0 sc1
    buffer_load_dwordx4 v[68:71], v9, s[12:15], s61 offen offset:1024 sc1
    buffer_load_dwordx4 v[72:75], v9, s[12:15], s61 offen offset:2048 sc1
    buffer_load_dwordx4 v[76:79], v9, s[12:15], s61 offen offset:3072 sc1
    v_mov_b32 v16, 0
    v_mov_b32 v17, 0
    v_mov_b32 v18, 0
    v_mov_b32 v19, 0
    v_mov_b32 v20, 0
    v_mov_b32 v21, 0
    v_mov_b32 v22, 0
    v_mov_b32 v23, 0
L_v_l1m_275:
    s_waitcnt vmcnt(3)
    ds_write_b128 v10, v[64:67] offset:0
    v_max3_u32 v24, v64, v65, v66
    v_max_u32 v24, v24, v67
    v_cmp_eq_u32 s[48:49], -1, v24
    s_waitcnt vmcnt(2)
    ds_write_b128 v10, v[68:71] offset:1024
    v_max3_u32 v24, v68, v69, v70
    v_max_u32 v24, v24, v71
    v_cmp_eq_u32 s[50:51], -1, v24
    s_waitcnt vmcnt(1)
    ds_write_b128 v10, v[72:75] offset:2048
    v_max3_u32 v24, v72, v73, v74
    v_max_u32 v24, v24, v75
    v_cmp_eq_u32 s[52:53], -1, v24
    s_waitcnt vmcnt(0)
    ds_write_b128 v10, v[76:79] offset:3072
    v_max3_u32 v24, v76, v77, v78
    v_max_u32 v24, v24, v79
    v_cmp_eq_u32 s[54:55], -1, v24
    s_or_b64 s[46:47], s[48:49], s[50:51]
    s_or_b64 vcc, s[52:53], s[54:55]
    s_or_b64 vcc, vcc, s[46:47]
    s_cbranch_scc1 L_v_l1_274
L_v_l1ok_276:
    s_waitcnt lgkmcnt(0)
    s_barrier
    v_smfmac_f32_16x16x64_bf16 v[16:19], v[64:67], a[0:7], v3
    v_smfmac_f32_16x16x64_bf16 v[20:23], v[64:67], a[32:39], v3
    v_smfmac_f32_16x16x64_bf16 v[16:19], v[68:71], a[8:15], v3
    v_smfmac_f32_16x16x64_bf16 v[20:23], v[68:71], a[40:47], v3
    v_smfmac_f32_16x16x64_bf16 v[16:19], v[72:75], a[16:23], v3
    v_smfmac_f32_16x16x64_bf16 v[20:23], v[72:75], a[48:55], v3
    v_smfmac_f32_16x16x64_bf16 v[16:19], v[76:79], a[24:31], v3
    v_smfmac_f32_16x16x64_bf16 v[20:23], v[76:79], a[56:63], v3
    s_nop 6
    v_permlane32_swap_b32 v16, v18
    v_permlane32_swap_b32 v17, v19
    v_permlane32_swap_b32 v20, v22
    v_permlane32_swap_b32 v21, v23
    v_add_f32 v16, v16, v18
    v_add_f32 v17, v17, v19
    v_add_f32 v18, v20, v22
    v_add_f32 v19, v21, v23
    ds_write_b128 v14, v[16:19]
    s_mov_b64 exec, 1
    ds_add_u32 v29, v30
    s_mov_b64 exec, -1
    s_add_u32 s58, s58, 4
    s_bitcmp1_b32 s44, 0
    s_cbranch_scc1 L_v_k1_278_c
    s_mov_b32 s70, 0
L_v_rl_279:
    ds_read_b32 v24, v29
    ds_read_b64 v[16:17], v13 offset:0
    ds_read_b64 v[18:19], v13 offset:1024
    ds_read_b64 v[20:21], v13 offset:2048
    ds_read_b64 v[22:23], v13 offset:3072
    s_waitcnt lgkmcnt(2)
    v_cmp_ne_u32 vcc, s58, v24
    v_add_f32 v16, v16, v18
    v_add_f32 v17, v17, v19
    s_waitcnt lgkmcnt(0)
    s_cbranch_vccnz L_rt_280
    v_add_f32 v20, v20, v22
    v_add_f32 v21, v21, v23
    v_add_f32 v16, v16, v20
    v_add_f32 v17, v17, v21
    s_mov_b32 vcc_lo, 0x55555555
    s_mov_b32 vcc_hi, 0x55555555
    v_cndmask_b32_dpp v18, v17, v16, vcc quad_perm:[1,0,3,2] row_mask:0xf bank_mask:0xf
    s_not_b64 vcc, vcc
    v_cndmask_b32_dpp v19, v16, v17, vcc quad_perm:[1,0,3,2] row_mask:0xf bank_mask:0xf
    v_cvt_pk_bf16_f32 v18, v18, v19
    v_min_u32 v18, -2, v18
    buffer_store_dword v18, v4, s[12:15], s62 offen sc1
    ds_write_b32 v5, v18
L_v_k1_278:
    s_cmp_eq_u32 s60, 63
    s_cbranch_scc1 L_v_last_277
    ds_read_b128 v[80:83], v27 offset:32768
    ds_read_b128 v[84:87], v27 offset:36864
    ds_read_b128 v[88:91], v27 offset:40960
    ds_read_b128 v[92:95], v27 offset:45056
    v_mov_b32 v96, 0
    v_mov_b32 v97, 0
    v_mov_b32 v98, 0
    v_mov_b32 v99, 0
    v_mov_b32 v100, 0
    v_mov_b32 v101, 0
    v_mov_b32 v102, 0
    v_mov_b32 v103, 0
    v_mov_b32 v104, 0
    v_mov_b32 v105, 0
    v_mov_b32 v106, 0
    v_mov_b32 v107, 0
    v_mov_b32 v108, 0
    v_mov_b32 v109, 0
    v_mov_b32 v110, 0
    v_mov_b32 v111, 0
    s_bitcmp1_b32 s44, 0
    s_cbranch_scc0 L_v_sv_281
    s_sleep 1
L_v_sv_281:
    s_sleep 3
    s_mov_b32 s70, 1
    buffer_load_dwordx4 v[64:67], v11, s[12:15], s62 offen offset:0 sc1
    buffer_load_dwordx4 v[68:71], v11, s[12:15], s62 offen offset:1024 sc1
L_v_vp_282_m:
    s_waitcnt vmcnt(0)
    v_max3_u32 v20, v64, v65, v66
    v_max3_u32 v20, v20, v67, v68
    v_max3_u32 v20, v20, v69, v70
    v_max_u32 v20, v20, v71
    v_cmp_eq_u32 vcc, -1, v20
    s_cbranch_vccnz L_rt_283
    v_smfmac_f32_16x16x64_bf16 v[96:99], v[64:67], a[64:71], v3
    v_smfmac_f32_16x16x64_bf16 v[96:99], v[68:71], a[72:79], v3
    v_smfmac_f32_16x16x64_bf16 v[100:103], v[64:67], a[80:87], v3
    v_smfmac_f32_16x16x64_bf16 v[100:103], v[68:71], a[88:95], v3
    v_smfmac_f32_16x16x64_bf16 v[104:107], v[64:67], a[96:103], v3
    v_smfmac_f32_16x16x64_bf16 v[104:107], v[68:71], a[104:111], v3
    v_smfmac_f32_16x16x64_bf16 v[108:111], v[64:67], a[112:119], v3
    v_smfmac_f32_16x16x64_bf16 v[108:111], v[68:71], a[120:127], v3
    s_nop 1
    v_cvt_pk_bf16_f32 v96, v96, v97
    v_cvt_pk_bf16_f32 v97, v98, v99
    ds_write_b64 v12, v[96:97] offset:0
    v_cvt_pk_bf16_f32 v100, v100, v101
    v_cvt_pk_bf16_f32 v101, v102, v103
    ds_write_b64 v12, v[100:101] offset:2048
    v_cvt_pk_bf16_f32 v104, v104, v105
    v_cvt_pk_bf16_f32 v105, v106, v107
    ds_write_b64 v12, v[104:105] offset:4096
    v_cvt_pk_bf16_f32 v108, v108, v109
    v_cvt_pk_bf16_f32 v109, v110, v111
    ds_write_b64 v12, v[108:109] offset:6144
    s_bitcmp1_b32 s44, 0
    s_cbranch_scc1 L_v_r8_284
L_v_r8_284_l:
    s_add_u32 s46, s65, 4096
    buffer_load_dwordx4 v[32:35], v15, s[12:15], s65 offen offset:0 sc1
    buffer_load_dwordx4 v[48:51], v15, s[12:15], s46 offen offset:0 sc1
    buffer_load_dwordx4 v[36:39], v15, s[12:15], s65 offen offset:1024 sc1
    buffer_load_dwordx4 v[52:55], v15, s[12:15], s46 offen offset:1024 sc1
    buffer_load_dwordx4 v[40:43], v15, s[12:15], s65 offen offset:2048 sc1
    buffer_load_dwordx4 v[56:59], v15, s[12:15], s46 offen offset:2048 sc1
    buffer_load_dwordx4 v[44:47], v15, s[12:15], s65 offen offset:3072 sc1
    buffer_load_dwordx4 v[60:63], v15, s[12:15], s46 offen offset:3072 sc1
    s_add_u32 s65, s65, 786432
L_v_r8_284:
    s_cmp_eq_u32 s60, 0
    s_cbranch_scc1 L_v_vt_285
L_v_vt_285_b:
    s_waitcnt lgkmcnt(0)
    s_barrier
    ds_read_b128 v[96:99], v2 offset:16384
    ds_read_b128 v[100:103], v2 offset:17408
    ds_read_b128 v[104:107], v2 offset:18432
    ds_read_b128 v[108:111], v2 offset:19456
    ds_read_b128 v[112:115], v31 offset:0
    ds_read_b128 v[116:119], v25 offset:0
    ds_read_b128 v[120:123], v31 offset:512
    ds_read_b128 v[124:127], v25 offset:1024
    s_waitcnt lgkmcnt(7)
    v_mfma_f32_16x16x32_bf16 v[16:19], v[80:83], v[96:99], 0
    s_waitcnt lgkmcnt(6)
    v_mfma_f32_16x16x32_bf16 v[16:19], v[84:87], v[100:103], v[16:19]
    s_waitcnt lgkmcnt(5)
    v_mfma_f32_16x16x32_bf16 v[16:19], v[88:91], v[104:107], v[16:19]
    s_waitcnt lgkmcnt(4)
    v_mfma_f32_16x16x32_bf16 v[16:19], v[92:95], v[108:111], v[16:19]
    s_waitcnt lgkmcnt(2)
    v_mfma_f32_16x16x32_bf16 v[16:19], v[116:119], v[112:115], v[16:19]
    s_waitcnt lgkmcnt(0)
    v_mfma_f32_16x16x32_bf16 v[16:19], v[124:127], v[120:123], v[16:19]
    s_mov_b32 exec_lo, 0x00ff00ff
    s_mov_b32 exec_hi, 0x00ff00ff
    s_nop 5
    v_cvt_pk_bf16_f32 v16, v16, v17
    v_cvt_pk_bf16_f32 v17, v18, v19
    v_min_u32 v16, -2, v16
    v_min_u32 v17, -2, v17
    buffer_store_dwordx2 v[16:17], v6, s[12:15], s63 offen sc1
    s_mov_b64 exec, -1
    s_waitcnt vmcnt(1)
    s_sub_u32 s45, s60, 3
    s_cmp_ge_u32 s45, 24
    s_cbranch_scc1 L_v_nx_286_s
    s_cmp_eq_u32 s45, 0
    s_cbranch_scc1 L_v_fl_287
L_v_fl_287_b:
    s_and_b32 s46, s45, 1
    s_lshl_b32 s47, s46, 14
    s_add_u32 s47, s47, s59
    s_lshl_b32 s46, s46, 15
    s_lshr_b32 s48, s45, 2
    s_lshl_b32 s48, s48, 16
    s_add_u32 s46, s46, s48
    s_and_b32 s48, s45, 2
    s_lshl_b32 s48, s48, 7
    s_add_u32 s46, s46, s48
    s_add_u32 m0, s47, 0
    s_add_u32 s48, s46, 0
    buffer_load_dwordx4 v28, s[12:15], s48 offen sc1 lds
    s_add_u32 m0, s47, 1024
    s_add_u32 s48, s46, 2048
    buffer_load_dwordx4 v28, s[12:15], s48 offen sc1 lds
    s_add_u32 m0, s47, 2048
    s_add_u32 s48, s46, 4096
    buffer_load_dwordx4 v28, s[12:15], s48 offen sc1 lds
    s_add_u32 m0, s47, 3072
    s_add_u32 s48, s46, 6144
    buffer_load_dwordx4 v28, s[12:15], s48 offen sc1 lds
L_v_nx_286:
    s_add_u32 s61, s61, 0x4000
    s_and_b32 s61, s61, 0xffff
    s_mov_b32 s70, 1
    s_sleep 5
    buffer_load_dword v96, v7, s[12:15], s63 offen offset:0 sc1
    buffer_load_dword v97, v7, s[12:15], s63 offen offset:256 sc1
    buffer_load_dword v98, v7, s[12:15], s63 offen offset:512 sc1
    buffer_load_dword v99, v7, s[12:15], s63 offen offset:768 sc1
    buffer_load_dword v100, v7, s[12:15], s63 offen offset:1024 sc1
    buffer_load_dword v101, v7, s[12:15], s63 offen offset:1280 sc1
    buffer_load_dword v102, v7, s[12:15], s63 offen offset:1536 sc1
    buffer_load_dword v103, v7, s[12:15], s63 offen offset:1792 sc1
    v_mfma_f32_16x16x32_bf16 v[64:67], v[32:35], a[64:67], 0
    v_mfma_f32_16x16x32_bf16 v[68:71], v[48:51], a[64:67], 0
    v_mfma_f32_16x16x32_bf16 v[64:67], v[36:39], a[68:71], v[64:67]
    v_mfma_f32_16x16x32_bf16 v[68:71], v[52:55], a[68:71], v[68:71]
    v_mfma_f32_16x16x32_bf16 v[64:67], v[40:43], a[72:75], v[64:67]
    v_mfma_f32_16x16x32_bf16 v[68:71], v[56:59], a[72:75], v[68:71]
    v_mfma_f32_16x16x32_bf16 v[64:67], v[44:47], a[76:79], v[64:67]
    v_mfma_f32_16x16x32_bf16 v[68:71], v[60:63], a[76:79], v[68:71]
    v_mfma_f32_16x16x32_bf16 v[72:75], v[32:35], a[80:83], 0
    v_mfma_f32_16x16x32_bf16 v[76:79], v[48:51], a[80:83], 0
    v_mfma_f32_16x16x32_bf16 v[72:75], v[36:39], a[84:87], v[72:75]
    v_mfma_f32_16x16x32_bf16 v[76:79], v[52:55], a[84:87], v[76:79]
    v_mfma_f32_16x16x32_bf16 v[72:75], v[40:43], a[88:91], v[72:75]
    v_mfma_f32_16x16x32_bf16 v[76:79], v[56:59], a[88:91], v[76:79]
    v_mfma_f32_16x16x32_bf16 v[72:75], v[44:47], a[92:95], v[72:75]
    v_mfma_f32_16x16x32_bf16 v[76:79], v[60:63], a[92:95], v[76:79]
    v_cvt_pk_bf16_f32 v64, v64, v65
    v_cvt_pk_bf16_f32 v65, v66, v67
    v_cvt_pk_bf16_f32 v66, v68, v69
    v_cvt_pk_bf16_f32 v67, v70, v71
    ds_write_b128 v10, v[64:67] offset:32768
    v_mfma_f32_16x16x32_bf16 v[80:83], v[32:35], a[96:99], 0
    v_mfma_f32_16x16x32_bf16 v[84:87], v[48:51], a[96:99], 0
    v_mfma_f32_16x16x32_bf16 v[80:83], v[36:39], a[100:103], v[80:83]
    v_mfma_f32_16x16x32_bf16 v[84:87], v[52:55], a[100:103], v[84:87]
    v_mfma_f32_16x16x32_bf16 v[80:83], v[40:43], a[104:107], v[80:83]
    v_mfma_f32_16x16x32_bf16 v[84:87], v[56:59], a[104:107], v[84:87]
    v_mfma_f32_16x16x32_bf16 v[80:83], v[44:47], a[108:111], v[80:83]
    v_mfma_f32_16x16x32_bf16 v[84:87], v[60:63], a[108:111], v[84:87]
    v_cvt_pk_bf16_f32 v72, v72, v73
    v_cvt_pk_bf16_f32 v73, v74, v75
    v_cvt_pk_bf16_f32 v74, v76, v77
    v_cvt_pk_bf16_f32 v75, v78, v79
    ds_write_b128 v10, v[72:75] offset:33792
L_v_gp_288:
    s_waitcnt vmcnt(7)
    v_lshlrev_b32 v20, 16, v96
    v_and_b32 v21, 0xffff0000, v96
    s_waitcnt vmcnt(6)
    v_lshlrev_b32 v22, 16, v97
    v_and_b32 v23, 0xffff0000, v97
    v_add_f32 v20, v20, v22
    v_add_f32 v21, v21, v23
    s_waitcnt vmcnt(5)
    v_lshlrev_b32 v22, 16, v98
    v_and_b32 v23, 0xffff0000, v98
    v_add_f32 v20, v20, v22
    v_add_f32 v21, v21, v23
    s_waitcnt vmcnt(4)
    v_lshlrev_b32 v22, 16, v99
    v_and_b32 v23, 0xffff0000, v99
    v_add_f32 v20, v20, v22
    v_add_f32 v21, v21, v23
    s_waitcnt vmcnt(3)
    v_lshlrev_b32 v22, 16, v100
    v_and_b32 v23, 0xffff0000, v100
    v_add_f32 v20, v20, v22
    v_add_f32 v21, v21, v23
    s_waitcnt vmcnt(2)
    v_lshlrev_b32 v22, 16, v101
    v_and_b32 v23, 0xffff0000, v101
    v_add_f32 v20, v20, v22
    v_add_f32 v21, v21, v23
    s_waitcnt vmcnt(1)
    v_lshlrev_b32 v22, 16, v102
    v_and_b32 v23, 0xffff0000, v102
    v_add_f32 v20, v20, v22
    v_add_f32 v21, v21, v23
    s_waitcnt vmcnt(0)
    v_lshlrev_b32 v22, 16, v103
    v_and_b32 v23, 0xffff0000, v103
    v_add_f32 v20, v20, v22
    v_add_f32 v21, v21, v23
    v_cmp_u_f32 vcc, v20, v21
    v_cvt_pk_bf16_f32 v20, v20, v21
    s_cbranch_vccnz L_v_gf_290
L_v_gok_289:
    buffer_store_dword v20, v8, s[12:15], s61 offen sc1
    s_xor_b32 s45, s61, 0x8000
    buffer_store_dword v26, v8, s[12:15], s45 offen sc1
    s_bitcmp1_b32 s44, 0
    s_cbranch_scc1 L_v_nr_291
    s_xor_b32 s45, s62, 0x4000
    buffer_store_dword v26, v4, s[12:15], s45 offen sc1
L_v_nr_291:
    s_add_u32 s60, s60, 1
    s_add_u32 s62, s62, 0x2000
    s_and_b32 s62, s62, 0x7fff
    s_and_b32 s45, s60, 0x38
    s_bitcmp1_b64 s[66:67], s45
    s_cselect_b32 s45, 8192, 0
    s_lshl_b32 s63, s60, 18
    s_add_u32 s63, s63, s45
    v_mfma_f32_16x16x32_bf16 v[88:91], v[32:35], a[112:115], 0
    v_mfma_f32_16x16x32_bf16 v[92:95], v[48:51], a[112:115], 0
    v_mfma_f32_16x16x32_bf16 v[88:91], v[36:39], a[116:119], v[88:91]
    v_mfma_f32_16x16x32_bf16 v[92:95], v[52:55], a[116:119], v[92:95]
    v_mfma_f32_16x16x32_bf16 v[88:91], v[40:43], a[120:123], v[88:91]
    v_mfma_f32_16x16x32_bf16 v[92:95], v[56:59], a[120:123], v[92:95]
    v_mfma_f32_16x16x32_bf16 v[88:91], v[44:47], a[124:127], v[88:91]
    v_mfma_f32_16x16x32_bf16 v[92:95], v[60:63], a[124:127], v[92:95]
    v_cvt_pk_bf16_f32 v80, v80, v81
    v_cvt_pk_bf16_f32 v81, v82, v83
    v_cvt_pk_bf16_f32 v82, v84, v85
    v_cvt_pk_bf16_f32 v83, v86, v87
    ds_write_b128 v10, v[80:83] offset:34816
    s_nop 2
    v_cvt_pk_bf16_f32 v88, v88, v89
    v_cvt_pk_bf16_f32 v89, v90, v91
    v_cvt_pk_bf16_f32 v90, v92, v93
    v_cvt_pk_bf16_f32 v91, v94, v95
    ds_write_b128 v10, v[88:91] offset:35840
    s_sleep 3
    s_branch L_v_loop_273
L_v_last_277:
    s_waitcnt lgkmcnt(0)
    s_barrier
    s_branch L_replica
L_v_l1_274:
    s_mov_b64 exec, s[48:49]
    s_cbranch_execz L_v_ls_292
    buffer_load_dwordx4 v[64:67], v9, s[12:15], s61 offen offset:0 sc1
L_v_ls_292:
    s_mov_b64 exec, s[50:51]
    s_cbranch_execz L_v_ls_293
    buffer_load_dwordx4 v[68:71], v9, s[12:15], s61 offen offset:1024 sc1
L_v_ls_293:
    s_mov_b64 exec, s[52:53]
    s_cbranch_execz L_v_ls_294
    buffer_load_dwordx4 v[72:75], v9, s[12:15], s61 offen offset:2048 sc1
L_v_ls_294:
    s_mov_b64 exec, s[54:55]
    s_cbranch_execz L_v_ls_295
    buffer_load_dwordx4 v[76:79], v9, s[12:15], s61 offen offset:3072 sc1
L_v_ls_295:
    s_mov_b64 exec, -1
    s_add_u32 s70, s70, 1
    s_cmp_ge_u32 s70, 524288
    s_cbranch_scc1 L_c_done_1
    s_waitcnt vmcnt(0)
    s_cmp_eq_u64 s[48:49], 0
    s_cbranch_scc1 L_v_lc_296
    ds_write_b128 v10, v[64:67] offset:0
    v_max3_u32 v24, v64, v65, v66
    v_max_u32 v24, v24, v67
    v_cmp_eq_u32 s[48:49], -1, v24
L_v_lc_296:
    s_cmp_eq_u64 s[50:51], 0
    s_cbranch_scc1 L_v_lc_297
    ds_write_b128 v10, v[68:71] offset:1024
    v_max3_u32 v24, v68, v69, v70
    v_max_u32 v24, v24, v71
    v_cmp_eq_u32 s[50:51], -1, v24
L_v_lc_297:
    s_cmp_eq_u64 s[52:53], 0
    s_cbranch_scc1 L_v_lc_298
    ds_write_b128 v10, v[72:75] offset:2048
    v_max3_u32 v24, v72, v73, v74
    v_max_u32 v24, v24, v75
    v_cmp_eq_u32 s[52:53], -1, v24
L_v_lc_298:
    s_cmp_eq_u64 s[54:55], 0
    s_cbranch_scc1 L_v_lc_299
    ds_write_b128 v10, v[76:79] offset:3072
    v_max3_u32 v24, v76, v77, v78
    v_max_u32 v24, v24, v79
    v_cmp_eq_u32 s[54:55], -1, v24
L_v_lc_299:
    s_or_b64 s[46:47], s[48:49], s[50:51]
    s_or_b64 vcc, s[52:53], s[54:55]
    s_or_b64 vcc, vcc, s[46:47]
    s_cbranch_scc1 L_v_l1_274
    s_branch L_v_l1ok_276
L_v_k1_278_c:
    s_add_u32 s46, s65, 4096
    buffer_load_dwordx4 v[32:35], v15, s[12:15], s65 offen offset:0 sc1
    buffer_load_dwordx4 v[48:51], v15, s[12:15], s46 offen offset:0 sc1
    buffer_load_dwordx4 v[36:39], v15, s[12:15], s65 offen offset:1024 sc1
    buffer_load_dwordx4 v[52:55], v15, s[12:15], s46 offen offset:1024 sc1
    buffer_load_dwordx4 v[40:43], v15, s[12:15], s65 offen offset:2048 sc1
    buffer_load_dwordx4 v[56:59], v15, s[12:15], s46 offen offset:2048 sc1
    buffer_load_dwordx4 v[44:47], v15, s[12:15], s65 offen offset:3072 sc1
    buffer_load_dwordx4 v[60:63], v15, s[12:15], s46 offen offset:3072 sc1
    s_add_u32 s65, s65, 786432
    s_branch L_v_k1_278
L_rt_280:
    s_add_u32 s70, s70, 1
    s_cmp_lt_u32 s70, 524288
    s_cbranch_scc1 L_v_rl_279
    s_branch L_c_done_1
L_v_vp_282:
    buffer_load_dwordx4 v[64:67], v11, s[12:15], s62 offen offset:0 sc1
    buffer_load_dwordx4 v[68:71], v11, s[12:15], s62 offen offset:1024 sc1
    s_branch L_v_vp_282_m
L_rt_283:
    s_add_u32 s70, s70, 1
    s_cmp_lt_u32 s70, 524288
    s_cbranch_scc1 L_v_vp_282
    s_branch L_c_done_1
L_v_vt_285:
    v_lshrrev_b32 v22, 3, v1
    v_lshlrev_b32 v22, 7, v22
    s_mov_b32 s45, 0x101800
    s_mov_b32 s46, 0
    s_mov_b32 s70, 0
L_spin_300:
    buffer_load_dword v23, v22, s[12:15], s45 offen sc1
    s_waitcnt vmcnt(0)
    v_cmp_ge_u32 vcc, s46, v23
    s_add_u32 s70, s70, 1
    s_cbranch_vccz L_spok_301
    s_sleep 3
    s_cmp_lt_u32 s70, 524288
    s_cbranch_scc1 L_spin_300
    s_branch L_c_done_1
L_spok_301:
    v_cmp_eq_u32 s[66:67], 3, v23
    s_nop 3
    s_bitcmp1_b32 s66, 0
    s_cselect_b32 s45, 8192, 0
    s_add_u32 s63, s63, s45
    s_branch L_v_vt_285_b
L_v_fl_287:
    v_and_b32 v22, 31, v1
    v_lshlrev_b32 v22, 7, v22
    s_mov_b32 s46, 0x109400
    s_mov_b32 s47, 56
    s_mov_b32 s70, 0
L_spin_302:
    buffer_load_dword v23, v22, s[12:15], s46 offen sc1
    s_waitcnt vmcnt(0)
    v_cmp_ge_u32 vcc, s47, v23
    s_add_u32 s70, s70, 1
    s_cbranch_vccz L_spok_303
    s_sleep 3
    s_cmp_lt_u32 s70, 524288
    s_cbranch_scc1 L_spin_302
    s_branch L_c_done_1
L_spok_303:
    s_branch L_v_fl_287_b
L_v_nx_286_s:
    s_sleep 2
    s_branch L_v_nx_286
L_v_gf_290:
    v_max3_u32 v24, v96, v97, v98
    v_max3_u32 v24, v24, v99, v100
    v_max3_u32 v24, v24, v101, v102
    v_max_u32 v24, v24, v103
    v_cmp_eq_u32 vcc, -1, v24
    v_min_u32 v20, -2, v20
    s_add_u32 s70, s70, 1
    s_cbranch_vccz L_v_gok_289
    buffer_load_dword v96, v7, s[12:15], s63 offen offset:0 sc1
    buffer_load_dword v97, v7, s[12:15], s63 offen offset:256 sc1
    buffer_load_dword v98, v7, s[12:15], s63 offen offset:512 sc1
    buffer_load_dword v99, v7, s[12:15], s63 offen offset:768 sc1
    buffer_load_dword v100, v7, s[12:15], s63 offen offset:1024 sc1
    buffer_load_dword v101, v7, s[12:15], s63 offen offset:1280 sc1
    buffer_load_dword v102, v7, s[12:15], s63 offen offset:1536 sc1
    buffer_load_dword v103, v7, s[12:15], s63 offen offset:1792 sc1
    s_cmp_lt_u32 s70, 524288
    s_cbranch_scc1 L_v_gp_288
    s_branch L_c_done_1
L_c_done_1:
    s_endpgm
.section .rodata,"a"
.p2align 6
.amdhsa_kernel k3_chain_kernel
  .amdhsa_next_free_vgpr 256
  .amdhsa_next_free_sgpr 102
  .amdhsa_accum_offset 128
  .amdhsa_group_segment_fixed_size 0
  .amdhsa_kernarg_size 136
  .amdhsa_user_sgpr_count 2
  .amdhsa_user_sgpr_kernarg_segment_ptr 1
  .amdhsa_system_sgpr_workgroup_id_x 1
.end_amdhsa_kernel
```

```asm
; @launch kernel=k3_chain_kernel grid=(256,1,1) block=(512,1,1) lds=147712
.amdgcn_target "amdgcn-amd-amdhsa--gfx950"
.text
.globl k3_chain_kernel
.p2align 8
.type k3_chain_kernel,@function
k3_chain_kernel:
    s_cmp_ge_u32 s2, 256
    s_cbranch_scc1 L_c_done_1
    s_load_dwordx4 s[20:23], s[0:1], 120
    v_and_b32 v1, 63, v0
    v_lshrrev_b32 v2, 6, v0
    s_nop 0
    v_readfirstlane_b32 s44, v2
    s_waitcnt lgkmcnt(0)
    s_mov_b32 s12, s22
    s_and_b32 s13, s23, 0xffff
    s_mov_b32 s14, 0x10000000
    s_mov_b32 s15, 0x00020000
    s_mov_b32 s16, s20
    s_and_b32 s17, s21, 0xffff
    s_mov_b32 s18, 0x100
    s_mov_b32 s19, 0x00020000
    s_load_dwordx4 s[8:11], s[0:1], 96
    v_lshrrev_b32 v5, 3, v0
    v_mul_u32_u24 v6, 24576, v5
    v_and_b32 v7, 7, v0
    v_lshl_add_u32 v6, v7, 4, v6
    v_add_u32 v7, 12288, v6
    v_lshlrev_b32 v5, 2, v5
    s_lshr_b32 s50, s2, 5
    s_and_b32 s51, s2, 31
    s_mul_i32 s52, s50, 1572864
    s_lshl_b32 s53, s51, 7
    s_add_u32 s52, s52, s53
    s_lshl_b32 s53, s50, 8
    s_waitcnt lgkmcnt(0)
    s_mov_b32 s28, s10
    s_and_b32 s29, s11, 0xffff
    s_mov_b32 s30, 0xc00000
    s_mov_b32 s31, 0x00020000
    s_mov_b32 s32, s8
    s_and_b32 s33, s9, 0xffff
    s_mov_b32 s34, 0x800
    s_mov_b32 s35, 0x00020000
    buffer_load_dword v8, v5, s[32:35], s53 offen
    buffer_load_dwordx4 v[12:15], v6, s[28:31], s52 offen nt
    buffer_load_dwordx4 v[16:19], v7, s[28:31], s52 offen nt
    s_getreg_b32 s39, hwreg(HW_REG_XCC_ID)
    s_and_b32 s39, s39, 7
    s_cmp_lg_u32 s44, 1
    s_cbranch_scc1 L_nz_5
    v_mov_b32 v32, 0
    v_mov_b32 v33, 0
    v_mov_b32 v34, 0
    v_mov_b32 v35, 0
    v_lshlrev_b32 v4, 4, v1
    s_lshl_b32 s45, s2, 10
    s_add_u32 s45, s45, 0x100000
    buffer_store_dwordx4 v[32:35], v4, s[12:15], s45 offen sc1
L_nz_5:
    s_waitcnt vmcnt(0)
    v_lshlrev_b32 v9, 16, v8
    v_and_b32 v10, 0xffff0000, v8
    v_mul_f32 v20, 0xbfb8aa3b, v9
    v_mul_f32 v21, 0xbfb8aa3b, v10
    v_exp_f32 v20, v20
    v_exp_f32 v21, v21
    s_nop 0
    v_add_f32 v20, 1.0, v20
    v_add_f32 v21, 1.0, v21
    v_rcp_f32 v20, v20
    v_rcp_f32 v21, v21
    s_nop 0
    v_mul_f32 v9, v9, v20
    v_mul_f32 v10, v10, v21
    v_cvt_pk_bf16_f32 v9, 0, v9
    v_cvt_pk_bf16_f32 v10, 0, v10
    v_lshlrev_b32 v28, 16, v12
    v_and_b32 v29, 0xffff0000, v12
    v_lshlrev_b32 v30, 16, v16
    v_and_b32 v31, 0xffff0000, v16
    v_mul_f32 v20, v28, v9
    v_mul_f32 v21, v29, v9
    v_fmac_f32 v20, v30, v10
    v_fmac_f32 v21, v31, v10
    v_lshlrev_b32 v28, 16, v13
    v_and_b32 v29, 0xffff0000, v13
    v_lshlrev_b32 v30, 16, v17
    v_and_b32 v31, 0xffff0000, v17
    v_mul_f32 v22, v28, v9
    v_mul_f32 v23, v29, v9
    v_fmac_f32 v22, v30, v10
    v_fmac_f32 v23, v31, v10
    v_lshlrev_b32 v28, 16, v14
    v_and_b32 v29, 0xffff0000, v14
    v_lshlrev_b32 v30, 16, v18
    v_and_b32 v31, 0xffff0000, v18
    v_mul_f32 v24, v28, v9
    v_mul_f32 v25, v29, v9
    v_fmac_f32 v24, v30, v10
    v_fmac_f32 v25, v31, v10
    v_lshlrev_b32 v28, 16, v15
    v_and_b32 v29, 0xffff0000, v15
    v_lshlrev_b32 v30, 16, v19
    v_and_b32 v31, 0xffff0000, v19
    v_mul_f32 v26, v28, v9
    v_mul_f32 v27, v29, v9
    v_fmac_f32 v26, v30, v10
    v_fmac_f32 v27, v31, v10
    s_nop 1
    v_add_f32_dpp v20, v20, v20 row_ror:8 row_mask:0xf bank_mask:0xf
    v_add_f32_dpp v21, v21, v21 row_ror:8 row_mask:0xf bank_mask:0xf
    v_add_f32_dpp v22, v22, v22 row_ror:8 row_mask:0xf bank_mask:0xf
    v_add_f32_dpp v23, v23, v23 row_ror:8 row_mask:0xf bank_mask:0xf
    v_add_f32_dpp v24, v24, v24 row_ror:8 row_mask:0xf bank_mask:0xf
    v_add_f32_dpp v25, v25, v25 row_ror:8 row_mask:0xf bank_mask:0xf
    v_add_f32_dpp v26, v26, v26 row_ror:8 row_mask:0xf bank_mask:0xf
    v_add_f32_dpp v27, v27, v27 row_ror:8 row_mask:0xf bank_mask:0xf
    s_nop 1
    v_permlane16_swap_b32 v20, v24
    v_permlane16_swap_b32 v21, v25
    v_permlane16_swap_b32 v22, v26
    v_permlane16_swap_b32 v23, v27
    v_add_f32 v20, v20, v24
    v_add_f32 v21, v21, v25
    v_add_f32 v22, v22, v26
    v_add_f32 v23, v23, v27
    s_nop 1
    v_permlane32_swap_b32 v20, v22
    v_permlane32_swap_b32 v21, v23
    v_add_f32 v20, v20, v22
    v_add_f32 v21, v21, v23
    v_and_b32 v22, 7, v1
    v_lshlrev_b32 v22, 5, v22
    v_bfe_u32 v23, v1, 4, 1
    v_lshl_add_u32 v22, v23, 4, v22
    v_lshrrev_b32 v23, 5, v1
    v_lshl_add_u32 v22, v23, 3, v22
    s_lshl_b32 s52, s44, 8
    s_add_u32 s52, s52, 139776
    v_add_u32 v22, s52, v22
    ds_write_b64 v22, v[20:21]
    s_waitcnt lgkmcnt(0)
    s_barrier
    s_cmp_lg_u32 s44, 1
    s_cbranch_scc1 L_m1_6
    v_lshlrev_b32 v22, 2, v1
    v_add_u32 v23, 139776, v22
    ds_read_b32 v24, v23 offset:0
    ds_read_b32 v25, v23 offset:256
    ds_read_b32 v26, v23 offset:512
    ds_read_b32 v27, v23 offset:768
    ds_read_b32 v28, v23 offset:1024
    ds_read_b32 v29, v23 offset:1280
    ds_read_b32 v30, v23 offset:1536
    ds_read_b32 v31, v23 offset:1792
    s_waitcnt lgkmcnt(0)
    v_add_f32 v24, v24, v28
    v_add_f32 v25, v25, v29
    v_add_f32 v26, v26, v30
    v_add_f32 v27, v27, v31
    v_add_f32 v24, v24, v26
    v_add_f32 v25, v25, v27
    v_add_f32 v24, v24, v25
    s_lshl_b32 s52, s2, 8
    s_add_u32 s52, s52, 0x10000
    buffer_store_dword v24, v22, s[12:15], s52 offen sc1
L_m1_6:
    s_cmp_lg_u32 s44, 1
    s_cbranch_scc1 L_tk_2
    v_mov_b32 v3, 1
    s_mov_b32 s40, s39
    s_lshl_b32 s45, s40, 5
    v_mov_b32 v4, 0
    s_waitcnt vmcnt(0)
    s_mov_b64 exec, 1
    buffer_atomic_add v3, v4, s[16:19], s45 offen sc0
    s_waitcnt vmcnt(0)
    v_readfirstlane_b32 s41, v3
    s_nop 3
    s_cmp_lt_u32 s41, 32
    s_cbranch_scc1 L_got_3
    v_mov_b32 v3, 1
    buffer_atomic_add v3, v4, s[16:19], 0 offen offset:16 sc0
    s_waitcnt vmcnt(0)
    v_readfirstlane_b32 s46, v3
    s_mov_b64 exec, -1
    v_and_b32 v4, 7, v1
    v_lshlrev_b32 v4, 5, v4
    s_mov_b32 s70, 0
L_sp_4:
    s_sleep 8
    buffer_load_dword v3, v4, s[16:19], 0 offen sc1
    s_waitcnt vmcnt(0)
    s_mov_b32 s48, 0
    v_readlane_b32 s50, v3, 0
    v_readlane_b32 s51, v3, 1
    v_readlane_b32 s52, v3, 2
    v_readlane_b32 s53, v3, 3
    v_readlane_b32 s54, v3, 4
    v_readlane_b32 s55, v3, 5
    v_readlane_b32 s56, v3, 6
    v_readlane_b32 s57, v3, 7
    s_nop 3
    s_add_u32 s48, s48, s50
    s_add_u32 s48, s48, s51
    s_add_u32 s48, s48, s52
    s_add_u32 s48, s48, s53
    s_add_u32 s48, s48, s54
    s_add_u32 s48, s48, s55
    s_add_u32 s48, s48, s56
    s_add_u32 s48, s48, s57
    s_add_u32 s70, s70, 1
    s_cmp_ge_u32 s70, 524288
    s_cbranch_scc1 L_c_done_1
    s_cmp_lt_u32 s48, 256
    s_cbranch_scc1 L_sp_4
    s_min_u32 s48, s50, 32
    s_mov_b32 s40, 0
    s_add_u32 s41, s48, s46
    s_cmp_lt_u32 s41, 32
    s_cbranch_scc1 L_got_3
    s_sub_u32 s46, s41, 32
    s_min_u32 s48, s51, 32
    s_mov_b32 s40, 1
    s_add_u32 s41, s48, s46
    s_cmp_lt_u32 s41, 32
    s_cbranch_scc1 L_got_3
    s_sub_u32 s46, s41, 32
    s_min_u32 s48, s52, 32
    s_mov_b32 s40, 2
    s_add_u32 s41, s48, s46
    s_cmp_lt_u32 s41, 32
    s_cbranch_scc1 L_got_3
    s_sub_u32 s46, s41, 32
    s_min_u32 s48, s53, 32
    s_mov_b32 s40, 3
    s_add_u32 s41, s48, s46
    s_cmp_lt_u32 s41, 32
    s_cbranch_scc1 L_got_3
    s_sub_u32 s46, s41, 32
    s_min_u32 s48, s54, 32
    s_mov_b32 s40, 4
    s_add_u32 s41, s48, s46
    s_cmp_lt_u32 s41, 32
    s_cbranch_scc1 L_got_3
    s_sub_u32 s46, s41, 32
    s_min_u32 s48, s55, 32
    s_mov_b32 s40, 5
    s_add_u32 s41, s48, s46
    s_cmp_lt_u32 s41, 32
    s_cbranch_scc1 L_got_3
    s_sub_u32 s46, s41, 32
    s_min_u32 s48, s56, 32
    s_mov_b32 s40, 6
    s_add_u32 s41, s48, s46
    s_cmp_lt_u32 s41, 32
    s_cbranch_scc1 L_got_3
    s_sub_u32 s46, s41, 32
    s_min_u32 s48, s57, 32
    s_mov_b32 s40, 7
    s_add_u32 s41, s48, s46
    s_cmp_lt_u32 s41, 32
    s_cbranch_scc1 L_got_3
    s_sub_u32 s46, s41, 32
    s_branch L_c_done_1
L_got_3:
    s_mov_b64 exec, -1
    s_lshl_b32 s45, s40, 8
    s_or_b32 s45, s45, s41
    v_mov_b32 v3, s45
    v_mov_b32 v4, 147464
    ds_write_b32 v4, v3
    s_waitcnt lgkmcnt(0)
L_tk_2:
    s_barrier
    v_mov_b32 v4, 147464
    ds_read_b32 v3, v4
    s_waitcnt lgkmcnt(0)
    v_readfirstlane_b32 s45, v3
    s_nop 3
    s_lshr_b32 s40, s45, 8
    s_and_b32 s41, s45, 0xff
    s_lshr_b32 s45, s40, 2
    s_xor_b32 s45, s45, 1
    s_lshl_b32 s45, s45, 4
    s_and_b32 s40, s40, 3
    s_lshl_b32 s40, s40, 1
    s_lshr_b32 s46, s41, 4
    s_add_u32 s40, s40, s46
    s_and_b32 s41, s41, 15
    s_add_u32 s41, s41, s45
    s_cmp_lt_u32 s41, 16
    s_cbranch_scc1 L_c_chain_7
    s_sub_u32 s48, s41, 16
    s_mov_b32 s78, 1
    s_cmp_lt_u32 s48, 12
    s_cbranch_scc1 L_w_g_8
    s_and_b32 s42, s48, 3
    s_mov_b32 s43, s40
    s_load_dwordx2 s[4:5], s[0:1], 0
    v_lshlrev_b32 v2, 4, v1
    v_lshlrev_b32 v3, 5, v1
    s_lshl_b32 s55, s43, 2
    s_add_u32 s55, s55, s42
    s_waitcnt lgkmcnt(0)
    s_mov_b32 s24, s4
    s_and_b32 s25, s5, 0xffff
    s_mov_b32 s26, 0x400000
    s_mov_b32 s27, 0x00020000
    s_lshl_b32 s46, s42, 3
    s_add_u32 s46, s46, s44
    s_lshl_b32 s46, s46, 11
    v_add_u32 v7, s46, v2
    s_lshl_b32 s63, s43, 16
    buffer_load_dwordx4 a[0:3], v7, s[24:27], s63 offen
    buffer_load_dwordx4 a[4:7], v7, s[24:27], s63 offen offset:1024
    s_cmp_lg_u32 s44, 0
    s_cbranch_scc1 L_zwok_17
    v_and_b32 v8, 7, v1
    v_lshlrev_b32 v8, 5, v8
    s_mov_b32 s70, 0
L_zw_16:
    buffer_load_dword v9, v8, s[16:19], 0 offen sc1
    s_waitcnt vmcnt(0)
    v_add_u32_dpp v9, v9, v9 row_ror:1 row_mask:0xf bank_mask:0xf
    s_nop 1
    v_add_u32_dpp v9, v9, v9 row_ror:2 row_mask:0xf bank_mask:0xf
    s_nop 1
    v_add_u32_dpp v9, v9, v9 row_ror:4 row_mask:0xf bank_mask:0xf
    v_cmp_ne_u32 vcc, 0x100, v9
    s_add_u32 s70, s70, 1
    s_cbranch_vccz L_zwok_17
    s_sleep 4
    s_cmp_lt_u32 s70, 524288
    s_cbranch_scc1 L_zw_16
    s_branch L_c_done_1
L_zwok_17:
    s_barrier
    v_lshlrev_b32 v4, 4, v0
    s_mov_b32 s46, 0x10000
    buffer_load_dwordx4 v[32:35], v4, s[12:15], s46 offen sc1
    s_mov_b32 s46, 0x12000
    buffer_load_dwordx4 v[36:39], v4, s[12:15], s46 offen sc1
    s_mov_b32 s46, 0x14000
    buffer_load_dwordx4 v[40:43], v4, s[12:15], s46 offen sc1
    s_mov_b32 s46, 0x16000
    buffer_load_dwordx4 v[44:47], v4, s[12:15], s46 offen sc1
    s_mov_b32 s46, 0x18000
    buffer_load_dwordx4 v[48:51], v4, s[12:15], s46 offen sc1
    s_mov_b32 s46, 0x1a000
    buffer_load_dwordx4 v[52:55], v4, s[12:15], s46 offen sc1
    s_mov_b32 s46, 0x1c000
    buffer_load_dwordx4 v[56:59], v4, s[12:15], s46 offen sc1
    s_mov_b32 s46, 0x1e000
    buffer_load_dwordx4 v[60:63], v4, s[12:15], s46 offen sc1
    s_cmp_lg_u32 s44, 0
    s_cbranch_scc1 L_l_nx_18
    s_cmp_ge_u32 s42, 2
    s_cbranch_scc1 L_l_nx_18
    s_or_b32 s47, s39, 0x100
    v_mov_b32 v8, s47
    v_mov_b32 v9, 0
    s_lshl_b32 s46, s40, 3
    s_lshl_b32 s47, s42, 2
    s_add_u32 s46, s46, s47
    s_add_u32 s46, s46, 0x101200
    s_mov_b64 exec, 1
    buffer_store_dword v8, v9, s[12:15], s46 offen sc1
    s_mov_b64 exec, -1
L_l_nx_18:
    s_mul_i32 s46, s44, 2064
    s_add_u32 s46, s46, 32768
    v_add_u32 v10, s46, v2
    v_and_b32 v11, 7, v1
    v_lshrrev_b32 v12, 3, v1
    v_mul_u32_u24 v13, 2064, v11
    v_lshl_add_u32 v13, v12, 4, v13
    s_lshl_b32 s46, s44, 8
    s_add_u32 s46, s46, 32768
    v_add_u32 v13, s46, v13
    v_lshlrev_b32 v11, 4, v11
    v_lshl_add_u32 v11, v12, 9, v11
    s_lshl_b32 s46, s44, 13
    s_lshl_b32 s47, s42, 7
    s_add_u32 s46, s46, s47
    s_add_u32 s46, s46, 0x400000
    v_add_u32 v11, s46, v11
    v_add_u32 v12, 4096, v11
    s_lshl_b32 s52, s43, 9
    s_lshl_b32 s47, s42, 7
    s_add_u32 s52, s52, s47
    s_add_u32 s52, s52, 0x109400
    s_mov_b32 s60, s43
    s_waitcnt vmcnt(0)
    v_add_f32 v32, v32, v48
    v_add_f32 v33, v33, v49
    v_add_f32 v34, v34, v50
    v_add_f32 v35, v35, v51
    v_add_f32 v36, v36, v52
    v_add_f32 v37, v37, v53
    v_add_f32 v38, v38, v54
    v_add_f32 v39, v39, v55
    v_add_f32 v40, v40, v56
    v_add_f32 v41, v41, v57
    v_add_f32 v42, v42, v58
    v_add_f32 v43, v43, v59
    v_add_f32 v44, v44, v60
    v_add_f32 v45, v45, v61
    v_add_f32 v46, v46, v62
    v_add_f32 v47, v47, v63
    v_add_f32 v32, v32, v40
    v_add_f32 v33, v33, v41
    v_add_f32 v34, v34, v42
    v_add_f32 v35, v35, v43
    v_add_f32 v36, v36, v44
    v_add_f32 v37, v37, v45
    v_add_f32 v38, v38, v46
    v_add_f32 v39, v39, v47
    v_add_f32 v32, v32, v36
    v_add_f32 v33, v33, v37
    v_add_f32 v34, v34, v38
    v_add_f32 v35, v35, v39
    v_cvt_pk_bf16_f32 v32, 0, v32
    v_cvt_pk_bf16_f32 v33, 0, v33
    v_cvt_pk_bf16_f32 v34, 0, v34
    v_cvt_pk_bf16_f32 v35, 0, v35
    ds_write_b128 v4, v[32:35]
    s_waitcnt lgkmcnt(0)
    s_barrier
    ds_read_b128 v[48:51], v3 offset:0
    ds_read_b128 v[52:55], v3 offset:16
    ds_read_b128 v[56:59], v3 offset:2048
    ds_read_b128 v[60:63], v3 offset:2064
    ds_read_b128 v[32:35], v3 offset:4096
    ds_read_b128 v[36:39], v3 offset:4112
    ds_read_b128 v[40:43], v3 offset:6144
    ds_read_b128 v[44:47], v3 offset:6160
    s_waitcnt lgkmcnt(0)
    v_add_f32 v32, 1.0, v32
    v_add_f32 v33, 1.0, v33
    v_add_f32 v34, 1.0, v34
    v_add_f32 v35, 1.0, v35
    v_add_f32 v36, 1.0, v36
    v_add_f32 v37, 1.0, v37
    v_add_f32 v38, 1.0, v38
    v_add_f32 v39, 1.0, v39
    v_add_f32 v40, 1.0, v40
    v_add_f32 v41, 1.0, v41
    v_add_f32 v42, 1.0, v42
    v_add_f32 v43, 1.0, v43
    v_add_f32 v44, 1.0, v44
    v_add_f32 v45, 1.0, v45
    v_add_f32 v46, 1.0, v46
    v_add_f32 v47, 1.0, v47
    v_cvt_pk_bf16_f32 v32, 0, v32
    v_cvt_pk_bf16_f32 v33, 0, v33
    v_cvt_pk_bf16_f32 v34, 0, v34
    v_cvt_pk_bf16_f32 v35, 0, v35
    v_cvt_pk_bf16_f32 v36, 0, v36
    v_cvt_pk_bf16_f32 v37, 0, v37
    v_cvt_pk_bf16_f32 v38, 0, v38
    v_cvt_pk_bf16_f32 v39, 0, v39
    v_cvt_pk_bf16_f32 v40, 0, v40
    v_cvt_pk_bf16_f32 v41, 0, v41
    v_cvt_pk_bf16_f32 v42, 0, v42
    v_cvt_pk_bf16_f32 v43, 0, v43
    v_cvt_pk_bf16_f32 v44, 0, v44
    v_cvt_pk_bf16_f32 v45, 0, v45
    v_cvt_pk_bf16_f32 v46, 0, v46
    v_cvt_pk_bf16_f32 v47, 0, v47
L_l_sub_19:
    s_lshl_b32 s63, s60, 16
    v_accvgpr_read_b32 v96, a0
    v_accvgpr_read_b32 v97, a1
    v_accvgpr_read_b32 v98, a2
    v_accvgpr_read_b32 v99, a3
    v_accvgpr_read_b32 v100, a4
    v_accvgpr_read_b32 v101, a5
    v_accvgpr_read_b32 v102, a6
    v_accvgpr_read_b32 v103, a7
    v_lshlrev_b32 v64, 16, v96
    v_and_b32 v65, 0xffff0000, v96
    v_lshlrev_b32 v66, 16, v97
    v_and_b32 v67, 0xffff0000, v97
    v_lshlrev_b32 v68, 16, v98
    v_and_b32 v69, 0xffff0000, v98
    v_lshlrev_b32 v70, 16, v99
    v_and_b32 v71, 0xffff0000, v99
    v_lshlrev_b32 v72, 16, v100
    v_and_b32 v73, 0xffff0000, v100
    v_lshlrev_b32 v74, 16, v101
    v_and_b32 v75, 0xffff0000, v101
    v_lshlrev_b32 v76, 16, v102
    v_and_b32 v77, 0xffff0000, v102
    v_lshlrev_b32 v78, 16, v103
    v_and_b32 v79, 0xffff0000, v103
    v_pk_add_f32 v[80:81], v[64:65], v[72:73]
    v_pk_add_f32 v[82:83], v[66:67], v[74:75]
    v_pk_add_f32 v[84:85], v[68:69], v[76:77]
    v_pk_add_f32 v[86:87], v[70:71], v[78:79]
    v_pk_add_f32 v[80:81], v[80:81], v[84:85]
    v_pk_add_f32 v[82:83], v[82:83], v[86:87]
    v_pk_add_f32 v[80:81], v[80:81], v[82:83]
    v_add_f32 v14, v80, v81
    s_nop 1
    v_add_f32_dpp v14, v14, v14 row_shr:1 row_mask:0xf bank_mask:0xf bound_ctrl:0
    s_nop 1
    v_add_f32_dpp v14, v14, v14 row_shr:2 row_mask:0xf bank_mask:0xf bound_ctrl:0
    s_nop 1
    v_add_f32_dpp v14, v14, v14 row_shr:4 row_mask:0xf bank_mask:0xf bound_ctrl:0
    s_nop 1
    v_add_f32_dpp v14, v14, v14 row_shr:8 row_mask:0xf bank_mask:0xf bound_ctrl:0
    s_nop 1
    v_add_f32_dpp v14, v14, v14 row_bcast:15 row_mask:0xa bank_mask:0xf
    s_nop 1
    v_add_f32_dpp v14, v14, v14 row_bcast:31 row_mask:0xc bank_mask:0xf
    s_nop 1
    v_readlane_b32 s46, v14, 63
    s_nop 1
    v_mov_b32 v15, s46
    v_mul_f32 v15, 0x3a800000, v15
    v_pk_add_f32 v[80:81], v[64:65], v[14:15] op_sel:[0,1] op_sel_hi:[1,1] neg_lo:[0,1] neg_hi:[0,1]
    v_pk_add_f32 v[82:83], v[66:67], v[14:15] op_sel:[0,1] op_sel_hi:[1,1] neg_lo:[0,1] neg_hi:[0,1]
    v_pk_add_f32 v[84:85], v[68:69], v[14:15] op_sel:[0,1] op_sel_hi:[1,1] neg_lo:[0,1] neg_hi:[0,1]
    v_pk_add_f32 v[86:87], v[70:71], v[14:15] op_sel:[0,1] op_sel_hi:[1,1] neg_lo:[0,1] neg_hi:[0,1]
    v_pk_add_f32 v[88:89], v[72:73], v[14:15] op_sel:[0,1] op_sel_hi:[1,1] neg_lo:[0,1] neg_hi:[0,1]
    v_pk_add_f32 v[90:91], v[74:75], v[14:15] op_sel:[0,1] op_sel_hi:[1,1] neg_lo:[0,1] neg_hi:[0,1]
    v_pk_add_f32 v[92:93], v[76:77], v[14:15] op_sel:[0,1] op_sel_hi:[1,1] neg_lo:[0,1] neg_hi:[0,1]
    v_pk_add_f32 v[94:95], v[78:79], v[14:15] op_sel:[0,1] op_sel_hi:[1,1] neg_lo:[0,1] neg_hi:[0,1]
    v_pk_mul_f32 v[104:105], v[80:81], v[80:81]
    v_pk_mul_f32 v[106:107], v[82:83], v[82:83]
    v_pk_fma_f32 v[104:105], v[84:85], v[84:85], v[104:105]
    v_pk_fma_f32 v[106:107], v[86:87], v[86:87], v[106:107]
    v_pk_fma_f32 v[104:105], v[88:89], v[88:89], v[104:105]
    v_pk_fma_f32 v[106:107], v[90:91], v[90:91], v[106:107]
    v_pk_fma_f32 v[104:105], v[92:93], v[92:93], v[104:105]
    v_pk_fma_f32 v[106:107], v[94:95], v[94:95], v[106:107]
    v_pk_add_f32 v[104:105], v[104:105], v[106:107]
    v_add_f32 v14, v104, v105
    v_cvt_pk_bf16_f32 v15, 0, v15
    s_nop 1
    v_add_f32_dpp v14, v14, v14 row_shr:1 row_mask:0xf bank_mask:0xf bound_ctrl:0
    s_nop 1
    v_add_f32_dpp v14, v14, v14 row_shr:2 row_mask:0xf bank_mask:0xf bound_ctrl:0
    s_nop 1
    v_add_f32_dpp v14, v14, v14 row_shr:4 row_mask:0xf bank_mask:0xf bound_ctrl:0
    s_nop 1
    v_add_f32_dpp v14, v14, v14 row_shr:8 row_mask:0xf bank_mask:0xf bound_ctrl:0
    s_nop 1
    v_add_f32_dpp v14, v14, v14 row_bcast:15 row_mask:0xa bank_mask:0xf
    s_nop 1
    v_add_f32_dpp v14, v14, v14 row_bcast:31 row_mask:0xc bank_mask:0xf
    s_nop 1
    v_readlane_b32 s47, v14, 63
    v_pk_add_f32 v[64:65], v[64:65], v[14:15] op_sel:[0,1] op_sel_hi:[1,1] neg_lo:[0,1] neg_hi:[0,1]
    v_pk_add_f32 v[66:67], v[66:67], v[14:15] op_sel:[0,1] op_sel_hi:[1,1] neg_lo:[0,1] neg_hi:[0,1]
    v_pk_add_f32 v[68:69], v[68:69], v[14:15] op_sel:[0,1] op_sel_hi:[1,1] neg_lo:[0,1] neg_hi:[0,1]
    v_pk_add_f32 v[70:71], v[70:71], v[14:15] op_sel:[0,1] op_sel_hi:[1,1] neg_lo:[0,1] neg_hi:[0,1]
    v_pk_add_f32 v[72:73], v[72:73], v[14:15] op_sel:[0,1] op_sel_hi:[1,1] neg_lo:[0,1] neg_hi:[0,1]
    v_pk_add_f32 v[74:75], v[74:75], v[14:15] op_sel:[0,1] op_sel_hi:[1,1] neg_lo:[0,1] neg_hi:[0,1]
    v_pk_add_f32 v[76:77], v[76:77], v[14:15] op_sel:[0,1] op_sel_hi:[1,1] neg_lo:[0,1] neg_hi:[0,1]
    v_pk_add_f32 v[78:79], v[78:79], v[14:15] op_sel:[0,1] op_sel_hi:[1,1] neg_lo:[0,1] neg_hi:[0,1]
    v_mov_b32 v14, s47
    v_mul_f32 v14, 0x3a800000, v14
    v_cvt_pk_bf16_f32 v14, 0, v14
    v_add_f32 v14, 0x3727c5ac, v14
    v_cvt_pk_bf16_f32 v14, 0, v14
    v_sqrt_f32 v14, v14
    s_nop 0
    v_cvt_pk_bf16_f32 v14, 0, v14
    v_rcp_f32 v14, v14
    v_cvt_pk_bf16_f32 v64, 0, v64
    v_cvt_pk_bf16_f32 v65, 0, v65
    v_cvt_pk_bf16_f32 v66, 0, v66
    v_cvt_pk_bf16_f32 v67, 0, v67
    v_cvt_pk_bf16_f32 v68, 0, v68
    v_cvt_pk_bf16_f32 v69, 0, v69
    v_cvt_pk_bf16_f32 v70, 0, v70
    v_cvt_pk_bf16_f32 v71, 0, v71
    v_cvt_pk_bf16_f32 v72, 0, v72
    v_cvt_pk_bf16_f32 v73, 0, v73
    v_cvt_pk_bf16_f32 v74, 0, v74
    v_cvt_pk_bf16_f32 v75, 0, v75
    v_cvt_pk_bf16_f32 v76, 0, v76
    v_cvt_pk_bf16_f32 v77, 0, v77
    v_cvt_pk_bf16_f32 v78, 0, v78
    v_cvt_pk_bf16_f32 v79, 0, v79
    v_pk_mul_f32 v[64:65], v[64:65], v[14:15] op_sel_hi:[1,0]
    v_pk_mul_f32 v[66:67], v[66:67], v[14:15] op_sel_hi:[1,0]
    v_pk_mul_f32 v[68:69], v[68:69], v[14:15] op_sel_hi:[1,0]
    v_pk_mul_f32 v[70:71], v[70:71], v[14:15] op_sel_hi:[1,0]
    v_pk_mul_f32 v[72:73], v[72:73], v[14:15] op_sel_hi:[1,0]
    v_pk_mul_f32 v[74:75], v[74:75], v[14:15] op_sel_hi:[1,0]
    v_pk_mul_f32 v[76:77], v[76:77], v[14:15] op_sel_hi:[1,0]
    v_pk_mul_f32 v[78:79], v[78:79], v[14:15] op_sel_hi:[1,0]
    v_cvt_pk_bf16_f32 v64, 0, v64
    v_cvt_pk_bf16_f32 v65, 0, v65
    v_cvt_pk_bf16_f32 v66, 0, v66
    v_cvt_pk_bf16_f32 v67, 0, v67
    v_cvt_pk_bf16_f32 v68, 0, v68
    v_cvt_pk_bf16_f32 v69, 0, v69
    v_cvt_pk_bf16_f32 v70, 0, v70
    v_cvt_pk_bf16_f32 v71, 0, v71
    v_cvt_pk_bf16_f32 v72, 0, v72
    v_cvt_pk_bf16_f32 v73, 0, v73
    v_cvt_pk_bf16_f32 v74, 0, v74
    v_cvt_pk_bf16_f32 v75, 0, v75
    v_cvt_pk_bf16_f32 v76, 0, v76
    v_cvt_pk_bf16_f32 v77, 0, v77
    v_cvt_pk_bf16_f32 v78, 0, v78
    v_cvt_pk_bf16_f32 v79, 0, v79
    v_pk_mul_f32 v[64:65], v[64:65], v[32:33]
    v_pk_mul_f32 v[66:67], v[66:67], v[34:35]
    v_pk_mul_f32 v[68:69], v[68:69], v[36:37]
    v_pk_mul_f32 v[70:71], v[70:71], v[38:39]
    v_pk_mul_f32 v[72:73], v[72:73], v[40:41]
    v_pk_mul_f32 v[74:75], v[74:75], v[42:43]
    v_pk_mul_f32 v[76:77], v[76:77], v[44:45]
    v_pk_mul_f32 v[78:79], v[78:79], v[46:47]
    v_cvt_pk_bf16_f32 v64, 0, v64
    v_cvt_pk_bf16_f32 v65, 0, v65
    v_cvt_pk_bf16_f32 v66, 0, v66
    v_cvt_pk_bf16_f32 v67, 0, v67
    v_cvt_pk_bf16_f32 v68, 0, v68
    v_cvt_pk_bf16_f32 v69, 0, v69
    v_cvt_pk_bf16_f32 v70, 0, v70
    v_cvt_pk_bf16_f32 v71, 0, v71
    v_cvt_pk_bf16_f32 v72, 0, v72
    v_cvt_pk_bf16_f32 v73, 0, v73
    v_cvt_pk_bf16_f32 v74, 0, v74
    v_cvt_pk_bf16_f32 v75, 0, v75
    v_cvt_pk_bf16_f32 v76, 0, v76
    v_cvt_pk_bf16_f32 v77, 0, v77
    v_cvt_pk_bf16_f32 v78, 0, v78
    v_cvt_pk_bf16_f32 v79, 0, v79
    v_pk_add_f32 v[64:65], v[64:65], v[48:49]
    v_pk_add_f32 v[66:67], v[66:67], v[50:51]
    v_pk_add_f32 v[68:69], v[68:69], v[52:53]
    v_pk_add_f32 v[70:71], v[70:71], v[54:55]
    v_pk_add_f32 v[72:73], v[72:73], v[56:57]
    v_pk_add_f32 v[74:75], v[74:75], v[58:59]
    v_pk_add_f32 v[76:77], v[76:77], v[60:61]
    v_pk_add_f32 v[78:79], v[78:79], v[62:63]
    v_cvt_pk_bf16_f32 v104, v64, v65
    v_cvt_pk_bf16_f32 v105, v66, v67
    v_cvt_pk_bf16_f32 v106, v68, v69
    v_cvt_pk_bf16_f32 v107, v70, v71
    v_cvt_pk_bf16_f32 v108, v72, v73
    v_cvt_pk_bf16_f32 v109, v74, v75
    v_cvt_pk_bf16_f32 v110, v76, v77
    v_cvt_pk_bf16_f32 v111, v78, v79
    ds_write_b128 v10, v[104:107]
    ds_write_b128 v10, v[108:111] offset:1024
    s_waitcnt lgkmcnt(0)
    s_barrier
    ds_read_b128 v[104:107], v13
    ds_read_b128 v[108:111], v13 offset:128
    s_waitcnt lgkmcnt(1)
    buffer_store_dwordx4 v[104:107], v11, s[12:15], s63 offen sc1
    s_waitcnt lgkmcnt(0)
    buffer_store_dwordx4 v[108:111], v12, s[12:15], s63 offen sc1
    s_waitcnt vmcnt(0)
    s_barrier
    s_cmp_lg_u32 s44, 0
    s_cbranch_scc1 L_sf_21
    v_mov_b32 v14, s60
    v_add_u32 v14, 1, v14
    v_mov_b32 v15, 0
    s_mov_b64 exec, 1
    buffer_store_dword v14, v15, s[12:15], s52 offen sc1
    s_mov_b64 exec, -1
L_sf_21:
    s_cmp_ge_u32 s60, 8
    s_cbranch_scc1 L_l_end_20
    s_add_u32 s63, s63, 524288
    buffer_load_dwordx4 a[8:11], v7, s[24:27], s63 offen
    buffer_load_dwordx4 a[12:15], v7, s[24:27], s63 offen offset:1024
    s_add_u32 s63, s63, 524288
    buffer_load_dwordx4 a[16:19], v7, s[24:27], s63 offen
    buffer_load_dwordx4 a[20:23], v7, s[24:27], s63 offen offset:1024
    s_add_u32 s63, s63, 524288
    buffer_load_dwordx4 a[24:27], v7, s[24:27], s63 offen
    buffer_load_dwordx4 a[28:31], v7, s[24:27], s63 offen offset:1024
    s_add_u32 s63, s63, 524288
    buffer_load_dwordx4 a[32:35], v7, s[24:27], s63 offen
    buffer_load_dwordx4 a[36:39], v7, s[24:27], s63 offen offset:1024
    s_add_u32 s63, s63, 524288
    buffer_load_dwordx4 a[40:43], v7, s[24:27], s63 offen
    buffer_load_dwordx4 a[44:47], v7, s[24:27], s63 offen offset:1024
    s_add_u32 s63, s63, 524288
    buffer_load_dwordx4 a[48:51], v7, s[24:27], s63 offen
    buffer_load_dwordx4 a[52:55], v7, s[24:27], s63 offen offset:1024
    s_add_u32 s63, s63, 524288
    buffer_load_dwordx4 a[56:59], v7, s[24:27], s63 offen
    buffer_load_dwordx4 a[60:63], v7, s[24:27], s63 offen offset:1024
    s_waitcnt vmcnt(0)
L_l_end_20:
    v_accvgpr_mov_b32 a0, a8
    v_accvgpr_mov_b32 a1, a9
    v_accvgpr_mov_b32 a2, a10
    v_accvgpr_mov_b32 a3, a11
    v_accvgpr_mov_b32 a4, a12
    v_accvgpr_mov_b32 a5, a13
    v_accvgpr_mov_b32 a6, a14
    v_accvgpr_mov_b32 a7, a15
    v_accvgpr_mov_b32 a8, a16
    v_accvgpr_mov_b32 a9, a17
    v_accvgpr_mov_b32 a10, a18
    v_accvgpr_mov_b32 a11, a19
    v_accvgpr_mov_b32 a12, a20
    v_accvgpr_mov_b32 a13, a21
    v_accvgpr_mov_b32 a14, a22
    v_accvgpr_mov_b32 a15, a23
    v_accvgpr_mov_b32 a16, a24
    v_accvgpr_mov_b32 a17, a25
    v_accvgpr_mov_b32 a18, a26
    v_accvgpr_mov_b32 a19, a27
    v_accvgpr_mov_b32 a20, a28
    v_accvgpr_mov_b32 a21, a29
    v_accvgpr_mov_b32 a22, a30
    v_accvgpr_mov_b32 a23, a31
    v_accvgpr_mov_b32 a24, a32
    v_accvgpr_mov_b32 a25, a33
    v_accvgpr_mov_b32 a26, a34
    v_accvgpr_mov_b32 a27, a35
    v_accvgpr_mov_b32 a28, a36
    v_accvgpr_mov_b32 a29, a37
    v_accvgpr_mov_b32 a30, a38
    v_accvgpr_mov_b32 a31, a39
    v_accvgpr_mov_b32 a32, a40
    v_accvgpr_mov_b32 a33, a41
    v_accvgpr_mov_b32 a34, a42
    v_accvgpr_mov_b32 a35, a43
    v_accvgpr_mov_b32 a36, a44
    v_accvgpr_mov_b32 a37, a45
    v_accvgpr_mov_b32 a38, a46
    v_accvgpr_mov_b32 a39, a47
    v_accvgpr_mov_b32 a40, a48
    v_accvgpr_mov_b32 a41, a49
    v_accvgpr_mov_b32 a42, a50
    v_accvgpr_mov_b32 a43, a51
    v_accvgpr_mov_b32 a44, a52
    v_accvgpr_mov_b32 a45, a53
    v_accvgpr_mov_b32 a46, a54
    v_accvgpr_mov_b32 a47, a55
    v_accvgpr_mov_b32 a48, a56
    v_accvgpr_mov_b32 a49, a57
    v_accvgpr_mov_b32 a50, a58
    v_accvgpr_mov_b32 a51, a59
    v_accvgpr_mov_b32 a52, a60
    v_accvgpr_mov_b32 a53, a61
    v_accvgpr_mov_b32 a54, a62
    v_accvgpr_mov_b32 a55, a63
    s_add_u32 s60, s60, 8
    s_cmp_lt_u32 s60, 64
    s_cbranch_scc1 L_l_sub_19
    s_cmp_lt_u32 s48, 14
    s_cbranch_scc1 L_w_h_15_s
    s_and_b32 s55, s48, 1
    s_lshl_b32 s55, s55, 3
    s_add_u32 s55, s55, s40
    s_load_dwordx4 s[8:11], s[0:1], 96
    v_lshrrev_b32 v5, 3, v0
    s_mov_b32 s46, 196608
    v_mul_lo_u32 v4, v5, s46
    v_and_b32 v6, 7, v0
    v_lshl_add_u32 v4, v6, 4, v4
    v_lshlrev_b32 v5, 5, v5
    s_waitcnt lgkmcnt(0)
    s_mov_b32 s28, s10
    s_and_b32 s29, s11, 0xffff
    s_mov_b32 s30, 0xc00000
    s_mov_b32 s31, 0x00020000
    s_mov_b32 s32, s8
    s_and_b32 s33, s9, 0xffff
    s_mov_b32 s34, 0x800
    s_mov_b32 s35, 0x00020000
    buffer_load_dwordx4 v[8:11], v5, s[32:35], 0 offen
    buffer_load_dwordx4 v[12:15], v5, s[32:35], 0 offen offset:16
    s_waitcnt vmcnt(0)
    v_lshlrev_b32 v16, 16, v8
    v_and_b32 v17, 0xffff0000, v8
    v_lshlrev_b32 v18, 16, v9
    v_and_b32 v19, 0xffff0000, v9
    v_lshlrev_b32 v20, 16, v10
    v_and_b32 v21, 0xffff0000, v10
    v_lshlrev_b32 v22, 16, v11
    v_and_b32 v23, 0xffff0000, v11
    v_lshlrev_b32 v24, 16, v12
    v_and_b32 v25, 0xffff0000, v12
    v_lshlrev_b32 v26, 16, v13
    v_and_b32 v27, 0xffff0000, v13
    v_lshlrev_b32 v28, 16, v14
    v_and_b32 v29, 0xffff0000, v14
    v_lshlrev_b32 v30, 16, v15
    v_and_b32 v31, 0xffff0000, v15
    v_mul_f32 v112, 0xbfb8aa3b, v16
    v_mul_f32 v113, 0xbfb8aa3b, v17
    v_mul_f32 v114, 0xbfb8aa3b, v18
    v_mul_f32 v115, 0xbfb8aa3b, v19
    v_mul_f32 v116, 0xbfb8aa3b, v20
    v_mul_f32 v117, 0xbfb8aa3b, v21
    v_mul_f32 v118, 0xbfb8aa3b, v22
    v_mul_f32 v119, 0xbfb8aa3b, v23
    v_mul_f32 v120, 0xbfb8aa3b, v24
    v_mul_f32 v121, 0xbfb8aa3b, v25
    v_mul_f32 v122, 0xbfb8aa3b, v26
    v_mul_f32 v123, 0xbfb8aa3b, v27
    v_mul_f32 v124, 0xbfb8aa3b, v28
    v_mul_f32 v125, 0xbfb8aa3b, v29
    v_mul_f32 v126, 0xbfb8aa3b, v30
    v_mul_f32 v127, 0xbfb8aa3b, v31
    v_exp_f32 v112, v112
    v_exp_f32 v113, v113
    v_exp_f32 v114, v114
    v_exp_f32 v115, v115
    v_exp_f32 v116, v116
    v_exp_f32 v117, v117
    v_exp_f32 v118, v118
    v_exp_f32 v119, v119
    v_exp_f32 v120, v120
    v_exp_f32 v121, v121
    v_exp_f32 v122, v122
    v_exp_f32 v123, v123
    v_exp_f32 v124, v124
    v_exp_f32 v125, v125
    v_exp_f32 v126, v126
    v_exp_f32 v127, v127
    v_add_f32 v112, 1.0, v112
    v_add_f32 v113, 1.0, v113
    v_add_f32 v114, 1.0, v114
    v_add_f32 v115, 1.0, v115
    v_add_f32 v116, 1.0, v116
    v_add_f32 v117, 1.0, v117
    v_add_f32 v118, 1.0, v118
    v_add_f32 v119, 1.0, v119
    v_add_f32 v120, 1.0, v120
    v_add_f32 v121, 1.0, v121
    v_add_f32 v122, 1.0, v122
    v_add_f32 v123, 1.0, v123
    v_add_f32 v124, 1.0, v124
    v_add_f32 v125, 1.0, v125
    v_add_f32 v126, 1.0, v126
    v_add_f32 v127, 1.0, v127
    v_rcp_f32 v112, v112
    v_rcp_f32 v113, v113
    v_rcp_f32 v114, v114
    v_rcp_f32 v115, v115
    v_rcp_f32 v116, v116
    v_rcp_f32 v117, v117
    v_rcp_f32 v118, v118
    v_rcp_f32 v119, v119
    v_rcp_f32 v120, v120
    v_rcp_f32 v121, v121
    v_rcp_f32 v122, v122
    v_rcp_f32 v123, v123
    v_rcp_f32 v124, v124
    v_rcp_f32 v125, v125
    v_rcp_f32 v126, v126
    v_rcp_f32 v127, v127
    v_mul_f32 v16, v16, v112
    v_mul_f32 v17, v17, v113
    v_mul_f32 v18, v18, v114
    v_mul_f32 v19, v19, v115
    v_mul_f32 v20, v20, v116
    v_mul_f32 v21, v21, v117
    v_mul_f32 v22, v22, v118
    v_mul_f32 v23, v23, v119
    v_mul_f32 v24, v24, v120
    v_mul_f32 v25, v25, v121
    v_mul_f32 v26, v26, v122
    v_mul_f32 v27, v27, v123
    v_mul_f32 v28, v28, v124
    v_mul_f32 v29, v29, v125
    v_mul_f32 v30, v30, v126
    v_mul_f32 v31, v31, v127
    v_cvt_pk_bf16_f32 v16, 0, v16
    v_cvt_pk_bf16_f32 v17, 0, v17
    v_cvt_pk_bf16_f32 v18, 0, v18
    v_cvt_pk_bf16_f32 v19, 0, v19
    v_cvt_pk_bf16_f32 v20, 0, v20
    v_cvt_pk_bf16_f32 v21, 0, v21
    v_cvt_pk_bf16_f32 v22, 0, v22
    v_cvt_pk_bf16_f32 v23, 0, v23
    v_cvt_pk_bf16_f32 v24, 0, v24
    v_cvt_pk_bf16_f32 v25, 0, v25
    v_cvt_pk_bf16_f32 v26, 0, v26
    v_cvt_pk_bf16_f32 v27, 0, v27
    v_cvt_pk_bf16_f32 v28, 0, v28
    v_cvt_pk_bf16_f32 v29, 0, v29
    v_cvt_pk_bf16_f32 v30, 0, v30
    v_cvt_pk_bf16_f32 v31, 0, v31
    s_lshl_b32 s53, s55, 9
    s_add_u32 s53, s53, 4096
L_m_loop_22:
    s_add_u32 s46, s53, 0
    buffer_load_dwordx4 v[32:35], v4, s[28:31], s46 offen nt
    s_add_u32 s46, s53, 12288
    buffer_load_dwordx4 v[36:39], v4, s[28:31], s46 offen nt
    s_add_u32 s46, s53, 24576
    buffer_load_dwordx4 v[40:43], v4, s[28:31], s46 offen nt
    s_add_u32 s46, s53, 36864
    buffer_load_dwordx4 v[44:47], v4, s[28:31], s46 offen nt
    s_add_u32 s46, s53, 49152
    buffer_load_dwordx4 v[48:51], v4, s[28:31], s46 offen nt
    s_add_u32 s46, s53, 61440
    buffer_load_dwordx4 v[52:55], v4, s[28:31], s46 offen nt
    s_add_u32 s46, s53, 73728
    buffer_load_dwordx4 v[56:59], v4, s[28:31], s46 offen nt
    s_add_u32 s46, s53, 86016
    buffer_load_dwordx4 v[60:63], v4, s[28:31], s46 offen nt
    s_add_u32 s46, s53, 98304
    buffer_load_dwordx4 v[64:67], v4, s[28:31], s46 offen nt
    s_add_u32 s46, s53, 110592
    buffer_load_dwordx4 v[68:71], v4, s[28:31], s46 offen nt
    s_add_u32 s46, s53, 122880
    buffer_load_dwordx4 v[72:75], v4, s[28:31], s46 offen nt
    s_add_u32 s46, s53, 135168
    buffer_load_dwordx4 v[76:79], v4, s[28:31], s46 offen nt
    s_add_u32 s46, s53, 147456
    buffer_load_dwordx4 v[80:83], v4, s[28:31], s46 offen nt
    s_add_u32 s46, s53, 159744
    buffer_load_dwordx4 v[84:87], v4, s[28:31], s46 offen nt
    s_add_u32 s46, s53, 172032
    buffer_load_dwordx4 v[88:91], v4, s[28:31], s46 offen nt
    s_add_u32 s46, s53, 184320
    buffer_load_dwordx4 v[92:95], v4, s[28:31], s46 offen nt
    s_waitcnt vmcnt(15)
    v_lshlrev_b32 v104, 16, v32
    v_and_b32 v105, 0xffff0000, v32
    v_mul_f32 v96, v104, v16
    v_mul_f32 v97, v105, v16
    v_lshlrev_b32 v104, 16, v33
    v_and_b32 v105, 0xffff0000, v33
    v_mul_f32 v98, v104, v16
    v_mul_f32 v99, v105, v16
    v_lshlrev_b32 v104, 16, v34
    v_and_b32 v105, 0xffff0000, v34
    v_mul_f32 v100, v104, v16
    v_mul_f32 v101, v105, v16
    v_lshlrev_b32 v104, 16, v35
    v_and_b32 v105, 0xffff0000, v35
    v_mul_f32 v102, v104, v16
    v_mul_f32 v103, v105, v16
    s_waitcnt vmcnt(14)
    v_lshlrev_b32 v104, 16, v36
    v_and_b32 v105, 0xffff0000, v36
    v_fmac_f32 v96, v104, v17
    v_fmac_f32 v97, v105, v17
    v_lshlrev_b32 v104, 16, v37
    v_and_b32 v105, 0xffff0000, v37
    v_fmac_f32 v98, v104, v17
    v_fmac_f32 v99, v105, v17
    v_lshlrev_b32 v104, 16, v38
    v_and_b32 v105, 0xffff0000, v38
    v_fmac_f32 v100, v104, v17
    v_fmac_f32 v101, v105, v17
    v_lshlrev_b32 v104, 16, v39
    v_and_b32 v105, 0xffff0000, v39
    v_fmac_f32 v102, v104, v17
    v_fmac_f32 v103, v105, v17
    s_waitcnt vmcnt(13)
    v_lshlrev_b32 v104, 16, v40
    v_and_b32 v105, 0xffff0000, v40
    v_fmac_f32 v96, v104, v18
    v_fmac_f32 v97, v105, v18
    v_lshlrev_b32 v104, 16, v41
    v_and_b32 v105, 0xffff0000, v41
    v_fmac_f32 v98, v104, v18
    v_fmac_f32 v99, v105, v18
    v_lshlrev_b32 v104, 16, v42
    v_and_b32 v105, 0xffff0000, v42
    v_fmac_f32 v100, v104, v18
    v_fmac_f32 v101, v105, v18
    v_lshlrev_b32 v104, 16, v43
    v_and_b32 v105, 0xffff0000, v43
    v_fmac_f32 v102, v104, v18
    v_fmac_f32 v103, v105, v18
    s_waitcnt vmcnt(12)
    v_lshlrev_b32 v104, 16, v44
    v_and_b32 v105, 0xffff0000, v44
    v_fmac_f32 v96, v104, v19
    v_fmac_f32 v97, v105, v19
    v_lshlrev_b32 v104, 16, v45
    v_and_b32 v105, 0xffff0000, v45
    v_fmac_f32 v98, v104, v19
    v_fmac_f32 v99, v105, v19
    v_lshlrev_b32 v104, 16, v46
    v_and_b32 v105, 0xffff0000, v46
    v_fmac_f32 v100, v104, v19
    v_fmac_f32 v101, v105, v19
    v_lshlrev_b32 v104, 16, v47
    v_and_b32 v105, 0xffff0000, v47
    v_fmac_f32 v102, v104, v19
    v_fmac_f32 v103, v105, v19
    s_waitcnt vmcnt(11)
    v_lshlrev_b32 v104, 16, v48
    v_and_b32 v105, 0xffff0000, v48
    v_fmac_f32 v96, v104, v20
    v_fmac_f32 v97, v105, v20
    v_lshlrev_b32 v104, 16, v49
    v_and_b32 v105, 0xffff0000, v49
    v_fmac_f32 v98, v104, v20
    v_fmac_f32 v99, v105, v20
    v_lshlrev_b32 v104, 16, v50
    v_and_b32 v105, 0xffff0000, v50
    v_fmac_f32 v100, v104, v20
    v_fmac_f32 v101, v105, v20
    v_lshlrev_b32 v104, 16, v51
    v_and_b32 v105, 0xffff0000, v51
    v_fmac_f32 v102, v104, v20
    v_fmac_f32 v103, v105, v20
    s_waitcnt vmcnt(10)
    v_lshlrev_b32 v104, 16, v52
    v_and_b32 v105, 0xffff0000, v52
    v_fmac_f32 v96, v104, v21
    v_fmac_f32 v97, v105, v21
    v_lshlrev_b32 v104, 16, v53
    v_and_b32 v105, 0xffff0000, v53
    v_fmac_f32 v98, v104, v21
    v_fmac_f32 v99, v105, v21
    v_lshlrev_b32 v104, 16, v54
    v_and_b32 v105, 0xffff0000, v54
    v_fmac_f32 v100, v104, v21
    v_fmac_f32 v101, v105, v21
    v_lshlrev_b32 v104, 16, v55
    v_and_b32 v105, 0xffff0000, v55
    v_fmac_f32 v102, v104, v21
    v_fmac_f32 v103, v105, v21
    s_waitcnt vmcnt(9)
    v_lshlrev_b32 v104, 16, v56
    v_and_b32 v105, 0xffff0000, v56
    v_fmac_f32 v96, v104, v22
    v_fmac_f32 v97, v105, v22
    v_lshlrev_b32 v104, 16, v57
    v_and_b32 v105, 0xffff0000, v57
    v_fmac_f32 v98, v104, v22
    v_fmac_f32 v99, v105, v22
    v_lshlrev_b32 v104, 16, v58
    v_and_b32 v105, 0xffff0000, v58
    v_fmac_f32 v100, v104, v22
    v_fmac_f32 v101, v105, v22
    v_lshlrev_b32 v104, 16, v59
    v_and_b32 v105, 0xffff0000, v59
    v_fmac_f32 v102, v104, v22
    v_fmac_f32 v103, v105, v22
    s_waitcnt vmcnt(8)
    v_lshlrev_b32 v104, 16, v60
    v_and_b32 v105, 0xffff0000, v60
    v_fmac_f32 v96, v104, v23
    v_fmac_f32 v97, v105, v23
    v_lshlrev_b32 v104, 16, v61
    v_and_b32 v105, 0xffff0000, v61
    v_fmac_f32 v98, v104, v23
    v_fmac_f32 v99, v105, v23
    v_lshlrev_b32 v104, 16, v62
    v_and_b32 v105, 0xffff0000, v62
    v_fmac_f32 v100, v104, v23
    v_fmac_f32 v101, v105, v23
    v_lshlrev_b32 v104, 16, v63
    v_and_b32 v105, 0xffff0000, v63
    v_fmac_f32 v102, v104, v23
    v_fmac_f32 v103, v105, v23
    s_waitcnt vmcnt(7)
    v_lshlrev_b32 v104, 16, v64
    v_and_b32 v105, 0xffff0000, v64
    v_fmac_f32 v96, v104, v24
    v_fmac_f32 v97, v105, v24
    v_lshlrev_b32 v104, 16, v65
    v_and_b32 v105, 0xffff0000, v65
    v_fmac_f32 v98, v104, v24
    v_fmac_f32 v99, v105, v24
    v_lshlrev_b32 v104, 16, v66
    v_and_b32 v105, 0xffff0000, v66
    v_fmac_f32 v100, v104, v24
    v_fmac_f32 v101, v105, v24
    v_lshlrev_b32 v104, 16, v67
    v_and_b32 v105, 0xffff0000, v67
    v_fmac_f32 v102, v104, v24
    v_fmac_f32 v103, v105, v24
    s_waitcnt vmcnt(6)
    v_lshlrev_b32 v104, 16, v68
    v_and_b32 v105, 0xffff0000, v68
    v_fmac_f32 v96, v104, v25
    v_fmac_f32 v97, v105, v25
    v_lshlrev_b32 v104, 16, v69
    v_and_b32 v105, 0xffff0000, v69
    v_fmac_f32 v98, v104, v25
    v_fmac_f32 v99, v105, v25
    v_lshlrev_b32 v104, 16, v70
    v_and_b32 v105, 0xffff0000, v70
    v_fmac_f32 v100, v104, v25
    v_fmac_f32 v101, v105, v25
    v_lshlrev_b32 v104, 16, v71
    v_and_b32 v105, 0xffff0000, v71
    v_fmac_f32 v102, v104, v25
    v_fmac_f32 v103, v105, v25
    s_waitcnt vmcnt(5)
    v_lshlrev_b32 v104, 16, v72
    v_and_b32 v105, 0xffff0000, v72
    v_fmac_f32 v96, v104, v26
    v_fmac_f32 v97, v105, v26
    v_lshlrev_b32 v104, 16, v73
    v_and_b32 v105, 0xffff0000, v73
    v_fmac_f32 v98, v104, v26
    v_fmac_f32 v99, v105, v26
    v_lshlrev_b32 v104, 16, v74
    v_and_b32 v105, 0xffff0000, v74
    v_fmac_f32 v100, v104, v26
    v_fmac_f32 v101, v105, v26
    v_lshlrev_b32 v104, 16, v75
    v_and_b32 v105, 0xffff0000, v75
    v_fmac_f32 v102, v104, v26
    v_fmac_f32 v103, v105, v26
    s_waitcnt vmcnt(4)
    v_lshlrev_b32 v104, 16, v76
    v_and_b32 v105, 0xffff0000, v76
    v_fmac_f32 v96, v104, v27
    v_fmac_f32 v97, v105, v27
    v_lshlrev_b32 v104, 16, v77
    v_and_b32 v105, 0xffff0000, v77
    v_fmac_f32 v98, v104, v27
    v_fmac_f32 v99, v105, v27
    v_lshlrev_b32 v104, 16, v78
    v_and_b32 v105, 0xffff0000, v78
    v_fmac_f32 v100, v104, v27
    v_fmac_f32 v101, v105, v27
    v_lshlrev_b32 v104, 16, v79
    v_and_b32 v105, 0xffff0000, v79
    v_fmac_f32 v102, v104, v27
    v_fmac_f32 v103, v105, v27
    s_waitcnt vmcnt(3)
    v_lshlrev_b32 v104, 16, v80
    v_and_b32 v105, 0xffff0000, v80
    v_fmac_f32 v96, v104, v28
    v_fmac_f32 v97, v105, v28
    v_lshlrev_b32 v104, 16, v81
    v_and_b32 v105, 0xffff0000, v81
    v_fmac_f32 v98, v104, v28
    v_fmac_f32 v99, v105, v28
    v_lshlrev_b32 v104, 16, v82
    v_and_b32 v105, 0xffff0000, v82
    v_fmac_f32 v100, v104, v28
    v_fmac_f32 v101, v105, v28
    v_lshlrev_b32 v104, 16, v83
    v_and_b32 v105, 0xffff0000, v83
    v_fmac_f32 v102, v104, v28
    v_fmac_f32 v103, v105, v28
    s_waitcnt vmcnt(2)
    v_lshlrev_b32 v104, 16, v84
    v_and_b32 v105, 0xffff0000, v84
    v_fmac_f32 v96, v104, v29
    v_fmac_f32 v97, v105, v29
    v_lshlrev_b32 v104, 16, v85
    v_and_b32 v105, 0xffff0000, v85
    v_fmac_f32 v98, v104, v29
    v_fmac_f32 v99, v105, v29
    v_lshlrev_b32 v104, 16, v86
    v_and_b32 v105, 0xffff0000, v86
    v_fmac_f32 v100, v104, v29
    v_fmac_f32 v101, v105, v29
    v_lshlrev_b32 v104, 16, v87
    v_and_b32 v105, 0xffff0000, v87
    v_fmac_f32 v102, v104, v29
    v_fmac_f32 v103, v105, v29
    s_waitcnt vmcnt(1)
    v_lshlrev_b32 v104, 16, v88
    v_and_b32 v105, 0xffff0000, v88
    v_fmac_f32 v96, v104, v30
    v_fmac_f32 v97, v105, v30
    v_lshlrev_b32 v104, 16, v89
    v_and_b32 v105, 0xffff0000, v89
    v_fmac_f32 v98, v104, v30
    v_fmac_f32 v99, v105, v30
    v_lshlrev_b32 v104, 16, v90
    v_and_b32 v105, 0xffff0000, v90
    v_fmac_f32 v100, v104, v30
    v_fmac_f32 v101, v105, v30
    v_lshlrev_b32 v104, 16, v91
    v_and_b32 v105, 0xffff0000, v91
    v_fmac_f32 v102, v104, v30
    v_fmac_f32 v103, v105, v30
    s_waitcnt vmcnt(0)
    v_lshlrev_b32 v104, 16, v92
    v_and_b32 v105, 0xffff0000, v92
    v_fmac_f32 v96, v104, v31
    v_fmac_f32 v97, v105, v31
    v_lshlrev_b32 v104, 16, v93
    v_and_b32 v105, 0xffff0000, v93
    v_fmac_f32 v98, v104, v31
    v_fmac_f32 v99, v105, v31
    v_lshlrev_b32 v104, 16, v94
    v_and_b32 v105, 0xffff0000, v94
    v_fmac_f32 v100, v104, v31
    v_fmac_f32 v101, v105, v31
    v_lshlrev_b32 v104, 16, v95
    v_and_b32 v105, 0xffff0000, v95
    v_fmac_f32 v102, v104, v31
    v_fmac_f32 v103, v105, v31
    v_lshlrev_b32 v104, 5, v0
    ds_write_b128 v104, v[96:99]
    ds_write_b128 v104, v[100:103] offset:16
    v_lshlrev_b32 v105, 2, v1
    s_lshl_b32 s46, s44, 11
    v_add_u32 v104, s46, v105
    s_waitcnt lgkmcnt(0)
    ds_read_b32 v96, v104 offset:0
    ds_read_b32 v97, v104 offset:256
    ds_read_b32 v98, v104 offset:512
    ds_read_b32 v99, v104 offset:768
    ds_read_b32 v100, v104 offset:1024
    ds_read_b32 v101, v104 offset:1280
    ds_read_b32 v102, v104 offset:1536
    ds_read_b32 v103, v104 offset:1792
    s_waitcnt lgkmcnt(0)
    v_add_f32 v96, v96, v100
    v_add_f32 v97, v97, v101
    v_add_f32 v98, v98, v102
    v_add_f32 v99, v99, v103
    v_add_f32 v96, v96, v98
    v_add_f32 v97, v97, v99
    v_add_f32 v96, v96, v97
    v_lshlrev_b32 v104, 2, v0
    ds_write_b32 v104, v96 offset:16384
    s_waitcnt lgkmcnt(0)
    s_barrier
    s_cmp_lg_u32 s44, 0
    s_cbranch_scc1 L_m_sk_23
    ds_read_b32 v96, v105 offset:16384
    ds_read_b32 v97, v105 offset:16640
    ds_read_b32 v98, v105 offset:16896
    ds_read_b32 v99, v105 offset:17152
    ds_read_b32 v100, v105 offset:17408
    ds_read_b32 v101, v105 offset:17664
    ds_read_b32 v102, v105 offset:17920
    ds_read_b32 v103, v105 offset:18176
    s_waitcnt lgkmcnt(0)
    v_add_f32 v96, v96, v100
    v_add_f32 v97, v97, v101
    v_add_f32 v98, v98, v102
    v_add_f32 v99, v99, v103
    v_add_f32 v96, v96, v98
    v_add_f32 v97, v97, v99
    v_add_f32 v96, v96, v97
    v_cvt_pk_bf16_f32 v96, 0, v96
    s_lshl_b32 s46, s53, 1
    buffer_store_dword v96, v105, s[12:15], s46 offen sc1
L_m_sk_23:
    s_barrier
    s_add_u32 s53, s53, 128
    s_and_b32 s46, s53, 511
    s_cmp_lg_u32 s46, 0
    s_cbranch_scc1 L_m_loop_22
    s_lshl_b32 s54, s55, 7
    s_add_u32 s54, s54, 0x10e400
    s_mov_b32 s60, 0
    s_waitcnt vmcnt(0)
    s_cmp_lg_u32 s44, 0
    s_cbranch_scc1 L_sf_24
    v_mov_b32 v8, s60
    v_add_u32 v8, 1, v8
    v_mov_b32 v9, 0
    s_mov_b64 exec, 1
    buffer_store_dword v8, v9, s[12:15], s54 offen sc1
    s_mov_b64 exec, -1
L_sf_24:
    s_barrier
L_w_h_15_s:
    s_mov_b32 s77, s48
    s_cmp_eq_u32 s48, 14
    s_cselect_b32 s53, 2, 1
    s_sub_u32 s48, s48, 12
    s_min_u32 s48, s48, 2
    s_mov_b32 s79, 0
L_w_h_15_n:
    s_cmp_eq_u32 s53, 1
    s_cselect_b32 s74, 41, 54
    s_cselect_b32 s75, 58, 64
    s_mov_b32 s76, 65536
    s_branch L_w_g_8_e
L_w_h_15:
    s_mov_b32 s48, s77
    s_cmp_lt_u32 s48, 14
    s_cbranch_scc1 L_w_att_13
    s_and_b32 s42, s40, 3
    s_lshr_b32 s43, s40, 2
    s_cmp_eq_u32 s48, 14
    s_cbranch_scc1 L_w_c_14
    s_mov_b32 s75, 58
    s_mov_b32 s76, 0
    s_mov_b32 s78, 2
L_w_h_15_f:
    s_load_dwordx2 s[4:5], s[0:1], 112
    s_load_dwordx2 s[6:7], s[0:1], 88
    v_lshlrev_b32 v2, 4, v1
    v_lshlrev_b32 v3, 5, v1
    s_waitcnt lgkmcnt(0)
    s_mov_b32 s24, s4
    s_and_b32 s25, s5, 0xffff
    s_mov_b32 s26, 0x400000
    s_mov_b32 s27, 0x00020000
    s_mov_b32 s28, s6
    s_and_b32 s29, s7, 0xffff
    s_mov_b32 s30, 0x800
    s_mov_b32 s31, 0x00020000
    s_cmp_lg_u32 s44, 0
    s_cbranch_scc1 L_mw_25
    v_and_b32 v8, 15, v1
    v_lshlrev_b32 v8, 7, v8
    s_mov_b32 s46, 0x10e400
    s_mov_b32 s47, 0
    s_mov_b32 s70, 0
L_spin_26:
    buffer_load_dword v9, v8, s[12:15], s46 offen sc1
    s_waitcnt vmcnt(0)
    v_cmp_ge_u32 vcc, s47, v9
    s_add_u32 s70, s70, 1
    s_cbranch_vccz L_spok_27
    s_sleep 2
    s_cmp_lt_u32 s70, 524288
    s_cbranch_scc1 L_spin_26
    s_branch L_c_done_1
L_spok_27:
L_mw_25:
    s_barrier
    s_mov_b32 s46, 20480
    buffer_load_dwordx4 v[16:19], v3, s[12:15], s46 offen offset:0 sc1
    buffer_load_dwordx4 v[20:23], v3, s[12:15], s46 offen offset:16 sc1
    buffer_load_dwordx4 v[24:27], v3, s[12:15], s46 offen offset:2048 sc1
    buffer_load_dwordx4 v[28:31], v3, s[12:15], s46 offen offset:2064 sc1
    buffer_load_dwordx4 v[48:51], v2, s[28:31], 0 offen
    buffer_load_dwordx4 v[52:55], v2, s[28:31], 0 offen offset:1024
    s_waitcnt vmcnt(0)
    v_lshlrev_b32 v32, 16, v48
    v_and_b32 v33, 0xffff0000, v48
    v_lshlrev_b32 v34, 16, v49
    v_and_b32 v35, 0xffff0000, v49
    v_lshlrev_b32 v36, 16, v50
    v_and_b32 v37, 0xffff0000, v50
    v_lshlrev_b32 v38, 16, v51
    v_and_b32 v39, 0xffff0000, v51
    v_lshlrev_b32 v40, 16, v52
    v_and_b32 v41, 0xffff0000, v52
    v_lshlrev_b32 v42, 16, v53
    v_and_b32 v43, 0xffff0000, v53
    v_lshlrev_b32 v44, 16, v54
    v_and_b32 v45, 0xffff0000, v54
    v_lshlrev_b32 v46, 16, v55
    v_and_b32 v47, 0xffff0000, v55
    s_lshl_b32 s46, s42, 14
    s_lshl_b32 s47, s44, 11
    s_add_u32 s46, s46, s47
    s_add_u32 s46, s46, 0xb000000
    v_add_u32 v4, s46, v2
    v_and_b32 v5, 31, v1
    v_lshlrev_b32 v5, 7, v5
    v_add_u32 v5, 0x108400, v5
    v_lshlrev_b32 v6, 2, v1
    s_lshl_b32 s46, s44, 9
    v_add_u32 v6, s46, v6
    s_lshl_b32 s46, s44, 12
    v_add_u32 v7, s46, v3
    s_lshl_b32 s46, s42, 3
    s_add_u32 s46, s46, s44
    s_lshl_b32 s46, s46, 11
    v_add_u32 v8, s46, v2
    v_add_u32 v9, 0x800000, v8
    s_mov_b32 s60, s43
L_r_loop_28:
    s_lshl_b32 s61, s60, 18
    s_lshl_b32 s63, s60, 16
    s_cmp_lg_u32 s44, 0
    s_cbranch_scc1 L_r_nsp_29
    s_mov_b32 s70, 0
L_spin_30:
    buffer_load_dword v14, v5, s[12:15], s76 offen sc1
    s_waitcnt vmcnt(0)
    v_cmp_ge_u32 vcc, s60, v14
    s_add_u32 s70, s70, 1
    s_cbranch_vccz L_spok_31
    s_sleep 3
    s_cmp_lt_u32 s70, 524288
    s_cbranch_scc1 L_spin_30
    s_branch L_c_done_1
L_spok_31:
L_r_nsp_29:
    s_barrier
    buffer_load_dwordx4 v[96:99], v4, s[12:15], s61 offen offset:0 sc1
    buffer_load_dwordx4 v[100:103], v4, s[12:15], s61 offen offset:1024 sc1
    s_add_u32 s61, s61, 65536
    buffer_load_dwordx4 v[104:107], v4, s[12:15], s61 offen offset:0 sc1
    buffer_load_dwordx4 v[108:111], v4, s[12:15], s61 offen offset:1024 sc1
    s_add_u32 s61, s61, 65536
    buffer_load_dwordx4 v[112:115], v4, s[12:15], s61 offen offset:0 sc1
    buffer_load_dwordx4 v[116:119], v4, s[12:15], s61 offen offset:1024 sc1
    s_add_u32 s61, s61, 65536
    buffer_load_dwordx4 v[120:123], v4, s[12:15], s61 offen offset:0 sc1
    buffer_load_dwordx4 v[124:127], v4, s[12:15], s61 offen offset:1024 sc1
    buffer_load_dwordx4 a[0:3], v9, s[12:15], s63 offen sc1
    buffer_load_dwordx4 a[4:7], v9, s[12:15], s63 offen offset:1024 sc1
    s_waitcnt vmcnt(8)
    v_lshlrev_b32 v64, 16, v96
    v_and_b32 v65, 0xffff0000, v96
    v_lshlrev_b32 v66, 16, v97
    v_and_b32 v67, 0xffff0000, v97
    v_lshlrev_b32 v68, 16, v98
    v_and_b32 v69, 0xffff0000, v98
    v_lshlrev_b32 v70, 16, v99
    v_and_b32 v71, 0xffff0000, v99
    v_lshlrev_b32 v72, 16, v100
    v_and_b32 v73, 0xffff0000, v100
    v_lshlrev_b32 v74, 16, v101
    v_and_b32 v75, 0xffff0000, v101
    v_lshlrev_b32 v76, 16, v102
    v_and_b32 v77, 0xffff0000, v102
    v_lshlrev_b32 v78, 16, v103
    v_and_b32 v79, 0xffff0000, v103
    s_waitcnt vmcnt(6)
    v_lshlrev_b32 v14, 16, v104
    v_and_b32 v15, 0xffff0000, v104
    v_pk_add_f32 v[64:65], v[64:65], v[14:15]
    v_lshlrev_b32 v14, 16, v105
    v_and_b32 v15, 0xffff0000, v105
    v_pk_add_f32 v[66:67], v[66:67], v[14:15]
    v_lshlrev_b32 v14, 16, v106
    v_and_b32 v15, 0xffff0000, v106
    v_pk_add_f32 v[68:69], v[68:69], v[14:15]
    v_lshlrev_b32 v14, 16, v107
    v_and_b32 v15, 0xffff0000, v107
    v_pk_add_f32 v[70:71], v[70:71], v[14:15]
    v_lshlrev_b32 v14, 16, v108
    v_and_b32 v15, 0xffff0000, v108
    v_pk_add_f32 v[72:73], v[72:73], v[14:15]
    v_lshlrev_b32 v14, 16, v109
    v_and_b32 v15, 0xffff0000, v109
    v_pk_add_f32 v[74:75], v[74:75], v[14:15]
    v_lshlrev_b32 v14, 16, v110
    v_and_b32 v15, 0xffff0000, v110
    v_pk_add_f32 v[76:77], v[76:77], v[14:15]
    v_lshlrev_b32 v14, 16, v111
    v_and_b32 v15, 0xffff0000, v111
    v_pk_add_f32 v[78:79], v[78:79], v[14:15]
    s_waitcnt vmcnt(4)
    v_lshlrev_b32 v14, 16, v112
    v_and_b32 v15, 0xffff0000, v112
    v_pk_add_f32 v[64:65], v[64:65], v[14:15]
    v_lshlrev_b32 v14, 16, v113
    v_and_b32 v15, 0xffff0000, v113
    v_pk_add_f32 v[66:67], v[66:67], v[14:15]
    v_lshlrev_b32 v14, 16, v114
    v_and_b32 v15, 0xffff0000, v114
    v_pk_add_f32 v[68:69], v[68:69], v[14:15]
    v_lshlrev_b32 v14, 16, v115
    v_and_b32 v15, 0xffff0000, v115
    v_pk_add_f32 v[70:71], v[70:71], v[14:15]
    v_lshlrev_b32 v14, 16, v116
    v_and_b32 v15, 0xffff0000, v116
    v_pk_add_f32 v[72:73], v[72:73], v[14:15]
    v_lshlrev_b32 v14, 16, v117
    v_and_b32 v15, 0xffff0000, v117
    v_pk_add_f32 v[74:75], v[74:75], v[14:15]
    v_lshlrev_b32 v14, 16, v118
    v_and_b32 v15, 0xffff0000, v118
    v_pk_add_f32 v[76:77], v[76:77], v[14:15]
    v_lshlrev_b32 v14, 16, v119
    v_and_b32 v15, 0xffff0000, v119
    v_pk_add_f32 v[78:79], v[78:79], v[14:15]
    s_waitcnt vmcnt(2)
    v_lshlrev_b32 v14, 16, v120
    v_and_b32 v15, 0xffff0000, v120
    v_pk_add_f32 v[64:65], v[64:65], v[14:15]
    v_lshlrev_b32 v14, 16, v121
    v_and_b32 v15, 0xffff0000, v121
    v_pk_add_f32 v[66:67], v[66:67], v[14:15]
    v_lshlrev_b32 v14, 16, v122
    v_and_b32 v15, 0xffff0000, v122
    v_pk_add_f32 v[68:69], v[68:69], v[14:15]
    v_lshlrev_b32 v14, 16, v123
    v_and_b32 v15, 0xffff0000, v123
    v_pk_add_f32 v[70:71], v[70:71], v[14:15]
    v_lshlrev_b32 v14, 16, v124
    v_and_b32 v15, 0xffff0000, v124
    v_pk_add_f32 v[72:73], v[72:73], v[14:15]
    v_lshlrev_b32 v14, 16, v125
    v_and_b32 v15, 0xffff0000, v125
    v_pk_add_f32 v[74:75], v[74:75], v[14:15]
    v_lshlrev_b32 v14, 16, v126
    v_and_b32 v15, 0xffff0000, v126
    v_pk_add_f32 v[76:77], v[76:77], v[14:15]
    v_lshlrev_b32 v14, 16, v127
    v_and_b32 v15, 0xffff0000, v127
    v_pk_add_f32 v[78:79], v[78:79], v[14:15]
    ds_write_b32 v6, v64 offset:0
    ds_write_b32 v6, v65 offset:4096
    ds_write_b32 v6, v66 offset:8192
    ds_write_b32 v6, v67 offset:12288
    ds_write_b32 v6, v68 offset:16384
    ds_write_b32 v6, v69 offset:20480
    ds_write_b32 v6, v70 offset:24576
    ds_write_b32 v6, v71 offset:28672
    ds_write_b32 v6, v72 offset:256
    ds_write_b32 v6, v73 offset:4352
    ds_write_b32 v6, v74 offset:8448
    ds_write_b32 v6, v75 offset:12544
    ds_write_b32 v6, v76 offset:16640
    ds_write_b32 v6, v77 offset:20736
    ds_write_b32 v6, v78 offset:24832
    ds_write_b32 v6, v79 offset:28928
    s_waitcnt lgkmcnt(0)
    s_barrier
    ds_read_b128 v[64:67], v7
    ds_read_b128 v[68:71], v7 offset:16
    ds_read_b128 v[72:75], v7 offset:2048
    ds_read_b128 v[76:79], v7 offset:2064
    s_waitcnt vmcnt(0)
    v_accvgpr_read_b32 v96, a0
    v_accvgpr_read_b32 v97, a1
    v_accvgpr_read_b32 v98, a2
    v_accvgpr_read_b32 v99, a3
    v_accvgpr_read_b32 v100, a4
    v_accvgpr_read_b32 v101, a5
    v_accvgpr_read_b32 v102, a6
    v_accvgpr_read_b32 v103, a7
    v_lshlrev_b32 v80, 16, v96
    v_and_b32 v81, 0xffff0000, v96
    v_lshlrev_b32 v82, 16, v97
    v_and_b32 v83, 0xffff0000, v97
    v_lshlrev_b32 v84, 16, v98
    v_and_b32 v85, 0xffff0000, v98
    v_lshlrev_b32 v86, 16, v99
    v_and_b32 v87, 0xffff0000, v99
    v_lshlrev_b32 v88, 16, v100
    v_and_b32 v89, 0xffff0000, v100
    v_lshlrev_b32 v90, 16, v101
    v_and_b32 v91, 0xffff0000, v101
    v_lshlrev_b32 v92, 16, v102
    v_and_b32 v93, 0xffff0000, v102
    v_lshlrev_b32 v94, 16, v103
    v_and_b32 v95, 0xffff0000, v103
    s_waitcnt lgkmcnt(0)
    v_cvt_pk_bf16_f32 v64, 0, v64
    v_cvt_pk_bf16_f32 v65, 0, v65
    v_cvt_pk_bf16_f32 v66, 0, v66
    v_cvt_pk_bf16_f32 v67, 0, v67
    v_cvt_pk_bf16_f32 v68, 0, v68
    v_cvt_pk_bf16_f32 v69, 0, v69
    v_cvt_pk_bf16_f32 v70, 0, v70
    v_cvt_pk_bf16_f32 v71, 0, v71
    v_cvt_pk_bf16_f32 v72, 0, v72
    v_cvt_pk_bf16_f32 v73, 0, v73
    v_cvt_pk_bf16_f32 v74, 0, v74
    v_cvt_pk_bf16_f32 v75, 0, v75
    v_cvt_pk_bf16_f32 v76, 0, v76
    v_cvt_pk_bf16_f32 v77, 0, v77
    v_cvt_pk_bf16_f32 v78, 0, v78
    v_cvt_pk_bf16_f32 v79, 0, v79
    v_pk_add_f32 v[64:65], v[64:65], v[32:33]
    v_pk_add_f32 v[66:67], v[66:67], v[34:35]
    v_pk_add_f32 v[68:69], v[68:69], v[36:37]
    v_pk_add_f32 v[70:71], v[70:71], v[38:39]
    v_pk_add_f32 v[72:73], v[72:73], v[40:41]
    v_pk_add_f32 v[74:75], v[74:75], v[42:43]
    v_pk_add_f32 v[76:77], v[76:77], v[44:45]
    v_pk_add_f32 v[78:79], v[78:79], v[46:47]
    v_cvt_pk_bf16_f32 v64, 0, v64
    v_cvt_pk_bf16_f32 v65, 0, v65
    v_cvt_pk_bf16_f32 v66, 0, v66
    v_cvt_pk_bf16_f32 v67, 0, v67
    v_cvt_pk_bf16_f32 v68, 0, v68
    v_cvt_pk_bf16_f32 v69, 0, v69
    v_cvt_pk_bf16_f32 v70, 0, v70
    v_cvt_pk_bf16_f32 v71, 0, v71
    v_cvt_pk_bf16_f32 v72, 0, v72
    v_cvt_pk_bf16_f32 v73, 0, v73
    v_cvt_pk_bf16_f32 v74, 0, v74
    v_cvt_pk_bf16_f32 v75, 0, v75
    v_cvt_pk_bf16_f32 v76, 0, v76
    v_cvt_pk_bf16_f32 v77, 0, v77
    v_cvt_pk_bf16_f32 v78, 0, v78
    v_cvt_pk_bf16_f32 v79, 0, v79
    v_pk_mul_f32 v[64:65], v[64:65], v[16:17]
    v_pk_mul_f32 v[66:67], v[66:67], v[18:19]
    v_pk_mul_f32 v[68:69], v[68:69], v[20:21]
    v_pk_mul_f32 v[70:71], v[70:71], v[22:23]
    v_pk_mul_f32 v[72:73], v[72:73], v[24:25]
    v_pk_mul_f32 v[74:75], v[74:75], v[26:27]
    v_pk_mul_f32 v[76:77], v[76:77], v[28:29]
    v_pk_mul_f32 v[78:79], v[78:79], v[30:31]
    v_cvt_pk_bf16_f32 v64, 0, v64
    v_cvt_pk_bf16_f32 v65, 0, v65
    v_cvt_pk_bf16_f32 v66, 0, v66
    v_cvt_pk_bf16_f32 v67, 0, v67
    v_cvt_pk_bf16_f32 v68, 0, v68
    v_cvt_pk_bf16_f32 v69, 0, v69
    v_cvt_pk_bf16_f32 v70, 0, v70
    v_cvt_pk_bf16_f32 v71, 0, v71
    v_cvt_pk_bf16_f32 v72, 0, v72
    v_cvt_pk_bf16_f32 v73, 0, v73
    v_cvt_pk_bf16_f32 v74, 0, v74
    v_cvt_pk_bf16_f32 v75, 0, v75
    v_cvt_pk_bf16_f32 v76, 0, v76
    v_cvt_pk_bf16_f32 v77, 0, v77
    v_cvt_pk_bf16_f32 v78, 0, v78
    v_cvt_pk_bf16_f32 v79, 0, v79
    v_pk_add_f32 v[64:65], v[64:65], v[80:81]
    v_pk_add_f32 v[66:67], v[66:67], v[82:83]
    v_pk_add_f32 v[68:69], v[68:69], v[84:85]
    v_pk_add_f32 v[70:71], v[70:71], v[86:87]
    v_pk_add_f32 v[72:73], v[72:73], v[88:89]
    v_pk_add_f32 v[74:75], v[74:75], v[90:91]
    v_pk_add_f32 v[76:77], v[76:77], v[92:93]
    v_pk_add_f32 v[78:79], v[78:79], v[94:95]
    v_cvt_pk_bf16_f32 v96, v64, v65
    v_cvt_pk_bf16_f32 v97, v66, v67
    v_cvt_pk_bf16_f32 v98, v68, v69
    v_cvt_pk_bf16_f32 v99, v70, v71
    v_cvt_pk_bf16_f32 v100, v72, v73
    v_cvt_pk_bf16_f32 v101, v74, v75
    v_cvt_pk_bf16_f32 v102, v76, v77
    v_cvt_pk_bf16_f32 v103, v78, v79
    buffer_store_dwordx4 v[96:99], v8, s[24:27], s63 offen
    buffer_store_dwordx4 v[100:103], v8, s[24:27], s63 offen offset:1024
    s_add_u32 s60, s60, s78
    s_cmp_lt_u32 s60, s75
    s_cbranch_scc1 L_r_loop_28
    s_branch L_c_done_1
L_w_c_14:
    s_load_dwordx2 s[4:5], s[0:1], 0
    s_load_dwordx2 s[6:7], s[0:1], 88
    v_lshlrev_b32 v2, 4, v1
    v_lshlrev_b32 v3, 5, v1
    s_waitcnt lgkmcnt(0)
    s_mov_b32 s24, s4
    s_and_b32 s25, s5, 0xffff
    s_mov_b32 s26, 0x400000
    s_mov_b32 s27, 0x00020000
    s_mov_b32 s28, s6
    s_and_b32 s29, s7, 0xffff
    s_mov_b32 s30, 0x800
    s_mov_b32 s31, 0x00020000
    s_cmp_lg_u32 s44, 0
    s_cbranch_scc1 L_mw_32
    v_and_b32 v8, 15, v1
    v_lshlrev_b32 v8, 7, v8
    s_mov_b32 s46, 0x10e400
    s_mov_b32 s47, 0
    s_mov_b32 s70, 0
L_spin_33:
    buffer_load_dword v9, v8, s[12:15], s46 offen sc1
    s_waitcnt vmcnt(0)
    v_cmp_ge_u32 vcc, s47, v9
    s_add_u32 s70, s70, 1
    s_cbranch_vccz L_spok_34
    s_sleep 2
    s_cmp_lt_u32 s70, 524288
    s_cbranch_scc1 L_spin_33
    s_branch L_c_done_1
L_spok_34:
L_mw_32:
    s_barrier
    s_mov_b32 s46, 8192
    buffer_load_dwordx4 v[16:19], v3, s[12:15], s46 offen offset:0 sc1
    buffer_load_dwordx4 v[20:23], v3, s[12:15], s46 offen offset:16 sc1
    buffer_load_dwordx4 v[24:27], v3, s[12:15], s46 offen offset:2048 sc1
    buffer_load_dwordx4 v[28:31], v3, s[12:15], s46 offen offset:2064 sc1
    s_mov_b32 s46, 16384
    buffer_load_dwordx4 v[32:35], v3, s[12:15], s46 offen offset:0 sc1
    buffer_load_dwordx4 v[36:39], v3, s[12:15], s46 offen offset:16 sc1
    buffer_load_dwordx4 v[40:43], v3, s[12:15], s46 offen offset:2048 sc1
    buffer_load_dwordx4 v[44:47], v3, s[12:15], s46 offen offset:2064 sc1
    s_mov_b32 s46, 12288
    buffer_load_dwordx4 v[48:51], v3, s[12:15], s46 offen offset:0 sc1
    buffer_load_dwordx4 v[52:55], v3, s[12:15], s46 offen offset:16 sc1
    buffer_load_dwordx4 v[56:59], v3, s[12:15], s46 offen offset:2048 sc1
    buffer_load_dwordx4 v[60:63], v3, s[12:15], s46 offen offset:2064 sc1
    s_waitcnt vmcnt(0)
    v_add_f32 v32, 1.0, v32
    v_add_f32 v33, 1.0, v33
    v_add_f32 v34, 1.0, v34
    v_add_f32 v35, 1.0, v35
    v_add_f32 v36, 1.0, v36
    v_add_f32 v37, 1.0, v37
    v_add_f32 v38, 1.0, v38
    v_add_f32 v39, 1.0, v39
    v_add_f32 v40, 1.0, v40
    v_add_f32 v41, 1.0, v41
    v_add_f32 v42, 1.0, v42
    v_add_f32 v43, 1.0, v43
    v_add_f32 v44, 1.0, v44
    v_add_f32 v45, 1.0, v45
    v_add_f32 v46, 1.0, v46
    v_add_f32 v47, 1.0, v47
    v_cvt_pk_bf16_f32 v32, 0, v32
    v_cvt_pk_bf16_f32 v33, 0, v33
    v_cvt_pk_bf16_f32 v34, 0, v34
    v_cvt_pk_bf16_f32 v35, 0, v35
    v_cvt_pk_bf16_f32 v36, 0, v36
    v_cvt_pk_bf16_f32 v37, 0, v37
    v_cvt_pk_bf16_f32 v38, 0, v38
    v_cvt_pk_bf16_f32 v39, 0, v39
    v_cvt_pk_bf16_f32 v40, 0, v40
    v_cvt_pk_bf16_f32 v41, 0, v41
    v_cvt_pk_bf16_f32 v42, 0, v42
    v_cvt_pk_bf16_f32 v43, 0, v43
    v_cvt_pk_bf16_f32 v44, 0, v44
    v_cvt_pk_bf16_f32 v45, 0, v45
    v_cvt_pk_bf16_f32 v46, 0, v46
    v_cvt_pk_bf16_f32 v47, 0, v47
    s_lshl_b32 s46, s42, 14
    s_lshl_b32 s47, s44, 11
    s_add_u32 s46, s46, s47
    s_add_u32 s46, s46, 0x9000000
    v_add_u32 v4, s46, v2
    v_and_b32 v5, 31, v1
    v_lshlrev_b32 v5, 7, v5
    v_add_u32 v5, 0x107400, v5
    v_lshlrev_b32 v6, 2, v1
    s_lshl_b32 s46, s44, 9
    v_add_u32 v6, s46, v6
    s_lshl_b32 s46, s44, 12
    v_add_u32 v7, s46, v3
    s_lshl_b32 s46, s42, 3
    s_add_u32 s46, s46, s44
    s_lshl_b32 s46, s46, 11
    v_add_u32 v8, s46, v2
    v_add_u32 v9, 0x800000, v8
    s_mul_i32 s46, s44, 2064
    s_add_u32 s46, s46, 32768
    v_add_u32 v10, s46, v2
    v_and_b32 v11, 7, v1
    v_lshrrev_b32 v12, 3, v1
    v_mul_u32_u24 v13, 2064, v11
    v_lshl_add_u32 v13, v12, 4, v13
    s_lshl_b32 s46, s44, 8
    s_add_u32 s46, s46, 32768
    v_add_u32 v13, s46, v13
    v_lshlrev_b32 v11, 4, v11
    v_lshl_add_u32 v11, v12, 9, v11
    s_lshl_b32 s46, s44, 13
    s_lshl_b32 s47, s42, 7
    s_add_u32 s46, s46, s47
    s_add_u32 s46, s46, 0xc00000
    v_add_u32 v11, s46, v11
    v_add_u32 v12, 4096, v11
    s_lshl_b32 s52, s43, 9
    s_lshl_b32 s47, s42, 7
    s_add_u32 s52, s52, s47
    s_add_u32 s52, s52, 0x10ec00
    s_mov_b32 s60, s43
L_r_loop_35:
    s_lshl_b32 s61, s60, 18
    s_lshl_b32 s63, s60, 16
    buffer_load_dwordx4 a[0:3], v8, s[24:27], s63 offen
    buffer_load_dwordx4 a[4:7], v8, s[24:27], s63 offen offset:1024
    s_cmp_lg_u32 s44, 0
    s_cbranch_scc1 L_r_nsp_36
    s_mov_b32 s70, 0
L_spin_37:
    buffer_load_dword v14, v5, s[12:15], 0 offen sc1
    s_waitcnt vmcnt(0)
    v_cmp_ge_u32 vcc, s60, v14
    s_add_u32 s70, s70, 1
    s_cbranch_vccz L_spok_38
    s_sleep 3
    s_cmp_lt_u32 s70, 524288
    s_cbranch_scc1 L_spin_37
    s_branch L_c_done_1
L_spok_38:
L_r_nsp_36:
    s_barrier
    buffer_load_dwordx4 v[96:99], v4, s[12:15], s61 offen offset:0 sc1
    buffer_load_dwordx4 v[100:103], v4, s[12:15], s61 offen offset:1024 sc1
    s_add_u32 s61, s61, 65536
    buffer_load_dwordx4 v[104:107], v4, s[12:15], s61 offen offset:0 sc1
    buffer_load_dwordx4 v[108:111], v4, s[12:15], s61 offen offset:1024 sc1
    s_add_u32 s61, s61, 65536
    buffer_load_dwordx4 v[112:115], v4, s[12:15], s61 offen offset:0 sc1
    buffer_load_dwordx4 v[116:119], v4, s[12:15], s61 offen offset:1024 sc1
    s_add_u32 s61, s61, 65536
    buffer_load_dwordx4 v[120:123], v4, s[12:15], s61 offen offset:0 sc1
    buffer_load_dwordx4 v[124:127], v4, s[12:15], s61 offen offset:1024 sc1
    s_waitcnt vmcnt(8)
    v_accvgpr_read_b32 v64, a0
    v_accvgpr_read_b32 v65, a1
    v_accvgpr_read_b32 v66, a2
    v_accvgpr_read_b32 v67, a3
    v_accvgpr_read_b32 v68, a4
    v_accvgpr_read_b32 v69, a5
    v_accvgpr_read_b32 v70, a6
    v_accvgpr_read_b32 v71, a7
    v_lshlrev_b32 v80, 16, v64
    v_and_b32 v81, 0xffff0000, v64
    v_lshlrev_b32 v82, 16, v65
    v_and_b32 v83, 0xffff0000, v65
    v_lshlrev_b32 v84, 16, v66
    v_and_b32 v85, 0xffff0000, v66
    v_lshlrev_b32 v86, 16, v67
    v_and_b32 v87, 0xffff0000, v67
    v_lshlrev_b32 v88, 16, v68
    v_and_b32 v89, 0xffff0000, v68
    v_lshlrev_b32 v90, 16, v69
    v_and_b32 v91, 0xffff0000, v69
    v_lshlrev_b32 v92, 16, v70
    v_and_b32 v93, 0xffff0000, v70
    v_lshlrev_b32 v94, 16, v71
    v_and_b32 v95, 0xffff0000, v71
    s_waitcnt vmcnt(6)
    v_lshlrev_b32 v64, 16, v96
    v_and_b32 v65, 0xffff0000, v96
    v_lshlrev_b32 v66, 16, v97
    v_and_b32 v67, 0xffff0000, v97
    v_lshlrev_b32 v68, 16, v98
    v_and_b32 v69, 0xffff0000, v98
    v_lshlrev_b32 v70, 16, v99
    v_and_b32 v71, 0xffff0000, v99
    v_lshlrev_b32 v72, 16, v100
    v_and_b32 v73, 0xffff0000, v100
    v_lshlrev_b32 v74, 16, v101
    v_and_b32 v75, 0xffff0000, v101
    v_lshlrev_b32 v76, 16, v102
    v_and_b32 v77, 0xffff0000, v102
    v_lshlrev_b32 v78, 16, v103
    v_and_b32 v79, 0xffff0000, v103
    s_waitcnt vmcnt(4)
    v_lshlrev_b32 v14, 16, v104
    v_and_b32 v15, 0xffff0000, v104
    v_pk_add_f32 v[64:65], v[64:65], v[14:15]
    v_lshlrev_b32 v14, 16, v105
    v_and_b32 v15, 0xffff0000, v105
    v_pk_add_f32 v[66:67], v[66:67], v[14:15]
    v_lshlrev_b32 v14, 16, v106
    v_and_b32 v15, 0xffff0000, v106
    v_pk_add_f32 v[68:69], v[68:69], v[14:15]
    v_lshlrev_b32 v14, 16, v107
    v_and_b32 v15, 0xffff0000, v107
    v_pk_add_f32 v[70:71], v[70:71], v[14:15]
    v_lshlrev_b32 v14, 16, v108
    v_and_b32 v15, 0xffff0000, v108
    v_pk_add_f32 v[72:73], v[72:73], v[14:15]
    v_lshlrev_b32 v14, 16, v109
    v_and_b32 v15, 0xffff0000, v109
    v_pk_add_f32 v[74:75], v[74:75], v[14:15]
    v_lshlrev_b32 v14, 16, v110
    v_and_b32 v15, 0xffff0000, v110
    v_pk_add_f32 v[76:77], v[76:77], v[14:15]
    v_lshlrev_b32 v14, 16, v111
    v_and_b32 v15, 0xffff0000, v111
    v_pk_add_f32 v[78:79], v[78:79], v[14:15]
    s_waitcnt vmcnt(2)
    v_lshlrev_b32 v14, 16, v112
    v_and_b32 v15, 0xffff0000, v112
    v_pk_add_f32 v[64:65], v[64:65], v[14:15]
    v_lshlrev_b32 v14, 16, v113
    v_and_b32 v15, 0xffff0000, v113
    v_pk_add_f32 v[66:67], v[66:67], v[14:15]
    v_lshlrev_b32 v14, 16, v114
    v_and_b32 v15, 0xffff0000, v114
    v_pk_add_f32 v[68:69], v[68:69], v[14:15]
    v_lshlrev_b32 v14, 16, v115
    v_and_b32 v15, 0xffff0000, v115
    v_pk_add_f32 v[70:71], v[70:71], v[14:15]
    v_lshlrev_b32 v14, 16, v116
    v_and_b32 v15, 0xffff0000, v116
    v_pk_add_f32 v[72:73], v[72:73], v[14:15]
    v_lshlrev_b32 v14, 16, v117
    v_and_b32 v15, 0xffff0000, v117
    v_pk_add_f32 v[74:75], v[74:75], v[14:15]
    v_lshlrev_b32 v14, 16, v118
    v_and_b32 v15, 0xffff0000, v118
    v_pk_add_f32 v[76:77], v[76:77], v[14:15]
    v_lshlrev_b32 v14, 16, v119
    v_and_b32 v15, 0xffff0000, v119
    v_pk_add_f32 v[78:79], v[78:79], v[14:15]
    s_waitcnt vmcnt(0)
    v_lshlrev_b32 v14, 16, v120
    v_and_b32 v15, 0xffff0000, v120
    v_pk_add_f32 v[64:65], v[64:65], v[14:15]
    v_lshlrev_b32 v14, 16, v121
    v_and_b32 v15, 0xffff0000, v121
    v_pk_add_f32 v[66:67], v[66:67], v[14:15]
    v_lshlrev_b32 v14, 16, v122
    v_and_b32 v15, 0xffff0000, v122
    v_pk_add_f32 v[68:69], v[68:69], v[14:15]
    v_lshlrev_b32 v14, 16, v123
    v_and_b32 v15, 0xffff0000, v123
    v_pk_add_f32 v[70:71], v[70:71], v[14:15]
    v_lshlrev_b32 v14, 16, v124
    v_and_b32 v15, 0xffff0000, v124
    v_pk_add_f32 v[72:73], v[72:73], v[14:15]
    v_lshlrev_b32 v14, 16, v125
    v_and_b32 v15, 0xffff0000, v125
    v_pk_add_f32 v[74:75], v[74:75], v[14:15]
    v_lshlrev_b32 v14, 16, v126
    v_and_b32 v15, 0xffff0000, v126
    v_pk_add_f32 v[76:77], v[76:77], v[14:15]
    v_lshlrev_b32 v14, 16, v127
    v_and_b32 v15, 0xffff0000, v127
    v_pk_add_f32 v[78:79], v[78:79], v[14:15]
    ds_write_b32 v6, v64 offset:0
    ds_write_b32 v6, v65 offset:4096
    ds_write_b32 v6, v66 offset:8192
    ds_write_b32 v6, v67 offset:12288
    ds_write_b32 v6, v68 offset:16384
    ds_write_b32 v6, v69 offset:20480
    ds_write_b32 v6, v70 offset:24576
    ds_write_b32 v6, v71 offset:28672
    ds_write_b32 v6, v72 offset:256
    ds_write_b32 v6, v73 offset:4352
    ds_write_b32 v6, v74 offset:8448
    ds_write_b32 v6, v75 offset:12544
    ds_write_b32 v6, v76 offset:16640
    ds_write_b32 v6, v77 offset:20736
    ds_write_b32 v6, v78 offset:24832
    ds_write_b32 v6, v79 offset:28928
    s_waitcnt lgkmcnt(0)
    s_barrier
    ds_read_b128 v[64:67], v7
    ds_read_b128 v[68:71], v7 offset:16
    ds_read_b128 v[72:75], v7 offset:2048
    ds_read_b128 v[76:79], v7 offset:2064
    s_waitcnt vmcnt(0)
    s_waitcnt lgkmcnt(0)
    v_cvt_pk_bf16_f32 v64, 0, v64
    v_cvt_pk_bf16_f32 v65, 0, v65
    v_cvt_pk_bf16_f32 v66, 0, v66
    v_cvt_pk_bf16_f32 v67, 0, v67
    v_cvt_pk_bf16_f32 v68, 0, v68
    v_cvt_pk_bf16_f32 v69, 0, v69
    v_cvt_pk_bf16_f32 v70, 0, v70
    v_cvt_pk_bf16_f32 v71, 0, v71
    v_cvt_pk_bf16_f32 v72, 0, v72
    v_cvt_pk_bf16_f32 v73, 0, v73
    v_cvt_pk_bf16_f32 v74, 0, v74
    v_cvt_pk_bf16_f32 v75, 0, v75
    v_cvt_pk_bf16_f32 v76, 0, v76
    v_cvt_pk_bf16_f32 v77, 0, v77
    v_cvt_pk_bf16_f32 v78, 0, v78
    v_cvt_pk_bf16_f32 v79, 0, v79
    v_pk_mul_f32 v[64:65], v[64:65], v[16:17]
    v_pk_mul_f32 v[66:67], v[66:67], v[18:19]
    v_pk_mul_f32 v[68:69], v[68:69], v[20:21]
    v_pk_mul_f32 v[70:71], v[70:71], v[22:23]
    v_pk_mul_f32 v[72:73], v[72:73], v[24:25]
    v_pk_mul_f32 v[74:75], v[74:75], v[26:27]
    v_pk_mul_f32 v[76:77], v[76:77], v[28:29]
    v_pk_mul_f32 v[78:79], v[78:79], v[30:31]
    v_cvt_pk_bf16_f32 v64, 0, v64
    v_cvt_pk_bf16_f32 v65, 0, v65
    v_cvt_pk_bf16_f32 v66, 0, v66
    v_cvt_pk_bf16_f32 v67, 0, v67
    v_cvt_pk_bf16_f32 v68, 0, v68
    v_cvt_pk_bf16_f32 v69, 0, v69
    v_cvt_pk_bf16_f32 v70, 0, v70
    v_cvt_pk_bf16_f32 v71, 0, v71
    v_cvt_pk_bf16_f32 v72, 0, v72
    v_cvt_pk_bf16_f32 v73, 0, v73
    v_cvt_pk_bf16_f32 v74, 0, v74
    v_cvt_pk_bf16_f32 v75, 0, v75
    v_cvt_pk_bf16_f32 v76, 0, v76
    v_cvt_pk_bf16_f32 v77, 0, v77
    v_cvt_pk_bf16_f32 v78, 0, v78
    v_cvt_pk_bf16_f32 v79, 0, v79
    v_pk_add_f32 v[64:65], v[64:65], v[80:81]
    v_pk_add_f32 v[66:67], v[66:67], v[82:83]
    v_pk_add_f32 v[68:69], v[68:69], v[84:85]
    v_pk_add_f32 v[70:71], v[70:71], v[86:87]
    v_pk_add_f32 v[72:73], v[72:73], v[88:89]
    v_pk_add_f32 v[74:75], v[74:75], v[90:91]
    v_pk_add_f32 v[76:77], v[76:77], v[92:93]
    v_pk_add_f32 v[78:79], v[78:79], v[94:95]
    v_cvt_pk_bf16_f32 v96, v64, v65
    v_cvt_pk_bf16_f32 v97, v66, v67
    v_cvt_pk_bf16_f32 v98, v68, v69
    v_cvt_pk_bf16_f32 v99, v70, v71
    v_cvt_pk_bf16_f32 v100, v72, v73
    v_cvt_pk_bf16_f32 v101, v74, v75
    v_cvt_pk_bf16_f32 v102, v76, v77
    v_cvt_pk_bf16_f32 v103, v78, v79
    buffer_store_dwordx4 v[96:99], v9, s[12:15], s63 offen sc1
    buffer_store_dwordx4 v[100:103], v9, s[12:15], s63 offen offset:1024 sc1
    v_lshlrev_b32 v64, 16, v96
    v_and_b32 v65, 0xffff0000, v96
    v_lshlrev_b32 v66, 16, v97
    v_and_b32 v67, 0xffff0000, v97
    v_lshlrev_b32 v68, 16, v98
    v_and_b32 v69, 0xffff0000, v98
    v_lshlrev_b32 v70, 16, v99
    v_and_b32 v71, 0xffff0000, v99
    v_lshlrev_b32 v72, 16, v100
    v_and_b32 v73, 0xffff0000, v100
    v_lshlrev_b32 v74, 16, v101
    v_and_b32 v75, 0xffff0000, v101
    v_lshlrev_b32 v76, 16, v102
    v_and_b32 v77, 0xffff0000, v102
    v_lshlrev_b32 v78, 16, v103
    v_and_b32 v79, 0xffff0000, v103
    v_pk_add_f32 v[80:81], v[64:65], v[72:73]
    v_pk_add_f32 v[82:83], v[66:67], v[74:75]
    v_pk_add_f32 v[84:85], v[68:69], v[76:77]
    v_pk_add_f32 v[86:87], v[70:71], v[78:79]
    v_pk_add_f32 v[80:81], v[80:81], v[84:85]
    v_pk_add_f32 v[82:83], v[82:83], v[86:87]
    v_pk_add_f32 v[80:81], v[80:81], v[82:83]
    v_add_f32 v14, v80, v81
    s_nop 1
    v_add_f32_dpp v14, v14, v14 row_shr:1 row_mask:0xf bank_mask:0xf bound_ctrl:0
    s_nop 1
    v_add_f32_dpp v14, v14, v14 row_shr:2 row_mask:0xf bank_mask:0xf bound_ctrl:0
    s_nop 1
    v_add_f32_dpp v14, v14, v14 row_shr:4 row_mask:0xf bank_mask:0xf bound_ctrl:0
    s_nop 1
    v_add_f32_dpp v14, v14, v14 row_shr:8 row_mask:0xf bank_mask:0xf bound_ctrl:0
    s_nop 1
    v_add_f32_dpp v14, v14, v14 row_bcast:15 row_mask:0xa bank_mask:0xf
    s_nop 1
    v_add_f32_dpp v14, v14, v14 row_bcast:31 row_mask:0xc bank_mask:0xf
    s_nop 1
    v_readlane_b32 s46, v14, 63
    s_nop 1
    v_mov_b32 v15, s46
    v_mul_f32 v15, 0x3a800000, v15
    v_pk_add_f32 v[80:81], v[64:65], v[14:15] op_sel:[0,1] op_sel_hi:[1,1] neg_lo:[0,1] neg_hi:[0,1]
    v_pk_add_f32 v[82:83], v[66:67], v[14:15] op_sel:[0,1] op_sel_hi:[1,1] neg_lo:[0,1] neg_hi:[0,1]
    v_pk_add_f32 v[84:85], v[68:69], v[14:15] op_sel:[0,1] op_sel_hi:[1,1] neg_lo:[0,1] neg_hi:[0,1]
    v_pk_add_f32 v[86:87], v[70:71], v[14:15] op_sel:[0,1] op_sel_hi:[1,1] neg_lo:[0,1] neg_hi:[0,1]
    v_pk_add_f32 v[88:89], v[72:73], v[14:15] op_sel:[0,1] op_sel_hi:[1,1] neg_lo:[0,1] neg_hi:[0,1]
    v_pk_add_f32 v[90:91], v[74:75], v[14:15] op_sel:[0,1] op_sel_hi:[1,1] neg_lo:[0,1] neg_hi:[0,1]
    v_pk_add_f32 v[92:93], v[76:77], v[14:15] op_sel:[0,1] op_sel_hi:[1,1] neg_lo:[0,1] neg_hi:[0,1]
    v_pk_add_f32 v[94:95], v[78:79], v[14:15] op_sel:[0,1] op_sel_hi:[1,1] neg_lo:[0,1] neg_hi:[0,1]
    v_pk_mul_f32 v[104:105], v[80:81], v[80:81]
    v_pk_mul_f32 v[106:107], v[82:83], v[82:83]
    v_pk_fma_f32 v[104:105], v[84:85], v[84:85], v[104:105]
    v_pk_fma_f32 v[106:107], v[86:87], v[86:87], v[106:107]
    v_pk_fma_f32 v[104:105], v[88:89], v[88:89], v[104:105]
    v_pk_fma_f32 v[106:107], v[90:91], v[90:91], v[106:107]
    v_pk_fma_f32 v[104:105], v[92:93], v[92:93], v[104:105]
    v_pk_fma_f32 v[106:107], v[94:95], v[94:95], v[106:107]
    v_pk_add_f32 v[104:105], v[104:105], v[106:107]
    v_add_f32 v14, v104, v105
    v_cvt_pk_bf16_f32 v15, 0, v15
    s_nop 1
    v_add_f32_dpp v14, v14, v14 row_shr:1 row_mask:0xf bank_mask:0xf bound_ctrl:0
    s_nop 1
    v_add_f32_dpp v14, v14, v14 row_shr:2 row_mask:0xf bank_mask:0xf bound_ctrl:0
    s_nop 1
    v_add_f32_dpp v14, v14, v14 row_shr:4 row_mask:0xf bank_mask:0xf bound_ctrl:0
    s_nop 1
    v_add_f32_dpp v14, v14, v14 row_shr:8 row_mask:0xf bank_mask:0xf bound_ctrl:0
    s_nop 1
    v_add_f32_dpp v14, v14, v14 row_bcast:15 row_mask:0xa bank_mask:0xf
    s_nop 1
    v_add_f32_dpp v14, v14, v14 row_bcast:31 row_mask:0xc bank_mask:0xf
    s_nop 1
    v_readlane_b32 s47, v14, 63
    v_pk_add_f32 v[64:65], v[64:65], v[14:15] op_sel:[0,1] op_sel_hi:[1,1] neg_lo:[0,1] neg_hi:[0,1]
    v_pk_add_f32 v[66:67], v[66:67], v[14:15] op_sel:[0,1] op_sel_hi:[1,1] neg_lo:[0,1] neg_hi:[0,1]
    v_pk_add_f32 v[68:69], v[68:69], v[14:15] op_sel:[0,1] op_sel_hi:[1,1] neg_lo:[0,1] neg_hi:[0,1]
    v_pk_add_f32 v[70:71], v[70:71], v[14:15] op_sel:[0,1] op_sel_hi:[1,1] neg_lo:[0,1] neg_hi:[0,1]
    v_pk_add_f32 v[72:73], v[72:73], v[14:15] op_sel:[0,1] op_sel_hi:[1,1] neg_lo:[0,1] neg_hi:[0,1]
    v_pk_add_f32 v[74:75], v[74:75], v[14:15] op_sel:[0,1] op_sel_hi:[1,1] neg_lo:[0,1] neg_hi:[0,1]
    v_pk_add_f32 v[76:77], v[76:77], v[14:15] op_sel:[0,1] op_sel_hi:[1,1] neg_lo:[0,1] neg_hi:[0,1]
    v_pk_add_f32 v[78:79], v[78:79], v[14:15] op_sel:[0,1] op_sel_hi:[1,1] neg_lo:[0,1] neg_hi:[0,1]
    v_mov_b32 v14, s47
    v_mul_f32 v14, 0x3a800000, v14
    v_cvt_pk_bf16_f32 v14, 0, v14
    v_add_f32 v14, 0x3727c5ac, v14
    v_cvt_pk_bf16_f32 v14, 0, v14
    v_sqrt_f32 v14, v14
    s_nop 0
    v_cvt_pk_bf16_f32 v14, 0, v14
    v_rcp_f32 v14, v14
    v_cvt_pk_bf16_f32 v64, 0, v64
    v_cvt_pk_bf16_f32 v65, 0, v65
    v_cvt_pk_bf16_f32 v66, 0, v66
    v_cvt_pk_bf16_f32 v67, 0, v67
    v_cvt_pk_bf16_f32 v68, 0, v68
    v_cvt_pk_bf16_f32 v69, 0, v69
    v_cvt_pk_bf16_f32 v70, 0, v70
    v_cvt_pk_bf16_f32 v71, 0, v71
    v_cvt_pk_bf16_f32 v72, 0, v72
    v_cvt_pk_bf16_f32 v73, 0, v73
    v_cvt_pk_bf16_f32 v74, 0, v74
    v_cvt_pk_bf16_f32 v75, 0, v75
    v_cvt_pk_bf16_f32 v76, 0, v76
    v_cvt_pk_bf16_f32 v77, 0, v77
    v_cvt_pk_bf16_f32 v78, 0, v78
    v_cvt_pk_bf16_f32 v79, 0, v79
    v_pk_mul_f32 v[64:65], v[64:65], v[14:15] op_sel_hi:[1,0]
    v_pk_mul_f32 v[66:67], v[66:67], v[14:15] op_sel_hi:[1,0]
    v_pk_mul_f32 v[68:69], v[68:69], v[14:15] op_sel_hi:[1,0]
    v_pk_mul_f32 v[70:71], v[70:71], v[14:15] op_sel_hi:[1,0]
    v_pk_mul_f32 v[72:73], v[72:73], v[14:15] op_sel_hi:[1,0]
    v_pk_mul_f32 v[74:75], v[74:75], v[14:15] op_sel_hi:[1,0]
    v_pk_mul_f32 v[76:77], v[76:77], v[14:15] op_sel_hi:[1,0]
    v_pk_mul_f32 v[78:79], v[78:79], v[14:15] op_sel_hi:[1,0]
    v_cvt_pk_bf16_f32 v64, 0, v64
    v_cvt_pk_bf16_f32 v65, 0, v65
    v_cvt_pk_bf16_f32 v66, 0, v66
    v_cvt_pk_bf16_f32 v67, 0, v67
    v_cvt_pk_bf16_f32 v68, 0, v68
    v_cvt_pk_bf16_f32 v69, 0, v69
    v_cvt_pk_bf16_f32 v70, 0, v70
    v_cvt_pk_bf16_f32 v71, 0, v71
    v_cvt_pk_bf16_f32 v72, 0, v72
    v_cvt_pk_bf16_f32 v73, 0, v73
    v_cvt_pk_bf16_f32 v74, 0, v74
    v_cvt_pk_bf16_f32 v75, 0, v75
    v_cvt_pk_bf16_f32 v76, 0, v76
    v_cvt_pk_bf16_f32 v77, 0, v77
    v_cvt_pk_bf16_f32 v78, 0, v78
    v_cvt_pk_bf16_f32 v79, 0, v79
    v_pk_mul_f32 v[64:65], v[64:65], v[32:33]
    v_pk_mul_f32 v[66:67], v[66:67], v[34:35]
    v_pk_mul_f32 v[68:69], v[68:69], v[36:37]
    v_pk_mul_f32 v[70:71], v[70:71], v[38:39]
    v_pk_mul_f32 v[72:73], v[72:73], v[40:41]
    v_pk_mul_f32 v[74:75], v[74:75], v[42:43]
    v_pk_mul_f32 v[76:77], v[76:77], v[44:45]
    v_pk_mul_f32 v[78:79], v[78:79], v[46:47]
    v_cvt_pk_bf16_f32 v64, 0, v64
    v_cvt_pk_bf16_f32 v65, 0, v65
    v_cvt_pk_bf16_f32 v66, 0, v66
    v_cvt_pk_bf16_f32 v67, 0, v67
    v_cvt_pk_bf16_f32 v68, 0, v68
    v_cvt_pk_bf16_f32 v69, 0, v69
    v_cvt_pk_bf16_f32 v70, 0, v70
    v_cvt_pk_bf16_f32 v71, 0, v71
    v_cvt_pk_bf16_f32 v72, 0, v72
    v_cvt_pk_bf16_f32 v73, 0, v73
    v_cvt_pk_bf16_f32 v74, 0, v74
    v_cvt_pk_bf16_f32 v75, 0, v75
    v_cvt_pk_bf16_f32 v76, 0, v76
    v_cvt_pk_bf16_f32 v77, 0, v77
    v_cvt_pk_bf16_f32 v78, 0, v78
    v_cvt_pk_bf16_f32 v79, 0, v79
    v_pk_add_f32 v[64:65], v[64:65], v[48:49]
    v_pk_add_f32 v[66:67], v[66:67], v[50:51]
    v_pk_add_f32 v[68:69], v[68:69], v[52:53]
    v_pk_add_f32 v[70:71], v[70:71], v[54:55]
    v_pk_add_f32 v[72:73], v[72:73], v[56:57]
    v_pk_add_f32 v[74:75], v[74:75], v[58:59]
    v_pk_add_f32 v[76:77], v[76:77], v[60:61]
    v_pk_add_f32 v[78:79], v[78:79], v[62:63]
    v_cvt_pk_bf16_f32 v104, v64, v65
    v_cvt_pk_bf16_f32 v105, v66, v67
    v_cvt_pk_bf16_f32 v106, v68, v69
    v_cvt_pk_bf16_f32 v107, v70, v71
    v_cvt_pk_bf16_f32 v108, v72, v73
    v_cvt_pk_bf16_f32 v109, v74, v75
    v_cvt_pk_bf16_f32 v110, v76, v77
    v_cvt_pk_bf16_f32 v111, v78, v79
    ds_write_b128 v10, v[104:107]
    ds_write_b128 v10, v[108:111] offset:1024
    s_waitcnt lgkmcnt(0)
    s_barrier
    ds_read_b128 v[104:107], v13
    ds_read_b128 v[108:111], v13 offset:128
    s_waitcnt lgkmcnt(1)
    buffer_store_dwordx4 v[104:107], v11, s[12:15], s63 offen sc1
    s_waitcnt lgkmcnt(0)
    buffer_store_dwordx4 v[108:111], v12, s[12:15], s63 offen sc1
    s_waitcnt vmcnt(0)
    s_barrier
    s_cmp_lg_u32 s44, 0
    s_cbranch_scc1 L_sf_39
    v_mov_b32 v14, s60
    v_add_u32 v14, 1, v14
    v_mov_b32 v15, 0
    s_mov_b64 exec, 1
    buffer_store_dword v14, v15, s[12:15], s52 offen sc1
    s_mov_b64 exec, -1
L_sf_39:
    s_add_u32 s60, s60, 3
    s_cmp_lt_u32 s60, 64
    s_cbranch_scc1 L_r_loop_35
    s_branch L_c_done_1
L_w_att_13:
    s_lshl_b32 s42, s40, 2
    s_and_b32 s46, s44, 3
    s_add_u32 s42, s42, s46
    s_and_b32 s43, s48, 1
    s_lshl_b32 s43, s43, 1
    s_lshr_b32 s46, s44, 2
    s_add_u32 s43, s43, s46
    s_mul_i32 s46, s42, 24576
    s_add_u32 s46, s46, 0x2000000
    v_lshlrev_b32 v2, 4, v1
    v_add_u32 v3, s46, v2
    v_add_u32 v5, 4096, v3
    v_lshrrev_b32 v4, 4, v1
    v_and_b32 v9, 15, v1
    s_lshl_b32 s46, s42, 12
    s_add_u32 s46, s46, 0x1000000
    v_and_b32 v6, 7, v1
    v_lshlrev_b32 v6, 4, v6
    v_lshl_add_u32 v6, v4, 7, v6
    v_add_u32 v6, s46, v6
    v_and_b32 v7, 31, v1
    v_lshlrev_b32 v7, 4, v7
    v_lshrrev_b32 v10, 5, v1
    v_lshl_add_u32 v7, v10, 10, v7
    v_add_u32 v7, s46, v7
    s_mul_i32 s50, s44, 13056
    v_mul_u32_u24 v8, 272, v9
    v_lshl_add_u32 v8, v4, 4, v8
    v_add_u32 v8, s50, v8
    v_bfe_u32 v11, v1, 2, 3
    v_mul_u32_u24 v11, 272, v11
    v_lshl_add_u32 v11, v10, 6, v11
    v_and_b32 v12, 3, v1
    v_lshl_add_u32 v11, v12, 4, v11
    v_add_u32 v11, s50, v11
    v_mul_u32_u24 v14, 272, v4
    v_lshl_add_u32 v14, v9, 4, v14
    v_add_u32 v14, s50, v14
    v_mov_b32 v16, 0
    v_mov_b32 v17, 0
    v_mov_b32 v18, 0
    v_mov_b32 v19, 0
    ds_write_b128 v14, v[16:19] offset:10880
    ds_write_b128 v14, v[16:19] offset:11968
    v_lshlrev_b32 v12, 2, v4
    v_bfe_u32 v13, v1, 2, 2
    v_add_u32 v12, v12, v13
    v_mul_u32_u24 v12, 272, v12
    v_and_b32 v13, 3, v1
    v_lshl_add_u32 v12, v13, 3, v12
    v_add_u32 v12, s50, v12
    v_lshlrev_b32 v13, 10, v13
    s_lshl_b32 s46, s42, 12
    s_add_u32 s46, s46, 0x1000000
    v_add_u32 v13, s46, v13
    v_lshlrev_b32 v10, 9, v4
    v_lshl_add_u32 v10, v9, 4, v10
    s_lshl_b32 s46, s42, 13
    s_add_u32 s46, s46, 0x5000000
    v_add_u32 v10, s46, v10
    s_lshl_b32 s52, s42, 9
    s_lshl_b32 s47, s43, 7
    s_add_u32 s52, s52, s47
    s_add_u32 s52, s52, 0x102000
    v_min_u32 v42, 2, v1
    v_lshlrev_b32 v42, 9, v42
    s_lshl_b32 s46, s40, 11
    s_and_b32 s47, s42, 3
    s_lshl_b32 s47, s47, 7
    s_add_u32 s46, s46, s47
    s_add_u32 s46, s46, 0x10a400
    v_add_u32 v48, s46, v42
    s_mul_i32 s46, s42, 24576
    s_add_u32 s46, s46, 0x2000000
    v_lshlrev_b32 v49, 7, v1
    v_add_u32 v49, s46, v49
    v_cmp_le_u32 s[56:57], 32, v1
    v_lshlrev_b32 v14, 2, v4
    s_mov_b32 s54, 0x3e0293ee
    s_mov_b32 s60, s43
    v_add_u32 v15, 0, v14
    v_cmp_gt_u32 s[84:85], v15, v9
    v_add_u32 v15, 1, v14
    v_cmp_gt_u32 s[86:87], v15, v9
    v_add_u32 v15, 2, v14
    v_cmp_gt_u32 s[88:89], v15, v9
    v_add_u32 v15, 3, v14
    v_cmp_gt_u32 s[90:91], v15, v9
L_a_loop_40:
    s_mul_i32 s45, s60, 786432
    s_add_u32 s48, s45, 8192
    s_add_u32 s49, s45, 16384
    s_lshl_b32 s61, s60, 17
    s_lshl_b32 s63, s60, 18
    s_mov_b32 s70, 0
L_spin_41:
    buffer_load_dword v40, v48, s[12:15], 0 offen sc1
    s_waitcnt vmcnt(0)
    v_cmp_ge_u32 vcc, s60, v40
    s_add_u32 s70, s70, 1
    s_cbranch_vccz L_spok_42
    s_sleep 3
    s_cmp_lt_u32 s70, 524288
    s_cbranch_scc1 L_spin_41
    s_branch L_c_done_1
L_spok_42:
    buffer_load_dwordx4 a[0:3], v3, s[12:15], s45 offen offset:0 sc1
    buffer_load_dwordx4 a[4:7], v3, s[12:15], s45 offen offset:1024 sc1
    buffer_load_dwordx4 a[8:11], v3, s[12:15], s45 offen offset:2048 sc1
    buffer_load_dwordx4 a[12:15], v3, s[12:15], s45 offen offset:3072 sc1
    buffer_load_dwordx4 a[16:19], v5, s[12:15], s45 offen offset:0 sc1
    buffer_load_dwordx4 a[20:23], v5, s[12:15], s45 offen offset:1024 sc1
    buffer_load_dwordx4 a[24:27], v5, s[12:15], s45 offen offset:2048 sc1
    buffer_load_dwordx4 a[28:31], v5, s[12:15], s45 offen offset:3072 sc1
    buffer_load_dwordx4 a[32:35], v3, s[12:15], s48 offen offset:0 sc1
    buffer_load_dwordx4 a[36:39], v3, s[12:15], s48 offen offset:1024 sc1
    buffer_load_dwordx4 a[40:43], v3, s[12:15], s48 offen offset:2048 sc1
    buffer_load_dwordx4 a[44:47], v3, s[12:15], s48 offen offset:3072 sc1
    buffer_load_dwordx4 a[48:51], v5, s[12:15], s48 offen offset:0 sc1
    buffer_load_dwordx4 a[52:55], v5, s[12:15], s48 offen offset:1024 sc1
    buffer_load_dwordx4 a[56:59], v5, s[12:15], s48 offen offset:2048 sc1
    buffer_load_dwordx4 a[60:63], v5, s[12:15], s48 offen offset:3072 sc1
    buffer_load_dwordx4 v[16:19], v3, s[12:15], s49 offen offset:0 sc1
    buffer_load_dwordx4 v[20:23], v3, s[12:15], s49 offen offset:1024 sc1
    buffer_load_dwordx4 v[24:27], v3, s[12:15], s49 offen offset:2048 sc1
    buffer_load_dwordx4 v[28:31], v3, s[12:15], s49 offen offset:3072 sc1
    buffer_load_dwordx4 v[32:35], v5, s[12:15], s49 offen offset:0 sc1
    buffer_load_dwordx4 v[36:39], v5, s[12:15], s49 offen offset:1024 sc1
    buffer_load_dwordx4 v[40:43], v5, s[12:15], s49 offen offset:2048 sc1
    buffer_load_dwordx4 v[44:47], v5, s[12:15], s49 offen offset:3072 sc1
    s_waitcnt vmcnt(0)
    ds_write_b128 v8, v[16:19] offset:0
    ds_write_b128 v8, v[20:23] offset:64
    ds_write_b128 v8, v[24:27] offset:128
    ds_write_b128 v8, v[28:31] offset:192
    ds_write_b128 v8, v[32:35] offset:4352
    ds_write_b128 v8, v[36:39] offset:4416
    ds_write_b128 v8, v[40:43] offset:4480
    ds_write_b128 v8, v[44:47] offset:4544
    v_mfma_f32_16x16x32_bf16 v[56:59], a[32:35], a[0:3], 0
    v_mfma_f32_16x16x32_bf16 v[60:63], a[32:35], a[16:19], 0
    v_mfma_f32_16x16x32_bf16 v[68:71], a[48:51], a[16:19], 0
    v_mfma_f32_16x16x32_bf16 v[56:59], a[36:39], a[4:7], v[56:59]
    v_mfma_f32_16x16x32_bf16 v[60:63], a[36:39], a[20:23], v[60:63]
    v_mfma_f32_16x16x32_bf16 v[68:71], a[52:55], a[20:23], v[68:71]
    v_mfma_f32_16x16x32_bf16 v[56:59], a[40:43], a[8:11], v[56:59]
    v_mfma_f32_16x16x32_bf16 v[60:63], a[40:43], a[24:27], v[60:63]
    v_mfma_f32_16x16x32_bf16 v[68:71], a[56:59], a[24:27], v[68:71]
    v_mfma_f32_16x16x32_bf16 v[56:59], a[44:47], a[12:15], v[56:59]
    v_mfma_f32_16x16x32_bf16 v[60:63], a[44:47], a[28:31], v[60:63]
    v_mfma_f32_16x16x32_bf16 v[68:71], a[60:63], a[28:31], v[68:71]
    s_waitcnt lgkmcnt(0)
    ds_read_b64_tr_b16 a[80:81], v12 offset:0
    ds_read_b64_tr_b16 a[82:83], v12 offset:4352
    ds_read_b64_tr_b16 a[86:87], v12 offset:32
    ds_read_b64_tr_b16 a[88:89], v12 offset:4384
    ds_read_b64_tr_b16 a[92:93], v12 offset:64
    ds_read_b64_tr_b16 a[94:95], v12 offset:4416
    ds_read_b64_tr_b16 a[98:99], v12 offset:96
    ds_read_b64_tr_b16 a[100:101], v12 offset:4448
    s_waitcnt lgkmcnt(0)
    ds_read_b64_tr_b16 a[104:105], v12 offset:128
    ds_read_b64_tr_b16 a[106:107], v12 offset:4480
    ds_read_b64_tr_b16 a[110:111], v12 offset:160
    ds_read_b64_tr_b16 a[112:113], v12 offset:4512
    ds_read_b64_tr_b16 a[116:117], v12 offset:192
    ds_read_b64_tr_b16 a[118:119], v12 offset:4544
    ds_read_b64_tr_b16 a[122:123], v12 offset:224
    ds_read_b64_tr_b16 a[124:125], v12 offset:4576
    v_mov_b32 v15, 0xff800000
    v_cndmask_b32 v56, v56, v15, s[84:85]
    v_cndmask_b32 v68, v68, v15, s[84:85]
    v_cndmask_b32 v57, v57, v15, s[86:87]
    v_cndmask_b32 v69, v69, v15, s[86:87]
    v_cndmask_b32 v58, v58, v15, s[88:89]
    v_cndmask_b32 v70, v70, v15, s[88:89]
    v_cndmask_b32 v59, v59, v15, s[90:91]
    v_cndmask_b32 v71, v71, v15, s[90:91]
    s_mov_b32 s70, 0
L_a_cp_43:
    s_add_u32 s70, s70, 1
    s_cmp_ge_u32 s60, 63
    s_cbranch_scc1 L_a_fl_44
    buffer_load_dword v40, v13, s[12:15], s61 offen sc1
    s_waitcnt vmcnt(0)
    v_cmp_eq_u32 vcc, -1, v40
    s_add_u32 s70, s70, 1
    s_cbranch_vccz L_a_fl_44
L_a_cp_43_s:
    s_sleep 4
    s_cmp_lt_u32 s70, 524288
    s_cbranch_scc1 L_a_cp_43
    s_branch L_c_done_1
L_a_fl_44:
    buffer_load_dwordx4 v[24:27], v6, s[12:15], s61 offen offset:0 sc1
    buffer_load_dwordx4 v[28:31], v6, s[12:15], s61 offen offset:1024 sc1
    buffer_load_dwordx4 v[32:35], v6, s[12:15], s61 offen offset:2048 sc1
    buffer_load_dwordx4 v[36:39], v6, s[12:15], s61 offen offset:3072 sc1
    buffer_load_dwordx4 v[16:19], v7, s[12:15], s61 offen offset:512 sc1
    buffer_load_dwordx4 v[20:23], v7, s[12:15], s61 offen offset:2560 sc1
    s_waitcnt vmcnt(0)
    v_max_u32 v40, v16, v17
    v_max3_u32 v40, v40, v18, v19
    v_max3_u32 v40, v40, v20, v21
    v_max3_u32 v40, v40, v22, v23
    v_max3_u32 v40, v40, v24, v25
    v_max3_u32 v40, v40, v26, v27
    v_max3_u32 v40, v40, v28, v29
    v_max3_u32 v40, v40, v30, v31
    v_max3_u32 v40, v40, v32, v33
    v_max3_u32 v40, v40, v34, v35
    v_max3_u32 v40, v40, v36, v37
    v_max3_u32 v40, v40, v38, v39
    v_cmp_eq_u32 vcc, -1, v40
    s_nop 0
    s_cbranch_vccnz L_a_cp_43_s
    v_mfma_f32_16x16x32_bf16 v[72:75], v[24:27], a[0:3], 0
    v_mfma_f32_16x16x32_bf16 v[76:79], v[24:27], a[16:19], 0
    v_mfma_f32_16x16x32_bf16 v[72:75], v[28:31], a[4:7], v[72:75]
    v_mfma_f32_16x16x32_bf16 v[76:79], v[28:31], a[20:23], v[76:79]
    v_mfma_f32_16x16x32_bf16 v[72:75], v[32:35], a[8:11], v[72:75]
    v_mfma_f32_16x16x32_bf16 v[76:79], v[32:35], a[24:27], v[76:79]
    v_mfma_f32_16x16x32_bf16 v[72:75], v[36:39], a[12:15], v[72:75]
    v_mfma_f32_16x16x32_bf16 v[76:79], v[36:39], a[28:31], v[76:79]
    ds_write_b128 v11, v[16:19] offset:8704
    ds_write_b128 v11, v[20:23] offset:8832
    s_waitcnt lgkmcnt(0)
    ds_read_b64_tr_b16 a[84:85], v12 offset:8704
    ds_read_b64_tr_b16 a[90:91], v12 offset:8736
    ds_read_b64_tr_b16 a[96:97], v12 offset:8768
    ds_read_b64_tr_b16 a[102:103], v12 offset:8800
    ds_read_b64_tr_b16 a[108:109], v12 offset:8832
    ds_read_b64_tr_b16 a[114:115], v12 offset:8864
    ds_read_b64_tr_b16 a[120:121], v12 offset:8896
    ds_read_b64_tr_b16 a[126:127], v12 offset:8928
    v_cndmask_b32 v72, v72, v15, s[56:57]
    v_cndmask_b32 v73, v73, v15, s[56:57]
    v_cndmask_b32 v74, v74, v15, s[56:57]
    v_cndmask_b32 v75, v75, v15, s[56:57]
    v_cndmask_b32 v76, v76, v15, s[56:57]
    v_cndmask_b32 v77, v77, v15, s[56:57]
    v_cndmask_b32 v78, v78, v15, s[56:57]
    v_cndmask_b32 v79, v79, v15, s[56:57]
    v_max_f32 v40, v56, v57
    v_max3_f32 v40, v40, v58, v59
    v_max3_f32 v40, v40, v72, v73
    v_max3_f32 v40, v40, v74, v75
    v_mov_b32 v41, v40
    s_nop 1
    v_permlane16_swap_b32 v40, v41
    v_max_f32 v40, v40, v41
    v_mov_b32 v41, v40
    s_nop 1
    v_permlane32_swap_b32 v40, v41
    v_max_f32 v40, v40, v41
    v_mul_f32 v40, s54, v40
    v_fma_f32 v56, v56, s54, -v40
    v_fma_f32 v57, v57, s54, -v40
    v_fma_f32 v58, v58, s54, -v40
    v_fma_f32 v59, v59, s54, -v40
    v_fma_f32 v72, v72, s54, -v40
    v_fma_f32 v73, v73, s54, -v40
    v_fma_f32 v74, v74, s54, -v40
    v_fma_f32 v75, v75, s54, -v40
    v_exp_f32 v56, v56
    v_exp_f32 v57, v57
    v_exp_f32 v58, v58
    v_exp_f32 v59, v59
    v_exp_f32 v72, v72
    v_exp_f32 v73, v73
    v_exp_f32 v74, v74
    v_exp_f32 v75, v75
    v_add_f32 v40, v56, v57
    v_add_f32 v40, v40, v58
    v_add_f32 v40, v40, v59
    v_add_f32 v40, v40, v72
    v_add_f32 v40, v40, v73
    v_add_f32 v40, v40, v74
    v_add_f32 v40, v40, v75
    v_mov_b32 v41, v40
    s_nop 1
    v_permlane16_swap_b32 v40, v41
    v_add_f32 v40, v40, v41
    v_mov_b32 v41, v40
    s_nop 1
    v_permlane32_swap_b32 v40, v41
    v_add_f32 v40, v40, v41
    v_rcp_f32 v40, v40
    s_nop 0
    v_mul_f32 v56, v56, v40
    v_mul_f32 v57, v57, v40
    v_mul_f32 v58, v58, v40
    v_mul_f32 v59, v59, v40
    v_mul_f32 v72, v72, v40
    v_mul_f32 v73, v73, v40
    v_mul_f32 v74, v74, v40
    v_mul_f32 v75, v75, v40
    v_cvt_pk_bf16_f32 v24, v56, v57
    v_cvt_pk_bf16_f32 v25, v58, v59
    v_cvt_pk_bf16_f32 v28, v72, v73
    v_cvt_pk_bf16_f32 v29, v74, v75
    v_max_f32 v40, v60, v61
    v_max3_f32 v40, v40, v62, v63
    v_max3_f32 v40, v40, v68, v69
    v_max3_f32 v40, v40, v70, v71
    v_max3_f32 v40, v40, v76, v77
    v_max3_f32 v40, v40, v78, v79
    v_mov_b32 v41, v40
    s_nop 1
    v_permlane16_swap_b32 v40, v41
    v_max_f32 v40, v40, v41
    v_mov_b32 v41, v40
    s_nop 1
    v_permlane32_swap_b32 v40, v41
    v_max_f32 v40, v40, v41
    v_mul_f32 v40, s54, v40
    v_fma_f32 v60, v60, s54, -v40
    v_fma_f32 v61, v61, s54, -v40
    v_fma_f32 v62, v62, s54, -v40
    v_fma_f32 v63, v63, s54, -v40
    v_fma_f32 v68, v68, s54, -v40
    v_fma_f32 v69, v69, s54, -v40
    v_fma_f32 v70, v70, s54, -v40
    v_fma_f32 v71, v71, s54, -v40
    v_fma_f32 v76, v76, s54, -v40
    v_fma_f32 v77, v77, s54, -v40
    v_fma_f32 v78, v78, s54, -v40
    v_fma_f32 v79, v79, s54, -v40
    v_exp_f32 v60, v60
    v_exp_f32 v61, v61
    v_exp_f32 v62, v62
    v_exp_f32 v63, v63
    v_exp_f32 v68, v68
    v_exp_f32 v69, v69
    v_exp_f32 v70, v70
    v_exp_f32 v71, v71
    v_exp_f32 v76, v76
    v_exp_f32 v77, v77
    v_exp_f32 v78, v78
    v_exp_f32 v79, v79
    v_add_f32 v40, v60, v61
    v_add_f32 v40, v40, v62
    v_add_f32 v40, v40, v63
    v_add_f32 v40, v40, v68
    v_add_f32 v40, v40, v69
    v_add_f32 v40, v40, v70
    v_add_f32 v40, v40, v71
    v_add_f32 v40, v40, v76
    v_add_f32 v40, v40, v77
    v_add_f32 v40, v40, v78
    v_add_f32 v40, v40, v79
    v_mov_b32 v41, v40
    s_nop 1
    v_permlane16_swap_b32 v40, v41
    v_add_f32 v40, v40, v41
    v_mov_b32 v41, v40
    s_nop 1
    v_permlane32_swap_b32 v40, v41
    v_add_f32 v40, v40, v41
    v_rcp_f32 v40, v40
    s_nop 0
    v_mul_f32 v60, v60, v40
    v_mul_f32 v61, v61, v40
    v_mul_f32 v62, v62, v40
    v_mul_f32 v63, v63, v40
    v_mul_f32 v68, v68, v40
    v_mul_f32 v69, v69, v40
    v_mul_f32 v70, v70, v40
    v_mul_f32 v71, v71, v40
    v_mul_f32 v76, v76, v40
    v_mul_f32 v77, v77, v40
    v_mul_f32 v78, v78, v40
    v_mul_f32 v79, v79, v40
    v_cvt_pk_bf16_f32 v30, v60, v61
    v_cvt_pk_bf16_f32 v31, v62, v63
    v_cvt_pk_bf16_f32 v32, v68, v69
    v_cvt_pk_bf16_f32 v33, v70, v71
    v_cvt_pk_bf16_f32 v34, v76, v77
    v_cvt_pk_bf16_f32 v35, v78, v79
    s_waitcnt lgkmcnt(0)
    s_nop 0
    v_mfma_f32_16x16x16_bf16 v[64:67], a[80:81], v[24:25], 0
    v_mfma_f32_16x16x16_bf16 v[68:71], a[86:87], v[24:25], 0
    v_mfma_f32_16x16x16_bf16 v[72:75], a[92:93], v[24:25], 0
    v_mfma_f32_16x16x16_bf16 v[76:79], a[98:99], v[24:25], 0
    v_mfma_f32_16x16x16_bf16 v[80:83], a[104:105], v[24:25], 0
    v_mfma_f32_16x16x16_bf16 v[84:87], a[110:111], v[24:25], 0
    v_mfma_f32_16x16x16_bf16 v[88:91], a[116:117], v[24:25], 0
    v_mfma_f32_16x16x16_bf16 v[92:95], a[122:123], v[24:25], 0
    v_mfma_f32_16x16x16_bf16 v[64:67], a[84:85], v[28:29], v[64:67]
    v_mfma_f32_16x16x16_bf16 v[68:71], a[90:91], v[28:29], v[68:71]
    v_mfma_f32_16x16x16_bf16 v[72:75], a[96:97], v[28:29], v[72:75]
    v_mfma_f32_16x16x16_bf16 v[76:79], a[102:103], v[28:29], v[76:79]
    v_mfma_f32_16x16x16_bf16 v[80:83], a[108:109], v[28:29], v[80:83]
    v_mfma_f32_16x16x16_bf16 v[84:87], a[114:115], v[28:29], v[84:87]
    v_mfma_f32_16x16x16_bf16 v[88:91], a[120:121], v[28:29], v[88:91]
    v_mfma_f32_16x16x16_bf16 v[92:95], a[126:127], v[28:29], v[92:95]
    v_mfma_f32_16x16x16_bf16 v[96:99], a[80:81], v[30:31], 0
    v_mfma_f32_16x16x16_bf16 v[100:103], a[86:87], v[30:31], 0
    v_mfma_f32_16x16x16_bf16 v[104:107], a[92:93], v[30:31], 0
    v_mfma_f32_16x16x16_bf16 v[108:111], a[98:99], v[30:31], 0
    v_mfma_f32_16x16x16_bf16 v[112:115], a[104:105], v[30:31], 0
    v_mfma_f32_16x16x16_bf16 v[116:119], a[110:111], v[30:31], 0
    v_mfma_f32_16x16x16_bf16 v[120:123], a[116:117], v[30:31], 0
    v_mfma_f32_16x16x16_bf16 v[124:127], a[122:123], v[30:31], 0
    v_mfma_f32_16x16x16_bf16 v[96:99], a[82:83], v[32:33], v[96:99]
    v_mfma_f32_16x16x16_bf16 v[100:103], a[88:89], v[32:33], v[100:103]
    v_mfma_f32_16x16x16_bf16 v[104:107], a[94:95], v[32:33], v[104:107]
    v_mfma_f32_16x16x16_bf16 v[108:111], a[100:101], v[32:33], v[108:111]
    v_mfma_f32_16x16x16_bf16 v[112:115], a[106:107], v[32:33], v[112:115]
    v_mfma_f32_16x16x16_bf16 v[116:119], a[112:113], v[32:33], v[116:119]
    v_mfma_f32_16x16x16_bf16 v[120:123], a[118:119], v[32:33], v[120:123]
    v_mfma_f32_16x16x16_bf16 v[124:127], a[124:125], v[32:33], v[124:127]
    v_mfma_f32_16x16x16_bf16 v[96:99], a[84:85], v[34:35], v[96:99]
    v_mfma_f32_16x16x16_bf16 v[100:103], a[90:91], v[34:35], v[100:103]
    v_mfma_f32_16x16x16_bf16 v[104:107], a[96:97], v[34:35], v[104:107]
    v_mfma_f32_16x16x16_bf16 v[108:111], a[102:103], v[34:35], v[108:111]
    v_mfma_f32_16x16x16_bf16 v[112:115], a[108:109], v[34:35], v[112:115]
    v_mfma_f32_16x16x16_bf16 v[116:119], a[114:115], v[34:35], v[116:119]
    v_mfma_f32_16x16x16_bf16 v[120:123], a[120:121], v[34:35], v[120:123]
    v_mfma_f32_16x16x16_bf16 v[124:127], a[126:127], v[34:35], v[124:127]
    s_add_u32 s46, s63, 4096
    v_cvt_pk_bf16_f32 v64, v64, v65
    v_cvt_pk_bf16_f32 v65, v66, v67
    v_cvt_pk_bf16_f32 v66, v68, v69
    v_cvt_pk_bf16_f32 v67, v70, v71
    buffer_store_dwordx4 v[64:67], v10, s[12:15], s63 offen offset:0 sc1
    v_cvt_pk_bf16_f32 v72, v72, v73
    v_cvt_pk_bf16_f32 v73, v74, v75
    v_cvt_pk_bf16_f32 v74, v76, v77
    v_cvt_pk_bf16_f32 v75, v78, v79
    buffer_store_dwordx4 v[72:75], v10, s[12:15], s63 offen offset:2048 sc1
    v_cvt_pk_bf16_f32 v80, v80, v81
    v_cvt_pk_bf16_f32 v81, v82, v83
    v_cvt_pk_bf16_f32 v82, v84, v85
    v_cvt_pk_bf16_f32 v83, v86, v87
    buffer_store_dwordx4 v[80:83], v10, s[12:15], s46 offen offset:0 sc1
    v_cvt_pk_bf16_f32 v88, v88, v89
    v_cvt_pk_bf16_f32 v89, v90, v91
    v_cvt_pk_bf16_f32 v90, v92, v93
    v_cvt_pk_bf16_f32 v91, v94, v95
    buffer_store_dwordx4 v[88:91], v10, s[12:15], s46 offen offset:2048 sc1
    v_cvt_pk_bf16_f32 v96, v96, v97
    v_cvt_pk_bf16_f32 v97, v98, v99
    v_cvt_pk_bf16_f32 v98, v100, v101
    v_cvt_pk_bf16_f32 v99, v102, v103
    buffer_store_dwordx4 v[96:99], v10, s[12:15], s63 offen offset:256 sc1
    v_cvt_pk_bf16_f32 v104, v104, v105
    v_cvt_pk_bf16_f32 v105, v106, v107
    v_cvt_pk_bf16_f32 v106, v108, v109
    v_cvt_pk_bf16_f32 v107, v110, v111
    buffer_store_dwordx4 v[104:107], v10, s[12:15], s63 offen offset:2304 sc1
    v_cvt_pk_bf16_f32 v112, v112, v113
    v_cvt_pk_bf16_f32 v113, v114, v115
    v_cvt_pk_bf16_f32 v114, v116, v117
    v_cvt_pk_bf16_f32 v115, v118, v119
    buffer_store_dwordx4 v[112:115], v10, s[12:15], s46 offen offset:256 sc1
    v_cvt_pk_bf16_f32 v120, v120, v121
    v_cvt_pk_bf16_f32 v121, v122, v123
    v_cvt_pk_bf16_f32 v122, v124, v125
    v_cvt_pk_bf16_f32 v123, v126, v127
    buffer_store_dwordx4 v[120:123], v10, s[12:15], s46 offen offset:2304 sc1
    s_waitcnt vmcnt(0)
    v_mov_b32 v16, s60
    v_add_u32 v16, 1, v16
    v_mov_b32 v17, 0
    s_mov_b64 exec, 1
    buffer_store_dword v16, v17, s[12:15], s52 offen sc1
    s_mov_b64 exec, -1
L_sf_46:
    s_add_u32 s60, s60, 4
    s_cmp_lt_u32 s60, 64
    s_cbranch_scc1 L_a_loop_40
    s_branch L_c_done_1
L_w_g_8:
    s_lshr_b32 s53, s48, 2
    s_cmp_lt_u32 s53, 2
    s_cselect_b32 s46, 1, 0
    s_xor_b32 s53, s53, s46
    s_mov_b32 s74, 0
    s_mov_b32 s76, 0
    s_cmp_eq_u32 s53, 1
    s_cselect_b32 s75, 41, 58
    s_cmp_eq_u32 s53, 2
    s_cselect_b32 s75, 54, s75
L_w_g_8_e:
    s_lshl_b32 s46, s53, 3
    s_add_u32 s46, s46, 16
    s_load_dwordx2 s[4:5], s[0:1], s46
    s_lshl_b32 s49, s40, 2
    s_and_b32 s46, s48, 3
    s_add_u32 s49, s49, s46
    s_load_dwordx2 s[6:7], s[0:1], 72
    s_and_b32 s50, s44, 3
    s_lshr_b32 s51, s44, 2
    s_waitcnt lgkmcnt(0)
    s_mov_b32 s24, s4
    s_and_b32 s25, s5, 0xffff
    s_mov_b32 s26, 0x800000
    s_mov_b32 s27, 0x00020000
    s_cmp_lg_u32 s76, 0
    s_cbranch_scc1 L_g_n3_47
    s_cmp_ge_u32 s44, 3
    s_cbranch_scc1 L_g_n3_47
    s_mul_i32 s46, s48, 3
    s_add_u32 s46, s46, s44
    s_cmp_ge_u32 s46, 32
    s_cbranch_scc1 L_g_n3_47
    s_lshr_b32 s47, s46, 4
    s_add_u32 s47, s47, 1
    s_cmp_eq_u32 s47, 3
    s_cselect_b32 s47, 0, s47
    s_lshl_b32 s47, s47, 3
    s_add_u32 s47, s47, 16
    s_load_dwordx2 s[8:9], s[0:1], s47
    s_and_b32 s46, s46, 15
    s_lshl_b32 s46, s46, 19
    s_lshl_b32 s47, s40, 10
    s_add_u32 s46, s46, s47
    s_add_u32 s46, s46, 384
    v_lshlrev_b32 v10, 13, v1
    s_waitcnt lgkmcnt(0)
    s_mov_b32 s28, s8
    s_and_b32 s29, s9, 0xffff
    s_mov_b32 s30, 0x800000
    s_mov_b32 s31, 0x00020000
    buffer_load_dword v16, v10, s[28:31], s46 offen
L_g_n3_47:
    s_cmp_lg_u32 s53, 0
    s_cbranch_scc1 L_g_nq_48
    s_load_dwordx4 s[8:11], s[0:1], 24
    v_bfe_u32 v10, v0, 1, 6
    v_lshlrev_b32 v10, 13, v10
    v_and_b32 v11, 1, v0
    v_lshl_add_u32 v10, v11, 7, v10
    v_bfe_u32 v11, v0, 7, 1
    v_lshl_add_u32 v10, v11, 22, v10
    s_lshl_b32 s46, s49, 8
    s_waitcnt lgkmcnt(0)
    s_mov_b32 s28, s10
    s_and_b32 s29, s11, 0xffff
    s_mov_b32 s30, 0x800000
    s_mov_b32 s31, 0x00020000
    s_mov_b32 s32, s8
    s_and_b32 s33, s9, 0xffff
    s_mov_b32 s34, 0x800000
    s_mov_b32 s35, 0x00020000
    s_lshl_b32 s47, s51, 19
    s_add_u32 s46, s46, s47
    s_add_u32 s47, s46, 0x200000
    buffer_load_dword v11, v10, s[28:31], s47 offen
    s_add_u32 s47, s46, 0x300000
    buffer_load_dword v12, v10, s[28:31], s47 offen
L_g_nq_48:
    v_lshrrev_b32 v3, 4, v1
    v_and_b32 v4, 15, v1
    v_lshlrev_b32 v5, 2, v3
    v_xor_b32 v4, v4, v5
    v_mul_u32_u24 v3, 8192, v3
    v_lshl_add_u32 v3, v4, 4, v3
    s_mul_i32 s46, s51, 512
    s_mul_i32 s47, s50, 16
    s_add_u32 s46, s46, s47
    s_mul_i32 s46, s46, 8192
    s_lshl_b32 s47, s49, 8
    s_add_u32 s46, s46, s47
    s_lshl_b32 s45, s51, 16
    s_mul_i32 s47, s50, 4096
    s_add_u32 s45, s45, s47
    v_bfe_u32 v4, v1, 2, 2
    v_bfe_u32 v5, v1, 4, 1
    v_lshlrev_b32 v5, 1, v5
    v_bfe_u32 v6, v1, 0, 1
    v_add_u32 v5, v5, v6
    s_lshl_b32 s47, s50, 2
    v_add_u32 v5, s47, v5
    v_lshlrev_b32 v6, 2, v4
    v_xor_b32 v5, v5, v6
    v_lshlrev_b32 v5, 4, v5
    v_lshl_add_u32 v5, v4, 8, v5
    v_bfe_u32 v6, v1, 1, 1
    v_lshl_add_u32 v5, v6, 3, v5
    v_lshrrev_b32 v6, 5, v1
    v_mul_u32_u24 v6, 2048, v6
    v_add_u32 v5, v5, v6
    s_lshl_b32 s47, s51, 16
    v_add_u32 v5, s47, v5
    v_bfe_u32 v4, v1, 2, 2
    v_xor_b32 v5, s50, v4
    v_lshlrev_b32 v5, 6, v5
    v_lshl_add_u32 v5, v4, 8, v5
    v_and_b32 v6, 3, v1
    v_lshl_add_u32 v5, v6, 4, v5
    v_lshrrev_b32 v6, 4, v1
    v_lshl_add_u32 v5, v6, 11, v5
    v_lshrrev_b32 v6, 5, v1
    s_lshl_b32 s47, s51, 16
    v_add_u32 v5, s47, v5
    s_add_u32 m0, s45, 0
    s_add_u32 s47, s46, 0x0
    buffer_load_dwordx4 v3, s[24:27], s47 offen  lds
    s_add_u32 m0, s45, 1024
    s_add_u32 s47, s46, 0x8000
    buffer_load_dwordx4 v3, s[24:27], s47 offen  lds
    s_add_u32 m0, s45, 2048
    s_add_u32 s47, s46, 0x10000
    buffer_load_dwordx4 v3, s[24:27], s47 offen  lds
    s_add_u32 m0, s45, 3072
    s_add_u32 s47, s46, 0x18000
    buffer_load_dwordx4 v3, s[24:27], s47 offen  lds
    s_add_u32 m0, s45, 16384
    s_add_u32 s47, s46, 0x80000
    buffer_load_dwordx4 v3, s[24:27], s47 offen  lds
    s_add_u32 m0, s45, 17408
    s_add_u32 s47, s46, 0x88000
    buffer_load_dwordx4 v3, s[24:27], s47 offen  lds
    s_add_u32 m0, s45, 18432
    s_add_u32 s47, s46, 0x90000
    buffer_load_dwordx4 v3, s[24:27], s47 offen  lds
    s_add_u32 m0, s45, 19456
    s_add_u32 s47, s46, 0x98000
    buffer_load_dwordx4 v3, s[24:27], s47 offen  lds
    s_add_u32 m0, s45, 32768
    s_add_u32 s47, s46, 0x100000
    buffer_load_dwordx4 v3, s[24:27], s47 offen  lds
    s_add_u32 m0, s45, 33792
    s_add_u32 s47, s46, 0x108000
    buffer_load_dwordx4 v3, s[24:27], s47 offen  lds
    s_add_u32 m0, s45, 34816
    s_add_u32 s47, s46, 0x110000
    buffer_load_dwordx4 v3, s[24:27], s47 offen  lds
    s_add_u32 m0, s45, 35840
    s_add_u32 s47, s46, 0x118000
    buffer_load_dwordx4 v3, s[24:27], s47 offen  lds
    s_add_u32 m0, s45, 49152
    s_add_u32 s47, s46, 0x180000
    buffer_load_dwordx4 v3, s[24:27], s47 offen  lds
    s_add_u32 m0, s45, 50176
    s_add_u32 s47, s46, 0x188000
    buffer_load_dwordx4 v3, s[24:27], s47 offen  lds
    s_add_u32 m0, s45, 51200
    s_add_u32 s47, s46, 0x190000
    buffer_load_dwordx4 v3, s[24:27], s47 offen  lds
    s_add_u32 m0, s45, 52224
    s_add_u32 s47, s46, 0x198000
    buffer_load_dwordx4 v3, s[24:27], s47 offen  lds
    s_waitcnt vmcnt(12) lgkmcnt(0)
    s_barrier
    ds_read_b64_tr_b16 a[0:1], v5 offset:0
    ds_read_b64_tr_b16 a[2:3], v5 offset:1024
    ds_read_b64_tr_b16 a[4:5], v5 offset:8
    ds_read_b64_tr_b16 a[6:7], v5 offset:1032
    ds_read_b64_tr_b16 a[8:9], v5 offset:8192
    ds_read_b64_tr_b16 a[10:11], v5 offset:9216
    ds_read_b64_tr_b16 a[12:13], v5 offset:8200
    ds_read_b64_tr_b16 a[14:15], v5 offset:9224
    s_waitcnt vmcnt(8) lgkmcnt(0)
    s_barrier
    s_add_u32 m0, s45, 0
    s_add_u32 s47, s46, 0x200000
    buffer_load_dwordx4 v3, s[24:27], s47 offen  lds
    s_add_u32 m0, s45, 1024
    s_add_u32 s47, s46, 0x208000
    buffer_load_dwordx4 v3, s[24:27], s47 offen  lds
    s_add_u32 m0, s45, 2048
    s_add_u32 s47, s46, 0x210000
    buffer_load_dwordx4 v3, s[24:27], s47 offen  lds
    s_add_u32 m0, s45, 3072
    s_add_u32 s47, s46, 0x218000
    buffer_load_dwordx4 v3, s[24:27], s47 offen  lds
    ds_read_b64_tr_b16 a[16:17], v5 offset:16384
    ds_read_b64_tr_b16 a[18:19], v5 offset:17408
    ds_read_b64_tr_b16 a[20:21], v5 offset:16392
    ds_read_b64_tr_b16 a[22:23], v5 offset:17416
    ds_read_b64_tr_b16 a[24:25], v5 offset:24576
    ds_read_b64_tr_b16 a[26:27], v5 offset:25600
    ds_read_b64_tr_b16 a[28:29], v5 offset:24584
    ds_read_b64_tr_b16 a[30:31], v5 offset:25608
    s_waitcnt vmcnt(8) lgkmcnt(0)
    s_barrier
    s_add_u32 m0, s45, 16384
    s_add_u32 s47, s46, 0x280000
    buffer_load_dwordx4 v3, s[24:27], s47 offen  lds
    s_add_u32 m0, s45, 17408
    s_add_u32 s47, s46, 0x288000
    buffer_load_dwordx4 v3, s[24:27], s47 offen  lds
    s_add_u32 m0, s45, 18432
    s_add_u32 s47, s46, 0x290000
    buffer_load_dwordx4 v3, s[24:27], s47 offen  lds
    s_add_u32 m0, s45, 19456
    s_add_u32 s47, s46, 0x298000
    buffer_load_dwordx4 v3, s[24:27], s47 offen  lds
    ds_read_b64_tr_b16 a[32:33], v5 offset:32768
    ds_read_b64_tr_b16 a[34:35], v5 offset:33792
    ds_read_b64_tr_b16 a[36:37], v5 offset:32776
    ds_read_b64_tr_b16 a[38:39], v5 offset:33800
    ds_read_b64_tr_b16 a[40:41], v5 offset:40960
    ds_read_b64_tr_b16 a[42:43], v5 offset:41984
    ds_read_b64_tr_b16 a[44:45], v5 offset:40968
    ds_read_b64_tr_b16 a[46:47], v5 offset:41992
    s_waitcnt vmcnt(8) lgkmcnt(0)
    s_barrier
    s_add_u32 m0, s45, 32768
    s_add_u32 s47, s46, 0x300000
    buffer_load_dwordx4 v3, s[24:27], s47 offen  lds
    s_add_u32 m0, s45, 33792
    s_add_u32 s47, s46, 0x308000
    buffer_load_dwordx4 v3, s[24:27], s47 offen  lds
    s_add_u32 m0, s45, 34816
    s_add_u32 s47, s46, 0x310000
    buffer_load_dwordx4 v3, s[24:27], s47 offen  lds
    s_add_u32 m0, s45, 35840
    s_add_u32 s47, s46, 0x318000
    buffer_load_dwordx4 v3, s[24:27], s47 offen  lds
    ds_read_b64_tr_b16 a[48:49], v5 offset:49152
    ds_read_b64_tr_b16 a[50:51], v5 offset:50176
    ds_read_b64_tr_b16 a[52:53], v5 offset:49160
    ds_read_b64_tr_b16 a[54:55], v5 offset:50184
    ds_read_b64_tr_b16 a[56:57], v5 offset:57344
    ds_read_b64_tr_b16 a[58:59], v5 offset:58368
    ds_read_b64_tr_b16 a[60:61], v5 offset:57352
    ds_read_b64_tr_b16 a[62:63], v5 offset:58376
    s_waitcnt vmcnt(8) lgkmcnt(0)
    s_barrier
    s_add_u32 m0, s45, 49152
    s_add_u32 s47, s46, 0x380000
    buffer_load_dwordx4 v3, s[24:27], s47 offen  lds
    s_add_u32 m0, s45, 50176
    s_add_u32 s47, s46, 0x388000
    buffer_load_dwordx4 v3, s[24:27], s47 offen  lds
    s_add_u32 m0, s45, 51200
    s_add_u32 s47, s46, 0x390000
    buffer_load_dwordx4 v3, s[24:27], s47 offen  lds
    s_add_u32 m0, s45, 52224
    s_add_u32 s47, s46, 0x398000
    buffer_load_dwordx4 v3, s[24:27], s47 offen  lds
    ds_read_b64_tr_b16 a[64:65], v5 offset:0
    ds_read_b64_tr_b16 a[66:67], v5 offset:1024
    ds_read_b64_tr_b16 a[68:69], v5 offset:8
    ds_read_b64_tr_b16 a[70:71], v5 offset:1032
    ds_read_b64_tr_b16 a[72:73], v5 offset:8192
    ds_read_b64_tr_b16 a[74:75], v5 offset:9216
    ds_read_b64_tr_b16 a[76:77], v5 offset:8200
    ds_read_b64_tr_b16 a[78:79], v5 offset:9224
    s_waitcnt vmcnt(8) lgkmcnt(0)
    s_barrier
    ds_read_b64_tr_b16 a[80:81], v5 offset:16384
    ds_read_b64_tr_b16 a[82:83], v5 offset:17408
    ds_read_b64_tr_b16 a[84:85], v5 offset:16392
    ds_read_b64_tr_b16 a[86:87], v5 offset:17416
    ds_read_b64_tr_b16 a[88:89], v5 offset:24576
    ds_read_b64_tr_b16 a[90:91], v5 offset:25600
    ds_read_b64_tr_b16 a[92:93], v5 offset:24584
    ds_read_b64_tr_b16 a[94:95], v5 offset:25608
    s_waitcnt vmcnt(4) lgkmcnt(0)
    s_barrier
    ds_read_b64_tr_b16 a[96:97], v5 offset:32768
    ds_read_b64_tr_b16 a[98:99], v5 offset:33792
    ds_read_b64_tr_b16 a[100:101], v5 offset:32776
    ds_read_b64_tr_b16 a[102:103], v5 offset:33800
    ds_read_b64_tr_b16 a[104:105], v5 offset:40960
    ds_read_b64_tr_b16 a[106:107], v5 offset:41984
    ds_read_b64_tr_b16 a[108:109], v5 offset:40968
    ds_read_b64_tr_b16 a[110:111], v5 offset:41992
    s_waitcnt vmcnt(0) lgkmcnt(0)
    s_barrier
    ds_read_b64_tr_b16 a[112:113], v5 offset:49152
    ds_read_b64_tr_b16 a[114:115], v5 offset:50176
    ds_read_b64_tr_b16 a[116:117], v5 offset:49160
    ds_read_b64_tr_b16 a[118:119], v5 offset:50184
    ds_read_b64_tr_b16 a[120:121], v5 offset:57344
    ds_read_b64_tr_b16 a[122:123], v5 offset:58368
    ds_read_b64_tr_b16 a[124:125], v5 offset:57352
    ds_read_b64_tr_b16 a[126:127], v5 offset:58376
    s_waitcnt lgkmcnt(0)
    s_barrier
    v_lshlrev_b32 v2, 4, v1
    s_mul_i32 s64, s44, 8192
    s_add_u32 s46, s64, 0x400000
    v_add_u32 v3, s46, v2
    s_mul_i32 s46, s51, 32768
    v_add_u32 v4, s46, v2
    v_and_b32 v6, 15, v1
    v_lshlrev_b32 v6, 4, v6
    v_lshrrev_b32 v7, 4, v1
    v_lshl_add_u32 v6, v7, 9, v6
    v_add_u32 v4, s46, v6
    s_lshl_b32 s46, s50, 12
    s_add_u32 s46, s46, 131072
    v_add_u32 v5, s46, v2
    v_and_b32 v7, 3, v1
    v_lshlrev_b32 v7, 7, v7
    v_add_u32 v7, 0x109400, v7
    s_mul_i32 s46, s49, 24576
    s_lshl_b32 s47, s53, 13
    s_add_u32 s46, s46, s47
    s_lshl_b32 s47, s50, 10
    s_add_u32 s46, s46, s47
    s_add_u32 s46, s46, 0x2000000
    v_and_b32 v8, 15, v1
    v_lshlrev_b32 v8, 4, v8
    v_bfe_u32 v9, v1, 4, 1
    v_lshl_add_u32 v8, v9, 12, v8
    v_lshrrev_b32 v9, 5, v1
    v_lshl_add_u32 v8, v9, 8, v8
    v_add_u32 v8, s46, v2
    v_add_u32 v9, 4096, v8
    s_lshl_b32 s52, s40, 2
    s_add_u32 s52, s52, s53
    s_lshl_b32 s52, s52, 2
    s_and_b32 s47, s48, 3
    s_add_u32 s52, s52, s47
    s_lshl_b32 s52, s52, 7
    s_add_u32 s52, s52, 0x10a400
    s_add_u32 s52, s52, s76
    v_mov_b32 v120, -1
    v_mov_b32 v121, -1
    v_mov_b32 v122, -1
    v_mov_b32 v123, -1
    s_lshl_b32 s46, s49, 12
    s_lshl_b32 s47, s50, 10
    s_add_u32 s46, s46, s47
    s_add_u32 s46, s46, 0x1000000
    v_add_u32 v64, s46, v2
    s_and_b32 s46, s48, 3
    s_lshl_b32 s46, s46, 16
    s_lshl_b32 s47, s50, 14
    s_add_u32 s46, s46, s47
    s_lshl_b32 s47, s40, 8
    s_add_u32 s46, s46, s47
    s_add_u32 s46, s46, 0x7800000
    v_and_b32 v65, 15, v1
    v_lshlrev_b32 v65, 4, v65
    v_lshrrev_b32 v66, 4, v1
    v_lshl_add_u32 v65, v66, 11, v65
    v_add_u32 v65, s46, v65
    v_add_u32 v68, 8192, v65
    s_lshl_b32 s58, s74, 17
    s_lshl_b32 s46, s53, 3
    s_sub_u32 s46, 80, s46
    s_load_dwordx2 s[8:9], s[0:1], s46
    v_lshlrev_b32 v66, 7, v1
    s_mul_i32 s57, s49, 229376
    s_waitcnt lgkmcnt(0)
    s_mov_b32 s32, s8
    s_and_b32 s33, s9, 0xffff
    s_mov_b32 s34, 0x700000
    s_mov_b32 s35, 0x00020000
    s_mov_b32 s60, 0
    s_mul_i32 s61, s74, 65536
    s_mov_b32 s62, 0
    s_mul_i32 s63, s74, 786432
    s_mul_i32 s85, s78, 65536
    s_mul_i32 s86, s78, 786432
    s_sub_u32 s46, s78, 1
    s_sub_u32 s75, s75, s74
    s_add_u32 s75, s75, s46
    s_lshr_b32 s75, s75, s46
    s_mov_b32 s67, 0
    s_mov_b32 s68, 3
    s_mov_b32 s71, 0
    v_mov_b32 v15, 147456
    v_mov_b32 v14, 0
    ds_write_b32 v15, v14 offset:4
    ds_write_b32 v15, v14 offset:12
    ds_write_b32 v15, v14 offset:16
    v_mov_b32 v114, 1
    v_mov_b32 v115, 0
    s_mov_b32 s81, 0
    s_mul_i32 s87, s78, 2
    s_sub_u32 s87, s74, s87
    s_add_u32 s87, s87, 1
    s_lshl_b32 s46, s44, 5
    v_add_u32 v119, s46, v15
    v_lshrrev_b32 v113, 4, v1
    v_mul_u32_u24 v113, s78, v113
    v_add_u32 v113, s74, v113
    s_mov_b32 s72, 0
    s_cmp_lg_u32 s44, 0
    s_cbranch_scc1 L_zwok_58
    v_and_b32 v10, 7, v1
    v_lshlrev_b32 v10, 5, v10
    s_mov_b32 s70, 0
L_zw_57:
    buffer_load_dword v11, v10, s[16:19], 0 offen sc1
    s_waitcnt vmcnt(0)
    v_add_u32_dpp v11, v11, v11 row_ror:1 row_mask:0xf bank_mask:0xf
    s_nop 1
    v_add_u32_dpp v11, v11, v11 row_ror:2 row_mask:0xf bank_mask:0xf
    s_nop 1
    v_add_u32_dpp v11, v11, v11 row_ror:4 row_mask:0xf bank_mask:0xf
    v_cmp_ne_u32 vcc, 0x100, v11
    s_add_u32 s70, s70, 1
    s_cbranch_vccz L_zwok_58
    s_sleep 4
    s_cmp_lt_u32 s70, 524288
    s_cbranch_scc1 L_zw_57
    s_branch L_c_done_1
L_zwok_58:
L_g_restart_49:
    s_cmp_lg_u32 s44, 0
    s_cbranch_scc1 L_g_nsp_50
    s_mov_b32 s70, 0
L_g_sp_56:
    s_add_u32 s54, s60, 0
    s_mul_i32 s55, s54, s78
    v_add_u32 v12, s55, v113
    v_and_b32 v13, 7, v12
    v_lshl_add_u32 v13, v13, 9, v7
    buffer_load_dword v11, v13, s[12:15], 0 offen sc1
    s_waitcnt vmcnt(0)
    v_cmp_ge_u32 vcc, v12, v11
    s_add_u32 s70, s70, 1
    s_and_b32 s46, vcc_lo, 0xffff
    s_cbranch_scc0 L_g_sp_56_ok
    s_sleep 3
    s_cmp_lt_u32 s70, 524288
    s_cbranch_scc1 L_g_sp_56
    s_branch L_c_done_1
L_g_sp_56_ok:
    v_cmp_ge_u32 vcc, v12, v11
    s_nop 0
    s_ff1_i32_b64 s46, vcc
    s_lshr_b32 s46, s46, 4
    s_min_u32 s46, s46, 4
    s_add_u32 s46, s46, s54
    s_min_u32 s46, s46, s75
    v_mov_b32 v118, s46
    ds_write_b32 v15, v118 offset:20
L_g_nsp_50:
    s_waitcnt lgkmcnt(0)
    s_barrier
    ds_read_b32 v14, v15 offset:20
    s_waitcnt lgkmcnt(0)
    v_readfirstlane_b32 s66, v14
    s_nop 3
L_g_restart_49_go:
    s_mov_b32 s69, 0
    s_cmp_gt_u32 s62, s60
    s_cbranch_scc1 L_g_nd_59
    s_cmp_ge_u32 s62, s66
    s_cbranch_scc1 L_g_nd_59
    s_add_u32 s47, s61, 4096
    s_add_u32 m0, s64, 0
    s_nop 0
    buffer_load_dwordx4 v3, s[12:15], s61 offen offset:0 sc1 lds
    buffer_load_dwordx4 v3, s[12:15], s61 offen offset:1024 sc1 lds
    buffer_load_dwordx4 v3, s[12:15], s61 offen offset:2048 sc1 lds
    buffer_load_dwordx4 v3, s[12:15], s61 offen offset:3072 sc1 lds
    s_add_u32 m0, s64, 4096
    s_nop 0
    buffer_load_dwordx4 v3, s[12:15], s47 offen offset:0 sc1 lds
    buffer_load_dwordx4 v3, s[12:15], s47 offen offset:1024 sc1 lds
    buffer_load_dwordx4 v3, s[12:15], s47 offen offset:2048 sc1 lds
    buffer_load_dwordx4 v3, s[12:15], s47 offen offset:3072 sc1 lds
    s_add_u32 s61, s61, s85
    s_add_u32 s62, s62, 1
    s_xor_b32 s64, s64, 0x10000
    s_mov_b32 s69, 1
L_g_nd_59:
    s_cmp_eq_u32 s51, 1
    s_cbranch_scc1 L_g_g1r_51
    s_add_u32 s59, s60, 1
    s_mov_b32 s69, 0
    s_cmp_gt_u32 s62, s59
    s_cbranch_scc1 L_g_nd_60
    s_cmp_ge_u32 s62, s66
    s_cbranch_scc1 L_g_nd_60
    s_add_u32 s47, s61, 4096
    s_add_u32 m0, s64, 0
    s_nop 0
    buffer_load_dwordx4 v3, s[12:15], s61 offen offset:0 sc1 lds
    buffer_load_dwordx4 v3, s[12:15], s61 offen offset:1024 sc1 lds
    buffer_load_dwordx4 v3, s[12:15], s61 offen offset:2048 sc1 lds
    buffer_load_dwordx4 v3, s[12:15], s61 offen offset:3072 sc1 lds
    s_add_u32 m0, s64, 4096
    s_nop 0
    buffer_load_dwordx4 v3, s[12:15], s47 offen offset:0 sc1 lds
    buffer_load_dwordx4 v3, s[12:15], s47 offen offset:1024 sc1 lds
    buffer_load_dwordx4 v3, s[12:15], s47 offen offset:2048 sc1 lds
    buffer_load_dwordx4 v3, s[12:15], s47 offen offset:3072 sc1 lds
    s_add_u32 s61, s61, s85
    s_add_u32 s62, s62, 1
    s_xor_b32 s64, s64, 0x10000
    s_mov_b32 s69, 1
L_g_nd_60:
    s_cmp_eq_u32 s69, 1
    s_cbranch_scc1 L_g_w0_61
    s_waitcnt vmcnt(0)
L_g_w0_61:
    s_waitcnt vmcnt(8)
    s_cmp_lg_u32 s44, 0
    s_cbranch_scc1 L_g_nl_62
    s_cmp_lt_u32 s66, s75
    s_cselect_b32 s81, 1, 2
L_g_nl_62:
L_g_loop0_52_l:
    s_barrier
    ds_read_b128 v[32:35], v4 offset:0
    ds_read_b128 v[36:39], v4 offset:256
    ds_read_b128 v[40:43], v4 offset:2048
    ds_read_b128 v[44:47], v4 offset:2304
    ds_read_b128 v[48:51], v4 offset:4096
    ds_read_b128 v[52:55], v4 offset:4352
    ds_read_b128 v[56:59], v4 offset:6144
    ds_read_b128 v[60:63], v4 offset:6400
    s_branch L_g_loop0_52_m
.p2align 6
L_g_loop0_52:
    s_barrier
L_g_loop0_52_m:
    s_setprio 2
    s_waitcnt lgkmcnt(6)
    v_mfma_f32_16x16x32_bf16 v[16:19], a[0:3], v[32:35], 0
    v_mfma_f32_16x16x32_bf16 v[20:23], a[4:7], v[32:35], 0
    ds_read_b128 v[32:35], v4 offset:8192
    v_mfma_f32_16x16x32_bf16 v[28:31], a[4:7], v[36:39], 0
    v_mfma_f32_16x16x32_bf16 v[24:27], a[0:3], v[36:39], 0
    ds_read_b128 v[36:39], v4 offset:8448
    s_cmp_eq_u32 s81, 1
    s_cbranch_scc1 L_g_h1_66
L_g_h1_66_b:
    s_waitcnt lgkmcnt(6)
    v_mfma_f32_16x16x32_bf16 v[16:19], a[8:11], v[40:43], v[16:19]
    v_mfma_f32_16x16x32_bf16 v[20:23], a[12:15], v[40:43], v[20:23]
    ds_read_b128 v[40:43], v4 offset:10240
    v_mfma_f32_16x16x32_bf16 v[28:31], a[12:15], v[44:47], v[28:31]
    v_mfma_f32_16x16x32_bf16 v[24:27], a[8:11], v[44:47], v[24:27]
    ds_read_b128 v[44:47], v4 offset:10496
    s_waitcnt lgkmcnt(6)
    v_mfma_f32_16x16x32_bf16 v[16:19], a[16:19], v[48:51], v[16:19]
    v_mfma_f32_16x16x32_bf16 v[20:23], a[20:23], v[48:51], v[20:23]
    ds_read_b128 v[48:51], v4 offset:12288
    v_mfma_f32_16x16x32_bf16 v[28:31], a[20:23], v[52:55], v[28:31]
    v_mfma_f32_16x16x32_bf16 v[24:27], a[16:19], v[52:55], v[24:27]
    ds_read_b128 v[52:55], v4 offset:12544
    s_waitcnt lgkmcnt(6)
    v_mfma_f32_16x16x32_bf16 v[16:19], a[24:27], v[56:59], v[16:19]
    v_mfma_f32_16x16x32_bf16 v[20:23], a[28:31], v[56:59], v[20:23]
    ds_read_b128 v[56:59], v4 offset:14336
    v_mfma_f32_16x16x32_bf16 v[28:31], a[28:31], v[60:63], v[28:31]
    v_mfma_f32_16x16x32_bf16 v[24:27], a[24:27], v[60:63], v[24:27]
    ds_read_b128 v[60:63], v4 offset:14592
    s_waitcnt lgkmcnt(6)
    v_mfma_f32_16x16x32_bf16 v[16:19], a[32:35], v[32:35], v[16:19]
    v_mfma_f32_16x16x32_bf16 v[20:23], a[36:39], v[32:35], v[20:23]
    ds_read_b128 v[32:35], v4 offset:16384
    v_mfma_f32_16x16x32_bf16 v[28:31], a[36:39], v[36:39], v[28:31]
    v_mfma_f32_16x16x32_bf16 v[24:27], a[32:35], v[36:39], v[24:27]
    ds_read_b128 v[36:39], v4 offset:16640
    s_waitcnt lgkmcnt(6)
    v_mfma_f32_16x16x32_bf16 v[16:19], a[40:43], v[40:43], v[16:19]
    v_mfma_f32_16x16x32_bf16 v[20:23], a[44:47], v[40:43], v[20:23]
    ds_read_b128 v[40:43], v4 offset:18432
    v_mfma_f32_16x16x32_bf16 v[28:31], a[44:47], v[44:47], v[28:31]
    v_mfma_f32_16x16x32_bf16 v[24:27], a[40:43], v[44:47], v[24:27]
    ds_read_b128 v[44:47], v4 offset:18688
    s_waitcnt lgkmcnt(6)
    v_mfma_f32_16x16x32_bf16 v[16:19], a[48:51], v[48:51], v[16:19]
    v_mfma_f32_16x16x32_bf16 v[20:23], a[52:55], v[48:51], v[20:23]
    ds_read_b128 v[48:51], v4 offset:20480
    v_mfma_f32_16x16x32_bf16 v[28:31], a[52:55], v[52:55], v[28:31]
    v_mfma_f32_16x16x32_bf16 v[24:27], a[48:51], v[52:55], v[24:27]
    ds_read_b128 v[52:55], v4 offset:20736
    s_waitcnt lgkmcnt(6)
    v_mfma_f32_16x16x32_bf16 v[16:19], a[56:59], v[56:59], v[16:19]
    v_mfma_f32_16x16x32_bf16 v[20:23], a[60:63], v[56:59], v[20:23]
    ds_read_b128 v[56:59], v4 offset:22528
    v_mfma_f32_16x16x32_bf16 v[28:31], a[60:63], v[60:63], v[28:31]
    v_mfma_f32_16x16x32_bf16 v[24:27], a[56:59], v[60:63], v[24:27]
    ds_read_b128 v[60:63], v4 offset:22784
    s_waitcnt lgkmcnt(6)
    v_mfma_f32_16x16x32_bf16 v[16:19], a[64:67], v[32:35], v[16:19]
    v_mfma_f32_16x16x32_bf16 v[20:23], a[68:71], v[32:35], v[20:23]
    ds_read_b128 v[32:35], v4 offset:24576
    v_mfma_f32_16x16x32_bf16 v[28:31], a[68:71], v[36:39], v[28:31]
    v_mfma_f32_16x16x32_bf16 v[24:27], a[64:67], v[36:39], v[24:27]
    ds_read_b128 v[36:39], v4 offset:24832
    s_waitcnt lgkmcnt(6)
    v_mfma_f32_16x16x32_bf16 v[16:19], a[72:75], v[40:43], v[16:19]
    v_mfma_f32_16x16x32_bf16 v[20:23], a[76:79], v[40:43], v[20:23]
    ds_read_b128 v[40:43], v4 offset:26624
    v_mfma_f32_16x16x32_bf16 v[28:31], a[76:79], v[44:47], v[28:31]
    v_mfma_f32_16x16x32_bf16 v[24:27], a[72:75], v[44:47], v[24:27]
    ds_read_b128 v[44:47], v4 offset:26880
    s_waitcnt lgkmcnt(6)
    v_mfma_f32_16x16x32_bf16 v[16:19], a[80:83], v[48:51], v[16:19]
    v_mfma_f32_16x16x32_bf16 v[20:23], a[84:87], v[48:51], v[20:23]
    ds_read_b128 v[48:51], v4 offset:28672
    v_mfma_f32_16x16x32_bf16 v[28:31], a[84:87], v[52:55], v[28:31]
    v_mfma_f32_16x16x32_bf16 v[24:27], a[80:83], v[52:55], v[24:27]
    ds_read_b128 v[52:55], v4 offset:28928
    s_waitcnt lgkmcnt(6)
    v_mfma_f32_16x16x32_bf16 v[16:19], a[88:91], v[56:59], v[16:19]
    v_mfma_f32_16x16x32_bf16 v[20:23], a[92:95], v[56:59], v[20:23]
    ds_read_b128 v[56:59], v4 offset:30720
    v_mfma_f32_16x16x32_bf16 v[28:31], a[92:95], v[60:63], v[28:31]
    v_mfma_f32_16x16x32_bf16 v[24:27], a[88:91], v[60:63], v[24:27]
    ds_read_b128 v[60:63], v4 offset:30976
    s_waitcnt lgkmcnt(6)
    v_mfma_f32_16x16x32_bf16 v[16:19], a[96:99], v[32:35], v[16:19]
    v_mfma_f32_16x16x32_bf16 v[20:23], a[100:103], v[32:35], v[20:23]
    v_mfma_f32_16x16x32_bf16 v[28:31], a[100:103], v[36:39], v[28:31]
    v_mfma_f32_16x16x32_bf16 v[24:27], a[96:99], v[36:39], v[24:27]
    s_waitcnt lgkmcnt(4)
    v_mfma_f32_16x16x32_bf16 v[16:19], a[104:107], v[40:43], v[16:19]
    v_mfma_f32_16x16x32_bf16 v[20:23], a[108:111], v[40:43], v[20:23]
    v_mfma_f32_16x16x32_bf16 v[28:31], a[108:111], v[44:47], v[28:31]
    v_mfma_f32_16x16x32_bf16 v[24:27], a[104:107], v[44:47], v[24:27]
    s_waitcnt lgkmcnt(2)
    v_mfma_f32_16x16x32_bf16 v[16:19], a[112:115], v[48:51], v[16:19]
    v_mfma_f32_16x16x32_bf16 v[20:23], a[116:119], v[48:51], v[20:23]
    s_cmp_eq_u32 s81, 1
    s_cbranch_scc1 L_g_h2_67
L_g_h2_67_b:
    ds_write_b32 v119, v118
    v_mfma_f32_16x16x32_bf16 v[28:31], a[116:119], v[52:55], v[28:31]
    v_mfma_f32_16x16x32_bf16 v[24:27], a[112:115], v[52:55], v[24:27]
    s_waitcnt lgkmcnt(0)
    v_mfma_f32_16x16x32_bf16 v[16:19], a[120:123], v[56:59], v[16:19]
    v_mfma_f32_16x16x32_bf16 v[20:23], a[124:127], v[56:59], v[20:23]
    v_mfma_f32_16x16x32_bf16 v[28:31], a[124:127], v[60:63], v[28:31]
    v_mfma_f32_16x16x32_bf16 v[24:27], a[120:123], v[60:63], v[24:27]
    v_xor_b32 v4, 0x10000, v4
    s_setprio 0
    s_waitcnt vmcnt(0)
    s_waitcnt lgkmcnt(0)
    s_barrier
    ds_read_b32 v14, v15
    s_nop 6
    ds_write_b128 v5, v[16:19] offset:0
    ds_write_b128 v5, v[20:23] offset:1024
    ds_write_b128 v5, v[24:27] offset:2048
    ds_write_b128 v5, v[28:31] offset:3072
    s_waitcnt lgkmcnt(4)
    v_readfirstlane_b32 s66, v14
    s_add_u32 s60, s60, 1
    s_mov_b32 s65, 0
    s_cmp_le_u32 s62, s60
    s_cbranch_scc1 L_g_dp_68_l
L_g_dp_68_a:
    s_cmp_ge_u32 s62, s66
    s_cbranch_scc1 L_g_dp_68_d
    s_add_u32 s47, s61, 4096
    s_mov_b32 m0, s64
    s_add_u32 s62, s62, 1
    buffer_load_dwordx4 v3, s[12:15], s61 offen offset:0 sc1 lds
    buffer_load_dwordx4 v3, s[12:15], s61 offen offset:1024 sc1 lds
    buffer_load_dwordx4 v3, s[12:15], s61 offen offset:2048 sc1 lds
    buffer_load_dwordx4 v3, s[12:15], s61 offen offset:3072 sc1 lds
    s_add_u32 m0, s64, 4096
    s_add_u32 s61, s61, s85
    buffer_load_dwordx4 v3, s[12:15], s47 offen offset:0 sc1 lds
    buffer_load_dwordx4 v3, s[12:15], s47 offen offset:1024 sc1 lds
    buffer_load_dwordx4 v3, s[12:15], s47 offen offset:2048 sc1 lds
    buffer_load_dwordx4 v3, s[12:15], s47 offen offset:3072 sc1 lds
    s_xor_b32 s64, s64, 0x10000
L_g_dp_68_d:
    s_cmp_le_u32 s66, s60
    s_cbranch_scc1 L_g_ex0_65
    s_cmp_lg_u32 s65, 0
    s_cbranch_scc1 L_g_nw_64
    ds_read_b128 v[32:35], v4 offset:0
    ds_read_b128 v[36:39], v4 offset:256
    ds_read_b128 v[40:43], v4 offset:2048
    ds_read_b128 v[44:47], v4 offset:2304
    ds_read_b128 v[48:51], v4 offset:4096
    ds_read_b128 v[52:55], v4 offset:4352
    ds_read_b128 v[56:59], v4 offset:6144
    ds_read_b128 v[60:63], v4 offset:6400
    s_cmp_lg_u32 s44, 0
    s_cbranch_scc1 L_g_nl_69
    s_mov_b32 s46, s66
    s_cmp_lg_u32 s81, 0
    s_cbranch_scc1 L_g_nl_69_e
    v_cmp_ge_u32 vcc, v12, v11
    s_nop 0
    s_ff1_i32_b64 s46, vcc
    s_lshr_b32 s46, s46, 4
    s_min_u32 s46, s46, 4
    s_add_u32 s46, s46, s54
    s_min_u32 s46, s46, s75
    v_mov_b32 v118, s46
L_g_nl_69_e:
    s_add_u32 s47, s60, 3
    s_min_u32 s47, s47, s75
    s_cmp_lt_u32 s46, s47
    s_cselect_b32 s81, 1, 0
    s_cbranch_scc1 L_g_nl_69
    s_add_u32 s54, s60, 2
    s_mul_i32 s55, s54, s78
    v_add_u32 v12, s55, v113
    v_and_b32 v13, 7, v12
    v_lshl_add_u32 v13, v13, 9, v7
    buffer_load_dword v11, v13, s[12:15], 0 offen sc1
L_g_nl_69:
    s_waitcnt lgkmcnt(8)
    s_branch L_g_loop0_52
L_g_ex0_65:
    s_cmp_lg_u32 s44, 0
    s_cbranch_scc1 L_g_ex0_65_n
    ds_write_b32 v15, v118 offset:20
    s_cmp_ge_u32 s60, s75
    s_cbranch_scc1 L_g_ex0_65_n
    s_sleep 6
    s_add_u32 s54, s60, 0
    s_mul_i32 s55, s54, s78
    v_add_u32 v12, s55, v113
    v_and_b32 v13, 7, v12
    v_lshl_add_u32 v13, v13, 9, v7
    buffer_load_dword v11, v13, s[12:15], 0 offen sc1
    s_waitcnt vmcnt(0)
    v_cmp_ge_u32 vcc, v12, v11
    s_nop 0
    s_ff1_i32_b64 s46, vcc
    s_lshr_b32 s46, s46, 4
    s_min_u32 s46, s46, 4
    s_add_u32 s46, s46, s54
    s_min_u32 s46, s46, s75
    v_mov_b32 v118, s46
    ds_write_b32 v15, v118 offset:20
L_g_ex0_65_n:
    s_waitcnt lgkmcnt(0)
    s_barrier
    ds_read_b32 v14, v15 offset:20
    s_waitcnt lgkmcnt(0)
    v_readfirstlane_b32 s66, v14
    s_barrier
    s_cmp_gt_u32 s66, s60
    s_cbranch_scc1 L_g_restart_49_go
    s_branch L_g_tail_54
L_g_g1r_51:
    s_mov_b32 s65, 1
    s_branch L_g_loop1_53_e
.p2align 6
L_g_loop1_53:
    s_mov_b32 s65, 0
L_g_loop1_53_e:
    s_barrier
    s_bitcmp1_b32 s67, 1
    s_cbranch_scc0 L_g_nfl_70
    s_cmp_lg_u32 s44, 4
    s_cbranch_scc1 L_g_nfl_70_d
    s_mul_i32 s59, s60, s78
    s_add_u32 s59, s59, s87
    v_mov_b32 v10, s59
    buffer_store_dword v10, v115, s[12:15], s52 offen sc1
L_g_nfl_70_d:
    ds_read_b128 v[80:83], v5 offset:0
    ds_read_b128 v[84:87], v5 offset:1024
    ds_read_b128 v[88:91], v5 offset:2048
    ds_read_b128 v[92:95], v5 offset:3072
    s_cmp_le_u32 s62, s60
    s_cbranch_scc1 L_g_dp_75_l
L_g_dp_75_a:
    s_cmp_ge_u32 s62, s66
    s_cbranch_scc1 L_g_dp_75_d
    s_add_u32 s47, s61, 4096
    s_mov_b32 m0, s64
    s_add_u32 s62, s62, 1
    buffer_load_dwordx4 v3, s[12:15], s61 offen offset:0 sc1 lds
    buffer_load_dwordx4 v3, s[12:15], s61 offen offset:1024 sc1 lds
    buffer_load_dwordx4 v3, s[12:15], s61 offen offset:2048 sc1 lds
    buffer_load_dwordx4 v3, s[12:15], s61 offen offset:3072 sc1 lds
    s_add_u32 m0, s64, 4096
    s_add_u32 s61, s61, s85
    buffer_load_dwordx4 v3, s[12:15], s47 offen offset:0 sc1 lds
    buffer_load_dwordx4 v3, s[12:15], s47 offen offset:1024 sc1 lds
    buffer_load_dwordx4 v3, s[12:15], s47 offen offset:2048 sc1 lds
    buffer_load_dwordx4 v3, s[12:15], s47 offen offset:3072 sc1 lds
    s_xor_b32 s64, s64, 0x10000
L_g_dp_75_d:
    s_bitcmp1_b32 s67, 0
    s_cbranch_scc0 L_g_nep_71
    s_waitcnt lgkmcnt(0)
    v_add_f32 v80, v80, v16
    v_add_f32 v81, v81, v17
    v_add_f32 v82, v82, v18
    v_add_f32 v83, v83, v19
    v_add_f32 v84, v84, v20
    v_add_f32 v85, v85, v21
    v_add_f32 v86, v86, v22
    v_add_f32 v87, v87, v23
    v_add_f32 v88, v88, v24
    v_add_f32 v89, v89, v25
    v_add_f32 v90, v90, v26
    v_add_f32 v91, v91, v27
    v_add_f32 v92, v92, v28
    v_add_f32 v93, v93, v29
    v_add_f32 v94, v94, v30
    v_add_f32 v95, v95, v31
    v_cvt_pk_bf16_f32 v104, v80, v81
    v_cvt_pk_bf16_f32 v105, v82, v83
    v_cvt_pk_bf16_f32 v106, v84, v85
    v_cvt_pk_bf16_f32 v107, v86, v87
    buffer_store_dwordx4 v[104:107], v8, s[12:15], s63 offen sc1
    v_cvt_pk_bf16_f32 v108, v88, v89
    v_cvt_pk_bf16_f32 v109, v90, v91
    v_cvt_pk_bf16_f32 v110, v92, v93
    v_cvt_pk_bf16_f32 v111, v94, v95
    buffer_store_dwordx4 v[108:111], v9, s[12:15], s63 offen sc1
    s_add_u32 s63, s63, s86
    s_cmp_lg_u32 s53, 2
    s_cbranch_scc1 L_g_pf_76
    s_lshl_b32 s73, s58, 1
    buffer_store_dwordx4 v[120:123], v64, s[12:15], s58 offen sc1
    buffer_store_dwordx4 v[120:123], v65, s[12:15], s73 offen sc1
    buffer_store_dwordx4 v[120:123], v68, s[12:15], s73 offen sc1
    s_add_u32 s58, s58, 131072
L_g_pf_76:
    s_cmp_le_u32 s60, 2
    s_cbranch_scc1 L_g_nep_71_e
L_g_nep_71:
    s_cmp_lg_u32 s65, 0
    s_cbranch_scc1 L_g_nw1_72
    ds_read_b128 v[32:35], v4 offset:0
    ds_read_b128 v[36:39], v4 offset:256
    ds_read_b128 v[40:43], v4 offset:2048
    ds_read_b128 v[44:47], v4 offset:2304
    ds_read_b128 v[48:51], v4 offset:4096
    ds_read_b128 v[52:55], v4 offset:4352
    ds_read_b128 v[56:59], v4 offset:6144
    ds_read_b128 v[60:63], v4 offset:6400
    s_barrier
L_g_jn_74:
    s_setprio 1
    s_waitcnt lgkmcnt(6)
    v_mfma_f32_16x16x32_bf16 v[16:19], a[0:3], v[32:35], 0
    ds_read_b32 v14, v15
    v_mfma_f32_16x16x32_bf16 v[20:23], a[4:7], v[32:35], 0
    ds_read_b128 v[32:35], v4 offset:8192
    v_mfma_f32_16x16x32_bf16 v[28:31], a[4:7], v[36:39], 0
    v_mfma_f32_16x16x32_bf16 v[24:27], a[0:3], v[36:39], 0
    ds_read_b128 v[36:39], v4 offset:8448
    s_waitcnt lgkmcnt(6)
    v_mfma_f32_16x16x32_bf16 v[16:19], a[8:11], v[40:43], v[16:19]
    v_mfma_f32_16x16x32_bf16 v[20:23], a[12:15], v[40:43], v[20:23]
    ds_read_b128 v[40:43], v4 offset:10240
    v_mfma_f32_16x16x32_bf16 v[28:31], a[12:15], v[44:47], v[28:31]
    v_mfma_f32_16x16x32_bf16 v[24:27], a[8:11], v[44:47], v[24:27]
    ds_read_b128 v[44:47], v4 offset:10496
    s_waitcnt lgkmcnt(6)
    v_mfma_f32_16x16x32_bf16 v[16:19], a[16:19], v[48:51], v[16:19]
    v_mfma_f32_16x16x32_bf16 v[20:23], a[20:23], v[48:51], v[20:23]
    ds_read_b128 v[48:51], v4 offset:12288
    v_mfma_f32_16x16x32_bf16 v[28:31], a[20:23], v[52:55], v[28:31]
    v_mfma_f32_16x16x32_bf16 v[24:27], a[16:19], v[52:55], v[24:27]
    ds_read_b128 v[52:55], v4 offset:12544
    s_waitcnt lgkmcnt(6)
    v_mfma_f32_16x16x32_bf16 v[16:19], a[24:27], v[56:59], v[16:19]
    v_mfma_f32_16x16x32_bf16 v[20:23], a[28:31], v[56:59], v[20:23]
    ds_read_b128 v[56:59], v4 offset:14336
    v_mfma_f32_16x16x32_bf16 v[28:31], a[28:31], v[60:63], v[28:31]
    v_mfma_f32_16x16x32_bf16 v[24:27], a[24:27], v[60:63], v[24:27]
    ds_read_b128 v[60:63], v4 offset:14592
    s_waitcnt lgkmcnt(6)
    v_mfma_f32_16x16x32_bf16 v[16:19], a[32:35], v[32:35], v[16:19]
    v_mfma_f32_16x16x32_bf16 v[20:23], a[36:39], v[32:35], v[20:23]
    ds_read_b128 v[32:35], v4 offset:16384
    v_mfma_f32_16x16x32_bf16 v[28:31], a[36:39], v[36:39], v[28:31]
    v_mfma_f32_16x16x32_bf16 v[24:27], a[32:35], v[36:39], v[24:27]
    ds_read_b128 v[36:39], v4 offset:16640
    s_waitcnt lgkmcnt(6)
    v_mfma_f32_16x16x32_bf16 v[16:19], a[40:43], v[40:43], v[16:19]
    v_mfma_f32_16x16x32_bf16 v[20:23], a[44:47], v[40:43], v[20:23]
    ds_read_b128 v[40:43], v4 offset:18432
    v_mfma_f32_16x16x32_bf16 v[28:31], a[44:47], v[44:47], v[28:31]
    v_mfma_f32_16x16x32_bf16 v[24:27], a[40:43], v[44:47], v[24:27]
    ds_read_b128 v[44:47], v4 offset:18688
    s_waitcnt lgkmcnt(6)
    v_mfma_f32_16x16x32_bf16 v[16:19], a[48:51], v[48:51], v[16:19]
    v_mfma_f32_16x16x32_bf16 v[20:23], a[52:55], v[48:51], v[20:23]
    ds_read_b128 v[48:51], v4 offset:20480
    v_mfma_f32_16x16x32_bf16 v[28:31], a[52:55], v[52:55], v[28:31]
    v_mfma_f32_16x16x32_bf16 v[24:27], a[48:51], v[52:55], v[24:27]
    ds_read_b128 v[52:55], v4 offset:20736
    s_waitcnt lgkmcnt(6)
    v_mfma_f32_16x16x32_bf16 v[16:19], a[56:59], v[56:59], v[16:19]
    v_mfma_f32_16x16x32_bf16 v[20:23], a[60:63], v[56:59], v[20:23]
    ds_read_b128 v[56:59], v4 offset:22528
    v_mfma_f32_16x16x32_bf16 v[28:31], a[60:63], v[60:63], v[28:31]
    v_mfma_f32_16x16x32_bf16 v[24:27], a[56:59], v[60:63], v[24:27]
    ds_read_b128 v[60:63], v4 offset:22784
    s_waitcnt lgkmcnt(6)
    v_mfma_f32_16x16x32_bf16 v[16:19], a[64:67], v[32:35], v[16:19]
    v_mfma_f32_16x16x32_bf16 v[20:23], a[68:71], v[32:35], v[20:23]
    ds_read_b128 v[32:35], v4 offset:24576
    v_mfma_f32_16x16x32_bf16 v[28:31], a[68:71], v[36:39], v[28:31]
    v_mfma_f32_16x16x32_bf16 v[24:27], a[64:67], v[36:39], v[24:27]
    ds_read_b128 v[36:39], v4 offset:24832
    s_waitcnt lgkmcnt(6)
    v_mfma_f32_16x16x32_bf16 v[16:19], a[72:75], v[40:43], v[16:19]
    v_mfma_f32_16x16x32_bf16 v[20:23], a[76:79], v[40:43], v[20:23]
    ds_read_b128 v[40:43], v4 offset:26624
    v_mfma_f32_16x16x32_bf16 v[28:31], a[76:79], v[44:47], v[28:31]
    v_mfma_f32_16x16x32_bf16 v[24:27], a[72:75], v[44:47], v[24:27]
    ds_read_b128 v[44:47], v4 offset:26880
    s_waitcnt lgkmcnt(6)
    v_mfma_f32_16x16x32_bf16 v[16:19], a[80:83], v[48:51], v[16:19]
    v_mfma_f32_16x16x32_bf16 v[20:23], a[84:87], v[48:51], v[20:23]
    ds_read_b128 v[48:51], v4 offset:28672
    v_mfma_f32_16x16x32_bf16 v[28:31], a[84:87], v[52:55], v[28:31]
    v_mfma_f32_16x16x32_bf16 v[24:27], a[80:83], v[52:55], v[24:27]
    ds_read_b128 v[52:55], v4 offset:28928
    s_waitcnt lgkmcnt(6)
    v_mfma_f32_16x16x32_bf16 v[16:19], a[88:91], v[56:59], v[16:19]
    v_mfma_f32_16x16x32_bf16 v[20:23], a[92:95], v[56:59], v[20:23]
    ds_read_b128 v[56:59], v4 offset:30720
    v_mfma_f32_16x16x32_bf16 v[28:31], a[92:95], v[60:63], v[28:31]
    v_mfma_f32_16x16x32_bf16 v[24:27], a[88:91], v[60:63], v[24:27]
    ds_read_b128 v[60:63], v4 offset:30976
    s_waitcnt lgkmcnt(6)
    v_mfma_f32_16x16x32_bf16 v[16:19], a[96:99], v[32:35], v[16:19]
    v_mfma_f32_16x16x32_bf16 v[20:23], a[100:103], v[32:35], v[20:23]
    v_mfma_f32_16x16x32_bf16 v[28:31], a[100:103], v[36:39], v[28:31]
    v_mfma_f32_16x16x32_bf16 v[24:27], a[96:99], v[36:39], v[24:27]
    s_waitcnt lgkmcnt(4)
    v_mfma_f32_16x16x32_bf16 v[16:19], a[104:107], v[40:43], v[16:19]
    v_mfma_f32_16x16x32_bf16 v[20:23], a[108:111], v[40:43], v[20:23]
    v_mfma_f32_16x16x32_bf16 v[28:31], a[108:111], v[44:47], v[28:31]
    v_mfma_f32_16x16x32_bf16 v[24:27], a[104:107], v[44:47], v[24:27]
    s_waitcnt lgkmcnt(2)
    v_mfma_f32_16x16x32_bf16 v[16:19], a[112:115], v[48:51], v[16:19]
    v_mfma_f32_16x16x32_bf16 v[20:23], a[116:119], v[48:51], v[20:23]
    v_mfma_f32_16x16x32_bf16 v[28:31], a[116:119], v[52:55], v[28:31]
    v_mfma_f32_16x16x32_bf16 v[24:27], a[112:115], v[52:55], v[24:27]
    s_waitcnt lgkmcnt(0)
    v_mfma_f32_16x16x32_bf16 v[16:19], a[120:123], v[56:59], v[16:19]
    v_mfma_f32_16x16x32_bf16 v[20:23], a[124:127], v[56:59], v[20:23]
    v_mfma_f32_16x16x32_bf16 v[28:31], a[124:127], v[60:63], v[28:31]
    v_mfma_f32_16x16x32_bf16 v[24:27], a[120:123], v[60:63], v[24:27]
    v_xor_b32 v4, 0x10000, v4
    s_setprio 0
    s_waitcnt vmcnt(0)
    v_readfirstlane_b32 s66, v14
    s_lshl_b32 s67, s67, 1
    s_or_b32 s67, s67, 1
    s_add_u32 s60, s60, 1
    s_cmp_gt_u32 s66, s60
    s_cbranch_scc1 L_g_loop1_53
    s_barrier
    ds_read_b32 v14, v15 offset:20
    ds_read_b128 v[80:83], v5 offset:0
    ds_read_b128 v[84:87], v5 offset:1024
    ds_read_b128 v[88:91], v5 offset:2048
    ds_read_b128 v[92:95], v5 offset:3072
    s_waitcnt lgkmcnt(4)
    v_readfirstlane_b32 s66, v14
    s_barrier
    s_mov_b32 s69, 0
    s_cmp_gt_u32 s62, s60
    s_cbranch_scc1 L_g_nd_77
    s_cmp_ge_u32 s62, s66
    s_cbranch_scc1 L_g_nd_77
    s_add_u32 s47, s61, 4096
    s_add_u32 m0, s64, 0
    s_nop 0
    buffer_load_dwordx4 v3, s[12:15], s61 offen offset:0 sc1 lds
    buffer_load_dwordx4 v3, s[12:15], s61 offen offset:1024 sc1 lds
    buffer_load_dwordx4 v3, s[12:15], s61 offen offset:2048 sc1 lds
    buffer_load_dwordx4 v3, s[12:15], s61 offen offset:3072 sc1 lds
    s_add_u32 m0, s64, 4096
    s_nop 0
    buffer_load_dwordx4 v3, s[12:15], s47 offen offset:0 sc1 lds
    buffer_load_dwordx4 v3, s[12:15], s47 offen offset:1024 sc1 lds
    buffer_load_dwordx4 v3, s[12:15], s47 offen offset:2048 sc1 lds
    buffer_load_dwordx4 v3, s[12:15], s47 offen offset:3072 sc1 lds
    s_add_u32 s61, s61, s85
    s_add_u32 s62, s62, 1
    s_xor_b32 s64, s64, 0x10000
    s_mov_b32 s69, 1
L_g_nd_77:
    s_waitcnt lgkmcnt(3)
    v_add_f32 v80, v80, v16
    v_add_f32 v81, v81, v17
    v_add_f32 v82, v82, v18
    v_add_f32 v83, v83, v19
    s_waitcnt lgkmcnt(2)
    v_add_f32 v84, v84, v20
    v_add_f32 v85, v85, v21
    v_add_f32 v86, v86, v22
    v_add_f32 v87, v87, v23
    s_waitcnt lgkmcnt(1)
    v_add_f32 v88, v88, v24
    v_add_f32 v89, v89, v25
    v_add_f32 v90, v90, v26
    v_add_f32 v91, v91, v27
    s_waitcnt lgkmcnt(0)
    v_add_f32 v92, v92, v28
    v_add_f32 v93, v93, v29
    v_add_f32 v94, v94, v30
    v_add_f32 v95, v95, v31
    v_cvt_pk_bf16_f32 v104, v80, v81
    v_cvt_pk_bf16_f32 v105, v82, v83
    v_cvt_pk_bf16_f32 v106, v84, v85
    v_cvt_pk_bf16_f32 v107, v86, v87
    buffer_store_dwordx4 v[104:107], v8, s[12:15], s63 offen sc1
    v_cvt_pk_bf16_f32 v108, v88, v89
    v_cvt_pk_bf16_f32 v109, v90, v91
    v_cvt_pk_bf16_f32 v110, v92, v93
    v_cvt_pk_bf16_f32 v111, v94, v95
    buffer_store_dwordx4 v[108:111], v9, s[12:15], s63 offen sc1
    s_add_u32 s63, s63, s86
    s_cmp_lg_u32 s53, 2
    s_cbranch_scc1 L_g_pf_78
    s_lshl_b32 s73, s58, 1
    buffer_store_dwordx4 v[120:123], v64, s[12:15], s58 offen sc1
    buffer_store_dwordx4 v[120:123], v65, s[12:15], s73 offen sc1
    buffer_store_dwordx4 v[120:123], v68, s[12:15], s73 offen sc1
    s_add_u32 s58, s58, 131072
L_g_pf_78:
    s_mov_b32 s67, 0
    s_mov_b32 s71, 1
    s_cmp_gt_u32 s66, s60
    s_cbranch_scc1 L_g_g1r_51
    v_mov_b32 v10, 1
    s_mov_b64 exec, 1
    s_waitcnt vmcnt(0)
    ds_add_rtn_u32 v10, v15, v10 offset:4
    s_waitcnt lgkmcnt(0)
    v_readfirstlane_b32 s46, v10
    s_mov_b64 exec, -1
    s_mov_b32 s71, 0
    s_sub_u32 s59, s60, 1
    s_mul_i32 s59, s59, s78
    s_add_u32 s59, s59, s74
    s_cmp_lg_u32 s46, s68
    s_cbranch_scc1 L_g_df_79
    v_mov_b32 v10, s59
    v_add_u32 v10, 1, v10
    v_mov_b32 v11, 0
    s_mov_b64 exec, 1
    buffer_store_dword v10, v11, s[12:15], s52 offen sc1
    s_mov_b64 exec, -1
L_sf_80:
L_g_df_79:
    s_add_u32 s68, s68, 4
    s_cmp_gt_u32 s66, s60
    s_cbranch_scc1 L_g_g1r_51
L_g_tail_54:
    s_cmp_lt_u32 s60, s75
    s_cbranch_scc1 L_g_restart_49
    s_waitcnt vmcnt(0)
    s_barrier
    s_branch L_w_p2_9
L_g_h1_66:
    s_add_u32 s54, s60, 1
    s_mul_i32 s55, s54, s78
    v_add_u32 v12, s55, v113
    v_and_b32 v13, 7, v12
    v_lshl_add_u32 v13, v13, 9, v7
    buffer_load_dword v11, v13, s[12:15], 0 offen sc1
    s_branch L_g_h1_66_b
L_g_h2_67:
    s_waitcnt vmcnt(0)
    v_cmp_ge_u32 vcc, v12, v11
    s_nop 0
    s_ff1_i32_b64 s46, vcc
    s_lshr_b32 s46, s46, 4
    s_min_u32 s46, s46, 4
    s_add_u32 s46, s46, s54
    s_min_u32 s46, s46, s75
    v_mov_b32 v118, s46
    s_branch L_g_h2_67_b
L_g_dp_68_l:
    s_cmp_ge_u32 s62, s66
    s_cbranch_scc1 L_g_dp_68_d
    s_mov_b32 s65, 1
    s_add_u32 s47, s61, 4096
    s_mov_b32 m0, s64
    s_add_u32 s62, s62, 1
    buffer_load_dwordx4 v3, s[12:15], s61 offen offset:0 sc1 lds
    buffer_load_dwordx4 v3, s[12:15], s61 offen offset:1024 sc1 lds
    buffer_load_dwordx4 v3, s[12:15], s61 offen offset:2048 sc1 lds
    buffer_load_dwordx4 v3, s[12:15], s61 offen offset:3072 sc1 lds
    s_add_u32 m0, s64, 4096
    s_add_u32 s61, s61, s85
    buffer_load_dwordx4 v3, s[12:15], s47 offen offset:0 sc1 lds
    buffer_load_dwordx4 v3, s[12:15], s47 offen offset:1024 sc1 lds
    buffer_load_dwordx4 v3, s[12:15], s47 offen offset:2048 sc1 lds
    buffer_load_dwordx4 v3, s[12:15], s47 offen offset:3072 sc1 lds
    s_xor_b32 s64, s64, 0x10000
    s_branch L_g_dp_68_a
L_g_nw_64:
    s_waitcnt vmcnt(0) lgkmcnt(0)
    s_cmp_lg_u32 s44, 0
    s_cbranch_scc1 L_g_nl_81
    s_cmp_lt_u32 s66, s75
    s_cselect_b32 s81, 1, 2
L_g_nl_81:
    s_branch L_g_loop0_52_l
L_g_nfl_70:
    s_cmp_eq_u32 s71, 0
    s_cbranch_scc1 L_g_nfl_70_d
    v_mov_b32 v10, 1
    s_mov_b64 exec, 1
    s_waitcnt vmcnt(0)
    ds_add_rtn_u32 v10, v15, v10 offset:4
    s_waitcnt lgkmcnt(0)
    v_readfirstlane_b32 s46, v10
    s_mov_b64 exec, -1
    s_mov_b32 s71, 0
    s_sub_u32 s59, s60, 1
    s_mul_i32 s59, s59, s78
    s_add_u32 s59, s59, s74
    s_cmp_lg_u32 s46, s68
    s_cbranch_scc1 L_g_df_82
    v_mov_b32 v10, s59
    v_add_u32 v10, 1, v10
    v_mov_b32 v11, 0
    s_mov_b64 exec, 1
    buffer_store_dword v10, v11, s[12:15], s52 offen sc1
    s_mov_b64 exec, -1
L_sf_83:
L_g_df_82:
    s_add_u32 s68, s68, 4
    s_mov_b32 s65, 2
    s_branch L_g_nfl_70_d
L_g_dp_75_l:
    s_cmp_ge_u32 s62, s66
    s_cbranch_scc1 L_g_dp_75_d
    s_or_b32 s65, s65, 1
    s_add_u32 s47, s61, 4096
    s_mov_b32 m0, s64
    s_add_u32 s62, s62, 1
    buffer_load_dwordx4 v3, s[12:15], s61 offen offset:0 sc1 lds
    buffer_load_dwordx4 v3, s[12:15], s61 offen offset:1024 sc1 lds
    buffer_load_dwordx4 v3, s[12:15], s61 offen offset:2048 sc1 lds
    buffer_load_dwordx4 v3, s[12:15], s61 offen offset:3072 sc1 lds
    s_add_u32 m0, s64, 4096
    s_add_u32 s61, s61, s85
    buffer_load_dwordx4 v3, s[12:15], s47 offen offset:0 sc1 lds
    buffer_load_dwordx4 v3, s[12:15], s47 offen offset:1024 sc1 lds
    buffer_load_dwordx4 v3, s[12:15], s47 offen offset:2048 sc1 lds
    buffer_load_dwordx4 v3, s[12:15], s47 offen offset:3072 sc1 lds
    s_xor_b32 s64, s64, 0x10000
    s_branch L_g_dp_75_a
L_g_nep_71_e:
    v_mov_b32 v10, 1
    s_mov_b64 exec, 1
    s_waitcnt vmcnt(0)
    ds_add_rtn_u32 v10, v15, v10 offset:4
    s_waitcnt lgkmcnt(0)
    v_readfirstlane_b32 s46, v10
    s_mov_b64 exec, -1
    s_mov_b32 s71, 0
    s_sub_u32 s59, s60, 1
    s_mul_i32 s59, s59, s78
    s_add_u32 s59, s59, s74
    s_cmp_lg_u32 s46, s68
    s_cbranch_scc1 L_g_df_84
    v_mov_b32 v10, s59
    v_add_u32 v10, 1, v10
    v_mov_b32 v11, 0
    s_mov_b64 exec, 1
    buffer_store_dword v10, v11, s[12:15], s52 offen sc1
    s_mov_b64 exec, -1
L_sf_85:
L_g_df_84:
    s_add_u32 s68, s68, 4
    s_branch L_g_nep_71
L_g_nw1_72:
    s_cmp_eq_u32 s65, 2
    s_cbranch_scc1 L_g_nw1_72_w
    s_waitcnt vmcnt(0)
L_g_nw1_72_w:
    s_barrier
    ds_read_b128 v[32:35], v4 offset:0
    ds_read_b128 v[36:39], v4 offset:256
    ds_read_b128 v[40:43], v4 offset:2048
    ds_read_b128 v[44:47], v4 offset:2304
    ds_read_b128 v[48:51], v4 offset:4096
    ds_read_b128 v[52:55], v4 offset:4352
    ds_read_b128 v[56:59], v4 offset:6144
    ds_read_b128 v[60:63], v4 offset:6400
    s_branch L_g_jn_74
L_w_p2_9:
    s_cmp_lg_u32 s44, 0
    s_cbranch_scc1 L_w_p2_9_h
    s_mov_b32 s47, 63
    s_cmp_eq_u32 s53, 0
    s_cbranch_scc1 L_w_p2_9_q
    s_sub_u32 s52, s52, s76
    v_mov_b32 v10, 1
    v_mov_b32 v11, 131072
    s_mov_b64 exec, 1
    buffer_atomic_add v10, v11, s[12:15], s52 offen sc0
    s_waitcnt vmcnt(0)
    v_readfirstlane_b32 s46, v10
    s_mov_b64 exec, -1
    s_mov_b32 s47, 63
    s_nop 1
    s_cmp_eq_u32 s46, 0
    s_cbranch_scc1 L_w_p2_9_h
L_w_p2_9_q:
    v_mov_b32 v10, s47
    v_add_u32 v10, 1, v10
    v_mov_b32 v11, 0
    s_mov_b64 exec, 1
    buffer_store_dword v10, v11, s[12:15], s52 offen sc1
    s_mov_b64 exec, -1
L_sf_86:
L_w_p2_9_h:
    s_cmp_eq_u32 s76, 0
    s_cbranch_scc1 L_w_p2_9_m
    s_cmp_eq_u32 s79, 1
    s_cbranch_scc1 L_w_h_15
    s_mov_b32 s79, 1
    s_cmp_lt_u32 s77, 14
    s_cselect_b32 s53, 2, s53
    s_cselect_b32 s48, s48, 3
    s_branch L_w_h_15_n
L_w_p2_9_m:
    s_cmp_lt_u32 s48, 8
    s_cselect_b32 s75, 58, 58
    s_cmp_lt_u32 s48, 4
    s_cselect_b32 s75, 64, s75
L_w_p2_9_r:
    s_lshr_b32 s42, s40, 1
    s_and_b32 s43, s40, 1
    s_lshl_b32 s43, s43, 2
    s_and_b32 s46, s48, 3
    s_add_u32 s43, s43, s46
    s_cmp_lt_u32 s48, 4
    s_cbranch_scc1 L_w_wo_10
    s_cmp_lt_u32 s48, 8
    s_cbranch_scc1 L_w_f2_11
    s_cmp_lg_u32 s43, 7
    s_cbranch_scc1 L_w_f1_12
    s_mov_b32 s43, 2
    s_cmp_eq_u32 s76, 0
    s_cbranch_scc1 L_w_c_14
    s_mov_b32 s43, 7
    s_mov_b32 s78, 2
L_w_f1_12_t:
    s_cmp_lt_u32 s41, 8
    s_cselect_b32 s74, 58, 59
    s_cselect_b32 s75, 64, 64
    s_lshl_b32 s43, s43, 1
    s_add_u32 s43, s43, s74
    s_cmp_lt_u32 s43, s75
    s_cbranch_scc1 L_w_h_15_f
    s_branch L_c_done_1
L_w_f1_12_d:
    s_cmp_eq_u32 s76, 0
    s_cbranch_scc1 L_c_done_1
    s_and_b32 s42, s49, 3
    s_lshr_b32 s43, s49, 2
    s_mov_b32 s78, 64
    s_branch L_w_f1_12_t
L_replica:
    s_setprio 0
    s_barrier
    s_and_b32 s48, s41, 7
    s_add_u32 s48, s48, 4
    s_cmp_lt_u32 s41, 8
    s_cselect_b32 s74, 58, 59
    s_cselect_b32 s75, 64, 64
    s_cselect_b32 s76, 1, 2
    s_cselect_b32 s46, 58, 59
    s_cselect_b32 s47, 64, 64
    s_mov_b32 s78, 2
    s_mul_i32 s76, s76, 65536
    s_cmp_lt_u32 s48, 8
    s_cselect_b32 s74, s46, s74
    s_cselect_b32 s75, s47, s75
    s_branch L_w_p2_9_r
L_w_f1_12:
    s_load_dwordx2 s[4:5], s[0:1], 64
    s_load_dwordx2 s[6:7], s[0:1], 72
    s_and_b32 s50, s44, 3
    s_lshr_b32 s51, s44, 2
    s_waitcnt lgkmcnt(0)
    s_mov_b32 s24, s4
    s_and_b32 s25, s5, 0xffff
    s_mov_b32 s26, 0x700000
    s_mov_b32 s27, 0x00020000
    s_mul_i32 s49, s42, 7
    s_add_u32 s49, s49, s43
    v_lshrrev_b32 v3, 4, v1
    v_and_b32 v4, 15, v1
    v_lshlrev_b32 v5, 2, v3
    v_xor_b32 v4, v4, v5
    v_mul_u32_u24 v3, 7168, v3
    v_lshl_add_u32 v3, v4, 4, v3
    s_mul_i32 s46, s51, 512
    s_mul_i32 s47, s50, 16
    s_add_u32 s46, s46, s47
    s_mul_i32 s46, s46, 7168
    s_lshl_b32 s47, s49, 8
    s_add_u32 s46, s46, s47
    s_lshl_b32 s45, s51, 16
    s_mul_i32 s47, s50, 4096
    s_add_u32 s45, s45, s47
    v_bfe_u32 v4, v1, 2, 2
    v_bfe_u32 v5, v1, 4, 1
    v_lshlrev_b32 v5, 1, v5
    v_bfe_u32 v6, v1, 1, 1
    v_add_u32 v5, v5, v6
    s_lshl_b32 s47, s50, 2
    v_add_u32 v5, s47, v5
    v_lshlrev_b32 v6, 2, v4
    v_xor_b32 v5, v5, v6
    v_lshlrev_b32 v5, 4, v5
    v_lshl_add_u32 v5, v4, 8, v5
    v_bfe_u32 v6, v1, 0, 1
    v_lshl_add_u32 v5, v6, 3, v5
    v_lshrrev_b32 v6, 5, v1
    v_mul_u32_u24 v6, 2048, v6
    v_add_u32 v5, v5, v6
    s_lshl_b32 s47, s51, 16
    v_add_u32 v5, s47, v5
    s_add_u32 m0, s45, 0
    s_add_u32 s47, s46, 0x0
    buffer_load_dwordx4 v3, s[24:27], s47 offen  lds
    s_add_u32 m0, s45, 1024
    s_add_u32 s47, s46, 0x7000
    buffer_load_dwordx4 v3, s[24:27], s47 offen  lds
    s_add_u32 m0, s45, 2048
    s_add_u32 s47, s46, 0xe000
    buffer_load_dwordx4 v3, s[24:27], s47 offen  lds
    s_add_u32 m0, s45, 3072
    s_add_u32 s47, s46, 0x15000
    buffer_load_dwordx4 v3, s[24:27], s47 offen  lds
    s_add_u32 m0, s45, 16384
    s_add_u32 s47, s46, 0x70000
    buffer_load_dwordx4 v3, s[24:27], s47 offen  lds
    s_add_u32 m0, s45, 17408
    s_add_u32 s47, s46, 0x77000
    buffer_load_dwordx4 v3, s[24:27], s47 offen  lds
    s_add_u32 m0, s45, 18432
    s_add_u32 s47, s46, 0x7e000
    buffer_load_dwordx4 v3, s[24:27], s47 offen  lds
    s_add_u32 m0, s45, 19456
    s_add_u32 s47, s46, 0x85000
    buffer_load_dwordx4 v3, s[24:27], s47 offen  lds
    s_add_u32 m0, s45, 32768
    s_add_u32 s47, s46, 0xe0000
    buffer_load_dwordx4 v3, s[24:27], s47 offen  lds
    s_add_u32 m0, s45, 33792
    s_add_u32 s47, s46, 0xe7000
    buffer_load_dwordx4 v3, s[24:27], s47 offen  lds
    s_add_u32 m0, s45, 34816
    s_add_u32 s47, s46, 0xee000
    buffer_load_dwordx4 v3, s[24:27], s47 offen  lds
    s_add_u32 m0, s45, 35840
    s_add_u32 s47, s46, 0xf5000
    buffer_load_dwordx4 v3, s[24:27], s47 offen  lds
    s_add_u32 m0, s45, 49152
    s_add_u32 s47, s46, 0x150000
    buffer_load_dwordx4 v3, s[24:27], s47 offen  lds
    s_add_u32 m0, s45, 50176
    s_add_u32 s47, s46, 0x157000
    buffer_load_dwordx4 v3, s[24:27], s47 offen  lds
    s_add_u32 m0, s45, 51200
    s_add_u32 s47, s46, 0x15e000
    buffer_load_dwordx4 v3, s[24:27], s47 offen  lds
    s_add_u32 m0, s45, 52224
    s_add_u32 s47, s46, 0x165000
    buffer_load_dwordx4 v3, s[24:27], s47 offen  lds
    s_waitcnt vmcnt(12) lgkmcnt(0)
    s_barrier
    ds_read_b64_tr_b16 a[0:1], v5 offset:0
    ds_read_b64_tr_b16 a[2:3], v5 offset:1024
    ds_read_b64_tr_b16 a[4:5], v5 offset:4096
    ds_read_b64_tr_b16 a[6:7], v5 offset:5120
    ds_read_b64_tr_b16 a[8:9], v5 offset:8192
    ds_read_b64_tr_b16 a[10:11], v5 offset:9216
    ds_read_b64_tr_b16 a[12:13], v5 offset:12288
    ds_read_b64_tr_b16 a[14:15], v5 offset:13312
    s_waitcnt vmcnt(8) lgkmcnt(0)
    s_barrier
    s_add_u32 m0, s45, 0
    s_add_u32 s47, s46, 0x1c0000
    buffer_load_dwordx4 v3, s[24:27], s47 offen  lds
    s_add_u32 m0, s45, 1024
    s_add_u32 s47, s46, 0x1c7000
    buffer_load_dwordx4 v3, s[24:27], s47 offen  lds
    s_add_u32 m0, s45, 2048
    s_add_u32 s47, s46, 0x1ce000
    buffer_load_dwordx4 v3, s[24:27], s47 offen  lds
    s_add_u32 m0, s45, 3072
    s_add_u32 s47, s46, 0x1d5000
    buffer_load_dwordx4 v3, s[24:27], s47 offen  lds
    ds_read_b64_tr_b16 a[16:17], v5 offset:16384
    ds_read_b64_tr_b16 a[18:19], v5 offset:17408
    ds_read_b64_tr_b16 a[20:21], v5 offset:20480
    ds_read_b64_tr_b16 a[22:23], v5 offset:21504
    ds_read_b64_tr_b16 a[24:25], v5 offset:24576
    ds_read_b64_tr_b16 a[26:27], v5 offset:25600
    ds_read_b64_tr_b16 a[28:29], v5 offset:28672
    ds_read_b64_tr_b16 a[30:31], v5 offset:29696
    s_waitcnt vmcnt(8) lgkmcnt(0)
    s_barrier
    s_add_u32 m0, s45, 16384
    s_add_u32 s47, s46, 0x230000
    buffer_load_dwordx4 v3, s[24:27], s47 offen  lds
    s_add_u32 m0, s45, 17408
    s_add_u32 s47, s46, 0x237000
    buffer_load_dwordx4 v3, s[24:27], s47 offen  lds
    s_add_u32 m0, s45, 18432
    s_add_u32 s47, s46, 0x23e000
    buffer_load_dwordx4 v3, s[24:27], s47 offen  lds
    s_add_u32 m0, s45, 19456
    s_add_u32 s47, s46, 0x245000
    buffer_load_dwordx4 v3, s[24:27], s47 offen  lds
    ds_read_b64_tr_b16 a[32:33], v5 offset:32768
    ds_read_b64_tr_b16 a[34:35], v5 offset:33792
    ds_read_b64_tr_b16 a[36:37], v5 offset:36864
    ds_read_b64_tr_b16 a[38:39], v5 offset:37888
    ds_read_b64_tr_b16 a[40:41], v5 offset:40960
    ds_read_b64_tr_b16 a[42:43], v5 offset:41984
    ds_read_b64_tr_b16 a[44:45], v5 offset:45056
    ds_read_b64_tr_b16 a[46:47], v5 offset:46080
    s_waitcnt vmcnt(8) lgkmcnt(0)
    s_barrier
    s_add_u32 m0, s45, 32768
    s_add_u32 s47, s46, 0x2a0000
    buffer_load_dwordx4 v3, s[24:27], s47 offen  lds
    s_add_u32 m0, s45, 33792
    s_add_u32 s47, s46, 0x2a7000
    buffer_load_dwordx4 v3, s[24:27], s47 offen  lds
    s_add_u32 m0, s45, 34816
    s_add_u32 s47, s46, 0x2ae000
    buffer_load_dwordx4 v3, s[24:27], s47 offen  lds
    s_add_u32 m0, s45, 35840
    s_add_u32 s47, s46, 0x2b5000
    buffer_load_dwordx4 v3, s[24:27], s47 offen  lds
    ds_read_b64_tr_b16 a[48:49], v5 offset:49152
    ds_read_b64_tr_b16 a[50:51], v5 offset:50176
    ds_read_b64_tr_b16 a[52:53], v5 offset:53248
    ds_read_b64_tr_b16 a[54:55], v5 offset:54272
    ds_read_b64_tr_b16 a[56:57], v5 offset:57344
    ds_read_b64_tr_b16 a[58:59], v5 offset:58368
    ds_read_b64_tr_b16 a[60:61], v5 offset:61440
    ds_read_b64_tr_b16 a[62:63], v5 offset:62464
    s_waitcnt vmcnt(8) lgkmcnt(0)
    s_barrier
    s_add_u32 m0, s45, 49152
    s_add_u32 s47, s46, 0x310000
    buffer_load_dwordx4 v3, s[24:27], s47 offen  lds
    s_add_u32 m0, s45, 50176
    s_add_u32 s47, s46, 0x317000
    buffer_load_dwordx4 v3, s[24:27], s47 offen  lds
    s_add_u32 m0, s45, 51200
    s_add_u32 s47, s46, 0x31e000
    buffer_load_dwordx4 v3, s[24:27], s47 offen  lds
    s_add_u32 m0, s45, 52224
    s_add_u32 s47, s46, 0x325000
    buffer_load_dwordx4 v3, s[24:27], s47 offen  lds
    ds_read_b64_tr_b16 a[64:65], v5 offset:0
    ds_read_b64_tr_b16 a[66:67], v5 offset:1024
    ds_read_b64_tr_b16 a[68:69], v5 offset:4096
    ds_read_b64_tr_b16 a[70:71], v5 offset:5120
    ds_read_b64_tr_b16 a[72:73], v5 offset:8192
    ds_read_b64_tr_b16 a[74:75], v5 offset:9216
    ds_read_b64_tr_b16 a[76:77], v5 offset:12288
    ds_read_b64_tr_b16 a[78:79], v5 offset:13312
    s_waitcnt vmcnt(8) lgkmcnt(0)
    s_barrier
    ds_read_b64_tr_b16 a[80:81], v5 offset:16384
    ds_read_b64_tr_b16 a[82:83], v5 offset:17408
    ds_read_b64_tr_b16 a[84:85], v5 offset:20480
    ds_read_b64_tr_b16 a[86:87], v5 offset:21504
    ds_read_b64_tr_b16 a[88:89], v5 offset:24576
    ds_read_b64_tr_b16 a[90:91], v5 offset:25600
    ds_read_b64_tr_b16 a[92:93], v5 offset:28672
    ds_read_b64_tr_b16 a[94:95], v5 offset:29696
    s_waitcnt vmcnt(4) lgkmcnt(0)
    s_barrier
    ds_read_b64_tr_b16 a[96:97], v5 offset:32768
    ds_read_b64_tr_b16 a[98:99], v5 offset:33792
    ds_read_b64_tr_b16 a[100:101], v5 offset:36864
    ds_read_b64_tr_b16 a[102:103], v5 offset:37888
    ds_read_b64_tr_b16 a[104:105], v5 offset:40960
    ds_read_b64_tr_b16 a[106:107], v5 offset:41984
    ds_read_b64_tr_b16 a[108:109], v5 offset:45056
    ds_read_b64_tr_b16 a[110:111], v5 offset:46080
    s_waitcnt vmcnt(0) lgkmcnt(0)
    s_barrier
    ds_read_b64_tr_b16 a[112:113], v5 offset:49152
    ds_read_b64_tr_b16 a[114:115], v5 offset:50176
    ds_read_b64_tr_b16 a[116:117], v5 offset:53248
    ds_read_b64_tr_b16 a[118:119], v5 offset:54272
    ds_read_b64_tr_b16 a[120:121], v5 offset:57344
    ds_read_b64_tr_b16 a[122:123], v5 offset:58368
    ds_read_b64_tr_b16 a[124:125], v5 offset:61440
    ds_read_b64_tr_b16 a[126:127], v5 offset:62464
    s_waitcnt lgkmcnt(0)
    s_barrier
    v_lshlrev_b32 v2, 4, v1
    s_mul_i32 s64, s44, 8192
    s_add_u32 s46, s64, 0xc00000
    v_add_u32 v3, s46, v2
    s_mul_i32 s46, s51, 32768
    v_add_u32 v4, s46, v2
    v_and_b32 v6, 15, v1
    v_lshlrev_b32 v6, 4, v6
    v_lshrrev_b32 v7, 4, v1
    v_lshl_add_u32 v6, v7, 9, v6
    s_lshl_b32 s46, s50, 12
    s_add_u32 s46, s46, 131072
    v_add_u32 v5, s46, v2
    v_and_b32 v7, 3, v1
    v_lshlrev_b32 v7, 7, v7
    v_add_u32 v7, 0x10ec00, v7
    s_lshl_b32 s46, s49, 13
    s_lshl_b32 s47, s50, 11
    s_add_u32 s46, s46, s47
    s_add_u32 s46, s46, 0x6000000
    v_add_u32 v8, s46, v2
    s_lshl_b32 s52, s49, 7
    s_add_u32 s52, s52, 0x106400
    s_add_u32 s52, s52, s76
    s_mov_b32 s28, s6
    s_and_b32 s29, s7, 0xffff
    s_mov_b32 s30, 0x1c00
    s_mov_b32 s31, 0x00020000
    s_lshl_b32 s46, s49, 8
    s_lshl_b32 s47, s50, 6
    s_add_u32 s46, s46, s47
    v_lshrrev_b32 v9, 5, v1
    v_lshlrev_b32 v9, 3, v9
    buffer_load_dwordx2 v[32:33], v9, s[28:31], s46 offen offset:0
    buffer_load_dwordx2 v[34:35], v9, s[28:31], s46 offen offset:16
    buffer_load_dwordx2 v[36:37], v9, s[28:31], s46 offen offset:32
    buffer_load_dwordx2 v[38:39], v9, s[28:31], s46 offen offset:48
    v_add_u32 v9, 1024, v8
    s_mov_b32 s56, 0xbdd2d3e8
    s_mov_b32 s57, 0xbdd2d3e8
    v_mov_b32 v112, 0xc0135761
    s_waitcnt vmcnt(0)
    v_lshlrev_b32 v64, 16, v32
    v_and_b32 v65, 0xffff0000, v32
    v_lshlrev_b32 v66, 16, v33
    v_and_b32 v67, 0xffff0000, v33
    v_lshlrev_b32 v68, 16, v34
    v_and_b32 v69, 0xffff0000, v34
    v_lshlrev_b32 v70, 16, v35
    v_and_b32 v71, 0xffff0000, v35
    v_lshlrev_b32 v72, 16, v36
    v_and_b32 v73, 0xffff0000, v36
    v_lshlrev_b32 v74, 16, v37
    v_and_b32 v75, 0xffff0000, v37
    v_lshlrev_b32 v76, 16, v38
    v_and_b32 v77, 0xffff0000, v38
    v_lshlrev_b32 v78, 16, v39
    v_and_b32 v79, 0xffff0000, v39
    s_mul_i32 s46, s43, 8192
    s_add_u32 s46, s46, 0xc00000
    s_mul_i32 s47, s42, 0
    s_add_u32 s46, s46, s47
    v_min_u32 v116, 63, v1
    v_lshlrev_b32 v116, 7, v116
    v_add_u32 v116, s46, v116
    s_mov_b32 s60, 0
    s_mul_i32 s61, s74, 65536
    s_mov_b32 s62, 0
    s_mul_i32 s63, s74, 229376
    s_mul_i32 s85, s78, 65536
    s_mul_i32 s86, s78, 229376
    s_sub_u32 s46, s78, 1
    s_sub_u32 s75, s75, s74
    s_add_u32 s75, s75, s46
    s_lshr_b32 s75, s75, s46
    s_mov_b32 s67, 0
    s_mov_b32 s68, 3
    s_mov_b32 s71, 0
    v_mov_b32 v15, 147456
    v_mov_b32 v14, 0
    ds_write_b32 v15, v14 offset:4
    ds_write_b32 v15, v14 offset:12
    ds_write_b32 v15, v14 offset:16
    v_mov_b32 v114, 1
    v_mov_b32 v115, 0
    s_mov_b32 s81, 0
    s_mul_i32 s87, s78, 3
    s_sub_u32 s87, s74, s87
    s_add_u32 s87, s87, 1
    s_lshl_b32 s46, s44, 5
    v_add_u32 v119, s46, v15
    v_lshrrev_b32 v113, 4, v1
    v_mul_u32_u24 v113, s78, v113
    v_add_u32 v113, s74, v113
    s_mov_b32 s72, 0
L_g_restart_87:
    s_cmp_lg_u32 s44, 0
    s_cbranch_scc1 L_g_nsp_88
    s_mov_b32 s70, 0
L_g_sp_94:
    s_add_u32 s54, s60, 0
    s_mul_i32 s55, s54, s78
    v_add_u32 v12, s55, v113
    v_mul_u32_u24 v13, 171, v12
    v_lshrrev_b32 v13, 9, v13
    v_mad_i32_i24 v13, v13, -3, v12
    v_lshl_add_u32 v13, v13, 9, v7
    buffer_load_dword v11, v13, s[12:15], 0 offen sc1
    s_waitcnt vmcnt(0)
    v_cmp_ge_u32 vcc, v12, v11
    s_add_u32 s70, s70, 1
    s_and_b32 s46, vcc_lo, 0xffff
    s_cbranch_scc0 L_g_sp_94_ok
    s_sleep 3
    s_cmp_lt_u32 s70, 524288
    s_cbranch_scc1 L_g_sp_94
    s_branch L_c_done_1
L_g_sp_94_ok:
    v_cmp_ge_u32 vcc, v12, v11
    s_nop 0
    s_ff1_i32_b64 s46, vcc
    s_lshr_b32 s46, s46, 4
    s_min_u32 s46, s46, 4
    s_add_u32 s46, s46, s54
    s_min_u32 s46, s46, s75
    v_mov_b32 v118, s46
    ds_write_b32 v15, v118 offset:20
L_g_nsp_88:
    s_waitcnt lgkmcnt(0)
    s_barrier
    ds_read_b32 v14, v15 offset:20
    s_waitcnt lgkmcnt(0)
    v_readfirstlane_b32 s66, v14
    s_nop 3
L_g_restart_87_go:
    s_mov_b32 s69, 0
    s_cmp_gt_u32 s62, s60
    s_cbranch_scc1 L_g_nd_95
    s_cmp_ge_u32 s62, s66
    s_cbranch_scc1 L_g_nd_95
    s_add_u32 s47, s61, 4096
    s_add_u32 m0, s64, 0
    s_nop 0
    buffer_load_dwordx4 v3, s[12:15], s61 offen offset:0 sc1 lds
    buffer_load_dwordx4 v3, s[12:15], s61 offen offset:1024 sc1 lds
    buffer_load_dwordx4 v3, s[12:15], s61 offen offset:2048 sc1 lds
    buffer_load_dwordx4 v3, s[12:15], s61 offen offset:3072 sc1 lds
    s_add_u32 m0, s64, 4096
    s_nop 0
    buffer_load_dwordx4 v3, s[12:15], s47 offen offset:0 sc1 lds
    buffer_load_dwordx4 v3, s[12:15], s47 offen offset:1024 sc1 lds
    buffer_load_dwordx4 v3, s[12:15], s47 offen offset:2048 sc1 lds
    buffer_load_dwordx4 v3, s[12:15], s47 offen offset:3072 sc1 lds
    s_add_u32 s61, s61, s85
    s_add_u32 s62, s62, 1
    s_xor_b32 s64, s64, 0x10000
    s_mov_b32 s69, 1
L_g_nd_95:
    s_cmp_eq_u32 s51, 1
    s_cbranch_scc1 L_g_g1r_89
    s_add_u32 s59, s60, 1
    s_mov_b32 s69, 0
    s_cmp_gt_u32 s62, s59
    s_cbranch_scc1 L_g_nd_96
    s_cmp_ge_u32 s62, s66
    s_cbranch_scc1 L_g_nd_96
    s_add_u32 s47, s61, 4096
    s_add_u32 m0, s64, 0
    s_nop 0
    buffer_load_dwordx4 v3, s[12:15], s61 offen offset:0 sc1 lds
    buffer_load_dwordx4 v3, s[12:15], s61 offen offset:1024 sc1 lds
    buffer_load_dwordx4 v3, s[12:15], s61 offen offset:2048 sc1 lds
    buffer_load_dwordx4 v3, s[12:15], s61 offen offset:3072 sc1 lds
    s_add_u32 m0, s64, 4096
    s_nop 0
    buffer_load_dwordx4 v3, s[12:15], s47 offen offset:0 sc1 lds
    buffer_load_dwordx4 v3, s[12:15], s47 offen offset:1024 sc1 lds
    buffer_load_dwordx4 v3, s[12:15], s47 offen offset:2048 sc1 lds
    buffer_load_dwordx4 v3, s[12:15], s47 offen offset:3072 sc1 lds
    s_add_u32 s61, s61, s85
    s_add_u32 s62, s62, 1
    s_xor_b32 s64, s64, 0x10000
    s_mov_b32 s69, 1
L_g_nd_96:
    s_cmp_eq_u32 s69, 1
    s_cbranch_scc1 L_g_w0_97
    s_waitcnt vmcnt(0)
L_g_w0_97:
    s_waitcnt vmcnt(8)
    s_cmp_lg_u32 s44, 0
    s_cbranch_scc1 L_g_nl_98
    s_cmp_lt_u32 s66, s75
    s_cselect_b32 s81, 1, 2
L_g_nl_98:
L_g_loop0_90_l:
    s_barrier
    ds_read_b128 v[32:35], v4 offset:0
    ds_read_b128 v[36:39], v4 offset:1024
    ds_read_b128 v[40:43], v4 offset:2048
    ds_read_b128 v[44:47], v4 offset:3072
    ds_read_b128 v[48:51], v4 offset:4096
    ds_read_b128 v[52:55], v4 offset:5120
    ds_read_b128 v[56:59], v4 offset:6144
    ds_read_b128 v[60:63], v4 offset:7168
    s_branch L_g_loop0_90_m
.p2align 6
L_g_loop0_90:
    s_barrier
L_g_loop0_90_m:
    s_setprio 2
    s_waitcnt lgkmcnt(6)
    v_mfma_f32_32x32x16_bf16 v[16:31], a[0:3], v[32:35], v[64:79]
    ds_read_b128 v[32:35], v4 offset:8192
    v_mfma_f32_32x32x16_bf16 v[16:31], a[4:7], v[36:39], v[16:31]
    ds_read_b128 v[36:39], v4 offset:9216
    s_cmp_eq_u32 s81, 1
    s_cbranch_scc1 L_g_h1_102
L_g_h1_102_b:
    s_waitcnt lgkmcnt(6)
    v_mfma_f32_32x32x16_bf16 v[16:31], a[8:11], v[40:43], v[16:31]
    ds_read_b128 v[40:43], v4 offset:10240
    v_mfma_f32_32x32x16_bf16 v[16:31], a[12:15], v[44:47], v[16:31]
    ds_read_b128 v[44:47], v4 offset:11264
    s_waitcnt lgkmcnt(6)
    v_mfma_f32_32x32x16_bf16 v[16:31], a[16:19], v[48:51], v[16:31]
    ds_read_b128 v[48:51], v4 offset:12288
    v_mfma_f32_32x32x16_bf16 v[16:31], a[20:23], v[52:55], v[16:31]
    ds_read_b128 v[52:55], v4 offset:13312
    s_waitcnt lgkmcnt(6)
    v_mfma_f32_32x32x16_bf16 v[16:31], a[24:27], v[56:59], v[16:31]
    ds_read_b128 v[56:59], v4 offset:14336
    v_mfma_f32_32x32x16_bf16 v[16:31], a[28:31], v[60:63], v[16:31]
    ds_read_b128 v[60:63], v4 offset:15360
    s_waitcnt lgkmcnt(6)
    v_mfma_f32_32x32x16_bf16 v[16:31], a[32:35], v[32:35], v[16:31]
    ds_read_b128 v[32:35], v4 offset:16384
    v_mfma_f32_32x32x16_bf16 v[16:31], a[36:39], v[36:39], v[16:31]
    ds_read_b128 v[36:39], v4 offset:17408
    s_waitcnt lgkmcnt(6)
    v_mfma_f32_32x32x16_bf16 v[16:31], a[40:43], v[40:43], v[16:31]
    ds_read_b128 v[40:43], v4 offset:18432
    v_mfma_f32_32x32x16_bf16 v[16:31], a[44:47], v[44:47], v[16:31]
    ds_read_b128 v[44:47], v4 offset:19456
    s_waitcnt lgkmcnt(6)
    v_mfma_f32_32x32x16_bf16 v[16:31], a[48:51], v[48:51], v[16:31]
    ds_read_b128 v[48:51], v4 offset:20480
    v_mfma_f32_32x32x16_bf16 v[16:31], a[52:55], v[52:55], v[16:31]
    ds_read_b128 v[52:55], v4 offset:21504
    s_waitcnt lgkmcnt(6)
    v_mfma_f32_32x32x16_bf16 v[16:31], a[56:59], v[56:59], v[16:31]
    ds_read_b128 v[56:59], v4 offset:22528
    v_mfma_f32_32x32x16_bf16 v[16:31], a[60:63], v[60:63], v[16:31]
    ds_read_b128 v[60:63], v4 offset:23552
    s_waitcnt lgkmcnt(6)
    v_mfma_f32_32x32x16_bf16 v[16:31], a[64:67], v[32:35], v[16:31]
    ds_read_b128 v[32:35], v4 offset:24576
    v_mfma_f32_32x32x16_bf16 v[16:31], a[68:71], v[36:39], v[16:31]
    ds_read_b128 v[36:39], v4 offset:25600
    s_waitcnt lgkmcnt(6)
    v_mfma_f32_32x32x16_bf16 v[16:31], a[72:75], v[40:43], v[16:31]
    ds_read_b128 v[40:43], v4 offset:26624
    v_mfma_f32_32x32x16_bf16 v[16:31], a[76:79], v[44:47], v[16:31]
    ds_read_b128 v[44:47], v4 offset:27648
    s_waitcnt lgkmcnt(6)
    v_mfma_f32_32x32x16_bf16 v[16:31], a[80:83], v[48:51], v[16:31]
    ds_read_b128 v[48:51], v4 offset:28672
    v_mfma_f32_32x32x16_bf16 v[16:31], a[84:87], v[52:55], v[16:31]
    ds_read_b128 v[52:55], v4 offset:29696
    s_waitcnt lgkmcnt(6)
    v_mfma_f32_32x32x16_bf16 v[16:31], a[88:91], v[56:59], v[16:31]
    ds_read_b128 v[56:59], v4 offset:30720
    v_mfma_f32_32x32x16_bf16 v[16:31], a[92:95], v[60:63], v[16:31]
    ds_read_b128 v[60:63], v4 offset:31744
    s_waitcnt lgkmcnt(6)
    v_mfma_f32_32x32x16_bf16 v[16:31], a[96:99], v[32:35], v[16:31]
    v_mfma_f32_32x32x16_bf16 v[16:31], a[100:103], v[36:39], v[16:31]
    s_waitcnt lgkmcnt(4)
    v_mfma_f32_32x32x16_bf16 v[16:31], a[104:107], v[40:43], v[16:31]
    v_mfma_f32_32x32x16_bf16 v[16:31], a[108:111], v[44:47], v[16:31]
    s_waitcnt lgkmcnt(2)
    v_mfma_f32_32x32x16_bf16 v[16:31], a[112:115], v[48:51], v[16:31]
    s_cmp_eq_u32 s81, 1
    s_cbranch_scc1 L_g_h2_103
L_g_h2_103_b:
    ds_write_b32 v119, v118
    v_mfma_f32_32x32x16_bf16 v[16:31], a[116:119], v[52:55], v[16:31]
    s_waitcnt lgkmcnt(0)
    v_mfma_f32_32x32x16_bf16 v[16:31], a[120:123], v[56:59], v[16:31]
    v_mfma_f32_32x32x16_bf16 v[16:31], a[124:127], v[60:63], v[16:31]
    v_xor_b32 v4, 0x10000, v4
    s_setprio 0
    s_waitcnt vmcnt(0)
    s_waitcnt lgkmcnt(0)
    s_barrier
    ds_read_b32 v14, v15
    s_nop 6
    ds_write_b128 v5, v[16:19] offset:0
    ds_write_b128 v5, v[20:23] offset:1024
    ds_write_b128 v5, v[24:27] offset:2048
    ds_write_b128 v5, v[28:31] offset:3072
    s_waitcnt lgkmcnt(4)
    v_readfirstlane_b32 s66, v14
    s_add_u32 s60, s60, 1
    s_mov_b32 s65, 0
    s_cmp_le_u32 s62, s60
    s_cbranch_scc1 L_g_dp_104_l
L_g_dp_104_a:
    s_cmp_ge_u32 s62, s66
    s_cbranch_scc1 L_g_dp_104_d
    s_add_u32 s47, s61, 4096
    s_mov_b32 m0, s64
    s_add_u32 s62, s62, 1
    buffer_load_dwordx4 v3, s[12:15], s61 offen offset:0 sc1 lds
    buffer_load_dwordx4 v3, s[12:15], s61 offen offset:1024 sc1 lds
    buffer_load_dwordx4 v3, s[12:15], s61 offen offset:2048 sc1 lds
    buffer_load_dwordx4 v3, s[12:15], s61 offen offset:3072 sc1 lds
    s_add_u32 m0, s64, 4096
    s_add_u32 s61, s61, s85
    buffer_load_dwordx4 v3, s[12:15], s47 offen offset:0 sc1 lds
    buffer_load_dwordx4 v3, s[12:15], s47 offen offset:1024 sc1 lds
    buffer_load_dwordx4 v3, s[12:15], s47 offen offset:2048 sc1 lds
    buffer_load_dwordx4 v3, s[12:15], s47 offen offset:3072 sc1 lds
    s_xor_b32 s64, s64, 0x10000
L_g_dp_104_d:
    s_cmp_lg_u32 s44, 2
    s_cbranch_scc1 L_g_pf_105
    s_cmp_ge_u32 s62, s66
    s_cbranch_scc1 L_g_pf_105
    buffer_load_dword v117, v116, s[12:15], s61 offen sc1
L_g_pf_105:
    s_cmp_le_u32 s66, s60
    s_cbranch_scc1 L_g_ex0_101
    s_cmp_lg_u32 s65, 0
    s_cbranch_scc1 L_g_nw_100
    ds_read_b128 v[32:35], v4 offset:0
    ds_read_b128 v[36:39], v4 offset:1024
    ds_read_b128 v[40:43], v4 offset:2048
    ds_read_b128 v[44:47], v4 offset:3072
    ds_read_b128 v[48:51], v4 offset:4096
    ds_read_b128 v[52:55], v4 offset:5120
    ds_read_b128 v[56:59], v4 offset:6144
    ds_read_b128 v[60:63], v4 offset:7168
    s_cmp_lg_u32 s44, 0
    s_cbranch_scc1 L_g_nl_106
    s_mov_b32 s46, s66
    s_cmp_lg_u32 s81, 0
    s_cbranch_scc1 L_g_nl_106_e
    v_cmp_ge_u32 vcc, v12, v11
    s_nop 0
    s_ff1_i32_b64 s46, vcc
    s_lshr_b32 s46, s46, 4
    s_min_u32 s46, s46, 4
    s_add_u32 s46, s46, s54
    s_min_u32 s46, s46, s75
    v_mov_b32 v118, s46
L_g_nl_106_e:
    s_add_u32 s47, s60, 3
    s_min_u32 s47, s47, s75
    s_cmp_lt_u32 s46, s47
    s_cselect_b32 s81, 1, 0
    s_cbranch_scc1 L_g_nl_106
    s_add_u32 s54, s60, 2
    s_mul_i32 s55, s54, s78
    v_add_u32 v12, s55, v113
    v_mul_u32_u24 v13, 171, v12
    v_lshrrev_b32 v13, 9, v13
    v_mad_i32_i24 v13, v13, -3, v12
    v_lshl_add_u32 v13, v13, 9, v7
    buffer_load_dword v11, v13, s[12:15], 0 offen sc1
L_g_nl_106:
    s_waitcnt lgkmcnt(8)
    s_branch L_g_loop0_90
L_g_ex0_101:
    s_cmp_lg_u32 s44, 0
    s_cbranch_scc1 L_g_ex0_101_n
    ds_write_b32 v15, v118 offset:20
    s_cmp_ge_u32 s60, s75
    s_cbranch_scc1 L_g_ex0_101_n
    s_sleep 6
    s_add_u32 s54, s60, 0
    s_mul_i32 s55, s54, s78
    v_add_u32 v12, s55, v113
    v_mul_u32_u24 v13, 171, v12
    v_lshrrev_b32 v13, 9, v13
    v_mad_i32_i24 v13, v13, -3, v12
    v_lshl_add_u32 v13, v13, 9, v7
    buffer_load_dword v11, v13, s[12:15], 0 offen sc1
    s_waitcnt vmcnt(0)
    v_cmp_ge_u32 vcc, v12, v11
    s_nop 0
    s_ff1_i32_b64 s46, vcc
    s_lshr_b32 s46, s46, 4
    s_min_u32 s46, s46, 4
    s_add_u32 s46, s46, s54
    s_min_u32 s46, s46, s75
    v_mov_b32 v118, s46
    ds_write_b32 v15, v118 offset:20
L_g_ex0_101_n:
    s_waitcnt lgkmcnt(0)
    s_barrier
    ds_read_b32 v14, v15 offset:20
    s_waitcnt lgkmcnt(0)
    v_readfirstlane_b32 s66, v14
    s_barrier
    s_cmp_gt_u32 s66, s60
    s_cbranch_scc1 L_g_restart_87_go
    s_branch L_g_tail_92
L_g_g1r_89:
    s_mov_b32 s65, 1
    s_branch L_g_loop1_91_e
.p2align 6
L_g_loop1_91:
    s_mov_b32 s65, 0
L_g_loop1_91_e:
    s_barrier
    s_bitcmp1_b32 s67, 2
    s_cbranch_scc0 L_g_nfl_107
    s_cmp_lg_u32 s44, 4
    s_cbranch_scc1 L_g_nfl_107_d
    s_mul_i32 s59, s60, s78
    s_add_u32 s59, s59, s87
    v_mov_b32 v10, s59
    buffer_store_dword v10, v115, s[12:15], s52 offen sc1
L_g_nfl_107_d:
    ds_read_b128 v[80:83], v5 offset:0
    ds_read_b128 v[84:87], v5 offset:1024
    ds_read_b128 v[88:91], v5 offset:2048
    ds_read_b128 v[92:95], v5 offset:3072
    s_cmp_le_u32 s62, s60
    s_cbranch_scc1 L_g_dp_112_l
L_g_dp_112_a:
    s_cmp_ge_u32 s62, s66
    s_cbranch_scc1 L_g_dp_112_d
    s_add_u32 s47, s61, 4096
    s_mov_b32 m0, s64
    s_add_u32 s62, s62, 1
    buffer_load_dwordx4 v3, s[12:15], s61 offen offset:0 sc1 lds
    buffer_load_dwordx4 v3, s[12:15], s61 offen offset:1024 sc1 lds
    buffer_load_dwordx4 v3, s[12:15], s61 offen offset:2048 sc1 lds
    buffer_load_dwordx4 v3, s[12:15], s61 offen offset:3072 sc1 lds
    s_add_u32 m0, s64, 4096
    s_add_u32 s61, s61, s85
    buffer_load_dwordx4 v3, s[12:15], s47 offen offset:0 sc1 lds
    buffer_load_dwordx4 v3, s[12:15], s47 offen offset:1024 sc1 lds
    buffer_load_dwordx4 v3, s[12:15], s47 offen offset:2048 sc1 lds
    buffer_load_dwordx4 v3, s[12:15], s47 offen offset:3072 sc1 lds
    s_xor_b32 s64, s64, 0x10000
L_g_dp_112_d:
    s_bitcmp1_b32 s67, 0
    s_cbranch_scc0 L_g_nep_108
    s_waitcnt lgkmcnt(0)
    v_add_f32 v80, v80, v16
    v_add_f32 v81, v81, v17
    v_add_f32 v82, v82, v18
    v_add_f32 v83, v83, v19
    v_add_f32 v84, v84, v20
    v_add_f32 v85, v85, v21
    v_add_f32 v86, v86, v22
    v_add_f32 v87, v87, v23
    v_add_f32 v88, v88, v24
    v_add_f32 v89, v89, v25
    v_add_f32 v90, v90, v26
    v_add_f32 v91, v91, v27
    v_add_f32 v92, v92, v28
    v_add_f32 v93, v93, v29
    v_add_f32 v94, v94, v30
    v_add_f32 v95, v95, v31
L_g_nep_108:
    v_mul_f32 v96, v80, v80
    v_mul_f32 v97, v81, v81
    v_mul_f32 v98, v82, v82
    v_mul_f32 v99, v83, v83
    v_mul_f32 v100, v84, v84
    v_mul_f32 v101, v85, v85
    v_mul_f32 v102, v86, v86
    v_mul_f32 v103, v87, v87
    v_fma_f32 v96, v96, s56, v112
    v_fma_f32 v97, v97, s56, v112
    v_fma_f32 v98, v98, s56, v112
    v_fma_f32 v99, v99, s56, v112
    v_fma_f32 v100, v100, s56, v112
    v_fma_f32 v101, v101, s56, v112
    v_fma_f32 v102, v102, s56, v112
    v_fma_f32 v103, v103, s56, v112
    v_mul_f32 v96, v96, v80
    v_mul_f32 v97, v97, v81
    v_mul_f32 v98, v98, v82
    v_mul_f32 v99, v99, v83
    v_mul_f32 v100, v100, v84
    v_mul_f32 v101, v101, v85
    v_mul_f32 v102, v102, v86
    v_mul_f32 v103, v103, v87
    v_exp_f32 v96, v96
    v_exp_f32 v97, v97
    v_exp_f32 v98, v98
    v_exp_f32 v99, v99
    v_exp_f32 v100, v100
    v_exp_f32 v101, v101
    v_exp_f32 v102, v102
    v_exp_f32 v103, v103
    v_add_f32 v96, 1.0, v96
    v_add_f32 v97, 1.0, v97
    v_add_f32 v98, 1.0, v98
    v_add_f32 v99, 1.0, v99
    v_add_f32 v100, 1.0, v100
    v_add_f32 v101, 1.0, v101
    v_add_f32 v102, 1.0, v102
    v_add_f32 v103, 1.0, v103
    v_rcp_f32 v96, v96
    v_rcp_f32 v97, v97
    v_rcp_f32 v98, v98
    v_rcp_f32 v99, v99
    v_rcp_f32 v100, v100
    v_rcp_f32 v101, v101
    v_rcp_f32 v102, v102
    v_rcp_f32 v103, v103
    v_mul_f32 v80, v80, v96
    v_mul_f32 v81, v81, v97
    s_cmp_lg_u32 s65, 0
    s_cbranch_scc1 L_g_nw1_109
    ds_read_b128 v[32:35], v4 offset:0
    ds_read_b128 v[36:39], v4 offset:1024
    ds_read_b128 v[40:43], v4 offset:2048
    ds_read_b128 v[44:47], v4 offset:3072
    ds_read_b128 v[48:51], v4 offset:4096
    ds_read_b128 v[52:55], v4 offset:5120
    ds_read_b128 v[56:59], v4 offset:6144
    ds_read_b128 v[60:63], v4 offset:7168
    s_barrier
L_g_jn_111:
    s_bitcmp1_b32 s67, 0
    s_cbranch_scc0 L_g_mm2_110
    s_setprio 1
    s_waitcnt lgkmcnt(6)
    v_mfma_f32_32x32x16_bf16 v[16:31], a[0:3], v[32:35], 0
    ds_read_b128 v[32:35], v4 offset:8192
    ds_read_b32 v14, v15
    v_mul_f32 v82, v82, v98
    v_mul_f32 v83, v83, v99
    v_mul_f32 v84, v84, v100
    v_mfma_f32_32x32x16_bf16 v[16:31], a[4:7], v[36:39], v[16:31]
    ds_read_b128 v[36:39], v4 offset:9216
    v_mul_f32 v85, v85, v101
    v_mul_f32 v86, v86, v102
    v_mul_f32 v87, v87, v103
    v_cvt_pk_bf16_f32 v104, v80, v81
    s_waitcnt lgkmcnt(6)
    v_mfma_f32_32x32x16_bf16 v[16:31], a[8:11], v[40:43], v[16:31]
    ds_read_b128 v[40:43], v4 offset:10240
    v_cvt_pk_bf16_f32 v105, v82, v83
    v_cvt_pk_bf16_f32 v106, v84, v85
    v_cvt_pk_bf16_f32 v107, v86, v87
    buffer_store_dwordx4 v[104:107], v8, s[12:15], s63 offen sc1
    v_mfma_f32_32x32x16_bf16 v[16:31], a[12:15], v[44:47], v[16:31]
    ds_read_b128 v[44:47], v4 offset:11264
    v_mul_f32 v96, v88, v88
    v_mul_f32 v97, v89, v89
    v_mul_f32 v98, v90, v90
    v_mul_f32 v99, v91, v91
    s_waitcnt lgkmcnt(6)
    v_mfma_f32_32x32x16_bf16 v[16:31], a[16:19], v[48:51], v[16:31]
    ds_read_b128 v[48:51], v4 offset:12288
    v_mul_f32 v100, v92, v92
    v_mul_f32 v101, v93, v93
    v_mul_f32 v102, v94, v94
    v_mul_f32 v103, v95, v95
    v_mfma_f32_32x32x16_bf16 v[16:31], a[20:23], v[52:55], v[16:31]
    ds_read_b128 v[52:55], v4 offset:13312
    v_fma_f32 v96, v96, s56, v112
    v_fma_f32 v97, v97, s56, v112
    v_fma_f32 v98, v98, s56, v112
    v_fma_f32 v99, v99, s56, v112
    s_waitcnt lgkmcnt(6)
    v_mfma_f32_32x32x16_bf16 v[16:31], a[24:27], v[56:59], v[16:31]
    ds_read_b128 v[56:59], v4 offset:14336
    v_fma_f32 v100, v100, s56, v112
    v_fma_f32 v101, v101, s56, v112
    v_fma_f32 v102, v102, s56, v112
    v_fma_f32 v103, v103, s56, v112
    v_mfma_f32_32x32x16_bf16 v[16:31], a[28:31], v[60:63], v[16:31]
    ds_read_b128 v[60:63], v4 offset:15360
    v_mul_f32 v96, v96, v88
    v_mul_f32 v97, v97, v89
    v_mul_f32 v98, v98, v90
    v_mul_f32 v99, v99, v91
    s_waitcnt lgkmcnt(6)
    v_mfma_f32_32x32x16_bf16 v[16:31], a[32:35], v[32:35], v[16:31]
    ds_read_b128 v[32:35], v4 offset:16384
    v_mul_f32 v100, v100, v92
    v_mul_f32 v101, v101, v93
    v_mul_f32 v102, v102, v94
    v_mul_f32 v103, v103, v95
    v_mfma_f32_32x32x16_bf16 v[16:31], a[36:39], v[36:39], v[16:31]
    ds_read_b128 v[36:39], v4 offset:17408
    v_exp_f32 v96, v96
    v_exp_f32 v97, v97
    s_waitcnt lgkmcnt(6)
    v_mfma_f32_32x32x16_bf16 v[16:31], a[40:43], v[40:43], v[16:31]
    ds_read_b128 v[40:43], v4 offset:18432
    v_exp_f32 v98, v98
    v_exp_f32 v99, v99
    v_mfma_f32_32x32x16_bf16 v[16:31], a[44:47], v[44:47], v[16:31]
    ds_read_b128 v[44:47], v4 offset:19456
    v_exp_f32 v100, v100
    v_exp_f32 v101, v101
    s_waitcnt lgkmcnt(6)
    v_mfma_f32_32x32x16_bf16 v[16:31], a[48:51], v[48:51], v[16:31]
    ds_read_b128 v[48:51], v4 offset:20480
    v_exp_f32 v102, v102
    v_exp_f32 v103, v103
    v_mfma_f32_32x32x16_bf16 v[16:31], a[52:55], v[52:55], v[16:31]
    ds_read_b128 v[52:55], v4 offset:21504
    v_add_f32 v96, 1.0, v96
    v_add_f32 v97, 1.0, v97
    v_add_f32 v98, 1.0, v98
    v_add_f32 v99, 1.0, v99
    s_waitcnt lgkmcnt(6)
    v_mfma_f32_32x32x16_bf16 v[16:31], a[56:59], v[56:59], v[16:31]
    ds_read_b128 v[56:59], v4 offset:22528
    v_add_f32 v100, 1.0, v100
    v_add_f32 v101, 1.0, v101
    v_add_f32 v102, 1.0, v102
    v_add_f32 v103, 1.0, v103
    v_mfma_f32_32x32x16_bf16 v[16:31], a[60:63], v[60:63], v[16:31]
    ds_read_b128 v[60:63], v4 offset:23552
    v_rcp_f32 v96, v96
    v_rcp_f32 v97, v97
    s_waitcnt lgkmcnt(6)
    v_mfma_f32_32x32x16_bf16 v[16:31], a[64:67], v[32:35], v[16:31]
    ds_read_b128 v[32:35], v4 offset:24576
    v_rcp_f32 v98, v98
    v_rcp_f32 v99, v99
    v_mfma_f32_32x32x16_bf16 v[16:31], a[68:71], v[36:39], v[16:31]
    ds_read_b128 v[36:39], v4 offset:25600
    v_rcp_f32 v100, v100
    v_rcp_f32 v101, v101
    s_waitcnt lgkmcnt(6)
    v_mfma_f32_32x32x16_bf16 v[16:31], a[72:75], v[40:43], v[16:31]
    ds_read_b128 v[40:43], v4 offset:26624
    v_rcp_f32 v102, v102
    v_rcp_f32 v103, v103
    v_mfma_f32_32x32x16_bf16 v[16:31], a[76:79], v[44:47], v[16:31]
    ds_read_b128 v[44:47], v4 offset:27648
    v_mul_f32 v88, v88, v96
    v_mul_f32 v89, v89, v97
    v_mul_f32 v90, v90, v98
    v_mul_f32 v91, v91, v99
    s_waitcnt lgkmcnt(6)
    v_mfma_f32_32x32x16_bf16 v[16:31], a[80:83], v[48:51], v[16:31]
    ds_read_b128 v[48:51], v4 offset:28672
    v_mul_f32 v92, v92, v100
    v_mul_f32 v93, v93, v101
    v_mul_f32 v94, v94, v102
    v_mul_f32 v95, v95, v103
    v_mfma_f32_32x32x16_bf16 v[16:31], a[84:87], v[52:55], v[16:31]
    ds_read_b128 v[52:55], v4 offset:29696
    v_cvt_pk_bf16_f32 v108, v88, v89
    v_cvt_pk_bf16_f32 v109, v90, v91
    v_cvt_pk_bf16_f32 v110, v92, v93
    v_cvt_pk_bf16_f32 v111, v94, v95
    s_waitcnt lgkmcnt(6)
    v_mfma_f32_32x32x16_bf16 v[16:31], a[88:91], v[56:59], v[16:31]
    ds_read_b128 v[56:59], v4 offset:30720
    buffer_store_dwordx4 v[108:111], v9, s[12:15], s63 offen sc1
    s_add_u32 s63, s63, s86
    v_mfma_f32_32x32x16_bf16 v[16:31], a[92:95], v[60:63], v[16:31]
    ds_read_b128 v[60:63], v4 offset:31744
    s_waitcnt lgkmcnt(6)
    v_mfma_f32_32x32x16_bf16 v[16:31], a[96:99], v[32:35], v[16:31]
    v_mfma_f32_32x32x16_bf16 v[16:31], a[100:103], v[36:39], v[16:31]
    s_waitcnt lgkmcnt(4)
    v_mfma_f32_32x32x16_bf16 v[16:31], a[104:107], v[40:43], v[16:31]
    v_mfma_f32_32x32x16_bf16 v[16:31], a[108:111], v[44:47], v[16:31]
    s_waitcnt lgkmcnt(2)
    v_mfma_f32_32x32x16_bf16 v[16:31], a[112:115], v[48:51], v[16:31]
    v_mfma_f32_32x32x16_bf16 v[16:31], a[116:119], v[52:55], v[16:31]
    s_waitcnt lgkmcnt(0)
    v_mfma_f32_32x32x16_bf16 v[16:31], a[120:123], v[56:59], v[16:31]
    v_mfma_f32_32x32x16_bf16 v[16:31], a[124:127], v[60:63], v[16:31]
    v_xor_b32 v4, 0x10000, v4
    s_setprio 0
    s_waitcnt vmcnt(2)
L_g_mm2_110_d:
    v_readfirstlane_b32 s66, v14
    s_lshl_b32 s67, s67, 1
    s_or_b32 s67, s67, 1
    s_add_u32 s60, s60, 1
    s_cmp_gt_u32 s66, s60
    s_cbranch_scc1 L_g_loop1_91
    s_barrier
    ds_read_b32 v14, v15 offset:20
    ds_read_b128 v[80:83], v5 offset:0
    ds_read_b128 v[84:87], v5 offset:1024
    ds_read_b128 v[88:91], v5 offset:2048
    ds_read_b128 v[92:95], v5 offset:3072
    s_waitcnt lgkmcnt(4)
    v_readfirstlane_b32 s66, v14
    s_barrier
    s_mov_b32 s69, 0
    s_cmp_gt_u32 s62, s60
    s_cbranch_scc1 L_g_nd_113
    s_cmp_ge_u32 s62, s66
    s_cbranch_scc1 L_g_nd_113
    s_add_u32 s47, s61, 4096
    s_add_u32 m0, s64, 0
    s_nop 0
    buffer_load_dwordx4 v3, s[12:15], s61 offen offset:0 sc1 lds
    buffer_load_dwordx4 v3, s[12:15], s61 offen offset:1024 sc1 lds
    buffer_load_dwordx4 v3, s[12:15], s61 offen offset:2048 sc1 lds
    buffer_load_dwordx4 v3, s[12:15], s61 offen offset:3072 sc1 lds
    s_add_u32 m0, s64, 4096
    s_nop 0
    buffer_load_dwordx4 v3, s[12:15], s47 offen offset:0 sc1 lds
    buffer_load_dwordx4 v3, s[12:15], s47 offen offset:1024 sc1 lds
    buffer_load_dwordx4 v3, s[12:15], s47 offen offset:2048 sc1 lds
    buffer_load_dwordx4 v3, s[12:15], s47 offen offset:3072 sc1 lds
    s_add_u32 s61, s61, s85
    s_add_u32 s62, s62, 1
    s_xor_b32 s64, s64, 0x10000
    s_mov_b32 s69, 1
L_g_nd_113:
    s_waitcnt lgkmcnt(3)
    v_add_f32 v80, v80, v16
    v_add_f32 v81, v81, v17
    v_add_f32 v82, v82, v18
    v_add_f32 v83, v83, v19
    s_waitcnt lgkmcnt(2)
    v_add_f32 v84, v84, v20
    v_add_f32 v85, v85, v21
    v_add_f32 v86, v86, v22
    v_add_f32 v87, v87, v23
    s_waitcnt lgkmcnt(1)
    v_add_f32 v88, v88, v24
    v_add_f32 v89, v89, v25
    v_add_f32 v90, v90, v26
    v_add_f32 v91, v91, v27
    s_waitcnt lgkmcnt(0)
    v_add_f32 v92, v92, v28
    v_add_f32 v93, v93, v29
    v_add_f32 v94, v94, v30
    v_add_f32 v95, v95, v31
    v_mul_f32 v96, v80, v80
    v_mul_f32 v97, v81, v81
    v_mul_f32 v98, v82, v82
    v_mul_f32 v99, v83, v83
    v_mul_f32 v100, v84, v84
    v_mul_f32 v101, v85, v85
    v_mul_f32 v102, v86, v86
    v_mul_f32 v103, v87, v87
    v_fma_f32 v96, v96, s56, v112
    v_fma_f32 v97, v97, s56, v112
    v_fma_f32 v98, v98, s56, v112
    v_fma_f32 v99, v99, s56, v112
    v_fma_f32 v100, v100, s56, v112
    v_fma_f32 v101, v101, s56, v112
    v_fma_f32 v102, v102, s56, v112
    v_fma_f32 v103, v103, s56, v112
    v_mul_f32 v96, v96, v80
    v_mul_f32 v97, v97, v81
    v_mul_f32 v98, v98, v82
    v_mul_f32 v99, v99, v83
    v_mul_f32 v100, v100, v84
    v_mul_f32 v101, v101, v85
    v_mul_f32 v102, v102, v86
    v_mul_f32 v103, v103, v87
    v_exp_f32 v96, v96
    v_exp_f32 v97, v97
    v_exp_f32 v98, v98
    v_exp_f32 v99, v99
    v_exp_f32 v100, v100
    v_exp_f32 v101, v101
    v_exp_f32 v102, v102
    v_exp_f32 v103, v103
    v_add_f32 v96, 1.0, v96
    v_add_f32 v97, 1.0, v97
    v_add_f32 v98, 1.0, v98
    v_add_f32 v99, 1.0, v99
    v_add_f32 v100, 1.0, v100
    v_add_f32 v101, 1.0, v101
    v_add_f32 v102, 1.0, v102
    v_add_f32 v103, 1.0, v103
    v_rcp_f32 v96, v96
    v_rcp_f32 v97, v97
    v_rcp_f32 v98, v98
    v_rcp_f32 v99, v99
    v_rcp_f32 v100, v100
    v_rcp_f32 v101, v101
    v_rcp_f32 v102, v102
    v_rcp_f32 v103, v103
    v_mul_f32 v80, v80, v96
    v_mul_f32 v81, v81, v97
    v_mul_f32 v82, v82, v98
    v_mul_f32 v83, v83, v99
    v_mul_f32 v84, v84, v100
    v_mul_f32 v85, v85, v101
    v_mul_f32 v86, v86, v102
    v_mul_f32 v87, v87, v103
    v_cvt_pk_bf16_f32 v104, v80, v81
    v_cvt_pk_bf16_f32 v105, v82, v83
    v_cvt_pk_bf16_f32 v106, v84, v85
    v_cvt_pk_bf16_f32 v107, v86, v87
    buffer_store_dwordx4 v[104:107], v8, s[12:15], s63 offen sc1
    v_mul_f32 v96, v88, v88
    v_mul_f32 v97, v89, v89
    v_mul_f32 v98, v90, v90
    v_mul_f32 v99, v91, v91
    v_mul_f32 v100, v92, v92
    v_mul_f32 v101, v93, v93
    v_mul_f32 v102, v94, v94
    v_mul_f32 v103, v95, v95
    v_fma_f32 v96, v96, s56, v112
    v_fma_f32 v97, v97, s56, v112
    v_fma_f32 v98, v98, s56, v112
    v_fma_f32 v99, v99, s56, v112
    v_fma_f32 v100, v100, s56, v112
    v_fma_f32 v101, v101, s56, v112
    v_fma_f32 v102, v102, s56, v112
    v_fma_f32 v103, v103, s56, v112
    v_mul_f32 v96, v96, v88
    v_mul_f32 v97, v97, v89
    v_mul_f32 v98, v98, v90
    v_mul_f32 v99, v99, v91
    v_mul_f32 v100, v100, v92
    v_mul_f32 v101, v101, v93
    v_mul_f32 v102, v102, v94
    v_mul_f32 v103, v103, v95
    v_exp_f32 v96, v96
    v_exp_f32 v97, v97
    v_exp_f32 v98, v98
    v_exp_f32 v99, v99
    v_exp_f32 v100, v100
    v_exp_f32 v101, v101
    v_exp_f32 v102, v102
    v_exp_f32 v103, v103
    v_add_f32 v96, 1.0, v96
    v_add_f32 v97, 1.0, v97
    v_add_f32 v98, 1.0, v98
    v_add_f32 v99, 1.0, v99
    v_add_f32 v100, 1.0, v100
    v_add_f32 v101, 1.0, v101
    v_add_f32 v102, 1.0, v102
    v_add_f32 v103, 1.0, v103
    v_rcp_f32 v96, v96
    v_rcp_f32 v97, v97
    v_rcp_f32 v98, v98
    v_rcp_f32 v99, v99
    v_rcp_f32 v100, v100
    v_rcp_f32 v101, v101
    v_rcp_f32 v102, v102
    v_rcp_f32 v103, v103
    v_mul_f32 v88, v88, v96
    v_mul_f32 v89, v89, v97
    v_mul_f32 v90, v90, v98
    v_mul_f32 v91, v91, v99
    v_mul_f32 v92, v92, v100
    v_mul_f32 v93, v93, v101
    v_mul_f32 v94, v94, v102
    v_mul_f32 v95, v95, v103
    v_cvt_pk_bf16_f32 v108, v88, v89
    v_cvt_pk_bf16_f32 v109, v90, v91
    v_cvt_pk_bf16_f32 v110, v92, v93
    v_cvt_pk_bf16_f32 v111, v94, v95
    buffer_store_dwordx4 v[108:111], v9, s[12:15], s63 offen sc1
    s_add_u32 s63, s63, s86
    s_mov_b32 s67, 0
    s_mov_b32 s71, 1
    s_cmp_gt_u32 s66, s60
    s_cbranch_scc1 L_g_g1r_89
    v_mov_b32 v10, 1
    s_mov_b64 exec, 1
    s_waitcnt vmcnt(0)
    ds_add_rtn_u32 v10, v15, v10 offset:4
    s_waitcnt lgkmcnt(0)
    v_readfirstlane_b32 s46, v10
    s_mov_b64 exec, -1
    s_mov_b32 s71, 0
    s_sub_u32 s59, s60, 1
    s_mul_i32 s59, s59, s78
    s_add_u32 s59, s59, s74
    s_cmp_lg_u32 s46, s68
    s_cbranch_scc1 L_g_df_114
    v_mov_b32 v10, s59
    v_add_u32 v10, 1, v10
    v_mov_b32 v11, 0
    s_mov_b64 exec, 1
    buffer_store_dword v10, v11, s[12:15], s52 offen sc1
    s_mov_b64 exec, -1
L_sf_115:
L_g_df_114:
    s_add_u32 s68, s68, 4
    s_cmp_gt_u32 s66, s60
    s_cbranch_scc1 L_g_g1r_89
L_g_tail_92:
    s_cmp_lt_u32 s60, s75
    s_cbranch_scc1 L_g_restart_87
    s_waitcnt vmcnt(0)
    s_barrier
    s_branch L_w_f1_12_d
L_g_h1_102:
    s_add_u32 s54, s60, 1
    s_mul_i32 s55, s54, s78
    v_add_u32 v12, s55, v113
    v_mul_u32_u24 v13, 171, v12
    v_lshrrev_b32 v13, 9, v13
    v_mad_i32_i24 v13, v13, -3, v12
    v_lshl_add_u32 v13, v13, 9, v7
    buffer_load_dword v11, v13, s[12:15], 0 offen sc1
    s_branch L_g_h1_102_b
L_g_h2_103:
    s_waitcnt vmcnt(0)
    v_cmp_ge_u32 vcc, v12, v11
    s_nop 0
    s_ff1_i32_b64 s46, vcc
    s_lshr_b32 s46, s46, 4
    s_min_u32 s46, s46, 4
    s_add_u32 s46, s46, s54
    s_min_u32 s46, s46, s75
    v_mov_b32 v118, s46
    s_branch L_g_h2_103_b
L_g_dp_104_l:
    s_cmp_ge_u32 s62, s66
    s_cbranch_scc1 L_g_dp_104_d
    s_mov_b32 s65, 1
    s_add_u32 s47, s61, 4096
    s_mov_b32 m0, s64
    s_add_u32 s62, s62, 1
    buffer_load_dwordx4 v3, s[12:15], s61 offen offset:0 sc1 lds
    buffer_load_dwordx4 v3, s[12:15], s61 offen offset:1024 sc1 lds
    buffer_load_dwordx4 v3, s[12:15], s61 offen offset:2048 sc1 lds
    buffer_load_dwordx4 v3, s[12:15], s61 offen offset:3072 sc1 lds
    s_add_u32 m0, s64, 4096
    s_add_u32 s61, s61, s85
    buffer_load_dwordx4 v3, s[12:15], s47 offen offset:0 sc1 lds
    buffer_load_dwordx4 v3, s[12:15], s47 offen offset:1024 sc1 lds
    buffer_load_dwordx4 v3, s[12:15], s47 offen offset:2048 sc1 lds
    buffer_load_dwordx4 v3, s[12:15], s47 offen offset:3072 sc1 lds
    s_xor_b32 s64, s64, 0x10000
    s_branch L_g_dp_104_a
L_g_nw_100:
    s_waitcnt vmcnt(0) lgkmcnt(0)
    s_cmp_lg_u32 s44, 0
    s_cbranch_scc1 L_g_nl_116
    s_cmp_lt_u32 s66, s75
    s_cselect_b32 s81, 1, 2
L_g_nl_116:
    s_branch L_g_loop0_90_l
L_g_nfl_107:
    s_cmp_eq_u32 s71, 0
    s_cbranch_scc1 L_g_nfl_107_d
    v_mov_b32 v10, 1
    s_mov_b64 exec, 1
    s_waitcnt vmcnt(0)
    ds_add_rtn_u32 v10, v15, v10 offset:4
    s_waitcnt lgkmcnt(0)
    v_readfirstlane_b32 s46, v10
    s_mov_b64 exec, -1
    s_mov_b32 s71, 0
    s_sub_u32 s59, s60, 1
    s_mul_i32 s59, s59, s78
    s_add_u32 s59, s59, s74
    s_cmp_lg_u32 s46, s68
    s_cbranch_scc1 L_g_df_117
    v_mov_b32 v10, s59
    v_add_u32 v10, 1, v10
    v_mov_b32 v11, 0
    s_mov_b64 exec, 1
    buffer_store_dword v10, v11, s[12:15], s52 offen sc1
    s_mov_b64 exec, -1
L_sf_118:
L_g_df_117:
    s_add_u32 s68, s68, 4
    s_mov_b32 s65, 2
    s_branch L_g_nfl_107_d
L_g_dp_112_l:
    s_cmp_ge_u32 s62, s66
    s_cbranch_scc1 L_g_dp_112_d
    s_or_b32 s65, s65, 1
    s_add_u32 s47, s61, 4096
    s_mov_b32 m0, s64
    s_add_u32 s62, s62, 1
    buffer_load_dwordx4 v3, s[12:15], s61 offen offset:0 sc1 lds
    buffer_load_dwordx4 v3, s[12:15], s61 offen offset:1024 sc1 lds
    buffer_load_dwordx4 v3, s[12:15], s61 offen offset:2048 sc1 lds
    buffer_load_dwordx4 v3, s[12:15], s61 offen offset:3072 sc1 lds
    s_add_u32 m0, s64, 4096
    s_add_u32 s61, s61, s85
    buffer_load_dwordx4 v3, s[12:15], s47 offen offset:0 sc1 lds
    buffer_load_dwordx4 v3, s[12:15], s47 offen offset:1024 sc1 lds
    buffer_load_dwordx4 v3, s[12:15], s47 offen offset:2048 sc1 lds
    buffer_load_dwordx4 v3, s[12:15], s47 offen offset:3072 sc1 lds
    s_xor_b32 s64, s64, 0x10000
    s_branch L_g_dp_112_a
L_g_nw1_109:
    s_cmp_eq_u32 s65, 2
    s_cbranch_scc1 L_g_nw1_109_w
    s_waitcnt vmcnt(0)
L_g_nw1_109_w:
    s_barrier
    ds_read_b128 v[32:35], v4 offset:0
    ds_read_b128 v[36:39], v4 offset:1024
    ds_read_b128 v[40:43], v4 offset:2048
    ds_read_b128 v[44:47], v4 offset:3072
    ds_read_b128 v[48:51], v4 offset:4096
    ds_read_b128 v[52:55], v4 offset:5120
    ds_read_b128 v[56:59], v4 offset:6144
    ds_read_b128 v[60:63], v4 offset:7168
    s_branch L_g_jn_111
L_g_mm2_110:
    s_setprio 1
    s_waitcnt lgkmcnt(6)
    v_mfma_f32_32x32x16_bf16 v[16:31], a[0:3], v[32:35], 0
    ds_read_b128 v[32:35], v4 offset:8192
    ds_read_b32 v14, v15
    v_mfma_f32_32x32x16_bf16 v[16:31], a[4:7], v[36:39], v[16:31]
    ds_read_b128 v[36:39], v4 offset:9216
    s_waitcnt lgkmcnt(6)
    v_mfma_f32_32x32x16_bf16 v[16:31], a[8:11], v[40:43], v[16:31]
    ds_read_b128 v[40:43], v4 offset:10240
    v_mfma_f32_32x32x16_bf16 v[16:31], a[12:15], v[44:47], v[16:31]
    ds_read_b128 v[44:47], v4 offset:11264
    s_waitcnt lgkmcnt(6)
    v_mfma_f32_32x32x16_bf16 v[16:31], a[16:19], v[48:51], v[16:31]
    ds_read_b128 v[48:51], v4 offset:12288
    v_mfma_f32_32x32x16_bf16 v[16:31], a[20:23], v[52:55], v[16:31]
    ds_read_b128 v[52:55], v4 offset:13312
    s_waitcnt lgkmcnt(6)
    v_mfma_f32_32x32x16_bf16 v[16:31], a[24:27], v[56:59], v[16:31]
    ds_read_b128 v[56:59], v4 offset:14336
    v_mfma_f32_32x32x16_bf16 v[16:31], a[28:31], v[60:63], v[16:31]
    ds_read_b128 v[60:63], v4 offset:15360
    s_waitcnt lgkmcnt(6)
    v_mfma_f32_32x32x16_bf16 v[16:31], a[32:35], v[32:35], v[16:31]
    ds_read_b128 v[32:35], v4 offset:16384
    v_mfma_f32_32x32x16_bf16 v[16:31], a[36:39], v[36:39], v[16:31]
    ds_read_b128 v[36:39], v4 offset:17408
    s_waitcnt lgkmcnt(6)
    v_mfma_f32_32x32x16_bf16 v[16:31], a[40:43], v[40:43], v[16:31]
    ds_read_b128 v[40:43], v4 offset:18432
    v_mfma_f32_32x32x16_bf16 v[16:31], a[44:47], v[44:47], v[16:31]
    ds_read_b128 v[44:47], v4 offset:19456
    s_waitcnt lgkmcnt(6)
    v_mfma_f32_32x32x16_bf16 v[16:31], a[48:51], v[48:51], v[16:31]
    ds_read_b128 v[48:51], v4 offset:20480
    v_mfma_f32_32x32x16_bf16 v[16:31], a[52:55], v[52:55], v[16:31]
    ds_read_b128 v[52:55], v4 offset:21504
    s_waitcnt lgkmcnt(6)
    v_mfma_f32_32x32x16_bf16 v[16:31], a[56:59], v[56:59], v[16:31]
    ds_read_b128 v[56:59], v4 offset:22528
    v_mfma_f32_32x32x16_bf16 v[16:31], a[60:63], v[60:63], v[16:31]
    ds_read_b128 v[60:63], v4 offset:23552
    s_waitcnt lgkmcnt(6)
    v_mfma_f32_32x32x16_bf16 v[16:31], a[64:67], v[32:35], v[16:31]
    ds_read_b128 v[32:35], v4 offset:24576
    v_mfma_f32_32x32x16_bf16 v[16:31], a[68:71], v[36:39], v[16:31]
    ds_read_b128 v[36:39], v4 offset:25600
    s_waitcnt lgkmcnt(6)
    v_mfma_f32_32x32x16_bf16 v[16:31], a[72:75], v[40:43], v[16:31]
    ds_read_b128 v[40:43], v4 offset:26624
    v_mfma_f32_32x32x16_bf16 v[16:31], a[76:79], v[44:47], v[16:31]
    ds_read_b128 v[44:47], v4 offset:27648
    s_waitcnt lgkmcnt(6)
    v_mfma_f32_32x32x16_bf16 v[16:31], a[80:83], v[48:51], v[16:31]
    ds_read_b128 v[48:51], v4 offset:28672
    v_mfma_f32_32x32x16_bf16 v[16:31], a[84:87], v[52:55], v[16:31]
    ds_read_b128 v[52:55], v4 offset:29696
    s_waitcnt lgkmcnt(6)
    v_mfma_f32_32x32x16_bf16 v[16:31], a[88:91], v[56:59], v[16:31]
    ds_read_b128 v[56:59], v4 offset:30720
    v_mfma_f32_32x32x16_bf16 v[16:31], a[92:95], v[60:63], v[16:31]
    ds_read_b128 v[60:63], v4 offset:31744
    s_waitcnt lgkmcnt(6)
    v_mfma_f32_32x32x16_bf16 v[16:31], a[96:99], v[32:35], v[16:31]
    v_mfma_f32_32x32x16_bf16 v[16:31], a[100:103], v[36:39], v[16:31]
    s_waitcnt lgkmcnt(4)
    v_mfma_f32_32x32x16_bf16 v[16:31], a[104:107], v[40:43], v[16:31]
    v_mfma_f32_32x32x16_bf16 v[16:31], a[108:111], v[44:47], v[16:31]
    s_waitcnt lgkmcnt(2)
    v_mfma_f32_32x32x16_bf16 v[16:31], a[112:115], v[48:51], v[16:31]
    v_mfma_f32_32x32x16_bf16 v[16:31], a[116:119], v[52:55], v[16:31]
    s_waitcnt lgkmcnt(0)
    v_mfma_f32_32x32x16_bf16 v[16:31], a[120:123], v[56:59], v[16:31]
    v_mfma_f32_32x32x16_bf16 v[16:31], a[124:127], v[60:63], v[16:31]
    v_xor_b32 v4, 0x10000, v4
    s_setprio 0
    s_waitcnt vmcnt(0)
    s_branch L_g_mm2_110_d
L_w_f2_11:
    s_load_dwordx2 s[4:5], s[0:1], 80
    s_load_dwordx2 s[6:7], s[0:1], 72
    s_and_b32 s50, s44, 3
    s_lshr_b32 s51, s44, 2
    s_waitcnt lgkmcnt(0)
    s_mov_b32 s24, s4
    s_and_b32 s25, s5, 0xffff
    s_mov_b32 s26, 0x700000
    s_mov_b32 s27, 0x00020000
    v_lshrrev_b32 v3, 4, v1
    v_and_b32 v4, 15, v1
    v_lshlrev_b32 v5, 2, v3
    v_xor_b32 v4, v4, v5
    v_mul_u32_u24 v3, 2048, v3
    v_lshl_add_u32 v3, v4, 4, v3
    s_mul_i32 s46, s51, 448
    s_mul_i32 s47, s50, 16
    s_add_u32 s46, s46, s47
    s_mul_i32 s47, s42, 896
    s_add_u32 s46, s46, s47
    s_mul_i32 s46, s46, 2048
    s_lshl_b32 s47, s43, 8
    s_add_u32 s46, s46, s47
    s_lshl_b32 s45, s51, 16
    s_mul_i32 s47, s50, 4096
    s_add_u32 s45, s45, s47
    v_bfe_u32 v4, v1, 2, 2
    v_bfe_u32 v5, v1, 4, 1
    v_lshlrev_b32 v5, 1, v5
    v_bfe_u32 v6, v1, 1, 1
    v_add_u32 v5, v5, v6
    s_lshl_b32 s47, s50, 2
    v_add_u32 v5, s47, v5
    v_lshlrev_b32 v6, 2, v4
    v_xor_b32 v5, v5, v6
    v_lshlrev_b32 v5, 4, v5
    v_lshl_add_u32 v5, v4, 8, v5
    v_bfe_u32 v6, v1, 0, 1
    v_lshl_add_u32 v5, v6, 3, v5
    v_lshrrev_b32 v6, 5, v1
    v_mul_u32_u24 v6, 1024, v6
    v_add_u32 v5, v5, v6
    s_lshl_b32 s47, s51, 16
    v_add_u32 v5, s47, v5
    v_bfe_u32 v4, v1, 2, 2
    v_xor_b32 v5, s50, v4
    v_lshlrev_b32 v5, 6, v5
    v_lshl_add_u32 v5, v4, 8, v5
    v_and_b32 v6, 3, v1
    v_lshl_add_u32 v5, v6, 3, v5
    v_lshrrev_b32 v6, 4, v1
    v_lshl_add_u32 v5, v6, 10, v5
    v_lshrrev_b32 v6, 5, v1
    v_lshl_add_u32 v5, v6, 11, v5
    s_lshl_b32 s47, s51, 16
    v_add_u32 v5, s47, v5
    s_add_u32 m0, s45, 0
    s_add_u32 s47, s46, 0x0
    buffer_load_dwordx4 v3, s[24:27], s47 offen nt lds
    s_add_u32 m0, s45, 1024
    s_add_u32 s47, s46, 0x2000
    buffer_load_dwordx4 v3, s[24:27], s47 offen nt lds
    s_add_u32 m0, s45, 2048
    s_add_u32 s47, s46, 0x4000
    buffer_load_dwordx4 v3, s[24:27], s47 offen nt lds
    s_add_u32 m0, s45, 3072
    s_add_u32 s47, s46, 0x6000
    buffer_load_dwordx4 v3, s[24:27], s47 offen nt lds
    s_add_u32 m0, s45, 16384
    s_add_u32 s47, s46, 0x20000
    buffer_load_dwordx4 v3, s[24:27], s47 offen nt lds
    s_add_u32 m0, s45, 17408
    s_add_u32 s47, s46, 0x22000
    buffer_load_dwordx4 v3, s[24:27], s47 offen nt lds
    s_add_u32 m0, s45, 18432
    s_add_u32 s47, s46, 0x24000
    buffer_load_dwordx4 v3, s[24:27], s47 offen nt lds
    s_add_u32 m0, s45, 19456
    s_add_u32 s47, s46, 0x26000
    buffer_load_dwordx4 v3, s[24:27], s47 offen nt lds
    s_add_u32 m0, s45, 32768
    s_add_u32 s47, s46, 0x40000
    buffer_load_dwordx4 v3, s[24:27], s47 offen nt lds
    s_add_u32 m0, s45, 33792
    s_add_u32 s47, s46, 0x42000
    buffer_load_dwordx4 v3, s[24:27], s47 offen nt lds
    s_add_u32 m0, s45, 34816
    s_add_u32 s47, s46, 0x44000
    buffer_load_dwordx4 v3, s[24:27], s47 offen nt lds
    s_add_u32 m0, s45, 35840
    s_add_u32 s47, s46, 0x46000
    buffer_load_dwordx4 v3, s[24:27], s47 offen nt lds
    s_add_u32 m0, s45, 49152
    s_add_u32 s47, s46, 0x60000
    buffer_load_dwordx4 v3, s[24:27], s47 offen nt lds
    s_add_u32 m0, s45, 50176
    s_add_u32 s47, s46, 0x62000
    buffer_load_dwordx4 v3, s[24:27], s47 offen nt lds
    s_add_u32 m0, s45, 51200
    s_add_u32 s47, s46, 0x64000
    buffer_load_dwordx4 v3, s[24:27], s47 offen nt lds
    s_add_u32 m0, s45, 52224
    s_add_u32 s47, s46, 0x66000
    buffer_load_dwordx4 v3, s[24:27], s47 offen nt lds
    s_waitcnt vmcnt(12) lgkmcnt(0)
    s_barrier
    ds_read_b64_tr_b16 a[0:1], v5 offset:0
    ds_read_b64_tr_b16 a[2:3], v5 offset:2048
    ds_read_b64_tr_b16 a[4:5], v5 offset:32
    ds_read_b64_tr_b16 a[6:7], v5 offset:2080
    ds_read_b64_tr_b16 a[8:9], v5 offset:8192
    ds_read_b64_tr_b16 a[10:11], v5 offset:10240
    ds_read_b64_tr_b16 a[12:13], v5 offset:8224
    ds_read_b64_tr_b16 a[14:15], v5 offset:10272
    s_waitcnt vmcnt(8) lgkmcnt(0)
    s_barrier
    s_add_u32 m0, s45, 0
    s_add_u32 s47, s46, 0x80000
    buffer_load_dwordx4 v3, s[24:27], s47 offen nt lds
    s_add_u32 m0, s45, 1024
    s_add_u32 s47, s46, 0x82000
    buffer_load_dwordx4 v3, s[24:27], s47 offen nt lds
    s_add_u32 m0, s45, 2048
    s_add_u32 s47, s46, 0x84000
    buffer_load_dwordx4 v3, s[24:27], s47 offen nt lds
    s_add_u32 m0, s45, 3072
    s_add_u32 s47, s46, 0x86000
    buffer_load_dwordx4 v3, s[24:27], s47 offen nt lds
    ds_read_b64_tr_b16 a[16:17], v5 offset:16384
    ds_read_b64_tr_b16 a[18:19], v5 offset:18432
    ds_read_b64_tr_b16 a[20:21], v5 offset:16416
    ds_read_b64_tr_b16 a[22:23], v5 offset:18464
    ds_read_b64_tr_b16 a[24:25], v5 offset:24576
    ds_read_b64_tr_b16 a[26:27], v5 offset:26624
    ds_read_b64_tr_b16 a[28:29], v5 offset:24608
    ds_read_b64_tr_b16 a[30:31], v5 offset:26656
    s_waitcnt vmcnt(8) lgkmcnt(0)
    s_barrier
    s_add_u32 m0, s45, 16384
    s_add_u32 s47, s46, 0xa0000
    buffer_load_dwordx4 v3, s[24:27], s47 offen nt lds
    s_add_u32 m0, s45, 17408
    s_add_u32 s47, s46, 0xa2000
    buffer_load_dwordx4 v3, s[24:27], s47 offen nt lds
    s_add_u32 m0, s45, 18432
    s_add_u32 s47, s46, 0xa4000
    buffer_load_dwordx4 v3, s[24:27], s47 offen nt lds
    s_add_u32 m0, s45, 19456
    s_add_u32 s47, s46, 0xa6000
    buffer_load_dwordx4 v3, s[24:27], s47 offen nt lds
    ds_read_b64_tr_b16 a[32:33], v5 offset:32768
    ds_read_b64_tr_b16 a[34:35], v5 offset:34816
    ds_read_b64_tr_b16 a[36:37], v5 offset:32800
    ds_read_b64_tr_b16 a[38:39], v5 offset:34848
    ds_read_b64_tr_b16 a[40:41], v5 offset:40960
    ds_read_b64_tr_b16 a[42:43], v5 offset:43008
    ds_read_b64_tr_b16 a[44:45], v5 offset:40992
    ds_read_b64_tr_b16 a[46:47], v5 offset:43040
    s_waitcnt vmcnt(8) lgkmcnt(0)
    s_barrier
    s_add_u32 m0, s45, 32768
    s_add_u32 s47, s46, 0xc0000
    buffer_load_dwordx4 v3, s[24:27], s47 offen nt lds
    s_add_u32 m0, s45, 33792
    s_add_u32 s47, s46, 0xc2000
    buffer_load_dwordx4 v3, s[24:27], s47 offen nt lds
    s_add_u32 m0, s45, 34816
    s_add_u32 s47, s46, 0xc4000
    buffer_load_dwordx4 v3, s[24:27], s47 offen nt lds
    s_add_u32 m0, s45, 35840
    s_add_u32 s47, s46, 0xc6000
    buffer_load_dwordx4 v3, s[24:27], s47 offen nt lds
    ds_read_b64_tr_b16 a[48:49], v5 offset:49152
    ds_read_b64_tr_b16 a[50:51], v5 offset:51200
    ds_read_b64_tr_b16 a[52:53], v5 offset:49184
    ds_read_b64_tr_b16 a[54:55], v5 offset:51232
    ds_read_b64_tr_b16 a[56:57], v5 offset:57344
    ds_read_b64_tr_b16 a[58:59], v5 offset:59392
    ds_read_b64_tr_b16 a[60:61], v5 offset:57376
    ds_read_b64_tr_b16 a[62:63], v5 offset:59424
    s_waitcnt vmcnt(8) lgkmcnt(0)
    s_barrier
    ds_read_b64_tr_b16 a[64:65], v5 offset:0
    ds_read_b64_tr_b16 a[66:67], v5 offset:2048
    ds_read_b64_tr_b16 a[68:69], v5 offset:32
    ds_read_b64_tr_b16 a[70:71], v5 offset:2080
    ds_read_b64_tr_b16 a[72:73], v5 offset:8192
    ds_read_b64_tr_b16 a[74:75], v5 offset:10240
    ds_read_b64_tr_b16 a[76:77], v5 offset:8224
    ds_read_b64_tr_b16 a[78:79], v5 offset:10272
    s_waitcnt vmcnt(4) lgkmcnt(0)
    s_barrier
    ds_read_b64_tr_b16 a[80:81], v5 offset:16384
    ds_read_b64_tr_b16 a[82:83], v5 offset:18432
    ds_read_b64_tr_b16 a[84:85], v5 offset:16416
    ds_read_b64_tr_b16 a[86:87], v5 offset:18464
    ds_read_b64_tr_b16 a[88:89], v5 offset:24576
    ds_read_b64_tr_b16 a[90:91], v5 offset:26624
    ds_read_b64_tr_b16 a[92:93], v5 offset:24608
    ds_read_b64_tr_b16 a[94:95], v5 offset:26656
    s_waitcnt vmcnt(0) lgkmcnt(0)
    s_barrier
    ds_read_b64_tr_b16 a[96:97], v5 offset:32768
    ds_read_b64_tr_b16 a[98:99], v5 offset:34816
    ds_read_b64_tr_b16 a[100:101], v5 offset:32800
    ds_read_b64_tr_b16 a[102:103], v5 offset:34848
    ds_read_b64_tr_b16 a[104:105], v5 offset:40960
    ds_read_b64_tr_b16 a[106:107], v5 offset:43008
    ds_read_b64_tr_b16 a[108:109], v5 offset:40992
    ds_read_b64_tr_b16 a[110:111], v5 offset:43040
    s_waitcnt lgkmcnt(0)
    s_barrier
    v_lshlrev_b32 v2, 4, v1
    s_mul_i32 s64, s44, 7168
    s_add_u32 s46, s64, 0x6000000
    s_mul_i32 s47, s42, 57344
    s_add_u32 s46, s46, s47
    v_add_u32 v3, s46, v2
    s_mul_i32 s46, s51, 28672
    v_add_u32 v4, s46, v2
    v_and_b32 v6, 15, v1
    v_lshlrev_b32 v6, 4, v6
    v_lshrrev_b32 v7, 4, v1
    v_lshl_add_u32 v6, v7, 9, v6
    v_add_u32 v4, s46, v6
    s_lshl_b32 s46, s50, 12
    s_add_u32 s46, s46, 131072
    v_add_u32 v5, s46, v2
    v_and_b32 v7, 15, v1
    v_min_u32 v7, 6, v7
    v_lshlrev_b32 v7, 7, v7
    s_mul_i32 s46, s42, 896
    s_add_u32 s46, s46, 0x106400
    v_add_u32 v7, s46, v7
    s_lshl_b32 s46, s42, 16
    s_lshl_b32 s47, s43, 11
    s_add_u32 s46, s46, s47
    s_lshl_b32 s47, s50, 9
    s_add_u32 s46, s46, s47
    s_add_u32 s46, s46, 0xb000000
    v_and_b32 v8, 31, v1
    v_lshlrev_b32 v8, 4, v8
    v_lshrrev_b32 v9, 5, v1
    v_lshl_add_u32 v8, v9, 14, v8
    v_add_u32 v8, s46, v8
    v_add_u32 v9, 0x8000, v8
    s_lshl_b32 s52, s43, 9
    s_lshl_b32 s47, s42, 7
    s_add_u32 s52, s52, s47
    s_add_u32 s52, s52, 0x108400
    s_add_u32 s52, s52, s76
    s_mul_i32 s46, s43, 7168
    s_add_u32 s46, s46, 0x6000000
    s_mul_i32 s47, s42, 57344
    s_add_u32 s46, s46, s47
    v_min_u32 v116, 55, v1
    v_lshlrev_b32 v116, 7, v116
    v_add_u32 v116, s46, v116
    s_mov_b32 s60, 0
    s_mul_i32 s61, s74, 229376
    s_mov_b32 s62, 0
    s_mul_i32 s63, s74, 262144
    s_mul_i32 s85, s78, 229376
    s_mul_i32 s86, s78, 262144
    s_sub_u32 s46, s78, 1
    s_sub_u32 s75, s75, s74
    s_add_u32 s75, s75, s46
    s_lshr_b32 s75, s75, s46
    s_mov_b32 s67, 0
    s_mov_b32 s68, 3
    s_mov_b32 s71, 0
    v_mov_b32 v15, 147456
    v_mov_b32 v14, 0
    ds_write_b32 v15, v14 offset:4
    ds_write_b32 v15, v14 offset:12
    ds_write_b32 v15, v14 offset:16
    v_mov_b32 v114, 1
    v_mov_b32 v115, 0
    s_mov_b32 s81, 0
    s_mul_i32 s87, s78, 2
    s_sub_u32 s87, s74, s87
    s_add_u32 s87, s87, 1
    s_lshl_b32 s46, s44, 5
    v_add_u32 v119, s46, v15
    v_lshrrev_b32 v113, 4, v1
    v_mul_u32_u24 v113, s78, v113
    v_add_u32 v113, s74, v113
    s_mov_b32 s72, 0
L_g_restart_119:
    s_cmp_lg_u32 s44, 0
    s_cbranch_scc1 L_g_nsp_120
    s_mov_b32 s70, 0
L_g_sp_126:
    s_add_u32 s54, s60, 0
    s_mul_i32 s55, s54, s78
    v_add_u32 v12, s55, v113
    v_subrev_u32 v13, 58, v12
    v_ashrrev_i32 v11, 31, v13
    v_and_b32 v13, 1, v13
    v_add_u32 v13, 1, v13
    v_bfi_b32 v13, v11, 0, v13
    v_lshl_add_u32 v13, v13, 16, v7
    buffer_load_dword v11, v13, s[12:15], 0 offen sc1
    s_waitcnt vmcnt(0)
    v_cmp_ge_u32 vcc, v12, v11
    s_add_u32 s70, s70, 1
    s_and_b32 s46, vcc_lo, 0xffff
    s_cbranch_scc0 L_g_sp_126_ok
    s_sleep 3
    s_cmp_lt_u32 s70, 524288
    s_cbranch_scc1 L_g_sp_126
    s_branch L_c_done_1
L_g_sp_126_ok:
    v_cmp_ge_u32 vcc, v12, v11
    s_nop 0
    s_ff1_i32_b64 s46, vcc
    s_lshr_b32 s46, s46, 4
    s_min_u32 s46, s46, 4
    s_add_u32 s46, s46, s54
    s_min_u32 s46, s46, s75
    v_mov_b32 v118, s46
    ds_write_b32 v15, v118 offset:20
L_g_nsp_120:
    s_waitcnt lgkmcnt(0)
    s_barrier
    ds_read_b32 v14, v15 offset:20
    s_waitcnt lgkmcnt(0)
    v_readfirstlane_b32 s66, v14
    s_nop 3
L_g_restart_119_go:
    s_mov_b32 s69, 0
    s_cmp_gt_u32 s62, s60
    s_cbranch_scc1 L_g_nd_127
    s_cmp_ge_u32 s62, s66
    s_cbranch_scc1 L_g_nd_127
    s_add_u32 s47, s61, 4096
    s_add_u32 m0, s64, 0
    s_nop 0
    buffer_load_dwordx4 v3, s[12:15], s61 offen offset:0 sc1 lds
    buffer_load_dwordx4 v3, s[12:15], s61 offen offset:1024 sc1 lds
    buffer_load_dwordx4 v3, s[12:15], s61 offen offset:2048 sc1 lds
    buffer_load_dwordx4 v3, s[12:15], s61 offen offset:3072 sc1 lds
    s_add_u32 m0, s64, 4096
    s_nop 0
    buffer_load_dwordx4 v3, s[12:15], s47 offen offset:0 sc1 lds
    buffer_load_dwordx4 v3, s[12:15], s47 offen offset:1024 sc1 lds
    buffer_load_dwordx4 v3, s[12:15], s47 offen offset:2048 sc1 lds
    s_add_u32 s61, s61, s85
    s_add_u32 s62, s62, 1
    s_xor_b32 s64, s64, 0x10000
    s_mov_b32 s69, 1
L_g_nd_127:
    s_cmp_eq_u32 s51, 1
    s_cbranch_scc1 L_g_g1r_121
    s_add_u32 s59, s60, 1
    s_mov_b32 s69, 0
    s_cmp_gt_u32 s62, s59
    s_cbranch_scc1 L_g_nd_128
    s_cmp_ge_u32 s62, s66
    s_cbranch_scc1 L_g_nd_128
    s_add_u32 s47, s61, 4096
    s_add_u32 m0, s64, 0
    s_nop 0
    buffer_load_dwordx4 v3, s[12:15], s61 offen offset:0 sc1 lds
    buffer_load_dwordx4 v3, s[12:15], s61 offen offset:1024 sc1 lds
    buffer_load_dwordx4 v3, s[12:15], s61 offen offset:2048 sc1 lds
    buffer_load_dwordx4 v3, s[12:15], s61 offen offset:3072 sc1 lds
    s_add_u32 m0, s64, 4096
    s_nop 0
    buffer_load_dwordx4 v3, s[12:15], s47 offen offset:0 sc1 lds
    buffer_load_dwordx4 v3, s[12:15], s47 offen offset:1024 sc1 lds
    buffer_load_dwordx4 v3, s[12:15], s47 offen offset:2048 sc1 lds
    s_add_u32 s61, s61, s85
    s_add_u32 s62, s62, 1
    s_xor_b32 s64, s64, 0x10000
    s_mov_b32 s69, 1
L_g_nd_128:
    s_cmp_eq_u32 s69, 1
    s_cbranch_scc1 L_g_w0_129
    s_waitcnt vmcnt(0)
L_g_w0_129:
    s_waitcnt vmcnt(7)
    s_cmp_lg_u32 s44, 0
    s_cbranch_scc1 L_g_nl_130
    s_cmp_lt_u32 s66, s75
    s_cselect_b32 s81, 1, 2
L_g_nl_130:
L_g_loop0_122_l:
    s_barrier
    ds_read_b128 v[32:35], v4 offset:0
    ds_read_b128 v[36:39], v4 offset:256
    ds_read_b128 v[40:43], v4 offset:2048
    ds_read_b128 v[44:47], v4 offset:2304
    ds_read_b128 v[48:51], v4 offset:4096
    ds_read_b128 v[52:55], v4 offset:4352
    ds_read_b128 v[56:59], v4 offset:6144
    ds_read_b128 v[60:63], v4 offset:6400
    s_branch L_g_loop0_122_m
.p2align 6
L_g_loop0_122:
    s_barrier
L_g_loop0_122_m:
    s_setprio 2
    s_waitcnt lgkmcnt(6)
    v_mfma_f32_16x16x32_bf16 v[16:19], v[32:35], a[0:3], 0
    v_mfma_f32_16x16x32_bf16 v[20:23], v[32:35], a[4:7], 0
    ds_read_b128 v[32:35], v4 offset:8192
    v_mfma_f32_16x16x32_bf16 v[28:31], v[36:39], a[4:7], 0
    v_mfma_f32_16x16x32_bf16 v[24:27], v[36:39], a[0:3], 0
    ds_read_b128 v[36:39], v4 offset:8448
    s_cmp_eq_u32 s81, 1
    s_cbranch_scc1 L_g_h1_134
L_g_h1_134_b:
    s_waitcnt lgkmcnt(6)
    v_mfma_f32_16x16x32_bf16 v[16:19], v[40:43], a[8:11], v[16:19]
    v_mfma_f32_16x16x32_bf16 v[20:23], v[40:43], a[12:15], v[20:23]
    ds_read_b128 v[40:43], v4 offset:10240
    v_mfma_f32_16x16x32_bf16 v[28:31], v[44:47], a[12:15], v[28:31]
    v_mfma_f32_16x16x32_bf16 v[24:27], v[44:47], a[8:11], v[24:27]
    ds_read_b128 v[44:47], v4 offset:10496
    s_waitcnt lgkmcnt(6)
    v_mfma_f32_16x16x32_bf16 v[16:19], v[48:51], a[16:19], v[16:19]
    v_mfma_f32_16x16x32_bf16 v[20:23], v[48:51], a[20:23], v[20:23]
    ds_read_b128 v[48:51], v4 offset:12288
    v_mfma_f32_16x16x32_bf16 v[28:31], v[52:55], a[20:23], v[28:31]
    v_mfma_f32_16x16x32_bf16 v[24:27], v[52:55], a[16:19], v[24:27]
    ds_read_b128 v[52:55], v4 offset:12544
    s_waitcnt lgkmcnt(6)
    v_mfma_f32_16x16x32_bf16 v[16:19], v[56:59], a[24:27], v[16:19]
    v_mfma_f32_16x16x32_bf16 v[20:23], v[56:59], a[28:31], v[20:23]
    ds_read_b128 v[56:59], v4 offset:14336
    v_mfma_f32_16x16x32_bf16 v[28:31], v[60:63], a[28:31], v[28:31]
    v_mfma_f32_16x16x32_bf16 v[24:27], v[60:63], a[24:27], v[24:27]
    ds_read_b128 v[60:63], v4 offset:14592
    s_waitcnt lgkmcnt(6)
    v_mfma_f32_16x16x32_bf16 v[16:19], v[32:35], a[32:35], v[16:19]
    v_mfma_f32_16x16x32_bf16 v[20:23], v[32:35], a[36:39], v[20:23]
    ds_read_b128 v[32:35], v4 offset:16384
    v_mfma_f32_16x16x32_bf16 v[28:31], v[36:39], a[36:39], v[28:31]
    v_mfma_f32_16x16x32_bf16 v[24:27], v[36:39], a[32:35], v[24:27]
    ds_read_b128 v[36:39], v4 offset:16640
    s_waitcnt lgkmcnt(6)
    v_mfma_f32_16x16x32_bf16 v[16:19], v[40:43], a[40:43], v[16:19]
    v_mfma_f32_16x16x32_bf16 v[20:23], v[40:43], a[44:47], v[20:23]
    ds_read_b128 v[40:43], v4 offset:18432
    v_mfma_f32_16x16x32_bf16 v[28:31], v[44:47], a[44:47], v[28:31]
    v_mfma_f32_16x16x32_bf16 v[24:27], v[44:47], a[40:43], v[24:27]
    ds_read_b128 v[44:47], v4 offset:18688
    s_waitcnt lgkmcnt(6)
    v_mfma_f32_16x16x32_bf16 v[16:19], v[48:51], a[48:51], v[16:19]
    v_mfma_f32_16x16x32_bf16 v[20:23], v[48:51], a[52:55], v[20:23]
    ds_read_b128 v[48:51], v4 offset:20480
    v_mfma_f32_16x16x32_bf16 v[28:31], v[52:55], a[52:55], v[28:31]
    v_mfma_f32_16x16x32_bf16 v[24:27], v[52:55], a[48:51], v[24:27]
    ds_read_b128 v[52:55], v4 offset:20736
    s_waitcnt lgkmcnt(6)
    v_mfma_f32_16x16x32_bf16 v[16:19], v[56:59], a[56:59], v[16:19]
    v_mfma_f32_16x16x32_bf16 v[20:23], v[56:59], a[60:63], v[20:23]
    ds_read_b128 v[56:59], v4 offset:22528
    v_mfma_f32_16x16x32_bf16 v[28:31], v[60:63], a[60:63], v[28:31]
    v_mfma_f32_16x16x32_bf16 v[24:27], v[60:63], a[56:59], v[24:27]
    ds_read_b128 v[60:63], v4 offset:22784
    s_waitcnt lgkmcnt(6)
    v_mfma_f32_16x16x32_bf16 v[16:19], v[32:35], a[64:67], v[16:19]
    v_mfma_f32_16x16x32_bf16 v[20:23], v[32:35], a[68:71], v[20:23]
    ds_read_b128 v[32:35], v4 offset:24576
    v_mfma_f32_16x16x32_bf16 v[28:31], v[36:39], a[68:71], v[28:31]
    v_mfma_f32_16x16x32_bf16 v[24:27], v[36:39], a[64:67], v[24:27]
    ds_read_b128 v[36:39], v4 offset:24832
    s_waitcnt lgkmcnt(6)
    v_mfma_f32_16x16x32_bf16 v[16:19], v[40:43], a[72:75], v[16:19]
    v_mfma_f32_16x16x32_bf16 v[20:23], v[40:43], a[76:79], v[20:23]
    ds_read_b128 v[40:43], v4 offset:26624
    v_mfma_f32_16x16x32_bf16 v[28:31], v[44:47], a[76:79], v[28:31]
    v_mfma_f32_16x16x32_bf16 v[24:27], v[44:47], a[72:75], v[24:27]
    ds_read_b128 v[44:47], v4 offset:26880
    s_waitcnt lgkmcnt(6)
    v_mfma_f32_16x16x32_bf16 v[16:19], v[48:51], a[80:83], v[16:19]
    v_mfma_f32_16x16x32_bf16 v[20:23], v[48:51], a[84:87], v[20:23]
    v_mfma_f32_16x16x32_bf16 v[28:31], v[52:55], a[84:87], v[28:31]
    v_mfma_f32_16x16x32_bf16 v[24:27], v[52:55], a[80:83], v[24:27]
    s_waitcnt lgkmcnt(4)
    v_mfma_f32_16x16x32_bf16 v[16:19], v[56:59], a[88:91], v[16:19]
    v_mfma_f32_16x16x32_bf16 v[20:23], v[56:59], a[92:95], v[20:23]
    v_mfma_f32_16x16x32_bf16 v[28:31], v[60:63], a[92:95], v[28:31]
    v_mfma_f32_16x16x32_bf16 v[24:27], v[60:63], a[88:91], v[24:27]
    s_waitcnt lgkmcnt(2)
    v_mfma_f32_16x16x32_bf16 v[16:19], v[32:35], a[96:99], v[16:19]
    v_mfma_f32_16x16x32_bf16 v[20:23], v[32:35], a[100:103], v[20:23]
    s_cmp_eq_u32 s81, 1
    s_cbranch_scc1 L_g_h2_135
L_g_h2_135_b:
    ds_write_b32 v119, v118
    v_mfma_f32_16x16x32_bf16 v[28:31], v[36:39], a[100:103], v[28:31]
    v_mfma_f32_16x16x32_bf16 v[24:27], v[36:39], a[96:99], v[24:27]
    s_waitcnt lgkmcnt(0)
    v_mfma_f32_16x16x32_bf16 v[16:19], v[40:43], a[104:107], v[16:19]
    v_mfma_f32_16x16x32_bf16 v[20:23], v[40:43], a[108:111], v[20:23]
    v_mfma_f32_16x16x32_bf16 v[28:31], v[44:47], a[108:111], v[28:31]
    v_mfma_f32_16x16x32_bf16 v[24:27], v[44:47], a[104:107], v[24:27]
    v_xor_b32 v4, 0x10000, v4
    s_setprio 0
    s_waitcnt vmcnt(0)
    s_waitcnt lgkmcnt(0)
    s_barrier
    ds_read_b32 v14, v15
    s_nop 6
    ds_write_b128 v5, v[16:19] offset:0
    ds_write_b128 v5, v[20:23] offset:1024
    ds_write_b128 v5, v[24:27] offset:2048
    ds_write_b128 v5, v[28:31] offset:3072
    s_waitcnt lgkmcnt(4)
    v_readfirstlane_b32 s66, v14
    s_add_u32 s60, s60, 1
    s_mov_b32 s65, 0
    s_cmp_le_u32 s62, s60
    s_cbranch_scc1 L_g_dp_136_l
L_g_dp_136_a:
    s_cmp_ge_u32 s62, s66
    s_cbranch_scc1 L_g_dp_136_d
    s_add_u32 s47, s61, 4096
    s_mov_b32 m0, s64
    s_add_u32 s62, s62, 1
    buffer_load_dwordx4 v3, s[12:15], s61 offen offset:0 sc1 lds
    buffer_load_dwordx4 v3, s[12:15], s61 offen offset:1024 sc1 lds
    buffer_load_dwordx4 v3, s[12:15], s61 offen offset:2048 sc1 lds
    buffer_load_dwordx4 v3, s[12:15], s61 offen offset:3072 sc1 lds
    s_add_u32 m0, s64, 4096
    s_add_u32 s61, s61, s85
    buffer_load_dwordx4 v3, s[12:15], s47 offen offset:0 sc1 lds
    buffer_load_dwordx4 v3, s[12:15], s47 offen offset:1024 sc1 lds
    buffer_load_dwordx4 v3, s[12:15], s47 offen offset:2048 sc1 lds
    s_xor_b32 s64, s64, 0x10000
L_g_dp_136_d:
    s_cmp_lg_u32 s44, 2
    s_cbranch_scc1 L_g_pf_137
    s_cmp_ge_u32 s62, s66
    s_cbranch_scc1 L_g_pf_137
    buffer_load_dword v117, v116, s[12:15], s61 offen sc1
L_g_pf_137:
    s_cmp_le_u32 s66, s60
    s_cbranch_scc1 L_g_ex0_133
    s_cmp_lg_u32 s65, 0
    s_cbranch_scc1 L_g_nw_132
    ds_read_b128 v[32:35], v4 offset:0
    ds_read_b128 v[36:39], v4 offset:256
    ds_read_b128 v[40:43], v4 offset:2048
    ds_read_b128 v[44:47], v4 offset:2304
    ds_read_b128 v[48:51], v4 offset:4096
    ds_read_b128 v[52:55], v4 offset:4352
    ds_read_b128 v[56:59], v4 offset:6144
    ds_read_b128 v[60:63], v4 offset:6400
    s_cmp_lg_u32 s44, 0
    s_cbranch_scc1 L_g_nl_138
    s_mov_b32 s46, s66
    s_cmp_lg_u32 s81, 0
    s_cbranch_scc1 L_g_nl_138_e
    v_cmp_ge_u32 vcc, v12, v11
    s_nop 0
    s_ff1_i32_b64 s46, vcc
    s_lshr_b32 s46, s46, 4
    s_min_u32 s46, s46, 4
    s_add_u32 s46, s46, s54
    s_min_u32 s46, s46, s75
    v_mov_b32 v118, s46
L_g_nl_138_e:
    s_add_u32 s47, s60, 3
    s_min_u32 s47, s47, s75
    s_cmp_lt_u32 s46, s47
    s_cselect_b32 s81, 1, 0
    s_cbranch_scc1 L_g_nl_138
    s_add_u32 s54, s60, 2
    s_mul_i32 s55, s54, s78
    v_add_u32 v12, s55, v113
    v_subrev_u32 v13, 58, v12
    v_ashrrev_i32 v11, 31, v13
    v_and_b32 v13, 1, v13
    v_add_u32 v13, 1, v13
    v_bfi_b32 v13, v11, 0, v13
    v_lshl_add_u32 v13, v13, 16, v7
    buffer_load_dword v11, v13, s[12:15], 0 offen sc1
L_g_nl_138:
    s_waitcnt lgkmcnt(8)
    s_branch L_g_loop0_122
L_g_ex0_133:
    s_cmp_lg_u32 s44, 0
    s_cbranch_scc1 L_g_ex0_133_n
    ds_write_b32 v15, v118 offset:20
    s_cmp_ge_u32 s60, s75
    s_cbranch_scc1 L_g_ex0_133_n
    s_sleep 6
    s_add_u32 s54, s60, 0
    s_mul_i32 s55, s54, s78
    v_add_u32 v12, s55, v113
    v_subrev_u32 v13, 58, v12
    v_ashrrev_i32 v11, 31, v13
    v_and_b32 v13, 1, v13
    v_add_u32 v13, 1, v13
    v_bfi_b32 v13, v11, 0, v13
    v_lshl_add_u32 v13, v13, 16, v7
    buffer_load_dword v11, v13, s[12:15], 0 offen sc1
    s_waitcnt vmcnt(0)
    v_cmp_ge_u32 vcc, v12, v11
    s_nop 0
    s_ff1_i32_b64 s46, vcc
    s_lshr_b32 s46, s46, 4
    s_min_u32 s46, s46, 4
    s_add_u32 s46, s46, s54
    s_min_u32 s46, s46, s75
    v_mov_b32 v118, s46
    ds_write_b32 v15, v118 offset:20
L_g_ex0_133_n:
    s_waitcnt lgkmcnt(0)
    s_barrier
    ds_read_b32 v14, v15 offset:20
    s_waitcnt lgkmcnt(0)
    v_readfirstlane_b32 s66, v14
    s_barrier
    s_cmp_gt_u32 s66, s60
    s_cbranch_scc1 L_g_restart_119_go
    s_branch L_g_tail_124
L_g_g1r_121:
    s_mov_b32 s65, 1
    s_branch L_g_loop1_123_e
.p2align 6
L_g_loop1_123:
    s_mov_b32 s65, 0
L_g_loop1_123_e:
    s_barrier
    s_bitcmp1_b32 s67, 1
    s_cbranch_scc0 L_g_nfl_139
    s_cmp_lg_u32 s44, 4
    s_cbranch_scc1 L_g_nfl_139_d
    s_mul_i32 s59, s60, s78
    s_add_u32 s59, s59, s87
    v_mov_b32 v10, s59
    buffer_store_dword v10, v115, s[12:15], s52 offen sc1
L_g_nfl_139_d:
    ds_read_b128 v[80:83], v5 offset:0
    ds_read_b128 v[84:87], v5 offset:1024
    ds_read_b128 v[88:91], v5 offset:2048
    ds_read_b128 v[92:95], v5 offset:3072
    s_cmp_le_u32 s62, s60
    s_cbranch_scc1 L_g_dp_144_l
L_g_dp_144_a:
    s_cmp_ge_u32 s62, s66
    s_cbranch_scc1 L_g_dp_144_d
    s_add_u32 s47, s61, 4096
    s_mov_b32 m0, s64
    s_add_u32 s62, s62, 1
    buffer_load_dwordx4 v3, s[12:15], s61 offen offset:0 sc1 lds
    buffer_load_dwordx4 v3, s[12:15], s61 offen offset:1024 sc1 lds
    buffer_load_dwordx4 v3, s[12:15], s61 offen offset:2048 sc1 lds
    buffer_load_dwordx4 v3, s[12:15], s61 offen offset:3072 sc1 lds
    s_add_u32 m0, s64, 4096
    s_add_u32 s61, s61, s85
    buffer_load_dwordx4 v3, s[12:15], s47 offen offset:0 sc1 lds
    buffer_load_dwordx4 v3, s[12:15], s47 offen offset:1024 sc1 lds
    buffer_load_dwordx4 v3, s[12:15], s47 offen offset:2048 sc1 lds
    s_xor_b32 s64, s64, 0x10000
L_g_dp_144_d:
    s_bitcmp1_b32 s67, 0
    s_cbranch_scc0 L_g_nep_140
    s_waitcnt lgkmcnt(0)
    v_add_f32 v80, v80, v16
    v_add_f32 v81, v81, v17
    v_add_f32 v82, v82, v18
    v_add_f32 v83, v83, v19
    v_add_f32 v84, v84, v20
    v_add_f32 v85, v85, v21
    v_add_f32 v86, v86, v22
    v_add_f32 v87, v87, v23
    v_add_f32 v88, v88, v24
    v_add_f32 v89, v89, v25
    v_add_f32 v90, v90, v26
    v_add_f32 v91, v91, v27
    v_add_f32 v92, v92, v28
    v_add_f32 v93, v93, v29
    v_add_f32 v94, v94, v30
    v_add_f32 v95, v95, v31
    v_cvt_pk_bf16_f32 v104, v80, v81
    v_cvt_pk_bf16_f32 v105, v82, v83
    v_cvt_pk_bf16_f32 v106, v84, v85
    v_cvt_pk_bf16_f32 v107, v86, v87
    s_nop 1
    v_permlane16_swap_b32 v104, v106
    v_permlane16_swap_b32 v105, v107
    buffer_store_dwordx4 v[104:107], v8, s[12:15], s63 offen sc1
    v_cvt_pk_bf16_f32 v108, v88, v89
    v_cvt_pk_bf16_f32 v109, v90, v91
    v_cvt_pk_bf16_f32 v110, v92, v93
    v_cvt_pk_bf16_f32 v111, v94, v95
    s_nop 1
    v_permlane16_swap_b32 v108, v110
    v_permlane16_swap_b32 v109, v111
    buffer_store_dwordx4 v[108:111], v9, s[12:15], s63 offen sc1
    s_add_u32 s63, s63, s86
L_g_nep_140:
    s_cmp_lg_u32 s65, 0
    s_cbranch_scc1 L_g_nw1_141
    ds_read_b128 v[32:35], v4 offset:0
    ds_read_b128 v[36:39], v4 offset:256
    ds_read_b128 v[40:43], v4 offset:2048
    ds_read_b128 v[44:47], v4 offset:2304
    ds_read_b128 v[48:51], v4 offset:4096
    ds_read_b128 v[52:55], v4 offset:4352
    ds_read_b128 v[56:59], v4 offset:6144
    ds_read_b128 v[60:63], v4 offset:6400
    s_barrier
L_g_jn_143:
    s_setprio 1
    s_waitcnt lgkmcnt(6)
    v_mfma_f32_16x16x32_bf16 v[16:19], v[32:35], a[0:3], 0
    ds_read_b32 v14, v15
    v_mfma_f32_16x16x32_bf16 v[20:23], v[32:35], a[4:7], 0
    ds_read_b128 v[32:35], v4 offset:8192
    v_mfma_f32_16x16x32_bf16 v[28:31], v[36:39], a[4:7], 0
    v_mfma_f32_16x16x32_bf16 v[24:27], v[36:39], a[0:3], 0
    ds_read_b128 v[36:39], v4 offset:8448
    s_waitcnt lgkmcnt(6)
    v_mfma_f32_16x16x32_bf16 v[16:19], v[40:43], a[8:11], v[16:19]
    v_mfma_f32_16x16x32_bf16 v[20:23], v[40:43], a[12:15], v[20:23]
    ds_read_b128 v[40:43], v4 offset:10240
    v_mfma_f32_16x16x32_bf16 v[28:31], v[44:47], a[12:15], v[28:31]
    v_mfma_f32_16x16x32_bf16 v[24:27], v[44:47], a[8:11], v[24:27]
    ds_read_b128 v[44:47], v4 offset:10496
    s_waitcnt lgkmcnt(6)
    v_mfma_f32_16x16x32_bf16 v[16:19], v[48:51], a[16:19], v[16:19]
    v_mfma_f32_16x16x32_bf16 v[20:23], v[48:51], a[20:23], v[20:23]
    ds_read_b128 v[48:51], v4 offset:12288
    v_mfma_f32_16x16x32_bf16 v[28:31], v[52:55], a[20:23], v[28:31]
    v_mfma_f32_16x16x32_bf16 v[24:27], v[52:55], a[16:19], v[24:27]
    ds_read_b128 v[52:55], v4 offset:12544
    s_waitcnt lgkmcnt(6)
    v_mfma_f32_16x16x32_bf16 v[16:19], v[56:59], a[24:27], v[16:19]
    v_mfma_f32_16x16x32_bf16 v[20:23], v[56:59], a[28:31], v[20:23]
    ds_read_b128 v[56:59], v4 offset:14336
    v_mfma_f32_16x16x32_bf16 v[28:31], v[60:63], a[28:31], v[28:31]
    v_mfma_f32_16x16x32_bf16 v[24:27], v[60:63], a[24:27], v[24:27]
    ds_read_b128 v[60:63], v4 offset:14592
    s_waitcnt lgkmcnt(6)
    v_mfma_f32_16x16x32_bf16 v[16:19], v[32:35], a[32:35], v[16:19]
    v_mfma_f32_16x16x32_bf16 v[20:23], v[32:35], a[36:39], v[20:23]
    ds_read_b128 v[32:35], v4 offset:16384
    v_mfma_f32_16x16x32_bf16 v[28:31], v[36:39], a[36:39], v[28:31]
    v_mfma_f32_16x16x32_bf16 v[24:27], v[36:39], a[32:35], v[24:27]
    ds_read_b128 v[36:39], v4 offset:16640
    s_waitcnt lgkmcnt(6)
    v_mfma_f32_16x16x32_bf16 v[16:19], v[40:43], a[40:43], v[16:19]
    v_mfma_f32_16x16x32_bf16 v[20:23], v[40:43], a[44:47], v[20:23]
    ds_read_b128 v[40:43], v4 offset:18432
    v_mfma_f32_16x16x32_bf16 v[28:31], v[44:47], a[44:47], v[28:31]
    v_mfma_f32_16x16x32_bf16 v[24:27], v[44:47], a[40:43], v[24:27]
    ds_read_b128 v[44:47], v4 offset:18688
    s_waitcnt lgkmcnt(6)
    v_mfma_f32_16x16x32_bf16 v[16:19], v[48:51], a[48:51], v[16:19]
    v_mfma_f32_16x16x32_bf16 v[20:23], v[48:51], a[52:55], v[20:23]
    ds_read_b128 v[48:51], v4 offset:20480
    v_mfma_f32_16x16x32_bf16 v[28:31], v[52:55], a[52:55], v[28:31]
    v_mfma_f32_16x16x32_bf16 v[24:27], v[52:55], a[48:51], v[24:27]
    ds_read_b128 v[52:55], v4 offset:20736
    s_waitcnt lgkmcnt(6)
    v_mfma_f32_16x16x32_bf16 v[16:19], v[56:59], a[56:59], v[16:19]
    v_mfma_f32_16x16x32_bf16 v[20:23], v[56:59], a[60:63], v[20:23]
    ds_read_b128 v[56:59], v4 offset:22528
    v_mfma_f32_16x16x32_bf16 v[28:31], v[60:63], a[60:63], v[28:31]
    v_mfma_f32_16x16x32_bf16 v[24:27], v[60:63], a[56:59], v[24:27]
    ds_read_b128 v[60:63], v4 offset:22784
    s_waitcnt lgkmcnt(6)
    v_mfma_f32_16x16x32_bf16 v[16:19], v[32:35], a[64:67], v[16:19]
    v_mfma_f32_16x16x32_bf16 v[20:23], v[32:35], a[68:71], v[20:23]
    ds_read_b128 v[32:35], v4 offset:24576
    v_mfma_f32_16x16x32_bf16 v[28:31], v[36:39], a[68:71], v[28:31]
    v_mfma_f32_16x16x32_bf16 v[24:27], v[36:39], a[64:67], v[24:27]
    ds_read_b128 v[36:39], v4 offset:24832
    s_waitcnt lgkmcnt(6)
    v_mfma_f32_16x16x32_bf16 v[16:19], v[40:43], a[72:75], v[16:19]
    v_mfma_f32_16x16x32_bf16 v[20:23], v[40:43], a[76:79], v[20:23]
    ds_read_b128 v[40:43], v4 offset:26624
    v_mfma_f32_16x16x32_bf16 v[28:31], v[44:47], a[76:79], v[28:31]
    v_mfma_f32_16x16x32_bf16 v[24:27], v[44:47], a[72:75], v[24:27]
    ds_read_b128 v[44:47], v4 offset:26880
    s_waitcnt lgkmcnt(6)
    v_mfma_f32_16x16x32_bf16 v[16:19], v[48:51], a[80:83], v[16:19]
    v_mfma_f32_16x16x32_bf16 v[20:23], v[48:51], a[84:87], v[20:23]
    v_mfma_f32_16x16x32_bf16 v[28:31], v[52:55], a[84:87], v[28:31]
    v_mfma_f32_16x16x32_bf16 v[24:27], v[52:55], a[80:83], v[24:27]
    s_waitcnt lgkmcnt(4)
    v_mfma_f32_16x16x32_bf16 v[16:19], v[56:59], a[88:91], v[16:19]
    v_mfma_f32_16x16x32_bf16 v[20:23], v[56:59], a[92:95], v[20:23]
    v_mfma_f32_16x16x32_bf16 v[28:31], v[60:63], a[92:95], v[28:31]
    v_mfma_f32_16x16x32_bf16 v[24:27], v[60:63], a[88:91], v[24:27]
    s_waitcnt lgkmcnt(2)
    v_mfma_f32_16x16x32_bf16 v[16:19], v[32:35], a[96:99], v[16:19]
    v_mfma_f32_16x16x32_bf16 v[20:23], v[32:35], a[100:103], v[20:23]
    v_mfma_f32_16x16x32_bf16 v[28:31], v[36:39], a[100:103], v[28:31]
    v_mfma_f32_16x16x32_bf16 v[24:27], v[36:39], a[96:99], v[24:27]
    s_waitcnt lgkmcnt(0)
    v_mfma_f32_16x16x32_bf16 v[16:19], v[40:43], a[104:107], v[16:19]
    v_mfma_f32_16x16x32_bf16 v[20:23], v[40:43], a[108:111], v[20:23]
    v_mfma_f32_16x16x32_bf16 v[28:31], v[44:47], a[108:111], v[28:31]
    v_mfma_f32_16x16x32_bf16 v[24:27], v[44:47], a[104:107], v[24:27]
    v_xor_b32 v4, 0x10000, v4
    s_setprio 0
    s_waitcnt vmcnt(0)
    v_readfirstlane_b32 s66, v14
    s_lshl_b32 s67, s67, 1
    s_or_b32 s67, s67, 1
    s_add_u32 s60, s60, 1
    s_cmp_gt_u32 s66, s60
    s_cbranch_scc1 L_g_loop1_123
    s_barrier
    ds_read_b32 v14, v15 offset:20
    ds_read_b128 v[80:83], v5 offset:0
    ds_read_b128 v[84:87], v5 offset:1024
    ds_read_b128 v[88:91], v5 offset:2048
    ds_read_b128 v[92:95], v5 offset:3072
    s_waitcnt lgkmcnt(4)
    v_readfirstlane_b32 s66, v14
    s_barrier
    s_mov_b32 s69, 0
    s_cmp_gt_u32 s62, s60
    s_cbranch_scc1 L_g_nd_145
    s_cmp_ge_u32 s62, s66
    s_cbranch_scc1 L_g_nd_145
    s_add_u32 s47, s61, 4096
    s_add_u32 m0, s64, 0
    s_nop 0
    buffer_load_dwordx4 v3, s[12:15], s61 offen offset:0 sc1 lds
    buffer_load_dwordx4 v3, s[12:15], s61 offen offset:1024 sc1 lds
    buffer_load_dwordx4 v3, s[12:15], s61 offen offset:2048 sc1 lds
    buffer_load_dwordx4 v3, s[12:15], s61 offen offset:3072 sc1 lds
    s_add_u32 m0, s64, 4096
    s_nop 0
    buffer_load_dwordx4 v3, s[12:15], s47 offen offset:0 sc1 lds
    buffer_load_dwordx4 v3, s[12:15], s47 offen offset:1024 sc1 lds
    buffer_load_dwordx4 v3, s[12:15], s47 offen offset:2048 sc1 lds
    s_add_u32 s61, s61, s85
    s_add_u32 s62, s62, 1
    s_xor_b32 s64, s64, 0x10000
    s_mov_b32 s69, 1
L_g_nd_145:
    s_waitcnt lgkmcnt(3)
    v_add_f32 v80, v80, v16
    v_add_f32 v81, v81, v17
    v_add_f32 v82, v82, v18
    v_add_f32 v83, v83, v19
    s_waitcnt lgkmcnt(2)
    v_add_f32 v84, v84, v20
    v_add_f32 v85, v85, v21
    v_add_f32 v86, v86, v22
    v_add_f32 v87, v87, v23
    s_waitcnt lgkmcnt(1)
    v_add_f32 v88, v88, v24
    v_add_f32 v89, v89, v25
    v_add_f32 v90, v90, v26
    v_add_f32 v91, v91, v27
    s_waitcnt lgkmcnt(0)
    v_add_f32 v92, v92, v28
    v_add_f32 v93, v93, v29
    v_add_f32 v94, v94, v30
    v_add_f32 v95, v95, v31
    v_cvt_pk_bf16_f32 v104, v80, v81
    v_cvt_pk_bf16_f32 v105, v82, v83
    v_cvt_pk_bf16_f32 v106, v84, v85
    v_cvt_pk_bf16_f32 v107, v86, v87
    s_nop 1
    v_permlane16_swap_b32 v104, v106
    v_permlane16_swap_b32 v105, v107
    buffer_store_dwordx4 v[104:107], v8, s[12:15], s63 offen sc1
    v_cvt_pk_bf16_f32 v108, v88, v89
    v_cvt_pk_bf16_f32 v109, v90, v91
    v_cvt_pk_bf16_f32 v110, v92, v93
    v_cvt_pk_bf16_f32 v111, v94, v95
    s_nop 1
    v_permlane16_swap_b32 v108, v110
    v_permlane16_swap_b32 v109, v111
    buffer_store_dwordx4 v[108:111], v9, s[12:15], s63 offen sc1
    s_add_u32 s63, s63, s86
    s_mov_b32 s67, 0
    s_mov_b32 s71, 1
    s_cmp_gt_u32 s66, s60
    s_cbranch_scc1 L_g_g1r_121
    v_mov_b32 v10, 1
    s_mov_b64 exec, 1
    s_waitcnt vmcnt(0)
    ds_add_rtn_u32 v10, v15, v10 offset:4
    s_waitcnt lgkmcnt(0)
    v_readfirstlane_b32 s46, v10
    s_mov_b64 exec, -1
    s_mov_b32 s71, 0
    s_sub_u32 s59, s60, 1
    s_mul_i32 s59, s59, s78
    s_add_u32 s59, s59, s74
    s_cmp_lg_u32 s46, s68
    s_cbranch_scc1 L_g_df_146
    v_mov_b32 v10, s59
    v_add_u32 v10, 1, v10
    v_mov_b32 v11, 0
    s_mov_b64 exec, 1
    buffer_store_dword v10, v11, s[12:15], s52 offen sc1
    s_mov_b64 exec, -1
L_sf_147:
L_g_df_146:
    s_add_u32 s68, s68, 4
    s_cmp_gt_u32 s66, s60
    s_cbranch_scc1 L_g_g1r_121
L_g_tail_124:
    s_cmp_lt_u32 s60, s75
    s_cbranch_scc1 L_g_restart_119
    s_waitcnt vmcnt(0)
    s_barrier
    s_branch L_c_done_1
L_g_h1_134:
    s_add_u32 s54, s60, 1
    s_mul_i32 s55, s54, s78
    v_add_u32 v12, s55, v113
    v_subrev_u32 v13, 58, v12
    v_ashrrev_i32 v11, 31, v13
    v_and_b32 v13, 1, v13
    v_add_u32 v13, 1, v13
    v_bfi_b32 v13, v11, 0, v13
    v_lshl_add_u32 v13, v13, 16, v7
    buffer_load_dword v11, v13, s[12:15], 0 offen sc1
    s_branch L_g_h1_134_b
L_g_h2_135:
    s_waitcnt vmcnt(0)
    v_cmp_ge_u32 vcc, v12, v11
    s_nop 0
    s_ff1_i32_b64 s46, vcc
    s_lshr_b32 s46, s46, 4
    s_min_u32 s46, s46, 4
    s_add_u32 s46, s46, s54
    s_min_u32 s46, s46, s75
    v_mov_b32 v118, s46
    s_branch L_g_h2_135_b
L_g_dp_136_l:
    s_cmp_ge_u32 s62, s66
    s_cbranch_scc1 L_g_dp_136_d
    s_mov_b32 s65, 1
    s_add_u32 s47, s61, 4096
    s_mov_b32 m0, s64
    s_add_u32 s62, s62, 1
    buffer_load_dwordx4 v3, s[12:15], s61 offen offset:0 sc1 lds
    buffer_load_dwordx4 v3, s[12:15], s61 offen offset:1024 sc1 lds
    buffer_load_dwordx4 v3, s[12:15], s61 offen offset:2048 sc1 lds
    buffer_load_dwordx4 v3, s[12:15], s61 offen offset:3072 sc1 lds
    s_add_u32 m0, s64, 4096
    s_add_u32 s61, s61, s85
    buffer_load_dwordx4 v3, s[12:15], s47 offen offset:0 sc1 lds
    buffer_load_dwordx4 v3, s[12:15], s47 offen offset:1024 sc1 lds
    buffer_load_dwordx4 v3, s[12:15], s47 offen offset:2048 sc1 lds
    s_xor_b32 s64, s64, 0x10000
    s_branch L_g_dp_136_a
L_g_nw_132:
    s_waitcnt vmcnt(0) lgkmcnt(0)
    s_cmp_lg_u32 s44, 0
    s_cbranch_scc1 L_g_nl_148
    s_cmp_lt_u32 s66, s75
    s_cselect_b32 s81, 1, 2
L_g_nl_148:
    s_branch L_g_loop0_122_l
L_g_nfl_139:
    s_cmp_eq_u32 s71, 0
    s_cbranch_scc1 L_g_nfl_139_d
    v_mov_b32 v10, 1
    s_mov_b64 exec, 1
    s_waitcnt vmcnt(0)
    ds_add_rtn_u32 v10, v15, v10 offset:4
    s_waitcnt lgkmcnt(0)
    v_readfirstlane_b32 s46, v10
    s_mov_b64 exec, -1
    s_mov_b32 s71, 0
    s_sub_u32 s59, s60, 1
    s_mul_i32 s59, s59, s78
    s_add_u32 s59, s59, s74
    s_cmp_lg_u32 s46, s68
    s_cbranch_scc1 L_g_df_149
    v_mov_b32 v10, s59
    v_add_u32 v10, 1, v10
    v_mov_b32 v11, 0
    s_mov_b64 exec, 1
    buffer_store_dword v10, v11, s[12:15], s52 offen sc1
    s_mov_b64 exec, -1
L_sf_150:
L_g_df_149:
    s_add_u32 s68, s68, 4
    s_mov_b32 s65, 2
    s_branch L_g_nfl_139_d
L_g_dp_144_l:
    s_cmp_ge_u32 s62, s66
    s_cbranch_scc1 L_g_dp_144_d
    s_or_b32 s65, s65, 1
    s_add_u32 s47, s61, 4096
    s_mov_b32 m0, s64
    s_add_u32 s62, s62, 1
    buffer_load_dwordx4 v3, s[12:15], s61 offen offset:0 sc1 lds
    buffer_load_dwordx4 v3, s[12:15], s61 offen offset:1024 sc1 lds
    buffer_load_dwordx4 v3, s[12:15], s61 offen offset:2048 sc1 lds
    buffer_load_dwordx4 v3, s[12:15], s61 offen offset:3072 sc1 lds
    s_add_u32 m0, s64, 4096
    s_add_u32 s61, s61, s85
    buffer_load_dwordx4 v3, s[12:15], s47 offen offset:0 sc1 lds
    buffer_load_dwordx4 v3, s[12:15], s47 offen offset:1024 sc1 lds
    buffer_load_dwordx4 v3, s[12:15], s47 offen offset:2048 sc1 lds
    s_xor_b32 s64, s64, 0x10000
    s_branch L_g_dp_144_a
L_g_nw1_141:
    s_cmp_eq_u32 s65, 2
    s_cbranch_scc1 L_g_nw1_141_w
    s_waitcnt vmcnt(0)
L_g_nw1_141_w:
    s_barrier
    ds_read_b128 v[32:35], v4 offset:0
    ds_read_b128 v[36:39], v4 offset:256
    ds_read_b128 v[40:43], v4 offset:2048
    ds_read_b128 v[44:47], v4 offset:2304
    ds_read_b128 v[48:51], v4 offset:4096
    ds_read_b128 v[52:55], v4 offset:4352
    ds_read_b128 v[56:59], v4 offset:6144
    ds_read_b128 v[60:63], v4 offset:6400
    s_branch L_g_jn_143
L_w_wo_10:
    s_load_dwordx2 s[4:5], s[0:1], 40
    s_load_dwordx2 s[6:7], s[0:1], 72
    s_and_b32 s50, s44, 3
    s_lshr_b32 s51, s44, 2
    s_waitcnt lgkmcnt(0)
    s_mov_b32 s24, s4
    s_and_b32 s25, s5, 0xffff
    s_mov_b32 s26, 0x800000
    s_mov_b32 s27, 0x00020000
    v_lshrrev_b32 v3, 4, v1
    v_and_b32 v4, 15, v1
    v_lshlrev_b32 v5, 2, v3
    v_xor_b32 v4, v4, v5
    v_mul_u32_u24 v3, 2048, v3
    v_lshl_add_u32 v3, v4, 4, v3
    s_mul_i32 s46, s51, 512
    s_mul_i32 s47, s50, 16
    s_add_u32 s46, s46, s47
    s_mul_i32 s47, s42, 1024
    s_add_u32 s46, s46, s47
    s_mul_i32 s46, s46, 2048
    s_lshl_b32 s47, s43, 8
    s_add_u32 s46, s46, s47
    s_lshl_b32 s45, s51, 16
    s_mul_i32 s47, s50, 4096
    s_add_u32 s45, s45, s47
    v_bfe_u32 v4, v1, 2, 2
    v_bfe_u32 v5, v1, 4, 1
    v_lshlrev_b32 v5, 1, v5
    v_bfe_u32 v6, v1, 1, 1
    v_add_u32 v5, v5, v6
    s_lshl_b32 s47, s50, 2
    v_add_u32 v5, s47, v5
    v_lshlrev_b32 v6, 2, v4
    v_xor_b32 v5, v5, v6
    v_lshlrev_b32 v5, 4, v5
    v_lshl_add_u32 v5, v4, 8, v5
    v_bfe_u32 v6, v1, 0, 1
    v_lshl_add_u32 v5, v6, 3, v5
    v_lshrrev_b32 v6, 5, v1
    v_mul_u32_u24 v6, 1024, v6
    v_add_u32 v5, v5, v6
    s_lshl_b32 s47, s51, 16
    v_add_u32 v5, s47, v5
    v_bfe_u32 v4, v1, 2, 2
    v_xor_b32 v5, s50, v4
    v_lshlrev_b32 v5, 6, v5
    v_lshl_add_u32 v5, v4, 8, v5
    v_and_b32 v6, 3, v1
    v_lshl_add_u32 v5, v6, 3, v5
    v_lshrrev_b32 v6, 4, v1
    v_lshl_add_u32 v5, v6, 10, v5
    v_lshrrev_b32 v6, 5, v1
    s_lshl_b32 s47, s51, 16
    v_add_u32 v5, s47, v5
    s_add_u32 m0, s45, 0
    s_add_u32 s47, s46, 0x0
    buffer_load_dwordx4 v3, s[24:27], s47 offen  lds
    s_add_u32 m0, s45, 1024
    s_add_u32 s47, s46, 0x2000
    buffer_load_dwordx4 v3, s[24:27], s47 offen  lds
    s_add_u32 m0, s45, 2048
    s_add_u32 s47, s46, 0x4000
    buffer_load_dwordx4 v3, s[24:27], s47 offen  lds
    s_add_u32 m0, s45, 3072
    s_add_u32 s47, s46, 0x6000
    buffer_load_dwordx4 v3, s[24:27], s47 offen  lds
    s_add_u32 m0, s45, 16384
    s_add_u32 s47, s46, 0x20000
    buffer_load_dwordx4 v3, s[24:27], s47 offen  lds
    s_add_u32 m0, s45, 17408
    s_add_u32 s47, s46, 0x22000
    buffer_load_dwordx4 v3, s[24:27], s47 offen  lds
    s_add_u32 m0, s45, 18432
    s_add_u32 s47, s46, 0x24000
    buffer_load_dwordx4 v3, s[24:27], s47 offen  lds
    s_add_u32 m0, s45, 19456
    s_add_u32 s47, s46, 0x26000
    buffer_load_dwordx4 v3, s[24:27], s47 offen  lds
    s_add_u32 m0, s45, 32768
    s_add_u32 s47, s46, 0x40000
    buffer_load_dwordx4 v3, s[24:27], s47 offen  lds
    s_add_u32 m0, s45, 33792
    s_add_u32 s47, s46, 0x42000
    buffer_load_dwordx4 v3, s[24:27], s47 offen  lds
    s_add_u32 m0, s45, 34816
    s_add_u32 s47, s46, 0x44000
    buffer_load_dwordx4 v3, s[24:27], s47 offen  lds
    s_add_u32 m0, s45, 35840
    s_add_u32 s47, s46, 0x46000
    buffer_load_dwordx4 v3, s[24:27], s47 offen  lds
    s_add_u32 m0, s45, 49152
    s_add_u32 s47, s46, 0x60000
    buffer_load_dwordx4 v3, s[24:27], s47 offen  lds
    s_add_u32 m0, s45, 50176
    s_add_u32 s47, s46, 0x62000
    buffer_load_dwordx4 v3, s[24:27], s47 offen  lds
    s_add_u32 m0, s45, 51200
    s_add_u32 s47, s46, 0x64000
    buffer_load_dwordx4 v3, s[24:27], s47 offen  lds
    s_add_u32 m0, s45, 52224
    s_add_u32 s47, s46, 0x66000
    buffer_load_dwordx4 v3, s[24:27], s47 offen  lds
    s_waitcnt vmcnt(12) lgkmcnt(0)
    s_barrier
    ds_read_b64_tr_b16 a[0:1], v5 offset:0
    ds_read_b64_tr_b16 a[2:3], v5 offset:4096
    ds_read_b64_tr_b16 a[4:5], v5 offset:32
    ds_read_b64_tr_b16 a[6:7], v5 offset:4128
    ds_read_b64_tr_b16 a[8:9], v5 offset:8192
    ds_read_b64_tr_b16 a[10:11], v5 offset:12288
    ds_read_b64_tr_b16 a[12:13], v5 offset:8224
    ds_read_b64_tr_b16 a[14:15], v5 offset:12320
    s_waitcnt vmcnt(8) lgkmcnt(0)
    s_barrier
    s_add_u32 m0, s45, 0
    s_add_u32 s47, s46, 0x80000
    buffer_load_dwordx4 v3, s[24:27], s47 offen  lds
    s_add_u32 m0, s45, 1024
    s_add_u32 s47, s46, 0x82000
    buffer_load_dwordx4 v3, s[24:27], s47 offen  lds
    s_add_u32 m0, s45, 2048
    s_add_u32 s47, s46, 0x84000
    buffer_load_dwordx4 v3, s[24:27], s47 offen  lds
    s_add_u32 m0, s45, 3072
    s_add_u32 s47, s46, 0x86000
    buffer_load_dwordx4 v3, s[24:27], s47 offen  lds
    ds_read_b64_tr_b16 a[16:17], v5 offset:16384
    ds_read_b64_tr_b16 a[18:19], v5 offset:20480
    ds_read_b64_tr_b16 a[20:21], v5 offset:16416
    ds_read_b64_tr_b16 a[22:23], v5 offset:20512
    ds_read_b64_tr_b16 a[24:25], v5 offset:24576
    ds_read_b64_tr_b16 a[26:27], v5 offset:28672
    ds_read_b64_tr_b16 a[28:29], v5 offset:24608
    ds_read_b64_tr_b16 a[30:31], v5 offset:28704
    s_waitcnt vmcnt(8) lgkmcnt(0)
    s_barrier
    s_add_u32 m0, s45, 16384
    s_add_u32 s47, s46, 0xa0000
    buffer_load_dwordx4 v3, s[24:27], s47 offen  lds
    s_add_u32 m0, s45, 17408
    s_add_u32 s47, s46, 0xa2000
    buffer_load_dwordx4 v3, s[24:27], s47 offen  lds
    s_add_u32 m0, s45, 18432
    s_add_u32 s47, s46, 0xa4000
    buffer_load_dwordx4 v3, s[24:27], s47 offen  lds
    s_add_u32 m0, s45, 19456
    s_add_u32 s47, s46, 0xa6000
    buffer_load_dwordx4 v3, s[24:27], s47 offen  lds
    ds_read_b64_tr_b16 a[32:33], v5 offset:32768
    ds_read_b64_tr_b16 a[34:35], v5 offset:36864
    ds_read_b64_tr_b16 a[36:37], v5 offset:32800
    ds_read_b64_tr_b16 a[38:39], v5 offset:36896
    ds_read_b64_tr_b16 a[40:41], v5 offset:40960
    ds_read_b64_tr_b16 a[42:43], v5 offset:45056
    ds_read_b64_tr_b16 a[44:45], v5 offset:40992
    ds_read_b64_tr_b16 a[46:47], v5 offset:45088
    s_waitcnt vmcnt(8) lgkmcnt(0)
    s_barrier
    s_add_u32 m0, s45, 32768
    s_add_u32 s47, s46, 0xc0000
    buffer_load_dwordx4 v3, s[24:27], s47 offen  lds
    s_add_u32 m0, s45, 33792
    s_add_u32 s47, s46, 0xc2000
    buffer_load_dwordx4 v3, s[24:27], s47 offen  lds
    s_add_u32 m0, s45, 34816
    s_add_u32 s47, s46, 0xc4000
    buffer_load_dwordx4 v3, s[24:27], s47 offen  lds
    s_add_u32 m0, s45, 35840
    s_add_u32 s47, s46, 0xc6000
    buffer_load_dwordx4 v3, s[24:27], s47 offen  lds
    ds_read_b64_tr_b16 a[48:49], v5 offset:49152
    ds_read_b64_tr_b16 a[50:51], v5 offset:53248
    ds_read_b64_tr_b16 a[52:53], v5 offset:49184
    ds_read_b64_tr_b16 a[54:55], v5 offset:53280
    ds_read_b64_tr_b16 a[56:57], v5 offset:57344
    ds_read_b64_tr_b16 a[58:59], v5 offset:61440
    ds_read_b64_tr_b16 a[60:61], v5 offset:57376
    ds_read_b64_tr_b16 a[62:63], v5 offset:61472
    s_waitcnt vmcnt(8) lgkmcnt(0)
    s_barrier
    s_add_u32 m0, s45, 49152
    s_add_u32 s47, s46, 0xe0000
    buffer_load_dwordx4 v3, s[24:27], s47 offen  lds
    s_add_u32 m0, s45, 50176
    s_add_u32 s47, s46, 0xe2000
    buffer_load_dwordx4 v3, s[24:27], s47 offen  lds
    s_add_u32 m0, s45, 51200
    s_add_u32 s47, s46, 0xe4000
    buffer_load_dwordx4 v3, s[24:27], s47 offen  lds
    s_add_u32 m0, s45, 52224
    s_add_u32 s47, s46, 0xe6000
    buffer_load_dwordx4 v3, s[24:27], s47 offen  lds
    ds_read_b64_tr_b16 a[64:65], v5 offset:0
    ds_read_b64_tr_b16 a[66:67], v5 offset:4096
    ds_read_b64_tr_b16 a[68:69], v5 offset:32
    ds_read_b64_tr_b16 a[70:71], v5 offset:4128
    ds_read_b64_tr_b16 a[72:73], v5 offset:8192
    ds_read_b64_tr_b16 a[74:75], v5 offset:12288
    ds_read_b64_tr_b16 a[76:77], v5 offset:8224
    ds_read_b64_tr_b16 a[78:79], v5 offset:12320
    s_waitcnt vmcnt(8) lgkmcnt(0)
    s_barrier
    ds_read_b64_tr_b16 a[80:81], v5 offset:16384
    ds_read_b64_tr_b16 a[82:83], v5 offset:20480
    ds_read_b64_tr_b16 a[84:85], v5 offset:16416
    ds_read_b64_tr_b16 a[86:87], v5 offset:20512
    ds_read_b64_tr_b16 a[88:89], v5 offset:24576
    ds_read_b64_tr_b16 a[90:91], v5 offset:28672
    ds_read_b64_tr_b16 a[92:93], v5 offset:24608
    ds_read_b64_tr_b16 a[94:95], v5 offset:28704
    s_waitcnt vmcnt(4) lgkmcnt(0)
    s_barrier
    ds_read_b64_tr_b16 a[96:97], v5 offset:32768
    ds_read_b64_tr_b16 a[98:99], v5 offset:36864
    ds_read_b64_tr_b16 a[100:101], v5 offset:32800
    ds_read_b64_tr_b16 a[102:103], v5 offset:36896
    ds_read_b64_tr_b16 a[104:105], v5 offset:40960
    ds_read_b64_tr_b16 a[106:107], v5 offset:45056
    ds_read_b64_tr_b16 a[108:109], v5 offset:40992
    ds_read_b64_tr_b16 a[110:111], v5 offset:45088
    s_waitcnt vmcnt(0) lgkmcnt(0)
    s_barrier
    ds_read_b64_tr_b16 a[112:113], v5 offset:49152
    ds_read_b64_tr_b16 a[114:115], v5 offset:53248
    ds_read_b64_tr_b16 a[116:117], v5 offset:49184
    ds_read_b64_tr_b16 a[118:119], v5 offset:53280
    ds_read_b64_tr_b16 a[120:121], v5 offset:57344
    ds_read_b64_tr_b16 a[122:123], v5 offset:61440
    ds_read_b64_tr_b16 a[124:125], v5 offset:57376
    ds_read_b64_tr_b16 a[126:127], v5 offset:61472
    s_waitcnt lgkmcnt(0)
    s_barrier
    s_load_dwordx2 s[8:9], s[0:1], 64
    s_load_dwordx2 s[10:11], s[0:1], 80
    s_lshl_b32 s46, s42, 3
    s_add_u32 s46, s46, s43
    s_mul_i32 s46, s46, 229376
    s_mul_i32 s47, s44, 28672
    s_add_u32 s46, s46, s47
    v_lshlrev_b32 v10, 7, v1
    s_waitcnt lgkmcnt(0)
    s_mov_b32 s28, s8
    s_and_b32 s29, s9, 0xffff
    s_mov_b32 s30, 0x700000
    s_mov_b32 s31, 0x00020000
    s_mov_b32 s32, s10
    s_and_b32 s33, s11, 0xffff
    s_mov_b32 s34, 0x700000
    s_mov_b32 s35, 0x00020000
    s_add_u32 s47, s46, 0
    buffer_load_dword v120, v10, s[28:31], s47 offen
    s_add_u32 s47, s46, 8192
    buffer_load_dword v121, v10, s[28:31], s47 offen
    s_add_u32 s47, s46, 16384
    buffer_load_dword v122, v10, s[28:31], s47 offen
    s_add_u32 s47, s46, 20480
    buffer_load_dword v123, v10, s[28:31], s47 offen
    v_lshlrev_b32 v2, 4, v1
    s_mul_i32 s64, s44, 8192
    s_add_u32 s46, s64, 0x5000000
    s_mul_i32 s47, s42, 65536
    s_add_u32 s46, s46, s47
    v_add_u32 v3, s46, v2
    s_mul_i32 s46, s51, 32768
    v_add_u32 v4, s46, v2
    v_and_b32 v6, 15, v1
    v_lshlrev_b32 v6, 4, v6
    v_lshrrev_b32 v7, 4, v1
    v_lshl_add_u32 v6, v7, 9, v6
    v_add_u32 v4, s46, v6
    s_lshl_b32 s46, s50, 12
    s_add_u32 s46, s46, 131072
    v_add_u32 v5, s46, v2
    v_and_b32 v7, 7, v1
    v_lshlrev_b32 v7, 9, v7
    s_lshl_b32 s46, s42, 12
    s_add_u32 s46, s46, 0x102000
    v_add_u32 v7, s46, v7
    s_lshl_b32 s46, s42, 16
    s_lshl_b32 s47, s43, 11
    s_add_u32 s46, s46, s47
    s_lshl_b32 s47, s50, 9
    s_add_u32 s46, s46, s47
    s_add_u32 s46, s46, 0x9000000
    v_and_b32 v8, 31, v1
    v_lshlrev_b32 v8, 4, v8
    v_lshrrev_b32 v9, 5, v1
    v_lshl_add_u32 v8, v9, 14, v8
    v_add_u32 v8, s46, v8
    v_add_u32 v9, 0x8000, v8
    s_lshl_b32 s52, s43, 9
    s_lshl_b32 s47, s42, 7
    s_add_u32 s52, s52, s47
    s_add_u32 s52, s52, 0x107400
    s_add_u32 s52, s52, s76
    s_mul_i32 s46, s43, 8192
    s_add_u32 s46, s46, 0x5000000
    s_mul_i32 s47, s42, 65536
    s_add_u32 s46, s46, s47
    v_min_u32 v116, 63, v1
    v_lshlrev_b32 v116, 7, v116
    v_add_u32 v116, s46, v116
    s_mov_b32 s60, 0
    s_mul_i32 s61, s74, 262144
    s_mov_b32 s62, 0
    s_mul_i32 s63, s74, 262144
    s_mul_i32 s85, s78, 262144
    s_mul_i32 s86, s78, 262144
    s_sub_u32 s46, s78, 1
    s_sub_u32 s75, s75, s74
    s_add_u32 s75, s75, s46
    s_lshr_b32 s75, s75, s46
    s_mov_b32 s67, 0
    s_mov_b32 s68, 3
    s_mov_b32 s71, 0
    v_mov_b32 v15, 147456
    v_mov_b32 v14, 0
    ds_write_b32 v15, v14 offset:4
    ds_write_b32 v15, v14 offset:12
    ds_write_b32 v15, v14 offset:16
    v_mov_b32 v114, 1
    v_mov_b32 v115, 0
    s_mov_b32 s81, 0
    s_mul_i32 s87, s78, 2
    s_sub_u32 s87, s74, s87
    s_add_u32 s87, s87, 1
    s_lshl_b32 s46, s44, 5
    v_add_u32 v119, s46, v15
    v_lshrrev_b32 v113, 4, v1
    v_mul_u32_u24 v113, s78, v113
    v_add_u32 v113, s74, v113
    s_mov_b32 s72, 0
L_g_restart_151:
    s_cmp_lg_u32 s44, 0
    s_cbranch_scc1 L_g_nsp_152
    s_mov_b32 s70, 0
L_g_sp_158:
    s_add_u32 s54, s60, 0
    s_mul_i32 s55, s54, s78
    v_add_u32 v12, s55, v113
    v_and_b32 v13, 3, v12
    v_lshl_add_u32 v13, v13, 7, v7
    buffer_load_dword v11, v13, s[12:15], 0 offen sc1
    s_waitcnt vmcnt(0)
    v_cmp_ge_u32 vcc, v12, v11
    s_add_u32 s70, s70, 1
    s_and_b32 s46, vcc_lo, 0xffff
    s_cbranch_scc0 L_g_sp_158_ok
    s_sleep 3
    s_cmp_lt_u32 s70, 524288
    s_cbranch_scc1 L_g_sp_158
    s_branch L_c_done_1
L_g_sp_158_ok:
    v_cmp_ge_u32 vcc, v12, v11
    s_nop 0
    s_ff1_i32_b64 s46, vcc
    s_lshr_b32 s46, s46, 4
    s_min_u32 s46, s46, 4
    s_add_u32 s46, s46, s54
    s_min_u32 s46, s46, s75
    v_mov_b32 v118, s46
    ds_write_b32 v15, v118 offset:20
L_g_nsp_152:
    s_waitcnt lgkmcnt(0)
    s_barrier
    ds_read_b32 v14, v15 offset:20
    s_waitcnt lgkmcnt(0)
    v_readfirstlane_b32 s66, v14
    s_nop 3
L_g_restart_151_go:
    s_mov_b32 s69, 0
    s_cmp_gt_u32 s62, s60
    s_cbranch_scc1 L_g_nd_159
    s_cmp_ge_u32 s62, s66
    s_cbranch_scc1 L_g_nd_159
    s_add_u32 s47, s61, 4096
    s_add_u32 m0, s64, 0
    s_nop 0
    buffer_load_dwordx4 v3, s[12:15], s61 offen offset:0 sc1 lds
    buffer_load_dwordx4 v3, s[12:15], s61 offen offset:1024 sc1 lds
    buffer_load_dwordx4 v3, s[12:15], s61 offen offset:2048 sc1 lds
    buffer_load_dwordx4 v3, s[12:15], s61 offen offset:3072 sc1 lds
    s_add_u32 m0, s64, 4096
    s_nop 0
    buffer_load_dwordx4 v3, s[12:15], s47 offen offset:0 sc1 lds
    buffer_load_dwordx4 v3, s[12:15], s47 offen offset:1024 sc1 lds
    buffer_load_dwordx4 v3, s[12:15], s47 offen offset:2048 sc1 lds
    buffer_load_dwordx4 v3, s[12:15], s47 offen offset:3072 sc1 lds
    s_add_u32 s61, s61, s85
    s_add_u32 s62, s62, 1
    s_xor_b32 s64, s64, 0x10000
    s_mov_b32 s69, 1
L_g_nd_159:
    s_cmp_eq_u32 s51, 1
    s_cbranch_scc1 L_g_g1r_153
    s_add_u32 s59, s60, 1
    s_mov_b32 s69, 0
    s_cmp_gt_u32 s62, s59
    s_cbranch_scc1 L_g_nd_160
    s_cmp_ge_u32 s62, s66
    s_cbranch_scc1 L_g_nd_160
    s_add_u32 s47, s61, 4096
    s_add_u32 m0, s64, 0
    s_nop 0
    buffer_load_dwordx4 v3, s[12:15], s61 offen offset:0 sc1 lds
    buffer_load_dwordx4 v3, s[12:15], s61 offen offset:1024 sc1 lds
    buffer_load_dwordx4 v3, s[12:15], s61 offen offset:2048 sc1 lds
    buffer_load_dwordx4 v3, s[12:15], s61 offen offset:3072 sc1 lds
    s_add_u32 m0, s64, 4096
    s_nop 0
    buffer_load_dwordx4 v3, s[12:15], s47 offen offset:0 sc1 lds
    buffer_load_dwordx4 v3, s[12:15], s47 offen offset:1024 sc1 lds
    buffer_load_dwordx4 v3, s[12:15], s47 offen offset:2048 sc1 lds
    buffer_load_dwordx4 v3, s[12:15], s47 offen offset:3072 sc1 lds
    s_add_u32 s61, s61, s85
    s_add_u32 s62, s62, 1
    s_xor_b32 s64, s64, 0x10000
    s_mov_b32 s69, 1
L_g_nd_160:
    s_cmp_eq_u32 s69, 1
    s_cbranch_scc1 L_g_w0_161
    s_waitcnt vmcnt(0)
L_g_w0_161:
    s_waitcnt vmcnt(8)
    s_cmp_lg_u32 s44, 0
    s_cbranch_scc1 L_g_nl_162
    s_cmp_lt_u32 s66, s75
    s_cselect_b32 s81, 1, 2
L_g_nl_162:
L_g_loop0_154_l:
    s_barrier
    ds_read_b128 v[32:35], v4 offset:0
    ds_read_b128 v[36:39], v4 offset:256
    ds_read_b128 v[40:43], v4 offset:2048
    ds_read_b128 v[44:47], v4 offset:2304
    ds_read_b128 v[48:51], v4 offset:4096
    ds_read_b128 v[52:55], v4 offset:4352
    ds_read_b128 v[56:59], v4 offset:6144
    ds_read_b128 v[60:63], v4 offset:6400
    s_branch L_g_loop0_154_m
.p2align 6
L_g_loop0_154:
    s_barrier
L_g_loop0_154_m:
    s_setprio 2
    s_waitcnt lgkmcnt(6)
    v_mfma_f32_16x16x32_bf16 v[16:19], v[32:35], a[0:3], 0
    v_mfma_f32_16x16x32_bf16 v[20:23], v[32:35], a[4:7], 0
    ds_read_b128 v[32:35], v4 offset:8192
    v_mfma_f32_16x16x32_bf16 v[28:31], v[36:39], a[4:7], 0
    v_mfma_f32_16x16x32_bf16 v[24:27], v[36:39], a[0:3], 0
    ds_read_b128 v[36:39], v4 offset:8448
    s_cmp_eq_u32 s81, 1
    s_cbranch_scc1 L_g_h1_166
L_g_h1_166_b:
    s_waitcnt lgkmcnt(6)
    v_mfma_f32_16x16x32_bf16 v[16:19], v[40:43], a[8:11], v[16:19]
    v_mfma_f32_16x16x32_bf16 v[20:23], v[40:43], a[12:15], v[20:23]
    ds_read_b128 v[40:43], v4 offset:10240
    v_mfma_f32_16x16x32_bf16 v[28:31], v[44:47], a[12:15], v[28:31]
    v_mfma_f32_16x16x32_bf16 v[24:27], v[44:47], a[8:11], v[24:27]
    ds_read_b128 v[44:47], v4 offset:10496
    s_waitcnt lgkmcnt(6)
    v_mfma_f32_16x16x32_bf16 v[16:19], v[48:51], a[16:19], v[16:19]
    v_mfma_f32_16x16x32_bf16 v[20:23], v[48:51], a[20:23], v[20:23]
    ds_read_b128 v[48:51], v4 offset:12288
    v_mfma_f32_16x16x32_bf16 v[28:31], v[52:55], a[20:23], v[28:31]
    v_mfma_f32_16x16x32_bf16 v[24:27], v[52:55], a[16:19], v[24:27]
    ds_read_b128 v[52:55], v4 offset:12544
    s_waitcnt lgkmcnt(6)
    v_mfma_f32_16x16x32_bf16 v[16:19], v[56:59], a[24:27], v[16:19]
    v_mfma_f32_16x16x32_bf16 v[20:23], v[56:59], a[28:31], v[20:23]
    ds_read_b128 v[56:59], v4 offset:14336
    v_mfma_f32_16x16x32_bf16 v[28:31], v[60:63], a[28:31], v[28:31]
    v_mfma_f32_16x16x32_bf16 v[24:27], v[60:63], a[24:27], v[24:27]
    ds_read_b128 v[60:63], v4 offset:14592
    s_waitcnt lgkmcnt(6)
    v_mfma_f32_16x16x32_bf16 v[16:19], v[32:35], a[32:35], v[16:19]
    v_mfma_f32_16x16x32_bf16 v[20:23], v[32:35], a[36:39], v[20:23]
    ds_read_b128 v[32:35], v4 offset:16384
    v_mfma_f32_16x16x32_bf16 v[28:31], v[36:39], a[36:39], v[28:31]
    v_mfma_f32_16x16x32_bf16 v[24:27], v[36:39], a[32:35], v[24:27]
    ds_read_b128 v[36:39], v4 offset:16640
    s_waitcnt lgkmcnt(6)
    v_mfma_f32_16x16x32_bf16 v[16:19], v[40:43], a[40:43], v[16:19]
    v_mfma_f32_16x16x32_bf16 v[20:23], v[40:43], a[44:47], v[20:23]
    ds_read_b128 v[40:43], v4 offset:18432
    v_mfma_f32_16x16x32_bf16 v[28:31], v[44:47], a[44:47], v[28:31]
    v_mfma_f32_16x16x32_bf16 v[24:27], v[44:47], a[40:43], v[24:27]
    ds_read_b128 v[44:47], v4 offset:18688
    s_waitcnt lgkmcnt(6)
    v_mfma_f32_16x16x32_bf16 v[16:19], v[48:51], a[48:51], v[16:19]
    v_mfma_f32_16x16x32_bf16 v[20:23], v[48:51], a[52:55], v[20:23]
    ds_read_b128 v[48:51], v4 offset:20480
    v_mfma_f32_16x16x32_bf16 v[28:31], v[52:55], a[52:55], v[28:31]
    v_mfma_f32_16x16x32_bf16 v[24:27], v[52:55], a[48:51], v[24:27]
    ds_read_b128 v[52:55], v4 offset:20736
    s_waitcnt lgkmcnt(6)
    v_mfma_f32_16x16x32_bf16 v[16:19], v[56:59], a[56:59], v[16:19]
    v_mfma_f32_16x16x32_bf16 v[20:23], v[56:59], a[60:63], v[20:23]
    ds_read_b128 v[56:59], v4 offset:22528
    v_mfma_f32_16x16x32_bf16 v[28:31], v[60:63], a[60:63], v[28:31]
    v_mfma_f32_16x16x32_bf16 v[24:27], v[60:63], a[56:59], v[24:27]
    ds_read_b128 v[60:63], v4 offset:22784
    s_waitcnt lgkmcnt(6)
    v_mfma_f32_16x16x32_bf16 v[16:19], v[32:35], a[64:67], v[16:19]
    v_mfma_f32_16x16x32_bf16 v[20:23], v[32:35], a[68:71], v[20:23]
    ds_read_b128 v[32:35], v4 offset:24576
    v_mfma_f32_16x16x32_bf16 v[28:31], v[36:39], a[68:71], v[28:31]
    v_mfma_f32_16x16x32_bf16 v[24:27], v[36:39], a[64:67], v[24:27]
    ds_read_b128 v[36:39], v4 offset:24832
    s_waitcnt lgkmcnt(6)
    v_mfma_f32_16x16x32_bf16 v[16:19], v[40:43], a[72:75], v[16:19]
    v_mfma_f32_16x16x32_bf16 v[20:23], v[40:43], a[76:79], v[20:23]
    ds_read_b128 v[40:43], v4 offset:26624
    v_mfma_f32_16x16x32_bf16 v[28:31], v[44:47], a[76:79], v[28:31]
    v_mfma_f32_16x16x32_bf16 v[24:27], v[44:47], a[72:75], v[24:27]
    ds_read_b128 v[44:47], v4 offset:26880
    s_waitcnt lgkmcnt(6)
    v_mfma_f32_16x16x32_bf16 v[16:19], v[48:51], a[80:83], v[16:19]
    v_mfma_f32_16x16x32_bf16 v[20:23], v[48:51], a[84:87], v[20:23]
    ds_read_b128 v[48:51], v4 offset:28672
    v_mfma_f32_16x16x32_bf16 v[28:31], v[52:55], a[84:87], v[28:31]
    v_mfma_f32_16x16x32_bf16 v[24:27], v[52:55], a[80:83], v[24:27]
    ds_read_b128 v[52:55], v4 offset:28928
    s_waitcnt lgkmcnt(6)
    v_mfma_f32_16x16x32_bf16 v[16:19], v[56:59], a[88:91], v[16:19]
    v_mfma_f32_16x16x32_bf16 v[20:23], v[56:59], a[92:95], v[20:23]
    ds_read_b128 v[56:59], v4 offset:30720
    v_mfma_f32_16x16x32_bf16 v[28:31], v[60:63], a[92:95], v[28:31]
    v_mfma_f32_16x16x32_bf16 v[24:27], v[60:63], a[88:91], v[24:27]
    ds_read_b128 v[60:63], v4 offset:30976
    s_waitcnt lgkmcnt(6)
    v_mfma_f32_16x16x32_bf16 v[16:19], v[32:35], a[96:99], v[16:19]
    v_mfma_f32_16x16x32_bf16 v[20:23], v[32:35], a[100:103], v[20:23]
    v_mfma_f32_16x16x32_bf16 v[28:31], v[36:39], a[100:103], v[28:31]
    v_mfma_f32_16x16x32_bf16 v[24:27], v[36:39], a[96:99], v[24:27]
    s_waitcnt lgkmcnt(4)
    v_mfma_f32_16x16x32_bf16 v[16:19], v[40:43], a[104:107], v[16:19]
    v_mfma_f32_16x16x32_bf16 v[20:23], v[40:43], a[108:111], v[20:23]
    v_mfma_f32_16x16x32_bf16 v[28:31], v[44:47], a[108:111], v[28:31]
    v_mfma_f32_16x16x32_bf16 v[24:27], v[44:47], a[104:107], v[24:27]
    s_waitcnt lgkmcnt(2)
    v_mfma_f32_16x16x32_bf16 v[16:19], v[48:51], a[112:115], v[16:19]
    v_mfma_f32_16x16x32_bf16 v[20:23], v[48:51], a[116:119], v[20:23]
    s_cmp_eq_u32 s81, 1
    s_cbranch_scc1 L_g_h2_167
L_g_h2_167_b:
    ds_write_b32 v119, v118
    v_mfma_f32_16x16x32_bf16 v[28:31], v[52:55], a[116:119], v[28:31]
    v_mfma_f32_16x16x32_bf16 v[24:27], v[52:55], a[112:115], v[24:27]
    s_waitcnt lgkmcnt(0)
    v_mfma_f32_16x16x32_bf16 v[16:19], v[56:59], a[120:123], v[16:19]
    v_mfma_f32_16x16x32_bf16 v[20:23], v[56:59], a[124:127], v[20:23]
    v_mfma_f32_16x16x32_bf16 v[28:31], v[60:63], a[124:127], v[28:31]
    v_mfma_f32_16x16x32_bf16 v[24:27], v[60:63], a[120:123], v[24:27]
    v_xor_b32 v4, 0x10000, v4
    s_setprio 0
    s_waitcnt vmcnt(0)
    s_waitcnt lgkmcnt(0)
    s_barrier
    ds_read_b32 v14, v15
    s_nop 6
    ds_write_b128 v5, v[16:19] offset:0
    ds_write_b128 v5, v[20:23] offset:1024
    ds_write_b128 v5, v[24:27] offset:2048
    ds_write_b128 v5, v[28:31] offset:3072
    s_waitcnt lgkmcnt(4)
    v_readfirstlane_b32 s66, v14
    s_add_u32 s60, s60, 1
    s_mov_b32 s65, 0
    s_cmp_le_u32 s62, s60
    s_cbranch_scc1 L_g_dp_168_l
L_g_dp_168_a:
    s_cmp_ge_u32 s62, s66
    s_cbranch_scc1 L_g_dp_168_d
    s_add_u32 s47, s61, 4096
    s_mov_b32 m0, s64
    s_add_u32 s62, s62, 1
    buffer_load_dwordx4 v3, s[12:15], s61 offen offset:0 sc1 lds
    buffer_load_dwordx4 v3, s[12:15], s61 offen offset:1024 sc1 lds
    buffer_load_dwordx4 v3, s[12:15], s61 offen offset:2048 sc1 lds
    buffer_load_dwordx4 v3, s[12:15], s61 offen offset:3072 sc1 lds
    s_add_u32 m0, s64, 4096
    s_add_u32 s61, s61, s85
    buffer_load_dwordx4 v3, s[12:15], s47 offen offset:0 sc1 lds
    buffer_load_dwordx4 v3, s[12:15], s47 offen offset:1024 sc1 lds
    buffer_load_dwordx4 v3, s[12:15], s47 offen offset:2048 sc1 lds
    buffer_load_dwordx4 v3, s[12:15], s47 offen offset:3072 sc1 lds
    s_xor_b32 s64, s64, 0x10000
L_g_dp_168_d:
    s_cmp_lg_u32 s44, 2
    s_cbranch_scc1 L_g_pf_169
    s_cmp_ge_u32 s62, s66
    s_cbranch_scc1 L_g_pf_169
    buffer_load_dword v117, v116, s[12:15], s61 offen sc1
L_g_pf_169:
    s_cmp_le_u32 s66, s60
    s_cbranch_scc1 L_g_ex0_165
    s_cmp_lg_u32 s65, 0
    s_cbranch_scc1 L_g_nw_164
    ds_read_b128 v[32:35], v4 offset:0
    ds_read_b128 v[36:39], v4 offset:256
    ds_read_b128 v[40:43], v4 offset:2048
    ds_read_b128 v[44:47], v4 offset:2304
    ds_read_b128 v[48:51], v4 offset:4096
    ds_read_b128 v[52:55], v4 offset:4352
    ds_read_b128 v[56:59], v4 offset:6144
    ds_read_b128 v[60:63], v4 offset:6400
    s_cmp_lg_u32 s44, 0
    s_cbranch_scc1 L_g_nl_170
    s_mov_b32 s46, s66
    s_cmp_lg_u32 s81, 0
    s_cbranch_scc1 L_g_nl_170_e
    v_cmp_ge_u32 vcc, v12, v11
    s_nop 0
    s_ff1_i32_b64 s46, vcc
    s_lshr_b32 s46, s46, 4
    s_min_u32 s46, s46, 4
    s_add_u32 s46, s46, s54
    s_min_u32 s46, s46, s75
    v_mov_b32 v118, s46
L_g_nl_170_e:
    s_add_u32 s47, s60, 3
    s_min_u32 s47, s47, s75
    s_cmp_lt_u32 s46, s47
    s_cselect_b32 s81, 1, 0
    s_cbranch_scc1 L_g_nl_170
    s_add_u32 s54, s60, 2
    s_mul_i32 s55, s54, s78
    v_add_u32 v12, s55, v113
    v_and_b32 v13, 3, v12
    v_lshl_add_u32 v13, v13, 7, v7
    buffer_load_dword v11, v13, s[12:15], 0 offen sc1
L_g_nl_170:
    s_waitcnt lgkmcnt(8)
    s_branch L_g_loop0_154
L_g_ex0_165:
    s_cmp_lg_u32 s44, 0
    s_cbranch_scc1 L_g_ex0_165_n
    ds_write_b32 v15, v118 offset:20
    s_cmp_ge_u32 s60, s75
    s_cbranch_scc1 L_g_ex0_165_n
    s_sleep 6
    s_add_u32 s54, s60, 0
    s_mul_i32 s55, s54, s78
    v_add_u32 v12, s55, v113
    v_and_b32 v13, 3, v12
    v_lshl_add_u32 v13, v13, 7, v7
    buffer_load_dword v11, v13, s[12:15], 0 offen sc1
    s_waitcnt vmcnt(0)
    v_cmp_ge_u32 vcc, v12, v11
    s_nop 0
    s_ff1_i32_b64 s46, vcc
    s_lshr_b32 s46, s46, 4
    s_min_u32 s46, s46, 4
    s_add_u32 s46, s46, s54
    s_min_u32 s46, s46, s75
    v_mov_b32 v118, s46
    ds_write_b32 v15, v118 offset:20
L_g_ex0_165_n:
    s_waitcnt lgkmcnt(0)
    s_barrier
    ds_read_b32 v14, v15 offset:20
    s_waitcnt lgkmcnt(0)
    v_readfirstlane_b32 s66, v14
    s_barrier
    s_cmp_gt_u32 s66, s60
    s_cbranch_scc1 L_g_restart_151_go
    s_branch L_g_tail_156
L_g_g1r_153:
    s_mov_b32 s65, 1
    s_branch L_g_loop1_155_e
.p2align 6
L_g_loop1_155:
    s_mov_b32 s65, 0
L_g_loop1_155_e:
    s_barrier
    s_bitcmp1_b32 s67, 1
    s_cbranch_scc0 L_g_nfl_171
    s_cmp_lg_u32 s44, 4
    s_cbranch_scc1 L_g_nfl_171_d
    s_mul_i32 s59, s60, s78
    s_add_u32 s59, s59, s87
    v_mov_b32 v10, s59
    buffer_store_dword v10, v115, s[12:15], s52 offen sc1
L_g_nfl_171_d:
    ds_read_b128 v[80:83], v5 offset:0
    ds_read_b128 v[84:87], v5 offset:1024
    ds_read_b128 v[88:91], v5 offset:2048
    ds_read_b128 v[92:95], v5 offset:3072
    s_cmp_le_u32 s62, s60
    s_cbranch_scc1 L_g_dp_176_l
L_g_dp_176_a:
    s_cmp_ge_u32 s62, s66
    s_cbranch_scc1 L_g_dp_176_d
    s_add_u32 s47, s61, 4096
    s_mov_b32 m0, s64
    s_add_u32 s62, s62, 1
    buffer_load_dwordx4 v3, s[12:15], s61 offen offset:0 sc1 lds
    buffer_load_dwordx4 v3, s[12:15], s61 offen offset:1024 sc1 lds
    buffer_load_dwordx4 v3, s[12:15], s61 offen offset:2048 sc1 lds
    buffer_load_dwordx4 v3, s[12:15], s61 offen offset:3072 sc1 lds
    s_add_u32 m0, s64, 4096
    s_add_u32 s61, s61, s85
    buffer_load_dwordx4 v3, s[12:15], s47 offen offset:0 sc1 lds
    buffer_load_dwordx4 v3, s[12:15], s47 offen offset:1024 sc1 lds
    buffer_load_dwordx4 v3, s[12:15], s47 offen offset:2048 sc1 lds
    buffer_load_dwordx4 v3, s[12:15], s47 offen offset:3072 sc1 lds
    s_xor_b32 s64, s64, 0x10000
L_g_dp_176_d:
    s_bitcmp1_b32 s67, 0
    s_cbranch_scc0 L_g_nep_172
    s_waitcnt lgkmcnt(0)
    v_add_f32 v80, v80, v16
    v_add_f32 v81, v81, v17
    v_add_f32 v82, v82, v18
    v_add_f32 v83, v83, v19
    v_add_f32 v84, v84, v20
    v_add_f32 v85, v85, v21
    v_add_f32 v86, v86, v22
    v_add_f32 v87, v87, v23
    v_add_f32 v88, v88, v24
    v_add_f32 v89, v89, v25
    v_add_f32 v90, v90, v26
    v_add_f32 v91, v91, v27
    v_add_f32 v92, v92, v28
    v_add_f32 v93, v93, v29
    v_add_f32 v94, v94, v30
    v_add_f32 v95, v95, v31
    v_cvt_pk_bf16_f32 v104, v80, v81
    v_cvt_pk_bf16_f32 v105, v82, v83
    v_cvt_pk_bf16_f32 v106, v84, v85
    v_cvt_pk_bf16_f32 v107, v86, v87
    s_nop 1
    v_permlane16_swap_b32 v104, v106
    v_permlane16_swap_b32 v105, v107
    buffer_store_dwordx4 v[104:107], v8, s[12:15], s63 offen sc1
    v_cvt_pk_bf16_f32 v108, v88, v89
    v_cvt_pk_bf16_f32 v109, v90, v91
    v_cvt_pk_bf16_f32 v110, v92, v93
    v_cvt_pk_bf16_f32 v111, v94, v95
    s_nop 1
    v_permlane16_swap_b32 v108, v110
    v_permlane16_swap_b32 v109, v111
    buffer_store_dwordx4 v[108:111], v9, s[12:15], s63 offen sc1
    s_add_u32 s63, s63, s86
L_g_nep_172:
    s_cmp_lg_u32 s65, 0
    s_cbranch_scc1 L_g_nw1_173
    ds_read_b128 v[32:35], v4 offset:0
    ds_read_b128 v[36:39], v4 offset:256
    ds_read_b128 v[40:43], v4 offset:2048
    ds_read_b128 v[44:47], v4 offset:2304
    ds_read_b128 v[48:51], v4 offset:4096
    ds_read_b128 v[52:55], v4 offset:4352
    ds_read_b128 v[56:59], v4 offset:6144
    ds_read_b128 v[60:63], v4 offset:6400
    s_barrier
L_g_jn_175:
    s_setprio 1
    s_waitcnt lgkmcnt(6)
    v_mfma_f32_16x16x32_bf16 v[16:19], v[32:35], a[0:3], 0
    ds_read_b32 v14, v15
    v_mfma_f32_16x16x32_bf16 v[20:23], v[32:35], a[4:7], 0
    ds_read_b128 v[32:35], v4 offset:8192
    v_mfma_f32_16x16x32_bf16 v[28:31], v[36:39], a[4:7], 0
    v_mfma_f32_16x16x32_bf16 v[24:27], v[36:39], a[0:3], 0
    ds_read_b128 v[36:39], v4 offset:8448
    s_waitcnt lgkmcnt(6)
    v_mfma_f32_16x16x32_bf16 v[16:19], v[40:43], a[8:11], v[16:19]
    v_mfma_f32_16x16x32_bf16 v[20:23], v[40:43], a[12:15], v[20:23]
    ds_read_b128 v[40:43], v4 offset:10240
    v_mfma_f32_16x16x32_bf16 v[28:31], v[44:47], a[12:15], v[28:31]
    v_mfma_f32_16x16x32_bf16 v[24:27], v[44:47], a[8:11], v[24:27]
    ds_read_b128 v[44:47], v4 offset:10496
    s_waitcnt lgkmcnt(6)
    v_mfma_f32_16x16x32_bf16 v[16:19], v[48:51], a[16:19], v[16:19]
    v_mfma_f32_16x16x32_bf16 v[20:23], v[48:51], a[20:23], v[20:23]
    ds_read_b128 v[48:51], v4 offset:12288
    v_mfma_f32_16x16x32_bf16 v[28:31], v[52:55], a[20:23], v[28:31]
    v_mfma_f32_16x16x32_bf16 v[24:27], v[52:55], a[16:19], v[24:27]
    ds_read_b128 v[52:55], v4 offset:12544
    s_waitcnt lgkmcnt(6)
    v_mfma_f32_16x16x32_bf16 v[16:19], v[56:59], a[24:27], v[16:19]
    v_mfma_f32_16x16x32_bf16 v[20:23], v[56:59], a[28:31], v[20:23]
    ds_read_b128 v[56:59], v4 offset:14336
    v_mfma_f32_16x16x32_bf16 v[28:31], v[60:63], a[28:31], v[28:31]
    v_mfma_f32_16x16x32_bf16 v[24:27], v[60:63], a[24:27], v[24:27]
    ds_read_b128 v[60:63], v4 offset:14592
    s_waitcnt lgkmcnt(6)
    v_mfma_f32_16x16x32_bf16 v[16:19], v[32:35], a[32:35], v[16:19]
    v_mfma_f32_16x16x32_bf16 v[20:23], v[32:35], a[36:39], v[20:23]
    ds_read_b128 v[32:35], v4 offset:16384
    v_mfma_f32_16x16x32_bf16 v[28:31], v[36:39], a[36:39], v[28:31]
    v_mfma_f32_16x16x32_bf16 v[24:27], v[36:39], a[32:35], v[24:27]
    ds_read_b128 v[36:39], v4 offset:16640
    s_waitcnt lgkmcnt(6)
    v_mfma_f32_16x16x32_bf16 v[16:19], v[40:43], a[40:43], v[16:19]
    v_mfma_f32_16x16x32_bf16 v[20:23], v[40:43], a[44:47], v[20:23]
    ds_read_b128 v[40:43], v4 offset:18432
    v_mfma_f32_16x16x32_bf16 v[28:31], v[44:47], a[44:47], v[28:31]
    v_mfma_f32_16x16x32_bf16 v[24:27], v[44:47], a[40:43], v[24:27]
    ds_read_b128 v[44:47], v4 offset:18688
    s_waitcnt lgkmcnt(6)
    v_mfma_f32_16x16x32_bf16 v[16:19], v[48:51], a[48:51], v[16:19]
    v_mfma_f32_16x16x32_bf16 v[20:23], v[48:51], a[52:55], v[20:23]
    ds_read_b128 v[48:51], v4 offset:20480
    v_mfma_f32_16x16x32_bf16 v[28:31], v[52:55], a[52:55], v[28:31]
    v_mfma_f32_16x16x32_bf16 v[24:27], v[52:55], a[48:51], v[24:27]
    ds_read_b128 v[52:55], v4 offset:20736
    s_waitcnt lgkmcnt(6)
    v_mfma_f32_16x16x32_bf16 v[16:19], v[56:59], a[56:59], v[16:19]
    v_mfma_f32_16x16x32_bf16 v[20:23], v[56:59], a[60:63], v[20:23]
    ds_read_b128 v[56:59], v4 offset:22528
    v_mfma_f32_16x16x32_bf16 v[28:31], v[60:63], a[60:63], v[28:31]
    v_mfma_f32_16x16x32_bf16 v[24:27], v[60:63], a[56:59], v[24:27]
    ds_read_b128 v[60:63], v4 offset:22784
    s_waitcnt lgkmcnt(6)
    v_mfma_f32_16x16x32_bf16 v[16:19], v[32:35], a[64:67], v[16:19]
    v_mfma_f32_16x16x32_bf16 v[20:23], v[32:35], a[68:71], v[20:23]
    ds_read_b128 v[32:35], v4 offset:24576
    v_mfma_f32_16x16x32_bf16 v[28:31], v[36:39], a[68:71], v[28:31]
    v_mfma_f32_16x16x32_bf16 v[24:27], v[36:39], a[64:67], v[24:27]
    ds_read_b128 v[36:39], v4 offset:24832
    s_waitcnt lgkmcnt(6)
    v_mfma_f32_16x16x32_bf16 v[16:19], v[40:43], a[72:75], v[16:19]
    v_mfma_f32_16x16x32_bf16 v[20:23], v[40:43], a[76:79], v[20:23]
    ds_read_b128 v[40:43], v4 offset:26624
    v_mfma_f32_16x16x32_bf16 v[28:31], v[44:47], a[76:79], v[28:31]
    v_mfma_f32_16x16x32_bf16 v[24:27], v[44:47], a[72:75], v[24:27]
    ds_read_b128 v[44:47], v4 offset:26880
    s_waitcnt lgkmcnt(6)
    v_mfma_f32_16x16x32_bf16 v[16:19], v[48:51], a[80:83], v[16:19]
    v_mfma_f32_16x16x32_bf16 v[20:23], v[48:51], a[84:87], v[20:23]
    ds_read_b128 v[48:51], v4 offset:28672
    v_mfma_f32_16x16x32_bf16 v[28:31], v[52:55], a[84:87], v[28:31]
    v_mfma_f32_16x16x32_bf16 v[24:27], v[52:55], a[80:83], v[24:27]
    ds_read_b128 v[52:55], v4 offset:28928
    s_waitcnt lgkmcnt(6)
    v_mfma_f32_16x16x32_bf16 v[16:19], v[56:59], a[88:91], v[16:19]
    v_mfma_f32_16x16x32_bf16 v[20:23], v[56:59], a[92:95], v[20:23]
    ds_read_b128 v[56:59], v4 offset:30720
    v_mfma_f32_16x16x32_bf16 v[28:31], v[60:63], a[92:95], v[28:31]
    v_mfma_f32_16x16x32_bf16 v[24:27], v[60:63], a[88:91], v[24:27]
    ds_read_b128 v[60:63], v4 offset:30976
    s_waitcnt lgkmcnt(6)
    v_mfma_f32_16x16x32_bf16 v[16:19], v[32:35], a[96:99], v[16:19]
    v_mfma_f32_16x16x32_bf16 v[20:23], v[32:35], a[100:103], v[20:23]
    v_mfma_f32_16x16x32_bf16 v[28:31], v[36:39], a[100:103], v[28:31]
    v_mfma_f32_16x16x32_bf16 v[24:27], v[36:39], a[96:99], v[24:27]
    s_waitcnt lgkmcnt(4)
    v_mfma_f32_16x16x32_bf16 v[16:19], v[40:43], a[104:107], v[16:19]
    v_mfma_f32_16x16x32_bf16 v[20:23], v[40:43], a[108:111], v[20:23]
    v_mfma_f32_16x16x32_bf16 v[28:31], v[44:47], a[108:111], v[28:31]
    v_mfma_f32_16x16x32_bf16 v[24:27], v[44:47], a[104:107], v[24:27]
    s_waitcnt lgkmcnt(2)
    v_mfma_f32_16x16x32_bf16 v[16:19], v[48:51], a[112:115], v[16:19]
    v_mfma_f32_16x16x32_bf16 v[20:23], v[48:51], a[116:119], v[20:23]
    v_mfma_f32_16x16x32_bf16 v[28:31], v[52:55], a[116:119], v[28:31]
    v_mfma_f32_16x16x32_bf16 v[24:27], v[52:55], a[112:115], v[24:27]
    s_waitcnt lgkmcnt(0)
    v_mfma_f32_16x16x32_bf16 v[16:19], v[56:59], a[120:123], v[16:19]
    v_mfma_f32_16x16x32_bf16 v[20:23], v[56:59], a[124:127], v[20:23]
    v_mfma_f32_16x16x32_bf16 v[28:31], v[60:63], a[124:127], v[28:31]
    v_mfma_f32_16x16x32_bf16 v[24:27], v[60:63], a[120:123], v[24:27]
    v_xor_b32 v4, 0x10000, v4
    s_setprio 0
    s_waitcnt vmcnt(0)
    v_readfirstlane_b32 s66, v14
    s_lshl_b32 s67, s67, 1
    s_or_b32 s67, s67, 1
    s_add_u32 s60, s60, 1
    s_cmp_gt_u32 s66, s60
    s_cbranch_scc1 L_g_loop1_155
    s_barrier
    ds_read_b32 v14, v15 offset:20
    ds_read_b128 v[80:83], v5 offset:0
    ds_read_b128 v[84:87], v5 offset:1024
    ds_read_b128 v[88:91], v5 offset:2048
    ds_read_b128 v[92:95], v5 offset:3072
    s_waitcnt lgkmcnt(4)
    v_readfirstlane_b32 s66, v14
    s_barrier
    s_mov_b32 s69, 0
    s_cmp_gt_u32 s62, s60
    s_cbranch_scc1 L_g_nd_177
    s_cmp_ge_u32 s62, s66
    s_cbranch_scc1 L_g_nd_177
    s_add_u32 s47, s61, 4096
    s_add_u32 m0, s64, 0
    s_nop 0
    buffer_load_dwordx4 v3, s[12:15], s61 offen offset:0 sc1 lds
    buffer_load_dwordx4 v3, s[12:15], s61 offen offset:1024 sc1 lds
    buffer_load_dwordx4 v3, s[12:15], s61 offen offset:2048 sc1 lds
    buffer_load_dwordx4 v3, s[12:15], s61 offen offset:3072 sc1 lds
    s_add_u32 m0, s64, 4096
    s_nop 0
    buffer_load_dwordx4 v3, s[12:15], s47 offen offset:0 sc1 lds
    buffer_load_dwordx4 v3, s[12:15], s47 offen offset:1024 sc1 lds
    buffer_load_dwordx4 v3, s[12:15], s47 offen offset:2048 sc1 lds
    buffer_load_dwordx4 v3, s[12:15], s47 offen offset:3072 sc1 lds
    s_add_u32 s61, s61, s85
    s_add_u32 s62, s62, 1
    s_xor_b32 s64, s64, 0x10000
    s_mov_b32 s69, 1
L_g_nd_177:
    s_waitcnt lgkmcnt(3)
    v_add_f32 v80, v80, v16
    v_add_f32 v81, v81, v17
    v_add_f32 v82, v82, v18
    v_add_f32 v83, v83, v19
    s_waitcnt lgkmcnt(2)
    v_add_f32 v84, v84, v20
    v_add_f32 v85, v85, v21
    v_add_f32 v86, v86, v22
    v_add_f32 v87, v87, v23
    s_waitcnt lgkmcnt(1)
    v_add_f32 v88, v88, v24
    v_add_f32 v89, v89, v25
    v_add_f32 v90, v90, v26
    v_add_f32 v91, v91, v27
    s_waitcnt lgkmcnt(0)
    v_add_f32 v92, v92, v28
    v_add_f32 v93, v93, v29
    v_add_f32 v94, v94, v30
    v_add_f32 v95, v95, v31
    v_cvt_pk_bf16_f32 v104, v80, v81
    v_cvt_pk_bf16_f32 v105, v82, v83
    v_cvt_pk_bf16_f32 v106, v84, v85
    v_cvt_pk_bf16_f32 v107, v86, v87
    s_nop 1
    v_permlane16_swap_b32 v104, v106
    v_permlane16_swap_b32 v105, v107
    buffer_store_dwordx4 v[104:107], v8, s[12:15], s63 offen sc1
    v_cvt_pk_bf16_f32 v108, v88, v89
    v_cvt_pk_bf16_f32 v109, v90, v91
    v_cvt_pk_bf16_f32 v110, v92, v93
    v_cvt_pk_bf16_f32 v111, v94, v95
    s_nop 1
    v_permlane16_swap_b32 v108, v110
    v_permlane16_swap_b32 v109, v111
    buffer_store_dwordx4 v[108:111], v9, s[12:15], s63 offen sc1
    s_add_u32 s63, s63, s86
    s_mov_b32 s67, 0
    s_mov_b32 s71, 1
    s_cmp_gt_u32 s66, s60
    s_cbranch_scc1 L_g_g1r_153
    v_mov_b32 v10, 1
    s_mov_b64 exec, 1
    s_waitcnt vmcnt(0)
    ds_add_rtn_u32 v10, v15, v10 offset:4
    s_waitcnt lgkmcnt(0)
    v_readfirstlane_b32 s46, v10
    s_mov_b64 exec, -1
    s_mov_b32 s71, 0
    s_sub_u32 s59, s60, 1
    s_mul_i32 s59, s59, s78
    s_add_u32 s59, s59, s74
    s_cmp_lg_u32 s46, s68
    s_cbranch_scc1 L_g_df_178
    v_mov_b32 v10, s59
    v_add_u32 v10, 1, v10
    v_mov_b32 v11, 0
    s_mov_b64 exec, 1
    buffer_store_dword v10, v11, s[12:15], s52 offen sc1
    s_mov_b64 exec, -1
L_sf_179:
L_g_df_178:
    s_add_u32 s68, s68, 4
    s_cmp_gt_u32 s66, s60
    s_cbranch_scc1 L_g_g1r_153
L_g_tail_156:
    s_cmp_lt_u32 s60, s75
    s_cbranch_scc1 L_g_restart_151
    s_waitcnt vmcnt(0)
    s_barrier
    s_branch L_c_done_1
L_g_h1_166:
    s_add_u32 s54, s60, 1
    s_mul_i32 s55, s54, s78
    v_add_u32 v12, s55, v113
    v_and_b32 v13, 3, v12
    v_lshl_add_u32 v13, v13, 7, v7
    buffer_load_dword v11, v13, s[12:15], 0 offen sc1
    s_branch L_g_h1_166_b
L_g_h2_167:
    s_waitcnt vmcnt(0)
    v_cmp_ge_u32 vcc, v12, v11
    s_nop 0
    s_ff1_i32_b64 s46, vcc
    s_lshr_b32 s46, s46, 4
    s_min_u32 s46, s46, 4
    s_add_u32 s46, s46, s54
    s_min_u32 s46, s46, s75
    v_mov_b32 v118, s46
    s_branch L_g_h2_167_b
L_g_dp_168_l:
    s_cmp_ge_u32 s62, s66
    s_cbranch_scc1 L_g_dp_168_d
    s_mov_b32 s65, 1
    s_add_u32 s47, s61, 4096
    s_mov_b32 m0, s64
    s_add_u32 s62, s62, 1
    buffer_load_dwordx4 v3, s[12:15], s61 offen offset:0 sc1 lds
    buffer_load_dwordx4 v3, s[12:15], s61 offen offset:1024 sc1 lds
    buffer_load_dwordx4 v3, s[12:15], s61 offen offset:2048 sc1 lds
    buffer_load_dwordx4 v3, s[12:15], s61 offen offset:3072 sc1 lds
    s_add_u32 m0, s64, 4096
    s_add_u32 s61, s61, s85
    buffer_load_dwordx4 v3, s[12:15], s47 offen offset:0 sc1 lds
    buffer_load_dwordx4 v3, s[12:15], s47 offen offset:1024 sc1 lds
    buffer_load_dwordx4 v3, s[12:15], s47 offen offset:2048 sc1 lds
    buffer_load_dwordx4 v3, s[12:15], s47 offen offset:3072 sc1 lds
    s_xor_b32 s64, s64, 0x10000
    s_branch L_g_dp_168_a
L_g_nw_164:
    s_waitcnt vmcnt(0) lgkmcnt(0)
    s_cmp_lg_u32 s44, 0
    s_cbranch_scc1 L_g_nl_180
    s_cmp_lt_u32 s66, s75
    s_cselect_b32 s81, 1, 2
L_g_nl_180:
    s_branch L_g_loop0_154_l
L_g_nfl_171:
    s_cmp_eq_u32 s71, 0
    s_cbranch_scc1 L_g_nfl_171_d
    v_mov_b32 v10, 1
    s_mov_b64 exec, 1
    s_waitcnt vmcnt(0)
    ds_add_rtn_u32 v10, v15, v10 offset:4
    s_waitcnt lgkmcnt(0)
    v_readfirstlane_b32 s46, v10
    s_mov_b64 exec, -1
    s_mov_b32 s71, 0
    s_sub_u32 s59, s60, 1
    s_mul_i32 s59, s59, s78
    s_add_u32 s59, s59, s74
    s_cmp_lg_u32 s46, s68
    s_cbranch_scc1 L_g_df_181
    v_mov_b32 v10, s59
    v_add_u32 v10, 1, v10
    v_mov_b32 v11, 0
    s_mov_b64 exec, 1
    buffer_store_dword v10, v11, s[12:15], s52 offen sc1
    s_mov_b64 exec, -1
L_sf_182:
L_g_df_181:
    s_add_u32 s68, s68, 4
    s_mov_b32 s65, 2
    s_branch L_g_nfl_171_d
L_g_dp_176_l:
    s_cmp_ge_u32 s62, s66
    s_cbranch_scc1 L_g_dp_176_d
    s_or_b32 s65, s65, 1
    s_add_u32 s47, s61, 4096
    s_mov_b32 m0, s64
    s_add_u32 s62, s62, 1
    buffer_load_dwordx4 v3, s[12:15], s61 offen offset:0 sc1 lds
    buffer_load_dwordx4 v3, s[12:15], s61 offen offset:1024 sc1 lds
    buffer_load_dwordx4 v3, s[12:15], s61 offen offset:2048 sc1 lds
    buffer_load_dwordx4 v3, s[12:15], s61 offen offset:3072 sc1 lds
    s_add_u32 m0, s64, 4096
    s_add_u32 s61, s61, s85
    buffer_load_dwordx4 v3, s[12:15], s47 offen offset:0 sc1 lds
    buffer_load_dwordx4 v3, s[12:15], s47 offen offset:1024 sc1 lds
    buffer_load_dwordx4 v3, s[12:15], s47 offen offset:2048 sc1 lds
    buffer_load_dwordx4 v3, s[12:15], s47 offen offset:3072 sc1 lds
    s_xor_b32 s64, s64, 0x10000
    s_branch L_g_dp_176_a
L_g_nw1_173:
    s_cmp_eq_u32 s65, 2
    s_cbranch_scc1 L_g_nw1_173_w
    s_waitcnt vmcnt(0)
L_g_nw1_173_w:
    s_barrier
    ds_read_b128 v[32:35], v4 offset:0
    ds_read_b128 v[36:39], v4 offset:256
    ds_read_b128 v[40:43], v4 offset:2048
    ds_read_b128 v[44:47], v4 offset:2304
    ds_read_b128 v[48:51], v4 offset:4096
    ds_read_b128 v[52:55], v4 offset:4352
    ds_read_b128 v[56:59], v4 offset:6144
    ds_read_b128 v[60:63], v4 offset:6400
    s_branch L_g_jn_175
L_c_chain_7:
    v_mov_b32 v4, 0
    v_mov_b32 v5, 0
    v_mov_b32 v6, 0
    v_mov_b32 v7, 0
    v_mov_b32 v8, 0
    v_mov_b32 v9, 0
    v_mov_b32 v10, 0
    v_mov_b32 v11, 0
    v_mov_b32 v12, 0
    v_mov_b32 v13, 0
    v_mov_b32 v14, 0
    v_mov_b32 v15, 0
    v_mov_b32 v32, -1
    v_mov_b32 v33, -1
    v_mov_b32 v34, -1
    v_mov_b32 v35, -1
    v_lshlrev_b32 v2, 4, v1
    s_lshl_b32 s45, s40, 16
    s_lshl_b32 s46, s41, 12
    s_add_u32 s45, s45, s46
    s_and_b32 s46, s44, 3
    s_lshl_b32 s46, s46, 10
    s_add_u32 s45, s45, s46
    s_lshr_b32 s46, s44, 2
    s_lshl_b32 s46, s46, 19
    s_add_u32 s45, s45, s46
    s_add_u32 s45, s45, 0x7000000
    buffer_store_dwordx4 v[32:35], v2, s[12:15], s45 offen sc1
    s_lshl_b32 s45, s40, 15
    s_lshl_b32 s46, s41, 11
    s_add_u32 s45, s45, s46
    s_lshl_b32 s46, s44, 8
    s_add_u32 s45, s45, s46
    s_add_u32 s45, s45, 0x7100000
    s_mov_b64 exec, 0xffff
    buffer_store_dwordx4 v[32:35], v2, s[12:15], s45 offen sc1
    s_lshl_b32 s45, s40, 16
    s_lshl_b32 s46, s41, 8
    s_add_u32 s45, s45, s46
    s_and_b32 s46, s44, 3
    s_lshl_b32 s46, s46, 14
    s_add_u32 s45, s45, s46
    s_add_u32 s45, s45, 0x7180000
    buffer_store_dwordx4 v[32:35], v2, s[12:15], s45 offen sc1
    s_mov_b64 exec, -1
    s_and_b32 s47, s44, 3
    s_cmp_eq_u32 s47, 3
    s_cbranch_scc1 L_c_t3_183
    s_cmp_eq_u32 s40, 7
    s_cselect_b32 s46, 8, 4
    s_cmp_ge_u32 s44, s46
    s_cbranch_scc1 L_c_t3_183
    s_lshl_b32 s46, s47, 3
    s_add_u32 s46, s46, 16
    s_load_dwordx2 s[4:5], s[0:1], s46
    v_lshlrev_b32 v2, 13, v1
    s_lshl_b32 s45, s41, 19
    s_lshl_b32 s46, s40, 10
    s_add_u32 s45, s45, s46
    s_add_u32 s45, s45, 384
    s_lshr_b32 s46, s44, 2
    s_lshl_b32 s46, s46, 9
    s_add_u32 s45, s45, s46
    s_waitcnt lgkmcnt(0)
    s_mov_b32 s24, s4
    s_and_b32 s25, s5, 0xffff
    s_mov_b32 s26, 0x800000
    s_mov_b32 s27, 0x00020000
    buffer_load_dword v110, v2, s[24:27], s45 offen
L_c_t3_183:
    s_cmp_lg_u32 s44, 3
    s_cbranch_scc1 L_c_t3_183_o
    s_load_dwordx2 s[4:5], s[0:1], 40
    v_lshlrev_b32 v2, 10, v1
    s_lshl_b32 s45, s40, 20
    s_lshl_b32 s46, s41, 16
    s_add_u32 s45, s45, s46
    s_add_u32 s45, s45, 384
    s_waitcnt lgkmcnt(0)
    s_mov_b32 s24, s4
    s_and_b32 s25, s5, 0xffff
    s_mov_b32 s26, 0x800000
    s_mov_b32 s27, 0x00020000
    buffer_load_dword v110, v2, s[24:27], s45 offen
L_c_t3_183_o:
    v_lshlrev_b32 v2, 4, v1
    v_and_b32 v3, 8, v1
    v_cmp_eq_u32 vcc, 0, v3
    v_mov_b32 v3, 0xeeeeeeee
    v_mov_b32 v4, 0x44444444
    v_cndmask_b32 v3, v3, v4, vcc
    v_and_b32 v100, 15, v1
    v_lshrrev_b32 v101, 4, v1
    v_and_b32 v102, 1, v101
    v_lshrrev_b32 v103, 1, v101
    v_lshlrev_b32 v104, 2, v102
    v_lshl_add_u32 v104, v103, 1, v104
    v_and_b32 v105, 1, v1
    v_add_u32 v104, v104, v105
    v_and_b32 v106, 7, v1
    v_bfe_u32 v107, v1, 3, 1
    s_lshr_b32 s42, s41, 2
    s_and_b32 s43, s41, 3
    s_lshl_b32 s49, s40, 2
    s_add_u32 s49, s49, s42
    s_lshl_b32 s45, s44, 14
    v_lshlrev_b32 v22, 3, v101
    v_bfe_u32 v23, v1, 2, 2
    v_add_u32 v22, v22, v23
    v_and_b32 v23, 3, v1
    v_lshlrev_b32 v24, 3, v23
    v_lshl_add_u32 v20, v22, 6, v24
    v_lshl_add_u32 v21, v22, 7, v24
    v_lshrrev_b32 v22, 2, v1
    v_lshlrev_b32 v23, 4, v23
    v_lshl_add_u32 v24, v22, 13, v23
    v_lshrrev_b32 v22, 3, v1
    v_lshlrev_b32 v23, 4, v106
    v_lshl_add_u32 v25, v22, 11, v23
    s_cmp_ge_u32 s44, 4
    s_cbranch_scc1 L_v_init_184
    s_lshr_b32 s50, s44, 1
    s_and_b32 s51, s44, 1
    s_load_dwordx4 s[4:7], s[0:1], 16
    s_lshl_b32 s46, s49, 8
    s_lshl_b32 s48, s43, 6
    s_add_u32 s46, s46, s48
    s_lshl_b32 s48, s44, 21
    s_add_u32 s46, s46, s48
    s_lshl_b32 s52, s51, 5
    s_xor_b32 s53, s50, 1
    s_lshl_b32 s53, s53, 16
    s_add_u32 s52, s52, s53
    v_add_u32 v20, s52, v20
    s_waitcnt lgkmcnt(0)
    s_mov_b32 s24, s6
    s_and_b32 s25, s7, 0xffff
    s_mov_b32 s26, 0x800000
    s_mov_b32 s27, 0x00020000
    s_mov_b32 s28, s4
    s_and_b32 s29, s5, 0xffff
    s_mov_b32 s30, 0x800000
    s_mov_b32 s31, 0x00020000
    s_lshl_b32 s52, s51, 9
    s_lshl_b32 s53, s50, 7
    s_add_u32 s52, s52, s53
    s_add_u32 s52, s52, 61440
    v_lshlrev_b32 v5, 1, v106
    v_lshl_add_u32 v5, v107, 8, v5
    v_lshl_add_u32 v5, v102, 6, v5
    v_lshl_add_u32 v5, v103, 5, v5
    v_add_u32 v5, s52, v5
    s_lshl_b32 s67, s49, 12
    s_lshl_b32 s53, s43, 10
    s_add_u32 s67, s67, s53
    s_add_u32 s67, s67, 0x1000000
    s_lshl_b32 s52, s40, 16
    s_lshl_b32 s53, s44, 11
    s_add_u32 s53, s52, s53
    s_add_u32 s53, s53, 0x7080000
    v_lshlrev_b32 v7, 3, v1
    v_add_u32 v7, s53, v7
    s_lshl_b32 s53, s44, 9
    s_add_u32 s53, s52, s53
    s_add_u32 s53, s53, 0x7180000
    v_lshlrev_b32 v28, 6, v103
    v_lshl_add_u32 v28, v106, 3, v28
    v_lshl_add_u32 v28, v102, 2, v28
    v_lshl_add_u32 v28, v107, 1, v28
    v_add_u32 v28, s53, v28
    s_lshl_b32 s52, s44, 10
    s_add_u32 s52, s52, 16384
    v_lshlrev_b32 v8, 8, v101
    v_lshl_add_u32 v8, v106, 4, v8
    v_lshl_add_u32 v8, v107, 3, v8
    v_add_u32 v8, s52, v8
    s_lshl_b32 s52, s44, 8
    s_add_u32 s52, s52, 20480
    v_lshlrev_b32 v9, 4, v106
    v_lshl_add_u32 v9, v101, 2, v9
    v_lshl_add_u32 v9, v107, 1, v9
    v_add_u32 v9, s52, v9
    s_mov_b32 s66, 0x3e0293ee
    s_xor_b32 s52, s44, 2
    s_xor_b32 s53, s41, 6
    s_or_b32 s52, s52, s53
    s_cbranch_scc1 L_c_join_185_q
    s_lshl_b32 s52, s40, 21
    s_add_u32 s52, s52, 0x79c0000
    v_and_b32 v10, 31, v1
    v_lshlrev_b32 v10, 4, v10
    v_lshl_add_u32 v10, v103, 13, v10
    buffer_store_dwordx4 v[32:35], v10, s[12:15], s52 offen sc1
    s_add_u32 s52, s52, 0x1000
    s_load_dword s47, s[22:23], s52
L_c_join_185_q:
    s_add_u32 m0, s45, 0
    s_add_u32 s48, s46, 0x0
    buffer_load_dwordx4 v24, s[24:27], s48 offen  lds
    s_add_u32 m0, s45, 1024
    s_add_u32 s48, s46, 0x20000
    buffer_load_dwordx4 v24, s[24:27], s48 offen  lds
    s_add_u32 m0, s45, 2048
    s_add_u32 s48, s46, 0x40000
    buffer_load_dwordx4 v24, s[24:27], s48 offen  lds
    s_add_u32 m0, s45, 3072
    s_add_u32 s48, s46, 0x60000
    buffer_load_dwordx4 v24, s[24:27], s48 offen  lds
    s_add_u32 m0, s45, 4096
    s_add_u32 s48, s46, 0x80000
    buffer_load_dwordx4 v24, s[24:27], s48 offen  lds
    s_add_u32 m0, s45, 5120
    s_add_u32 s48, s46, 0xa0000
    buffer_load_dwordx4 v24, s[24:27], s48 offen  lds
    s_add_u32 m0, s45, 6144
    s_add_u32 s48, s46, 0xc0000
    buffer_load_dwordx4 v24, s[24:27], s48 offen  lds
    s_add_u32 m0, s45, 7168
    s_add_u32 s48, s46, 0xe0000
    buffer_load_dwordx4 v24, s[24:27], s48 offen  lds
    s_add_u32 m0, s45, 8192
    s_add_u32 s48, s46, 0x100000
    buffer_load_dwordx4 v24, s[24:27], s48 offen  lds
    s_add_u32 m0, s45, 9216
    s_add_u32 s48, s46, 0x120000
    buffer_load_dwordx4 v24, s[24:27], s48 offen  lds
    s_add_u32 m0, s45, 10240
    s_add_u32 s48, s46, 0x140000
    buffer_load_dwordx4 v24, s[24:27], s48 offen  lds
    s_add_u32 m0, s45, 11264
    s_add_u32 s48, s46, 0x160000
    buffer_load_dwordx4 v24, s[24:27], s48 offen  lds
    s_add_u32 m0, s45, 12288
    s_add_u32 s48, s46, 0x180000
    buffer_load_dwordx4 v24, s[24:27], s48 offen  lds
    s_add_u32 m0, s45, 13312
    s_add_u32 s48, s46, 0x1a0000
    buffer_load_dwordx4 v24, s[24:27], s48 offen  lds
    s_add_u32 m0, s45, 14336
    s_add_u32 s48, s46, 0x1c0000
    buffer_load_dwordx4 v24, s[24:27], s48 offen  lds
    s_add_u32 m0, s45, 15360
    s_add_u32 s48, s46, 0x1e0000
    buffer_load_dwordx4 v24, s[24:27], s48 offen  lds
    s_add_u32 s45, s45, 0x10000
    s_add_u32 m0, s45, 0
    s_add_u32 s48, s46, 0x0
    buffer_load_dwordx4 v24, s[28:31], s48 offen  lds
    s_add_u32 m0, s45, 1024
    s_add_u32 s48, s46, 0x20000
    buffer_load_dwordx4 v24, s[28:31], s48 offen  lds
    s_add_u32 m0, s45, 2048
    s_add_u32 s48, s46, 0x40000
    buffer_load_dwordx4 v24, s[28:31], s48 offen  lds
    s_add_u32 m0, s45, 3072
    s_add_u32 s48, s46, 0x60000
    buffer_load_dwordx4 v24, s[28:31], s48 offen  lds
    s_add_u32 m0, s45, 4096
    s_add_u32 s48, s46, 0x80000
    buffer_load_dwordx4 v24, s[28:31], s48 offen  lds
    s_add_u32 m0, s45, 5120
    s_add_u32 s48, s46, 0xa0000
    buffer_load_dwordx4 v24, s[28:31], s48 offen  lds
    s_add_u32 m0, s45, 6144
    s_add_u32 s48, s46, 0xc0000
    buffer_load_dwordx4 v24, s[28:31], s48 offen  lds
    s_add_u32 m0, s45, 7168
    s_add_u32 s48, s46, 0xe0000
    buffer_load_dwordx4 v24, s[28:31], s48 offen  lds
    s_add_u32 m0, s45, 8192
    s_add_u32 s48, s46, 0x100000
    buffer_load_dwordx4 v24, s[28:31], s48 offen  lds
    s_add_u32 m0, s45, 9216
    s_add_u32 s48, s46, 0x120000
    buffer_load_dwordx4 v24, s[28:31], s48 offen  lds
    s_add_u32 m0, s45, 10240
    s_add_u32 s48, s46, 0x140000
    buffer_load_dwordx4 v24, s[28:31], s48 offen  lds
    s_add_u32 m0, s45, 11264
    s_add_u32 s48, s46, 0x160000
    buffer_load_dwordx4 v24, s[28:31], s48 offen  lds
    s_add_u32 m0, s45, 12288
    s_add_u32 s48, s46, 0x180000
    buffer_load_dwordx4 v24, s[28:31], s48 offen  lds
    s_add_u32 m0, s45, 13312
    s_add_u32 s48, s46, 0x1a0000
    buffer_load_dwordx4 v24, s[28:31], s48 offen  lds
    s_add_u32 m0, s45, 14336
    s_add_u32 s48, s46, 0x1c0000
    buffer_load_dwordx4 v24, s[28:31], s48 offen  lds
    s_add_u32 m0, s45, 15360
    s_add_u32 s48, s46, 0x1e0000
    buffer_load_dwordx4 v24, s[28:31], s48 offen  lds
    s_add_u32 s45, s45, 0x10000
    s_waitcnt vmcnt(0)
    s_barrier
    s_cmp_lg_u32 s44, 0
    s_cbranch_scc1 L_zwok_187
    v_and_b32 v16, 7, v1
    v_lshlrev_b32 v16, 5, v16
    s_mov_b32 s70, 0
L_zw_186:
    buffer_load_dword v17, v16, s[16:19], 0 offen sc1
    s_waitcnt vmcnt(0)
    v_add_u32_dpp v17, v17, v17 row_ror:1 row_mask:0xf bank_mask:0xf
    s_nop 1
    v_add_u32_dpp v17, v17, v17 row_ror:2 row_mask:0xf bank_mask:0xf
    s_nop 1
    v_add_u32_dpp v17, v17, v17 row_ror:4 row_mask:0xf bank_mask:0xf
    v_cmp_ne_u32 vcc, 0x100, v17
    s_add_u32 s70, s70, 1
    s_cbranch_vccz L_zwok_187
    s_sleep 4
    s_cmp_lt_u32 s70, 524288
    s_cbranch_scc1 L_zw_186
    s_branch L_c_done_1
L_zwok_187:
    s_cmp_lg_u32 s44, 0
    s_cbranch_scc1 L_c_nr_188
    s_or_b32 s47, s39, 0x100
    v_mov_b32 v16, s47
    s_lshl_b32 s52, s40, 6
    s_lshl_b32 s53, s41, 2
    s_add_u32 s52, s52, s53
    s_add_u32 s52, s52, 0x101000
    v_mov_b32 v17, 0
    s_mov_b64 exec, 1
    buffer_store_dword v16, v17, s[12:15], s52 offen sc1
    s_mov_b64 exec, -1
L_c_nr_188:
    ds_read_b64_tr_b16 a[0:1], v20 offset:0
    ds_read_b64_tr_b16 a[2:3], v20 offset:256
    ds_read_b64_tr_b16 a[4:5], v20 offset:2048
    ds_read_b64_tr_b16 a[6:7], v20 offset:2304
    ds_read_b64_tr_b16 a[8:9], v20 offset:4096
    ds_read_b64_tr_b16 a[10:11], v20 offset:4352
    ds_read_b64_tr_b16 a[12:13], v20 offset:6144
    ds_read_b64_tr_b16 a[14:15], v20 offset:6400
    s_waitcnt lgkmcnt(0)
    ds_read_b64_tr_b16 a[16:17], v20 offset:8192
    ds_read_b64_tr_b16 a[18:19], v20 offset:8448
    ds_read_b64_tr_b16 a[20:21], v20 offset:10240
    ds_read_b64_tr_b16 a[22:23], v20 offset:10496
    ds_read_b64_tr_b16 a[24:25], v20 offset:12288
    ds_read_b64_tr_b16 a[26:27], v20 offset:12544
    ds_read_b64_tr_b16 a[28:29], v20 offset:14336
    ds_read_b64_tr_b16 a[30:31], v20 offset:14592
    s_waitcnt lgkmcnt(0)
    ds_read_b64_tr_b16 a[32:33], v20 offset:16384
    ds_read_b64_tr_b16 a[34:35], v20 offset:16640
    ds_read_b64_tr_b16 a[36:37], v20 offset:18432
    ds_read_b64_tr_b16 a[38:39], v20 offset:18688
    ds_read_b64_tr_b16 a[40:41], v20 offset:20480
    ds_read_b64_tr_b16 a[42:43], v20 offset:20736
    ds_read_b64_tr_b16 a[44:45], v20 offset:22528
    ds_read_b64_tr_b16 a[46:47], v20 offset:22784
    s_waitcnt lgkmcnt(0)
    ds_read_b64_tr_b16 a[48:49], v20 offset:24576
    ds_read_b64_tr_b16 a[50:51], v20 offset:24832
    ds_read_b64_tr_b16 a[52:53], v20 offset:26624
    ds_read_b64_tr_b16 a[54:55], v20 offset:26880
    ds_read_b64_tr_b16 a[56:57], v20 offset:28672
    ds_read_b64_tr_b16 a[58:59], v20 offset:28928
    ds_read_b64_tr_b16 a[60:61], v20 offset:30720
    ds_read_b64_tr_b16 a[62:63], v20 offset:30976
    s_waitcnt lgkmcnt(0)
    ds_read_b64_tr_b16 a[64:65], v20 offset:32768
    ds_read_b64_tr_b16 a[66:67], v20 offset:33024
    ds_read_b64_tr_b16 a[68:69], v20 offset:34816
    ds_read_b64_tr_b16 a[70:71], v20 offset:35072
    ds_read_b64_tr_b16 a[72:73], v20 offset:36864
    ds_read_b64_tr_b16 a[74:75], v20 offset:37120
    ds_read_b64_tr_b16 a[76:77], v20 offset:38912
    ds_read_b64_tr_b16 a[78:79], v20 offset:39168
    s_waitcnt lgkmcnt(0)
    ds_read_b64_tr_b16 a[80:81], v20 offset:40960
    ds_read_b64_tr_b16 a[82:83], v20 offset:41216
    ds_read_b64_tr_b16 a[84:85], v20 offset:43008
    ds_read_b64_tr_b16 a[86:87], v20 offset:43264
    ds_read_b64_tr_b16 a[88:89], v20 offset:45056
    ds_read_b64_tr_b16 a[90:91], v20 offset:45312
    ds_read_b64_tr_b16 a[92:93], v20 offset:47104
    ds_read_b64_tr_b16 a[94:95], v20 offset:47360
    s_waitcnt lgkmcnt(0)
    ds_read_b64_tr_b16 a[96:97], v20 offset:49152
    ds_read_b64_tr_b16 a[98:99], v20 offset:49408
    ds_read_b64_tr_b16 a[100:101], v20 offset:51200
    ds_read_b64_tr_b16 a[102:103], v20 offset:51456
    ds_read_b64_tr_b16 a[104:105], v20 offset:53248
    ds_read_b64_tr_b16 a[106:107], v20 offset:53504
    ds_read_b64_tr_b16 a[108:109], v20 offset:55296
    ds_read_b64_tr_b16 a[110:111], v20 offset:55552
    s_waitcnt lgkmcnt(0)
    ds_read_b64_tr_b16 a[112:113], v20 offset:57344
    ds_read_b64_tr_b16 a[114:115], v20 offset:57600
    ds_read_b64_tr_b16 a[116:117], v20 offset:59392
    ds_read_b64_tr_b16 a[118:119], v20 offset:59648
    ds_read_b64_tr_b16 a[120:121], v20 offset:61440
    ds_read_b64_tr_b16 a[122:123], v20 offset:61696
    ds_read_b64_tr_b16 a[124:125], v20 offset:63488
    ds_read_b64_tr_b16 a[126:127], v20 offset:63744
    s_waitcnt lgkmcnt(0)
    s_mov_b32 s63, 0
    s_barrier
    s_lshl_b32 s52, s40, 2
    s_add_u32 s52, s52, s44
    s_mul_i32 s52, s52, 24576
    s_lshl_b32 s53, s41, 9
    s_add_u32 s52, s52, s53
    s_add_u32 s52, s52, 0x2004000
    v_and_b32 v14, 3, v1
    v_lshlrev_b32 v14, 7, v14
    v_add_u32 v14, s52, v14
    s_lshl_b32 s52, s40, 16
    s_lshl_b32 s53, s41, 9
    s_add_u32 s53, s53, s52
    s_lshl_b32 s54, s44, 6
    s_add_u32 s53, s53, s54
    s_add_u32 s53, s53, 0x7080000
    v_lshlrev_b32 v4, 3, v106
    v_lshl_add_u32 v10, v102, 6, v4
    v_lshl_add_u32 v4, v101, 7, v4
    v_add_u32 v4, s53, v4
    v_mov_b32 v54, 0xfffefffe
    v_mov_b32 v56, 0
    v_mov_b32 v57, 0
    v_mov_b32 v58, 0
    v_mov_b32 v59, 0
    s_lshl_b32 s53, s41, 7
    s_add_u32 s53, s53, s52
    s_add_u32 s53, s53, 0x7180000
    v_add_u32 v10, s53, v10
    s_cmp_ge_u32 s44, 2
    s_cselect_b64 vcc, -1, 0
    v_cndmask_b32 v4, v4, v10, vcc
    s_mul_i32 s52, s49, 24576
    s_lshl_b32 s53, s44, 12
    s_add_u32 s52, s52, s53
    s_lshl_b32 s53, s43, 10
    s_add_u32 s52, s52, s53
    s_add_u32 s52, s52, 0x2002000
    v_add_u32 v6, s52, v2
    v_lshrrev_b32 v10, 3, v1
    v_lshlrev_b32 v10, 8, v10
    v_lshl_add_u32 v10, v106, 4, v10
    v_add_u32 v10, 61568, v10
    v_add_u32 v11, 27648, v2
    v_cmp_gt_u32 s[52:53], 32, v1
    s_nop 1
    v_cndmask_b32 v10, v11, v10, s[52:53]
    v_cndmask_b32 v6, v6, v10, vcc
    v_mov_b32 v24, -1
    v_mov_b32 v25, -1
    v_mov_b32 v26, -1
    v_mov_b32 v27, -1
    s_and_b32 s52, s40, 1
    s_lshl_b32 s52, s52, 14
    s_lshl_b32 s53, s41, 10
    s_add_u32 s52, s52, s53
    s_lshl_b32 s53, s50, 9
    s_add_u32 s52, s52, s53
    s_lshl_b32 s53, s51, 7
    s_add_u32 s52, s52, s53
    s_add_u32 s52, s52, 0x7a0000
    v_mov_b32 v46, s52
    v_add_u32 v44, 65536, v2
    s_lshl_b32 s52, s50, 10
    s_add_u32 s52, s52, 62464
    v_add_u32 v31, s52, v2
    s_lshl_b32 s53, s51, 9
    s_add_u32 s52, s52, s53
    v_lshlrev_b32 v45, 4, v100
    v_lshl_add_u32 v45, v103, 8, v45
    v_lshl_add_u32 v45, v102, 3, v45
    v_add_u32 v45, s52, v45
    s_mul_i32 s52, s49, 24576
    s_lshl_b32 s53, s50, 13
    s_add_u32 s52, s52, s53
    s_lshl_b32 s53, s43, 10
    s_add_u32 s52, s52, s53
    s_add_u32 s52, s52, 0x4b80000
    v_add_u32 v13, s52, v2
    v_mov_b32 v29, 26644
    v_mov_b32 v30, 0
    ds_write_b32 v29, v30
    v_mov_b32 v30, 1
    s_lshl_b32 s58, s40, 11
    s_lshl_b32 s53, s44, 7
    s_add_u32 s58, s58, s53
    s_add_u32 s58, s58, 0x10a600
    s_mov_b32 s69, 0
    v_mov_b32 v0, 0
    s_cmp_ge_u32 s44, 2
    s_cselect_b32 s50, 0, 0x00ff00ff
    s_mov_b32 s51, 0x00ff00ff
    s_xor_b32 s45, s44, 2
    s_xor_b32 s46, s41, 6
    s_or_b32 s45, s45, s46
    s_cbranch_scc1 L_c_join_185_p
    s_lshl_b32 s45, s40, 21
    s_add_u32 s45, s45, 0x79c0000
    s_mov_b32 s60, -1
    s_mov_b32 s61, -1
    s_waitcnt vmcnt(0) lgkmcnt(0)
    s_add_u32 s46, s45, 0
    s_memtime s[84:85]
    s_waitcnt lgkmcnt(0)
    s_load_dword s47, s[22:23], s46
    s_waitcnt lgkmcnt(0)
    s_memtime s[86:87]
    s_waitcnt lgkmcnt(0)
    s_sub_u32 s86, s86, s84
    s_min_u32 s60, s60, s86
    s_add_u32 s46, s45, 8192
    s_memtime s[84:85]
    s_waitcnt lgkmcnt(0)
    s_load_dword s47, s[22:23], s46
    s_waitcnt lgkmcnt(0)
    s_memtime s[86:87]
    s_waitcnt lgkmcnt(0)
    s_sub_u32 s86, s86, s84
    s_min_u32 s61, s61, s86
    s_add_u32 s46, s45, 128
    s_memtime s[84:85]
    s_waitcnt lgkmcnt(0)
    s_load_dword s47, s[22:23], s46
    s_waitcnt lgkmcnt(0)
    s_memtime s[86:87]
    s_waitcnt lgkmcnt(0)
    s_sub_u32 s86, s86, s84
    s_min_u32 s60, s60, s86
    s_add_u32 s46, s45, 8320
    s_memtime s[84:85]
    s_waitcnt lgkmcnt(0)
    s_load_dword s47, s[22:23], s46
    s_waitcnt lgkmcnt(0)
    s_memtime s[86:87]
    s_waitcnt lgkmcnt(0)
    s_sub_u32 s86, s86, s84
    s_min_u32 s61, s61, s86
    s_add_u32 s46, s45, 256
    s_memtime s[84:85]
    s_waitcnt lgkmcnt(0)
    s_load_dword s47, s[22:23], s46
    s_waitcnt lgkmcnt(0)
    s_memtime s[86:87]
    s_waitcnt lgkmcnt(0)
    s_sub_u32 s86, s86, s84
    s_min_u32 s60, s60, s86
    s_add_u32 s46, s45, 8448
    s_memtime s[84:85]
    s_waitcnt lgkmcnt(0)
    s_load_dword s47, s[22:23], s46
    s_waitcnt lgkmcnt(0)
    s_memtime s[86:87]
    s_waitcnt lgkmcnt(0)
    s_sub_u32 s86, s86, s84
    s_min_u32 s61, s61, s86
    s_cmp_gt_u32 s60, s61
    s_cselect_b32 s45, 3, 2
    v_mov_b32 v10, s45
    v_mov_b32 v11, 0
    s_lshl_b32 s45, s40, 7
    s_add_u32 s45, s45, 0x101800
    s_mov_b64 exec, 1
    buffer_store_dword v10, v11, s[12:15], s45 offen sc1
    s_mov_b64 exec, -1
L_c_join_185_p:
    s_setprio 1
    s_branch L_c_join_185
L_v_init_184:
    s_sub_u32 s54, s44, 4
    s_lshr_b32 s51, s54, 1
    s_and_b32 s50, s54, 1
    s_load_dwordx4 s[4:7], s[0:1], 32
    s_load_dwordx2 s[8:9], s[0:1], 8
    s_waitcnt lgkmcnt(0)
    s_mov_b32 s24, s4
    s_and_b32 s25, s5, 0xffff
    s_mov_b32 s26, 0x800000
    s_mov_b32 s27, 0x00020000
    s_mov_b32 s28, s6
    s_and_b32 s29, s7, 0xffff
    s_mov_b32 s30, 0x800000
    s_mov_b32 s31, 0x00020000
    s_mov_b32 s32, s8
    s_and_b32 s33, s9, 0xffff
    s_mov_b32 s34, 0x4000
    s_mov_b32 s35, 0x00020000
    s_lshl_b32 s45, s54, 12
    s_add_u32 s45, s45, 0x20000
    v_add_u32 v20, s45, v20
    v_add_u32 v21, s45, v21
    v_add_u32 v22, s45, v2
    s_lshl_b32 s46, s49, 8
    s_lshl_b32 s48, s43, 6
    s_add_u32 s46, s46, s48
    s_lshl_b32 s48, s54, 21
    s_add_u32 s46, s46, s48
    s_add_u32 s48, s46, 0x0
    buffer_load_dwordx4 a[0:3], v24, s[24:27], s48 offen
    s_add_u32 s48, s46, 0x20000
    buffer_load_dwordx4 a[32:35], v24, s[24:27], s48 offen
    s_add_u32 s48, s46, 0x40000
    buffer_load_dwordx4 a[4:7], v24, s[24:27], s48 offen
    s_add_u32 s48, s46, 0x60000
    buffer_load_dwordx4 a[36:39], v24, s[24:27], s48 offen
    s_add_u32 s48, s46, 0x80000
    buffer_load_dwordx4 a[8:11], v24, s[24:27], s48 offen
    s_add_u32 s48, s46, 0xa0000
    buffer_load_dwordx4 a[40:43], v24, s[24:27], s48 offen
    s_add_u32 s48, s46, 0xc0000
    buffer_load_dwordx4 a[12:15], v24, s[24:27], s48 offen
    s_add_u32 s48, s46, 0xe0000
    buffer_load_dwordx4 a[44:47], v24, s[24:27], s48 offen
    s_add_u32 s48, s46, 0x100000
    buffer_load_dwordx4 a[16:19], v24, s[24:27], s48 offen
    s_add_u32 s48, s46, 0x120000
    buffer_load_dwordx4 a[48:51], v24, s[24:27], s48 offen
    s_add_u32 s48, s46, 0x140000
    buffer_load_dwordx4 a[20:23], v24, s[24:27], s48 offen
    s_add_u32 s48, s46, 0x160000
    buffer_load_dwordx4 a[52:55], v24, s[24:27], s48 offen
    s_add_u32 s48, s46, 0x180000
    buffer_load_dwordx4 a[24:27], v24, s[24:27], s48 offen
    s_add_u32 s48, s46, 0x1a0000
    buffer_load_dwordx4 a[56:59], v24, s[24:27], s48 offen
    s_add_u32 s48, s46, 0x1c0000
    buffer_load_dwordx4 a[28:31], v24, s[24:27], s48 offen
    s_add_u32 s48, s46, 0x1e0000
    buffer_load_dwordx4 a[60:63], v24, s[24:27], s48 offen
    s_lshl_b32 s52, s40, 15
    s_lshl_b32 s53, s42, 11
    s_add_u32 s52, s52, s53
    s_lshl_b32 s53, s43, 9
    s_add_u32 s52, s52, s53
    s_lshl_b32 s53, s51, 8
    s_add_u32 s52, s52, s53
    s_add_u32 s52, s52, 0x7100000
    v_bfe_u32 v4, v1, 1, 1
    v_lshlrev_b32 v4, 7, v4
    v_lshl_add_u32 v4, v104, 4, v4
    v_and_b32 v5, 12, v100
    v_add_u32 v4, v4, v5
    v_add_u32 v4, s52, v4
    v_mov_b32 v26, -1
    s_lshl_b32 s52, s51, 5
    s_add_u32 s52, s52, 28160
    v_and_b32 v5, 14, v100
    v_lshlrev_b32 v5, 1, v5
    v_lshl_add_u32 v5, v104, 6, v5
    v_add_u32 v5, s52, v5
    s_lshl_b32 s52, s41, 14
    s_lshl_b32 s53, s54, 11
    s_add_u32 s52, s52, s53
    s_add_u32 s52, s52, 0x7800000
    v_lshlrev_b32 v6, 3, v101
    v_lshl_add_u32 v6, v106, 5, v6
    v_and_b32 v7, 3, v1
    v_lshlrev_b32 v7, 3, v7
    v_bfe_u32 v30, v1, 2, 3
    v_lshl_add_u32 v7, v30, 5, v7
    v_lshl_add_u32 v7, v103, 2, v7
    v_add_u32 v7, s52, v7
    s_lshl_b32 s53, s40, 8
    s_add_u32 s52, s52, s53
    v_add_u32 v6, s52, v6
    v_lshlrev_b32 v30, 4, v100
    v_lshl_add_u32 v30, v101, 18, v30
    v_add_u32 v30, s52, v30
    v_mov_b32 v32, -1
    v_mov_b32 v33, -1
    v_mov_b32 v34, -1
    v_mov_b32 v35, -1
    buffer_store_dwordx4 v[32:35], v30, s[12:15], 0 offen sc1
    s_mov_b32 s53, 8192
    buffer_store_dwordx4 v[32:35], v30, s[12:15], s53 offen sc1
    s_lshl_b32 s55, s40, 16
    s_add_u32 s55, s55, 0x7000000
    s_lshl_b32 s52, s41, 10
    s_lshl_b32 s53, s54, 8
    s_add_u32 s52, s52, s53
    s_add_u32 s52, s52, s55
    v_lshlrev_b32 v8, 2, v1
    v_add_u32 v8, s52, v8
    s_lshl_b32 s53, s54, 12
    v_add_u32 v10, s53, v2
    v_add_u32 v9, s55, v10
    s_lshl_b32 s52, s40, 15
    s_lshl_b32 s53, s54, 11
    s_add_u32 s52, s52, s53
    s_add_u32 s52, s52, 0x7100000
    v_add_u32 v11, s52, v2
    s_lshl_b32 s52, s54, 9
    s_add_u32 s52, s52, 53248
    v_lshlrev_b32 v12, 4, v100
    v_lshl_add_u32 v12, v102, 3, v12
    v_lshl_add_u32 v12, v103, 8, v12
    v_add_u32 v12, s52, v12
    s_lshl_b32 s52, s51, 3
    s_add_u32 s52, s52, 49152
    v_add_u32 v13, s52, v2
    s_lshl_b32 s52, s54, 10
    s_add_u32 s52, s52, 49152
    v_add_u32 v14, s52, v2
    s_lshl_b32 s52, s40, 2
    s_add_u32 s52, s52, s54
    s_mul_i32 s52, s52, 24576
    s_add_u32 s52, s52, 0x2004000
    v_add_u32 v15, s52, v2
    s_lshl_b32 s52, s54, 10
    v_add_u32 v27, s52, v2
    v_lshlrev_b32 v30, 11, v106
    v_lshl_add_u32 v30, v101, 5, v30
    s_lshl_b32 s52, s54, 9
    buffer_load_dwordx4 v[64:67], v30, s[32:35], s52 offen offset:0
    buffer_load_dwordx4 v[68:71], v30, s[32:35], s52 offen offset:16
    buffer_load_dwordx4 v[72:75], v30, s[32:35], s52 offen offset:128
    buffer_load_dwordx4 v[76:79], v30, s[32:35], s52 offen offset:144
    buffer_load_dwordx4 v[80:83], v30, s[32:35], s52 offen offset:256
    buffer_load_dwordx4 v[84:87], v30, s[32:35], s52 offen offset:272
    buffer_load_dwordx4 v[88:91], v30, s[32:35], s52 offen offset:384
    buffer_load_dwordx4 v[92:95], v30, s[32:35], s52 offen offset:400
    s_lshl_b32 s46, s40, 2
    s_add_u32 s46, s46, s54
    s_lshl_b32 s46, s46, 18
    s_lshl_b32 s48, s41, 7
    s_add_u32 s46, s46, s48
    s_add_u32 s48, s46, 0x0
    buffer_load_dwordx4 a[64:67], v25, s[28:31], s48 offen
    s_add_u32 s48, s46, 0x4000
    buffer_load_dwordx4 a[80:83], v25, s[28:31], s48 offen
    s_add_u32 s48, s46, 0x8000
    buffer_load_dwordx4 a[96:99], v25, s[28:31], s48 offen
    s_add_u32 s48, s46, 0xc000
    buffer_load_dwordx4 a[112:115], v25, s[28:31], s48 offen
    s_add_u32 s48, s46, 0x10000
    buffer_load_dwordx4 a[68:71], v25, s[28:31], s48 offen
    s_add_u32 s48, s46, 0x14000
    buffer_load_dwordx4 a[84:87], v25, s[28:31], s48 offen
    s_add_u32 s48, s46, 0x18000
    buffer_load_dwordx4 a[100:103], v25, s[28:31], s48 offen
    s_add_u32 s48, s46, 0x1c000
    buffer_load_dwordx4 a[116:119], v25, s[28:31], s48 offen
    s_add_u32 s48, s46, 0x20000
    buffer_load_dwordx4 a[72:75], v25, s[28:31], s48 offen
    s_add_u32 s48, s46, 0x24000
    buffer_load_dwordx4 a[88:91], v25, s[28:31], s48 offen
    s_add_u32 s48, s46, 0x28000
    buffer_load_dwordx4 a[104:107], v25, s[28:31], s48 offen
    s_add_u32 s48, s46, 0x2c000
    buffer_load_dwordx4 a[120:123], v25, s[28:31], s48 offen
    s_add_u32 s48, s46, 0x30000
    buffer_load_dwordx4 a[76:79], v25, s[28:31], s48 offen
    s_add_u32 s48, s46, 0x34000
    buffer_load_dwordx4 a[92:95], v25, s[28:31], s48 offen
    s_add_u32 s48, s46, 0x38000
    buffer_load_dwordx4 a[108:111], v25, s[28:31], s48 offen
    s_add_u32 s48, s46, 0x3c000
    buffer_load_dwordx4 a[124:127], v25, s[28:31], s48 offen
    s_waitcnt vmcnt(16)
    v_cmp_eq_u32 vcc, 1, v107
    s_nop 1
    v_cndmask_b32 v112, v64, v65, vcc
    v_cndmask_b32 v113, v66, v67, vcc
    v_cndmask_b32 v114, v68, v69, vcc
    v_cndmask_b32 v115, v70, v71, vcc
    v_cndmask_b32 v116, v72, v73, vcc
    v_cndmask_b32 v117, v74, v75, vcc
    v_cndmask_b32 v118, v76, v77, vcc
    v_cndmask_b32 v119, v78, v79, vcc
    v_cndmask_b32 v120, v80, v81, vcc
    v_cndmask_b32 v121, v82, v83, vcc
    v_cndmask_b32 v122, v84, v85, vcc
    v_cndmask_b32 v123, v86, v87, vcc
    v_cndmask_b32 v124, v88, v89, vcc
    v_cndmask_b32 v125, v90, v91, vcc
    v_cndmask_b32 v126, v92, v93, vcc
    v_cndmask_b32 v127, v94, v95, vcc
    ds_write_b128 v22, a[0:3] offset:0
    ds_write_b128 v22, a[32:35] offset:1024
    ds_write_b128 v22, a[4:7] offset:2048
    ds_write_b128 v22, a[36:39] offset:3072
    s_waitcnt lgkmcnt(0)
    ds_read_b64_tr_b16 a[0:1], v20 offset:0
    ds_read_b64_tr_b16 a[2:3], v20 offset:256
    ds_read_b64_tr_b16 a[32:33], v20 offset:32
    ds_read_b64_tr_b16 a[34:35], v20 offset:288
    ds_read_b64_tr_b16 a[4:5], v20 offset:2048
    ds_read_b64_tr_b16 a[6:7], v20 offset:2304
    ds_read_b64_tr_b16 a[36:37], v20 offset:2080
    ds_read_b64_tr_b16 a[38:39], v20 offset:2336
    s_waitcnt lgkmcnt(0)
    ds_write_b128 v22, a[8:11] offset:0
    ds_write_b128 v22, a[40:43] offset:1024
    ds_write_b128 v22, a[12:15] offset:2048
    ds_write_b128 v22, a[44:47] offset:3072
    s_waitcnt lgkmcnt(0)
    ds_read_b64_tr_b16 a[8:9], v20 offset:0
    ds_read_b64_tr_b16 a[10:11], v20 offset:256
    ds_read_b64_tr_b16 a[40:41], v20 offset:32
    ds_read_b64_tr_b16 a[42:43], v20 offset:288
    ds_read_b64_tr_b16 a[12:13], v20 offset:2048
    ds_read_b64_tr_b16 a[14:15], v20 offset:2304
    ds_read_b64_tr_b16 a[44:45], v20 offset:2080
    ds_read_b64_tr_b16 a[46:47], v20 offset:2336
    s_waitcnt lgkmcnt(0)
    ds_write_b128 v22, a[16:19] offset:0
    ds_write_b128 v22, a[48:51] offset:1024
    ds_write_b128 v22, a[20:23] offset:2048
    ds_write_b128 v22, a[52:55] offset:3072
    s_waitcnt lgkmcnt(0)
    ds_read_b64_tr_b16 a[16:17], v20 offset:0
    ds_read_b64_tr_b16 a[18:19], v20 offset:256
    ds_read_b64_tr_b16 a[48:49], v20 offset:32
    ds_read_b64_tr_b16 a[50:51], v20 offset:288
    ds_read_b64_tr_b16 a[20:21], v20 offset:2048
    ds_read_b64_tr_b16 a[22:23], v20 offset:2304
    ds_read_b64_tr_b16 a[52:53], v20 offset:2080
    ds_read_b64_tr_b16 a[54:55], v20 offset:2336
    s_waitcnt lgkmcnt(0)
    ds_write_b128 v22, a[24:27] offset:0
    ds_write_b128 v22, a[56:59] offset:1024
    ds_write_b128 v22, a[28:31] offset:2048
    ds_write_b128 v22, a[60:63] offset:3072
    s_waitcnt lgkmcnt(0)
    ds_read_b64_tr_b16 a[24:25], v20 offset:0
    ds_read_b64_tr_b16 a[26:27], v20 offset:256
    ds_read_b64_tr_b16 a[56:57], v20 offset:32
    ds_read_b64_tr_b16 a[58:59], v20 offset:288
    ds_read_b64_tr_b16 a[28:29], v20 offset:2048
    ds_read_b64_tr_b16 a[30:31], v20 offset:2304
    ds_read_b64_tr_b16 a[60:61], v20 offset:2080
    ds_read_b64_tr_b16 a[62:63], v20 offset:2336
    s_waitcnt lgkmcnt(0)
    s_barrier
    s_waitcnt vmcnt(0)
    ds_write_b128 v22, a[64:67] offset:0
    ds_write_b128 v22, a[80:83] offset:1024
    ds_write_b128 v22, a[96:99] offset:2048
    ds_write_b128 v22, a[112:115] offset:3072
    s_waitcnt lgkmcnt(0)
    ds_read_b64_tr_b16 a[64:65], v21 offset:0
    ds_read_b64_tr_b16 a[66:67], v21 offset:512
    ds_read_b64_tr_b16 a[80:81], v21 offset:32
    ds_read_b64_tr_b16 a[82:83], v21 offset:544
    ds_read_b64_tr_b16 a[96:97], v21 offset:64
    ds_read_b64_tr_b16 a[98:99], v21 offset:576
    ds_read_b64_tr_b16 a[112:113], v21 offset:96
    ds_read_b64_tr_b16 a[114:115], v21 offset:608
    s_waitcnt lgkmcnt(0)
    ds_write_b128 v22, a[68:71] offset:0
    ds_write_b128 v22, a[84:87] offset:1024
    ds_write_b128 v22, a[100:103] offset:2048
    ds_write_b128 v22, a[116:119] offset:3072
    s_waitcnt lgkmcnt(0)
    ds_read_b64_tr_b16 a[68:69], v21 offset:0
    ds_read_b64_tr_b16 a[70:71], v21 offset:512
    ds_read_b64_tr_b16 a[84:85], v21 offset:32
    ds_read_b64_tr_b16 a[86:87], v21 offset:544
    ds_read_b64_tr_b16 a[100:101], v21 offset:64
    ds_read_b64_tr_b16 a[102:103], v21 offset:576
    ds_read_b64_tr_b16 a[116:117], v21 offset:96
    ds_read_b64_tr_b16 a[118:119], v21 offset:608
    s_waitcnt lgkmcnt(0)
    ds_write_b128 v22, a[72:75] offset:0
    ds_write_b128 v22, a[88:91] offset:1024
    ds_write_b128 v22, a[104:107] offset:2048
    ds_write_b128 v22, a[120:123] offset:3072
    s_waitcnt lgkmcnt(0)
    ds_read_b64_tr_b16 a[72:73], v21 offset:0
    ds_read_b64_tr_b16 a[74:75], v21 offset:512
    ds_read_b64_tr_b16 a[88:89], v21 offset:32
    ds_read_b64_tr_b16 a[90:91], v21 offset:544
    ds_read_b64_tr_b16 a[104:105], v21 offset:64
    ds_read_b64_tr_b16 a[106:107], v21 offset:576
    ds_read_b64_tr_b16 a[120:121], v21 offset:96
    ds_read_b64_tr_b16 a[122:123], v21 offset:608
    s_waitcnt lgkmcnt(0)
    ds_write_b128 v22, a[76:79] offset:0
    ds_write_b128 v22, a[92:95] offset:1024
    ds_write_b128 v22, a[108:111] offset:2048
    ds_write_b128 v22, a[124:127] offset:3072
    s_waitcnt lgkmcnt(0)
    ds_read_b64_tr_b16 a[76:77], v21 offset:0
    ds_read_b64_tr_b16 a[78:79], v21 offset:512
    ds_read_b64_tr_b16 a[92:93], v21 offset:32
    ds_read_b64_tr_b16 a[94:95], v21 offset:544
    ds_read_b64_tr_b16 a[108:109], v21 offset:64
    ds_read_b64_tr_b16 a[110:111], v21 offset:576
    ds_read_b64_tr_b16 a[124:125], v21 offset:96
    ds_read_b64_tr_b16 a[126:127], v21 offset:608
    s_waitcnt lgkmcnt(0)
    s_mov_b32 s65, 0
    s_waitcnt vmcnt(0)
    s_barrier
    s_lshl_b32 s57, s40, 11
    s_lshl_b32 s53, s54, 7
    s_add_u32 s57, s57, s53
    s_add_u32 s57, s57, 0x10a600
    s_mov_b32 s69, 0
    s_mov_b32 s68, 0
    s_cmp_gt_u32 s69, s68
    s_cbranch_scc1 L_kv_ok_190
    s_mov_b32 s70, 0
L_kv_lp_189:
    v_and_b32 v22, 1, v1
    v_lshlrev_b32 v22, 9, v22
    buffer_load_dword v23, v22, s[12:15], s57 offen sc1
    s_waitcnt vmcnt(0)
    v_readlane_b32 s69, v23, 0
    v_readlane_b32 s45, v23, 1
    s_add_u32 s70, s70, 1
    s_nop 2
    s_min_u32 s69, s69, s45
    s_cmp_gt_u32 s69, s68
    s_cbranch_scc1 L_kv_ok_190
    s_sleep 4
    s_cmp_lt_u32 s70, 524288
    s_cbranch_scc1 L_kv_lp_189
    s_branch L_c_done_1
L_kv_ok_190:
    v_lshlrev_b32 v28, 9, v101
    v_lshl_add_u32 v28, v100, 4, v28
    s_lshl_b32 s52, s54, 13
    s_add_u32 s52, s52, 0x7a0000
    v_add_u32 v28, s52, v28
    s_lshl_b32 s59, s54, 12
    s_add_u32 s59, s59, 65536
    v_lshlrev_b32 v31, 4, v100
    v_lshl_add_u32 v31, v103, 8, v31
    v_add_u32 v31, 20480, v31
    s_lshl_b32 s52, s54, 11
    s_add_u32 s52, s52, 53248
    v_add_u32 v25, s52, v2
    v_mov_b32 v29, 26640
    v_mov_b32 v30, 0
    ds_write_b32 v29, v30
    v_mov_b32 v30, 1
    s_mov_b32 s58, 0
    s_mov_b32 s64, 0
    s_add_u32 s46, s65, 4096
    buffer_load_dwordx4 v[32:35], v15, s[12:15], s65 offen offset:0 sc1
    buffer_load_dwordx4 v[48:51], v15, s[12:15], s46 offen offset:0 sc1
    buffer_load_dwordx4 v[36:39], v15, s[12:15], s65 offen offset:1024 sc1
    buffer_load_dwordx4 v[52:55], v15, s[12:15], s46 offen offset:1024 sc1
    buffer_load_dwordx4 v[40:43], v15, s[12:15], s65 offen offset:2048 sc1
    buffer_load_dwordx4 v[56:59], v15, s[12:15], s46 offen offset:2048 sc1
    buffer_load_dwordx4 v[44:47], v15, s[12:15], s65 offen offset:3072 sc1
    buffer_load_dwordx4 v[60:63], v15, s[12:15], s46 offen offset:3072 sc1
    s_add_u32 s65, s65, 786432
    s_waitcnt vmcnt(0)
    v_mfma_f32_16x16x32_bf16 v[64:67], v[32:35], a[64:67], 0
    v_mfma_f32_16x16x32_bf16 v[68:71], v[48:51], a[64:67], 0
    v_mfma_f32_16x16x32_bf16 v[64:67], v[36:39], a[68:71], v[64:67]
    v_mfma_f32_16x16x32_bf16 v[68:71], v[52:55], a[68:71], v[68:71]
    v_mfma_f32_16x16x32_bf16 v[64:67], v[40:43], a[72:75], v[64:67]
    v_mfma_f32_16x16x32_bf16 v[68:71], v[56:59], a[72:75], v[68:71]
    v_mfma_f32_16x16x32_bf16 v[64:67], v[44:47], a[76:79], v[64:67]
    v_mfma_f32_16x16x32_bf16 v[68:71], v[60:63], a[76:79], v[68:71]
    v_mfma_f32_16x16x32_bf16 v[72:75], v[32:35], a[80:83], 0
    v_mfma_f32_16x16x32_bf16 v[76:79], v[48:51], a[80:83], 0
    v_mfma_f32_16x16x32_bf16 v[72:75], v[36:39], a[84:87], v[72:75]
    v_mfma_f32_16x16x32_bf16 v[76:79], v[52:55], a[84:87], v[76:79]
    v_mfma_f32_16x16x32_bf16 v[72:75], v[40:43], a[88:91], v[72:75]
    v_mfma_f32_16x16x32_bf16 v[76:79], v[56:59], a[88:91], v[76:79]
    v_mfma_f32_16x16x32_bf16 v[72:75], v[44:47], a[92:95], v[72:75]
    v_mfma_f32_16x16x32_bf16 v[76:79], v[60:63], a[92:95], v[76:79]
    v_cvt_pk_bf16_f32 v64, v64, v65
    v_cvt_pk_bf16_f32 v65, v66, v67
    v_cvt_pk_bf16_f32 v66, v68, v69
    v_cvt_pk_bf16_f32 v67, v70, v71
    ds_write_b128 v10, v[64:67] offset:32768
    v_mfma_f32_16x16x32_bf16 v[80:83], v[32:35], a[96:99], 0
    v_mfma_f32_16x16x32_bf16 v[84:87], v[48:51], a[96:99], 0
    v_mfma_f32_16x16x32_bf16 v[80:83], v[36:39], a[100:103], v[80:83]
    v_mfma_f32_16x16x32_bf16 v[84:87], v[52:55], a[100:103], v[84:87]
    v_mfma_f32_16x16x32_bf16 v[80:83], v[40:43], a[104:107], v[80:83]
    v_mfma_f32_16x16x32_bf16 v[84:87], v[56:59], a[104:107], v[84:87]
    v_mfma_f32_16x16x32_bf16 v[80:83], v[44:47], a[108:111], v[80:83]
    v_mfma_f32_16x16x32_bf16 v[84:87], v[60:63], a[108:111], v[84:87]
    v_cvt_pk_bf16_f32 v72, v72, v73
    v_cvt_pk_bf16_f32 v73, v74, v75
    v_cvt_pk_bf16_f32 v74, v76, v77
    v_cvt_pk_bf16_f32 v75, v78, v79
    ds_write_b128 v10, v[72:75] offset:33792
    v_mfma_f32_16x16x32_bf16 v[88:91], v[32:35], a[112:115], 0
    v_mfma_f32_16x16x32_bf16 v[92:95], v[48:51], a[112:115], 0
    v_mfma_f32_16x16x32_bf16 v[88:91], v[36:39], a[116:119], v[88:91]
    v_mfma_f32_16x16x32_bf16 v[92:95], v[52:55], a[116:119], v[92:95]
    v_mfma_f32_16x16x32_bf16 v[88:91], v[40:43], a[120:123], v[88:91]
    v_mfma_f32_16x16x32_bf16 v[92:95], v[56:59], a[120:123], v[92:95]
    v_mfma_f32_16x16x32_bf16 v[88:91], v[44:47], a[124:127], v[88:91]
    v_mfma_f32_16x16x32_bf16 v[92:95], v[60:63], a[124:127], v[92:95]
    v_cvt_pk_bf16_f32 v80, v80, v81
    v_cvt_pk_bf16_f32 v81, v82, v83
    v_cvt_pk_bf16_f32 v82, v84, v85
    v_cvt_pk_bf16_f32 v83, v86, v87
    ds_write_b128 v10, v[80:83] offset:34816
    s_nop 2
    v_cvt_pk_bf16_f32 v88, v88, v89
    v_cvt_pk_bf16_f32 v89, v90, v91
    v_cvt_pk_bf16_f32 v90, v92, v93
    v_cvt_pk_bf16_f32 v91, v94, v95
    ds_write_b128 v10, v[88:91] offset:35840
    s_mov_b64 s[66:67], 0
    s_mov_b32 s63, 0
    s_mov_b32 s68, 1
    s_cmp_gt_u32 s69, s68
    s_cbranch_scc1 L_kv_ok_192
    s_mov_b32 s70, 0
L_kv_lp_191:
    v_and_b32 v22, 1, v1
    v_lshlrev_b32 v22, 9, v22
    buffer_load_dword v23, v22, s[12:15], s57 offen sc1
    s_waitcnt vmcnt(0)
    v_readlane_b32 s69, v23, 0
    v_readlane_b32 s45, v23, 1
    s_add_u32 s70, s70, 1
    s_nop 2
    s_min_u32 s69, s69, s45
    s_cmp_gt_u32 s69, s68
    s_cbranch_scc1 L_kv_ok_192
    s_sleep 4
    s_cmp_lt_u32 s70, 524288
    s_cbranch_scc1 L_kv_lp_191
    s_branch L_c_done_1
L_kv_ok_192:
    s_waitcnt lgkmcnt(0)
    v_min_u32 v64, -2, v112
    v_min_u32 v65, -2, v113
    v_min_u32 v66, -2, v114
    v_min_u32 v67, -2, v115
    v_min_u32 v68, -2, v116
    v_min_u32 v69, -2, v117
    v_min_u32 v70, -2, v118
    v_min_u32 v71, -2, v119
    v_min_u32 v72, -2, v120
    v_min_u32 v73, -2, v121
    v_min_u32 v74, -2, v122
    v_min_u32 v75, -2, v123
    v_min_u32 v76, -2, v124
    v_min_u32 v77, -2, v125
    v_min_u32 v78, -2, v126
    v_min_u32 v79, -2, v127
    v_mov_b32 v16, 0
    v_mov_b32 v17, 0
    v_mov_b32 v18, 0
    v_mov_b32 v19, 0
    v_mov_b32 v20, 0
    v_mov_b32 v21, 0
    v_mov_b32 v22, 0
    v_mov_b32 v23, 0
L_c_join_185:
    s_mov_b32 s60, 0
    s_mov_b32 s61, 0
    s_mov_b32 s62, 0
    s_cmp_lg_u32 s44, 0
    s_cbranch_scc1 L_c_nh_193
    v_lshlrev_b32 v17, 3, v1
    s_lshl_b32 s46, s40, 3
    v_mov_b32 v21, s46
    s_mov_b32 s45, 0x101000
    s_mov_b32 s70, 0
L_c_rp_194:
    buffer_load_dwordx2 v[18:19], v17, s[12:15], s45 offen sc1
    buffer_load_dwordx2 v[22:23], v21, s[12:15], s45 offen offset:512 sc1
    s_waitcnt vmcnt(0)
    v_min3_u32 v20, v18, v19, v22
    v_min_u32 v20, v20, v23
    v_cmp_eq_u32 vcc, 0, v20
    s_cbranch_vccnz L_rt_195
    v_cmp_eq_u32 s[52:53], v18, v16
    v_cmp_eq_u32 vcc, v19, v16
    v_cmp_eq_u32 s[54:55], v22, v16
    v_cmp_eq_u32 s[56:57], v23, v16
    s_lshl_b32 s46, s40, 3
    s_nop 3
    s_and_b64 s[52:53], s[52:53], vcc
    s_lshr_b64 s[52:53], s[52:53], s46
    s_and_b32 s52, s52, 0xff
    s_cmp_eq_u32 s52, 0xff
    s_cselect_b32 s52, 1, 0
    v_mov_b32 v16, s52
    v_mov_b32 v17, 26624
    ds_write_b32 v17, v16
L_c_nh_193:
    s_waitcnt lgkmcnt(0)
    s_barrier
    v_mov_b32 v17, 26624
    ds_read_b32 v16, v17
    s_waitcnt lgkmcnt(0)
    v_readfirstlane_b32 s52, v16
    s_nop 3
    s_cmp_ge_u32 s44, 4
    s_cbranch_scc1 L_vf_198
    s_mov_b32 s57, s58
    s_mov_b32 s58, 0
    s_cmp_ge_u32 s44, 2
    s_cbranch_scc1 L_sf_196
    buffer_load_dwordx4 v[32:35], v6, s[12:15], 0 offen sc1
L_sf_196:
    s_mov_b32 s54, s52
    v_add_u32 v52, 786432, v6
    s_mul_i32 s53, s49, 24576
    s_lshl_b32 s55, s43, 11
    s_add_u32 s53, s53, s55
    s_and_b32 s55, s44, 1
    s_lshl_b32 s55, s55, 10
    s_add_u32 s53, s53, s55
    s_add_u32 s53, s53, 0x2184000
    v_and_b32 v53, 7, v1
    v_lshlrev_b32 v53, 7, v53
    v_add_u32 v53, s53, v53
    s_cmp_ge_u32 s44, 2
    s_cselect_b64 vcc, -1, 0
    s_cselect_b64 s[52:53], 0xff, -1
    v_cndmask_b32 v52, v52, v53, vcc
    s_cselect_b32 s55, 786432, 0
    v_readfirstlane_b32 s56, v52
    s_nop 3
    s_sub_u32 s56, s56, s55
    s_cmp_eq_u32 s54, 0
    s_cbranch_scc1 L_ss_197
.p2align 6
L_s_loop_200:
    v_mov_b32 v16, 0
    v_mov_b32 v17, 0
    v_mov_b32 v18, 0
    v_mov_b32 v19, 0
    s_add_u32 s58, s58, 4
    s_mov_b32 s70, 1
    s_waitcnt vmcnt(0) lgkmcnt(0)
    s_barrier
    ds_read_b128 v[64:67], v2 offset:0
    ds_read_b128 v[68:71], v2 offset:1024
    ds_read_b128 v[72:75], v2 offset:2048
    ds_read_b128 v[76:79], v2 offset:3072
    ds_read_b128 v[80:83], v2 offset:4096
    ds_read_b128 v[84:87], v2 offset:5120
    ds_read_b128 v[88:91], v2 offset:6144
    ds_read_b128 v[92:95], v2 offset:7168
    ds_read_b128 v[96:99], v2 offset:8192
    ds_read_b128 v[100:103], v2 offset:9216
    ds_read_b128 v[104:107], v2 offset:10240
    ds_read_b128 v[108:111], v2 offset:11264
    s_waitcnt lgkmcnt(11)
    v_smfmac_f32_16x16x64_bf16 v[16:19], v[64:67], a[0:7], v3
    ds_read_b128 v[112:115], v2 offset:12288
    s_waitcnt lgkmcnt(11)
    v_smfmac_f32_16x16x64_bf16 v[16:19], v[68:71], a[8:15], v3
    ds_read_b128 v[116:119], v2 offset:13312
    s_waitcnt lgkmcnt(11)
    v_smfmac_f32_16x16x64_bf16 v[16:19], v[72:75], a[16:23], v3
    ds_read_b128 v[120:123], v2 offset:14336
    s_waitcnt lgkmcnt(11)
    v_smfmac_f32_16x16x64_bf16 v[16:19], v[76:79], a[24:31], v3
    ds_read_b128 v[124:127], v2 offset:15360
    s_waitcnt lgkmcnt(11)
    v_smfmac_f32_16x16x64_bf16 v[16:19], v[80:83], a[32:39], v3
    s_waitcnt lgkmcnt(10)
    v_smfmac_f32_16x16x64_bf16 v[16:19], v[84:87], a[40:47], v3
    s_waitcnt lgkmcnt(9)
    v_smfmac_f32_16x16x64_bf16 v[16:19], v[88:91], a[48:55], v3
    s_waitcnt lgkmcnt(8)
    v_smfmac_f32_16x16x64_bf16 v[16:19], v[92:95], a[56:63], v3
    s_waitcnt lgkmcnt(7)
    v_smfmac_f32_16x16x64_bf16 v[16:19], v[96:99], a[64:71], v3
    s_waitcnt lgkmcnt(6)
    v_smfmac_f32_16x16x64_bf16 v[16:19], v[100:103], a[72:79], v3
    s_waitcnt lgkmcnt(5)
    v_smfmac_f32_16x16x64_bf16 v[16:19], v[104:107], a[80:87], v3
    s_waitcnt lgkmcnt(4)
    v_smfmac_f32_16x16x64_bf16 v[16:19], v[108:111], a[88:95], v3
    s_waitcnt lgkmcnt(3)
    v_smfmac_f32_16x16x64_bf16 v[16:19], v[112:115], a[96:103], v3
    s_waitcnt lgkmcnt(2)
    v_smfmac_f32_16x16x64_bf16 v[16:19], v[116:119], a[104:111], v3
    s_waitcnt lgkmcnt(1)
    v_smfmac_f32_16x16x64_bf16 v[16:19], v[120:123], a[112:119], v3
    s_waitcnt lgkmcnt(0)
    v_smfmac_f32_16x16x64_bf16 v[16:19], v[124:127], a[120:127], v3
    s_nop 7
    v_permlane32_swap_b32 v16, v18
    v_permlane32_swap_b32 v17, v19
    v_add_f32 v16, v16, v18
    v_add_f32 v17, v17, v19
    v_cvt_pk_bf16_f32 v16, v16, v17
    ds_write_b16 v5, v16
    ds_write_b16_d16_hi v5, v16 offset:16
    s_mov_b64 exec, 1
    ds_add_u32 v29, v30
    s_mov_b64 exec, -1
L_s_xl_202:
    ds_read_b32 v10, v29
    ds_read_b128 v[64:67], v2 offset:61440
    s_cmp_eq_u32 s60, 63
    s_cbranch_scc1 L_s_last_201
    s_cmp_ge_u32 s44, 2
    s_cbranch_scc1 L_s_w2_203
    s_waitcnt lgkmcnt(0)
    v_mfma_f32_16x16x32_bf16 v[16:19], v[32:35], v[64:67], 0
L_s_w2_203_b:
    v_cmp_ne_u32 vcc, s58, v10
    s_nop 0
    s_cbranch_vccnz L_rt_205
    s_mov_b64 exec, s[50:51]
    s_nop 3
    v_cvt_pk_bf16_f32 v16, v16, v17
    v_cvt_pk_bf16_f32 v17, v18, v19
    v_pk_min_u16 v16, v16, v54
    v_pk_min_u16 v17, v17, v54
    buffer_store_dwordx2 v[16:17], v4, s[12:15], s61 offen
    s_mov_b64 exec, -1
L_s_w3_204_b:
    s_sleep 5
    s_mov_b32 s70, 1
L_s_xp_207:
    buffer_load_dwordx2 v[64:65], v7, s[12:15], s61 offen offset:0 sc1
    buffer_load_short_d16_hi v56, v28, s[12:15], s61 offen offset:0 sc1
    buffer_load_dwordx2 v[66:67], v7, s[12:15], s61 offen offset:512 sc1
    buffer_load_short_d16_hi v57, v28, s[12:15], s61 offen offset:128 sc1
    buffer_load_dwordx2 v[68:69], v7, s[12:15], s61 offen offset:1024 sc1
    buffer_load_short_d16_hi v58, v28, s[12:15], s61 offen offset:256 sc1
    buffer_load_dwordx2 v[70:71], v7, s[12:15], s61 offen offset:1536 sc1
    buffer_load_short_d16_hi v59, v28, s[12:15], s61 offen offset:384 sc1
L_s_xc_206_b:
    s_mov_b32 s46, 0x00003f80
    s_mov_b32 s47, 0x3f800000
    s_waitcnt vmcnt(6)
    v_dot2_f32_bf16 v16, v64, s46, 0
    v_dot2_f32_bf16 v17, v64, s47, 0
    v_dot2_f32_bf16 v18, v65, s46, 0
    v_dot2_f32_bf16 v19, v65, s47, 0
    s_waitcnt vmcnt(4)
    v_dot2_f32_bf16 v16, v66, s46, v16
    v_dot2_f32_bf16 v17, v66, s47, v17
    v_dot2_f32_bf16 v18, v67, s46, v18
    v_dot2_f32_bf16 v19, v67, s47, v19
    v_add_f32 v20, v56, v57
    s_waitcnt vmcnt(2)
    v_dot2_f32_bf16 v16, v68, s46, v16
    v_dot2_f32_bf16 v17, v68, s47, v17
    v_dot2_f32_bf16 v18, v69, s46, v18
    v_dot2_f32_bf16 v19, v69, s47, v19
    v_add_f32 v20, v20, v58
    s_waitcnt vmcnt(0)
    v_dot2_f32_bf16 v16, v70, s46, v16
    v_dot2_f32_bf16 v17, v70, s47, v17
    v_dot2_f32_bf16 v18, v71, s46, v18
    v_dot2_f32_bf16 v19, v71, s47, v19
    v_add_f32 v20, v20, v59
    s_nop 0
    v_cmp_u_f32 s[46:47], v16, v17
    v_cmp_u_f32 s[48:49], v18, v19
    v_cmp_u_f32 vcc, v20, v20
    v_max3_f32 v10, v16, v17, v18
    s_or_b64 s[46:47], s[46:47], s[48:49]
    v_max3_f32 v10, v10, v19, v20
    s_or_b64 vcc, vcc, s[46:47]
    s_cbranch_scc1 L_s_xf_208
L_s_xok_209:
    v_max_f32_dpp v11, v10, v10 row_ror:8 row_mask:0xf bank_mask:0xf
    v_max_f32_dpp v10, v10, v10 row_ror:8 row_mask:0xf bank_mask:0xf
    s_nop 1
    v_permlane16_swap_b32 v10, v11
    v_max_f32 v12, v10, v11
    v_max_f32 v10, v10, v11
    s_nop 1
    v_permlane32_swap_b32 v10, v12
    v_max_f32 v10, v10, v12
    v_mul_f32 v10, s66, v10
    v_fma_f32 v16, v16, s66, -v10
    v_fma_f32 v17, v17, s66, -v10
    v_fma_f32 v18, v18, s66, -v10
    v_fma_f32 v19, v19, s66, -v10
    v_fma_f32 v20, v20, s66, -v10
    v_exp_f32 v16, v16
    v_exp_f32 v17, v17
    v_exp_f32 v18, v18
    v_exp_f32 v19, v19
    v_exp_f32 v20, v20
    v_add_f32 v10, v16, v17
    v_add_f32 v11, v18, v19
    v_add_f32 v10, v10, v20
    v_add_f32 v10, v10, v11
    s_nop 1
    v_add_f32_dpp v11, v10, v10 row_ror:8 row_mask:0xf bank_mask:0xf
    v_add_f32_dpp v10, v10, v10 row_ror:8 row_mask:0xf bank_mask:0xf
    s_nop 1
    v_permlane16_swap_b32 v10, v11
    v_add_f32 v12, v10, v11
    v_add_f32 v10, v10, v11
    s_nop 1
    v_permlane32_swap_b32 v10, v12
    v_add_f32 v10, v10, v12
    v_rcp_f32 v10, v10
    s_nop 0
    v_mul_f32 v16, v16, v10
    v_mul_f32 v17, v17, v10
    v_mul_f32 v18, v18, v10
    v_mul_f32 v19, v19, v10
    v_mul_f32 v20, v20, v10
    v_cvt_pk_bf16_f32 v16, v16, v17
    v_cvt_pk_bf16_f32 v17, v18, v19
    v_cvt_pk_bf16_f32 v18, v20, v20
    ds_write_b64 v8, v[16:17]
    ds_write_b16 v9, v18
    s_waitcnt lgkmcnt(0)
    s_barrier
    s_add_u32 s63, s63, 786432
    s_cmp_ge_u32 s44, 2
    s_cbranch_scc1 L_s_nk_210
    buffer_load_dwordx4 v[32:35], v6, s[12:15], s63 offen sc1
L_s_nk_210:
    s_add_u32 s45, s60, 2
    s_cmp_le_u32 s69, s45
    s_cbranch_scc1 L_s_nk_210_w
    s_add_u32 s45, s63, 786432
    s_mov_b64 exec, 0xf
    buffer_load_dword v15, v14, s[12:15], s45 offen sc1
    s_mov_b64 exec, -1
L_s_nk_210_w:
    s_cmp_eq_u32 s44, 3
    s_cbranch_scc1 L_s_nr_211
    s_xor_b32 s45, s61, 0x8000
    s_mov_b64 exec, s[50:51]
    buffer_store_dwordx2 v[24:25], v4, s[12:15], s45 offen
    s_mov_b64 exec, -1
L_s_nr_211:
    s_cmp_lg_u32 s44, 3
    s_cbranch_scc1 L_s_np_212
    ds_read_b128 v[20:23], v6
    s_lshl_b32 s45, s60, 17
    s_add_u32 s45, s45, s67
    s_waitcnt lgkmcnt(0)
    v_min_u32 v20, -2, v20
    v_min_u32 v21, -2, v21
    v_min_u32 v22, -2, v22
    v_min_u32 v23, -2, v23
    buffer_store_dwordx4 v[20:23], v2, s[12:15], s45 offen sc1
L_s_np_212:
    s_add_u32 s68, s60, 2
    s_min_u32 s68, s68, 63
    v_readlane_b32 s45, v0, 0
    v_readlane_b32 s46, v0, 1
    s_nop 0
    s_min_u32 s45, s45, s46
    s_max_u32 s69, s69, s45
    s_cmp_gt_u32 s69, s68
    s_cbranch_scc1 L_kv_ok_215
    s_mov_b32 s70, 0
L_kv_lp_214:
    v_and_b32 v22, 1, v1
    v_lshlrev_b32 v22, 9, v22
    buffer_load_dword v23, v22, s[12:15], s57 offen sc1
    s_waitcnt vmcnt(0)
    v_readlane_b32 s69, v23, 0
    v_readlane_b32 s45, v23, 1
    s_add_u32 s70, s70, 1
    s_nop 2
    s_min_u32 s69, s69, s45
    s_cmp_gt_u32 s69, s68
    s_cbranch_scc1 L_kv_ok_215
    s_sleep 4
    s_cmp_lt_u32 s70, 524288
    s_cbranch_scc1 L_kv_lp_214
    s_branch L_c_done_1
L_kv_ok_215:
    s_add_u32 s45, s60, 7
    s_min_u32 s45, s45, 63
    s_cmp_gt_u32 s69, s45
    s_cbranch_scc1 L_s_na_213
    v_and_b32 v22, 1, v1
    v_lshlrev_b32 v22, 9, v22
    buffer_load_dword v0, v22, s[12:15], s57 offen sc1
L_s_na_213:
    s_sub_u32 s45, s60, 4
    s_cmp_gt_u32 s45, 24
    s_cbranch_scc1 L_s_xe_216
    s_sleep 1
    s_setprio 0
    s_bitcmp1_b32 s45, 0
    s_cbranch_scc1 L_s_x1_217
    s_cmp_eq_u32 s45, 0
    s_cbranch_scc1 L_s_x0_218
    s_bitcmp1_b32 s44, 0
    s_cbranch_scc1 L_s_x0_218
    ds_read_b128 v[40:43], v31
    s_sub_u32 s46, s45, 2
    s_lshr_b32 s47, s46, 2
    s_mul_i32 s47, s47, 786432
    s_and_b32 s46, s46, 2
    s_lshl_b32 s46, s46, 11
    s_add_u32 s47, s47, s46
    s_waitcnt lgkmcnt(0)
    buffer_store_dwordx4 v[40:43], v13, s[12:15], s47 offen sc1
L_s_x0_218:
    s_cmp_eq_u32 s45, 24
    s_cbranch_scc1 L_s_xe_216
    ds_read_b128 v[64:67], v44 offset:0
    ds_read_b128 v[68:71], v44 offset:1024
    ds_read_b128 v[72:75], v44 offset:2048
    ds_read_b128 v[76:79], v44 offset:3072
    ds_read_b128 v[80:83], v44 offset:4096
    ds_read_b128 v[84:87], v44 offset:5120
    ds_read_b128 v[88:91], v44 offset:6144
    ds_read_b128 v[92:95], v44 offset:7168
    ds_read_b128 v[96:99], v44 offset:8192
    ds_read_b128 v[100:103], v44 offset:9216
    ds_read_b128 v[104:107], v44 offset:10240
    ds_read_b128 v[108:111], v44 offset:11264
    s_waitcnt lgkmcnt(11)
    v_mfma_f32_16x16x32_bf16 v[36:39], a[0:3], v[64:67], 0
    ds_read_b128 v[112:115], v44 offset:12288
    s_waitcnt lgkmcnt(11)
    v_mfma_f32_16x16x32_bf16 v[36:39], a[4:7], v[68:71], v[36:39]
    ds_read_b128 v[116:119], v44 offset:13312
    s_waitcnt lgkmcnt(11)
    v_mfma_f32_16x16x32_bf16 v[36:39], a[8:11], v[72:75], v[36:39]
    ds_read_b128 v[120:123], v44 offset:14336
    s_waitcnt lgkmcnt(11)
    v_mfma_f32_16x16x32_bf16 v[36:39], a[12:15], v[76:79], v[36:39]
    ds_read_b128 v[124:127], v44 offset:15360
    s_waitcnt lgkmcnt(11)
    v_mfma_f32_16x16x32_bf16 v[36:39], a[16:19], v[80:83], v[36:39]
    s_waitcnt lgkmcnt(10)
    v_mfma_f32_16x16x32_bf16 v[36:39], a[20:23], v[84:87], v[36:39]
    s_waitcnt lgkmcnt(9)
    v_mfma_f32_16x16x32_bf16 v[36:39], a[24:27], v[88:91], v[36:39]
    s_waitcnt lgkmcnt(8)
    v_mfma_f32_16x16x32_bf16 v[36:39], a[28:31], v[92:95], v[36:39]
    s_waitcnt lgkmcnt(7)
    v_mfma_f32_16x16x32_bf16 v[36:39], a[32:35], v[96:99], v[36:39]
    s_waitcnt lgkmcnt(6)
    v_mfma_f32_16x16x32_bf16 v[36:39], a[36:39], v[100:103], v[36:39]
    s_waitcnt lgkmcnt(5)
    v_mfma_f32_16x16x32_bf16 v[36:39], a[40:43], v[104:107], v[36:39]
    s_waitcnt lgkmcnt(4)
    v_mfma_f32_16x16x32_bf16 v[36:39], a[44:47], v[108:111], v[36:39]
    s_waitcnt lgkmcnt(3)
    v_mfma_f32_16x16x32_bf16 v[36:39], a[48:51], v[112:115], v[36:39]
    s_waitcnt lgkmcnt(2)
    v_mfma_f32_16x16x32_bf16 v[36:39], a[52:55], v[116:119], v[36:39]
    s_waitcnt lgkmcnt(1)
    v_mfma_f32_16x16x32_bf16 v[36:39], a[56:59], v[120:123], v[36:39]
    s_waitcnt lgkmcnt(0)
    v_mfma_f32_16x16x32_bf16 v[36:39], a[60:63], v[124:127], v[36:39]
    s_branch L_s_xe_216
L_s_x1_217:
    ds_read_b128 v[64:67], v44 offset:16384
    ds_read_b128 v[68:71], v44 offset:17408
    ds_read_b128 v[72:75], v44 offset:18432
    ds_read_b128 v[76:79], v44 offset:19456
    ds_read_b128 v[80:83], v44 offset:20480
    ds_read_b128 v[84:87], v44 offset:21504
    ds_read_b128 v[88:91], v44 offset:22528
    ds_read_b128 v[92:95], v44 offset:23552
    ds_read_b128 v[96:99], v44 offset:24576
    ds_read_b128 v[100:103], v44 offset:25600
    ds_read_b128 v[104:107], v44 offset:26624
    ds_read_b128 v[108:111], v44 offset:27648
    s_waitcnt lgkmcnt(11)
    v_mfma_f32_16x16x32_bf16 v[36:39], a[64:67], v[64:67], v[36:39]
    ds_read_b128 v[112:115], v44 offset:28672
    s_waitcnt lgkmcnt(11)
    v_mfma_f32_16x16x32_bf16 v[36:39], a[68:71], v[68:71], v[36:39]
    ds_read_b128 v[116:119], v44 offset:29696
    s_waitcnt lgkmcnt(11)
    v_mfma_f32_16x16x32_bf16 v[36:39], a[72:75], v[72:75], v[36:39]
    ds_read_b128 v[120:123], v44 offset:30720
    s_waitcnt lgkmcnt(11)
    v_mfma_f32_16x16x32_bf16 v[36:39], a[76:79], v[76:79], v[36:39]
    ds_read_b128 v[124:127], v44 offset:31744
    s_waitcnt lgkmcnt(11)
    v_mfma_f32_16x16x32_bf16 v[36:39], a[80:83], v[80:83], v[36:39]
    s_waitcnt lgkmcnt(10)
    v_mfma_f32_16x16x32_bf16 v[36:39], a[84:87], v[84:87], v[36:39]
    s_waitcnt lgkmcnt(9)
    v_mfma_f32_16x16x32_bf16 v[36:39], a[88:91], v[88:91], v[36:39]
    s_waitcnt lgkmcnt(8)
    v_mfma_f32_16x16x32_bf16 v[36:39], a[92:95], v[92:95], v[36:39]
    s_waitcnt lgkmcnt(7)
    v_mfma_f32_16x16x32_bf16 v[36:39], a[96:99], v[96:99], v[36:39]
    s_waitcnt lgkmcnt(6)
    v_mfma_f32_16x16x32_bf16 v[36:39], a[100:103], v[100:103], v[36:39]
    s_waitcnt lgkmcnt(5)
    v_mfma_f32_16x16x32_bf16 v[36:39], a[104:107], v[104:107], v[36:39]
    s_waitcnt lgkmcnt(4)
    v_mfma_f32_16x16x32_bf16 v[36:39], a[108:111], v[108:111], v[36:39]
    s_waitcnt lgkmcnt(3)
    v_mfma_f32_16x16x32_bf16 v[36:39], a[112:115], v[112:115], v[36:39]
    s_waitcnt lgkmcnt(2)
    v_mfma_f32_16x16x32_bf16 v[36:39], a[116:119], v[116:119], v[36:39]
    s_waitcnt lgkmcnt(1)
    v_mfma_f32_16x16x32_bf16 v[36:39], a[120:123], v[120:123], v[36:39]
    s_waitcnt lgkmcnt(0)
    v_mfma_f32_16x16x32_bf16 v[36:39], a[124:127], v[124:127], v[36:39]
    s_nop 7
    v_cvt_pk_bf16_f32 v40, v36, v37
    v_cvt_pk_bf16_f32 v41, v38, v39
    ds_write_b64 v45, v[40:41]
    s_waitcnt lgkmcnt(0)
L_s_xe_216:
    s_setprio 1
    s_add_u32 s60, s60, 1
    s_add_u32 s61, s61, 0x4000
    s_and_b32 s61, s61, 0xffff
    s_branch L_s_loop_200
L_s_last_201:
    s_waitcnt lgkmcnt(0)
    s_barrier
    s_cmp_lg_u32 s44, 3
    s_cbranch_scc1 L_s_np_219
    ds_read_b128 v[20:23], v6
    s_lshl_b32 s45, s60, 17
    s_add_u32 s45, s45, s67
    s_waitcnt lgkmcnt(0)
    v_min_u32 v20, -2, v20
    v_min_u32 v21, -2, v21
    v_min_u32 v22, -2, v22
    v_min_u32 v23, -2, v23
    buffer_store_dwordx4 v[20:23], v2, s[12:15], s45 offen sc1
L_s_np_219:
    s_branch L_replica
L_rt_195:
    s_add_u32 s70, s70, 1
    s_cmp_lt_u32 s70, 524288
    s_cbranch_scc1 L_c_rp_194
    s_branch L_c_done_1
L_rt_205:
    s_add_u32 s70, s70, 1
    s_cmp_lt_u32 s70, 524288
    s_cbranch_scc1 L_s_xl_202
    s_branch L_c_done_1
L_s_w2_203:
    s_cmp_eq_u32 s44, 3
    s_cbranch_scc1 L_s_w3_204
    s_waitcnt lgkmcnt(0)
    v_mfma_f32_16x16x32_bf16 v[16:19], v[64:67], v[64:67], 0
    s_branch L_s_w2_203_b
L_s_w3_204:
    s_sleep 3
    s_branch L_s_w3_204_b
L_s_xf_208:
    v_or_b32 v72, 0xffff, v56
    v_or_b32 v73, 0xffff, v57
    v_or_b32 v74, 0xffff, v58
    v_or_b32 v75, 0xffff, v59
    v_max3_u32 v11, v64, v65, v66
    v_max3_u32 v11, v11, v67, v68
    v_max3_u32 v11, v11, v69, v70
    v_max3_u32 v11, v11, v71, v72
    v_max3_u32 v11, v11, v73, v74
    v_max_u32 v11, v11, v75
    v_cmp_eq_u32 vcc, -1, v11
    s_add_u32 s70, s70, 1
    s_cbranch_vccz L_s_xok_209
    s_cmp_lt_u32 s70, 524288
    s_cbranch_scc1 L_s_xp_207
    s_branch L_c_done_1
L_ss_197:
.p2align 6
L_s_loop_220:
    v_mov_b32 v16, 0
    v_mov_b32 v17, 0
    v_mov_b32 v18, 0
    v_mov_b32 v19, 0
    s_add_u32 s58, s58, 4
    s_mov_b32 s70, 1
    s_waitcnt vmcnt(0) lgkmcnt(0)
    s_barrier
    ds_read_b128 v[64:67], v2 offset:0
    ds_read_b128 v[68:71], v2 offset:1024
    ds_read_b128 v[72:75], v2 offset:2048
    ds_read_b128 v[76:79], v2 offset:3072
    ds_read_b128 v[80:83], v2 offset:4096
    ds_read_b128 v[84:87], v2 offset:5120
    ds_read_b128 v[88:91], v2 offset:6144
    ds_read_b128 v[92:95], v2 offset:7168
    ds_read_b128 v[96:99], v2 offset:8192
    ds_read_b128 v[100:103], v2 offset:9216
    ds_read_b128 v[104:107], v2 offset:10240
    ds_read_b128 v[108:111], v2 offset:11264
    s_waitcnt lgkmcnt(11)
    v_smfmac_f32_16x16x64_bf16 v[16:19], v[64:67], a[0:7], v3
    ds_read_b128 v[112:115], v2 offset:12288
    s_waitcnt lgkmcnt(11)
    v_smfmac_f32_16x16x64_bf16 v[16:19], v[68:71], a[8:15], v3
    ds_read_b128 v[116:119], v2 offset:13312
    s_waitcnt lgkmcnt(11)
    v_smfmac_f32_16x16x64_bf16 v[16:19], v[72:75], a[16:23], v3
    ds_read_b128 v[120:123], v2 offset:14336
    s_waitcnt lgkmcnt(11)
    v_smfmac_f32_16x16x64_bf16 v[16:19], v[76:79], a[24:31], v3
    ds_read_b128 v[124:127], v2 offset:15360
    s_waitcnt lgkmcnt(11)
    v_smfmac_f32_16x16x64_bf16 v[16:19], v[80:83], a[32:39], v3
    s_waitcnt lgkmcnt(10)
    v_smfmac_f32_16x16x64_bf16 v[16:19], v[84:87], a[40:47], v3
    s_waitcnt lgkmcnt(9)
    v_smfmac_f32_16x16x64_bf16 v[16:19], v[88:91], a[48:55], v3
    s_waitcnt lgkmcnt(8)
    v_smfmac_f32_16x16x64_bf16 v[16:19], v[92:95], a[56:63], v3
    s_waitcnt lgkmcnt(7)
    v_smfmac_f32_16x16x64_bf16 v[16:19], v[96:99], a[64:71], v3
    s_waitcnt lgkmcnt(6)
    v_smfmac_f32_16x16x64_bf16 v[16:19], v[100:103], a[72:79], v3
    s_waitcnt lgkmcnt(5)
    v_smfmac_f32_16x16x64_bf16 v[16:19], v[104:107], a[80:87], v3
    s_waitcnt lgkmcnt(4)
    v_smfmac_f32_16x16x64_bf16 v[16:19], v[108:111], a[88:95], v3
    s_waitcnt lgkmcnt(3)
    v_smfmac_f32_16x16x64_bf16 v[16:19], v[112:115], a[96:103], v3
    s_waitcnt lgkmcnt(2)
    v_smfmac_f32_16x16x64_bf16 v[16:19], v[116:119], a[104:111], v3
    s_waitcnt lgkmcnt(1)
    v_smfmac_f32_16x16x64_bf16 v[16:19], v[120:123], a[112:119], v3
    s_waitcnt lgkmcnt(0)
    v_smfmac_f32_16x16x64_bf16 v[16:19], v[124:127], a[120:127], v3
    s_nop 7
    v_permlane32_swap_b32 v16, v18
    v_permlane32_swap_b32 v17, v19
    v_add_f32 v16, v16, v18
    v_add_f32 v17, v17, v19
    v_cvt_pk_bf16_f32 v16, v16, v17
    ds_write_b16 v5, v16
    ds_write_b16_d16_hi v5, v16 offset:16
    s_mov_b64 exec, 1
    ds_add_u32 v29, v30
    s_mov_b64 exec, -1
L_s_xl_222:
    ds_read_b32 v10, v29
    ds_read_b128 v[64:67], v2 offset:61440
    s_cmp_eq_u32 s60, 63
    s_cbranch_scc1 L_s_last_221
    s_cmp_ge_u32 s44, 2
    s_cbranch_scc1 L_s_w2_223
    s_waitcnt lgkmcnt(0)
    v_mfma_f32_16x16x32_bf16 v[16:19], v[32:35], v[64:67], 0
L_s_w2_223_b:
    v_cmp_ne_u32 vcc, s58, v10
    s_nop 0
    s_cbranch_vccnz L_rt_225
    s_mov_b64 exec, s[50:51]
    s_nop 3
    v_cvt_pk_bf16_f32 v16, v16, v17
    v_cvt_pk_bf16_f32 v17, v18, v19
    v_pk_min_u16 v16, v16, v54
    v_pk_min_u16 v17, v17, v54
    buffer_store_dwordx2 v[16:17], v4, s[12:15], s61 offen sc1
    s_mov_b64 exec, -1
L_s_w3_224_b:
    s_sleep 5
    s_mov_b32 s70, 1
L_s_xp_227:
    buffer_load_dwordx2 v[64:65], v7, s[12:15], s61 offen offset:0 sc1
    buffer_load_short_d16_hi v56, v28, s[12:15], s61 offen offset:0 sc1
    buffer_load_dwordx2 v[66:67], v7, s[12:15], s61 offen offset:512 sc1
    buffer_load_short_d16_hi v57, v28, s[12:15], s61 offen offset:128 sc1
    buffer_load_dwordx2 v[68:69], v7, s[12:15], s61 offen offset:1024 sc1
    buffer_load_short_d16_hi v58, v28, s[12:15], s61 offen offset:256 sc1
    buffer_load_dwordx2 v[70:71], v7, s[12:15], s61 offen offset:1536 sc1
    buffer_load_short_d16_hi v59, v28, s[12:15], s61 offen offset:384 sc1
L_s_xc_226_b:
    s_mov_b32 s46, 0x00003f80
    s_mov_b32 s47, 0x3f800000
    s_waitcnt vmcnt(6)
    v_dot2_f32_bf16 v16, v64, s46, 0
    v_dot2_f32_bf16 v17, v64, s47, 0
    v_dot2_f32_bf16 v18, v65, s46, 0
    v_dot2_f32_bf16 v19, v65, s47, 0
    s_waitcnt vmcnt(4)
    v_dot2_f32_bf16 v16, v66, s46, v16
    v_dot2_f32_bf16 v17, v66, s47, v17
    v_dot2_f32_bf16 v18, v67, s46, v18
    v_dot2_f32_bf16 v19, v67, s47, v19
    v_add_f32 v20, v56, v57
    s_waitcnt vmcnt(2)
    v_dot2_f32_bf16 v16, v68, s46, v16
    v_dot2_f32_bf16 v17, v68, s47, v17
    v_dot2_f32_bf16 v18, v69, s46, v18
    v_dot2_f32_bf16 v19, v69, s47, v19
    v_add_f32 v20, v20, v58
    s_waitcnt vmcnt(0)
    v_dot2_f32_bf16 v16, v70, s46, v16
    v_dot2_f32_bf16 v17, v70, s47, v17
    v_dot2_f32_bf16 v18, v71, s46, v18
    v_dot2_f32_bf16 v19, v71, s47, v19
    v_add_f32 v20, v20, v59
    s_nop 0
    v_cmp_u_f32 s[46:47], v16, v17
    v_cmp_u_f32 s[48:49], v18, v19
    v_cmp_u_f32 vcc, v20, v20
    v_max3_f32 v10, v16, v17, v18
    s_or_b64 s[46:47], s[46:47], s[48:49]
    v_max3_f32 v10, v10, v19, v20
    s_or_b64 vcc, vcc, s[46:47]
    s_cbranch_scc1 L_s_xf_228
L_s_xok_229:
    v_max_f32_dpp v11, v10, v10 row_ror:8 row_mask:0xf bank_mask:0xf
    v_max_f32_dpp v10, v10, v10 row_ror:8 row_mask:0xf bank_mask:0xf
    s_nop 1
    v_permlane16_swap_b32 v10, v11
    v_max_f32 v12, v10, v11
    v_max_f32 v10, v10, v11
    s_nop 1
    v_permlane32_swap_b32 v10, v12
    v_max_f32 v10, v10, v12
    v_mul_f32 v10, s66, v10
    v_fma_f32 v16, v16, s66, -v10
    v_fma_f32 v17, v17, s66, -v10
    v_fma_f32 v18, v18, s66, -v10
    v_fma_f32 v19, v19, s66, -v10
    v_fma_f32 v20, v20, s66, -v10
    v_exp_f32 v16, v16
    v_exp_f32 v17, v17
    v_exp_f32 v18, v18
    v_exp_f32 v19, v19
    v_exp_f32 v20, v20
    v_add_f32 v10, v16, v17
    v_add_f32 v11, v18, v19
    v_add_f32 v10, v10, v20
    v_add_f32 v10, v10, v11
    s_nop 1
    v_add_f32_dpp v11, v10, v10 row_ror:8 row_mask:0xf bank_mask:0xf
    v_add_f32_dpp v10, v10, v10 row_ror:8 row_mask:0xf bank_mask:0xf
    s_nop 1
    v_permlane16_swap_b32 v10, v11
    v_add_f32 v12, v10, v11
    v_add_f32 v10, v10, v11
    s_nop 1
    v_permlane32_swap_b32 v10, v12
    v_add_f32 v10, v10, v12
    v_rcp_f32 v10, v10
    s_nop 0
    v_mul_f32 v16, v16, v10
    v_mul_f32 v17, v17, v10
    v_mul_f32 v18, v18, v10
    v_mul_f32 v19, v19, v10
    v_mul_f32 v20, v20, v10
    v_cvt_pk_bf16_f32 v16, v16, v17
    v_cvt_pk_bf16_f32 v17, v18, v19
    v_cvt_pk_bf16_f32 v18, v20, v20
    ds_write_b64 v8, v[16:17]
    ds_write_b16 v9, v18
    s_waitcnt lgkmcnt(0)
    s_barrier
    s_add_u32 s63, s63, 786432
    s_cmp_ge_u32 s44, 2
    s_cbranch_scc1 L_s_nk_230
    buffer_load_dwordx4 v[32:35], v6, s[12:15], s63 offen sc1
L_s_nk_230:
    s_add_u32 s45, s60, 2
    s_cmp_le_u32 s69, s45
    s_cbranch_scc1 L_s_nk_230_w
    s_add_u32 s45, s63, 786432
    s_mov_b64 exec, 0xf
    buffer_load_dword v15, v14, s[12:15], s45 offen sc1
    s_mov_b64 exec, -1
L_s_nk_230_w:
    s_cmp_eq_u32 s44, 3
    s_cbranch_scc1 L_s_nr_231
    s_xor_b32 s45, s61, 0x8000
    s_mov_b64 exec, s[50:51]
    buffer_store_dwordx2 v[24:25], v4, s[12:15], s45 offen sc1
    s_mov_b64 exec, -1
L_s_nr_231:
    s_cmp_lg_u32 s44, 3
    s_cbranch_scc1 L_s_np_232
    ds_read_b128 v[20:23], v6
    s_lshl_b32 s45, s60, 17
    s_add_u32 s45, s45, s67
    s_waitcnt lgkmcnt(0)
    v_min_u32 v20, -2, v20
    v_min_u32 v21, -2, v21
    v_min_u32 v22, -2, v22
    v_min_u32 v23, -2, v23
    buffer_store_dwordx4 v[20:23], v2, s[12:15], s45 offen sc1
L_s_np_232:
    s_add_u32 s68, s60, 2
    s_min_u32 s68, s68, 63
    v_readlane_b32 s45, v0, 0
    v_readlane_b32 s46, v0, 1
    s_nop 0
    s_min_u32 s45, s45, s46
    s_max_u32 s69, s69, s45
    s_cmp_gt_u32 s69, s68
    s_cbranch_scc1 L_kv_ok_235
    s_mov_b32 s70, 0
L_kv_lp_234:
    v_and_b32 v22, 1, v1
    v_lshlrev_b32 v22, 9, v22
    buffer_load_dword v23, v22, s[12:15], s57 offen sc1
    s_waitcnt vmcnt(0)
    v_readlane_b32 s69, v23, 0
    v_readlane_b32 s45, v23, 1
    s_add_u32 s70, s70, 1
    s_nop 2
    s_min_u32 s69, s69, s45
    s_cmp_gt_u32 s69, s68
    s_cbranch_scc1 L_kv_ok_235
    s_sleep 4
    s_cmp_lt_u32 s70, 524288
    s_cbranch_scc1 L_kv_lp_234
    s_branch L_c_done_1
L_kv_ok_235:
    s_add_u32 s45, s60, 7
    s_min_u32 s45, s45, 63
    s_cmp_gt_u32 s69, s45
    s_cbranch_scc1 L_s_na_233
    v_and_b32 v22, 1, v1
    v_lshlrev_b32 v22, 9, v22
    buffer_load_dword v0, v22, s[12:15], s57 offen sc1
L_s_na_233:
    s_sub_u32 s45, s60, 4
    s_cmp_gt_u32 s45, 24
    s_cbranch_scc1 L_s_xe_236
    s_sleep 1
    s_setprio 0
    s_bitcmp1_b32 s45, 0
    s_cbranch_scc1 L_s_x1_237
    s_cmp_eq_u32 s45, 0
    s_cbranch_scc1 L_s_x0_238
    s_bitcmp1_b32 s44, 0
    s_cbranch_scc1 L_s_x0_238
    ds_read_b128 v[40:43], v31
    s_sub_u32 s46, s45, 2
    s_lshr_b32 s47, s46, 2
    s_mul_i32 s47, s47, 786432
    s_and_b32 s46, s46, 2
    s_lshl_b32 s46, s46, 11
    s_add_u32 s47, s47, s46
    s_waitcnt lgkmcnt(0)
    buffer_store_dwordx4 v[40:43], v13, s[12:15], s47 offen sc1
L_s_x0_238:
    s_cmp_eq_u32 s45, 24
    s_cbranch_scc1 L_s_xe_236
    ds_read_b128 v[64:67], v44 offset:0
    ds_read_b128 v[68:71], v44 offset:1024
    ds_read_b128 v[72:75], v44 offset:2048
    ds_read_b128 v[76:79], v44 offset:3072
    ds_read_b128 v[80:83], v44 offset:4096
    ds_read_b128 v[84:87], v44 offset:5120
    ds_read_b128 v[88:91], v44 offset:6144
    ds_read_b128 v[92:95], v44 offset:7168
    ds_read_b128 v[96:99], v44 offset:8192
    ds_read_b128 v[100:103], v44 offset:9216
    ds_read_b128 v[104:107], v44 offset:10240
    ds_read_b128 v[108:111], v44 offset:11264
    s_waitcnt lgkmcnt(11)
    v_mfma_f32_16x16x32_bf16 v[36:39], a[0:3], v[64:67], 0
    ds_read_b128 v[112:115], v44 offset:12288
    s_waitcnt lgkmcnt(11)
    v_mfma_f32_16x16x32_bf16 v[36:39], a[4:7], v[68:71], v[36:39]
    ds_read_b128 v[116:119], v44 offset:13312
    s_waitcnt lgkmcnt(11)
    v_mfma_f32_16x16x32_bf16 v[36:39], a[8:11], v[72:75], v[36:39]
    ds_read_b128 v[120:123], v44 offset:14336
    s_waitcnt lgkmcnt(11)
    v_mfma_f32_16x16x32_bf16 v[36:39], a[12:15], v[76:79], v[36:39]
    ds_read_b128 v[124:127], v44 offset:15360
    s_waitcnt lgkmcnt(11)
    v_mfma_f32_16x16x32_bf16 v[36:39], a[16:19], v[80:83], v[36:39]
    s_waitcnt lgkmcnt(10)
    v_mfma_f32_16x16x32_bf16 v[36:39], a[20:23], v[84:87], v[36:39]
    s_waitcnt lgkmcnt(9)
    v_mfma_f32_16x16x32_bf16 v[36:39], a[24:27], v[88:91], v[36:39]
    s_waitcnt lgkmcnt(8)
    v_mfma_f32_16x16x32_bf16 v[36:39], a[28:31], v[92:95], v[36:39]
    s_waitcnt lgkmcnt(7)
    v_mfma_f32_16x16x32_bf16 v[36:39], a[32:35], v[96:99], v[36:39]
    s_waitcnt lgkmcnt(6)
    v_mfma_f32_16x16x32_bf16 v[36:39], a[36:39], v[100:103], v[36:39]
    s_waitcnt lgkmcnt(5)
    v_mfma_f32_16x16x32_bf16 v[36:39], a[40:43], v[104:107], v[36:39]
    s_waitcnt lgkmcnt(4)
    v_mfma_f32_16x16x32_bf16 v[36:39], a[44:47], v[108:111], v[36:39]
    s_waitcnt lgkmcnt(3)
    v_mfma_f32_16x16x32_bf16 v[36:39], a[48:51], v[112:115], v[36:39]
    s_waitcnt lgkmcnt(2)
    v_mfma_f32_16x16x32_bf16 v[36:39], a[52:55], v[116:119], v[36:39]
    s_waitcnt lgkmcnt(1)
    v_mfma_f32_16x16x32_bf16 v[36:39], a[56:59], v[120:123], v[36:39]
    s_waitcnt lgkmcnt(0)
    v_mfma_f32_16x16x32_bf16 v[36:39], a[60:63], v[124:127], v[36:39]
    s_branch L_s_xe_236
L_s_x1_237:
    ds_read_b128 v[64:67], v44 offset:16384
    ds_read_b128 v[68:71], v44 offset:17408
    ds_read_b128 v[72:75], v44 offset:18432
    ds_read_b128 v[76:79], v44 offset:19456
    ds_read_b128 v[80:83], v44 offset:20480
    ds_read_b128 v[84:87], v44 offset:21504
    ds_read_b128 v[88:91], v44 offset:22528
    ds_read_b128 v[92:95], v44 offset:23552
    ds_read_b128 v[96:99], v44 offset:24576
    ds_read_b128 v[100:103], v44 offset:25600
    ds_read_b128 v[104:107], v44 offset:26624
    ds_read_b128 v[108:111], v44 offset:27648
    s_waitcnt lgkmcnt(11)
    v_mfma_f32_16x16x32_bf16 v[36:39], a[64:67], v[64:67], v[36:39]
    ds_read_b128 v[112:115], v44 offset:28672
    s_waitcnt lgkmcnt(11)
    v_mfma_f32_16x16x32_bf16 v[36:39], a[68:71], v[68:71], v[36:39]
    ds_read_b128 v[116:119], v44 offset:29696
    s_waitcnt lgkmcnt(11)
    v_mfma_f32_16x16x32_bf16 v[36:39], a[72:75], v[72:75], v[36:39]
    ds_read_b128 v[120:123], v44 offset:30720
    s_waitcnt lgkmcnt(11)
    v_mfma_f32_16x16x32_bf16 v[36:39], a[76:79], v[76:79], v[36:39]
    ds_read_b128 v[124:127], v44 offset:31744
    s_waitcnt lgkmcnt(11)
    v_mfma_f32_16x16x32_bf16 v[36:39], a[80:83], v[80:83], v[36:39]
    s_waitcnt lgkmcnt(10)
    v_mfma_f32_16x16x32_bf16 v[36:39], a[84:87], v[84:87], v[36:39]
    s_waitcnt lgkmcnt(9)
    v_mfma_f32_16x16x32_bf16 v[36:39], a[88:91], v[88:91], v[36:39]
    s_waitcnt lgkmcnt(8)
    v_mfma_f32_16x16x32_bf16 v[36:39], a[92:95], v[92:95], v[36:39]
    s_waitcnt lgkmcnt(7)
    v_mfma_f32_16x16x32_bf16 v[36:39], a[96:99], v[96:99], v[36:39]
    s_waitcnt lgkmcnt(6)
    v_mfma_f32_16x16x32_bf16 v[36:39], a[100:103], v[100:103], v[36:39]
    s_waitcnt lgkmcnt(5)
    v_mfma_f32_16x16x32_bf16 v[36:39], a[104:107], v[104:107], v[36:39]
    s_waitcnt lgkmcnt(4)
    v_mfma_f32_16x16x32_bf16 v[36:39], a[108:111], v[108:111], v[36:39]
    s_waitcnt lgkmcnt(3)
    v_mfma_f32_16x16x32_bf16 v[36:39], a[112:115], v[112:115], v[36:39]
    s_waitcnt lgkmcnt(2)
    v_mfma_f32_16x16x32_bf16 v[36:39], a[116:119], v[116:119], v[36:39]
    s_waitcnt lgkmcnt(1)
    v_mfma_f32_16x16x32_bf16 v[36:39], a[120:123], v[120:123], v[36:39]
    s_waitcnt lgkmcnt(0)
    v_mfma_f32_16x16x32_bf16 v[36:39], a[124:127], v[124:127], v[36:39]
    s_nop 7
    v_cvt_pk_bf16_f32 v40, v36, v37
    v_cvt_pk_bf16_f32 v41, v38, v39
    ds_write_b64 v45, v[40:41]
    s_waitcnt lgkmcnt(0)
L_s_xe_236:
    s_setprio 1
    s_add_u32 s60, s60, 1
    s_add_u32 s61, s61, 0x4000
    s_and_b32 s61, s61, 0xffff
    s_branch L_s_loop_220
L_s_last_221:
    s_waitcnt lgkmcnt(0)
    s_barrier
    s_cmp_lg_u32 s44, 3
    s_cbranch_scc1 L_s_np_239
    ds_read_b128 v[20:23], v6
    s_lshl_b32 s45, s60, 17
    s_add_u32 s45, s45, s67
    s_waitcnt lgkmcnt(0)
    v_min_u32 v20, -2, v20
    v_min_u32 v21, -2, v21
    v_min_u32 v22, -2, v22
    v_min_u32 v23, -2, v23
    buffer_store_dwordx4 v[20:23], v2, s[12:15], s45 offen sc1
L_s_np_239:
    s_branch L_replica
L_rt_225:
    s_add_u32 s70, s70, 1
    s_cmp_lt_u32 s70, 524288
    s_cbranch_scc1 L_s_xl_222
    s_branch L_c_done_1
L_s_w2_223:
    s_cmp_eq_u32 s44, 3
    s_cbranch_scc1 L_s_w3_224
    s_waitcnt lgkmcnt(0)
    v_mfma_f32_16x16x32_bf16 v[16:19], v[64:67], v[64:67], 0
    s_branch L_s_w2_223_b
L_s_w3_224:
    s_sleep 3
    s_branch L_s_w3_224_b
L_s_xf_228:
    v_or_b32 v72, 0xffff, v56
    v_or_b32 v73, 0xffff, v57
    v_or_b32 v74, 0xffff, v58
    v_or_b32 v75, 0xffff, v59
    v_max3_u32 v11, v64, v65, v66
    v_max3_u32 v11, v11, v67, v68
    v_max3_u32 v11, v11, v69, v70
    v_max3_u32 v11, v11, v71, v72
    v_max3_u32 v11, v11, v73, v74
    v_max_u32 v11, v11, v75
    v_cmp_eq_u32 vcc, -1, v11
    s_add_u32 s70, s70, 1
    s_cbranch_vccz L_s_xok_229
    s_cmp_lt_u32 s70, 524288
    s_cbranch_scc1 L_s_xp_227
    s_branch L_c_done_1
L_vf_198:
    s_cmp_eq_u32 s52, 0
    s_cbranch_scc1 L_vs_199
    s_mov_b32 s70, 1
    v_mov_b32 v16, 0
    v_mov_b32 v17, 0
    s_branch L_v_l1m_242
.p2align 6
L_v_loop_240:
    s_mov_b32 s70, 1
    buffer_load_dwordx4 v[64:67], v9, s[12:15], s61 offen offset:0 sc1
    buffer_load_dwordx4 v[68:71], v9, s[12:15], s61 offen offset:1024 sc1
    buffer_load_dwordx4 v[72:75], v9, s[12:15], s61 offen offset:2048 sc1
    buffer_load_dwordx4 v[76:79], v9, s[12:15], s61 offen offset:3072 sc1
    v_mov_b32 v16, 0
    v_mov_b32 v17, 0
    v_mov_b32 v18, 0
    v_mov_b32 v19, 0
    v_mov_b32 v20, 0
    v_mov_b32 v21, 0
    v_mov_b32 v22, 0
    v_mov_b32 v23, 0
L_v_l1m_242:
    s_waitcnt vmcnt(3)
    ds_write_b128 v10, v[64:67] offset:0
    v_max3_u32 v24, v64, v65, v66
    v_max_u32 v24, v24, v67
    v_cmp_eq_u32 s[48:49], -1, v24
    s_waitcnt vmcnt(2)
    ds_write_b128 v10, v[68:71] offset:1024
    v_max3_u32 v24, v68, v69, v70
    v_max_u32 v24, v24, v71
    v_cmp_eq_u32 s[50:51], -1, v24
    s_waitcnt vmcnt(1)
    ds_write_b128 v10, v[72:75] offset:2048
    v_max3_u32 v24, v72, v73, v74
    v_max_u32 v24, v24, v75
    v_cmp_eq_u32 s[52:53], -1, v24
    s_waitcnt vmcnt(0)
    ds_write_b128 v10, v[76:79] offset:3072
    v_max3_u32 v24, v76, v77, v78
    v_max_u32 v24, v24, v79
    v_cmp_eq_u32 s[54:55], -1, v24
    s_or_b64 s[46:47], s[48:49], s[50:51]
    s_or_b64 vcc, s[52:53], s[54:55]
    s_or_b64 vcc, vcc, s[46:47]
    s_cbranch_scc1 L_v_l1_241
L_v_l1ok_243:
    s_waitcnt lgkmcnt(0)
    s_barrier
    v_smfmac_f32_16x16x64_bf16 v[16:19], v[64:67], a[0:7], v3
    v_smfmac_f32_16x16x64_bf16 v[20:23], v[64:67], a[32:39], v3
    v_smfmac_f32_16x16x64_bf16 v[16:19], v[68:71], a[8:15], v3
    v_smfmac_f32_16x16x64_bf16 v[20:23], v[68:71], a[40:47], v3
    v_smfmac_f32_16x16x64_bf16 v[16:19], v[72:75], a[16:23], v3
    v_smfmac_f32_16x16x64_bf16 v[20:23], v[72:75], a[48:55], v3
    v_smfmac_f32_16x16x64_bf16 v[16:19], v[76:79], a[24:31], v3
    v_smfmac_f32_16x16x64_bf16 v[20:23], v[76:79], a[56:63], v3
    s_nop 6
    v_permlane32_swap_b32 v16, v18
    v_permlane32_swap_b32 v17, v19
    v_permlane32_swap_b32 v20, v22
    v_permlane32_swap_b32 v21, v23
    v_add_f32 v16, v16, v18
    v_add_f32 v17, v17, v19
    v_add_f32 v18, v20, v22
    v_add_f32 v19, v21, v23
    ds_write_b128 v14, v[16:19]
    s_mov_b64 exec, 1
    ds_add_u32 v29, v30
    s_mov_b64 exec, -1
    s_add_u32 s58, s58, 4
    s_bitcmp1_b32 s44, 0
    s_cbranch_scc1 L_v_k1_245_c
    s_mov_b32 s70, 0
L_v_rl_246:
    ds_read_b32 v24, v29
    ds_read_b64 v[16:17], v13 offset:0
    ds_read_b64 v[18:19], v13 offset:1024
    ds_read_b64 v[20:21], v13 offset:2048
    ds_read_b64 v[22:23], v13 offset:3072
    s_waitcnt lgkmcnt(2)
    v_cmp_ne_u32 vcc, s58, v24
    v_add_f32 v16, v16, v18
    v_add_f32 v17, v17, v19
    s_waitcnt lgkmcnt(0)
    s_cbranch_vccnz L_rt_247
    v_add_f32 v20, v20, v22
    v_add_f32 v21, v21, v23
    v_add_f32 v16, v16, v20
    v_add_f32 v17, v17, v21
    s_mov_b32 vcc_lo, 0x55555555
    s_mov_b32 vcc_hi, 0x55555555
    v_cndmask_b32_dpp v18, v17, v16, vcc quad_perm:[1,0,3,2] row_mask:0xf bank_mask:0xf
    s_not_b64 vcc, vcc
    v_cndmask_b32_dpp v19, v16, v17, vcc quad_perm:[1,0,3,2] row_mask:0xf bank_mask:0xf
    v_cvt_pk_bf16_f32 v18, v18, v19
    v_min_u32 v18, -2, v18
    buffer_store_dword v18, v4, s[12:15], s62 offen
    ds_write_b32 v5, v18
L_v_k1_245:
    s_cmp_eq_u32 s60, 63
    s_cbranch_scc1 L_v_last_244
    ds_read_b128 v[80:83], v27 offset:32768
    ds_read_b128 v[84:87], v27 offset:36864
    ds_read_b128 v[88:91], v27 offset:40960
    ds_read_b128 v[92:95], v27 offset:45056
    v_mov_b32 v96, 0
    v_mov_b32 v97, 0
    v_mov_b32 v98, 0
    v_mov_b32 v99, 0
    v_mov_b32 v100, 0
    v_mov_b32 v101, 0
    v_mov_b32 v102, 0
    v_mov_b32 v103, 0
    v_mov_b32 v104, 0
    v_mov_b32 v105, 0
    v_mov_b32 v106, 0
    v_mov_b32 v107, 0
    v_mov_b32 v108, 0
    v_mov_b32 v109, 0
    v_mov_b32 v110, 0
    v_mov_b32 v111, 0
    s_bitcmp1_b32 s44, 0
    s_cbranch_scc0 L_v_sv_248
    s_sleep 1
L_v_sv_248:
    s_sleep 3
    s_mov_b32 s70, 1
    buffer_load_dwordx4 v[64:67], v11, s[12:15], s62 offen offset:0 sc1
    buffer_load_dwordx4 v[68:71], v11, s[12:15], s62 offen offset:1024 sc1
L_v_vp_249_m:
    s_waitcnt vmcnt(0)
    v_max3_u32 v20, v64, v65, v66
    v_max3_u32 v20, v20, v67, v68
    v_max3_u32 v20, v20, v69, v70
    v_max_u32 v20, v20, v71
    v_cmp_eq_u32 vcc, -1, v20
    s_cbranch_vccnz L_rt_250
    v_smfmac_f32_16x16x64_bf16 v[96:99], v[64:67], a[64:71], v3
    v_smfmac_f32_16x16x64_bf16 v[96:99], v[68:71], a[72:79], v3
    v_smfmac_f32_16x16x64_bf16 v[100:103], v[64:67], a[80:87], v3
    v_smfmac_f32_16x16x64_bf16 v[100:103], v[68:71], a[88:95], v3
    v_smfmac_f32_16x16x64_bf16 v[104:107], v[64:67], a[96:103], v3
    v_smfmac_f32_16x16x64_bf16 v[104:107], v[68:71], a[104:111], v3
    v_smfmac_f32_16x16x64_bf16 v[108:111], v[64:67], a[112:119], v3
    v_smfmac_f32_16x16x64_bf16 v[108:111], v[68:71], a[120:127], v3
    s_nop 1
    v_cvt_pk_bf16_f32 v96, v96, v97
    v_cvt_pk_bf16_f32 v97, v98, v99
    ds_write_b64 v12, v[96:97] offset:0
    v_cvt_pk_bf16_f32 v100, v100, v101
    v_cvt_pk_bf16_f32 v101, v102, v103
    ds_write_b64 v12, v[100:101] offset:2048
    v_cvt_pk_bf16_f32 v104, v104, v105
    v_cvt_pk_bf16_f32 v105, v106, v107
    ds_write_b64 v12, v[104:105] offset:4096
    v_cvt_pk_bf16_f32 v108, v108, v109
    v_cvt_pk_bf16_f32 v109, v110, v111
    ds_write_b64 v12, v[108:109] offset:6144
    s_bitcmp1_b32 s44, 0
    s_cbranch_scc1 L_v_r8_251
L_v_r8_251_l:
    s_add_u32 s46, s65, 4096
    buffer_load_dwordx4 v[32:35], v15, s[12:15], s65 offen offset:0 sc1
    buffer_load_dwordx4 v[48:51], v15, s[12:15], s46 offen offset:0 sc1
    buffer_load_dwordx4 v[36:39], v15, s[12:15], s65 offen offset:1024 sc1
    buffer_load_dwordx4 v[52:55], v15, s[12:15], s46 offen offset:1024 sc1
    buffer_load_dwordx4 v[40:43], v15, s[12:15], s65 offen offset:2048 sc1
    buffer_load_dwordx4 v[56:59], v15, s[12:15], s46 offen offset:2048 sc1
    buffer_load_dwordx4 v[44:47], v15, s[12:15], s65 offen offset:3072 sc1
    buffer_load_dwordx4 v[60:63], v15, s[12:15], s46 offen offset:3072 sc1
    s_add_u32 s65, s65, 786432
L_v_r8_251:
    s_cmp_eq_u32 s60, 0
    s_cbranch_scc1 L_v_vt_252
L_v_vt_252_b:
    s_waitcnt lgkmcnt(0)
    s_barrier
    ds_read_b128 v[96:99], v2 offset:16384
    ds_read_b128 v[100:103], v2 offset:17408
    ds_read_b128 v[104:107], v2 offset:18432
    ds_read_b128 v[108:111], v2 offset:19456
    ds_read_b128 v[112:115], v31 offset:0
    ds_read_b128 v[116:119], v25 offset:0
    ds_read_b128 v[120:123], v31 offset:512
    ds_read_b128 v[124:127], v25 offset:1024
    s_waitcnt lgkmcnt(7)
    v_mfma_f32_16x16x32_bf16 v[16:19], v[80:83], v[96:99], 0
    s_waitcnt lgkmcnt(6)
    v_mfma_f32_16x16x32_bf16 v[16:19], v[84:87], v[100:103], v[16:19]
    s_waitcnt lgkmcnt(5)
    v_mfma_f32_16x16x32_bf16 v[16:19], v[88:91], v[104:107], v[16:19]
    s_waitcnt lgkmcnt(4)
    v_mfma_f32_16x16x32_bf16 v[16:19], v[92:95], v[108:111], v[16:19]
    s_waitcnt lgkmcnt(2)
    v_mfma_f32_16x16x32_bf16 v[16:19], v[116:119], v[112:115], v[16:19]
    s_waitcnt lgkmcnt(0)
    v_mfma_f32_16x16x32_bf16 v[16:19], v[124:127], v[120:123], v[16:19]
    s_mov_b32 exec_lo, 0x00ff00ff
    s_mov_b32 exec_hi, 0x00ff00ff
    s_nop 5
    v_cvt_pk_bf16_f32 v16, v16, v17
    v_cvt_pk_bf16_f32 v17, v18, v19
    v_min_u32 v16, -2, v16
    v_min_u32 v17, -2, v17
    buffer_store_dwordx2 v[16:17], v6, s[12:15], s63 offen sc1
    s_mov_b64 exec, -1
    s_waitcnt vmcnt(1)
    s_sub_u32 s45, s60, 3
    s_cmp_ge_u32 s45, 24
    s_cbranch_scc1 L_v_nx_253_s
    s_cmp_eq_u32 s45, 0
    s_cbranch_scc1 L_v_fl_254
L_v_fl_254_b:
    s_and_b32 s46, s45, 1
    s_lshl_b32 s47, s46, 14
    s_add_u32 s47, s47, s59
    s_lshl_b32 s46, s46, 15
    s_lshr_b32 s48, s45, 2
    s_lshl_b32 s48, s48, 16
    s_add_u32 s46, s46, s48
    s_and_b32 s48, s45, 2
    s_lshl_b32 s48, s48, 7
    s_add_u32 s46, s46, s48
    s_add_u32 m0, s47, 0
    s_add_u32 s48, s46, 0
    buffer_load_dwordx4 v28, s[12:15], s48 offen sc1 lds
    s_add_u32 m0, s47, 1024
    s_add_u32 s48, s46, 2048
    buffer_load_dwordx4 v28, s[12:15], s48 offen sc1 lds
    s_add_u32 m0, s47, 2048
    s_add_u32 s48, s46, 4096
    buffer_load_dwordx4 v28, s[12:15], s48 offen sc1 lds
    s_add_u32 m0, s47, 3072
    s_add_u32 s48, s46, 6144
    buffer_load_dwordx4 v28, s[12:15], s48 offen sc1 lds
L_v_nx_253:
    s_add_u32 s61, s61, 0x4000
    s_and_b32 s61, s61, 0xffff
    s_mov_b32 s70, 1
    s_sleep 5
    buffer_load_dword v96, v7, s[12:15], s63 offen offset:0 sc1
    buffer_load_dword v97, v7, s[12:15], s63 offen offset:256 sc1
    buffer_load_dword v98, v7, s[12:15], s63 offen offset:512 sc1
    buffer_load_dword v99, v7, s[12:15], s63 offen offset:768 sc1
    buffer_load_dword v100, v7, s[12:15], s63 offen offset:1024 sc1
    buffer_load_dword v101, v7, s[12:15], s63 offen offset:1280 sc1
    buffer_load_dword v102, v7, s[12:15], s63 offen offset:1536 sc1
    buffer_load_dword v103, v7, s[12:15], s63 offen offset:1792 sc1
    v_mfma_f32_16x16x32_bf16 v[64:67], v[32:35], a[64:67], 0
    v_mfma_f32_16x16x32_bf16 v[68:71], v[48:51], a[64:67], 0
    v_mfma_f32_16x16x32_bf16 v[64:67], v[36:39], a[68:71], v[64:67]
    v_mfma_f32_16x16x32_bf16 v[68:71], v[52:55], a[68:71], v[68:71]
    v_mfma_f32_16x16x32_bf16 v[64:67], v[40:43], a[72:75], v[64:67]
    v_mfma_f32_16x16x32_bf16 v[68:71], v[56:59], a[72:75], v[68:71]
    v_mfma_f32_16x16x32_bf16 v[64:67], v[44:47], a[76:79], v[64:67]
    v_mfma_f32_16x16x32_bf16 v[68:71], v[60:63], a[76:79], v[68:71]
    v_mfma_f32_16x16x32_bf16 v[72:75], v[32:35], a[80:83], 0
    v_mfma_f32_16x16x32_bf16 v[76:79], v[48:51], a[80:83], 0
    v_mfma_f32_16x16x32_bf16 v[72:75], v[36:39], a[84:87], v[72:75]
    v_mfma_f32_16x16x32_bf16 v[76:79], v[52:55], a[84:87], v[76:79]
    v_mfma_f32_16x16x32_bf16 v[72:75], v[40:43], a[88:91], v[72:75]
    v_mfma_f32_16x16x32_bf16 v[76:79], v[56:59], a[88:91], v[76:79]
    v_mfma_f32_16x16x32_bf16 v[72:75], v[44:47], a[92:95], v[72:75]
    v_mfma_f32_16x16x32_bf16 v[76:79], v[60:63], a[92:95], v[76:79]
    v_cvt_pk_bf16_f32 v64, v64, v65
    v_cvt_pk_bf16_f32 v65, v66, v67
    v_cvt_pk_bf16_f32 v66, v68, v69
    v_cvt_pk_bf16_f32 v67, v70, v71
    ds_write_b128 v10, v[64:67] offset:32768
    v_mfma_f32_16x16x32_bf16 v[80:83], v[32:35], a[96:99], 0
    v_mfma_f32_16x16x32_bf16 v[84:87], v[48:51], a[96:99], 0
    v_mfma_f32_16x16x32_bf16 v[80:83], v[36:39], a[100:103], v[80:83]
    v_mfma_f32_16x16x32_bf16 v[84:87], v[52:55], a[100:103], v[84:87]
    v_mfma_f32_16x16x32_bf16 v[80:83], v[40:43], a[104:107], v[80:83]
    v_mfma_f32_16x16x32_bf16 v[84:87], v[56:59], a[104:107], v[84:87]
    v_mfma_f32_16x16x32_bf16 v[80:83], v[44:47], a[108:111], v[80:83]
    v_mfma_f32_16x16x32_bf16 v[84:87], v[60:63], a[108:111], v[84:87]
    v_cvt_pk_bf16_f32 v72, v72, v73
    v_cvt_pk_bf16_f32 v73, v74, v75
    v_cvt_pk_bf16_f32 v74, v76, v77
    v_cvt_pk_bf16_f32 v75, v78, v79
    ds_write_b128 v10, v[72:75] offset:33792
L_v_gp_255:
    s_waitcnt vmcnt(7)
    v_lshlrev_b32 v20, 16, v96
    v_and_b32 v21, 0xffff0000, v96
    s_waitcnt vmcnt(6)
    v_lshlrev_b32 v22, 16, v97
    v_and_b32 v23, 0xffff0000, v97
    v_add_f32 v20, v20, v22
    v_add_f32 v21, v21, v23
    s_waitcnt vmcnt(5)
    v_lshlrev_b32 v22, 16, v98
    v_and_b32 v23, 0xffff0000, v98
    v_add_f32 v20, v20, v22
    v_add_f32 v21, v21, v23
    s_waitcnt vmcnt(4)
    v_lshlrev_b32 v22, 16, v99
    v_and_b32 v23, 0xffff0000, v99
    v_add_f32 v20, v20, v22
    v_add_f32 v21, v21, v23
    s_waitcnt vmcnt(3)
    v_lshlrev_b32 v22, 16, v100
    v_and_b32 v23, 0xffff0000, v100
    v_add_f32 v20, v20, v22
    v_add_f32 v21, v21, v23
    s_waitcnt vmcnt(2)
    v_lshlrev_b32 v22, 16, v101
    v_and_b32 v23, 0xffff0000, v101
    v_add_f32 v20, v20, v22
    v_add_f32 v21, v21, v23
    s_waitcnt vmcnt(1)
    v_lshlrev_b32 v22, 16, v102
    v_and_b32 v23, 0xffff0000, v102
    v_add_f32 v20, v20, v22
    v_add_f32 v21, v21, v23
    s_waitcnt vmcnt(0)
    v_lshlrev_b32 v22, 16, v103
    v_and_b32 v23, 0xffff0000, v103
    v_add_f32 v20, v20, v22
    v_add_f32 v21, v21, v23
    v_cmp_u_f32 vcc, v20, v21
    v_cvt_pk_bf16_f32 v20, v20, v21
    s_cbranch_vccnz L_v_gf_257
L_v_gok_256:
    buffer_store_dword v20, v8, s[12:15], s61 offen
    s_xor_b32 s45, s61, 0x8000
    buffer_store_dword v26, v8, s[12:15], s45 offen
    s_bitcmp1_b32 s44, 0
    s_cbranch_scc1 L_v_nr_258
    s_xor_b32 s45, s62, 0x4000
    buffer_store_dword v26, v4, s[12:15], s45 offen
L_v_nr_258:
    s_add_u32 s60, s60, 1
    s_add_u32 s62, s62, 0x2000
    s_and_b32 s62, s62, 0x7fff
    s_and_b32 s45, s60, 0x38
    s_bitcmp1_b64 s[66:67], s45
    s_cselect_b32 s45, 8192, 0
    s_lshl_b32 s63, s60, 18
    s_add_u32 s63, s63, s45
    v_mfma_f32_16x16x32_bf16 v[88:91], v[32:35], a[112:115], 0
    v_mfma_f32_16x16x32_bf16 v[92:95], v[48:51], a[112:115], 0
    v_mfma_f32_16x16x32_bf16 v[88:91], v[36:39], a[116:119], v[88:91]
    v_mfma_f32_16x16x32_bf16 v[92:95], v[52:55], a[116:119], v[92:95]
    v_mfma_f32_16x16x32_bf16 v[88:91], v[40:43], a[120:123], v[88:91]
    v_mfma_f32_16x16x32_bf16 v[92:95], v[56:59], a[120:123], v[92:95]
    v_mfma_f32_16x16x32_bf16 v[88:91], v[44:47], a[124:127], v[88:91]
    v_mfma_f32_16x16x32_bf16 v[92:95], v[60:63], a[124:127], v[92:95]
    v_cvt_pk_bf16_f32 v80, v80, v81
    v_cvt_pk_bf16_f32 v81, v82, v83
    v_cvt_pk_bf16_f32 v82, v84, v85
    v_cvt_pk_bf16_f32 v83, v86, v87
    ds_write_b128 v10, v[80:83] offset:34816
    s_nop 2
    v_cvt_pk_bf16_f32 v88, v88, v89
    v_cvt_pk_bf16_f32 v89, v90, v91
    v_cvt_pk_bf16_f32 v90, v92, v93
    v_cvt_pk_bf16_f32 v91, v94, v95
    ds_write_b128 v10, v[88:91] offset:35840
    s_sleep 3
    s_branch L_v_loop_240
L_v_last_244:
    s_waitcnt lgkmcnt(0)
    s_barrier
    s_branch L_replica
L_v_l1_241:
    s_mov_b64 exec, s[48:49]
    s_cbranch_execz L_v_ls_259
    buffer_load_dwordx4 v[64:67], v9, s[12:15], s61 offen offset:0 sc1
L_v_ls_259:
    s_mov_b64 exec, s[50:51]
    s_cbranch_execz L_v_ls_260
    buffer_load_dwordx4 v[68:71], v9, s[12:15], s61 offen offset:1024 sc1
L_v_ls_260:
    s_mov_b64 exec, s[52:53]
    s_cbranch_execz L_v_ls_261
    buffer_load_dwordx4 v[72:75], v9, s[12:15], s61 offen offset:2048 sc1
L_v_ls_261:
    s_mov_b64 exec, s[54:55]
    s_cbranch_execz L_v_ls_262
    buffer_load_dwordx4 v[76:79], v9, s[12:15], s61 offen offset:3072 sc1
L_v_ls_262:
    s_mov_b64 exec, -1
    s_add_u32 s70, s70, 1
    s_cmp_ge_u32 s70, 524288
    s_cbranch_scc1 L_c_done_1
    s_waitcnt vmcnt(0)
    s_cmp_eq_u64 s[48:49], 0
    s_cbranch_scc1 L_v_lc_263
    ds_write_b128 v10, v[64:67] offset:0
    v_max3_u32 v24, v64, v65, v66
    v_max_u32 v24, v24, v67
    v_cmp_eq_u32 s[48:49], -1, v24
L_v_lc_263:
    s_cmp_eq_u64 s[50:51], 0
    s_cbranch_scc1 L_v_lc_264
    ds_write_b128 v10, v[68:71] offset:1024
    v_max3_u32 v24, v68, v69, v70
    v_max_u32 v24, v24, v71
    v_cmp_eq_u32 s[50:51], -1, v24
L_v_lc_264:
    s_cmp_eq_u64 s[52:53], 0
    s_cbranch_scc1 L_v_lc_265
    ds_write_b128 v10, v[72:75] offset:2048
    v_max3_u32 v24, v72, v73, v74
    v_max_u32 v24, v24, v75
    v_cmp_eq_u32 s[52:53], -1, v24
L_v_lc_265:
    s_cmp_eq_u64 s[54:55], 0
    s_cbranch_scc1 L_v_lc_266
    ds_write_b128 v10, v[76:79] offset:3072
    v_max3_u32 v24, v76, v77, v78
    v_max_u32 v24, v24, v79
    v_cmp_eq_u32 s[54:55], -1, v24
L_v_lc_266:
    s_or_b64 s[46:47], s[48:49], s[50:51]
    s_or_b64 vcc, s[52:53], s[54:55]
    s_or_b64 vcc, vcc, s[46:47]
    s_cbranch_scc1 L_v_l1_241
    s_branch L_v_l1ok_243
L_v_k1_245_c:
    s_add_u32 s46, s65, 4096
    buffer_load_dwordx4 v[32:35], v15, s[12:15], s65 offen offset:0 sc1
    buffer_load_dwordx4 v[48:51], v15, s[12:15], s46 offen offset:0 sc1
    buffer_load_dwordx4 v[36:39], v15, s[12:15], s65 offen offset:1024 sc1
    buffer_load_dwordx4 v[52:55], v15, s[12:15], s46 offen offset:1024 sc1
    buffer_load_dwordx4 v[40:43], v15, s[12:15], s65 offen offset:2048 sc1
    buffer_load_dwordx4 v[56:59], v15, s[12:15], s46 offen offset:2048 sc1
    buffer_load_dwordx4 v[44:47], v15, s[12:15], s65 offen offset:3072 sc1
    buffer_load_dwordx4 v[60:63], v15, s[12:15], s46 offen offset:3072 sc1
    s_add_u32 s65, s65, 786432
    s_branch L_v_k1_245
L_rt_247:
    s_add_u32 s70, s70, 1
    s_cmp_lt_u32 s70, 524288
    s_cbranch_scc1 L_v_rl_246
    s_branch L_c_done_1
L_v_vp_249:
    buffer_load_dwordx4 v[64:67], v11, s[12:15], s62 offen offset:0 sc1
    buffer_load_dwordx4 v[68:71], v11, s[12:15], s62 offen offset:1024 sc1
    s_branch L_v_vp_249_m
L_rt_250:
    s_add_u32 s70, s70, 1
    s_cmp_lt_u32 s70, 524288
    s_cbranch_scc1 L_v_vp_249
    s_branch L_c_done_1
L_v_vt_252:
    v_lshrrev_b32 v22, 3, v1
    v_lshlrev_b32 v22, 7, v22
    s_mov_b32 s45, 0x101800
    s_mov_b32 s46, 0
    s_mov_b32 s70, 0
L_spin_267:
    buffer_load_dword v23, v22, s[12:15], s45 offen sc1
    s_waitcnt vmcnt(0)
    v_cmp_ge_u32 vcc, s46, v23
    s_add_u32 s70, s70, 1
    s_cbranch_vccz L_spok_268
    s_sleep 3
    s_cmp_lt_u32 s70, 524288
    s_cbranch_scc1 L_spin_267
    s_branch L_c_done_1
L_spok_268:
    v_cmp_eq_u32 s[66:67], 3, v23
    s_nop 3
    s_bitcmp1_b32 s66, 0
    s_cselect_b32 s45, 8192, 0
    s_add_u32 s63, s63, s45
    s_branch L_v_vt_252_b
L_v_fl_254:
    v_and_b32 v22, 31, v1
    v_lshlrev_b32 v22, 7, v22
    s_mov_b32 s46, 0x109400
    s_mov_b32 s47, 56
    s_mov_b32 s70, 0
L_spin_269:
    buffer_load_dword v23, v22, s[12:15], s46 offen sc1
    s_waitcnt vmcnt(0)
    v_cmp_ge_u32 vcc, s47, v23
    s_add_u32 s70, s70, 1
    s_cbranch_vccz L_spok_270
    s_sleep 3
    s_cmp_lt_u32 s70, 524288
    s_cbranch_scc1 L_spin_269
    s_branch L_c_done_1
L_spok_270:
    s_branch L_v_fl_254_b
L_v_nx_253_s:
    s_sleep 2
    s_branch L_v_nx_253
L_v_gf_257:
    v_max3_u32 v24, v96, v97, v98
    v_max3_u32 v24, v24, v99, v100
    v_max3_u32 v24, v24, v101, v102
    v_max_u32 v24, v24, v103
    v_cmp_eq_u32 vcc, -1, v24
    v_min_u32 v20, -2, v20
    s_add_u32 s70, s70, 1
    s_cbranch_vccz L_v_gok_256
    buffer_load_dword v96, v7, s[12:15], s63 offen offset:0 sc1
    buffer_load_dword v97, v7, s[12:15], s63 offen offset:256 sc1
    buffer_load_dword v98, v7, s[12:15], s63 offen offset:512 sc1
    buffer_load_dword v99, v7, s[12:15], s63 offen offset:768 sc1
    buffer_load_dword v100, v7, s[12:15], s63 offen offset:1024 sc1
    buffer_load_dword v101, v7, s[12:15], s63 offen offset:1280 sc1
    buffer_load_dword v102, v7, s[12:15], s63 offen offset:1536 sc1
    buffer_load_dword v103, v7, s[12:15], s63 offen offset:1792 sc1
    s_cmp_lt_u32 s70, 524288
    s_cbranch_scc1 L_v_gp_255
    s_branch L_c_done_1
L_vs_199:
    s_mov_b32 s70, 1
    v_mov_b32 v16, 0
    v_mov_b32 v17, 0
    s_branch L_v_l1m_273
.p2align 6
L_v_loop_271:
    s_mov_b32 s70, 1
    buffer_load_dwordx4 v[64:67], v9, s[12:15], s61 offen offset:0 sc1
    buffer_load_dwordx4 v[68:71], v9, s[12:15], s61 offen offset:1024 sc1
    buffer_load_dwordx4 v[72:75], v9, s[12:15], s61 offen offset:2048 sc1
    buffer_load_dwordx4 v[76:79], v9, s[12:15], s61 offen offset:3072 sc1
    v_mov_b32 v16, 0
    v_mov_b32 v17, 0
    v_mov_b32 v18, 0
    v_mov_b32 v19, 0
    v_mov_b32 v20, 0
    v_mov_b32 v21, 0
    v_mov_b32 v22, 0
    v_mov_b32 v23, 0
L_v_l1m_273:
    s_waitcnt vmcnt(3)
    ds_write_b128 v10, v[64:67] offset:0
    v_max3_u32 v24, v64, v65, v66
    v_max_u32 v24, v24, v67
    v_cmp_eq_u32 s[48:49], -1, v24
    s_waitcnt vmcnt(2)
    ds_write_b128 v10, v[68:71] offset:1024
    v_max3_u32 v24, v68, v69, v70
    v_max_u32 v24, v24, v71
    v_cmp_eq_u32 s[50:51], -1, v24
    s_waitcnt vmcnt(1)
    ds_write_b128 v10, v[72:75] offset:2048
    v_max3_u32 v24, v72, v73, v74
    v_max_u32 v24, v24, v75
    v_cmp_eq_u32 s[52:53], -1, v24
    s_waitcnt vmcnt(0)
    ds_write_b128 v10, v[76:79] offset:3072
    v_max3_u32 v24, v76, v77, v78
    v_max_u32 v24, v24, v79
    v_cmp_eq_u32 s[54:55], -1, v24
    s_or_b64 s[46:47], s[48:49], s[50:51]
    s_or_b64 vcc, s[52:53], s[54:55]
    s_or_b64 vcc, vcc, s[46:47]
    s_cbranch_scc1 L_v_l1_272
L_v_l1ok_274:
    s_waitcnt lgkmcnt(0)
    s_barrier
    v_smfmac_f32_16x16x64_bf16 v[16:19], v[64:67], a[0:7], v3
    v_smfmac_f32_16x16x64_bf16 v[20:23], v[64:67], a[32:39], v3
    v_smfmac_f32_16x16x64_bf16 v[16:19], v[68:71], a[8:15], v3
    v_smfmac_f32_16x16x64_bf16 v[20:23], v[68:71], a[40:47], v3
    v_smfmac_f32_16x16x64_bf16 v[16:19], v[72:75], a[16:23], v3
    v_smfmac_f32_16x16x64_bf16 v[20:23], v[72:75], a[48:55], v3
    v_smfmac_f32_16x16x64_bf16 v[16:19], v[76:79], a[24:31], v3
    v_smfmac_f32_16x16x64_bf16 v[20:23], v[76:79], a[56:63], v3
    s_nop 6
    v_permlane32_swap_b32 v16, v18
    v_permlane32_swap_b32 v17, v19
    v_permlane32_swap_b32 v20, v22
    v_permlane32_swap_b32 v21, v23
    v_add_f32 v16, v16, v18
    v_add_f32 v17, v17, v19
    v_add_f32 v18, v20, v22
    v_add_f32 v19, v21, v23
    ds_write_b128 v14, v[16:19]
    s_mov_b64 exec, 1
    ds_add_u32 v29, v30
    s_mov_b64 exec, -1
    s_add_u32 s58, s58, 4
    s_bitcmp1_b32 s44, 0
    s_cbranch_scc1 L_v_k1_276_c
    s_mov_b32 s70, 0
L_v_rl_277:
    ds_read_b32 v24, v29
    ds_read_b64 v[16:17], v13 offset:0
    ds_read_b64 v[18:19], v13 offset:1024
    ds_read_b64 v[20:21], v13 offset:2048
    ds_read_b64 v[22:23], v13 offset:3072
    s_waitcnt lgkmcnt(2)
    v_cmp_ne_u32 vcc, s58, v24
    v_add_f32 v16, v16, v18
    v_add_f32 v17, v17, v19
    s_waitcnt lgkmcnt(0)
    s_cbranch_vccnz L_rt_278
    v_add_f32 v20, v20, v22
    v_add_f32 v21, v21, v23
    v_add_f32 v16, v16, v20
    v_add_f32 v17, v17, v21
    s_mov_b32 vcc_lo, 0x55555555
    s_mov_b32 vcc_hi, 0x55555555
    v_cndmask_b32_dpp v18, v17, v16, vcc quad_perm:[1,0,3,2] row_mask:0xf bank_mask:0xf
    s_not_b64 vcc, vcc
    v_cndmask_b32_dpp v19, v16, v17, vcc quad_perm:[1,0,3,2] row_mask:0xf bank_mask:0xf
    v_cvt_pk_bf16_f32 v18, v18, v19
    v_min_u32 v18, -2, v18
    buffer_store_dword v18, v4, s[12:15], s62 offen sc1
    ds_write_b32 v5, v18
L_v_k1_276:
    s_cmp_eq_u32 s60, 63
    s_cbranch_scc1 L_v_last_275
    ds_read_b128 v[80:83], v27 offset:32768
    ds_read_b128 v[84:87], v27 offset:36864
    ds_read_b128 v[88:91], v27 offset:40960
    ds_read_b128 v[92:95], v27 offset:45056
    v_mov_b32 v96, 0
    v_mov_b32 v97, 0
    v_mov_b32 v98, 0
    v_mov_b32 v99, 0
    v_mov_b32 v100, 0
    v_mov_b32 v101, 0
    v_mov_b32 v102, 0
    v_mov_b32 v103, 0
    v_mov_b32 v104, 0
    v_mov_b32 v105, 0
    v_mov_b32 v106, 0
    v_mov_b32 v107, 0
    v_mov_b32 v108, 0
    v_mov_b32 v109, 0
    v_mov_b32 v110, 0
    v_mov_b32 v111, 0
    s_bitcmp1_b32 s44, 0
    s_cbranch_scc0 L_v_sv_279
    s_sleep 1
L_v_sv_279:
    s_sleep 3
    s_mov_b32 s70, 1
    buffer_load_dwordx4 v[64:67], v11, s[12:15], s62 offen offset:0 sc1
    buffer_load_dwordx4 v[68:71], v11, s[12:15], s62 offen offset:1024 sc1
L_v_vp_280_m:
    s_waitcnt vmcnt(0)
    v_max3_u32 v20, v64, v65, v66
    v_max3_u32 v20, v20, v67, v68
    v_max3_u32 v20, v20, v69, v70
    v_max_u32 v20, v20, v71
    v_cmp_eq_u32 vcc, -1, v20
    s_cbranch_vccnz L_rt_281
    v_smfmac_f32_16x16x64_bf16 v[96:99], v[64:67], a[64:71], v3
    v_smfmac_f32_16x16x64_bf16 v[96:99], v[68:71], a[72:79], v3
    v_smfmac_f32_16x16x64_bf16 v[100:103], v[64:67], a[80:87], v3
    v_smfmac_f32_16x16x64_bf16 v[100:103], v[68:71], a[88:95], v3
    v_smfmac_f32_16x16x64_bf16 v[104:107], v[64:67], a[96:103], v3
    v_smfmac_f32_16x16x64_bf16 v[104:107], v[68:71], a[104:111], v3
    v_smfmac_f32_16x16x64_bf16 v[108:111], v[64:67], a[112:119], v3
    v_smfmac_f32_16x16x64_bf16 v[108:111], v[68:71], a[120:127], v3
    s_nop 1
    v_cvt_pk_bf16_f32 v96, v96, v97
    v_cvt_pk_bf16_f32 v97, v98, v99
    ds_write_b64 v12, v[96:97] offset:0
    v_cvt_pk_bf16_f32 v100, v100, v101
    v_cvt_pk_bf16_f32 v101, v102, v103
    ds_write_b64 v12, v[100:101] offset:2048
    v_cvt_pk_bf16_f32 v104, v104, v105
    v_cvt_pk_bf16_f32 v105, v106, v107
    ds_write_b64 v12, v[104:105] offset:4096
    v_cvt_pk_bf16_f32 v108, v108, v109
    v_cvt_pk_bf16_f32 v109, v110, v111
    ds_write_b64 v12, v[108:109] offset:6144
    s_bitcmp1_b32 s44, 0
    s_cbranch_scc1 L_v_r8_282
L_v_r8_282_l:
    s_add_u32 s46, s65, 4096
    buffer_load_dwordx4 v[32:35], v15, s[12:15], s65 offen offset:0 sc1
    buffer_load_dwordx4 v[48:51], v15, s[12:15], s46 offen offset:0 sc1
    buffer_load_dwordx4 v[36:39], v15, s[12:15], s65 offen offset:1024 sc1
    buffer_load_dwordx4 v[52:55], v15, s[12:15], s46 offen offset:1024 sc1
    buffer_load_dwordx4 v[40:43], v15, s[12:15], s65 offen offset:2048 sc1
    buffer_load_dwordx4 v[56:59], v15, s[12:15], s46 offen offset:2048 sc1
    buffer_load_dwordx4 v[44:47], v15, s[12:15], s65 offen offset:3072 sc1
    buffer_load_dwordx4 v[60:63], v15, s[12:15], s46 offen offset:3072 sc1
    s_add_u32 s65, s65, 786432
L_v_r8_282:
    s_cmp_eq_u32 s60, 0
    s_cbranch_scc1 L_v_vt_283
L_v_vt_283_b:
    s_waitcnt lgkmcnt(0)
    s_barrier
    ds_read_b128 v[96:99], v2 offset:16384
    ds_read_b128 v[100:103], v2 offset:17408
    ds_read_b128 v[104:107], v2 offset:18432
    ds_read_b128 v[108:111], v2 offset:19456
    ds_read_b128 v[112:115], v31 offset:0
    ds_read_b128 v[116:119], v25 offset:0
    ds_read_b128 v[120:123], v31 offset:512
    ds_read_b128 v[124:127], v25 offset:1024
    s_waitcnt lgkmcnt(7)
    v_mfma_f32_16x16x32_bf16 v[16:19], v[80:83], v[96:99], 0
    s_waitcnt lgkmcnt(6)
    v_mfma_f32_16x16x32_bf16 v[16:19], v[84:87], v[100:103], v[16:19]
    s_waitcnt lgkmcnt(5)
    v_mfma_f32_16x16x32_bf16 v[16:19], v[88:91], v[104:107], v[16:19]
    s_waitcnt lgkmcnt(4)
    v_mfma_f32_16x16x32_bf16 v[16:19], v[92:95], v[108:111], v[16:19]
    s_waitcnt lgkmcnt(2)
    v_mfma_f32_16x16x32_bf16 v[16:19], v[116:119], v[112:115], v[16:19]
    s_waitcnt lgkmcnt(0)
    v_mfma_f32_16x16x32_bf16 v[16:19], v[124:127], v[120:123], v[16:19]
    s_mov_b32 exec_lo, 0x00ff00ff
    s_mov_b32 exec_hi, 0x00ff00ff
    s_nop 5
    v_cvt_pk_bf16_f32 v16, v16, v17
    v_cvt_pk_bf16_f32 v17, v18, v19
    v_min_u32 v16, -2, v16
    v_min_u32 v17, -2, v17
    buffer_store_dwordx2 v[16:17], v6, s[12:15], s63 offen sc1
    s_mov_b64 exec, -1
    s_waitcnt vmcnt(1)
    s_sub_u32 s45, s60, 3
    s_cmp_ge_u32 s45, 24
    s_cbranch_scc1 L_v_nx_284_s
    s_cmp_eq_u32 s45, 0
    s_cbranch_scc1 L_v_fl_285
L_v_fl_285_b:
    s_and_b32 s46, s45, 1
    s_lshl_b32 s47, s46, 14
    s_add_u32 s47, s47, s59
    s_lshl_b32 s46, s46, 15
    s_lshr_b32 s48, s45, 2
    s_lshl_b32 s48, s48, 16
    s_add_u32 s46, s46, s48
    s_and_b32 s48, s45, 2
    s_lshl_b32 s48, s48, 7
    s_add_u32 s46, s46, s48
    s_add_u32 m0, s47, 0
    s_add_u32 s48, s46, 0
    buffer_load_dwordx4 v28, s[12:15], s48 offen sc1 lds
    s_add_u32 m0, s47, 1024
    s_add_u32 s48, s46, 2048
    buffer_load_dwordx4 v28, s[12:15], s48 offen sc1 lds
    s_add_u32 m0, s47, 2048
    s_add_u32 s48, s46, 4096
    buffer_load_dwordx4 v28, s[12:15], s48 offen sc1 lds
    s_add_u32 m0, s47, 3072
    s_add_u32 s48, s46, 6144
    buffer_load_dwordx4 v28, s[12:15], s48 offen sc1 lds
L_v_nx_284:
    s_add_u32 s61, s61, 0x4000
    s_and_b32 s61, s61, 0xffff
    s_mov_b32 s70, 1
    s_sleep 5
    buffer_load_dword v96, v7, s[12:15], s63 offen offset:0 sc1
    buffer_load_dword v97, v7, s[12:15], s63 offen offset:256 sc1
    buffer_load_dword v98, v7, s[12:15], s63 offen offset:512 sc1
    buffer_load_dword v99, v7, s[12:15], s63 offen offset:768 sc1
    buffer_load_dword v100, v7, s[12:15], s63 offen offset:1024 sc1
    buffer_load_dword v101, v7, s[12:15], s63 offen offset:1280 sc1
    buffer_load_dword v102, v7, s[12:15], s63 offen offset:1536 sc1
    buffer_load_dword v103, v7, s[12:15], s63 offen offset:1792 sc1
    v_mfma_f32_16x16x32_bf16 v[64:67], v[32:35], a[64:67], 0
    v_mfma_f32_16x16x32_bf16 v[68:71], v[48:51], a[64:67], 0
    v_mfma_f32_16x16x32_bf16 v[64:67], v[36:39], a[68:71], v[64:67]
    v_mfma_f32_16x16x32_bf16 v[68:71], v[52:55], a[68:71], v[68:71]
    v_mfma_f32_16x16x32_bf16 v[64:67], v[40:43], a[72:75], v[64:67]
    v_mfma_f32_16x16x32_bf16 v[68:71], v[56:59], a[72:75], v[68:71]
    v_mfma_f32_16x16x32_bf16 v[64:67], v[44:47], a[76:79], v[64:67]
    v_mfma_f32_16x16x32_bf16 v[68:71], v[60:63], a[76:79], v[68:71]
    v_mfma_f32_16x16x32_bf16 v[72:75], v[32:35], a[80:83], 0
    v_mfma_f32_16x16x32_bf16 v[76:79], v[48:51], a[80:83], 0
    v_mfma_f32_16x16x32_bf16 v[72:75], v[36:39], a[84:87], v[72:75]
    v_mfma_f32_16x16x32_bf16 v[76:79], v[52:55], a[84:87], v[76:79]
    v_mfma_f32_16x16x32_bf16 v[72:75], v[40:43], a[88:91], v[72:75]
    v_mfma_f32_16x16x32_bf16 v[76:79], v[56:59], a[88:91], v[76:79]
    v_mfma_f32_16x16x32_bf16 v[72:75], v[44:47], a[92:95], v[72:75]
    v_mfma_f32_16x16x32_bf16 v[76:79], v[60:63], a[92:95], v[76:79]
    v_cvt_pk_bf16_f32 v64, v64, v65
    v_cvt_pk_bf16_f32 v65, v66, v67
    v_cvt_pk_bf16_f32 v66, v68, v69
    v_cvt_pk_bf16_f32 v67, v70, v71
    ds_write_b128 v10, v[64:67] offset:32768
    v_mfma_f32_16x16x32_bf16 v[80:83], v[32:35], a[96:99], 0
    v_mfma_f32_16x16x32_bf16 v[84:87], v[48:51], a[96:99], 0
    v_mfma_f32_16x16x32_bf16 v[80:83], v[36:39], a[100:103], v[80:83]
    v_mfma_f32_16x16x32_bf16 v[84:87], v[52:55], a[100:103], v[84:87]
    v_mfma_f32_16x16x32_bf16 v[80:83], v[40:43], a[104:107], v[80:83]
    v_mfma_f32_16x16x32_bf16 v[84:87], v[56:59], a[104:107], v[84:87]
    v_mfma_f32_16x16x32_bf16 v[80:83], v[44:47], a[108:111], v[80:83]
    v_mfma_f32_16x16x32_bf16 v[84:87], v[60:63], a[108:111], v[84:87]
    v_cvt_pk_bf16_f32 v72, v72, v73
    v_cvt_pk_bf16_f32 v73, v74, v75
    v_cvt_pk_bf16_f32 v74, v76, v77
    v_cvt_pk_bf16_f32 v75, v78, v79
    ds_write_b128 v10, v[72:75] offset:33792
L_v_gp_286:
    s_waitcnt vmcnt(7)
    v_lshlrev_b32 v20, 16, v96
    v_and_b32 v21, 0xffff0000, v96
    s_waitcnt vmcnt(6)
    v_lshlrev_b32 v22, 16, v97
    v_and_b32 v23, 0xffff0000, v97
    v_add_f32 v20, v20, v22
    v_add_f32 v21, v21, v23
    s_waitcnt vmcnt(5)
    v_lshlrev_b32 v22, 16, v98
    v_and_b32 v23, 0xffff0000, v98
    v_add_f32 v20, v20, v22
    v_add_f32 v21, v21, v23
    s_waitcnt vmcnt(4)
    v_lshlrev_b32 v22, 16, v99
    v_and_b32 v23, 0xffff0000, v99
    v_add_f32 v20, v20, v22
    v_add_f32 v21, v21, v23
    s_waitcnt vmcnt(3)
    v_lshlrev_b32 v22, 16, v100
    v_and_b32 v23, 0xffff0000, v100
    v_add_f32 v20, v20, v22
    v_add_f32 v21, v21, v23
    s_waitcnt vmcnt(2)
    v_lshlrev_b32 v22, 16, v101
    v_and_b32 v23, 0xffff0000, v101
    v_add_f32 v20, v20, v22
    v_add_f32 v21, v21, v23
    s_waitcnt vmcnt(1)
    v_lshlrev_b32 v22, 16, v102
    v_and_b32 v23, 0xffff0000, v102
    v_add_f32 v20, v20, v22
    v_add_f32 v21, v21, v23
    s_waitcnt vmcnt(0)
    v_lshlrev_b32 v22, 16, v103
    v_and_b32 v23, 0xffff0000, v103
    v_add_f32 v20, v20, v22
    v_add_f32 v21, v21, v23
    v_cmp_u_f32 vcc, v20, v21
    v_cvt_pk_bf16_f32 v20, v20, v21
    s_cbranch_vccnz L_v_gf_288
L_v_gok_287:
    buffer_store_dword v20, v8, s[12:15], s61 offen sc1
    s_xor_b32 s45, s61, 0x8000
    buffer_store_dword v26, v8, s[12:15], s45 offen sc1
    s_bitcmp1_b32 s44, 0
    s_cbranch_scc1 L_v_nr_289
    s_xor_b32 s45, s62, 0x4000
    buffer_store_dword v26, v4, s[12:15], s45 offen sc1
L_v_nr_289:
    s_add_u32 s60, s60, 1
    s_add_u32 s62, s62, 0x2000
    s_and_b32 s62, s62, 0x7fff
    s_and_b32 s45, s60, 0x38
    s_bitcmp1_b64 s[66:67], s45
    s_cselect_b32 s45, 8192, 0
    s_lshl_b32 s63, s60, 18
    s_add_u32 s63, s63, s45
    v_mfma_f32_16x16x32_bf16 v[88:91], v[32:35], a[112:115], 0
    v_mfma_f32_16x16x32_bf16 v[92:95], v[48:51], a[112:115], 0
    v_mfma_f32_16x16x32_bf16 v[88:91], v[36:39], a[116:119], v[88:91]
    v_mfma_f32_16x16x32_bf16 v[92:95], v[52:55], a[116:119], v[92:95]
    v_mfma_f32_16x16x32_bf16 v[88:91], v[40:43], a[120:123], v[88:91]
    v_mfma_f32_16x16x32_bf16 v[92:95], v[56:59], a[120:123], v[92:95]
    v_mfma_f32_16x16x32_bf16 v[88:91], v[44:47], a[124:127], v[88:91]
    v_mfma_f32_16x16x32_bf16 v[92:95], v[60:63], a[124:127], v[92:95]
    v_cvt_pk_bf16_f32 v80, v80, v81
    v_cvt_pk_bf16_f32 v81, v82, v83
    v_cvt_pk_bf16_f32 v82, v84, v85
    v_cvt_pk_bf16_f32 v83, v86, v87
    ds_write_b128 v10, v[80:83] offset:34816
    s_nop 2
    v_cvt_pk_bf16_f32 v88, v88, v89
    v_cvt_pk_bf16_f32 v89, v90, v91
    v_cvt_pk_bf16_f32 v90, v92, v93
    v_cvt_pk_bf16_f32 v91, v94, v95
    ds_write_b128 v10, v[88:91] offset:35840
    s_sleep 3
    s_branch L_v_loop_271
L_v_last_275:
    s_waitcnt lgkmcnt(0)
    s_barrier
    s_branch L_replica
L_v_l1_272:
    s_mov_b64 exec, s[48:49]
    s_cbranch_execz L_v_ls_290
    buffer_load_dwordx4 v[64:67], v9, s[12:15], s61 offen offset:0 sc1
L_v_ls_290:
    s_mov_b64 exec, s[50:51]
    s_cbranch_execz L_v_ls_291
    buffer_load_dwordx4 v[68:71], v9, s[12:15], s61 offen offset:1024 sc1
L_v_ls_291:
    s_mov_b64 exec, s[52:53]
    s_cbranch_execz L_v_ls_292
    buffer_load_dwordx4 v[72:75], v9, s[12:15], s61 offen offset:2048 sc1
L_v_ls_292:
    s_mov_b64 exec, s[54:55]
    s_cbranch_execz L_v_ls_293
    buffer_load_dwordx4 v[76:79], v9, s[12:15], s61 offen offset:3072 sc1
L_v_ls_293:
    s_mov_b64 exec, -1
    s_add_u32 s70, s70, 1
    s_cmp_ge_u32 s70, 524288
    s_cbranch_scc1 L_c_done_1
    s_waitcnt vmcnt(0)
    s_cmp_eq_u64 s[48:49], 0
    s_cbranch_scc1 L_v_lc_294
    ds_write_b128 v10, v[64:67] offset:0
    v_max3_u32 v24, v64, v65, v66
    v_max_u32 v24, v24, v67
    v_cmp_eq_u32 s[48:49], -1, v24
L_v_lc_294:
    s_cmp_eq_u64 s[50:51], 0
    s_cbranch_scc1 L_v_lc_295
    ds_write_b128 v10, v[68:71] offset:1024
    v_max3_u32 v24, v68, v69, v70
    v_max_u32 v24, v24, v71
    v_cmp_eq_u32 s[50:51], -1, v24
L_v_lc_295:
    s_cmp_eq_u64 s[52:53], 0
    s_cbranch_scc1 L_v_lc_296
    ds_write_b128 v10, v[72:75] offset:2048
    v_max3_u32 v24, v72, v73, v74
    v_max_u32 v24, v24, v75
    v_cmp_eq_u32 s[52:53], -1, v24
L_v_lc_296:
    s_cmp_eq_u64 s[54:55], 0
    s_cbranch_scc1 L_v_lc_297
    ds_write_b128 v10, v[76:79] offset:3072
    v_max3_u32 v24, v76, v77, v78
    v_max_u32 v24, v24, v79
    v_cmp_eq_u32 s[54:55], -1, v24
L_v_lc_297:
    s_or_b64 s[46:47], s[48:49], s[50:51]
    s_or_b64 vcc, s[52:53], s[54:55]
    s_or_b64 vcc, vcc, s[46:47]
    s_cbranch_scc1 L_v_l1_272
    s_branch L_v_l1ok_274
L_v_k1_276_c:
    s_add_u32 s46, s65, 4096
    buffer_load_dwordx4 v[32:35], v15, s[12:15], s65 offen offset:0 sc1
    buffer_load_dwordx4 v[48:51], v15, s[12:15], s46 offen offset:0 sc1
    buffer_load_dwordx4 v[36:39], v15, s[12:15], s65 offen offset:1024 sc1
    buffer_load_dwordx4 v[52:55], v15, s[12:15], s46 offen offset:1024 sc1
    buffer_load_dwordx4 v[40:43], v15, s[12:15], s65 offen offset:2048 sc1
    buffer_load_dwordx4 v[56:59], v15, s[12:15], s46 offen offset:2048 sc1
    buffer_load_dwordx4 v[44:47], v15, s[12:15], s65 offen offset:3072 sc1
    buffer_load_dwordx4 v[60:63], v15, s[12:15], s46 offen offset:3072 sc1
    s_add_u32 s65, s65, 786432
    s_branch L_v_k1_276
L_rt_278:
    s_add_u32 s70, s70, 1
    s_cmp_lt_u32 s70, 524288
    s_cbranch_scc1 L_v_rl_277
    s_branch L_c_done_1
L_v_vp_280:
    buffer_load_dwordx4 v[64:67], v11, s[12:15], s62 offen offset:0 sc1
    buffer_load_dwordx4 v[68:71], v11, s[12:15], s62 offen offset:1024 sc1
    s_branch L_v_vp_280_m
L_rt_281:
    s_add_u32 s70, s70, 1
    s_cmp_lt_u32 s70, 524288
    s_cbranch_scc1 L_v_vp_280
    s_branch L_c_done_1
L_v_vt_283:
    v_lshrrev_b32 v22, 3, v1
    v_lshlrev_b32 v22, 7, v22
    s_mov_b32 s45, 0x101800
    s_mov_b32 s46, 0
    s_mov_b32 s70, 0
L_spin_298:
    buffer_load_dword v23, v22, s[12:15], s45 offen sc1
    s_waitcnt vmcnt(0)
    v_cmp_ge_u32 vcc, s46, v23
    s_add_u32 s70, s70, 1
    s_cbranch_vccz L_spok_299
    s_sleep 3
    s_cmp_lt_u32 s70, 524288
    s_cbranch_scc1 L_spin_298
    s_branch L_c_done_1
L_spok_299:
    v_cmp_eq_u32 s[66:67], 3, v23
    s_nop 3
    s_bitcmp1_b32 s66, 0
    s_cselect_b32 s45, 8192, 0
    s_add_u32 s63, s63, s45
    s_branch L_v_vt_283_b
L_v_fl_285:
    v_and_b32 v22, 31, v1
    v_lshlrev_b32 v22, 7, v22
    s_mov_b32 s46, 0x109400
    s_mov_b32 s47, 56
    s_mov_b32 s70, 0
L_spin_300:
    buffer_load_dword v23, v22, s[12:15], s46 offen sc1
    s_waitcnt vmcnt(0)
    v_cmp_ge_u32 vcc, s47, v23
    s_add_u32 s70, s70, 1
    s_cbranch_vccz L_spok_301
    s_sleep 3
    s_cmp_lt_u32 s70, 524288
    s_cbranch_scc1 L_spin_300
    s_branch L_c_done_1
L_spok_301:
    s_branch L_v_fl_285_b
L_v_nx_284_s:
    s_sleep 2
    s_branch L_v_nx_284
L_v_gf_288:
    v_max3_u32 v24, v96, v97, v98
    v_max3_u32 v24, v24, v99, v100
    v_max3_u32 v24, v24, v101, v102
    v_max_u32 v24, v24, v103
    v_cmp_eq_u32 vcc, -1, v24
    v_min_u32 v20, -2, v20
    s_add_u32 s70, s70, 1
    s_cbranch_vccz L_v_gok_287
    buffer_load_dword v96, v7, s[12:15], s63 offen offset:0 sc1
    buffer_load_dword v97, v7, s[12:15], s63 offen offset:256 sc1
    buffer_load_dword v98, v7, s[12:15], s63 offen offset:512 sc1
    buffer_load_dword v99, v7, s[12:15], s63 offen offset:768 sc1
    buffer_load_dword v100, v7, s[12:15], s63 offen offset:1024 sc1
    buffer_load_dword v101, v7, s[12:15], s63 offen offset:1280 sc1
    buffer_load_dword v102, v7, s[12:15], s63 offen offset:1536 sc1
    buffer_load_dword v103, v7, s[12:15], s63 offen offset:1792 sc1
    s_cmp_lt_u32 s70, 524288
    s_cbranch_scc1 L_v_gp_286
    s_branch L_c_done_1
L_c_done_1:
    s_endpgm
.section .rodata,"a"
.p2align 6
.amdhsa_kernel k3_chain_kernel
  .amdhsa_next_free_vgpr 256
  .amdhsa_next_free_sgpr 102
  .amdhsa_accum_offset 128
  .amdhsa_group_segment_fixed_size 0
  .amdhsa_kernarg_size 136
  .amdhsa_user_sgpr_count 2
  .amdhsa_user_sgpr_kernarg_segment_ptr 1
  .amdhsa_system_sgpr_workgroup_id_x 1
.end_amdhsa_kernel
```
